```python
import torch

def _softmax(x, axis=-1):
    return torch.softmax(x, dim=axis)
def _gelu(x):
    return torch.nn.functional.gelu(x, approximate="tanh")
def _silu(x):
    return torch.nn.functional.silu(x)
def _sigmoid(x):
    return torch.sigmoid(x)
def _layernorm(x, axis=-1, eps=1e-5):
    m = x.mean(dim=axis, keepdim=True)
    v = x.var(dim=axis, keepdim=True, unbiased=False)
    return (x - m) / torch.sqrt(v + eps)
def _scatter_add(tgt, idx, src, axis=0):
    return tgt.clone().index_add_(axis, idx, src)
def _segment_sum(src, seg, n):
    out = torch.zeros((n,) + src.shape[1:], dtype=src.dtype)
    return out.index_add_(0, seg, src)
def _pad(x, pw):
    flat = tuple(v for pair in reversed(pw) for v in pair)
    return torch.nn.functional.pad(x, flat)

kernel_name = 'interleave_layers__sliding_local_dilated__linear_kernel_hedgehog__prompt'

def setup_inputs():

    _w = (lambda a: (lambda t: t.to(torch.bfloat16) if t.is_floating_point() else t)(torch.as_tensor(a)))
    def _A_setup():
        B, S, D = 1, 2048, 1024
        return {
            "x": _w((lambda *s: torch.randn(*s, dtype=torch.bfloat16) * 0.05)(B, S, D)),
            "wqkv": _w((lambda *s: torch.randn(*s, dtype=torch.bfloat16) * 0.05)(D, 3 * D)),
            "wo": _w((lambda *s: torch.randn(*s, dtype=torch.bfloat16) * 0.05)(D, D)),
        }
    _A_in = _A_setup()

    def _B_setup():
        B, S, D, H = 1, 2048, 1024, 32
        Dh = D // H
        return {
            "x": _w((lambda *s: torch.randn(*s, dtype=torch.bfloat16) * 0.05)(B, S, D)),
            "wqkv": _w((lambda *s: torch.randn(*s, dtype=torch.bfloat16) * 0.4)(D, 3 * D)),
            "w_phi": _w((lambda *s: torch.randn(*s, dtype=torch.bfloat16) * 0.4)(H, Dh, Dh) * (Dh ** -0.5)),
            "wo": _w((lambda *s: torch.randn(*s, dtype=torch.bfloat16) * 0.1)(D, D)),
        }
    _B_in = _B_setup()

    return {
        "A_x": _A_in["x"],
        "A_wqkv": _A_in["wqkv"],
        "A_wo": _A_in["wo"],
        "B_x": _B_in["x"],
        "B_wqkv": _B_in["wqkv"],
        "B_w_phi": _B_in["w_phi"],
        "B_wo": _B_in["wo"],
    }

def reference(A_x, A_wqkv, A_wo, B_x, B_wqkv, B_w_phi, B_wo):
    def _A_ref(x, wqkv, wo):
        B, S, D = x.shape
        H = 32; Dh = D // H
        W, dil = 8, 2
        qkv = (lambda x, *d: x.permute(*d))((x @ wqkv).reshape(B, S, 3, H, Dh), 2, 0, 3, 1, 4)
        q, k, v = qkv[0], qkv[1], qkv[2]
        scale = Dh ** -0.5
        pos = torch.arange(S)
        off = torch.arange(W) * dil
        idx = pos[:, None] - off[None, :]
        mask = idx >= 0
        idx_c = torch.where(mask, idx, 0).reshape(-1)
        kg = k[:, :, idx_c, :].reshape(B, H, S, W, Dh)
        vg = v[:, :, idx_c, :].reshape(B, H, S, W, Dh)
        logits = torch.einsum("bhsd,bhswd->bhsw", q, kg) * scale
        logits = torch.where(mask[None, None, :, :], logits, -1e9)
        attn = _softmax(logits, axis=-1)
        o = torch.einsum("bhsw,bhswd->bhsd", attn, vg)
        return (lambda x, *d: x.permute(*d))(o, 0, 2, 1, 3).reshape(B, S, D) @ wo

    def _B_ref(x, wqkv, w_phi, wo):
        B, S, D = x.shape
        H = 32; Dh = D // H
        qkv = (lambda x, *d: x.permute(*d))((x @ wqkv).reshape(B, S, 3, H, Dh), 2, 0, 3, 1, 4)
        q, k, v = qkv[0], qkv[1], qkv[2]
        pq = torch.einsum("bhsd,hdf->bhsf", q, w_phi)
        pk = torch.einsum("bhsd,hdf->bhsf", k, w_phi)
        phi_q = torch.concatenate([_softmax(pq, axis=-1), _softmax(-pq, axis=-1)], axis=-1)
        phi_k = torch.concatenate([_softmax(pk, axis=-1), _softmax(-pk, axis=-1)], axis=-1)
        kv = torch.einsum("bhsf,bhsd->bhfd", phi_k, v)
        z  = torch.einsum("bhsf->bhf", phi_k)
        num = torch.einsum("bhqf,bhfd->bhqd", phi_q, kv)
        den = torch.einsum("bhqf,bhf->bhq", phi_q, z)[..., None] + 1e-6
        o = num / den
        return (lambda x, *d: x.permute(*d))(o, 0, 2, 1, 3).reshape(B, S, D) @ wo

    x = A_x
    x = x + _A_ref(_layernorm(x, axis=-1), A_wqkv, A_wo)
    x = x + _B_ref(_layernorm(x, axis=-1), B_wqkv, B_w_phi, B_wo)
    x = x + _A_ref(_layernorm(x, axis=-1), A_wqkv, A_wo)
    x = x + _B_ref(_layernorm(x, axis=-1), B_wqkv, B_w_phi, B_wo)
    return x
```

```asm
; @launch kernel=qkv0_kernel grid=(256,1,1) block=(512,1,1) lds=155904
; @launch kernel=out0_kernel grid=(256,1,1) block=(256,1,1) lds=131072
; @launch kernel=qkv1_kernel grid=(256,1,1) block=(512,1,1) lds=155904
; @launch kernel=lin1_kernel grid=(256,1,1) block=(256,1,1) lds=12288
; @launch kernel=out1_kernel grid=(256,1,1) block=(256,1,1) lds=131072
; @launch kernel=qkv2_kernel grid=(256,1,1) block=(512,1,1) lds=155904
; @launch kernel=out2_kernel grid=(256,1,1) block=(256,1,1) lds=131072
; @launch kernel=qkv3_kernel grid=(256,1,1) block=(512,1,1) lds=155904
; @launch kernel=lin3_kernel grid=(256,1,1) block=(256,1,1) lds=12288
; @launch kernel=out3_kernel grid=(256,1,1) block=(256,1,1) lds=131072
.amdgcn_target "amdgcn-amd-amdhsa--gfx950"
.text
.globl qkv0_kernel
.p2align 8
.type qkv0_kernel,@function
qkv0_kernel:
s_cmp_ge_u32 s2, 256
s_cbranch_scc1 qkv0_kernel_end
s_load_dwordx2 s[8:9], s[0:1], 72
s_load_dwordx2 s[6:7], s[0:1], 8
s_load_dwordx2 s[4:5], s[0:1], 0
v_lshrrev_b32 v1, 6, v0
v_and_b32 v0, 63, v0
v_readfirstlane_b32 s28, v1
s_and_b32 s35, s2, 7
s_lshr_b32 s41, s2, 3
s_and_b32 s29, s35, 7
s_lshl_b32 s29, s29, 1
s_and_b32 s30, s41, 1
s_add_u32 s29, s29, s30
s_lshr_b32 s30, s35, 3
s_lshl_b32 s30, s30, 4
s_lshr_b32 s41, s41, 1
s_add_u32 s30, s30, s41
v_and_b32 v2, 15, v0
v_lshrrev_b32 v3, 4, v0
v_lshrrev_b32 v4, 1, v2
v_xor_b32 v4, v4, v3
v_lshlrev_b32 v4, 4, v4
v_lshl_add_u32 v10, v2, 7, v4
v_xor_b32 v11, 64, v10
s_waitcnt lgkmcnt(0)
s_mov_b32 s12, s4
s_and_b32 s13, s5, 0xffff
s_mov_b32 s14, 4194304
s_mov_b32 s15, 0x00020000
s_mov_b32 s16, s6
s_and_b32 s17, s7, 0xffff
s_mov_b32 s18, 6291456
s_mov_b32 s19, 0x00020000
s_mov_b32 s20, s8
s_and_b32 s21, s9, 0xffff
s_mov_b32 s22, 268435456
s_mov_b32 s23, 0x00020000
s_cmp_ge_u32 s28, 4
s_cbranch_scc1 qkv0_kernel_loader
s_setprio 1
s_and_b32 s43, s28, 1
s_lshr_b32 s44, s28, 1
v_lshrrev_b32 v4, 2, v2
v_and_b32 v5, 3, v0
v_lshl_add_u32 v6, v3, 3, v4
v_lshlrev_b32 v6, 7, v6
v_lshl_add_u32 v6, v5, 3, v6
v_lshrrev_b32 v7, 1, v4
v_and_b32 v8, 1, v3
v_lshl_add_u32 v7, v8, 1, v7
s_lshl_b32 s35, s43, 1
v_xor_b32 v7, s35, v7
v_lshl_add_u32 v12, v7, 5, v6
v_add_u32 v12, 18432, v12
v_xor_b32 v13, 32, v12
v_mov_b32 v14, v10
v_mov_b32 v15, v11
v_mov_b32 v16, v12
v_mov_b32 v17, v13
v_mov_b32 v148, 0
v_mov_b32 v149, 0
v_mov_b32 v150, 0
v_mov_b32 v151, 0
v_mov_b32 v152, 0
v_mov_b32 v153, 0
v_mov_b32 v154, 0
v_mov_b32 v155, 0
v_mov_b32 v156, 0
v_mov_b32 v157, 0
v_mov_b32 v158, 0
v_mov_b32 v159, 0
v_mov_b32 v160, 0
v_mov_b32 v161, 0
v_mov_b32 v162, 0
v_mov_b32 v163, 0
v_mov_b32 v164, 0
v_mov_b32 v165, 0
v_mov_b32 v166, 0
v_mov_b32 v167, 0
v_mov_b32 v168, 0
v_mov_b32 v169, 0
v_mov_b32 v170, 0
v_mov_b32 v171, 0
v_mov_b32 v172, 0
v_mov_b32 v173, 0
v_mov_b32 v174, 0
v_mov_b32 v175, 0
v_mov_b32 v176, 0
v_mov_b32 v177, 0
v_mov_b32 v178, 0
v_mov_b32 v179, 0
v_mov_b32 v180, 0
v_mov_b32 v181, 0
v_mov_b32 v182, 0
v_mov_b32 v183, 0
v_mov_b32 v184, 0
v_mov_b32 v185, 0
v_mov_b32 v186, 0
v_mov_b32 v187, 0
v_mov_b32 v188, 0
v_mov_b32 v189, 0
v_mov_b32 v190, 0
v_mov_b32 v191, 0
v_mov_b32 v192, 0
v_mov_b32 v193, 0
v_mov_b32 v194, 0
v_mov_b32 v195, 0
v_mov_b32 v196, 0
v_mov_b32 v197, 0
v_mov_b32 v198, 0
v_mov_b32 v199, 0
v_mov_b32 v200, 0
v_mov_b32 v201, 0
v_mov_b32 v202, 0
v_mov_b32 v203, 0
v_mov_b32 v204, 0
v_mov_b32 v205, 0
v_mov_b32 v206, 0
v_mov_b32 v207, 0
v_mov_b32 v208, 0
v_mov_b32 v209, 0
v_mov_b32 v210, 0
v_mov_b32 v211, 0
v_mov_b32 v212, 0
v_mov_b32 v213, 0
v_mov_b32 v214, 0
v_mov_b32 v215, 0
v_mov_b32 v216, 0
v_mov_b32 v217, 0
v_mov_b32 v218, 0
v_mov_b32 v219, 0
v_mov_b32 v220, 0
v_mov_b32 v221, 0
v_mov_b32 v222, 0
v_mov_b32 v223, 0
v_mov_b32 v224, 0
v_mov_b32 v225, 0
v_mov_b32 v226, 0
v_mov_b32 v227, 0
v_mov_b32 v228, 0
v_mov_b32 v229, 0
v_mov_b32 v230, 0
v_mov_b32 v231, 0
v_mov_b32 v232, 0
v_mov_b32 v233, 0
v_mov_b32 v234, 0
v_mov_b32 v235, 0
v_mov_b32 v236, 0
v_mov_b32 v237, 0
v_mov_b32 v238, 0
v_mov_b32 v239, 0
v_mov_b32 v240, 0
v_mov_b32 v241, 0
v_mov_b32 v242, 0
v_mov_b32 v243, 0
v_mov_b32 v244, 0
v_mov_b32 v245, 0
v_mov_b32 v246, 0
v_mov_b32 v247, 0
v_mov_b32 v248, 0
v_mov_b32 v249, 0
v_mov_b32 v250, 0
v_mov_b32 v251, 0
v_mov_b32 v252, 0
v_mov_b32 v253, 0
v_mov_b32 v254, 0
v_mov_b32 v255, 0
s_mov_b32 s31, 0
s_mov_b32 s32, 0
s_cmp_eq_u32 s44, 1
s_cbranch_scc1 qkv0_kernel_th1
s_barrier
ds_read_b128 v[60:63], v14 offset:2048
ds_read_b128 v[64:67], v14 offset:4096
ds_read_b128 v[68:71], v14 offset:6144
ds_read_b128 v[72:75], v14 offset:8192
ds_read_b128 v[76:79], v14
ds_read_b64_tr_b16 v[80:81], v16 offset:0
ds_read_b64_tr_b16 v[82:83], v16 offset:512
ds_read_b64_tr_b16 v[84:85], v17 offset:0
ds_read_b64_tr_b16 v[86:87], v17 offset:512
ds_read_b64_tr_b16 v[88:89], v16 offset:8192
ds_read_b64_tr_b16 v[90:91], v16 offset:8704
ds_read_b64_tr_b16 v[92:93], v17 offset:8192
ds_read_b64_tr_b16 v[94:95], v17 offset:8704
ds_read_b64_tr_b16 v[96:97], v16 offset:16384
ds_read_b64_tr_b16 v[98:99], v16 offset:16896
ds_read_b64_tr_b16 v[100:101], v17 offset:16384
ds_read_b64_tr_b16 v[102:103], v17 offset:16896
qkv0_kernel_loop0:
s_add_u32 s32, s32, 43008
s_cmp_eq_u32 s32, 129024
s_cselect_b32 s32, 0, s32
s_waitcnt lgkmcnt(0)
v_mfma_f32_16x16x32_bf16 v[244:247], v[80:83], v[76:79], v[244:247]
ds_read_b128 v[104:107], v15 offset:2048
v_mfma_f32_16x16x32_bf16 v[248:251], v[88:91], v[76:79], v[248:251]
ds_read_b128 v[108:111], v15 offset:4096
v_mfma_f32_16x16x32_bf16 v[252:255], v[76:79], v[96:99], v[252:255]
ds_read_b128 v[112:115], v15 offset:6144
v_mfma_f32_16x16x32_bf16 v[204:207], v[88:91], v[72:75], v[204:207]
ds_read_b128 v[116:119], v15 offset:8192
v_mfma_f32_16x16x32_bf16 v[236:239], v[72:75], v[96:99], v[236:239]
ds_read_b128 v[120:123], v15
v_mfma_f32_16x16x32_bf16 v[172:175], v[80:83], v[72:75], v[172:175]
ds_read_b64_tr_b16 v[124:125], v16 offset:4096
v_mfma_f32_16x16x32_bf16 v[208:211], v[92:95], v[72:75], v[208:211]
ds_read_b64_tr_b16 v[126:127], v16 offset:4608
v_mfma_f32_16x16x32_bf16 v[240:243], v[72:75], v[100:103], v[240:243]
ds_read_b64_tr_b16 v[128:129], v17 offset:4096
v_mfma_f32_16x16x32_bf16 v[176:179], v[84:87], v[72:75], v[176:179]
ds_read_b64_tr_b16 v[130:131], v17 offset:4608
v_mfma_f32_16x16x32_bf16 v[196:199], v[88:91], v[68:71], v[196:199]
ds_read_b64_tr_b16 v[132:133], v16 offset:12288
v_mfma_f32_16x16x32_bf16 v[228:231], v[68:71], v[96:99], v[228:231]
ds_read_b64_tr_b16 v[134:135], v16 offset:12800
v_mfma_f32_16x16x32_bf16 v[164:167], v[80:83], v[68:71], v[164:167]
ds_read_b64_tr_b16 v[136:137], v17 offset:12288
v_mfma_f32_16x16x32_bf16 v[200:203], v[92:95], v[68:71], v[200:203]
ds_read_b64_tr_b16 v[138:139], v17 offset:12800
v_mfma_f32_16x16x32_bf16 v[232:235], v[68:71], v[100:103], v[232:235]
ds_read_b64_tr_b16 v[140:141], v16 offset:20480
v_mfma_f32_16x16x32_bf16 v[168:171], v[84:87], v[68:71], v[168:171]
ds_read_b64_tr_b16 v[142:143], v16 offset:20992
v_mfma_f32_16x16x32_bf16 v[188:191], v[88:91], v[64:67], v[188:191]
ds_read_b64_tr_b16 v[144:145], v17 offset:20480
v_mfma_f32_16x16x32_bf16 v[220:223], v[64:67], v[96:99], v[220:223]
ds_read_b64_tr_b16 v[146:147], v17 offset:20992
v_mfma_f32_16x16x32_bf16 v[156:159], v[80:83], v[64:67], v[156:159]
v_mfma_f32_16x16x32_bf16 v[192:195], v[92:95], v[64:67], v[192:195]
v_mfma_f32_16x16x32_bf16 v[224:227], v[64:67], v[100:103], v[224:227]
v_mfma_f32_16x16x32_bf16 v[160:163], v[84:87], v[64:67], v[160:163]
v_mfma_f32_16x16x32_bf16 v[180:183], v[88:91], v[60:63], v[180:183]
v_mfma_f32_16x16x32_bf16 v[212:215], v[60:63], v[96:99], v[212:215]
v_mfma_f32_16x16x32_bf16 v[148:151], v[80:83], v[60:63], v[148:151]
v_mfma_f32_16x16x32_bf16 v[184:187], v[92:95], v[60:63], v[184:187]
v_mfma_f32_16x16x32_bf16 v[216:219], v[60:63], v[100:103], v[216:219]
v_mfma_f32_16x16x32_bf16 v[152:155], v[84:87], v[60:63], v[152:155]
s_waitcnt lgkmcnt(0)
s_barrier
v_mfma_f32_16x16x32_bf16 v[244:247], v[124:127], v[120:123], v[244:247]
v_add_u32 v14, s32, v10
v_mfma_f32_16x16x32_bf16 v[248:251], v[132:135], v[120:123], v[248:251]
v_add_u32 v16, s32, v12
v_add_u32 v17, s32, v13
v_mfma_f32_16x16x32_bf16 v[252:255], v[120:123], v[140:143], v[252:255]
ds_read_b128 v[60:63], v14 offset:2048
v_mfma_f32_16x16x32_bf16 v[204:207], v[132:135], v[116:119], v[204:207]
ds_read_b128 v[64:67], v14 offset:4096
v_mfma_f32_16x16x32_bf16 v[236:239], v[116:119], v[140:143], v[236:239]
ds_read_b128 v[68:71], v14 offset:6144
v_mfma_f32_16x16x32_bf16 v[172:175], v[124:127], v[116:119], v[172:175]
ds_read_b128 v[72:75], v14 offset:8192
v_mfma_f32_16x16x32_bf16 v[208:211], v[136:139], v[116:119], v[208:211]
ds_read_b128 v[76:79], v14
v_mfma_f32_16x16x32_bf16 v[240:243], v[116:119], v[144:147], v[240:243]
ds_read_b64_tr_b16 v[80:81], v16 offset:0
v_mfma_f32_16x16x32_bf16 v[176:179], v[128:131], v[116:119], v[176:179]
ds_read_b64_tr_b16 v[82:83], v16 offset:512
v_mfma_f32_16x16x32_bf16 v[196:199], v[132:135], v[112:115], v[196:199]
ds_read_b64_tr_b16 v[84:85], v17 offset:0
v_mfma_f32_16x16x32_bf16 v[228:231], v[112:115], v[140:143], v[228:231]
ds_read_b64_tr_b16 v[86:87], v17 offset:512
v_mfma_f32_16x16x32_bf16 v[164:167], v[124:127], v[112:115], v[164:167]
ds_read_b64_tr_b16 v[88:89], v16 offset:8192
v_mfma_f32_16x16x32_bf16 v[200:203], v[136:139], v[112:115], v[200:203]
ds_read_b64_tr_b16 v[90:91], v16 offset:8704
v_mfma_f32_16x16x32_bf16 v[232:235], v[112:115], v[144:147], v[232:235]
ds_read_b64_tr_b16 v[92:93], v17 offset:8192
v_mfma_f32_16x16x32_bf16 v[168:171], v[128:131], v[112:115], v[168:171]
ds_read_b64_tr_b16 v[94:95], v17 offset:8704
v_mfma_f32_16x16x32_bf16 v[188:191], v[132:135], v[108:111], v[188:191]
ds_read_b64_tr_b16 v[96:97], v16 offset:16384
v_mfma_f32_16x16x32_bf16 v[220:223], v[108:111], v[140:143], v[220:223]
ds_read_b64_tr_b16 v[98:99], v16 offset:16896
v_mfma_f32_16x16x32_bf16 v[156:159], v[124:127], v[108:111], v[156:159]
ds_read_b64_tr_b16 v[100:101], v17 offset:16384
v_mfma_f32_16x16x32_bf16 v[192:195], v[136:139], v[108:111], v[192:195]
ds_read_b64_tr_b16 v[102:103], v17 offset:16896
v_mfma_f32_16x16x32_bf16 v[224:227], v[108:111], v[144:147], v[224:227]
v_add_u32 v15, s32, v11
v_mfma_f32_16x16x32_bf16 v[160:163], v[128:131], v[108:111], v[160:163]
s_add_u32 s31, s31, 1
v_mfma_f32_16x16x32_bf16 v[180:183], v[132:135], v[104:107], v[180:183]
s_cmp_lt_u32 s31, 16
v_mfma_f32_16x16x32_bf16 v[212:215], v[104:107], v[140:143], v[212:215]
v_mfma_f32_16x16x32_bf16 v[148:151], v[124:127], v[104:107], v[148:151]
v_mfma_f32_16x16x32_bf16 v[184:187], v[136:139], v[104:107], v[184:187]
v_mfma_f32_16x16x32_bf16 v[216:219], v[104:107], v[144:147], v[216:219]
v_mfma_f32_16x16x32_bf16 v[152:155], v[128:131], v[104:107], v[152:155]
s_cbranch_scc1 qkv0_kernel_loop0
s_branch qkv0_kernel_epi
qkv0_kernel_th1:
s_barrier
ds_read_b128 v[60:63], v14 offset:10240
ds_read_b128 v[64:67], v14 offset:12288
ds_read_b128 v[68:71], v14 offset:14336
ds_read_b128 v[72:75], v14 offset:16384
ds_read_b128 v[76:79], v14
ds_read_b64_tr_b16 v[80:81], v16 offset:0
ds_read_b64_tr_b16 v[82:83], v16 offset:512
ds_read_b64_tr_b16 v[84:85], v17 offset:0
ds_read_b64_tr_b16 v[86:87], v17 offset:512
ds_read_b64_tr_b16 v[88:89], v16 offset:8192
ds_read_b64_tr_b16 v[90:91], v16 offset:8704
ds_read_b64_tr_b16 v[92:93], v17 offset:8192
ds_read_b64_tr_b16 v[94:95], v17 offset:8704
ds_read_b64_tr_b16 v[96:97], v16 offset:16384
ds_read_b64_tr_b16 v[98:99], v16 offset:16896
ds_read_b64_tr_b16 v[100:101], v17 offset:16384
ds_read_b64_tr_b16 v[102:103], v17 offset:16896
qkv0_kernel_loop1:
s_add_u32 s32, s32, 43008
s_cmp_eq_u32 s32, 129024
s_cselect_b32 s32, 0, s32
s_waitcnt lgkmcnt(0)
v_mfma_f32_16x16x32_bf16 v[244:247], v[84:87], v[76:79], v[244:247]
ds_read_b128 v[104:107], v15 offset:10240
v_mfma_f32_16x16x32_bf16 v[248:251], v[92:95], v[76:79], v[248:251]
ds_read_b128 v[108:111], v15 offset:12288
v_mfma_f32_16x16x32_bf16 v[252:255], v[76:79], v[100:103], v[252:255]
ds_read_b128 v[112:115], v15 offset:14336
v_mfma_f32_16x16x32_bf16 v[204:207], v[88:91], v[72:75], v[204:207]
ds_read_b128 v[116:119], v15 offset:16384
v_mfma_f32_16x16x32_bf16 v[236:239], v[72:75], v[96:99], v[236:239]
ds_read_b128 v[120:123], v15
v_mfma_f32_16x16x32_bf16 v[172:175], v[80:83], v[72:75], v[172:175]
ds_read_b64_tr_b16 v[124:125], v16 offset:4096
v_mfma_f32_16x16x32_bf16 v[208:211], v[92:95], v[72:75], v[208:211]
ds_read_b64_tr_b16 v[126:127], v16 offset:4608
v_mfma_f32_16x16x32_bf16 v[240:243], v[72:75], v[100:103], v[240:243]
ds_read_b64_tr_b16 v[128:129], v17 offset:4096
v_mfma_f32_16x16x32_bf16 v[176:179], v[84:87], v[72:75], v[176:179]
ds_read_b64_tr_b16 v[130:131], v17 offset:4608
v_mfma_f32_16x16x32_bf16 v[196:199], v[88:91], v[68:71], v[196:199]
ds_read_b64_tr_b16 v[132:133], v16 offset:12288
v_mfma_f32_16x16x32_bf16 v[228:231], v[68:71], v[96:99], v[228:231]
ds_read_b64_tr_b16 v[134:135], v16 offset:12800
v_mfma_f32_16x16x32_bf16 v[164:167], v[80:83], v[68:71], v[164:167]
ds_read_b64_tr_b16 v[136:137], v17 offset:12288
v_mfma_f32_16x16x32_bf16 v[200:203], v[92:95], v[68:71], v[200:203]
ds_read_b64_tr_b16 v[138:139], v17 offset:12800
v_mfma_f32_16x16x32_bf16 v[232:235], v[68:71], v[100:103], v[232:235]
ds_read_b64_tr_b16 v[140:141], v16 offset:20480
v_mfma_f32_16x16x32_bf16 v[168:171], v[84:87], v[68:71], v[168:171]
ds_read_b64_tr_b16 v[142:143], v16 offset:20992
v_mfma_f32_16x16x32_bf16 v[188:191], v[88:91], v[64:67], v[188:191]
ds_read_b64_tr_b16 v[144:145], v17 offset:20480
v_mfma_f32_16x16x32_bf16 v[220:223], v[64:67], v[96:99], v[220:223]
ds_read_b64_tr_b16 v[146:147], v17 offset:20992
v_mfma_f32_16x16x32_bf16 v[156:159], v[80:83], v[64:67], v[156:159]
v_mfma_f32_16x16x32_bf16 v[192:195], v[92:95], v[64:67], v[192:195]
v_mfma_f32_16x16x32_bf16 v[224:227], v[64:67], v[100:103], v[224:227]
v_mfma_f32_16x16x32_bf16 v[160:163], v[84:87], v[64:67], v[160:163]
v_mfma_f32_16x16x32_bf16 v[180:183], v[88:91], v[60:63], v[180:183]
v_mfma_f32_16x16x32_bf16 v[212:215], v[60:63], v[96:99], v[212:215]
v_mfma_f32_16x16x32_bf16 v[148:151], v[80:83], v[60:63], v[148:151]
v_mfma_f32_16x16x32_bf16 v[184:187], v[92:95], v[60:63], v[184:187]
v_mfma_f32_16x16x32_bf16 v[216:219], v[60:63], v[100:103], v[216:219]
v_mfma_f32_16x16x32_bf16 v[152:155], v[84:87], v[60:63], v[152:155]
s_waitcnt lgkmcnt(0)
s_barrier
v_mfma_f32_16x16x32_bf16 v[244:247], v[128:131], v[120:123], v[244:247]
v_add_u32 v14, s32, v10
v_mfma_f32_16x16x32_bf16 v[248:251], v[136:139], v[120:123], v[248:251]
v_add_u32 v16, s32, v12
v_add_u32 v17, s32, v13
v_mfma_f32_16x16x32_bf16 v[252:255], v[120:123], v[144:147], v[252:255]
ds_read_b128 v[60:63], v14 offset:10240
v_mfma_f32_16x16x32_bf16 v[204:207], v[132:135], v[116:119], v[204:207]
ds_read_b128 v[64:67], v14 offset:12288
v_mfma_f32_16x16x32_bf16 v[236:239], v[116:119], v[140:143], v[236:239]
ds_read_b128 v[68:71], v14 offset:14336
v_mfma_f32_16x16x32_bf16 v[172:175], v[124:127], v[116:119], v[172:175]
ds_read_b128 v[72:75], v14 offset:16384
v_mfma_f32_16x16x32_bf16 v[208:211], v[136:139], v[116:119], v[208:211]
ds_read_b128 v[76:79], v14
v_mfma_f32_16x16x32_bf16 v[240:243], v[116:119], v[144:147], v[240:243]
ds_read_b64_tr_b16 v[80:81], v16 offset:0
v_mfma_f32_16x16x32_bf16 v[176:179], v[128:131], v[116:119], v[176:179]
ds_read_b64_tr_b16 v[82:83], v16 offset:512
v_mfma_f32_16x16x32_bf16 v[196:199], v[132:135], v[112:115], v[196:199]
ds_read_b64_tr_b16 v[84:85], v17 offset:0
v_mfma_f32_16x16x32_bf16 v[228:231], v[112:115], v[140:143], v[228:231]
ds_read_b64_tr_b16 v[86:87], v17 offset:512
v_mfma_f32_16x16x32_bf16 v[164:167], v[124:127], v[112:115], v[164:167]
ds_read_b64_tr_b16 v[88:89], v16 offset:8192
v_mfma_f32_16x16x32_bf16 v[200:203], v[136:139], v[112:115], v[200:203]
ds_read_b64_tr_b16 v[90:91], v16 offset:8704
v_mfma_f32_16x16x32_bf16 v[232:235], v[112:115], v[144:147], v[232:235]
ds_read_b64_tr_b16 v[92:93], v17 offset:8192
v_mfma_f32_16x16x32_bf16 v[168:171], v[128:131], v[112:115], v[168:171]
ds_read_b64_tr_b16 v[94:95], v17 offset:8704
v_mfma_f32_16x16x32_bf16 v[188:191], v[132:135], v[108:111], v[188:191]
ds_read_b64_tr_b16 v[96:97], v16 offset:16384
v_mfma_f32_16x16x32_bf16 v[220:223], v[108:111], v[140:143], v[220:223]
ds_read_b64_tr_b16 v[98:99], v16 offset:16896
v_mfma_f32_16x16x32_bf16 v[156:159], v[124:127], v[108:111], v[156:159]
ds_read_b64_tr_b16 v[100:101], v17 offset:16384
v_mfma_f32_16x16x32_bf16 v[192:195], v[136:139], v[108:111], v[192:195]
ds_read_b64_tr_b16 v[102:103], v17 offset:16896
v_mfma_f32_16x16x32_bf16 v[224:227], v[108:111], v[144:147], v[224:227]
v_add_u32 v15, s32, v11
v_mfma_f32_16x16x32_bf16 v[160:163], v[128:131], v[108:111], v[160:163]
s_add_u32 s31, s31, 1
v_mfma_f32_16x16x32_bf16 v[180:183], v[132:135], v[104:107], v[180:183]
s_cmp_lt_u32 s31, 16
v_mfma_f32_16x16x32_bf16 v[212:215], v[104:107], v[140:143], v[212:215]
v_mfma_f32_16x16x32_bf16 v[148:151], v[124:127], v[104:107], v[148:151]
v_mfma_f32_16x16x32_bf16 v[184:187], v[136:139], v[104:107], v[184:187]
v_mfma_f32_16x16x32_bf16 v[216:219], v[104:107], v[144:147], v[216:219]
v_mfma_f32_16x16x32_bf16 v[152:155], v[128:131], v[104:107], v[152:155]
s_cbranch_scc1 qkv0_kernel_loop1
qkv0_kernel_epi:
v_lshlrev_b32 v4, 4, v0
s_mul_i32 s35, s28, 3072
s_add_u32 s35, s35, 131328
v_add_u32 v5, s35, v4
s_waitcnt lgkmcnt(0)
ds_write_b128 v5, v[244:247] offset:0
ds_write_b128 v5, v[248:251] offset:1024
ds_write_b128 v5, v[252:255] offset:2048
s_cmp_eq_u32 s44, 1
s_cbranch_scc1 qkv0_kernel_nodump
ds_write_b128 v5, v[204:207] offset:13312
ds_write_b128 v5, v[236:239] offset:14336
ds_write_b128 v5, v[208:211] offset:19456
ds_write_b128 v5, v[240:243] offset:20480
qkv0_kernel_nodump:
s_mul_i32 s35, s43, 3072
s_add_u32 s35, s35, 131328
v_lshlrev_b32 v6, 8, v3
v_add_u32 v6, s35, v6
v_lshlrev_b32 v7, 4, v2
v_add_u32 v7, s35, v7
s_lshl_b32 s36, s44, 6
v_add_u32 v8, s36, v2
v_lshlrev_b32 v8, 3, v8
v_add_u32 v8, 129024, v8
v_lshl_add_u32 v9, v3, 2, s36
v_lshlrev_b32 v9, 2, v9
v_add_u32 v9, 130176, v9
s_mul_i32 s37, s44, 12288
s_add_u32 s35, s35, s37
v_add_u32 v5, s35, v4
s_waitcnt lgkmcnt(0)
s_barrier
ds_read_b128 v[60:63], v6 offset:0
ds_read_b128 v[64:67], v6 offset:6144
ds_read_b128 v[68:71], v6 offset:1024
ds_read_b128 v[72:75], v6 offset:7168
ds_read_b64 v[78:79], v8 offset:0
ds_read_b64 v[80:81], v8 offset:128
ds_read_b64 v[82:83], v8 offset:256
ds_read_b64 v[84:85], v8 offset:384
ds_read_b64 v[86:87], v8 offset:512
ds_read_b128 v[128:131], v5 offset:1024
ds_read_b128 v[132:135], v5 offset:7168
ds_read_b32 v76, v7 offset:2048
ds_read_b32 v77, v7 offset:8192
ds_read_b128 v[136:139], v5 offset:2048
ds_read_b128 v[140:143], v5 offset:8192
ds_read_b128 v[88:91], v9 offset:0
ds_read_b128 v[108:111], v9 offset:576
ds_read_b128 v[92:95], v9 offset:64
ds_read_b128 v[112:115], v9 offset:640
ds_read_b128 v[96:99], v9 offset:128
ds_read_b128 v[116:119], v9 offset:704
ds_read_b128 v[100:103], v9 offset:192
ds_read_b128 v[120:123], v9 offset:768
ds_read_b128 v[104:107], v9 offset:256
ds_read_b128 v[124:127], v9 offset:832
s_waitcnt lgkmcnt(14)
s_lshl_b32 s35, s29, 3
s_lshl_b32 s36, s44, 2
s_add_u32 s35, s35, s36
s_lshl_b32 s35, s35, 5
s_lshl_b32 s45, s30, 1
s_add_u32 s45, s45, s43
s_add_u32 s35, s35, s45
s_lshl_b32 s35, s35, 10
s_add_u32 s46, s35, 12582912
v_lshlrev_b32 v18, 4, v0
v_pk_fma_f32 v[148:149], v[60:61], v[80:81], v[148:149] op_sel:[0,1,0] op_sel_hi:[1,1,1]
v_pk_fma_f32 v[150:151], v[62:63], v[80:81], v[150:151] op_sel:[0,1,0] op_sel_hi:[1,1,1]
v_pk_fma_f32 v[152:153], v[64:65], v[80:81], v[152:153] op_sel:[0,1,0] op_sel_hi:[1,1,1]
v_pk_fma_f32 v[154:155], v[66:67], v[80:81], v[154:155] op_sel:[0,1,0] op_sel_hi:[1,1,1]
v_pk_mul_f32 v[148:149], v[148:149], v[80:81] op_sel:[0,0] op_sel_hi:[1,0]
v_pk_mul_f32 v[150:151], v[150:151], v[80:81] op_sel:[0,0] op_sel_hi:[1,0]
v_pk_mul_f32 v[152:153], v[152:153], v[80:81] op_sel:[0,0] op_sel_hi:[1,0]
v_pk_mul_f32 v[154:155], v[154:155], v[80:81] op_sel:[0,0] op_sel_hi:[1,0]
v_cvt_pk_bf16_f32 v148, v148, v149
v_cvt_pk_bf16_f32 v149, v150, v151
v_cvt_pk_bf16_f32 v150, v152, v153
v_cvt_pk_bf16_f32 v151, v154, v155
v_pk_fma_f32 v[156:157], v[60:61], v[82:83], v[156:157] op_sel:[0,1,0] op_sel_hi:[1,1,1]
v_pk_fma_f32 v[158:159], v[62:63], v[82:83], v[158:159] op_sel:[0,1,0] op_sel_hi:[1,1,1]
v_pk_fma_f32 v[160:161], v[64:65], v[82:83], v[160:161] op_sel:[0,1,0] op_sel_hi:[1,1,1]
v_pk_fma_f32 v[162:163], v[66:67], v[82:83], v[162:163] op_sel:[0,1,0] op_sel_hi:[1,1,1]
v_pk_mul_f32 v[156:157], v[156:157], v[82:83] op_sel:[0,0] op_sel_hi:[1,0]
v_pk_mul_f32 v[158:159], v[158:159], v[82:83] op_sel:[0,0] op_sel_hi:[1,0]
v_pk_mul_f32 v[160:161], v[160:161], v[82:83] op_sel:[0,0] op_sel_hi:[1,0]
v_pk_mul_f32 v[162:163], v[162:163], v[82:83] op_sel:[0,0] op_sel_hi:[1,0]
v_cvt_pk_bf16_f32 v156, v156, v157
v_cvt_pk_bf16_f32 v157, v158, v159
v_cvt_pk_bf16_f32 v158, v160, v161
v_cvt_pk_bf16_f32 v159, v162, v163
v_pk_fma_f32 v[164:165], v[60:61], v[84:85], v[164:165] op_sel:[0,1,0] op_sel_hi:[1,1,1]
v_pk_fma_f32 v[166:167], v[62:63], v[84:85], v[166:167] op_sel:[0,1,0] op_sel_hi:[1,1,1]
v_pk_fma_f32 v[168:169], v[64:65], v[84:85], v[168:169] op_sel:[0,1,0] op_sel_hi:[1,1,1]
v_pk_fma_f32 v[170:171], v[66:67], v[84:85], v[170:171] op_sel:[0,1,0] op_sel_hi:[1,1,1]
v_pk_mul_f32 v[164:165], v[164:165], v[84:85] op_sel:[0,0] op_sel_hi:[1,0]
v_pk_mul_f32 v[166:167], v[166:167], v[84:85] op_sel:[0,0] op_sel_hi:[1,0]
v_pk_mul_f32 v[168:169], v[168:169], v[84:85] op_sel:[0,0] op_sel_hi:[1,0]
v_pk_mul_f32 v[170:171], v[170:171], v[84:85] op_sel:[0,0] op_sel_hi:[1,0]
v_cvt_pk_bf16_f32 v164, v164, v165
v_cvt_pk_bf16_f32 v165, v166, v167
v_cvt_pk_bf16_f32 v166, v168, v169
v_cvt_pk_bf16_f32 v167, v170, v171
v_pk_fma_f32 v[172:173], v[60:61], v[86:87], v[172:173] op_sel:[0,1,0] op_sel_hi:[1,1,1]
v_pk_fma_f32 v[174:175], v[62:63], v[86:87], v[174:175] op_sel:[0,1,0] op_sel_hi:[1,1,1]
v_pk_fma_f32 v[176:177], v[64:65], v[86:87], v[176:177] op_sel:[0,1,0] op_sel_hi:[1,1,1]
v_pk_fma_f32 v[178:179], v[66:67], v[86:87], v[178:179] op_sel:[0,1,0] op_sel_hi:[1,1,1]
v_pk_mul_f32 v[172:173], v[172:173], v[86:87] op_sel:[0,0] op_sel_hi:[1,0]
v_pk_mul_f32 v[174:175], v[174:175], v[86:87] op_sel:[0,0] op_sel_hi:[1,0]
v_pk_mul_f32 v[176:177], v[176:177], v[86:87] op_sel:[0,0] op_sel_hi:[1,0]
v_pk_mul_f32 v[178:179], v[178:179], v[86:87] op_sel:[0,0] op_sel_hi:[1,0]
v_cvt_pk_bf16_f32 v172, v172, v173
v_cvt_pk_bf16_f32 v173, v174, v175
v_cvt_pk_bf16_f32 v174, v176, v177
v_cvt_pk_bf16_f32 v175, v178, v179
v_pk_fma_f32 v[128:129], v[68:69], v[78:79], v[128:129] op_sel:[0,1,0] op_sel_hi:[1,1,1]
v_pk_fma_f32 v[130:131], v[70:71], v[78:79], v[130:131] op_sel:[0,1,0] op_sel_hi:[1,1,1]
v_pk_fma_f32 v[132:133], v[72:73], v[78:79], v[132:133] op_sel:[0,1,0] op_sel_hi:[1,1,1]
v_pk_fma_f32 v[134:135], v[74:75], v[78:79], v[134:135] op_sel:[0,1,0] op_sel_hi:[1,1,1]
v_pk_mul_f32 v[128:129], v[128:129], v[78:79] op_sel:[0,0] op_sel_hi:[1,0]
v_pk_mul_f32 v[130:131], v[130:131], v[78:79] op_sel:[0,0] op_sel_hi:[1,0]
v_pk_mul_f32 v[132:133], v[132:133], v[78:79] op_sel:[0,0] op_sel_hi:[1,0]
v_pk_mul_f32 v[134:135], v[134:135], v[78:79] op_sel:[0,0] op_sel_hi:[1,0]
v_cvt_pk_bf16_f32 v128, v128, v129
v_cvt_pk_bf16_f32 v129, v130, v131
v_cvt_pk_bf16_f32 v130, v132, v133
v_cvt_pk_bf16_f32 v131, v134, v135
v_pk_fma_f32 v[180:181], v[68:69], v[80:81], v[180:181] op_sel:[0,1,0] op_sel_hi:[1,1,1]
v_pk_fma_f32 v[182:183], v[70:71], v[80:81], v[182:183] op_sel:[0,1,0] op_sel_hi:[1,1,1]
v_pk_fma_f32 v[184:185], v[72:73], v[80:81], v[184:185] op_sel:[0,1,0] op_sel_hi:[1,1,1]
v_pk_fma_f32 v[186:187], v[74:75], v[80:81], v[186:187] op_sel:[0,1,0] op_sel_hi:[1,1,1]
v_pk_mul_f32 v[180:181], v[180:181], v[80:81] op_sel:[0,0] op_sel_hi:[1,0]
v_pk_mul_f32 v[182:183], v[182:183], v[80:81] op_sel:[0,0] op_sel_hi:[1,0]
v_pk_mul_f32 v[184:185], v[184:185], v[80:81] op_sel:[0,0] op_sel_hi:[1,0]
v_pk_mul_f32 v[186:187], v[186:187], v[80:81] op_sel:[0,0] op_sel_hi:[1,0]
v_cvt_pk_bf16_f32 v180, v180, v181
v_cvt_pk_bf16_f32 v181, v182, v183
v_cvt_pk_bf16_f32 v182, v184, v185
v_cvt_pk_bf16_f32 v183, v186, v187
v_pk_fma_f32 v[188:189], v[68:69], v[82:83], v[188:189] op_sel:[0,1,0] op_sel_hi:[1,1,1]
v_pk_fma_f32 v[190:191], v[70:71], v[82:83], v[190:191] op_sel:[0,1,0] op_sel_hi:[1,1,1]
v_pk_fma_f32 v[192:193], v[72:73], v[82:83], v[192:193] op_sel:[0,1,0] op_sel_hi:[1,1,1]
v_pk_fma_f32 v[194:195], v[74:75], v[82:83], v[194:195] op_sel:[0,1,0] op_sel_hi:[1,1,1]
v_pk_mul_f32 v[188:189], v[188:189], v[82:83] op_sel:[0,0] op_sel_hi:[1,0]
v_pk_mul_f32 v[190:191], v[190:191], v[82:83] op_sel:[0,0] op_sel_hi:[1,0]
v_pk_mul_f32 v[192:193], v[192:193], v[82:83] op_sel:[0,0] op_sel_hi:[1,0]
v_pk_mul_f32 v[194:195], v[194:195], v[82:83] op_sel:[0,0] op_sel_hi:[1,0]
v_cvt_pk_bf16_f32 v188, v188, v189
v_cvt_pk_bf16_f32 v189, v190, v191
v_cvt_pk_bf16_f32 v190, v192, v193
v_cvt_pk_bf16_f32 v191, v194, v195
v_pk_fma_f32 v[196:197], v[68:69], v[84:85], v[196:197] op_sel:[0,1,0] op_sel_hi:[1,1,1]
v_pk_fma_f32 v[198:199], v[70:71], v[84:85], v[198:199] op_sel:[0,1,0] op_sel_hi:[1,1,1]
v_pk_fma_f32 v[200:201], v[72:73], v[84:85], v[200:201] op_sel:[0,1,0] op_sel_hi:[1,1,1]
v_pk_fma_f32 v[202:203], v[74:75], v[84:85], v[202:203] op_sel:[0,1,0] op_sel_hi:[1,1,1]
v_pk_mul_f32 v[196:197], v[196:197], v[84:85] op_sel:[0,0] op_sel_hi:[1,0]
v_pk_mul_f32 v[198:199], v[198:199], v[84:85] op_sel:[0,0] op_sel_hi:[1,0]
v_pk_mul_f32 v[200:201], v[200:201], v[84:85] op_sel:[0,0] op_sel_hi:[1,0]
v_pk_mul_f32 v[202:203], v[202:203], v[84:85] op_sel:[0,0] op_sel_hi:[1,0]
v_cvt_pk_bf16_f32 v196, v196, v197
v_cvt_pk_bf16_f32 v197, v198, v199
v_cvt_pk_bf16_f32 v198, v200, v201
v_cvt_pk_bf16_f32 v199, v202, v203
v_pk_fma_f32 v[204:205], v[68:69], v[86:87], v[204:205] op_sel:[0,1,0] op_sel_hi:[1,1,1]
v_pk_fma_f32 v[206:207], v[70:71], v[86:87], v[206:207] op_sel:[0,1,0] op_sel_hi:[1,1,1]
v_pk_fma_f32 v[208:209], v[72:73], v[86:87], v[208:209] op_sel:[0,1,0] op_sel_hi:[1,1,1]
v_pk_fma_f32 v[210:211], v[74:75], v[86:87], v[210:211] op_sel:[0,1,0] op_sel_hi:[1,1,1]
v_pk_mul_f32 v[204:205], v[204:205], v[86:87] op_sel:[0,0] op_sel_hi:[1,0]
v_pk_mul_f32 v[206:207], v[206:207], v[86:87] op_sel:[0,0] op_sel_hi:[1,0]
v_pk_mul_f32 v[208:209], v[208:209], v[86:87] op_sel:[0,0] op_sel_hi:[1,0]
v_pk_mul_f32 v[210:211], v[210:211], v[86:87] op_sel:[0,0] op_sel_hi:[1,0]
v_cvt_pk_bf16_f32 v204, v204, v205
v_cvt_pk_bf16_f32 v205, v206, v207
v_cvt_pk_bf16_f32 v206, v208, v209
v_cvt_pk_bf16_f32 v207, v210, v211
s_mov_b32 s36, 0xf149f2ca
v_mov_b32 v53, s36
v_lshlrev_b32 v4, 2, v3
v_sub_u32 v4, v2, v4
v_subrev_u32 v5, 0, v4
v_and_b32 v6, 0x80000001, v5
v_cmp_eq_u32 vcc, 0, v6
v_add_u32 v5, 1, v5
v_and_b32 v6, 0x80000001, v5
v_cndmask_b32 v44, v53, 0, vcc
v_cmp_eq_u32 vcc, 0x80000001, v6
s_nop 1
v_cndmask_b32 v40, v53, 0, vcc
v_subrev_u32 v5, 1, v4
v_and_b32 v6, 0x80000001, v5
v_cmp_eq_u32 vcc, 0, v6
v_add_u32 v5, 1, v5
v_and_b32 v6, 0x80000001, v5
v_cndmask_b32 v45, v53, 0, vcc
v_cmp_eq_u32 vcc, 0x80000001, v6
s_nop 1
v_cndmask_b32 v41, v53, 0, vcc
v_subrev_u32 v5, 2, v4
v_and_b32 v6, 0x80000001, v5
v_cmp_eq_u32 vcc, 0, v6
v_add_u32 v5, 1, v5
v_and_b32 v6, 0x80000001, v5
v_cndmask_b32 v46, v53, 0, vcc
v_cmp_eq_u32 vcc, 0x80000001, v6
s_nop 1
v_cndmask_b32 v42, v53, 0, vcc
v_subrev_u32 v5, 3, v4
v_and_b32 v6, 0x80000001, v5
v_cmp_eq_u32 vcc, 0, v6
v_add_u32 v5, 1, v5
v_and_b32 v6, 0x80000001, v5
v_cndmask_b32 v47, v53, 0, vcc
v_cmp_eq_u32 vcc, 0x80000001, v6
s_nop 1
v_cndmask_b32 v43, v53, 0, vcc
s_or_b32 s36, s29, s44
s_cmp_eq_u32 s36, 0
s_cselect_b64 vcc, -1, 0
v_cndmask_b32 v48, v40, v53, vcc
v_cndmask_b32 v49, v41, v53, vcc
v_cndmask_b32 v50, v42, v53, vcc
v_cndmask_b32 v51, v43, v53, vcc
v_and_b32 v4, 1, v2
v_lshlrev_b32 v4, 4, v4
v_mov_b32 v5, 0xffff
v_lshlrev_b32 v52, v4, v5
v_mov_b32 v56, 0x3f803f80
v_mov_b32 v57, 0x3f803f80
v_mov_b32 v58, 0x3f803f80
v_mov_b32 v59, 0x3f803f80
v_mfma_f32_16x16x32_bf16 v[152:155], v[128:131], v[148:151], v[48:51]
v_mfma_f32_16x16x32_bf16 v[184:187], v[180:183], v[148:151], v[44:47]
v_mfma_f32_16x16x32_bf16 v[160:163], v[180:183], v[156:159], v[40:43]
v_mfma_f32_16x16x32_bf16 v[192:195], v[188:191], v[156:159], v[44:47]
v_mfma_f32_16x16x32_bf16 v[168:171], v[188:191], v[164:167], v[40:43]
v_mfma_f32_16x16x32_bf16 v[200:203], v[196:199], v[164:167], v[44:47]
v_mfma_f32_16x16x32_bf16 v[176:179], v[196:199], v[172:175], v[40:43]
v_mfma_f32_16x16x32_bf16 v[208:211], v[204:207], v[172:175], v[44:47]
s_waitcnt lgkmcnt(0)
v_pk_fma_f32 v[136:137], v[108:109], v[76:77], v[136:137] op_sel:[0,0,0] op_sel_hi:[1,0,1]
v_pk_fma_f32 v[138:139], v[110:111], v[76:77], v[138:139] op_sel:[0,0,0] op_sel_hi:[1,0,1]
v_pk_mul_f32 v[136:137], v[136:137], v[88:89]
v_pk_mul_f32 v[138:139], v[138:139], v[90:91]
v_cvt_pk_bf16_f32 v20, v136, v137
v_cvt_pk_bf16_f32 v21, v138, v139
v_pk_fma_f32 v[212:213], v[112:113], v[76:77], v[212:213] op_sel:[0,0,0] op_sel_hi:[1,0,1]
v_pk_fma_f32 v[214:215], v[114:115], v[76:77], v[214:215] op_sel:[0,0,0] op_sel_hi:[1,0,1]
v_pk_mul_f32 v[212:213], v[212:213], v[92:93]
v_pk_mul_f32 v[214:215], v[214:215], v[94:95]
v_cvt_pk_bf16_f32 v22, v212, v213
v_cvt_pk_bf16_f32 v23, v214, v215
v_pk_fma_f32 v[220:221], v[116:117], v[76:77], v[220:221] op_sel:[0,0,0] op_sel_hi:[1,0,1]
v_pk_fma_f32 v[222:223], v[118:119], v[76:77], v[222:223] op_sel:[0,0,0] op_sel_hi:[1,0,1]
v_pk_mul_f32 v[220:221], v[220:221], v[96:97]
v_pk_mul_f32 v[222:223], v[222:223], v[98:99]
v_cvt_pk_bf16_f32 v24, v220, v221
v_cvt_pk_bf16_f32 v25, v222, v223
v_pk_fma_f32 v[228:229], v[120:121], v[76:77], v[228:229] op_sel:[0,0,0] op_sel_hi:[1,0,1]
v_pk_fma_f32 v[230:231], v[122:123], v[76:77], v[230:231] op_sel:[0,0,0] op_sel_hi:[1,0,1]
v_pk_mul_f32 v[228:229], v[228:229], v[100:101]
v_pk_mul_f32 v[230:231], v[230:231], v[102:103]
v_cvt_pk_bf16_f32 v26, v228, v229
v_cvt_pk_bf16_f32 v27, v230, v231
v_pk_fma_f32 v[236:237], v[124:125], v[76:77], v[236:237] op_sel:[0,0,0] op_sel_hi:[1,0,1]
v_pk_fma_f32 v[238:239], v[126:127], v[76:77], v[238:239] op_sel:[0,0,0] op_sel_hi:[1,0,1]
v_pk_mul_f32 v[236:237], v[236:237], v[104:105]
v_pk_mul_f32 v[238:239], v[238:239], v[106:107]
v_cvt_pk_bf16_f32 v28, v236, v237
v_cvt_pk_bf16_f32 v29, v238, v239
v_pk_fma_f32 v[140:141], v[108:109], v[76:77], v[140:141] op_sel:[0,1,0] op_sel_hi:[1,1,1]
v_pk_fma_f32 v[142:143], v[110:111], v[76:77], v[142:143] op_sel:[0,1,0] op_sel_hi:[1,1,1]
v_pk_mul_f32 v[140:141], v[140:141], v[88:89]
v_pk_mul_f32 v[142:143], v[142:143], v[90:91]
v_cvt_pk_bf16_f32 v30, v140, v141
v_cvt_pk_bf16_f32 v31, v142, v143
v_pk_fma_f32 v[216:217], v[112:113], v[76:77], v[216:217] op_sel:[0,1,0] op_sel_hi:[1,1,1]
v_pk_fma_f32 v[218:219], v[114:115], v[76:77], v[218:219] op_sel:[0,1,0] op_sel_hi:[1,1,1]
v_pk_mul_f32 v[216:217], v[216:217], v[92:93]
v_pk_mul_f32 v[218:219], v[218:219], v[94:95]
v_cvt_pk_bf16_f32 v32, v216, v217
v_cvt_pk_bf16_f32 v33, v218, v219
v_pk_fma_f32 v[224:225], v[116:117], v[76:77], v[224:225] op_sel:[0,1,0] op_sel_hi:[1,1,1]
v_pk_fma_f32 v[226:227], v[118:119], v[76:77], v[226:227] op_sel:[0,1,0] op_sel_hi:[1,1,1]
v_pk_mul_f32 v[224:225], v[224:225], v[96:97]
v_pk_mul_f32 v[226:227], v[226:227], v[98:99]
v_cvt_pk_bf16_f32 v34, v224, v225
v_cvt_pk_bf16_f32 v35, v226, v227
v_pk_fma_f32 v[232:233], v[120:121], v[76:77], v[232:233] op_sel:[0,1,0] op_sel_hi:[1,1,1]
v_pk_fma_f32 v[234:235], v[122:123], v[76:77], v[234:235] op_sel:[0,1,0] op_sel_hi:[1,1,1]
v_pk_mul_f32 v[232:233], v[232:233], v[100:101]
v_pk_mul_f32 v[234:235], v[234:235], v[102:103]
v_cvt_pk_bf16_f32 v36, v232, v233
v_cvt_pk_bf16_f32 v37, v234, v235
v_pk_fma_f32 v[240:241], v[124:125], v[76:77], v[240:241] op_sel:[0,1,0] op_sel_hi:[1,1,1]
v_pk_fma_f32 v[242:243], v[126:127], v[76:77], v[242:243] op_sel:[0,1,0] op_sel_hi:[1,1,1]
v_pk_mul_f32 v[240:241], v[240:241], v[104:105]
v_pk_mul_f32 v[242:243], v[242:243], v[106:107]
v_cvt_pk_bf16_f32 v38, v240, v241
v_cvt_pk_bf16_f32 v39, v242, v243
s_mov_b32 s42, 0x3e8293ee
v_max_f32 v148, v152, v153
v_max_f32 v149, v154, v155
v_max_f32 v150, v184, v185
v_max_f32 v151, v186, v187
v_max3_f32 v60, v148, v149, v150
v_max_f32 v60, v60, v151
v_max_f32 v156, v160, v161
v_max_f32 v157, v162, v163
v_max_f32 v158, v192, v193
v_max_f32 v159, v194, v195
v_max3_f32 v61, v156, v157, v158
v_max_f32 v61, v61, v159
v_max_f32 v164, v168, v169
v_max_f32 v165, v170, v171
v_max_f32 v166, v200, v201
v_max_f32 v167, v202, v203
v_max3_f32 v62, v164, v165, v166
v_max_f32 v62, v62, v167
v_max_f32 v172, v176, v177
v_max_f32 v173, v178, v179
v_max_f32 v174, v208, v209
v_max_f32 v175, v210, v211
v_max3_f32 v63, v172, v173, v174
v_max_f32 v63, v63, v175
s_nop 1
v_permlane32_swap_b32 v60, v61
v_permlane32_swap_b32 v62, v63
s_nop 0
v_max_f32 v60, v60, v61
v_max_f32 v62, v62, v63
s_nop 1
v_permlane16_swap_b32 v60, v62
s_nop 0
v_max_f32 v60, v60, v62
v_mul_f32 v60, s42, v60
v_mov_b32 v62, v60
s_nop 1
v_permlane16_swap_b32 v60, v62
s_nop 0
v_mov_b32 v61, v60
v_mov_b32 v63, v62
s_nop 1
v_permlane32_swap_b32 v60, v61
v_permlane32_swap_b32 v62, v63
s_nop 0
v_fma_f32 v148, v148, s42, -v60
v_fma_f32 v149, v149, s42, -v60
v_fma_f32 v150, v150, s42, -v60
v_fma_f32 v151, v151, s42, -v60
v_exp_f32 v148, v148
v_exp_f32 v149, v149
v_exp_f32 v150, v150
v_exp_f32 v151, v151
v_fma_f32 v156, v156, s42, -v61
v_fma_f32 v157, v157, s42, -v61
v_fma_f32 v158, v158, s42, -v61
v_fma_f32 v159, v159, s42, -v61
v_exp_f32 v156, v156
v_exp_f32 v157, v157
v_exp_f32 v158, v158
v_exp_f32 v159, v159
v_fma_f32 v164, v164, s42, -v62
v_fma_f32 v165, v165, s42, -v62
v_fma_f32 v166, v166, s42, -v62
v_fma_f32 v167, v167, s42, -v62
v_exp_f32 v164, v164
v_exp_f32 v165, v165
v_exp_f32 v166, v166
v_exp_f32 v167, v167
v_fma_f32 v172, v172, s42, -v63
v_fma_f32 v173, v173, s42, -v63
v_fma_f32 v174, v174, s42, -v63
v_fma_f32 v175, v175, s42, -v63
v_exp_f32 v172, v172
v_exp_f32 v173, v173
v_exp_f32 v174, v174
v_exp_f32 v175, v175
v_cvt_pk_bf16_f32 v148, v148, v148
v_cvt_pk_bf16_f32 v149, v149, v149
v_cvt_pk_bf16_f32 v150, v150, v150
v_cvt_pk_bf16_f32 v151, v151, v151
v_and_b32 v148, v52, v148
v_and_b32 v149, v52, v149
v_and_b32 v150, v52, v150
v_and_b32 v151, v52, v151
v_cvt_pk_bf16_f32 v156, v156, v156
v_cvt_pk_bf16_f32 v157, v157, v157
v_cvt_pk_bf16_f32 v158, v158, v158
v_cvt_pk_bf16_f32 v159, v159, v159
v_and_b32 v156, v52, v156
v_and_b32 v157, v52, v157
v_and_b32 v158, v52, v158
v_and_b32 v159, v52, v159
v_cvt_pk_bf16_f32 v164, v164, v164
v_cvt_pk_bf16_f32 v165, v165, v165
v_cvt_pk_bf16_f32 v166, v166, v166
v_cvt_pk_bf16_f32 v167, v167, v167
v_and_b32 v164, v52, v164
v_and_b32 v165, v52, v165
v_and_b32 v166, v52, v166
v_and_b32 v167, v52, v167
v_cvt_pk_bf16_f32 v172, v172, v172
v_cvt_pk_bf16_f32 v173, v173, v173
v_cvt_pk_bf16_f32 v174, v174, v174
v_cvt_pk_bf16_f32 v175, v175, v175
v_and_b32 v172, v52, v172
v_and_b32 v173, v52, v173
v_and_b32 v174, v52, v174
v_and_b32 v175, v52, v175
s_nop 1
v_mfma_f32_16x16x32_bf16 v[152:155], v[56:59], v[148:151], 0
v_mfma_f32_16x16x32_bf16 v[212:215], v[20:23], v[148:151], 0
v_mfma_f32_16x16x32_bf16 v[216:219], v[30:33], v[148:151], 0
v_mfma_f32_16x16x32_bf16 v[160:163], v[56:59], v[156:159], 0
v_mfma_f32_16x16x32_bf16 v[220:223], v[22:25], v[156:159], 0
v_mfma_f32_16x16x32_bf16 v[224:227], v[32:35], v[156:159], 0
v_mfma_f32_16x16x32_bf16 v[168:171], v[56:59], v[164:167], 0
v_mfma_f32_16x16x32_bf16 v[228:231], v[24:27], v[164:167], 0
v_mfma_f32_16x16x32_bf16 v[232:235], v[34:37], v[164:167], 0
v_mfma_f32_16x16x32_bf16 v[176:179], v[56:59], v[172:175], 0
v_mfma_f32_16x16x32_bf16 v[236:239], v[26:29], v[172:175], 0
v_mfma_f32_16x16x32_bf16 v[240:243], v[36:39], v[172:175], 0
s_nop 0
s_nop 2
v_rcp_f32 v152, v152
v_rcp_f32 v160, v160
v_rcp_f32 v168, v168
v_rcp_f32 v176, v176
s_nop 7
v_pk_mul_f32 v[212:213], v[212:213], v[152:153] op_sel:[0,0] op_sel_hi:[1,0]
v_pk_mul_f32 v[214:215], v[214:215], v[152:153] op_sel:[0,0] op_sel_hi:[1,0]
v_pk_mul_f32 v[216:217], v[216:217], v[152:153] op_sel:[0,0] op_sel_hi:[1,0]
v_pk_mul_f32 v[218:219], v[218:219], v[152:153] op_sel:[0,0] op_sel_hi:[1,0]
v_cvt_pk_bf16_f32 v212, v212, v213
v_cvt_pk_bf16_f32 v213, v214, v215
v_cvt_pk_bf16_f32 v214, v216, v217
v_cvt_pk_bf16_f32 v215, v218, v219
buffer_store_dwordx4 v[212:215], v18, s[20:23], s46 offen
s_add_u32 s46, s46, 32768
v_pk_mul_f32 v[220:221], v[220:221], v[160:161] op_sel:[0,0] op_sel_hi:[1,0]
v_pk_mul_f32 v[222:223], v[222:223], v[160:161] op_sel:[0,0] op_sel_hi:[1,0]
v_pk_mul_f32 v[224:225], v[224:225], v[160:161] op_sel:[0,0] op_sel_hi:[1,0]
v_pk_mul_f32 v[226:227], v[226:227], v[160:161] op_sel:[0,0] op_sel_hi:[1,0]
v_cvt_pk_bf16_f32 v220, v220, v221
v_cvt_pk_bf16_f32 v221, v222, v223
v_cvt_pk_bf16_f32 v222, v224, v225
v_cvt_pk_bf16_f32 v223, v226, v227
buffer_store_dwordx4 v[220:223], v18, s[20:23], s46 offen
s_add_u32 s46, s46, 32768
v_pk_mul_f32 v[228:229], v[228:229], v[168:169] op_sel:[0,0] op_sel_hi:[1,0]
v_pk_mul_f32 v[230:231], v[230:231], v[168:169] op_sel:[0,0] op_sel_hi:[1,0]
v_pk_mul_f32 v[232:233], v[232:233], v[168:169] op_sel:[0,0] op_sel_hi:[1,0]
v_pk_mul_f32 v[234:235], v[234:235], v[168:169] op_sel:[0,0] op_sel_hi:[1,0]
v_cvt_pk_bf16_f32 v228, v228, v229
v_cvt_pk_bf16_f32 v229, v230, v231
v_cvt_pk_bf16_f32 v230, v232, v233
v_cvt_pk_bf16_f32 v231, v234, v235
buffer_store_dwordx4 v[228:231], v18, s[20:23], s46 offen
s_add_u32 s46, s46, 32768
v_pk_mul_f32 v[236:237], v[236:237], v[176:177] op_sel:[0,0] op_sel_hi:[1,0]
v_pk_mul_f32 v[238:239], v[238:239], v[176:177] op_sel:[0,0] op_sel_hi:[1,0]
v_pk_mul_f32 v[240:241], v[240:241], v[176:177] op_sel:[0,0] op_sel_hi:[1,0]
v_pk_mul_f32 v[242:243], v[242:243], v[176:177] op_sel:[0,0] op_sel_hi:[1,0]
v_cvt_pk_bf16_f32 v236, v236, v237
v_cvt_pk_bf16_f32 v237, v238, v239
v_cvt_pk_bf16_f32 v238, v240, v241
v_cvt_pk_bf16_f32 v239, v242, v243
buffer_store_dwordx4 v[236:239], v18, s[20:23], s46 offen
s_endpgm
qkv0_kernel_loader:
s_sub_u32 s43, s28, 4
v_lshrrev_b32 v4, 3, v0
v_and_b32 v5, 7, v0
s_lshl_b32 s35, s29, 7
s_lshl_b32 s36, s43, 4
s_add_u32 s35, s35, s36
v_add_u32 v6, s35, v4
v_lshlrev_b32 v6, 11, v6
v_lshrrev_b32 v7, 1, v4
v_xor_b32 v7, v7, v5
v_lshl_add_u32 v20, v7, 4, v6
v_xor_b32 v21, 64, v20
v_add_u32 v21, 15360, v21
v_add_u32 v22, 131072, v20
v_add_u32 v23, 131072, v21
v_subrev_u32 v24, 32768, v20
v_subrev_u32 v25, 32768, v21
s_lshl_b32 s35, s43, 4
v_add_u32 v6, s35, v4
v_mul_u32_u24 v6, 6144, v6
v_and_b32 v7, 2, v4
v_xor_b32 v7, v7, v5
s_lshl_b32 s35, s30, 7
v_lshl_add_u32 v26, v7, 4, v6
v_add_u32 v26, s35, v26
v_xor_b32 v27, 64, v26
v_add_u32 v27, 48128, v27
s_lshl_b32 s44, s43, 11
v_add_u32 v10, s44, v10
v_add_u32 v11, s44, v11
s_mov_b32 s33, 0
s_mov_b32 s34, 0
s_mov_b32 s32, 0
s_mov_b32 s36, 0xffffff00
s_mov_b32 s37, -1
s_mov_b64 s[38:39], -1
s_cmp_lg_u32 s43, 0
s_cbranch_scc1 qkv0_kernel_nofill
v_mov_b32 v40, 0x3f803f80
v_mov_b32 v41, 0x3f803f80
v_mov_b32 v42, 0x3f803f80
v_mov_b32 v43, 0x3f803f80
v_lshlrev_b32 v6, 4, v0
v_add_u32 v7, 86016, v6
ds_write_b128 v6, v[40:43] offset:0
ds_write_b128 v6, v[40:43] offset:1024
ds_write_b128 v6, v[40:43] offset:43008
ds_write_b128 v6, v[40:43] offset:44032
ds_write_b128 v7, v[40:43] offset:0
ds_write_b128 v7, v[40:43] offset:1024
s_waitcnt lgkmcnt(0)
qkv0_kernel_nofill:
s_mov_b32 s31, 0
qkv0_kernel_pro:
s_cmp_lg_u32 s43, 0
s_cbranch_scc1 qkv0_kernel_nohalop
s_mov_b32 m0, s32
s_mov_b64 exec, s[36:37]
buffer_load_dwordx4 v24, s[12:15], s33 offen lds
s_mov_b64 exec, s[38:39]
buffer_load_dwordx4 v25, s[12:15], s33 offen offset:1024 lds
s_mov_b64 exec, -1
qkv0_kernel_nohalop:
s_add_u32 s35, s32, s44
s_add_u32 m0, s35, 18432
s_nop 0
buffer_load_dwordx4 v26, s[16:19], s34 offen lds
buffer_load_dwordx4 v27, s[16:19], s34 offen offset:1024 lds
s_add_u32 m0, s35, 2048
s_nop 0
buffer_load_dwordx4 v20, s[12:15], s33 offen lds
buffer_load_dwordx4 v21, s[12:15], s33 offen offset:1024 lds
s_add_u32 m0, s35, 26624
s_add_u32 s41, s34, 2048
buffer_load_dwordx4 v26, s[16:19], s41 offen lds
buffer_load_dwordx4 v27, s[16:19], s41 offen offset:1024 lds
s_add_u32 m0, s35, 10240
s_nop 0
buffer_load_dwordx4 v22, s[12:15], s33 offen lds
buffer_load_dwordx4 v23, s[12:15], s33 offen offset:1024 lds
s_add_u32 m0, s35, 34816
s_add_u32 s41, s34, 4096
buffer_load_dwordx4 v26, s[16:19], s41 offen lds
buffer_load_dwordx4 v27, s[16:19], s41 offen offset:1024 lds
s_add_u32 s33, s33, 128
s_add_u32 s34, s34, 393216
s_add_u32 s32, s32, 43008
s_cmp_eq_u32 s32, 129024
s_cselect_b32 s32, 0, s32
s_add_u32 s31, s31, 1
s_cmp_lt_u32 s31, 3
s_cbranch_scc1 qkv0_kernel_pro
v_mov_b32 v30, 0
v_mov_b32 v31, 0
v_mov_b32 v32, 0
v_mov_b32 v33, 0
v_mov_b32 v34, 0
v_mov_b32 v35, 0
v_mov_b32 v36, 0
v_mov_b32 v37, 0
v_mov_b32 v28, 0x3f803f80
s_mov_b32 s40, 0
s_mov_b32 s31, 0
s_waitcnt vmcnt(20)
s_barrier
v_add_u32 v12, s40, v10
v_add_u32 v13, s40, v11
ds_read_b128 v[40:43], v12 offset:2048
ds_read_b128 v[44:47], v13 offset:2048
ds_read_b128 v[48:51], v12 offset:10240
ds_read_b128 v[52:55], v13 offset:10240
ds_read_b128 v[56:59], v12 offset:0
ds_read_b128 v[60:63], v13 offset:0
s_add_u32 s40, s40, 43008
s_cmp_eq_u32 s40, 129024
s_cselect_b32 s40, 0, s40
s_waitcnt lgkmcnt(0)
v_dot2c_f32_bf16 v30, v40, v28
v_dot2c_f32_bf16 v31, v40, v40
v_dot2c_f32_bf16 v32, v48, v28
v_dot2c_f32_bf16 v33, v48, v48
v_dot2c_f32_bf16 v34, v56, v28
v_dot2c_f32_bf16 v35, v56, v56
v_dot2c_f32_bf16 v30, v41, v28
v_dot2c_f32_bf16 v31, v41, v41
v_dot2c_f32_bf16 v32, v49, v28
v_dot2c_f32_bf16 v33, v49, v49
v_dot2c_f32_bf16 v34, v57, v28
v_dot2c_f32_bf16 v35, v57, v57
v_dot2c_f32_bf16 v30, v42, v28
v_dot2c_f32_bf16 v31, v42, v42
v_dot2c_f32_bf16 v32, v50, v28
v_dot2c_f32_bf16 v33, v50, v50
v_dot2c_f32_bf16 v34, v58, v28
v_dot2c_f32_bf16 v35, v58, v58
v_dot2c_f32_bf16 v30, v43, v28
v_dot2c_f32_bf16 v31, v43, v43
v_dot2c_f32_bf16 v32, v51, v28
v_dot2c_f32_bf16 v33, v51, v51
v_dot2c_f32_bf16 v34, v59, v28
v_dot2c_f32_bf16 v35, v59, v59
v_dot2c_f32_bf16 v30, v44, v28
v_dot2c_f32_bf16 v31, v44, v44
v_dot2c_f32_bf16 v32, v52, v28
v_dot2c_f32_bf16 v33, v52, v52
v_dot2c_f32_bf16 v34, v60, v28
v_dot2c_f32_bf16 v35, v60, v60
v_dot2c_f32_bf16 v30, v45, v28
v_dot2c_f32_bf16 v31, v45, v45
v_dot2c_f32_bf16 v32, v53, v28
v_dot2c_f32_bf16 v33, v53, v53
v_dot2c_f32_bf16 v34, v61, v28
v_dot2c_f32_bf16 v35, v61, v61
v_dot2c_f32_bf16 v30, v46, v28
v_dot2c_f32_bf16 v31, v46, v46
v_dot2c_f32_bf16 v32, v54, v28
v_dot2c_f32_bf16 v33, v54, v54
v_dot2c_f32_bf16 v34, v62, v28
v_dot2c_f32_bf16 v35, v62, v62
v_dot2c_f32_bf16 v30, v47, v28
v_dot2c_f32_bf16 v31, v47, v47
v_dot2c_f32_bf16 v32, v55, v28
v_dot2c_f32_bf16 v33, v55, v55
v_dot2c_f32_bf16 v34, v63, v28
v_dot2c_f32_bf16 v35, v63, v63
qkv0_kernel_lloop:
s_waitcnt vmcnt(10)
s_barrier
v_add_u32 v12, s40, v10
v_add_u32 v13, s40, v11
ds_read_b128 v[40:43], v12 offset:2048
ds_read_b128 v[44:47], v13 offset:2048
ds_read_b128 v[48:51], v12 offset:10240
ds_read_b128 v[52:55], v13 offset:10240
ds_read_b128 v[56:59], v12 offset:0
ds_read_b128 v[60:63], v13 offset:0
s_add_u32 s40, s40, 43008
s_cmp_eq_u32 s40, 129024
s_cselect_b32 s40, 0, s40
s_cmp_lg_u32 s43, 0
s_cbranch_scc1 qkv0_kernel_nohalol
s_mov_b32 m0, s32
s_mov_b64 exec, s[36:37]
buffer_load_dwordx4 v24, s[12:15], s33 offen lds
s_mov_b64 exec, s[38:39]
buffer_load_dwordx4 v25, s[12:15], s33 offen offset:1024 lds
s_mov_b64 exec, -1
qkv0_kernel_nohalol:
s_add_u32 s35, s32, s44
s_add_u32 m0, s35, 18432
s_nop 0
buffer_load_dwordx4 v26, s[16:19], s34 offen lds
buffer_load_dwordx4 v27, s[16:19], s34 offen offset:1024 lds
s_waitcnt lgkmcnt(0)
v_dot2c_f32_bf16 v30, v40, v28
v_dot2c_f32_bf16 v31, v40, v40
v_dot2c_f32_bf16 v32, v48, v28
v_dot2c_f32_bf16 v33, v48, v48
v_dot2c_f32_bf16 v34, v56, v28
v_dot2c_f32_bf16 v35, v56, v56
s_add_u32 m0, s35, 2048
s_nop 0
buffer_load_dwordx4 v20, s[12:15], s33 offen lds
v_dot2c_f32_bf16 v30, v41, v28
v_dot2c_f32_bf16 v31, v41, v41
v_dot2c_f32_bf16 v32, v49, v28
v_dot2c_f32_bf16 v33, v49, v49
v_dot2c_f32_bf16 v34, v57, v28
v_dot2c_f32_bf16 v35, v57, v57
buffer_load_dwordx4 v21, s[12:15], s33 offen offset:1024 lds
v_dot2c_f32_bf16 v30, v42, v28
v_dot2c_f32_bf16 v31, v42, v42
v_dot2c_f32_bf16 v32, v50, v28
v_dot2c_f32_bf16 v33, v50, v50
v_dot2c_f32_bf16 v34, v58, v28
v_dot2c_f32_bf16 v35, v58, v58
s_add_u32 m0, s35, 26624
s_add_u32 s41, s34, 2048
buffer_load_dwordx4 v26, s[16:19], s41 offen lds
v_dot2c_f32_bf16 v30, v43, v28
v_dot2c_f32_bf16 v31, v43, v43
v_dot2c_f32_bf16 v32, v51, v28
v_dot2c_f32_bf16 v33, v51, v51
v_dot2c_f32_bf16 v34, v59, v28
v_dot2c_f32_bf16 v35, v59, v59
buffer_load_dwordx4 v27, s[16:19], s41 offen offset:1024 lds
v_dot2c_f32_bf16 v30, v44, v28
v_dot2c_f32_bf16 v31, v44, v44
v_dot2c_f32_bf16 v32, v52, v28
v_dot2c_f32_bf16 v33, v52, v52
v_dot2c_f32_bf16 v34, v60, v28
v_dot2c_f32_bf16 v35, v60, v60
s_add_u32 m0, s35, 10240
s_nop 0
buffer_load_dwordx4 v22, s[12:15], s33 offen lds
v_dot2c_f32_bf16 v30, v45, v28
v_dot2c_f32_bf16 v31, v45, v45
v_dot2c_f32_bf16 v32, v53, v28
v_dot2c_f32_bf16 v33, v53, v53
v_dot2c_f32_bf16 v34, v61, v28
v_dot2c_f32_bf16 v35, v61, v61
buffer_load_dwordx4 v23, s[12:15], s33 offen offset:1024 lds
v_dot2c_f32_bf16 v30, v46, v28
v_dot2c_f32_bf16 v31, v46, v46
v_dot2c_f32_bf16 v32, v54, v28
v_dot2c_f32_bf16 v33, v54, v54
v_dot2c_f32_bf16 v34, v62, v28
v_dot2c_f32_bf16 v35, v62, v62
s_add_u32 m0, s35, 34816
s_add_u32 s41, s34, 4096
buffer_load_dwordx4 v26, s[16:19], s41 offen lds
v_dot2c_f32_bf16 v30, v47, v28
v_dot2c_f32_bf16 v31, v47, v47
v_dot2c_f32_bf16 v32, v55, v28
v_dot2c_f32_bf16 v33, v55, v55
v_dot2c_f32_bf16 v34, v63, v28
v_dot2c_f32_bf16 v35, v63, v63
buffer_load_dwordx4 v27, s[16:19], s41 offen offset:1024 lds
s_add_u32 s33, s33, 128
s_add_u32 s34, s34, 393216
s_add_u32 s32, s32, 43008
s_cmp_eq_u32 s32, 129024
s_cselect_b32 s32, 0, s32
s_add_u32 s31, s31, 1
s_cmp_lt_u32 s31, 13
s_cbranch_scc1 qkv0_kernel_lloop
s_waitcnt vmcnt(10)
qkv0_kernel_ltail:
s_barrier
v_add_u32 v12, s40, v10
v_add_u32 v13, s40, v11
ds_read_b128 v[40:43], v12 offset:2048
ds_read_b128 v[44:47], v13 offset:2048
ds_read_b128 v[48:51], v12 offset:10240
ds_read_b128 v[52:55], v13 offset:10240
ds_read_b128 v[56:59], v12 offset:0
ds_read_b128 v[60:63], v13 offset:0
s_add_u32 s40, s40, 43008
s_cmp_eq_u32 s40, 129024
s_cselect_b32 s40, 0, s40
s_waitcnt lgkmcnt(0)
v_dot2c_f32_bf16 v30, v40, v28
v_dot2c_f32_bf16 v31, v40, v40
v_dot2c_f32_bf16 v32, v48, v28
v_dot2c_f32_bf16 v33, v48, v48
v_dot2c_f32_bf16 v34, v56, v28
v_dot2c_f32_bf16 v35, v56, v56
v_dot2c_f32_bf16 v30, v41, v28
v_dot2c_f32_bf16 v31, v41, v41
v_dot2c_f32_bf16 v32, v49, v28
v_dot2c_f32_bf16 v33, v49, v49
v_dot2c_f32_bf16 v34, v57, v28
v_dot2c_f32_bf16 v35, v57, v57
v_dot2c_f32_bf16 v30, v42, v28
v_dot2c_f32_bf16 v31, v42, v42
v_dot2c_f32_bf16 v32, v50, v28
v_dot2c_f32_bf16 v33, v50, v50
v_dot2c_f32_bf16 v34, v58, v28
v_dot2c_f32_bf16 v35, v58, v58
v_dot2c_f32_bf16 v30, v43, v28
v_dot2c_f32_bf16 v31, v43, v43
v_dot2c_f32_bf16 v32, v51, v28
v_dot2c_f32_bf16 v33, v51, v51
v_dot2c_f32_bf16 v34, v59, v28
v_dot2c_f32_bf16 v35, v59, v59
v_dot2c_f32_bf16 v30, v44, v28
v_dot2c_f32_bf16 v31, v44, v44
v_dot2c_f32_bf16 v32, v52, v28
v_dot2c_f32_bf16 v33, v52, v52
v_dot2c_f32_bf16 v34, v60, v28
v_dot2c_f32_bf16 v35, v60, v60
v_dot2c_f32_bf16 v30, v45, v28
v_dot2c_f32_bf16 v31, v45, v45
v_dot2c_f32_bf16 v32, v53, v28
v_dot2c_f32_bf16 v33, v53, v53
v_dot2c_f32_bf16 v34, v61, v28
v_dot2c_f32_bf16 v35, v61, v61
v_dot2c_f32_bf16 v30, v46, v28
v_dot2c_f32_bf16 v31, v46, v46
v_dot2c_f32_bf16 v32, v54, v28
v_dot2c_f32_bf16 v33, v54, v54
v_dot2c_f32_bf16 v34, v62, v28
v_dot2c_f32_bf16 v35, v62, v62
v_dot2c_f32_bf16 v30, v47, v28
v_dot2c_f32_bf16 v31, v47, v47
v_dot2c_f32_bf16 v32, v55, v28
v_dot2c_f32_bf16 v33, v55, v55
v_dot2c_f32_bf16 v34, v63, v28
v_dot2c_f32_bf16 v35, v63, v63
s_waitcnt vmcnt(0)
s_add_u32 s31, s31, 1
s_cmp_lt_u32 s31, 15
s_cbranch_scc1 qkv0_kernel_ltail
s_nop 2
s_nop 1
v_permlane32_swap_b32 v30, v31
v_permlane32_swap_b32 v32, v33
s_nop 0
v_add_f32 v30, v30, v31
v_add_f32 v32, v32, v33
s_nop 1
v_permlane16_swap_b32 v30, v32
s_nop 0
v_add_f32 v30, v30, v32
v_mul_f32 v30, 0x3a800000, v30
v_mov_b32 v32, v30
s_nop 1
v_permlane16_swap_b32 v30, v32
s_nop 0
v_mov_b32 v31, v30
v_mov_b32 v33, v32
s_nop 1
v_permlane32_swap_b32 v30, v31
v_permlane32_swap_b32 v32, v33
s_nop 0
s_nop 1
v_permlane32_swap_b32 v34, v35
v_permlane32_swap_b32 v36, v37
s_nop 0
v_add_f32 v34, v34, v35
v_add_f32 v36, v36, v37
s_nop 1
v_permlane16_swap_b32 v34, v36
s_nop 0
v_add_f32 v34, v34, v36
v_mul_f32 v34, 0x3a800000, v34
v_mov_b32 v36, v34
s_nop 1
v_permlane16_swap_b32 v34, v36
s_nop 0
v_mov_b32 v35, v34
v_mov_b32 v37, v36
s_nop 1
v_permlane32_swap_b32 v34, v35
v_permlane32_swap_b32 v36, v37
s_nop 0
s_lshl_b32 s35, s43, 4
v_add_u32 v6, s35, v2
v_lshlrev_b32 v7, 3, v6
v_add_u32 v7, 129024, v7
v_lshlrev_b32 v6, 2, v6
v_add_u32 v6, 130176, v6
v_fma_f32 v31, -v30, v30, v31
v_max_f32 v31, 0, v31
v_add_f32 v31, 0x3727c5ac, v31
v_rsq_f32 v40, v31
v_sub_f32 v41, 0, v30
v_fma_f32 v33, -v32, v32, v33
v_max_f32 v33, 0, v33
v_add_f32 v33, 0x3727c5ac, v33
v_rsq_f32 v42, v33
v_sub_f32 v43, 0, v32
v_fma_f32 v35, -v34, v34, v35
v_max_f32 v35, 0, v35
v_add_f32 v35, 0x3727c5ac, v35
v_rsq_f32 v44, v35
v_sub_f32 v45, 0, v34
s_mov_b64 exec, 0xffff
ds_write_b64 v7, v[40:41] offset:128
ds_write_b32 v6, v40 offset:64
ds_write_b32 v6, v41 offset:640
ds_write_b64 v7, v[42:43] offset:640
ds_write_b32 v6, v42 offset:320
ds_write_b32 v6, v43 offset:896
s_cmp_lg_u32 s43, 0
s_cbranch_scc1 qkv0_kernel_nost
ds_write_b64 v7, v[44:45] offset:0
ds_write_b32 v6, v44 offset:0
ds_write_b32 v6, v45 offset:576
qkv0_kernel_nost:
s_waitcnt lgkmcnt(0)
s_barrier
s_barrier
qkv0_kernel_end:
s_endpgm
.text
.globl out0_kernel
.p2align 8
.type out0_kernel,@function
out0_kernel:
s_cmp_ge_u32 s2, 256
s_cbranch_scc1 out0_kernel_end
s_load_dwordx2 s[8:9], s[0:1], 72
s_load_dwordx2 s[6:7], s[0:1], 16
s_load_dwordx2 s[4:5], s[0:1], 0
v_lshrrev_b32 v1, 6, v0
v_and_b32 v0, 63, v0
v_readfirstlane_b32 s28, v1
s_and_b32 s35, s2, 7
s_lshr_b32 s41, s2, 3
s_and_b32 s29, s35, 7
s_lshl_b32 s29, s29, 1
s_and_b32 s30, s41, 1
s_add_u32 s29, s29, s30
s_lshr_b32 s30, s35, 3
s_lshl_b32 s30, s30, 4
s_lshr_b32 s41, s41, 1
s_add_u32 s30, s30, s41
v_and_b32 v2, 15, v0
v_lshrrev_b32 v3, 4, v0
v_lshlrev_b32 v18, 4, v0
v_lshrrev_b32 v4, 3, v0
v_and_b32 v5, 7, v0
s_lshr_b32 s35, s28, 1
s_lshl_b32 s35, s35, 5
s_and_b32 s36, s28, 1
s_lshl_b32 s36, s36, 3
s_add_u32 s35, s35, s36
v_lshrrev_b32 v6, 2, v4
v_lshlrev_b32 v6, 4, v6
v_and_b32 v7, 3, v4
v_add3_u32 v6, v6, v7, s35
v_lshlrev_b32 v6, 11, v6
v_and_b32 v7, 2, v4
v_xor_b32 v7, v7, v5
s_lshl_b32 s35, s30, 7
v_lshl_add_u32 v10, v7, 4, v6
v_add_u32 v10, s35, v10
v_xor_b32 v11, 64, v10
v_add_u32 v11, 7168, v11
s_lshl_b32 s35, s29, 3
s_lshl_b32 s36, s28, 1
s_add_u32 s47, s35, s36
s_lshl_b32 s35, s47, 15
v_add_u32 v12, s35, v18
v_add_u32 v13, 32768, v12
v_lshrrev_b32 v4, 2, v2
v_and_b32 v5, 3, v0
v_lshl_add_u32 v6, v3, 3, v4
v_lshlrev_b32 v6, 7, v6
v_lshl_add_u32 v6, v5, 3, v6
v_lshrrev_b32 v7, 1, v4
v_and_b32 v8, 1, v3
v_lshl_add_u32 v7, v8, 1, v7
v_lshl_add_u32 v14, v7, 5, v6
v_xor_b32 v15, 32, v14
v_xor_b32 v16, 64, v14
v_xor_b32 v17, 96, v14
s_waitcnt lgkmcnt(0)
s_mov_b32 s16, s6
s_and_b32 s17, s7, 0xffff
s_mov_b32 s18, 2097152
s_mov_b32 s19, 0x00020000
s_mov_b32 s20, s8
s_and_b32 s21, s9, 0xffff
s_mov_b32 s22, 268435456
s_mov_b32 s23, 0x00020000
s_mov_b32 s12, s4
s_and_b32 s13, s5, 0xffff
s_mov_b32 s14, 4194304
s_mov_b32 s15, 0x00020000
s_lshl_b32 s33, s28, 11
s_mov_b32 s34, 12582912
s_mov_b32 s41, 0
s_add_u32 m0, s33, 0
buffer_load_dwordx4 v[64:67], v12, s[20:23], s34 offen
buffer_load_dwordx4 v10, s[16:19], s41 offen lds
buffer_load_dwordx4 v[68:71], v13, s[20:23], s34 offen
buffer_load_dwordx4 v11, s[16:19], s41 offen offset:1024 lds
buffer_load_dwordx4 v[72:75], v12, s[20:23], s34 offen offset:1024
buffer_load_dwordx4 v[76:79], v13, s[20:23], s34 offen offset:1024
s_add_u32 s34, s34, 2048
s_add_u32 s41, s41, 131072
s_add_u32 m0, s33, 8192
buffer_load_dwordx4 v[80:83], v12, s[20:23], s34 offen
buffer_load_dwordx4 v10, s[16:19], s41 offen lds
buffer_load_dwordx4 v[84:87], v13, s[20:23], s34 offen
buffer_load_dwordx4 v11, s[16:19], s41 offen offset:1024 lds
buffer_load_dwordx4 v[88:91], v12, s[20:23], s34 offen offset:1024
buffer_load_dwordx4 v[92:95], v13, s[20:23], s34 offen offset:1024
s_add_u32 s34, s34, 2048
s_add_u32 s41, s41, 131072
s_add_u32 m0, s33, 16384
buffer_load_dwordx4 v[96:99], v12, s[20:23], s34 offen
buffer_load_dwordx4 v10, s[16:19], s41 offen lds
buffer_load_dwordx4 v[100:103], v13, s[20:23], s34 offen
buffer_load_dwordx4 v11, s[16:19], s41 offen offset:1024 lds
buffer_load_dwordx4 v[104:107], v12, s[20:23], s34 offen offset:1024
buffer_load_dwordx4 v[108:111], v13, s[20:23], s34 offen offset:1024
s_add_u32 s34, s34, 2048
s_add_u32 s41, s41, 131072
s_lshl_b32 s35, s47, 4
v_add_u32 v4, s35, v2
v_lshlrev_b32 v4, 11, v4
v_and_b32 v5, 1, v3
v_lshl_add_u32 v4, v5, 5, v4
v_lshrrev_b32 v5, 1, v3
v_lshl_add_u32 v4, v5, 4, v4
s_lshl_b32 s35, s30, 7
v_add_u32 v20, s35, v4
v_add_u32 v21, 32768, v20
s_lshl_b32 s48, s30, 11
v_mov_b32 v160, 0
v_mov_b32 v161, 0
v_mov_b32 v162, 0
v_mov_b32 v163, 0
v_mov_b32 v164, 0
v_mov_b32 v165, 0
v_mov_b32 v166, 0
v_mov_b32 v167, 0
v_mov_b32 v168, 0
v_mov_b32 v169, 0
v_mov_b32 v170, 0
v_mov_b32 v171, 0
v_mov_b32 v172, 0
v_mov_b32 v173, 0
v_mov_b32 v174, 0
v_mov_b32 v175, 0
v_mov_b32 v176, 0
v_mov_b32 v177, 0
v_mov_b32 v178, 0
v_mov_b32 v179, 0
v_mov_b32 v180, 0
v_mov_b32 v181, 0
v_mov_b32 v182, 0
v_mov_b32 v183, 0
v_mov_b32 v184, 0
v_mov_b32 v185, 0
v_mov_b32 v186, 0
v_mov_b32 v187, 0
v_mov_b32 v188, 0
v_mov_b32 v189, 0
v_mov_b32 v190, 0
v_mov_b32 v191, 0
s_waitcnt vmcnt(12)
s_barrier
ds_read_b64_tr_b16 v[128:129], v14 offset:0
ds_read_b64_tr_b16 v[130:131], v14 offset:512
ds_read_b64_tr_b16 v[132:133], v15 offset:0
ds_read_b64_tr_b16 v[134:135], v15 offset:512
ds_read_b64_tr_b16 v[136:137], v16 offset:0
ds_read_b64_tr_b16 v[138:139], v16 offset:512
ds_read_b64_tr_b16 v[140:141], v17 offset:0
ds_read_b64_tr_b16 v[142:143], v17 offset:512
s_waitcnt lgkmcnt(0)
v_mfma_f32_16x16x32_bf16 v[160:163], v[128:131], v[64:67], v[160:163]
ds_read_b64_tr_b16 v[144:145], v14 offset:4096
ds_read_b64_tr_b16 v[146:147], v14 offset:4608
v_mfma_f32_16x16x32_bf16 v[176:179], v[128:131], v[68:71], v[176:179]
ds_read_b64_tr_b16 v[148:149], v15 offset:4096
ds_read_b64_tr_b16 v[150:151], v15 offset:4608
v_mfma_f32_16x16x32_bf16 v[164:167], v[132:135], v[64:67], v[164:167]
ds_read_b64_tr_b16 v[152:153], v16 offset:4096
ds_read_b64_tr_b16 v[154:155], v16 offset:4608
v_mfma_f32_16x16x32_bf16 v[180:183], v[132:135], v[68:71], v[180:183]
ds_read_b64_tr_b16 v[156:157], v17 offset:4096
ds_read_b64_tr_b16 v[158:159], v17 offset:4608
v_mfma_f32_16x16x32_bf16 v[168:171], v[136:139], v[64:67], v[168:171]
s_add_u32 m0, s33, 24576
buffer_load_dwordx4 v[112:115], v12, s[20:23], s34 offen
v_mfma_f32_16x16x32_bf16 v[184:187], v[136:139], v[68:71], v[184:187]
buffer_load_dwordx4 v10, s[16:19], s41 offen lds
buffer_load_dwordx4 v[116:119], v13, s[20:23], s34 offen
v_mfma_f32_16x16x32_bf16 v[172:175], v[140:143], v[64:67], v[172:175]
buffer_load_dwordx4 v11, s[16:19], s41 offen offset:1024 lds
buffer_load_dwordx4 v[120:123], v12, s[20:23], s34 offen offset:1024
v_mfma_f32_16x16x32_bf16 v[188:191], v[140:143], v[68:71], v[188:191]
buffer_load_dwordx4 v[124:127], v13, s[20:23], s34 offen offset:1024
s_add_u32 s34, s34, 2048
s_add_u32 s41, s41, 131072
s_waitcnt vmcnt(12) lgkmcnt(0)
s_barrier
v_mfma_f32_16x16x32_bf16 v[160:163], v[144:147], v[72:75], v[160:163]
ds_read_b64_tr_b16 v[128:129], v14 offset:8192
v_mfma_f32_16x16x32_bf16 v[176:179], v[144:147], v[76:79], v[176:179]
ds_read_b64_tr_b16 v[130:131], v14 offset:8704
v_mfma_f32_16x16x32_bf16 v[164:167], v[148:151], v[72:75], v[164:167]
ds_read_b64_tr_b16 v[132:133], v15 offset:8192
v_mfma_f32_16x16x32_bf16 v[180:183], v[148:151], v[76:79], v[180:183]
ds_read_b64_tr_b16 v[134:135], v15 offset:8704
v_mfma_f32_16x16x32_bf16 v[168:171], v[152:155], v[72:75], v[168:171]
ds_read_b64_tr_b16 v[136:137], v16 offset:8192
v_mfma_f32_16x16x32_bf16 v[184:187], v[152:155], v[76:79], v[184:187]
ds_read_b64_tr_b16 v[138:139], v16 offset:8704
v_mfma_f32_16x16x32_bf16 v[172:175], v[156:159], v[72:75], v[172:175]
ds_read_b64_tr_b16 v[140:141], v17 offset:8192
v_mfma_f32_16x16x32_bf16 v[188:191], v[156:159], v[76:79], v[188:191]
ds_read_b64_tr_b16 v[142:143], v17 offset:8704
s_waitcnt lgkmcnt(0)
v_mfma_f32_16x16x32_bf16 v[160:163], v[128:131], v[80:83], v[160:163]
ds_read_b64_tr_b16 v[144:145], v14 offset:12288
ds_read_b64_tr_b16 v[146:147], v14 offset:12800
v_mfma_f32_16x16x32_bf16 v[176:179], v[128:131], v[84:87], v[176:179]
ds_read_b64_tr_b16 v[148:149], v15 offset:12288
ds_read_b64_tr_b16 v[150:151], v15 offset:12800
v_mfma_f32_16x16x32_bf16 v[164:167], v[132:135], v[80:83], v[164:167]
ds_read_b64_tr_b16 v[152:153], v16 offset:12288
ds_read_b64_tr_b16 v[154:155], v16 offset:12800
v_mfma_f32_16x16x32_bf16 v[180:183], v[132:135], v[84:87], v[180:183]
ds_read_b64_tr_b16 v[156:157], v17 offset:12288
ds_read_b64_tr_b16 v[158:159], v17 offset:12800
v_mfma_f32_16x16x32_bf16 v[168:171], v[136:139], v[80:83], v[168:171]
s_add_u32 m0, s33, 32768
buffer_load_dwordx4 v[64:67], v12, s[20:23], s34 offen
v_mfma_f32_16x16x32_bf16 v[184:187], v[136:139], v[84:87], v[184:187]
buffer_load_dwordx4 v10, s[16:19], s41 offen lds
buffer_load_dwordx4 v[68:71], v13, s[20:23], s34 offen
v_mfma_f32_16x16x32_bf16 v[172:175], v[140:143], v[80:83], v[172:175]
buffer_load_dwordx4 v11, s[16:19], s41 offen offset:1024 lds
buffer_load_dwordx4 v[72:75], v12, s[20:23], s34 offen offset:1024
v_mfma_f32_16x16x32_bf16 v[188:191], v[140:143], v[84:87], v[188:191]
buffer_load_dwordx4 v[76:79], v13, s[20:23], s34 offen offset:1024
s_add_u32 s34, s34, 2048
s_add_u32 s41, s41, 131072
s_waitcnt vmcnt(12) lgkmcnt(0)
s_barrier
v_mfma_f32_16x16x32_bf16 v[160:163], v[144:147], v[88:91], v[160:163]
ds_read_b64_tr_b16 v[128:129], v14 offset:16384
v_mfma_f32_16x16x32_bf16 v[176:179], v[144:147], v[92:95], v[176:179]
ds_read_b64_tr_b16 v[130:131], v14 offset:16896
v_mfma_f32_16x16x32_bf16 v[164:167], v[148:151], v[88:91], v[164:167]
ds_read_b64_tr_b16 v[132:133], v15 offset:16384
v_mfma_f32_16x16x32_bf16 v[180:183], v[148:151], v[92:95], v[180:183]
ds_read_b64_tr_b16 v[134:135], v15 offset:16896
v_mfma_f32_16x16x32_bf16 v[168:171], v[152:155], v[88:91], v[168:171]
ds_read_b64_tr_b16 v[136:137], v16 offset:16384
v_mfma_f32_16x16x32_bf16 v[184:187], v[152:155], v[92:95], v[184:187]
ds_read_b64_tr_b16 v[138:139], v16 offset:16896
v_mfma_f32_16x16x32_bf16 v[172:175], v[156:159], v[88:91], v[172:175]
ds_read_b64_tr_b16 v[140:141], v17 offset:16384
v_mfma_f32_16x16x32_bf16 v[188:191], v[156:159], v[92:95], v[188:191]
ds_read_b64_tr_b16 v[142:143], v17 offset:16896
s_waitcnt lgkmcnt(0)
v_mfma_f32_16x16x32_bf16 v[160:163], v[128:131], v[96:99], v[160:163]
ds_read_b64_tr_b16 v[144:145], v14 offset:20480
ds_read_b64_tr_b16 v[146:147], v14 offset:20992
v_mfma_f32_16x16x32_bf16 v[176:179], v[128:131], v[100:103], v[176:179]
ds_read_b64_tr_b16 v[148:149], v15 offset:20480
ds_read_b64_tr_b16 v[150:151], v15 offset:20992
v_mfma_f32_16x16x32_bf16 v[164:167], v[132:135], v[96:99], v[164:167]
ds_read_b64_tr_b16 v[152:153], v16 offset:20480
ds_read_b64_tr_b16 v[154:155], v16 offset:20992
v_mfma_f32_16x16x32_bf16 v[180:183], v[132:135], v[100:103], v[180:183]
ds_read_b64_tr_b16 v[156:157], v17 offset:20480
ds_read_b64_tr_b16 v[158:159], v17 offset:20992
v_mfma_f32_16x16x32_bf16 v[168:171], v[136:139], v[96:99], v[168:171]
s_add_u32 m0, s33, 40960
buffer_load_dwordx4 v[80:83], v12, s[20:23], s34 offen
v_mfma_f32_16x16x32_bf16 v[184:187], v[136:139], v[100:103], v[184:187]
buffer_load_dwordx4 v10, s[16:19], s41 offen lds
buffer_load_dwordx4 v[84:87], v13, s[20:23], s34 offen
v_mfma_f32_16x16x32_bf16 v[172:175], v[140:143], v[96:99], v[172:175]
buffer_load_dwordx4 v11, s[16:19], s41 offen offset:1024 lds
buffer_load_dwordx4 v[88:91], v12, s[20:23], s34 offen offset:1024
v_mfma_f32_16x16x32_bf16 v[188:191], v[140:143], v[100:103], v[188:191]
buffer_load_dwordx4 v[92:95], v13, s[20:23], s34 offen offset:1024
s_add_u32 s34, s34, 2048
s_add_u32 s41, s41, 131072
s_waitcnt vmcnt(12) lgkmcnt(0)
s_barrier
v_mfma_f32_16x16x32_bf16 v[160:163], v[144:147], v[104:107], v[160:163]
ds_read_b64_tr_b16 v[128:129], v14 offset:24576
v_mfma_f32_16x16x32_bf16 v[176:179], v[144:147], v[108:111], v[176:179]
ds_read_b64_tr_b16 v[130:131], v14 offset:25088
v_mfma_f32_16x16x32_bf16 v[164:167], v[148:151], v[104:107], v[164:167]
ds_read_b64_tr_b16 v[132:133], v15 offset:24576
v_mfma_f32_16x16x32_bf16 v[180:183], v[148:151], v[108:111], v[180:183]
ds_read_b64_tr_b16 v[134:135], v15 offset:25088
v_mfma_f32_16x16x32_bf16 v[168:171], v[152:155], v[104:107], v[168:171]
ds_read_b64_tr_b16 v[136:137], v16 offset:24576
v_mfma_f32_16x16x32_bf16 v[184:187], v[152:155], v[108:111], v[184:187]
ds_read_b64_tr_b16 v[138:139], v16 offset:25088
v_mfma_f32_16x16x32_bf16 v[172:175], v[156:159], v[104:107], v[172:175]
ds_read_b64_tr_b16 v[140:141], v17 offset:24576
v_mfma_f32_16x16x32_bf16 v[188:191], v[156:159], v[108:111], v[188:191]
ds_read_b64_tr_b16 v[142:143], v17 offset:25088
s_waitcnt lgkmcnt(0)
v_mfma_f32_16x16x32_bf16 v[160:163], v[128:131], v[112:115], v[160:163]
ds_read_b64_tr_b16 v[144:145], v14 offset:28672
ds_read_b64_tr_b16 v[146:147], v14 offset:29184
v_mfma_f32_16x16x32_bf16 v[176:179], v[128:131], v[116:119], v[176:179]
ds_read_b64_tr_b16 v[148:149], v15 offset:28672
ds_read_b64_tr_b16 v[150:151], v15 offset:29184
v_mfma_f32_16x16x32_bf16 v[164:167], v[132:135], v[112:115], v[164:167]
ds_read_b64_tr_b16 v[152:153], v16 offset:28672
ds_read_b64_tr_b16 v[154:155], v16 offset:29184
v_mfma_f32_16x16x32_bf16 v[180:183], v[132:135], v[116:119], v[180:183]
ds_read_b64_tr_b16 v[156:157], v17 offset:28672
ds_read_b64_tr_b16 v[158:159], v17 offset:29184
v_mfma_f32_16x16x32_bf16 v[168:171], v[136:139], v[112:115], v[168:171]
s_add_u32 m0, s33, 49152
buffer_load_dwordx4 v[96:99], v12, s[20:23], s34 offen
v_mfma_f32_16x16x32_bf16 v[184:187], v[136:139], v[116:119], v[184:187]
buffer_load_dwordx4 v10, s[16:19], s41 offen lds
buffer_load_dwordx4 v[100:103], v13, s[20:23], s34 offen
v_mfma_f32_16x16x32_bf16 v[172:175], v[140:143], v[112:115], v[172:175]
buffer_load_dwordx4 v11, s[16:19], s41 offen offset:1024 lds
buffer_load_dwordx4 v[104:107], v12, s[20:23], s34 offen offset:1024
v_mfma_f32_16x16x32_bf16 v[188:191], v[140:143], v[116:119], v[188:191]
buffer_load_dwordx4 v[108:111], v13, s[20:23], s34 offen offset:1024
s_add_u32 s34, s34, 2048
s_add_u32 s41, s41, 131072
s_waitcnt vmcnt(12) lgkmcnt(0)
s_barrier
v_mfma_f32_16x16x32_bf16 v[160:163], v[144:147], v[120:123], v[160:163]
ds_read_b64_tr_b16 v[128:129], v14 offset:32768
v_mfma_f32_16x16x32_bf16 v[176:179], v[144:147], v[124:127], v[176:179]
ds_read_b64_tr_b16 v[130:131], v14 offset:33280
v_mfma_f32_16x16x32_bf16 v[164:167], v[148:151], v[120:123], v[164:167]
ds_read_b64_tr_b16 v[132:133], v15 offset:32768
v_mfma_f32_16x16x32_bf16 v[180:183], v[148:151], v[124:127], v[180:183]
ds_read_b64_tr_b16 v[134:135], v15 offset:33280
v_mfma_f32_16x16x32_bf16 v[168:171], v[152:155], v[120:123], v[168:171]
ds_read_b64_tr_b16 v[136:137], v16 offset:32768
v_mfma_f32_16x16x32_bf16 v[184:187], v[152:155], v[124:127], v[184:187]
ds_read_b64_tr_b16 v[138:139], v16 offset:33280
v_mfma_f32_16x16x32_bf16 v[172:175], v[156:159], v[120:123], v[172:175]
ds_read_b64_tr_b16 v[140:141], v17 offset:32768
v_mfma_f32_16x16x32_bf16 v[188:191], v[156:159], v[124:127], v[188:191]
ds_read_b64_tr_b16 v[142:143], v17 offset:33280
s_waitcnt lgkmcnt(0)
v_mfma_f32_16x16x32_bf16 v[160:163], v[128:131], v[64:67], v[160:163]
ds_read_b64_tr_b16 v[144:145], v14 offset:36864
ds_read_b64_tr_b16 v[146:147], v14 offset:37376
v_mfma_f32_16x16x32_bf16 v[176:179], v[128:131], v[68:71], v[176:179]
ds_read_b64_tr_b16 v[148:149], v15 offset:36864
ds_read_b64_tr_b16 v[150:151], v15 offset:37376
v_mfma_f32_16x16x32_bf16 v[164:167], v[132:135], v[64:67], v[164:167]
ds_read_b64_tr_b16 v[152:153], v16 offset:36864
ds_read_b64_tr_b16 v[154:155], v16 offset:37376
v_mfma_f32_16x16x32_bf16 v[180:183], v[132:135], v[68:71], v[180:183]
ds_read_b64_tr_b16 v[156:157], v17 offset:36864
ds_read_b64_tr_b16 v[158:159], v17 offset:37376
v_mfma_f32_16x16x32_bf16 v[168:171], v[136:139], v[64:67], v[168:171]
s_add_u32 m0, s33, 57344
buffer_load_dwordx4 v[112:115], v12, s[20:23], s34 offen
v_mfma_f32_16x16x32_bf16 v[184:187], v[136:139], v[68:71], v[184:187]
buffer_load_dwordx4 v10, s[16:19], s41 offen lds
buffer_load_dwordx4 v[116:119], v13, s[20:23], s34 offen
v_mfma_f32_16x16x32_bf16 v[172:175], v[140:143], v[64:67], v[172:175]
buffer_load_dwordx4 v11, s[16:19], s41 offen offset:1024 lds
buffer_load_dwordx4 v[120:123], v12, s[20:23], s34 offen offset:1024
v_mfma_f32_16x16x32_bf16 v[188:191], v[140:143], v[68:71], v[188:191]
buffer_load_dwordx4 v[124:127], v13, s[20:23], s34 offen offset:1024
s_add_u32 s34, s34, 2048
s_add_u32 s41, s41, 131072
s_waitcnt vmcnt(12) lgkmcnt(0)
s_barrier
v_mfma_f32_16x16x32_bf16 v[160:163], v[144:147], v[72:75], v[160:163]
ds_read_b64_tr_b16 v[128:129], v14 offset:40960
v_mfma_f32_16x16x32_bf16 v[176:179], v[144:147], v[76:79], v[176:179]
ds_read_b64_tr_b16 v[130:131], v14 offset:41472
v_mfma_f32_16x16x32_bf16 v[164:167], v[148:151], v[72:75], v[164:167]
ds_read_b64_tr_b16 v[132:133], v15 offset:40960
v_mfma_f32_16x16x32_bf16 v[180:183], v[148:151], v[76:79], v[180:183]
ds_read_b64_tr_b16 v[134:135], v15 offset:41472
v_mfma_f32_16x16x32_bf16 v[168:171], v[152:155], v[72:75], v[168:171]
ds_read_b64_tr_b16 v[136:137], v16 offset:40960
v_mfma_f32_16x16x32_bf16 v[184:187], v[152:155], v[76:79], v[184:187]
ds_read_b64_tr_b16 v[138:139], v16 offset:41472
v_mfma_f32_16x16x32_bf16 v[172:175], v[156:159], v[72:75], v[172:175]
ds_read_b64_tr_b16 v[140:141], v17 offset:40960
v_mfma_f32_16x16x32_bf16 v[188:191], v[156:159], v[76:79], v[188:191]
ds_read_b64_tr_b16 v[142:143], v17 offset:41472
s_waitcnt lgkmcnt(0)
v_mfma_f32_16x16x32_bf16 v[160:163], v[128:131], v[80:83], v[160:163]
ds_read_b64_tr_b16 v[144:145], v14 offset:45056
ds_read_b64_tr_b16 v[146:147], v14 offset:45568
v_mfma_f32_16x16x32_bf16 v[176:179], v[128:131], v[84:87], v[176:179]
ds_read_b64_tr_b16 v[148:149], v15 offset:45056
ds_read_b64_tr_b16 v[150:151], v15 offset:45568
v_mfma_f32_16x16x32_bf16 v[164:167], v[132:135], v[80:83], v[164:167]
ds_read_b64_tr_b16 v[152:153], v16 offset:45056
ds_read_b64_tr_b16 v[154:155], v16 offset:45568
v_mfma_f32_16x16x32_bf16 v[180:183], v[132:135], v[84:87], v[180:183]
ds_read_b64_tr_b16 v[156:157], v17 offset:45056
ds_read_b64_tr_b16 v[158:159], v17 offset:45568
v_mfma_f32_16x16x32_bf16 v[168:171], v[136:139], v[80:83], v[168:171]
s_add_u32 m0, s33, 65536
buffer_load_dwordx4 v[64:67], v12, s[20:23], s34 offen
v_mfma_f32_16x16x32_bf16 v[184:187], v[136:139], v[84:87], v[184:187]
buffer_load_dwordx4 v10, s[16:19], s41 offen lds
buffer_load_dwordx4 v[68:71], v13, s[20:23], s34 offen
v_mfma_f32_16x16x32_bf16 v[172:175], v[140:143], v[80:83], v[172:175]
buffer_load_dwordx4 v11, s[16:19], s41 offen offset:1024 lds
buffer_load_dwordx4 v[72:75], v12, s[20:23], s34 offen offset:1024
v_mfma_f32_16x16x32_bf16 v[188:191], v[140:143], v[84:87], v[188:191]
buffer_load_dwordx4 v[76:79], v13, s[20:23], s34 offen offset:1024
s_add_u32 s34, s34, 2048
s_add_u32 s41, s41, 131072
s_waitcnt vmcnt(12) lgkmcnt(0)
s_barrier
v_mfma_f32_16x16x32_bf16 v[160:163], v[144:147], v[88:91], v[160:163]
ds_read_b64_tr_b16 v[128:129], v14 offset:49152
v_mfma_f32_16x16x32_bf16 v[176:179], v[144:147], v[92:95], v[176:179]
ds_read_b64_tr_b16 v[130:131], v14 offset:49664
v_mfma_f32_16x16x32_bf16 v[164:167], v[148:151], v[88:91], v[164:167]
ds_read_b64_tr_b16 v[132:133], v15 offset:49152
v_mfma_f32_16x16x32_bf16 v[180:183], v[148:151], v[92:95], v[180:183]
ds_read_b64_tr_b16 v[134:135], v15 offset:49664
v_mfma_f32_16x16x32_bf16 v[168:171], v[152:155], v[88:91], v[168:171]
ds_read_b64_tr_b16 v[136:137], v16 offset:49152
v_mfma_f32_16x16x32_bf16 v[184:187], v[152:155], v[92:95], v[184:187]
ds_read_b64_tr_b16 v[138:139], v16 offset:49664
v_mfma_f32_16x16x32_bf16 v[172:175], v[156:159], v[88:91], v[172:175]
ds_read_b64_tr_b16 v[140:141], v17 offset:49152
v_mfma_f32_16x16x32_bf16 v[188:191], v[156:159], v[92:95], v[188:191]
ds_read_b64_tr_b16 v[142:143], v17 offset:49664
s_waitcnt lgkmcnt(0)
v_mfma_f32_16x16x32_bf16 v[160:163], v[128:131], v[96:99], v[160:163]
ds_read_b64_tr_b16 v[144:145], v14 offset:53248
ds_read_b64_tr_b16 v[146:147], v14 offset:53760
v_mfma_f32_16x16x32_bf16 v[176:179], v[128:131], v[100:103], v[176:179]
ds_read_b64_tr_b16 v[148:149], v15 offset:53248
ds_read_b64_tr_b16 v[150:151], v15 offset:53760
v_mfma_f32_16x16x32_bf16 v[164:167], v[132:135], v[96:99], v[164:167]
ds_read_b64_tr_b16 v[152:153], v16 offset:53248
ds_read_b64_tr_b16 v[154:155], v16 offset:53760
v_mfma_f32_16x16x32_bf16 v[180:183], v[132:135], v[100:103], v[180:183]
ds_read_b64_tr_b16 v[156:157], v17 offset:53248
ds_read_b64_tr_b16 v[158:159], v17 offset:53760
v_mfma_f32_16x16x32_bf16 v[168:171], v[136:139], v[96:99], v[168:171]
s_add_u32 m0, s33, 73728
buffer_load_dwordx4 v[80:83], v12, s[20:23], s34 offen
v_mfma_f32_16x16x32_bf16 v[184:187], v[136:139], v[100:103], v[184:187]
buffer_load_dwordx4 v10, s[16:19], s41 offen lds
buffer_load_dwordx4 v[84:87], v13, s[20:23], s34 offen
v_mfma_f32_16x16x32_bf16 v[172:175], v[140:143], v[96:99], v[172:175]
buffer_load_dwordx4 v11, s[16:19], s41 offen offset:1024 lds
buffer_load_dwordx4 v[88:91], v12, s[20:23], s34 offen offset:1024
v_mfma_f32_16x16x32_bf16 v[188:191], v[140:143], v[100:103], v[188:191]
buffer_load_dwordx4 v[92:95], v13, s[20:23], s34 offen offset:1024
s_add_u32 s34, s34, 2048
s_add_u32 s41, s41, 131072
s_waitcnt vmcnt(12) lgkmcnt(0)
s_barrier
v_mfma_f32_16x16x32_bf16 v[160:163], v[144:147], v[104:107], v[160:163]
ds_read_b64_tr_b16 v[128:129], v14 offset:57344
v_mfma_f32_16x16x32_bf16 v[176:179], v[144:147], v[108:111], v[176:179]
ds_read_b64_tr_b16 v[130:131], v14 offset:57856
v_mfma_f32_16x16x32_bf16 v[164:167], v[148:151], v[104:107], v[164:167]
ds_read_b64_tr_b16 v[132:133], v15 offset:57344
v_mfma_f32_16x16x32_bf16 v[180:183], v[148:151], v[108:111], v[180:183]
ds_read_b64_tr_b16 v[134:135], v15 offset:57856
v_mfma_f32_16x16x32_bf16 v[168:171], v[152:155], v[104:107], v[168:171]
ds_read_b64_tr_b16 v[136:137], v16 offset:57344
v_mfma_f32_16x16x32_bf16 v[184:187], v[152:155], v[108:111], v[184:187]
ds_read_b64_tr_b16 v[138:139], v16 offset:57856
v_mfma_f32_16x16x32_bf16 v[172:175], v[156:159], v[104:107], v[172:175]
ds_read_b64_tr_b16 v[140:141], v17 offset:57344
v_mfma_f32_16x16x32_bf16 v[188:191], v[156:159], v[108:111], v[188:191]
ds_read_b64_tr_b16 v[142:143], v17 offset:57856
s_waitcnt lgkmcnt(0)
v_mfma_f32_16x16x32_bf16 v[160:163], v[128:131], v[112:115], v[160:163]
ds_read_b64_tr_b16 v[144:145], v14 offset:61440
ds_read_b64_tr_b16 v[146:147], v14 offset:61952
v_mfma_f32_16x16x32_bf16 v[176:179], v[128:131], v[116:119], v[176:179]
ds_read_b64_tr_b16 v[148:149], v15 offset:61440
ds_read_b64_tr_b16 v[150:151], v15 offset:61952
v_mfma_f32_16x16x32_bf16 v[164:167], v[132:135], v[112:115], v[164:167]
ds_read_b64_tr_b16 v[152:153], v16 offset:61440
ds_read_b64_tr_b16 v[154:155], v16 offset:61952
v_mfma_f32_16x16x32_bf16 v[180:183], v[132:135], v[116:119], v[180:183]
ds_read_b64_tr_b16 v[156:157], v17 offset:61440
ds_read_b64_tr_b16 v[158:159], v17 offset:61952
v_mfma_f32_16x16x32_bf16 v[168:171], v[136:139], v[112:115], v[168:171]
s_add_u32 m0, s33, 81920
buffer_load_dwordx4 v[96:99], v12, s[20:23], s34 offen
v_mfma_f32_16x16x32_bf16 v[184:187], v[136:139], v[116:119], v[184:187]
buffer_load_dwordx4 v10, s[16:19], s41 offen lds
buffer_load_dwordx4 v[100:103], v13, s[20:23], s34 offen
v_mfma_f32_16x16x32_bf16 v[172:175], v[140:143], v[112:115], v[172:175]
buffer_load_dwordx4 v11, s[16:19], s41 offen offset:1024 lds
buffer_load_dwordx4 v[104:107], v12, s[20:23], s34 offen offset:1024
v_mfma_f32_16x16x32_bf16 v[188:191], v[140:143], v[116:119], v[188:191]
buffer_load_dwordx4 v[108:111], v13, s[20:23], s34 offen offset:1024
s_add_u32 s34, s34, 2048
s_add_u32 s41, s41, 131072
s_waitcnt vmcnt(12) lgkmcnt(0)
s_barrier
v_add_u32 v14, 0x10000, v14
v_add_u32 v15, 0x10000, v15
v_add_u32 v16, 0x10000, v16
v_add_u32 v17, 0x10000, v17
v_mfma_f32_16x16x32_bf16 v[160:163], v[144:147], v[120:123], v[160:163]
ds_read_b64_tr_b16 v[128:129], v14 offset:0
v_mfma_f32_16x16x32_bf16 v[176:179], v[144:147], v[124:127], v[176:179]
ds_read_b64_tr_b16 v[130:131], v14 offset:512
v_mfma_f32_16x16x32_bf16 v[164:167], v[148:151], v[120:123], v[164:167]
ds_read_b64_tr_b16 v[132:133], v15 offset:0
v_mfma_f32_16x16x32_bf16 v[180:183], v[148:151], v[124:127], v[180:183]
ds_read_b64_tr_b16 v[134:135], v15 offset:512
v_mfma_f32_16x16x32_bf16 v[168:171], v[152:155], v[120:123], v[168:171]
ds_read_b64_tr_b16 v[136:137], v16 offset:0
v_mfma_f32_16x16x32_bf16 v[184:187], v[152:155], v[124:127], v[184:187]
ds_read_b64_tr_b16 v[138:139], v16 offset:512
v_mfma_f32_16x16x32_bf16 v[172:175], v[156:159], v[120:123], v[172:175]
ds_read_b64_tr_b16 v[140:141], v17 offset:0
v_mfma_f32_16x16x32_bf16 v[188:191], v[156:159], v[124:127], v[188:191]
ds_read_b64_tr_b16 v[142:143], v17 offset:512
s_waitcnt lgkmcnt(0)
v_mfma_f32_16x16x32_bf16 v[160:163], v[128:131], v[64:67], v[160:163]
ds_read_b64_tr_b16 v[144:145], v14 offset:4096
ds_read_b64_tr_b16 v[146:147], v14 offset:4608
v_mfma_f32_16x16x32_bf16 v[176:179], v[128:131], v[68:71], v[176:179]
ds_read_b64_tr_b16 v[148:149], v15 offset:4096
ds_read_b64_tr_b16 v[150:151], v15 offset:4608
v_mfma_f32_16x16x32_bf16 v[164:167], v[132:135], v[64:67], v[164:167]
ds_read_b64_tr_b16 v[152:153], v16 offset:4096
ds_read_b64_tr_b16 v[154:155], v16 offset:4608
v_mfma_f32_16x16x32_bf16 v[180:183], v[132:135], v[68:71], v[180:183]
ds_read_b64_tr_b16 v[156:157], v17 offset:4096
ds_read_b64_tr_b16 v[158:159], v17 offset:4608
v_mfma_f32_16x16x32_bf16 v[168:171], v[136:139], v[64:67], v[168:171]
s_add_u32 m0, s33, 90112
buffer_load_dwordx4 v[112:115], v12, s[20:23], s34 offen
v_mfma_f32_16x16x32_bf16 v[184:187], v[136:139], v[68:71], v[184:187]
buffer_load_dwordx4 v10, s[16:19], s41 offen lds
buffer_load_dwordx4 v[116:119], v13, s[20:23], s34 offen
v_mfma_f32_16x16x32_bf16 v[172:175], v[140:143], v[64:67], v[172:175]
buffer_load_dwordx4 v11, s[16:19], s41 offen offset:1024 lds
buffer_load_dwordx4 v[120:123], v12, s[20:23], s34 offen offset:1024
v_mfma_f32_16x16x32_bf16 v[188:191], v[140:143], v[68:71], v[188:191]
buffer_load_dwordx4 v[124:127], v13, s[20:23], s34 offen offset:1024
s_add_u32 s34, s34, 2048
s_add_u32 s41, s41, 131072
s_waitcnt vmcnt(12) lgkmcnt(0)
s_barrier
v_mfma_f32_16x16x32_bf16 v[160:163], v[144:147], v[72:75], v[160:163]
ds_read_b64_tr_b16 v[128:129], v14 offset:8192
v_mfma_f32_16x16x32_bf16 v[176:179], v[144:147], v[76:79], v[176:179]
ds_read_b64_tr_b16 v[130:131], v14 offset:8704
v_mfma_f32_16x16x32_bf16 v[164:167], v[148:151], v[72:75], v[164:167]
ds_read_b64_tr_b16 v[132:133], v15 offset:8192
v_mfma_f32_16x16x32_bf16 v[180:183], v[148:151], v[76:79], v[180:183]
ds_read_b64_tr_b16 v[134:135], v15 offset:8704
v_mfma_f32_16x16x32_bf16 v[168:171], v[152:155], v[72:75], v[168:171]
ds_read_b64_tr_b16 v[136:137], v16 offset:8192
v_mfma_f32_16x16x32_bf16 v[184:187], v[152:155], v[76:79], v[184:187]
ds_read_b64_tr_b16 v[138:139], v16 offset:8704
v_mfma_f32_16x16x32_bf16 v[172:175], v[156:159], v[72:75], v[172:175]
ds_read_b64_tr_b16 v[140:141], v17 offset:8192
v_mfma_f32_16x16x32_bf16 v[188:191], v[156:159], v[76:79], v[188:191]
ds_read_b64_tr_b16 v[142:143], v17 offset:8704
s_waitcnt lgkmcnt(0)
v_mfma_f32_16x16x32_bf16 v[160:163], v[128:131], v[80:83], v[160:163]
ds_read_b64_tr_b16 v[144:145], v14 offset:12288
ds_read_b64_tr_b16 v[146:147], v14 offset:12800
v_mfma_f32_16x16x32_bf16 v[176:179], v[128:131], v[84:87], v[176:179]
ds_read_b64_tr_b16 v[148:149], v15 offset:12288
ds_read_b64_tr_b16 v[150:151], v15 offset:12800
v_mfma_f32_16x16x32_bf16 v[164:167], v[132:135], v[80:83], v[164:167]
ds_read_b64_tr_b16 v[152:153], v16 offset:12288
ds_read_b64_tr_b16 v[154:155], v16 offset:12800
v_mfma_f32_16x16x32_bf16 v[180:183], v[132:135], v[84:87], v[180:183]
ds_read_b64_tr_b16 v[156:157], v17 offset:12288
ds_read_b64_tr_b16 v[158:159], v17 offset:12800
v_mfma_f32_16x16x32_bf16 v[168:171], v[136:139], v[80:83], v[168:171]
s_add_u32 m0, s33, 98304
buffer_load_dwordx4 v[64:67], v12, s[20:23], s34 offen
v_mfma_f32_16x16x32_bf16 v[184:187], v[136:139], v[84:87], v[184:187]
buffer_load_dwordx4 v10, s[16:19], s41 offen lds
buffer_load_dwordx4 v[68:71], v13, s[20:23], s34 offen
v_mfma_f32_16x16x32_bf16 v[172:175], v[140:143], v[80:83], v[172:175]
buffer_load_dwordx4 v11, s[16:19], s41 offen offset:1024 lds
buffer_load_dwordx4 v[72:75], v12, s[20:23], s34 offen offset:1024
v_mfma_f32_16x16x32_bf16 v[188:191], v[140:143], v[84:87], v[188:191]
buffer_load_dwordx4 v[76:79], v13, s[20:23], s34 offen offset:1024
s_add_u32 s34, s34, 2048
s_add_u32 s41, s41, 131072
s_waitcnt vmcnt(12) lgkmcnt(0)
s_barrier
v_mfma_f32_16x16x32_bf16 v[160:163], v[144:147], v[88:91], v[160:163]
ds_read_b64_tr_b16 v[128:129], v14 offset:16384
v_mfma_f32_16x16x32_bf16 v[176:179], v[144:147], v[92:95], v[176:179]
ds_read_b64_tr_b16 v[130:131], v14 offset:16896
v_mfma_f32_16x16x32_bf16 v[164:167], v[148:151], v[88:91], v[164:167]
ds_read_b64_tr_b16 v[132:133], v15 offset:16384
v_mfma_f32_16x16x32_bf16 v[180:183], v[148:151], v[92:95], v[180:183]
ds_read_b64_tr_b16 v[134:135], v15 offset:16896
v_mfma_f32_16x16x32_bf16 v[168:171], v[152:155], v[88:91], v[168:171]
ds_read_b64_tr_b16 v[136:137], v16 offset:16384
v_mfma_f32_16x16x32_bf16 v[184:187], v[152:155], v[92:95], v[184:187]
ds_read_b64_tr_b16 v[138:139], v16 offset:16896
v_mfma_f32_16x16x32_bf16 v[172:175], v[156:159], v[88:91], v[172:175]
ds_read_b64_tr_b16 v[140:141], v17 offset:16384
v_mfma_f32_16x16x32_bf16 v[188:191], v[156:159], v[92:95], v[188:191]
ds_read_b64_tr_b16 v[142:143], v17 offset:16896
s_waitcnt lgkmcnt(0)
v_mfma_f32_16x16x32_bf16 v[160:163], v[128:131], v[96:99], v[160:163]
ds_read_b64_tr_b16 v[144:145], v14 offset:20480
ds_read_b64_tr_b16 v[146:147], v14 offset:20992
v_mfma_f32_16x16x32_bf16 v[176:179], v[128:131], v[100:103], v[176:179]
ds_read_b64_tr_b16 v[148:149], v15 offset:20480
ds_read_b64_tr_b16 v[150:151], v15 offset:20992
v_mfma_f32_16x16x32_bf16 v[164:167], v[132:135], v[96:99], v[164:167]
ds_read_b64_tr_b16 v[152:153], v16 offset:20480
ds_read_b64_tr_b16 v[154:155], v16 offset:20992
v_mfma_f32_16x16x32_bf16 v[180:183], v[132:135], v[100:103], v[180:183]
ds_read_b64_tr_b16 v[156:157], v17 offset:20480
ds_read_b64_tr_b16 v[158:159], v17 offset:20992
v_mfma_f32_16x16x32_bf16 v[168:171], v[136:139], v[96:99], v[168:171]
s_add_u32 m0, s33, 106496
buffer_load_dwordx4 v[80:83], v12, s[20:23], s34 offen
v_mfma_f32_16x16x32_bf16 v[184:187], v[136:139], v[100:103], v[184:187]
buffer_load_dwordx4 v10, s[16:19], s41 offen lds
buffer_load_dwordx4 v[84:87], v13, s[20:23], s34 offen
v_mfma_f32_16x16x32_bf16 v[172:175], v[140:143], v[96:99], v[172:175]
buffer_load_dwordx4 v11, s[16:19], s41 offen offset:1024 lds
buffer_load_dwordx4 v[88:91], v12, s[20:23], s34 offen offset:1024
v_mfma_f32_16x16x32_bf16 v[188:191], v[140:143], v[100:103], v[188:191]
buffer_load_dwordx4 v[92:95], v13, s[20:23], s34 offen offset:1024
s_add_u32 s34, s34, 2048
s_add_u32 s41, s41, 131072
s_waitcnt vmcnt(12) lgkmcnt(0)
s_barrier
v_mfma_f32_16x16x32_bf16 v[160:163], v[144:147], v[104:107], v[160:163]
ds_read_b64_tr_b16 v[128:129], v14 offset:24576
v_mfma_f32_16x16x32_bf16 v[176:179], v[144:147], v[108:111], v[176:179]
ds_read_b64_tr_b16 v[130:131], v14 offset:25088
v_mfma_f32_16x16x32_bf16 v[164:167], v[148:151], v[104:107], v[164:167]
ds_read_b64_tr_b16 v[132:133], v15 offset:24576
v_mfma_f32_16x16x32_bf16 v[180:183], v[148:151], v[108:111], v[180:183]
ds_read_b64_tr_b16 v[134:135], v15 offset:25088
v_mfma_f32_16x16x32_bf16 v[168:171], v[152:155], v[104:107], v[168:171]
ds_read_b64_tr_b16 v[136:137], v16 offset:24576
v_mfma_f32_16x16x32_bf16 v[184:187], v[152:155], v[108:111], v[184:187]
ds_read_b64_tr_b16 v[138:139], v16 offset:25088
v_mfma_f32_16x16x32_bf16 v[172:175], v[156:159], v[104:107], v[172:175]
ds_read_b64_tr_b16 v[140:141], v17 offset:24576
v_mfma_f32_16x16x32_bf16 v[188:191], v[156:159], v[108:111], v[188:191]
ds_read_b64_tr_b16 v[142:143], v17 offset:25088
s_waitcnt lgkmcnt(0)
v_mfma_f32_16x16x32_bf16 v[160:163], v[128:131], v[112:115], v[160:163]
ds_read_b64_tr_b16 v[144:145], v14 offset:28672
ds_read_b64_tr_b16 v[146:147], v14 offset:29184
v_mfma_f32_16x16x32_bf16 v[176:179], v[128:131], v[116:119], v[176:179]
ds_read_b64_tr_b16 v[148:149], v15 offset:28672
ds_read_b64_tr_b16 v[150:151], v15 offset:29184
v_mfma_f32_16x16x32_bf16 v[164:167], v[132:135], v[112:115], v[164:167]
ds_read_b64_tr_b16 v[152:153], v16 offset:28672
ds_read_b64_tr_b16 v[154:155], v16 offset:29184
v_mfma_f32_16x16x32_bf16 v[180:183], v[132:135], v[116:119], v[180:183]
ds_read_b64_tr_b16 v[156:157], v17 offset:28672
ds_read_b64_tr_b16 v[158:159], v17 offset:29184
v_mfma_f32_16x16x32_bf16 v[168:171], v[136:139], v[112:115], v[168:171]
s_add_u32 m0, s33, 114688
buffer_load_dwordx4 v[96:99], v12, s[20:23], s34 offen
v_mfma_f32_16x16x32_bf16 v[184:187], v[136:139], v[116:119], v[184:187]
buffer_load_dwordx4 v10, s[16:19], s41 offen lds
buffer_load_dwordx4 v[100:103], v13, s[20:23], s34 offen
v_mfma_f32_16x16x32_bf16 v[172:175], v[140:143], v[112:115], v[172:175]
buffer_load_dwordx4 v11, s[16:19], s41 offen offset:1024 lds
buffer_load_dwordx4 v[104:107], v12, s[20:23], s34 offen offset:1024
v_mfma_f32_16x16x32_bf16 v[188:191], v[140:143], v[116:119], v[188:191]
buffer_load_dwordx4 v[108:111], v13, s[20:23], s34 offen offset:1024
s_add_u32 s34, s34, 2048
s_add_u32 s41, s41, 131072
s_waitcnt vmcnt(12) lgkmcnt(0)
s_barrier
v_mfma_f32_16x16x32_bf16 v[160:163], v[144:147], v[120:123], v[160:163]
ds_read_b64_tr_b16 v[128:129], v14 offset:32768
v_mfma_f32_16x16x32_bf16 v[176:179], v[144:147], v[124:127], v[176:179]
ds_read_b64_tr_b16 v[130:131], v14 offset:33280
v_mfma_f32_16x16x32_bf16 v[164:167], v[148:151], v[120:123], v[164:167]
ds_read_b64_tr_b16 v[132:133], v15 offset:32768
v_mfma_f32_16x16x32_bf16 v[180:183], v[148:151], v[124:127], v[180:183]
ds_read_b64_tr_b16 v[134:135], v15 offset:33280
v_mfma_f32_16x16x32_bf16 v[168:171], v[152:155], v[120:123], v[168:171]
ds_read_b64_tr_b16 v[136:137], v16 offset:32768
v_mfma_f32_16x16x32_bf16 v[184:187], v[152:155], v[124:127], v[184:187]
ds_read_b64_tr_b16 v[138:139], v16 offset:33280
v_mfma_f32_16x16x32_bf16 v[172:175], v[156:159], v[120:123], v[172:175]
ds_read_b64_tr_b16 v[140:141], v17 offset:32768
v_mfma_f32_16x16x32_bf16 v[188:191], v[156:159], v[124:127], v[188:191]
ds_read_b64_tr_b16 v[142:143], v17 offset:33280
s_waitcnt lgkmcnt(0)
v_mfma_f32_16x16x32_bf16 v[160:163], v[128:131], v[64:67], v[160:163]
ds_read_b64_tr_b16 v[144:145], v14 offset:36864
ds_read_b64_tr_b16 v[146:147], v14 offset:37376
v_mfma_f32_16x16x32_bf16 v[176:179], v[128:131], v[68:71], v[176:179]
ds_read_b64_tr_b16 v[148:149], v15 offset:36864
ds_read_b64_tr_b16 v[150:151], v15 offset:37376
v_mfma_f32_16x16x32_bf16 v[164:167], v[132:135], v[64:67], v[164:167]
ds_read_b64_tr_b16 v[152:153], v16 offset:36864
ds_read_b64_tr_b16 v[154:155], v16 offset:37376
v_mfma_f32_16x16x32_bf16 v[180:183], v[132:135], v[68:71], v[180:183]
ds_read_b64_tr_b16 v[156:157], v17 offset:36864
ds_read_b64_tr_b16 v[158:159], v17 offset:37376
v_mfma_f32_16x16x32_bf16 v[168:171], v[136:139], v[64:67], v[168:171]
s_add_u32 m0, s33, 122880
buffer_load_dwordx4 v[112:115], v12, s[20:23], s34 offen
v_mfma_f32_16x16x32_bf16 v[184:187], v[136:139], v[68:71], v[184:187]
buffer_load_dwordx4 v10, s[16:19], s41 offen lds
buffer_load_dwordx4 v[116:119], v13, s[20:23], s34 offen
v_mfma_f32_16x16x32_bf16 v[172:175], v[140:143], v[64:67], v[172:175]
buffer_load_dwordx4 v11, s[16:19], s41 offen offset:1024 lds
buffer_load_dwordx4 v[120:123], v12, s[20:23], s34 offen offset:1024
v_mfma_f32_16x16x32_bf16 v[188:191], v[140:143], v[68:71], v[188:191]
buffer_load_dwordx4 v[124:127], v13, s[20:23], s34 offen offset:1024
s_add_u32 s34, s34, 2048
s_add_u32 s41, s41, 131072
s_waitcnt vmcnt(12) lgkmcnt(0)
s_barrier
v_mfma_f32_16x16x32_bf16 v[160:163], v[144:147], v[72:75], v[160:163]
ds_read_b64_tr_b16 v[128:129], v14 offset:40960
v_mfma_f32_16x16x32_bf16 v[176:179], v[144:147], v[76:79], v[176:179]
ds_read_b64_tr_b16 v[130:131], v14 offset:41472
v_mfma_f32_16x16x32_bf16 v[164:167], v[148:151], v[72:75], v[164:167]
ds_read_b64_tr_b16 v[132:133], v15 offset:40960
v_mfma_f32_16x16x32_bf16 v[180:183], v[148:151], v[76:79], v[180:183]
ds_read_b64_tr_b16 v[134:135], v15 offset:41472
v_mfma_f32_16x16x32_bf16 v[168:171], v[152:155], v[72:75], v[168:171]
ds_read_b64_tr_b16 v[136:137], v16 offset:40960
v_mfma_f32_16x16x32_bf16 v[184:187], v[152:155], v[76:79], v[184:187]
ds_read_b64_tr_b16 v[138:139], v16 offset:41472
v_mfma_f32_16x16x32_bf16 v[172:175], v[156:159], v[72:75], v[172:175]
ds_read_b64_tr_b16 v[140:141], v17 offset:40960
v_mfma_f32_16x16x32_bf16 v[188:191], v[156:159], v[76:79], v[188:191]
ds_read_b64_tr_b16 v[142:143], v17 offset:41472
s_waitcnt lgkmcnt(0)
v_mfma_f32_16x16x32_bf16 v[160:163], v[128:131], v[80:83], v[160:163]
ds_read_b64_tr_b16 v[144:145], v14 offset:45056
ds_read_b64_tr_b16 v[146:147], v14 offset:45568
v_mfma_f32_16x16x32_bf16 v[176:179], v[128:131], v[84:87], v[176:179]
ds_read_b64_tr_b16 v[148:149], v15 offset:45056
v_mfma_f32_16x16x32_bf16 v[164:167], v[132:135], v[80:83], v[164:167]
ds_read_b64_tr_b16 v[150:151], v15 offset:45568
ds_read_b64_tr_b16 v[152:153], v16 offset:45056
v_mfma_f32_16x16x32_bf16 v[180:183], v[132:135], v[84:87], v[180:183]
ds_read_b64_tr_b16 v[154:155], v16 offset:45568
v_mfma_f32_16x16x32_bf16 v[168:171], v[136:139], v[80:83], v[168:171]
ds_read_b64_tr_b16 v[156:157], v17 offset:45056
ds_read_b64_tr_b16 v[158:159], v17 offset:45568
v_mfma_f32_16x16x32_bf16 v[184:187], v[136:139], v[84:87], v[184:187]
buffer_load_dwordx4 v[24:27], v20, s[12:15], 0 offen offset:0
v_mfma_f32_16x16x32_bf16 v[172:175], v[140:143], v[80:83], v[172:175]
buffer_load_dwordx4 v[28:31], v20, s[12:15], 0 offen offset:64
buffer_load_dwordx4 v[32:35], v21, s[12:15], 0 offen offset:0
v_mfma_f32_16x16x32_bf16 v[188:191], v[140:143], v[84:87], v[188:191]
buffer_load_dwordx4 v[36:39], v21, s[12:15], 0 offen offset:64
s_waitcnt vmcnt(10) lgkmcnt(0)
s_barrier
v_mfma_f32_16x16x32_bf16 v[160:163], v[144:147], v[88:91], v[160:163]
ds_read_b64_tr_b16 v[128:129], v14 offset:49152
v_mfma_f32_16x16x32_bf16 v[176:179], v[144:147], v[92:95], v[176:179]
ds_read_b64_tr_b16 v[130:131], v14 offset:49664
v_mfma_f32_16x16x32_bf16 v[164:167], v[148:151], v[88:91], v[164:167]
ds_read_b64_tr_b16 v[132:133], v15 offset:49152
v_mfma_f32_16x16x32_bf16 v[180:183], v[148:151], v[92:95], v[180:183]
ds_read_b64_tr_b16 v[134:135], v15 offset:49664
v_mfma_f32_16x16x32_bf16 v[168:171], v[152:155], v[88:91], v[168:171]
ds_read_b64_tr_b16 v[136:137], v16 offset:49152
v_mfma_f32_16x16x32_bf16 v[184:187], v[152:155], v[92:95], v[184:187]
ds_read_b64_tr_b16 v[138:139], v16 offset:49664
v_mfma_f32_16x16x32_bf16 v[172:175], v[156:159], v[88:91], v[172:175]
ds_read_b64_tr_b16 v[140:141], v17 offset:49152
v_mfma_f32_16x16x32_bf16 v[188:191], v[156:159], v[92:95], v[188:191]
ds_read_b64_tr_b16 v[142:143], v17 offset:49664
s_waitcnt lgkmcnt(0)
v_mfma_f32_16x16x32_bf16 v[160:163], v[128:131], v[96:99], v[160:163]
ds_read_b64_tr_b16 v[144:145], v14 offset:53248
v_mfma_f32_16x16x32_bf16 v[176:179], v[128:131], v[100:103], v[176:179]
ds_read_b64_tr_b16 v[146:147], v14 offset:53760
v_mfma_f32_16x16x32_bf16 v[164:167], v[132:135], v[96:99], v[164:167]
ds_read_b64_tr_b16 v[148:149], v15 offset:53248
v_mfma_f32_16x16x32_bf16 v[180:183], v[132:135], v[100:103], v[180:183]
ds_read_b64_tr_b16 v[150:151], v15 offset:53760
v_mfma_f32_16x16x32_bf16 v[168:171], v[136:139], v[96:99], v[168:171]
ds_read_b64_tr_b16 v[152:153], v16 offset:53248
v_mfma_f32_16x16x32_bf16 v[184:187], v[136:139], v[100:103], v[184:187]
ds_read_b64_tr_b16 v[154:155], v16 offset:53760
v_mfma_f32_16x16x32_bf16 v[172:175], v[140:143], v[96:99], v[172:175]
ds_read_b64_tr_b16 v[156:157], v17 offset:53248
v_mfma_f32_16x16x32_bf16 v[188:191], v[140:143], v[100:103], v[188:191]
ds_read_b64_tr_b16 v[158:159], v17 offset:53760
s_waitcnt vmcnt(4) lgkmcnt(0)
s_barrier
v_mfma_f32_16x16x32_bf16 v[160:163], v[144:147], v[104:107], v[160:163]
ds_read_b64_tr_b16 v[128:129], v14 offset:57344
v_mfma_f32_16x16x32_bf16 v[176:179], v[144:147], v[108:111], v[176:179]
ds_read_b64_tr_b16 v[130:131], v14 offset:57856
v_mfma_f32_16x16x32_bf16 v[164:167], v[148:151], v[104:107], v[164:167]
ds_read_b64_tr_b16 v[132:133], v15 offset:57344
v_mfma_f32_16x16x32_bf16 v[180:183], v[148:151], v[108:111], v[180:183]
ds_read_b64_tr_b16 v[134:135], v15 offset:57856
v_mfma_f32_16x16x32_bf16 v[168:171], v[152:155], v[104:107], v[168:171]
ds_read_b64_tr_b16 v[136:137], v16 offset:57344
v_mfma_f32_16x16x32_bf16 v[184:187], v[152:155], v[108:111], v[184:187]
ds_read_b64_tr_b16 v[138:139], v16 offset:57856
v_mfma_f32_16x16x32_bf16 v[172:175], v[156:159], v[104:107], v[172:175]
ds_read_b64_tr_b16 v[140:141], v17 offset:57344
v_mfma_f32_16x16x32_bf16 v[188:191], v[156:159], v[108:111], v[188:191]
ds_read_b64_tr_b16 v[142:143], v17 offset:57856
s_waitcnt lgkmcnt(0)
v_mfma_f32_16x16x32_bf16 v[160:163], v[128:131], v[112:115], v[160:163]
ds_read_b64_tr_b16 v[144:145], v14 offset:61440
v_mfma_f32_16x16x32_bf16 v[176:179], v[128:131], v[116:119], v[176:179]
ds_read_b64_tr_b16 v[146:147], v14 offset:61952
v_mfma_f32_16x16x32_bf16 v[164:167], v[132:135], v[112:115], v[164:167]
ds_read_b64_tr_b16 v[148:149], v15 offset:61440
v_mfma_f32_16x16x32_bf16 v[180:183], v[132:135], v[116:119], v[180:183]
ds_read_b64_tr_b16 v[150:151], v15 offset:61952
v_mfma_f32_16x16x32_bf16 v[168:171], v[136:139], v[112:115], v[168:171]
ds_read_b64_tr_b16 v[152:153], v16 offset:61440
v_mfma_f32_16x16x32_bf16 v[184:187], v[136:139], v[116:119], v[184:187]
ds_read_b64_tr_b16 v[154:155], v16 offset:61952
v_mfma_f32_16x16x32_bf16 v[172:175], v[140:143], v[112:115], v[172:175]
ds_read_b64_tr_b16 v[156:157], v17 offset:61440
v_mfma_f32_16x16x32_bf16 v[188:191], v[140:143], v[116:119], v[188:191]
ds_read_b64_tr_b16 v[158:159], v17 offset:61952
s_waitcnt lgkmcnt(0)
v_mfma_f32_16x16x32_bf16 v[160:163], v[144:147], v[120:123], v[160:163]
v_mfma_f32_16x16x32_bf16 v[176:179], v[144:147], v[124:127], v[176:179]
v_mfma_f32_16x16x32_bf16 v[164:167], v[148:151], v[120:123], v[164:167]
v_mfma_f32_16x16x32_bf16 v[180:183], v[148:151], v[124:127], v[180:183]
v_mfma_f32_16x16x32_bf16 v[168:171], v[152:155], v[120:123], v[168:171]
v_mfma_f32_16x16x32_bf16 v[184:187], v[152:155], v[124:127], v[184:187]
v_mfma_f32_16x16x32_bf16 v[172:175], v[156:159], v[120:123], v[172:175]
v_mfma_f32_16x16x32_bf16 v[188:191], v[156:159], v[124:127], v[188:191]
s_add_u32 s49, s48, 0
s_waitcnt vmcnt(0)
v_permlane16_swap_b32 v24, v26
v_permlane16_swap_b32 v25, v27
v_permlane16_swap_b32 v28, v30
v_permlane16_swap_b32 v29, v31
v_permlane16_swap_b32 v32, v34
v_permlane16_swap_b32 v33, v35
v_permlane16_swap_b32 v36, v38
v_permlane16_swap_b32 v37, v39
s_nop 4
v_lshlrev_b32 v4, 16, v24
v_and_b32 v5, 0xffff0000, v24
v_pk_add_f32 v[160:161], v[160:161], v[4:5]
v_lshlrev_b32 v4, 16, v25
v_and_b32 v5, 0xffff0000, v25
v_pk_add_f32 v[162:163], v[162:163], v[4:5]
v_lshlrev_b32 v4, 16, v26
v_and_b32 v5, 0xffff0000, v26
v_pk_add_f32 v[164:165], v[164:165], v[4:5]
v_lshlrev_b32 v4, 16, v27
v_and_b32 v5, 0xffff0000, v27
v_pk_add_f32 v[166:167], v[166:167], v[4:5]
v_cvt_pk_bf16_f32 v160, v160, v161
v_cvt_pk_bf16_f32 v161, v162, v163
v_cvt_pk_bf16_f32 v162, v164, v165
v_cvt_pk_bf16_f32 v163, v166, v167
buffer_store_dwordx4 v[160:163], v12, s[20:23], s49 offen offset:0
v_lshlrev_b32 v4, 16, v28
v_and_b32 v5, 0xffff0000, v28
v_pk_add_f32 v[168:169], v[168:169], v[4:5]
v_lshlrev_b32 v4, 16, v29
v_and_b32 v5, 0xffff0000, v29
v_pk_add_f32 v[170:171], v[170:171], v[4:5]
v_lshlrev_b32 v4, 16, v30
v_and_b32 v5, 0xffff0000, v30
v_pk_add_f32 v[172:173], v[172:173], v[4:5]
v_lshlrev_b32 v4, 16, v31
v_and_b32 v5, 0xffff0000, v31
v_pk_add_f32 v[174:175], v[174:175], v[4:5]
v_cvt_pk_bf16_f32 v168, v168, v169
v_cvt_pk_bf16_f32 v169, v170, v171
v_cvt_pk_bf16_f32 v170, v172, v173
v_cvt_pk_bf16_f32 v171, v174, v175
buffer_store_dwordx4 v[168:171], v12, s[20:23], s49 offen offset:1024
v_lshlrev_b32 v4, 16, v32
v_and_b32 v5, 0xffff0000, v32
v_pk_add_f32 v[176:177], v[176:177], v[4:5]
v_lshlrev_b32 v4, 16, v33
v_and_b32 v5, 0xffff0000, v33
v_pk_add_f32 v[178:179], v[178:179], v[4:5]
v_lshlrev_b32 v4, 16, v34
v_and_b32 v5, 0xffff0000, v34
v_pk_add_f32 v[180:181], v[180:181], v[4:5]
v_lshlrev_b32 v4, 16, v35
v_and_b32 v5, 0xffff0000, v35
v_pk_add_f32 v[182:183], v[182:183], v[4:5]
v_cvt_pk_bf16_f32 v176, v176, v177
v_cvt_pk_bf16_f32 v177, v178, v179
v_cvt_pk_bf16_f32 v178, v180, v181
v_cvt_pk_bf16_f32 v179, v182, v183
buffer_store_dwordx4 v[176:179], v13, s[20:23], s49 offen offset:0
v_lshlrev_b32 v4, 16, v36
v_and_b32 v5, 0xffff0000, v36
v_pk_add_f32 v[184:185], v[184:185], v[4:5]
v_lshlrev_b32 v4, 16, v37
v_and_b32 v5, 0xffff0000, v37
v_pk_add_f32 v[186:187], v[186:187], v[4:5]
v_lshlrev_b32 v4, 16, v38
v_and_b32 v5, 0xffff0000, v38
v_pk_add_f32 v[188:189], v[188:189], v[4:5]
v_lshlrev_b32 v4, 16, v39
v_and_b32 v5, 0xffff0000, v39
v_pk_add_f32 v[190:191], v[190:191], v[4:5]
v_cvt_pk_bf16_f32 v184, v184, v185
v_cvt_pk_bf16_f32 v185, v186, v187
v_cvt_pk_bf16_f32 v186, v188, v189
v_cvt_pk_bf16_f32 v187, v190, v191
buffer_store_dwordx4 v[184:187], v13, s[20:23], s49 offen offset:1024
out0_kernel_end:
s_endpgm
.text
.globl qkv1_kernel
.p2align 8
.type qkv1_kernel,@function
qkv1_kernel:
s_cmp_ge_u32 s2, 256
s_cbranch_scc1 qkv1_kernel_end
s_load_dwordx2 s[8:9], s[0:1], 72
s_load_dwordx2 s[6:7], s[0:1], 32
s_load_dwordx2 s[10:11], s[0:1], 40
v_lshrrev_b32 v1, 6, v0
v_and_b32 v0, 63, v0
v_readfirstlane_b32 s28, v1
s_and_b32 s35, s2, 7
s_lshr_b32 s41, s2, 3
s_and_b32 s29, s35, 7
s_lshl_b32 s29, s29, 1
s_and_b32 s30, s41, 1
s_add_u32 s29, s29, s30
s_lshr_b32 s30, s35, 3
s_lshl_b32 s30, s30, 4
s_lshr_b32 s41, s41, 1
s_add_u32 s30, s30, s41
v_and_b32 v2, 15, v0
v_lshrrev_b32 v3, 4, v0
v_lshlrev_b32 v10, 4, v0
v_add_u32 v11, 1024, v10
s_waitcnt lgkmcnt(0)
s_add_u32 s4, s8, 0
s_addc_u32 s5, s9, 0
s_mov_b32 s12, s4
s_and_b32 s13, s5, 0xffff
s_mov_b32 s14, 4194304
s_mov_b32 s15, 0x00020000
s_mov_b32 s16, s6
s_and_b32 s17, s7, 0xffff
s_mov_b32 s18, 6291456
s_mov_b32 s19, 0x00020000
s_mov_b32 s20, s8
s_and_b32 s21, s9, 0xffff
s_mov_b32 s22, 268435456
s_mov_b32 s23, 0x00020000
s_mov_b32 s24, s10
s_and_b32 s25, s11, 0xffff
s_mov_b32 s26, 65536
s_mov_b32 s27, 0x00020000
s_cmp_ge_u32 s28, 4
s_cbranch_scc1 qkv1_kernel_loader
s_setprio 1
s_and_b32 s43, s28, 1
s_lshr_b32 s44, s28, 1
v_lshrrev_b32 v4, 2, v2
v_and_b32 v5, 3, v0
v_lshl_add_u32 v6, v3, 3, v4
v_lshlrev_b32 v6, 7, v6
v_lshl_add_u32 v6, v5, 3, v6
v_lshrrev_b32 v7, 1, v4
v_and_b32 v8, 1, v3
v_lshl_add_u32 v7, v8, 1, v7
s_lshl_b32 s35, s43, 1
v_xor_b32 v7, s35, v7
v_lshl_add_u32 v12, v7, 5, v6
v_add_u32 v12, 18432, v12
v_xor_b32 v13, 32, v12
v_mov_b32 v14, v10
v_mov_b32 v15, v11
v_mov_b32 v16, v12
v_mov_b32 v17, v13
v_mov_b32 v148, 0
v_mov_b32 v149, 0
v_mov_b32 v150, 0
v_mov_b32 v151, 0
v_mov_b32 v152, 0
v_mov_b32 v153, 0
v_mov_b32 v154, 0
v_mov_b32 v155, 0
v_mov_b32 v156, 0
v_mov_b32 v157, 0
v_mov_b32 v158, 0
v_mov_b32 v159, 0
v_mov_b32 v160, 0
v_mov_b32 v161, 0
v_mov_b32 v162, 0
v_mov_b32 v163, 0
v_mov_b32 v164, 0
v_mov_b32 v165, 0
v_mov_b32 v166, 0
v_mov_b32 v167, 0
v_mov_b32 v168, 0
v_mov_b32 v169, 0
v_mov_b32 v170, 0
v_mov_b32 v171, 0
v_mov_b32 v172, 0
v_mov_b32 v173, 0
v_mov_b32 v174, 0
v_mov_b32 v175, 0
v_mov_b32 v176, 0
v_mov_b32 v177, 0
v_mov_b32 v178, 0
v_mov_b32 v179, 0
v_mov_b32 v180, 0
v_mov_b32 v181, 0
v_mov_b32 v182, 0
v_mov_b32 v183, 0
v_mov_b32 v184, 0
v_mov_b32 v185, 0
v_mov_b32 v186, 0
v_mov_b32 v187, 0
v_mov_b32 v188, 0
v_mov_b32 v189, 0
v_mov_b32 v190, 0
v_mov_b32 v191, 0
v_mov_b32 v192, 0
v_mov_b32 v193, 0
v_mov_b32 v194, 0
v_mov_b32 v195, 0
v_mov_b32 v196, 0
v_mov_b32 v197, 0
v_mov_b32 v198, 0
v_mov_b32 v199, 0
v_mov_b32 v200, 0
v_mov_b32 v201, 0
v_mov_b32 v202, 0
v_mov_b32 v203, 0
v_mov_b32 v204, 0
v_mov_b32 v205, 0
v_mov_b32 v206, 0
v_mov_b32 v207, 0
v_mov_b32 v208, 0
v_mov_b32 v209, 0
v_mov_b32 v210, 0
v_mov_b32 v211, 0
v_mov_b32 v212, 0
v_mov_b32 v213, 0
v_mov_b32 v214, 0
v_mov_b32 v215, 0
v_mov_b32 v216, 0
v_mov_b32 v217, 0
v_mov_b32 v218, 0
v_mov_b32 v219, 0
v_mov_b32 v220, 0
v_mov_b32 v221, 0
v_mov_b32 v222, 0
v_mov_b32 v223, 0
v_mov_b32 v224, 0
v_mov_b32 v225, 0
v_mov_b32 v226, 0
v_mov_b32 v227, 0
v_mov_b32 v228, 0
v_mov_b32 v229, 0
v_mov_b32 v230, 0
v_mov_b32 v231, 0
v_mov_b32 v232, 0
v_mov_b32 v233, 0
v_mov_b32 v234, 0
v_mov_b32 v235, 0
v_mov_b32 v236, 0
v_mov_b32 v237, 0
v_mov_b32 v238, 0
v_mov_b32 v239, 0
v_mov_b32 v240, 0
v_mov_b32 v241, 0
v_mov_b32 v242, 0
v_mov_b32 v243, 0
v_mov_b32 v244, 0
v_mov_b32 v245, 0
v_mov_b32 v246, 0
v_mov_b32 v247, 0
v_mov_b32 v248, 0
v_mov_b32 v249, 0
v_mov_b32 v250, 0
v_mov_b32 v251, 0
v_mov_b32 v252, 0
v_mov_b32 v253, 0
v_mov_b32 v254, 0
v_mov_b32 v255, 0
v_mov_b32 v76, 0x3f803f80
v_mov_b32 v77, 0x3f803f80
v_mov_b32 v78, 0x3f803f80
v_mov_b32 v79, 0x3f803f80
s_mov_b32 s31, 0
s_mov_b32 s32, 0
s_cmp_eq_u32 s44, 1
s_cbranch_scc1 qkv1_kernel_th1
s_barrier
ds_read_b128 v[60:63], v14 offset:2048
ds_read_b128 v[64:67], v14 offset:4096
ds_read_b128 v[68:71], v14 offset:6144
ds_read_b128 v[72:75], v14 offset:8192
ds_read_b64_tr_b16 v[80:81], v16 offset:0
ds_read_b64_tr_b16 v[82:83], v16 offset:512
ds_read_b64_tr_b16 v[84:85], v17 offset:0
ds_read_b64_tr_b16 v[86:87], v17 offset:512
ds_read_b64_tr_b16 v[88:89], v16 offset:8192
ds_read_b64_tr_b16 v[90:91], v16 offset:8704
ds_read_b64_tr_b16 v[92:93], v17 offset:8192
ds_read_b64_tr_b16 v[94:95], v17 offset:8704
ds_read_b64_tr_b16 v[96:97], v16 offset:16384
ds_read_b64_tr_b16 v[98:99], v16 offset:16896
ds_read_b64_tr_b16 v[100:101], v17 offset:16384
ds_read_b64_tr_b16 v[102:103], v17 offset:16896
qkv1_kernel_loop0:
s_add_u32 s32, s32, 43008
s_cmp_eq_u32 s32, 129024
s_cselect_b32 s32, 0, s32
s_waitcnt lgkmcnt(0)
v_mfma_f32_16x16x32_bf16 v[244:247], v[80:83], v[76:79], v[244:247]
ds_read_b128 v[104:107], v15 offset:2048
v_mfma_f32_16x16x32_bf16 v[248:251], v[88:91], v[76:79], v[248:251]
ds_read_b128 v[108:111], v15 offset:4096
v_mfma_f32_16x16x32_bf16 v[252:255], v[76:79], v[96:99], v[252:255]
ds_read_b128 v[112:115], v15 offset:6144
v_mfma_f32_16x16x32_bf16 v[204:207], v[88:91], v[72:75], v[204:207]
ds_read_b128 v[116:119], v15 offset:8192
v_mfma_f32_16x16x32_bf16 v[236:239], v[72:75], v[96:99], v[236:239]
ds_read_b64_tr_b16 v[124:125], v16 offset:4096
v_mfma_f32_16x16x32_bf16 v[172:175], v[80:83], v[72:75], v[172:175]
ds_read_b64_tr_b16 v[126:127], v16 offset:4608
v_mfma_f32_16x16x32_bf16 v[208:211], v[92:95], v[72:75], v[208:211]
ds_read_b64_tr_b16 v[128:129], v17 offset:4096
v_mfma_f32_16x16x32_bf16 v[240:243], v[72:75], v[100:103], v[240:243]
ds_read_b64_tr_b16 v[130:131], v17 offset:4608
v_mfma_f32_16x16x32_bf16 v[176:179], v[84:87], v[72:75], v[176:179]
ds_read_b64_tr_b16 v[132:133], v16 offset:12288
v_mfma_f32_16x16x32_bf16 v[196:199], v[88:91], v[68:71], v[196:199]
ds_read_b64_tr_b16 v[134:135], v16 offset:12800
v_mfma_f32_16x16x32_bf16 v[228:231], v[68:71], v[96:99], v[228:231]
ds_read_b64_tr_b16 v[136:137], v17 offset:12288
v_mfma_f32_16x16x32_bf16 v[164:167], v[80:83], v[68:71], v[164:167]
ds_read_b64_tr_b16 v[138:139], v17 offset:12800
v_mfma_f32_16x16x32_bf16 v[200:203], v[92:95], v[68:71], v[200:203]
ds_read_b64_tr_b16 v[140:141], v16 offset:20480
v_mfma_f32_16x16x32_bf16 v[232:235], v[68:71], v[100:103], v[232:235]
ds_read_b64_tr_b16 v[142:143], v16 offset:20992
v_mfma_f32_16x16x32_bf16 v[168:171], v[84:87], v[68:71], v[168:171]
ds_read_b64_tr_b16 v[144:145], v17 offset:20480
v_mfma_f32_16x16x32_bf16 v[188:191], v[88:91], v[64:67], v[188:191]
ds_read_b64_tr_b16 v[146:147], v17 offset:20992
v_mfma_f32_16x16x32_bf16 v[220:223], v[64:67], v[96:99], v[220:223]
v_mfma_f32_16x16x32_bf16 v[156:159], v[80:83], v[64:67], v[156:159]
v_mfma_f32_16x16x32_bf16 v[192:195], v[92:95], v[64:67], v[192:195]
v_mfma_f32_16x16x32_bf16 v[224:227], v[64:67], v[100:103], v[224:227]
v_mfma_f32_16x16x32_bf16 v[160:163], v[84:87], v[64:67], v[160:163]
v_mfma_f32_16x16x32_bf16 v[180:183], v[88:91], v[60:63], v[180:183]
v_mfma_f32_16x16x32_bf16 v[212:215], v[60:63], v[96:99], v[212:215]
v_mfma_f32_16x16x32_bf16 v[148:151], v[80:83], v[60:63], v[148:151]
v_mfma_f32_16x16x32_bf16 v[184:187], v[92:95], v[60:63], v[184:187]
v_mfma_f32_16x16x32_bf16 v[216:219], v[60:63], v[100:103], v[216:219]
v_mfma_f32_16x16x32_bf16 v[152:155], v[84:87], v[60:63], v[152:155]
s_waitcnt lgkmcnt(0)
s_barrier
v_mfma_f32_16x16x32_bf16 v[244:247], v[124:127], v[76:79], v[244:247]
v_add_u32 v14, s32, v10
v_mfma_f32_16x16x32_bf16 v[248:251], v[132:135], v[76:79], v[248:251]
v_add_u32 v16, s32, v12
v_add_u32 v17, s32, v13
v_mfma_f32_16x16x32_bf16 v[252:255], v[76:79], v[140:143], v[252:255]
ds_read_b128 v[60:63], v14 offset:2048
v_mfma_f32_16x16x32_bf16 v[204:207], v[132:135], v[116:119], v[204:207]
ds_read_b128 v[64:67], v14 offset:4096
v_mfma_f32_16x16x32_bf16 v[236:239], v[116:119], v[140:143], v[236:239]
ds_read_b128 v[68:71], v14 offset:6144
v_mfma_f32_16x16x32_bf16 v[172:175], v[124:127], v[116:119], v[172:175]
ds_read_b128 v[72:75], v14 offset:8192
v_mfma_f32_16x16x32_bf16 v[208:211], v[136:139], v[116:119], v[208:211]
ds_read_b64_tr_b16 v[80:81], v16 offset:0
v_mfma_f32_16x16x32_bf16 v[240:243], v[116:119], v[144:147], v[240:243]
ds_read_b64_tr_b16 v[82:83], v16 offset:512
v_mfma_f32_16x16x32_bf16 v[176:179], v[128:131], v[116:119], v[176:179]
ds_read_b64_tr_b16 v[84:85], v17 offset:0
v_mfma_f32_16x16x32_bf16 v[196:199], v[132:135], v[112:115], v[196:199]
ds_read_b64_tr_b16 v[86:87], v17 offset:512
v_mfma_f32_16x16x32_bf16 v[228:231], v[112:115], v[140:143], v[228:231]
ds_read_b64_tr_b16 v[88:89], v16 offset:8192
v_mfma_f32_16x16x32_bf16 v[164:167], v[124:127], v[112:115], v[164:167]
ds_read_b64_tr_b16 v[90:91], v16 offset:8704
v_mfma_f32_16x16x32_bf16 v[200:203], v[136:139], v[112:115], v[200:203]
ds_read_b64_tr_b16 v[92:93], v17 offset:8192
v_mfma_f32_16x16x32_bf16 v[232:235], v[112:115], v[144:147], v[232:235]
ds_read_b64_tr_b16 v[94:95], v17 offset:8704
v_mfma_f32_16x16x32_bf16 v[168:171], v[128:131], v[112:115], v[168:171]
ds_read_b64_tr_b16 v[96:97], v16 offset:16384
v_mfma_f32_16x16x32_bf16 v[188:191], v[132:135], v[108:111], v[188:191]
ds_read_b64_tr_b16 v[98:99], v16 offset:16896
v_mfma_f32_16x16x32_bf16 v[220:223], v[108:111], v[140:143], v[220:223]
ds_read_b64_tr_b16 v[100:101], v17 offset:16384
v_mfma_f32_16x16x32_bf16 v[156:159], v[124:127], v[108:111], v[156:159]
ds_read_b64_tr_b16 v[102:103], v17 offset:16896
v_mfma_f32_16x16x32_bf16 v[192:195], v[136:139], v[108:111], v[192:195]
v_add_u32 v15, s32, v11
v_mfma_f32_16x16x32_bf16 v[224:227], v[108:111], v[144:147], v[224:227]
s_add_u32 s31, s31, 1
v_mfma_f32_16x16x32_bf16 v[160:163], v[128:131], v[108:111], v[160:163]
s_cmp_lt_u32 s31, 16
v_mfma_f32_16x16x32_bf16 v[180:183], v[132:135], v[104:107], v[180:183]
v_mfma_f32_16x16x32_bf16 v[212:215], v[104:107], v[140:143], v[212:215]
v_mfma_f32_16x16x32_bf16 v[148:151], v[124:127], v[104:107], v[148:151]
v_mfma_f32_16x16x32_bf16 v[184:187], v[136:139], v[104:107], v[184:187]
v_mfma_f32_16x16x32_bf16 v[216:219], v[104:107], v[144:147], v[216:219]
v_mfma_f32_16x16x32_bf16 v[152:155], v[128:131], v[104:107], v[152:155]
s_cbranch_scc1 qkv1_kernel_loop0
s_branch qkv1_kernel_epi
qkv1_kernel_th1:
s_barrier
ds_read_b128 v[60:63], v14 offset:10240
ds_read_b128 v[64:67], v14 offset:12288
ds_read_b128 v[68:71], v14 offset:14336
ds_read_b128 v[72:75], v14 offset:16384
ds_read_b64_tr_b16 v[80:81], v16 offset:0
ds_read_b64_tr_b16 v[82:83], v16 offset:512
ds_read_b64_tr_b16 v[84:85], v17 offset:0
ds_read_b64_tr_b16 v[86:87], v17 offset:512
ds_read_b64_tr_b16 v[88:89], v16 offset:8192
ds_read_b64_tr_b16 v[90:91], v16 offset:8704
ds_read_b64_tr_b16 v[92:93], v17 offset:8192
ds_read_b64_tr_b16 v[94:95], v17 offset:8704
ds_read_b64_tr_b16 v[96:97], v16 offset:16384
ds_read_b64_tr_b16 v[98:99], v16 offset:16896
ds_read_b64_tr_b16 v[100:101], v17 offset:16384
ds_read_b64_tr_b16 v[102:103], v17 offset:16896
qkv1_kernel_loop1:
s_add_u32 s32, s32, 43008
s_cmp_eq_u32 s32, 129024
s_cselect_b32 s32, 0, s32
s_waitcnt lgkmcnt(0)
v_mfma_f32_16x16x32_bf16 v[244:247], v[84:87], v[76:79], v[244:247]
ds_read_b128 v[104:107], v15 offset:10240
v_mfma_f32_16x16x32_bf16 v[248:251], v[92:95], v[76:79], v[248:251]
ds_read_b128 v[108:111], v15 offset:12288
v_mfma_f32_16x16x32_bf16 v[252:255], v[76:79], v[100:103], v[252:255]
ds_read_b128 v[112:115], v15 offset:14336
v_mfma_f32_16x16x32_bf16 v[204:207], v[88:91], v[72:75], v[204:207]
ds_read_b128 v[116:119], v15 offset:16384
v_mfma_f32_16x16x32_bf16 v[236:239], v[72:75], v[96:99], v[236:239]
ds_read_b64_tr_b16 v[124:125], v16 offset:4096
v_mfma_f32_16x16x32_bf16 v[172:175], v[80:83], v[72:75], v[172:175]
ds_read_b64_tr_b16 v[126:127], v16 offset:4608
v_mfma_f32_16x16x32_bf16 v[208:211], v[92:95], v[72:75], v[208:211]
ds_read_b64_tr_b16 v[128:129], v17 offset:4096
v_mfma_f32_16x16x32_bf16 v[240:243], v[72:75], v[100:103], v[240:243]
ds_read_b64_tr_b16 v[130:131], v17 offset:4608
v_mfma_f32_16x16x32_bf16 v[176:179], v[84:87], v[72:75], v[176:179]
ds_read_b64_tr_b16 v[132:133], v16 offset:12288
v_mfma_f32_16x16x32_bf16 v[196:199], v[88:91], v[68:71], v[196:199]
ds_read_b64_tr_b16 v[134:135], v16 offset:12800
v_mfma_f32_16x16x32_bf16 v[228:231], v[68:71], v[96:99], v[228:231]
ds_read_b64_tr_b16 v[136:137], v17 offset:12288
v_mfma_f32_16x16x32_bf16 v[164:167], v[80:83], v[68:71], v[164:167]
ds_read_b64_tr_b16 v[138:139], v17 offset:12800
v_mfma_f32_16x16x32_bf16 v[200:203], v[92:95], v[68:71], v[200:203]
ds_read_b64_tr_b16 v[140:141], v16 offset:20480
v_mfma_f32_16x16x32_bf16 v[232:235], v[68:71], v[100:103], v[232:235]
ds_read_b64_tr_b16 v[142:143], v16 offset:20992
v_mfma_f32_16x16x32_bf16 v[168:171], v[84:87], v[68:71], v[168:171]
ds_read_b64_tr_b16 v[144:145], v17 offset:20480
v_mfma_f32_16x16x32_bf16 v[188:191], v[88:91], v[64:67], v[188:191]
ds_read_b64_tr_b16 v[146:147], v17 offset:20992
v_mfma_f32_16x16x32_bf16 v[220:223], v[64:67], v[96:99], v[220:223]
v_mfma_f32_16x16x32_bf16 v[156:159], v[80:83], v[64:67], v[156:159]
v_mfma_f32_16x16x32_bf16 v[192:195], v[92:95], v[64:67], v[192:195]
v_mfma_f32_16x16x32_bf16 v[224:227], v[64:67], v[100:103], v[224:227]
v_mfma_f32_16x16x32_bf16 v[160:163], v[84:87], v[64:67], v[160:163]
v_mfma_f32_16x16x32_bf16 v[180:183], v[88:91], v[60:63], v[180:183]
v_mfma_f32_16x16x32_bf16 v[212:215], v[60:63], v[96:99], v[212:215]
v_mfma_f32_16x16x32_bf16 v[148:151], v[80:83], v[60:63], v[148:151]
v_mfma_f32_16x16x32_bf16 v[184:187], v[92:95], v[60:63], v[184:187]
v_mfma_f32_16x16x32_bf16 v[216:219], v[60:63], v[100:103], v[216:219]
v_mfma_f32_16x16x32_bf16 v[152:155], v[84:87], v[60:63], v[152:155]
s_waitcnt lgkmcnt(0)
s_barrier
v_mfma_f32_16x16x32_bf16 v[244:247], v[128:131], v[76:79], v[244:247]
v_add_u32 v14, s32, v10
v_mfma_f32_16x16x32_bf16 v[248:251], v[136:139], v[76:79], v[248:251]
v_add_u32 v16, s32, v12
v_add_u32 v17, s32, v13
v_mfma_f32_16x16x32_bf16 v[252:255], v[76:79], v[144:147], v[252:255]
ds_read_b128 v[60:63], v14 offset:10240
v_mfma_f32_16x16x32_bf16 v[204:207], v[132:135], v[116:119], v[204:207]
ds_read_b128 v[64:67], v14 offset:12288
v_mfma_f32_16x16x32_bf16 v[236:239], v[116:119], v[140:143], v[236:239]
ds_read_b128 v[68:71], v14 offset:14336
v_mfma_f32_16x16x32_bf16 v[172:175], v[124:127], v[116:119], v[172:175]
ds_read_b128 v[72:75], v14 offset:16384
v_mfma_f32_16x16x32_bf16 v[208:211], v[136:139], v[116:119], v[208:211]
ds_read_b64_tr_b16 v[80:81], v16 offset:0
v_mfma_f32_16x16x32_bf16 v[240:243], v[116:119], v[144:147], v[240:243]
ds_read_b64_tr_b16 v[82:83], v16 offset:512
v_mfma_f32_16x16x32_bf16 v[176:179], v[128:131], v[116:119], v[176:179]
ds_read_b64_tr_b16 v[84:85], v17 offset:0
v_mfma_f32_16x16x32_bf16 v[196:199], v[132:135], v[112:115], v[196:199]
ds_read_b64_tr_b16 v[86:87], v17 offset:512
v_mfma_f32_16x16x32_bf16 v[228:231], v[112:115], v[140:143], v[228:231]
ds_read_b64_tr_b16 v[88:89], v16 offset:8192
v_mfma_f32_16x16x32_bf16 v[164:167], v[124:127], v[112:115], v[164:167]
ds_read_b64_tr_b16 v[90:91], v16 offset:8704
v_mfma_f32_16x16x32_bf16 v[200:203], v[136:139], v[112:115], v[200:203]
ds_read_b64_tr_b16 v[92:93], v17 offset:8192
v_mfma_f32_16x16x32_bf16 v[232:235], v[112:115], v[144:147], v[232:235]
ds_read_b64_tr_b16 v[94:95], v17 offset:8704
v_mfma_f32_16x16x32_bf16 v[168:171], v[128:131], v[112:115], v[168:171]
ds_read_b64_tr_b16 v[96:97], v16 offset:16384
v_mfma_f32_16x16x32_bf16 v[188:191], v[132:135], v[108:111], v[188:191]
ds_read_b64_tr_b16 v[98:99], v16 offset:16896
v_mfma_f32_16x16x32_bf16 v[220:223], v[108:111], v[140:143], v[220:223]
ds_read_b64_tr_b16 v[100:101], v17 offset:16384
v_mfma_f32_16x16x32_bf16 v[156:159], v[124:127], v[108:111], v[156:159]
ds_read_b64_tr_b16 v[102:103], v17 offset:16896
v_mfma_f32_16x16x32_bf16 v[192:195], v[136:139], v[108:111], v[192:195]
v_add_u32 v15, s32, v11
v_mfma_f32_16x16x32_bf16 v[224:227], v[108:111], v[144:147], v[224:227]
s_add_u32 s31, s31, 1
v_mfma_f32_16x16x32_bf16 v[160:163], v[128:131], v[108:111], v[160:163]
s_cmp_lt_u32 s31, 16
v_mfma_f32_16x16x32_bf16 v[180:183], v[132:135], v[104:107], v[180:183]
v_mfma_f32_16x16x32_bf16 v[212:215], v[104:107], v[140:143], v[212:215]
v_mfma_f32_16x16x32_bf16 v[148:151], v[124:127], v[104:107], v[148:151]
v_mfma_f32_16x16x32_bf16 v[184:187], v[136:139], v[104:107], v[184:187]
v_mfma_f32_16x16x32_bf16 v[216:219], v[104:107], v[144:147], v[216:219]
v_mfma_f32_16x16x32_bf16 v[152:155], v[128:131], v[104:107], v[152:155]
s_cbranch_scc1 qkv1_kernel_loop1
qkv1_kernel_epi:
v_lshlrev_b32 v4, 4, v0
s_mul_i32 s35, s28, 3072
s_add_u32 s35, s35, 131328
v_add_u32 v5, s35, v4
s_waitcnt lgkmcnt(0)
ds_write_b128 v5, v[244:247] offset:0
ds_write_b128 v5, v[248:251] offset:1024
ds_write_b128 v5, v[252:255] offset:2048
s_mul_i32 s35, s43, 3072
s_add_u32 s35, s35, 131328
v_lshlrev_b32 v6, 8, v3
v_add_u32 v6, s35, v6
v_lshlrev_b32 v7, 4, v2
v_add_u32 v7, s35, v7
s_lshl_b32 s36, s44, 6
v_add_u32 v8, s36, v2
v_lshlrev_b32 v8, 3, v8
v_add_u32 v8, 129024, v8
v_lshl_add_u32 v9, v3, 2, s36
v_lshlrev_b32 v9, 2, v9
v_add_u32 v9, 130176, v9
s_waitcnt lgkmcnt(0)
s_barrier
ds_read_b128 v[60:63], v6 offset:0
ds_read_b128 v[64:67], v6 offset:6144
ds_read_b128 v[68:71], v6 offset:1024
ds_read_b128 v[72:75], v6 offset:7168
ds_read_b64 v[80:81], v8 offset:128
ds_read_b64 v[82:83], v8 offset:256
ds_read_b64 v[84:85], v8 offset:384
ds_read_b64 v[86:87], v8 offset:512
ds_read_b32 v76, v7 offset:2048
ds_read_b32 v77, v7 offset:8192
ds_read_b128 v[92:95], v9 offset:64
ds_read_b128 v[112:115], v9 offset:640
ds_read_b128 v[96:99], v9 offset:128
ds_read_b128 v[116:119], v9 offset:704
ds_read_b128 v[100:103], v9 offset:192
ds_read_b128 v[120:123], v9 offset:768
ds_read_b128 v[104:107], v9 offset:256
ds_read_b128 v[124:127], v9 offset:832
v_lshrrev_b32 v4, 2, v2
v_lshl_add_u32 v4, v3, 2, v4
v_lshlrev_b32 v4, 6, v4
v_and_b32 v5, 3, v0
v_lshl_add_u32 v4, v5, 3, v4
s_lshl_b32 s35, s43, 11
s_add_u32 s35, s35, 143616
v_add_u32 v4, s35, v4
ds_read_b64_tr_b16 v[40:41], v4 offset:0
ds_read_b64_tr_b16 v[42:43], v4 offset:1024
ds_read_b64_tr_b16 v[44:45], v4 offset:32
ds_read_b64_tr_b16 v[46:47], v4 offset:1056
s_waitcnt lgkmcnt(14)
s_lshl_b32 s35, s29, 3
s_lshl_b32 s36, s44, 2
s_add_u32 s35, s35, s36
s_lshl_b32 s35, s35, 5
s_lshl_b32 s45, s30, 1
s_add_u32 s45, s45, s43
s_add_u32 s35, s35, s45
s_lshl_b32 s35, s35, 10
s_add_u32 s46, s35, 16777216
v_lshlrev_b32 v18, 4, v0
v_pk_fma_f32 v[148:149], v[60:61], v[80:81], v[148:149] op_sel:[0,1,0] op_sel_hi:[1,1,1]
v_pk_fma_f32 v[150:151], v[62:63], v[80:81], v[150:151] op_sel:[0,1,0] op_sel_hi:[1,1,1]
v_pk_fma_f32 v[152:153], v[64:65], v[80:81], v[152:153] op_sel:[0,1,0] op_sel_hi:[1,1,1]
v_pk_fma_f32 v[154:155], v[66:67], v[80:81], v[154:155] op_sel:[0,1,0] op_sel_hi:[1,1,1]
v_pk_mul_f32 v[148:149], v[148:149], v[80:81] op_sel:[0,0] op_sel_hi:[1,0]
v_pk_mul_f32 v[150:151], v[150:151], v[80:81] op_sel:[0,0] op_sel_hi:[1,0]
v_pk_mul_f32 v[152:153], v[152:153], v[80:81] op_sel:[0,0] op_sel_hi:[1,0]
v_pk_mul_f32 v[154:155], v[154:155], v[80:81] op_sel:[0,0] op_sel_hi:[1,0]
v_cvt_pk_bf16_f32 v148, v148, v149
v_cvt_pk_bf16_f32 v149, v150, v151
v_cvt_pk_bf16_f32 v150, v152, v153
v_cvt_pk_bf16_f32 v151, v154, v155
buffer_store_dwordx4 v[148:151], v18, s[20:23], s46 offen
s_add_u32 s46, s46, 32768
v_pk_fma_f32 v[156:157], v[60:61], v[82:83], v[156:157] op_sel:[0,1,0] op_sel_hi:[1,1,1]
v_pk_fma_f32 v[158:159], v[62:63], v[82:83], v[158:159] op_sel:[0,1,0] op_sel_hi:[1,1,1]
v_pk_fma_f32 v[160:161], v[64:65], v[82:83], v[160:161] op_sel:[0,1,0] op_sel_hi:[1,1,1]
v_pk_fma_f32 v[162:163], v[66:67], v[82:83], v[162:163] op_sel:[0,1,0] op_sel_hi:[1,1,1]
v_pk_mul_f32 v[156:157], v[156:157], v[82:83] op_sel:[0,0] op_sel_hi:[1,0]
v_pk_mul_f32 v[158:159], v[158:159], v[82:83] op_sel:[0,0] op_sel_hi:[1,0]
v_pk_mul_f32 v[160:161], v[160:161], v[82:83] op_sel:[0,0] op_sel_hi:[1,0]
v_pk_mul_f32 v[162:163], v[162:163], v[82:83] op_sel:[0,0] op_sel_hi:[1,0]
v_cvt_pk_bf16_f32 v156, v156, v157
v_cvt_pk_bf16_f32 v157, v158, v159
v_cvt_pk_bf16_f32 v158, v160, v161
v_cvt_pk_bf16_f32 v159, v162, v163
buffer_store_dwordx4 v[156:159], v18, s[20:23], s46 offen
s_add_u32 s46, s46, 32768
v_pk_fma_f32 v[164:165], v[60:61], v[84:85], v[164:165] op_sel:[0,1,0] op_sel_hi:[1,1,1]
v_pk_fma_f32 v[166:167], v[62:63], v[84:85], v[166:167] op_sel:[0,1,0] op_sel_hi:[1,1,1]
v_pk_fma_f32 v[168:169], v[64:65], v[84:85], v[168:169] op_sel:[0,1,0] op_sel_hi:[1,1,1]
v_pk_fma_f32 v[170:171], v[66:67], v[84:85], v[170:171] op_sel:[0,1,0] op_sel_hi:[1,1,1]
v_pk_mul_f32 v[164:165], v[164:165], v[84:85] op_sel:[0,0] op_sel_hi:[1,0]
v_pk_mul_f32 v[166:167], v[166:167], v[84:85] op_sel:[0,0] op_sel_hi:[1,0]
v_pk_mul_f32 v[168:169], v[168:169], v[84:85] op_sel:[0,0] op_sel_hi:[1,0]
v_pk_mul_f32 v[170:171], v[170:171], v[84:85] op_sel:[0,0] op_sel_hi:[1,0]
v_cvt_pk_bf16_f32 v164, v164, v165
v_cvt_pk_bf16_f32 v165, v166, v167
v_cvt_pk_bf16_f32 v166, v168, v169
v_cvt_pk_bf16_f32 v167, v170, v171
buffer_store_dwordx4 v[164:167], v18, s[20:23], s46 offen
s_add_u32 s46, s46, 32768
v_pk_fma_f32 v[172:173], v[60:61], v[86:87], v[172:173] op_sel:[0,1,0] op_sel_hi:[1,1,1]
v_pk_fma_f32 v[174:175], v[62:63], v[86:87], v[174:175] op_sel:[0,1,0] op_sel_hi:[1,1,1]
v_pk_fma_f32 v[176:177], v[64:65], v[86:87], v[176:177] op_sel:[0,1,0] op_sel_hi:[1,1,1]
v_pk_fma_f32 v[178:179], v[66:67], v[86:87], v[178:179] op_sel:[0,1,0] op_sel_hi:[1,1,1]
v_pk_mul_f32 v[172:173], v[172:173], v[86:87] op_sel:[0,0] op_sel_hi:[1,0]
v_pk_mul_f32 v[174:175], v[174:175], v[86:87] op_sel:[0,0] op_sel_hi:[1,0]
v_pk_mul_f32 v[176:177], v[176:177], v[86:87] op_sel:[0,0] op_sel_hi:[1,0]
v_pk_mul_f32 v[178:179], v[178:179], v[86:87] op_sel:[0,0] op_sel_hi:[1,0]
v_cvt_pk_bf16_f32 v172, v172, v173
v_cvt_pk_bf16_f32 v173, v174, v175
v_cvt_pk_bf16_f32 v174, v176, v177
v_cvt_pk_bf16_f32 v175, v178, v179
buffer_store_dwordx4 v[172:175], v18, s[20:23], s46 offen
v_pk_fma_f32 v[180:181], v[68:69], v[80:81], v[180:181] op_sel:[0,1,0] op_sel_hi:[1,1,1]
v_pk_fma_f32 v[182:183], v[70:71], v[80:81], v[182:183] op_sel:[0,1,0] op_sel_hi:[1,1,1]
v_pk_fma_f32 v[184:185], v[72:73], v[80:81], v[184:185] op_sel:[0,1,0] op_sel_hi:[1,1,1]
v_pk_fma_f32 v[186:187], v[74:75], v[80:81], v[186:187] op_sel:[0,1,0] op_sel_hi:[1,1,1]
v_pk_mul_f32 v[180:181], v[180:181], v[80:81] op_sel:[0,0] op_sel_hi:[1,0]
v_pk_mul_f32 v[182:183], v[182:183], v[80:81] op_sel:[0,0] op_sel_hi:[1,0]
v_pk_mul_f32 v[184:185], v[184:185], v[80:81] op_sel:[0,0] op_sel_hi:[1,0]
v_pk_mul_f32 v[186:187], v[186:187], v[80:81] op_sel:[0,0] op_sel_hi:[1,0]
v_cvt_pk_bf16_f32 v180, v180, v181
v_cvt_pk_bf16_f32 v181, v182, v183
v_cvt_pk_bf16_f32 v182, v184, v185
v_cvt_pk_bf16_f32 v183, v186, v187
v_pk_fma_f32 v[188:189], v[68:69], v[82:83], v[188:189] op_sel:[0,1,0] op_sel_hi:[1,1,1]
v_pk_fma_f32 v[190:191], v[70:71], v[82:83], v[190:191] op_sel:[0,1,0] op_sel_hi:[1,1,1]
v_pk_fma_f32 v[192:193], v[72:73], v[82:83], v[192:193] op_sel:[0,1,0] op_sel_hi:[1,1,1]
v_pk_fma_f32 v[194:195], v[74:75], v[82:83], v[194:195] op_sel:[0,1,0] op_sel_hi:[1,1,1]
v_pk_mul_f32 v[188:189], v[188:189], v[82:83] op_sel:[0,0] op_sel_hi:[1,0]
v_pk_mul_f32 v[190:191], v[190:191], v[82:83] op_sel:[0,0] op_sel_hi:[1,0]
v_pk_mul_f32 v[192:193], v[192:193], v[82:83] op_sel:[0,0] op_sel_hi:[1,0]
v_pk_mul_f32 v[194:195], v[194:195], v[82:83] op_sel:[0,0] op_sel_hi:[1,0]
v_cvt_pk_bf16_f32 v188, v188, v189
v_cvt_pk_bf16_f32 v189, v190, v191
v_cvt_pk_bf16_f32 v190, v192, v193
v_cvt_pk_bf16_f32 v191, v194, v195
v_pk_fma_f32 v[196:197], v[68:69], v[84:85], v[196:197] op_sel:[0,1,0] op_sel_hi:[1,1,1]
v_pk_fma_f32 v[198:199], v[70:71], v[84:85], v[198:199] op_sel:[0,1,0] op_sel_hi:[1,1,1]
v_pk_fma_f32 v[200:201], v[72:73], v[84:85], v[200:201] op_sel:[0,1,0] op_sel_hi:[1,1,1]
v_pk_fma_f32 v[202:203], v[74:75], v[84:85], v[202:203] op_sel:[0,1,0] op_sel_hi:[1,1,1]
v_pk_mul_f32 v[196:197], v[196:197], v[84:85] op_sel:[0,0] op_sel_hi:[1,0]
v_pk_mul_f32 v[198:199], v[198:199], v[84:85] op_sel:[0,0] op_sel_hi:[1,0]
v_pk_mul_f32 v[200:201], v[200:201], v[84:85] op_sel:[0,0] op_sel_hi:[1,0]
v_pk_mul_f32 v[202:203], v[202:203], v[84:85] op_sel:[0,0] op_sel_hi:[1,0]
v_cvt_pk_bf16_f32 v196, v196, v197
v_cvt_pk_bf16_f32 v197, v198, v199
v_cvt_pk_bf16_f32 v198, v200, v201
v_cvt_pk_bf16_f32 v199, v202, v203
v_pk_fma_f32 v[204:205], v[68:69], v[86:87], v[204:205] op_sel:[0,1,0] op_sel_hi:[1,1,1]
v_pk_fma_f32 v[206:207], v[70:71], v[86:87], v[206:207] op_sel:[0,1,0] op_sel_hi:[1,1,1]
v_pk_fma_f32 v[208:209], v[72:73], v[86:87], v[208:209] op_sel:[0,1,0] op_sel_hi:[1,1,1]
v_pk_fma_f32 v[210:211], v[74:75], v[86:87], v[210:211] op_sel:[0,1,0] op_sel_hi:[1,1,1]
v_pk_mul_f32 v[204:205], v[204:205], v[86:87] op_sel:[0,0] op_sel_hi:[1,0]
v_pk_mul_f32 v[206:207], v[206:207], v[86:87] op_sel:[0,0] op_sel_hi:[1,0]
v_pk_mul_f32 v[208:209], v[208:209], v[86:87] op_sel:[0,0] op_sel_hi:[1,0]
v_pk_mul_f32 v[210:211], v[210:211], v[86:87] op_sel:[0,0] op_sel_hi:[1,0]
v_cvt_pk_bf16_f32 v204, v204, v205
v_cvt_pk_bf16_f32 v205, v206, v207
v_cvt_pk_bf16_f32 v206, v208, v209
v_cvt_pk_bf16_f32 v207, v210, v211
s_waitcnt lgkmcnt(0)
v_pk_fma_f32 v[212:213], v[112:113], v[76:77], v[212:213] op_sel:[0,0,0] op_sel_hi:[1,0,1]
v_pk_fma_f32 v[214:215], v[114:115], v[76:77], v[214:215] op_sel:[0,0,0] op_sel_hi:[1,0,1]
v_pk_mul_f32 v[212:213], v[212:213], v[92:93]
v_pk_mul_f32 v[214:215], v[214:215], v[94:95]
v_cvt_pk_bf16_f32 v22, v212, v213
v_cvt_pk_bf16_f32 v23, v214, v215
v_pk_fma_f32 v[220:221], v[116:117], v[76:77], v[220:221] op_sel:[0,0,0] op_sel_hi:[1,0,1]
v_pk_fma_f32 v[222:223], v[118:119], v[76:77], v[222:223] op_sel:[0,0,0] op_sel_hi:[1,0,1]
v_pk_mul_f32 v[220:221], v[220:221], v[96:97]
v_pk_mul_f32 v[222:223], v[222:223], v[98:99]
v_cvt_pk_bf16_f32 v24, v220, v221
v_cvt_pk_bf16_f32 v25, v222, v223
v_pk_fma_f32 v[228:229], v[120:121], v[76:77], v[228:229] op_sel:[0,0,0] op_sel_hi:[1,0,1]
v_pk_fma_f32 v[230:231], v[122:123], v[76:77], v[230:231] op_sel:[0,0,0] op_sel_hi:[1,0,1]
v_pk_mul_f32 v[228:229], v[228:229], v[100:101]
v_pk_mul_f32 v[230:231], v[230:231], v[102:103]
v_cvt_pk_bf16_f32 v26, v228, v229
v_cvt_pk_bf16_f32 v27, v230, v231
v_pk_fma_f32 v[236:237], v[124:125], v[76:77], v[236:237] op_sel:[0,0,0] op_sel_hi:[1,0,1]
v_pk_fma_f32 v[238:239], v[126:127], v[76:77], v[238:239] op_sel:[0,0,0] op_sel_hi:[1,0,1]
v_pk_mul_f32 v[236:237], v[236:237], v[104:105]
v_pk_mul_f32 v[238:239], v[238:239], v[106:107]
v_cvt_pk_bf16_f32 v28, v236, v237
v_cvt_pk_bf16_f32 v29, v238, v239
v_pk_fma_f32 v[216:217], v[112:113], v[76:77], v[216:217] op_sel:[0,1,0] op_sel_hi:[1,1,1]
v_pk_fma_f32 v[218:219], v[114:115], v[76:77], v[218:219] op_sel:[0,1,0] op_sel_hi:[1,1,1]
v_pk_mul_f32 v[216:217], v[216:217], v[92:93]
v_pk_mul_f32 v[218:219], v[218:219], v[94:95]
v_cvt_pk_bf16_f32 v32, v216, v217
v_cvt_pk_bf16_f32 v33, v218, v219
v_pk_fma_f32 v[224:225], v[116:117], v[76:77], v[224:225] op_sel:[0,1,0] op_sel_hi:[1,1,1]
v_pk_fma_f32 v[226:227], v[118:119], v[76:77], v[226:227] op_sel:[0,1,0] op_sel_hi:[1,1,1]
v_pk_mul_f32 v[224:225], v[224:225], v[96:97]
v_pk_mul_f32 v[226:227], v[226:227], v[98:99]
v_cvt_pk_bf16_f32 v34, v224, v225
v_cvt_pk_bf16_f32 v35, v226, v227
v_pk_fma_f32 v[232:233], v[120:121], v[76:77], v[232:233] op_sel:[0,1,0] op_sel_hi:[1,1,1]
v_pk_fma_f32 v[234:235], v[122:123], v[76:77], v[234:235] op_sel:[0,1,0] op_sel_hi:[1,1,1]
v_pk_mul_f32 v[232:233], v[232:233], v[100:101]
v_pk_mul_f32 v[234:235], v[234:235], v[102:103]
v_cvt_pk_bf16_f32 v36, v232, v233
v_cvt_pk_bf16_f32 v37, v234, v235
v_pk_fma_f32 v[240:241], v[124:125], v[76:77], v[240:241] op_sel:[0,1,0] op_sel_hi:[1,1,1]
v_pk_fma_f32 v[242:243], v[126:127], v[76:77], v[242:243] op_sel:[0,1,0] op_sel_hi:[1,1,1]
v_pk_mul_f32 v[240:241], v[240:241], v[104:105]
v_pk_mul_f32 v[242:243], v[242:243], v[106:107]
v_cvt_pk_bf16_f32 v38, v240, v241
v_cvt_pk_bf16_f32 v39, v242, v243
s_mov_b32 s42, 0x3fb8aa3b
s_lshl_b32 s35, s28, 12
s_add_u32 s35, s35, 32768
v_add_u32 v5, s35, v18
ds_write_b128 v5, v[22:25] offset:0
ds_write_b128 v5, v[26:29] offset:1024
ds_write_b128 v5, v[32:35] offset:2048
ds_write_b128 v5, v[36:39] offset:3072
v_mfma_f32_16x16x32_bf16 v[60:63], v[40:43], v[180:183], 0
v_mfma_f32_16x16x32_bf16 v[64:67], v[44:47], v[180:183], 0
v_mfma_f32_16x16x32_bf16 v[68:71], v[40:43], v[188:191], 0
v_mfma_f32_16x16x32_bf16 v[72:75], v[44:47], v[188:191], 0
v_mfma_f32_16x16x32_bf16 v[76:79], v[40:43], v[196:199], 0
v_mfma_f32_16x16x32_bf16 v[80:83], v[44:47], v[196:199], 0
v_mfma_f32_16x16x32_bf16 v[84:87], v[40:43], v[204:207], 0
v_mfma_f32_16x16x32_bf16 v[88:91], v[44:47], v[204:207], 0
s_nop 4
v_max3_f32 v48, v60, v61, v62
v_min3_f32 v52, v60, v61, v62
v_max3_f32 v48, v48, v63, v64
v_min3_f32 v52, v52, v63, v64
v_max3_f32 v48, v48, v65, v66
v_min3_f32 v52, v52, v65, v66
v_max_f32 v48, v48, v67
v_min_f32 v52, v52, v67
v_max3_f32 v49, v68, v69, v70
v_min3_f32 v53, v68, v69, v70
v_max3_f32 v49, v49, v71, v72
v_min3_f32 v53, v53, v71, v72
v_max3_f32 v49, v49, v73, v74
v_min3_f32 v53, v53, v73, v74
v_max_f32 v49, v49, v75
v_min_f32 v53, v53, v75
v_max3_f32 v50, v76, v77, v78
v_min3_f32 v54, v76, v77, v78
v_max3_f32 v50, v50, v79, v80
v_min3_f32 v54, v54, v79, v80
v_max3_f32 v50, v50, v81, v82
v_min3_f32 v54, v54, v81, v82
v_max_f32 v50, v50, v83
v_min_f32 v54, v54, v83
s_nop 1
v_max3_f32 v51, v84, v85, v86
v_min3_f32 v55, v84, v85, v86
v_max3_f32 v51, v51, v87, v88
v_min3_f32 v55, v55, v87, v88
v_max3_f32 v51, v51, v89, v90
v_min3_f32 v55, v55, v89, v90
v_max_f32 v51, v51, v91
v_min_f32 v55, v55, v91
s_nop 1
v_permlane32_swap_b32 v48, v49
v_permlane32_swap_b32 v50, v51
s_nop 0
v_max_f32 v48, v48, v49
v_max_f32 v50, v50, v51
s_nop 1
v_permlane16_swap_b32 v48, v50
s_nop 0
v_max_f32 v48, v48, v50
v_mul_f32 v48, s42, v48
v_mov_b32 v50, v48
s_nop 1
v_permlane16_swap_b32 v48, v50
s_nop 0
v_mov_b32 v49, v48
v_mov_b32 v51, v50
s_nop 1
v_permlane32_swap_b32 v48, v49
v_permlane32_swap_b32 v50, v51
s_nop 0
s_nop 1
v_permlane32_swap_b32 v52, v53
v_permlane32_swap_b32 v54, v55
s_nop 0
v_min_f32 v52, v52, v53
v_min_f32 v54, v54, v55
s_nop 1
v_permlane16_swap_b32 v52, v54
s_nop 0
v_min_f32 v52, v52, v54
v_mul_f32 v52, s42, v52
v_mov_b32 v54, v52
s_nop 1
v_permlane16_swap_b32 v52, v54
s_nop 0
v_mov_b32 v53, v52
v_mov_b32 v55, v54
s_nop 1
v_permlane32_swap_b32 v52, v53
v_permlane32_swap_b32 v54, v55
s_nop 0
v_fma_f32 v92, -v60, s42, v52
v_fma_f32 v60, v60, s42, -v48
v_fma_f32 v93, -v61, s42, v52
v_fma_f32 v61, v61, s42, -v48
v_fma_f32 v94, -v62, s42, v52
v_fma_f32 v62, v62, s42, -v48
v_fma_f32 v95, -v63, s42, v52
v_fma_f32 v63, v63, s42, -v48
v_fma_f32 v96, -v64, s42, v52
v_fma_f32 v64, v64, s42, -v48
v_fma_f32 v97, -v65, s42, v52
v_fma_f32 v65, v65, s42, -v48
v_fma_f32 v98, -v66, s42, v52
v_fma_f32 v66, v66, s42, -v48
v_fma_f32 v99, -v67, s42, v52
v_fma_f32 v67, v67, s42, -v48
v_exp_f32 v92, v92
v_exp_f32 v60, v60
v_exp_f32 v93, v93
v_exp_f32 v61, v61
v_exp_f32 v94, v94
v_exp_f32 v62, v62
v_exp_f32 v95, v95
v_exp_f32 v63, v63
v_exp_f32 v96, v96
v_exp_f32 v64, v64
v_exp_f32 v97, v97
v_exp_f32 v65, v65
v_exp_f32 v98, v98
v_exp_f32 v66, v66
v_exp_f32 v99, v99
v_exp_f32 v67, v67
v_fma_f32 v100, -v68, s42, v53
v_fma_f32 v68, v68, s42, -v49
v_fma_f32 v101, -v69, s42, v53
v_fma_f32 v69, v69, s42, -v49
v_fma_f32 v102, -v70, s42, v53
v_fma_f32 v70, v70, s42, -v49
v_fma_f32 v103, -v71, s42, v53
v_fma_f32 v71, v71, s42, -v49
v_fma_f32 v104, -v72, s42, v53
v_fma_f32 v72, v72, s42, -v49
v_fma_f32 v105, -v73, s42, v53
v_fma_f32 v73, v73, s42, -v49
v_fma_f32 v106, -v74, s42, v53
v_fma_f32 v74, v74, s42, -v49
v_fma_f32 v107, -v75, s42, v53
v_fma_f32 v75, v75, s42, -v49
v_exp_f32 v100, v100
v_exp_f32 v68, v68
v_exp_f32 v101, v101
v_exp_f32 v69, v69
v_exp_f32 v102, v102
v_exp_f32 v70, v70
v_exp_f32 v103, v103
v_exp_f32 v71, v71
v_exp_f32 v104, v104
v_exp_f32 v72, v72
v_exp_f32 v105, v105
v_exp_f32 v73, v73
v_exp_f32 v106, v106
v_exp_f32 v74, v74
v_exp_f32 v107, v107
v_exp_f32 v75, v75
v_fma_f32 v108, -v76, s42, v54
v_fma_f32 v76, v76, s42, -v50
v_fma_f32 v109, -v77, s42, v54
v_fma_f32 v77, v77, s42, -v50
v_fma_f32 v110, -v78, s42, v54
v_fma_f32 v78, v78, s42, -v50
v_fma_f32 v111, -v79, s42, v54
v_fma_f32 v79, v79, s42, -v50
v_fma_f32 v112, -v80, s42, v54
v_fma_f32 v80, v80, s42, -v50
v_fma_f32 v113, -v81, s42, v54
v_fma_f32 v81, v81, s42, -v50
v_fma_f32 v114, -v82, s42, v54
v_fma_f32 v82, v82, s42, -v50
v_fma_f32 v115, -v83, s42, v54
v_fma_f32 v83, v83, s42, -v50
v_exp_f32 v108, v108
v_exp_f32 v76, v76
v_exp_f32 v109, v109
v_exp_f32 v77, v77
v_exp_f32 v110, v110
v_exp_f32 v78, v78
v_exp_f32 v111, v111
v_exp_f32 v79, v79
v_exp_f32 v112, v112
v_exp_f32 v80, v80
v_exp_f32 v113, v113
v_exp_f32 v81, v81
v_exp_f32 v114, v114
v_exp_f32 v82, v82
v_exp_f32 v115, v115
v_exp_f32 v83, v83
v_fma_f32 v116, -v84, s42, v55
v_fma_f32 v84, v84, s42, -v51
v_fma_f32 v117, -v85, s42, v55
v_fma_f32 v85, v85, s42, -v51
v_fma_f32 v118, -v86, s42, v55
v_fma_f32 v86, v86, s42, -v51
v_fma_f32 v119, -v87, s42, v55
v_fma_f32 v87, v87, s42, -v51
v_fma_f32 v120, -v88, s42, v55
v_fma_f32 v88, v88, s42, -v51
v_fma_f32 v121, -v89, s42, v55
v_fma_f32 v89, v89, s42, -v51
v_fma_f32 v122, -v90, s42, v55
v_fma_f32 v90, v90, s42, -v51
v_fma_f32 v123, -v91, s42, v55
v_fma_f32 v91, v91, s42, -v51
v_exp_f32 v116, v116
v_exp_f32 v84, v84
v_exp_f32 v117, v117
v_exp_f32 v85, v85
v_exp_f32 v118, v118
v_exp_f32 v86, v86
v_exp_f32 v119, v119
v_exp_f32 v87, v87
v_exp_f32 v120, v120
v_exp_f32 v88, v88
v_exp_f32 v121, v121
v_exp_f32 v89, v89
v_exp_f32 v122, v122
v_exp_f32 v90, v90
v_exp_f32 v123, v123
v_exp_f32 v91, v91
s_nop 0
v_add_f32 v48, v60, v61
v_add_f32 v52, v92, v93
v_add_f32 v48, v48, v62
v_add_f32 v52, v52, v94
v_add_f32 v48, v48, v63
v_add_f32 v52, v52, v95
v_add_f32 v48, v48, v64
v_add_f32 v52, v52, v96
v_add_f32 v48, v48, v65
v_add_f32 v52, v52, v97
v_add_f32 v48, v48, v66
v_add_f32 v52, v52, v98
v_add_f32 v48, v48, v67
v_add_f32 v52, v52, v99
v_add_f32 v49, v68, v69
v_add_f32 v53, v100, v101
v_add_f32 v49, v49, v70
v_add_f32 v53, v53, v102
v_add_f32 v49, v49, v71
v_add_f32 v53, v53, v103
v_add_f32 v49, v49, v72
v_add_f32 v53, v53, v104
v_add_f32 v49, v49, v73
v_add_f32 v53, v53, v105
v_add_f32 v49, v49, v74
v_add_f32 v53, v53, v106
v_add_f32 v49, v49, v75
v_add_f32 v53, v53, v107
v_add_f32 v50, v76, v77
v_add_f32 v54, v108, v109
v_add_f32 v50, v50, v78
v_add_f32 v54, v54, v110
v_add_f32 v50, v50, v79
v_add_f32 v54, v54, v111
v_add_f32 v50, v50, v80
v_add_f32 v54, v54, v112
v_add_f32 v50, v50, v81
v_add_f32 v54, v54, v113
v_add_f32 v50, v50, v82
v_add_f32 v54, v54, v114
v_add_f32 v50, v50, v83
v_add_f32 v54, v54, v115
v_add_f32 v51, v84, v85
v_add_f32 v55, v116, v117
v_add_f32 v51, v51, v86
v_add_f32 v55, v55, v118
v_add_f32 v51, v51, v87
v_add_f32 v55, v55, v119
v_add_f32 v51, v51, v88
v_add_f32 v55, v55, v120
v_add_f32 v51, v51, v89
v_add_f32 v55, v55, v121
v_add_f32 v51, v51, v90
v_add_f32 v55, v55, v122
v_add_f32 v51, v51, v91
v_add_f32 v55, v55, v123
s_nop 1
v_permlane32_swap_b32 v48, v49
v_permlane32_swap_b32 v50, v51
s_nop 0
v_add_f32 v48, v48, v49
v_add_f32 v50, v50, v51
s_nop 1
v_permlane16_swap_b32 v48, v50
s_nop 0
v_add_f32 v48, v48, v50
v_rcp_f32 v48, v48
s_nop 0
v_mov_b32 v50, v48
s_nop 1
v_permlane16_swap_b32 v48, v50
s_nop 0
v_mov_b32 v49, v48
v_mov_b32 v51, v50
s_nop 1
v_permlane32_swap_b32 v48, v49
v_permlane32_swap_b32 v50, v51
s_nop 0
s_nop 1
v_permlane32_swap_b32 v52, v53
v_permlane32_swap_b32 v54, v55
s_nop 0
v_add_f32 v52, v52, v53
v_add_f32 v54, v54, v55
s_nop 1
v_permlane16_swap_b32 v52, v54
s_nop 0
v_add_f32 v52, v52, v54
v_rcp_f32 v52, v52
s_nop 0
v_mov_b32 v54, v52
s_nop 1
v_permlane16_swap_b32 v52, v54
s_nop 0
v_mov_b32 v53, v52
v_mov_b32 v55, v54
s_nop 1
v_permlane32_swap_b32 v52, v53
v_permlane32_swap_b32 v54, v55
s_nop 0
v_pk_mul_f32 v[60:61], v[60:61], v[48:49] op_sel:[0,0] op_sel_hi:[1,0]
v_pk_mul_f32 v[62:63], v[62:63], v[48:49] op_sel:[0,0] op_sel_hi:[1,0]
v_pk_mul_f32 v[64:65], v[64:65], v[48:49] op_sel:[0,0] op_sel_hi:[1,0]
v_pk_mul_f32 v[66:67], v[66:67], v[48:49] op_sel:[0,0] op_sel_hi:[1,0]
v_pk_mul_f32 v[92:93], v[92:93], v[52:53] op_sel:[0,0] op_sel_hi:[1,0]
v_pk_mul_f32 v[94:95], v[94:95], v[52:53] op_sel:[0,0] op_sel_hi:[1,0]
v_pk_mul_f32 v[96:97], v[96:97], v[52:53] op_sel:[0,0] op_sel_hi:[1,0]
v_pk_mul_f32 v[98:99], v[98:99], v[52:53] op_sel:[0,0] op_sel_hi:[1,0]
v_cvt_pk_bf16_f32 v60, v60, v61
v_cvt_pk_bf16_f32 v61, v62, v63
v_cvt_pk_bf16_f32 v62, v64, v65
v_cvt_pk_bf16_f32 v63, v66, v67
v_cvt_pk_bf16_f32 v92, v92, v93
v_cvt_pk_bf16_f32 v93, v94, v95
v_cvt_pk_bf16_f32 v94, v96, v97
v_cvt_pk_bf16_f32 v95, v98, v99
v_pk_mul_f32 v[68:69], v[68:69], v[48:49] op_sel:[0,1] op_sel_hi:[1,1]
v_pk_mul_f32 v[70:71], v[70:71], v[48:49] op_sel:[0,1] op_sel_hi:[1,1]
v_pk_mul_f32 v[72:73], v[72:73], v[48:49] op_sel:[0,1] op_sel_hi:[1,1]
v_pk_mul_f32 v[74:75], v[74:75], v[48:49] op_sel:[0,1] op_sel_hi:[1,1]
v_pk_mul_f32 v[100:101], v[100:101], v[52:53] op_sel:[0,1] op_sel_hi:[1,1]
v_pk_mul_f32 v[102:103], v[102:103], v[52:53] op_sel:[0,1] op_sel_hi:[1,1]
v_pk_mul_f32 v[104:105], v[104:105], v[52:53] op_sel:[0,1] op_sel_hi:[1,1]
v_pk_mul_f32 v[106:107], v[106:107], v[52:53] op_sel:[0,1] op_sel_hi:[1,1]
v_cvt_pk_bf16_f32 v68, v68, v69
v_cvt_pk_bf16_f32 v69, v70, v71
v_cvt_pk_bf16_f32 v70, v72, v73
v_cvt_pk_bf16_f32 v71, v74, v75
v_cvt_pk_bf16_f32 v100, v100, v101
v_cvt_pk_bf16_f32 v101, v102, v103
v_cvt_pk_bf16_f32 v102, v104, v105
v_cvt_pk_bf16_f32 v103, v106, v107
v_pk_mul_f32 v[76:77], v[76:77], v[50:51] op_sel:[0,0] op_sel_hi:[1,0]
v_pk_mul_f32 v[78:79], v[78:79], v[50:51] op_sel:[0,0] op_sel_hi:[1,0]
v_pk_mul_f32 v[80:81], v[80:81], v[50:51] op_sel:[0,0] op_sel_hi:[1,0]
v_pk_mul_f32 v[82:83], v[82:83], v[50:51] op_sel:[0,0] op_sel_hi:[1,0]
v_pk_mul_f32 v[108:109], v[108:109], v[54:55] op_sel:[0,0] op_sel_hi:[1,0]
v_pk_mul_f32 v[110:111], v[110:111], v[54:55] op_sel:[0,0] op_sel_hi:[1,0]
v_pk_mul_f32 v[112:113], v[112:113], v[54:55] op_sel:[0,0] op_sel_hi:[1,0]
v_pk_mul_f32 v[114:115], v[114:115], v[54:55] op_sel:[0,0] op_sel_hi:[1,0]
v_cvt_pk_bf16_f32 v76, v76, v77
v_cvt_pk_bf16_f32 v77, v78, v79
v_cvt_pk_bf16_f32 v78, v80, v81
v_cvt_pk_bf16_f32 v79, v82, v83
v_cvt_pk_bf16_f32 v108, v108, v109
v_cvt_pk_bf16_f32 v109, v110, v111
v_cvt_pk_bf16_f32 v110, v112, v113
v_cvt_pk_bf16_f32 v111, v114, v115
v_pk_mul_f32 v[84:85], v[84:85], v[50:51] op_sel:[0,1] op_sel_hi:[1,1]
v_pk_mul_f32 v[86:87], v[86:87], v[50:51] op_sel:[0,1] op_sel_hi:[1,1]
v_pk_mul_f32 v[88:89], v[88:89], v[50:51] op_sel:[0,1] op_sel_hi:[1,1]
v_pk_mul_f32 v[90:91], v[90:91], v[50:51] op_sel:[0,1] op_sel_hi:[1,1]
v_pk_mul_f32 v[116:117], v[116:117], v[54:55] op_sel:[0,1] op_sel_hi:[1,1]
v_pk_mul_f32 v[118:119], v[118:119], v[54:55] op_sel:[0,1] op_sel_hi:[1,1]
v_pk_mul_f32 v[120:121], v[120:121], v[54:55] op_sel:[0,1] op_sel_hi:[1,1]
v_pk_mul_f32 v[122:123], v[122:123], v[54:55] op_sel:[0,1] op_sel_hi:[1,1]
v_cvt_pk_bf16_f32 v84, v84, v85
v_cvt_pk_bf16_f32 v85, v86, v87
v_cvt_pk_bf16_f32 v86, v88, v89
v_cvt_pk_bf16_f32 v87, v90, v91
v_cvt_pk_bf16_f32 v116, v116, v117
v_cvt_pk_bf16_f32 v117, v118, v119
v_cvt_pk_bf16_f32 v118, v120, v121
v_cvt_pk_bf16_f32 v119, v122, v123
s_lshl_b32 s35, s43, 14
s_lshl_b32 s36, s44, 12
s_add_u32 s35, s35, s36
v_add_u32 v5, s35, v18
ds_write_b128 v5, v[60:63] offset:0
ds_write_b128 v5, v[92:95] offset:8192
ds_write_b128 v5, v[68:71] offset:1024
ds_write_b128 v5, v[100:103] offset:9216
ds_write_b128 v5, v[76:79] offset:2048
ds_write_b128 v5, v[108:111] offset:10240
ds_write_b128 v5, v[84:87] offset:3072
ds_write_b128 v5, v[116:119] offset:11264
v_and_b32 v4, 3, v0
v_lshlrev_b32 v4, 4, v4
v_lshrrev_b32 v6, 2, v2
v_lshl_add_u32 v6, v3, 2, v6
v_add_u32 v4, v4, v6
v_lshlrev_b32 v4, 4, v4
s_lshl_b32 s36, s44, 13
s_add_u32 s35, s35, s36
v_add_u32 v6, s35, v4
v_xor_b32 v7, 4096, v6
s_xor_b32 s35, s28, 2
s_lshl_b32 s35, s35, 12
s_add_u32 s35, s35, 32768
v_add_u32 v5, s35, v18
v_mov_b32 v56, 0x3f803f80
v_mov_b32 v57, 0x3f803f80
v_mov_b32 v58, 0x3f803f80
v_mov_b32 v59, 0x3f803f80
s_waitcnt lgkmcnt(0)
s_barrier
ds_read_b64_tr_b16 v[60:61], v6 offset:0
ds_read_b64_tr_b16 v[62:63], v6 offset:1024
ds_read_b64_tr_b16 v[64:65], v6 offset:8
ds_read_b64_tr_b16 v[66:67], v6 offset:1032
ds_read_b64_tr_b16 v[68:69], v6 offset:2048
ds_read_b64_tr_b16 v[70:71], v6 offset:3072
ds_read_b64_tr_b16 v[72:73], v6 offset:2056
ds_read_b64_tr_b16 v[74:75], v6 offset:3080
ds_read_b128 v[92:95], v5 offset:0
ds_read_b128 v[96:99], v5 offset:1024
ds_read_b128 v[100:103], v5 offset:2048
ds_read_b128 v[104:107], v5 offset:3072
s_waitcnt lgkmcnt(4)
ds_read_b64_tr_b16 v[76:77], v7 offset:0
ds_read_b64_tr_b16 v[78:79], v7 offset:1024
ds_read_b64_tr_b16 v[80:81], v7 offset:8
ds_read_b64_tr_b16 v[82:83], v7 offset:1032
ds_read_b64_tr_b16 v[84:85], v7 offset:2048
ds_read_b64_tr_b16 v[86:87], v7 offset:3072
ds_read_b64_tr_b16 v[88:89], v7 offset:2056
ds_read_b64_tr_b16 v[90:91], v7 offset:3080
v_mfma_f32_16x16x32_bf16 v[148:151], v[60:63], v[22:25], 0
v_mfma_f32_16x16x32_bf16 v[156:159], v[60:63], v[32:35], 0
v_mfma_f32_16x16x32_bf16 v[164:167], v[60:63], v[56:59], 0
v_mfma_f32_16x16x32_bf16 v[152:155], v[64:67], v[22:25], 0
v_mfma_f32_16x16x32_bf16 v[160:163], v[64:67], v[32:35], 0
v_mfma_f32_16x16x32_bf16 v[168:171], v[64:67], v[56:59], 0
v_mfma_f32_16x16x32_bf16 v[148:151], v[68:71], v[26:29], v[148:151]
v_mfma_f32_16x16x32_bf16 v[156:159], v[68:71], v[36:39], v[156:159]
v_mfma_f32_16x16x32_bf16 v[164:167], v[68:71], v[56:59], v[164:167]
v_mfma_f32_16x16x32_bf16 v[152:155], v[72:75], v[26:29], v[152:155]
v_mfma_f32_16x16x32_bf16 v[160:163], v[72:75], v[36:39], v[160:163]
v_mfma_f32_16x16x32_bf16 v[168:171], v[72:75], v[56:59], v[168:171]
s_waitcnt lgkmcnt(0)
v_mfma_f32_16x16x32_bf16 v[148:151], v[76:79], v[92:95], v[148:151]
v_mfma_f32_16x16x32_bf16 v[156:159], v[76:79], v[100:103], v[156:159]
v_mfma_f32_16x16x32_bf16 v[164:167], v[76:79], v[56:59], v[164:167]
v_mfma_f32_16x16x32_bf16 v[152:155], v[80:83], v[92:95], v[152:155]
v_mfma_f32_16x16x32_bf16 v[160:163], v[80:83], v[100:103], v[160:163]
v_mfma_f32_16x16x32_bf16 v[168:171], v[80:83], v[56:59], v[168:171]
v_mfma_f32_16x16x32_bf16 v[148:151], v[84:87], v[96:99], v[148:151]
v_mfma_f32_16x16x32_bf16 v[156:159], v[84:87], v[104:107], v[156:159]
v_mfma_f32_16x16x32_bf16 v[164:167], v[84:87], v[56:59], v[164:167]
v_mfma_f32_16x16x32_bf16 v[152:155], v[88:91], v[96:99], v[152:155]
v_mfma_f32_16x16x32_bf16 v[160:163], v[88:91], v[104:107], v[160:163]
v_mfma_f32_16x16x32_bf16 v[168:171], v[88:91], v[56:59], v[168:171]
s_lshl_b32 s35, s45, 1
s_add_u32 s35, s35, s44
s_lshl_b32 s36, s35, 15
s_lshl_b32 s37, s29, 10
s_add_u32 s36, s36, s37
s_add_u32 s36, s36, 20971520
s_add_u32 s37, s36, 16384
s_lshl_b32 s35, s35, 10
s_add_u32 s35, s35, 24117248
v_cmp_eq_u32 vcc, s29, v2
s_nop 2
v_cvt_pk_bf16_f32 v148, v148, v149
v_cvt_pk_bf16_f32 v149, v150, v151
v_cvt_pk_bf16_f32 v150, v152, v153
v_cvt_pk_bf16_f32 v151, v154, v155
v_cvt_pk_bf16_f32 v156, v156, v157
v_cvt_pk_bf16_f32 v157, v158, v159
v_cvt_pk_bf16_f32 v158, v160, v161
v_cvt_pk_bf16_f32 v159, v162, v163
v_cvt_pk_bf16_f32 v164, v164, v165
v_cvt_pk_bf16_f32 v165, v166, v167
v_cvt_pk_bf16_f32 v166, v168, v169
v_cvt_pk_bf16_f32 v167, v170, v171
buffer_store_dwordx4 v[148:151], v18, s[20:23], s36 offen
buffer_store_dwordx4 v[156:159], v18, s[20:23], s37 offen
s_and_saveexec_b64 s[38:39], vcc
buffer_store_dwordx4 v[164:167], v18, s[20:23], s35 offen
s_mov_b64 exec, s[38:39]
s_endpgm
qkv1_kernel_loader:
s_sub_u32 s43, s28, 4
v_lshrrev_b32 v4, 3, v0
v_and_b32 v5, 7, v0
s_lshl_b32 s35, s29, 3
s_add_u32 s35, s35, s43
s_lshl_b32 s35, s35, 15
v_lshl_add_u32 v20, v0, 4, s35
v_mov_b32 v21, v20
v_add_u32 v22, 131072, v20
v_add_u32 v23, 131072, v21
v_subrev_u32 v24, 32768, v20
v_subrev_u32 v25, 32768, v21
s_lshr_b32 s35, s43, 1
s_lshl_b32 s35, s35, 5
s_and_b32 s36, s43, 1
s_lshl_b32 s36, s36, 3
s_add_u32 s35, s35, s36
v_lshrrev_b32 v6, 2, v4
v_lshlrev_b32 v6, 4, v6
v_and_b32 v7, 3, v4
v_add3_u32 v6, v6, v7, s35
v_mul_u32_u24 v6, 6144, v6
v_and_b32 v7, 2, v4
v_xor_b32 v7, v7, v5
s_lshl_b32 s35, s30, 7
v_lshl_add_u32 v26, v7, 4, v6
v_add_u32 v26, s35, v26
v_xor_b32 v27, 64, v26
v_add_u32 v27, 23552, v27
s_lshl_b32 s44, s43, 11
v_add_u32 v10, s44, v10
v_add_u32 v11, s44, v11
s_mov_b32 s33, 0
s_mov_b32 s34, 0
s_mov_b32 s32, 0
s_lshl_b32 s35, s30, 12
s_lshl_b32 s36, s43, 10
s_add_u32 s35, s35, s36
s_add_u32 m0, s36, 143616
v_lshlrev_b32 v6, 4, v0
buffer_load_dwordx4 v6, s[24:27], s35 offen lds
s_mov_b32 s31, 0
qkv1_kernel_pro:
s_add_u32 s35, s32, s44
s_add_u32 m0, s35, 18432
s_nop 0
buffer_load_dwordx4 v26, s[16:19], s34 offen lds
buffer_load_dwordx4 v27, s[16:19], s34 offen offset:1024 lds
s_add_u32 m0, s35, 2048
s_nop 0
buffer_load_dwordx4 v20, s[12:15], s33 offen lds
buffer_load_dwordx4 v21, s[12:15], s33 offen offset:1024 lds
s_add_u32 m0, s35, 26624
s_add_u32 s41, s34, 2048
buffer_load_dwordx4 v26, s[16:19], s41 offen lds
buffer_load_dwordx4 v27, s[16:19], s41 offen offset:1024 lds
s_add_u32 m0, s35, 10240
s_nop 0
buffer_load_dwordx4 v22, s[12:15], s33 offen lds
buffer_load_dwordx4 v23, s[12:15], s33 offen offset:1024 lds
s_add_u32 m0, s35, 34816
s_add_u32 s41, s34, 4096
buffer_load_dwordx4 v26, s[16:19], s41 offen lds
buffer_load_dwordx4 v27, s[16:19], s41 offen offset:1024 lds
s_add_u32 s33, s33, 2048
s_add_u32 s34, s34, 393216
s_add_u32 s32, s32, 43008
s_cmp_eq_u32 s32, 129024
s_cselect_b32 s32, 0, s32
s_add_u32 s31, s31, 1
s_cmp_lt_u32 s31, 3
s_cbranch_scc1 qkv1_kernel_pro
v_mov_b32 v30, 0
v_mov_b32 v31, 0
v_mov_b32 v32, 0
v_mov_b32 v33, 0
v_mov_b32 v34, 0
v_mov_b32 v35, 0
v_mov_b32 v36, 0
v_mov_b32 v37, 0
v_mov_b32 v28, 0x3f803f80
s_mov_b32 s40, 0
s_mov_b32 s31, 0
s_waitcnt vmcnt(20)
s_barrier
v_add_u32 v12, s40, v10
v_add_u32 v13, s40, v11
ds_read_b128 v[40:43], v12 offset:2048
ds_read_b128 v[44:47], v13 offset:2048
ds_read_b128 v[48:51], v12 offset:10240
ds_read_b128 v[52:55], v13 offset:10240
s_add_u32 s40, s40, 43008
s_cmp_eq_u32 s40, 129024
s_cselect_b32 s40, 0, s40
s_waitcnt lgkmcnt(0)
v_dot2c_f32_bf16 v30, v40, v28
v_dot2c_f32_bf16 v31, v40, v40
v_dot2c_f32_bf16 v32, v48, v28
v_dot2c_f32_bf16 v33, v48, v48
v_dot2c_f32_bf16 v30, v41, v28
v_dot2c_f32_bf16 v31, v41, v41
v_dot2c_f32_bf16 v32, v49, v28
v_dot2c_f32_bf16 v33, v49, v49
v_dot2c_f32_bf16 v30, v42, v28
v_dot2c_f32_bf16 v31, v42, v42
v_dot2c_f32_bf16 v32, v50, v28
v_dot2c_f32_bf16 v33, v50, v50
v_dot2c_f32_bf16 v30, v43, v28
v_dot2c_f32_bf16 v31, v43, v43
v_dot2c_f32_bf16 v32, v51, v28
v_dot2c_f32_bf16 v33, v51, v51
v_dot2c_f32_bf16 v30, v44, v28
v_dot2c_f32_bf16 v31, v44, v44
v_dot2c_f32_bf16 v32, v52, v28
v_dot2c_f32_bf16 v33, v52, v52
v_dot2c_f32_bf16 v30, v45, v28
v_dot2c_f32_bf16 v31, v45, v45
v_dot2c_f32_bf16 v32, v53, v28
v_dot2c_f32_bf16 v33, v53, v53
v_dot2c_f32_bf16 v30, v46, v28
v_dot2c_f32_bf16 v31, v46, v46
v_dot2c_f32_bf16 v32, v54, v28
v_dot2c_f32_bf16 v33, v54, v54
v_dot2c_f32_bf16 v30, v47, v28
v_dot2c_f32_bf16 v31, v47, v47
v_dot2c_f32_bf16 v32, v55, v28
v_dot2c_f32_bf16 v33, v55, v55
qkv1_kernel_lloop:
s_waitcnt vmcnt(10)
s_barrier
v_add_u32 v12, s40, v10
v_add_u32 v13, s40, v11
ds_read_b128 v[40:43], v12 offset:2048
ds_read_b128 v[44:47], v13 offset:2048
ds_read_b128 v[48:51], v12 offset:10240
ds_read_b128 v[52:55], v13 offset:10240
s_add_u32 s40, s40, 43008
s_cmp_eq_u32 s40, 129024
s_cselect_b32 s40, 0, s40
s_add_u32 s35, s32, s44
s_add_u32 m0, s35, 18432
s_nop 0
buffer_load_dwordx4 v26, s[16:19], s34 offen lds
buffer_load_dwordx4 v27, s[16:19], s34 offen offset:1024 lds
s_waitcnt lgkmcnt(0)
v_dot2c_f32_bf16 v30, v40, v28
v_dot2c_f32_bf16 v31, v40, v40
v_dot2c_f32_bf16 v32, v48, v28
v_dot2c_f32_bf16 v33, v48, v48
s_add_u32 m0, s35, 2048
s_nop 0
buffer_load_dwordx4 v20, s[12:15], s33 offen lds
v_dot2c_f32_bf16 v30, v41, v28
v_dot2c_f32_bf16 v31, v41, v41
v_dot2c_f32_bf16 v32, v49, v28
v_dot2c_f32_bf16 v33, v49, v49
buffer_load_dwordx4 v21, s[12:15], s33 offen offset:1024 lds
v_dot2c_f32_bf16 v30, v42, v28
v_dot2c_f32_bf16 v31, v42, v42
v_dot2c_f32_bf16 v32, v50, v28
v_dot2c_f32_bf16 v33, v50, v50
s_add_u32 m0, s35, 26624
s_add_u32 s41, s34, 2048
buffer_load_dwordx4 v26, s[16:19], s41 offen lds
v_dot2c_f32_bf16 v30, v43, v28
v_dot2c_f32_bf16 v31, v43, v43
v_dot2c_f32_bf16 v32, v51, v28
v_dot2c_f32_bf16 v33, v51, v51
buffer_load_dwordx4 v27, s[16:19], s41 offen offset:1024 lds
v_dot2c_f32_bf16 v30, v44, v28
v_dot2c_f32_bf16 v31, v44, v44
v_dot2c_f32_bf16 v32, v52, v28
v_dot2c_f32_bf16 v33, v52, v52
s_add_u32 m0, s35, 10240
s_nop 0
buffer_load_dwordx4 v22, s[12:15], s33 offen lds
v_dot2c_f32_bf16 v30, v45, v28
v_dot2c_f32_bf16 v31, v45, v45
v_dot2c_f32_bf16 v32, v53, v28
v_dot2c_f32_bf16 v33, v53, v53
buffer_load_dwordx4 v23, s[12:15], s33 offen offset:1024 lds
v_dot2c_f32_bf16 v30, v46, v28
v_dot2c_f32_bf16 v31, v46, v46
v_dot2c_f32_bf16 v32, v54, v28
v_dot2c_f32_bf16 v33, v54, v54
s_add_u32 m0, s35, 34816
s_add_u32 s41, s34, 4096
buffer_load_dwordx4 v26, s[16:19], s41 offen lds
v_dot2c_f32_bf16 v30, v47, v28
v_dot2c_f32_bf16 v31, v47, v47
v_dot2c_f32_bf16 v32, v55, v28
v_dot2c_f32_bf16 v33, v55, v55
buffer_load_dwordx4 v27, s[16:19], s41 offen offset:1024 lds
s_add_u32 s33, s33, 2048
s_add_u32 s34, s34, 393216
s_add_u32 s32, s32, 43008
s_cmp_eq_u32 s32, 129024
s_cselect_b32 s32, 0, s32
s_add_u32 s31, s31, 1
s_cmp_lt_u32 s31, 13
s_cbranch_scc1 qkv1_kernel_lloop
s_waitcnt vmcnt(10)
qkv1_kernel_ltail:
s_barrier
v_add_u32 v12, s40, v10
v_add_u32 v13, s40, v11
ds_read_b128 v[40:43], v12 offset:2048
ds_read_b128 v[44:47], v13 offset:2048
ds_read_b128 v[48:51], v12 offset:10240
ds_read_b128 v[52:55], v13 offset:10240
s_add_u32 s40, s40, 43008
s_cmp_eq_u32 s40, 129024
s_cselect_b32 s40, 0, s40
s_waitcnt lgkmcnt(0)
v_dot2c_f32_bf16 v30, v40, v28
v_dot2c_f32_bf16 v31, v40, v40
v_dot2c_f32_bf16 v32, v48, v28
v_dot2c_f32_bf16 v33, v48, v48
v_dot2c_f32_bf16 v30, v41, v28
v_dot2c_f32_bf16 v31, v41, v41
v_dot2c_f32_bf16 v32, v49, v28
v_dot2c_f32_bf16 v33, v49, v49
v_dot2c_f32_bf16 v30, v42, v28
v_dot2c_f32_bf16 v31, v42, v42
v_dot2c_f32_bf16 v32, v50, v28
v_dot2c_f32_bf16 v33, v50, v50
v_dot2c_f32_bf16 v30, v43, v28
v_dot2c_f32_bf16 v31, v43, v43
v_dot2c_f32_bf16 v32, v51, v28
v_dot2c_f32_bf16 v33, v51, v51
v_dot2c_f32_bf16 v30, v44, v28
v_dot2c_f32_bf16 v31, v44, v44
v_dot2c_f32_bf16 v32, v52, v28
v_dot2c_f32_bf16 v33, v52, v52
v_dot2c_f32_bf16 v30, v45, v28
v_dot2c_f32_bf16 v31, v45, v45
v_dot2c_f32_bf16 v32, v53, v28
v_dot2c_f32_bf16 v33, v53, v53
v_dot2c_f32_bf16 v30, v46, v28
v_dot2c_f32_bf16 v31, v46, v46
v_dot2c_f32_bf16 v32, v54, v28
v_dot2c_f32_bf16 v33, v54, v54
v_dot2c_f32_bf16 v30, v47, v28
v_dot2c_f32_bf16 v31, v47, v47
v_dot2c_f32_bf16 v32, v55, v28
v_dot2c_f32_bf16 v33, v55, v55
s_waitcnt vmcnt(0)
s_add_u32 s31, s31, 1
s_cmp_lt_u32 s31, 15
s_cbranch_scc1 qkv1_kernel_ltail
s_nop 2
s_nop 1
v_permlane32_swap_b32 v30, v31
v_permlane32_swap_b32 v32, v33
s_nop 0
v_add_f32 v30, v30, v31
v_add_f32 v32, v32, v33
s_nop 1
v_permlane16_swap_b32 v30, v32
s_nop 0
v_add_f32 v30, v30, v32
v_mul_f32 v30, 0x3a800000, v30
v_mov_b32 v32, v30
s_nop 1
v_permlane16_swap_b32 v30, v32
s_nop 0
v_mov_b32 v31, v30
v_mov_b32 v33, v32
s_nop 1
v_permlane32_swap_b32 v30, v31
v_permlane32_swap_b32 v32, v33
s_nop 0
s_lshl_b32 s35, s43, 4
v_add_u32 v6, s35, v2
v_lshlrev_b32 v7, 3, v6
v_add_u32 v7, 129024, v7
v_lshlrev_b32 v6, 2, v6
v_add_u32 v6, 130176, v6
v_fma_f32 v31, -v30, v30, v31
v_max_f32 v31, 0, v31
v_add_f32 v31, 0x3727c5ac, v31
v_rsq_f32 v40, v31
v_sub_f32 v41, 0, v30
v_fma_f32 v33, -v32, v32, v33
v_max_f32 v33, 0, v33
v_add_f32 v33, 0x3727c5ac, v33
v_rsq_f32 v42, v33
v_sub_f32 v43, 0, v32
s_mov_b64 exec, 0xffff
ds_write_b64 v7, v[40:41] offset:128
ds_write_b32 v6, v40 offset:64
ds_write_b32 v6, v41 offset:640
ds_write_b64 v7, v[42:43] offset:640
ds_write_b32 v6, v42 offset:320
ds_write_b32 v6, v43 offset:896
s_waitcnt lgkmcnt(0)
s_barrier
s_barrier
qkv1_kernel_end:
s_endpgm
.text
.globl lin1_kernel
.p2align 8
.type lin1_kernel,@function
lin1_kernel:
s_cmp_ge_u32 s2, 256
s_cbranch_scc1 lin1_kernel_end
s_load_dwordx2 s[8:9], s[0:1], 72
s_load_dwordx2 s[10:11], s[0:1], 40
v_lshrrev_b32 v1, 6, v0
v_and_b32 v0, 63, v0
v_readfirstlane_b32 s28, v1
v_and_b32 v2, 15, v0
v_lshrrev_b32 v3, 4, v0
v_lshlrev_b32 v18, 4, v0
s_and_b32 s29, s2, 7
s_lshr_b32 s45, s2, 3
s_waitcnt lgkmcnt(0)
s_mov_b32 s20, s8
s_and_b32 s21, s9, 0xffff
s_mov_b32 s22, 268435456
s_mov_b32 s23, 0x00020000
s_mov_b32 s24, s10
s_and_b32 s25, s11, 0xffff
s_mov_b32 s26, 65536
s_mov_b32 s27, 0x00020000
s_lshl_b32 s36, s28, 11
s_mov_b32 m0, s36
s_lshl_b32 s35, s45, 11
buffer_load_dwordx4 v18, s[24:27], s35 offen lds
buffer_load_dwordx4 v18, s[24:27], s35 offen offset:1024 lds
s_lshl_b32 s35, s29, 4
s_lshl_b32 s37, s28, 2
s_add_u32 s35, s35, s37
s_lshl_b32 s35, s35, 5
s_add_u32 s35, s35, s45
s_lshl_b32 s35, s35, 10
s_add_u32 s46, s35, 12582912
s_add_u32 s35, s35, 16777216
buffer_load_dwordx4 v[20:23], v18, s[20:23], s35 offen
s_add_u32 s35, s35, 32768
buffer_load_dwordx4 v[24:27], v18, s[20:23], s35 offen
s_add_u32 s35, s35, 32768
buffer_load_dwordx4 v[28:31], v18, s[20:23], s35 offen
s_add_u32 s35, s35, 32768
buffer_load_dwordx4 v[32:35], v18, s[20:23], s35 offen
s_lshl_b32 s35, s45, 2
s_add_u32 s35, s35, s28
s_lshl_b32 s35, s35, 14
s_add_u32 s35, s35, 20971520
buffer_load_dwordx4 v[128:131], v18, s[20:23], s35 offen offset:0
buffer_load_dwordx4 v[132:135], v18, s[20:23], s35 offen offset:1024
buffer_load_dwordx4 v[136:139], v18, s[20:23], s35 offen offset:2048
buffer_load_dwordx4 v[140:143], v18, s[20:23], s35 offen offset:3072
s_add_u32 s35, s35, 4096
buffer_load_dwordx4 v[144:147], v18, s[20:23], s35 offen offset:0
buffer_load_dwordx4 v[148:151], v18, s[20:23], s35 offen offset:1024
buffer_load_dwordx4 v[152:155], v18, s[20:23], s35 offen offset:2048
buffer_load_dwordx4 v[156:159], v18, s[20:23], s35 offen offset:3072
s_add_u32 s35, s35, 4096
buffer_load_dwordx4 v[160:163], v18, s[20:23], s35 offen offset:0
buffer_load_dwordx4 v[164:167], v18, s[20:23], s35 offen offset:1024
buffer_load_dwordx4 v[168:171], v18, s[20:23], s35 offen offset:2048
buffer_load_dwordx4 v[172:175], v18, s[20:23], s35 offen offset:3072
s_add_u32 s35, s35, 4096
buffer_load_dwordx4 v[176:179], v18, s[20:23], s35 offen offset:0
buffer_load_dwordx4 v[180:183], v18, s[20:23], s35 offen offset:1024
buffer_load_dwordx4 v[184:187], v18, s[20:23], s35 offen offset:2048
buffer_load_dwordx4 v[188:191], v18, s[20:23], s35 offen offset:3072
s_lshl_b32 s35, s45, 11
s_add_u32 s35, s35, 24117248
buffer_load_dwordx4 v[192:195], v18, s[20:23], s35 offen offset:0
buffer_load_dwordx4 v[196:199], v18, s[20:23], s35 offen offset:1024
v_lshrrev_b32 v4, 2, v2
v_lshl_add_u32 v4, v3, 2, v4
v_lshlrev_b32 v4, 6, v4
v_and_b32 v5, 3, v0
v_lshl_add_u32 v4, v5, 3, v4
v_add_u32 v4, s36, v4
v_lshrrev_b32 v6, 2, v2
v_cmp_eq_u32 vcc, v6, v3
v_and_b32 v7, 1, v0
v_lshlrev_b32 v7, 4, v7
v_mov_b32 v8, 0x3f80
v_lshlrev_b32 v7, v7, v8
v_cndmask_b32 v7, 0, v7, vcc
v_and_b32 v6, 2, v0
v_cmp_eq_u32 vcc, 0, v6
v_mov_b32 v200, 0
v_mov_b32 v201, 0
v_mov_b32 v204, 0
v_mov_b32 v205, 0
v_cndmask_b32 v202, 0, v7, vcc
v_cndmask_b32 v203, v7, 0, vcc
s_mov_b32 s42, 0x3fb8aa3b
s_waitcnt vmcnt(22)
ds_read_b64_tr_b16 v[40:41], v4 offset:0
ds_read_b64_tr_b16 v[42:43], v4 offset:1024
ds_read_b64_tr_b16 v[44:45], v4 offset:32
ds_read_b64_tr_b16 v[46:47], v4 offset:1056
s_waitcnt vmcnt(18) lgkmcnt(0)
v_mfma_f32_16x16x32_bf16 v[60:63], v[40:43], v[20:23], 0
v_mfma_f32_16x16x32_bf16 v[64:67], v[44:47], v[20:23], 0
v_mfma_f32_16x16x32_bf16 v[68:71], v[40:43], v[24:27], 0
v_mfma_f32_16x16x32_bf16 v[72:75], v[44:47], v[24:27], 0
v_mfma_f32_16x16x32_bf16 v[76:79], v[40:43], v[28:31], 0
v_mfma_f32_16x16x32_bf16 v[80:83], v[44:47], v[28:31], 0
v_mfma_f32_16x16x32_bf16 v[84:87], v[40:43], v[32:35], 0
v_mfma_f32_16x16x32_bf16 v[88:91], v[44:47], v[32:35], 0
s_nop 4
v_max3_f32 v48, v60, v61, v62
v_min3_f32 v52, v60, v61, v62
v_max3_f32 v48, v48, v63, v64
v_min3_f32 v52, v52, v63, v64
v_max3_f32 v48, v48, v65, v66
v_min3_f32 v52, v52, v65, v66
v_max_f32 v48, v48, v67
v_min_f32 v52, v52, v67
v_max3_f32 v49, v68, v69, v70
v_min3_f32 v53, v68, v69, v70
v_max3_f32 v49, v49, v71, v72
v_min3_f32 v53, v53, v71, v72
v_max3_f32 v49, v49, v73, v74
v_min3_f32 v53, v53, v73, v74
v_max_f32 v49, v49, v75
v_min_f32 v53, v53, v75
v_max3_f32 v50, v76, v77, v78
v_min3_f32 v54, v76, v77, v78
v_max3_f32 v50, v50, v79, v80
v_min3_f32 v54, v54, v79, v80
v_max3_f32 v50, v50, v81, v82
v_min3_f32 v54, v54, v81, v82
v_max_f32 v50, v50, v83
v_min_f32 v54, v54, v83
s_nop 1
v_max3_f32 v51, v84, v85, v86
v_min3_f32 v55, v84, v85, v86
v_max3_f32 v51, v51, v87, v88
v_min3_f32 v55, v55, v87, v88
v_max3_f32 v51, v51, v89, v90
v_min3_f32 v55, v55, v89, v90
v_max_f32 v51, v51, v91
v_min_f32 v55, v55, v91
s_nop 1
v_permlane32_swap_b32 v48, v49
v_permlane32_swap_b32 v50, v51
s_nop 0
v_max_f32 v48, v48, v49
v_max_f32 v50, v50, v51
s_nop 1
v_permlane16_swap_b32 v48, v50
s_nop 0
v_max_f32 v48, v48, v50
v_mul_f32 v48, s42, v48
v_mov_b32 v50, v48
s_nop 1
v_permlane16_swap_b32 v48, v50
s_nop 0
v_mov_b32 v49, v48
v_mov_b32 v51, v50
s_nop 1
v_permlane32_swap_b32 v48, v49
v_permlane32_swap_b32 v50, v51
s_nop 0
s_nop 1
v_permlane32_swap_b32 v52, v53
v_permlane32_swap_b32 v54, v55
s_nop 0
v_min_f32 v52, v52, v53
v_min_f32 v54, v54, v55
s_nop 1
v_permlane16_swap_b32 v52, v54
s_nop 0
v_min_f32 v52, v52, v54
v_mul_f32 v52, s42, v52
v_mov_b32 v54, v52
s_nop 1
v_permlane16_swap_b32 v52, v54
s_nop 0
v_mov_b32 v53, v52
v_mov_b32 v55, v54
s_nop 1
v_permlane32_swap_b32 v52, v53
v_permlane32_swap_b32 v54, v55
s_nop 0
v_fma_f32 v92, -v60, s42, v52
v_fma_f32 v60, v60, s42, -v48
v_fma_f32 v93, -v61, s42, v52
v_fma_f32 v61, v61, s42, -v48
v_fma_f32 v94, -v62, s42, v52
v_fma_f32 v62, v62, s42, -v48
v_fma_f32 v95, -v63, s42, v52
v_fma_f32 v63, v63, s42, -v48
v_fma_f32 v96, -v64, s42, v52
v_fma_f32 v64, v64, s42, -v48
v_fma_f32 v97, -v65, s42, v52
v_fma_f32 v65, v65, s42, -v48
v_fma_f32 v98, -v66, s42, v52
v_fma_f32 v66, v66, s42, -v48
v_fma_f32 v99, -v67, s42, v52
v_fma_f32 v67, v67, s42, -v48
v_exp_f32 v92, v92
v_exp_f32 v60, v60
v_exp_f32 v93, v93
v_exp_f32 v61, v61
v_exp_f32 v94, v94
v_exp_f32 v62, v62
v_exp_f32 v95, v95
v_exp_f32 v63, v63
v_exp_f32 v96, v96
v_exp_f32 v64, v64
v_exp_f32 v97, v97
v_exp_f32 v65, v65
v_exp_f32 v98, v98
v_exp_f32 v66, v66
v_exp_f32 v99, v99
v_exp_f32 v67, v67
v_fma_f32 v100, -v68, s42, v53
v_fma_f32 v68, v68, s42, -v49
v_fma_f32 v101, -v69, s42, v53
v_fma_f32 v69, v69, s42, -v49
v_fma_f32 v102, -v70, s42, v53
v_fma_f32 v70, v70, s42, -v49
v_fma_f32 v103, -v71, s42, v53
v_fma_f32 v71, v71, s42, -v49
v_fma_f32 v104, -v72, s42, v53
v_fma_f32 v72, v72, s42, -v49
v_fma_f32 v105, -v73, s42, v53
v_fma_f32 v73, v73, s42, -v49
v_fma_f32 v106, -v74, s42, v53
v_fma_f32 v74, v74, s42, -v49
v_fma_f32 v107, -v75, s42, v53
v_fma_f32 v75, v75, s42, -v49
v_exp_f32 v100, v100
v_exp_f32 v68, v68
v_exp_f32 v101, v101
v_exp_f32 v69, v69
v_exp_f32 v102, v102
v_exp_f32 v70, v70
v_exp_f32 v103, v103
v_exp_f32 v71, v71
v_exp_f32 v104, v104
v_exp_f32 v72, v72
v_exp_f32 v105, v105
v_exp_f32 v73, v73
v_exp_f32 v106, v106
v_exp_f32 v74, v74
v_exp_f32 v107, v107
v_exp_f32 v75, v75
v_fma_f32 v108, -v76, s42, v54
v_fma_f32 v76, v76, s42, -v50
v_fma_f32 v109, -v77, s42, v54
v_fma_f32 v77, v77, s42, -v50
v_fma_f32 v110, -v78, s42, v54
v_fma_f32 v78, v78, s42, -v50
v_fma_f32 v111, -v79, s42, v54
v_fma_f32 v79, v79, s42, -v50
v_fma_f32 v112, -v80, s42, v54
v_fma_f32 v80, v80, s42, -v50
v_fma_f32 v113, -v81, s42, v54
v_fma_f32 v81, v81, s42, -v50
v_fma_f32 v114, -v82, s42, v54
v_fma_f32 v82, v82, s42, -v50
v_fma_f32 v115, -v83, s42, v54
v_fma_f32 v83, v83, s42, -v50
v_exp_f32 v108, v108
v_exp_f32 v76, v76
v_exp_f32 v109, v109
v_exp_f32 v77, v77
v_exp_f32 v110, v110
v_exp_f32 v78, v78
v_exp_f32 v111, v111
v_exp_f32 v79, v79
v_exp_f32 v112, v112
v_exp_f32 v80, v80
v_exp_f32 v113, v113
v_exp_f32 v81, v81
v_exp_f32 v114, v114
v_exp_f32 v82, v82
v_exp_f32 v115, v115
v_exp_f32 v83, v83
v_fma_f32 v116, -v84, s42, v55
v_fma_f32 v84, v84, s42, -v51
v_fma_f32 v117, -v85, s42, v55
v_fma_f32 v85, v85, s42, -v51
v_fma_f32 v118, -v86, s42, v55
v_fma_f32 v86, v86, s42, -v51
v_fma_f32 v119, -v87, s42, v55
v_fma_f32 v87, v87, s42, -v51
v_fma_f32 v120, -v88, s42, v55
v_fma_f32 v88, v88, s42, -v51
v_fma_f32 v121, -v89, s42, v55
v_fma_f32 v89, v89, s42, -v51
v_fma_f32 v122, -v90, s42, v55
v_fma_f32 v90, v90, s42, -v51
v_fma_f32 v123, -v91, s42, v55
v_fma_f32 v91, v91, s42, -v51
v_exp_f32 v116, v116
v_exp_f32 v84, v84
v_exp_f32 v117, v117
v_exp_f32 v85, v85
v_exp_f32 v118, v118
v_exp_f32 v86, v86
v_exp_f32 v119, v119
v_exp_f32 v87, v87
v_exp_f32 v120, v120
v_exp_f32 v88, v88
v_exp_f32 v121, v121
v_exp_f32 v89, v89
v_exp_f32 v122, v122
v_exp_f32 v90, v90
v_exp_f32 v123, v123
v_exp_f32 v91, v91
s_nop 0
v_add_f32 v48, v60, v61
v_add_f32 v52, v92, v93
v_add_f32 v48, v48, v62
v_add_f32 v52, v52, v94
v_add_f32 v48, v48, v63
v_add_f32 v52, v52, v95
v_add_f32 v48, v48, v64
v_add_f32 v52, v52, v96
v_add_f32 v48, v48, v65
v_add_f32 v52, v52, v97
v_add_f32 v48, v48, v66
v_add_f32 v52, v52, v98
v_add_f32 v48, v48, v67
v_add_f32 v52, v52, v99
v_add_f32 v49, v68, v69
v_add_f32 v53, v100, v101
v_add_f32 v49, v49, v70
v_add_f32 v53, v53, v102
v_add_f32 v49, v49, v71
v_add_f32 v53, v53, v103
v_add_f32 v49, v49, v72
v_add_f32 v53, v53, v104
v_add_f32 v49, v49, v73
v_add_f32 v53, v53, v105
v_add_f32 v49, v49, v74
v_add_f32 v53, v53, v106
v_add_f32 v49, v49, v75
v_add_f32 v53, v53, v107
v_add_f32 v50, v76, v77
v_add_f32 v54, v108, v109
v_add_f32 v50, v50, v78
v_add_f32 v54, v54, v110
v_add_f32 v50, v50, v79
v_add_f32 v54, v54, v111
v_add_f32 v50, v50, v80
v_add_f32 v54, v54, v112
v_add_f32 v50, v50, v81
v_add_f32 v54, v54, v113
v_add_f32 v50, v50, v82
v_add_f32 v54, v54, v114
v_add_f32 v50, v50, v83
v_add_f32 v54, v54, v115
v_add_f32 v51, v84, v85
v_add_f32 v55, v116, v117
v_add_f32 v51, v51, v86
v_add_f32 v55, v55, v118
v_add_f32 v51, v51, v87
v_add_f32 v55, v55, v119
v_add_f32 v51, v51, v88
v_add_f32 v55, v55, v120
v_add_f32 v51, v51, v89
v_add_f32 v55, v55, v121
v_add_f32 v51, v51, v90
v_add_f32 v55, v55, v122
v_add_f32 v51, v51, v91
v_add_f32 v55, v55, v123
s_nop 1
v_permlane32_swap_b32 v48, v49
v_permlane32_swap_b32 v50, v51
s_nop 0
v_add_f32 v48, v48, v49
v_add_f32 v50, v50, v51
s_nop 1
v_permlane16_swap_b32 v48, v50
s_nop 0
v_add_f32 v48, v48, v50
v_rcp_f32 v48, v48
s_nop 0
v_mov_b32 v50, v48
s_nop 1
v_permlane16_swap_b32 v48, v50
s_nop 0
v_mov_b32 v49, v48
v_mov_b32 v51, v50
s_nop 1
v_permlane32_swap_b32 v48, v49
v_permlane32_swap_b32 v50, v51
s_nop 0
s_nop 1
v_permlane32_swap_b32 v52, v53
v_permlane32_swap_b32 v54, v55
s_nop 0
v_add_f32 v52, v52, v53
v_add_f32 v54, v54, v55
s_nop 1
v_permlane16_swap_b32 v52, v54
s_nop 0
v_add_f32 v52, v52, v54
v_rcp_f32 v52, v52
s_nop 0
v_mov_b32 v54, v52
s_nop 1
v_permlane16_swap_b32 v52, v54
s_nop 0
v_mov_b32 v53, v52
v_mov_b32 v55, v54
s_nop 1
v_permlane32_swap_b32 v52, v53
v_permlane32_swap_b32 v54, v55
s_nop 0
v_pk_mul_f32 v[60:61], v[60:61], v[48:49] op_sel:[0,0] op_sel_hi:[1,0]
v_pk_mul_f32 v[62:63], v[62:63], v[48:49] op_sel:[0,0] op_sel_hi:[1,0]
v_pk_mul_f32 v[64:65], v[64:65], v[48:49] op_sel:[0,0] op_sel_hi:[1,0]
v_pk_mul_f32 v[66:67], v[66:67], v[48:49] op_sel:[0,0] op_sel_hi:[1,0]
v_pk_mul_f32 v[92:93], v[92:93], v[52:53] op_sel:[0,0] op_sel_hi:[1,0]
v_pk_mul_f32 v[94:95], v[94:95], v[52:53] op_sel:[0,0] op_sel_hi:[1,0]
v_pk_mul_f32 v[96:97], v[96:97], v[52:53] op_sel:[0,0] op_sel_hi:[1,0]
v_pk_mul_f32 v[98:99], v[98:99], v[52:53] op_sel:[0,0] op_sel_hi:[1,0]
v_cvt_pk_bf16_f32 v60, v60, v61
v_cvt_pk_bf16_f32 v61, v62, v63
v_cvt_pk_bf16_f32 v62, v64, v65
v_cvt_pk_bf16_f32 v63, v66, v67
v_cvt_pk_bf16_f32 v92, v92, v93
v_cvt_pk_bf16_f32 v93, v94, v95
v_cvt_pk_bf16_f32 v94, v96, v97
v_cvt_pk_bf16_f32 v95, v98, v99
v_pk_mul_f32 v[68:69], v[68:69], v[48:49] op_sel:[0,1] op_sel_hi:[1,1]
v_pk_mul_f32 v[70:71], v[70:71], v[48:49] op_sel:[0,1] op_sel_hi:[1,1]
v_pk_mul_f32 v[72:73], v[72:73], v[48:49] op_sel:[0,1] op_sel_hi:[1,1]
v_pk_mul_f32 v[74:75], v[74:75], v[48:49] op_sel:[0,1] op_sel_hi:[1,1]
v_pk_mul_f32 v[100:101], v[100:101], v[52:53] op_sel:[0,1] op_sel_hi:[1,1]
v_pk_mul_f32 v[102:103], v[102:103], v[52:53] op_sel:[0,1] op_sel_hi:[1,1]
v_pk_mul_f32 v[104:105], v[104:105], v[52:53] op_sel:[0,1] op_sel_hi:[1,1]
v_pk_mul_f32 v[106:107], v[106:107], v[52:53] op_sel:[0,1] op_sel_hi:[1,1]
v_cvt_pk_bf16_f32 v68, v68, v69
v_cvt_pk_bf16_f32 v69, v70, v71
v_cvt_pk_bf16_f32 v70, v72, v73
v_cvt_pk_bf16_f32 v71, v74, v75
v_cvt_pk_bf16_f32 v100, v100, v101
v_cvt_pk_bf16_f32 v101, v102, v103
v_cvt_pk_bf16_f32 v102, v104, v105
v_cvt_pk_bf16_f32 v103, v106, v107
v_pk_mul_f32 v[76:77], v[76:77], v[50:51] op_sel:[0,0] op_sel_hi:[1,0]
v_pk_mul_f32 v[78:79], v[78:79], v[50:51] op_sel:[0,0] op_sel_hi:[1,0]
v_pk_mul_f32 v[80:81], v[80:81], v[50:51] op_sel:[0,0] op_sel_hi:[1,0]
v_pk_mul_f32 v[82:83], v[82:83], v[50:51] op_sel:[0,0] op_sel_hi:[1,0]
v_pk_mul_f32 v[108:109], v[108:109], v[54:55] op_sel:[0,0] op_sel_hi:[1,0]
v_pk_mul_f32 v[110:111], v[110:111], v[54:55] op_sel:[0,0] op_sel_hi:[1,0]
v_pk_mul_f32 v[112:113], v[112:113], v[54:55] op_sel:[0,0] op_sel_hi:[1,0]
v_pk_mul_f32 v[114:115], v[114:115], v[54:55] op_sel:[0,0] op_sel_hi:[1,0]
v_cvt_pk_bf16_f32 v76, v76, v77
v_cvt_pk_bf16_f32 v77, v78, v79
v_cvt_pk_bf16_f32 v78, v80, v81
v_cvt_pk_bf16_f32 v79, v82, v83
v_cvt_pk_bf16_f32 v108, v108, v109
v_cvt_pk_bf16_f32 v109, v110, v111
v_cvt_pk_bf16_f32 v110, v112, v113
v_cvt_pk_bf16_f32 v111, v114, v115
v_pk_mul_f32 v[84:85], v[84:85], v[50:51] op_sel:[0,1] op_sel_hi:[1,1]
v_pk_mul_f32 v[86:87], v[86:87], v[50:51] op_sel:[0,1] op_sel_hi:[1,1]
v_pk_mul_f32 v[88:89], v[88:89], v[50:51] op_sel:[0,1] op_sel_hi:[1,1]
v_pk_mul_f32 v[90:91], v[90:91], v[50:51] op_sel:[0,1] op_sel_hi:[1,1]
v_pk_mul_f32 v[116:117], v[116:117], v[54:55] op_sel:[0,1] op_sel_hi:[1,1]
v_pk_mul_f32 v[118:119], v[118:119], v[54:55] op_sel:[0,1] op_sel_hi:[1,1]
v_pk_mul_f32 v[120:121], v[120:121], v[54:55] op_sel:[0,1] op_sel_hi:[1,1]
v_pk_mul_f32 v[122:123], v[122:123], v[54:55] op_sel:[0,1] op_sel_hi:[1,1]
v_cvt_pk_bf16_f32 v84, v84, v85
v_cvt_pk_bf16_f32 v85, v86, v87
v_cvt_pk_bf16_f32 v86, v88, v89
v_cvt_pk_bf16_f32 v87, v90, v91
v_cvt_pk_bf16_f32 v116, v116, v117
v_cvt_pk_bf16_f32 v117, v118, v119
v_cvt_pk_bf16_f32 v118, v120, v121
v_cvt_pk_bf16_f32 v119, v122, v123
s_waitcnt vmcnt(0)
v_mfma_f32_16x16x32_bf16 v[20:23], v[202:205], v[128:131], 0
v_mfma_f32_16x16x32_bf16 v[24:27], v[200:203], v[128:131], 0
v_mfma_f32_16x16x32_bf16 v[20:23], v[202:205], v[132:135], v[20:23]
v_mfma_f32_16x16x32_bf16 v[24:27], v[200:203], v[132:135], v[24:27]
v_mfma_f32_16x16x32_bf16 v[20:23], v[202:205], v[136:139], v[20:23]
v_mfma_f32_16x16x32_bf16 v[24:27], v[200:203], v[136:139], v[24:27]
v_mfma_f32_16x16x32_bf16 v[20:23], v[202:205], v[140:143], v[20:23]
v_mfma_f32_16x16x32_bf16 v[24:27], v[200:203], v[140:143], v[24:27]
v_mfma_f32_16x16x32_bf16 v[20:23], v[202:205], v[144:147], v[20:23]
v_mfma_f32_16x16x32_bf16 v[24:27], v[200:203], v[144:147], v[24:27]
v_mfma_f32_16x16x32_bf16 v[20:23], v[202:205], v[148:151], v[20:23]
v_mfma_f32_16x16x32_bf16 v[24:27], v[200:203], v[148:151], v[24:27]
v_mfma_f32_16x16x32_bf16 v[20:23], v[202:205], v[152:155], v[20:23]
v_mfma_f32_16x16x32_bf16 v[24:27], v[200:203], v[152:155], v[24:27]
v_mfma_f32_16x16x32_bf16 v[20:23], v[202:205], v[156:159], v[20:23]
v_mfma_f32_16x16x32_bf16 v[24:27], v[200:203], v[156:159], v[24:27]
v_mfma_f32_16x16x32_bf16 v[20:23], v[202:205], v[160:163], v[20:23]
v_mfma_f32_16x16x32_bf16 v[24:27], v[200:203], v[160:163], v[24:27]
v_mfma_f32_16x16x32_bf16 v[20:23], v[202:205], v[164:167], v[20:23]
v_mfma_f32_16x16x32_bf16 v[24:27], v[200:203], v[164:167], v[24:27]
v_mfma_f32_16x16x32_bf16 v[20:23], v[202:205], v[168:171], v[20:23]
v_mfma_f32_16x16x32_bf16 v[24:27], v[200:203], v[168:171], v[24:27]
v_mfma_f32_16x16x32_bf16 v[20:23], v[202:205], v[172:175], v[20:23]
v_mfma_f32_16x16x32_bf16 v[24:27], v[200:203], v[172:175], v[24:27]
v_mfma_f32_16x16x32_bf16 v[20:23], v[202:205], v[176:179], v[20:23]
v_mfma_f32_16x16x32_bf16 v[24:27], v[200:203], v[176:179], v[24:27]
v_mfma_f32_16x16x32_bf16 v[20:23], v[202:205], v[180:183], v[20:23]
v_mfma_f32_16x16x32_bf16 v[24:27], v[200:203], v[180:183], v[24:27]
v_mfma_f32_16x16x32_bf16 v[20:23], v[202:205], v[184:187], v[20:23]
v_mfma_f32_16x16x32_bf16 v[24:27], v[200:203], v[184:187], v[24:27]
v_mfma_f32_16x16x32_bf16 v[20:23], v[202:205], v[188:191], v[20:23]
v_mfma_f32_16x16x32_bf16 v[24:27], v[200:203], v[188:191], v[24:27]
s_lshl_b32 s35, s28, 10
s_add_u32 s35, s35, 8192
v_add_u32 v5, s35, v18
s_nop 6
v_cvt_pk_bf16_f32 v20, v20, v21
v_cvt_pk_bf16_f32 v21, v22, v23
v_cvt_pk_bf16_f32 v22, v24, v25
v_cvt_pk_bf16_f32 v23, v26, v27
ds_write_b128 v5, v[20:23]
v_mfma_f32_16x16x32_bf16 v[128:131], v[192:195], v[60:63], 0
v_mfma_f32_16x16x32_bf16 v[132:135], v[192:195], v[68:71], 0
v_mfma_f32_16x16x32_bf16 v[136:139], v[192:195], v[76:79], 0
v_mfma_f32_16x16x32_bf16 v[140:143], v[192:195], v[84:87], 0
v_mfma_f32_16x16x32_bf16 v[128:131], v[196:199], v[92:95], v[128:131]
v_mfma_f32_16x16x32_bf16 v[132:135], v[196:199], v[100:103], v[132:135]
v_mfma_f32_16x16x32_bf16 v[136:139], v[196:199], v[108:111], v[136:139]
v_mfma_f32_16x16x32_bf16 v[140:143], v[196:199], v[116:119], v[140:143]
s_waitcnt lgkmcnt(0)
s_barrier
ds_read_b128 v[20:23], v18 offset:8192
ds_read_b128 v[24:27], v18 offset:9216
ds_read_b128 v[28:31], v18 offset:10240
ds_read_b128 v[32:35], v18 offset:11264
s_nop 3
v_add_f32 v48, v128, v129
v_add_f32 v130, v130, v131
v_add_f32 v48, v48, v130
v_add_f32 v49, v132, v133
v_add_f32 v134, v134, v135
v_add_f32 v49, v49, v134
v_add_f32 v50, v136, v137
v_add_f32 v138, v138, v139
v_add_f32 v50, v50, v138
v_add_f32 v51, v140, v141
v_add_f32 v142, v142, v143
v_add_f32 v51, v51, v142
s_waitcnt lgkmcnt(0)
v_mfma_f32_16x16x32_bf16 v[144:147], v[20:23], v[60:63], 0
v_mfma_f32_16x16x32_bf16 v[148:151], v[24:27], v[60:63], 0
v_mfma_f32_16x16x32_bf16 v[152:155], v[20:23], v[68:71], 0
v_mfma_f32_16x16x32_bf16 v[156:159], v[24:27], v[68:71], 0
v_mfma_f32_16x16x32_bf16 v[160:163], v[20:23], v[76:79], 0
v_mfma_f32_16x16x32_bf16 v[164:167], v[24:27], v[76:79], 0
v_mfma_f32_16x16x32_bf16 v[168:171], v[20:23], v[84:87], 0
v_mfma_f32_16x16x32_bf16 v[172:175], v[24:27], v[84:87], 0
v_mfma_f32_16x16x32_bf16 v[144:147], v[28:31], v[92:95], v[144:147]
v_mfma_f32_16x16x32_bf16 v[148:151], v[32:35], v[92:95], v[148:151]
v_mfma_f32_16x16x32_bf16 v[152:155], v[28:31], v[100:103], v[152:155]
v_mfma_f32_16x16x32_bf16 v[156:159], v[32:35], v[100:103], v[156:159]
v_mfma_f32_16x16x32_bf16 v[160:163], v[28:31], v[108:111], v[160:163]
v_mfma_f32_16x16x32_bf16 v[164:167], v[32:35], v[108:111], v[164:167]
v_mfma_f32_16x16x32_bf16 v[168:171], v[28:31], v[116:119], v[168:171]
v_mfma_f32_16x16x32_bf16 v[172:175], v[32:35], v[116:119], v[172:175]
s_nop 1
v_permlane32_swap_b32 v48, v49
v_permlane32_swap_b32 v50, v51
s_nop 0
v_add_f32 v48, v48, v49
v_add_f32 v50, v50, v51
s_nop 1
v_permlane16_swap_b32 v48, v50
s_nop 0
v_add_f32 v48, v48, v50
v_add_f32 v48, 0x358637bd, v48
v_rcp_f32 v48, v48
s_nop 0
v_mov_b32 v50, v48
s_nop 1
v_permlane16_swap_b32 v48, v50
s_nop 0
v_mov_b32 v49, v48
v_mov_b32 v51, v50
s_nop 1
v_permlane32_swap_b32 v48, v49
v_permlane32_swap_b32 v50, v51
s_nop 0
v_pk_mul_f32 v[144:145], v[144:145], v[48:49] op_sel:[0,0] op_sel_hi:[1,0]
v_pk_mul_f32 v[146:147], v[146:147], v[48:49] op_sel:[0,0] op_sel_hi:[1,0]
v_pk_mul_f32 v[148:149], v[148:149], v[48:49] op_sel:[0,0] op_sel_hi:[1,0]
v_pk_mul_f32 v[150:151], v[150:151], v[48:49] op_sel:[0,0] op_sel_hi:[1,0]
v_cvt_pk_bf16_f32 v144, v144, v145
v_cvt_pk_bf16_f32 v145, v146, v147
v_cvt_pk_bf16_f32 v146, v148, v149
v_cvt_pk_bf16_f32 v147, v150, v151
buffer_store_dwordx4 v[144:147], v18, s[20:23], s46 offen
s_add_u32 s46, s46, 32768
v_pk_mul_f32 v[152:153], v[152:153], v[48:49] op_sel:[0,1] op_sel_hi:[1,1]
v_pk_mul_f32 v[154:155], v[154:155], v[48:49] op_sel:[0,1] op_sel_hi:[1,1]
v_pk_mul_f32 v[156:157], v[156:157], v[48:49] op_sel:[0,1] op_sel_hi:[1,1]
v_pk_mul_f32 v[158:159], v[158:159], v[48:49] op_sel:[0,1] op_sel_hi:[1,1]
v_cvt_pk_bf16_f32 v152, v152, v153
v_cvt_pk_bf16_f32 v153, v154, v155
v_cvt_pk_bf16_f32 v154, v156, v157
v_cvt_pk_bf16_f32 v155, v158, v159
buffer_store_dwordx4 v[152:155], v18, s[20:23], s46 offen
s_add_u32 s46, s46, 32768
v_pk_mul_f32 v[160:161], v[160:161], v[50:51] op_sel:[0,0] op_sel_hi:[1,0]
v_pk_mul_f32 v[162:163], v[162:163], v[50:51] op_sel:[0,0] op_sel_hi:[1,0]
v_pk_mul_f32 v[164:165], v[164:165], v[50:51] op_sel:[0,0] op_sel_hi:[1,0]
v_pk_mul_f32 v[166:167], v[166:167], v[50:51] op_sel:[0,0] op_sel_hi:[1,0]
v_cvt_pk_bf16_f32 v160, v160, v161
v_cvt_pk_bf16_f32 v161, v162, v163
v_cvt_pk_bf16_f32 v162, v164, v165
v_cvt_pk_bf16_f32 v163, v166, v167
buffer_store_dwordx4 v[160:163], v18, s[20:23], s46 offen
s_add_u32 s46, s46, 32768
v_pk_mul_f32 v[168:169], v[168:169], v[50:51] op_sel:[0,1] op_sel_hi:[1,1]
v_pk_mul_f32 v[170:171], v[170:171], v[50:51] op_sel:[0,1] op_sel_hi:[1,1]
v_pk_mul_f32 v[172:173], v[172:173], v[50:51] op_sel:[0,1] op_sel_hi:[1,1]
v_pk_mul_f32 v[174:175], v[174:175], v[50:51] op_sel:[0,1] op_sel_hi:[1,1]
v_cvt_pk_bf16_f32 v168, v168, v169
v_cvt_pk_bf16_f32 v169, v170, v171
v_cvt_pk_bf16_f32 v170, v172, v173
v_cvt_pk_bf16_f32 v171, v174, v175
buffer_store_dwordx4 v[168:171], v18, s[20:23], s46 offen
lin1_kernel_end:
s_endpgm
.text
.globl out1_kernel
.p2align 8
.type out1_kernel,@function
out1_kernel:
s_cmp_ge_u32 s2, 256
s_cbranch_scc1 out1_kernel_end
s_load_dwordx2 s[8:9], s[0:1], 72
s_load_dwordx2 s[6:7], s[0:1], 48
v_lshrrev_b32 v1, 6, v0
v_and_b32 v0, 63, v0
v_readfirstlane_b32 s28, v1
s_and_b32 s35, s2, 7
s_lshr_b32 s41, s2, 3
s_and_b32 s29, s35, 7
s_lshl_b32 s29, s29, 1
s_and_b32 s30, s41, 1
s_add_u32 s29, s29, s30
s_lshr_b32 s30, s35, 3
s_lshl_b32 s30, s30, 4
s_lshr_b32 s41, s41, 1
s_add_u32 s30, s30, s41
v_and_b32 v2, 15, v0
v_lshrrev_b32 v3, 4, v0
v_lshlrev_b32 v18, 4, v0
v_lshrrev_b32 v4, 3, v0
v_and_b32 v5, 7, v0
s_lshr_b32 s35, s28, 1
s_lshl_b32 s35, s35, 5
s_and_b32 s36, s28, 1
s_lshl_b32 s36, s36, 3
s_add_u32 s35, s35, s36
v_lshrrev_b32 v6, 2, v4
v_lshlrev_b32 v6, 4, v6
v_and_b32 v7, 3, v4
v_add3_u32 v6, v6, v7, s35
v_lshlrev_b32 v6, 11, v6
v_and_b32 v7, 2, v4
v_xor_b32 v7, v7, v5
s_lshl_b32 s35, s30, 7
v_lshl_add_u32 v10, v7, 4, v6
v_add_u32 v10, s35, v10
v_xor_b32 v11, 64, v10
v_add_u32 v11, 7168, v11
s_lshl_b32 s35, s29, 3
s_lshl_b32 s36, s28, 1
s_add_u32 s47, s35, s36
s_lshl_b32 s35, s47, 15
v_add_u32 v12, s35, v18
v_add_u32 v13, 32768, v12
v_lshrrev_b32 v4, 2, v2
v_and_b32 v5, 3, v0
v_lshl_add_u32 v6, v3, 3, v4
v_lshlrev_b32 v6, 7, v6
v_lshl_add_u32 v6, v5, 3, v6
v_lshrrev_b32 v7, 1, v4
v_and_b32 v8, 1, v3
v_lshl_add_u32 v7, v8, 1, v7
v_lshl_add_u32 v14, v7, 5, v6
v_xor_b32 v15, 32, v14
v_xor_b32 v16, 64, v14
v_xor_b32 v17, 96, v14
s_waitcnt lgkmcnt(0)
s_mov_b32 s16, s6
s_and_b32 s17, s7, 0xffff
s_mov_b32 s18, 2097152
s_mov_b32 s19, 0x00020000
s_mov_b32 s20, s8
s_and_b32 s21, s9, 0xffff
s_mov_b32 s22, 268435456
s_mov_b32 s23, 0x00020000
s_lshl_b32 s33, s28, 11
s_mov_b32 s34, 12582912
s_mov_b32 s41, 0
s_add_u32 m0, s33, 0
buffer_load_dwordx4 v[64:67], v12, s[20:23], s34 offen
buffer_load_dwordx4 v10, s[16:19], s41 offen lds
buffer_load_dwordx4 v[68:71], v13, s[20:23], s34 offen
buffer_load_dwordx4 v11, s[16:19], s41 offen offset:1024 lds
buffer_load_dwordx4 v[72:75], v12, s[20:23], s34 offen offset:1024
buffer_load_dwordx4 v[76:79], v13, s[20:23], s34 offen offset:1024
s_add_u32 s34, s34, 2048
s_add_u32 s41, s41, 131072
s_add_u32 m0, s33, 8192
buffer_load_dwordx4 v[80:83], v12, s[20:23], s34 offen
buffer_load_dwordx4 v10, s[16:19], s41 offen lds
buffer_load_dwordx4 v[84:87], v13, s[20:23], s34 offen
buffer_load_dwordx4 v11, s[16:19], s41 offen offset:1024 lds
buffer_load_dwordx4 v[88:91], v12, s[20:23], s34 offen offset:1024
buffer_load_dwordx4 v[92:95], v13, s[20:23], s34 offen offset:1024
s_add_u32 s34, s34, 2048
s_add_u32 s41, s41, 131072
s_add_u32 m0, s33, 16384
buffer_load_dwordx4 v[96:99], v12, s[20:23], s34 offen
buffer_load_dwordx4 v10, s[16:19], s41 offen lds
buffer_load_dwordx4 v[100:103], v13, s[20:23], s34 offen
buffer_load_dwordx4 v11, s[16:19], s41 offen offset:1024 lds
buffer_load_dwordx4 v[104:107], v12, s[20:23], s34 offen offset:1024
buffer_load_dwordx4 v[108:111], v13, s[20:23], s34 offen offset:1024
s_add_u32 s34, s34, 2048
s_add_u32 s41, s41, 131072
s_lshl_b32 s48, s30, 11
s_add_u32 s49, s48, 0
v_mov_b32 v160, 0
v_mov_b32 v161, 0
v_mov_b32 v162, 0
v_mov_b32 v163, 0
v_mov_b32 v164, 0
v_mov_b32 v165, 0
v_mov_b32 v166, 0
v_mov_b32 v167, 0
v_mov_b32 v168, 0
v_mov_b32 v169, 0
v_mov_b32 v170, 0
v_mov_b32 v171, 0
v_mov_b32 v172, 0
v_mov_b32 v173, 0
v_mov_b32 v174, 0
v_mov_b32 v175, 0
v_mov_b32 v176, 0
v_mov_b32 v177, 0
v_mov_b32 v178, 0
v_mov_b32 v179, 0
v_mov_b32 v180, 0
v_mov_b32 v181, 0
v_mov_b32 v182, 0
v_mov_b32 v183, 0
v_mov_b32 v184, 0
v_mov_b32 v185, 0
v_mov_b32 v186, 0
v_mov_b32 v187, 0
v_mov_b32 v188, 0
v_mov_b32 v189, 0
v_mov_b32 v190, 0
v_mov_b32 v191, 0
s_waitcnt vmcnt(12)
s_barrier
ds_read_b64_tr_b16 v[128:129], v14 offset:0
ds_read_b64_tr_b16 v[130:131], v14 offset:512
ds_read_b64_tr_b16 v[132:133], v15 offset:0
ds_read_b64_tr_b16 v[134:135], v15 offset:512
ds_read_b64_tr_b16 v[136:137], v16 offset:0
ds_read_b64_tr_b16 v[138:139], v16 offset:512
ds_read_b64_tr_b16 v[140:141], v17 offset:0
ds_read_b64_tr_b16 v[142:143], v17 offset:512
s_waitcnt lgkmcnt(0)
v_mfma_f32_16x16x32_bf16 v[160:163], v[128:131], v[64:67], v[160:163]
ds_read_b64_tr_b16 v[144:145], v14 offset:4096
ds_read_b64_tr_b16 v[146:147], v14 offset:4608
v_mfma_f32_16x16x32_bf16 v[176:179], v[128:131], v[68:71], v[176:179]
ds_read_b64_tr_b16 v[148:149], v15 offset:4096
ds_read_b64_tr_b16 v[150:151], v15 offset:4608
v_mfma_f32_16x16x32_bf16 v[164:167], v[132:135], v[64:67], v[164:167]
ds_read_b64_tr_b16 v[152:153], v16 offset:4096
ds_read_b64_tr_b16 v[154:155], v16 offset:4608
v_mfma_f32_16x16x32_bf16 v[180:183], v[132:135], v[68:71], v[180:183]
ds_read_b64_tr_b16 v[156:157], v17 offset:4096
ds_read_b64_tr_b16 v[158:159], v17 offset:4608
v_mfma_f32_16x16x32_bf16 v[168:171], v[136:139], v[64:67], v[168:171]
s_add_u32 m0, s33, 24576
buffer_load_dwordx4 v[112:115], v12, s[20:23], s34 offen
v_mfma_f32_16x16x32_bf16 v[184:187], v[136:139], v[68:71], v[184:187]
buffer_load_dwordx4 v10, s[16:19], s41 offen lds
buffer_load_dwordx4 v[116:119], v13, s[20:23], s34 offen
v_mfma_f32_16x16x32_bf16 v[172:175], v[140:143], v[64:67], v[172:175]
buffer_load_dwordx4 v11, s[16:19], s41 offen offset:1024 lds
buffer_load_dwordx4 v[120:123], v12, s[20:23], s34 offen offset:1024
v_mfma_f32_16x16x32_bf16 v[188:191], v[140:143], v[68:71], v[188:191]
buffer_load_dwordx4 v[124:127], v13, s[20:23], s34 offen offset:1024
s_add_u32 s34, s34, 2048
s_add_u32 s41, s41, 131072
s_waitcnt vmcnt(12) lgkmcnt(0)
s_barrier
v_mfma_f32_16x16x32_bf16 v[160:163], v[144:147], v[72:75], v[160:163]
ds_read_b64_tr_b16 v[128:129], v14 offset:8192
v_mfma_f32_16x16x32_bf16 v[176:179], v[144:147], v[76:79], v[176:179]
ds_read_b64_tr_b16 v[130:131], v14 offset:8704
v_mfma_f32_16x16x32_bf16 v[164:167], v[148:151], v[72:75], v[164:167]
ds_read_b64_tr_b16 v[132:133], v15 offset:8192
v_mfma_f32_16x16x32_bf16 v[180:183], v[148:151], v[76:79], v[180:183]
ds_read_b64_tr_b16 v[134:135], v15 offset:8704
v_mfma_f32_16x16x32_bf16 v[168:171], v[152:155], v[72:75], v[168:171]
ds_read_b64_tr_b16 v[136:137], v16 offset:8192
v_mfma_f32_16x16x32_bf16 v[184:187], v[152:155], v[76:79], v[184:187]
ds_read_b64_tr_b16 v[138:139], v16 offset:8704
v_mfma_f32_16x16x32_bf16 v[172:175], v[156:159], v[72:75], v[172:175]
ds_read_b64_tr_b16 v[140:141], v17 offset:8192
v_mfma_f32_16x16x32_bf16 v[188:191], v[156:159], v[76:79], v[188:191]
ds_read_b64_tr_b16 v[142:143], v17 offset:8704
s_waitcnt lgkmcnt(0)
v_mfma_f32_16x16x32_bf16 v[160:163], v[128:131], v[80:83], v[160:163]
ds_read_b64_tr_b16 v[144:145], v14 offset:12288
ds_read_b64_tr_b16 v[146:147], v14 offset:12800
v_mfma_f32_16x16x32_bf16 v[176:179], v[128:131], v[84:87], v[176:179]
ds_read_b64_tr_b16 v[148:149], v15 offset:12288
ds_read_b64_tr_b16 v[150:151], v15 offset:12800
v_mfma_f32_16x16x32_bf16 v[164:167], v[132:135], v[80:83], v[164:167]
ds_read_b64_tr_b16 v[152:153], v16 offset:12288
ds_read_b64_tr_b16 v[154:155], v16 offset:12800
v_mfma_f32_16x16x32_bf16 v[180:183], v[132:135], v[84:87], v[180:183]
ds_read_b64_tr_b16 v[156:157], v17 offset:12288
ds_read_b64_tr_b16 v[158:159], v17 offset:12800
v_mfma_f32_16x16x32_bf16 v[168:171], v[136:139], v[80:83], v[168:171]
s_add_u32 m0, s33, 32768
buffer_load_dwordx4 v[64:67], v12, s[20:23], s34 offen
v_mfma_f32_16x16x32_bf16 v[184:187], v[136:139], v[84:87], v[184:187]
buffer_load_dwordx4 v10, s[16:19], s41 offen lds
buffer_load_dwordx4 v[68:71], v13, s[20:23], s34 offen
v_mfma_f32_16x16x32_bf16 v[172:175], v[140:143], v[80:83], v[172:175]
buffer_load_dwordx4 v11, s[16:19], s41 offen offset:1024 lds
buffer_load_dwordx4 v[72:75], v12, s[20:23], s34 offen offset:1024
v_mfma_f32_16x16x32_bf16 v[188:191], v[140:143], v[84:87], v[188:191]
buffer_load_dwordx4 v[76:79], v13, s[20:23], s34 offen offset:1024
s_add_u32 s34, s34, 2048
s_add_u32 s41, s41, 131072
s_waitcnt vmcnt(12) lgkmcnt(0)
s_barrier
v_mfma_f32_16x16x32_bf16 v[160:163], v[144:147], v[88:91], v[160:163]
ds_read_b64_tr_b16 v[128:129], v14 offset:16384
v_mfma_f32_16x16x32_bf16 v[176:179], v[144:147], v[92:95], v[176:179]
ds_read_b64_tr_b16 v[130:131], v14 offset:16896
v_mfma_f32_16x16x32_bf16 v[164:167], v[148:151], v[88:91], v[164:167]
ds_read_b64_tr_b16 v[132:133], v15 offset:16384
v_mfma_f32_16x16x32_bf16 v[180:183], v[148:151], v[92:95], v[180:183]
ds_read_b64_tr_b16 v[134:135], v15 offset:16896
v_mfma_f32_16x16x32_bf16 v[168:171], v[152:155], v[88:91], v[168:171]
ds_read_b64_tr_b16 v[136:137], v16 offset:16384
v_mfma_f32_16x16x32_bf16 v[184:187], v[152:155], v[92:95], v[184:187]
ds_read_b64_tr_b16 v[138:139], v16 offset:16896
v_mfma_f32_16x16x32_bf16 v[172:175], v[156:159], v[88:91], v[172:175]
ds_read_b64_tr_b16 v[140:141], v17 offset:16384
v_mfma_f32_16x16x32_bf16 v[188:191], v[156:159], v[92:95], v[188:191]
ds_read_b64_tr_b16 v[142:143], v17 offset:16896
s_waitcnt lgkmcnt(0)
v_mfma_f32_16x16x32_bf16 v[160:163], v[128:131], v[96:99], v[160:163]
ds_read_b64_tr_b16 v[144:145], v14 offset:20480
ds_read_b64_tr_b16 v[146:147], v14 offset:20992
v_mfma_f32_16x16x32_bf16 v[176:179], v[128:131], v[100:103], v[176:179]
ds_read_b64_tr_b16 v[148:149], v15 offset:20480
ds_read_b64_tr_b16 v[150:151], v15 offset:20992
v_mfma_f32_16x16x32_bf16 v[164:167], v[132:135], v[96:99], v[164:167]
ds_read_b64_tr_b16 v[152:153], v16 offset:20480
ds_read_b64_tr_b16 v[154:155], v16 offset:20992
v_mfma_f32_16x16x32_bf16 v[180:183], v[132:135], v[100:103], v[180:183]
ds_read_b64_tr_b16 v[156:157], v17 offset:20480
ds_read_b64_tr_b16 v[158:159], v17 offset:20992
v_mfma_f32_16x16x32_bf16 v[168:171], v[136:139], v[96:99], v[168:171]
s_add_u32 m0, s33, 40960
buffer_load_dwordx4 v[80:83], v12, s[20:23], s34 offen
v_mfma_f32_16x16x32_bf16 v[184:187], v[136:139], v[100:103], v[184:187]
buffer_load_dwordx4 v10, s[16:19], s41 offen lds
buffer_load_dwordx4 v[84:87], v13, s[20:23], s34 offen
v_mfma_f32_16x16x32_bf16 v[172:175], v[140:143], v[96:99], v[172:175]
buffer_load_dwordx4 v11, s[16:19], s41 offen offset:1024 lds
buffer_load_dwordx4 v[88:91], v12, s[20:23], s34 offen offset:1024
v_mfma_f32_16x16x32_bf16 v[188:191], v[140:143], v[100:103], v[188:191]
buffer_load_dwordx4 v[92:95], v13, s[20:23], s34 offen offset:1024
s_add_u32 s34, s34, 2048
s_add_u32 s41, s41, 131072
s_waitcnt vmcnt(12) lgkmcnt(0)
s_barrier
v_mfma_f32_16x16x32_bf16 v[160:163], v[144:147], v[104:107], v[160:163]
ds_read_b64_tr_b16 v[128:129], v14 offset:24576
v_mfma_f32_16x16x32_bf16 v[176:179], v[144:147], v[108:111], v[176:179]
ds_read_b64_tr_b16 v[130:131], v14 offset:25088
v_mfma_f32_16x16x32_bf16 v[164:167], v[148:151], v[104:107], v[164:167]
ds_read_b64_tr_b16 v[132:133], v15 offset:24576
v_mfma_f32_16x16x32_bf16 v[180:183], v[148:151], v[108:111], v[180:183]
ds_read_b64_tr_b16 v[134:135], v15 offset:25088
v_mfma_f32_16x16x32_bf16 v[168:171], v[152:155], v[104:107], v[168:171]
ds_read_b64_tr_b16 v[136:137], v16 offset:24576
v_mfma_f32_16x16x32_bf16 v[184:187], v[152:155], v[108:111], v[184:187]
ds_read_b64_tr_b16 v[138:139], v16 offset:25088
v_mfma_f32_16x16x32_bf16 v[172:175], v[156:159], v[104:107], v[172:175]
ds_read_b64_tr_b16 v[140:141], v17 offset:24576
v_mfma_f32_16x16x32_bf16 v[188:191], v[156:159], v[108:111], v[188:191]
ds_read_b64_tr_b16 v[142:143], v17 offset:25088
s_waitcnt lgkmcnt(0)
v_mfma_f32_16x16x32_bf16 v[160:163], v[128:131], v[112:115], v[160:163]
ds_read_b64_tr_b16 v[144:145], v14 offset:28672
ds_read_b64_tr_b16 v[146:147], v14 offset:29184
v_mfma_f32_16x16x32_bf16 v[176:179], v[128:131], v[116:119], v[176:179]
ds_read_b64_tr_b16 v[148:149], v15 offset:28672
ds_read_b64_tr_b16 v[150:151], v15 offset:29184
v_mfma_f32_16x16x32_bf16 v[164:167], v[132:135], v[112:115], v[164:167]
ds_read_b64_tr_b16 v[152:153], v16 offset:28672
ds_read_b64_tr_b16 v[154:155], v16 offset:29184
v_mfma_f32_16x16x32_bf16 v[180:183], v[132:135], v[116:119], v[180:183]
ds_read_b64_tr_b16 v[156:157], v17 offset:28672
ds_read_b64_tr_b16 v[158:159], v17 offset:29184
v_mfma_f32_16x16x32_bf16 v[168:171], v[136:139], v[112:115], v[168:171]
s_add_u32 m0, s33, 49152
buffer_load_dwordx4 v[96:99], v12, s[20:23], s34 offen
v_mfma_f32_16x16x32_bf16 v[184:187], v[136:139], v[116:119], v[184:187]
buffer_load_dwordx4 v10, s[16:19], s41 offen lds
buffer_load_dwordx4 v[100:103], v13, s[20:23], s34 offen
v_mfma_f32_16x16x32_bf16 v[172:175], v[140:143], v[112:115], v[172:175]
buffer_load_dwordx4 v11, s[16:19], s41 offen offset:1024 lds
buffer_load_dwordx4 v[104:107], v12, s[20:23], s34 offen offset:1024
v_mfma_f32_16x16x32_bf16 v[188:191], v[140:143], v[116:119], v[188:191]
buffer_load_dwordx4 v[108:111], v13, s[20:23], s34 offen offset:1024
s_add_u32 s34, s34, 2048
s_add_u32 s41, s41, 131072
s_waitcnt vmcnt(12) lgkmcnt(0)
s_barrier
v_mfma_f32_16x16x32_bf16 v[160:163], v[144:147], v[120:123], v[160:163]
ds_read_b64_tr_b16 v[128:129], v14 offset:32768
v_mfma_f32_16x16x32_bf16 v[176:179], v[144:147], v[124:127], v[176:179]
ds_read_b64_tr_b16 v[130:131], v14 offset:33280
v_mfma_f32_16x16x32_bf16 v[164:167], v[148:151], v[120:123], v[164:167]
ds_read_b64_tr_b16 v[132:133], v15 offset:32768
v_mfma_f32_16x16x32_bf16 v[180:183], v[148:151], v[124:127], v[180:183]
ds_read_b64_tr_b16 v[134:135], v15 offset:33280
v_mfma_f32_16x16x32_bf16 v[168:171], v[152:155], v[120:123], v[168:171]
ds_read_b64_tr_b16 v[136:137], v16 offset:32768
v_mfma_f32_16x16x32_bf16 v[184:187], v[152:155], v[124:127], v[184:187]
ds_read_b64_tr_b16 v[138:139], v16 offset:33280
v_mfma_f32_16x16x32_bf16 v[172:175], v[156:159], v[120:123], v[172:175]
ds_read_b64_tr_b16 v[140:141], v17 offset:32768
v_mfma_f32_16x16x32_bf16 v[188:191], v[156:159], v[124:127], v[188:191]
ds_read_b64_tr_b16 v[142:143], v17 offset:33280
s_waitcnt lgkmcnt(0)
v_mfma_f32_16x16x32_bf16 v[160:163], v[128:131], v[64:67], v[160:163]
ds_read_b64_tr_b16 v[144:145], v14 offset:36864
ds_read_b64_tr_b16 v[146:147], v14 offset:37376
v_mfma_f32_16x16x32_bf16 v[176:179], v[128:131], v[68:71], v[176:179]
ds_read_b64_tr_b16 v[148:149], v15 offset:36864
ds_read_b64_tr_b16 v[150:151], v15 offset:37376
v_mfma_f32_16x16x32_bf16 v[164:167], v[132:135], v[64:67], v[164:167]
ds_read_b64_tr_b16 v[152:153], v16 offset:36864
ds_read_b64_tr_b16 v[154:155], v16 offset:37376
v_mfma_f32_16x16x32_bf16 v[180:183], v[132:135], v[68:71], v[180:183]
ds_read_b64_tr_b16 v[156:157], v17 offset:36864
ds_read_b64_tr_b16 v[158:159], v17 offset:37376
v_mfma_f32_16x16x32_bf16 v[168:171], v[136:139], v[64:67], v[168:171]
s_add_u32 m0, s33, 57344
buffer_load_dwordx4 v[112:115], v12, s[20:23], s34 offen
v_mfma_f32_16x16x32_bf16 v[184:187], v[136:139], v[68:71], v[184:187]
buffer_load_dwordx4 v10, s[16:19], s41 offen lds
buffer_load_dwordx4 v[116:119], v13, s[20:23], s34 offen
v_mfma_f32_16x16x32_bf16 v[172:175], v[140:143], v[64:67], v[172:175]
buffer_load_dwordx4 v11, s[16:19], s41 offen offset:1024 lds
buffer_load_dwordx4 v[120:123], v12, s[20:23], s34 offen offset:1024
v_mfma_f32_16x16x32_bf16 v[188:191], v[140:143], v[68:71], v[188:191]
buffer_load_dwordx4 v[124:127], v13, s[20:23], s34 offen offset:1024
s_add_u32 s34, s34, 2048
s_add_u32 s41, s41, 131072
s_waitcnt vmcnt(12) lgkmcnt(0)
s_barrier
v_mfma_f32_16x16x32_bf16 v[160:163], v[144:147], v[72:75], v[160:163]
ds_read_b64_tr_b16 v[128:129], v14 offset:40960
v_mfma_f32_16x16x32_bf16 v[176:179], v[144:147], v[76:79], v[176:179]
ds_read_b64_tr_b16 v[130:131], v14 offset:41472
v_mfma_f32_16x16x32_bf16 v[164:167], v[148:151], v[72:75], v[164:167]
ds_read_b64_tr_b16 v[132:133], v15 offset:40960
v_mfma_f32_16x16x32_bf16 v[180:183], v[148:151], v[76:79], v[180:183]
ds_read_b64_tr_b16 v[134:135], v15 offset:41472
v_mfma_f32_16x16x32_bf16 v[168:171], v[152:155], v[72:75], v[168:171]
ds_read_b64_tr_b16 v[136:137], v16 offset:40960
v_mfma_f32_16x16x32_bf16 v[184:187], v[152:155], v[76:79], v[184:187]
ds_read_b64_tr_b16 v[138:139], v16 offset:41472
v_mfma_f32_16x16x32_bf16 v[172:175], v[156:159], v[72:75], v[172:175]
ds_read_b64_tr_b16 v[140:141], v17 offset:40960
v_mfma_f32_16x16x32_bf16 v[188:191], v[156:159], v[76:79], v[188:191]
ds_read_b64_tr_b16 v[142:143], v17 offset:41472
s_waitcnt lgkmcnt(0)
v_mfma_f32_16x16x32_bf16 v[160:163], v[128:131], v[80:83], v[160:163]
ds_read_b64_tr_b16 v[144:145], v14 offset:45056
ds_read_b64_tr_b16 v[146:147], v14 offset:45568
v_mfma_f32_16x16x32_bf16 v[176:179], v[128:131], v[84:87], v[176:179]
ds_read_b64_tr_b16 v[148:149], v15 offset:45056
ds_read_b64_tr_b16 v[150:151], v15 offset:45568
v_mfma_f32_16x16x32_bf16 v[164:167], v[132:135], v[80:83], v[164:167]
ds_read_b64_tr_b16 v[152:153], v16 offset:45056
ds_read_b64_tr_b16 v[154:155], v16 offset:45568
v_mfma_f32_16x16x32_bf16 v[180:183], v[132:135], v[84:87], v[180:183]
ds_read_b64_tr_b16 v[156:157], v17 offset:45056
ds_read_b64_tr_b16 v[158:159], v17 offset:45568
v_mfma_f32_16x16x32_bf16 v[168:171], v[136:139], v[80:83], v[168:171]
s_add_u32 m0, s33, 65536
buffer_load_dwordx4 v[64:67], v12, s[20:23], s34 offen
v_mfma_f32_16x16x32_bf16 v[184:187], v[136:139], v[84:87], v[184:187]
buffer_load_dwordx4 v10, s[16:19], s41 offen lds
buffer_load_dwordx4 v[68:71], v13, s[20:23], s34 offen
v_mfma_f32_16x16x32_bf16 v[172:175], v[140:143], v[80:83], v[172:175]
buffer_load_dwordx4 v11, s[16:19], s41 offen offset:1024 lds
buffer_load_dwordx4 v[72:75], v12, s[20:23], s34 offen offset:1024
v_mfma_f32_16x16x32_bf16 v[188:191], v[140:143], v[84:87], v[188:191]
buffer_load_dwordx4 v[76:79], v13, s[20:23], s34 offen offset:1024
s_add_u32 s34, s34, 2048
s_add_u32 s41, s41, 131072
s_waitcnt vmcnt(12) lgkmcnt(0)
s_barrier
v_mfma_f32_16x16x32_bf16 v[160:163], v[144:147], v[88:91], v[160:163]
ds_read_b64_tr_b16 v[128:129], v14 offset:49152
v_mfma_f32_16x16x32_bf16 v[176:179], v[144:147], v[92:95], v[176:179]
ds_read_b64_tr_b16 v[130:131], v14 offset:49664
v_mfma_f32_16x16x32_bf16 v[164:167], v[148:151], v[88:91], v[164:167]
ds_read_b64_tr_b16 v[132:133], v15 offset:49152
v_mfma_f32_16x16x32_bf16 v[180:183], v[148:151], v[92:95], v[180:183]
ds_read_b64_tr_b16 v[134:135], v15 offset:49664
v_mfma_f32_16x16x32_bf16 v[168:171], v[152:155], v[88:91], v[168:171]
ds_read_b64_tr_b16 v[136:137], v16 offset:49152
v_mfma_f32_16x16x32_bf16 v[184:187], v[152:155], v[92:95], v[184:187]
ds_read_b64_tr_b16 v[138:139], v16 offset:49664
v_mfma_f32_16x16x32_bf16 v[172:175], v[156:159], v[88:91], v[172:175]
ds_read_b64_tr_b16 v[140:141], v17 offset:49152
v_mfma_f32_16x16x32_bf16 v[188:191], v[156:159], v[92:95], v[188:191]
ds_read_b64_tr_b16 v[142:143], v17 offset:49664
s_waitcnt lgkmcnt(0)
v_mfma_f32_16x16x32_bf16 v[160:163], v[128:131], v[96:99], v[160:163]
ds_read_b64_tr_b16 v[144:145], v14 offset:53248
ds_read_b64_tr_b16 v[146:147], v14 offset:53760
v_mfma_f32_16x16x32_bf16 v[176:179], v[128:131], v[100:103], v[176:179]
ds_read_b64_tr_b16 v[148:149], v15 offset:53248
ds_read_b64_tr_b16 v[150:151], v15 offset:53760
v_mfma_f32_16x16x32_bf16 v[164:167], v[132:135], v[96:99], v[164:167]
ds_read_b64_tr_b16 v[152:153], v16 offset:53248
ds_read_b64_tr_b16 v[154:155], v16 offset:53760
v_mfma_f32_16x16x32_bf16 v[180:183], v[132:135], v[100:103], v[180:183]
ds_read_b64_tr_b16 v[156:157], v17 offset:53248
ds_read_b64_tr_b16 v[158:159], v17 offset:53760
v_mfma_f32_16x16x32_bf16 v[168:171], v[136:139], v[96:99], v[168:171]
s_add_u32 m0, s33, 73728
buffer_load_dwordx4 v[80:83], v12, s[20:23], s34 offen
v_mfma_f32_16x16x32_bf16 v[184:187], v[136:139], v[100:103], v[184:187]
buffer_load_dwordx4 v10, s[16:19], s41 offen lds
buffer_load_dwordx4 v[84:87], v13, s[20:23], s34 offen
v_mfma_f32_16x16x32_bf16 v[172:175], v[140:143], v[96:99], v[172:175]
buffer_load_dwordx4 v11, s[16:19], s41 offen offset:1024 lds
buffer_load_dwordx4 v[88:91], v12, s[20:23], s34 offen offset:1024
v_mfma_f32_16x16x32_bf16 v[188:191], v[140:143], v[100:103], v[188:191]
buffer_load_dwordx4 v[92:95], v13, s[20:23], s34 offen offset:1024
s_add_u32 s34, s34, 2048
s_add_u32 s41, s41, 131072
s_waitcnt vmcnt(12) lgkmcnt(0)
s_barrier
v_mfma_f32_16x16x32_bf16 v[160:163], v[144:147], v[104:107], v[160:163]
ds_read_b64_tr_b16 v[128:129], v14 offset:57344
v_mfma_f32_16x16x32_bf16 v[176:179], v[144:147], v[108:111], v[176:179]
ds_read_b64_tr_b16 v[130:131], v14 offset:57856
v_mfma_f32_16x16x32_bf16 v[164:167], v[148:151], v[104:107], v[164:167]
ds_read_b64_tr_b16 v[132:133], v15 offset:57344
v_mfma_f32_16x16x32_bf16 v[180:183], v[148:151], v[108:111], v[180:183]
ds_read_b64_tr_b16 v[134:135], v15 offset:57856
v_mfma_f32_16x16x32_bf16 v[168:171], v[152:155], v[104:107], v[168:171]
ds_read_b64_tr_b16 v[136:137], v16 offset:57344
v_mfma_f32_16x16x32_bf16 v[184:187], v[152:155], v[108:111], v[184:187]
ds_read_b64_tr_b16 v[138:139], v16 offset:57856
v_mfma_f32_16x16x32_bf16 v[172:175], v[156:159], v[104:107], v[172:175]
ds_read_b64_tr_b16 v[140:141], v17 offset:57344
v_mfma_f32_16x16x32_bf16 v[188:191], v[156:159], v[108:111], v[188:191]
ds_read_b64_tr_b16 v[142:143], v17 offset:57856
s_waitcnt lgkmcnt(0)
v_mfma_f32_16x16x32_bf16 v[160:163], v[128:131], v[112:115], v[160:163]
ds_read_b64_tr_b16 v[144:145], v14 offset:61440
ds_read_b64_tr_b16 v[146:147], v14 offset:61952
v_mfma_f32_16x16x32_bf16 v[176:179], v[128:131], v[116:119], v[176:179]
ds_read_b64_tr_b16 v[148:149], v15 offset:61440
ds_read_b64_tr_b16 v[150:151], v15 offset:61952
v_mfma_f32_16x16x32_bf16 v[164:167], v[132:135], v[112:115], v[164:167]
ds_read_b64_tr_b16 v[152:153], v16 offset:61440
ds_read_b64_tr_b16 v[154:155], v16 offset:61952
v_mfma_f32_16x16x32_bf16 v[180:183], v[132:135], v[116:119], v[180:183]
ds_read_b64_tr_b16 v[156:157], v17 offset:61440
ds_read_b64_tr_b16 v[158:159], v17 offset:61952
v_mfma_f32_16x16x32_bf16 v[168:171], v[136:139], v[112:115], v[168:171]
s_add_u32 m0, s33, 81920
buffer_load_dwordx4 v[96:99], v12, s[20:23], s34 offen
v_mfma_f32_16x16x32_bf16 v[184:187], v[136:139], v[116:119], v[184:187]
buffer_load_dwordx4 v10, s[16:19], s41 offen lds
buffer_load_dwordx4 v[100:103], v13, s[20:23], s34 offen
v_mfma_f32_16x16x32_bf16 v[172:175], v[140:143], v[112:115], v[172:175]
buffer_load_dwordx4 v11, s[16:19], s41 offen offset:1024 lds
buffer_load_dwordx4 v[104:107], v12, s[20:23], s34 offen offset:1024
v_mfma_f32_16x16x32_bf16 v[188:191], v[140:143], v[116:119], v[188:191]
buffer_load_dwordx4 v[108:111], v13, s[20:23], s34 offen offset:1024
s_add_u32 s34, s34, 2048
s_add_u32 s41, s41, 131072
s_waitcnt vmcnt(12) lgkmcnt(0)
s_barrier
v_add_u32 v14, 0x10000, v14
v_add_u32 v15, 0x10000, v15
v_add_u32 v16, 0x10000, v16
v_add_u32 v17, 0x10000, v17
v_mfma_f32_16x16x32_bf16 v[160:163], v[144:147], v[120:123], v[160:163]
ds_read_b64_tr_b16 v[128:129], v14 offset:0
v_mfma_f32_16x16x32_bf16 v[176:179], v[144:147], v[124:127], v[176:179]
ds_read_b64_tr_b16 v[130:131], v14 offset:512
v_mfma_f32_16x16x32_bf16 v[164:167], v[148:151], v[120:123], v[164:167]
ds_read_b64_tr_b16 v[132:133], v15 offset:0
v_mfma_f32_16x16x32_bf16 v[180:183], v[148:151], v[124:127], v[180:183]
ds_read_b64_tr_b16 v[134:135], v15 offset:512
v_mfma_f32_16x16x32_bf16 v[168:171], v[152:155], v[120:123], v[168:171]
ds_read_b64_tr_b16 v[136:137], v16 offset:0
v_mfma_f32_16x16x32_bf16 v[184:187], v[152:155], v[124:127], v[184:187]
ds_read_b64_tr_b16 v[138:139], v16 offset:512
v_mfma_f32_16x16x32_bf16 v[172:175], v[156:159], v[120:123], v[172:175]
ds_read_b64_tr_b16 v[140:141], v17 offset:0
v_mfma_f32_16x16x32_bf16 v[188:191], v[156:159], v[124:127], v[188:191]
ds_read_b64_tr_b16 v[142:143], v17 offset:512
s_waitcnt lgkmcnt(0)
v_mfma_f32_16x16x32_bf16 v[160:163], v[128:131], v[64:67], v[160:163]
ds_read_b64_tr_b16 v[144:145], v14 offset:4096
ds_read_b64_tr_b16 v[146:147], v14 offset:4608
v_mfma_f32_16x16x32_bf16 v[176:179], v[128:131], v[68:71], v[176:179]
ds_read_b64_tr_b16 v[148:149], v15 offset:4096
ds_read_b64_tr_b16 v[150:151], v15 offset:4608
v_mfma_f32_16x16x32_bf16 v[164:167], v[132:135], v[64:67], v[164:167]
ds_read_b64_tr_b16 v[152:153], v16 offset:4096
ds_read_b64_tr_b16 v[154:155], v16 offset:4608
v_mfma_f32_16x16x32_bf16 v[180:183], v[132:135], v[68:71], v[180:183]
ds_read_b64_tr_b16 v[156:157], v17 offset:4096
ds_read_b64_tr_b16 v[158:159], v17 offset:4608
v_mfma_f32_16x16x32_bf16 v[168:171], v[136:139], v[64:67], v[168:171]
s_add_u32 m0, s33, 90112
buffer_load_dwordx4 v[112:115], v12, s[20:23], s34 offen
v_mfma_f32_16x16x32_bf16 v[184:187], v[136:139], v[68:71], v[184:187]
buffer_load_dwordx4 v10, s[16:19], s41 offen lds
buffer_load_dwordx4 v[116:119], v13, s[20:23], s34 offen
v_mfma_f32_16x16x32_bf16 v[172:175], v[140:143], v[64:67], v[172:175]
buffer_load_dwordx4 v11, s[16:19], s41 offen offset:1024 lds
buffer_load_dwordx4 v[120:123], v12, s[20:23], s34 offen offset:1024
v_mfma_f32_16x16x32_bf16 v[188:191], v[140:143], v[68:71], v[188:191]
buffer_load_dwordx4 v[124:127], v13, s[20:23], s34 offen offset:1024
s_add_u32 s34, s34, 2048
s_add_u32 s41, s41, 131072
s_waitcnt vmcnt(12) lgkmcnt(0)
s_barrier
v_mfma_f32_16x16x32_bf16 v[160:163], v[144:147], v[72:75], v[160:163]
ds_read_b64_tr_b16 v[128:129], v14 offset:8192
v_mfma_f32_16x16x32_bf16 v[176:179], v[144:147], v[76:79], v[176:179]
ds_read_b64_tr_b16 v[130:131], v14 offset:8704
v_mfma_f32_16x16x32_bf16 v[164:167], v[148:151], v[72:75], v[164:167]
ds_read_b64_tr_b16 v[132:133], v15 offset:8192
v_mfma_f32_16x16x32_bf16 v[180:183], v[148:151], v[76:79], v[180:183]
ds_read_b64_tr_b16 v[134:135], v15 offset:8704
v_mfma_f32_16x16x32_bf16 v[168:171], v[152:155], v[72:75], v[168:171]
ds_read_b64_tr_b16 v[136:137], v16 offset:8192
v_mfma_f32_16x16x32_bf16 v[184:187], v[152:155], v[76:79], v[184:187]
ds_read_b64_tr_b16 v[138:139], v16 offset:8704
v_mfma_f32_16x16x32_bf16 v[172:175], v[156:159], v[72:75], v[172:175]
ds_read_b64_tr_b16 v[140:141], v17 offset:8192
v_mfma_f32_16x16x32_bf16 v[188:191], v[156:159], v[76:79], v[188:191]
ds_read_b64_tr_b16 v[142:143], v17 offset:8704
s_waitcnt lgkmcnt(0)
v_mfma_f32_16x16x32_bf16 v[160:163], v[128:131], v[80:83], v[160:163]
ds_read_b64_tr_b16 v[144:145], v14 offset:12288
ds_read_b64_tr_b16 v[146:147], v14 offset:12800
v_mfma_f32_16x16x32_bf16 v[176:179], v[128:131], v[84:87], v[176:179]
ds_read_b64_tr_b16 v[148:149], v15 offset:12288
ds_read_b64_tr_b16 v[150:151], v15 offset:12800
v_mfma_f32_16x16x32_bf16 v[164:167], v[132:135], v[80:83], v[164:167]
ds_read_b64_tr_b16 v[152:153], v16 offset:12288
ds_read_b64_tr_b16 v[154:155], v16 offset:12800
v_mfma_f32_16x16x32_bf16 v[180:183], v[132:135], v[84:87], v[180:183]
ds_read_b64_tr_b16 v[156:157], v17 offset:12288
ds_read_b64_tr_b16 v[158:159], v17 offset:12800
v_mfma_f32_16x16x32_bf16 v[168:171], v[136:139], v[80:83], v[168:171]
s_add_u32 m0, s33, 98304
buffer_load_dwordx4 v[64:67], v12, s[20:23], s34 offen
v_mfma_f32_16x16x32_bf16 v[184:187], v[136:139], v[84:87], v[184:187]
buffer_load_dwordx4 v10, s[16:19], s41 offen lds
buffer_load_dwordx4 v[68:71], v13, s[20:23], s34 offen
v_mfma_f32_16x16x32_bf16 v[172:175], v[140:143], v[80:83], v[172:175]
buffer_load_dwordx4 v11, s[16:19], s41 offen offset:1024 lds
buffer_load_dwordx4 v[72:75], v12, s[20:23], s34 offen offset:1024
v_mfma_f32_16x16x32_bf16 v[188:191], v[140:143], v[84:87], v[188:191]
buffer_load_dwordx4 v[76:79], v13, s[20:23], s34 offen offset:1024
s_add_u32 s34, s34, 2048
s_add_u32 s41, s41, 131072
s_waitcnt vmcnt(12) lgkmcnt(0)
s_barrier
v_mfma_f32_16x16x32_bf16 v[160:163], v[144:147], v[88:91], v[160:163]
ds_read_b64_tr_b16 v[128:129], v14 offset:16384
v_mfma_f32_16x16x32_bf16 v[176:179], v[144:147], v[92:95], v[176:179]
ds_read_b64_tr_b16 v[130:131], v14 offset:16896
v_mfma_f32_16x16x32_bf16 v[164:167], v[148:151], v[88:91], v[164:167]
ds_read_b64_tr_b16 v[132:133], v15 offset:16384
v_mfma_f32_16x16x32_bf16 v[180:183], v[148:151], v[92:95], v[180:183]
ds_read_b64_tr_b16 v[134:135], v15 offset:16896
v_mfma_f32_16x16x32_bf16 v[168:171], v[152:155], v[88:91], v[168:171]
ds_read_b64_tr_b16 v[136:137], v16 offset:16384
v_mfma_f32_16x16x32_bf16 v[184:187], v[152:155], v[92:95], v[184:187]
ds_read_b64_tr_b16 v[138:139], v16 offset:16896
v_mfma_f32_16x16x32_bf16 v[172:175], v[156:159], v[88:91], v[172:175]
ds_read_b64_tr_b16 v[140:141], v17 offset:16384
v_mfma_f32_16x16x32_bf16 v[188:191], v[156:159], v[92:95], v[188:191]
ds_read_b64_tr_b16 v[142:143], v17 offset:16896
s_waitcnt lgkmcnt(0)
v_mfma_f32_16x16x32_bf16 v[160:163], v[128:131], v[96:99], v[160:163]
ds_read_b64_tr_b16 v[144:145], v14 offset:20480
ds_read_b64_tr_b16 v[146:147], v14 offset:20992
v_mfma_f32_16x16x32_bf16 v[176:179], v[128:131], v[100:103], v[176:179]
ds_read_b64_tr_b16 v[148:149], v15 offset:20480
ds_read_b64_tr_b16 v[150:151], v15 offset:20992
v_mfma_f32_16x16x32_bf16 v[164:167], v[132:135], v[96:99], v[164:167]
ds_read_b64_tr_b16 v[152:153], v16 offset:20480
ds_read_b64_tr_b16 v[154:155], v16 offset:20992
v_mfma_f32_16x16x32_bf16 v[180:183], v[132:135], v[100:103], v[180:183]
ds_read_b64_tr_b16 v[156:157], v17 offset:20480
ds_read_b64_tr_b16 v[158:159], v17 offset:20992
v_mfma_f32_16x16x32_bf16 v[168:171], v[136:139], v[96:99], v[168:171]
s_add_u32 m0, s33, 106496
buffer_load_dwordx4 v[80:83], v12, s[20:23], s34 offen
v_mfma_f32_16x16x32_bf16 v[184:187], v[136:139], v[100:103], v[184:187]
buffer_load_dwordx4 v10, s[16:19], s41 offen lds
buffer_load_dwordx4 v[84:87], v13, s[20:23], s34 offen
v_mfma_f32_16x16x32_bf16 v[172:175], v[140:143], v[96:99], v[172:175]
buffer_load_dwordx4 v11, s[16:19], s41 offen offset:1024 lds
buffer_load_dwordx4 v[88:91], v12, s[20:23], s34 offen offset:1024
v_mfma_f32_16x16x32_bf16 v[188:191], v[140:143], v[100:103], v[188:191]
buffer_load_dwordx4 v[92:95], v13, s[20:23], s34 offen offset:1024
s_add_u32 s34, s34, 2048
s_add_u32 s41, s41, 131072
s_waitcnt vmcnt(12) lgkmcnt(0)
s_barrier
v_mfma_f32_16x16x32_bf16 v[160:163], v[144:147], v[104:107], v[160:163]
ds_read_b64_tr_b16 v[128:129], v14 offset:24576
v_mfma_f32_16x16x32_bf16 v[176:179], v[144:147], v[108:111], v[176:179]
ds_read_b64_tr_b16 v[130:131], v14 offset:25088
v_mfma_f32_16x16x32_bf16 v[164:167], v[148:151], v[104:107], v[164:167]
ds_read_b64_tr_b16 v[132:133], v15 offset:24576
v_mfma_f32_16x16x32_bf16 v[180:183], v[148:151], v[108:111], v[180:183]
ds_read_b64_tr_b16 v[134:135], v15 offset:25088
v_mfma_f32_16x16x32_bf16 v[168:171], v[152:155], v[104:107], v[168:171]
ds_read_b64_tr_b16 v[136:137], v16 offset:24576
v_mfma_f32_16x16x32_bf16 v[184:187], v[152:155], v[108:111], v[184:187]
ds_read_b64_tr_b16 v[138:139], v16 offset:25088
v_mfma_f32_16x16x32_bf16 v[172:175], v[156:159], v[104:107], v[172:175]
ds_read_b64_tr_b16 v[140:141], v17 offset:24576
v_mfma_f32_16x16x32_bf16 v[188:191], v[156:159], v[108:111], v[188:191]
ds_read_b64_tr_b16 v[142:143], v17 offset:25088
s_waitcnt lgkmcnt(0)
v_mfma_f32_16x16x32_bf16 v[160:163], v[128:131], v[112:115], v[160:163]
ds_read_b64_tr_b16 v[144:145], v14 offset:28672
ds_read_b64_tr_b16 v[146:147], v14 offset:29184
v_mfma_f32_16x16x32_bf16 v[176:179], v[128:131], v[116:119], v[176:179]
ds_read_b64_tr_b16 v[148:149], v15 offset:28672
ds_read_b64_tr_b16 v[150:151], v15 offset:29184
v_mfma_f32_16x16x32_bf16 v[164:167], v[132:135], v[112:115], v[164:167]
ds_read_b64_tr_b16 v[152:153], v16 offset:28672
ds_read_b64_tr_b16 v[154:155], v16 offset:29184
v_mfma_f32_16x16x32_bf16 v[180:183], v[132:135], v[116:119], v[180:183]
ds_read_b64_tr_b16 v[156:157], v17 offset:28672
ds_read_b64_tr_b16 v[158:159], v17 offset:29184
v_mfma_f32_16x16x32_bf16 v[168:171], v[136:139], v[112:115], v[168:171]
s_add_u32 m0, s33, 114688
buffer_load_dwordx4 v[96:99], v12, s[20:23], s34 offen
v_mfma_f32_16x16x32_bf16 v[184:187], v[136:139], v[116:119], v[184:187]
buffer_load_dwordx4 v10, s[16:19], s41 offen lds
buffer_load_dwordx4 v[100:103], v13, s[20:23], s34 offen
v_mfma_f32_16x16x32_bf16 v[172:175], v[140:143], v[112:115], v[172:175]
buffer_load_dwordx4 v11, s[16:19], s41 offen offset:1024 lds
buffer_load_dwordx4 v[104:107], v12, s[20:23], s34 offen offset:1024
v_mfma_f32_16x16x32_bf16 v[188:191], v[140:143], v[116:119], v[188:191]
buffer_load_dwordx4 v[108:111], v13, s[20:23], s34 offen offset:1024
s_add_u32 s34, s34, 2048
s_add_u32 s41, s41, 131072
s_waitcnt vmcnt(12) lgkmcnt(0)
s_barrier
v_mfma_f32_16x16x32_bf16 v[160:163], v[144:147], v[120:123], v[160:163]
ds_read_b64_tr_b16 v[128:129], v14 offset:32768
v_mfma_f32_16x16x32_bf16 v[176:179], v[144:147], v[124:127], v[176:179]
ds_read_b64_tr_b16 v[130:131], v14 offset:33280
v_mfma_f32_16x16x32_bf16 v[164:167], v[148:151], v[120:123], v[164:167]
ds_read_b64_tr_b16 v[132:133], v15 offset:32768
v_mfma_f32_16x16x32_bf16 v[180:183], v[148:151], v[124:127], v[180:183]
ds_read_b64_tr_b16 v[134:135], v15 offset:33280
v_mfma_f32_16x16x32_bf16 v[168:171], v[152:155], v[120:123], v[168:171]
ds_read_b64_tr_b16 v[136:137], v16 offset:32768
v_mfma_f32_16x16x32_bf16 v[184:187], v[152:155], v[124:127], v[184:187]
ds_read_b64_tr_b16 v[138:139], v16 offset:33280
v_mfma_f32_16x16x32_bf16 v[172:175], v[156:159], v[120:123], v[172:175]
ds_read_b64_tr_b16 v[140:141], v17 offset:32768
v_mfma_f32_16x16x32_bf16 v[188:191], v[156:159], v[124:127], v[188:191]
ds_read_b64_tr_b16 v[142:143], v17 offset:33280
s_waitcnt lgkmcnt(0)
v_mfma_f32_16x16x32_bf16 v[160:163], v[128:131], v[64:67], v[160:163]
ds_read_b64_tr_b16 v[144:145], v14 offset:36864
ds_read_b64_tr_b16 v[146:147], v14 offset:37376
v_mfma_f32_16x16x32_bf16 v[176:179], v[128:131], v[68:71], v[176:179]
ds_read_b64_tr_b16 v[148:149], v15 offset:36864
ds_read_b64_tr_b16 v[150:151], v15 offset:37376
v_mfma_f32_16x16x32_bf16 v[164:167], v[132:135], v[64:67], v[164:167]
ds_read_b64_tr_b16 v[152:153], v16 offset:36864
ds_read_b64_tr_b16 v[154:155], v16 offset:37376
v_mfma_f32_16x16x32_bf16 v[180:183], v[132:135], v[68:71], v[180:183]
ds_read_b64_tr_b16 v[156:157], v17 offset:36864
ds_read_b64_tr_b16 v[158:159], v17 offset:37376
v_mfma_f32_16x16x32_bf16 v[168:171], v[136:139], v[64:67], v[168:171]
s_add_u32 m0, s33, 122880
buffer_load_dwordx4 v[112:115], v12, s[20:23], s34 offen
v_mfma_f32_16x16x32_bf16 v[184:187], v[136:139], v[68:71], v[184:187]
buffer_load_dwordx4 v10, s[16:19], s41 offen lds
buffer_load_dwordx4 v[116:119], v13, s[20:23], s34 offen
v_mfma_f32_16x16x32_bf16 v[172:175], v[140:143], v[64:67], v[172:175]
buffer_load_dwordx4 v11, s[16:19], s41 offen offset:1024 lds
buffer_load_dwordx4 v[120:123], v12, s[20:23], s34 offen offset:1024
v_mfma_f32_16x16x32_bf16 v[188:191], v[140:143], v[68:71], v[188:191]
buffer_load_dwordx4 v[124:127], v13, s[20:23], s34 offen offset:1024
s_add_u32 s34, s34, 2048
s_add_u32 s41, s41, 131072
s_waitcnt vmcnt(12) lgkmcnt(0)
s_barrier
v_mfma_f32_16x16x32_bf16 v[160:163], v[144:147], v[72:75], v[160:163]
ds_read_b64_tr_b16 v[128:129], v14 offset:40960
v_mfma_f32_16x16x32_bf16 v[176:179], v[144:147], v[76:79], v[176:179]
ds_read_b64_tr_b16 v[130:131], v14 offset:41472
v_mfma_f32_16x16x32_bf16 v[164:167], v[148:151], v[72:75], v[164:167]
ds_read_b64_tr_b16 v[132:133], v15 offset:40960
v_mfma_f32_16x16x32_bf16 v[180:183], v[148:151], v[76:79], v[180:183]
ds_read_b64_tr_b16 v[134:135], v15 offset:41472
v_mfma_f32_16x16x32_bf16 v[168:171], v[152:155], v[72:75], v[168:171]
ds_read_b64_tr_b16 v[136:137], v16 offset:40960
v_mfma_f32_16x16x32_bf16 v[184:187], v[152:155], v[76:79], v[184:187]
ds_read_b64_tr_b16 v[138:139], v16 offset:41472
v_mfma_f32_16x16x32_bf16 v[172:175], v[156:159], v[72:75], v[172:175]
ds_read_b64_tr_b16 v[140:141], v17 offset:40960
v_mfma_f32_16x16x32_bf16 v[188:191], v[156:159], v[76:79], v[188:191]
ds_read_b64_tr_b16 v[142:143], v17 offset:41472
s_waitcnt lgkmcnt(0)
v_mfma_f32_16x16x32_bf16 v[160:163], v[128:131], v[80:83], v[160:163]
ds_read_b64_tr_b16 v[144:145], v14 offset:45056
ds_read_b64_tr_b16 v[146:147], v14 offset:45568
v_mfma_f32_16x16x32_bf16 v[176:179], v[128:131], v[84:87], v[176:179]
ds_read_b64_tr_b16 v[148:149], v15 offset:45056
v_mfma_f32_16x16x32_bf16 v[164:167], v[132:135], v[80:83], v[164:167]
ds_read_b64_tr_b16 v[150:151], v15 offset:45568
ds_read_b64_tr_b16 v[152:153], v16 offset:45056
v_mfma_f32_16x16x32_bf16 v[180:183], v[132:135], v[84:87], v[180:183]
ds_read_b64_tr_b16 v[154:155], v16 offset:45568
v_mfma_f32_16x16x32_bf16 v[168:171], v[136:139], v[80:83], v[168:171]
ds_read_b64_tr_b16 v[156:157], v17 offset:45056
ds_read_b64_tr_b16 v[158:159], v17 offset:45568
v_mfma_f32_16x16x32_bf16 v[184:187], v[136:139], v[84:87], v[184:187]
buffer_load_dwordx4 v[24:27], v12, s[20:23], s49 offen offset:0
v_mfma_f32_16x16x32_bf16 v[172:175], v[140:143], v[80:83], v[172:175]
buffer_load_dwordx4 v[28:31], v12, s[20:23], s49 offen offset:1024
buffer_load_dwordx4 v[32:35], v13, s[20:23], s49 offen offset:0
v_mfma_f32_16x16x32_bf16 v[188:191], v[140:143], v[84:87], v[188:191]
buffer_load_dwordx4 v[36:39], v13, s[20:23], s49 offen offset:1024
s_waitcnt vmcnt(10) lgkmcnt(0)
s_barrier
v_mfma_f32_16x16x32_bf16 v[160:163], v[144:147], v[88:91], v[160:163]
ds_read_b64_tr_b16 v[128:129], v14 offset:49152
v_mfma_f32_16x16x32_bf16 v[176:179], v[144:147], v[92:95], v[176:179]
ds_read_b64_tr_b16 v[130:131], v14 offset:49664
v_mfma_f32_16x16x32_bf16 v[164:167], v[148:151], v[88:91], v[164:167]
ds_read_b64_tr_b16 v[132:133], v15 offset:49152
v_mfma_f32_16x16x32_bf16 v[180:183], v[148:151], v[92:95], v[180:183]
ds_read_b64_tr_b16 v[134:135], v15 offset:49664
v_mfma_f32_16x16x32_bf16 v[168:171], v[152:155], v[88:91], v[168:171]
ds_read_b64_tr_b16 v[136:137], v16 offset:49152
v_mfma_f32_16x16x32_bf16 v[184:187], v[152:155], v[92:95], v[184:187]
ds_read_b64_tr_b16 v[138:139], v16 offset:49664
v_mfma_f32_16x16x32_bf16 v[172:175], v[156:159], v[88:91], v[172:175]
ds_read_b64_tr_b16 v[140:141], v17 offset:49152
v_mfma_f32_16x16x32_bf16 v[188:191], v[156:159], v[92:95], v[188:191]
ds_read_b64_tr_b16 v[142:143], v17 offset:49664
s_waitcnt lgkmcnt(0)
v_mfma_f32_16x16x32_bf16 v[160:163], v[128:131], v[96:99], v[160:163]
ds_read_b64_tr_b16 v[144:145], v14 offset:53248
v_mfma_f32_16x16x32_bf16 v[176:179], v[128:131], v[100:103], v[176:179]
ds_read_b64_tr_b16 v[146:147], v14 offset:53760
v_mfma_f32_16x16x32_bf16 v[164:167], v[132:135], v[96:99], v[164:167]
ds_read_b64_tr_b16 v[148:149], v15 offset:53248
v_mfma_f32_16x16x32_bf16 v[180:183], v[132:135], v[100:103], v[180:183]
ds_read_b64_tr_b16 v[150:151], v15 offset:53760
v_mfma_f32_16x16x32_bf16 v[168:171], v[136:139], v[96:99], v[168:171]
ds_read_b64_tr_b16 v[152:153], v16 offset:53248
v_mfma_f32_16x16x32_bf16 v[184:187], v[136:139], v[100:103], v[184:187]
ds_read_b64_tr_b16 v[154:155], v16 offset:53760
v_mfma_f32_16x16x32_bf16 v[172:175], v[140:143], v[96:99], v[172:175]
ds_read_b64_tr_b16 v[156:157], v17 offset:53248
v_mfma_f32_16x16x32_bf16 v[188:191], v[140:143], v[100:103], v[188:191]
ds_read_b64_tr_b16 v[158:159], v17 offset:53760
s_waitcnt vmcnt(4) lgkmcnt(0)
s_barrier
v_mfma_f32_16x16x32_bf16 v[160:163], v[144:147], v[104:107], v[160:163]
ds_read_b64_tr_b16 v[128:129], v14 offset:57344
v_mfma_f32_16x16x32_bf16 v[176:179], v[144:147], v[108:111], v[176:179]
ds_read_b64_tr_b16 v[130:131], v14 offset:57856
v_mfma_f32_16x16x32_bf16 v[164:167], v[148:151], v[104:107], v[164:167]
ds_read_b64_tr_b16 v[132:133], v15 offset:57344
v_mfma_f32_16x16x32_bf16 v[180:183], v[148:151], v[108:111], v[180:183]
ds_read_b64_tr_b16 v[134:135], v15 offset:57856
v_mfma_f32_16x16x32_bf16 v[168:171], v[152:155], v[104:107], v[168:171]
ds_read_b64_tr_b16 v[136:137], v16 offset:57344
v_mfma_f32_16x16x32_bf16 v[184:187], v[152:155], v[108:111], v[184:187]
ds_read_b64_tr_b16 v[138:139], v16 offset:57856
v_mfma_f32_16x16x32_bf16 v[172:175], v[156:159], v[104:107], v[172:175]
ds_read_b64_tr_b16 v[140:141], v17 offset:57344
v_mfma_f32_16x16x32_bf16 v[188:191], v[156:159], v[108:111], v[188:191]
ds_read_b64_tr_b16 v[142:143], v17 offset:57856
s_waitcnt lgkmcnt(0)
v_mfma_f32_16x16x32_bf16 v[160:163], v[128:131], v[112:115], v[160:163]
ds_read_b64_tr_b16 v[144:145], v14 offset:61440
v_mfma_f32_16x16x32_bf16 v[176:179], v[128:131], v[116:119], v[176:179]
ds_read_b64_tr_b16 v[146:147], v14 offset:61952
v_mfma_f32_16x16x32_bf16 v[164:167], v[132:135], v[112:115], v[164:167]
ds_read_b64_tr_b16 v[148:149], v15 offset:61440
v_mfma_f32_16x16x32_bf16 v[180:183], v[132:135], v[116:119], v[180:183]
ds_read_b64_tr_b16 v[150:151], v15 offset:61952
v_mfma_f32_16x16x32_bf16 v[168:171], v[136:139], v[112:115], v[168:171]
ds_read_b64_tr_b16 v[152:153], v16 offset:61440
v_mfma_f32_16x16x32_bf16 v[184:187], v[136:139], v[116:119], v[184:187]
ds_read_b64_tr_b16 v[154:155], v16 offset:61952
v_mfma_f32_16x16x32_bf16 v[172:175], v[140:143], v[112:115], v[172:175]
ds_read_b64_tr_b16 v[156:157], v17 offset:61440
v_mfma_f32_16x16x32_bf16 v[188:191], v[140:143], v[116:119], v[188:191]
ds_read_b64_tr_b16 v[158:159], v17 offset:61952
s_waitcnt lgkmcnt(0)
v_mfma_f32_16x16x32_bf16 v[160:163], v[144:147], v[120:123], v[160:163]
v_mfma_f32_16x16x32_bf16 v[176:179], v[144:147], v[124:127], v[176:179]
v_mfma_f32_16x16x32_bf16 v[164:167], v[148:151], v[120:123], v[164:167]
v_mfma_f32_16x16x32_bf16 v[180:183], v[148:151], v[124:127], v[180:183]
v_mfma_f32_16x16x32_bf16 v[168:171], v[152:155], v[120:123], v[168:171]
v_mfma_f32_16x16x32_bf16 v[184:187], v[152:155], v[124:127], v[184:187]
v_mfma_f32_16x16x32_bf16 v[172:175], v[156:159], v[120:123], v[172:175]
v_mfma_f32_16x16x32_bf16 v[188:191], v[156:159], v[124:127], v[188:191]
s_add_u32 s49, s48, 4194304
s_waitcnt vmcnt(0)
s_nop 4
v_lshlrev_b32 v4, 16, v24
v_and_b32 v5, 0xffff0000, v24
v_pk_add_f32 v[160:161], v[160:161], v[4:5]
v_lshlrev_b32 v4, 16, v25
v_and_b32 v5, 0xffff0000, v25
v_pk_add_f32 v[162:163], v[162:163], v[4:5]
v_lshlrev_b32 v4, 16, v26
v_and_b32 v5, 0xffff0000, v26
v_pk_add_f32 v[164:165], v[164:165], v[4:5]
v_lshlrev_b32 v4, 16, v27
v_and_b32 v5, 0xffff0000, v27
v_pk_add_f32 v[166:167], v[166:167], v[4:5]
v_cvt_pk_bf16_f32 v160, v160, v161
v_cvt_pk_bf16_f32 v161, v162, v163
v_cvt_pk_bf16_f32 v162, v164, v165
v_cvt_pk_bf16_f32 v163, v166, v167
buffer_store_dwordx4 v[160:163], v12, s[20:23], s49 offen offset:0
v_lshlrev_b32 v4, 16, v28
v_and_b32 v5, 0xffff0000, v28
v_pk_add_f32 v[168:169], v[168:169], v[4:5]
v_lshlrev_b32 v4, 16, v29
v_and_b32 v5, 0xffff0000, v29
v_pk_add_f32 v[170:171], v[170:171], v[4:5]
v_lshlrev_b32 v4, 16, v30
v_and_b32 v5, 0xffff0000, v30
v_pk_add_f32 v[172:173], v[172:173], v[4:5]
v_lshlrev_b32 v4, 16, v31
v_and_b32 v5, 0xffff0000, v31
v_pk_add_f32 v[174:175], v[174:175], v[4:5]
v_cvt_pk_bf16_f32 v168, v168, v169
v_cvt_pk_bf16_f32 v169, v170, v171
v_cvt_pk_bf16_f32 v170, v172, v173
v_cvt_pk_bf16_f32 v171, v174, v175
buffer_store_dwordx4 v[168:171], v12, s[20:23], s49 offen offset:1024
v_lshlrev_b32 v4, 16, v32
v_and_b32 v5, 0xffff0000, v32
v_pk_add_f32 v[176:177], v[176:177], v[4:5]
v_lshlrev_b32 v4, 16, v33
v_and_b32 v5, 0xffff0000, v33
v_pk_add_f32 v[178:179], v[178:179], v[4:5]
v_lshlrev_b32 v4, 16, v34
v_and_b32 v5, 0xffff0000, v34
v_pk_add_f32 v[180:181], v[180:181], v[4:5]
v_lshlrev_b32 v4, 16, v35
v_and_b32 v5, 0xffff0000, v35
v_pk_add_f32 v[182:183], v[182:183], v[4:5]
v_cvt_pk_bf16_f32 v176, v176, v177
v_cvt_pk_bf16_f32 v177, v178, v179
v_cvt_pk_bf16_f32 v178, v180, v181
v_cvt_pk_bf16_f32 v179, v182, v183
buffer_store_dwordx4 v[176:179], v13, s[20:23], s49 offen offset:0
v_lshlrev_b32 v4, 16, v36
v_and_b32 v5, 0xffff0000, v36
v_pk_add_f32 v[184:185], v[184:185], v[4:5]
v_lshlrev_b32 v4, 16, v37
v_and_b32 v5, 0xffff0000, v37
v_pk_add_f32 v[186:187], v[186:187], v[4:5]
v_lshlrev_b32 v4, 16, v38
v_and_b32 v5, 0xffff0000, v38
v_pk_add_f32 v[188:189], v[188:189], v[4:5]
v_lshlrev_b32 v4, 16, v39
v_and_b32 v5, 0xffff0000, v39
v_pk_add_f32 v[190:191], v[190:191], v[4:5]
v_cvt_pk_bf16_f32 v184, v184, v185
v_cvt_pk_bf16_f32 v185, v186, v187
v_cvt_pk_bf16_f32 v186, v188, v189
v_cvt_pk_bf16_f32 v187, v190, v191
buffer_store_dwordx4 v[184:187], v13, s[20:23], s49 offen offset:1024
out1_kernel_end:
s_endpgm
.text
.globl qkv2_kernel
.p2align 8
.type qkv2_kernel,@function
qkv2_kernel:
s_cmp_ge_u32 s2, 256
s_cbranch_scc1 qkv2_kernel_end
s_load_dwordx2 s[8:9], s[0:1], 72
s_load_dwordx2 s[6:7], s[0:1], 8
v_lshrrev_b32 v1, 6, v0
v_and_b32 v0, 63, v0
v_readfirstlane_b32 s28, v1
s_and_b32 s35, s2, 7
s_lshr_b32 s41, s2, 3
s_and_b32 s29, s35, 7
s_lshl_b32 s29, s29, 1
s_and_b32 s30, s41, 1
s_add_u32 s29, s29, s30
s_lshr_b32 s30, s35, 3
s_lshl_b32 s30, s30, 4
s_lshr_b32 s41, s41, 1
s_add_u32 s30, s30, s41
v_and_b32 v2, 15, v0
v_lshrrev_b32 v3, 4, v0
v_lshlrev_b32 v10, 4, v0
v_add_u32 v11, 1024, v10
s_waitcnt lgkmcnt(0)
s_add_u32 s4, s8, 4194304
s_addc_u32 s5, s9, 0
s_mov_b32 s12, s4
s_and_b32 s13, s5, 0xffff
s_mov_b32 s14, 4194304
s_mov_b32 s15, 0x00020000
s_mov_b32 s16, s6
s_and_b32 s17, s7, 0xffff
s_mov_b32 s18, 6291456
s_mov_b32 s19, 0x00020000
s_mov_b32 s20, s8
s_and_b32 s21, s9, 0xffff
s_mov_b32 s22, 268435456
s_mov_b32 s23, 0x00020000
s_cmp_ge_u32 s28, 4
s_cbranch_scc1 qkv2_kernel_loader
s_setprio 1
s_and_b32 s43, s28, 1
s_lshr_b32 s44, s28, 1
v_lshrrev_b32 v4, 2, v2
v_and_b32 v5, 3, v0
v_lshl_add_u32 v6, v3, 3, v4
v_lshlrev_b32 v6, 7, v6
v_lshl_add_u32 v6, v5, 3, v6
v_lshrrev_b32 v7, 1, v4
v_and_b32 v8, 1, v3
v_lshl_add_u32 v7, v8, 1, v7
s_lshl_b32 s35, s43, 1
v_xor_b32 v7, s35, v7
v_lshl_add_u32 v12, v7, 5, v6
v_add_u32 v12, 18432, v12
v_xor_b32 v13, 32, v12
v_mov_b32 v14, v10
v_mov_b32 v15, v11
v_mov_b32 v16, v12
v_mov_b32 v17, v13
v_mov_b32 v148, 0
v_mov_b32 v149, 0
v_mov_b32 v150, 0
v_mov_b32 v151, 0
v_mov_b32 v152, 0
v_mov_b32 v153, 0
v_mov_b32 v154, 0
v_mov_b32 v155, 0
v_mov_b32 v156, 0
v_mov_b32 v157, 0
v_mov_b32 v158, 0
v_mov_b32 v159, 0
v_mov_b32 v160, 0
v_mov_b32 v161, 0
v_mov_b32 v162, 0
v_mov_b32 v163, 0
v_mov_b32 v164, 0
v_mov_b32 v165, 0
v_mov_b32 v166, 0
v_mov_b32 v167, 0
v_mov_b32 v168, 0
v_mov_b32 v169, 0
v_mov_b32 v170, 0
v_mov_b32 v171, 0
v_mov_b32 v172, 0
v_mov_b32 v173, 0
v_mov_b32 v174, 0
v_mov_b32 v175, 0
v_mov_b32 v176, 0
v_mov_b32 v177, 0
v_mov_b32 v178, 0
v_mov_b32 v179, 0
v_mov_b32 v180, 0
v_mov_b32 v181, 0
v_mov_b32 v182, 0
v_mov_b32 v183, 0
v_mov_b32 v184, 0
v_mov_b32 v185, 0
v_mov_b32 v186, 0
v_mov_b32 v187, 0
v_mov_b32 v188, 0
v_mov_b32 v189, 0
v_mov_b32 v190, 0
v_mov_b32 v191, 0
v_mov_b32 v192, 0
v_mov_b32 v193, 0
v_mov_b32 v194, 0
v_mov_b32 v195, 0
v_mov_b32 v196, 0
v_mov_b32 v197, 0
v_mov_b32 v198, 0
v_mov_b32 v199, 0
v_mov_b32 v200, 0
v_mov_b32 v201, 0
v_mov_b32 v202, 0
v_mov_b32 v203, 0
v_mov_b32 v204, 0
v_mov_b32 v205, 0
v_mov_b32 v206, 0
v_mov_b32 v207, 0
v_mov_b32 v208, 0
v_mov_b32 v209, 0
v_mov_b32 v210, 0
v_mov_b32 v211, 0
v_mov_b32 v212, 0
v_mov_b32 v213, 0
v_mov_b32 v214, 0
v_mov_b32 v215, 0
v_mov_b32 v216, 0
v_mov_b32 v217, 0
v_mov_b32 v218, 0
v_mov_b32 v219, 0
v_mov_b32 v220, 0
v_mov_b32 v221, 0
v_mov_b32 v222, 0
v_mov_b32 v223, 0
v_mov_b32 v224, 0
v_mov_b32 v225, 0
v_mov_b32 v226, 0
v_mov_b32 v227, 0
v_mov_b32 v228, 0
v_mov_b32 v229, 0
v_mov_b32 v230, 0
v_mov_b32 v231, 0
v_mov_b32 v232, 0
v_mov_b32 v233, 0
v_mov_b32 v234, 0
v_mov_b32 v235, 0
v_mov_b32 v236, 0
v_mov_b32 v237, 0
v_mov_b32 v238, 0
v_mov_b32 v239, 0
v_mov_b32 v240, 0
v_mov_b32 v241, 0
v_mov_b32 v242, 0
v_mov_b32 v243, 0
v_mov_b32 v244, 0
v_mov_b32 v245, 0
v_mov_b32 v246, 0
v_mov_b32 v247, 0
v_mov_b32 v248, 0
v_mov_b32 v249, 0
v_mov_b32 v250, 0
v_mov_b32 v251, 0
v_mov_b32 v252, 0
v_mov_b32 v253, 0
v_mov_b32 v254, 0
v_mov_b32 v255, 0
s_mov_b32 s31, 0
s_mov_b32 s32, 0
s_cmp_eq_u32 s44, 1
s_cbranch_scc1 qkv2_kernel_th1
s_barrier
ds_read_b128 v[60:63], v14 offset:2048
ds_read_b128 v[64:67], v14 offset:4096
ds_read_b128 v[68:71], v14 offset:6144
ds_read_b128 v[72:75], v14 offset:8192
ds_read_b128 v[76:79], v14
ds_read_b64_tr_b16 v[80:81], v16 offset:0
ds_read_b64_tr_b16 v[82:83], v16 offset:512
ds_read_b64_tr_b16 v[84:85], v17 offset:0
ds_read_b64_tr_b16 v[86:87], v17 offset:512
ds_read_b64_tr_b16 v[88:89], v16 offset:8192
ds_read_b64_tr_b16 v[90:91], v16 offset:8704
ds_read_b64_tr_b16 v[92:93], v17 offset:8192
ds_read_b64_tr_b16 v[94:95], v17 offset:8704
ds_read_b64_tr_b16 v[96:97], v16 offset:16384
ds_read_b64_tr_b16 v[98:99], v16 offset:16896
ds_read_b64_tr_b16 v[100:101], v17 offset:16384
ds_read_b64_tr_b16 v[102:103], v17 offset:16896
qkv2_kernel_loop0:
s_add_u32 s32, s32, 43008
s_cmp_eq_u32 s32, 129024
s_cselect_b32 s32, 0, s32
s_waitcnt lgkmcnt(0)
v_mfma_f32_16x16x32_bf16 v[244:247], v[80:83], v[76:79], v[244:247]
ds_read_b128 v[104:107], v15 offset:2048
v_mfma_f32_16x16x32_bf16 v[248:251], v[88:91], v[76:79], v[248:251]
ds_read_b128 v[108:111], v15 offset:4096
v_mfma_f32_16x16x32_bf16 v[252:255], v[76:79], v[96:99], v[252:255]
ds_read_b128 v[112:115], v15 offset:6144
v_mfma_f32_16x16x32_bf16 v[204:207], v[88:91], v[72:75], v[204:207]
ds_read_b128 v[116:119], v15 offset:8192
v_mfma_f32_16x16x32_bf16 v[236:239], v[72:75], v[96:99], v[236:239]
ds_read_b128 v[120:123], v15
v_mfma_f32_16x16x32_bf16 v[172:175], v[80:83], v[72:75], v[172:175]
ds_read_b64_tr_b16 v[124:125], v16 offset:4096
v_mfma_f32_16x16x32_bf16 v[208:211], v[92:95], v[72:75], v[208:211]
ds_read_b64_tr_b16 v[126:127], v16 offset:4608
v_mfma_f32_16x16x32_bf16 v[240:243], v[72:75], v[100:103], v[240:243]
ds_read_b64_tr_b16 v[128:129], v17 offset:4096
v_mfma_f32_16x16x32_bf16 v[176:179], v[84:87], v[72:75], v[176:179]
ds_read_b64_tr_b16 v[130:131], v17 offset:4608
v_mfma_f32_16x16x32_bf16 v[196:199], v[88:91], v[68:71], v[196:199]
ds_read_b64_tr_b16 v[132:133], v16 offset:12288
v_mfma_f32_16x16x32_bf16 v[228:231], v[68:71], v[96:99], v[228:231]
ds_read_b64_tr_b16 v[134:135], v16 offset:12800
v_mfma_f32_16x16x32_bf16 v[164:167], v[80:83], v[68:71], v[164:167]
ds_read_b64_tr_b16 v[136:137], v17 offset:12288
v_mfma_f32_16x16x32_bf16 v[200:203], v[92:95], v[68:71], v[200:203]
ds_read_b64_tr_b16 v[138:139], v17 offset:12800
v_mfma_f32_16x16x32_bf16 v[232:235], v[68:71], v[100:103], v[232:235]
ds_read_b64_tr_b16 v[140:141], v16 offset:20480
v_mfma_f32_16x16x32_bf16 v[168:171], v[84:87], v[68:71], v[168:171]
ds_read_b64_tr_b16 v[142:143], v16 offset:20992
v_mfma_f32_16x16x32_bf16 v[188:191], v[88:91], v[64:67], v[188:191]
ds_read_b64_tr_b16 v[144:145], v17 offset:20480
v_mfma_f32_16x16x32_bf16 v[220:223], v[64:67], v[96:99], v[220:223]
ds_read_b64_tr_b16 v[146:147], v17 offset:20992
v_mfma_f32_16x16x32_bf16 v[156:159], v[80:83], v[64:67], v[156:159]
v_mfma_f32_16x16x32_bf16 v[192:195], v[92:95], v[64:67], v[192:195]
v_mfma_f32_16x16x32_bf16 v[224:227], v[64:67], v[100:103], v[224:227]
v_mfma_f32_16x16x32_bf16 v[160:163], v[84:87], v[64:67], v[160:163]
v_mfma_f32_16x16x32_bf16 v[180:183], v[88:91], v[60:63], v[180:183]
v_mfma_f32_16x16x32_bf16 v[212:215], v[60:63], v[96:99], v[212:215]
v_mfma_f32_16x16x32_bf16 v[148:151], v[80:83], v[60:63], v[148:151]
v_mfma_f32_16x16x32_bf16 v[184:187], v[92:95], v[60:63], v[184:187]
v_mfma_f32_16x16x32_bf16 v[216:219], v[60:63], v[100:103], v[216:219]
v_mfma_f32_16x16x32_bf16 v[152:155], v[84:87], v[60:63], v[152:155]
s_waitcnt lgkmcnt(0)
s_barrier
v_mfma_f32_16x16x32_bf16 v[244:247], v[124:127], v[120:123], v[244:247]
v_add_u32 v14, s32, v10
v_mfma_f32_16x16x32_bf16 v[248:251], v[132:135], v[120:123], v[248:251]
v_add_u32 v16, s32, v12
v_add_u32 v17, s32, v13
v_mfma_f32_16x16x32_bf16 v[252:255], v[120:123], v[140:143], v[252:255]
ds_read_b128 v[60:63], v14 offset:2048
v_mfma_f32_16x16x32_bf16 v[204:207], v[132:135], v[116:119], v[204:207]
ds_read_b128 v[64:67], v14 offset:4096
v_mfma_f32_16x16x32_bf16 v[236:239], v[116:119], v[140:143], v[236:239]
ds_read_b128 v[68:71], v14 offset:6144
v_mfma_f32_16x16x32_bf16 v[172:175], v[124:127], v[116:119], v[172:175]
ds_read_b128 v[72:75], v14 offset:8192
v_mfma_f32_16x16x32_bf16 v[208:211], v[136:139], v[116:119], v[208:211]
ds_read_b128 v[76:79], v14
v_mfma_f32_16x16x32_bf16 v[240:243], v[116:119], v[144:147], v[240:243]
ds_read_b64_tr_b16 v[80:81], v16 offset:0
v_mfma_f32_16x16x32_bf16 v[176:179], v[128:131], v[116:119], v[176:179]
ds_read_b64_tr_b16 v[82:83], v16 offset:512
v_mfma_f32_16x16x32_bf16 v[196:199], v[132:135], v[112:115], v[196:199]
ds_read_b64_tr_b16 v[84:85], v17 offset:0
v_mfma_f32_16x16x32_bf16 v[228:231], v[112:115], v[140:143], v[228:231]
ds_read_b64_tr_b16 v[86:87], v17 offset:512
v_mfma_f32_16x16x32_bf16 v[164:167], v[124:127], v[112:115], v[164:167]
ds_read_b64_tr_b16 v[88:89], v16 offset:8192
v_mfma_f32_16x16x32_bf16 v[200:203], v[136:139], v[112:115], v[200:203]
ds_read_b64_tr_b16 v[90:91], v16 offset:8704
v_mfma_f32_16x16x32_bf16 v[232:235], v[112:115], v[144:147], v[232:235]
ds_read_b64_tr_b16 v[92:93], v17 offset:8192
v_mfma_f32_16x16x32_bf16 v[168:171], v[128:131], v[112:115], v[168:171]
ds_read_b64_tr_b16 v[94:95], v17 offset:8704
v_mfma_f32_16x16x32_bf16 v[188:191], v[132:135], v[108:111], v[188:191]
ds_read_b64_tr_b16 v[96:97], v16 offset:16384
v_mfma_f32_16x16x32_bf16 v[220:223], v[108:111], v[140:143], v[220:223]
ds_read_b64_tr_b16 v[98:99], v16 offset:16896
v_mfma_f32_16x16x32_bf16 v[156:159], v[124:127], v[108:111], v[156:159]
ds_read_b64_tr_b16 v[100:101], v17 offset:16384
v_mfma_f32_16x16x32_bf16 v[192:195], v[136:139], v[108:111], v[192:195]
ds_read_b64_tr_b16 v[102:103], v17 offset:16896
v_mfma_f32_16x16x32_bf16 v[224:227], v[108:111], v[144:147], v[224:227]
v_add_u32 v15, s32, v11
v_mfma_f32_16x16x32_bf16 v[160:163], v[128:131], v[108:111], v[160:163]
s_add_u32 s31, s31, 1
v_mfma_f32_16x16x32_bf16 v[180:183], v[132:135], v[104:107], v[180:183]
s_cmp_lt_u32 s31, 16
v_mfma_f32_16x16x32_bf16 v[212:215], v[104:107], v[140:143], v[212:215]
v_mfma_f32_16x16x32_bf16 v[148:151], v[124:127], v[104:107], v[148:151]
v_mfma_f32_16x16x32_bf16 v[184:187], v[136:139], v[104:107], v[184:187]
v_mfma_f32_16x16x32_bf16 v[216:219], v[104:107], v[144:147], v[216:219]
v_mfma_f32_16x16x32_bf16 v[152:155], v[128:131], v[104:107], v[152:155]
s_cbranch_scc1 qkv2_kernel_loop0
s_branch qkv2_kernel_epi
qkv2_kernel_th1:
s_barrier
ds_read_b128 v[60:63], v14 offset:10240
ds_read_b128 v[64:67], v14 offset:12288
ds_read_b128 v[68:71], v14 offset:14336
ds_read_b128 v[72:75], v14 offset:16384
ds_read_b128 v[76:79], v14
ds_read_b64_tr_b16 v[80:81], v16 offset:0
ds_read_b64_tr_b16 v[82:83], v16 offset:512
ds_read_b64_tr_b16 v[84:85], v17 offset:0
ds_read_b64_tr_b16 v[86:87], v17 offset:512
ds_read_b64_tr_b16 v[88:89], v16 offset:8192
ds_read_b64_tr_b16 v[90:91], v16 offset:8704
ds_read_b64_tr_b16 v[92:93], v17 offset:8192
ds_read_b64_tr_b16 v[94:95], v17 offset:8704
ds_read_b64_tr_b16 v[96:97], v16 offset:16384
ds_read_b64_tr_b16 v[98:99], v16 offset:16896
ds_read_b64_tr_b16 v[100:101], v17 offset:16384
ds_read_b64_tr_b16 v[102:103], v17 offset:16896
qkv2_kernel_loop1:
s_add_u32 s32, s32, 43008
s_cmp_eq_u32 s32, 129024
s_cselect_b32 s32, 0, s32
s_waitcnt lgkmcnt(0)
v_mfma_f32_16x16x32_bf16 v[244:247], v[84:87], v[76:79], v[244:247]
ds_read_b128 v[104:107], v15 offset:10240
v_mfma_f32_16x16x32_bf16 v[248:251], v[92:95], v[76:79], v[248:251]
ds_read_b128 v[108:111], v15 offset:12288
v_mfma_f32_16x16x32_bf16 v[252:255], v[76:79], v[100:103], v[252:255]
ds_read_b128 v[112:115], v15 offset:14336
v_mfma_f32_16x16x32_bf16 v[204:207], v[88:91], v[72:75], v[204:207]
ds_read_b128 v[116:119], v15 offset:16384
v_mfma_f32_16x16x32_bf16 v[236:239], v[72:75], v[96:99], v[236:239]
ds_read_b128 v[120:123], v15
v_mfma_f32_16x16x32_bf16 v[172:175], v[80:83], v[72:75], v[172:175]
ds_read_b64_tr_b16 v[124:125], v16 offset:4096
v_mfma_f32_16x16x32_bf16 v[208:211], v[92:95], v[72:75], v[208:211]
ds_read_b64_tr_b16 v[126:127], v16 offset:4608
v_mfma_f32_16x16x32_bf16 v[240:243], v[72:75], v[100:103], v[240:243]
ds_read_b64_tr_b16 v[128:129], v17 offset:4096
v_mfma_f32_16x16x32_bf16 v[176:179], v[84:87], v[72:75], v[176:179]
ds_read_b64_tr_b16 v[130:131], v17 offset:4608
v_mfma_f32_16x16x32_bf16 v[196:199], v[88:91], v[68:71], v[196:199]
ds_read_b64_tr_b16 v[132:133], v16 offset:12288
v_mfma_f32_16x16x32_bf16 v[228:231], v[68:71], v[96:99], v[228:231]
ds_read_b64_tr_b16 v[134:135], v16 offset:12800
v_mfma_f32_16x16x32_bf16 v[164:167], v[80:83], v[68:71], v[164:167]
ds_read_b64_tr_b16 v[136:137], v17 offset:12288
v_mfma_f32_16x16x32_bf16 v[200:203], v[92:95], v[68:71], v[200:203]
ds_read_b64_tr_b16 v[138:139], v17 offset:12800
v_mfma_f32_16x16x32_bf16 v[232:235], v[68:71], v[100:103], v[232:235]
ds_read_b64_tr_b16 v[140:141], v16 offset:20480
v_mfma_f32_16x16x32_bf16 v[168:171], v[84:87], v[68:71], v[168:171]
ds_read_b64_tr_b16 v[142:143], v16 offset:20992
v_mfma_f32_16x16x32_bf16 v[188:191], v[88:91], v[64:67], v[188:191]
ds_read_b64_tr_b16 v[144:145], v17 offset:20480
v_mfma_f32_16x16x32_bf16 v[220:223], v[64:67], v[96:99], v[220:223]
ds_read_b64_tr_b16 v[146:147], v17 offset:20992
v_mfma_f32_16x16x32_bf16 v[156:159], v[80:83], v[64:67], v[156:159]
v_mfma_f32_16x16x32_bf16 v[192:195], v[92:95], v[64:67], v[192:195]
v_mfma_f32_16x16x32_bf16 v[224:227], v[64:67], v[100:103], v[224:227]
v_mfma_f32_16x16x32_bf16 v[160:163], v[84:87], v[64:67], v[160:163]
v_mfma_f32_16x16x32_bf16 v[180:183], v[88:91], v[60:63], v[180:183]
v_mfma_f32_16x16x32_bf16 v[212:215], v[60:63], v[96:99], v[212:215]
v_mfma_f32_16x16x32_bf16 v[148:151], v[80:83], v[60:63], v[148:151]
v_mfma_f32_16x16x32_bf16 v[184:187], v[92:95], v[60:63], v[184:187]
v_mfma_f32_16x16x32_bf16 v[216:219], v[60:63], v[100:103], v[216:219]
v_mfma_f32_16x16x32_bf16 v[152:155], v[84:87], v[60:63], v[152:155]
s_waitcnt lgkmcnt(0)
s_barrier
v_mfma_f32_16x16x32_bf16 v[244:247], v[128:131], v[120:123], v[244:247]
v_add_u32 v14, s32, v10
v_mfma_f32_16x16x32_bf16 v[248:251], v[136:139], v[120:123], v[248:251]
v_add_u32 v16, s32, v12
v_add_u32 v17, s32, v13
v_mfma_f32_16x16x32_bf16 v[252:255], v[120:123], v[144:147], v[252:255]
ds_read_b128 v[60:63], v14 offset:10240
v_mfma_f32_16x16x32_bf16 v[204:207], v[132:135], v[116:119], v[204:207]
ds_read_b128 v[64:67], v14 offset:12288
v_mfma_f32_16x16x32_bf16 v[236:239], v[116:119], v[140:143], v[236:239]
ds_read_b128 v[68:71], v14 offset:14336
v_mfma_f32_16x16x32_bf16 v[172:175], v[124:127], v[116:119], v[172:175]
ds_read_b128 v[72:75], v14 offset:16384
v_mfma_f32_16x16x32_bf16 v[208:211], v[136:139], v[116:119], v[208:211]
ds_read_b128 v[76:79], v14
v_mfma_f32_16x16x32_bf16 v[240:243], v[116:119], v[144:147], v[240:243]
ds_read_b64_tr_b16 v[80:81], v16 offset:0
v_mfma_f32_16x16x32_bf16 v[176:179], v[128:131], v[116:119], v[176:179]
ds_read_b64_tr_b16 v[82:83], v16 offset:512
v_mfma_f32_16x16x32_bf16 v[196:199], v[132:135], v[112:115], v[196:199]
ds_read_b64_tr_b16 v[84:85], v17 offset:0
v_mfma_f32_16x16x32_bf16 v[228:231], v[112:115], v[140:143], v[228:231]
ds_read_b64_tr_b16 v[86:87], v17 offset:512
v_mfma_f32_16x16x32_bf16 v[164:167], v[124:127], v[112:115], v[164:167]
ds_read_b64_tr_b16 v[88:89], v16 offset:8192
v_mfma_f32_16x16x32_bf16 v[200:203], v[136:139], v[112:115], v[200:203]
ds_read_b64_tr_b16 v[90:91], v16 offset:8704
v_mfma_f32_16x16x32_bf16 v[232:235], v[112:115], v[144:147], v[232:235]
ds_read_b64_tr_b16 v[92:93], v17 offset:8192
v_mfma_f32_16x16x32_bf16 v[168:171], v[128:131], v[112:115], v[168:171]
ds_read_b64_tr_b16 v[94:95], v17 offset:8704
v_mfma_f32_16x16x32_bf16 v[188:191], v[132:135], v[108:111], v[188:191]
ds_read_b64_tr_b16 v[96:97], v16 offset:16384
v_mfma_f32_16x16x32_bf16 v[220:223], v[108:111], v[140:143], v[220:223]
ds_read_b64_tr_b16 v[98:99], v16 offset:16896
v_mfma_f32_16x16x32_bf16 v[156:159], v[124:127], v[108:111], v[156:159]
ds_read_b64_tr_b16 v[100:101], v17 offset:16384
v_mfma_f32_16x16x32_bf16 v[192:195], v[136:139], v[108:111], v[192:195]
ds_read_b64_tr_b16 v[102:103], v17 offset:16896
v_mfma_f32_16x16x32_bf16 v[224:227], v[108:111], v[144:147], v[224:227]
v_add_u32 v15, s32, v11
v_mfma_f32_16x16x32_bf16 v[160:163], v[128:131], v[108:111], v[160:163]
s_add_u32 s31, s31, 1
v_mfma_f32_16x16x32_bf16 v[180:183], v[132:135], v[104:107], v[180:183]
s_cmp_lt_u32 s31, 16
v_mfma_f32_16x16x32_bf16 v[212:215], v[104:107], v[140:143], v[212:215]
v_mfma_f32_16x16x32_bf16 v[148:151], v[124:127], v[104:107], v[148:151]
v_mfma_f32_16x16x32_bf16 v[184:187], v[136:139], v[104:107], v[184:187]
v_mfma_f32_16x16x32_bf16 v[216:219], v[104:107], v[144:147], v[216:219]
v_mfma_f32_16x16x32_bf16 v[152:155], v[128:131], v[104:107], v[152:155]
s_cbranch_scc1 qkv2_kernel_loop1
qkv2_kernel_epi:
v_lshlrev_b32 v4, 4, v0
s_mul_i32 s35, s28, 3072
s_add_u32 s35, s35, 131328
v_add_u32 v5, s35, v4
s_waitcnt lgkmcnt(0)
ds_write_b128 v5, v[244:247] offset:0
ds_write_b128 v5, v[248:251] offset:1024
ds_write_b128 v5, v[252:255] offset:2048
s_cmp_eq_u32 s44, 1
s_cbranch_scc1 qkv2_kernel_nodump
ds_write_b128 v5, v[204:207] offset:13312
ds_write_b128 v5, v[236:239] offset:14336
ds_write_b128 v5, v[208:211] offset:19456
ds_write_b128 v5, v[240:243] offset:20480
qkv2_kernel_nodump:
s_mul_i32 s35, s43, 3072
s_add_u32 s35, s35, 131328
v_lshlrev_b32 v6, 8, v3
v_add_u32 v6, s35, v6
v_lshlrev_b32 v7, 4, v2
v_add_u32 v7, s35, v7
s_lshl_b32 s36, s44, 6
v_add_u32 v8, s36, v2
v_lshlrev_b32 v8, 3, v8
v_add_u32 v8, 129024, v8
v_lshl_add_u32 v9, v3, 2, s36
v_lshlrev_b32 v9, 2, v9
v_add_u32 v9, 130176, v9
s_mul_i32 s37, s44, 12288
s_add_u32 s35, s35, s37
v_add_u32 v5, s35, v4
s_waitcnt lgkmcnt(0)
s_barrier
ds_read_b128 v[60:63], v6 offset:0
ds_read_b128 v[64:67], v6 offset:6144
ds_read_b128 v[68:71], v6 offset:1024
ds_read_b128 v[72:75], v6 offset:7168
ds_read_b64 v[78:79], v8 offset:0
ds_read_b64 v[80:81], v8 offset:128
ds_read_b64 v[82:83], v8 offset:256
ds_read_b64 v[84:85], v8 offset:384
ds_read_b64 v[86:87], v8 offset:512
ds_read_b128 v[128:131], v5 offset:1024
ds_read_b128 v[132:135], v5 offset:7168
ds_read_b32 v76, v7 offset:2048
ds_read_b32 v77, v7 offset:8192
ds_read_b128 v[136:139], v5 offset:2048
ds_read_b128 v[140:143], v5 offset:8192
ds_read_b128 v[88:91], v9 offset:0
ds_read_b128 v[108:111], v9 offset:576
ds_read_b128 v[92:95], v9 offset:64
ds_read_b128 v[112:115], v9 offset:640
ds_read_b128 v[96:99], v9 offset:128
ds_read_b128 v[116:119], v9 offset:704
ds_read_b128 v[100:103], v9 offset:192
ds_read_b128 v[120:123], v9 offset:768
ds_read_b128 v[104:107], v9 offset:256
ds_read_b128 v[124:127], v9 offset:832
s_waitcnt lgkmcnt(14)
s_lshl_b32 s35, s29, 3
s_lshl_b32 s36, s44, 2
s_add_u32 s35, s35, s36
s_lshl_b32 s35, s35, 5
s_lshl_b32 s45, s30, 1
s_add_u32 s45, s45, s43
s_add_u32 s35, s35, s45
s_lshl_b32 s35, s35, 10
s_add_u32 s46, s35, 12582912
v_lshlrev_b32 v18, 4, v0
v_pk_fma_f32 v[148:149], v[60:61], v[80:81], v[148:149] op_sel:[0,1,0] op_sel_hi:[1,1,1]
v_pk_fma_f32 v[150:151], v[62:63], v[80:81], v[150:151] op_sel:[0,1,0] op_sel_hi:[1,1,1]
v_pk_fma_f32 v[152:153], v[64:65], v[80:81], v[152:153] op_sel:[0,1,0] op_sel_hi:[1,1,1]
v_pk_fma_f32 v[154:155], v[66:67], v[80:81], v[154:155] op_sel:[0,1,0] op_sel_hi:[1,1,1]
v_pk_mul_f32 v[148:149], v[148:149], v[80:81] op_sel:[0,0] op_sel_hi:[1,0]
v_pk_mul_f32 v[150:151], v[150:151], v[80:81] op_sel:[0,0] op_sel_hi:[1,0]
v_pk_mul_f32 v[152:153], v[152:153], v[80:81] op_sel:[0,0] op_sel_hi:[1,0]
v_pk_mul_f32 v[154:155], v[154:155], v[80:81] op_sel:[0,0] op_sel_hi:[1,0]
v_cvt_pk_bf16_f32 v148, v148, v149
v_cvt_pk_bf16_f32 v149, v150, v151
v_cvt_pk_bf16_f32 v150, v152, v153
v_cvt_pk_bf16_f32 v151, v154, v155
v_pk_fma_f32 v[156:157], v[60:61], v[82:83], v[156:157] op_sel:[0,1,0] op_sel_hi:[1,1,1]
v_pk_fma_f32 v[158:159], v[62:63], v[82:83], v[158:159] op_sel:[0,1,0] op_sel_hi:[1,1,1]
v_pk_fma_f32 v[160:161], v[64:65], v[82:83], v[160:161] op_sel:[0,1,0] op_sel_hi:[1,1,1]
v_pk_fma_f32 v[162:163], v[66:67], v[82:83], v[162:163] op_sel:[0,1,0] op_sel_hi:[1,1,1]
v_pk_mul_f32 v[156:157], v[156:157], v[82:83] op_sel:[0,0] op_sel_hi:[1,0]
v_pk_mul_f32 v[158:159], v[158:159], v[82:83] op_sel:[0,0] op_sel_hi:[1,0]
v_pk_mul_f32 v[160:161], v[160:161], v[82:83] op_sel:[0,0] op_sel_hi:[1,0]
v_pk_mul_f32 v[162:163], v[162:163], v[82:83] op_sel:[0,0] op_sel_hi:[1,0]
v_cvt_pk_bf16_f32 v156, v156, v157
v_cvt_pk_bf16_f32 v157, v158, v159
v_cvt_pk_bf16_f32 v158, v160, v161
v_cvt_pk_bf16_f32 v159, v162, v163
v_pk_fma_f32 v[164:165], v[60:61], v[84:85], v[164:165] op_sel:[0,1,0] op_sel_hi:[1,1,1]
v_pk_fma_f32 v[166:167], v[62:63], v[84:85], v[166:167] op_sel:[0,1,0] op_sel_hi:[1,1,1]
v_pk_fma_f32 v[168:169], v[64:65], v[84:85], v[168:169] op_sel:[0,1,0] op_sel_hi:[1,1,1]
v_pk_fma_f32 v[170:171], v[66:67], v[84:85], v[170:171] op_sel:[0,1,0] op_sel_hi:[1,1,1]
v_pk_mul_f32 v[164:165], v[164:165], v[84:85] op_sel:[0,0] op_sel_hi:[1,0]
v_pk_mul_f32 v[166:167], v[166:167], v[84:85] op_sel:[0,0] op_sel_hi:[1,0]
v_pk_mul_f32 v[168:169], v[168:169], v[84:85] op_sel:[0,0] op_sel_hi:[1,0]
v_pk_mul_f32 v[170:171], v[170:171], v[84:85] op_sel:[0,0] op_sel_hi:[1,0]
v_cvt_pk_bf16_f32 v164, v164, v165
v_cvt_pk_bf16_f32 v165, v166, v167
v_cvt_pk_bf16_f32 v166, v168, v169
v_cvt_pk_bf16_f32 v167, v170, v171
v_pk_fma_f32 v[172:173], v[60:61], v[86:87], v[172:173] op_sel:[0,1,0] op_sel_hi:[1,1,1]
v_pk_fma_f32 v[174:175], v[62:63], v[86:87], v[174:175] op_sel:[0,1,0] op_sel_hi:[1,1,1]
v_pk_fma_f32 v[176:177], v[64:65], v[86:87], v[176:177] op_sel:[0,1,0] op_sel_hi:[1,1,1]
v_pk_fma_f32 v[178:179], v[66:67], v[86:87], v[178:179] op_sel:[0,1,0] op_sel_hi:[1,1,1]
v_pk_mul_f32 v[172:173], v[172:173], v[86:87] op_sel:[0,0] op_sel_hi:[1,0]
v_pk_mul_f32 v[174:175], v[174:175], v[86:87] op_sel:[0,0] op_sel_hi:[1,0]
v_pk_mul_f32 v[176:177], v[176:177], v[86:87] op_sel:[0,0] op_sel_hi:[1,0]
v_pk_mul_f32 v[178:179], v[178:179], v[86:87] op_sel:[0,0] op_sel_hi:[1,0]
v_cvt_pk_bf16_f32 v172, v172, v173
v_cvt_pk_bf16_f32 v173, v174, v175
v_cvt_pk_bf16_f32 v174, v176, v177
v_cvt_pk_bf16_f32 v175, v178, v179
v_pk_fma_f32 v[128:129], v[68:69], v[78:79], v[128:129] op_sel:[0,1,0] op_sel_hi:[1,1,1]
v_pk_fma_f32 v[130:131], v[70:71], v[78:79], v[130:131] op_sel:[0,1,0] op_sel_hi:[1,1,1]
v_pk_fma_f32 v[132:133], v[72:73], v[78:79], v[132:133] op_sel:[0,1,0] op_sel_hi:[1,1,1]
v_pk_fma_f32 v[134:135], v[74:75], v[78:79], v[134:135] op_sel:[0,1,0] op_sel_hi:[1,1,1]
v_pk_mul_f32 v[128:129], v[128:129], v[78:79] op_sel:[0,0] op_sel_hi:[1,0]
v_pk_mul_f32 v[130:131], v[130:131], v[78:79] op_sel:[0,0] op_sel_hi:[1,0]
v_pk_mul_f32 v[132:133], v[132:133], v[78:79] op_sel:[0,0] op_sel_hi:[1,0]
v_pk_mul_f32 v[134:135], v[134:135], v[78:79] op_sel:[0,0] op_sel_hi:[1,0]
v_cvt_pk_bf16_f32 v128, v128, v129
v_cvt_pk_bf16_f32 v129, v130, v131
v_cvt_pk_bf16_f32 v130, v132, v133
v_cvt_pk_bf16_f32 v131, v134, v135
v_pk_fma_f32 v[180:181], v[68:69], v[80:81], v[180:181] op_sel:[0,1,0] op_sel_hi:[1,1,1]
v_pk_fma_f32 v[182:183], v[70:71], v[80:81], v[182:183] op_sel:[0,1,0] op_sel_hi:[1,1,1]
v_pk_fma_f32 v[184:185], v[72:73], v[80:81], v[184:185] op_sel:[0,1,0] op_sel_hi:[1,1,1]
v_pk_fma_f32 v[186:187], v[74:75], v[80:81], v[186:187] op_sel:[0,1,0] op_sel_hi:[1,1,1]
v_pk_mul_f32 v[180:181], v[180:181], v[80:81] op_sel:[0,0] op_sel_hi:[1,0]
v_pk_mul_f32 v[182:183], v[182:183], v[80:81] op_sel:[0,0] op_sel_hi:[1,0]
v_pk_mul_f32 v[184:185], v[184:185], v[80:81] op_sel:[0,0] op_sel_hi:[1,0]
v_pk_mul_f32 v[186:187], v[186:187], v[80:81] op_sel:[0,0] op_sel_hi:[1,0]
v_cvt_pk_bf16_f32 v180, v180, v181
v_cvt_pk_bf16_f32 v181, v182, v183
v_cvt_pk_bf16_f32 v182, v184, v185
v_cvt_pk_bf16_f32 v183, v186, v187
v_pk_fma_f32 v[188:189], v[68:69], v[82:83], v[188:189] op_sel:[0,1,0] op_sel_hi:[1,1,1]
v_pk_fma_f32 v[190:191], v[70:71], v[82:83], v[190:191] op_sel:[0,1,0] op_sel_hi:[1,1,1]
v_pk_fma_f32 v[192:193], v[72:73], v[82:83], v[192:193] op_sel:[0,1,0] op_sel_hi:[1,1,1]
v_pk_fma_f32 v[194:195], v[74:75], v[82:83], v[194:195] op_sel:[0,1,0] op_sel_hi:[1,1,1]
v_pk_mul_f32 v[188:189], v[188:189], v[82:83] op_sel:[0,0] op_sel_hi:[1,0]
v_pk_mul_f32 v[190:191], v[190:191], v[82:83] op_sel:[0,0] op_sel_hi:[1,0]
v_pk_mul_f32 v[192:193], v[192:193], v[82:83] op_sel:[0,0] op_sel_hi:[1,0]
v_pk_mul_f32 v[194:195], v[194:195], v[82:83] op_sel:[0,0] op_sel_hi:[1,0]
v_cvt_pk_bf16_f32 v188, v188, v189
v_cvt_pk_bf16_f32 v189, v190, v191
v_cvt_pk_bf16_f32 v190, v192, v193
v_cvt_pk_bf16_f32 v191, v194, v195
v_pk_fma_f32 v[196:197], v[68:69], v[84:85], v[196:197] op_sel:[0,1,0] op_sel_hi:[1,1,1]
v_pk_fma_f32 v[198:199], v[70:71], v[84:85], v[198:199] op_sel:[0,1,0] op_sel_hi:[1,1,1]
v_pk_fma_f32 v[200:201], v[72:73], v[84:85], v[200:201] op_sel:[0,1,0] op_sel_hi:[1,1,1]
v_pk_fma_f32 v[202:203], v[74:75], v[84:85], v[202:203] op_sel:[0,1,0] op_sel_hi:[1,1,1]
v_pk_mul_f32 v[196:197], v[196:197], v[84:85] op_sel:[0,0] op_sel_hi:[1,0]
v_pk_mul_f32 v[198:199], v[198:199], v[84:85] op_sel:[0,0] op_sel_hi:[1,0]
v_pk_mul_f32 v[200:201], v[200:201], v[84:85] op_sel:[0,0] op_sel_hi:[1,0]
v_pk_mul_f32 v[202:203], v[202:203], v[84:85] op_sel:[0,0] op_sel_hi:[1,0]
v_cvt_pk_bf16_f32 v196, v196, v197
v_cvt_pk_bf16_f32 v197, v198, v199
v_cvt_pk_bf16_f32 v198, v200, v201
v_cvt_pk_bf16_f32 v199, v202, v203
v_pk_fma_f32 v[204:205], v[68:69], v[86:87], v[204:205] op_sel:[0,1,0] op_sel_hi:[1,1,1]
v_pk_fma_f32 v[206:207], v[70:71], v[86:87], v[206:207] op_sel:[0,1,0] op_sel_hi:[1,1,1]
v_pk_fma_f32 v[208:209], v[72:73], v[86:87], v[208:209] op_sel:[0,1,0] op_sel_hi:[1,1,1]
v_pk_fma_f32 v[210:211], v[74:75], v[86:87], v[210:211] op_sel:[0,1,0] op_sel_hi:[1,1,1]
v_pk_mul_f32 v[204:205], v[204:205], v[86:87] op_sel:[0,0] op_sel_hi:[1,0]
v_pk_mul_f32 v[206:207], v[206:207], v[86:87] op_sel:[0,0] op_sel_hi:[1,0]
v_pk_mul_f32 v[208:209], v[208:209], v[86:87] op_sel:[0,0] op_sel_hi:[1,0]
v_pk_mul_f32 v[210:211], v[210:211], v[86:87] op_sel:[0,0] op_sel_hi:[1,0]
v_cvt_pk_bf16_f32 v204, v204, v205
v_cvt_pk_bf16_f32 v205, v206, v207
v_cvt_pk_bf16_f32 v206, v208, v209
v_cvt_pk_bf16_f32 v207, v210, v211
s_mov_b32 s36, 0xf149f2ca
v_mov_b32 v53, s36
v_lshlrev_b32 v4, 2, v3
v_sub_u32 v4, v2, v4
v_subrev_u32 v5, 0, v4
v_and_b32 v6, 0x80000001, v5
v_cmp_eq_u32 vcc, 0, v6
v_add_u32 v5, 1, v5
v_and_b32 v6, 0x80000001, v5
v_cndmask_b32 v44, v53, 0, vcc
v_cmp_eq_u32 vcc, 0x80000001, v6
s_nop 1
v_cndmask_b32 v40, v53, 0, vcc
v_subrev_u32 v5, 1, v4
v_and_b32 v6, 0x80000001, v5
v_cmp_eq_u32 vcc, 0, v6
v_add_u32 v5, 1, v5
v_and_b32 v6, 0x80000001, v5
v_cndmask_b32 v45, v53, 0, vcc
v_cmp_eq_u32 vcc, 0x80000001, v6
s_nop 1
v_cndmask_b32 v41, v53, 0, vcc
v_subrev_u32 v5, 2, v4
v_and_b32 v6, 0x80000001, v5
v_cmp_eq_u32 vcc, 0, v6
v_add_u32 v5, 1, v5
v_and_b32 v6, 0x80000001, v5
v_cndmask_b32 v46, v53, 0, vcc
v_cmp_eq_u32 vcc, 0x80000001, v6
s_nop 1
v_cndmask_b32 v42, v53, 0, vcc
v_subrev_u32 v5, 3, v4
v_and_b32 v6, 0x80000001, v5
v_cmp_eq_u32 vcc, 0, v6
v_add_u32 v5, 1, v5
v_and_b32 v6, 0x80000001, v5
v_cndmask_b32 v47, v53, 0, vcc
v_cmp_eq_u32 vcc, 0x80000001, v6
s_nop 1
v_cndmask_b32 v43, v53, 0, vcc
s_or_b32 s36, s29, s44
s_cmp_eq_u32 s36, 0
s_cselect_b64 vcc, -1, 0
v_cndmask_b32 v48, v40, v53, vcc
v_cndmask_b32 v49, v41, v53, vcc
v_cndmask_b32 v50, v42, v53, vcc
v_cndmask_b32 v51, v43, v53, vcc
v_and_b32 v4, 1, v2
v_lshlrev_b32 v4, 4, v4
v_mov_b32 v5, 0xffff
v_lshlrev_b32 v52, v4, v5
v_mov_b32 v56, 0x3f803f80
v_mov_b32 v57, 0x3f803f80
v_mov_b32 v58, 0x3f803f80
v_mov_b32 v59, 0x3f803f80
v_mfma_f32_16x16x32_bf16 v[152:155], v[128:131], v[148:151], v[48:51]
v_mfma_f32_16x16x32_bf16 v[184:187], v[180:183], v[148:151], v[44:47]
v_mfma_f32_16x16x32_bf16 v[160:163], v[180:183], v[156:159], v[40:43]
v_mfma_f32_16x16x32_bf16 v[192:195], v[188:191], v[156:159], v[44:47]
v_mfma_f32_16x16x32_bf16 v[168:171], v[188:191], v[164:167], v[40:43]
v_mfma_f32_16x16x32_bf16 v[200:203], v[196:199], v[164:167], v[44:47]
v_mfma_f32_16x16x32_bf16 v[176:179], v[196:199], v[172:175], v[40:43]
v_mfma_f32_16x16x32_bf16 v[208:211], v[204:207], v[172:175], v[44:47]
s_waitcnt lgkmcnt(0)
v_pk_fma_f32 v[136:137], v[108:109], v[76:77], v[136:137] op_sel:[0,0,0] op_sel_hi:[1,0,1]
v_pk_fma_f32 v[138:139], v[110:111], v[76:77], v[138:139] op_sel:[0,0,0] op_sel_hi:[1,0,1]
v_pk_mul_f32 v[136:137], v[136:137], v[88:89]
v_pk_mul_f32 v[138:139], v[138:139], v[90:91]
v_cvt_pk_bf16_f32 v20, v136, v137
v_cvt_pk_bf16_f32 v21, v138, v139
v_pk_fma_f32 v[212:213], v[112:113], v[76:77], v[212:213] op_sel:[0,0,0] op_sel_hi:[1,0,1]
v_pk_fma_f32 v[214:215], v[114:115], v[76:77], v[214:215] op_sel:[0,0,0] op_sel_hi:[1,0,1]
v_pk_mul_f32 v[212:213], v[212:213], v[92:93]
v_pk_mul_f32 v[214:215], v[214:215], v[94:95]
v_cvt_pk_bf16_f32 v22, v212, v213
v_cvt_pk_bf16_f32 v23, v214, v215
v_pk_fma_f32 v[220:221], v[116:117], v[76:77], v[220:221] op_sel:[0,0,0] op_sel_hi:[1,0,1]
v_pk_fma_f32 v[222:223], v[118:119], v[76:77], v[222:223] op_sel:[0,0,0] op_sel_hi:[1,0,1]
v_pk_mul_f32 v[220:221], v[220:221], v[96:97]
v_pk_mul_f32 v[222:223], v[222:223], v[98:99]
v_cvt_pk_bf16_f32 v24, v220, v221
v_cvt_pk_bf16_f32 v25, v222, v223
v_pk_fma_f32 v[228:229], v[120:121], v[76:77], v[228:229] op_sel:[0,0,0] op_sel_hi:[1,0,1]
v_pk_fma_f32 v[230:231], v[122:123], v[76:77], v[230:231] op_sel:[0,0,0] op_sel_hi:[1,0,1]
v_pk_mul_f32 v[228:229], v[228:229], v[100:101]
v_pk_mul_f32 v[230:231], v[230:231], v[102:103]
v_cvt_pk_bf16_f32 v26, v228, v229
v_cvt_pk_bf16_f32 v27, v230, v231
v_pk_fma_f32 v[236:237], v[124:125], v[76:77], v[236:237] op_sel:[0,0,0] op_sel_hi:[1,0,1]
v_pk_fma_f32 v[238:239], v[126:127], v[76:77], v[238:239] op_sel:[0,0,0] op_sel_hi:[1,0,1]
v_pk_mul_f32 v[236:237], v[236:237], v[104:105]
v_pk_mul_f32 v[238:239], v[238:239], v[106:107]
v_cvt_pk_bf16_f32 v28, v236, v237
v_cvt_pk_bf16_f32 v29, v238, v239
v_pk_fma_f32 v[140:141], v[108:109], v[76:77], v[140:141] op_sel:[0,1,0] op_sel_hi:[1,1,1]
v_pk_fma_f32 v[142:143], v[110:111], v[76:77], v[142:143] op_sel:[0,1,0] op_sel_hi:[1,1,1]
v_pk_mul_f32 v[140:141], v[140:141], v[88:89]
v_pk_mul_f32 v[142:143], v[142:143], v[90:91]
v_cvt_pk_bf16_f32 v30, v140, v141
v_cvt_pk_bf16_f32 v31, v142, v143
v_pk_fma_f32 v[216:217], v[112:113], v[76:77], v[216:217] op_sel:[0,1,0] op_sel_hi:[1,1,1]
v_pk_fma_f32 v[218:219], v[114:115], v[76:77], v[218:219] op_sel:[0,1,0] op_sel_hi:[1,1,1]
v_pk_mul_f32 v[216:217], v[216:217], v[92:93]
v_pk_mul_f32 v[218:219], v[218:219], v[94:95]
v_cvt_pk_bf16_f32 v32, v216, v217
v_cvt_pk_bf16_f32 v33, v218, v219
v_pk_fma_f32 v[224:225], v[116:117], v[76:77], v[224:225] op_sel:[0,1,0] op_sel_hi:[1,1,1]
v_pk_fma_f32 v[226:227], v[118:119], v[76:77], v[226:227] op_sel:[0,1,0] op_sel_hi:[1,1,1]
v_pk_mul_f32 v[224:225], v[224:225], v[96:97]
v_pk_mul_f32 v[226:227], v[226:227], v[98:99]
v_cvt_pk_bf16_f32 v34, v224, v225
v_cvt_pk_bf16_f32 v35, v226, v227
v_pk_fma_f32 v[232:233], v[120:121], v[76:77], v[232:233] op_sel:[0,1,0] op_sel_hi:[1,1,1]
v_pk_fma_f32 v[234:235], v[122:123], v[76:77], v[234:235] op_sel:[0,1,0] op_sel_hi:[1,1,1]
v_pk_mul_f32 v[232:233], v[232:233], v[100:101]
v_pk_mul_f32 v[234:235], v[234:235], v[102:103]
v_cvt_pk_bf16_f32 v36, v232, v233
v_cvt_pk_bf16_f32 v37, v234, v235
v_pk_fma_f32 v[240:241], v[124:125], v[76:77], v[240:241] op_sel:[0,1,0] op_sel_hi:[1,1,1]
v_pk_fma_f32 v[242:243], v[126:127], v[76:77], v[242:243] op_sel:[0,1,0] op_sel_hi:[1,1,1]
v_pk_mul_f32 v[240:241], v[240:241], v[104:105]
v_pk_mul_f32 v[242:243], v[242:243], v[106:107]
v_cvt_pk_bf16_f32 v38, v240, v241
v_cvt_pk_bf16_f32 v39, v242, v243
s_mov_b32 s42, 0x3e8293ee
v_max_f32 v148, v152, v153
v_max_f32 v149, v154, v155
v_max_f32 v150, v184, v185
v_max_f32 v151, v186, v187
v_max3_f32 v60, v148, v149, v150
v_max_f32 v60, v60, v151
v_max_f32 v156, v160, v161
v_max_f32 v157, v162, v163
v_max_f32 v158, v192, v193
v_max_f32 v159, v194, v195
v_max3_f32 v61, v156, v157, v158
v_max_f32 v61, v61, v159
v_max_f32 v164, v168, v169
v_max_f32 v165, v170, v171
v_max_f32 v166, v200, v201
v_max_f32 v167, v202, v203
v_max3_f32 v62, v164, v165, v166
v_max_f32 v62, v62, v167
v_max_f32 v172, v176, v177
v_max_f32 v173, v178, v179
v_max_f32 v174, v208, v209
v_max_f32 v175, v210, v211
v_max3_f32 v63, v172, v173, v174
v_max_f32 v63, v63, v175
s_nop 1
v_permlane32_swap_b32 v60, v61
v_permlane32_swap_b32 v62, v63
s_nop 0
v_max_f32 v60, v60, v61
v_max_f32 v62, v62, v63
s_nop 1
v_permlane16_swap_b32 v60, v62
s_nop 0
v_max_f32 v60, v60, v62
v_mul_f32 v60, s42, v60
v_mov_b32 v62, v60
s_nop 1
v_permlane16_swap_b32 v60, v62
s_nop 0
v_mov_b32 v61, v60
v_mov_b32 v63, v62
s_nop 1
v_permlane32_swap_b32 v60, v61
v_permlane32_swap_b32 v62, v63
s_nop 0
v_fma_f32 v148, v148, s42, -v60
v_fma_f32 v149, v149, s42, -v60
v_fma_f32 v150, v150, s42, -v60
v_fma_f32 v151, v151, s42, -v60
v_exp_f32 v148, v148
v_exp_f32 v149, v149
v_exp_f32 v150, v150
v_exp_f32 v151, v151
v_fma_f32 v156, v156, s42, -v61
v_fma_f32 v157, v157, s42, -v61
v_fma_f32 v158, v158, s42, -v61
v_fma_f32 v159, v159, s42, -v61
v_exp_f32 v156, v156
v_exp_f32 v157, v157
v_exp_f32 v158, v158
v_exp_f32 v159, v159
v_fma_f32 v164, v164, s42, -v62
v_fma_f32 v165, v165, s42, -v62
v_fma_f32 v166, v166, s42, -v62
v_fma_f32 v167, v167, s42, -v62
v_exp_f32 v164, v164
v_exp_f32 v165, v165
v_exp_f32 v166, v166
v_exp_f32 v167, v167
v_fma_f32 v172, v172, s42, -v63
v_fma_f32 v173, v173, s42, -v63
v_fma_f32 v174, v174, s42, -v63
v_fma_f32 v175, v175, s42, -v63
v_exp_f32 v172, v172
v_exp_f32 v173, v173
v_exp_f32 v174, v174
v_exp_f32 v175, v175
v_cvt_pk_bf16_f32 v148, v148, v148
v_cvt_pk_bf16_f32 v149, v149, v149
v_cvt_pk_bf16_f32 v150, v150, v150
v_cvt_pk_bf16_f32 v151, v151, v151
v_and_b32 v148, v52, v148
v_and_b32 v149, v52, v149
v_and_b32 v150, v52, v150
v_and_b32 v151, v52, v151
v_cvt_pk_bf16_f32 v156, v156, v156
v_cvt_pk_bf16_f32 v157, v157, v157
v_cvt_pk_bf16_f32 v158, v158, v158
v_cvt_pk_bf16_f32 v159, v159, v159
v_and_b32 v156, v52, v156
v_and_b32 v157, v52, v157
v_and_b32 v158, v52, v158
v_and_b32 v159, v52, v159
v_cvt_pk_bf16_f32 v164, v164, v164
v_cvt_pk_bf16_f32 v165, v165, v165
v_cvt_pk_bf16_f32 v166, v166, v166
v_cvt_pk_bf16_f32 v167, v167, v167
v_and_b32 v164, v52, v164
v_and_b32 v165, v52, v165
v_and_b32 v166, v52, v166
v_and_b32 v167, v52, v167
v_cvt_pk_bf16_f32 v172, v172, v172
v_cvt_pk_bf16_f32 v173, v173, v173
v_cvt_pk_bf16_f32 v174, v174, v174
v_cvt_pk_bf16_f32 v175, v175, v175
v_and_b32 v172, v52, v172
v_and_b32 v173, v52, v173
v_and_b32 v174, v52, v174
v_and_b32 v175, v52, v175
s_nop 1
v_mfma_f32_16x16x32_bf16 v[152:155], v[56:59], v[148:151], 0
v_mfma_f32_16x16x32_bf16 v[212:215], v[20:23], v[148:151], 0
v_mfma_f32_16x16x32_bf16 v[216:219], v[30:33], v[148:151], 0
v_mfma_f32_16x16x32_bf16 v[160:163], v[56:59], v[156:159], 0
v_mfma_f32_16x16x32_bf16 v[220:223], v[22:25], v[156:159], 0
v_mfma_f32_16x16x32_bf16 v[224:227], v[32:35], v[156:159], 0
v_mfma_f32_16x16x32_bf16 v[168:171], v[56:59], v[164:167], 0
v_mfma_f32_16x16x32_bf16 v[228:231], v[24:27], v[164:167], 0
v_mfma_f32_16x16x32_bf16 v[232:235], v[34:37], v[164:167], 0
v_mfma_f32_16x16x32_bf16 v[176:179], v[56:59], v[172:175], 0
v_mfma_f32_16x16x32_bf16 v[236:239], v[26:29], v[172:175], 0
v_mfma_f32_16x16x32_bf16 v[240:243], v[36:39], v[172:175], 0
s_nop 0
s_nop 2
v_rcp_f32 v152, v152
v_rcp_f32 v160, v160
v_rcp_f32 v168, v168
v_rcp_f32 v176, v176
s_nop 7
v_pk_mul_f32 v[212:213], v[212:213], v[152:153] op_sel:[0,0] op_sel_hi:[1,0]
v_pk_mul_f32 v[214:215], v[214:215], v[152:153] op_sel:[0,0] op_sel_hi:[1,0]
v_pk_mul_f32 v[216:217], v[216:217], v[152:153] op_sel:[0,0] op_sel_hi:[1,0]
v_pk_mul_f32 v[218:219], v[218:219], v[152:153] op_sel:[0,0] op_sel_hi:[1,0]
v_cvt_pk_bf16_f32 v212, v212, v213
v_cvt_pk_bf16_f32 v213, v214, v215
v_cvt_pk_bf16_f32 v214, v216, v217
v_cvt_pk_bf16_f32 v215, v218, v219
buffer_store_dwordx4 v[212:215], v18, s[20:23], s46 offen
s_add_u32 s46, s46, 32768
v_pk_mul_f32 v[220:221], v[220:221], v[160:161] op_sel:[0,0] op_sel_hi:[1,0]
v_pk_mul_f32 v[222:223], v[222:223], v[160:161] op_sel:[0,0] op_sel_hi:[1,0]
v_pk_mul_f32 v[224:225], v[224:225], v[160:161] op_sel:[0,0] op_sel_hi:[1,0]
v_pk_mul_f32 v[226:227], v[226:227], v[160:161] op_sel:[0,0] op_sel_hi:[1,0]
v_cvt_pk_bf16_f32 v220, v220, v221
v_cvt_pk_bf16_f32 v221, v222, v223
v_cvt_pk_bf16_f32 v222, v224, v225
v_cvt_pk_bf16_f32 v223, v226, v227
buffer_store_dwordx4 v[220:223], v18, s[20:23], s46 offen
s_add_u32 s46, s46, 32768
v_pk_mul_f32 v[228:229], v[228:229], v[168:169] op_sel:[0,0] op_sel_hi:[1,0]
v_pk_mul_f32 v[230:231], v[230:231], v[168:169] op_sel:[0,0] op_sel_hi:[1,0]
v_pk_mul_f32 v[232:233], v[232:233], v[168:169] op_sel:[0,0] op_sel_hi:[1,0]
v_pk_mul_f32 v[234:235], v[234:235], v[168:169] op_sel:[0,0] op_sel_hi:[1,0]
v_cvt_pk_bf16_f32 v228, v228, v229
v_cvt_pk_bf16_f32 v229, v230, v231
v_cvt_pk_bf16_f32 v230, v232, v233
v_cvt_pk_bf16_f32 v231, v234, v235
buffer_store_dwordx4 v[228:231], v18, s[20:23], s46 offen
s_add_u32 s46, s46, 32768
v_pk_mul_f32 v[236:237], v[236:237], v[176:177] op_sel:[0,0] op_sel_hi:[1,0]
v_pk_mul_f32 v[238:239], v[238:239], v[176:177] op_sel:[0,0] op_sel_hi:[1,0]
v_pk_mul_f32 v[240:241], v[240:241], v[176:177] op_sel:[0,0] op_sel_hi:[1,0]
v_pk_mul_f32 v[242:243], v[242:243], v[176:177] op_sel:[0,0] op_sel_hi:[1,0]
v_cvt_pk_bf16_f32 v236, v236, v237
v_cvt_pk_bf16_f32 v237, v238, v239
v_cvt_pk_bf16_f32 v238, v240, v241
v_cvt_pk_bf16_f32 v239, v242, v243
buffer_store_dwordx4 v[236:239], v18, s[20:23], s46 offen
s_endpgm
qkv2_kernel_loader:
s_sub_u32 s43, s28, 4
v_lshrrev_b32 v4, 3, v0
v_and_b32 v5, 7, v0
s_lshl_b32 s35, s29, 3
s_add_u32 s35, s35, s43
s_lshl_b32 s35, s35, 15
v_lshl_add_u32 v20, v0, 4, s35
v_mov_b32 v21, v20
v_add_u32 v22, 131072, v20
v_add_u32 v23, 131072, v21
v_subrev_u32 v24, 32768, v20
v_subrev_u32 v25, 32768, v21
s_lshr_b32 s35, s43, 1
s_lshl_b32 s35, s35, 5
s_and_b32 s36, s43, 1
s_lshl_b32 s36, s36, 3
s_add_u32 s35, s35, s36
v_lshrrev_b32 v6, 2, v4
v_lshlrev_b32 v6, 4, v6
v_and_b32 v7, 3, v4
v_add3_u32 v6, v6, v7, s35
v_mul_u32_u24 v6, 6144, v6
v_and_b32 v7, 2, v4
v_xor_b32 v7, v7, v5
s_lshl_b32 s35, s30, 7
v_lshl_add_u32 v26, v7, 4, v6
v_add_u32 v26, s35, v26
v_xor_b32 v27, 64, v26
v_add_u32 v27, 23552, v27
s_lshl_b32 s44, s43, 11
v_add_u32 v10, s44, v10
v_add_u32 v11, s44, v11
s_mov_b32 s33, 0
s_mov_b32 s34, 0
s_mov_b32 s32, 0
s_mov_b32 s36, 0xfffefffe
s_mov_b32 s37, s36
s_mov_b64 s[38:39], s[36:37]
s_cmp_lg_u32 s43, 0
s_cbranch_scc1 qkv2_kernel_nofill
v_mov_b32 v40, 0x3f803f80
v_mov_b32 v41, 0x3f803f80
v_mov_b32 v42, 0x3f803f80
v_mov_b32 v43, 0x3f803f80
v_lshlrev_b32 v6, 4, v0
v_add_u32 v7, 86016, v6
ds_write_b128 v6, v[40:43] offset:0
ds_write_b128 v6, v[40:43] offset:1024
ds_write_b128 v6, v[40:43] offset:43008
ds_write_b128 v6, v[40:43] offset:44032
ds_write_b128 v7, v[40:43] offset:0
ds_write_b128 v7, v[40:43] offset:1024
s_waitcnt lgkmcnt(0)
qkv2_kernel_nofill:
s_mov_b32 s31, 0
qkv2_kernel_pro:
s_cmp_lg_u32 s43, 0
s_cbranch_scc1 qkv2_kernel_nohalop
s_mov_b32 m0, s32
s_mov_b64 exec, s[36:37]
buffer_load_dwordx4 v24, s[12:15], s33 offen lds
s_mov_b64 exec, s[38:39]
buffer_load_dwordx4 v25, s[12:15], s33 offen offset:1024 lds
s_mov_b64 exec, -1
qkv2_kernel_nohalop:
s_add_u32 s35, s32, s44
s_add_u32 m0, s35, 18432
s_nop 0
buffer_load_dwordx4 v26, s[16:19], s34 offen lds
buffer_load_dwordx4 v27, s[16:19], s34 offen offset:1024 lds
s_add_u32 m0, s35, 2048
s_nop 0
buffer_load_dwordx4 v20, s[12:15], s33 offen lds
buffer_load_dwordx4 v21, s[12:15], s33 offen offset:1024 lds
s_add_u32 m0, s35, 26624
s_add_u32 s41, s34, 2048
buffer_load_dwordx4 v26, s[16:19], s41 offen lds
buffer_load_dwordx4 v27, s[16:19], s41 offen offset:1024 lds
s_add_u32 m0, s35, 10240
s_nop 0
buffer_load_dwordx4 v22, s[12:15], s33 offen lds
buffer_load_dwordx4 v23, s[12:15], s33 offen offset:1024 lds
s_add_u32 m0, s35, 34816
s_add_u32 s41, s34, 4096
buffer_load_dwordx4 v26, s[16:19], s41 offen lds
buffer_load_dwordx4 v27, s[16:19], s41 offen offset:1024 lds
s_add_u32 s33, s33, 2048
s_add_u32 s34, s34, 393216
s_add_u32 s32, s32, 43008
s_cmp_eq_u32 s32, 129024
s_cselect_b32 s32, 0, s32
s_add_u32 s31, s31, 1
s_cmp_lt_u32 s31, 3
s_cbranch_scc1 qkv2_kernel_pro
v_mov_b32 v30, 0
v_mov_b32 v31, 0
v_mov_b32 v32, 0
v_mov_b32 v33, 0
v_mov_b32 v34, 0
v_mov_b32 v35, 0
v_mov_b32 v36, 0
v_mov_b32 v37, 0
v_mov_b32 v28, 0x3f803f80
s_mov_b32 s40, 0
s_mov_b32 s31, 0
s_waitcnt vmcnt(20)
s_barrier
v_add_u32 v12, s40, v10
v_add_u32 v13, s40, v11
ds_read_b128 v[40:43], v12 offset:2048
ds_read_b128 v[44:47], v13 offset:2048
ds_read_b128 v[48:51], v12 offset:10240
ds_read_b128 v[52:55], v13 offset:10240
ds_read_b128 v[56:59], v12 offset:0
ds_read_b128 v[60:63], v13 offset:0
s_add_u32 s40, s40, 43008
s_cmp_eq_u32 s40, 129024
s_cselect_b32 s40, 0, s40
s_waitcnt lgkmcnt(0)
v_dot2c_f32_bf16 v30, v40, v28
v_dot2c_f32_bf16 v31, v40, v40
v_dot2c_f32_bf16 v32, v48, v28
v_dot2c_f32_bf16 v33, v48, v48
v_dot2c_f32_bf16 v34, v56, v28
v_dot2c_f32_bf16 v35, v56, v56
v_dot2c_f32_bf16 v30, v41, v28
v_dot2c_f32_bf16 v31, v41, v41
v_dot2c_f32_bf16 v32, v49, v28
v_dot2c_f32_bf16 v33, v49, v49
v_dot2c_f32_bf16 v34, v57, v28
v_dot2c_f32_bf16 v35, v57, v57
v_dot2c_f32_bf16 v30, v42, v28
v_dot2c_f32_bf16 v31, v42, v42
v_dot2c_f32_bf16 v32, v50, v28
v_dot2c_f32_bf16 v33, v50, v50
v_dot2c_f32_bf16 v34, v58, v28
v_dot2c_f32_bf16 v35, v58, v58
v_dot2c_f32_bf16 v30, v43, v28
v_dot2c_f32_bf16 v31, v43, v43
v_dot2c_f32_bf16 v32, v51, v28
v_dot2c_f32_bf16 v33, v51, v51
v_dot2c_f32_bf16 v34, v59, v28
v_dot2c_f32_bf16 v35, v59, v59
v_dot2c_f32_bf16 v30, v44, v28
v_dot2c_f32_bf16 v31, v44, v44
v_dot2c_f32_bf16 v32, v52, v28
v_dot2c_f32_bf16 v33, v52, v52
v_dot2c_f32_bf16 v34, v60, v28
v_dot2c_f32_bf16 v35, v60, v60
v_dot2c_f32_bf16 v30, v45, v28
v_dot2c_f32_bf16 v31, v45, v45
v_dot2c_f32_bf16 v32, v53, v28
v_dot2c_f32_bf16 v33, v53, v53
v_dot2c_f32_bf16 v34, v61, v28
v_dot2c_f32_bf16 v35, v61, v61
v_dot2c_f32_bf16 v30, v46, v28
v_dot2c_f32_bf16 v31, v46, v46
v_dot2c_f32_bf16 v32, v54, v28
v_dot2c_f32_bf16 v33, v54, v54
v_dot2c_f32_bf16 v34, v62, v28
v_dot2c_f32_bf16 v35, v62, v62
v_dot2c_f32_bf16 v30, v47, v28
v_dot2c_f32_bf16 v31, v47, v47
v_dot2c_f32_bf16 v32, v55, v28
v_dot2c_f32_bf16 v33, v55, v55
v_dot2c_f32_bf16 v34, v63, v28
v_dot2c_f32_bf16 v35, v63, v63
qkv2_kernel_lloop:
s_waitcnt vmcnt(10)
s_barrier
v_add_u32 v12, s40, v10
v_add_u32 v13, s40, v11
ds_read_b128 v[40:43], v12 offset:2048
ds_read_b128 v[44:47], v13 offset:2048
ds_read_b128 v[48:51], v12 offset:10240
ds_read_b128 v[52:55], v13 offset:10240
ds_read_b128 v[56:59], v12 offset:0
ds_read_b128 v[60:63], v13 offset:0
s_add_u32 s40, s40, 43008
s_cmp_eq_u32 s40, 129024
s_cselect_b32 s40, 0, s40
s_cmp_lg_u32 s43, 0
s_cbranch_scc1 qkv2_kernel_nohalol
s_mov_b32 m0, s32
s_mov_b64 exec, s[36:37]
buffer_load_dwordx4 v24, s[12:15], s33 offen lds
s_mov_b64 exec, s[38:39]
buffer_load_dwordx4 v25, s[12:15], s33 offen offset:1024 lds
s_mov_b64 exec, -1
qkv2_kernel_nohalol:
s_add_u32 s35, s32, s44
s_add_u32 m0, s35, 18432
s_nop 0
buffer_load_dwordx4 v26, s[16:19], s34 offen lds
buffer_load_dwordx4 v27, s[16:19], s34 offen offset:1024 lds
s_waitcnt lgkmcnt(0)
v_dot2c_f32_bf16 v30, v40, v28
v_dot2c_f32_bf16 v31, v40, v40
v_dot2c_f32_bf16 v32, v48, v28
v_dot2c_f32_bf16 v33, v48, v48
v_dot2c_f32_bf16 v34, v56, v28
v_dot2c_f32_bf16 v35, v56, v56
s_add_u32 m0, s35, 2048
s_nop 0
buffer_load_dwordx4 v20, s[12:15], s33 offen lds
v_dot2c_f32_bf16 v30, v41, v28
v_dot2c_f32_bf16 v31, v41, v41
v_dot2c_f32_bf16 v32, v49, v28
v_dot2c_f32_bf16 v33, v49, v49
v_dot2c_f32_bf16 v34, v57, v28
v_dot2c_f32_bf16 v35, v57, v57
buffer_load_dwordx4 v21, s[12:15], s33 offen offset:1024 lds
v_dot2c_f32_bf16 v30, v42, v28
v_dot2c_f32_bf16 v31, v42, v42
v_dot2c_f32_bf16 v32, v50, v28
v_dot2c_f32_bf16 v33, v50, v50
v_dot2c_f32_bf16 v34, v58, v28
v_dot2c_f32_bf16 v35, v58, v58
s_add_u32 m0, s35, 26624
s_add_u32 s41, s34, 2048
buffer_load_dwordx4 v26, s[16:19], s41 offen lds
v_dot2c_f32_bf16 v30, v43, v28
v_dot2c_f32_bf16 v31, v43, v43
v_dot2c_f32_bf16 v32, v51, v28
v_dot2c_f32_bf16 v33, v51, v51
v_dot2c_f32_bf16 v34, v59, v28
v_dot2c_f32_bf16 v35, v59, v59
buffer_load_dwordx4 v27, s[16:19], s41 offen offset:1024 lds
v_dot2c_f32_bf16 v30, v44, v28
v_dot2c_f32_bf16 v31, v44, v44
v_dot2c_f32_bf16 v32, v52, v28
v_dot2c_f32_bf16 v33, v52, v52
v_dot2c_f32_bf16 v34, v60, v28
v_dot2c_f32_bf16 v35, v60, v60
s_add_u32 m0, s35, 10240
s_nop 0
buffer_load_dwordx4 v22, s[12:15], s33 offen lds
v_dot2c_f32_bf16 v30, v45, v28
v_dot2c_f32_bf16 v31, v45, v45
v_dot2c_f32_bf16 v32, v53, v28
v_dot2c_f32_bf16 v33, v53, v53
v_dot2c_f32_bf16 v34, v61, v28
v_dot2c_f32_bf16 v35, v61, v61
buffer_load_dwordx4 v23, s[12:15], s33 offen offset:1024 lds
v_dot2c_f32_bf16 v30, v46, v28
v_dot2c_f32_bf16 v31, v46, v46
v_dot2c_f32_bf16 v32, v54, v28
v_dot2c_f32_bf16 v33, v54, v54
v_dot2c_f32_bf16 v34, v62, v28
v_dot2c_f32_bf16 v35, v62, v62
s_add_u32 m0, s35, 34816
s_add_u32 s41, s34, 4096
buffer_load_dwordx4 v26, s[16:19], s41 offen lds
v_dot2c_f32_bf16 v30, v47, v28
v_dot2c_f32_bf16 v31, v47, v47
v_dot2c_f32_bf16 v32, v55, v28
v_dot2c_f32_bf16 v33, v55, v55
v_dot2c_f32_bf16 v34, v63, v28
v_dot2c_f32_bf16 v35, v63, v63
buffer_load_dwordx4 v27, s[16:19], s41 offen offset:1024 lds
s_add_u32 s33, s33, 2048
s_add_u32 s34, s34, 393216
s_add_u32 s32, s32, 43008
s_cmp_eq_u32 s32, 129024
s_cselect_b32 s32, 0, s32
s_add_u32 s31, s31, 1
s_cmp_lt_u32 s31, 13
s_cbranch_scc1 qkv2_kernel_lloop
s_waitcnt vmcnt(10)
qkv2_kernel_ltail:
s_barrier
v_add_u32 v12, s40, v10
v_add_u32 v13, s40, v11
ds_read_b128 v[40:43], v12 offset:2048
ds_read_b128 v[44:47], v13 offset:2048
ds_read_b128 v[48:51], v12 offset:10240
ds_read_b128 v[52:55], v13 offset:10240
ds_read_b128 v[56:59], v12 offset:0
ds_read_b128 v[60:63], v13 offset:0
s_add_u32 s40, s40, 43008
s_cmp_eq_u32 s40, 129024
s_cselect_b32 s40, 0, s40
s_waitcnt lgkmcnt(0)
v_dot2c_f32_bf16 v30, v40, v28
v_dot2c_f32_bf16 v31, v40, v40
v_dot2c_f32_bf16 v32, v48, v28
v_dot2c_f32_bf16 v33, v48, v48
v_dot2c_f32_bf16 v34, v56, v28
v_dot2c_f32_bf16 v35, v56, v56
v_dot2c_f32_bf16 v30, v41, v28
v_dot2c_f32_bf16 v31, v41, v41
v_dot2c_f32_bf16 v32, v49, v28
v_dot2c_f32_bf16 v33, v49, v49
v_dot2c_f32_bf16 v34, v57, v28
v_dot2c_f32_bf16 v35, v57, v57
v_dot2c_f32_bf16 v30, v42, v28
v_dot2c_f32_bf16 v31, v42, v42
v_dot2c_f32_bf16 v32, v50, v28
v_dot2c_f32_bf16 v33, v50, v50
v_dot2c_f32_bf16 v34, v58, v28
v_dot2c_f32_bf16 v35, v58, v58
v_dot2c_f32_bf16 v30, v43, v28
v_dot2c_f32_bf16 v31, v43, v43
v_dot2c_f32_bf16 v32, v51, v28
v_dot2c_f32_bf16 v33, v51, v51
v_dot2c_f32_bf16 v34, v59, v28
v_dot2c_f32_bf16 v35, v59, v59
v_dot2c_f32_bf16 v30, v44, v28
v_dot2c_f32_bf16 v31, v44, v44
v_dot2c_f32_bf16 v32, v52, v28
v_dot2c_f32_bf16 v33, v52, v52
v_dot2c_f32_bf16 v34, v60, v28
v_dot2c_f32_bf16 v35, v60, v60
v_dot2c_f32_bf16 v30, v45, v28
v_dot2c_f32_bf16 v31, v45, v45
v_dot2c_f32_bf16 v32, v53, v28
v_dot2c_f32_bf16 v33, v53, v53
v_dot2c_f32_bf16 v34, v61, v28
v_dot2c_f32_bf16 v35, v61, v61
v_dot2c_f32_bf16 v30, v46, v28
v_dot2c_f32_bf16 v31, v46, v46
v_dot2c_f32_bf16 v32, v54, v28
v_dot2c_f32_bf16 v33, v54, v54
v_dot2c_f32_bf16 v34, v62, v28
v_dot2c_f32_bf16 v35, v62, v62
v_dot2c_f32_bf16 v30, v47, v28
v_dot2c_f32_bf16 v31, v47, v47
v_dot2c_f32_bf16 v32, v55, v28
v_dot2c_f32_bf16 v33, v55, v55
v_dot2c_f32_bf16 v34, v63, v28
v_dot2c_f32_bf16 v35, v63, v63
s_waitcnt vmcnt(0)
s_add_u32 s31, s31, 1
s_cmp_lt_u32 s31, 15
s_cbranch_scc1 qkv2_kernel_ltail
s_nop 2
s_nop 1
v_permlane32_swap_b32 v30, v31
v_permlane32_swap_b32 v32, v33
s_nop 0
v_add_f32 v30, v30, v31
v_add_f32 v32, v32, v33
s_nop 1
v_permlane16_swap_b32 v30, v32
s_nop 0
v_add_f32 v30, v30, v32
v_mul_f32 v30, 0x3a800000, v30
v_mov_b32 v32, v30
s_nop 1
v_permlane16_swap_b32 v30, v32
s_nop 0
v_mov_b32 v31, v30
v_mov_b32 v33, v32
s_nop 1
v_permlane32_swap_b32 v30, v31
v_permlane32_swap_b32 v32, v33
s_nop 0
s_nop 1
v_permlane32_swap_b32 v34, v35
v_permlane32_swap_b32 v36, v37
s_nop 0
v_add_f32 v34, v34, v35
v_add_f32 v36, v36, v37
s_nop 1
v_permlane16_swap_b32 v34, v36
s_nop 0
v_add_f32 v34, v34, v36
v_mul_f32 v34, 0x3a800000, v34
v_mov_b32 v36, v34
s_nop 1
v_permlane16_swap_b32 v34, v36
s_nop 0
v_mov_b32 v35, v34
v_mov_b32 v37, v36
s_nop 1
v_permlane32_swap_b32 v34, v35
v_permlane32_swap_b32 v36, v37
s_nop 0
s_lshl_b32 s35, s43, 4
v_add_u32 v6, s35, v2
v_lshlrev_b32 v7, 3, v6
v_add_u32 v7, 129024, v7
v_lshlrev_b32 v6, 2, v6
v_add_u32 v6, 130176, v6
v_fma_f32 v31, -v30, v30, v31
v_max_f32 v31, 0, v31
v_add_f32 v31, 0x3727c5ac, v31
v_rsq_f32 v40, v31
v_sub_f32 v41, 0, v30
v_fma_f32 v33, -v32, v32, v33
v_max_f32 v33, 0, v33
v_add_f32 v33, 0x3727c5ac, v33
v_rsq_f32 v42, v33
v_sub_f32 v43, 0, v32
v_fma_f32 v35, -v34, v34, v35
v_max_f32 v35, 0, v35
v_add_f32 v35, 0x3727c5ac, v35
v_rsq_f32 v44, v35
v_sub_f32 v45, 0, v34
s_mov_b64 exec, 0xffff
ds_write_b64 v7, v[40:41] offset:128
ds_write_b32 v6, v40 offset:64
ds_write_b32 v6, v41 offset:640
ds_write_b64 v7, v[42:43] offset:640
ds_write_b32 v6, v42 offset:320
ds_write_b32 v6, v43 offset:896
s_cmp_lg_u32 s43, 0
s_cbranch_scc1 qkv2_kernel_nost
ds_write_b64 v7, v[44:45] offset:0
ds_write_b32 v6, v44 offset:0
ds_write_b32 v6, v45 offset:576
qkv2_kernel_nost:
s_waitcnt lgkmcnt(0)
s_barrier
s_barrier
qkv2_kernel_end:
s_endpgm
.text
.globl out2_kernel
.p2align 8
.type out2_kernel,@function
out2_kernel:
s_cmp_ge_u32 s2, 256
s_cbranch_scc1 out2_kernel_end
s_load_dwordx2 s[8:9], s[0:1], 72
s_load_dwordx2 s[6:7], s[0:1], 16
v_lshrrev_b32 v1, 6, v0
v_and_b32 v0, 63, v0
v_readfirstlane_b32 s28, v1
s_and_b32 s35, s2, 7
s_lshr_b32 s41, s2, 3
s_and_b32 s29, s35, 7
s_lshl_b32 s29, s29, 1
s_and_b32 s30, s41, 1
s_add_u32 s29, s29, s30
s_lshr_b32 s30, s35, 3
s_lshl_b32 s30, s30, 4
s_lshr_b32 s41, s41, 1
s_add_u32 s30, s30, s41
v_and_b32 v2, 15, v0
v_lshrrev_b32 v3, 4, v0
v_lshlrev_b32 v18, 4, v0
v_lshrrev_b32 v4, 3, v0
v_and_b32 v5, 7, v0
s_lshr_b32 s35, s28, 1
s_lshl_b32 s35, s35, 5
s_and_b32 s36, s28, 1
s_lshl_b32 s36, s36, 3
s_add_u32 s35, s35, s36
v_lshrrev_b32 v6, 2, v4
v_lshlrev_b32 v6, 4, v6
v_and_b32 v7, 3, v4
v_add3_u32 v6, v6, v7, s35
v_lshlrev_b32 v6, 11, v6
v_and_b32 v7, 2, v4
v_xor_b32 v7, v7, v5
s_lshl_b32 s35, s30, 7
v_lshl_add_u32 v10, v7, 4, v6
v_add_u32 v10, s35, v10
v_xor_b32 v11, 64, v10
v_add_u32 v11, 7168, v11
s_lshl_b32 s35, s29, 3
s_lshl_b32 s36, s28, 1
s_add_u32 s47, s35, s36
s_lshl_b32 s35, s47, 15
v_add_u32 v12, s35, v18
v_add_u32 v13, 32768, v12
v_lshrrev_b32 v4, 2, v2
v_and_b32 v5, 3, v0
v_lshl_add_u32 v6, v3, 3, v4
v_lshlrev_b32 v6, 7, v6
v_lshl_add_u32 v6, v5, 3, v6
v_lshrrev_b32 v7, 1, v4
v_and_b32 v8, 1, v3
v_lshl_add_u32 v7, v8, 1, v7
v_lshl_add_u32 v14, v7, 5, v6
v_xor_b32 v15, 32, v14
v_xor_b32 v16, 64, v14
v_xor_b32 v17, 96, v14
s_waitcnt lgkmcnt(0)
s_mov_b32 s16, s6
s_and_b32 s17, s7, 0xffff
s_mov_b32 s18, 2097152
s_mov_b32 s19, 0x00020000
s_mov_b32 s20, s8
s_and_b32 s21, s9, 0xffff
s_mov_b32 s22, 268435456
s_mov_b32 s23, 0x00020000
s_lshl_b32 s33, s28, 11
s_mov_b32 s34, 12582912
s_mov_b32 s41, 0
s_add_u32 m0, s33, 0
buffer_load_dwordx4 v[64:67], v12, s[20:23], s34 offen
buffer_load_dwordx4 v10, s[16:19], s41 offen lds
buffer_load_dwordx4 v[68:71], v13, s[20:23], s34 offen
buffer_load_dwordx4 v11, s[16:19], s41 offen offset:1024 lds
buffer_load_dwordx4 v[72:75], v12, s[20:23], s34 offen offset:1024
buffer_load_dwordx4 v[76:79], v13, s[20:23], s34 offen offset:1024
s_add_u32 s34, s34, 2048
s_add_u32 s41, s41, 131072
s_add_u32 m0, s33, 8192
buffer_load_dwordx4 v[80:83], v12, s[20:23], s34 offen
buffer_load_dwordx4 v10, s[16:19], s41 offen lds
buffer_load_dwordx4 v[84:87], v13, s[20:23], s34 offen
buffer_load_dwordx4 v11, s[16:19], s41 offen offset:1024 lds
buffer_load_dwordx4 v[88:91], v12, s[20:23], s34 offen offset:1024
buffer_load_dwordx4 v[92:95], v13, s[20:23], s34 offen offset:1024
s_add_u32 s34, s34, 2048
s_add_u32 s41, s41, 131072
s_add_u32 m0, s33, 16384
buffer_load_dwordx4 v[96:99], v12, s[20:23], s34 offen
buffer_load_dwordx4 v10, s[16:19], s41 offen lds
buffer_load_dwordx4 v[100:103], v13, s[20:23], s34 offen
buffer_load_dwordx4 v11, s[16:19], s41 offen offset:1024 lds
buffer_load_dwordx4 v[104:107], v12, s[20:23], s34 offen offset:1024
buffer_load_dwordx4 v[108:111], v13, s[20:23], s34 offen offset:1024
s_add_u32 s34, s34, 2048
s_add_u32 s41, s41, 131072
s_lshl_b32 s48, s30, 11
s_add_u32 s49, s48, 4194304
v_mov_b32 v160, 0
v_mov_b32 v161, 0
v_mov_b32 v162, 0
v_mov_b32 v163, 0
v_mov_b32 v164, 0
v_mov_b32 v165, 0
v_mov_b32 v166, 0
v_mov_b32 v167, 0
v_mov_b32 v168, 0
v_mov_b32 v169, 0
v_mov_b32 v170, 0
v_mov_b32 v171, 0
v_mov_b32 v172, 0
v_mov_b32 v173, 0
v_mov_b32 v174, 0
v_mov_b32 v175, 0
v_mov_b32 v176, 0
v_mov_b32 v177, 0
v_mov_b32 v178, 0
v_mov_b32 v179, 0
v_mov_b32 v180, 0
v_mov_b32 v181, 0
v_mov_b32 v182, 0
v_mov_b32 v183, 0
v_mov_b32 v184, 0
v_mov_b32 v185, 0
v_mov_b32 v186, 0
v_mov_b32 v187, 0
v_mov_b32 v188, 0
v_mov_b32 v189, 0
v_mov_b32 v190, 0
v_mov_b32 v191, 0
s_waitcnt vmcnt(12)
s_barrier
ds_read_b64_tr_b16 v[128:129], v14 offset:0
ds_read_b64_tr_b16 v[130:131], v14 offset:512
ds_read_b64_tr_b16 v[132:133], v15 offset:0
ds_read_b64_tr_b16 v[134:135], v15 offset:512
ds_read_b64_tr_b16 v[136:137], v16 offset:0
ds_read_b64_tr_b16 v[138:139], v16 offset:512
ds_read_b64_tr_b16 v[140:141], v17 offset:0
ds_read_b64_tr_b16 v[142:143], v17 offset:512
s_waitcnt lgkmcnt(0)
v_mfma_f32_16x16x32_bf16 v[160:163], v[128:131], v[64:67], v[160:163]
ds_read_b64_tr_b16 v[144:145], v14 offset:4096
ds_read_b64_tr_b16 v[146:147], v14 offset:4608
v_mfma_f32_16x16x32_bf16 v[176:179], v[128:131], v[68:71], v[176:179]
ds_read_b64_tr_b16 v[148:149], v15 offset:4096
ds_read_b64_tr_b16 v[150:151], v15 offset:4608
v_mfma_f32_16x16x32_bf16 v[164:167], v[132:135], v[64:67], v[164:167]
ds_read_b64_tr_b16 v[152:153], v16 offset:4096
ds_read_b64_tr_b16 v[154:155], v16 offset:4608
v_mfma_f32_16x16x32_bf16 v[180:183], v[132:135], v[68:71], v[180:183]
ds_read_b64_tr_b16 v[156:157], v17 offset:4096
ds_read_b64_tr_b16 v[158:159], v17 offset:4608
v_mfma_f32_16x16x32_bf16 v[168:171], v[136:139], v[64:67], v[168:171]
s_add_u32 m0, s33, 24576
buffer_load_dwordx4 v[112:115], v12, s[20:23], s34 offen
v_mfma_f32_16x16x32_bf16 v[184:187], v[136:139], v[68:71], v[184:187]
buffer_load_dwordx4 v10, s[16:19], s41 offen lds
buffer_load_dwordx4 v[116:119], v13, s[20:23], s34 offen
v_mfma_f32_16x16x32_bf16 v[172:175], v[140:143], v[64:67], v[172:175]
buffer_load_dwordx4 v11, s[16:19], s41 offen offset:1024 lds
buffer_load_dwordx4 v[120:123], v12, s[20:23], s34 offen offset:1024
v_mfma_f32_16x16x32_bf16 v[188:191], v[140:143], v[68:71], v[188:191]
buffer_load_dwordx4 v[124:127], v13, s[20:23], s34 offen offset:1024
s_add_u32 s34, s34, 2048
s_add_u32 s41, s41, 131072
s_waitcnt vmcnt(12) lgkmcnt(0)
s_barrier
v_mfma_f32_16x16x32_bf16 v[160:163], v[144:147], v[72:75], v[160:163]
ds_read_b64_tr_b16 v[128:129], v14 offset:8192
v_mfma_f32_16x16x32_bf16 v[176:179], v[144:147], v[76:79], v[176:179]
ds_read_b64_tr_b16 v[130:131], v14 offset:8704
v_mfma_f32_16x16x32_bf16 v[164:167], v[148:151], v[72:75], v[164:167]
ds_read_b64_tr_b16 v[132:133], v15 offset:8192
v_mfma_f32_16x16x32_bf16 v[180:183], v[148:151], v[76:79], v[180:183]
ds_read_b64_tr_b16 v[134:135], v15 offset:8704
v_mfma_f32_16x16x32_bf16 v[168:171], v[152:155], v[72:75], v[168:171]
ds_read_b64_tr_b16 v[136:137], v16 offset:8192
v_mfma_f32_16x16x32_bf16 v[184:187], v[152:155], v[76:79], v[184:187]
ds_read_b64_tr_b16 v[138:139], v16 offset:8704
v_mfma_f32_16x16x32_bf16 v[172:175], v[156:159], v[72:75], v[172:175]
ds_read_b64_tr_b16 v[140:141], v17 offset:8192
v_mfma_f32_16x16x32_bf16 v[188:191], v[156:159], v[76:79], v[188:191]
ds_read_b64_tr_b16 v[142:143], v17 offset:8704
s_waitcnt lgkmcnt(0)
v_mfma_f32_16x16x32_bf16 v[160:163], v[128:131], v[80:83], v[160:163]
ds_read_b64_tr_b16 v[144:145], v14 offset:12288
ds_read_b64_tr_b16 v[146:147], v14 offset:12800
v_mfma_f32_16x16x32_bf16 v[176:179], v[128:131], v[84:87], v[176:179]
ds_read_b64_tr_b16 v[148:149], v15 offset:12288
ds_read_b64_tr_b16 v[150:151], v15 offset:12800
v_mfma_f32_16x16x32_bf16 v[164:167], v[132:135], v[80:83], v[164:167]
ds_read_b64_tr_b16 v[152:153], v16 offset:12288
ds_read_b64_tr_b16 v[154:155], v16 offset:12800
v_mfma_f32_16x16x32_bf16 v[180:183], v[132:135], v[84:87], v[180:183]
ds_read_b64_tr_b16 v[156:157], v17 offset:12288
ds_read_b64_tr_b16 v[158:159], v17 offset:12800
v_mfma_f32_16x16x32_bf16 v[168:171], v[136:139], v[80:83], v[168:171]
s_add_u32 m0, s33, 32768
buffer_load_dwordx4 v[64:67], v12, s[20:23], s34 offen
v_mfma_f32_16x16x32_bf16 v[184:187], v[136:139], v[84:87], v[184:187]
buffer_load_dwordx4 v10, s[16:19], s41 offen lds
buffer_load_dwordx4 v[68:71], v13, s[20:23], s34 offen
v_mfma_f32_16x16x32_bf16 v[172:175], v[140:143], v[80:83], v[172:175]
buffer_load_dwordx4 v11, s[16:19], s41 offen offset:1024 lds
buffer_load_dwordx4 v[72:75], v12, s[20:23], s34 offen offset:1024
v_mfma_f32_16x16x32_bf16 v[188:191], v[140:143], v[84:87], v[188:191]
buffer_load_dwordx4 v[76:79], v13, s[20:23], s34 offen offset:1024
s_add_u32 s34, s34, 2048
s_add_u32 s41, s41, 131072
s_waitcnt vmcnt(12) lgkmcnt(0)
s_barrier
v_mfma_f32_16x16x32_bf16 v[160:163], v[144:147], v[88:91], v[160:163]
ds_read_b64_tr_b16 v[128:129], v14 offset:16384
v_mfma_f32_16x16x32_bf16 v[176:179], v[144:147], v[92:95], v[176:179]
ds_read_b64_tr_b16 v[130:131], v14 offset:16896
v_mfma_f32_16x16x32_bf16 v[164:167], v[148:151], v[88:91], v[164:167]
ds_read_b64_tr_b16 v[132:133], v15 offset:16384
v_mfma_f32_16x16x32_bf16 v[180:183], v[148:151], v[92:95], v[180:183]
ds_read_b64_tr_b16 v[134:135], v15 offset:16896
v_mfma_f32_16x16x32_bf16 v[168:171], v[152:155], v[88:91], v[168:171]
ds_read_b64_tr_b16 v[136:137], v16 offset:16384
v_mfma_f32_16x16x32_bf16 v[184:187], v[152:155], v[92:95], v[184:187]
ds_read_b64_tr_b16 v[138:139], v16 offset:16896
v_mfma_f32_16x16x32_bf16 v[172:175], v[156:159], v[88:91], v[172:175]
ds_read_b64_tr_b16 v[140:141], v17 offset:16384
v_mfma_f32_16x16x32_bf16 v[188:191], v[156:159], v[92:95], v[188:191]
ds_read_b64_tr_b16 v[142:143], v17 offset:16896
s_waitcnt lgkmcnt(0)
v_mfma_f32_16x16x32_bf16 v[160:163], v[128:131], v[96:99], v[160:163]
ds_read_b64_tr_b16 v[144:145], v14 offset:20480
ds_read_b64_tr_b16 v[146:147], v14 offset:20992
v_mfma_f32_16x16x32_bf16 v[176:179], v[128:131], v[100:103], v[176:179]
ds_read_b64_tr_b16 v[148:149], v15 offset:20480
ds_read_b64_tr_b16 v[150:151], v15 offset:20992
v_mfma_f32_16x16x32_bf16 v[164:167], v[132:135], v[96:99], v[164:167]
ds_read_b64_tr_b16 v[152:153], v16 offset:20480
ds_read_b64_tr_b16 v[154:155], v16 offset:20992
v_mfma_f32_16x16x32_bf16 v[180:183], v[132:135], v[100:103], v[180:183]
ds_read_b64_tr_b16 v[156:157], v17 offset:20480
ds_read_b64_tr_b16 v[158:159], v17 offset:20992
v_mfma_f32_16x16x32_bf16 v[168:171], v[136:139], v[96:99], v[168:171]
s_add_u32 m0, s33, 40960
buffer_load_dwordx4 v[80:83], v12, s[20:23], s34 offen
v_mfma_f32_16x16x32_bf16 v[184:187], v[136:139], v[100:103], v[184:187]
buffer_load_dwordx4 v10, s[16:19], s41 offen lds
buffer_load_dwordx4 v[84:87], v13, s[20:23], s34 offen
v_mfma_f32_16x16x32_bf16 v[172:175], v[140:143], v[96:99], v[172:175]
buffer_load_dwordx4 v11, s[16:19], s41 offen offset:1024 lds
buffer_load_dwordx4 v[88:91], v12, s[20:23], s34 offen offset:1024
v_mfma_f32_16x16x32_bf16 v[188:191], v[140:143], v[100:103], v[188:191]
buffer_load_dwordx4 v[92:95], v13, s[20:23], s34 offen offset:1024
s_add_u32 s34, s34, 2048
s_add_u32 s41, s41, 131072
s_waitcnt vmcnt(12) lgkmcnt(0)
s_barrier
v_mfma_f32_16x16x32_bf16 v[160:163], v[144:147], v[104:107], v[160:163]
ds_read_b64_tr_b16 v[128:129], v14 offset:24576
v_mfma_f32_16x16x32_bf16 v[176:179], v[144:147], v[108:111], v[176:179]
ds_read_b64_tr_b16 v[130:131], v14 offset:25088
v_mfma_f32_16x16x32_bf16 v[164:167], v[148:151], v[104:107], v[164:167]
ds_read_b64_tr_b16 v[132:133], v15 offset:24576
v_mfma_f32_16x16x32_bf16 v[180:183], v[148:151], v[108:111], v[180:183]
ds_read_b64_tr_b16 v[134:135], v15 offset:25088
v_mfma_f32_16x16x32_bf16 v[168:171], v[152:155], v[104:107], v[168:171]
ds_read_b64_tr_b16 v[136:137], v16 offset:24576
v_mfma_f32_16x16x32_bf16 v[184:187], v[152:155], v[108:111], v[184:187]
ds_read_b64_tr_b16 v[138:139], v16 offset:25088
v_mfma_f32_16x16x32_bf16 v[172:175], v[156:159], v[104:107], v[172:175]
ds_read_b64_tr_b16 v[140:141], v17 offset:24576
v_mfma_f32_16x16x32_bf16 v[188:191], v[156:159], v[108:111], v[188:191]
ds_read_b64_tr_b16 v[142:143], v17 offset:25088
s_waitcnt lgkmcnt(0)
v_mfma_f32_16x16x32_bf16 v[160:163], v[128:131], v[112:115], v[160:163]
ds_read_b64_tr_b16 v[144:145], v14 offset:28672
ds_read_b64_tr_b16 v[146:147], v14 offset:29184
v_mfma_f32_16x16x32_bf16 v[176:179], v[128:131], v[116:119], v[176:179]
ds_read_b64_tr_b16 v[148:149], v15 offset:28672
ds_read_b64_tr_b16 v[150:151], v15 offset:29184
v_mfma_f32_16x16x32_bf16 v[164:167], v[132:135], v[112:115], v[164:167]
ds_read_b64_tr_b16 v[152:153], v16 offset:28672
ds_read_b64_tr_b16 v[154:155], v16 offset:29184
v_mfma_f32_16x16x32_bf16 v[180:183], v[132:135], v[116:119], v[180:183]
ds_read_b64_tr_b16 v[156:157], v17 offset:28672
ds_read_b64_tr_b16 v[158:159], v17 offset:29184
v_mfma_f32_16x16x32_bf16 v[168:171], v[136:139], v[112:115], v[168:171]
s_add_u32 m0, s33, 49152
buffer_load_dwordx4 v[96:99], v12, s[20:23], s34 offen
v_mfma_f32_16x16x32_bf16 v[184:187], v[136:139], v[116:119], v[184:187]
buffer_load_dwordx4 v10, s[16:19], s41 offen lds
buffer_load_dwordx4 v[100:103], v13, s[20:23], s34 offen
v_mfma_f32_16x16x32_bf16 v[172:175], v[140:143], v[112:115], v[172:175]
buffer_load_dwordx4 v11, s[16:19], s41 offen offset:1024 lds
buffer_load_dwordx4 v[104:107], v12, s[20:23], s34 offen offset:1024
v_mfma_f32_16x16x32_bf16 v[188:191], v[140:143], v[116:119], v[188:191]
buffer_load_dwordx4 v[108:111], v13, s[20:23], s34 offen offset:1024
s_add_u32 s34, s34, 2048
s_add_u32 s41, s41, 131072
s_waitcnt vmcnt(12) lgkmcnt(0)
s_barrier
v_mfma_f32_16x16x32_bf16 v[160:163], v[144:147], v[120:123], v[160:163]
ds_read_b64_tr_b16 v[128:129], v14 offset:32768
v_mfma_f32_16x16x32_bf16 v[176:179], v[144:147], v[124:127], v[176:179]
ds_read_b64_tr_b16 v[130:131], v14 offset:33280
v_mfma_f32_16x16x32_bf16 v[164:167], v[148:151], v[120:123], v[164:167]
ds_read_b64_tr_b16 v[132:133], v15 offset:32768
v_mfma_f32_16x16x32_bf16 v[180:183], v[148:151], v[124:127], v[180:183]
ds_read_b64_tr_b16 v[134:135], v15 offset:33280
v_mfma_f32_16x16x32_bf16 v[168:171], v[152:155], v[120:123], v[168:171]
ds_read_b64_tr_b16 v[136:137], v16 offset:32768
v_mfma_f32_16x16x32_bf16 v[184:187], v[152:155], v[124:127], v[184:187]
ds_read_b64_tr_b16 v[138:139], v16 offset:33280
v_mfma_f32_16x16x32_bf16 v[172:175], v[156:159], v[120:123], v[172:175]
ds_read_b64_tr_b16 v[140:141], v17 offset:32768
v_mfma_f32_16x16x32_bf16 v[188:191], v[156:159], v[124:127], v[188:191]
ds_read_b64_tr_b16 v[142:143], v17 offset:33280
s_waitcnt lgkmcnt(0)
v_mfma_f32_16x16x32_bf16 v[160:163], v[128:131], v[64:67], v[160:163]
ds_read_b64_tr_b16 v[144:145], v14 offset:36864
ds_read_b64_tr_b16 v[146:147], v14 offset:37376
v_mfma_f32_16x16x32_bf16 v[176:179], v[128:131], v[68:71], v[176:179]
ds_read_b64_tr_b16 v[148:149], v15 offset:36864
ds_read_b64_tr_b16 v[150:151], v15 offset:37376
v_mfma_f32_16x16x32_bf16 v[164:167], v[132:135], v[64:67], v[164:167]
ds_read_b64_tr_b16 v[152:153], v16 offset:36864
ds_read_b64_tr_b16 v[154:155], v16 offset:37376
v_mfma_f32_16x16x32_bf16 v[180:183], v[132:135], v[68:71], v[180:183]
ds_read_b64_tr_b16 v[156:157], v17 offset:36864
ds_read_b64_tr_b16 v[158:159], v17 offset:37376
v_mfma_f32_16x16x32_bf16 v[168:171], v[136:139], v[64:67], v[168:171]
s_add_u32 m0, s33, 57344
buffer_load_dwordx4 v[112:115], v12, s[20:23], s34 offen
v_mfma_f32_16x16x32_bf16 v[184:187], v[136:139], v[68:71], v[184:187]
buffer_load_dwordx4 v10, s[16:19], s41 offen lds
buffer_load_dwordx4 v[116:119], v13, s[20:23], s34 offen
v_mfma_f32_16x16x32_bf16 v[172:175], v[140:143], v[64:67], v[172:175]
buffer_load_dwordx4 v11, s[16:19], s41 offen offset:1024 lds
buffer_load_dwordx4 v[120:123], v12, s[20:23], s34 offen offset:1024
v_mfma_f32_16x16x32_bf16 v[188:191], v[140:143], v[68:71], v[188:191]
buffer_load_dwordx4 v[124:127], v13, s[20:23], s34 offen offset:1024
s_add_u32 s34, s34, 2048
s_add_u32 s41, s41, 131072
s_waitcnt vmcnt(12) lgkmcnt(0)
s_barrier
v_mfma_f32_16x16x32_bf16 v[160:163], v[144:147], v[72:75], v[160:163]
ds_read_b64_tr_b16 v[128:129], v14 offset:40960
v_mfma_f32_16x16x32_bf16 v[176:179], v[144:147], v[76:79], v[176:179]
ds_read_b64_tr_b16 v[130:131], v14 offset:41472
v_mfma_f32_16x16x32_bf16 v[164:167], v[148:151], v[72:75], v[164:167]
ds_read_b64_tr_b16 v[132:133], v15 offset:40960
v_mfma_f32_16x16x32_bf16 v[180:183], v[148:151], v[76:79], v[180:183]
ds_read_b64_tr_b16 v[134:135], v15 offset:41472
v_mfma_f32_16x16x32_bf16 v[168:171], v[152:155], v[72:75], v[168:171]
ds_read_b64_tr_b16 v[136:137], v16 offset:40960
v_mfma_f32_16x16x32_bf16 v[184:187], v[152:155], v[76:79], v[184:187]
ds_read_b64_tr_b16 v[138:139], v16 offset:41472
v_mfma_f32_16x16x32_bf16 v[172:175], v[156:159], v[72:75], v[172:175]
ds_read_b64_tr_b16 v[140:141], v17 offset:40960
v_mfma_f32_16x16x32_bf16 v[188:191], v[156:159], v[76:79], v[188:191]
ds_read_b64_tr_b16 v[142:143], v17 offset:41472
s_waitcnt lgkmcnt(0)
v_mfma_f32_16x16x32_bf16 v[160:163], v[128:131], v[80:83], v[160:163]
ds_read_b64_tr_b16 v[144:145], v14 offset:45056
ds_read_b64_tr_b16 v[146:147], v14 offset:45568
v_mfma_f32_16x16x32_bf16 v[176:179], v[128:131], v[84:87], v[176:179]
ds_read_b64_tr_b16 v[148:149], v15 offset:45056
ds_read_b64_tr_b16 v[150:151], v15 offset:45568
v_mfma_f32_16x16x32_bf16 v[164:167], v[132:135], v[80:83], v[164:167]
ds_read_b64_tr_b16 v[152:153], v16 offset:45056
ds_read_b64_tr_b16 v[154:155], v16 offset:45568
v_mfma_f32_16x16x32_bf16 v[180:183], v[132:135], v[84:87], v[180:183]
ds_read_b64_tr_b16 v[156:157], v17 offset:45056
ds_read_b64_tr_b16 v[158:159], v17 offset:45568
v_mfma_f32_16x16x32_bf16 v[168:171], v[136:139], v[80:83], v[168:171]
s_add_u32 m0, s33, 65536
buffer_load_dwordx4 v[64:67], v12, s[20:23], s34 offen
v_mfma_f32_16x16x32_bf16 v[184:187], v[136:139], v[84:87], v[184:187]
buffer_load_dwordx4 v10, s[16:19], s41 offen lds
buffer_load_dwordx4 v[68:71], v13, s[20:23], s34 offen
v_mfma_f32_16x16x32_bf16 v[172:175], v[140:143], v[80:83], v[172:175]
buffer_load_dwordx4 v11, s[16:19], s41 offen offset:1024 lds
buffer_load_dwordx4 v[72:75], v12, s[20:23], s34 offen offset:1024
v_mfma_f32_16x16x32_bf16 v[188:191], v[140:143], v[84:87], v[188:191]
buffer_load_dwordx4 v[76:79], v13, s[20:23], s34 offen offset:1024
s_add_u32 s34, s34, 2048
s_add_u32 s41, s41, 131072
s_waitcnt vmcnt(12) lgkmcnt(0)
s_barrier
v_mfma_f32_16x16x32_bf16 v[160:163], v[144:147], v[88:91], v[160:163]
ds_read_b64_tr_b16 v[128:129], v14 offset:49152
v_mfma_f32_16x16x32_bf16 v[176:179], v[144:147], v[92:95], v[176:179]
ds_read_b64_tr_b16 v[130:131], v14 offset:49664
v_mfma_f32_16x16x32_bf16 v[164:167], v[148:151], v[88:91], v[164:167]
ds_read_b64_tr_b16 v[132:133], v15 offset:49152
v_mfma_f32_16x16x32_bf16 v[180:183], v[148:151], v[92:95], v[180:183]
ds_read_b64_tr_b16 v[134:135], v15 offset:49664
v_mfma_f32_16x16x32_bf16 v[168:171], v[152:155], v[88:91], v[168:171]
ds_read_b64_tr_b16 v[136:137], v16 offset:49152
v_mfma_f32_16x16x32_bf16 v[184:187], v[152:155], v[92:95], v[184:187]
ds_read_b64_tr_b16 v[138:139], v16 offset:49664
v_mfma_f32_16x16x32_bf16 v[172:175], v[156:159], v[88:91], v[172:175]
ds_read_b64_tr_b16 v[140:141], v17 offset:49152
v_mfma_f32_16x16x32_bf16 v[188:191], v[156:159], v[92:95], v[188:191]
ds_read_b64_tr_b16 v[142:143], v17 offset:49664
s_waitcnt lgkmcnt(0)
v_mfma_f32_16x16x32_bf16 v[160:163], v[128:131], v[96:99], v[160:163]
ds_read_b64_tr_b16 v[144:145], v14 offset:53248
ds_read_b64_tr_b16 v[146:147], v14 offset:53760
v_mfma_f32_16x16x32_bf16 v[176:179], v[128:131], v[100:103], v[176:179]
ds_read_b64_tr_b16 v[148:149], v15 offset:53248
ds_read_b64_tr_b16 v[150:151], v15 offset:53760
v_mfma_f32_16x16x32_bf16 v[164:167], v[132:135], v[96:99], v[164:167]
ds_read_b64_tr_b16 v[152:153], v16 offset:53248
ds_read_b64_tr_b16 v[154:155], v16 offset:53760
v_mfma_f32_16x16x32_bf16 v[180:183], v[132:135], v[100:103], v[180:183]
ds_read_b64_tr_b16 v[156:157], v17 offset:53248
ds_read_b64_tr_b16 v[158:159], v17 offset:53760
v_mfma_f32_16x16x32_bf16 v[168:171], v[136:139], v[96:99], v[168:171]
s_add_u32 m0, s33, 73728
buffer_load_dwordx4 v[80:83], v12, s[20:23], s34 offen
v_mfma_f32_16x16x32_bf16 v[184:187], v[136:139], v[100:103], v[184:187]
buffer_load_dwordx4 v10, s[16:19], s41 offen lds
buffer_load_dwordx4 v[84:87], v13, s[20:23], s34 offen
v_mfma_f32_16x16x32_bf16 v[172:175], v[140:143], v[96:99], v[172:175]
buffer_load_dwordx4 v11, s[16:19], s41 offen offset:1024 lds
buffer_load_dwordx4 v[88:91], v12, s[20:23], s34 offen offset:1024
v_mfma_f32_16x16x32_bf16 v[188:191], v[140:143], v[100:103], v[188:191]
buffer_load_dwordx4 v[92:95], v13, s[20:23], s34 offen offset:1024
s_add_u32 s34, s34, 2048
s_add_u32 s41, s41, 131072
s_waitcnt vmcnt(12) lgkmcnt(0)
s_barrier
v_mfma_f32_16x16x32_bf16 v[160:163], v[144:147], v[104:107], v[160:163]
ds_read_b64_tr_b16 v[128:129], v14 offset:57344
v_mfma_f32_16x16x32_bf16 v[176:179], v[144:147], v[108:111], v[176:179]
ds_read_b64_tr_b16 v[130:131], v14 offset:57856
v_mfma_f32_16x16x32_bf16 v[164:167], v[148:151], v[104:107], v[164:167]
ds_read_b64_tr_b16 v[132:133], v15 offset:57344
v_mfma_f32_16x16x32_bf16 v[180:183], v[148:151], v[108:111], v[180:183]
ds_read_b64_tr_b16 v[134:135], v15 offset:57856
v_mfma_f32_16x16x32_bf16 v[168:171], v[152:155], v[104:107], v[168:171]
ds_read_b64_tr_b16 v[136:137], v16 offset:57344
v_mfma_f32_16x16x32_bf16 v[184:187], v[152:155], v[108:111], v[184:187]
ds_read_b64_tr_b16 v[138:139], v16 offset:57856
v_mfma_f32_16x16x32_bf16 v[172:175], v[156:159], v[104:107], v[172:175]
ds_read_b64_tr_b16 v[140:141], v17 offset:57344
v_mfma_f32_16x16x32_bf16 v[188:191], v[156:159], v[108:111], v[188:191]
ds_read_b64_tr_b16 v[142:143], v17 offset:57856
s_waitcnt lgkmcnt(0)
v_mfma_f32_16x16x32_bf16 v[160:163], v[128:131], v[112:115], v[160:163]
ds_read_b64_tr_b16 v[144:145], v14 offset:61440
ds_read_b64_tr_b16 v[146:147], v14 offset:61952
v_mfma_f32_16x16x32_bf16 v[176:179], v[128:131], v[116:119], v[176:179]
ds_read_b64_tr_b16 v[148:149], v15 offset:61440
ds_read_b64_tr_b16 v[150:151], v15 offset:61952
v_mfma_f32_16x16x32_bf16 v[164:167], v[132:135], v[112:115], v[164:167]
ds_read_b64_tr_b16 v[152:153], v16 offset:61440
ds_read_b64_tr_b16 v[154:155], v16 offset:61952
v_mfma_f32_16x16x32_bf16 v[180:183], v[132:135], v[116:119], v[180:183]
ds_read_b64_tr_b16 v[156:157], v17 offset:61440
ds_read_b64_tr_b16 v[158:159], v17 offset:61952
v_mfma_f32_16x16x32_bf16 v[168:171], v[136:139], v[112:115], v[168:171]
s_add_u32 m0, s33, 81920
buffer_load_dwordx4 v[96:99], v12, s[20:23], s34 offen
v_mfma_f32_16x16x32_bf16 v[184:187], v[136:139], v[116:119], v[184:187]
buffer_load_dwordx4 v10, s[16:19], s41 offen lds
buffer_load_dwordx4 v[100:103], v13, s[20:23], s34 offen
v_mfma_f32_16x16x32_bf16 v[172:175], v[140:143], v[112:115], v[172:175]
buffer_load_dwordx4 v11, s[16:19], s41 offen offset:1024 lds
buffer_load_dwordx4 v[104:107], v12, s[20:23], s34 offen offset:1024
v_mfma_f32_16x16x32_bf16 v[188:191], v[140:143], v[116:119], v[188:191]
buffer_load_dwordx4 v[108:111], v13, s[20:23], s34 offen offset:1024
s_add_u32 s34, s34, 2048
s_add_u32 s41, s41, 131072
s_waitcnt vmcnt(12) lgkmcnt(0)
s_barrier
v_add_u32 v14, 0x10000, v14
v_add_u32 v15, 0x10000, v15
v_add_u32 v16, 0x10000, v16
v_add_u32 v17, 0x10000, v17
v_mfma_f32_16x16x32_bf16 v[160:163], v[144:147], v[120:123], v[160:163]
ds_read_b64_tr_b16 v[128:129], v14 offset:0
v_mfma_f32_16x16x32_bf16 v[176:179], v[144:147], v[124:127], v[176:179]
ds_read_b64_tr_b16 v[130:131], v14 offset:512
v_mfma_f32_16x16x32_bf16 v[164:167], v[148:151], v[120:123], v[164:167]
ds_read_b64_tr_b16 v[132:133], v15 offset:0
v_mfma_f32_16x16x32_bf16 v[180:183], v[148:151], v[124:127], v[180:183]
ds_read_b64_tr_b16 v[134:135], v15 offset:512
v_mfma_f32_16x16x32_bf16 v[168:171], v[152:155], v[120:123], v[168:171]
ds_read_b64_tr_b16 v[136:137], v16 offset:0
v_mfma_f32_16x16x32_bf16 v[184:187], v[152:155], v[124:127], v[184:187]
ds_read_b64_tr_b16 v[138:139], v16 offset:512
v_mfma_f32_16x16x32_bf16 v[172:175], v[156:159], v[120:123], v[172:175]
ds_read_b64_tr_b16 v[140:141], v17 offset:0
v_mfma_f32_16x16x32_bf16 v[188:191], v[156:159], v[124:127], v[188:191]
ds_read_b64_tr_b16 v[142:143], v17 offset:512
s_waitcnt lgkmcnt(0)
v_mfma_f32_16x16x32_bf16 v[160:163], v[128:131], v[64:67], v[160:163]
ds_read_b64_tr_b16 v[144:145], v14 offset:4096
ds_read_b64_tr_b16 v[146:147], v14 offset:4608
v_mfma_f32_16x16x32_bf16 v[176:179], v[128:131], v[68:71], v[176:179]
ds_read_b64_tr_b16 v[148:149], v15 offset:4096
ds_read_b64_tr_b16 v[150:151], v15 offset:4608
v_mfma_f32_16x16x32_bf16 v[164:167], v[132:135], v[64:67], v[164:167]
ds_read_b64_tr_b16 v[152:153], v16 offset:4096
ds_read_b64_tr_b16 v[154:155], v16 offset:4608
v_mfma_f32_16x16x32_bf16 v[180:183], v[132:135], v[68:71], v[180:183]
ds_read_b64_tr_b16 v[156:157], v17 offset:4096
ds_read_b64_tr_b16 v[158:159], v17 offset:4608
v_mfma_f32_16x16x32_bf16 v[168:171], v[136:139], v[64:67], v[168:171]
s_add_u32 m0, s33, 90112
buffer_load_dwordx4 v[112:115], v12, s[20:23], s34 offen
v_mfma_f32_16x16x32_bf16 v[184:187], v[136:139], v[68:71], v[184:187]
buffer_load_dwordx4 v10, s[16:19], s41 offen lds
buffer_load_dwordx4 v[116:119], v13, s[20:23], s34 offen
v_mfma_f32_16x16x32_bf16 v[172:175], v[140:143], v[64:67], v[172:175]
buffer_load_dwordx4 v11, s[16:19], s41 offen offset:1024 lds
buffer_load_dwordx4 v[120:123], v12, s[20:23], s34 offen offset:1024
v_mfma_f32_16x16x32_bf16 v[188:191], v[140:143], v[68:71], v[188:191]
buffer_load_dwordx4 v[124:127], v13, s[20:23], s34 offen offset:1024
s_add_u32 s34, s34, 2048
s_add_u32 s41, s41, 131072
s_waitcnt vmcnt(12) lgkmcnt(0)
s_barrier
v_mfma_f32_16x16x32_bf16 v[160:163], v[144:147], v[72:75], v[160:163]
ds_read_b64_tr_b16 v[128:129], v14 offset:8192
v_mfma_f32_16x16x32_bf16 v[176:179], v[144:147], v[76:79], v[176:179]
ds_read_b64_tr_b16 v[130:131], v14 offset:8704
v_mfma_f32_16x16x32_bf16 v[164:167], v[148:151], v[72:75], v[164:167]
ds_read_b64_tr_b16 v[132:133], v15 offset:8192
v_mfma_f32_16x16x32_bf16 v[180:183], v[148:151], v[76:79], v[180:183]
ds_read_b64_tr_b16 v[134:135], v15 offset:8704
v_mfma_f32_16x16x32_bf16 v[168:171], v[152:155], v[72:75], v[168:171]
ds_read_b64_tr_b16 v[136:137], v16 offset:8192
v_mfma_f32_16x16x32_bf16 v[184:187], v[152:155], v[76:79], v[184:187]
ds_read_b64_tr_b16 v[138:139], v16 offset:8704
v_mfma_f32_16x16x32_bf16 v[172:175], v[156:159], v[72:75], v[172:175]
ds_read_b64_tr_b16 v[140:141], v17 offset:8192
v_mfma_f32_16x16x32_bf16 v[188:191], v[156:159], v[76:79], v[188:191]
ds_read_b64_tr_b16 v[142:143], v17 offset:8704
s_waitcnt lgkmcnt(0)
v_mfma_f32_16x16x32_bf16 v[160:163], v[128:131], v[80:83], v[160:163]
ds_read_b64_tr_b16 v[144:145], v14 offset:12288
ds_read_b64_tr_b16 v[146:147], v14 offset:12800
v_mfma_f32_16x16x32_bf16 v[176:179], v[128:131], v[84:87], v[176:179]
ds_read_b64_tr_b16 v[148:149], v15 offset:12288
ds_read_b64_tr_b16 v[150:151], v15 offset:12800
v_mfma_f32_16x16x32_bf16 v[164:167], v[132:135], v[80:83], v[164:167]
ds_read_b64_tr_b16 v[152:153], v16 offset:12288
ds_read_b64_tr_b16 v[154:155], v16 offset:12800
v_mfma_f32_16x16x32_bf16 v[180:183], v[132:135], v[84:87], v[180:183]
ds_read_b64_tr_b16 v[156:157], v17 offset:12288
ds_read_b64_tr_b16 v[158:159], v17 offset:12800
v_mfma_f32_16x16x32_bf16 v[168:171], v[136:139], v[80:83], v[168:171]
s_add_u32 m0, s33, 98304
buffer_load_dwordx4 v[64:67], v12, s[20:23], s34 offen
v_mfma_f32_16x16x32_bf16 v[184:187], v[136:139], v[84:87], v[184:187]
buffer_load_dwordx4 v10, s[16:19], s41 offen lds
buffer_load_dwordx4 v[68:71], v13, s[20:23], s34 offen
v_mfma_f32_16x16x32_bf16 v[172:175], v[140:143], v[80:83], v[172:175]
buffer_load_dwordx4 v11, s[16:19], s41 offen offset:1024 lds
buffer_load_dwordx4 v[72:75], v12, s[20:23], s34 offen offset:1024
v_mfma_f32_16x16x32_bf16 v[188:191], v[140:143], v[84:87], v[188:191]
buffer_load_dwordx4 v[76:79], v13, s[20:23], s34 offen offset:1024
s_add_u32 s34, s34, 2048
s_add_u32 s41, s41, 131072
s_waitcnt vmcnt(12) lgkmcnt(0)
s_barrier
v_mfma_f32_16x16x32_bf16 v[160:163], v[144:147], v[88:91], v[160:163]
ds_read_b64_tr_b16 v[128:129], v14 offset:16384
v_mfma_f32_16x16x32_bf16 v[176:179], v[144:147], v[92:95], v[176:179]
ds_read_b64_tr_b16 v[130:131], v14 offset:16896
v_mfma_f32_16x16x32_bf16 v[164:167], v[148:151], v[88:91], v[164:167]
ds_read_b64_tr_b16 v[132:133], v15 offset:16384
v_mfma_f32_16x16x32_bf16 v[180:183], v[148:151], v[92:95], v[180:183]
ds_read_b64_tr_b16 v[134:135], v15 offset:16896
v_mfma_f32_16x16x32_bf16 v[168:171], v[152:155], v[88:91], v[168:171]
ds_read_b64_tr_b16 v[136:137], v16 offset:16384
v_mfma_f32_16x16x32_bf16 v[184:187], v[152:155], v[92:95], v[184:187]
ds_read_b64_tr_b16 v[138:139], v16 offset:16896
v_mfma_f32_16x16x32_bf16 v[172:175], v[156:159], v[88:91], v[172:175]
ds_read_b64_tr_b16 v[140:141], v17 offset:16384
v_mfma_f32_16x16x32_bf16 v[188:191], v[156:159], v[92:95], v[188:191]
ds_read_b64_tr_b16 v[142:143], v17 offset:16896
s_waitcnt lgkmcnt(0)
v_mfma_f32_16x16x32_bf16 v[160:163], v[128:131], v[96:99], v[160:163]
ds_read_b64_tr_b16 v[144:145], v14 offset:20480
ds_read_b64_tr_b16 v[146:147], v14 offset:20992
v_mfma_f32_16x16x32_bf16 v[176:179], v[128:131], v[100:103], v[176:179]
ds_read_b64_tr_b16 v[148:149], v15 offset:20480
ds_read_b64_tr_b16 v[150:151], v15 offset:20992
v_mfma_f32_16x16x32_bf16 v[164:167], v[132:135], v[96:99], v[164:167]
ds_read_b64_tr_b16 v[152:153], v16 offset:20480
ds_read_b64_tr_b16 v[154:155], v16 offset:20992
v_mfma_f32_16x16x32_bf16 v[180:183], v[132:135], v[100:103], v[180:183]
ds_read_b64_tr_b16 v[156:157], v17 offset:20480
ds_read_b64_tr_b16 v[158:159], v17 offset:20992
v_mfma_f32_16x16x32_bf16 v[168:171], v[136:139], v[96:99], v[168:171]
s_add_u32 m0, s33, 106496
buffer_load_dwordx4 v[80:83], v12, s[20:23], s34 offen
v_mfma_f32_16x16x32_bf16 v[184:187], v[136:139], v[100:103], v[184:187]
buffer_load_dwordx4 v10, s[16:19], s41 offen lds
buffer_load_dwordx4 v[84:87], v13, s[20:23], s34 offen
v_mfma_f32_16x16x32_bf16 v[172:175], v[140:143], v[96:99], v[172:175]
buffer_load_dwordx4 v11, s[16:19], s41 offen offset:1024 lds
buffer_load_dwordx4 v[88:91], v12, s[20:23], s34 offen offset:1024
v_mfma_f32_16x16x32_bf16 v[188:191], v[140:143], v[100:103], v[188:191]
buffer_load_dwordx4 v[92:95], v13, s[20:23], s34 offen offset:1024
s_add_u32 s34, s34, 2048
s_add_u32 s41, s41, 131072
s_waitcnt vmcnt(12) lgkmcnt(0)
s_barrier
v_mfma_f32_16x16x32_bf16 v[160:163], v[144:147], v[104:107], v[160:163]
ds_read_b64_tr_b16 v[128:129], v14 offset:24576
v_mfma_f32_16x16x32_bf16 v[176:179], v[144:147], v[108:111], v[176:179]
ds_read_b64_tr_b16 v[130:131], v14 offset:25088
v_mfma_f32_16x16x32_bf16 v[164:167], v[148:151], v[104:107], v[164:167]
ds_read_b64_tr_b16 v[132:133], v15 offset:24576
v_mfma_f32_16x16x32_bf16 v[180:183], v[148:151], v[108:111], v[180:183]
ds_read_b64_tr_b16 v[134:135], v15 offset:25088
v_mfma_f32_16x16x32_bf16 v[168:171], v[152:155], v[104:107], v[168:171]
ds_read_b64_tr_b16 v[136:137], v16 offset:24576
v_mfma_f32_16x16x32_bf16 v[184:187], v[152:155], v[108:111], v[184:187]
ds_read_b64_tr_b16 v[138:139], v16 offset:25088
v_mfma_f32_16x16x32_bf16 v[172:175], v[156:159], v[104:107], v[172:175]
ds_read_b64_tr_b16 v[140:141], v17 offset:24576
v_mfma_f32_16x16x32_bf16 v[188:191], v[156:159], v[108:111], v[188:191]
ds_read_b64_tr_b16 v[142:143], v17 offset:25088
s_waitcnt lgkmcnt(0)
v_mfma_f32_16x16x32_bf16 v[160:163], v[128:131], v[112:115], v[160:163]
ds_read_b64_tr_b16 v[144:145], v14 offset:28672
ds_read_b64_tr_b16 v[146:147], v14 offset:29184
v_mfma_f32_16x16x32_bf16 v[176:179], v[128:131], v[116:119], v[176:179]
ds_read_b64_tr_b16 v[148:149], v15 offset:28672
ds_read_b64_tr_b16 v[150:151], v15 offset:29184
v_mfma_f32_16x16x32_bf16 v[164:167], v[132:135], v[112:115], v[164:167]
ds_read_b64_tr_b16 v[152:153], v16 offset:28672
ds_read_b64_tr_b16 v[154:155], v16 offset:29184
v_mfma_f32_16x16x32_bf16 v[180:183], v[132:135], v[116:119], v[180:183]
ds_read_b64_tr_b16 v[156:157], v17 offset:28672
ds_read_b64_tr_b16 v[158:159], v17 offset:29184
v_mfma_f32_16x16x32_bf16 v[168:171], v[136:139], v[112:115], v[168:171]
s_add_u32 m0, s33, 114688
buffer_load_dwordx4 v[96:99], v12, s[20:23], s34 offen
v_mfma_f32_16x16x32_bf16 v[184:187], v[136:139], v[116:119], v[184:187]
buffer_load_dwordx4 v10, s[16:19], s41 offen lds
buffer_load_dwordx4 v[100:103], v13, s[20:23], s34 offen
v_mfma_f32_16x16x32_bf16 v[172:175], v[140:143], v[112:115], v[172:175]
buffer_load_dwordx4 v11, s[16:19], s41 offen offset:1024 lds
buffer_load_dwordx4 v[104:107], v12, s[20:23], s34 offen offset:1024
v_mfma_f32_16x16x32_bf16 v[188:191], v[140:143], v[116:119], v[188:191]
buffer_load_dwordx4 v[108:111], v13, s[20:23], s34 offen offset:1024
s_add_u32 s34, s34, 2048
s_add_u32 s41, s41, 131072
s_waitcnt vmcnt(12) lgkmcnt(0)
s_barrier
v_mfma_f32_16x16x32_bf16 v[160:163], v[144:147], v[120:123], v[160:163]
ds_read_b64_tr_b16 v[128:129], v14 offset:32768
v_mfma_f32_16x16x32_bf16 v[176:179], v[144:147], v[124:127], v[176:179]
ds_read_b64_tr_b16 v[130:131], v14 offset:33280
v_mfma_f32_16x16x32_bf16 v[164:167], v[148:151], v[120:123], v[164:167]
ds_read_b64_tr_b16 v[132:133], v15 offset:32768
v_mfma_f32_16x16x32_bf16 v[180:183], v[148:151], v[124:127], v[180:183]
ds_read_b64_tr_b16 v[134:135], v15 offset:33280
v_mfma_f32_16x16x32_bf16 v[168:171], v[152:155], v[120:123], v[168:171]
ds_read_b64_tr_b16 v[136:137], v16 offset:32768
v_mfma_f32_16x16x32_bf16 v[184:187], v[152:155], v[124:127], v[184:187]
ds_read_b64_tr_b16 v[138:139], v16 offset:33280
v_mfma_f32_16x16x32_bf16 v[172:175], v[156:159], v[120:123], v[172:175]
ds_read_b64_tr_b16 v[140:141], v17 offset:32768
v_mfma_f32_16x16x32_bf16 v[188:191], v[156:159], v[124:127], v[188:191]
ds_read_b64_tr_b16 v[142:143], v17 offset:33280
s_waitcnt lgkmcnt(0)
v_mfma_f32_16x16x32_bf16 v[160:163], v[128:131], v[64:67], v[160:163]
ds_read_b64_tr_b16 v[144:145], v14 offset:36864
ds_read_b64_tr_b16 v[146:147], v14 offset:37376
v_mfma_f32_16x16x32_bf16 v[176:179], v[128:131], v[68:71], v[176:179]
ds_read_b64_tr_b16 v[148:149], v15 offset:36864
ds_read_b64_tr_b16 v[150:151], v15 offset:37376
v_mfma_f32_16x16x32_bf16 v[164:167], v[132:135], v[64:67], v[164:167]
ds_read_b64_tr_b16 v[152:153], v16 offset:36864
ds_read_b64_tr_b16 v[154:155], v16 offset:37376
v_mfma_f32_16x16x32_bf16 v[180:183], v[132:135], v[68:71], v[180:183]
ds_read_b64_tr_b16 v[156:157], v17 offset:36864
ds_read_b64_tr_b16 v[158:159], v17 offset:37376
v_mfma_f32_16x16x32_bf16 v[168:171], v[136:139], v[64:67], v[168:171]
s_add_u32 m0, s33, 122880
buffer_load_dwordx4 v[112:115], v12, s[20:23], s34 offen
v_mfma_f32_16x16x32_bf16 v[184:187], v[136:139], v[68:71], v[184:187]
buffer_load_dwordx4 v10, s[16:19], s41 offen lds
buffer_load_dwordx4 v[116:119], v13, s[20:23], s34 offen
v_mfma_f32_16x16x32_bf16 v[172:175], v[140:143], v[64:67], v[172:175]
buffer_load_dwordx4 v11, s[16:19], s41 offen offset:1024 lds
buffer_load_dwordx4 v[120:123], v12, s[20:23], s34 offen offset:1024
v_mfma_f32_16x16x32_bf16 v[188:191], v[140:143], v[68:71], v[188:191]
buffer_load_dwordx4 v[124:127], v13, s[20:23], s34 offen offset:1024
s_add_u32 s34, s34, 2048
s_add_u32 s41, s41, 131072
s_waitcnt vmcnt(12) lgkmcnt(0)
s_barrier
v_mfma_f32_16x16x32_bf16 v[160:163], v[144:147], v[72:75], v[160:163]
ds_read_b64_tr_b16 v[128:129], v14 offset:40960
v_mfma_f32_16x16x32_bf16 v[176:179], v[144:147], v[76:79], v[176:179]
ds_read_b64_tr_b16 v[130:131], v14 offset:41472
v_mfma_f32_16x16x32_bf16 v[164:167], v[148:151], v[72:75], v[164:167]
ds_read_b64_tr_b16 v[132:133], v15 offset:40960
v_mfma_f32_16x16x32_bf16 v[180:183], v[148:151], v[76:79], v[180:183]
ds_read_b64_tr_b16 v[134:135], v15 offset:41472
v_mfma_f32_16x16x32_bf16 v[168:171], v[152:155], v[72:75], v[168:171]
ds_read_b64_tr_b16 v[136:137], v16 offset:40960
v_mfma_f32_16x16x32_bf16 v[184:187], v[152:155], v[76:79], v[184:187]
ds_read_b64_tr_b16 v[138:139], v16 offset:41472
v_mfma_f32_16x16x32_bf16 v[172:175], v[156:159], v[72:75], v[172:175]
ds_read_b64_tr_b16 v[140:141], v17 offset:40960
v_mfma_f32_16x16x32_bf16 v[188:191], v[156:159], v[76:79], v[188:191]
ds_read_b64_tr_b16 v[142:143], v17 offset:41472
s_waitcnt lgkmcnt(0)
v_mfma_f32_16x16x32_bf16 v[160:163], v[128:131], v[80:83], v[160:163]
ds_read_b64_tr_b16 v[144:145], v14 offset:45056
ds_read_b64_tr_b16 v[146:147], v14 offset:45568
v_mfma_f32_16x16x32_bf16 v[176:179], v[128:131], v[84:87], v[176:179]
ds_read_b64_tr_b16 v[148:149], v15 offset:45056
v_mfma_f32_16x16x32_bf16 v[164:167], v[132:135], v[80:83], v[164:167]
ds_read_b64_tr_b16 v[150:151], v15 offset:45568
ds_read_b64_tr_b16 v[152:153], v16 offset:45056
v_mfma_f32_16x16x32_bf16 v[180:183], v[132:135], v[84:87], v[180:183]
ds_read_b64_tr_b16 v[154:155], v16 offset:45568
v_mfma_f32_16x16x32_bf16 v[168:171], v[136:139], v[80:83], v[168:171]
ds_read_b64_tr_b16 v[156:157], v17 offset:45056
ds_read_b64_tr_b16 v[158:159], v17 offset:45568
v_mfma_f32_16x16x32_bf16 v[184:187], v[136:139], v[84:87], v[184:187]
buffer_load_dwordx4 v[24:27], v12, s[20:23], s49 offen offset:0
v_mfma_f32_16x16x32_bf16 v[172:175], v[140:143], v[80:83], v[172:175]
buffer_load_dwordx4 v[28:31], v12, s[20:23], s49 offen offset:1024
buffer_load_dwordx4 v[32:35], v13, s[20:23], s49 offen offset:0
v_mfma_f32_16x16x32_bf16 v[188:191], v[140:143], v[84:87], v[188:191]
buffer_load_dwordx4 v[36:39], v13, s[20:23], s49 offen offset:1024
s_waitcnt vmcnt(10) lgkmcnt(0)
s_barrier
v_mfma_f32_16x16x32_bf16 v[160:163], v[144:147], v[88:91], v[160:163]
ds_read_b64_tr_b16 v[128:129], v14 offset:49152
v_mfma_f32_16x16x32_bf16 v[176:179], v[144:147], v[92:95], v[176:179]
ds_read_b64_tr_b16 v[130:131], v14 offset:49664
v_mfma_f32_16x16x32_bf16 v[164:167], v[148:151], v[88:91], v[164:167]
ds_read_b64_tr_b16 v[132:133], v15 offset:49152
v_mfma_f32_16x16x32_bf16 v[180:183], v[148:151], v[92:95], v[180:183]
ds_read_b64_tr_b16 v[134:135], v15 offset:49664
v_mfma_f32_16x16x32_bf16 v[168:171], v[152:155], v[88:91], v[168:171]
ds_read_b64_tr_b16 v[136:137], v16 offset:49152
v_mfma_f32_16x16x32_bf16 v[184:187], v[152:155], v[92:95], v[184:187]
ds_read_b64_tr_b16 v[138:139], v16 offset:49664
v_mfma_f32_16x16x32_bf16 v[172:175], v[156:159], v[88:91], v[172:175]
ds_read_b64_tr_b16 v[140:141], v17 offset:49152
v_mfma_f32_16x16x32_bf16 v[188:191], v[156:159], v[92:95], v[188:191]
ds_read_b64_tr_b16 v[142:143], v17 offset:49664
s_waitcnt lgkmcnt(0)
v_mfma_f32_16x16x32_bf16 v[160:163], v[128:131], v[96:99], v[160:163]
ds_read_b64_tr_b16 v[144:145], v14 offset:53248
v_mfma_f32_16x16x32_bf16 v[176:179], v[128:131], v[100:103], v[176:179]
ds_read_b64_tr_b16 v[146:147], v14 offset:53760
v_mfma_f32_16x16x32_bf16 v[164:167], v[132:135], v[96:99], v[164:167]
ds_read_b64_tr_b16 v[148:149], v15 offset:53248
v_mfma_f32_16x16x32_bf16 v[180:183], v[132:135], v[100:103], v[180:183]
ds_read_b64_tr_b16 v[150:151], v15 offset:53760
v_mfma_f32_16x16x32_bf16 v[168:171], v[136:139], v[96:99], v[168:171]
ds_read_b64_tr_b16 v[152:153], v16 offset:53248
v_mfma_f32_16x16x32_bf16 v[184:187], v[136:139], v[100:103], v[184:187]
ds_read_b64_tr_b16 v[154:155], v16 offset:53760
v_mfma_f32_16x16x32_bf16 v[172:175], v[140:143], v[96:99], v[172:175]
ds_read_b64_tr_b16 v[156:157], v17 offset:53248
v_mfma_f32_16x16x32_bf16 v[188:191], v[140:143], v[100:103], v[188:191]
ds_read_b64_tr_b16 v[158:159], v17 offset:53760
s_waitcnt vmcnt(4) lgkmcnt(0)
s_barrier
v_mfma_f32_16x16x32_bf16 v[160:163], v[144:147], v[104:107], v[160:163]
ds_read_b64_tr_b16 v[128:129], v14 offset:57344
v_mfma_f32_16x16x32_bf16 v[176:179], v[144:147], v[108:111], v[176:179]
ds_read_b64_tr_b16 v[130:131], v14 offset:57856
v_mfma_f32_16x16x32_bf16 v[164:167], v[148:151], v[104:107], v[164:167]
ds_read_b64_tr_b16 v[132:133], v15 offset:57344
v_mfma_f32_16x16x32_bf16 v[180:183], v[148:151], v[108:111], v[180:183]
ds_read_b64_tr_b16 v[134:135], v15 offset:57856
v_mfma_f32_16x16x32_bf16 v[168:171], v[152:155], v[104:107], v[168:171]
ds_read_b64_tr_b16 v[136:137], v16 offset:57344
v_mfma_f32_16x16x32_bf16 v[184:187], v[152:155], v[108:111], v[184:187]
ds_read_b64_tr_b16 v[138:139], v16 offset:57856
v_mfma_f32_16x16x32_bf16 v[172:175], v[156:159], v[104:107], v[172:175]
ds_read_b64_tr_b16 v[140:141], v17 offset:57344
v_mfma_f32_16x16x32_bf16 v[188:191], v[156:159], v[108:111], v[188:191]
ds_read_b64_tr_b16 v[142:143], v17 offset:57856
s_waitcnt lgkmcnt(0)
v_mfma_f32_16x16x32_bf16 v[160:163], v[128:131], v[112:115], v[160:163]
ds_read_b64_tr_b16 v[144:145], v14 offset:61440
v_mfma_f32_16x16x32_bf16 v[176:179], v[128:131], v[116:119], v[176:179]
ds_read_b64_tr_b16 v[146:147], v14 offset:61952
v_mfma_f32_16x16x32_bf16 v[164:167], v[132:135], v[112:115], v[164:167]
ds_read_b64_tr_b16 v[148:149], v15 offset:61440
v_mfma_f32_16x16x32_bf16 v[180:183], v[132:135], v[116:119], v[180:183]
ds_read_b64_tr_b16 v[150:151], v15 offset:61952
v_mfma_f32_16x16x32_bf16 v[168:171], v[136:139], v[112:115], v[168:171]
ds_read_b64_tr_b16 v[152:153], v16 offset:61440
v_mfma_f32_16x16x32_bf16 v[184:187], v[136:139], v[116:119], v[184:187]
ds_read_b64_tr_b16 v[154:155], v16 offset:61952
v_mfma_f32_16x16x32_bf16 v[172:175], v[140:143], v[112:115], v[172:175]
ds_read_b64_tr_b16 v[156:157], v17 offset:61440
v_mfma_f32_16x16x32_bf16 v[188:191], v[140:143], v[116:119], v[188:191]
ds_read_b64_tr_b16 v[158:159], v17 offset:61952
s_waitcnt lgkmcnt(0)
v_mfma_f32_16x16x32_bf16 v[160:163], v[144:147], v[120:123], v[160:163]
v_mfma_f32_16x16x32_bf16 v[176:179], v[144:147], v[124:127], v[176:179]
v_mfma_f32_16x16x32_bf16 v[164:167], v[148:151], v[120:123], v[164:167]
v_mfma_f32_16x16x32_bf16 v[180:183], v[148:151], v[124:127], v[180:183]
v_mfma_f32_16x16x32_bf16 v[168:171], v[152:155], v[120:123], v[168:171]
v_mfma_f32_16x16x32_bf16 v[184:187], v[152:155], v[124:127], v[184:187]
v_mfma_f32_16x16x32_bf16 v[172:175], v[156:159], v[120:123], v[172:175]
v_mfma_f32_16x16x32_bf16 v[188:191], v[156:159], v[124:127], v[188:191]
s_add_u32 s49, s48, 8388608
s_waitcnt vmcnt(0)
s_nop 4
v_lshlrev_b32 v4, 16, v24
v_and_b32 v5, 0xffff0000, v24
v_pk_add_f32 v[160:161], v[160:161], v[4:5]
v_lshlrev_b32 v4, 16, v25
v_and_b32 v5, 0xffff0000, v25
v_pk_add_f32 v[162:163], v[162:163], v[4:5]
v_lshlrev_b32 v4, 16, v26
v_and_b32 v5, 0xffff0000, v26
v_pk_add_f32 v[164:165], v[164:165], v[4:5]
v_lshlrev_b32 v4, 16, v27
v_and_b32 v5, 0xffff0000, v27
v_pk_add_f32 v[166:167], v[166:167], v[4:5]
v_cvt_pk_bf16_f32 v160, v160, v161
v_cvt_pk_bf16_f32 v161, v162, v163
v_cvt_pk_bf16_f32 v162, v164, v165
v_cvt_pk_bf16_f32 v163, v166, v167
buffer_store_dwordx4 v[160:163], v12, s[20:23], s49 offen offset:0
v_lshlrev_b32 v4, 16, v28
v_and_b32 v5, 0xffff0000, v28
v_pk_add_f32 v[168:169], v[168:169], v[4:5]
v_lshlrev_b32 v4, 16, v29
v_and_b32 v5, 0xffff0000, v29
v_pk_add_f32 v[170:171], v[170:171], v[4:5]
v_lshlrev_b32 v4, 16, v30
v_and_b32 v5, 0xffff0000, v30
v_pk_add_f32 v[172:173], v[172:173], v[4:5]
v_lshlrev_b32 v4, 16, v31
v_and_b32 v5, 0xffff0000, v31
v_pk_add_f32 v[174:175], v[174:175], v[4:5]
v_cvt_pk_bf16_f32 v168, v168, v169
v_cvt_pk_bf16_f32 v169, v170, v171
v_cvt_pk_bf16_f32 v170, v172, v173
v_cvt_pk_bf16_f32 v171, v174, v175
buffer_store_dwordx4 v[168:171], v12, s[20:23], s49 offen offset:1024
v_lshlrev_b32 v4, 16, v32
v_and_b32 v5, 0xffff0000, v32
v_pk_add_f32 v[176:177], v[176:177], v[4:5]
v_lshlrev_b32 v4, 16, v33
v_and_b32 v5, 0xffff0000, v33
v_pk_add_f32 v[178:179], v[178:179], v[4:5]
v_lshlrev_b32 v4, 16, v34
v_and_b32 v5, 0xffff0000, v34
v_pk_add_f32 v[180:181], v[180:181], v[4:5]
v_lshlrev_b32 v4, 16, v35
v_and_b32 v5, 0xffff0000, v35
v_pk_add_f32 v[182:183], v[182:183], v[4:5]
v_cvt_pk_bf16_f32 v176, v176, v177
v_cvt_pk_bf16_f32 v177, v178, v179
v_cvt_pk_bf16_f32 v178, v180, v181
v_cvt_pk_bf16_f32 v179, v182, v183
buffer_store_dwordx4 v[176:179], v13, s[20:23], s49 offen offset:0
v_lshlrev_b32 v4, 16, v36
v_and_b32 v5, 0xffff0000, v36
v_pk_add_f32 v[184:185], v[184:185], v[4:5]
v_lshlrev_b32 v4, 16, v37
v_and_b32 v5, 0xffff0000, v37
v_pk_add_f32 v[186:187], v[186:187], v[4:5]
v_lshlrev_b32 v4, 16, v38
v_and_b32 v5, 0xffff0000, v38
v_pk_add_f32 v[188:189], v[188:189], v[4:5]
v_lshlrev_b32 v4, 16, v39
v_and_b32 v5, 0xffff0000, v39
v_pk_add_f32 v[190:191], v[190:191], v[4:5]
v_cvt_pk_bf16_f32 v184, v184, v185
v_cvt_pk_bf16_f32 v185, v186, v187
v_cvt_pk_bf16_f32 v186, v188, v189
v_cvt_pk_bf16_f32 v187, v190, v191
buffer_store_dwordx4 v[184:187], v13, s[20:23], s49 offen offset:1024
out2_kernel_end:
s_endpgm
.text
.globl qkv3_kernel
.p2align 8
.type qkv3_kernel,@function
qkv3_kernel:
s_cmp_ge_u32 s2, 256
s_cbranch_scc1 qkv3_kernel_end
s_load_dwordx2 s[8:9], s[0:1], 72
s_load_dwordx2 s[6:7], s[0:1], 32
s_load_dwordx2 s[10:11], s[0:1], 40
v_lshrrev_b32 v1, 6, v0
v_and_b32 v0, 63, v0
v_readfirstlane_b32 s28, v1
s_and_b32 s35, s2, 7
s_lshr_b32 s41, s2, 3
s_and_b32 s29, s35, 7
s_lshl_b32 s29, s29, 1
s_and_b32 s30, s41, 1
s_add_u32 s29, s29, s30
s_lshr_b32 s30, s35, 3
s_lshl_b32 s30, s30, 4
s_lshr_b32 s41, s41, 1
s_add_u32 s30, s30, s41
v_and_b32 v2, 15, v0
v_lshrrev_b32 v3, 4, v0
v_lshlrev_b32 v10, 4, v0
v_add_u32 v11, 1024, v10
s_waitcnt lgkmcnt(0)
s_add_u32 s4, s8, 8388608
s_addc_u32 s5, s9, 0
s_mov_b32 s12, s4
s_and_b32 s13, s5, 0xffff
s_mov_b32 s14, 4194304
s_mov_b32 s15, 0x00020000
s_mov_b32 s16, s6
s_and_b32 s17, s7, 0xffff
s_mov_b32 s18, 6291456
s_mov_b32 s19, 0x00020000
s_mov_b32 s20, s8
s_and_b32 s21, s9, 0xffff
s_mov_b32 s22, 268435456
s_mov_b32 s23, 0x00020000
s_mov_b32 s24, s10
s_and_b32 s25, s11, 0xffff
s_mov_b32 s26, 65536
s_mov_b32 s27, 0x00020000
s_cmp_ge_u32 s28, 4
s_cbranch_scc1 qkv3_kernel_loader
s_setprio 1
s_and_b32 s43, s28, 1
s_lshr_b32 s44, s28, 1
v_lshrrev_b32 v4, 2, v2
v_and_b32 v5, 3, v0
v_lshl_add_u32 v6, v3, 3, v4
v_lshlrev_b32 v6, 7, v6
v_lshl_add_u32 v6, v5, 3, v6
v_lshrrev_b32 v7, 1, v4
v_and_b32 v8, 1, v3
v_lshl_add_u32 v7, v8, 1, v7
s_lshl_b32 s35, s43, 1
v_xor_b32 v7, s35, v7
v_lshl_add_u32 v12, v7, 5, v6
v_add_u32 v12, 18432, v12
v_xor_b32 v13, 32, v12
v_mov_b32 v14, v10
v_mov_b32 v15, v11
v_mov_b32 v16, v12
v_mov_b32 v17, v13
v_mov_b32 v148, 0
v_mov_b32 v149, 0
v_mov_b32 v150, 0
v_mov_b32 v151, 0
v_mov_b32 v152, 0
v_mov_b32 v153, 0
v_mov_b32 v154, 0
v_mov_b32 v155, 0
v_mov_b32 v156, 0
v_mov_b32 v157, 0
v_mov_b32 v158, 0
v_mov_b32 v159, 0
v_mov_b32 v160, 0
v_mov_b32 v161, 0
v_mov_b32 v162, 0
v_mov_b32 v163, 0
v_mov_b32 v164, 0
v_mov_b32 v165, 0
v_mov_b32 v166, 0
v_mov_b32 v167, 0
v_mov_b32 v168, 0
v_mov_b32 v169, 0
v_mov_b32 v170, 0
v_mov_b32 v171, 0
v_mov_b32 v172, 0
v_mov_b32 v173, 0
v_mov_b32 v174, 0
v_mov_b32 v175, 0
v_mov_b32 v176, 0
v_mov_b32 v177, 0
v_mov_b32 v178, 0
v_mov_b32 v179, 0
v_mov_b32 v180, 0
v_mov_b32 v181, 0
v_mov_b32 v182, 0
v_mov_b32 v183, 0
v_mov_b32 v184, 0
v_mov_b32 v185, 0
v_mov_b32 v186, 0
v_mov_b32 v187, 0
v_mov_b32 v188, 0
v_mov_b32 v189, 0
v_mov_b32 v190, 0
v_mov_b32 v191, 0
v_mov_b32 v192, 0
v_mov_b32 v193, 0
v_mov_b32 v194, 0
v_mov_b32 v195, 0
v_mov_b32 v196, 0
v_mov_b32 v197, 0
v_mov_b32 v198, 0
v_mov_b32 v199, 0
v_mov_b32 v200, 0
v_mov_b32 v201, 0
v_mov_b32 v202, 0
v_mov_b32 v203, 0
v_mov_b32 v204, 0
v_mov_b32 v205, 0
v_mov_b32 v206, 0
v_mov_b32 v207, 0
v_mov_b32 v208, 0
v_mov_b32 v209, 0
v_mov_b32 v210, 0
v_mov_b32 v211, 0
v_mov_b32 v212, 0
v_mov_b32 v213, 0
v_mov_b32 v214, 0
v_mov_b32 v215, 0
v_mov_b32 v216, 0
v_mov_b32 v217, 0
v_mov_b32 v218, 0
v_mov_b32 v219, 0
v_mov_b32 v220, 0
v_mov_b32 v221, 0
v_mov_b32 v222, 0
v_mov_b32 v223, 0
v_mov_b32 v224, 0
v_mov_b32 v225, 0
v_mov_b32 v226, 0
v_mov_b32 v227, 0
v_mov_b32 v228, 0
v_mov_b32 v229, 0
v_mov_b32 v230, 0
v_mov_b32 v231, 0
v_mov_b32 v232, 0
v_mov_b32 v233, 0
v_mov_b32 v234, 0
v_mov_b32 v235, 0
v_mov_b32 v236, 0
v_mov_b32 v237, 0
v_mov_b32 v238, 0
v_mov_b32 v239, 0
v_mov_b32 v240, 0
v_mov_b32 v241, 0
v_mov_b32 v242, 0
v_mov_b32 v243, 0
v_mov_b32 v244, 0
v_mov_b32 v245, 0
v_mov_b32 v246, 0
v_mov_b32 v247, 0
v_mov_b32 v248, 0
v_mov_b32 v249, 0
v_mov_b32 v250, 0
v_mov_b32 v251, 0
v_mov_b32 v252, 0
v_mov_b32 v253, 0
v_mov_b32 v254, 0
v_mov_b32 v255, 0
v_mov_b32 v76, 0x3f803f80
v_mov_b32 v77, 0x3f803f80
v_mov_b32 v78, 0x3f803f80
v_mov_b32 v79, 0x3f803f80
s_mov_b32 s31, 0
s_mov_b32 s32, 0
s_cmp_eq_u32 s44, 1
s_cbranch_scc1 qkv3_kernel_th1
s_barrier
ds_read_b128 v[60:63], v14 offset:2048
ds_read_b128 v[64:67], v14 offset:4096
ds_read_b128 v[68:71], v14 offset:6144
ds_read_b128 v[72:75], v14 offset:8192
ds_read_b64_tr_b16 v[80:81], v16 offset:0
ds_read_b64_tr_b16 v[82:83], v16 offset:512
ds_read_b64_tr_b16 v[84:85], v17 offset:0
ds_read_b64_tr_b16 v[86:87], v17 offset:512
ds_read_b64_tr_b16 v[88:89], v16 offset:8192
ds_read_b64_tr_b16 v[90:91], v16 offset:8704
ds_read_b64_tr_b16 v[92:93], v17 offset:8192
ds_read_b64_tr_b16 v[94:95], v17 offset:8704
ds_read_b64_tr_b16 v[96:97], v16 offset:16384
ds_read_b64_tr_b16 v[98:99], v16 offset:16896
ds_read_b64_tr_b16 v[100:101], v17 offset:16384
ds_read_b64_tr_b16 v[102:103], v17 offset:16896
qkv3_kernel_loop0:
s_add_u32 s32, s32, 43008
s_cmp_eq_u32 s32, 129024
s_cselect_b32 s32, 0, s32
s_waitcnt lgkmcnt(0)
v_mfma_f32_16x16x32_bf16 v[244:247], v[80:83], v[76:79], v[244:247]
ds_read_b128 v[104:107], v15 offset:2048
v_mfma_f32_16x16x32_bf16 v[248:251], v[88:91], v[76:79], v[248:251]
ds_read_b128 v[108:111], v15 offset:4096
v_mfma_f32_16x16x32_bf16 v[252:255], v[76:79], v[96:99], v[252:255]
ds_read_b128 v[112:115], v15 offset:6144
v_mfma_f32_16x16x32_bf16 v[204:207], v[88:91], v[72:75], v[204:207]
ds_read_b128 v[116:119], v15 offset:8192
v_mfma_f32_16x16x32_bf16 v[236:239], v[72:75], v[96:99], v[236:239]
ds_read_b64_tr_b16 v[124:125], v16 offset:4096
v_mfma_f32_16x16x32_bf16 v[172:175], v[80:83], v[72:75], v[172:175]
ds_read_b64_tr_b16 v[126:127], v16 offset:4608
v_mfma_f32_16x16x32_bf16 v[208:211], v[92:95], v[72:75], v[208:211]
ds_read_b64_tr_b16 v[128:129], v17 offset:4096
v_mfma_f32_16x16x32_bf16 v[240:243], v[72:75], v[100:103], v[240:243]
ds_read_b64_tr_b16 v[130:131], v17 offset:4608
v_mfma_f32_16x16x32_bf16 v[176:179], v[84:87], v[72:75], v[176:179]
ds_read_b64_tr_b16 v[132:133], v16 offset:12288
v_mfma_f32_16x16x32_bf16 v[196:199], v[88:91], v[68:71], v[196:199]
ds_read_b64_tr_b16 v[134:135], v16 offset:12800
v_mfma_f32_16x16x32_bf16 v[228:231], v[68:71], v[96:99], v[228:231]
ds_read_b64_tr_b16 v[136:137], v17 offset:12288
v_mfma_f32_16x16x32_bf16 v[164:167], v[80:83], v[68:71], v[164:167]
ds_read_b64_tr_b16 v[138:139], v17 offset:12800
v_mfma_f32_16x16x32_bf16 v[200:203], v[92:95], v[68:71], v[200:203]
ds_read_b64_tr_b16 v[140:141], v16 offset:20480
v_mfma_f32_16x16x32_bf16 v[232:235], v[68:71], v[100:103], v[232:235]
ds_read_b64_tr_b16 v[142:143], v16 offset:20992
v_mfma_f32_16x16x32_bf16 v[168:171], v[84:87], v[68:71], v[168:171]
ds_read_b64_tr_b16 v[144:145], v17 offset:20480
v_mfma_f32_16x16x32_bf16 v[188:191], v[88:91], v[64:67], v[188:191]
ds_read_b64_tr_b16 v[146:147], v17 offset:20992
v_mfma_f32_16x16x32_bf16 v[220:223], v[64:67], v[96:99], v[220:223]
v_mfma_f32_16x16x32_bf16 v[156:159], v[80:83], v[64:67], v[156:159]
v_mfma_f32_16x16x32_bf16 v[192:195], v[92:95], v[64:67], v[192:195]
v_mfma_f32_16x16x32_bf16 v[224:227], v[64:67], v[100:103], v[224:227]
v_mfma_f32_16x16x32_bf16 v[160:163], v[84:87], v[64:67], v[160:163]
v_mfma_f32_16x16x32_bf16 v[180:183], v[88:91], v[60:63], v[180:183]
v_mfma_f32_16x16x32_bf16 v[212:215], v[60:63], v[96:99], v[212:215]
v_mfma_f32_16x16x32_bf16 v[148:151], v[80:83], v[60:63], v[148:151]
v_mfma_f32_16x16x32_bf16 v[184:187], v[92:95], v[60:63], v[184:187]
v_mfma_f32_16x16x32_bf16 v[216:219], v[60:63], v[100:103], v[216:219]
v_mfma_f32_16x16x32_bf16 v[152:155], v[84:87], v[60:63], v[152:155]
s_waitcnt lgkmcnt(0)
s_barrier
v_mfma_f32_16x16x32_bf16 v[244:247], v[124:127], v[76:79], v[244:247]
v_add_u32 v14, s32, v10
v_mfma_f32_16x16x32_bf16 v[248:251], v[132:135], v[76:79], v[248:251]
v_add_u32 v16, s32, v12
v_add_u32 v17, s32, v13
v_mfma_f32_16x16x32_bf16 v[252:255], v[76:79], v[140:143], v[252:255]
ds_read_b128 v[60:63], v14 offset:2048
v_mfma_f32_16x16x32_bf16 v[204:207], v[132:135], v[116:119], v[204:207]
ds_read_b128 v[64:67], v14 offset:4096
v_mfma_f32_16x16x32_bf16 v[236:239], v[116:119], v[140:143], v[236:239]
ds_read_b128 v[68:71], v14 offset:6144
v_mfma_f32_16x16x32_bf16 v[172:175], v[124:127], v[116:119], v[172:175]
ds_read_b128 v[72:75], v14 offset:8192
v_mfma_f32_16x16x32_bf16 v[208:211], v[136:139], v[116:119], v[208:211]
ds_read_b64_tr_b16 v[80:81], v16 offset:0
v_mfma_f32_16x16x32_bf16 v[240:243], v[116:119], v[144:147], v[240:243]
ds_read_b64_tr_b16 v[82:83], v16 offset:512
v_mfma_f32_16x16x32_bf16 v[176:179], v[128:131], v[116:119], v[176:179]
ds_read_b64_tr_b16 v[84:85], v17 offset:0
v_mfma_f32_16x16x32_bf16 v[196:199], v[132:135], v[112:115], v[196:199]
ds_read_b64_tr_b16 v[86:87], v17 offset:512
v_mfma_f32_16x16x32_bf16 v[228:231], v[112:115], v[140:143], v[228:231]
ds_read_b64_tr_b16 v[88:89], v16 offset:8192
v_mfma_f32_16x16x32_bf16 v[164:167], v[124:127], v[112:115], v[164:167]
ds_read_b64_tr_b16 v[90:91], v16 offset:8704
v_mfma_f32_16x16x32_bf16 v[200:203], v[136:139], v[112:115], v[200:203]
ds_read_b64_tr_b16 v[92:93], v17 offset:8192
v_mfma_f32_16x16x32_bf16 v[232:235], v[112:115], v[144:147], v[232:235]
ds_read_b64_tr_b16 v[94:95], v17 offset:8704
v_mfma_f32_16x16x32_bf16 v[168:171], v[128:131], v[112:115], v[168:171]
ds_read_b64_tr_b16 v[96:97], v16 offset:16384
v_mfma_f32_16x16x32_bf16 v[188:191], v[132:135], v[108:111], v[188:191]
ds_read_b64_tr_b16 v[98:99], v16 offset:16896
v_mfma_f32_16x16x32_bf16 v[220:223], v[108:111], v[140:143], v[220:223]
ds_read_b64_tr_b16 v[100:101], v17 offset:16384
v_mfma_f32_16x16x32_bf16 v[156:159], v[124:127], v[108:111], v[156:159]
ds_read_b64_tr_b16 v[102:103], v17 offset:16896
v_mfma_f32_16x16x32_bf16 v[192:195], v[136:139], v[108:111], v[192:195]
v_add_u32 v15, s32, v11
v_mfma_f32_16x16x32_bf16 v[224:227], v[108:111], v[144:147], v[224:227]
s_add_u32 s31, s31, 1
v_mfma_f32_16x16x32_bf16 v[160:163], v[128:131], v[108:111], v[160:163]
s_cmp_lt_u32 s31, 16
v_mfma_f32_16x16x32_bf16 v[180:183], v[132:135], v[104:107], v[180:183]
v_mfma_f32_16x16x32_bf16 v[212:215], v[104:107], v[140:143], v[212:215]
v_mfma_f32_16x16x32_bf16 v[148:151], v[124:127], v[104:107], v[148:151]
v_mfma_f32_16x16x32_bf16 v[184:187], v[136:139], v[104:107], v[184:187]
v_mfma_f32_16x16x32_bf16 v[216:219], v[104:107], v[144:147], v[216:219]
v_mfma_f32_16x16x32_bf16 v[152:155], v[128:131], v[104:107], v[152:155]
s_cbranch_scc1 qkv3_kernel_loop0
s_branch qkv3_kernel_epi
qkv3_kernel_th1:
s_barrier
ds_read_b128 v[60:63], v14 offset:10240
ds_read_b128 v[64:67], v14 offset:12288
ds_read_b128 v[68:71], v14 offset:14336
ds_read_b128 v[72:75], v14 offset:16384
ds_read_b64_tr_b16 v[80:81], v16 offset:0
ds_read_b64_tr_b16 v[82:83], v16 offset:512
ds_read_b64_tr_b16 v[84:85], v17 offset:0
ds_read_b64_tr_b16 v[86:87], v17 offset:512
ds_read_b64_tr_b16 v[88:89], v16 offset:8192
ds_read_b64_tr_b16 v[90:91], v16 offset:8704
ds_read_b64_tr_b16 v[92:93], v17 offset:8192
ds_read_b64_tr_b16 v[94:95], v17 offset:8704
ds_read_b64_tr_b16 v[96:97], v16 offset:16384
ds_read_b64_tr_b16 v[98:99], v16 offset:16896
ds_read_b64_tr_b16 v[100:101], v17 offset:16384
ds_read_b64_tr_b16 v[102:103], v17 offset:16896
qkv3_kernel_loop1:
s_add_u32 s32, s32, 43008
s_cmp_eq_u32 s32, 129024
s_cselect_b32 s32, 0, s32
s_waitcnt lgkmcnt(0)
v_mfma_f32_16x16x32_bf16 v[244:247], v[84:87], v[76:79], v[244:247]
ds_read_b128 v[104:107], v15 offset:10240
v_mfma_f32_16x16x32_bf16 v[248:251], v[92:95], v[76:79], v[248:251]
ds_read_b128 v[108:111], v15 offset:12288
v_mfma_f32_16x16x32_bf16 v[252:255], v[76:79], v[100:103], v[252:255]
ds_read_b128 v[112:115], v15 offset:14336
v_mfma_f32_16x16x32_bf16 v[204:207], v[88:91], v[72:75], v[204:207]
ds_read_b128 v[116:119], v15 offset:16384
v_mfma_f32_16x16x32_bf16 v[236:239], v[72:75], v[96:99], v[236:239]
ds_read_b64_tr_b16 v[124:125], v16 offset:4096
v_mfma_f32_16x16x32_bf16 v[172:175], v[80:83], v[72:75], v[172:175]
ds_read_b64_tr_b16 v[126:127], v16 offset:4608
v_mfma_f32_16x16x32_bf16 v[208:211], v[92:95], v[72:75], v[208:211]
ds_read_b64_tr_b16 v[128:129], v17 offset:4096
v_mfma_f32_16x16x32_bf16 v[240:243], v[72:75], v[100:103], v[240:243]
ds_read_b64_tr_b16 v[130:131], v17 offset:4608
v_mfma_f32_16x16x32_bf16 v[176:179], v[84:87], v[72:75], v[176:179]
ds_read_b64_tr_b16 v[132:133], v16 offset:12288
v_mfma_f32_16x16x32_bf16 v[196:199], v[88:91], v[68:71], v[196:199]
ds_read_b64_tr_b16 v[134:135], v16 offset:12800
v_mfma_f32_16x16x32_bf16 v[228:231], v[68:71], v[96:99], v[228:231]
ds_read_b64_tr_b16 v[136:137], v17 offset:12288
v_mfma_f32_16x16x32_bf16 v[164:167], v[80:83], v[68:71], v[164:167]
ds_read_b64_tr_b16 v[138:139], v17 offset:12800
v_mfma_f32_16x16x32_bf16 v[200:203], v[92:95], v[68:71], v[200:203]
ds_read_b64_tr_b16 v[140:141], v16 offset:20480
v_mfma_f32_16x16x32_bf16 v[232:235], v[68:71], v[100:103], v[232:235]
ds_read_b64_tr_b16 v[142:143], v16 offset:20992
v_mfma_f32_16x16x32_bf16 v[168:171], v[84:87], v[68:71], v[168:171]
ds_read_b64_tr_b16 v[144:145], v17 offset:20480
v_mfma_f32_16x16x32_bf16 v[188:191], v[88:91], v[64:67], v[188:191]
ds_read_b64_tr_b16 v[146:147], v17 offset:20992
v_mfma_f32_16x16x32_bf16 v[220:223], v[64:67], v[96:99], v[220:223]
v_mfma_f32_16x16x32_bf16 v[156:159], v[80:83], v[64:67], v[156:159]
v_mfma_f32_16x16x32_bf16 v[192:195], v[92:95], v[64:67], v[192:195]
v_mfma_f32_16x16x32_bf16 v[224:227], v[64:67], v[100:103], v[224:227]
v_mfma_f32_16x16x32_bf16 v[160:163], v[84:87], v[64:67], v[160:163]
v_mfma_f32_16x16x32_bf16 v[180:183], v[88:91], v[60:63], v[180:183]
v_mfma_f32_16x16x32_bf16 v[212:215], v[60:63], v[96:99], v[212:215]
v_mfma_f32_16x16x32_bf16 v[148:151], v[80:83], v[60:63], v[148:151]
v_mfma_f32_16x16x32_bf16 v[184:187], v[92:95], v[60:63], v[184:187]
v_mfma_f32_16x16x32_bf16 v[216:219], v[60:63], v[100:103], v[216:219]
v_mfma_f32_16x16x32_bf16 v[152:155], v[84:87], v[60:63], v[152:155]
s_waitcnt lgkmcnt(0)
s_barrier
v_mfma_f32_16x16x32_bf16 v[244:247], v[128:131], v[76:79], v[244:247]
v_add_u32 v14, s32, v10
v_mfma_f32_16x16x32_bf16 v[248:251], v[136:139], v[76:79], v[248:251]
v_add_u32 v16, s32, v12
v_add_u32 v17, s32, v13
v_mfma_f32_16x16x32_bf16 v[252:255], v[76:79], v[144:147], v[252:255]
ds_read_b128 v[60:63], v14 offset:10240
v_mfma_f32_16x16x32_bf16 v[204:207], v[132:135], v[116:119], v[204:207]
ds_read_b128 v[64:67], v14 offset:12288
v_mfma_f32_16x16x32_bf16 v[236:239], v[116:119], v[140:143], v[236:239]
ds_read_b128 v[68:71], v14 offset:14336
v_mfma_f32_16x16x32_bf16 v[172:175], v[124:127], v[116:119], v[172:175]
ds_read_b128 v[72:75], v14 offset:16384
v_mfma_f32_16x16x32_bf16 v[208:211], v[136:139], v[116:119], v[208:211]
ds_read_b64_tr_b16 v[80:81], v16 offset:0
v_mfma_f32_16x16x32_bf16 v[240:243], v[116:119], v[144:147], v[240:243]
ds_read_b64_tr_b16 v[82:83], v16 offset:512
v_mfma_f32_16x16x32_bf16 v[176:179], v[128:131], v[116:119], v[176:179]
ds_read_b64_tr_b16 v[84:85], v17 offset:0
v_mfma_f32_16x16x32_bf16 v[196:199], v[132:135], v[112:115], v[196:199]
ds_read_b64_tr_b16 v[86:87], v17 offset:512
v_mfma_f32_16x16x32_bf16 v[228:231], v[112:115], v[140:143], v[228:231]
ds_read_b64_tr_b16 v[88:89], v16 offset:8192
v_mfma_f32_16x16x32_bf16 v[164:167], v[124:127], v[112:115], v[164:167]
ds_read_b64_tr_b16 v[90:91], v16 offset:8704
v_mfma_f32_16x16x32_bf16 v[200:203], v[136:139], v[112:115], v[200:203]
ds_read_b64_tr_b16 v[92:93], v17 offset:8192
v_mfma_f32_16x16x32_bf16 v[232:235], v[112:115], v[144:147], v[232:235]
ds_read_b64_tr_b16 v[94:95], v17 offset:8704
v_mfma_f32_16x16x32_bf16 v[168:171], v[128:131], v[112:115], v[168:171]
ds_read_b64_tr_b16 v[96:97], v16 offset:16384
v_mfma_f32_16x16x32_bf16 v[188:191], v[132:135], v[108:111], v[188:191]
ds_read_b64_tr_b16 v[98:99], v16 offset:16896
v_mfma_f32_16x16x32_bf16 v[220:223], v[108:111], v[140:143], v[220:223]
ds_read_b64_tr_b16 v[100:101], v17 offset:16384
v_mfma_f32_16x16x32_bf16 v[156:159], v[124:127], v[108:111], v[156:159]
ds_read_b64_tr_b16 v[102:103], v17 offset:16896
v_mfma_f32_16x16x32_bf16 v[192:195], v[136:139], v[108:111], v[192:195]
v_add_u32 v15, s32, v11
v_mfma_f32_16x16x32_bf16 v[224:227], v[108:111], v[144:147], v[224:227]
s_add_u32 s31, s31, 1
v_mfma_f32_16x16x32_bf16 v[160:163], v[128:131], v[108:111], v[160:163]
s_cmp_lt_u32 s31, 16
v_mfma_f32_16x16x32_bf16 v[180:183], v[132:135], v[104:107], v[180:183]
v_mfma_f32_16x16x32_bf16 v[212:215], v[104:107], v[140:143], v[212:215]
v_mfma_f32_16x16x32_bf16 v[148:151], v[124:127], v[104:107], v[148:151]
v_mfma_f32_16x16x32_bf16 v[184:187], v[136:139], v[104:107], v[184:187]
v_mfma_f32_16x16x32_bf16 v[216:219], v[104:107], v[144:147], v[216:219]
v_mfma_f32_16x16x32_bf16 v[152:155], v[128:131], v[104:107], v[152:155]
s_cbranch_scc1 qkv3_kernel_loop1
qkv3_kernel_epi:
v_lshlrev_b32 v4, 4, v0
s_mul_i32 s35, s28, 3072
s_add_u32 s35, s35, 131328
v_add_u32 v5, s35, v4
s_waitcnt lgkmcnt(0)
ds_write_b128 v5, v[244:247] offset:0
ds_write_b128 v5, v[248:251] offset:1024
ds_write_b128 v5, v[252:255] offset:2048
s_mul_i32 s35, s43, 3072
s_add_u32 s35, s35, 131328
v_lshlrev_b32 v6, 8, v3
v_add_u32 v6, s35, v6
v_lshlrev_b32 v7, 4, v2
v_add_u32 v7, s35, v7
s_lshl_b32 s36, s44, 6
v_add_u32 v8, s36, v2
v_lshlrev_b32 v8, 3, v8
v_add_u32 v8, 129024, v8
v_lshl_add_u32 v9, v3, 2, s36
v_lshlrev_b32 v9, 2, v9
v_add_u32 v9, 130176, v9
s_waitcnt lgkmcnt(0)
s_barrier
ds_read_b128 v[60:63], v6 offset:0
ds_read_b128 v[64:67], v6 offset:6144
ds_read_b128 v[68:71], v6 offset:1024
ds_read_b128 v[72:75], v6 offset:7168
ds_read_b64 v[80:81], v8 offset:128
ds_read_b64 v[82:83], v8 offset:256
ds_read_b64 v[84:85], v8 offset:384
ds_read_b64 v[86:87], v8 offset:512
ds_read_b32 v76, v7 offset:2048
ds_read_b32 v77, v7 offset:8192
ds_read_b128 v[92:95], v9 offset:64
ds_read_b128 v[112:115], v9 offset:640
ds_read_b128 v[96:99], v9 offset:128
ds_read_b128 v[116:119], v9 offset:704
ds_read_b128 v[100:103], v9 offset:192
ds_read_b128 v[120:123], v9 offset:768
ds_read_b128 v[104:107], v9 offset:256
ds_read_b128 v[124:127], v9 offset:832
v_lshrrev_b32 v4, 2, v2
v_lshl_add_u32 v4, v3, 2, v4
v_lshlrev_b32 v4, 6, v4
v_and_b32 v5, 3, v0
v_lshl_add_u32 v4, v5, 3, v4
s_lshl_b32 s35, s43, 11
s_add_u32 s35, s35, 143616
v_add_u32 v4, s35, v4
ds_read_b64_tr_b16 v[40:41], v4 offset:0
ds_read_b64_tr_b16 v[42:43], v4 offset:1024
ds_read_b64_tr_b16 v[44:45], v4 offset:32
ds_read_b64_tr_b16 v[46:47], v4 offset:1056
s_waitcnt lgkmcnt(14)
s_lshl_b32 s35, s29, 3
s_lshl_b32 s36, s44, 2
s_add_u32 s35, s35, s36
s_lshl_b32 s35, s35, 5
s_lshl_b32 s45, s30, 1
s_add_u32 s45, s45, s43
s_add_u32 s35, s35, s45
s_lshl_b32 s35, s35, 10
s_add_u32 s46, s35, 16777216
v_lshlrev_b32 v18, 4, v0
v_pk_fma_f32 v[148:149], v[60:61], v[80:81], v[148:149] op_sel:[0,1,0] op_sel_hi:[1,1,1]
v_pk_fma_f32 v[150:151], v[62:63], v[80:81], v[150:151] op_sel:[0,1,0] op_sel_hi:[1,1,1]
v_pk_fma_f32 v[152:153], v[64:65], v[80:81], v[152:153] op_sel:[0,1,0] op_sel_hi:[1,1,1]
v_pk_fma_f32 v[154:155], v[66:67], v[80:81], v[154:155] op_sel:[0,1,0] op_sel_hi:[1,1,1]
v_pk_mul_f32 v[148:149], v[148:149], v[80:81] op_sel:[0,0] op_sel_hi:[1,0]
v_pk_mul_f32 v[150:151], v[150:151], v[80:81] op_sel:[0,0] op_sel_hi:[1,0]
v_pk_mul_f32 v[152:153], v[152:153], v[80:81] op_sel:[0,0] op_sel_hi:[1,0]
v_pk_mul_f32 v[154:155], v[154:155], v[80:81] op_sel:[0,0] op_sel_hi:[1,0]
v_cvt_pk_bf16_f32 v148, v148, v149
v_cvt_pk_bf16_f32 v149, v150, v151
v_cvt_pk_bf16_f32 v150, v152, v153
v_cvt_pk_bf16_f32 v151, v154, v155
buffer_store_dwordx4 v[148:151], v18, s[20:23], s46 offen
s_add_u32 s46, s46, 32768
v_pk_fma_f32 v[156:157], v[60:61], v[82:83], v[156:157] op_sel:[0,1,0] op_sel_hi:[1,1,1]
v_pk_fma_f32 v[158:159], v[62:63], v[82:83], v[158:159] op_sel:[0,1,0] op_sel_hi:[1,1,1]
v_pk_fma_f32 v[160:161], v[64:65], v[82:83], v[160:161] op_sel:[0,1,0] op_sel_hi:[1,1,1]
v_pk_fma_f32 v[162:163], v[66:67], v[82:83], v[162:163] op_sel:[0,1,0] op_sel_hi:[1,1,1]
v_pk_mul_f32 v[156:157], v[156:157], v[82:83] op_sel:[0,0] op_sel_hi:[1,0]
v_pk_mul_f32 v[158:159], v[158:159], v[82:83] op_sel:[0,0] op_sel_hi:[1,0]
v_pk_mul_f32 v[160:161], v[160:161], v[82:83] op_sel:[0,0] op_sel_hi:[1,0]
v_pk_mul_f32 v[162:163], v[162:163], v[82:83] op_sel:[0,0] op_sel_hi:[1,0]
v_cvt_pk_bf16_f32 v156, v156, v157
v_cvt_pk_bf16_f32 v157, v158, v159
v_cvt_pk_bf16_f32 v158, v160, v161
v_cvt_pk_bf16_f32 v159, v162, v163
buffer_store_dwordx4 v[156:159], v18, s[20:23], s46 offen
s_add_u32 s46, s46, 32768
v_pk_fma_f32 v[164:165], v[60:61], v[84:85], v[164:165] op_sel:[0,1,0] op_sel_hi:[1,1,1]
v_pk_fma_f32 v[166:167], v[62:63], v[84:85], v[166:167] op_sel:[0,1,0] op_sel_hi:[1,1,1]
v_pk_fma_f32 v[168:169], v[64:65], v[84:85], v[168:169] op_sel:[0,1,0] op_sel_hi:[1,1,1]
v_pk_fma_f32 v[170:171], v[66:67], v[84:85], v[170:171] op_sel:[0,1,0] op_sel_hi:[1,1,1]
v_pk_mul_f32 v[164:165], v[164:165], v[84:85] op_sel:[0,0] op_sel_hi:[1,0]
v_pk_mul_f32 v[166:167], v[166:167], v[84:85] op_sel:[0,0] op_sel_hi:[1,0]
v_pk_mul_f32 v[168:169], v[168:169], v[84:85] op_sel:[0,0] op_sel_hi:[1,0]
v_pk_mul_f32 v[170:171], v[170:171], v[84:85] op_sel:[0,0] op_sel_hi:[1,0]
v_cvt_pk_bf16_f32 v164, v164, v165
v_cvt_pk_bf16_f32 v165, v166, v167
v_cvt_pk_bf16_f32 v166, v168, v169
v_cvt_pk_bf16_f32 v167, v170, v171
buffer_store_dwordx4 v[164:167], v18, s[20:23], s46 offen
s_add_u32 s46, s46, 32768
v_pk_fma_f32 v[172:173], v[60:61], v[86:87], v[172:173] op_sel:[0,1,0] op_sel_hi:[1,1,1]
v_pk_fma_f32 v[174:175], v[62:63], v[86:87], v[174:175] op_sel:[0,1,0] op_sel_hi:[1,1,1]
v_pk_fma_f32 v[176:177], v[64:65], v[86:87], v[176:177] op_sel:[0,1,0] op_sel_hi:[1,1,1]
v_pk_fma_f32 v[178:179], v[66:67], v[86:87], v[178:179] op_sel:[0,1,0] op_sel_hi:[1,1,1]
v_pk_mul_f32 v[172:173], v[172:173], v[86:87] op_sel:[0,0] op_sel_hi:[1,0]
v_pk_mul_f32 v[174:175], v[174:175], v[86:87] op_sel:[0,0] op_sel_hi:[1,0]
v_pk_mul_f32 v[176:177], v[176:177], v[86:87] op_sel:[0,0] op_sel_hi:[1,0]
v_pk_mul_f32 v[178:179], v[178:179], v[86:87] op_sel:[0,0] op_sel_hi:[1,0]
v_cvt_pk_bf16_f32 v172, v172, v173
v_cvt_pk_bf16_f32 v173, v174, v175
v_cvt_pk_bf16_f32 v174, v176, v177
v_cvt_pk_bf16_f32 v175, v178, v179
buffer_store_dwordx4 v[172:175], v18, s[20:23], s46 offen
v_pk_fma_f32 v[180:181], v[68:69], v[80:81], v[180:181] op_sel:[0,1,0] op_sel_hi:[1,1,1]
v_pk_fma_f32 v[182:183], v[70:71], v[80:81], v[182:183] op_sel:[0,1,0] op_sel_hi:[1,1,1]
v_pk_fma_f32 v[184:185], v[72:73], v[80:81], v[184:185] op_sel:[0,1,0] op_sel_hi:[1,1,1]
v_pk_fma_f32 v[186:187], v[74:75], v[80:81], v[186:187] op_sel:[0,1,0] op_sel_hi:[1,1,1]
v_pk_mul_f32 v[180:181], v[180:181], v[80:81] op_sel:[0,0] op_sel_hi:[1,0]
v_pk_mul_f32 v[182:183], v[182:183], v[80:81] op_sel:[0,0] op_sel_hi:[1,0]
v_pk_mul_f32 v[184:185], v[184:185], v[80:81] op_sel:[0,0] op_sel_hi:[1,0]
v_pk_mul_f32 v[186:187], v[186:187], v[80:81] op_sel:[0,0] op_sel_hi:[1,0]
v_cvt_pk_bf16_f32 v180, v180, v181
v_cvt_pk_bf16_f32 v181, v182, v183
v_cvt_pk_bf16_f32 v182, v184, v185
v_cvt_pk_bf16_f32 v183, v186, v187
v_pk_fma_f32 v[188:189], v[68:69], v[82:83], v[188:189] op_sel:[0,1,0] op_sel_hi:[1,1,1]
v_pk_fma_f32 v[190:191], v[70:71], v[82:83], v[190:191] op_sel:[0,1,0] op_sel_hi:[1,1,1]
v_pk_fma_f32 v[192:193], v[72:73], v[82:83], v[192:193] op_sel:[0,1,0] op_sel_hi:[1,1,1]
v_pk_fma_f32 v[194:195], v[74:75], v[82:83], v[194:195] op_sel:[0,1,0] op_sel_hi:[1,1,1]
v_pk_mul_f32 v[188:189], v[188:189], v[82:83] op_sel:[0,0] op_sel_hi:[1,0]
v_pk_mul_f32 v[190:191], v[190:191], v[82:83] op_sel:[0,0] op_sel_hi:[1,0]
v_pk_mul_f32 v[192:193], v[192:193], v[82:83] op_sel:[0,0] op_sel_hi:[1,0]
v_pk_mul_f32 v[194:195], v[194:195], v[82:83] op_sel:[0,0] op_sel_hi:[1,0]
v_cvt_pk_bf16_f32 v188, v188, v189
v_cvt_pk_bf16_f32 v189, v190, v191
v_cvt_pk_bf16_f32 v190, v192, v193
v_cvt_pk_bf16_f32 v191, v194, v195
v_pk_fma_f32 v[196:197], v[68:69], v[84:85], v[196:197] op_sel:[0,1,0] op_sel_hi:[1,1,1]
v_pk_fma_f32 v[198:199], v[70:71], v[84:85], v[198:199] op_sel:[0,1,0] op_sel_hi:[1,1,1]
v_pk_fma_f32 v[200:201], v[72:73], v[84:85], v[200:201] op_sel:[0,1,0] op_sel_hi:[1,1,1]
v_pk_fma_f32 v[202:203], v[74:75], v[84:85], v[202:203] op_sel:[0,1,0] op_sel_hi:[1,1,1]
v_pk_mul_f32 v[196:197], v[196:197], v[84:85] op_sel:[0,0] op_sel_hi:[1,0]
v_pk_mul_f32 v[198:199], v[198:199], v[84:85] op_sel:[0,0] op_sel_hi:[1,0]
v_pk_mul_f32 v[200:201], v[200:201], v[84:85] op_sel:[0,0] op_sel_hi:[1,0]
v_pk_mul_f32 v[202:203], v[202:203], v[84:85] op_sel:[0,0] op_sel_hi:[1,0]
v_cvt_pk_bf16_f32 v196, v196, v197
v_cvt_pk_bf16_f32 v197, v198, v199
v_cvt_pk_bf16_f32 v198, v200, v201
v_cvt_pk_bf16_f32 v199, v202, v203
v_pk_fma_f32 v[204:205], v[68:69], v[86:87], v[204:205] op_sel:[0,1,0] op_sel_hi:[1,1,1]
v_pk_fma_f32 v[206:207], v[70:71], v[86:87], v[206:207] op_sel:[0,1,0] op_sel_hi:[1,1,1]
v_pk_fma_f32 v[208:209], v[72:73], v[86:87], v[208:209] op_sel:[0,1,0] op_sel_hi:[1,1,1]
v_pk_fma_f32 v[210:211], v[74:75], v[86:87], v[210:211] op_sel:[0,1,0] op_sel_hi:[1,1,1]
v_pk_mul_f32 v[204:205], v[204:205], v[86:87] op_sel:[0,0] op_sel_hi:[1,0]
v_pk_mul_f32 v[206:207], v[206:207], v[86:87] op_sel:[0,0] op_sel_hi:[1,0]
v_pk_mul_f32 v[208:209], v[208:209], v[86:87] op_sel:[0,0] op_sel_hi:[1,0]
v_pk_mul_f32 v[210:211], v[210:211], v[86:87] op_sel:[0,0] op_sel_hi:[1,0]
v_cvt_pk_bf16_f32 v204, v204, v205
v_cvt_pk_bf16_f32 v205, v206, v207
v_cvt_pk_bf16_f32 v206, v208, v209
v_cvt_pk_bf16_f32 v207, v210, v211
s_waitcnt lgkmcnt(0)
v_pk_fma_f32 v[212:213], v[112:113], v[76:77], v[212:213] op_sel:[0,0,0] op_sel_hi:[1,0,1]
v_pk_fma_f32 v[214:215], v[114:115], v[76:77], v[214:215] op_sel:[0,0,0] op_sel_hi:[1,0,1]
v_pk_mul_f32 v[212:213], v[212:213], v[92:93]
v_pk_mul_f32 v[214:215], v[214:215], v[94:95]
v_cvt_pk_bf16_f32 v22, v212, v213
v_cvt_pk_bf16_f32 v23, v214, v215
v_pk_fma_f32 v[220:221], v[116:117], v[76:77], v[220:221] op_sel:[0,0,0] op_sel_hi:[1,0,1]
v_pk_fma_f32 v[222:223], v[118:119], v[76:77], v[222:223] op_sel:[0,0,0] op_sel_hi:[1,0,1]
v_pk_mul_f32 v[220:221], v[220:221], v[96:97]
v_pk_mul_f32 v[222:223], v[222:223], v[98:99]
v_cvt_pk_bf16_f32 v24, v220, v221
v_cvt_pk_bf16_f32 v25, v222, v223
v_pk_fma_f32 v[228:229], v[120:121], v[76:77], v[228:229] op_sel:[0,0,0] op_sel_hi:[1,0,1]
v_pk_fma_f32 v[230:231], v[122:123], v[76:77], v[230:231] op_sel:[0,0,0] op_sel_hi:[1,0,1]
v_pk_mul_f32 v[228:229], v[228:229], v[100:101]
v_pk_mul_f32 v[230:231], v[230:231], v[102:103]
v_cvt_pk_bf16_f32 v26, v228, v229
v_cvt_pk_bf16_f32 v27, v230, v231
v_pk_fma_f32 v[236:237], v[124:125], v[76:77], v[236:237] op_sel:[0,0,0] op_sel_hi:[1,0,1]
v_pk_fma_f32 v[238:239], v[126:127], v[76:77], v[238:239] op_sel:[0,0,0] op_sel_hi:[1,0,1]
v_pk_mul_f32 v[236:237], v[236:237], v[104:105]
v_pk_mul_f32 v[238:239], v[238:239], v[106:107]
v_cvt_pk_bf16_f32 v28, v236, v237
v_cvt_pk_bf16_f32 v29, v238, v239
v_pk_fma_f32 v[216:217], v[112:113], v[76:77], v[216:217] op_sel:[0,1,0] op_sel_hi:[1,1,1]
v_pk_fma_f32 v[218:219], v[114:115], v[76:77], v[218:219] op_sel:[0,1,0] op_sel_hi:[1,1,1]
v_pk_mul_f32 v[216:217], v[216:217], v[92:93]
v_pk_mul_f32 v[218:219], v[218:219], v[94:95]
v_cvt_pk_bf16_f32 v32, v216, v217
v_cvt_pk_bf16_f32 v33, v218, v219
v_pk_fma_f32 v[224:225], v[116:117], v[76:77], v[224:225] op_sel:[0,1,0] op_sel_hi:[1,1,1]
v_pk_fma_f32 v[226:227], v[118:119], v[76:77], v[226:227] op_sel:[0,1,0] op_sel_hi:[1,1,1]
v_pk_mul_f32 v[224:225], v[224:225], v[96:97]
v_pk_mul_f32 v[226:227], v[226:227], v[98:99]
v_cvt_pk_bf16_f32 v34, v224, v225
v_cvt_pk_bf16_f32 v35, v226, v227
v_pk_fma_f32 v[232:233], v[120:121], v[76:77], v[232:233] op_sel:[0,1,0] op_sel_hi:[1,1,1]
v_pk_fma_f32 v[234:235], v[122:123], v[76:77], v[234:235] op_sel:[0,1,0] op_sel_hi:[1,1,1]
v_pk_mul_f32 v[232:233], v[232:233], v[100:101]
v_pk_mul_f32 v[234:235], v[234:235], v[102:103]
v_cvt_pk_bf16_f32 v36, v232, v233
v_cvt_pk_bf16_f32 v37, v234, v235
v_pk_fma_f32 v[240:241], v[124:125], v[76:77], v[240:241] op_sel:[0,1,0] op_sel_hi:[1,1,1]
v_pk_fma_f32 v[242:243], v[126:127], v[76:77], v[242:243] op_sel:[0,1,0] op_sel_hi:[1,1,1]
v_pk_mul_f32 v[240:241], v[240:241], v[104:105]
v_pk_mul_f32 v[242:243], v[242:243], v[106:107]
v_cvt_pk_bf16_f32 v38, v240, v241
v_cvt_pk_bf16_f32 v39, v242, v243
s_mov_b32 s42, 0x3fb8aa3b
s_lshl_b32 s35, s28, 12
s_add_u32 s35, s35, 32768
v_add_u32 v5, s35, v18
ds_write_b128 v5, v[22:25] offset:0
ds_write_b128 v5, v[26:29] offset:1024
ds_write_b128 v5, v[32:35] offset:2048
ds_write_b128 v5, v[36:39] offset:3072
v_mfma_f32_16x16x32_bf16 v[60:63], v[40:43], v[180:183], 0
v_mfma_f32_16x16x32_bf16 v[64:67], v[44:47], v[180:183], 0
v_mfma_f32_16x16x32_bf16 v[68:71], v[40:43], v[188:191], 0
v_mfma_f32_16x16x32_bf16 v[72:75], v[44:47], v[188:191], 0
v_mfma_f32_16x16x32_bf16 v[76:79], v[40:43], v[196:199], 0
v_mfma_f32_16x16x32_bf16 v[80:83], v[44:47], v[196:199], 0
v_mfma_f32_16x16x32_bf16 v[84:87], v[40:43], v[204:207], 0
v_mfma_f32_16x16x32_bf16 v[88:91], v[44:47], v[204:207], 0
s_nop 4
v_max3_f32 v48, v60, v61, v62
v_min3_f32 v52, v60, v61, v62
v_max3_f32 v48, v48, v63, v64
v_min3_f32 v52, v52, v63, v64
v_max3_f32 v48, v48, v65, v66
v_min3_f32 v52, v52, v65, v66
v_max_f32 v48, v48, v67
v_min_f32 v52, v52, v67
v_max3_f32 v49, v68, v69, v70
v_min3_f32 v53, v68, v69, v70
v_max3_f32 v49, v49, v71, v72
v_min3_f32 v53, v53, v71, v72
v_max3_f32 v49, v49, v73, v74
v_min3_f32 v53, v53, v73, v74
v_max_f32 v49, v49, v75
v_min_f32 v53, v53, v75
v_max3_f32 v50, v76, v77, v78
v_min3_f32 v54, v76, v77, v78
v_max3_f32 v50, v50, v79, v80
v_min3_f32 v54, v54, v79, v80
v_max3_f32 v50, v50, v81, v82
v_min3_f32 v54, v54, v81, v82
v_max_f32 v50, v50, v83
v_min_f32 v54, v54, v83
s_nop 1
v_max3_f32 v51, v84, v85, v86
v_min3_f32 v55, v84, v85, v86
v_max3_f32 v51, v51, v87, v88
v_min3_f32 v55, v55, v87, v88
v_max3_f32 v51, v51, v89, v90
v_min3_f32 v55, v55, v89, v90
v_max_f32 v51, v51, v91
v_min_f32 v55, v55, v91
s_nop 1
v_permlane32_swap_b32 v48, v49
v_permlane32_swap_b32 v50, v51
s_nop 0
v_max_f32 v48, v48, v49
v_max_f32 v50, v50, v51
s_nop 1
v_permlane16_swap_b32 v48, v50
s_nop 0
v_max_f32 v48, v48, v50
v_mul_f32 v48, s42, v48
v_mov_b32 v50, v48
s_nop 1
v_permlane16_swap_b32 v48, v50
s_nop 0
v_mov_b32 v49, v48
v_mov_b32 v51, v50
s_nop 1
v_permlane32_swap_b32 v48, v49
v_permlane32_swap_b32 v50, v51
s_nop 0
s_nop 1
v_permlane32_swap_b32 v52, v53
v_permlane32_swap_b32 v54, v55
s_nop 0
v_min_f32 v52, v52, v53
v_min_f32 v54, v54, v55
s_nop 1
v_permlane16_swap_b32 v52, v54
s_nop 0
v_min_f32 v52, v52, v54
v_mul_f32 v52, s42, v52
v_mov_b32 v54, v52
s_nop 1
v_permlane16_swap_b32 v52, v54
s_nop 0
v_mov_b32 v53, v52
v_mov_b32 v55, v54
s_nop 1
v_permlane32_swap_b32 v52, v53
v_permlane32_swap_b32 v54, v55
s_nop 0
v_fma_f32 v92, -v60, s42, v52
v_fma_f32 v60, v60, s42, -v48
v_fma_f32 v93, -v61, s42, v52
v_fma_f32 v61, v61, s42, -v48
v_fma_f32 v94, -v62, s42, v52
v_fma_f32 v62, v62, s42, -v48
v_fma_f32 v95, -v63, s42, v52
v_fma_f32 v63, v63, s42, -v48
v_fma_f32 v96, -v64, s42, v52
v_fma_f32 v64, v64, s42, -v48
v_fma_f32 v97, -v65, s42, v52
v_fma_f32 v65, v65, s42, -v48
v_fma_f32 v98, -v66, s42, v52
v_fma_f32 v66, v66, s42, -v48
v_fma_f32 v99, -v67, s42, v52
v_fma_f32 v67, v67, s42, -v48
v_exp_f32 v92, v92
v_exp_f32 v60, v60
v_exp_f32 v93, v93
v_exp_f32 v61, v61
v_exp_f32 v94, v94
v_exp_f32 v62, v62
v_exp_f32 v95, v95
v_exp_f32 v63, v63
v_exp_f32 v96, v96
v_exp_f32 v64, v64
v_exp_f32 v97, v97
v_exp_f32 v65, v65
v_exp_f32 v98, v98
v_exp_f32 v66, v66
v_exp_f32 v99, v99
v_exp_f32 v67, v67
v_fma_f32 v100, -v68, s42, v53
v_fma_f32 v68, v68, s42, -v49
v_fma_f32 v101, -v69, s42, v53
v_fma_f32 v69, v69, s42, -v49
v_fma_f32 v102, -v70, s42, v53
v_fma_f32 v70, v70, s42, -v49
v_fma_f32 v103, -v71, s42, v53
v_fma_f32 v71, v71, s42, -v49
v_fma_f32 v104, -v72, s42, v53
v_fma_f32 v72, v72, s42, -v49
v_fma_f32 v105, -v73, s42, v53
v_fma_f32 v73, v73, s42, -v49
v_fma_f32 v106, -v74, s42, v53
v_fma_f32 v74, v74, s42, -v49
v_fma_f32 v107, -v75, s42, v53
v_fma_f32 v75, v75, s42, -v49
v_exp_f32 v100, v100
v_exp_f32 v68, v68
v_exp_f32 v101, v101
v_exp_f32 v69, v69
v_exp_f32 v102, v102
v_exp_f32 v70, v70
v_exp_f32 v103, v103
v_exp_f32 v71, v71
v_exp_f32 v104, v104
v_exp_f32 v72, v72
v_exp_f32 v105, v105
v_exp_f32 v73, v73
v_exp_f32 v106, v106
v_exp_f32 v74, v74
v_exp_f32 v107, v107
v_exp_f32 v75, v75
v_fma_f32 v108, -v76, s42, v54
v_fma_f32 v76, v76, s42, -v50
v_fma_f32 v109, -v77, s42, v54
v_fma_f32 v77, v77, s42, -v50
v_fma_f32 v110, -v78, s42, v54
v_fma_f32 v78, v78, s42, -v50
v_fma_f32 v111, -v79, s42, v54
v_fma_f32 v79, v79, s42, -v50
v_fma_f32 v112, -v80, s42, v54
v_fma_f32 v80, v80, s42, -v50
v_fma_f32 v113, -v81, s42, v54
v_fma_f32 v81, v81, s42, -v50
v_fma_f32 v114, -v82, s42, v54
v_fma_f32 v82, v82, s42, -v50
v_fma_f32 v115, -v83, s42, v54
v_fma_f32 v83, v83, s42, -v50
v_exp_f32 v108, v108
v_exp_f32 v76, v76
v_exp_f32 v109, v109
v_exp_f32 v77, v77
v_exp_f32 v110, v110
v_exp_f32 v78, v78
v_exp_f32 v111, v111
v_exp_f32 v79, v79
v_exp_f32 v112, v112
v_exp_f32 v80, v80
v_exp_f32 v113, v113
v_exp_f32 v81, v81
v_exp_f32 v114, v114
v_exp_f32 v82, v82
v_exp_f32 v115, v115
v_exp_f32 v83, v83
v_fma_f32 v116, -v84, s42, v55
v_fma_f32 v84, v84, s42, -v51
v_fma_f32 v117, -v85, s42, v55
v_fma_f32 v85, v85, s42, -v51
v_fma_f32 v118, -v86, s42, v55
v_fma_f32 v86, v86, s42, -v51
v_fma_f32 v119, -v87, s42, v55
v_fma_f32 v87, v87, s42, -v51
v_fma_f32 v120, -v88, s42, v55
v_fma_f32 v88, v88, s42, -v51
v_fma_f32 v121, -v89, s42, v55
v_fma_f32 v89, v89, s42, -v51
v_fma_f32 v122, -v90, s42, v55
v_fma_f32 v90, v90, s42, -v51
v_fma_f32 v123, -v91, s42, v55
v_fma_f32 v91, v91, s42, -v51
v_exp_f32 v116, v116
v_exp_f32 v84, v84
v_exp_f32 v117, v117
v_exp_f32 v85, v85
v_exp_f32 v118, v118
v_exp_f32 v86, v86
v_exp_f32 v119, v119
v_exp_f32 v87, v87
v_exp_f32 v120, v120
v_exp_f32 v88, v88
v_exp_f32 v121, v121
v_exp_f32 v89, v89
v_exp_f32 v122, v122
v_exp_f32 v90, v90
v_exp_f32 v123, v123
v_exp_f32 v91, v91
s_nop 0
v_add_f32 v48, v60, v61
v_add_f32 v52, v92, v93
v_add_f32 v48, v48, v62
v_add_f32 v52, v52, v94
v_add_f32 v48, v48, v63
v_add_f32 v52, v52, v95
v_add_f32 v48, v48, v64
v_add_f32 v52, v52, v96
v_add_f32 v48, v48, v65
v_add_f32 v52, v52, v97
v_add_f32 v48, v48, v66
v_add_f32 v52, v52, v98
v_add_f32 v48, v48, v67
v_add_f32 v52, v52, v99
v_add_f32 v49, v68, v69
v_add_f32 v53, v100, v101
v_add_f32 v49, v49, v70
v_add_f32 v53, v53, v102
v_add_f32 v49, v49, v71
v_add_f32 v53, v53, v103
v_add_f32 v49, v49, v72
v_add_f32 v53, v53, v104
v_add_f32 v49, v49, v73
v_add_f32 v53, v53, v105
v_add_f32 v49, v49, v74
v_add_f32 v53, v53, v106
v_add_f32 v49, v49, v75
v_add_f32 v53, v53, v107
v_add_f32 v50, v76, v77
v_add_f32 v54, v108, v109
v_add_f32 v50, v50, v78
v_add_f32 v54, v54, v110
v_add_f32 v50, v50, v79
v_add_f32 v54, v54, v111
v_add_f32 v50, v50, v80
v_add_f32 v54, v54, v112
v_add_f32 v50, v50, v81
v_add_f32 v54, v54, v113
v_add_f32 v50, v50, v82
v_add_f32 v54, v54, v114
v_add_f32 v50, v50, v83
v_add_f32 v54, v54, v115
v_add_f32 v51, v84, v85
v_add_f32 v55, v116, v117
v_add_f32 v51, v51, v86
v_add_f32 v55, v55, v118
v_add_f32 v51, v51, v87
v_add_f32 v55, v55, v119
v_add_f32 v51, v51, v88
v_add_f32 v55, v55, v120
v_add_f32 v51, v51, v89
v_add_f32 v55, v55, v121
v_add_f32 v51, v51, v90
v_add_f32 v55, v55, v122
v_add_f32 v51, v51, v91
v_add_f32 v55, v55, v123
s_nop 1
v_permlane32_swap_b32 v48, v49
v_permlane32_swap_b32 v50, v51
s_nop 0
v_add_f32 v48, v48, v49
v_add_f32 v50, v50, v51
s_nop 1
v_permlane16_swap_b32 v48, v50
s_nop 0
v_add_f32 v48, v48, v50
v_rcp_f32 v48, v48
s_nop 0
v_mov_b32 v50, v48
s_nop 1
v_permlane16_swap_b32 v48, v50
s_nop 0
v_mov_b32 v49, v48
v_mov_b32 v51, v50
s_nop 1
v_permlane32_swap_b32 v48, v49
v_permlane32_swap_b32 v50, v51
s_nop 0
s_nop 1
v_permlane32_swap_b32 v52, v53
v_permlane32_swap_b32 v54, v55
s_nop 0
v_add_f32 v52, v52, v53
v_add_f32 v54, v54, v55
s_nop 1
v_permlane16_swap_b32 v52, v54
s_nop 0
v_add_f32 v52, v52, v54
v_rcp_f32 v52, v52
s_nop 0
v_mov_b32 v54, v52
s_nop 1
v_permlane16_swap_b32 v52, v54
s_nop 0
v_mov_b32 v53, v52
v_mov_b32 v55, v54
s_nop 1
v_permlane32_swap_b32 v52, v53
v_permlane32_swap_b32 v54, v55
s_nop 0
v_pk_mul_f32 v[60:61], v[60:61], v[48:49] op_sel:[0,0] op_sel_hi:[1,0]
v_pk_mul_f32 v[62:63], v[62:63], v[48:49] op_sel:[0,0] op_sel_hi:[1,0]
v_pk_mul_f32 v[64:65], v[64:65], v[48:49] op_sel:[0,0] op_sel_hi:[1,0]
v_pk_mul_f32 v[66:67], v[66:67], v[48:49] op_sel:[0,0] op_sel_hi:[1,0]
v_pk_mul_f32 v[92:93], v[92:93], v[52:53] op_sel:[0,0] op_sel_hi:[1,0]
v_pk_mul_f32 v[94:95], v[94:95], v[52:53] op_sel:[0,0] op_sel_hi:[1,0]
v_pk_mul_f32 v[96:97], v[96:97], v[52:53] op_sel:[0,0] op_sel_hi:[1,0]
v_pk_mul_f32 v[98:99], v[98:99], v[52:53] op_sel:[0,0] op_sel_hi:[1,0]
v_cvt_pk_bf16_f32 v60, v60, v61
v_cvt_pk_bf16_f32 v61, v62, v63
v_cvt_pk_bf16_f32 v62, v64, v65
v_cvt_pk_bf16_f32 v63, v66, v67
v_cvt_pk_bf16_f32 v92, v92, v93
v_cvt_pk_bf16_f32 v93, v94, v95
v_cvt_pk_bf16_f32 v94, v96, v97
v_cvt_pk_bf16_f32 v95, v98, v99
v_pk_mul_f32 v[68:69], v[68:69], v[48:49] op_sel:[0,1] op_sel_hi:[1,1]
v_pk_mul_f32 v[70:71], v[70:71], v[48:49] op_sel:[0,1] op_sel_hi:[1,1]
v_pk_mul_f32 v[72:73], v[72:73], v[48:49] op_sel:[0,1] op_sel_hi:[1,1]
v_pk_mul_f32 v[74:75], v[74:75], v[48:49] op_sel:[0,1] op_sel_hi:[1,1]
v_pk_mul_f32 v[100:101], v[100:101], v[52:53] op_sel:[0,1] op_sel_hi:[1,1]
v_pk_mul_f32 v[102:103], v[102:103], v[52:53] op_sel:[0,1] op_sel_hi:[1,1]
v_pk_mul_f32 v[104:105], v[104:105], v[52:53] op_sel:[0,1] op_sel_hi:[1,1]
v_pk_mul_f32 v[106:107], v[106:107], v[52:53] op_sel:[0,1] op_sel_hi:[1,1]
v_cvt_pk_bf16_f32 v68, v68, v69
v_cvt_pk_bf16_f32 v69, v70, v71
v_cvt_pk_bf16_f32 v70, v72, v73
v_cvt_pk_bf16_f32 v71, v74, v75
v_cvt_pk_bf16_f32 v100, v100, v101
v_cvt_pk_bf16_f32 v101, v102, v103
v_cvt_pk_bf16_f32 v102, v104, v105
v_cvt_pk_bf16_f32 v103, v106, v107
v_pk_mul_f32 v[76:77], v[76:77], v[50:51] op_sel:[0,0] op_sel_hi:[1,0]
v_pk_mul_f32 v[78:79], v[78:79], v[50:51] op_sel:[0,0] op_sel_hi:[1,0]
v_pk_mul_f32 v[80:81], v[80:81], v[50:51] op_sel:[0,0] op_sel_hi:[1,0]
v_pk_mul_f32 v[82:83], v[82:83], v[50:51] op_sel:[0,0] op_sel_hi:[1,0]
v_pk_mul_f32 v[108:109], v[108:109], v[54:55] op_sel:[0,0] op_sel_hi:[1,0]
v_pk_mul_f32 v[110:111], v[110:111], v[54:55] op_sel:[0,0] op_sel_hi:[1,0]
v_pk_mul_f32 v[112:113], v[112:113], v[54:55] op_sel:[0,0] op_sel_hi:[1,0]
v_pk_mul_f32 v[114:115], v[114:115], v[54:55] op_sel:[0,0] op_sel_hi:[1,0]
v_cvt_pk_bf16_f32 v76, v76, v77
v_cvt_pk_bf16_f32 v77, v78, v79
v_cvt_pk_bf16_f32 v78, v80, v81
v_cvt_pk_bf16_f32 v79, v82, v83
v_cvt_pk_bf16_f32 v108, v108, v109
v_cvt_pk_bf16_f32 v109, v110, v111
v_cvt_pk_bf16_f32 v110, v112, v113
v_cvt_pk_bf16_f32 v111, v114, v115
v_pk_mul_f32 v[84:85], v[84:85], v[50:51] op_sel:[0,1] op_sel_hi:[1,1]
v_pk_mul_f32 v[86:87], v[86:87], v[50:51] op_sel:[0,1] op_sel_hi:[1,1]
v_pk_mul_f32 v[88:89], v[88:89], v[50:51] op_sel:[0,1] op_sel_hi:[1,1]
v_pk_mul_f32 v[90:91], v[90:91], v[50:51] op_sel:[0,1] op_sel_hi:[1,1]
v_pk_mul_f32 v[116:117], v[116:117], v[54:55] op_sel:[0,1] op_sel_hi:[1,1]
v_pk_mul_f32 v[118:119], v[118:119], v[54:55] op_sel:[0,1] op_sel_hi:[1,1]
v_pk_mul_f32 v[120:121], v[120:121], v[54:55] op_sel:[0,1] op_sel_hi:[1,1]
v_pk_mul_f32 v[122:123], v[122:123], v[54:55] op_sel:[0,1] op_sel_hi:[1,1]
v_cvt_pk_bf16_f32 v84, v84, v85
v_cvt_pk_bf16_f32 v85, v86, v87
v_cvt_pk_bf16_f32 v86, v88, v89
v_cvt_pk_bf16_f32 v87, v90, v91
v_cvt_pk_bf16_f32 v116, v116, v117
v_cvt_pk_bf16_f32 v117, v118, v119
v_cvt_pk_bf16_f32 v118, v120, v121
v_cvt_pk_bf16_f32 v119, v122, v123
s_lshl_b32 s35, s43, 14
s_lshl_b32 s36, s44, 12
s_add_u32 s35, s35, s36
v_add_u32 v5, s35, v18
ds_write_b128 v5, v[60:63] offset:0
ds_write_b128 v5, v[92:95] offset:8192
ds_write_b128 v5, v[68:71] offset:1024
ds_write_b128 v5, v[100:103] offset:9216
ds_write_b128 v5, v[76:79] offset:2048
ds_write_b128 v5, v[108:111] offset:10240
ds_write_b128 v5, v[84:87] offset:3072
ds_write_b128 v5, v[116:119] offset:11264
v_and_b32 v4, 3, v0
v_lshlrev_b32 v4, 4, v4
v_lshrrev_b32 v6, 2, v2
v_lshl_add_u32 v6, v3, 2, v6
v_add_u32 v4, v4, v6
v_lshlrev_b32 v4, 4, v4
s_lshl_b32 s36, s44, 13
s_add_u32 s35, s35, s36
v_add_u32 v6, s35, v4
v_xor_b32 v7, 4096, v6
s_xor_b32 s35, s28, 2
s_lshl_b32 s35, s35, 12
s_add_u32 s35, s35, 32768
v_add_u32 v5, s35, v18
v_mov_b32 v56, 0x3f803f80
v_mov_b32 v57, 0x3f803f80
v_mov_b32 v58, 0x3f803f80
v_mov_b32 v59, 0x3f803f80
s_waitcnt lgkmcnt(0)
s_barrier
ds_read_b64_tr_b16 v[60:61], v6 offset:0
ds_read_b64_tr_b16 v[62:63], v6 offset:1024
ds_read_b64_tr_b16 v[64:65], v6 offset:8
ds_read_b64_tr_b16 v[66:67], v6 offset:1032
ds_read_b64_tr_b16 v[68:69], v6 offset:2048
ds_read_b64_tr_b16 v[70:71], v6 offset:3072
ds_read_b64_tr_b16 v[72:73], v6 offset:2056
ds_read_b64_tr_b16 v[74:75], v6 offset:3080
ds_read_b128 v[92:95], v5 offset:0
ds_read_b128 v[96:99], v5 offset:1024
ds_read_b128 v[100:103], v5 offset:2048
ds_read_b128 v[104:107], v5 offset:3072
s_waitcnt lgkmcnt(4)
ds_read_b64_tr_b16 v[76:77], v7 offset:0
ds_read_b64_tr_b16 v[78:79], v7 offset:1024
ds_read_b64_tr_b16 v[80:81], v7 offset:8
ds_read_b64_tr_b16 v[82:83], v7 offset:1032
ds_read_b64_tr_b16 v[84:85], v7 offset:2048
ds_read_b64_tr_b16 v[86:87], v7 offset:3072
ds_read_b64_tr_b16 v[88:89], v7 offset:2056
ds_read_b64_tr_b16 v[90:91], v7 offset:3080
v_mfma_f32_16x16x32_bf16 v[148:151], v[60:63], v[22:25], 0
v_mfma_f32_16x16x32_bf16 v[156:159], v[60:63], v[32:35], 0
v_mfma_f32_16x16x32_bf16 v[164:167], v[60:63], v[56:59], 0
v_mfma_f32_16x16x32_bf16 v[152:155], v[64:67], v[22:25], 0
v_mfma_f32_16x16x32_bf16 v[160:163], v[64:67], v[32:35], 0
v_mfma_f32_16x16x32_bf16 v[168:171], v[64:67], v[56:59], 0
v_mfma_f32_16x16x32_bf16 v[148:151], v[68:71], v[26:29], v[148:151]
v_mfma_f32_16x16x32_bf16 v[156:159], v[68:71], v[36:39], v[156:159]
v_mfma_f32_16x16x32_bf16 v[164:167], v[68:71], v[56:59], v[164:167]
v_mfma_f32_16x16x32_bf16 v[152:155], v[72:75], v[26:29], v[152:155]
v_mfma_f32_16x16x32_bf16 v[160:163], v[72:75], v[36:39], v[160:163]
v_mfma_f32_16x16x32_bf16 v[168:171], v[72:75], v[56:59], v[168:171]
s_waitcnt lgkmcnt(0)
v_mfma_f32_16x16x32_bf16 v[148:151], v[76:79], v[92:95], v[148:151]
v_mfma_f32_16x16x32_bf16 v[156:159], v[76:79], v[100:103], v[156:159]
v_mfma_f32_16x16x32_bf16 v[164:167], v[76:79], v[56:59], v[164:167]
v_mfma_f32_16x16x32_bf16 v[152:155], v[80:83], v[92:95], v[152:155]
v_mfma_f32_16x16x32_bf16 v[160:163], v[80:83], v[100:103], v[160:163]
v_mfma_f32_16x16x32_bf16 v[168:171], v[80:83], v[56:59], v[168:171]
v_mfma_f32_16x16x32_bf16 v[148:151], v[84:87], v[96:99], v[148:151]
v_mfma_f32_16x16x32_bf16 v[156:159], v[84:87], v[104:107], v[156:159]
v_mfma_f32_16x16x32_bf16 v[164:167], v[84:87], v[56:59], v[164:167]
v_mfma_f32_16x16x32_bf16 v[152:155], v[88:91], v[96:99], v[152:155]
v_mfma_f32_16x16x32_bf16 v[160:163], v[88:91], v[104:107], v[160:163]
v_mfma_f32_16x16x32_bf16 v[168:171], v[88:91], v[56:59], v[168:171]
s_lshl_b32 s35, s45, 1
s_add_u32 s35, s35, s44
s_lshl_b32 s36, s35, 15
s_lshl_b32 s37, s29, 10
s_add_u32 s36, s36, s37
s_add_u32 s36, s36, 20971520
s_add_u32 s37, s36, 16384
s_lshl_b32 s35, s35, 10
s_add_u32 s35, s35, 24117248
v_cmp_eq_u32 vcc, s29, v2
s_nop 2
v_cvt_pk_bf16_f32 v148, v148, v149
v_cvt_pk_bf16_f32 v149, v150, v151
v_cvt_pk_bf16_f32 v150, v152, v153
v_cvt_pk_bf16_f32 v151, v154, v155
v_cvt_pk_bf16_f32 v156, v156, v157
v_cvt_pk_bf16_f32 v157, v158, v159
v_cvt_pk_bf16_f32 v158, v160, v161
v_cvt_pk_bf16_f32 v159, v162, v163
v_cvt_pk_bf16_f32 v164, v164, v165
v_cvt_pk_bf16_f32 v165, v166, v167
v_cvt_pk_bf16_f32 v166, v168, v169
v_cvt_pk_bf16_f32 v167, v170, v171
buffer_store_dwordx4 v[148:151], v18, s[20:23], s36 offen
buffer_store_dwordx4 v[156:159], v18, s[20:23], s37 offen
s_and_saveexec_b64 s[38:39], vcc
buffer_store_dwordx4 v[164:167], v18, s[20:23], s35 offen
s_mov_b64 exec, s[38:39]
s_endpgm
qkv3_kernel_loader:
s_sub_u32 s43, s28, 4
v_lshrrev_b32 v4, 3, v0
v_and_b32 v5, 7, v0
s_lshl_b32 s35, s29, 3
s_add_u32 s35, s35, s43
s_lshl_b32 s35, s35, 15
v_lshl_add_u32 v20, v0, 4, s35
v_mov_b32 v21, v20
v_add_u32 v22, 131072, v20
v_add_u32 v23, 131072, v21
v_subrev_u32 v24, 32768, v20
v_subrev_u32 v25, 32768, v21
s_lshr_b32 s35, s43, 1
s_lshl_b32 s35, s35, 5
s_and_b32 s36, s43, 1
s_lshl_b32 s36, s36, 3
s_add_u32 s35, s35, s36
v_lshrrev_b32 v6, 2, v4
v_lshlrev_b32 v6, 4, v6
v_and_b32 v7, 3, v4
v_add3_u32 v6, v6, v7, s35
v_mul_u32_u24 v6, 6144, v6
v_and_b32 v7, 2, v4
v_xor_b32 v7, v7, v5
s_lshl_b32 s35, s30, 7
v_lshl_add_u32 v26, v7, 4, v6
v_add_u32 v26, s35, v26
v_xor_b32 v27, 64, v26
v_add_u32 v27, 23552, v27
s_lshl_b32 s44, s43, 11
v_add_u32 v10, s44, v10
v_add_u32 v11, s44, v11
s_mov_b32 s33, 0
s_mov_b32 s34, 0
s_mov_b32 s32, 0
s_lshl_b32 s35, s30, 12
s_lshl_b32 s36, s43, 10
s_add_u32 s35, s35, s36
s_add_u32 m0, s36, 143616
v_lshlrev_b32 v6, 4, v0
buffer_load_dwordx4 v6, s[24:27], s35 offen lds
s_mov_b32 s31, 0
qkv3_kernel_pro:
s_add_u32 s35, s32, s44
s_add_u32 m0, s35, 18432
s_nop 0
buffer_load_dwordx4 v26, s[16:19], s34 offen lds
buffer_load_dwordx4 v27, s[16:19], s34 offen offset:1024 lds
s_add_u32 m0, s35, 2048
s_nop 0
buffer_load_dwordx4 v20, s[12:15], s33 offen lds
buffer_load_dwordx4 v21, s[12:15], s33 offen offset:1024 lds
s_add_u32 m0, s35, 26624
s_add_u32 s41, s34, 2048
buffer_load_dwordx4 v26, s[16:19], s41 offen lds
buffer_load_dwordx4 v27, s[16:19], s41 offen offset:1024 lds
s_add_u32 m0, s35, 10240
s_nop 0
buffer_load_dwordx4 v22, s[12:15], s33 offen lds
buffer_load_dwordx4 v23, s[12:15], s33 offen offset:1024 lds
s_add_u32 m0, s35, 34816
s_add_u32 s41, s34, 4096
buffer_load_dwordx4 v26, s[16:19], s41 offen lds
buffer_load_dwordx4 v27, s[16:19], s41 offen offset:1024 lds
s_add_u32 s33, s33, 2048
s_add_u32 s34, s34, 393216
s_add_u32 s32, s32, 43008
s_cmp_eq_u32 s32, 129024
s_cselect_b32 s32, 0, s32
s_add_u32 s31, s31, 1
s_cmp_lt_u32 s31, 3
s_cbranch_scc1 qkv3_kernel_pro
v_mov_b32 v30, 0
v_mov_b32 v31, 0
v_mov_b32 v32, 0
v_mov_b32 v33, 0
v_mov_b32 v34, 0
v_mov_b32 v35, 0
v_mov_b32 v36, 0
v_mov_b32 v37, 0
v_mov_b32 v28, 0x3f803f80
s_mov_b32 s40, 0
s_mov_b32 s31, 0
s_waitcnt vmcnt(20)
s_barrier
v_add_u32 v12, s40, v10
v_add_u32 v13, s40, v11
ds_read_b128 v[40:43], v12 offset:2048
ds_read_b128 v[44:47], v13 offset:2048
ds_read_b128 v[48:51], v12 offset:10240
ds_read_b128 v[52:55], v13 offset:10240
s_add_u32 s40, s40, 43008
s_cmp_eq_u32 s40, 129024
s_cselect_b32 s40, 0, s40
s_waitcnt lgkmcnt(0)
v_dot2c_f32_bf16 v30, v40, v28
v_dot2c_f32_bf16 v31, v40, v40
v_dot2c_f32_bf16 v32, v48, v28
v_dot2c_f32_bf16 v33, v48, v48
v_dot2c_f32_bf16 v30, v41, v28
v_dot2c_f32_bf16 v31, v41, v41
v_dot2c_f32_bf16 v32, v49, v28
v_dot2c_f32_bf16 v33, v49, v49
v_dot2c_f32_bf16 v30, v42, v28
v_dot2c_f32_bf16 v31, v42, v42
v_dot2c_f32_bf16 v32, v50, v28
v_dot2c_f32_bf16 v33, v50, v50
v_dot2c_f32_bf16 v30, v43, v28
v_dot2c_f32_bf16 v31, v43, v43
v_dot2c_f32_bf16 v32, v51, v28
v_dot2c_f32_bf16 v33, v51, v51
v_dot2c_f32_bf16 v30, v44, v28
v_dot2c_f32_bf16 v31, v44, v44
v_dot2c_f32_bf16 v32, v52, v28
v_dot2c_f32_bf16 v33, v52, v52
v_dot2c_f32_bf16 v30, v45, v28
v_dot2c_f32_bf16 v31, v45, v45
v_dot2c_f32_bf16 v32, v53, v28
v_dot2c_f32_bf16 v33, v53, v53
v_dot2c_f32_bf16 v30, v46, v28
v_dot2c_f32_bf16 v31, v46, v46
v_dot2c_f32_bf16 v32, v54, v28
v_dot2c_f32_bf16 v33, v54, v54
v_dot2c_f32_bf16 v30, v47, v28
v_dot2c_f32_bf16 v31, v47, v47
v_dot2c_f32_bf16 v32, v55, v28
v_dot2c_f32_bf16 v33, v55, v55
qkv3_kernel_lloop:
s_waitcnt vmcnt(10)
s_barrier
v_add_u32 v12, s40, v10
v_add_u32 v13, s40, v11
ds_read_b128 v[40:43], v12 offset:2048
ds_read_b128 v[44:47], v13 offset:2048
ds_read_b128 v[48:51], v12 offset:10240
ds_read_b128 v[52:55], v13 offset:10240
s_add_u32 s40, s40, 43008
s_cmp_eq_u32 s40, 129024
s_cselect_b32 s40, 0, s40
s_add_u32 s35, s32, s44
s_add_u32 m0, s35, 18432
s_nop 0
buffer_load_dwordx4 v26, s[16:19], s34 offen lds
buffer_load_dwordx4 v27, s[16:19], s34 offen offset:1024 lds
s_waitcnt lgkmcnt(0)
v_dot2c_f32_bf16 v30, v40, v28
v_dot2c_f32_bf16 v31, v40, v40
v_dot2c_f32_bf16 v32, v48, v28
v_dot2c_f32_bf16 v33, v48, v48
s_add_u32 m0, s35, 2048
s_nop 0
buffer_load_dwordx4 v20, s[12:15], s33 offen lds
v_dot2c_f32_bf16 v30, v41, v28
v_dot2c_f32_bf16 v31, v41, v41
v_dot2c_f32_bf16 v32, v49, v28
v_dot2c_f32_bf16 v33, v49, v49
buffer_load_dwordx4 v21, s[12:15], s33 offen offset:1024 lds
v_dot2c_f32_bf16 v30, v42, v28
v_dot2c_f32_bf16 v31, v42, v42
v_dot2c_f32_bf16 v32, v50, v28
v_dot2c_f32_bf16 v33, v50, v50
s_add_u32 m0, s35, 26624
s_add_u32 s41, s34, 2048
buffer_load_dwordx4 v26, s[16:19], s41 offen lds
v_dot2c_f32_bf16 v30, v43, v28
v_dot2c_f32_bf16 v31, v43, v43
v_dot2c_f32_bf16 v32, v51, v28
v_dot2c_f32_bf16 v33, v51, v51
buffer_load_dwordx4 v27, s[16:19], s41 offen offset:1024 lds
v_dot2c_f32_bf16 v30, v44, v28
v_dot2c_f32_bf16 v31, v44, v44
v_dot2c_f32_bf16 v32, v52, v28
v_dot2c_f32_bf16 v33, v52, v52
s_add_u32 m0, s35, 10240
s_nop 0
buffer_load_dwordx4 v22, s[12:15], s33 offen lds
v_dot2c_f32_bf16 v30, v45, v28
v_dot2c_f32_bf16 v31, v45, v45
v_dot2c_f32_bf16 v32, v53, v28
v_dot2c_f32_bf16 v33, v53, v53
buffer_load_dwordx4 v23, s[12:15], s33 offen offset:1024 lds
v_dot2c_f32_bf16 v30, v46, v28
v_dot2c_f32_bf16 v31, v46, v46
v_dot2c_f32_bf16 v32, v54, v28
v_dot2c_f32_bf16 v33, v54, v54
s_add_u32 m0, s35, 34816
s_add_u32 s41, s34, 4096
buffer_load_dwordx4 v26, s[16:19], s41 offen lds
v_dot2c_f32_bf16 v30, v47, v28
v_dot2c_f32_bf16 v31, v47, v47
v_dot2c_f32_bf16 v32, v55, v28
v_dot2c_f32_bf16 v33, v55, v55
buffer_load_dwordx4 v27, s[16:19], s41 offen offset:1024 lds
s_add_u32 s33, s33, 2048
s_add_u32 s34, s34, 393216
s_add_u32 s32, s32, 43008
s_cmp_eq_u32 s32, 129024
s_cselect_b32 s32, 0, s32
s_add_u32 s31, s31, 1
s_cmp_lt_u32 s31, 13
s_cbranch_scc1 qkv3_kernel_lloop
s_waitcnt vmcnt(10)
qkv3_kernel_ltail:
s_barrier
v_add_u32 v12, s40, v10
v_add_u32 v13, s40, v11
ds_read_b128 v[40:43], v12 offset:2048
ds_read_b128 v[44:47], v13 offset:2048
ds_read_b128 v[48:51], v12 offset:10240
ds_read_b128 v[52:55], v13 offset:10240
s_add_u32 s40, s40, 43008
s_cmp_eq_u32 s40, 129024
s_cselect_b32 s40, 0, s40
s_waitcnt lgkmcnt(0)
v_dot2c_f32_bf16 v30, v40, v28
v_dot2c_f32_bf16 v31, v40, v40
v_dot2c_f32_bf16 v32, v48, v28
v_dot2c_f32_bf16 v33, v48, v48
v_dot2c_f32_bf16 v30, v41, v28
v_dot2c_f32_bf16 v31, v41, v41
v_dot2c_f32_bf16 v32, v49, v28
v_dot2c_f32_bf16 v33, v49, v49
v_dot2c_f32_bf16 v30, v42, v28
v_dot2c_f32_bf16 v31, v42, v42
v_dot2c_f32_bf16 v32, v50, v28
v_dot2c_f32_bf16 v33, v50, v50
v_dot2c_f32_bf16 v30, v43, v28
v_dot2c_f32_bf16 v31, v43, v43
v_dot2c_f32_bf16 v32, v51, v28
v_dot2c_f32_bf16 v33, v51, v51
v_dot2c_f32_bf16 v30, v44, v28
v_dot2c_f32_bf16 v31, v44, v44
v_dot2c_f32_bf16 v32, v52, v28
v_dot2c_f32_bf16 v33, v52, v52
v_dot2c_f32_bf16 v30, v45, v28
v_dot2c_f32_bf16 v31, v45, v45
v_dot2c_f32_bf16 v32, v53, v28
v_dot2c_f32_bf16 v33, v53, v53
v_dot2c_f32_bf16 v30, v46, v28
v_dot2c_f32_bf16 v31, v46, v46
v_dot2c_f32_bf16 v32, v54, v28
v_dot2c_f32_bf16 v33, v54, v54
v_dot2c_f32_bf16 v30, v47, v28
v_dot2c_f32_bf16 v31, v47, v47
v_dot2c_f32_bf16 v32, v55, v28
v_dot2c_f32_bf16 v33, v55, v55
s_waitcnt vmcnt(0)
s_add_u32 s31, s31, 1
s_cmp_lt_u32 s31, 15
s_cbranch_scc1 qkv3_kernel_ltail
s_nop 2
s_nop 1
v_permlane32_swap_b32 v30, v31
v_permlane32_swap_b32 v32, v33
s_nop 0
v_add_f32 v30, v30, v31
v_add_f32 v32, v32, v33
s_nop 1
v_permlane16_swap_b32 v30, v32
s_nop 0
v_add_f32 v30, v30, v32
v_mul_f32 v30, 0x3a800000, v30
v_mov_b32 v32, v30
s_nop 1
v_permlane16_swap_b32 v30, v32
s_nop 0
v_mov_b32 v31, v30
v_mov_b32 v33, v32
s_nop 1
v_permlane32_swap_b32 v30, v31
v_permlane32_swap_b32 v32, v33
s_nop 0
s_lshl_b32 s35, s43, 4
v_add_u32 v6, s35, v2
v_lshlrev_b32 v7, 3, v6
v_add_u32 v7, 129024, v7
v_lshlrev_b32 v6, 2, v6
v_add_u32 v6, 130176, v6
v_fma_f32 v31, -v30, v30, v31
v_max_f32 v31, 0, v31
v_add_f32 v31, 0x3727c5ac, v31
v_rsq_f32 v40, v31
v_sub_f32 v41, 0, v30
v_fma_f32 v33, -v32, v32, v33
v_max_f32 v33, 0, v33
v_add_f32 v33, 0x3727c5ac, v33
v_rsq_f32 v42, v33
v_sub_f32 v43, 0, v32
s_mov_b64 exec, 0xffff
ds_write_b64 v7, v[40:41] offset:128
ds_write_b32 v6, v40 offset:64
ds_write_b32 v6, v41 offset:640
ds_write_b64 v7, v[42:43] offset:640
ds_write_b32 v6, v42 offset:320
ds_write_b32 v6, v43 offset:896
s_waitcnt lgkmcnt(0)
s_barrier
s_barrier
qkv3_kernel_end:
s_endpgm
.text
.globl lin3_kernel
.p2align 8
.type lin3_kernel,@function
lin3_kernel:
s_cmp_ge_u32 s2, 256
s_cbranch_scc1 lin3_kernel_end
s_load_dwordx2 s[8:9], s[0:1], 72
s_load_dwordx2 s[10:11], s[0:1], 40
v_lshrrev_b32 v1, 6, v0
v_and_b32 v0, 63, v0
v_readfirstlane_b32 s28, v1
v_and_b32 v2, 15, v0
v_lshrrev_b32 v3, 4, v0
v_lshlrev_b32 v18, 4, v0
s_and_b32 s29, s2, 7
s_lshr_b32 s45, s2, 3
s_waitcnt lgkmcnt(0)
s_mov_b32 s20, s8
s_and_b32 s21, s9, 0xffff
s_mov_b32 s22, 268435456
s_mov_b32 s23, 0x00020000
s_mov_b32 s24, s10
s_and_b32 s25, s11, 0xffff
s_mov_b32 s26, 65536
s_mov_b32 s27, 0x00020000
s_lshl_b32 s36, s28, 11
s_mov_b32 m0, s36
s_lshl_b32 s35, s45, 11
buffer_load_dwordx4 v18, s[24:27], s35 offen lds
buffer_load_dwordx4 v18, s[24:27], s35 offen offset:1024 lds
s_lshl_b32 s35, s29, 4
s_lshl_b32 s37, s28, 2
s_add_u32 s35, s35, s37
s_lshl_b32 s35, s35, 5
s_add_u32 s35, s35, s45
s_lshl_b32 s35, s35, 10
s_add_u32 s46, s35, 12582912
s_add_u32 s35, s35, 16777216
buffer_load_dwordx4 v[20:23], v18, s[20:23], s35 offen
s_add_u32 s35, s35, 32768
buffer_load_dwordx4 v[24:27], v18, s[20:23], s35 offen
s_add_u32 s35, s35, 32768
buffer_load_dwordx4 v[28:31], v18, s[20:23], s35 offen
s_add_u32 s35, s35, 32768
buffer_load_dwordx4 v[32:35], v18, s[20:23], s35 offen
s_lshl_b32 s35, s45, 2
s_add_u32 s35, s35, s28
s_lshl_b32 s35, s35, 14
s_add_u32 s35, s35, 20971520
buffer_load_dwordx4 v[128:131], v18, s[20:23], s35 offen offset:0
buffer_load_dwordx4 v[132:135], v18, s[20:23], s35 offen offset:1024
buffer_load_dwordx4 v[136:139], v18, s[20:23], s35 offen offset:2048
buffer_load_dwordx4 v[140:143], v18, s[20:23], s35 offen offset:3072
s_add_u32 s35, s35, 4096
buffer_load_dwordx4 v[144:147], v18, s[20:23], s35 offen offset:0
buffer_load_dwordx4 v[148:151], v18, s[20:23], s35 offen offset:1024
buffer_load_dwordx4 v[152:155], v18, s[20:23], s35 offen offset:2048
buffer_load_dwordx4 v[156:159], v18, s[20:23], s35 offen offset:3072
s_add_u32 s35, s35, 4096
buffer_load_dwordx4 v[160:163], v18, s[20:23], s35 offen offset:0
buffer_load_dwordx4 v[164:167], v18, s[20:23], s35 offen offset:1024
buffer_load_dwordx4 v[168:171], v18, s[20:23], s35 offen offset:2048
buffer_load_dwordx4 v[172:175], v18, s[20:23], s35 offen offset:3072
s_add_u32 s35, s35, 4096
buffer_load_dwordx4 v[176:179], v18, s[20:23], s35 offen offset:0
buffer_load_dwordx4 v[180:183], v18, s[20:23], s35 offen offset:1024
buffer_load_dwordx4 v[184:187], v18, s[20:23], s35 offen offset:2048
buffer_load_dwordx4 v[188:191], v18, s[20:23], s35 offen offset:3072
s_lshl_b32 s35, s45, 11
s_add_u32 s35, s35, 24117248
buffer_load_dwordx4 v[192:195], v18, s[20:23], s35 offen offset:0
buffer_load_dwordx4 v[196:199], v18, s[20:23], s35 offen offset:1024
v_lshrrev_b32 v4, 2, v2
v_lshl_add_u32 v4, v3, 2, v4
v_lshlrev_b32 v4, 6, v4
v_and_b32 v5, 3, v0
v_lshl_add_u32 v4, v5, 3, v4
v_add_u32 v4, s36, v4
v_lshrrev_b32 v6, 2, v2
v_cmp_eq_u32 vcc, v6, v3
v_and_b32 v7, 1, v0
v_lshlrev_b32 v7, 4, v7
v_mov_b32 v8, 0x3f80
v_lshlrev_b32 v7, v7, v8
v_cndmask_b32 v7, 0, v7, vcc
v_and_b32 v6, 2, v0
v_cmp_eq_u32 vcc, 0, v6
v_mov_b32 v200, 0
v_mov_b32 v201, 0
v_mov_b32 v204, 0
v_mov_b32 v205, 0
v_cndmask_b32 v202, 0, v7, vcc
v_cndmask_b32 v203, v7, 0, vcc
s_mov_b32 s42, 0x3fb8aa3b
s_waitcnt vmcnt(22)
ds_read_b64_tr_b16 v[40:41], v4 offset:0
ds_read_b64_tr_b16 v[42:43], v4 offset:1024
ds_read_b64_tr_b16 v[44:45], v4 offset:32
ds_read_b64_tr_b16 v[46:47], v4 offset:1056
s_waitcnt vmcnt(18) lgkmcnt(0)
v_mfma_f32_16x16x32_bf16 v[60:63], v[40:43], v[20:23], 0
v_mfma_f32_16x16x32_bf16 v[64:67], v[44:47], v[20:23], 0
v_mfma_f32_16x16x32_bf16 v[68:71], v[40:43], v[24:27], 0
v_mfma_f32_16x16x32_bf16 v[72:75], v[44:47], v[24:27], 0
v_mfma_f32_16x16x32_bf16 v[76:79], v[40:43], v[28:31], 0
v_mfma_f32_16x16x32_bf16 v[80:83], v[44:47], v[28:31], 0
v_mfma_f32_16x16x32_bf16 v[84:87], v[40:43], v[32:35], 0
v_mfma_f32_16x16x32_bf16 v[88:91], v[44:47], v[32:35], 0
s_nop 4
v_max3_f32 v48, v60, v61, v62
v_min3_f32 v52, v60, v61, v62
v_max3_f32 v48, v48, v63, v64
v_min3_f32 v52, v52, v63, v64
v_max3_f32 v48, v48, v65, v66
v_min3_f32 v52, v52, v65, v66
v_max_f32 v48, v48, v67
v_min_f32 v52, v52, v67
v_max3_f32 v49, v68, v69, v70
v_min3_f32 v53, v68, v69, v70
v_max3_f32 v49, v49, v71, v72
v_min3_f32 v53, v53, v71, v72
v_max3_f32 v49, v49, v73, v74
v_min3_f32 v53, v53, v73, v74
v_max_f32 v49, v49, v75
v_min_f32 v53, v53, v75
v_max3_f32 v50, v76, v77, v78
v_min3_f32 v54, v76, v77, v78
v_max3_f32 v50, v50, v79, v80
v_min3_f32 v54, v54, v79, v80
v_max3_f32 v50, v50, v81, v82
v_min3_f32 v54, v54, v81, v82
v_max_f32 v50, v50, v83
v_min_f32 v54, v54, v83
s_nop 1
v_max3_f32 v51, v84, v85, v86
v_min3_f32 v55, v84, v85, v86
v_max3_f32 v51, v51, v87, v88
v_min3_f32 v55, v55, v87, v88
v_max3_f32 v51, v51, v89, v90
v_min3_f32 v55, v55, v89, v90
v_max_f32 v51, v51, v91
v_min_f32 v55, v55, v91
s_nop 1
v_permlane32_swap_b32 v48, v49
v_permlane32_swap_b32 v50, v51
s_nop 0
v_max_f32 v48, v48, v49
v_max_f32 v50, v50, v51
s_nop 1
v_permlane16_swap_b32 v48, v50
s_nop 0
v_max_f32 v48, v48, v50
v_mul_f32 v48, s42, v48
v_mov_b32 v50, v48
s_nop 1
v_permlane16_swap_b32 v48, v50
s_nop 0
v_mov_b32 v49, v48
v_mov_b32 v51, v50
s_nop 1
v_permlane32_swap_b32 v48, v49
v_permlane32_swap_b32 v50, v51
s_nop 0
s_nop 1
v_permlane32_swap_b32 v52, v53
v_permlane32_swap_b32 v54, v55
s_nop 0
v_min_f32 v52, v52, v53
v_min_f32 v54, v54, v55
s_nop 1
v_permlane16_swap_b32 v52, v54
s_nop 0
v_min_f32 v52, v52, v54
v_mul_f32 v52, s42, v52
v_mov_b32 v54, v52
s_nop 1
v_permlane16_swap_b32 v52, v54
s_nop 0
v_mov_b32 v53, v52
v_mov_b32 v55, v54
s_nop 1
v_permlane32_swap_b32 v52, v53
v_permlane32_swap_b32 v54, v55
s_nop 0
v_fma_f32 v92, -v60, s42, v52
v_fma_f32 v60, v60, s42, -v48
v_fma_f32 v93, -v61, s42, v52
v_fma_f32 v61, v61, s42, -v48
v_fma_f32 v94, -v62, s42, v52
v_fma_f32 v62, v62, s42, -v48
v_fma_f32 v95, -v63, s42, v52
v_fma_f32 v63, v63, s42, -v48
v_fma_f32 v96, -v64, s42, v52
v_fma_f32 v64, v64, s42, -v48
v_fma_f32 v97, -v65, s42, v52
v_fma_f32 v65, v65, s42, -v48
v_fma_f32 v98, -v66, s42, v52
v_fma_f32 v66, v66, s42, -v48
v_fma_f32 v99, -v67, s42, v52
v_fma_f32 v67, v67, s42, -v48
v_exp_f32 v92, v92
v_exp_f32 v60, v60
v_exp_f32 v93, v93
v_exp_f32 v61, v61
v_exp_f32 v94, v94
v_exp_f32 v62, v62
v_exp_f32 v95, v95
v_exp_f32 v63, v63
v_exp_f32 v96, v96
v_exp_f32 v64, v64
v_exp_f32 v97, v97
v_exp_f32 v65, v65
v_exp_f32 v98, v98
v_exp_f32 v66, v66
v_exp_f32 v99, v99
v_exp_f32 v67, v67
v_fma_f32 v100, -v68, s42, v53
v_fma_f32 v68, v68, s42, -v49
v_fma_f32 v101, -v69, s42, v53
v_fma_f32 v69, v69, s42, -v49
v_fma_f32 v102, -v70, s42, v53
v_fma_f32 v70, v70, s42, -v49
v_fma_f32 v103, -v71, s42, v53
v_fma_f32 v71, v71, s42, -v49
v_fma_f32 v104, -v72, s42, v53
v_fma_f32 v72, v72, s42, -v49
v_fma_f32 v105, -v73, s42, v53
v_fma_f32 v73, v73, s42, -v49
v_fma_f32 v106, -v74, s42, v53
v_fma_f32 v74, v74, s42, -v49
v_fma_f32 v107, -v75, s42, v53
v_fma_f32 v75, v75, s42, -v49
v_exp_f32 v100, v100
v_exp_f32 v68, v68
v_exp_f32 v101, v101
v_exp_f32 v69, v69
v_exp_f32 v102, v102
v_exp_f32 v70, v70
v_exp_f32 v103, v103
v_exp_f32 v71, v71
v_exp_f32 v104, v104
v_exp_f32 v72, v72
v_exp_f32 v105, v105
v_exp_f32 v73, v73
v_exp_f32 v106, v106
v_exp_f32 v74, v74
v_exp_f32 v107, v107
v_exp_f32 v75, v75
v_fma_f32 v108, -v76, s42, v54
v_fma_f32 v76, v76, s42, -v50
v_fma_f32 v109, -v77, s42, v54
v_fma_f32 v77, v77, s42, -v50
v_fma_f32 v110, -v78, s42, v54
v_fma_f32 v78, v78, s42, -v50
v_fma_f32 v111, -v79, s42, v54
v_fma_f32 v79, v79, s42, -v50
v_fma_f32 v112, -v80, s42, v54
v_fma_f32 v80, v80, s42, -v50
v_fma_f32 v113, -v81, s42, v54
v_fma_f32 v81, v81, s42, -v50
v_fma_f32 v114, -v82, s42, v54
v_fma_f32 v82, v82, s42, -v50
v_fma_f32 v115, -v83, s42, v54
v_fma_f32 v83, v83, s42, -v50
v_exp_f32 v108, v108
v_exp_f32 v76, v76
v_exp_f32 v109, v109
v_exp_f32 v77, v77
v_exp_f32 v110, v110
v_exp_f32 v78, v78
v_exp_f32 v111, v111
v_exp_f32 v79, v79
v_exp_f32 v112, v112
v_exp_f32 v80, v80
v_exp_f32 v113, v113
v_exp_f32 v81, v81
v_exp_f32 v114, v114
v_exp_f32 v82, v82
v_exp_f32 v115, v115
v_exp_f32 v83, v83
v_fma_f32 v116, -v84, s42, v55
v_fma_f32 v84, v84, s42, -v51
v_fma_f32 v117, -v85, s42, v55
v_fma_f32 v85, v85, s42, -v51
v_fma_f32 v118, -v86, s42, v55
v_fma_f32 v86, v86, s42, -v51
v_fma_f32 v119, -v87, s42, v55
v_fma_f32 v87, v87, s42, -v51
v_fma_f32 v120, -v88, s42, v55
v_fma_f32 v88, v88, s42, -v51
v_fma_f32 v121, -v89, s42, v55
v_fma_f32 v89, v89, s42, -v51
v_fma_f32 v122, -v90, s42, v55
v_fma_f32 v90, v90, s42, -v51
v_fma_f32 v123, -v91, s42, v55
v_fma_f32 v91, v91, s42, -v51
v_exp_f32 v116, v116
v_exp_f32 v84, v84
v_exp_f32 v117, v117
v_exp_f32 v85, v85
v_exp_f32 v118, v118
v_exp_f32 v86, v86
v_exp_f32 v119, v119
v_exp_f32 v87, v87
v_exp_f32 v120, v120
v_exp_f32 v88, v88
v_exp_f32 v121, v121
v_exp_f32 v89, v89
v_exp_f32 v122, v122
v_exp_f32 v90, v90
v_exp_f32 v123, v123
v_exp_f32 v91, v91
s_nop 0
v_add_f32 v48, v60, v61
v_add_f32 v52, v92, v93
v_add_f32 v48, v48, v62
v_add_f32 v52, v52, v94
v_add_f32 v48, v48, v63
v_add_f32 v52, v52, v95
v_add_f32 v48, v48, v64
v_add_f32 v52, v52, v96
v_add_f32 v48, v48, v65
v_add_f32 v52, v52, v97
v_add_f32 v48, v48, v66
v_add_f32 v52, v52, v98
v_add_f32 v48, v48, v67
v_add_f32 v52, v52, v99
v_add_f32 v49, v68, v69
v_add_f32 v53, v100, v101
v_add_f32 v49, v49, v70
v_add_f32 v53, v53, v102
v_add_f32 v49, v49, v71
v_add_f32 v53, v53, v103
v_add_f32 v49, v49, v72
v_add_f32 v53, v53, v104
v_add_f32 v49, v49, v73
v_add_f32 v53, v53, v105
v_add_f32 v49, v49, v74
v_add_f32 v53, v53, v106
v_add_f32 v49, v49, v75
v_add_f32 v53, v53, v107
v_add_f32 v50, v76, v77
v_add_f32 v54, v108, v109
v_add_f32 v50, v50, v78
v_add_f32 v54, v54, v110
v_add_f32 v50, v50, v79
v_add_f32 v54, v54, v111
v_add_f32 v50, v50, v80
v_add_f32 v54, v54, v112
v_add_f32 v50, v50, v81
v_add_f32 v54, v54, v113
v_add_f32 v50, v50, v82
v_add_f32 v54, v54, v114
v_add_f32 v50, v50, v83
v_add_f32 v54, v54, v115
v_add_f32 v51, v84, v85
v_add_f32 v55, v116, v117
v_add_f32 v51, v51, v86
v_add_f32 v55, v55, v118
v_add_f32 v51, v51, v87
v_add_f32 v55, v55, v119
v_add_f32 v51, v51, v88
v_add_f32 v55, v55, v120
v_add_f32 v51, v51, v89
v_add_f32 v55, v55, v121
v_add_f32 v51, v51, v90
v_add_f32 v55, v55, v122
v_add_f32 v51, v51, v91
v_add_f32 v55, v55, v123
s_nop 1
v_permlane32_swap_b32 v48, v49
v_permlane32_swap_b32 v50, v51
s_nop 0
v_add_f32 v48, v48, v49
v_add_f32 v50, v50, v51
s_nop 1
v_permlane16_swap_b32 v48, v50
s_nop 0
v_add_f32 v48, v48, v50
v_rcp_f32 v48, v48
s_nop 0
v_mov_b32 v50, v48
s_nop 1
v_permlane16_swap_b32 v48, v50
s_nop 0
v_mov_b32 v49, v48
v_mov_b32 v51, v50
s_nop 1
v_permlane32_swap_b32 v48, v49
v_permlane32_swap_b32 v50, v51
s_nop 0
s_nop 1
v_permlane32_swap_b32 v52, v53
v_permlane32_swap_b32 v54, v55
s_nop 0
v_add_f32 v52, v52, v53
v_add_f32 v54, v54, v55
s_nop 1
v_permlane16_swap_b32 v52, v54
s_nop 0
v_add_f32 v52, v52, v54
v_rcp_f32 v52, v52
s_nop 0
v_mov_b32 v54, v52
s_nop 1
v_permlane16_swap_b32 v52, v54
s_nop 0
v_mov_b32 v53, v52
v_mov_b32 v55, v54
s_nop 1
v_permlane32_swap_b32 v52, v53
v_permlane32_swap_b32 v54, v55
s_nop 0
v_pk_mul_f32 v[60:61], v[60:61], v[48:49] op_sel:[0,0] op_sel_hi:[1,0]
v_pk_mul_f32 v[62:63], v[62:63], v[48:49] op_sel:[0,0] op_sel_hi:[1,0]
v_pk_mul_f32 v[64:65], v[64:65], v[48:49] op_sel:[0,0] op_sel_hi:[1,0]
v_pk_mul_f32 v[66:67], v[66:67], v[48:49] op_sel:[0,0] op_sel_hi:[1,0]
v_pk_mul_f32 v[92:93], v[92:93], v[52:53] op_sel:[0,0] op_sel_hi:[1,0]
v_pk_mul_f32 v[94:95], v[94:95], v[52:53] op_sel:[0,0] op_sel_hi:[1,0]
v_pk_mul_f32 v[96:97], v[96:97], v[52:53] op_sel:[0,0] op_sel_hi:[1,0]
v_pk_mul_f32 v[98:99], v[98:99], v[52:53] op_sel:[0,0] op_sel_hi:[1,0]
v_cvt_pk_bf16_f32 v60, v60, v61
v_cvt_pk_bf16_f32 v61, v62, v63
v_cvt_pk_bf16_f32 v62, v64, v65
v_cvt_pk_bf16_f32 v63, v66, v67
v_cvt_pk_bf16_f32 v92, v92, v93
v_cvt_pk_bf16_f32 v93, v94, v95
v_cvt_pk_bf16_f32 v94, v96, v97
v_cvt_pk_bf16_f32 v95, v98, v99
v_pk_mul_f32 v[68:69], v[68:69], v[48:49] op_sel:[0,1] op_sel_hi:[1,1]
v_pk_mul_f32 v[70:71], v[70:71], v[48:49] op_sel:[0,1] op_sel_hi:[1,1]
v_pk_mul_f32 v[72:73], v[72:73], v[48:49] op_sel:[0,1] op_sel_hi:[1,1]
v_pk_mul_f32 v[74:75], v[74:75], v[48:49] op_sel:[0,1] op_sel_hi:[1,1]
v_pk_mul_f32 v[100:101], v[100:101], v[52:53] op_sel:[0,1] op_sel_hi:[1,1]
v_pk_mul_f32 v[102:103], v[102:103], v[52:53] op_sel:[0,1] op_sel_hi:[1,1]
v_pk_mul_f32 v[104:105], v[104:105], v[52:53] op_sel:[0,1] op_sel_hi:[1,1]
v_pk_mul_f32 v[106:107], v[106:107], v[52:53] op_sel:[0,1] op_sel_hi:[1,1]
v_cvt_pk_bf16_f32 v68, v68, v69
v_cvt_pk_bf16_f32 v69, v70, v71
v_cvt_pk_bf16_f32 v70, v72, v73
v_cvt_pk_bf16_f32 v71, v74, v75
v_cvt_pk_bf16_f32 v100, v100, v101
v_cvt_pk_bf16_f32 v101, v102, v103
v_cvt_pk_bf16_f32 v102, v104, v105
v_cvt_pk_bf16_f32 v103, v106, v107
v_pk_mul_f32 v[76:77], v[76:77], v[50:51] op_sel:[0,0] op_sel_hi:[1,0]
v_pk_mul_f32 v[78:79], v[78:79], v[50:51] op_sel:[0,0] op_sel_hi:[1,0]
v_pk_mul_f32 v[80:81], v[80:81], v[50:51] op_sel:[0,0] op_sel_hi:[1,0]
v_pk_mul_f32 v[82:83], v[82:83], v[50:51] op_sel:[0,0] op_sel_hi:[1,0]
v_pk_mul_f32 v[108:109], v[108:109], v[54:55] op_sel:[0,0] op_sel_hi:[1,0]
v_pk_mul_f32 v[110:111], v[110:111], v[54:55] op_sel:[0,0] op_sel_hi:[1,0]
v_pk_mul_f32 v[112:113], v[112:113], v[54:55] op_sel:[0,0] op_sel_hi:[1,0]
v_pk_mul_f32 v[114:115], v[114:115], v[54:55] op_sel:[0,0] op_sel_hi:[1,0]
v_cvt_pk_bf16_f32 v76, v76, v77
v_cvt_pk_bf16_f32 v77, v78, v79
v_cvt_pk_bf16_f32 v78, v80, v81
v_cvt_pk_bf16_f32 v79, v82, v83
v_cvt_pk_bf16_f32 v108, v108, v109
v_cvt_pk_bf16_f32 v109, v110, v111
v_cvt_pk_bf16_f32 v110, v112, v113
v_cvt_pk_bf16_f32 v111, v114, v115
v_pk_mul_f32 v[84:85], v[84:85], v[50:51] op_sel:[0,1] op_sel_hi:[1,1]
v_pk_mul_f32 v[86:87], v[86:87], v[50:51] op_sel:[0,1] op_sel_hi:[1,1]
v_pk_mul_f32 v[88:89], v[88:89], v[50:51] op_sel:[0,1] op_sel_hi:[1,1]
v_pk_mul_f32 v[90:91], v[90:91], v[50:51] op_sel:[0,1] op_sel_hi:[1,1]
v_pk_mul_f32 v[116:117], v[116:117], v[54:55] op_sel:[0,1] op_sel_hi:[1,1]
v_pk_mul_f32 v[118:119], v[118:119], v[54:55] op_sel:[0,1] op_sel_hi:[1,1]
v_pk_mul_f32 v[120:121], v[120:121], v[54:55] op_sel:[0,1] op_sel_hi:[1,1]
v_pk_mul_f32 v[122:123], v[122:123], v[54:55] op_sel:[0,1] op_sel_hi:[1,1]
v_cvt_pk_bf16_f32 v84, v84, v85
v_cvt_pk_bf16_f32 v85, v86, v87
v_cvt_pk_bf16_f32 v86, v88, v89
v_cvt_pk_bf16_f32 v87, v90, v91
v_cvt_pk_bf16_f32 v116, v116, v117
v_cvt_pk_bf16_f32 v117, v118, v119
v_cvt_pk_bf16_f32 v118, v120, v121
v_cvt_pk_bf16_f32 v119, v122, v123
s_waitcnt vmcnt(0)
v_mfma_f32_16x16x32_bf16 v[20:23], v[202:205], v[128:131], 0
v_mfma_f32_16x16x32_bf16 v[24:27], v[200:203], v[128:131], 0
v_mfma_f32_16x16x32_bf16 v[20:23], v[202:205], v[132:135], v[20:23]
v_mfma_f32_16x16x32_bf16 v[24:27], v[200:203], v[132:135], v[24:27]
v_mfma_f32_16x16x32_bf16 v[20:23], v[202:205], v[136:139], v[20:23]
v_mfma_f32_16x16x32_bf16 v[24:27], v[200:203], v[136:139], v[24:27]
v_mfma_f32_16x16x32_bf16 v[20:23], v[202:205], v[140:143], v[20:23]
v_mfma_f32_16x16x32_bf16 v[24:27], v[200:203], v[140:143], v[24:27]
v_mfma_f32_16x16x32_bf16 v[20:23], v[202:205], v[144:147], v[20:23]
v_mfma_f32_16x16x32_bf16 v[24:27], v[200:203], v[144:147], v[24:27]
v_mfma_f32_16x16x32_bf16 v[20:23], v[202:205], v[148:151], v[20:23]
v_mfma_f32_16x16x32_bf16 v[24:27], v[200:203], v[148:151], v[24:27]
v_mfma_f32_16x16x32_bf16 v[20:23], v[202:205], v[152:155], v[20:23]
v_mfma_f32_16x16x32_bf16 v[24:27], v[200:203], v[152:155], v[24:27]
v_mfma_f32_16x16x32_bf16 v[20:23], v[202:205], v[156:159], v[20:23]
v_mfma_f32_16x16x32_bf16 v[24:27], v[200:203], v[156:159], v[24:27]
v_mfma_f32_16x16x32_bf16 v[20:23], v[202:205], v[160:163], v[20:23]
v_mfma_f32_16x16x32_bf16 v[24:27], v[200:203], v[160:163], v[24:27]
v_mfma_f32_16x16x32_bf16 v[20:23], v[202:205], v[164:167], v[20:23]
v_mfma_f32_16x16x32_bf16 v[24:27], v[200:203], v[164:167], v[24:27]
v_mfma_f32_16x16x32_bf16 v[20:23], v[202:205], v[168:171], v[20:23]
v_mfma_f32_16x16x32_bf16 v[24:27], v[200:203], v[168:171], v[24:27]
v_mfma_f32_16x16x32_bf16 v[20:23], v[202:205], v[172:175], v[20:23]
v_mfma_f32_16x16x32_bf16 v[24:27], v[200:203], v[172:175], v[24:27]
v_mfma_f32_16x16x32_bf16 v[20:23], v[202:205], v[176:179], v[20:23]
v_mfma_f32_16x16x32_bf16 v[24:27], v[200:203], v[176:179], v[24:27]
v_mfma_f32_16x16x32_bf16 v[20:23], v[202:205], v[180:183], v[20:23]
v_mfma_f32_16x16x32_bf16 v[24:27], v[200:203], v[180:183], v[24:27]
v_mfma_f32_16x16x32_bf16 v[20:23], v[202:205], v[184:187], v[20:23]
v_mfma_f32_16x16x32_bf16 v[24:27], v[200:203], v[184:187], v[24:27]
v_mfma_f32_16x16x32_bf16 v[20:23], v[202:205], v[188:191], v[20:23]
v_mfma_f32_16x16x32_bf16 v[24:27], v[200:203], v[188:191], v[24:27]
s_lshl_b32 s35, s28, 10
s_add_u32 s35, s35, 8192
v_add_u32 v5, s35, v18
s_nop 6
v_cvt_pk_bf16_f32 v20, v20, v21
v_cvt_pk_bf16_f32 v21, v22, v23
v_cvt_pk_bf16_f32 v22, v24, v25
v_cvt_pk_bf16_f32 v23, v26, v27
ds_write_b128 v5, v[20:23]
v_mfma_f32_16x16x32_bf16 v[128:131], v[192:195], v[60:63], 0
v_mfma_f32_16x16x32_bf16 v[132:135], v[192:195], v[68:71], 0
v_mfma_f32_16x16x32_bf16 v[136:139], v[192:195], v[76:79], 0
v_mfma_f32_16x16x32_bf16 v[140:143], v[192:195], v[84:87], 0
v_mfma_f32_16x16x32_bf16 v[128:131], v[196:199], v[92:95], v[128:131]
v_mfma_f32_16x16x32_bf16 v[132:135], v[196:199], v[100:103], v[132:135]
v_mfma_f32_16x16x32_bf16 v[136:139], v[196:199], v[108:111], v[136:139]
v_mfma_f32_16x16x32_bf16 v[140:143], v[196:199], v[116:119], v[140:143]
s_waitcnt lgkmcnt(0)
s_barrier
ds_read_b128 v[20:23], v18 offset:8192
ds_read_b128 v[24:27], v18 offset:9216
ds_read_b128 v[28:31], v18 offset:10240
ds_read_b128 v[32:35], v18 offset:11264
s_nop 3
v_add_f32 v48, v128, v129
v_add_f32 v130, v130, v131
v_add_f32 v48, v48, v130
v_add_f32 v49, v132, v133
v_add_f32 v134, v134, v135
v_add_f32 v49, v49, v134
v_add_f32 v50, v136, v137
v_add_f32 v138, v138, v139
v_add_f32 v50, v50, v138
v_add_f32 v51, v140, v141
v_add_f32 v142, v142, v143
v_add_f32 v51, v51, v142
s_waitcnt lgkmcnt(0)
v_mfma_f32_16x16x32_bf16 v[144:147], v[20:23], v[60:63], 0
v_mfma_f32_16x16x32_bf16 v[148:151], v[24:27], v[60:63], 0
v_mfma_f32_16x16x32_bf16 v[152:155], v[20:23], v[68:71], 0
v_mfma_f32_16x16x32_bf16 v[156:159], v[24:27], v[68:71], 0
v_mfma_f32_16x16x32_bf16 v[160:163], v[20:23], v[76:79], 0
v_mfma_f32_16x16x32_bf16 v[164:167], v[24:27], v[76:79], 0
v_mfma_f32_16x16x32_bf16 v[168:171], v[20:23], v[84:87], 0
v_mfma_f32_16x16x32_bf16 v[172:175], v[24:27], v[84:87], 0
v_mfma_f32_16x16x32_bf16 v[144:147], v[28:31], v[92:95], v[144:147]
v_mfma_f32_16x16x32_bf16 v[148:151], v[32:35], v[92:95], v[148:151]
v_mfma_f32_16x16x32_bf16 v[152:155], v[28:31], v[100:103], v[152:155]
v_mfma_f32_16x16x32_bf16 v[156:159], v[32:35], v[100:103], v[156:159]
v_mfma_f32_16x16x32_bf16 v[160:163], v[28:31], v[108:111], v[160:163]
v_mfma_f32_16x16x32_bf16 v[164:167], v[32:35], v[108:111], v[164:167]
v_mfma_f32_16x16x32_bf16 v[168:171], v[28:31], v[116:119], v[168:171]
v_mfma_f32_16x16x32_bf16 v[172:175], v[32:35], v[116:119], v[172:175]
s_nop 1
v_permlane32_swap_b32 v48, v49
v_permlane32_swap_b32 v50, v51
s_nop 0
v_add_f32 v48, v48, v49
v_add_f32 v50, v50, v51
s_nop 1
v_permlane16_swap_b32 v48, v50
s_nop 0
v_add_f32 v48, v48, v50
v_add_f32 v48, 0x358637bd, v48
v_rcp_f32 v48, v48
s_nop 0
v_mov_b32 v50, v48
s_nop 1
v_permlane16_swap_b32 v48, v50
s_nop 0
v_mov_b32 v49, v48
v_mov_b32 v51, v50
s_nop 1
v_permlane32_swap_b32 v48, v49
v_permlane32_swap_b32 v50, v51
s_nop 0
v_pk_mul_f32 v[144:145], v[144:145], v[48:49] op_sel:[0,0] op_sel_hi:[1,0]
v_pk_mul_f32 v[146:147], v[146:147], v[48:49] op_sel:[0,0] op_sel_hi:[1,0]
v_pk_mul_f32 v[148:149], v[148:149], v[48:49] op_sel:[0,0] op_sel_hi:[1,0]
v_pk_mul_f32 v[150:151], v[150:151], v[48:49] op_sel:[0,0] op_sel_hi:[1,0]
v_cvt_pk_bf16_f32 v144, v144, v145
v_cvt_pk_bf16_f32 v145, v146, v147
v_cvt_pk_bf16_f32 v146, v148, v149
v_cvt_pk_bf16_f32 v147, v150, v151
buffer_store_dwordx4 v[144:147], v18, s[20:23], s46 offen
s_add_u32 s46, s46, 32768
v_pk_mul_f32 v[152:153], v[152:153], v[48:49] op_sel:[0,1] op_sel_hi:[1,1]
v_pk_mul_f32 v[154:155], v[154:155], v[48:49] op_sel:[0,1] op_sel_hi:[1,1]
v_pk_mul_f32 v[156:157], v[156:157], v[48:49] op_sel:[0,1] op_sel_hi:[1,1]
v_pk_mul_f32 v[158:159], v[158:159], v[48:49] op_sel:[0,1] op_sel_hi:[1,1]
v_cvt_pk_bf16_f32 v152, v152, v153
v_cvt_pk_bf16_f32 v153, v154, v155
v_cvt_pk_bf16_f32 v154, v156, v157
v_cvt_pk_bf16_f32 v155, v158, v159
buffer_store_dwordx4 v[152:155], v18, s[20:23], s46 offen
s_add_u32 s46, s46, 32768
v_pk_mul_f32 v[160:161], v[160:161], v[50:51] op_sel:[0,0] op_sel_hi:[1,0]
v_pk_mul_f32 v[162:163], v[162:163], v[50:51] op_sel:[0,0] op_sel_hi:[1,0]
v_pk_mul_f32 v[164:165], v[164:165], v[50:51] op_sel:[0,0] op_sel_hi:[1,0]
v_pk_mul_f32 v[166:167], v[166:167], v[50:51] op_sel:[0,0] op_sel_hi:[1,0]
v_cvt_pk_bf16_f32 v160, v160, v161
v_cvt_pk_bf16_f32 v161, v162, v163
v_cvt_pk_bf16_f32 v162, v164, v165
v_cvt_pk_bf16_f32 v163, v166, v167
buffer_store_dwordx4 v[160:163], v18, s[20:23], s46 offen
s_add_u32 s46, s46, 32768
v_pk_mul_f32 v[168:169], v[168:169], v[50:51] op_sel:[0,1] op_sel_hi:[1,1]
v_pk_mul_f32 v[170:171], v[170:171], v[50:51] op_sel:[0,1] op_sel_hi:[1,1]
v_pk_mul_f32 v[172:173], v[172:173], v[50:51] op_sel:[0,1] op_sel_hi:[1,1]
v_pk_mul_f32 v[174:175], v[174:175], v[50:51] op_sel:[0,1] op_sel_hi:[1,1]
v_cvt_pk_bf16_f32 v168, v168, v169
v_cvt_pk_bf16_f32 v169, v170, v171
v_cvt_pk_bf16_f32 v170, v172, v173
v_cvt_pk_bf16_f32 v171, v174, v175
buffer_store_dwordx4 v[168:171], v18, s[20:23], s46 offen
lin3_kernel_end:
s_endpgm
.text
.globl out3_kernel
.p2align 8
.type out3_kernel,@function
out3_kernel:
s_cmp_ge_u32 s2, 256
s_cbranch_scc1 out3_kernel_end
s_load_dwordx2 s[8:9], s[0:1], 72
s_load_dwordx2 s[6:7], s[0:1], 48
s_load_dwordx2 s[4:5], s[0:1], 56
v_lshrrev_b32 v1, 6, v0
v_and_b32 v0, 63, v0
v_readfirstlane_b32 s28, v1
s_and_b32 s35, s2, 7
s_lshr_b32 s41, s2, 3
s_and_b32 s29, s35, 7
s_lshl_b32 s29, s29, 1
s_and_b32 s30, s41, 1
s_add_u32 s29, s29, s30
s_lshr_b32 s30, s35, 3
s_lshl_b32 s30, s30, 4
s_lshr_b32 s41, s41, 1
s_add_u32 s30, s30, s41
v_and_b32 v2, 15, v0
v_lshrrev_b32 v3, 4, v0
v_lshlrev_b32 v18, 4, v0
v_lshrrev_b32 v4, 3, v0
v_and_b32 v5, 7, v0
s_lshr_b32 s35, s28, 1
s_lshl_b32 s35, s35, 5
s_and_b32 s36, s28, 1
s_lshl_b32 s36, s36, 3
s_add_u32 s35, s35, s36
v_lshrrev_b32 v6, 2, v4
v_lshlrev_b32 v6, 4, v6
v_and_b32 v7, 3, v4
v_add3_u32 v6, v6, v7, s35
v_lshlrev_b32 v6, 11, v6
v_and_b32 v7, 2, v4
v_xor_b32 v7, v7, v5
s_lshl_b32 s35, s30, 7
v_lshl_add_u32 v10, v7, 4, v6
v_add_u32 v10, s35, v10
v_xor_b32 v11, 64, v10
v_add_u32 v11, 7168, v11
s_lshl_b32 s35, s29, 3
s_lshl_b32 s36, s28, 1
s_add_u32 s47, s35, s36
s_lshl_b32 s35, s47, 15
v_add_u32 v12, s35, v18
v_add_u32 v13, 32768, v12
v_lshrrev_b32 v4, 2, v2
v_and_b32 v5, 3, v0
v_lshl_add_u32 v6, v3, 3, v4
v_lshlrev_b32 v6, 7, v6
v_lshl_add_u32 v6, v5, 3, v6
v_lshrrev_b32 v7, 1, v4
v_and_b32 v8, 1, v3
v_lshl_add_u32 v7, v8, 1, v7
v_lshl_add_u32 v14, v7, 5, v6
v_xor_b32 v15, 32, v14
v_xor_b32 v16, 64, v14
v_xor_b32 v17, 96, v14
s_waitcnt lgkmcnt(0)
s_mov_b32 s16, s6
s_and_b32 s17, s7, 0xffff
s_mov_b32 s18, 2097152
s_mov_b32 s19, 0x00020000
s_mov_b32 s20, s8
s_and_b32 s21, s9, 0xffff
s_mov_b32 s22, 268435456
s_mov_b32 s23, 0x00020000
s_mov_b32 s12, s4
s_and_b32 s13, s5, 0xffff
s_mov_b32 s14, 4194304
s_mov_b32 s15, 0x00020000
s_lshl_b32 s33, s28, 11
s_mov_b32 s34, 12582912
s_mov_b32 s41, 0
s_add_u32 m0, s33, 0
buffer_load_dwordx4 v[64:67], v12, s[20:23], s34 offen
buffer_load_dwordx4 v10, s[16:19], s41 offen lds
buffer_load_dwordx4 v[68:71], v13, s[20:23], s34 offen
buffer_load_dwordx4 v11, s[16:19], s41 offen offset:1024 lds
buffer_load_dwordx4 v[72:75], v12, s[20:23], s34 offen offset:1024
buffer_load_dwordx4 v[76:79], v13, s[20:23], s34 offen offset:1024
s_add_u32 s34, s34, 2048
s_add_u32 s41, s41, 131072
s_add_u32 m0, s33, 8192
buffer_load_dwordx4 v[80:83], v12, s[20:23], s34 offen
buffer_load_dwordx4 v10, s[16:19], s41 offen lds
buffer_load_dwordx4 v[84:87], v13, s[20:23], s34 offen
buffer_load_dwordx4 v11, s[16:19], s41 offen offset:1024 lds
buffer_load_dwordx4 v[88:91], v12, s[20:23], s34 offen offset:1024
buffer_load_dwordx4 v[92:95], v13, s[20:23], s34 offen offset:1024
s_add_u32 s34, s34, 2048
s_add_u32 s41, s41, 131072
s_add_u32 m0, s33, 16384
buffer_load_dwordx4 v[96:99], v12, s[20:23], s34 offen
buffer_load_dwordx4 v10, s[16:19], s41 offen lds
buffer_load_dwordx4 v[100:103], v13, s[20:23], s34 offen
buffer_load_dwordx4 v11, s[16:19], s41 offen offset:1024 lds
buffer_load_dwordx4 v[104:107], v12, s[20:23], s34 offen offset:1024
buffer_load_dwordx4 v[108:111], v13, s[20:23], s34 offen offset:1024
s_add_u32 s34, s34, 2048
s_add_u32 s41, s41, 131072
s_lshl_b32 s35, s47, 4
v_add_u32 v4, s35, v2
v_lshlrev_b32 v4, 11, v4
v_and_b32 v5, 1, v3
v_lshl_add_u32 v4, v5, 5, v4
v_lshrrev_b32 v5, 1, v3
v_lshl_add_u32 v4, v5, 4, v4
s_lshl_b32 s35, s30, 7
v_add_u32 v20, s35, v4
v_add_u32 v21, 32768, v20
s_lshl_b32 s48, s30, 11
s_add_u32 s49, s48, 8388608
v_mov_b32 v160, 0
v_mov_b32 v161, 0
v_mov_b32 v162, 0
v_mov_b32 v163, 0
v_mov_b32 v164, 0
v_mov_b32 v165, 0
v_mov_b32 v166, 0
v_mov_b32 v167, 0
v_mov_b32 v168, 0
v_mov_b32 v169, 0
v_mov_b32 v170, 0
v_mov_b32 v171, 0
v_mov_b32 v172, 0
v_mov_b32 v173, 0
v_mov_b32 v174, 0
v_mov_b32 v175, 0
v_mov_b32 v176, 0
v_mov_b32 v177, 0
v_mov_b32 v178, 0
v_mov_b32 v179, 0
v_mov_b32 v180, 0
v_mov_b32 v181, 0
v_mov_b32 v182, 0
v_mov_b32 v183, 0
v_mov_b32 v184, 0
v_mov_b32 v185, 0
v_mov_b32 v186, 0
v_mov_b32 v187, 0
v_mov_b32 v188, 0
v_mov_b32 v189, 0
v_mov_b32 v190, 0
v_mov_b32 v191, 0
s_waitcnt vmcnt(12)
s_barrier
ds_read_b64_tr_b16 v[128:129], v14 offset:0
ds_read_b64_tr_b16 v[130:131], v14 offset:512
ds_read_b64_tr_b16 v[132:133], v15 offset:0
ds_read_b64_tr_b16 v[134:135], v15 offset:512
ds_read_b64_tr_b16 v[136:137], v16 offset:0
ds_read_b64_tr_b16 v[138:139], v16 offset:512
ds_read_b64_tr_b16 v[140:141], v17 offset:0
ds_read_b64_tr_b16 v[142:143], v17 offset:512
s_waitcnt lgkmcnt(0)
v_mfma_f32_16x16x32_bf16 v[160:163], v[128:131], v[64:67], v[160:163]
ds_read_b64_tr_b16 v[144:145], v14 offset:4096
ds_read_b64_tr_b16 v[146:147], v14 offset:4608
v_mfma_f32_16x16x32_bf16 v[176:179], v[128:131], v[68:71], v[176:179]
ds_read_b64_tr_b16 v[148:149], v15 offset:4096
ds_read_b64_tr_b16 v[150:151], v15 offset:4608
v_mfma_f32_16x16x32_bf16 v[164:167], v[132:135], v[64:67], v[164:167]
ds_read_b64_tr_b16 v[152:153], v16 offset:4096
ds_read_b64_tr_b16 v[154:155], v16 offset:4608
v_mfma_f32_16x16x32_bf16 v[180:183], v[132:135], v[68:71], v[180:183]
ds_read_b64_tr_b16 v[156:157], v17 offset:4096
ds_read_b64_tr_b16 v[158:159], v17 offset:4608
v_mfma_f32_16x16x32_bf16 v[168:171], v[136:139], v[64:67], v[168:171]
s_add_u32 m0, s33, 24576
buffer_load_dwordx4 v[112:115], v12, s[20:23], s34 offen
v_mfma_f32_16x16x32_bf16 v[184:187], v[136:139], v[68:71], v[184:187]
buffer_load_dwordx4 v10, s[16:19], s41 offen lds
buffer_load_dwordx4 v[116:119], v13, s[20:23], s34 offen
v_mfma_f32_16x16x32_bf16 v[172:175], v[140:143], v[64:67], v[172:175]
buffer_load_dwordx4 v11, s[16:19], s41 offen offset:1024 lds
buffer_load_dwordx4 v[120:123], v12, s[20:23], s34 offen offset:1024
v_mfma_f32_16x16x32_bf16 v[188:191], v[140:143], v[68:71], v[188:191]
buffer_load_dwordx4 v[124:127], v13, s[20:23], s34 offen offset:1024
s_add_u32 s34, s34, 2048
s_add_u32 s41, s41, 131072
s_waitcnt vmcnt(12) lgkmcnt(0)
s_barrier
v_mfma_f32_16x16x32_bf16 v[160:163], v[144:147], v[72:75], v[160:163]
ds_read_b64_tr_b16 v[128:129], v14 offset:8192
v_mfma_f32_16x16x32_bf16 v[176:179], v[144:147], v[76:79], v[176:179]
ds_read_b64_tr_b16 v[130:131], v14 offset:8704
v_mfma_f32_16x16x32_bf16 v[164:167], v[148:151], v[72:75], v[164:167]
ds_read_b64_tr_b16 v[132:133], v15 offset:8192
v_mfma_f32_16x16x32_bf16 v[180:183], v[148:151], v[76:79], v[180:183]
ds_read_b64_tr_b16 v[134:135], v15 offset:8704
v_mfma_f32_16x16x32_bf16 v[168:171], v[152:155], v[72:75], v[168:171]
ds_read_b64_tr_b16 v[136:137], v16 offset:8192
v_mfma_f32_16x16x32_bf16 v[184:187], v[152:155], v[76:79], v[184:187]
ds_read_b64_tr_b16 v[138:139], v16 offset:8704
v_mfma_f32_16x16x32_bf16 v[172:175], v[156:159], v[72:75], v[172:175]
ds_read_b64_tr_b16 v[140:141], v17 offset:8192
v_mfma_f32_16x16x32_bf16 v[188:191], v[156:159], v[76:79], v[188:191]
ds_read_b64_tr_b16 v[142:143], v17 offset:8704
s_waitcnt lgkmcnt(0)
v_mfma_f32_16x16x32_bf16 v[160:163], v[128:131], v[80:83], v[160:163]
ds_read_b64_tr_b16 v[144:145], v14 offset:12288
ds_read_b64_tr_b16 v[146:147], v14 offset:12800
v_mfma_f32_16x16x32_bf16 v[176:179], v[128:131], v[84:87], v[176:179]
ds_read_b64_tr_b16 v[148:149], v15 offset:12288
ds_read_b64_tr_b16 v[150:151], v15 offset:12800
v_mfma_f32_16x16x32_bf16 v[164:167], v[132:135], v[80:83], v[164:167]
ds_read_b64_tr_b16 v[152:153], v16 offset:12288
ds_read_b64_tr_b16 v[154:155], v16 offset:12800
v_mfma_f32_16x16x32_bf16 v[180:183], v[132:135], v[84:87], v[180:183]
ds_read_b64_tr_b16 v[156:157], v17 offset:12288
ds_read_b64_tr_b16 v[158:159], v17 offset:12800
v_mfma_f32_16x16x32_bf16 v[168:171], v[136:139], v[80:83], v[168:171]
s_add_u32 m0, s33, 32768
buffer_load_dwordx4 v[64:67], v12, s[20:23], s34 offen
v_mfma_f32_16x16x32_bf16 v[184:187], v[136:139], v[84:87], v[184:187]
buffer_load_dwordx4 v10, s[16:19], s41 offen lds
buffer_load_dwordx4 v[68:71], v13, s[20:23], s34 offen
v_mfma_f32_16x16x32_bf16 v[172:175], v[140:143], v[80:83], v[172:175]
buffer_load_dwordx4 v11, s[16:19], s41 offen offset:1024 lds
buffer_load_dwordx4 v[72:75], v12, s[20:23], s34 offen offset:1024
v_mfma_f32_16x16x32_bf16 v[188:191], v[140:143], v[84:87], v[188:191]
buffer_load_dwordx4 v[76:79], v13, s[20:23], s34 offen offset:1024
s_add_u32 s34, s34, 2048
s_add_u32 s41, s41, 131072
s_waitcnt vmcnt(12) lgkmcnt(0)
s_barrier
v_mfma_f32_16x16x32_bf16 v[160:163], v[144:147], v[88:91], v[160:163]
ds_read_b64_tr_b16 v[128:129], v14 offset:16384
v_mfma_f32_16x16x32_bf16 v[176:179], v[144:147], v[92:95], v[176:179]
ds_read_b64_tr_b16 v[130:131], v14 offset:16896
v_mfma_f32_16x16x32_bf16 v[164:167], v[148:151], v[88:91], v[164:167]
ds_read_b64_tr_b16 v[132:133], v15 offset:16384
v_mfma_f32_16x16x32_bf16 v[180:183], v[148:151], v[92:95], v[180:183]
ds_read_b64_tr_b16 v[134:135], v15 offset:16896
v_mfma_f32_16x16x32_bf16 v[168:171], v[152:155], v[88:91], v[168:171]
ds_read_b64_tr_b16 v[136:137], v16 offset:16384
v_mfma_f32_16x16x32_bf16 v[184:187], v[152:155], v[92:95], v[184:187]
ds_read_b64_tr_b16 v[138:139], v16 offset:16896
v_mfma_f32_16x16x32_bf16 v[172:175], v[156:159], v[88:91], v[172:175]
ds_read_b64_tr_b16 v[140:141], v17 offset:16384
v_mfma_f32_16x16x32_bf16 v[188:191], v[156:159], v[92:95], v[188:191]
ds_read_b64_tr_b16 v[142:143], v17 offset:16896
s_waitcnt lgkmcnt(0)
v_mfma_f32_16x16x32_bf16 v[160:163], v[128:131], v[96:99], v[160:163]
ds_read_b64_tr_b16 v[144:145], v14 offset:20480
ds_read_b64_tr_b16 v[146:147], v14 offset:20992
v_mfma_f32_16x16x32_bf16 v[176:179], v[128:131], v[100:103], v[176:179]
ds_read_b64_tr_b16 v[148:149], v15 offset:20480
ds_read_b64_tr_b16 v[150:151], v15 offset:20992
v_mfma_f32_16x16x32_bf16 v[164:167], v[132:135], v[96:99], v[164:167]
ds_read_b64_tr_b16 v[152:153], v16 offset:20480
ds_read_b64_tr_b16 v[154:155], v16 offset:20992
v_mfma_f32_16x16x32_bf16 v[180:183], v[132:135], v[100:103], v[180:183]
ds_read_b64_tr_b16 v[156:157], v17 offset:20480
ds_read_b64_tr_b16 v[158:159], v17 offset:20992
v_mfma_f32_16x16x32_bf16 v[168:171], v[136:139], v[96:99], v[168:171]
s_add_u32 m0, s33, 40960
buffer_load_dwordx4 v[80:83], v12, s[20:23], s34 offen
v_mfma_f32_16x16x32_bf16 v[184:187], v[136:139], v[100:103], v[184:187]
buffer_load_dwordx4 v10, s[16:19], s41 offen lds
buffer_load_dwordx4 v[84:87], v13, s[20:23], s34 offen
v_mfma_f32_16x16x32_bf16 v[172:175], v[140:143], v[96:99], v[172:175]
buffer_load_dwordx4 v11, s[16:19], s41 offen offset:1024 lds
buffer_load_dwordx4 v[88:91], v12, s[20:23], s34 offen offset:1024
v_mfma_f32_16x16x32_bf16 v[188:191], v[140:143], v[100:103], v[188:191]
buffer_load_dwordx4 v[92:95], v13, s[20:23], s34 offen offset:1024
s_add_u32 s34, s34, 2048
s_add_u32 s41, s41, 131072
s_waitcnt vmcnt(12) lgkmcnt(0)
s_barrier
v_mfma_f32_16x16x32_bf16 v[160:163], v[144:147], v[104:107], v[160:163]
ds_read_b64_tr_b16 v[128:129], v14 offset:24576
v_mfma_f32_16x16x32_bf16 v[176:179], v[144:147], v[108:111], v[176:179]
ds_read_b64_tr_b16 v[130:131], v14 offset:25088
v_mfma_f32_16x16x32_bf16 v[164:167], v[148:151], v[104:107], v[164:167]
ds_read_b64_tr_b16 v[132:133], v15 offset:24576
v_mfma_f32_16x16x32_bf16 v[180:183], v[148:151], v[108:111], v[180:183]
ds_read_b64_tr_b16 v[134:135], v15 offset:25088
v_mfma_f32_16x16x32_bf16 v[168:171], v[152:155], v[104:107], v[168:171]
ds_read_b64_tr_b16 v[136:137], v16 offset:24576
v_mfma_f32_16x16x32_bf16 v[184:187], v[152:155], v[108:111], v[184:187]
ds_read_b64_tr_b16 v[138:139], v16 offset:25088
v_mfma_f32_16x16x32_bf16 v[172:175], v[156:159], v[104:107], v[172:175]
ds_read_b64_tr_b16 v[140:141], v17 offset:24576
v_mfma_f32_16x16x32_bf16 v[188:191], v[156:159], v[108:111], v[188:191]
ds_read_b64_tr_b16 v[142:143], v17 offset:25088
s_waitcnt lgkmcnt(0)
v_mfma_f32_16x16x32_bf16 v[160:163], v[128:131], v[112:115], v[160:163]
ds_read_b64_tr_b16 v[144:145], v14 offset:28672
ds_read_b64_tr_b16 v[146:147], v14 offset:29184
v_mfma_f32_16x16x32_bf16 v[176:179], v[128:131], v[116:119], v[176:179]
ds_read_b64_tr_b16 v[148:149], v15 offset:28672
ds_read_b64_tr_b16 v[150:151], v15 offset:29184
v_mfma_f32_16x16x32_bf16 v[164:167], v[132:135], v[112:115], v[164:167]
ds_read_b64_tr_b16 v[152:153], v16 offset:28672
ds_read_b64_tr_b16 v[154:155], v16 offset:29184
v_mfma_f32_16x16x32_bf16 v[180:183], v[132:135], v[116:119], v[180:183]
ds_read_b64_tr_b16 v[156:157], v17 offset:28672
ds_read_b64_tr_b16 v[158:159], v17 offset:29184
v_mfma_f32_16x16x32_bf16 v[168:171], v[136:139], v[112:115], v[168:171]
s_add_u32 m0, s33, 49152
buffer_load_dwordx4 v[96:99], v12, s[20:23], s34 offen
v_mfma_f32_16x16x32_bf16 v[184:187], v[136:139], v[116:119], v[184:187]
buffer_load_dwordx4 v10, s[16:19], s41 offen lds
buffer_load_dwordx4 v[100:103], v13, s[20:23], s34 offen
v_mfma_f32_16x16x32_bf16 v[172:175], v[140:143], v[112:115], v[172:175]
buffer_load_dwordx4 v11, s[16:19], s41 offen offset:1024 lds
buffer_load_dwordx4 v[104:107], v12, s[20:23], s34 offen offset:1024
v_mfma_f32_16x16x32_bf16 v[188:191], v[140:143], v[116:119], v[188:191]
buffer_load_dwordx4 v[108:111], v13, s[20:23], s34 offen offset:1024
s_add_u32 s34, s34, 2048
s_add_u32 s41, s41, 131072
s_waitcnt vmcnt(12) lgkmcnt(0)
s_barrier
v_mfma_f32_16x16x32_bf16 v[160:163], v[144:147], v[120:123], v[160:163]
ds_read_b64_tr_b16 v[128:129], v14 offset:32768
v_mfma_f32_16x16x32_bf16 v[176:179], v[144:147], v[124:127], v[176:179]
ds_read_b64_tr_b16 v[130:131], v14 offset:33280
v_mfma_f32_16x16x32_bf16 v[164:167], v[148:151], v[120:123], v[164:167]
ds_read_b64_tr_b16 v[132:133], v15 offset:32768
v_mfma_f32_16x16x32_bf16 v[180:183], v[148:151], v[124:127], v[180:183]
ds_read_b64_tr_b16 v[134:135], v15 offset:33280
v_mfma_f32_16x16x32_bf16 v[168:171], v[152:155], v[120:123], v[168:171]
ds_read_b64_tr_b16 v[136:137], v16 offset:32768
v_mfma_f32_16x16x32_bf16 v[184:187], v[152:155], v[124:127], v[184:187]
ds_read_b64_tr_b16 v[138:139], v16 offset:33280
v_mfma_f32_16x16x32_bf16 v[172:175], v[156:159], v[120:123], v[172:175]
ds_read_b64_tr_b16 v[140:141], v17 offset:32768
v_mfma_f32_16x16x32_bf16 v[188:191], v[156:159], v[124:127], v[188:191]
ds_read_b64_tr_b16 v[142:143], v17 offset:33280
s_waitcnt lgkmcnt(0)
v_mfma_f32_16x16x32_bf16 v[160:163], v[128:131], v[64:67], v[160:163]
ds_read_b64_tr_b16 v[144:145], v14 offset:36864
ds_read_b64_tr_b16 v[146:147], v14 offset:37376
v_mfma_f32_16x16x32_bf16 v[176:179], v[128:131], v[68:71], v[176:179]
ds_read_b64_tr_b16 v[148:149], v15 offset:36864
ds_read_b64_tr_b16 v[150:151], v15 offset:37376
v_mfma_f32_16x16x32_bf16 v[164:167], v[132:135], v[64:67], v[164:167]
ds_read_b64_tr_b16 v[152:153], v16 offset:36864
ds_read_b64_tr_b16 v[154:155], v16 offset:37376
v_mfma_f32_16x16x32_bf16 v[180:183], v[132:135], v[68:71], v[180:183]
ds_read_b64_tr_b16 v[156:157], v17 offset:36864
ds_read_b64_tr_b16 v[158:159], v17 offset:37376
v_mfma_f32_16x16x32_bf16 v[168:171], v[136:139], v[64:67], v[168:171]
s_add_u32 m0, s33, 57344
buffer_load_dwordx4 v[112:115], v12, s[20:23], s34 offen
v_mfma_f32_16x16x32_bf16 v[184:187], v[136:139], v[68:71], v[184:187]
buffer_load_dwordx4 v10, s[16:19], s41 offen lds
buffer_load_dwordx4 v[116:119], v13, s[20:23], s34 offen
v_mfma_f32_16x16x32_bf16 v[172:175], v[140:143], v[64:67], v[172:175]
buffer_load_dwordx4 v11, s[16:19], s41 offen offset:1024 lds
buffer_load_dwordx4 v[120:123], v12, s[20:23], s34 offen offset:1024
v_mfma_f32_16x16x32_bf16 v[188:191], v[140:143], v[68:71], v[188:191]
buffer_load_dwordx4 v[124:127], v13, s[20:23], s34 offen offset:1024
s_add_u32 s34, s34, 2048
s_add_u32 s41, s41, 131072
s_waitcnt vmcnt(12) lgkmcnt(0)
s_barrier
v_mfma_f32_16x16x32_bf16 v[160:163], v[144:147], v[72:75], v[160:163]
ds_read_b64_tr_b16 v[128:129], v14 offset:40960
v_mfma_f32_16x16x32_bf16 v[176:179], v[144:147], v[76:79], v[176:179]
ds_read_b64_tr_b16 v[130:131], v14 offset:41472
v_mfma_f32_16x16x32_bf16 v[164:167], v[148:151], v[72:75], v[164:167]
ds_read_b64_tr_b16 v[132:133], v15 offset:40960
v_mfma_f32_16x16x32_bf16 v[180:183], v[148:151], v[76:79], v[180:183]
ds_read_b64_tr_b16 v[134:135], v15 offset:41472
v_mfma_f32_16x16x32_bf16 v[168:171], v[152:155], v[72:75], v[168:171]
ds_read_b64_tr_b16 v[136:137], v16 offset:40960
v_mfma_f32_16x16x32_bf16 v[184:187], v[152:155], v[76:79], v[184:187]
ds_read_b64_tr_b16 v[138:139], v16 offset:41472
v_mfma_f32_16x16x32_bf16 v[172:175], v[156:159], v[72:75], v[172:175]
ds_read_b64_tr_b16 v[140:141], v17 offset:40960
v_mfma_f32_16x16x32_bf16 v[188:191], v[156:159], v[76:79], v[188:191]
ds_read_b64_tr_b16 v[142:143], v17 offset:41472
s_waitcnt lgkmcnt(0)
v_mfma_f32_16x16x32_bf16 v[160:163], v[128:131], v[80:83], v[160:163]
ds_read_b64_tr_b16 v[144:145], v14 offset:45056
ds_read_b64_tr_b16 v[146:147], v14 offset:45568
v_mfma_f32_16x16x32_bf16 v[176:179], v[128:131], v[84:87], v[176:179]
ds_read_b64_tr_b16 v[148:149], v15 offset:45056
ds_read_b64_tr_b16 v[150:151], v15 offset:45568
v_mfma_f32_16x16x32_bf16 v[164:167], v[132:135], v[80:83], v[164:167]
ds_read_b64_tr_b16 v[152:153], v16 offset:45056
ds_read_b64_tr_b16 v[154:155], v16 offset:45568
v_mfma_f32_16x16x32_bf16 v[180:183], v[132:135], v[84:87], v[180:183]
ds_read_b64_tr_b16 v[156:157], v17 offset:45056
ds_read_b64_tr_b16 v[158:159], v17 offset:45568
v_mfma_f32_16x16x32_bf16 v[168:171], v[136:139], v[80:83], v[168:171]
s_add_u32 m0, s33, 65536
buffer_load_dwordx4 v[64:67], v12, s[20:23], s34 offen
v_mfma_f32_16x16x32_bf16 v[184:187], v[136:139], v[84:87], v[184:187]
buffer_load_dwordx4 v10, s[16:19], s41 offen lds
buffer_load_dwordx4 v[68:71], v13, s[20:23], s34 offen
v_mfma_f32_16x16x32_bf16 v[172:175], v[140:143], v[80:83], v[172:175]
buffer_load_dwordx4 v11, s[16:19], s41 offen offset:1024 lds
buffer_load_dwordx4 v[72:75], v12, s[20:23], s34 offen offset:1024
v_mfma_f32_16x16x32_bf16 v[188:191], v[140:143], v[84:87], v[188:191]
buffer_load_dwordx4 v[76:79], v13, s[20:23], s34 offen offset:1024
s_add_u32 s34, s34, 2048
s_add_u32 s41, s41, 131072
s_waitcnt vmcnt(12) lgkmcnt(0)
s_barrier
v_mfma_f32_16x16x32_bf16 v[160:163], v[144:147], v[88:91], v[160:163]
ds_read_b64_tr_b16 v[128:129], v14 offset:49152
v_mfma_f32_16x16x32_bf16 v[176:179], v[144:147], v[92:95], v[176:179]
ds_read_b64_tr_b16 v[130:131], v14 offset:49664
v_mfma_f32_16x16x32_bf16 v[164:167], v[148:151], v[88:91], v[164:167]
ds_read_b64_tr_b16 v[132:133], v15 offset:49152
v_mfma_f32_16x16x32_bf16 v[180:183], v[148:151], v[92:95], v[180:183]
ds_read_b64_tr_b16 v[134:135], v15 offset:49664
v_mfma_f32_16x16x32_bf16 v[168:171], v[152:155], v[88:91], v[168:171]
ds_read_b64_tr_b16 v[136:137], v16 offset:49152
v_mfma_f32_16x16x32_bf16 v[184:187], v[152:155], v[92:95], v[184:187]
ds_read_b64_tr_b16 v[138:139], v16 offset:49664
v_mfma_f32_16x16x32_bf16 v[172:175], v[156:159], v[88:91], v[172:175]
ds_read_b64_tr_b16 v[140:141], v17 offset:49152
v_mfma_f32_16x16x32_bf16 v[188:191], v[156:159], v[92:95], v[188:191]
ds_read_b64_tr_b16 v[142:143], v17 offset:49664
s_waitcnt lgkmcnt(0)
v_mfma_f32_16x16x32_bf16 v[160:163], v[128:131], v[96:99], v[160:163]
ds_read_b64_tr_b16 v[144:145], v14 offset:53248
ds_read_b64_tr_b16 v[146:147], v14 offset:53760
v_mfma_f32_16x16x32_bf16 v[176:179], v[128:131], v[100:103], v[176:179]
ds_read_b64_tr_b16 v[148:149], v15 offset:53248
ds_read_b64_tr_b16 v[150:151], v15 offset:53760
v_mfma_f32_16x16x32_bf16 v[164:167], v[132:135], v[96:99], v[164:167]
ds_read_b64_tr_b16 v[152:153], v16 offset:53248
ds_read_b64_tr_b16 v[154:155], v16 offset:53760
v_mfma_f32_16x16x32_bf16 v[180:183], v[132:135], v[100:103], v[180:183]
ds_read_b64_tr_b16 v[156:157], v17 offset:53248
ds_read_b64_tr_b16 v[158:159], v17 offset:53760
v_mfma_f32_16x16x32_bf16 v[168:171], v[136:139], v[96:99], v[168:171]
s_add_u32 m0, s33, 73728
buffer_load_dwordx4 v[80:83], v12, s[20:23], s34 offen
v_mfma_f32_16x16x32_bf16 v[184:187], v[136:139], v[100:103], v[184:187]
buffer_load_dwordx4 v10, s[16:19], s41 offen lds
buffer_load_dwordx4 v[84:87], v13, s[20:23], s34 offen
v_mfma_f32_16x16x32_bf16 v[172:175], v[140:143], v[96:99], v[172:175]
buffer_load_dwordx4 v11, s[16:19], s41 offen offset:1024 lds
buffer_load_dwordx4 v[88:91], v12, s[20:23], s34 offen offset:1024
v_mfma_f32_16x16x32_bf16 v[188:191], v[140:143], v[100:103], v[188:191]
buffer_load_dwordx4 v[92:95], v13, s[20:23], s34 offen offset:1024
s_add_u32 s34, s34, 2048
s_add_u32 s41, s41, 131072
s_waitcnt vmcnt(12) lgkmcnt(0)
s_barrier
v_mfma_f32_16x16x32_bf16 v[160:163], v[144:147], v[104:107], v[160:163]
ds_read_b64_tr_b16 v[128:129], v14 offset:57344
v_mfma_f32_16x16x32_bf16 v[176:179], v[144:147], v[108:111], v[176:179]
ds_read_b64_tr_b16 v[130:131], v14 offset:57856
v_mfma_f32_16x16x32_bf16 v[164:167], v[148:151], v[104:107], v[164:167]
ds_read_b64_tr_b16 v[132:133], v15 offset:57344
v_mfma_f32_16x16x32_bf16 v[180:183], v[148:151], v[108:111], v[180:183]
ds_read_b64_tr_b16 v[134:135], v15 offset:57856
v_mfma_f32_16x16x32_bf16 v[168:171], v[152:155], v[104:107], v[168:171]
ds_read_b64_tr_b16 v[136:137], v16 offset:57344
v_mfma_f32_16x16x32_bf16 v[184:187], v[152:155], v[108:111], v[184:187]
ds_read_b64_tr_b16 v[138:139], v16 offset:57856
v_mfma_f32_16x16x32_bf16 v[172:175], v[156:159], v[104:107], v[172:175]
ds_read_b64_tr_b16 v[140:141], v17 offset:57344
v_mfma_f32_16x16x32_bf16 v[188:191], v[156:159], v[108:111], v[188:191]
ds_read_b64_tr_b16 v[142:143], v17 offset:57856
s_waitcnt lgkmcnt(0)
v_mfma_f32_16x16x32_bf16 v[160:163], v[128:131], v[112:115], v[160:163]
ds_read_b64_tr_b16 v[144:145], v14 offset:61440
ds_read_b64_tr_b16 v[146:147], v14 offset:61952
v_mfma_f32_16x16x32_bf16 v[176:179], v[128:131], v[116:119], v[176:179]
ds_read_b64_tr_b16 v[148:149], v15 offset:61440
ds_read_b64_tr_b16 v[150:151], v15 offset:61952
v_mfma_f32_16x16x32_bf16 v[164:167], v[132:135], v[112:115], v[164:167]
ds_read_b64_tr_b16 v[152:153], v16 offset:61440
ds_read_b64_tr_b16 v[154:155], v16 offset:61952
v_mfma_f32_16x16x32_bf16 v[180:183], v[132:135], v[116:119], v[180:183]
ds_read_b64_tr_b16 v[156:157], v17 offset:61440
ds_read_b64_tr_b16 v[158:159], v17 offset:61952
v_mfma_f32_16x16x32_bf16 v[168:171], v[136:139], v[112:115], v[168:171]
s_add_u32 m0, s33, 81920
buffer_load_dwordx4 v[96:99], v12, s[20:23], s34 offen
v_mfma_f32_16x16x32_bf16 v[184:187], v[136:139], v[116:119], v[184:187]
buffer_load_dwordx4 v10, s[16:19], s41 offen lds
buffer_load_dwordx4 v[100:103], v13, s[20:23], s34 offen
v_mfma_f32_16x16x32_bf16 v[172:175], v[140:143], v[112:115], v[172:175]
buffer_load_dwordx4 v11, s[16:19], s41 offen offset:1024 lds
buffer_load_dwordx4 v[104:107], v12, s[20:23], s34 offen offset:1024
v_mfma_f32_16x16x32_bf16 v[188:191], v[140:143], v[116:119], v[188:191]
buffer_load_dwordx4 v[108:111], v13, s[20:23], s34 offen offset:1024
s_add_u32 s34, s34, 2048
s_add_u32 s41, s41, 131072
s_waitcnt vmcnt(12) lgkmcnt(0)
s_barrier
v_add_u32 v14, 0x10000, v14
v_add_u32 v15, 0x10000, v15
v_add_u32 v16, 0x10000, v16
v_add_u32 v17, 0x10000, v17
v_mfma_f32_16x16x32_bf16 v[160:163], v[144:147], v[120:123], v[160:163]
ds_read_b64_tr_b16 v[128:129], v14 offset:0
v_mfma_f32_16x16x32_bf16 v[176:179], v[144:147], v[124:127], v[176:179]
ds_read_b64_tr_b16 v[130:131], v14 offset:512
v_mfma_f32_16x16x32_bf16 v[164:167], v[148:151], v[120:123], v[164:167]
ds_read_b64_tr_b16 v[132:133], v15 offset:0
v_mfma_f32_16x16x32_bf16 v[180:183], v[148:151], v[124:127], v[180:183]
ds_read_b64_tr_b16 v[134:135], v15 offset:512
v_mfma_f32_16x16x32_bf16 v[168:171], v[152:155], v[120:123], v[168:171]
ds_read_b64_tr_b16 v[136:137], v16 offset:0
v_mfma_f32_16x16x32_bf16 v[184:187], v[152:155], v[124:127], v[184:187]
ds_read_b64_tr_b16 v[138:139], v16 offset:512
v_mfma_f32_16x16x32_bf16 v[172:175], v[156:159], v[120:123], v[172:175]
ds_read_b64_tr_b16 v[140:141], v17 offset:0
v_mfma_f32_16x16x32_bf16 v[188:191], v[156:159], v[124:127], v[188:191]
ds_read_b64_tr_b16 v[142:143], v17 offset:512
s_waitcnt lgkmcnt(0)
v_mfma_f32_16x16x32_bf16 v[160:163], v[128:131], v[64:67], v[160:163]
ds_read_b64_tr_b16 v[144:145], v14 offset:4096
ds_read_b64_tr_b16 v[146:147], v14 offset:4608
v_mfma_f32_16x16x32_bf16 v[176:179], v[128:131], v[68:71], v[176:179]
ds_read_b64_tr_b16 v[148:149], v15 offset:4096
ds_read_b64_tr_b16 v[150:151], v15 offset:4608
v_mfma_f32_16x16x32_bf16 v[164:167], v[132:135], v[64:67], v[164:167]
ds_read_b64_tr_b16 v[152:153], v16 offset:4096
ds_read_b64_tr_b16 v[154:155], v16 offset:4608
v_mfma_f32_16x16x32_bf16 v[180:183], v[132:135], v[68:71], v[180:183]
ds_read_b64_tr_b16 v[156:157], v17 offset:4096
ds_read_b64_tr_b16 v[158:159], v17 offset:4608
v_mfma_f32_16x16x32_bf16 v[168:171], v[136:139], v[64:67], v[168:171]
s_add_u32 m0, s33, 90112
buffer_load_dwordx4 v[112:115], v12, s[20:23], s34 offen
v_mfma_f32_16x16x32_bf16 v[184:187], v[136:139], v[68:71], v[184:187]
buffer_load_dwordx4 v10, s[16:19], s41 offen lds
buffer_load_dwordx4 v[116:119], v13, s[20:23], s34 offen
v_mfma_f32_16x16x32_bf16 v[172:175], v[140:143], v[64:67], v[172:175]
buffer_load_dwordx4 v11, s[16:19], s41 offen offset:1024 lds
buffer_load_dwordx4 v[120:123], v12, s[20:23], s34 offen offset:1024
v_mfma_f32_16x16x32_bf16 v[188:191], v[140:143], v[68:71], v[188:191]
buffer_load_dwordx4 v[124:127], v13, s[20:23], s34 offen offset:1024
s_add_u32 s34, s34, 2048
s_add_u32 s41, s41, 131072
s_waitcnt vmcnt(12) lgkmcnt(0)
s_barrier
v_mfma_f32_16x16x32_bf16 v[160:163], v[144:147], v[72:75], v[160:163]
ds_read_b64_tr_b16 v[128:129], v14 offset:8192
v_mfma_f32_16x16x32_bf16 v[176:179], v[144:147], v[76:79], v[176:179]
ds_read_b64_tr_b16 v[130:131], v14 offset:8704
v_mfma_f32_16x16x32_bf16 v[164:167], v[148:151], v[72:75], v[164:167]
ds_read_b64_tr_b16 v[132:133], v15 offset:8192
v_mfma_f32_16x16x32_bf16 v[180:183], v[148:151], v[76:79], v[180:183]
ds_read_b64_tr_b16 v[134:135], v15 offset:8704
v_mfma_f32_16x16x32_bf16 v[168:171], v[152:155], v[72:75], v[168:171]
ds_read_b64_tr_b16 v[136:137], v16 offset:8192
v_mfma_f32_16x16x32_bf16 v[184:187], v[152:155], v[76:79], v[184:187]
ds_read_b64_tr_b16 v[138:139], v16 offset:8704
v_mfma_f32_16x16x32_bf16 v[172:175], v[156:159], v[72:75], v[172:175]
ds_read_b64_tr_b16 v[140:141], v17 offset:8192
v_mfma_f32_16x16x32_bf16 v[188:191], v[156:159], v[76:79], v[188:191]
ds_read_b64_tr_b16 v[142:143], v17 offset:8704
s_waitcnt lgkmcnt(0)
v_mfma_f32_16x16x32_bf16 v[160:163], v[128:131], v[80:83], v[160:163]
ds_read_b64_tr_b16 v[144:145], v14 offset:12288
ds_read_b64_tr_b16 v[146:147], v14 offset:12800
v_mfma_f32_16x16x32_bf16 v[176:179], v[128:131], v[84:87], v[176:179]
ds_read_b64_tr_b16 v[148:149], v15 offset:12288
ds_read_b64_tr_b16 v[150:151], v15 offset:12800
v_mfma_f32_16x16x32_bf16 v[164:167], v[132:135], v[80:83], v[164:167]
ds_read_b64_tr_b16 v[152:153], v16 offset:12288
ds_read_b64_tr_b16 v[154:155], v16 offset:12800
v_mfma_f32_16x16x32_bf16 v[180:183], v[132:135], v[84:87], v[180:183]
ds_read_b64_tr_b16 v[156:157], v17 offset:12288
ds_read_b64_tr_b16 v[158:159], v17 offset:12800
v_mfma_f32_16x16x32_bf16 v[168:171], v[136:139], v[80:83], v[168:171]
s_add_u32 m0, s33, 98304
buffer_load_dwordx4 v[64:67], v12, s[20:23], s34 offen
v_mfma_f32_16x16x32_bf16 v[184:187], v[136:139], v[84:87], v[184:187]
buffer_load_dwordx4 v10, s[16:19], s41 offen lds
buffer_load_dwordx4 v[68:71], v13, s[20:23], s34 offen
v_mfma_f32_16x16x32_bf16 v[172:175], v[140:143], v[80:83], v[172:175]
buffer_load_dwordx4 v11, s[16:19], s41 offen offset:1024 lds
buffer_load_dwordx4 v[72:75], v12, s[20:23], s34 offen offset:1024
v_mfma_f32_16x16x32_bf16 v[188:191], v[140:143], v[84:87], v[188:191]
buffer_load_dwordx4 v[76:79], v13, s[20:23], s34 offen offset:1024
s_add_u32 s34, s34, 2048
s_add_u32 s41, s41, 131072
s_waitcnt vmcnt(12) lgkmcnt(0)
s_barrier
v_mfma_f32_16x16x32_bf16 v[160:163], v[144:147], v[88:91], v[160:163]
ds_read_b64_tr_b16 v[128:129], v14 offset:16384
v_mfma_f32_16x16x32_bf16 v[176:179], v[144:147], v[92:95], v[176:179]
ds_read_b64_tr_b16 v[130:131], v14 offset:16896
v_mfma_f32_16x16x32_bf16 v[164:167], v[148:151], v[88:91], v[164:167]
ds_read_b64_tr_b16 v[132:133], v15 offset:16384
v_mfma_f32_16x16x32_bf16 v[180:183], v[148:151], v[92:95], v[180:183]
ds_read_b64_tr_b16 v[134:135], v15 offset:16896
v_mfma_f32_16x16x32_bf16 v[168:171], v[152:155], v[88:91], v[168:171]
ds_read_b64_tr_b16 v[136:137], v16 offset:16384
v_mfma_f32_16x16x32_bf16 v[184:187], v[152:155], v[92:95], v[184:187]
ds_read_b64_tr_b16 v[138:139], v16 offset:16896
v_mfma_f32_16x16x32_bf16 v[172:175], v[156:159], v[88:91], v[172:175]
ds_read_b64_tr_b16 v[140:141], v17 offset:16384
v_mfma_f32_16x16x32_bf16 v[188:191], v[156:159], v[92:95], v[188:191]
ds_read_b64_tr_b16 v[142:143], v17 offset:16896
s_waitcnt lgkmcnt(0)
v_mfma_f32_16x16x32_bf16 v[160:163], v[128:131], v[96:99], v[160:163]
ds_read_b64_tr_b16 v[144:145], v14 offset:20480
ds_read_b64_tr_b16 v[146:147], v14 offset:20992
v_mfma_f32_16x16x32_bf16 v[176:179], v[128:131], v[100:103], v[176:179]
ds_read_b64_tr_b16 v[148:149], v15 offset:20480
ds_read_b64_tr_b16 v[150:151], v15 offset:20992
v_mfma_f32_16x16x32_bf16 v[164:167], v[132:135], v[96:99], v[164:167]
ds_read_b64_tr_b16 v[152:153], v16 offset:20480
ds_read_b64_tr_b16 v[154:155], v16 offset:20992
v_mfma_f32_16x16x32_bf16 v[180:183], v[132:135], v[100:103], v[180:183]
ds_read_b64_tr_b16 v[156:157], v17 offset:20480
ds_read_b64_tr_b16 v[158:159], v17 offset:20992
v_mfma_f32_16x16x32_bf16 v[168:171], v[136:139], v[96:99], v[168:171]
s_add_u32 m0, s33, 106496
buffer_load_dwordx4 v[80:83], v12, s[20:23], s34 offen
v_mfma_f32_16x16x32_bf16 v[184:187], v[136:139], v[100:103], v[184:187]
buffer_load_dwordx4 v10, s[16:19], s41 offen lds
buffer_load_dwordx4 v[84:87], v13, s[20:23], s34 offen
v_mfma_f32_16x16x32_bf16 v[172:175], v[140:143], v[96:99], v[172:175]
buffer_load_dwordx4 v11, s[16:19], s41 offen offset:1024 lds
buffer_load_dwordx4 v[88:91], v12, s[20:23], s34 offen offset:1024
v_mfma_f32_16x16x32_bf16 v[188:191], v[140:143], v[100:103], v[188:191]
buffer_load_dwordx4 v[92:95], v13, s[20:23], s34 offen offset:1024
s_add_u32 s34, s34, 2048
s_add_u32 s41, s41, 131072
s_waitcnt vmcnt(12) lgkmcnt(0)
s_barrier
v_mfma_f32_16x16x32_bf16 v[160:163], v[144:147], v[104:107], v[160:163]
ds_read_b64_tr_b16 v[128:129], v14 offset:24576
v_mfma_f32_16x16x32_bf16 v[176:179], v[144:147], v[108:111], v[176:179]
ds_read_b64_tr_b16 v[130:131], v14 offset:25088
v_mfma_f32_16x16x32_bf16 v[164:167], v[148:151], v[104:107], v[164:167]
ds_read_b64_tr_b16 v[132:133], v15 offset:24576
v_mfma_f32_16x16x32_bf16 v[180:183], v[148:151], v[108:111], v[180:183]
ds_read_b64_tr_b16 v[134:135], v15 offset:25088
v_mfma_f32_16x16x32_bf16 v[168:171], v[152:155], v[104:107], v[168:171]
ds_read_b64_tr_b16 v[136:137], v16 offset:24576
v_mfma_f32_16x16x32_bf16 v[184:187], v[152:155], v[108:111], v[184:187]
ds_read_b64_tr_b16 v[138:139], v16 offset:25088
v_mfma_f32_16x16x32_bf16 v[172:175], v[156:159], v[104:107], v[172:175]
ds_read_b64_tr_b16 v[140:141], v17 offset:24576
v_mfma_f32_16x16x32_bf16 v[188:191], v[156:159], v[108:111], v[188:191]
ds_read_b64_tr_b16 v[142:143], v17 offset:25088
s_waitcnt lgkmcnt(0)
v_mfma_f32_16x16x32_bf16 v[160:163], v[128:131], v[112:115], v[160:163]
ds_read_b64_tr_b16 v[144:145], v14 offset:28672
ds_read_b64_tr_b16 v[146:147], v14 offset:29184
v_mfma_f32_16x16x32_bf16 v[176:179], v[128:131], v[116:119], v[176:179]
ds_read_b64_tr_b16 v[148:149], v15 offset:28672
ds_read_b64_tr_b16 v[150:151], v15 offset:29184
v_mfma_f32_16x16x32_bf16 v[164:167], v[132:135], v[112:115], v[164:167]
ds_read_b64_tr_b16 v[152:153], v16 offset:28672
ds_read_b64_tr_b16 v[154:155], v16 offset:29184
v_mfma_f32_16x16x32_bf16 v[180:183], v[132:135], v[116:119], v[180:183]
ds_read_b64_tr_b16 v[156:157], v17 offset:28672
ds_read_b64_tr_b16 v[158:159], v17 offset:29184
v_mfma_f32_16x16x32_bf16 v[168:171], v[136:139], v[112:115], v[168:171]
s_add_u32 m0, s33, 114688
buffer_load_dwordx4 v[96:99], v12, s[20:23], s34 offen
v_mfma_f32_16x16x32_bf16 v[184:187], v[136:139], v[116:119], v[184:187]
buffer_load_dwordx4 v10, s[16:19], s41 offen lds
buffer_load_dwordx4 v[100:103], v13, s[20:23], s34 offen
v_mfma_f32_16x16x32_bf16 v[172:175], v[140:143], v[112:115], v[172:175]
buffer_load_dwordx4 v11, s[16:19], s41 offen offset:1024 lds
buffer_load_dwordx4 v[104:107], v12, s[20:23], s34 offen offset:1024
v_mfma_f32_16x16x32_bf16 v[188:191], v[140:143], v[116:119], v[188:191]
buffer_load_dwordx4 v[108:111], v13, s[20:23], s34 offen offset:1024
s_add_u32 s34, s34, 2048
s_add_u32 s41, s41, 131072
s_waitcnt vmcnt(12) lgkmcnt(0)
s_barrier
v_mfma_f32_16x16x32_bf16 v[160:163], v[144:147], v[120:123], v[160:163]
ds_read_b64_tr_b16 v[128:129], v14 offset:32768
v_mfma_f32_16x16x32_bf16 v[176:179], v[144:147], v[124:127], v[176:179]
ds_read_b64_tr_b16 v[130:131], v14 offset:33280
v_mfma_f32_16x16x32_bf16 v[164:167], v[148:151], v[120:123], v[164:167]
ds_read_b64_tr_b16 v[132:133], v15 offset:32768
v_mfma_f32_16x16x32_bf16 v[180:183], v[148:151], v[124:127], v[180:183]
ds_read_b64_tr_b16 v[134:135], v15 offset:33280
v_mfma_f32_16x16x32_bf16 v[168:171], v[152:155], v[120:123], v[168:171]
ds_read_b64_tr_b16 v[136:137], v16 offset:32768
v_mfma_f32_16x16x32_bf16 v[184:187], v[152:155], v[124:127], v[184:187]
ds_read_b64_tr_b16 v[138:139], v16 offset:33280
v_mfma_f32_16x16x32_bf16 v[172:175], v[156:159], v[120:123], v[172:175]
ds_read_b64_tr_b16 v[140:141], v17 offset:32768
v_mfma_f32_16x16x32_bf16 v[188:191], v[156:159], v[124:127], v[188:191]
ds_read_b64_tr_b16 v[142:143], v17 offset:33280
s_waitcnt lgkmcnt(0)
v_mfma_f32_16x16x32_bf16 v[160:163], v[128:131], v[64:67], v[160:163]
ds_read_b64_tr_b16 v[144:145], v14 offset:36864
ds_read_b64_tr_b16 v[146:147], v14 offset:37376
v_mfma_f32_16x16x32_bf16 v[176:179], v[128:131], v[68:71], v[176:179]
ds_read_b64_tr_b16 v[148:149], v15 offset:36864
ds_read_b64_tr_b16 v[150:151], v15 offset:37376
v_mfma_f32_16x16x32_bf16 v[164:167], v[132:135], v[64:67], v[164:167]
ds_read_b64_tr_b16 v[152:153], v16 offset:36864
ds_read_b64_tr_b16 v[154:155], v16 offset:37376
v_mfma_f32_16x16x32_bf16 v[180:183], v[132:135], v[68:71], v[180:183]
ds_read_b64_tr_b16 v[156:157], v17 offset:36864
ds_read_b64_tr_b16 v[158:159], v17 offset:37376
v_mfma_f32_16x16x32_bf16 v[168:171], v[136:139], v[64:67], v[168:171]
s_add_u32 m0, s33, 122880
buffer_load_dwordx4 v[112:115], v12, s[20:23], s34 offen
v_mfma_f32_16x16x32_bf16 v[184:187], v[136:139], v[68:71], v[184:187]
buffer_load_dwordx4 v10, s[16:19], s41 offen lds
buffer_load_dwordx4 v[116:119], v13, s[20:23], s34 offen
v_mfma_f32_16x16x32_bf16 v[172:175], v[140:143], v[64:67], v[172:175]
buffer_load_dwordx4 v11, s[16:19], s41 offen offset:1024 lds
buffer_load_dwordx4 v[120:123], v12, s[20:23], s34 offen offset:1024
v_mfma_f32_16x16x32_bf16 v[188:191], v[140:143], v[68:71], v[188:191]
buffer_load_dwordx4 v[124:127], v13, s[20:23], s34 offen offset:1024
s_add_u32 s34, s34, 2048
s_add_u32 s41, s41, 131072
s_waitcnt vmcnt(12) lgkmcnt(0)
s_barrier
v_mfma_f32_16x16x32_bf16 v[160:163], v[144:147], v[72:75], v[160:163]
ds_read_b64_tr_b16 v[128:129], v14 offset:40960
v_mfma_f32_16x16x32_bf16 v[176:179], v[144:147], v[76:79], v[176:179]
ds_read_b64_tr_b16 v[130:131], v14 offset:41472
v_mfma_f32_16x16x32_bf16 v[164:167], v[148:151], v[72:75], v[164:167]
ds_read_b64_tr_b16 v[132:133], v15 offset:40960
v_mfma_f32_16x16x32_bf16 v[180:183], v[148:151], v[76:79], v[180:183]
ds_read_b64_tr_b16 v[134:135], v15 offset:41472
v_mfma_f32_16x16x32_bf16 v[168:171], v[152:155], v[72:75], v[168:171]
ds_read_b64_tr_b16 v[136:137], v16 offset:40960
v_mfma_f32_16x16x32_bf16 v[184:187], v[152:155], v[76:79], v[184:187]
ds_read_b64_tr_b16 v[138:139], v16 offset:41472
v_mfma_f32_16x16x32_bf16 v[172:175], v[156:159], v[72:75], v[172:175]
ds_read_b64_tr_b16 v[140:141], v17 offset:40960
v_mfma_f32_16x16x32_bf16 v[188:191], v[156:159], v[76:79], v[188:191]
ds_read_b64_tr_b16 v[142:143], v17 offset:41472
s_waitcnt lgkmcnt(0)
v_mfma_f32_16x16x32_bf16 v[160:163], v[128:131], v[80:83], v[160:163]
ds_read_b64_tr_b16 v[144:145], v14 offset:45056
ds_read_b64_tr_b16 v[146:147], v14 offset:45568
v_mfma_f32_16x16x32_bf16 v[176:179], v[128:131], v[84:87], v[176:179]
ds_read_b64_tr_b16 v[148:149], v15 offset:45056
v_mfma_f32_16x16x32_bf16 v[164:167], v[132:135], v[80:83], v[164:167]
ds_read_b64_tr_b16 v[150:151], v15 offset:45568
ds_read_b64_tr_b16 v[152:153], v16 offset:45056
v_mfma_f32_16x16x32_bf16 v[180:183], v[132:135], v[84:87], v[180:183]
ds_read_b64_tr_b16 v[154:155], v16 offset:45568
v_mfma_f32_16x16x32_bf16 v[168:171], v[136:139], v[80:83], v[168:171]
ds_read_b64_tr_b16 v[156:157], v17 offset:45056
ds_read_b64_tr_b16 v[158:159], v17 offset:45568
v_mfma_f32_16x16x32_bf16 v[184:187], v[136:139], v[84:87], v[184:187]
buffer_load_dwordx4 v[24:27], v12, s[20:23], s49 offen offset:0
v_mfma_f32_16x16x32_bf16 v[172:175], v[140:143], v[80:83], v[172:175]
buffer_load_dwordx4 v[28:31], v12, s[20:23], s49 offen offset:1024
buffer_load_dwordx4 v[32:35], v13, s[20:23], s49 offen offset:0
v_mfma_f32_16x16x32_bf16 v[188:191], v[140:143], v[84:87], v[188:191]
buffer_load_dwordx4 v[36:39], v13, s[20:23], s49 offen offset:1024
s_waitcnt vmcnt(10) lgkmcnt(0)
s_barrier
v_mfma_f32_16x16x32_bf16 v[160:163], v[144:147], v[88:91], v[160:163]
ds_read_b64_tr_b16 v[128:129], v14 offset:49152
v_mfma_f32_16x16x32_bf16 v[176:179], v[144:147], v[92:95], v[176:179]
ds_read_b64_tr_b16 v[130:131], v14 offset:49664
v_mfma_f32_16x16x32_bf16 v[164:167], v[148:151], v[88:91], v[164:167]
ds_read_b64_tr_b16 v[132:133], v15 offset:49152
v_mfma_f32_16x16x32_bf16 v[180:183], v[148:151], v[92:95], v[180:183]
ds_read_b64_tr_b16 v[134:135], v15 offset:49664
v_mfma_f32_16x16x32_bf16 v[168:171], v[152:155], v[88:91], v[168:171]
ds_read_b64_tr_b16 v[136:137], v16 offset:49152
v_mfma_f32_16x16x32_bf16 v[184:187], v[152:155], v[92:95], v[184:187]
ds_read_b64_tr_b16 v[138:139], v16 offset:49664
v_mfma_f32_16x16x32_bf16 v[172:175], v[156:159], v[88:91], v[172:175]
ds_read_b64_tr_b16 v[140:141], v17 offset:49152
v_mfma_f32_16x16x32_bf16 v[188:191], v[156:159], v[92:95], v[188:191]
ds_read_b64_tr_b16 v[142:143], v17 offset:49664
s_waitcnt lgkmcnt(0)
v_mfma_f32_16x16x32_bf16 v[160:163], v[128:131], v[96:99], v[160:163]
ds_read_b64_tr_b16 v[144:145], v14 offset:53248
v_mfma_f32_16x16x32_bf16 v[176:179], v[128:131], v[100:103], v[176:179]
ds_read_b64_tr_b16 v[146:147], v14 offset:53760
v_mfma_f32_16x16x32_bf16 v[164:167], v[132:135], v[96:99], v[164:167]
ds_read_b64_tr_b16 v[148:149], v15 offset:53248
v_mfma_f32_16x16x32_bf16 v[180:183], v[132:135], v[100:103], v[180:183]
ds_read_b64_tr_b16 v[150:151], v15 offset:53760
v_mfma_f32_16x16x32_bf16 v[168:171], v[136:139], v[96:99], v[168:171]
ds_read_b64_tr_b16 v[152:153], v16 offset:53248
v_mfma_f32_16x16x32_bf16 v[184:187], v[136:139], v[100:103], v[184:187]
ds_read_b64_tr_b16 v[154:155], v16 offset:53760
v_mfma_f32_16x16x32_bf16 v[172:175], v[140:143], v[96:99], v[172:175]
ds_read_b64_tr_b16 v[156:157], v17 offset:53248
v_mfma_f32_16x16x32_bf16 v[188:191], v[140:143], v[100:103], v[188:191]
ds_read_b64_tr_b16 v[158:159], v17 offset:53760
s_waitcnt vmcnt(4) lgkmcnt(0)
s_barrier
v_mfma_f32_16x16x32_bf16 v[160:163], v[144:147], v[104:107], v[160:163]
ds_read_b64_tr_b16 v[128:129], v14 offset:57344
v_mfma_f32_16x16x32_bf16 v[176:179], v[144:147], v[108:111], v[176:179]
ds_read_b64_tr_b16 v[130:131], v14 offset:57856
v_mfma_f32_16x16x32_bf16 v[164:167], v[148:151], v[104:107], v[164:167]
ds_read_b64_tr_b16 v[132:133], v15 offset:57344
v_mfma_f32_16x16x32_bf16 v[180:183], v[148:151], v[108:111], v[180:183]
ds_read_b64_tr_b16 v[134:135], v15 offset:57856
v_mfma_f32_16x16x32_bf16 v[168:171], v[152:155], v[104:107], v[168:171]
ds_read_b64_tr_b16 v[136:137], v16 offset:57344
v_mfma_f32_16x16x32_bf16 v[184:187], v[152:155], v[108:111], v[184:187]
ds_read_b64_tr_b16 v[138:139], v16 offset:57856
v_mfma_f32_16x16x32_bf16 v[172:175], v[156:159], v[104:107], v[172:175]
ds_read_b64_tr_b16 v[140:141], v17 offset:57344
v_mfma_f32_16x16x32_bf16 v[188:191], v[156:159], v[108:111], v[188:191]
ds_read_b64_tr_b16 v[142:143], v17 offset:57856
s_waitcnt lgkmcnt(0)
v_mfma_f32_16x16x32_bf16 v[160:163], v[128:131], v[112:115], v[160:163]
ds_read_b64_tr_b16 v[144:145], v14 offset:61440
v_mfma_f32_16x16x32_bf16 v[176:179], v[128:131], v[116:119], v[176:179]
ds_read_b64_tr_b16 v[146:147], v14 offset:61952
v_mfma_f32_16x16x32_bf16 v[164:167], v[132:135], v[112:115], v[164:167]
ds_read_b64_tr_b16 v[148:149], v15 offset:61440
v_mfma_f32_16x16x32_bf16 v[180:183], v[132:135], v[116:119], v[180:183]
ds_read_b64_tr_b16 v[150:151], v15 offset:61952
v_mfma_f32_16x16x32_bf16 v[168:171], v[136:139], v[112:115], v[168:171]
ds_read_b64_tr_b16 v[152:153], v16 offset:61440
v_mfma_f32_16x16x32_bf16 v[184:187], v[136:139], v[116:119], v[184:187]
ds_read_b64_tr_b16 v[154:155], v16 offset:61952
v_mfma_f32_16x16x32_bf16 v[172:175], v[140:143], v[112:115], v[172:175]
ds_read_b64_tr_b16 v[156:157], v17 offset:61440
v_mfma_f32_16x16x32_bf16 v[188:191], v[140:143], v[116:119], v[188:191]
ds_read_b64_tr_b16 v[158:159], v17 offset:61952
s_waitcnt lgkmcnt(0)
v_mfma_f32_16x16x32_bf16 v[160:163], v[144:147], v[120:123], v[160:163]
v_mfma_f32_16x16x32_bf16 v[176:179], v[144:147], v[124:127], v[176:179]
v_mfma_f32_16x16x32_bf16 v[164:167], v[148:151], v[120:123], v[164:167]
v_mfma_f32_16x16x32_bf16 v[180:183], v[148:151], v[124:127], v[180:183]
v_mfma_f32_16x16x32_bf16 v[168:171], v[152:155], v[120:123], v[168:171]
v_mfma_f32_16x16x32_bf16 v[184:187], v[152:155], v[124:127], v[184:187]
v_mfma_f32_16x16x32_bf16 v[172:175], v[156:159], v[120:123], v[172:175]
v_mfma_f32_16x16x32_bf16 v[188:191], v[156:159], v[124:127], v[188:191]
s_waitcnt vmcnt(0)
s_nop 4
v_lshlrev_b32 v4, 16, v24
v_and_b32 v5, 0xffff0000, v24
v_pk_add_f32 v[160:161], v[160:161], v[4:5]
v_lshlrev_b32 v4, 16, v25
v_and_b32 v5, 0xffff0000, v25
v_pk_add_f32 v[162:163], v[162:163], v[4:5]
v_lshlrev_b32 v4, 16, v26
v_and_b32 v5, 0xffff0000, v26
v_pk_add_f32 v[164:165], v[164:165], v[4:5]
v_lshlrev_b32 v4, 16, v27
v_and_b32 v5, 0xffff0000, v27
v_pk_add_f32 v[166:167], v[166:167], v[4:5]
v_cvt_pk_bf16_f32 v160, v160, v161
v_cvt_pk_bf16_f32 v161, v162, v163
v_cvt_pk_bf16_f32 v162, v164, v165
v_cvt_pk_bf16_f32 v163, v166, v167
s_nop 1
v_permlane16_swap_b32 v160, v162
v_permlane16_swap_b32 v161, v163
buffer_store_dwordx4 v[160:163], v20, s[12:15], 0 offen offset:0
v_lshlrev_b32 v4, 16, v28
v_and_b32 v5, 0xffff0000, v28
v_pk_add_f32 v[168:169], v[168:169], v[4:5]
v_lshlrev_b32 v4, 16, v29
v_and_b32 v5, 0xffff0000, v29
v_pk_add_f32 v[170:171], v[170:171], v[4:5]
v_lshlrev_b32 v4, 16, v30
v_and_b32 v5, 0xffff0000, v30
v_pk_add_f32 v[172:173], v[172:173], v[4:5]
v_lshlrev_b32 v4, 16, v31
v_and_b32 v5, 0xffff0000, v31
v_pk_add_f32 v[174:175], v[174:175], v[4:5]
v_cvt_pk_bf16_f32 v168, v168, v169
v_cvt_pk_bf16_f32 v169, v170, v171
v_cvt_pk_bf16_f32 v170, v172, v173
v_cvt_pk_bf16_f32 v171, v174, v175
s_nop 1
v_permlane16_swap_b32 v168, v170
v_permlane16_swap_b32 v169, v171
buffer_store_dwordx4 v[168:171], v20, s[12:15], 0 offen offset:64
v_lshlrev_b32 v4, 16, v32
v_and_b32 v5, 0xffff0000, v32
v_pk_add_f32 v[176:177], v[176:177], v[4:5]
v_lshlrev_b32 v4, 16, v33
v_and_b32 v5, 0xffff0000, v33
v_pk_add_f32 v[178:179], v[178:179], v[4:5]
v_lshlrev_b32 v4, 16, v34
v_and_b32 v5, 0xffff0000, v34
v_pk_add_f32 v[180:181], v[180:181], v[4:5]
v_lshlrev_b32 v4, 16, v35
v_and_b32 v5, 0xffff0000, v35
v_pk_add_f32 v[182:183], v[182:183], v[4:5]
v_cvt_pk_bf16_f32 v176, v176, v177
v_cvt_pk_bf16_f32 v177, v178, v179
v_cvt_pk_bf16_f32 v178, v180, v181
v_cvt_pk_bf16_f32 v179, v182, v183
s_nop 1
v_permlane16_swap_b32 v176, v178
v_permlane16_swap_b32 v177, v179
buffer_store_dwordx4 v[176:179], v21, s[12:15], 0 offen offset:0
v_lshlrev_b32 v4, 16, v36
v_and_b32 v5, 0xffff0000, v36
v_pk_add_f32 v[184:185], v[184:185], v[4:5]
v_lshlrev_b32 v4, 16, v37
v_and_b32 v5, 0xffff0000, v37
v_pk_add_f32 v[186:187], v[186:187], v[4:5]
v_lshlrev_b32 v4, 16, v38
v_and_b32 v5, 0xffff0000, v38
v_pk_add_f32 v[188:189], v[188:189], v[4:5]
v_lshlrev_b32 v4, 16, v39
v_and_b32 v5, 0xffff0000, v39
v_pk_add_f32 v[190:191], v[190:191], v[4:5]
v_cvt_pk_bf16_f32 v184, v184, v185
v_cvt_pk_bf16_f32 v185, v186, v187
v_cvt_pk_bf16_f32 v186, v188, v189
v_cvt_pk_bf16_f32 v187, v190, v191
s_nop 1
v_permlane16_swap_b32 v184, v186
v_permlane16_swap_b32 v185, v187
buffer_store_dwordx4 v[184:187], v21, s[12:15], 0 offen offset:64
out3_kernel_end:
s_endpgm
.section .rodata,"a"
.p2align 6
.amdhsa_kernel qkv0_kernel
  .amdhsa_next_free_vgpr 256
  .amdhsa_next_free_sgpr 102
  .amdhsa_accum_offset 256
  .amdhsa_group_segment_fixed_size 0
  .amdhsa_kernarg_size 80
  .amdhsa_user_sgpr_count 2
  .amdhsa_user_sgpr_kernarg_segment_ptr 1
  .amdhsa_system_sgpr_workgroup_id_x 1
.end_amdhsa_kernel
.section .rodata,"a"
.p2align 6
.amdhsa_kernel out0_kernel
  .amdhsa_next_free_vgpr 192
  .amdhsa_next_free_sgpr 102
  .amdhsa_accum_offset 192
  .amdhsa_group_segment_fixed_size 0
  .amdhsa_kernarg_size 80
  .amdhsa_user_sgpr_count 2
  .amdhsa_user_sgpr_kernarg_segment_ptr 1
  .amdhsa_system_sgpr_workgroup_id_x 1
.end_amdhsa_kernel
.section .rodata,"a"
.p2align 6
.amdhsa_kernel qkv1_kernel
  .amdhsa_next_free_vgpr 256
  .amdhsa_next_free_sgpr 102
  .amdhsa_accum_offset 256
  .amdhsa_group_segment_fixed_size 0
  .amdhsa_kernarg_size 80
  .amdhsa_user_sgpr_count 2
  .amdhsa_user_sgpr_kernarg_segment_ptr 1
  .amdhsa_system_sgpr_workgroup_id_x 1
.end_amdhsa_kernel
.section .rodata,"a"
.p2align 6
.amdhsa_kernel lin1_kernel
  .amdhsa_next_free_vgpr 208
  .amdhsa_next_free_sgpr 102
  .amdhsa_accum_offset 208
  .amdhsa_group_segment_fixed_size 0
  .amdhsa_kernarg_size 80
  .amdhsa_user_sgpr_count 2
  .amdhsa_user_sgpr_kernarg_segment_ptr 1
  .amdhsa_system_sgpr_workgroup_id_x 1
.end_amdhsa_kernel
.section .rodata,"a"
.p2align 6
.amdhsa_kernel out1_kernel
  .amdhsa_next_free_vgpr 192
  .amdhsa_next_free_sgpr 102
  .amdhsa_accum_offset 192
  .amdhsa_group_segment_fixed_size 0
  .amdhsa_kernarg_size 80
  .amdhsa_user_sgpr_count 2
  .amdhsa_user_sgpr_kernarg_segment_ptr 1
  .amdhsa_system_sgpr_workgroup_id_x 1
.end_amdhsa_kernel
.section .rodata,"a"
.p2align 6
.amdhsa_kernel qkv2_kernel
  .amdhsa_next_free_vgpr 256
  .amdhsa_next_free_sgpr 102
  .amdhsa_accum_offset 256
  .amdhsa_group_segment_fixed_size 0
  .amdhsa_kernarg_size 80
  .amdhsa_user_sgpr_count 2
  .amdhsa_user_sgpr_kernarg_segment_ptr 1
  .amdhsa_system_sgpr_workgroup_id_x 1
.end_amdhsa_kernel
.section .rodata,"a"
.p2align 6
.amdhsa_kernel out2_kernel
  .amdhsa_next_free_vgpr 192
  .amdhsa_next_free_sgpr 102
  .amdhsa_accum_offset 192
  .amdhsa_group_segment_fixed_size 0
  .amdhsa_kernarg_size 80
  .amdhsa_user_sgpr_count 2
  .amdhsa_user_sgpr_kernarg_segment_ptr 1
  .amdhsa_system_sgpr_workgroup_id_x 1
.end_amdhsa_kernel
.section .rodata,"a"
.p2align 6
.amdhsa_kernel qkv3_kernel
  .amdhsa_next_free_vgpr 256
  .amdhsa_next_free_sgpr 102
  .amdhsa_accum_offset 256
  .amdhsa_group_segment_fixed_size 0
  .amdhsa_kernarg_size 80
  .amdhsa_user_sgpr_count 2
  .amdhsa_user_sgpr_kernarg_segment_ptr 1
  .amdhsa_system_sgpr_workgroup_id_x 1
.end_amdhsa_kernel
.section .rodata,"a"
.p2align 6
.amdhsa_kernel lin3_kernel
  .amdhsa_next_free_vgpr 208
  .amdhsa_next_free_sgpr 102
  .amdhsa_accum_offset 208
  .amdhsa_group_segment_fixed_size 0
  .amdhsa_kernarg_size 80
  .amdhsa_user_sgpr_count 2
  .amdhsa_user_sgpr_kernarg_segment_ptr 1
  .amdhsa_system_sgpr_workgroup_id_x 1
.end_amdhsa_kernel
.section .rodata,"a"
.p2align 6
.amdhsa_kernel out3_kernel
  .amdhsa_next_free_vgpr 192
  .amdhsa_next_free_sgpr 102
  .amdhsa_accum_offset 192
  .amdhsa_group_segment_fixed_size 0
  .amdhsa_kernarg_size 80
  .amdhsa_user_sgpr_count 2
  .amdhsa_user_sgpr_kernarg_segment_ptr 1
  .amdhsa_system_sgpr_workgroup_id_x 1
.end_amdhsa_kernel
```

```asm
; @launch grid=(256,1,1) block=(512,1,1) lds=163840
.amdgcn_target "amdgcn-amd-amdhsa--gfx950"
.text
.globl interleave_layers__sliding_local_dilated__linear_kernel_hedgehog__prompt_kernel
.p2align 8
.type interleave_layers__sliding_local_dilated__linear_kernel_hedgehog__prompt_kernel,@function
interleave_layers__sliding_local_dilated__linear_kernel_hedgehog__prompt_kernel:
s_cmp_ge_u32 s2, 256
s_cbranch_scc1 L_end
s_load_dwordx16 s[4:19], s[0:1], 0
s_load_dwordx4 s[20:23], s[0:1], 64
v_lshrrev_b32 v1, 6, v0
v_and_b32 v0, 63, v0
v_readfirstlane_b32 s40, v1
v_and_b32 v2, 15, v0
v_lshrrev_b32 v3, 4, v0
v_lshlrev_b32 v18, 4, v0
s_and_b32 s48, s2, 7
s_lshr_b32 s49, s2, 3
s_and_b32 s74, s49, 1
s_lshl_b32 s41, s48, 1
s_add_u32 s41, s41, s74
s_lshr_b32 s42, s49, 1
s_lshl_b32 s48, s48, 1
s_add_u32 s47, s42, s48
s_and_b32 s47, s47, 15
s_mov_b32 s46, 0
s_waitcnt lgkmcnt(0)
s_mov_b32 s24, s4
s_and_b32 s25, s5, 0xffff
s_mov_b32 s26, 4194304
s_mov_b32 s27, 0x00020000
s_mov_b32 s32, s22
s_and_b32 s33, s23, 0xffff
s_mov_b32 s34, 268435456
s_mov_b32 s35, 0x00020000
s_cmp_ge_u32 s40, 4
s_cbranch_scc1 L_helper
s_setprio 1
s_and_b32 s43, s40, 1
s_lshr_b32 s44, s40, 1
s_lshl_b32 s45, s42, 1
s_add_u32 s45, s45, s43
s_cmp_lg_u32 s40, 0
s_cbranch_scc1 noinit_1
v_lshrrev_b32 v4, 2, v0
v_and_b32 v5, 3, v0
v_mov_b32 v6, s41
v_mov_b32 v7, s42
v_cmp_eq_u32 vcc, 2, v4
v_cmp_eq_u32 s[48:49], 4, v4
s_nop 1
s_or_b64 vcc, vcc, s[48:49]
v_cndmask_b32 v8, v6, v7, vcc
v_cndmask_b32 v9, v7, v6, vcc
v_cmp_eq_u32 vcc, 0, v4
v_lshrrev_b32 v10, 1, v5
v_and_b32 v11, 1, v5
v_lshl_add_u32 v11, v7, 1, v11
v_cndmask_b32 v5, v5, v10, vcc
v_cndmask_b32 v9, v9, v11, vcc
v_lshl_add_u32 v8, v8, 2, v5
v_lshl_add_u32 v8, v4, 6, v8
v_lshlrev_b32 v8, 7, v8
v_lshl_add_u32 v8, v9, 2, v8
v_mov_b32 v9, 0
s_mov_b32 s48, 14155776
s_mov_b64 exec, 0xffffff
buffer_store_dword v9, v8, s[32:35], s48 offen sc1
s_mov_b64 exec, 1
s_getreg_b32 s48, hwreg(HW_REG_XCC_ID)
s_and_b32 s48, s48, 15
s_lshl_b32 s48, 1, s48
s_and_b32 s49, s2, 7
s_lshl_b32 s49, s49, 2
s_add_u32 s49, s49, 4
v_mov_b32 v4, s49
v_mov_b32 v5, s48
global_atomic_or v4, v5, s[20:21]
v_mov_b32 v6, 1
s_waitcnt vmcnt(0)
global_atomic_add v9, v6, s[20:21]
s_mov_b64 exec, -1
noinit_1:
s_cmp_lg_u32 s40, 1
s_cbranch_scc1 nopf_2
s_getpc_b64 s[48:49]
L_pc:
s_sub_u32 s48, s48, L_pc - interleave_layers__sliding_local_dilated__linear_kernel_hedgehog__prompt_kernel
s_subb_u32 s49, s49, 0
s_lshr_b32 s50, s2, 3
s_lshl_b32 s50, s50, 12
v_lshl_add_u32 v4, v0, 6, s50
v_cmp_gt_u32 vcc, L_code_end - interleave_layers__sliding_local_dilated__linear_kernel_hedgehog__prompt_kernel, v4
s_and_saveexec_b64 s[50:51], vcc
s_cbranch_execz nopf_2
global_load_dword v254, v4, s[48:49]
nopf_2:
s_mov_b64 exec, -1
v_lshrrev_b32 v4, 1, v2
v_xor_b32 v4, v4, v3
v_lshlrev_b32 v4, 4, v4
v_lshl_add_u32 v10, v2, 7, v4
v_xor_b32 v11, 64, v10
s_lshl_b32 s48, s43, 1
v_lshrrev_b32 v4, 2, v2
v_and_b32 v5, 3, v0
v_lshl_add_u32 v6, v3, 3, v4
v_lshlrev_b32 v6, 7, v6
v_lshl_add_u32 v6, v5, 3, v6
v_lshrrev_b32 v7, 1, v4
v_and_b32 v8, 1, v3
v_lshl_add_u32 v7, v8, 1, v7
v_xor_b32 v7, s48, v7
v_lshl_add_u32 v12, v7, 5, v6
v_add_u32 v12, 18432, v12
v_xor_b32 v13, 32, v12
v_mov_b32 v14, v10
v_mov_b32 v15, v11
v_mov_b32 v16, v12
v_mov_b32 v17, v13
v_mov_b32 v148, 0
v_mov_b32 v149, 0
v_mov_b32 v150, 0
v_mov_b32 v151, 0
v_mov_b32 v152, 0
v_mov_b32 v153, 0
v_mov_b32 v154, 0
v_mov_b32 v155, 0
v_mov_b32 v156, 0
v_mov_b32 v157, 0
v_mov_b32 v158, 0
v_mov_b32 v159, 0
v_mov_b32 v160, 0
v_mov_b32 v161, 0
v_mov_b32 v162, 0
v_mov_b32 v163, 0
v_mov_b32 v164, 0
v_mov_b32 v165, 0
v_mov_b32 v166, 0
v_mov_b32 v167, 0
v_mov_b32 v168, 0
v_mov_b32 v169, 0
v_mov_b32 v170, 0
v_mov_b32 v171, 0
v_mov_b32 v172, 0
v_mov_b32 v173, 0
v_mov_b32 v174, 0
v_mov_b32 v175, 0
v_mov_b32 v176, 0
v_mov_b32 v177, 0
v_mov_b32 v178, 0
v_mov_b32 v179, 0
v_mov_b32 v180, 0
v_mov_b32 v181, 0
v_mov_b32 v182, 0
v_mov_b32 v183, 0
v_mov_b32 v184, 0
v_mov_b32 v185, 0
v_mov_b32 v186, 0
v_mov_b32 v187, 0
v_mov_b32 v188, 0
v_mov_b32 v189, 0
v_mov_b32 v190, 0
v_mov_b32 v191, 0
v_mov_b32 v192, 0
v_mov_b32 v193, 0
v_mov_b32 v194, 0
v_mov_b32 v195, 0
v_mov_b32 v196, 0
v_mov_b32 v197, 0
v_mov_b32 v198, 0
v_mov_b32 v199, 0
v_mov_b32 v200, 0
v_mov_b32 v201, 0
v_mov_b32 v202, 0
v_mov_b32 v203, 0
v_mov_b32 v204, 0
v_mov_b32 v205, 0
v_mov_b32 v206, 0
v_mov_b32 v207, 0
v_mov_b32 v208, 0
v_mov_b32 v209, 0
v_mov_b32 v210, 0
v_mov_b32 v211, 0
v_mov_b32 v212, 0
v_mov_b32 v213, 0
v_mov_b32 v214, 0
v_mov_b32 v215, 0
v_mov_b32 v216, 0
v_mov_b32 v217, 0
v_mov_b32 v218, 0
v_mov_b32 v219, 0
v_mov_b32 v220, 0
v_mov_b32 v221, 0
v_mov_b32 v222, 0
v_mov_b32 v223, 0
v_mov_b32 v224, 0
v_mov_b32 v225, 0
v_mov_b32 v226, 0
v_mov_b32 v227, 0
v_mov_b32 v228, 0
v_mov_b32 v229, 0
v_mov_b32 v230, 0
v_mov_b32 v231, 0
v_mov_b32 v232, 0
v_mov_b32 v233, 0
v_mov_b32 v234, 0
v_mov_b32 v235, 0
v_mov_b32 v236, 0
v_mov_b32 v237, 0
v_mov_b32 v238, 0
v_mov_b32 v239, 0
v_mov_b32 v240, 0
v_mov_b32 v241, 0
v_mov_b32 v242, 0
v_mov_b32 v243, 0
v_mov_b32 v244, 0
v_mov_b32 v245, 0
v_mov_b32 v246, 0
v_mov_b32 v247, 0
v_mov_b32 v248, 0
v_mov_b32 v249, 0
v_mov_b32 v250, 0
v_mov_b32 v251, 0
s_mov_b32 s64, 0
s_mov_b32 s65, 0
s_barrier
s_cmp_eq_u32 s44, 1
s_cbranch_scc1 c0_th1
ds_read_b128 v[60:63], v14 offset:2048
ds_read_b128 v[64:67], v14 offset:4096
ds_read_b128 v[68:71], v14 offset:6144
ds_read_b128 v[72:75], v14 offset:8192
ds_read_b128 v[76:79], v14
ds_read_b64_tr_b16 v[80:81], v16 offset:0
ds_read_b64_tr_b16 v[82:83], v16 offset:512
ds_read_b64_tr_b16 v[84:85], v17 offset:0
ds_read_b64_tr_b16 v[86:87], v17 offset:512
ds_read_b64_tr_b16 v[88:89], v16 offset:8192
ds_read_b64_tr_b16 v[90:91], v16 offset:8704
ds_read_b64_tr_b16 v[92:93], v17 offset:8192
ds_read_b64_tr_b16 v[94:95], v17 offset:8704
ds_read_b64_tr_b16 v[96:97], v16 offset:16384
ds_read_b64_tr_b16 v[98:99], v16 offset:16896
ds_read_b64_tr_b16 v[100:101], v17 offset:16384
ds_read_b64_tr_b16 v[102:103], v17 offset:16896
c0_loop0:
s_add_u32 s65, s65, 43008
s_cmp_eq_u32 s65, 129024
s_cselect_b32 s65, 0, s65
s_waitcnt lgkmcnt(0)
v_mfma_f32_16x16x32_bf16 v[244:247], v[88:91], v[76:79], v[244:247]
ds_read_b128 v[104:107], v15 offset:2048
v_mfma_f32_16x16x32_bf16 v[248:251], v[76:79], v[96:99], v[248:251]
ds_read_b128 v[108:111], v15 offset:4096
v_mfma_f32_16x16x32_bf16 v[204:207], v[88:91], v[72:75], v[204:207]
ds_read_b128 v[112:115], v15 offset:6144
v_mfma_f32_16x16x32_bf16 v[196:199], v[88:91], v[68:71], v[196:199]
ds_read_b128 v[116:119], v15 offset:8192
v_mfma_f32_16x16x32_bf16 v[188:191], v[88:91], v[64:67], v[188:191]
ds_read_b128 v[120:123], v15
v_mfma_f32_16x16x32_bf16 v[180:183], v[88:91], v[60:63], v[180:183]
ds_read_b64_tr_b16 v[124:125], v16 offset:4096
v_mfma_f32_16x16x32_bf16 v[184:187], v[92:95], v[60:63], v[184:187]
ds_read_b64_tr_b16 v[126:127], v16 offset:4608
v_mfma_f32_16x16x32_bf16 v[192:195], v[92:95], v[64:67], v[192:195]
ds_read_b64_tr_b16 v[128:129], v17 offset:4096
v_mfma_f32_16x16x32_bf16 v[200:203], v[92:95], v[68:71], v[200:203]
ds_read_b64_tr_b16 v[130:131], v17 offset:4608
v_mfma_f32_16x16x32_bf16 v[208:211], v[92:95], v[72:75], v[208:211]
ds_read_b64_tr_b16 v[132:133], v16 offset:12288
v_mfma_f32_16x16x32_bf16 v[236:239], v[72:75], v[96:99], v[236:239]
ds_read_b64_tr_b16 v[134:135], v16 offset:12800
v_mfma_f32_16x16x32_bf16 v[228:231], v[68:71], v[96:99], v[228:231]
ds_read_b64_tr_b16 v[136:137], v17 offset:12288
v_mfma_f32_16x16x32_bf16 v[220:223], v[64:67], v[96:99], v[220:223]
ds_read_b64_tr_b16 v[138:139], v17 offset:12800
v_mfma_f32_16x16x32_bf16 v[212:215], v[60:63], v[96:99], v[212:215]
ds_read_b64_tr_b16 v[140:141], v16 offset:20480
v_mfma_f32_16x16x32_bf16 v[216:219], v[60:63], v[100:103], v[216:219]
ds_read_b64_tr_b16 v[142:143], v16 offset:20992
v_mfma_f32_16x16x32_bf16 v[224:227], v[64:67], v[100:103], v[224:227]
ds_read_b64_tr_b16 v[144:145], v17 offset:20480
v_mfma_f32_16x16x32_bf16 v[232:235], v[68:71], v[100:103], v[232:235]
ds_read_b64_tr_b16 v[146:147], v17 offset:20992
v_mfma_f32_16x16x32_bf16 v[240:243], v[72:75], v[100:103], v[240:243]
v_mfma_f32_16x16x32_bf16 v[172:175], v[80:83], v[72:75], v[172:175]
v_mfma_f32_16x16x32_bf16 v[164:167], v[80:83], v[68:71], v[164:167]
v_mfma_f32_16x16x32_bf16 v[156:159], v[80:83], v[64:67], v[156:159]
v_mfma_f32_16x16x32_bf16 v[148:151], v[80:83], v[60:63], v[148:151]
v_mfma_f32_16x16x32_bf16 v[152:155], v[84:87], v[60:63], v[152:155]
v_mfma_f32_16x16x32_bf16 v[160:163], v[84:87], v[64:67], v[160:163]
v_mfma_f32_16x16x32_bf16 v[168:171], v[84:87], v[68:71], v[168:171]
v_mfma_f32_16x16x32_bf16 v[176:179], v[84:87], v[72:75], v[176:179]
s_waitcnt lgkmcnt(0)
s_barrier
v_mfma_f32_16x16x32_bf16 v[244:247], v[132:135], v[120:123], v[244:247]
v_add_u32 v14, s65, v10
v_mfma_f32_16x16x32_bf16 v[248:251], v[120:123], v[140:143], v[248:251]
v_add_u32 v16, s65, v12
v_add_u32 v17, s65, v13
v_mfma_f32_16x16x32_bf16 v[204:207], v[132:135], v[116:119], v[204:207]
ds_read_b128 v[60:63], v14 offset:2048
v_mfma_f32_16x16x32_bf16 v[196:199], v[132:135], v[112:115], v[196:199]
ds_read_b128 v[64:67], v14 offset:4096
v_mfma_f32_16x16x32_bf16 v[188:191], v[132:135], v[108:111], v[188:191]
ds_read_b128 v[68:71], v14 offset:6144
v_mfma_f32_16x16x32_bf16 v[180:183], v[132:135], v[104:107], v[180:183]
ds_read_b128 v[72:75], v14 offset:8192
v_mfma_f32_16x16x32_bf16 v[184:187], v[136:139], v[104:107], v[184:187]
ds_read_b128 v[76:79], v14
v_mfma_f32_16x16x32_bf16 v[192:195], v[136:139], v[108:111], v[192:195]
ds_read_b64_tr_b16 v[80:81], v16 offset:0
v_mfma_f32_16x16x32_bf16 v[200:203], v[136:139], v[112:115], v[200:203]
ds_read_b64_tr_b16 v[82:83], v16 offset:512
v_mfma_f32_16x16x32_bf16 v[208:211], v[136:139], v[116:119], v[208:211]
ds_read_b64_tr_b16 v[84:85], v17 offset:0
v_mfma_f32_16x16x32_bf16 v[236:239], v[116:119], v[140:143], v[236:239]
ds_read_b64_tr_b16 v[86:87], v17 offset:512
v_mfma_f32_16x16x32_bf16 v[228:231], v[112:115], v[140:143], v[228:231]
ds_read_b64_tr_b16 v[88:89], v16 offset:8192
v_mfma_f32_16x16x32_bf16 v[220:223], v[108:111], v[140:143], v[220:223]
ds_read_b64_tr_b16 v[90:91], v16 offset:8704
v_mfma_f32_16x16x32_bf16 v[212:215], v[104:107], v[140:143], v[212:215]
ds_read_b64_tr_b16 v[92:93], v17 offset:8192
v_mfma_f32_16x16x32_bf16 v[216:219], v[104:107], v[144:147], v[216:219]
ds_read_b64_tr_b16 v[94:95], v17 offset:8704
v_mfma_f32_16x16x32_bf16 v[224:227], v[108:111], v[144:147], v[224:227]
ds_read_b64_tr_b16 v[96:97], v16 offset:16384
v_mfma_f32_16x16x32_bf16 v[232:235], v[112:115], v[144:147], v[232:235]
ds_read_b64_tr_b16 v[98:99], v16 offset:16896
v_mfma_f32_16x16x32_bf16 v[240:243], v[116:119], v[144:147], v[240:243]
ds_read_b64_tr_b16 v[100:101], v17 offset:16384
v_mfma_f32_16x16x32_bf16 v[172:175], v[124:127], v[116:119], v[172:175]
ds_read_b64_tr_b16 v[102:103], v17 offset:16896
v_mfma_f32_16x16x32_bf16 v[164:167], v[124:127], v[112:115], v[164:167]
v_add_u32 v15, s65, v11
v_mfma_f32_16x16x32_bf16 v[156:159], v[124:127], v[108:111], v[156:159]
s_add_u32 s64, s64, 1
v_mfma_f32_16x16x32_bf16 v[148:151], v[124:127], v[104:107], v[148:151]
s_cmp_lt_u32 s64, 16
v_mfma_f32_16x16x32_bf16 v[152:155], v[128:131], v[104:107], v[152:155]
v_mfma_f32_16x16x32_bf16 v[160:163], v[128:131], v[108:111], v[160:163]
v_mfma_f32_16x16x32_bf16 v[168:171], v[128:131], v[112:115], v[168:171]
v_mfma_f32_16x16x32_bf16 v[176:179], v[128:131], v[116:119], v[176:179]
s_cbranch_scc1 c0_loop0
s_branch c0_epi
c0_th1:
ds_read_b128 v[60:63], v14 offset:10240
ds_read_b128 v[64:67], v14 offset:12288
ds_read_b128 v[68:71], v14 offset:14336
ds_read_b128 v[72:75], v14 offset:16384
ds_read_b128 v[76:79], v14
ds_read_b64_tr_b16 v[80:81], v16 offset:0
ds_read_b64_tr_b16 v[82:83], v16 offset:512
ds_read_b64_tr_b16 v[84:85], v17 offset:0
ds_read_b64_tr_b16 v[86:87], v17 offset:512
ds_read_b64_tr_b16 v[88:89], v16 offset:8192
ds_read_b64_tr_b16 v[90:91], v16 offset:8704
ds_read_b64_tr_b16 v[92:93], v17 offset:8192
ds_read_b64_tr_b16 v[94:95], v17 offset:8704
ds_read_b64_tr_b16 v[96:97], v16 offset:16384
ds_read_b64_tr_b16 v[98:99], v16 offset:16896
ds_read_b64_tr_b16 v[100:101], v17 offset:16384
ds_read_b64_tr_b16 v[102:103], v17 offset:16896
c0_loop1:
s_add_u32 s65, s65, 43008
s_cmp_eq_u32 s65, 129024
s_cselect_b32 s65, 0, s65
s_waitcnt lgkmcnt(0)
v_mfma_f32_16x16x32_bf16 v[244:247], v[92:95], v[76:79], v[244:247]
ds_read_b128 v[104:107], v15 offset:10240
v_mfma_f32_16x16x32_bf16 v[248:251], v[76:79], v[100:103], v[248:251]
ds_read_b128 v[108:111], v15 offset:12288
v_mfma_f32_16x16x32_bf16 v[204:207], v[88:91], v[72:75], v[204:207]
ds_read_b128 v[112:115], v15 offset:14336
v_mfma_f32_16x16x32_bf16 v[196:199], v[88:91], v[68:71], v[196:199]
ds_read_b128 v[116:119], v15 offset:16384
v_mfma_f32_16x16x32_bf16 v[188:191], v[88:91], v[64:67], v[188:191]
ds_read_b128 v[120:123], v15
v_mfma_f32_16x16x32_bf16 v[180:183], v[88:91], v[60:63], v[180:183]
ds_read_b64_tr_b16 v[124:125], v16 offset:4096
v_mfma_f32_16x16x32_bf16 v[184:187], v[92:95], v[60:63], v[184:187]
ds_read_b64_tr_b16 v[126:127], v16 offset:4608
v_mfma_f32_16x16x32_bf16 v[192:195], v[92:95], v[64:67], v[192:195]
ds_read_b64_tr_b16 v[128:129], v17 offset:4096
v_mfma_f32_16x16x32_bf16 v[200:203], v[92:95], v[68:71], v[200:203]
ds_read_b64_tr_b16 v[130:131], v17 offset:4608
v_mfma_f32_16x16x32_bf16 v[208:211], v[92:95], v[72:75], v[208:211]
ds_read_b64_tr_b16 v[132:133], v16 offset:12288
v_mfma_f32_16x16x32_bf16 v[236:239], v[72:75], v[96:99], v[236:239]
ds_read_b64_tr_b16 v[134:135], v16 offset:12800
v_mfma_f32_16x16x32_bf16 v[228:231], v[68:71], v[96:99], v[228:231]
ds_read_b64_tr_b16 v[136:137], v17 offset:12288
v_mfma_f32_16x16x32_bf16 v[220:223], v[64:67], v[96:99], v[220:223]
ds_read_b64_tr_b16 v[138:139], v17 offset:12800
v_mfma_f32_16x16x32_bf16 v[212:215], v[60:63], v[96:99], v[212:215]
ds_read_b64_tr_b16 v[140:141], v16 offset:20480
v_mfma_f32_16x16x32_bf16 v[216:219], v[60:63], v[100:103], v[216:219]
ds_read_b64_tr_b16 v[142:143], v16 offset:20992
v_mfma_f32_16x16x32_bf16 v[224:227], v[64:67], v[100:103], v[224:227]
ds_read_b64_tr_b16 v[144:145], v17 offset:20480
v_mfma_f32_16x16x32_bf16 v[232:235], v[68:71], v[100:103], v[232:235]
ds_read_b64_tr_b16 v[146:147], v17 offset:20992
v_mfma_f32_16x16x32_bf16 v[240:243], v[72:75], v[100:103], v[240:243]
v_mfma_f32_16x16x32_bf16 v[172:175], v[80:83], v[72:75], v[172:175]
v_mfma_f32_16x16x32_bf16 v[164:167], v[80:83], v[68:71], v[164:167]
v_mfma_f32_16x16x32_bf16 v[156:159], v[80:83], v[64:67], v[156:159]
v_mfma_f32_16x16x32_bf16 v[148:151], v[80:83], v[60:63], v[148:151]
v_mfma_f32_16x16x32_bf16 v[152:155], v[84:87], v[60:63], v[152:155]
v_mfma_f32_16x16x32_bf16 v[160:163], v[84:87], v[64:67], v[160:163]
v_mfma_f32_16x16x32_bf16 v[168:171], v[84:87], v[68:71], v[168:171]
v_mfma_f32_16x16x32_bf16 v[176:179], v[84:87], v[72:75], v[176:179]
s_waitcnt lgkmcnt(0)
s_barrier
v_mfma_f32_16x16x32_bf16 v[244:247], v[136:139], v[120:123], v[244:247]
v_add_u32 v14, s65, v10
v_mfma_f32_16x16x32_bf16 v[248:251], v[120:123], v[144:147], v[248:251]
v_add_u32 v16, s65, v12
v_add_u32 v17, s65, v13
v_mfma_f32_16x16x32_bf16 v[204:207], v[132:135], v[116:119], v[204:207]
ds_read_b128 v[60:63], v14 offset:10240
v_mfma_f32_16x16x32_bf16 v[196:199], v[132:135], v[112:115], v[196:199]
ds_read_b128 v[64:67], v14 offset:12288
v_mfma_f32_16x16x32_bf16 v[188:191], v[132:135], v[108:111], v[188:191]
ds_read_b128 v[68:71], v14 offset:14336
v_mfma_f32_16x16x32_bf16 v[180:183], v[132:135], v[104:107], v[180:183]
ds_read_b128 v[72:75], v14 offset:16384
v_mfma_f32_16x16x32_bf16 v[184:187], v[136:139], v[104:107], v[184:187]
ds_read_b128 v[76:79], v14
v_mfma_f32_16x16x32_bf16 v[192:195], v[136:139], v[108:111], v[192:195]
ds_read_b64_tr_b16 v[80:81], v16 offset:0
v_mfma_f32_16x16x32_bf16 v[200:203], v[136:139], v[112:115], v[200:203]
ds_read_b64_tr_b16 v[82:83], v16 offset:512
v_mfma_f32_16x16x32_bf16 v[208:211], v[136:139], v[116:119], v[208:211]
ds_read_b64_tr_b16 v[84:85], v17 offset:0
v_mfma_f32_16x16x32_bf16 v[236:239], v[116:119], v[140:143], v[236:239]
ds_read_b64_tr_b16 v[86:87], v17 offset:512
v_mfma_f32_16x16x32_bf16 v[228:231], v[112:115], v[140:143], v[228:231]
ds_read_b64_tr_b16 v[88:89], v16 offset:8192
v_mfma_f32_16x16x32_bf16 v[220:223], v[108:111], v[140:143], v[220:223]
ds_read_b64_tr_b16 v[90:91], v16 offset:8704
v_mfma_f32_16x16x32_bf16 v[212:215], v[104:107], v[140:143], v[212:215]
ds_read_b64_tr_b16 v[92:93], v17 offset:8192
v_mfma_f32_16x16x32_bf16 v[216:219], v[104:107], v[144:147], v[216:219]
ds_read_b64_tr_b16 v[94:95], v17 offset:8704
v_mfma_f32_16x16x32_bf16 v[224:227], v[108:111], v[144:147], v[224:227]
ds_read_b64_tr_b16 v[96:97], v16 offset:16384
v_mfma_f32_16x16x32_bf16 v[232:235], v[112:115], v[144:147], v[232:235]
ds_read_b64_tr_b16 v[98:99], v16 offset:16896
v_mfma_f32_16x16x32_bf16 v[240:243], v[116:119], v[144:147], v[240:243]
ds_read_b64_tr_b16 v[100:101], v17 offset:16384
v_mfma_f32_16x16x32_bf16 v[172:175], v[124:127], v[116:119], v[172:175]
ds_read_b64_tr_b16 v[102:103], v17 offset:16896
v_mfma_f32_16x16x32_bf16 v[164:167], v[124:127], v[112:115], v[164:167]
v_add_u32 v15, s65, v11
v_mfma_f32_16x16x32_bf16 v[156:159], v[124:127], v[108:111], v[156:159]
s_add_u32 s64, s64, 1
v_mfma_f32_16x16x32_bf16 v[148:151], v[124:127], v[104:107], v[148:151]
s_cmp_lt_u32 s64, 16
v_mfma_f32_16x16x32_bf16 v[152:155], v[128:131], v[104:107], v[152:155]
v_mfma_f32_16x16x32_bf16 v[160:163], v[128:131], v[108:111], v[160:163]
v_mfma_f32_16x16x32_bf16 v[168:171], v[128:131], v[112:115], v[168:171]
v_mfma_f32_16x16x32_bf16 v[176:179], v[128:131], v[116:119], v[176:179]
s_cbranch_scc1 c0_loop1
c0_epi:
s_waitcnt lgkmcnt(0)
s_lshl_b32 s48, s43, 12
s_add_u32 s48, s48, 139264
s_lshl_b32 s49, s44, 11
s_add_u32 s49, s49, s48
v_add_u32 v5, s49, v18
ds_write_b128 v5, v[244:247]
ds_write_b128 v5, v[248:251] offset:1024
s_cmp_eq_u32 s44, 1
s_cbranch_scc1 c0_nodump
ds_write_b128 v5, v[204:207] offset:8192
ds_write_b128 v5, v[236:239] offset:9216
ds_write_b128 v5, v[208:211] offset:10240
ds_write_b128 v5, v[240:243] offset:11264
c0_nodump:
s_lshl_b32 s49, s44, 13
s_add_u32 s49, s49, s48
v_add_u32 v5, s49, v18
s_lshl_b32 s48, s43, 7
s_add_u32 s48, s48, 133376
v_lshl_add_u32 v6, v3, 4, s48
v_lshl_add_u32 v7, v2, 2, s48
s_lshl_b32 s49, s44, 6
v_add_u32 v8, s49, v2
v_lshlrev_b32 v8, 3, v8
v_add_u32 v8, 131072, v8
v_lshl_add_u32 v9, v3, 2, s49
v_lshlrev_b32 v9, 2, v9
v_add_u32 v9, 132224, v9
v_mov_b32 v19, 134912
s_waitcnt lgkmcnt(0)
s_barrier
ds_read_b32 v19, v19
ds_read_b128 v[60:63], v6 offset:0
ds_read_b128 v[64:67], v6 offset:64
ds_read_b128 v[68:71], v6 offset:256
ds_read_b128 v[72:75], v6 offset:320
ds_read_b64 v[78:79], v8 offset:0
ds_read_b64 v[80:81], v8 offset:128
ds_read_b64 v[82:83], v8 offset:256
ds_read_b64 v[84:85], v8 offset:384
ds_read_b64 v[86:87], v8 offset:512
ds_read_b128 v[128:131], v5 offset:0
ds_read_b128 v[132:135], v5 offset:2048
ds_read_b32 v76, v7 offset:512
ds_read_b32 v77, v7 offset:576
ds_read_b128 v[136:139], v5 offset:1024
ds_read_b128 v[140:143], v5 offset:3072
ds_read_b128 v[88:91], v9 offset:0
ds_read_b128 v[108:111], v9 offset:576
ds_read_b128 v[92:95], v9 offset:64
ds_read_b128 v[112:115], v9 offset:640
ds_read_b128 v[96:99], v9 offset:128
ds_read_b128 v[116:119], v9 offset:704
ds_read_b128 v[100:103], v9 offset:192
ds_read_b128 v[120:123], v9 offset:768
ds_read_b128 v[104:107], v9 offset:256
ds_read_b128 v[124:127], v9 offset:832
s_waitcnt lgkmcnt(14)
v_readfirstlane_b32 s46, v19
v_pk_fma_f32 v[148:149], v[60:61], v[80:81], v[148:149] op_sel:[0,1,0] op_sel_hi:[1,1,1]
v_pk_fma_f32 v[150:151], v[62:63], v[80:81], v[150:151] op_sel:[0,1,0] op_sel_hi:[1,1,1]
v_pk_fma_f32 v[152:153], v[64:65], v[80:81], v[152:153] op_sel:[0,1,0] op_sel_hi:[1,1,1]
v_pk_fma_f32 v[154:155], v[66:67], v[80:81], v[154:155] op_sel:[0,1,0] op_sel_hi:[1,1,1]
v_pk_mul_f32 v[148:149], v[148:149], v[80:81] op_sel:[0,0] op_sel_hi:[1,0]
v_pk_mul_f32 v[150:151], v[150:151], v[80:81] op_sel:[0,0] op_sel_hi:[1,0]
v_pk_mul_f32 v[152:153], v[152:153], v[80:81] op_sel:[0,0] op_sel_hi:[1,0]
v_pk_mul_f32 v[154:155], v[154:155], v[80:81] op_sel:[0,0] op_sel_hi:[1,0]
v_cvt_pk_bf16_f32 v148, v148, v149
v_cvt_pk_bf16_f32 v149, v150, v151
v_cvt_pk_bf16_f32 v150, v152, v153
v_cvt_pk_bf16_f32 v151, v154, v155
v_pk_fma_f32 v[156:157], v[60:61], v[82:83], v[156:157] op_sel:[0,1,0] op_sel_hi:[1,1,1]
v_pk_fma_f32 v[158:159], v[62:63], v[82:83], v[158:159] op_sel:[0,1,0] op_sel_hi:[1,1,1]
v_pk_fma_f32 v[160:161], v[64:65], v[82:83], v[160:161] op_sel:[0,1,0] op_sel_hi:[1,1,1]
v_pk_fma_f32 v[162:163], v[66:67], v[82:83], v[162:163] op_sel:[0,1,0] op_sel_hi:[1,1,1]
v_pk_mul_f32 v[156:157], v[156:157], v[82:83] op_sel:[0,0] op_sel_hi:[1,0]
v_pk_mul_f32 v[158:159], v[158:159], v[82:83] op_sel:[0,0] op_sel_hi:[1,0]
v_pk_mul_f32 v[160:161], v[160:161], v[82:83] op_sel:[0,0] op_sel_hi:[1,0]
v_pk_mul_f32 v[162:163], v[162:163], v[82:83] op_sel:[0,0] op_sel_hi:[1,0]
v_cvt_pk_bf16_f32 v156, v156, v157
v_cvt_pk_bf16_f32 v157, v158, v159
v_cvt_pk_bf16_f32 v158, v160, v161
v_cvt_pk_bf16_f32 v159, v162, v163
v_pk_fma_f32 v[164:165], v[60:61], v[84:85], v[164:165] op_sel:[0,1,0] op_sel_hi:[1,1,1]
v_pk_fma_f32 v[166:167], v[62:63], v[84:85], v[166:167] op_sel:[0,1,0] op_sel_hi:[1,1,1]
v_pk_fma_f32 v[168:169], v[64:65], v[84:85], v[168:169] op_sel:[0,1,0] op_sel_hi:[1,1,1]
v_pk_fma_f32 v[170:171], v[66:67], v[84:85], v[170:171] op_sel:[0,1,0] op_sel_hi:[1,1,1]
v_pk_mul_f32 v[164:165], v[164:165], v[84:85] op_sel:[0,0] op_sel_hi:[1,0]
v_pk_mul_f32 v[166:167], v[166:167], v[84:85] op_sel:[0,0] op_sel_hi:[1,0]
v_pk_mul_f32 v[168:169], v[168:169], v[84:85] op_sel:[0,0] op_sel_hi:[1,0]
v_pk_mul_f32 v[170:171], v[170:171], v[84:85] op_sel:[0,0] op_sel_hi:[1,0]
v_cvt_pk_bf16_f32 v164, v164, v165
v_cvt_pk_bf16_f32 v165, v166, v167
v_cvt_pk_bf16_f32 v166, v168, v169
v_cvt_pk_bf16_f32 v167, v170, v171
v_pk_fma_f32 v[172:173], v[60:61], v[86:87], v[172:173] op_sel:[0,1,0] op_sel_hi:[1,1,1]
v_pk_fma_f32 v[174:175], v[62:63], v[86:87], v[174:175] op_sel:[0,1,0] op_sel_hi:[1,1,1]
v_pk_fma_f32 v[176:177], v[64:65], v[86:87], v[176:177] op_sel:[0,1,0] op_sel_hi:[1,1,1]
v_pk_fma_f32 v[178:179], v[66:67], v[86:87], v[178:179] op_sel:[0,1,0] op_sel_hi:[1,1,1]
v_pk_mul_f32 v[172:173], v[172:173], v[86:87] op_sel:[0,0] op_sel_hi:[1,0]
v_pk_mul_f32 v[174:175], v[174:175], v[86:87] op_sel:[0,0] op_sel_hi:[1,0]
v_pk_mul_f32 v[176:177], v[176:177], v[86:87] op_sel:[0,0] op_sel_hi:[1,0]
v_pk_mul_f32 v[178:179], v[178:179], v[86:87] op_sel:[0,0] op_sel_hi:[1,0]
v_cvt_pk_bf16_f32 v172, v172, v173
v_cvt_pk_bf16_f32 v173, v174, v175
v_cvt_pk_bf16_f32 v174, v176, v177
v_cvt_pk_bf16_f32 v175, v178, v179
v_pk_fma_f32 v[128:129], v[68:69], v[78:79], v[128:129] op_sel:[0,1,0] op_sel_hi:[1,1,1]
v_pk_fma_f32 v[130:131], v[70:71], v[78:79], v[130:131] op_sel:[0,1,0] op_sel_hi:[1,1,1]
v_pk_fma_f32 v[132:133], v[72:73], v[78:79], v[132:133] op_sel:[0,1,0] op_sel_hi:[1,1,1]
v_pk_fma_f32 v[134:135], v[74:75], v[78:79], v[134:135] op_sel:[0,1,0] op_sel_hi:[1,1,1]
v_pk_mul_f32 v[128:129], v[128:129], v[78:79] op_sel:[0,0] op_sel_hi:[1,0]
v_pk_mul_f32 v[130:131], v[130:131], v[78:79] op_sel:[0,0] op_sel_hi:[1,0]
v_pk_mul_f32 v[132:133], v[132:133], v[78:79] op_sel:[0,0] op_sel_hi:[1,0]
v_pk_mul_f32 v[134:135], v[134:135], v[78:79] op_sel:[0,0] op_sel_hi:[1,0]
v_cvt_pk_bf16_f32 v128, v128, v129
v_cvt_pk_bf16_f32 v129, v130, v131
v_cvt_pk_bf16_f32 v130, v132, v133
v_cvt_pk_bf16_f32 v131, v134, v135
v_pk_fma_f32 v[180:181], v[68:69], v[80:81], v[180:181] op_sel:[0,1,0] op_sel_hi:[1,1,1]
v_pk_fma_f32 v[182:183], v[70:71], v[80:81], v[182:183] op_sel:[0,1,0] op_sel_hi:[1,1,1]
v_pk_fma_f32 v[184:185], v[72:73], v[80:81], v[184:185] op_sel:[0,1,0] op_sel_hi:[1,1,1]
v_pk_fma_f32 v[186:187], v[74:75], v[80:81], v[186:187] op_sel:[0,1,0] op_sel_hi:[1,1,1]
v_pk_mul_f32 v[180:181], v[180:181], v[80:81] op_sel:[0,0] op_sel_hi:[1,0]
v_pk_mul_f32 v[182:183], v[182:183], v[80:81] op_sel:[0,0] op_sel_hi:[1,0]
v_pk_mul_f32 v[184:185], v[184:185], v[80:81] op_sel:[0,0] op_sel_hi:[1,0]
v_pk_mul_f32 v[186:187], v[186:187], v[80:81] op_sel:[0,0] op_sel_hi:[1,0]
v_cvt_pk_bf16_f32 v180, v180, v181
v_cvt_pk_bf16_f32 v181, v182, v183
v_cvt_pk_bf16_f32 v182, v184, v185
v_cvt_pk_bf16_f32 v183, v186, v187
v_pk_fma_f32 v[188:189], v[68:69], v[82:83], v[188:189] op_sel:[0,1,0] op_sel_hi:[1,1,1]
v_pk_fma_f32 v[190:191], v[70:71], v[82:83], v[190:191] op_sel:[0,1,0] op_sel_hi:[1,1,1]
v_pk_fma_f32 v[192:193], v[72:73], v[82:83], v[192:193] op_sel:[0,1,0] op_sel_hi:[1,1,1]
v_pk_fma_f32 v[194:195], v[74:75], v[82:83], v[194:195] op_sel:[0,1,0] op_sel_hi:[1,1,1]
v_pk_mul_f32 v[188:189], v[188:189], v[82:83] op_sel:[0,0] op_sel_hi:[1,0]
v_pk_mul_f32 v[190:191], v[190:191], v[82:83] op_sel:[0,0] op_sel_hi:[1,0]
v_pk_mul_f32 v[192:193], v[192:193], v[82:83] op_sel:[0,0] op_sel_hi:[1,0]
v_pk_mul_f32 v[194:195], v[194:195], v[82:83] op_sel:[0,0] op_sel_hi:[1,0]
v_cvt_pk_bf16_f32 v188, v188, v189
v_cvt_pk_bf16_f32 v189, v190, v191
v_cvt_pk_bf16_f32 v190, v192, v193
v_cvt_pk_bf16_f32 v191, v194, v195
v_pk_fma_f32 v[196:197], v[68:69], v[84:85], v[196:197] op_sel:[0,1,0] op_sel_hi:[1,1,1]
v_pk_fma_f32 v[198:199], v[70:71], v[84:85], v[198:199] op_sel:[0,1,0] op_sel_hi:[1,1,1]
v_pk_fma_f32 v[200:201], v[72:73], v[84:85], v[200:201] op_sel:[0,1,0] op_sel_hi:[1,1,1]
v_pk_fma_f32 v[202:203], v[74:75], v[84:85], v[202:203] op_sel:[0,1,0] op_sel_hi:[1,1,1]
v_pk_mul_f32 v[196:197], v[196:197], v[84:85] op_sel:[0,0] op_sel_hi:[1,0]
v_pk_mul_f32 v[198:199], v[198:199], v[84:85] op_sel:[0,0] op_sel_hi:[1,0]
v_pk_mul_f32 v[200:201], v[200:201], v[84:85] op_sel:[0,0] op_sel_hi:[1,0]
v_pk_mul_f32 v[202:203], v[202:203], v[84:85] op_sel:[0,0] op_sel_hi:[1,0]
v_cvt_pk_bf16_f32 v196, v196, v197
v_cvt_pk_bf16_f32 v197, v198, v199
v_cvt_pk_bf16_f32 v198, v200, v201
v_cvt_pk_bf16_f32 v199, v202, v203
v_pk_fma_f32 v[204:205], v[68:69], v[86:87], v[204:205] op_sel:[0,1,0] op_sel_hi:[1,1,1]
v_pk_fma_f32 v[206:207], v[70:71], v[86:87], v[206:207] op_sel:[0,1,0] op_sel_hi:[1,1,1]
v_pk_fma_f32 v[208:209], v[72:73], v[86:87], v[208:209] op_sel:[0,1,0] op_sel_hi:[1,1,1]
v_pk_fma_f32 v[210:211], v[74:75], v[86:87], v[210:211] op_sel:[0,1,0] op_sel_hi:[1,1,1]
v_pk_mul_f32 v[204:205], v[204:205], v[86:87] op_sel:[0,0] op_sel_hi:[1,0]
v_pk_mul_f32 v[206:207], v[206:207], v[86:87] op_sel:[0,0] op_sel_hi:[1,0]
v_pk_mul_f32 v[208:209], v[208:209], v[86:87] op_sel:[0,0] op_sel_hi:[1,0]
v_pk_mul_f32 v[210:211], v[210:211], v[86:87] op_sel:[0,0] op_sel_hi:[1,0]
v_cvt_pk_bf16_f32 v204, v204, v205
v_cvt_pk_bf16_f32 v205, v206, v207
v_cvt_pk_bf16_f32 v206, v208, v209
v_cvt_pk_bf16_f32 v207, v210, v211
s_mov_b32 s48, 0xf149f2ca
v_mov_b32 v53, s48
v_lshlrev_b32 v4, 2, v3
v_sub_u32 v4, v2, v4
v_subrev_u32 v5, 0, v4
v_and_b32 v6, 0x80000001, v5
v_cmp_eq_u32 vcc, 0, v6
v_add_u32 v5, 1, v5
v_and_b32 v6, 0x80000001, v5
v_cndmask_b32 v44, v53, 0, vcc
v_cmp_eq_u32 vcc, 0x80000001, v6
s_nop 1
v_cndmask_b32 v40, v53, 0, vcc
v_subrev_u32 v5, 1, v4
v_and_b32 v6, 0x80000001, v5
v_cmp_eq_u32 vcc, 0, v6
v_add_u32 v5, 1, v5
v_and_b32 v6, 0x80000001, v5
v_cndmask_b32 v45, v53, 0, vcc
v_cmp_eq_u32 vcc, 0x80000001, v6
s_nop 1
v_cndmask_b32 v41, v53, 0, vcc
v_subrev_u32 v5, 2, v4
v_and_b32 v6, 0x80000001, v5
v_cmp_eq_u32 vcc, 0, v6
v_add_u32 v5, 1, v5
v_and_b32 v6, 0x80000001, v5
v_cndmask_b32 v46, v53, 0, vcc
v_cmp_eq_u32 vcc, 0x80000001, v6
s_nop 1
v_cndmask_b32 v42, v53, 0, vcc
v_subrev_u32 v5, 3, v4
v_and_b32 v6, 0x80000001, v5
v_cmp_eq_u32 vcc, 0, v6
v_add_u32 v5, 1, v5
v_and_b32 v6, 0x80000001, v5
v_cndmask_b32 v47, v53, 0, vcc
v_cmp_eq_u32 vcc, 0x80000001, v6
s_nop 1
v_cndmask_b32 v43, v53, 0, vcc
s_or_b32 s48, s41, s44
s_cmp_eq_u32 s48, 0
s_cselect_b64 vcc, -1, 0
v_cndmask_b32 v48, v40, v53, vcc
v_cndmask_b32 v49, v41, v53, vcc
v_cndmask_b32 v50, v42, v53, vcc
v_cndmask_b32 v51, v43, v53, vcc
v_and_b32 v4, 1, v2
v_lshlrev_b32 v4, 4, v4
v_mov_b32 v5, 0xffff
v_lshlrev_b32 v52, v4, v5
v_mov_b32 v56, 0x3f803f80
v_mov_b32 v57, 0x3f803f80
v_mov_b32 v58, 0x3f803f80
v_mov_b32 v59, 0x3f803f80
v_mfma_f32_16x16x32_bf16 v[152:155], v[128:131], v[148:151], v[48:51]
v_mfma_f32_16x16x32_bf16 v[184:187], v[180:183], v[148:151], v[44:47]
v_mfma_f32_16x16x32_bf16 v[160:163], v[180:183], v[156:159], v[40:43]
v_mfma_f32_16x16x32_bf16 v[192:195], v[188:191], v[156:159], v[44:47]
v_mfma_f32_16x16x32_bf16 v[168:171], v[188:191], v[164:167], v[40:43]
v_mfma_f32_16x16x32_bf16 v[200:203], v[196:199], v[164:167], v[44:47]
v_mfma_f32_16x16x32_bf16 v[176:179], v[196:199], v[172:175], v[40:43]
v_mfma_f32_16x16x32_bf16 v[208:211], v[204:207], v[172:175], v[44:47]
s_waitcnt lgkmcnt(0)
v_pk_fma_f32 v[136:137], v[108:109], v[76:77], v[136:137] op_sel:[0,0,0] op_sel_hi:[1,0,1]
v_pk_fma_f32 v[138:139], v[110:111], v[76:77], v[138:139] op_sel:[0,0,0] op_sel_hi:[1,0,1]
v_pk_mul_f32 v[136:137], v[136:137], v[88:89]
v_pk_mul_f32 v[138:139], v[138:139], v[90:91]
v_cvt_pk_bf16_f32 v20, v136, v137
v_cvt_pk_bf16_f32 v21, v138, v139
v_pk_fma_f32 v[212:213], v[112:113], v[76:77], v[212:213] op_sel:[0,0,0] op_sel_hi:[1,0,1]
v_pk_fma_f32 v[214:215], v[114:115], v[76:77], v[214:215] op_sel:[0,0,0] op_sel_hi:[1,0,1]
v_pk_mul_f32 v[212:213], v[212:213], v[92:93]
v_pk_mul_f32 v[214:215], v[214:215], v[94:95]
v_cvt_pk_bf16_f32 v22, v212, v213
v_cvt_pk_bf16_f32 v23, v214, v215
v_pk_fma_f32 v[220:221], v[116:117], v[76:77], v[220:221] op_sel:[0,0,0] op_sel_hi:[1,0,1]
v_pk_fma_f32 v[222:223], v[118:119], v[76:77], v[222:223] op_sel:[0,0,0] op_sel_hi:[1,0,1]
v_pk_mul_f32 v[220:221], v[220:221], v[96:97]
v_pk_mul_f32 v[222:223], v[222:223], v[98:99]
v_cvt_pk_bf16_f32 v24, v220, v221
v_cvt_pk_bf16_f32 v25, v222, v223
v_pk_fma_f32 v[228:229], v[120:121], v[76:77], v[228:229] op_sel:[0,0,0] op_sel_hi:[1,0,1]
v_pk_fma_f32 v[230:231], v[122:123], v[76:77], v[230:231] op_sel:[0,0,0] op_sel_hi:[1,0,1]
v_pk_mul_f32 v[228:229], v[228:229], v[100:101]
v_pk_mul_f32 v[230:231], v[230:231], v[102:103]
v_cvt_pk_bf16_f32 v26, v228, v229
v_cvt_pk_bf16_f32 v27, v230, v231
v_pk_fma_f32 v[236:237], v[124:125], v[76:77], v[236:237] op_sel:[0,0,0] op_sel_hi:[1,0,1]
v_pk_fma_f32 v[238:239], v[126:127], v[76:77], v[238:239] op_sel:[0,0,0] op_sel_hi:[1,0,1]
v_pk_mul_f32 v[236:237], v[236:237], v[104:105]
v_pk_mul_f32 v[238:239], v[238:239], v[106:107]
v_cvt_pk_bf16_f32 v28, v236, v237
v_cvt_pk_bf16_f32 v29, v238, v239
v_pk_fma_f32 v[140:141], v[108:109], v[76:77], v[140:141] op_sel:[0,1,0] op_sel_hi:[1,1,1]
v_pk_fma_f32 v[142:143], v[110:111], v[76:77], v[142:143] op_sel:[0,1,0] op_sel_hi:[1,1,1]
v_pk_mul_f32 v[140:141], v[140:141], v[88:89]
v_pk_mul_f32 v[142:143], v[142:143], v[90:91]
v_cvt_pk_bf16_f32 v30, v140, v141
v_cvt_pk_bf16_f32 v31, v142, v143
v_pk_fma_f32 v[216:217], v[112:113], v[76:77], v[216:217] op_sel:[0,1,0] op_sel_hi:[1,1,1]
v_pk_fma_f32 v[218:219], v[114:115], v[76:77], v[218:219] op_sel:[0,1,0] op_sel_hi:[1,1,1]
v_pk_mul_f32 v[216:217], v[216:217], v[92:93]
v_pk_mul_f32 v[218:219], v[218:219], v[94:95]
v_cvt_pk_bf16_f32 v32, v216, v217
v_cvt_pk_bf16_f32 v33, v218, v219
v_pk_fma_f32 v[224:225], v[116:117], v[76:77], v[224:225] op_sel:[0,1,0] op_sel_hi:[1,1,1]
v_pk_fma_f32 v[226:227], v[118:119], v[76:77], v[226:227] op_sel:[0,1,0] op_sel_hi:[1,1,1]
v_pk_mul_f32 v[224:225], v[224:225], v[96:97]
v_pk_mul_f32 v[226:227], v[226:227], v[98:99]
v_cvt_pk_bf16_f32 v34, v224, v225
v_cvt_pk_bf16_f32 v35, v226, v227
v_pk_fma_f32 v[232:233], v[120:121], v[76:77], v[232:233] op_sel:[0,1,0] op_sel_hi:[1,1,1]
v_pk_fma_f32 v[234:235], v[122:123], v[76:77], v[234:235] op_sel:[0,1,0] op_sel_hi:[1,1,1]
v_pk_mul_f32 v[232:233], v[232:233], v[100:101]
v_pk_mul_f32 v[234:235], v[234:235], v[102:103]
v_cvt_pk_bf16_f32 v36, v232, v233
v_cvt_pk_bf16_f32 v37, v234, v235
v_pk_fma_f32 v[240:241], v[124:125], v[76:77], v[240:241] op_sel:[0,1,0] op_sel_hi:[1,1,1]
v_pk_fma_f32 v[242:243], v[126:127], v[76:77], v[242:243] op_sel:[0,1,0] op_sel_hi:[1,1,1]
v_pk_mul_f32 v[240:241], v[240:241], v[104:105]
v_pk_mul_f32 v[242:243], v[242:243], v[106:107]
v_cvt_pk_bf16_f32 v38, v240, v241
v_cvt_pk_bf16_f32 v39, v242, v243
s_mov_b32 s66, 0x3e8293ee
v_max_f32 v148, v152, v153
v_max_f32 v149, v154, v155
v_max_f32 v150, v184, v185
v_max_f32 v151, v186, v187
v_max3_f32 v60, v148, v149, v150
v_max_f32 v60, v60, v151
v_max_f32 v156, v160, v161
v_max_f32 v157, v162, v163
v_max_f32 v158, v192, v193
v_max_f32 v159, v194, v195
v_max3_f32 v61, v156, v157, v158
v_max_f32 v61, v61, v159
v_max_f32 v164, v168, v169
v_max_f32 v165, v170, v171
v_max_f32 v166, v200, v201
v_max_f32 v167, v202, v203
v_max3_f32 v62, v164, v165, v166
v_max_f32 v62, v62, v167
v_max_f32 v172, v176, v177
v_max_f32 v173, v178, v179
v_max_f32 v174, v208, v209
v_max_f32 v175, v210, v211
v_max3_f32 v63, v172, v173, v174
v_max_f32 v63, v63, v175
s_nop 1
v_permlane32_swap_b32 v60, v61
v_permlane32_swap_b32 v62, v63
s_nop 0
v_max_f32 v60, v60, v61
v_max_f32 v62, v62, v63
s_nop 1
v_permlane16_swap_b32 v60, v62
s_nop 0
v_max_f32 v60, v60, v62
v_mul_f32 v60, s66, v60
v_mov_b32 v62, v60
s_nop 1
v_permlane16_swap_b32 v60, v62
s_nop 0
v_mov_b32 v61, v60
v_mov_b32 v63, v62
s_nop 1
v_permlane32_swap_b32 v60, v61
v_permlane32_swap_b32 v62, v63
s_nop 0
v_fma_f32 v148, v148, s66, -v60
v_fma_f32 v149, v149, s66, -v60
v_fma_f32 v150, v150, s66, -v60
v_fma_f32 v151, v151, s66, -v60
v_exp_f32 v148, v148
v_exp_f32 v149, v149
v_exp_f32 v150, v150
v_exp_f32 v151, v151
v_fma_f32 v156, v156, s66, -v61
v_fma_f32 v157, v157, s66, -v61
v_fma_f32 v158, v158, s66, -v61
v_fma_f32 v159, v159, s66, -v61
v_exp_f32 v156, v156
v_exp_f32 v157, v157
v_exp_f32 v158, v158
v_exp_f32 v159, v159
v_fma_f32 v164, v164, s66, -v62
v_fma_f32 v165, v165, s66, -v62
v_fma_f32 v166, v166, s66, -v62
v_fma_f32 v167, v167, s66, -v62
v_exp_f32 v164, v164
v_exp_f32 v165, v165
v_exp_f32 v166, v166
v_exp_f32 v167, v167
v_fma_f32 v172, v172, s66, -v63
v_fma_f32 v173, v173, s66, -v63
v_fma_f32 v174, v174, s66, -v63
v_fma_f32 v175, v175, s66, -v63
v_exp_f32 v172, v172
v_exp_f32 v173, v173
v_exp_f32 v174, v174
v_exp_f32 v175, v175
v_cvt_pk_bf16_f32 v148, v148, v148
v_cvt_pk_bf16_f32 v149, v149, v149
v_cvt_pk_bf16_f32 v150, v150, v150
v_cvt_pk_bf16_f32 v151, v151, v151
v_and_b32 v148, v52, v148
v_and_b32 v149, v52, v149
v_and_b32 v150, v52, v150
v_and_b32 v151, v52, v151
v_cvt_pk_bf16_f32 v156, v156, v156
v_cvt_pk_bf16_f32 v157, v157, v157
v_cvt_pk_bf16_f32 v158, v158, v158
v_cvt_pk_bf16_f32 v159, v159, v159
v_and_b32 v156, v52, v156
v_and_b32 v157, v52, v157
v_and_b32 v158, v52, v158
v_and_b32 v159, v52, v159
v_cvt_pk_bf16_f32 v164, v164, v164
v_cvt_pk_bf16_f32 v165, v165, v165
v_cvt_pk_bf16_f32 v166, v166, v166
v_cvt_pk_bf16_f32 v167, v167, v167
v_and_b32 v164, v52, v164
v_and_b32 v165, v52, v165
v_and_b32 v166, v52, v166
v_and_b32 v167, v52, v167
v_cvt_pk_bf16_f32 v172, v172, v172
v_cvt_pk_bf16_f32 v173, v173, v173
v_cvt_pk_bf16_f32 v174, v174, v174
v_cvt_pk_bf16_f32 v175, v175, v175
v_and_b32 v172, v52, v172
v_and_b32 v173, v52, v173
v_and_b32 v174, v52, v174
v_and_b32 v175, v52, v175
s_nop 1
v_mfma_f32_16x16x32_bf16 v[152:155], v[56:59], v[148:151], 0
v_mfma_f32_16x16x32_bf16 v[160:163], v[56:59], v[156:159], 0
v_mfma_f32_16x16x32_bf16 v[168:171], v[56:59], v[164:167], 0
v_mfma_f32_16x16x32_bf16 v[176:179], v[56:59], v[172:175], 0
v_mfma_f32_16x16x32_bf16 v[212:215], v[20:23], v[148:151], 0
v_mfma_f32_16x16x32_bf16 v[216:219], v[30:33], v[148:151], 0
v_mfma_f32_16x16x32_bf16 v[220:223], v[22:25], v[156:159], 0
v_mfma_f32_16x16x32_bf16 v[224:227], v[32:35], v[156:159], 0
v_mfma_f32_16x16x32_bf16 v[228:231], v[24:27], v[164:167], 0
v_mfma_f32_16x16x32_bf16 v[232:235], v[34:37], v[164:167], 0
v_mfma_f32_16x16x32_bf16 v[236:239], v[26:29], v[172:175], 0
v_mfma_f32_16x16x32_bf16 v[240:243], v[36:39], v[172:175], 0
v_rcp_f32 v152, v152
v_rcp_f32 v160, v160
v_rcp_f32 v168, v168
v_rcp_f32 v176, v176
s_lshl_b32 s48, s41, 3
s_lshl_b32 s49, s44, 2
s_add_u32 s48, s48, s49
s_lshl_b32 s48, s48, 5
s_add_u32 s48, s48, s45
s_lshl_b32 s48, s48, 10
s_add_u32 s48, s48, 4194304
s_add_u32 s49, s48, 32768
s_add_u32 s50, s48, 65536
s_add_u32 s51, s48, 98304
s_lshl_b32 s52, s41, 2
s_add_u32 s52, s52, s44
s_lshl_b32 s52, s52, 7
s_add_u32 s52, s52, 14155776
s_cmp_eq_u32 s46, 0
s_cbranch_scc1 slow_3
v_pk_mul_f32 v[212:213], v[212:213], v[152:153] op_sel:[0,0] op_sel_hi:[1,0]
v_pk_mul_f32 v[214:215], v[214:215], v[152:153] op_sel:[0,0] op_sel_hi:[1,0]
v_pk_mul_f32 v[216:217], v[216:217], v[152:153] op_sel:[0,0] op_sel_hi:[1,0]
v_pk_mul_f32 v[218:219], v[218:219], v[152:153] op_sel:[0,0] op_sel_hi:[1,0]
v_cvt_pk_bf16_f32 v212, v212, v213
v_cvt_pk_bf16_f32 v213, v214, v215
v_cvt_pk_bf16_f32 v214, v216, v217
v_cvt_pk_bf16_f32 v215, v218, v219
buffer_store_dwordx4 v[212:215], v18, s[32:35], s48 offen
v_pk_mul_f32 v[220:221], v[220:221], v[160:161] op_sel:[0,0] op_sel_hi:[1,0]
v_pk_mul_f32 v[222:223], v[222:223], v[160:161] op_sel:[0,0] op_sel_hi:[1,0]
v_pk_mul_f32 v[224:225], v[224:225], v[160:161] op_sel:[0,0] op_sel_hi:[1,0]
v_pk_mul_f32 v[226:227], v[226:227], v[160:161] op_sel:[0,0] op_sel_hi:[1,0]
v_cvt_pk_bf16_f32 v220, v220, v221
v_cvt_pk_bf16_f32 v221, v222, v223
v_cvt_pk_bf16_f32 v222, v224, v225
v_cvt_pk_bf16_f32 v223, v226, v227
buffer_store_dwordx4 v[220:223], v18, s[32:35], s49 offen
v_pk_mul_f32 v[228:229], v[228:229], v[168:169] op_sel:[0,0] op_sel_hi:[1,0]
v_pk_mul_f32 v[230:231], v[230:231], v[168:169] op_sel:[0,0] op_sel_hi:[1,0]
v_pk_mul_f32 v[232:233], v[232:233], v[168:169] op_sel:[0,0] op_sel_hi:[1,0]
v_pk_mul_f32 v[234:235], v[234:235], v[168:169] op_sel:[0,0] op_sel_hi:[1,0]
v_cvt_pk_bf16_f32 v228, v228, v229
v_cvt_pk_bf16_f32 v229, v230, v231
v_cvt_pk_bf16_f32 v230, v232, v233
v_cvt_pk_bf16_f32 v231, v234, v235
buffer_store_dwordx4 v[228:231], v18, s[32:35], s50 offen
v_pk_mul_f32 v[236:237], v[236:237], v[176:177] op_sel:[0,0] op_sel_hi:[1,0]
v_pk_mul_f32 v[238:239], v[238:239], v[176:177] op_sel:[0,0] op_sel_hi:[1,0]
v_pk_mul_f32 v[240:241], v[240:241], v[176:177] op_sel:[0,0] op_sel_hi:[1,0]
v_pk_mul_f32 v[242:243], v[242:243], v[176:177] op_sel:[0,0] op_sel_hi:[1,0]
v_cvt_pk_bf16_f32 v236, v236, v237
v_cvt_pk_bf16_f32 v237, v238, v239
v_cvt_pk_bf16_f32 v238, v240, v241
v_cvt_pk_bf16_f32 v239, v242, v243
buffer_store_dwordx4 v[236:239], v18, s[32:35], s51 offen
s_waitcnt vmcnt(0)
s_lshl_b32 s62, s45, 2
v_mov_b32 v4, s62
v_mov_b32 v5, 1
s_mov_b64 exec, 1
buffer_store_dword v5, v4, s[32:35], s52 offen
s_mov_b64 exec, -1
back_4:
s_lshl_b32 s48, s41, 3
s_lshl_b32 s49, s40, 1
s_add_u32 s48, s48, s49
s_lshl_b32 s49, s48, 4
v_add_u32 v4, s49, v2
v_lshlrev_b32 v4, 11, v4
v_and_b32 v5, 1, v3
v_lshl_add_u32 v4, v5, 5, v4
v_lshrrev_b32 v5, 1, v3
v_lshl_add_u32 v4, v5, 4, v4
s_lshl_b32 s49, s42, 7
v_add_u32 v12, s49, v4
v_add_u32 v13, 32768, v12
buffer_load_dwordx4 v[88:91], v12, s[24:27], 0 offen offset:0
buffer_load_dwordx4 v[92:95], v12, s[24:27], 0 offen offset:64
buffer_load_dwordx4 v[96:99], v13, s[24:27], 0 offen offset:0
buffer_load_dwordx4 v[100:103], v13, s[24:27], 0 offen offset:64
v_lshrrev_b32 v4, 2, v2
v_and_b32 v5, 3, v0
v_lshl_add_u32 v6, v3, 3, v4
v_lshlrev_b32 v6, 7, v6
v_lshl_add_u32 v6, v5, 3, v6
v_lshrrev_b32 v7, 1, v4
v_and_b32 v8, 1, v3
v_lshl_add_u32 v7, v8, 1, v7
v_lshl_add_u32 v14, v7, 5, v6
v_xor_b32 v15, 32, v14
v_xor_b32 v16, 64, v14
v_xor_b32 v17, 96, v14
s_lshl_b32 s48, s41, 3
s_lshl_b32 s49, s40, 1
s_add_u32 s56, s48, s49
s_lshl_b32 s48, s56, 15
s_add_u32 s48, s48, 4194304
v_add_u32 v12, s48, v18
v_add_u32 v13, 32768, v12
v_mov_b32 v20, 0
v_mov_b32 v21, 0
v_mov_b32 v22, 0
v_mov_b32 v23, 0
v_mov_b32 v24, 0
v_mov_b32 v25, 0
v_mov_b32 v26, 0
v_mov_b32 v27, 0
v_mov_b32 v28, 0
v_mov_b32 v29, 0
v_mov_b32 v30, 0
v_mov_b32 v31, 0
v_mov_b32 v32, 0
v_mov_b32 v33, 0
v_mov_b32 v34, 0
v_mov_b32 v35, 0
v_mov_b32 v36, 0
v_mov_b32 v37, 0
v_mov_b32 v38, 0
v_mov_b32 v39, 0
v_mov_b32 v40, 0
v_mov_b32 v41, 0
v_mov_b32 v42, 0
v_mov_b32 v43, 0
v_mov_b32 v44, 0
v_mov_b32 v45, 0
v_mov_b32 v46, 0
v_mov_b32 v47, 0
v_mov_b32 v48, 0
v_mov_b32 v49, 0
v_mov_b32 v50, 0
v_mov_b32 v51, 0
s_lshl_b32 s57, s47, 11
s_lshl_b32 s52, s41, 2
s_add_u32 s52, s52, s44
s_lshl_b32 s52, s52, 7
s_add_u32 s52, s52, 14155776
v_and_b32 v4, 31, v0
v_lshlrev_b32 v4, 2, v4
buffer_load_dword v5, v4, s[32:35], s52 offen sc1
s_barrier
ds_read_b64_tr_b16 v[212:213], v14 offset:0
ds_read_b64_tr_b16 v[214:215], v14 offset:512
ds_read_b64_tr_b16 v[216:217], v15 offset:0
ds_read_b64_tr_b16 v[218:219], v15 offset:512
ds_read_b64_tr_b16 v[220:221], v16 offset:0
ds_read_b64_tr_b16 v[222:223], v16 offset:512
ds_read_b64_tr_b16 v[224:225], v17 offset:0
ds_read_b64_tr_b16 v[226:227], v17 offset:512
s_mov_b32 s63, 0
s_waitcnt vmcnt(0)
poll_5:
v_cmp_gt_u32 vcc, 1, v5
s_cbranch_vccz polled_6
buffer_load_dword v5, v4, s[32:35], s52 offen sc1
s_add_u32 s63, s63, 1
s_cmp_lt_u32 s63, 0x80000
s_waitcnt vmcnt(0)
s_cbranch_scc1 poll_5
polled_6:
buffer_load_dwordx4 v[148:151], v12, s[32:35], s57 offen sc1
buffer_load_dwordx4 v[152:155], v13, s[32:35], s57 offen sc1
buffer_load_dwordx4 v[156:159], v12, s[32:35], s57 offen offset:1024 sc1
buffer_load_dwordx4 v[160:163], v13, s[32:35], s57 offen offset:1024 sc1
s_add_u32 s57, s57, 2048
s_and_b32 s57, s57, 0x7fff
buffer_load_dwordx4 v[164:167], v12, s[32:35], s57 offen sc1
buffer_load_dwordx4 v[168:171], v13, s[32:35], s57 offen sc1
buffer_load_dwordx4 v[172:175], v12, s[32:35], s57 offen offset:1024 sc1
buffer_load_dwordx4 v[176:179], v13, s[32:35], s57 offen offset:1024 sc1
s_add_u32 s57, s57, 2048
s_and_b32 s57, s57, 0x7fff
buffer_load_dwordx4 v[180:183], v12, s[32:35], s57 offen sc1
buffer_load_dwordx4 v[184:187], v13, s[32:35], s57 offen sc1
buffer_load_dwordx4 v[188:191], v12, s[32:35], s57 offen offset:1024 sc1
buffer_load_dwordx4 v[192:195], v13, s[32:35], s57 offen offset:1024 sc1
s_add_u32 s57, s57, 2048
s_and_b32 s57, s57, 0x7fff
s_waitcnt vmcnt(10) lgkmcnt(0)
v_mfma_f32_16x16x32_bf16 v[20:23], v[212:215], v[148:151], v[20:23]
ds_read_b64_tr_b16 v[228:229], v14 offset:4096
ds_read_b64_tr_b16 v[230:231], v14 offset:4608
v_mfma_f32_16x16x32_bf16 v[36:39], v[212:215], v[152:155], v[36:39]
ds_read_b64_tr_b16 v[232:233], v15 offset:4096
v_mfma_f32_16x16x32_bf16 v[24:27], v[216:219], v[148:151], v[24:27]
ds_read_b64_tr_b16 v[234:235], v15 offset:4608
ds_read_b64_tr_b16 v[236:237], v16 offset:4096
v_mfma_f32_16x16x32_bf16 v[40:43], v[216:219], v[152:155], v[40:43]
ds_read_b64_tr_b16 v[238:239], v16 offset:4608
v_mfma_f32_16x16x32_bf16 v[28:31], v[220:223], v[148:151], v[28:31]
ds_read_b64_tr_b16 v[240:241], v17 offset:4096
ds_read_b64_tr_b16 v[242:243], v17 offset:4608
v_mfma_f32_16x16x32_bf16 v[44:47], v[220:223], v[152:155], v[44:47]
buffer_load_dwordx4 v[196:199], v12, s[32:35], s57 offen sc1
v_mfma_f32_16x16x32_bf16 v[32:35], v[224:227], v[148:151], v[32:35]
buffer_load_dwordx4 v[200:203], v13, s[32:35], s57 offen sc1
buffer_load_dwordx4 v[204:207], v12, s[32:35], s57 offen offset:1024 sc1
v_mfma_f32_16x16x32_bf16 v[48:51], v[224:227], v[152:155], v[48:51]
buffer_load_dwordx4 v[208:211], v13, s[32:35], s57 offen offset:1024 sc1
s_add_u32 s57, s57, 2048
s_and_b32 s57, s57, 0x7fff
s_waitcnt vmcnt(12) lgkmcnt(0)
v_mfma_f32_16x16x32_bf16 v[20:23], v[228:231], v[156:159], v[20:23]
ds_read_b64_tr_b16 v[212:213], v14 offset:8192
v_mfma_f32_16x16x32_bf16 v[36:39], v[228:231], v[160:163], v[36:39]
ds_read_b64_tr_b16 v[214:215], v14 offset:8704
v_mfma_f32_16x16x32_bf16 v[24:27], v[232:235], v[156:159], v[24:27]
ds_read_b64_tr_b16 v[216:217], v15 offset:8192
v_mfma_f32_16x16x32_bf16 v[40:43], v[232:235], v[160:163], v[40:43]
ds_read_b64_tr_b16 v[218:219], v15 offset:8704
v_mfma_f32_16x16x32_bf16 v[28:31], v[236:239], v[156:159], v[28:31]
ds_read_b64_tr_b16 v[220:221], v16 offset:8192
v_mfma_f32_16x16x32_bf16 v[44:47], v[236:239], v[160:163], v[44:47]
ds_read_b64_tr_b16 v[222:223], v16 offset:8704
v_mfma_f32_16x16x32_bf16 v[32:35], v[240:243], v[156:159], v[32:35]
ds_read_b64_tr_b16 v[224:225], v17 offset:8192
v_mfma_f32_16x16x32_bf16 v[48:51], v[240:243], v[160:163], v[48:51]
ds_read_b64_tr_b16 v[226:227], v17 offset:8704
s_waitcnt vmcnt(10) lgkmcnt(0)
v_mfma_f32_16x16x32_bf16 v[20:23], v[212:215], v[164:167], v[20:23]
ds_read_b64_tr_b16 v[228:229], v14 offset:12288
ds_read_b64_tr_b16 v[230:231], v14 offset:12800
v_mfma_f32_16x16x32_bf16 v[36:39], v[212:215], v[168:171], v[36:39]
ds_read_b64_tr_b16 v[232:233], v15 offset:12288
v_mfma_f32_16x16x32_bf16 v[24:27], v[216:219], v[164:167], v[24:27]
ds_read_b64_tr_b16 v[234:235], v15 offset:12800
ds_read_b64_tr_b16 v[236:237], v16 offset:12288
v_mfma_f32_16x16x32_bf16 v[40:43], v[216:219], v[168:171], v[40:43]
ds_read_b64_tr_b16 v[238:239], v16 offset:12800
v_mfma_f32_16x16x32_bf16 v[28:31], v[220:223], v[164:167], v[28:31]
ds_read_b64_tr_b16 v[240:241], v17 offset:12288
ds_read_b64_tr_b16 v[242:243], v17 offset:12800
v_mfma_f32_16x16x32_bf16 v[44:47], v[220:223], v[168:171], v[44:47]
buffer_load_dwordx4 v[148:151], v12, s[32:35], s57 offen sc1
v_mfma_f32_16x16x32_bf16 v[32:35], v[224:227], v[164:167], v[32:35]
buffer_load_dwordx4 v[152:155], v13, s[32:35], s57 offen sc1
buffer_load_dwordx4 v[156:159], v12, s[32:35], s57 offen offset:1024 sc1
v_mfma_f32_16x16x32_bf16 v[48:51], v[224:227], v[168:171], v[48:51]
buffer_load_dwordx4 v[160:163], v13, s[32:35], s57 offen offset:1024 sc1
s_add_u32 s57, s57, 2048
s_and_b32 s57, s57, 0x7fff
s_waitcnt vmcnt(12) lgkmcnt(0)
v_mfma_f32_16x16x32_bf16 v[20:23], v[228:231], v[172:175], v[20:23]
ds_read_b64_tr_b16 v[212:213], v14 offset:16384
v_mfma_f32_16x16x32_bf16 v[36:39], v[228:231], v[176:179], v[36:39]
ds_read_b64_tr_b16 v[214:215], v14 offset:16896
v_mfma_f32_16x16x32_bf16 v[24:27], v[232:235], v[172:175], v[24:27]
ds_read_b64_tr_b16 v[216:217], v15 offset:16384
v_mfma_f32_16x16x32_bf16 v[40:43], v[232:235], v[176:179], v[40:43]
ds_read_b64_tr_b16 v[218:219], v15 offset:16896
v_mfma_f32_16x16x32_bf16 v[28:31], v[236:239], v[172:175], v[28:31]
ds_read_b64_tr_b16 v[220:221], v16 offset:16384
v_mfma_f32_16x16x32_bf16 v[44:47], v[236:239], v[176:179], v[44:47]
ds_read_b64_tr_b16 v[222:223], v16 offset:16896
v_mfma_f32_16x16x32_bf16 v[32:35], v[240:243], v[172:175], v[32:35]
ds_read_b64_tr_b16 v[224:225], v17 offset:16384
v_mfma_f32_16x16x32_bf16 v[48:51], v[240:243], v[176:179], v[48:51]
ds_read_b64_tr_b16 v[226:227], v17 offset:16896
s_waitcnt vmcnt(10) lgkmcnt(0)
v_mfma_f32_16x16x32_bf16 v[20:23], v[212:215], v[180:183], v[20:23]
ds_read_b64_tr_b16 v[228:229], v14 offset:20480
ds_read_b64_tr_b16 v[230:231], v14 offset:20992
v_mfma_f32_16x16x32_bf16 v[36:39], v[212:215], v[184:187], v[36:39]
ds_read_b64_tr_b16 v[232:233], v15 offset:20480
v_mfma_f32_16x16x32_bf16 v[24:27], v[216:219], v[180:183], v[24:27]
ds_read_b64_tr_b16 v[234:235], v15 offset:20992
ds_read_b64_tr_b16 v[236:237], v16 offset:20480
v_mfma_f32_16x16x32_bf16 v[40:43], v[216:219], v[184:187], v[40:43]
ds_read_b64_tr_b16 v[238:239], v16 offset:20992
v_mfma_f32_16x16x32_bf16 v[28:31], v[220:223], v[180:183], v[28:31]
ds_read_b64_tr_b16 v[240:241], v17 offset:20480
ds_read_b64_tr_b16 v[242:243], v17 offset:20992
v_mfma_f32_16x16x32_bf16 v[44:47], v[220:223], v[184:187], v[44:47]
buffer_load_dwordx4 v[164:167], v12, s[32:35], s57 offen sc1
v_mfma_f32_16x16x32_bf16 v[32:35], v[224:227], v[180:183], v[32:35]
buffer_load_dwordx4 v[168:171], v13, s[32:35], s57 offen sc1
buffer_load_dwordx4 v[172:175], v12, s[32:35], s57 offen offset:1024 sc1
v_mfma_f32_16x16x32_bf16 v[48:51], v[224:227], v[184:187], v[48:51]
buffer_load_dwordx4 v[176:179], v13, s[32:35], s57 offen offset:1024 sc1
s_add_u32 s57, s57, 2048
s_and_b32 s57, s57, 0x7fff
s_waitcnt vmcnt(12) lgkmcnt(0)
v_mfma_f32_16x16x32_bf16 v[20:23], v[228:231], v[188:191], v[20:23]
ds_read_b64_tr_b16 v[212:213], v14 offset:24576
v_mfma_f32_16x16x32_bf16 v[36:39], v[228:231], v[192:195], v[36:39]
ds_read_b64_tr_b16 v[214:215], v14 offset:25088
v_mfma_f32_16x16x32_bf16 v[24:27], v[232:235], v[188:191], v[24:27]
ds_read_b64_tr_b16 v[216:217], v15 offset:24576
v_mfma_f32_16x16x32_bf16 v[40:43], v[232:235], v[192:195], v[40:43]
ds_read_b64_tr_b16 v[218:219], v15 offset:25088
v_mfma_f32_16x16x32_bf16 v[28:31], v[236:239], v[188:191], v[28:31]
ds_read_b64_tr_b16 v[220:221], v16 offset:24576
v_mfma_f32_16x16x32_bf16 v[44:47], v[236:239], v[192:195], v[44:47]
ds_read_b64_tr_b16 v[222:223], v16 offset:25088
v_mfma_f32_16x16x32_bf16 v[32:35], v[240:243], v[188:191], v[32:35]
ds_read_b64_tr_b16 v[224:225], v17 offset:24576
v_mfma_f32_16x16x32_bf16 v[48:51], v[240:243], v[192:195], v[48:51]
ds_read_b64_tr_b16 v[226:227], v17 offset:25088
s_waitcnt vmcnt(10) lgkmcnt(0)
v_mfma_f32_16x16x32_bf16 v[20:23], v[212:215], v[196:199], v[20:23]
ds_read_b64_tr_b16 v[228:229], v14 offset:28672
ds_read_b64_tr_b16 v[230:231], v14 offset:29184
v_mfma_f32_16x16x32_bf16 v[36:39], v[212:215], v[200:203], v[36:39]
ds_read_b64_tr_b16 v[232:233], v15 offset:28672
v_mfma_f32_16x16x32_bf16 v[24:27], v[216:219], v[196:199], v[24:27]
ds_read_b64_tr_b16 v[234:235], v15 offset:29184
ds_read_b64_tr_b16 v[236:237], v16 offset:28672
v_mfma_f32_16x16x32_bf16 v[40:43], v[216:219], v[200:203], v[40:43]
ds_read_b64_tr_b16 v[238:239], v16 offset:29184
v_mfma_f32_16x16x32_bf16 v[28:31], v[220:223], v[196:199], v[28:31]
ds_read_b64_tr_b16 v[240:241], v17 offset:28672
ds_read_b64_tr_b16 v[242:243], v17 offset:29184
v_mfma_f32_16x16x32_bf16 v[44:47], v[220:223], v[200:203], v[44:47]
buffer_load_dwordx4 v[180:183], v12, s[32:35], s57 offen sc1
v_mfma_f32_16x16x32_bf16 v[32:35], v[224:227], v[196:199], v[32:35]
buffer_load_dwordx4 v[184:187], v13, s[32:35], s57 offen sc1
buffer_load_dwordx4 v[188:191], v12, s[32:35], s57 offen offset:1024 sc1
v_mfma_f32_16x16x32_bf16 v[48:51], v[224:227], v[200:203], v[48:51]
buffer_load_dwordx4 v[192:195], v13, s[32:35], s57 offen offset:1024 sc1
s_add_u32 s57, s57, 2048
s_and_b32 s57, s57, 0x7fff
s_waitcnt vmcnt(12) lgkmcnt(0)
v_mfma_f32_16x16x32_bf16 v[20:23], v[228:231], v[204:207], v[20:23]
ds_read_b64_tr_b16 v[212:213], v14 offset:32768
v_mfma_f32_16x16x32_bf16 v[36:39], v[228:231], v[208:211], v[36:39]
ds_read_b64_tr_b16 v[214:215], v14 offset:33280
v_mfma_f32_16x16x32_bf16 v[24:27], v[232:235], v[204:207], v[24:27]
ds_read_b64_tr_b16 v[216:217], v15 offset:32768
v_mfma_f32_16x16x32_bf16 v[40:43], v[232:235], v[208:211], v[40:43]
ds_read_b64_tr_b16 v[218:219], v15 offset:33280
v_mfma_f32_16x16x32_bf16 v[28:31], v[236:239], v[204:207], v[28:31]
ds_read_b64_tr_b16 v[220:221], v16 offset:32768
v_mfma_f32_16x16x32_bf16 v[44:47], v[236:239], v[208:211], v[44:47]
ds_read_b64_tr_b16 v[222:223], v16 offset:33280
v_mfma_f32_16x16x32_bf16 v[32:35], v[240:243], v[204:207], v[32:35]
ds_read_b64_tr_b16 v[224:225], v17 offset:32768
v_mfma_f32_16x16x32_bf16 v[48:51], v[240:243], v[208:211], v[48:51]
ds_read_b64_tr_b16 v[226:227], v17 offset:33280
s_waitcnt vmcnt(10) lgkmcnt(0)
v_mfma_f32_16x16x32_bf16 v[20:23], v[212:215], v[148:151], v[20:23]
ds_read_b64_tr_b16 v[228:229], v14 offset:36864
ds_read_b64_tr_b16 v[230:231], v14 offset:37376
v_mfma_f32_16x16x32_bf16 v[36:39], v[212:215], v[152:155], v[36:39]
ds_read_b64_tr_b16 v[232:233], v15 offset:36864
v_mfma_f32_16x16x32_bf16 v[24:27], v[216:219], v[148:151], v[24:27]
ds_read_b64_tr_b16 v[234:235], v15 offset:37376
ds_read_b64_tr_b16 v[236:237], v16 offset:36864
v_mfma_f32_16x16x32_bf16 v[40:43], v[216:219], v[152:155], v[40:43]
ds_read_b64_tr_b16 v[238:239], v16 offset:37376
v_mfma_f32_16x16x32_bf16 v[28:31], v[220:223], v[148:151], v[28:31]
ds_read_b64_tr_b16 v[240:241], v17 offset:36864
ds_read_b64_tr_b16 v[242:243], v17 offset:37376
v_mfma_f32_16x16x32_bf16 v[44:47], v[220:223], v[152:155], v[44:47]
buffer_load_dwordx4 v[196:199], v12, s[32:35], s57 offen sc1
v_mfma_f32_16x16x32_bf16 v[32:35], v[224:227], v[148:151], v[32:35]
buffer_load_dwordx4 v[200:203], v13, s[32:35], s57 offen sc1
buffer_load_dwordx4 v[204:207], v12, s[32:35], s57 offen offset:1024 sc1
v_mfma_f32_16x16x32_bf16 v[48:51], v[224:227], v[152:155], v[48:51]
buffer_load_dwordx4 v[208:211], v13, s[32:35], s57 offen offset:1024 sc1
s_add_u32 s57, s57, 2048
s_and_b32 s57, s57, 0x7fff
s_waitcnt vmcnt(12) lgkmcnt(0)
v_mfma_f32_16x16x32_bf16 v[20:23], v[228:231], v[156:159], v[20:23]
ds_read_b64_tr_b16 v[212:213], v14 offset:40960
v_mfma_f32_16x16x32_bf16 v[36:39], v[228:231], v[160:163], v[36:39]
ds_read_b64_tr_b16 v[214:215], v14 offset:41472
v_mfma_f32_16x16x32_bf16 v[24:27], v[232:235], v[156:159], v[24:27]
ds_read_b64_tr_b16 v[216:217], v15 offset:40960
v_mfma_f32_16x16x32_bf16 v[40:43], v[232:235], v[160:163], v[40:43]
ds_read_b64_tr_b16 v[218:219], v15 offset:41472
v_mfma_f32_16x16x32_bf16 v[28:31], v[236:239], v[156:159], v[28:31]
ds_read_b64_tr_b16 v[220:221], v16 offset:40960
v_mfma_f32_16x16x32_bf16 v[44:47], v[236:239], v[160:163], v[44:47]
ds_read_b64_tr_b16 v[222:223], v16 offset:41472
v_mfma_f32_16x16x32_bf16 v[32:35], v[240:243], v[156:159], v[32:35]
ds_read_b64_tr_b16 v[224:225], v17 offset:40960
v_mfma_f32_16x16x32_bf16 v[48:51], v[240:243], v[160:163], v[48:51]
ds_read_b64_tr_b16 v[226:227], v17 offset:41472
s_waitcnt vmcnt(10) lgkmcnt(0)
v_mfma_f32_16x16x32_bf16 v[20:23], v[212:215], v[164:167], v[20:23]
ds_read_b64_tr_b16 v[228:229], v14 offset:45056
ds_read_b64_tr_b16 v[230:231], v14 offset:45568
v_mfma_f32_16x16x32_bf16 v[36:39], v[212:215], v[168:171], v[36:39]
ds_read_b64_tr_b16 v[232:233], v15 offset:45056
v_mfma_f32_16x16x32_bf16 v[24:27], v[216:219], v[164:167], v[24:27]
ds_read_b64_tr_b16 v[234:235], v15 offset:45568
ds_read_b64_tr_b16 v[236:237], v16 offset:45056
v_mfma_f32_16x16x32_bf16 v[40:43], v[216:219], v[168:171], v[40:43]
ds_read_b64_tr_b16 v[238:239], v16 offset:45568
v_mfma_f32_16x16x32_bf16 v[28:31], v[220:223], v[164:167], v[28:31]
ds_read_b64_tr_b16 v[240:241], v17 offset:45056
ds_read_b64_tr_b16 v[242:243], v17 offset:45568
v_mfma_f32_16x16x32_bf16 v[44:47], v[220:223], v[168:171], v[44:47]
buffer_load_dwordx4 v[148:151], v12, s[32:35], s57 offen sc1
v_mfma_f32_16x16x32_bf16 v[32:35], v[224:227], v[164:167], v[32:35]
buffer_load_dwordx4 v[152:155], v13, s[32:35], s57 offen sc1
buffer_load_dwordx4 v[156:159], v12, s[32:35], s57 offen offset:1024 sc1
v_mfma_f32_16x16x32_bf16 v[48:51], v[224:227], v[168:171], v[48:51]
buffer_load_dwordx4 v[160:163], v13, s[32:35], s57 offen offset:1024 sc1
s_add_u32 s57, s57, 2048
s_and_b32 s57, s57, 0x7fff
s_waitcnt vmcnt(12) lgkmcnt(0)
v_mfma_f32_16x16x32_bf16 v[20:23], v[228:231], v[172:175], v[20:23]
ds_read_b64_tr_b16 v[212:213], v14 offset:49152
v_mfma_f32_16x16x32_bf16 v[36:39], v[228:231], v[176:179], v[36:39]
ds_read_b64_tr_b16 v[214:215], v14 offset:49664
v_mfma_f32_16x16x32_bf16 v[24:27], v[232:235], v[172:175], v[24:27]
ds_read_b64_tr_b16 v[216:217], v15 offset:49152
v_mfma_f32_16x16x32_bf16 v[40:43], v[232:235], v[176:179], v[40:43]
ds_read_b64_tr_b16 v[218:219], v15 offset:49664
v_mfma_f32_16x16x32_bf16 v[28:31], v[236:239], v[172:175], v[28:31]
ds_read_b64_tr_b16 v[220:221], v16 offset:49152
v_mfma_f32_16x16x32_bf16 v[44:47], v[236:239], v[176:179], v[44:47]
ds_read_b64_tr_b16 v[222:223], v16 offset:49664
v_mfma_f32_16x16x32_bf16 v[32:35], v[240:243], v[172:175], v[32:35]
ds_read_b64_tr_b16 v[224:225], v17 offset:49152
v_mfma_f32_16x16x32_bf16 v[48:51], v[240:243], v[176:179], v[48:51]
ds_read_b64_tr_b16 v[226:227], v17 offset:49664
s_waitcnt vmcnt(10) lgkmcnt(0)
v_mfma_f32_16x16x32_bf16 v[20:23], v[212:215], v[180:183], v[20:23]
ds_read_b64_tr_b16 v[228:229], v14 offset:53248
ds_read_b64_tr_b16 v[230:231], v14 offset:53760
v_mfma_f32_16x16x32_bf16 v[36:39], v[212:215], v[184:187], v[36:39]
ds_read_b64_tr_b16 v[232:233], v15 offset:53248
v_mfma_f32_16x16x32_bf16 v[24:27], v[216:219], v[180:183], v[24:27]
ds_read_b64_tr_b16 v[234:235], v15 offset:53760
ds_read_b64_tr_b16 v[236:237], v16 offset:53248
v_mfma_f32_16x16x32_bf16 v[40:43], v[216:219], v[184:187], v[40:43]
ds_read_b64_tr_b16 v[238:239], v16 offset:53760
v_mfma_f32_16x16x32_bf16 v[28:31], v[220:223], v[180:183], v[28:31]
ds_read_b64_tr_b16 v[240:241], v17 offset:53248
ds_read_b64_tr_b16 v[242:243], v17 offset:53760
v_mfma_f32_16x16x32_bf16 v[44:47], v[220:223], v[184:187], v[44:47]
buffer_load_dwordx4 v[164:167], v12, s[32:35], s57 offen sc1
v_mfma_f32_16x16x32_bf16 v[32:35], v[224:227], v[180:183], v[32:35]
buffer_load_dwordx4 v[168:171], v13, s[32:35], s57 offen sc1
buffer_load_dwordx4 v[172:175], v12, s[32:35], s57 offen offset:1024 sc1
v_mfma_f32_16x16x32_bf16 v[48:51], v[224:227], v[184:187], v[48:51]
buffer_load_dwordx4 v[176:179], v13, s[32:35], s57 offen offset:1024 sc1
s_add_u32 s57, s57, 2048
s_and_b32 s57, s57, 0x7fff
s_waitcnt vmcnt(12) lgkmcnt(0)
v_mfma_f32_16x16x32_bf16 v[20:23], v[228:231], v[188:191], v[20:23]
ds_read_b64_tr_b16 v[212:213], v14 offset:57344
v_mfma_f32_16x16x32_bf16 v[36:39], v[228:231], v[192:195], v[36:39]
ds_read_b64_tr_b16 v[214:215], v14 offset:57856
v_mfma_f32_16x16x32_bf16 v[24:27], v[232:235], v[188:191], v[24:27]
ds_read_b64_tr_b16 v[216:217], v15 offset:57344
v_mfma_f32_16x16x32_bf16 v[40:43], v[232:235], v[192:195], v[40:43]
ds_read_b64_tr_b16 v[218:219], v15 offset:57856
v_mfma_f32_16x16x32_bf16 v[28:31], v[236:239], v[188:191], v[28:31]
ds_read_b64_tr_b16 v[220:221], v16 offset:57344
v_mfma_f32_16x16x32_bf16 v[44:47], v[236:239], v[192:195], v[44:47]
ds_read_b64_tr_b16 v[222:223], v16 offset:57856
v_mfma_f32_16x16x32_bf16 v[32:35], v[240:243], v[188:191], v[32:35]
ds_read_b64_tr_b16 v[224:225], v17 offset:57344
v_mfma_f32_16x16x32_bf16 v[48:51], v[240:243], v[192:195], v[48:51]
ds_read_b64_tr_b16 v[226:227], v17 offset:57856
s_waitcnt vmcnt(10) lgkmcnt(0)
v_mfma_f32_16x16x32_bf16 v[20:23], v[212:215], v[196:199], v[20:23]
ds_read_b64_tr_b16 v[228:229], v14 offset:61440
ds_read_b64_tr_b16 v[230:231], v14 offset:61952
v_mfma_f32_16x16x32_bf16 v[36:39], v[212:215], v[200:203], v[36:39]
ds_read_b64_tr_b16 v[232:233], v15 offset:61440
v_mfma_f32_16x16x32_bf16 v[24:27], v[216:219], v[196:199], v[24:27]
ds_read_b64_tr_b16 v[234:235], v15 offset:61952
ds_read_b64_tr_b16 v[236:237], v16 offset:61440
v_mfma_f32_16x16x32_bf16 v[40:43], v[216:219], v[200:203], v[40:43]
ds_read_b64_tr_b16 v[238:239], v16 offset:61952
v_mfma_f32_16x16x32_bf16 v[28:31], v[220:223], v[196:199], v[28:31]
ds_read_b64_tr_b16 v[240:241], v17 offset:61440
ds_read_b64_tr_b16 v[242:243], v17 offset:61952
v_mfma_f32_16x16x32_bf16 v[44:47], v[220:223], v[200:203], v[44:47]
buffer_load_dwordx4 v[180:183], v12, s[32:35], s57 offen sc1
v_mfma_f32_16x16x32_bf16 v[32:35], v[224:227], v[196:199], v[32:35]
buffer_load_dwordx4 v[184:187], v13, s[32:35], s57 offen sc1
buffer_load_dwordx4 v[188:191], v12, s[32:35], s57 offen offset:1024 sc1
v_mfma_f32_16x16x32_bf16 v[48:51], v[224:227], v[200:203], v[48:51]
buffer_load_dwordx4 v[192:195], v13, s[32:35], s57 offen offset:1024 sc1
s_add_u32 s57, s57, 2048
s_and_b32 s57, s57, 0x7fff
s_waitcnt vmcnt(12) lgkmcnt(0)
v_add_u32 v14, 0x10000, v14
v_add_u32 v15, 0x10000, v15
v_add_u32 v16, 0x10000, v16
v_add_u32 v17, 0x10000, v17
v_mfma_f32_16x16x32_bf16 v[20:23], v[228:231], v[204:207], v[20:23]
ds_read_b64_tr_b16 v[212:213], v14 offset:0
v_mfma_f32_16x16x32_bf16 v[36:39], v[228:231], v[208:211], v[36:39]
ds_read_b64_tr_b16 v[214:215], v14 offset:512
v_mfma_f32_16x16x32_bf16 v[24:27], v[232:235], v[204:207], v[24:27]
ds_read_b64_tr_b16 v[216:217], v15 offset:0
v_mfma_f32_16x16x32_bf16 v[40:43], v[232:235], v[208:211], v[40:43]
ds_read_b64_tr_b16 v[218:219], v15 offset:512
v_mfma_f32_16x16x32_bf16 v[28:31], v[236:239], v[204:207], v[28:31]
ds_read_b64_tr_b16 v[220:221], v16 offset:0
v_mfma_f32_16x16x32_bf16 v[44:47], v[236:239], v[208:211], v[44:47]
ds_read_b64_tr_b16 v[222:223], v16 offset:512
v_mfma_f32_16x16x32_bf16 v[32:35], v[240:243], v[204:207], v[32:35]
ds_read_b64_tr_b16 v[224:225], v17 offset:0
v_mfma_f32_16x16x32_bf16 v[48:51], v[240:243], v[208:211], v[48:51]
ds_read_b64_tr_b16 v[226:227], v17 offset:512
s_waitcnt vmcnt(10) lgkmcnt(0)
v_mfma_f32_16x16x32_bf16 v[20:23], v[212:215], v[148:151], v[20:23]
ds_read_b64_tr_b16 v[228:229], v14 offset:4096
ds_read_b64_tr_b16 v[230:231], v14 offset:4608
v_mfma_f32_16x16x32_bf16 v[36:39], v[212:215], v[152:155], v[36:39]
ds_read_b64_tr_b16 v[232:233], v15 offset:4096
v_mfma_f32_16x16x32_bf16 v[24:27], v[216:219], v[148:151], v[24:27]
ds_read_b64_tr_b16 v[234:235], v15 offset:4608
ds_read_b64_tr_b16 v[236:237], v16 offset:4096
v_mfma_f32_16x16x32_bf16 v[40:43], v[216:219], v[152:155], v[40:43]
ds_read_b64_tr_b16 v[238:239], v16 offset:4608
v_mfma_f32_16x16x32_bf16 v[28:31], v[220:223], v[148:151], v[28:31]
ds_read_b64_tr_b16 v[240:241], v17 offset:4096
ds_read_b64_tr_b16 v[242:243], v17 offset:4608
v_mfma_f32_16x16x32_bf16 v[44:47], v[220:223], v[152:155], v[44:47]
buffer_load_dwordx4 v[196:199], v12, s[32:35], s57 offen sc1
v_mfma_f32_16x16x32_bf16 v[32:35], v[224:227], v[148:151], v[32:35]
buffer_load_dwordx4 v[200:203], v13, s[32:35], s57 offen sc1
buffer_load_dwordx4 v[204:207], v12, s[32:35], s57 offen offset:1024 sc1
v_mfma_f32_16x16x32_bf16 v[48:51], v[224:227], v[152:155], v[48:51]
buffer_load_dwordx4 v[208:211], v13, s[32:35], s57 offen offset:1024 sc1
s_add_u32 s57, s57, 2048
s_and_b32 s57, s57, 0x7fff
s_waitcnt vmcnt(12) lgkmcnt(0)
v_mfma_f32_16x16x32_bf16 v[20:23], v[228:231], v[156:159], v[20:23]
ds_read_b64_tr_b16 v[212:213], v14 offset:8192
v_mfma_f32_16x16x32_bf16 v[36:39], v[228:231], v[160:163], v[36:39]
ds_read_b64_tr_b16 v[214:215], v14 offset:8704
v_mfma_f32_16x16x32_bf16 v[24:27], v[232:235], v[156:159], v[24:27]
ds_read_b64_tr_b16 v[216:217], v15 offset:8192
v_mfma_f32_16x16x32_bf16 v[40:43], v[232:235], v[160:163], v[40:43]
ds_read_b64_tr_b16 v[218:219], v15 offset:8704
v_mfma_f32_16x16x32_bf16 v[28:31], v[236:239], v[156:159], v[28:31]
ds_read_b64_tr_b16 v[220:221], v16 offset:8192
v_mfma_f32_16x16x32_bf16 v[44:47], v[236:239], v[160:163], v[44:47]
ds_read_b64_tr_b16 v[222:223], v16 offset:8704
v_mfma_f32_16x16x32_bf16 v[32:35], v[240:243], v[156:159], v[32:35]
ds_read_b64_tr_b16 v[224:225], v17 offset:8192
v_mfma_f32_16x16x32_bf16 v[48:51], v[240:243], v[160:163], v[48:51]
ds_read_b64_tr_b16 v[226:227], v17 offset:8704
s_waitcnt vmcnt(10) lgkmcnt(0)
v_mfma_f32_16x16x32_bf16 v[20:23], v[212:215], v[164:167], v[20:23]
ds_read_b64_tr_b16 v[228:229], v14 offset:12288
ds_read_b64_tr_b16 v[230:231], v14 offset:12800
v_mfma_f32_16x16x32_bf16 v[36:39], v[212:215], v[168:171], v[36:39]
ds_read_b64_tr_b16 v[232:233], v15 offset:12288
v_mfma_f32_16x16x32_bf16 v[24:27], v[216:219], v[164:167], v[24:27]
ds_read_b64_tr_b16 v[234:235], v15 offset:12800
ds_read_b64_tr_b16 v[236:237], v16 offset:12288
v_mfma_f32_16x16x32_bf16 v[40:43], v[216:219], v[168:171], v[40:43]
ds_read_b64_tr_b16 v[238:239], v16 offset:12800
v_mfma_f32_16x16x32_bf16 v[28:31], v[220:223], v[164:167], v[28:31]
ds_read_b64_tr_b16 v[240:241], v17 offset:12288
ds_read_b64_tr_b16 v[242:243], v17 offset:12800
v_mfma_f32_16x16x32_bf16 v[44:47], v[220:223], v[168:171], v[44:47]
buffer_load_dwordx4 v[148:151], v12, s[32:35], s57 offen sc1
v_mfma_f32_16x16x32_bf16 v[32:35], v[224:227], v[164:167], v[32:35]
buffer_load_dwordx4 v[152:155], v13, s[32:35], s57 offen sc1
buffer_load_dwordx4 v[156:159], v12, s[32:35], s57 offen offset:1024 sc1
v_mfma_f32_16x16x32_bf16 v[48:51], v[224:227], v[168:171], v[48:51]
buffer_load_dwordx4 v[160:163], v13, s[32:35], s57 offen offset:1024 sc1
s_add_u32 s57, s57, 2048
s_and_b32 s57, s57, 0x7fff
s_waitcnt vmcnt(12) lgkmcnt(0)
v_mfma_f32_16x16x32_bf16 v[20:23], v[228:231], v[172:175], v[20:23]
ds_read_b64_tr_b16 v[212:213], v14 offset:16384
v_mfma_f32_16x16x32_bf16 v[36:39], v[228:231], v[176:179], v[36:39]
ds_read_b64_tr_b16 v[214:215], v14 offset:16896
v_mfma_f32_16x16x32_bf16 v[24:27], v[232:235], v[172:175], v[24:27]
ds_read_b64_tr_b16 v[216:217], v15 offset:16384
v_mfma_f32_16x16x32_bf16 v[40:43], v[232:235], v[176:179], v[40:43]
ds_read_b64_tr_b16 v[218:219], v15 offset:16896
v_mfma_f32_16x16x32_bf16 v[28:31], v[236:239], v[172:175], v[28:31]
ds_read_b64_tr_b16 v[220:221], v16 offset:16384
v_mfma_f32_16x16x32_bf16 v[44:47], v[236:239], v[176:179], v[44:47]
ds_read_b64_tr_b16 v[222:223], v16 offset:16896
v_mfma_f32_16x16x32_bf16 v[32:35], v[240:243], v[172:175], v[32:35]
ds_read_b64_tr_b16 v[224:225], v17 offset:16384
v_mfma_f32_16x16x32_bf16 v[48:51], v[240:243], v[176:179], v[48:51]
ds_read_b64_tr_b16 v[226:227], v17 offset:16896
s_waitcnt vmcnt(10) lgkmcnt(0)
v_mfma_f32_16x16x32_bf16 v[20:23], v[212:215], v[180:183], v[20:23]
ds_read_b64_tr_b16 v[228:229], v14 offset:20480
ds_read_b64_tr_b16 v[230:231], v14 offset:20992
v_mfma_f32_16x16x32_bf16 v[36:39], v[212:215], v[184:187], v[36:39]
ds_read_b64_tr_b16 v[232:233], v15 offset:20480
v_mfma_f32_16x16x32_bf16 v[24:27], v[216:219], v[180:183], v[24:27]
ds_read_b64_tr_b16 v[234:235], v15 offset:20992
ds_read_b64_tr_b16 v[236:237], v16 offset:20480
v_mfma_f32_16x16x32_bf16 v[40:43], v[216:219], v[184:187], v[40:43]
ds_read_b64_tr_b16 v[238:239], v16 offset:20992
v_mfma_f32_16x16x32_bf16 v[28:31], v[220:223], v[180:183], v[28:31]
ds_read_b64_tr_b16 v[240:241], v17 offset:20480
ds_read_b64_tr_b16 v[242:243], v17 offset:20992
v_mfma_f32_16x16x32_bf16 v[44:47], v[220:223], v[184:187], v[44:47]
buffer_load_dwordx4 v[164:167], v12, s[32:35], s57 offen sc1
v_mfma_f32_16x16x32_bf16 v[32:35], v[224:227], v[180:183], v[32:35]
buffer_load_dwordx4 v[168:171], v13, s[32:35], s57 offen sc1
buffer_load_dwordx4 v[172:175], v12, s[32:35], s57 offen offset:1024 sc1
v_mfma_f32_16x16x32_bf16 v[48:51], v[224:227], v[184:187], v[48:51]
buffer_load_dwordx4 v[176:179], v13, s[32:35], s57 offen offset:1024 sc1
s_add_u32 s57, s57, 2048
s_and_b32 s57, s57, 0x7fff
s_waitcnt vmcnt(12) lgkmcnt(0)
v_mfma_f32_16x16x32_bf16 v[20:23], v[228:231], v[188:191], v[20:23]
ds_read_b64_tr_b16 v[212:213], v14 offset:24576
v_mfma_f32_16x16x32_bf16 v[36:39], v[228:231], v[192:195], v[36:39]
ds_read_b64_tr_b16 v[214:215], v14 offset:25088
v_mfma_f32_16x16x32_bf16 v[24:27], v[232:235], v[188:191], v[24:27]
ds_read_b64_tr_b16 v[216:217], v15 offset:24576
v_mfma_f32_16x16x32_bf16 v[40:43], v[232:235], v[192:195], v[40:43]
ds_read_b64_tr_b16 v[218:219], v15 offset:25088
v_mfma_f32_16x16x32_bf16 v[28:31], v[236:239], v[188:191], v[28:31]
ds_read_b64_tr_b16 v[220:221], v16 offset:24576
v_mfma_f32_16x16x32_bf16 v[44:47], v[236:239], v[192:195], v[44:47]
ds_read_b64_tr_b16 v[222:223], v16 offset:25088
v_mfma_f32_16x16x32_bf16 v[32:35], v[240:243], v[188:191], v[32:35]
ds_read_b64_tr_b16 v[224:225], v17 offset:24576
v_mfma_f32_16x16x32_bf16 v[48:51], v[240:243], v[192:195], v[48:51]
ds_read_b64_tr_b16 v[226:227], v17 offset:25088
s_waitcnt vmcnt(10) lgkmcnt(0)
v_mfma_f32_16x16x32_bf16 v[20:23], v[212:215], v[196:199], v[20:23]
ds_read_b64_tr_b16 v[228:229], v14 offset:28672
ds_read_b64_tr_b16 v[230:231], v14 offset:29184
v_mfma_f32_16x16x32_bf16 v[36:39], v[212:215], v[200:203], v[36:39]
ds_read_b64_tr_b16 v[232:233], v15 offset:28672
v_mfma_f32_16x16x32_bf16 v[24:27], v[216:219], v[196:199], v[24:27]
ds_read_b64_tr_b16 v[234:235], v15 offset:29184
ds_read_b64_tr_b16 v[236:237], v16 offset:28672
v_mfma_f32_16x16x32_bf16 v[40:43], v[216:219], v[200:203], v[40:43]
ds_read_b64_tr_b16 v[238:239], v16 offset:29184
v_mfma_f32_16x16x32_bf16 v[28:31], v[220:223], v[196:199], v[28:31]
ds_read_b64_tr_b16 v[240:241], v17 offset:28672
ds_read_b64_tr_b16 v[242:243], v17 offset:29184
v_mfma_f32_16x16x32_bf16 v[44:47], v[220:223], v[200:203], v[44:47]
buffer_load_dwordx4 v[180:183], v12, s[32:35], s57 offen sc1
v_mfma_f32_16x16x32_bf16 v[32:35], v[224:227], v[196:199], v[32:35]
buffer_load_dwordx4 v[184:187], v13, s[32:35], s57 offen sc1
buffer_load_dwordx4 v[188:191], v12, s[32:35], s57 offen offset:1024 sc1
v_mfma_f32_16x16x32_bf16 v[48:51], v[224:227], v[200:203], v[48:51]
buffer_load_dwordx4 v[192:195], v13, s[32:35], s57 offen offset:1024 sc1
s_add_u32 s57, s57, 2048
s_and_b32 s57, s57, 0x7fff
s_waitcnt vmcnt(12) lgkmcnt(0)
v_mfma_f32_16x16x32_bf16 v[20:23], v[228:231], v[204:207], v[20:23]
ds_read_b64_tr_b16 v[212:213], v14 offset:32768
v_mfma_f32_16x16x32_bf16 v[36:39], v[228:231], v[208:211], v[36:39]
ds_read_b64_tr_b16 v[214:215], v14 offset:33280
v_mfma_f32_16x16x32_bf16 v[24:27], v[232:235], v[204:207], v[24:27]
ds_read_b64_tr_b16 v[216:217], v15 offset:32768
v_mfma_f32_16x16x32_bf16 v[40:43], v[232:235], v[208:211], v[40:43]
ds_read_b64_tr_b16 v[218:219], v15 offset:33280
v_mfma_f32_16x16x32_bf16 v[28:31], v[236:239], v[204:207], v[28:31]
ds_read_b64_tr_b16 v[220:221], v16 offset:32768
v_mfma_f32_16x16x32_bf16 v[44:47], v[236:239], v[208:211], v[44:47]
ds_read_b64_tr_b16 v[222:223], v16 offset:33280
v_mfma_f32_16x16x32_bf16 v[32:35], v[240:243], v[204:207], v[32:35]
ds_read_b64_tr_b16 v[224:225], v17 offset:32768
v_mfma_f32_16x16x32_bf16 v[48:51], v[240:243], v[208:211], v[48:51]
ds_read_b64_tr_b16 v[226:227], v17 offset:33280
s_waitcnt vmcnt(10) lgkmcnt(0)
v_mfma_f32_16x16x32_bf16 v[20:23], v[212:215], v[148:151], v[20:23]
ds_read_b64_tr_b16 v[228:229], v14 offset:36864
ds_read_b64_tr_b16 v[230:231], v14 offset:37376
v_mfma_f32_16x16x32_bf16 v[36:39], v[212:215], v[152:155], v[36:39]
ds_read_b64_tr_b16 v[232:233], v15 offset:36864
v_mfma_f32_16x16x32_bf16 v[24:27], v[216:219], v[148:151], v[24:27]
ds_read_b64_tr_b16 v[234:235], v15 offset:37376
ds_read_b64_tr_b16 v[236:237], v16 offset:36864
v_mfma_f32_16x16x32_bf16 v[40:43], v[216:219], v[152:155], v[40:43]
ds_read_b64_tr_b16 v[238:239], v16 offset:37376
v_mfma_f32_16x16x32_bf16 v[28:31], v[220:223], v[148:151], v[28:31]
ds_read_b64_tr_b16 v[240:241], v17 offset:36864
ds_read_b64_tr_b16 v[242:243], v17 offset:37376
v_mfma_f32_16x16x32_bf16 v[44:47], v[220:223], v[152:155], v[44:47]
buffer_load_dwordx4 v[196:199], v12, s[32:35], s57 offen sc1
v_mfma_f32_16x16x32_bf16 v[32:35], v[224:227], v[148:151], v[32:35]
buffer_load_dwordx4 v[200:203], v13, s[32:35], s57 offen sc1
buffer_load_dwordx4 v[204:207], v12, s[32:35], s57 offen offset:1024 sc1
v_mfma_f32_16x16x32_bf16 v[48:51], v[224:227], v[152:155], v[48:51]
buffer_load_dwordx4 v[208:211], v13, s[32:35], s57 offen offset:1024 sc1
s_add_u32 s57, s57, 2048
s_and_b32 s57, s57, 0x7fff
s_waitcnt vmcnt(12) lgkmcnt(0)
v_mfma_f32_16x16x32_bf16 v[20:23], v[228:231], v[156:159], v[20:23]
ds_read_b64_tr_b16 v[212:213], v14 offset:40960
v_mfma_f32_16x16x32_bf16 v[36:39], v[228:231], v[160:163], v[36:39]
ds_read_b64_tr_b16 v[214:215], v14 offset:41472
v_mfma_f32_16x16x32_bf16 v[24:27], v[232:235], v[156:159], v[24:27]
ds_read_b64_tr_b16 v[216:217], v15 offset:40960
v_mfma_f32_16x16x32_bf16 v[40:43], v[232:235], v[160:163], v[40:43]
ds_read_b64_tr_b16 v[218:219], v15 offset:41472
v_mfma_f32_16x16x32_bf16 v[28:31], v[236:239], v[156:159], v[28:31]
ds_read_b64_tr_b16 v[220:221], v16 offset:40960
v_mfma_f32_16x16x32_bf16 v[44:47], v[236:239], v[160:163], v[44:47]
ds_read_b64_tr_b16 v[222:223], v16 offset:41472
v_mfma_f32_16x16x32_bf16 v[32:35], v[240:243], v[156:159], v[32:35]
ds_read_b64_tr_b16 v[224:225], v17 offset:40960
v_mfma_f32_16x16x32_bf16 v[48:51], v[240:243], v[160:163], v[48:51]
ds_read_b64_tr_b16 v[226:227], v17 offset:41472
s_waitcnt vmcnt(10) lgkmcnt(0)
v_mfma_f32_16x16x32_bf16 v[20:23], v[212:215], v[164:167], v[20:23]
ds_read_b64_tr_b16 v[228:229], v14 offset:45056
v_mfma_f32_16x16x32_bf16 v[36:39], v[212:215], v[168:171], v[36:39]
ds_read_b64_tr_b16 v[230:231], v14 offset:45568
v_mfma_f32_16x16x32_bf16 v[24:27], v[216:219], v[164:167], v[24:27]
ds_read_b64_tr_b16 v[232:233], v15 offset:45056
v_mfma_f32_16x16x32_bf16 v[40:43], v[216:219], v[168:171], v[40:43]
ds_read_b64_tr_b16 v[234:235], v15 offset:45568
v_mfma_f32_16x16x32_bf16 v[28:31], v[220:223], v[164:167], v[28:31]
ds_read_b64_tr_b16 v[236:237], v16 offset:45056
v_mfma_f32_16x16x32_bf16 v[44:47], v[220:223], v[168:171], v[44:47]
ds_read_b64_tr_b16 v[238:239], v16 offset:45568
v_mfma_f32_16x16x32_bf16 v[32:35], v[224:227], v[164:167], v[32:35]
ds_read_b64_tr_b16 v[240:241], v17 offset:45056
v_mfma_f32_16x16x32_bf16 v[48:51], v[224:227], v[168:171], v[48:51]
ds_read_b64_tr_b16 v[242:243], v17 offset:45568
s_waitcnt vmcnt(8) lgkmcnt(0)
v_mfma_f32_16x16x32_bf16 v[20:23], v[228:231], v[172:175], v[20:23]
ds_read_b64_tr_b16 v[212:213], v14 offset:49152
v_mfma_f32_16x16x32_bf16 v[36:39], v[228:231], v[176:179], v[36:39]
ds_read_b64_tr_b16 v[214:215], v14 offset:49664
v_mfma_f32_16x16x32_bf16 v[24:27], v[232:235], v[172:175], v[24:27]
ds_read_b64_tr_b16 v[216:217], v15 offset:49152
v_mfma_f32_16x16x32_bf16 v[40:43], v[232:235], v[176:179], v[40:43]
ds_read_b64_tr_b16 v[218:219], v15 offset:49664
v_mfma_f32_16x16x32_bf16 v[28:31], v[236:239], v[172:175], v[28:31]
ds_read_b64_tr_b16 v[220:221], v16 offset:49152
v_mfma_f32_16x16x32_bf16 v[44:47], v[236:239], v[176:179], v[44:47]
ds_read_b64_tr_b16 v[222:223], v16 offset:49664
v_mfma_f32_16x16x32_bf16 v[32:35], v[240:243], v[172:175], v[32:35]
ds_read_b64_tr_b16 v[224:225], v17 offset:49152
v_mfma_f32_16x16x32_bf16 v[48:51], v[240:243], v[176:179], v[48:51]
ds_read_b64_tr_b16 v[226:227], v17 offset:49664
s_waitcnt vmcnt(6) lgkmcnt(0)
v_mfma_f32_16x16x32_bf16 v[20:23], v[212:215], v[180:183], v[20:23]
ds_read_b64_tr_b16 v[228:229], v14 offset:53248
v_mfma_f32_16x16x32_bf16 v[36:39], v[212:215], v[184:187], v[36:39]
ds_read_b64_tr_b16 v[230:231], v14 offset:53760
v_mfma_f32_16x16x32_bf16 v[24:27], v[216:219], v[180:183], v[24:27]
ds_read_b64_tr_b16 v[232:233], v15 offset:53248
v_mfma_f32_16x16x32_bf16 v[40:43], v[216:219], v[184:187], v[40:43]
ds_read_b64_tr_b16 v[234:235], v15 offset:53760
v_mfma_f32_16x16x32_bf16 v[28:31], v[220:223], v[180:183], v[28:31]
ds_read_b64_tr_b16 v[236:237], v16 offset:53248
v_mfma_f32_16x16x32_bf16 v[44:47], v[220:223], v[184:187], v[44:47]
ds_read_b64_tr_b16 v[238:239], v16 offset:53760
v_mfma_f32_16x16x32_bf16 v[32:35], v[224:227], v[180:183], v[32:35]
ds_read_b64_tr_b16 v[240:241], v17 offset:53248
v_mfma_f32_16x16x32_bf16 v[48:51], v[224:227], v[184:187], v[48:51]
ds_read_b64_tr_b16 v[242:243], v17 offset:53760
s_waitcnt vmcnt(4) lgkmcnt(0)
v_mfma_f32_16x16x32_bf16 v[20:23], v[228:231], v[188:191], v[20:23]
ds_read_b64_tr_b16 v[212:213], v14 offset:57344
v_mfma_f32_16x16x32_bf16 v[36:39], v[228:231], v[192:195], v[36:39]
ds_read_b64_tr_b16 v[214:215], v14 offset:57856
v_mfma_f32_16x16x32_bf16 v[24:27], v[232:235], v[188:191], v[24:27]
ds_read_b64_tr_b16 v[216:217], v15 offset:57344
v_mfma_f32_16x16x32_bf16 v[40:43], v[232:235], v[192:195], v[40:43]
ds_read_b64_tr_b16 v[218:219], v15 offset:57856
v_mfma_f32_16x16x32_bf16 v[28:31], v[236:239], v[188:191], v[28:31]
ds_read_b64_tr_b16 v[220:221], v16 offset:57344
v_mfma_f32_16x16x32_bf16 v[44:47], v[236:239], v[192:195], v[44:47]
ds_read_b64_tr_b16 v[222:223], v16 offset:57856
v_mfma_f32_16x16x32_bf16 v[32:35], v[240:243], v[188:191], v[32:35]
ds_read_b64_tr_b16 v[224:225], v17 offset:57344
v_mfma_f32_16x16x32_bf16 v[48:51], v[240:243], v[192:195], v[48:51]
ds_read_b64_tr_b16 v[226:227], v17 offset:57856
s_waitcnt vmcnt(2) lgkmcnt(0)
v_mfma_f32_16x16x32_bf16 v[20:23], v[212:215], v[196:199], v[20:23]
ds_read_b64_tr_b16 v[228:229], v14 offset:61440
v_mfma_f32_16x16x32_bf16 v[36:39], v[212:215], v[200:203], v[36:39]
ds_read_b64_tr_b16 v[230:231], v14 offset:61952
v_mfma_f32_16x16x32_bf16 v[24:27], v[216:219], v[196:199], v[24:27]
ds_read_b64_tr_b16 v[232:233], v15 offset:61440
v_mfma_f32_16x16x32_bf16 v[40:43], v[216:219], v[200:203], v[40:43]
ds_read_b64_tr_b16 v[234:235], v15 offset:61952
v_mfma_f32_16x16x32_bf16 v[28:31], v[220:223], v[196:199], v[28:31]
ds_read_b64_tr_b16 v[236:237], v16 offset:61440
v_mfma_f32_16x16x32_bf16 v[44:47], v[220:223], v[200:203], v[44:47]
ds_read_b64_tr_b16 v[238:239], v16 offset:61952
v_mfma_f32_16x16x32_bf16 v[32:35], v[224:227], v[196:199], v[32:35]
ds_read_b64_tr_b16 v[240:241], v17 offset:61440
v_mfma_f32_16x16x32_bf16 v[48:51], v[224:227], v[200:203], v[48:51]
ds_read_b64_tr_b16 v[242:243], v17 offset:61952
s_waitcnt vmcnt(0) lgkmcnt(0)
s_barrier
v_mfma_f32_16x16x32_bf16 v[20:23], v[228:231], v[204:207], v[20:23]
v_mfma_f32_16x16x32_bf16 v[36:39], v[228:231], v[208:211], v[36:39]
v_mfma_f32_16x16x32_bf16 v[24:27], v[232:235], v[204:207], v[24:27]
v_mfma_f32_16x16x32_bf16 v[40:43], v[232:235], v[208:211], v[40:43]
v_mfma_f32_16x16x32_bf16 v[28:31], v[236:239], v[204:207], v[28:31]
v_mfma_f32_16x16x32_bf16 v[44:47], v[236:239], v[208:211], v[44:47]
v_mfma_f32_16x16x32_bf16 v[32:35], v[240:243], v[204:207], v[32:35]
v_mfma_f32_16x16x32_bf16 v[48:51], v[240:243], v[208:211], v[48:51]
v_permlane16_swap_b32 v88, v90
v_permlane16_swap_b32 v89, v91
v_permlane16_swap_b32 v92, v94
v_permlane16_swap_b32 v93, v95
v_permlane16_swap_b32 v96, v98
v_permlane16_swap_b32 v97, v99
v_permlane16_swap_b32 v100, v102
v_permlane16_swap_b32 v101, v103
s_lshl_b32 s48, s56, 15
s_lshl_b32 s49, s42, 11
s_add_u32 s48, s48, s49
s_add_u32 s49, s48, 32768
s_lshl_b32 s50, s41, 2
s_add_u32 s50, s50, s40
s_lshl_b32 s50, s50, 4
s_add_u32 s50, s50, s42
s_lshl_b32 s50, s50, 8
s_add_u32 s50, s50, 13238272
s_lshl_b32 s52, s41, 2
s_add_u32 s52, s52, s40
s_lshl_b32 s52, s52, 7
s_add_u32 s52, s52, 14163968
v_lshlrev_b32 v19, 2, v0
v_mov_b32 v10, 0x3f803f80
v_mov_b32 v6, 0
v_mov_b32 v7, 0
v_mov_b32 v8, 0
v_mov_b32 v9, 0
s_nop 2
s_cmp_eq_u32 s46, 0
s_cbranch_scc1 slow_7
v_lshlrev_b32 v4, 16, v88
v_and_b32 v5, 0xffff0000, v88
v_pk_add_f32 v[20:21], v[20:21], v[4:5]
v_lshlrev_b32 v4, 16, v89
v_and_b32 v5, 0xffff0000, v89
v_pk_add_f32 v[22:23], v[22:23], v[4:5]
v_lshlrev_b32 v4, 16, v90
v_and_b32 v5, 0xffff0000, v90
v_pk_add_f32 v[24:25], v[24:25], v[4:5]
v_lshlrev_b32 v4, 16, v91
v_and_b32 v5, 0xffff0000, v91
v_pk_add_f32 v[26:27], v[26:27], v[4:5]
v_cvt_pk_bf16_f32 v20, v20, v21
v_cvt_pk_bf16_f32 v21, v22, v23
v_cvt_pk_bf16_f32 v22, v24, v25
v_cvt_pk_bf16_f32 v23, v26, v27
buffer_store_dwordx4 v[20:23], v18, s[32:35], s48 offen offset:0
v_lshlrev_b32 v4, 16, v92
v_and_b32 v5, 0xffff0000, v92
v_pk_add_f32 v[28:29], v[28:29], v[4:5]
v_lshlrev_b32 v4, 16, v93
v_and_b32 v5, 0xffff0000, v93
v_pk_add_f32 v[30:31], v[30:31], v[4:5]
v_lshlrev_b32 v4, 16, v94
v_and_b32 v5, 0xffff0000, v94
v_pk_add_f32 v[32:33], v[32:33], v[4:5]
v_lshlrev_b32 v4, 16, v95
v_and_b32 v5, 0xffff0000, v95
v_pk_add_f32 v[34:35], v[34:35], v[4:5]
v_cvt_pk_bf16_f32 v28, v28, v29
v_cvt_pk_bf16_f32 v29, v30, v31
v_cvt_pk_bf16_f32 v30, v32, v33
v_cvt_pk_bf16_f32 v31, v34, v35
buffer_store_dwordx4 v[28:31], v18, s[32:35], s48 offen offset:1024
v_lshlrev_b32 v4, 16, v96
v_and_b32 v5, 0xffff0000, v96
v_pk_add_f32 v[36:37], v[36:37], v[4:5]
v_lshlrev_b32 v4, 16, v97
v_and_b32 v5, 0xffff0000, v97
v_pk_add_f32 v[38:39], v[38:39], v[4:5]
v_lshlrev_b32 v4, 16, v98
v_and_b32 v5, 0xffff0000, v98
v_pk_add_f32 v[40:41], v[40:41], v[4:5]
v_lshlrev_b32 v4, 16, v99
v_and_b32 v5, 0xffff0000, v99
v_pk_add_f32 v[42:43], v[42:43], v[4:5]
v_cvt_pk_bf16_f32 v36, v36, v37
v_cvt_pk_bf16_f32 v37, v38, v39
v_cvt_pk_bf16_f32 v38, v40, v41
v_cvt_pk_bf16_f32 v39, v42, v43
buffer_store_dwordx4 v[36:39], v18, s[32:35], s49 offen offset:0
v_lshlrev_b32 v4, 16, v100
v_and_b32 v5, 0xffff0000, v100
v_pk_add_f32 v[44:45], v[44:45], v[4:5]
v_lshlrev_b32 v4, 16, v101
v_and_b32 v5, 0xffff0000, v101
v_pk_add_f32 v[46:47], v[46:47], v[4:5]
v_lshlrev_b32 v4, 16, v102
v_and_b32 v5, 0xffff0000, v102
v_pk_add_f32 v[48:49], v[48:49], v[4:5]
v_lshlrev_b32 v4, 16, v103
v_and_b32 v5, 0xffff0000, v103
v_pk_add_f32 v[50:51], v[50:51], v[4:5]
v_cvt_pk_bf16_f32 v44, v44, v45
v_cvt_pk_bf16_f32 v45, v46, v47
v_cvt_pk_bf16_f32 v46, v48, v49
v_cvt_pk_bf16_f32 v47, v50, v51
buffer_store_dwordx4 v[44:47], v18, s[32:35], s49 offen offset:1024
v_dot2c_f32_bf16 v6, v20, v10
v_dot2c_f32_bf16 v8, v20, v20
v_dot2c_f32_bf16 v7, v36, v10
v_dot2c_f32_bf16 v9, v36, v36
v_dot2c_f32_bf16 v6, v21, v10
v_dot2c_f32_bf16 v8, v21, v21
v_dot2c_f32_bf16 v7, v37, v10
v_dot2c_f32_bf16 v9, v37, v37
v_dot2c_f32_bf16 v6, v22, v10
v_dot2c_f32_bf16 v8, v22, v22
v_dot2c_f32_bf16 v7, v38, v10
v_dot2c_f32_bf16 v9, v38, v38
v_dot2c_f32_bf16 v6, v23, v10
v_dot2c_f32_bf16 v8, v23, v23
v_dot2c_f32_bf16 v7, v39, v10
v_dot2c_f32_bf16 v9, v39, v39
v_dot2c_f32_bf16 v6, v28, v10
v_dot2c_f32_bf16 v8, v28, v28
v_dot2c_f32_bf16 v7, v44, v10
v_dot2c_f32_bf16 v9, v44, v44
v_dot2c_f32_bf16 v6, v29, v10
v_dot2c_f32_bf16 v8, v29, v29
v_dot2c_f32_bf16 v7, v45, v10
v_dot2c_f32_bf16 v9, v45, v45
v_dot2c_f32_bf16 v6, v30, v10
v_dot2c_f32_bf16 v8, v30, v30
v_dot2c_f32_bf16 v7, v46, v10
v_dot2c_f32_bf16 v9, v46, v46
v_dot2c_f32_bf16 v6, v31, v10
v_dot2c_f32_bf16 v8, v31, v31
v_dot2c_f32_bf16 v7, v47, v10
v_dot2c_f32_bf16 v9, v47, v47
s_nop 1
s_nop 1
v_permlane32_swap_b32 v6, v7
v_permlane32_swap_b32 v8, v9
s_nop 0
v_add_f32 v6, v6, v7
v_add_f32 v8, v8, v9
s_nop 1
v_permlane16_swap_b32 v6, v8
s_nop 0
v_add_f32 v6, v6, v8
buffer_store_dword v6, v19, s[32:35], s50 offen
s_waitcnt vmcnt(0)
s_lshl_b32 s62, s42, 2
v_mov_b32 v4, s62
v_mov_b32 v5, 1
s_mov_b64 exec, 1
buffer_store_dword v5, v4, s[32:35], s52 offen
s_mov_b64 exec, -1
back_8:
v_mov_b32 v10, v18
v_add_u32 v11, 1024, v18
s_lshl_b32 s48, s43, 1
v_lshrrev_b32 v4, 2, v2
v_and_b32 v5, 3, v0
v_lshl_add_u32 v6, v3, 3, v4
v_lshlrev_b32 v6, 7, v6
v_lshl_add_u32 v6, v5, 3, v6
v_lshrrev_b32 v7, 1, v4
v_and_b32 v8, 1, v3
v_lshl_add_u32 v7, v8, 1, v7
v_xor_b32 v7, s48, v7
v_lshl_add_u32 v12, v7, 5, v6
v_add_u32 v12, 18432, v12
v_xor_b32 v13, 32, v12
v_mov_b32 v14, v10
v_mov_b32 v15, v11
v_mov_b32 v16, v12
v_mov_b32 v17, v13
v_mov_b32 v148, 0
v_mov_b32 v149, 0
v_mov_b32 v150, 0
v_mov_b32 v151, 0
v_mov_b32 v152, 0
v_mov_b32 v153, 0
v_mov_b32 v154, 0
v_mov_b32 v155, 0
v_mov_b32 v156, 0
v_mov_b32 v157, 0
v_mov_b32 v158, 0
v_mov_b32 v159, 0
v_mov_b32 v160, 0
v_mov_b32 v161, 0
v_mov_b32 v162, 0
v_mov_b32 v163, 0
v_mov_b32 v164, 0
v_mov_b32 v165, 0
v_mov_b32 v166, 0
v_mov_b32 v167, 0
v_mov_b32 v168, 0
v_mov_b32 v169, 0
v_mov_b32 v170, 0
v_mov_b32 v171, 0
v_mov_b32 v172, 0
v_mov_b32 v173, 0
v_mov_b32 v174, 0
v_mov_b32 v175, 0
v_mov_b32 v176, 0
v_mov_b32 v177, 0
v_mov_b32 v178, 0
v_mov_b32 v179, 0
v_mov_b32 v180, 0
v_mov_b32 v181, 0
v_mov_b32 v182, 0
v_mov_b32 v183, 0
v_mov_b32 v184, 0
v_mov_b32 v185, 0
v_mov_b32 v186, 0
v_mov_b32 v187, 0
v_mov_b32 v188, 0
v_mov_b32 v189, 0
v_mov_b32 v190, 0
v_mov_b32 v191, 0
v_mov_b32 v192, 0
v_mov_b32 v193, 0
v_mov_b32 v194, 0
v_mov_b32 v195, 0
v_mov_b32 v196, 0
v_mov_b32 v197, 0
v_mov_b32 v198, 0
v_mov_b32 v199, 0
v_mov_b32 v200, 0
v_mov_b32 v201, 0
v_mov_b32 v202, 0
v_mov_b32 v203, 0
v_mov_b32 v204, 0
v_mov_b32 v205, 0
v_mov_b32 v206, 0
v_mov_b32 v207, 0
v_mov_b32 v208, 0
v_mov_b32 v209, 0
v_mov_b32 v210, 0
v_mov_b32 v211, 0
v_mov_b32 v212, 0
v_mov_b32 v213, 0
v_mov_b32 v214, 0
v_mov_b32 v215, 0
v_mov_b32 v216, 0
v_mov_b32 v217, 0
v_mov_b32 v218, 0
v_mov_b32 v219, 0
v_mov_b32 v220, 0
v_mov_b32 v221, 0
v_mov_b32 v222, 0
v_mov_b32 v223, 0
v_mov_b32 v224, 0
v_mov_b32 v225, 0
v_mov_b32 v226, 0
v_mov_b32 v227, 0
v_mov_b32 v228, 0
v_mov_b32 v229, 0
v_mov_b32 v230, 0
v_mov_b32 v231, 0
v_mov_b32 v232, 0
v_mov_b32 v233, 0
v_mov_b32 v234, 0
v_mov_b32 v235, 0
v_mov_b32 v236, 0
v_mov_b32 v237, 0
v_mov_b32 v238, 0
v_mov_b32 v239, 0
v_mov_b32 v240, 0
v_mov_b32 v241, 0
v_mov_b32 v242, 0
v_mov_b32 v243, 0
s_mov_b32 s64, 0
s_mov_b32 s65, 0
s_barrier
s_lshl_b32 s48, s44, 13
v_add_u32 v10, s48, v10
v_add_u32 v11, s48, v11
v_add_u32 v14, s48, v14
v_add_u32 v15, s48, v15
ds_read_b128 v[60:63], v14 offset:2048
ds_read_b128 v[64:67], v14 offset:4096
ds_read_b128 v[68:71], v14 offset:6144
ds_read_b128 v[72:75], v14 offset:8192
ds_read_b64_tr_b16 v[80:81], v16 offset:0
ds_read_b64_tr_b16 v[82:83], v16 offset:512
ds_read_b64_tr_b16 v[84:85], v17 offset:0
ds_read_b64_tr_b16 v[86:87], v17 offset:512
ds_read_b64_tr_b16 v[88:89], v16 offset:8192
ds_read_b64_tr_b16 v[90:91], v16 offset:8704
ds_read_b64_tr_b16 v[92:93], v17 offset:8192
ds_read_b64_tr_b16 v[94:95], v17 offset:8704
ds_read_b64_tr_b16 v[96:97], v16 offset:16384
ds_read_b64_tr_b16 v[98:99], v16 offset:16896
ds_read_b64_tr_b16 v[100:101], v17 offset:16384
ds_read_b64_tr_b16 v[102:103], v17 offset:16896
c1_loop0:
s_add_u32 s65, s65, 43008
s_cmp_eq_u32 s65, 129024
s_cselect_b32 s65, 0, s65
s_waitcnt lgkmcnt(0)
v_mfma_f32_16x16x32_bf16 v[204:207], v[88:91], v[72:75], v[204:207]
ds_read_b128 v[104:107], v15 offset:2048
v_mfma_f32_16x16x32_bf16 v[196:199], v[88:91], v[68:71], v[196:199]
ds_read_b128 v[108:111], v15 offset:4096
v_mfma_f32_16x16x32_bf16 v[188:191], v[88:91], v[64:67], v[188:191]
ds_read_b128 v[112:115], v15 offset:6144
v_mfma_f32_16x16x32_bf16 v[180:183], v[88:91], v[60:63], v[180:183]
ds_read_b128 v[116:119], v15 offset:8192
v_mfma_f32_16x16x32_bf16 v[184:187], v[92:95], v[60:63], v[184:187]
ds_read_b64_tr_b16 v[124:125], v16 offset:4096
v_mfma_f32_16x16x32_bf16 v[192:195], v[92:95], v[64:67], v[192:195]
ds_read_b64_tr_b16 v[126:127], v16 offset:4608
v_mfma_f32_16x16x32_bf16 v[200:203], v[92:95], v[68:71], v[200:203]
ds_read_b64_tr_b16 v[128:129], v17 offset:4096
v_mfma_f32_16x16x32_bf16 v[208:211], v[92:95], v[72:75], v[208:211]
ds_read_b64_tr_b16 v[130:131], v17 offset:4608
v_mfma_f32_16x16x32_bf16 v[236:239], v[72:75], v[96:99], v[236:239]
ds_read_b64_tr_b16 v[132:133], v16 offset:12288
v_mfma_f32_16x16x32_bf16 v[228:231], v[68:71], v[96:99], v[228:231]
ds_read_b64_tr_b16 v[134:135], v16 offset:12800
v_mfma_f32_16x16x32_bf16 v[220:223], v[64:67], v[96:99], v[220:223]
ds_read_b64_tr_b16 v[136:137], v17 offset:12288
v_mfma_f32_16x16x32_bf16 v[212:215], v[60:63], v[96:99], v[212:215]
ds_read_b64_tr_b16 v[138:139], v17 offset:12800
v_mfma_f32_16x16x32_bf16 v[216:219], v[60:63], v[100:103], v[216:219]
ds_read_b64_tr_b16 v[140:141], v16 offset:20480
v_mfma_f32_16x16x32_bf16 v[224:227], v[64:67], v[100:103], v[224:227]
ds_read_b64_tr_b16 v[142:143], v16 offset:20992
v_mfma_f32_16x16x32_bf16 v[232:235], v[68:71], v[100:103], v[232:235]
ds_read_b64_tr_b16 v[144:145], v17 offset:20480
v_mfma_f32_16x16x32_bf16 v[240:243], v[72:75], v[100:103], v[240:243]
ds_read_b64_tr_b16 v[146:147], v17 offset:20992
v_mfma_f32_16x16x32_bf16 v[172:175], v[80:83], v[72:75], v[172:175]
v_mfma_f32_16x16x32_bf16 v[164:167], v[80:83], v[68:71], v[164:167]
v_mfma_f32_16x16x32_bf16 v[156:159], v[80:83], v[64:67], v[156:159]
v_mfma_f32_16x16x32_bf16 v[148:151], v[80:83], v[60:63], v[148:151]
v_mfma_f32_16x16x32_bf16 v[152:155], v[84:87], v[60:63], v[152:155]
v_mfma_f32_16x16x32_bf16 v[160:163], v[84:87], v[64:67], v[160:163]
v_mfma_f32_16x16x32_bf16 v[168:171], v[84:87], v[68:71], v[168:171]
v_mfma_f32_16x16x32_bf16 v[176:179], v[84:87], v[72:75], v[176:179]
s_waitcnt lgkmcnt(0)
s_barrier
v_mfma_f32_16x16x32_bf16 v[204:207], v[132:135], v[116:119], v[204:207]
v_add_u32 v14, s65, v10
v_mfma_f32_16x16x32_bf16 v[196:199], v[132:135], v[112:115], v[196:199]
v_add_u32 v16, s65, v12
v_add_u32 v17, s65, v13
v_mfma_f32_16x16x32_bf16 v[188:191], v[132:135], v[108:111], v[188:191]
ds_read_b128 v[60:63], v14 offset:2048
v_mfma_f32_16x16x32_bf16 v[180:183], v[132:135], v[104:107], v[180:183]
ds_read_b128 v[64:67], v14 offset:4096
v_mfma_f32_16x16x32_bf16 v[184:187], v[136:139], v[104:107], v[184:187]
ds_read_b128 v[68:71], v14 offset:6144
v_mfma_f32_16x16x32_bf16 v[192:195], v[136:139], v[108:111], v[192:195]
ds_read_b128 v[72:75], v14 offset:8192
v_mfma_f32_16x16x32_bf16 v[200:203], v[136:139], v[112:115], v[200:203]
ds_read_b64_tr_b16 v[80:81], v16 offset:0
v_mfma_f32_16x16x32_bf16 v[208:211], v[136:139], v[116:119], v[208:211]
ds_read_b64_tr_b16 v[82:83], v16 offset:512
v_mfma_f32_16x16x32_bf16 v[236:239], v[116:119], v[140:143], v[236:239]
ds_read_b64_tr_b16 v[84:85], v17 offset:0
v_mfma_f32_16x16x32_bf16 v[228:231], v[112:115], v[140:143], v[228:231]
ds_read_b64_tr_b16 v[86:87], v17 offset:512
v_mfma_f32_16x16x32_bf16 v[220:223], v[108:111], v[140:143], v[220:223]
ds_read_b64_tr_b16 v[88:89], v16 offset:8192
v_mfma_f32_16x16x32_bf16 v[212:215], v[104:107], v[140:143], v[212:215]
ds_read_b64_tr_b16 v[90:91], v16 offset:8704
v_mfma_f32_16x16x32_bf16 v[216:219], v[104:107], v[144:147], v[216:219]
ds_read_b64_tr_b16 v[92:93], v17 offset:8192
v_mfma_f32_16x16x32_bf16 v[224:227], v[108:111], v[144:147], v[224:227]
ds_read_b64_tr_b16 v[94:95], v17 offset:8704
v_mfma_f32_16x16x32_bf16 v[232:235], v[112:115], v[144:147], v[232:235]
ds_read_b64_tr_b16 v[96:97], v16 offset:16384
v_mfma_f32_16x16x32_bf16 v[240:243], v[116:119], v[144:147], v[240:243]
ds_read_b64_tr_b16 v[98:99], v16 offset:16896
v_mfma_f32_16x16x32_bf16 v[172:175], v[124:127], v[116:119], v[172:175]
ds_read_b64_tr_b16 v[100:101], v17 offset:16384
v_mfma_f32_16x16x32_bf16 v[164:167], v[124:127], v[112:115], v[164:167]
ds_read_b64_tr_b16 v[102:103], v17 offset:16896
v_mfma_f32_16x16x32_bf16 v[156:159], v[124:127], v[108:111], v[156:159]
v_add_u32 v15, s65, v11
v_mfma_f32_16x16x32_bf16 v[148:151], v[124:127], v[104:107], v[148:151]
s_add_u32 s64, s64, 1
v_mfma_f32_16x16x32_bf16 v[152:155], v[128:131], v[104:107], v[152:155]
s_cmp_lt_u32 s64, 16
v_mfma_f32_16x16x32_bf16 v[160:163], v[128:131], v[108:111], v[160:163]
v_mfma_f32_16x16x32_bf16 v[168:171], v[128:131], v[112:115], v[168:171]
v_mfma_f32_16x16x32_bf16 v[176:179], v[128:131], v[116:119], v[176:179]
s_cbranch_scc1 c1_loop0
c1_epi:
s_waitcnt lgkmcnt(0)
s_lshl_b32 s48, s43, 7
s_add_u32 s48, s48, 134144
v_lshl_add_u32 v6, v3, 4, s48
v_lshl_add_u32 v7, v2, 2, s48
s_lshl_b32 s49, s44, 6
v_add_u32 v8, s49, v2
v_lshlrev_b32 v8, 3, v8
v_add_u32 v8, 131072, v8
v_lshl_add_u32 v9, v3, 2, s49
v_lshlrev_b32 v9, 2, v9
v_add_u32 v9, 132224, v9
s_waitcnt lgkmcnt(0)
s_barrier
ds_read_b128 v[68:71], v6 offset:256
ds_read_b128 v[72:75], v6 offset:320
ds_read_b128 v[128:131], v6 offset:0
ds_read_b128 v[132:135], v6 offset:64
ds_read_b64 v[138:139], v8 offset:128
ds_read_b64 v[140:141], v8 offset:256
ds_read_b64 v[142:143], v8 offset:384
ds_read_b64 v[144:145], v8 offset:512
ds_read_b32 v76, v7 offset:512
ds_read_b32 v77, v7 offset:576
ds_read_b128 v[92:95], v9 offset:64
ds_read_b128 v[112:115], v9 offset:640
ds_read_b128 v[96:99], v9 offset:128
ds_read_b128 v[116:119], v9 offset:704
ds_read_b128 v[100:103], v9 offset:192
ds_read_b128 v[120:123], v9 offset:768
ds_read_b128 v[104:107], v9 offset:256
ds_read_b128 v[124:127], v9 offset:832
v_lshrrev_b32 v4, 2, v2
v_lshl_add_u32 v4, v3, 2, v4
v_lshlrev_b32 v4, 6, v4
v_and_b32 v5, 3, v0
v_lshl_add_u32 v4, v5, 3, v4
s_lshl_b32 s48, s43, 11
s_add_u32 s48, s48, 135168
v_add_u32 v4, s48, v4
ds_read_b64_tr_b16 v[40:41], v4 offset:0
ds_read_b64_tr_b16 v[42:43], v4 offset:1024
ds_read_b64_tr_b16 v[44:45], v4 offset:32
ds_read_b64_tr_b16 v[46:47], v4 offset:1056
s_waitcnt lgkmcnt(14)
v_pk_fma_f32 v[180:181], v[68:69], v[138:139], v[180:181] op_sel:[0,1,0] op_sel_hi:[1,1,1]
v_pk_fma_f32 v[182:183], v[70:71], v[138:139], v[182:183] op_sel:[0,1,0] op_sel_hi:[1,1,1]
v_pk_fma_f32 v[184:185], v[72:73], v[138:139], v[184:185] op_sel:[0,1,0] op_sel_hi:[1,1,1]
v_pk_fma_f32 v[186:187], v[74:75], v[138:139], v[186:187] op_sel:[0,1,0] op_sel_hi:[1,1,1]
v_pk_mul_f32 v[180:181], v[180:181], v[138:139] op_sel:[0,0] op_sel_hi:[1,0]
v_pk_mul_f32 v[182:183], v[182:183], v[138:139] op_sel:[0,0] op_sel_hi:[1,0]
v_pk_mul_f32 v[184:185], v[184:185], v[138:139] op_sel:[0,0] op_sel_hi:[1,0]
v_pk_mul_f32 v[186:187], v[186:187], v[138:139] op_sel:[0,0] op_sel_hi:[1,0]
v_cvt_pk_bf16_f32 v180, v180, v181
v_cvt_pk_bf16_f32 v181, v182, v183
v_cvt_pk_bf16_f32 v182, v184, v185
v_cvt_pk_bf16_f32 v183, v186, v187
v_pk_fma_f32 v[188:189], v[68:69], v[140:141], v[188:189] op_sel:[0,1,0] op_sel_hi:[1,1,1]
v_pk_fma_f32 v[190:191], v[70:71], v[140:141], v[190:191] op_sel:[0,1,0] op_sel_hi:[1,1,1]
v_pk_fma_f32 v[192:193], v[72:73], v[140:141], v[192:193] op_sel:[0,1,0] op_sel_hi:[1,1,1]
v_pk_fma_f32 v[194:195], v[74:75], v[140:141], v[194:195] op_sel:[0,1,0] op_sel_hi:[1,1,1]
v_pk_mul_f32 v[188:189], v[188:189], v[140:141] op_sel:[0,0] op_sel_hi:[1,0]
v_pk_mul_f32 v[190:191], v[190:191], v[140:141] op_sel:[0,0] op_sel_hi:[1,0]
v_pk_mul_f32 v[192:193], v[192:193], v[140:141] op_sel:[0,0] op_sel_hi:[1,0]
v_pk_mul_f32 v[194:195], v[194:195], v[140:141] op_sel:[0,0] op_sel_hi:[1,0]
v_cvt_pk_bf16_f32 v188, v188, v189
v_cvt_pk_bf16_f32 v189, v190, v191
v_cvt_pk_bf16_f32 v190, v192, v193
v_cvt_pk_bf16_f32 v191, v194, v195
v_pk_fma_f32 v[196:197], v[68:69], v[142:143], v[196:197] op_sel:[0,1,0] op_sel_hi:[1,1,1]
v_pk_fma_f32 v[198:199], v[70:71], v[142:143], v[198:199] op_sel:[0,1,0] op_sel_hi:[1,1,1]
v_pk_fma_f32 v[200:201], v[72:73], v[142:143], v[200:201] op_sel:[0,1,0] op_sel_hi:[1,1,1]
v_pk_fma_f32 v[202:203], v[74:75], v[142:143], v[202:203] op_sel:[0,1,0] op_sel_hi:[1,1,1]
v_pk_mul_f32 v[196:197], v[196:197], v[142:143] op_sel:[0,0] op_sel_hi:[1,0]
v_pk_mul_f32 v[198:199], v[198:199], v[142:143] op_sel:[0,0] op_sel_hi:[1,0]
v_pk_mul_f32 v[200:201], v[200:201], v[142:143] op_sel:[0,0] op_sel_hi:[1,0]
v_pk_mul_f32 v[202:203], v[202:203], v[142:143] op_sel:[0,0] op_sel_hi:[1,0]
v_cvt_pk_bf16_f32 v196, v196, v197
v_cvt_pk_bf16_f32 v197, v198, v199
v_cvt_pk_bf16_f32 v198, v200, v201
v_cvt_pk_bf16_f32 v199, v202, v203
v_pk_fma_f32 v[204:205], v[68:69], v[144:145], v[204:205] op_sel:[0,1,0] op_sel_hi:[1,1,1]
v_pk_fma_f32 v[206:207], v[70:71], v[144:145], v[206:207] op_sel:[0,1,0] op_sel_hi:[1,1,1]
v_pk_fma_f32 v[208:209], v[72:73], v[144:145], v[208:209] op_sel:[0,1,0] op_sel_hi:[1,1,1]
v_pk_fma_f32 v[210:211], v[74:75], v[144:145], v[210:211] op_sel:[0,1,0] op_sel_hi:[1,1,1]
v_pk_mul_f32 v[204:205], v[204:205], v[144:145] op_sel:[0,0] op_sel_hi:[1,0]
v_pk_mul_f32 v[206:207], v[206:207], v[144:145] op_sel:[0,0] op_sel_hi:[1,0]
v_pk_mul_f32 v[208:209], v[208:209], v[144:145] op_sel:[0,0] op_sel_hi:[1,0]
v_pk_mul_f32 v[210:211], v[210:211], v[144:145] op_sel:[0,0] op_sel_hi:[1,0]
v_cvt_pk_bf16_f32 v204, v204, v205
v_cvt_pk_bf16_f32 v205, v206, v207
v_cvt_pk_bf16_f32 v206, v208, v209
v_cvt_pk_bf16_f32 v207, v210, v211
s_waitcnt lgkmcnt(0)
v_pk_fma_f32 v[212:213], v[112:113], v[76:77], v[212:213] op_sel:[0,0,0] op_sel_hi:[1,0,1]
v_pk_fma_f32 v[214:215], v[114:115], v[76:77], v[214:215] op_sel:[0,0,0] op_sel_hi:[1,0,1]
v_pk_mul_f32 v[212:213], v[212:213], v[92:93]
v_pk_mul_f32 v[214:215], v[214:215], v[94:95]
v_cvt_pk_bf16_f32 v22, v212, v213
v_cvt_pk_bf16_f32 v23, v214, v215
v_pk_fma_f32 v[220:221], v[116:117], v[76:77], v[220:221] op_sel:[0,0,0] op_sel_hi:[1,0,1]
v_pk_fma_f32 v[222:223], v[118:119], v[76:77], v[222:223] op_sel:[0,0,0] op_sel_hi:[1,0,1]
v_pk_mul_f32 v[220:221], v[220:221], v[96:97]
v_pk_mul_f32 v[222:223], v[222:223], v[98:99]
v_cvt_pk_bf16_f32 v24, v220, v221
v_cvt_pk_bf16_f32 v25, v222, v223
v_pk_fma_f32 v[228:229], v[120:121], v[76:77], v[228:229] op_sel:[0,0,0] op_sel_hi:[1,0,1]
v_pk_fma_f32 v[230:231], v[122:123], v[76:77], v[230:231] op_sel:[0,0,0] op_sel_hi:[1,0,1]
v_pk_mul_f32 v[228:229], v[228:229], v[100:101]
v_pk_mul_f32 v[230:231], v[230:231], v[102:103]
v_cvt_pk_bf16_f32 v26, v228, v229
v_cvt_pk_bf16_f32 v27, v230, v231
v_pk_fma_f32 v[236:237], v[124:125], v[76:77], v[236:237] op_sel:[0,0,0] op_sel_hi:[1,0,1]
v_pk_fma_f32 v[238:239], v[126:127], v[76:77], v[238:239] op_sel:[0,0,0] op_sel_hi:[1,0,1]
v_pk_mul_f32 v[236:237], v[236:237], v[104:105]
v_pk_mul_f32 v[238:239], v[238:239], v[106:107]
v_cvt_pk_bf16_f32 v28, v236, v237
v_cvt_pk_bf16_f32 v29, v238, v239
v_pk_fma_f32 v[216:217], v[112:113], v[76:77], v[216:217] op_sel:[0,1,0] op_sel_hi:[1,1,1]
v_pk_fma_f32 v[218:219], v[114:115], v[76:77], v[218:219] op_sel:[0,1,0] op_sel_hi:[1,1,1]
v_pk_mul_f32 v[216:217], v[216:217], v[92:93]
v_pk_mul_f32 v[218:219], v[218:219], v[94:95]
v_cvt_pk_bf16_f32 v32, v216, v217
v_cvt_pk_bf16_f32 v33, v218, v219
v_pk_fma_f32 v[224:225], v[116:117], v[76:77], v[224:225] op_sel:[0,1,0] op_sel_hi:[1,1,1]
v_pk_fma_f32 v[226:227], v[118:119], v[76:77], v[226:227] op_sel:[0,1,0] op_sel_hi:[1,1,1]
v_pk_mul_f32 v[224:225], v[224:225], v[96:97]
v_pk_mul_f32 v[226:227], v[226:227], v[98:99]
v_cvt_pk_bf16_f32 v34, v224, v225
v_cvt_pk_bf16_f32 v35, v226, v227
v_pk_fma_f32 v[232:233], v[120:121], v[76:77], v[232:233] op_sel:[0,1,0] op_sel_hi:[1,1,1]
v_pk_fma_f32 v[234:235], v[122:123], v[76:77], v[234:235] op_sel:[0,1,0] op_sel_hi:[1,1,1]
v_pk_mul_f32 v[232:233], v[232:233], v[100:101]
v_pk_mul_f32 v[234:235], v[234:235], v[102:103]
v_cvt_pk_bf16_f32 v36, v232, v233
v_cvt_pk_bf16_f32 v37, v234, v235
v_pk_fma_f32 v[240:241], v[124:125], v[76:77], v[240:241] op_sel:[0,1,0] op_sel_hi:[1,1,1]
v_pk_fma_f32 v[242:243], v[126:127], v[76:77], v[242:243] op_sel:[0,1,0] op_sel_hi:[1,1,1]
v_pk_mul_f32 v[240:241], v[240:241], v[104:105]
v_pk_mul_f32 v[242:243], v[242:243], v[106:107]
v_cvt_pk_bf16_f32 v38, v240, v241
v_cvt_pk_bf16_f32 v39, v242, v243
s_mov_b32 s66, 0x3fb8aa3b
s_lshl_b32 s48, s40, 12
s_add_u32 s48, s48, 139264
v_add_u32 v5, s48, v18
ds_write_b128 v5, v[22:25] offset:0
ds_write_b128 v5, v[26:29] offset:1024
ds_write_b128 v5, v[32:35] offset:2048
ds_write_b128 v5, v[36:39] offset:3072
v_mfma_f32_16x16x32_bf16 v[60:63], v[40:43], v[180:183], 0
v_mfma_f32_16x16x32_bf16 v[64:67], v[44:47], v[180:183], 0
v_mfma_f32_16x16x32_bf16 v[68:71], v[40:43], v[188:191], 0
v_mfma_f32_16x16x32_bf16 v[72:75], v[44:47], v[188:191], 0
v_mfma_f32_16x16x32_bf16 v[76:79], v[40:43], v[196:199], 0
v_mfma_f32_16x16x32_bf16 v[80:83], v[44:47], v[196:199], 0
v_mfma_f32_16x16x32_bf16 v[84:87], v[40:43], v[204:207], 0
v_mfma_f32_16x16x32_bf16 v[88:91], v[44:47], v[204:207], 0
s_nop 4
v_max3_f32 v48, v60, v61, v62
v_min3_f32 v52, v60, v61, v62
v_max3_f32 v48, v48, v63, v64
v_min3_f32 v52, v52, v63, v64
v_max3_f32 v48, v48, v65, v66
v_min3_f32 v52, v52, v65, v66
v_max_f32 v48, v48, v67
v_min_f32 v52, v52, v67
v_max3_f32 v49, v68, v69, v70
v_min3_f32 v53, v68, v69, v70
v_max3_f32 v49, v49, v71, v72
v_min3_f32 v53, v53, v71, v72
v_max3_f32 v49, v49, v73, v74
v_min3_f32 v53, v53, v73, v74
v_max_f32 v49, v49, v75
v_min_f32 v53, v53, v75
v_max3_f32 v50, v76, v77, v78
v_min3_f32 v54, v76, v77, v78
v_max3_f32 v50, v50, v79, v80
v_min3_f32 v54, v54, v79, v80
v_max3_f32 v50, v50, v81, v82
v_min3_f32 v54, v54, v81, v82
v_max_f32 v50, v50, v83
v_min_f32 v54, v54, v83
v_max3_f32 v51, v84, v85, v86
v_min3_f32 v55, v84, v85, v86
v_max3_f32 v51, v51, v87, v88
v_min3_f32 v55, v55, v87, v88
v_max3_f32 v51, v51, v89, v90
v_min3_f32 v55, v55, v89, v90
v_max_f32 v51, v51, v91
v_min_f32 v55, v55, v91
s_nop 1
v_permlane32_swap_b32 v48, v49
v_permlane32_swap_b32 v50, v51
s_nop 0
v_max_f32 v48, v48, v49
v_max_f32 v50, v50, v51
s_nop 1
v_permlane16_swap_b32 v48, v50
s_nop 0
v_max_f32 v48, v48, v50
v_mul_f32 v48, s66, v48
v_mov_b32 v50, v48
s_nop 1
v_permlane16_swap_b32 v48, v50
s_nop 0
v_mov_b32 v49, v48
v_mov_b32 v51, v50
s_nop 1
v_permlane32_swap_b32 v48, v49
v_permlane32_swap_b32 v50, v51
s_nop 0
s_nop 1
v_permlane32_swap_b32 v52, v53
v_permlane32_swap_b32 v54, v55
s_nop 0
v_min_f32 v52, v52, v53
v_min_f32 v54, v54, v55
s_nop 1
v_permlane16_swap_b32 v52, v54
s_nop 0
v_min_f32 v52, v52, v54
v_mul_f32 v52, s66, v52
v_mov_b32 v54, v52
s_nop 1
v_permlane16_swap_b32 v52, v54
s_nop 0
v_mov_b32 v53, v52
v_mov_b32 v55, v54
s_nop 1
v_permlane32_swap_b32 v52, v53
v_permlane32_swap_b32 v54, v55
s_nop 0
v_fma_f32 v92, -v60, s66, v52
v_fma_f32 v60, v60, s66, -v48
v_fma_f32 v93, -v61, s66, v52
v_fma_f32 v61, v61, s66, -v48
v_fma_f32 v94, -v62, s66, v52
v_fma_f32 v62, v62, s66, -v48
v_fma_f32 v95, -v63, s66, v52
v_fma_f32 v63, v63, s66, -v48
v_fma_f32 v96, -v64, s66, v52
v_fma_f32 v64, v64, s66, -v48
v_fma_f32 v97, -v65, s66, v52
v_fma_f32 v65, v65, s66, -v48
v_fma_f32 v98, -v66, s66, v52
v_fma_f32 v66, v66, s66, -v48
v_fma_f32 v99, -v67, s66, v52
v_fma_f32 v67, v67, s66, -v48
v_exp_f32 v92, v92
v_exp_f32 v60, v60
v_exp_f32 v93, v93
v_exp_f32 v61, v61
v_exp_f32 v94, v94
v_exp_f32 v62, v62
v_exp_f32 v95, v95
v_exp_f32 v63, v63
v_exp_f32 v96, v96
v_exp_f32 v64, v64
v_exp_f32 v97, v97
v_exp_f32 v65, v65
v_exp_f32 v98, v98
v_exp_f32 v66, v66
v_exp_f32 v99, v99
v_exp_f32 v67, v67
v_fma_f32 v100, -v68, s66, v53
v_fma_f32 v68, v68, s66, -v49
v_fma_f32 v101, -v69, s66, v53
v_fma_f32 v69, v69, s66, -v49
v_fma_f32 v102, -v70, s66, v53
v_fma_f32 v70, v70, s66, -v49
v_fma_f32 v103, -v71, s66, v53
v_fma_f32 v71, v71, s66, -v49
v_fma_f32 v104, -v72, s66, v53
v_fma_f32 v72, v72, s66, -v49
v_fma_f32 v105, -v73, s66, v53
v_fma_f32 v73, v73, s66, -v49
v_fma_f32 v106, -v74, s66, v53
v_fma_f32 v74, v74, s66, -v49
v_fma_f32 v107, -v75, s66, v53
v_fma_f32 v75, v75, s66, -v49
v_exp_f32 v100, v100
v_exp_f32 v68, v68
v_exp_f32 v101, v101
v_exp_f32 v69, v69
v_exp_f32 v102, v102
v_exp_f32 v70, v70
v_exp_f32 v103, v103
v_exp_f32 v71, v71
v_exp_f32 v104, v104
v_exp_f32 v72, v72
v_exp_f32 v105, v105
v_exp_f32 v73, v73
v_exp_f32 v106, v106
v_exp_f32 v74, v74
v_exp_f32 v107, v107
v_exp_f32 v75, v75
v_fma_f32 v108, -v76, s66, v54
v_fma_f32 v76, v76, s66, -v50
v_fma_f32 v109, -v77, s66, v54
v_fma_f32 v77, v77, s66, -v50
v_fma_f32 v110, -v78, s66, v54
v_fma_f32 v78, v78, s66, -v50
v_fma_f32 v111, -v79, s66, v54
v_fma_f32 v79, v79, s66, -v50
v_fma_f32 v112, -v80, s66, v54
v_fma_f32 v80, v80, s66, -v50
v_fma_f32 v113, -v81, s66, v54
v_fma_f32 v81, v81, s66, -v50
v_fma_f32 v114, -v82, s66, v54
v_fma_f32 v82, v82, s66, -v50
v_fma_f32 v115, -v83, s66, v54
v_fma_f32 v83, v83, s66, -v50
v_exp_f32 v108, v108
v_exp_f32 v76, v76
v_exp_f32 v109, v109
v_exp_f32 v77, v77
v_exp_f32 v110, v110
v_exp_f32 v78, v78
v_exp_f32 v111, v111
v_exp_f32 v79, v79
v_exp_f32 v112, v112
v_exp_f32 v80, v80
v_exp_f32 v113, v113
v_exp_f32 v81, v81
v_exp_f32 v114, v114
v_exp_f32 v82, v82
v_exp_f32 v115, v115
v_exp_f32 v83, v83
v_fma_f32 v116, -v84, s66, v55
v_fma_f32 v84, v84, s66, -v51
v_fma_f32 v117, -v85, s66, v55
v_fma_f32 v85, v85, s66, -v51
v_fma_f32 v118, -v86, s66, v55
v_fma_f32 v86, v86, s66, -v51
v_fma_f32 v119, -v87, s66, v55
v_fma_f32 v87, v87, s66, -v51
v_fma_f32 v120, -v88, s66, v55
v_fma_f32 v88, v88, s66, -v51
v_fma_f32 v121, -v89, s66, v55
v_fma_f32 v89, v89, s66, -v51
v_fma_f32 v122, -v90, s66, v55
v_fma_f32 v90, v90, s66, -v51
v_fma_f32 v123, -v91, s66, v55
v_fma_f32 v91, v91, s66, -v51
v_exp_f32 v116, v116
v_exp_f32 v84, v84
v_exp_f32 v117, v117
v_exp_f32 v85, v85
v_exp_f32 v118, v118
v_exp_f32 v86, v86
v_exp_f32 v119, v119
v_exp_f32 v87, v87
v_exp_f32 v120, v120
v_exp_f32 v88, v88
v_exp_f32 v121, v121
v_exp_f32 v89, v89
v_exp_f32 v122, v122
v_exp_f32 v90, v90
v_exp_f32 v123, v123
v_exp_f32 v91, v91
s_nop 0
v_add_f32 v48, v60, v61
v_add_f32 v52, v92, v93
v_add_f32 v48, v48, v62
v_add_f32 v52, v52, v94
v_add_f32 v48, v48, v63
v_add_f32 v52, v52, v95
v_add_f32 v48, v48, v64
v_add_f32 v52, v52, v96
v_add_f32 v48, v48, v65
v_add_f32 v52, v52, v97
v_add_f32 v48, v48, v66
v_add_f32 v52, v52, v98
v_add_f32 v48, v48, v67
v_add_f32 v52, v52, v99
v_add_f32 v49, v68, v69
v_add_f32 v53, v100, v101
v_add_f32 v49, v49, v70
v_add_f32 v53, v53, v102
v_add_f32 v49, v49, v71
v_add_f32 v53, v53, v103
v_add_f32 v49, v49, v72
v_add_f32 v53, v53, v104
v_add_f32 v49, v49, v73
v_add_f32 v53, v53, v105
v_add_f32 v49, v49, v74
v_add_f32 v53, v53, v106
v_add_f32 v49, v49, v75
v_add_f32 v53, v53, v107
v_add_f32 v50, v76, v77
v_add_f32 v54, v108, v109
v_add_f32 v50, v50, v78
v_add_f32 v54, v54, v110
v_add_f32 v50, v50, v79
v_add_f32 v54, v54, v111
v_add_f32 v50, v50, v80
v_add_f32 v54, v54, v112
v_add_f32 v50, v50, v81
v_add_f32 v54, v54, v113
v_add_f32 v50, v50, v82
v_add_f32 v54, v54, v114
v_add_f32 v50, v50, v83
v_add_f32 v54, v54, v115
v_add_f32 v51, v84, v85
v_add_f32 v55, v116, v117
v_add_f32 v51, v51, v86
v_add_f32 v55, v55, v118
v_add_f32 v51, v51, v87
v_add_f32 v55, v55, v119
v_add_f32 v51, v51, v88
v_add_f32 v55, v55, v120
v_add_f32 v51, v51, v89
v_add_f32 v55, v55, v121
v_add_f32 v51, v51, v90
v_add_f32 v55, v55, v122
v_add_f32 v51, v51, v91
v_add_f32 v55, v55, v123
s_nop 1
v_permlane32_swap_b32 v48, v49
v_permlane32_swap_b32 v50, v51
s_nop 0
v_add_f32 v48, v48, v49
v_add_f32 v50, v50, v51
s_nop 1
v_permlane16_swap_b32 v48, v50
s_nop 0
v_add_f32 v48, v48, v50
v_rcp_f32 v48, v48
s_nop 0
v_mov_b32 v50, v48
s_nop 1
v_permlane16_swap_b32 v48, v50
s_nop 0
v_mov_b32 v49, v48
v_mov_b32 v51, v50
s_nop 1
v_permlane32_swap_b32 v48, v49
v_permlane32_swap_b32 v50, v51
s_nop 0
s_nop 1
v_permlane32_swap_b32 v52, v53
v_permlane32_swap_b32 v54, v55
s_nop 0
v_add_f32 v52, v52, v53
v_add_f32 v54, v54, v55
s_nop 1
v_permlane16_swap_b32 v52, v54
s_nop 0
v_add_f32 v52, v52, v54
v_rcp_f32 v52, v52
s_nop 0
v_mov_b32 v54, v52
s_nop 1
v_permlane16_swap_b32 v52, v54
s_nop 0
v_mov_b32 v53, v52
v_mov_b32 v55, v54
s_nop 1
v_permlane32_swap_b32 v52, v53
v_permlane32_swap_b32 v54, v55
s_nop 0
v_pk_mul_f32 v[60:61], v[60:61], v[48:49] op_sel:[0,0] op_sel_hi:[1,0]
v_pk_mul_f32 v[62:63], v[62:63], v[48:49] op_sel:[0,0] op_sel_hi:[1,0]
v_pk_mul_f32 v[64:65], v[64:65], v[48:49] op_sel:[0,0] op_sel_hi:[1,0]
v_pk_mul_f32 v[66:67], v[66:67], v[48:49] op_sel:[0,0] op_sel_hi:[1,0]
v_pk_mul_f32 v[92:93], v[92:93], v[52:53] op_sel:[0,0] op_sel_hi:[1,0]
v_pk_mul_f32 v[94:95], v[94:95], v[52:53] op_sel:[0,0] op_sel_hi:[1,0]
v_pk_mul_f32 v[96:97], v[96:97], v[52:53] op_sel:[0,0] op_sel_hi:[1,0]
v_pk_mul_f32 v[98:99], v[98:99], v[52:53] op_sel:[0,0] op_sel_hi:[1,0]
v_cvt_pk_bf16_f32 v60, v60, v61
v_cvt_pk_bf16_f32 v61, v62, v63
v_cvt_pk_bf16_f32 v62, v64, v65
v_cvt_pk_bf16_f32 v63, v66, v67
v_cvt_pk_bf16_f32 v92, v92, v93
v_cvt_pk_bf16_f32 v93, v94, v95
v_cvt_pk_bf16_f32 v94, v96, v97
v_cvt_pk_bf16_f32 v95, v98, v99
v_pk_mul_f32 v[68:69], v[68:69], v[48:49] op_sel:[0,1] op_sel_hi:[1,1]
v_pk_mul_f32 v[70:71], v[70:71], v[48:49] op_sel:[0,1] op_sel_hi:[1,1]
v_pk_mul_f32 v[72:73], v[72:73], v[48:49] op_sel:[0,1] op_sel_hi:[1,1]
v_pk_mul_f32 v[74:75], v[74:75], v[48:49] op_sel:[0,1] op_sel_hi:[1,1]
v_pk_mul_f32 v[100:101], v[100:101], v[52:53] op_sel:[0,1] op_sel_hi:[1,1]
v_pk_mul_f32 v[102:103], v[102:103], v[52:53] op_sel:[0,1] op_sel_hi:[1,1]
v_pk_mul_f32 v[104:105], v[104:105], v[52:53] op_sel:[0,1] op_sel_hi:[1,1]
v_pk_mul_f32 v[106:107], v[106:107], v[52:53] op_sel:[0,1] op_sel_hi:[1,1]
v_cvt_pk_bf16_f32 v68, v68, v69
v_cvt_pk_bf16_f32 v69, v70, v71
v_cvt_pk_bf16_f32 v70, v72, v73
v_cvt_pk_bf16_f32 v71, v74, v75
v_cvt_pk_bf16_f32 v100, v100, v101
v_cvt_pk_bf16_f32 v101, v102, v103
v_cvt_pk_bf16_f32 v102, v104, v105
v_cvt_pk_bf16_f32 v103, v106, v107
v_pk_mul_f32 v[76:77], v[76:77], v[50:51] op_sel:[0,0] op_sel_hi:[1,0]
v_pk_mul_f32 v[78:79], v[78:79], v[50:51] op_sel:[0,0] op_sel_hi:[1,0]
v_pk_mul_f32 v[80:81], v[80:81], v[50:51] op_sel:[0,0] op_sel_hi:[1,0]
v_pk_mul_f32 v[82:83], v[82:83], v[50:51] op_sel:[0,0] op_sel_hi:[1,0]
v_pk_mul_f32 v[108:109], v[108:109], v[54:55] op_sel:[0,0] op_sel_hi:[1,0]
v_pk_mul_f32 v[110:111], v[110:111], v[54:55] op_sel:[0,0] op_sel_hi:[1,0]
v_pk_mul_f32 v[112:113], v[112:113], v[54:55] op_sel:[0,0] op_sel_hi:[1,0]
v_pk_mul_f32 v[114:115], v[114:115], v[54:55] op_sel:[0,0] op_sel_hi:[1,0]
v_cvt_pk_bf16_f32 v76, v76, v77
v_cvt_pk_bf16_f32 v77, v78, v79
v_cvt_pk_bf16_f32 v78, v80, v81
v_cvt_pk_bf16_f32 v79, v82, v83
v_cvt_pk_bf16_f32 v108, v108, v109
v_cvt_pk_bf16_f32 v109, v110, v111
v_cvt_pk_bf16_f32 v110, v112, v113
v_cvt_pk_bf16_f32 v111, v114, v115
v_pk_mul_f32 v[84:85], v[84:85], v[50:51] op_sel:[0,1] op_sel_hi:[1,1]
v_pk_mul_f32 v[86:87], v[86:87], v[50:51] op_sel:[0,1] op_sel_hi:[1,1]
v_pk_mul_f32 v[88:89], v[88:89], v[50:51] op_sel:[0,1] op_sel_hi:[1,1]
v_pk_mul_f32 v[90:91], v[90:91], v[50:51] op_sel:[0,1] op_sel_hi:[1,1]
v_pk_mul_f32 v[116:117], v[116:117], v[54:55] op_sel:[0,1] op_sel_hi:[1,1]
v_pk_mul_f32 v[118:119], v[118:119], v[54:55] op_sel:[0,1] op_sel_hi:[1,1]
v_pk_mul_f32 v[120:121], v[120:121], v[54:55] op_sel:[0,1] op_sel_hi:[1,1]
v_pk_mul_f32 v[122:123], v[122:123], v[54:55] op_sel:[0,1] op_sel_hi:[1,1]
v_cvt_pk_bf16_f32 v84, v84, v85
v_cvt_pk_bf16_f32 v85, v86, v87
v_cvt_pk_bf16_f32 v86, v88, v89
v_cvt_pk_bf16_f32 v87, v90, v91
v_cvt_pk_bf16_f32 v116, v116, v117
v_cvt_pk_bf16_f32 v117, v118, v119
v_cvt_pk_bf16_f32 v118, v120, v121
v_cvt_pk_bf16_f32 v119, v122, v123
s_lshl_b32 s48, s43, 14
s_lshl_b32 s49, s44, 12
s_add_u32 s48, s48, s49
v_add_u32 v5, s48, v18
ds_write_b128 v5, v[60:63] offset:0
ds_write_b128 v5, v[92:95] offset:8192
ds_write_b128 v5, v[68:71] offset:1024
ds_write_b128 v5, v[100:103] offset:9216
ds_write_b128 v5, v[76:79] offset:2048
ds_write_b128 v5, v[108:111] offset:10240
ds_write_b128 v5, v[84:87] offset:3072
ds_write_b128 v5, v[116:119] offset:11264
v_and_b32 v4, 3, v0
v_lshlrev_b32 v4, 4, v4
v_lshrrev_b32 v6, 2, v2
v_lshl_add_u32 v6, v3, 2, v6
v_add_u32 v4, v4, v6
v_lshlrev_b32 v4, 4, v4
s_lshl_b32 s49, s44, 13
s_add_u32 s48, s48, s49
v_add_u32 v6, s48, v4
v_xor_b32 v7, 4096, v6
s_xor_b32 s48, s40, 2
s_lshl_b32 s48, s48, 12
s_add_u32 s48, s48, 139264
v_add_u32 v5, s48, v18
v_mov_b32 v56, 0x3f803f80
v_mov_b32 v57, 0x3f803f80
v_mov_b32 v58, 0x3f803f80
v_mov_b32 v59, 0x3f803f80
s_waitcnt lgkmcnt(0)
s_barrier
ds_read_b64_tr_b16 v[60:61], v6 offset:0
ds_read_b64_tr_b16 v[62:63], v6 offset:1024
ds_read_b64_tr_b16 v[64:65], v6 offset:8
ds_read_b64_tr_b16 v[66:67], v6 offset:1032
ds_read_b64_tr_b16 v[68:69], v6 offset:2048
ds_read_b64_tr_b16 v[70:71], v6 offset:3072
ds_read_b64_tr_b16 v[72:73], v6 offset:2056
ds_read_b64_tr_b16 v[74:75], v6 offset:3080
ds_read_b128 v[92:95], v5 offset:0
ds_read_b128 v[96:99], v5 offset:1024
ds_read_b128 v[100:103], v5 offset:2048
ds_read_b128 v[104:107], v5 offset:3072
s_waitcnt lgkmcnt(4)
ds_read_b64_tr_b16 v[76:77], v7 offset:0
ds_read_b64_tr_b16 v[78:79], v7 offset:1024
ds_read_b64_tr_b16 v[80:81], v7 offset:8
ds_read_b64_tr_b16 v[82:83], v7 offset:1032
ds_read_b64_tr_b16 v[84:85], v7 offset:2048
ds_read_b64_tr_b16 v[86:87], v7 offset:3072
ds_read_b64_tr_b16 v[88:89], v7 offset:2056
ds_read_b64_tr_b16 v[90:91], v7 offset:3080
v_mfma_f32_16x16x32_bf16 v[180:183], v[60:63], v[22:25], 0
v_mfma_f32_16x16x32_bf16 v[188:191], v[60:63], v[32:35], 0
v_mfma_f32_16x16x32_bf16 v[196:199], v[60:63], v[56:59], 0
v_mfma_f32_16x16x32_bf16 v[184:187], v[64:67], v[22:25], 0
v_mfma_f32_16x16x32_bf16 v[192:195], v[64:67], v[32:35], 0
v_mfma_f32_16x16x32_bf16 v[200:203], v[64:67], v[56:59], 0
v_mfma_f32_16x16x32_bf16 v[180:183], v[68:71], v[26:29], v[180:183]
v_mfma_f32_16x16x32_bf16 v[188:191], v[68:71], v[36:39], v[188:191]
v_mfma_f32_16x16x32_bf16 v[196:199], v[68:71], v[56:59], v[196:199]
v_mfma_f32_16x16x32_bf16 v[184:187], v[72:75], v[26:29], v[184:187]
v_mfma_f32_16x16x32_bf16 v[192:195], v[72:75], v[36:39], v[192:195]
v_mfma_f32_16x16x32_bf16 v[200:203], v[72:75], v[56:59], v[200:203]
s_waitcnt lgkmcnt(0)
v_mfma_f32_16x16x32_bf16 v[180:183], v[76:79], v[92:95], v[180:183]
v_mfma_f32_16x16x32_bf16 v[188:191], v[76:79], v[100:103], v[188:191]
v_mfma_f32_16x16x32_bf16 v[196:199], v[76:79], v[56:59], v[196:199]
v_mfma_f32_16x16x32_bf16 v[184:187], v[80:83], v[92:95], v[184:187]
v_mfma_f32_16x16x32_bf16 v[192:195], v[80:83], v[100:103], v[192:195]
v_mfma_f32_16x16x32_bf16 v[200:203], v[80:83], v[56:59], v[200:203]
v_mfma_f32_16x16x32_bf16 v[180:183], v[84:87], v[96:99], v[180:183]
v_mfma_f32_16x16x32_bf16 v[188:191], v[84:87], v[104:107], v[188:191]
v_mfma_f32_16x16x32_bf16 v[196:199], v[84:87], v[56:59], v[196:199]
v_mfma_f32_16x16x32_bf16 v[184:187], v[88:91], v[96:99], v[184:187]
v_mfma_f32_16x16x32_bf16 v[192:195], v[88:91], v[104:107], v[192:195]
v_mfma_f32_16x16x32_bf16 v[200:203], v[88:91], v[56:59], v[200:203]
s_lshl_b32 s48, s45, 1
s_add_u32 s48, s48, s44
s_lshl_b32 s53, s48, 15
s_add_u32 s53, s53, 8388608
s_lshl_b32 s50, s41, 10
s_add_u32 s49, s53, s50
s_add_u32 s50, s49, 16384
s_lshl_b32 s54, s48, 10
s_add_u32 s54, s54, 12582912
v_cmp_eq_u32 vcc, s41, v2
s_nop 1
v_cvt_pk_bf16_f32 v180, v180, v181
v_cvt_pk_bf16_f32 v181, v182, v183
v_cvt_pk_bf16_f32 v182, v184, v185
v_cvt_pk_bf16_f32 v183, v186, v187
v_cvt_pk_bf16_f32 v188, v188, v189
v_cvt_pk_bf16_f32 v189, v190, v191
v_cvt_pk_bf16_f32 v190, v192, v193
v_cvt_pk_bf16_f32 v191, v194, v195
v_cvt_pk_bf16_f32 v196, v196, v197
v_cvt_pk_bf16_f32 v197, v198, v199
v_cvt_pk_bf16_f32 v198, v200, v201
v_cvt_pk_bf16_f32 v199, v202, v203
buffer_store_dwordx4 v[180:183], v18, s[32:35], s49 offen sc1
buffer_store_dwordx4 v[188:191], v18, s[32:35], s50 offen sc1
s_mov_b64 exec, vcc
buffer_store_dwordx4 v[196:199], v18, s[32:35], s54 offen sc1
s_mov_b64 exec, -1
s_barrier
v_pk_fma_f32 v[148:149], v[128:129], v[138:139], v[148:149] op_sel:[0,1,0] op_sel_hi:[1,1,1]
v_pk_fma_f32 v[150:151], v[130:131], v[138:139], v[150:151] op_sel:[0,1,0] op_sel_hi:[1,1,1]
v_pk_fma_f32 v[152:153], v[132:133], v[138:139], v[152:153] op_sel:[0,1,0] op_sel_hi:[1,1,1]
v_pk_fma_f32 v[154:155], v[134:135], v[138:139], v[154:155] op_sel:[0,1,0] op_sel_hi:[1,1,1]
v_pk_mul_f32 v[148:149], v[148:149], v[138:139] op_sel:[0,0] op_sel_hi:[1,0]
v_pk_mul_f32 v[150:151], v[150:151], v[138:139] op_sel:[0,0] op_sel_hi:[1,0]
v_pk_mul_f32 v[152:153], v[152:153], v[138:139] op_sel:[0,0] op_sel_hi:[1,0]
v_pk_mul_f32 v[154:155], v[154:155], v[138:139] op_sel:[0,0] op_sel_hi:[1,0]
v_cvt_pk_bf16_f32 v148, v148, v149
v_cvt_pk_bf16_f32 v149, v150, v151
v_cvt_pk_bf16_f32 v150, v152, v153
v_cvt_pk_bf16_f32 v151, v154, v155
v_pk_fma_f32 v[156:157], v[128:129], v[140:141], v[156:157] op_sel:[0,1,0] op_sel_hi:[1,1,1]
v_pk_fma_f32 v[158:159], v[130:131], v[140:141], v[158:159] op_sel:[0,1,0] op_sel_hi:[1,1,1]
v_pk_fma_f32 v[160:161], v[132:133], v[140:141], v[160:161] op_sel:[0,1,0] op_sel_hi:[1,1,1]
v_pk_fma_f32 v[162:163], v[134:135], v[140:141], v[162:163] op_sel:[0,1,0] op_sel_hi:[1,1,1]
v_pk_mul_f32 v[156:157], v[156:157], v[140:141] op_sel:[0,0] op_sel_hi:[1,0]
v_pk_mul_f32 v[158:159], v[158:159], v[140:141] op_sel:[0,0] op_sel_hi:[1,0]
v_pk_mul_f32 v[160:161], v[160:161], v[140:141] op_sel:[0,0] op_sel_hi:[1,0]
v_pk_mul_f32 v[162:163], v[162:163], v[140:141] op_sel:[0,0] op_sel_hi:[1,0]
v_cvt_pk_bf16_f32 v156, v156, v157
v_cvt_pk_bf16_f32 v157, v158, v159
v_cvt_pk_bf16_f32 v158, v160, v161
v_cvt_pk_bf16_f32 v159, v162, v163
v_pk_fma_f32 v[164:165], v[128:129], v[142:143], v[164:165] op_sel:[0,1,0] op_sel_hi:[1,1,1]
v_pk_fma_f32 v[166:167], v[130:131], v[142:143], v[166:167] op_sel:[0,1,0] op_sel_hi:[1,1,1]
v_pk_fma_f32 v[168:169], v[132:133], v[142:143], v[168:169] op_sel:[0,1,0] op_sel_hi:[1,1,1]
v_pk_fma_f32 v[170:171], v[134:135], v[142:143], v[170:171] op_sel:[0,1,0] op_sel_hi:[1,1,1]
v_pk_mul_f32 v[164:165], v[164:165], v[142:143] op_sel:[0,0] op_sel_hi:[1,0]
v_pk_mul_f32 v[166:167], v[166:167], v[142:143] op_sel:[0,0] op_sel_hi:[1,0]
v_pk_mul_f32 v[168:169], v[168:169], v[142:143] op_sel:[0,0] op_sel_hi:[1,0]
v_pk_mul_f32 v[170:171], v[170:171], v[142:143] op_sel:[0,0] op_sel_hi:[1,0]
v_cvt_pk_bf16_f32 v164, v164, v165
v_cvt_pk_bf16_f32 v165, v166, v167
v_cvt_pk_bf16_f32 v166, v168, v169
v_cvt_pk_bf16_f32 v167, v170, v171
v_pk_fma_f32 v[172:173], v[128:129], v[144:145], v[172:173] op_sel:[0,1,0] op_sel_hi:[1,1,1]
v_pk_fma_f32 v[174:175], v[130:131], v[144:145], v[174:175] op_sel:[0,1,0] op_sel_hi:[1,1,1]
v_pk_fma_f32 v[176:177], v[132:133], v[144:145], v[176:177] op_sel:[0,1,0] op_sel_hi:[1,1,1]
v_pk_fma_f32 v[178:179], v[134:135], v[144:145], v[178:179] op_sel:[0,1,0] op_sel_hi:[1,1,1]
v_pk_mul_f32 v[172:173], v[172:173], v[144:145] op_sel:[0,0] op_sel_hi:[1,0]
v_pk_mul_f32 v[174:175], v[174:175], v[144:145] op_sel:[0,0] op_sel_hi:[1,0]
v_pk_mul_f32 v[176:177], v[176:177], v[144:145] op_sel:[0,0] op_sel_hi:[1,0]
v_pk_mul_f32 v[178:179], v[178:179], v[144:145] op_sel:[0,0] op_sel_hi:[1,0]
v_cvt_pk_bf16_f32 v172, v172, v173
v_cvt_pk_bf16_f32 v173, v174, v175
v_cvt_pk_bf16_f32 v174, v176, v177
v_cvt_pk_bf16_f32 v175, v178, v179
s_lshl_b32 s55, s42, 2
s_add_u32 s55, s55, s40
s_lshl_b32 s55, s55, 7
s_add_u32 s55, s55, 14172160
s_waitcnt vmcnt(0)
s_lshl_b32 s62, s41, 2
v_mov_b32 v4, s62
v_mov_b32 v5, 1
s_mov_b64 exec, 1
buffer_store_dword v5, v4, s[32:35], s55 offen sc1
s_mov_b64 exec, -1
v_mfma_f32_16x16x32_bf16 v[60:63], v[40:43], v[148:151], 0
v_mfma_f32_16x16x32_bf16 v[64:67], v[44:47], v[148:151], 0
v_mfma_f32_16x16x32_bf16 v[68:71], v[40:43], v[156:159], 0
v_mfma_f32_16x16x32_bf16 v[72:75], v[44:47], v[156:159], 0
v_mfma_f32_16x16x32_bf16 v[76:79], v[40:43], v[164:167], 0
v_mfma_f32_16x16x32_bf16 v[80:83], v[44:47], v[164:167], 0
v_mfma_f32_16x16x32_bf16 v[84:87], v[40:43], v[172:175], 0
v_mfma_f32_16x16x32_bf16 v[88:91], v[44:47], v[172:175], 0
s_nop 4
v_max3_f32 v48, v60, v61, v62
v_min3_f32 v52, v60, v61, v62
v_max3_f32 v48, v48, v63, v64
v_min3_f32 v52, v52, v63, v64
v_max3_f32 v48, v48, v65, v66
v_min3_f32 v52, v52, v65, v66
v_max_f32 v48, v48, v67
v_min_f32 v52, v52, v67
v_max3_f32 v49, v68, v69, v70
v_min3_f32 v53, v68, v69, v70
v_max3_f32 v49, v49, v71, v72
v_min3_f32 v53, v53, v71, v72
v_max3_f32 v49, v49, v73, v74
v_min3_f32 v53, v53, v73, v74
v_max_f32 v49, v49, v75
v_min_f32 v53, v53, v75
v_max3_f32 v50, v76, v77, v78
v_min3_f32 v54, v76, v77, v78
v_max3_f32 v50, v50, v79, v80
v_min3_f32 v54, v54, v79, v80
v_max3_f32 v50, v50, v81, v82
v_min3_f32 v54, v54, v81, v82
v_max_f32 v50, v50, v83
v_min_f32 v54, v54, v83
v_max3_f32 v51, v84, v85, v86
v_min3_f32 v55, v84, v85, v86
v_max3_f32 v51, v51, v87, v88
v_min3_f32 v55, v55, v87, v88
v_max3_f32 v51, v51, v89, v90
v_min3_f32 v55, v55, v89, v90
v_max_f32 v51, v51, v91
v_min_f32 v55, v55, v91
s_nop 1
v_permlane32_swap_b32 v48, v49
v_permlane32_swap_b32 v50, v51
s_nop 0
v_max_f32 v48, v48, v49
v_max_f32 v50, v50, v51
s_nop 1
v_permlane16_swap_b32 v48, v50
s_nop 0
v_max_f32 v48, v48, v50
v_mul_f32 v48, s66, v48
v_mov_b32 v50, v48
s_nop 1
v_permlane16_swap_b32 v48, v50
s_nop 0
v_mov_b32 v49, v48
v_mov_b32 v51, v50
s_nop 1
v_permlane32_swap_b32 v48, v49
v_permlane32_swap_b32 v50, v51
s_nop 0
s_nop 1
v_permlane32_swap_b32 v52, v53
v_permlane32_swap_b32 v54, v55
s_nop 0
v_min_f32 v52, v52, v53
v_min_f32 v54, v54, v55
s_nop 1
v_permlane16_swap_b32 v52, v54
s_nop 0
v_min_f32 v52, v52, v54
v_mul_f32 v52, s66, v52
v_mov_b32 v54, v52
s_nop 1
v_permlane16_swap_b32 v52, v54
s_nop 0
v_mov_b32 v53, v52
v_mov_b32 v55, v54
s_nop 1
v_permlane32_swap_b32 v52, v53
v_permlane32_swap_b32 v54, v55
s_nop 0
v_fma_f32 v92, -v60, s66, v52
v_fma_f32 v60, v60, s66, -v48
v_fma_f32 v93, -v61, s66, v52
v_fma_f32 v61, v61, s66, -v48
v_fma_f32 v94, -v62, s66, v52
v_fma_f32 v62, v62, s66, -v48
v_fma_f32 v95, -v63, s66, v52
v_fma_f32 v63, v63, s66, -v48
v_fma_f32 v96, -v64, s66, v52
v_fma_f32 v64, v64, s66, -v48
v_fma_f32 v97, -v65, s66, v52
v_fma_f32 v65, v65, s66, -v48
v_fma_f32 v98, -v66, s66, v52
v_fma_f32 v66, v66, s66, -v48
v_fma_f32 v99, -v67, s66, v52
v_fma_f32 v67, v67, s66, -v48
v_exp_f32 v92, v92
v_exp_f32 v60, v60
v_exp_f32 v93, v93
v_exp_f32 v61, v61
v_exp_f32 v94, v94
v_exp_f32 v62, v62
v_exp_f32 v95, v95
v_exp_f32 v63, v63
v_exp_f32 v96, v96
v_exp_f32 v64, v64
v_exp_f32 v97, v97
v_exp_f32 v65, v65
v_exp_f32 v98, v98
v_exp_f32 v66, v66
v_exp_f32 v99, v99
v_exp_f32 v67, v67
v_fma_f32 v100, -v68, s66, v53
v_fma_f32 v68, v68, s66, -v49
v_fma_f32 v101, -v69, s66, v53
v_fma_f32 v69, v69, s66, -v49
v_fma_f32 v102, -v70, s66, v53
v_fma_f32 v70, v70, s66, -v49
v_fma_f32 v103, -v71, s66, v53
v_fma_f32 v71, v71, s66, -v49
v_fma_f32 v104, -v72, s66, v53
v_fma_f32 v72, v72, s66, -v49
v_fma_f32 v105, -v73, s66, v53
v_fma_f32 v73, v73, s66, -v49
v_fma_f32 v106, -v74, s66, v53
v_fma_f32 v74, v74, s66, -v49
v_fma_f32 v107, -v75, s66, v53
v_fma_f32 v75, v75, s66, -v49
v_exp_f32 v100, v100
v_exp_f32 v68, v68
v_exp_f32 v101, v101
v_exp_f32 v69, v69
v_exp_f32 v102, v102
v_exp_f32 v70, v70
v_exp_f32 v103, v103
v_exp_f32 v71, v71
v_exp_f32 v104, v104
v_exp_f32 v72, v72
v_exp_f32 v105, v105
v_exp_f32 v73, v73
v_exp_f32 v106, v106
v_exp_f32 v74, v74
v_exp_f32 v107, v107
v_exp_f32 v75, v75
v_fma_f32 v108, -v76, s66, v54
v_fma_f32 v76, v76, s66, -v50
v_fma_f32 v109, -v77, s66, v54
v_fma_f32 v77, v77, s66, -v50
v_fma_f32 v110, -v78, s66, v54
v_fma_f32 v78, v78, s66, -v50
v_fma_f32 v111, -v79, s66, v54
v_fma_f32 v79, v79, s66, -v50
v_fma_f32 v112, -v80, s66, v54
v_fma_f32 v80, v80, s66, -v50
v_fma_f32 v113, -v81, s66, v54
v_fma_f32 v81, v81, s66, -v50
v_fma_f32 v114, -v82, s66, v54
v_fma_f32 v82, v82, s66, -v50
v_fma_f32 v115, -v83, s66, v54
v_fma_f32 v83, v83, s66, -v50
v_exp_f32 v108, v108
v_exp_f32 v76, v76
v_exp_f32 v109, v109
v_exp_f32 v77, v77
v_exp_f32 v110, v110
v_exp_f32 v78, v78
v_exp_f32 v111, v111
v_exp_f32 v79, v79
v_exp_f32 v112, v112
v_exp_f32 v80, v80
v_exp_f32 v113, v113
v_exp_f32 v81, v81
v_exp_f32 v114, v114
v_exp_f32 v82, v82
v_exp_f32 v115, v115
v_exp_f32 v83, v83
v_fma_f32 v116, -v84, s66, v55
v_fma_f32 v84, v84, s66, -v51
v_fma_f32 v117, -v85, s66, v55
v_fma_f32 v85, v85, s66, -v51
v_fma_f32 v118, -v86, s66, v55
v_fma_f32 v86, v86, s66, -v51
v_fma_f32 v119, -v87, s66, v55
v_fma_f32 v87, v87, s66, -v51
v_fma_f32 v120, -v88, s66, v55
v_fma_f32 v88, v88, s66, -v51
v_fma_f32 v121, -v89, s66, v55
v_fma_f32 v89, v89, s66, -v51
v_fma_f32 v122, -v90, s66, v55
v_fma_f32 v90, v90, s66, -v51
v_fma_f32 v123, -v91, s66, v55
v_fma_f32 v91, v91, s66, -v51
v_exp_f32 v116, v116
v_exp_f32 v84, v84
v_exp_f32 v117, v117
v_exp_f32 v85, v85
v_exp_f32 v118, v118
v_exp_f32 v86, v86
v_exp_f32 v119, v119
v_exp_f32 v87, v87
v_exp_f32 v120, v120
v_exp_f32 v88, v88
v_exp_f32 v121, v121
v_exp_f32 v89, v89
v_exp_f32 v122, v122
v_exp_f32 v90, v90
v_exp_f32 v123, v123
v_exp_f32 v91, v91
s_nop 0
v_add_f32 v48, v60, v61
v_add_f32 v52, v92, v93
v_add_f32 v48, v48, v62
v_add_f32 v52, v52, v94
v_add_f32 v48, v48, v63
v_add_f32 v52, v52, v95
v_add_f32 v48, v48, v64
v_add_f32 v52, v52, v96
v_add_f32 v48, v48, v65
v_add_f32 v52, v52, v97
v_add_f32 v48, v48, v66
v_add_f32 v52, v52, v98
v_add_f32 v48, v48, v67
v_add_f32 v52, v52, v99
v_add_f32 v49, v68, v69
v_add_f32 v53, v100, v101
v_add_f32 v49, v49, v70
v_add_f32 v53, v53, v102
v_add_f32 v49, v49, v71
v_add_f32 v53, v53, v103
v_add_f32 v49, v49, v72
v_add_f32 v53, v53, v104
v_add_f32 v49, v49, v73
v_add_f32 v53, v53, v105
v_add_f32 v49, v49, v74
v_add_f32 v53, v53, v106
v_add_f32 v49, v49, v75
v_add_f32 v53, v53, v107
v_add_f32 v50, v76, v77
v_add_f32 v54, v108, v109
v_add_f32 v50, v50, v78
v_add_f32 v54, v54, v110
v_add_f32 v50, v50, v79
v_add_f32 v54, v54, v111
v_add_f32 v50, v50, v80
v_add_f32 v54, v54, v112
v_add_f32 v50, v50, v81
v_add_f32 v54, v54, v113
v_add_f32 v50, v50, v82
v_add_f32 v54, v54, v114
v_add_f32 v50, v50, v83
v_add_f32 v54, v54, v115
v_add_f32 v51, v84, v85
v_add_f32 v55, v116, v117
v_add_f32 v51, v51, v86
v_add_f32 v55, v55, v118
v_add_f32 v51, v51, v87
v_add_f32 v55, v55, v119
v_add_f32 v51, v51, v88
v_add_f32 v55, v55, v120
v_add_f32 v51, v51, v89
v_add_f32 v55, v55, v121
v_add_f32 v51, v51, v90
v_add_f32 v55, v55, v122
v_add_f32 v51, v51, v91
v_add_f32 v55, v55, v123
s_nop 1
v_permlane32_swap_b32 v48, v49
v_permlane32_swap_b32 v50, v51
s_nop 0
v_add_f32 v48, v48, v49
v_add_f32 v50, v50, v51
s_nop 1
v_permlane16_swap_b32 v48, v50
s_nop 0
v_add_f32 v48, v48, v50
v_rcp_f32 v48, v48
s_nop 0
v_mov_b32 v50, v48
s_nop 1
v_permlane16_swap_b32 v48, v50
s_nop 0
v_mov_b32 v49, v48
v_mov_b32 v51, v50
s_nop 1
v_permlane32_swap_b32 v48, v49
v_permlane32_swap_b32 v50, v51
s_nop 0
s_nop 1
v_permlane32_swap_b32 v52, v53
v_permlane32_swap_b32 v54, v55
s_nop 0
v_add_f32 v52, v52, v53
v_add_f32 v54, v54, v55
s_nop 1
v_permlane16_swap_b32 v52, v54
s_nop 0
v_add_f32 v52, v52, v54
v_rcp_f32 v52, v52
s_nop 0
v_mov_b32 v54, v52
s_nop 1
v_permlane16_swap_b32 v52, v54
s_nop 0
v_mov_b32 v53, v52
v_mov_b32 v55, v54
s_nop 1
v_permlane32_swap_b32 v52, v53
v_permlane32_swap_b32 v54, v55
s_nop 0
v_pk_mul_f32 v[60:61], v[60:61], v[48:49] op_sel:[0,0] op_sel_hi:[1,0]
v_pk_mul_f32 v[62:63], v[62:63], v[48:49] op_sel:[0,0] op_sel_hi:[1,0]
v_pk_mul_f32 v[64:65], v[64:65], v[48:49] op_sel:[0,0] op_sel_hi:[1,0]
v_pk_mul_f32 v[66:67], v[66:67], v[48:49] op_sel:[0,0] op_sel_hi:[1,0]
v_pk_mul_f32 v[92:93], v[92:93], v[52:53] op_sel:[0,0] op_sel_hi:[1,0]
v_pk_mul_f32 v[94:95], v[94:95], v[52:53] op_sel:[0,0] op_sel_hi:[1,0]
v_pk_mul_f32 v[96:97], v[96:97], v[52:53] op_sel:[0,0] op_sel_hi:[1,0]
v_pk_mul_f32 v[98:99], v[98:99], v[52:53] op_sel:[0,0] op_sel_hi:[1,0]
v_cvt_pk_bf16_f32 v60, v60, v61
v_cvt_pk_bf16_f32 v61, v62, v63
v_cvt_pk_bf16_f32 v62, v64, v65
v_cvt_pk_bf16_f32 v63, v66, v67
v_cvt_pk_bf16_f32 v92, v92, v93
v_cvt_pk_bf16_f32 v93, v94, v95
v_cvt_pk_bf16_f32 v94, v96, v97
v_cvt_pk_bf16_f32 v95, v98, v99
v_pk_mul_f32 v[68:69], v[68:69], v[48:49] op_sel:[0,1] op_sel_hi:[1,1]
v_pk_mul_f32 v[70:71], v[70:71], v[48:49] op_sel:[0,1] op_sel_hi:[1,1]
v_pk_mul_f32 v[72:73], v[72:73], v[48:49] op_sel:[0,1] op_sel_hi:[1,1]
v_pk_mul_f32 v[74:75], v[74:75], v[48:49] op_sel:[0,1] op_sel_hi:[1,1]
v_pk_mul_f32 v[100:101], v[100:101], v[52:53] op_sel:[0,1] op_sel_hi:[1,1]
v_pk_mul_f32 v[102:103], v[102:103], v[52:53] op_sel:[0,1] op_sel_hi:[1,1]
v_pk_mul_f32 v[104:105], v[104:105], v[52:53] op_sel:[0,1] op_sel_hi:[1,1]
v_pk_mul_f32 v[106:107], v[106:107], v[52:53] op_sel:[0,1] op_sel_hi:[1,1]
v_cvt_pk_bf16_f32 v68, v68, v69
v_cvt_pk_bf16_f32 v69, v70, v71
v_cvt_pk_bf16_f32 v70, v72, v73
v_cvt_pk_bf16_f32 v71, v74, v75
v_cvt_pk_bf16_f32 v100, v100, v101
v_cvt_pk_bf16_f32 v101, v102, v103
v_cvt_pk_bf16_f32 v102, v104, v105
v_cvt_pk_bf16_f32 v103, v106, v107
v_pk_mul_f32 v[76:77], v[76:77], v[50:51] op_sel:[0,0] op_sel_hi:[1,0]
v_pk_mul_f32 v[78:79], v[78:79], v[50:51] op_sel:[0,0] op_sel_hi:[1,0]
v_pk_mul_f32 v[80:81], v[80:81], v[50:51] op_sel:[0,0] op_sel_hi:[1,0]
v_pk_mul_f32 v[82:83], v[82:83], v[50:51] op_sel:[0,0] op_sel_hi:[1,0]
v_pk_mul_f32 v[108:109], v[108:109], v[54:55] op_sel:[0,0] op_sel_hi:[1,0]
v_pk_mul_f32 v[110:111], v[110:111], v[54:55] op_sel:[0,0] op_sel_hi:[1,0]
v_pk_mul_f32 v[112:113], v[112:113], v[54:55] op_sel:[0,0] op_sel_hi:[1,0]
v_pk_mul_f32 v[114:115], v[114:115], v[54:55] op_sel:[0,0] op_sel_hi:[1,0]
v_cvt_pk_bf16_f32 v76, v76, v77
v_cvt_pk_bf16_f32 v77, v78, v79
v_cvt_pk_bf16_f32 v78, v80, v81
v_cvt_pk_bf16_f32 v79, v82, v83
v_cvt_pk_bf16_f32 v108, v108, v109
v_cvt_pk_bf16_f32 v109, v110, v111
v_cvt_pk_bf16_f32 v110, v112, v113
v_cvt_pk_bf16_f32 v111, v114, v115
v_pk_mul_f32 v[84:85], v[84:85], v[50:51] op_sel:[0,1] op_sel_hi:[1,1]
v_pk_mul_f32 v[86:87], v[86:87], v[50:51] op_sel:[0,1] op_sel_hi:[1,1]
v_pk_mul_f32 v[88:89], v[88:89], v[50:51] op_sel:[0,1] op_sel_hi:[1,1]
v_pk_mul_f32 v[90:91], v[90:91], v[50:51] op_sel:[0,1] op_sel_hi:[1,1]
v_pk_mul_f32 v[116:117], v[116:117], v[54:55] op_sel:[0,1] op_sel_hi:[1,1]
v_pk_mul_f32 v[118:119], v[118:119], v[54:55] op_sel:[0,1] op_sel_hi:[1,1]
v_pk_mul_f32 v[120:121], v[120:121], v[54:55] op_sel:[0,1] op_sel_hi:[1,1]
v_pk_mul_f32 v[122:123], v[122:123], v[54:55] op_sel:[0,1] op_sel_hi:[1,1]
v_cvt_pk_bf16_f32 v84, v84, v85
v_cvt_pk_bf16_f32 v85, v86, v87
v_cvt_pk_bf16_f32 v86, v88, v89
v_cvt_pk_bf16_f32 v87, v90, v91
v_cvt_pk_bf16_f32 v116, v116, v117
v_cvt_pk_bf16_f32 v117, v118, v119
v_cvt_pk_bf16_f32 v118, v120, v121
v_cvt_pk_bf16_f32 v119, v122, v123
v_lshrrev_b32 v6, 2, v2
v_cmp_eq_u32 vcc, v6, v3
v_and_b32 v7, 1, v0
v_lshlrev_b32 v7, 4, v7
v_mov_b32 v8, 0x3f80
v_lshlrev_b32 v7, v7, v8
v_cndmask_b32 v7, 0, v7, vcc
v_and_b32 v6, 2, v0
v_cmp_eq_u32 vcc, 0, v6
v_mov_b32 v24, 0
v_mov_b32 v25, 0
v_mov_b32 v28, 0
v_mov_b32 v29, 0
v_cndmask_b32 v26, 0, v7, vcc
v_cndmask_b32 v27, v7, 0, vcc
v_and_b32 v4, 15, v0
v_lshlrev_b32 v4, 2, v4
buffer_load_dword v5, v4, s[32:35], s55 offen sc1
s_mov_b32 s63, 0
s_waitcnt vmcnt(0)
poll_9:
v_cmp_gt_u32 vcc, 1, v5
s_cbranch_vccz polled_10
buffer_load_dword v5, v4, s[32:35], s55 offen sc1
s_add_u32 s63, s63, 1
s_cmp_lt_u32 s63, 0x80000
s_waitcnt vmcnt(0)
s_cbranch_scc1 poll_9
polled_10:
buffer_load_dwordx4 v[148:151], v18, s[32:35], s53 offen offset:0 sc1
buffer_load_dwordx4 v[152:155], v18, s[32:35], s53 offen offset:1024 sc1
buffer_load_dwordx4 v[156:159], v18, s[32:35], s53 offen offset:2048 sc1
buffer_load_dwordx4 v[160:163], v18, s[32:35], s53 offen offset:3072 sc1
s_add_u32 s53, s53, 4096
buffer_load_dwordx4 v[164:167], v18, s[32:35], s53 offen offset:0 sc1
buffer_load_dwordx4 v[168:171], v18, s[32:35], s53 offen offset:1024 sc1
buffer_load_dwordx4 v[172:175], v18, s[32:35], s53 offen offset:2048 sc1
buffer_load_dwordx4 v[176:179], v18, s[32:35], s53 offen offset:3072 sc1
s_add_u32 s53, s53, 4096
buffer_load_dwordx4 v[180:183], v18, s[32:35], s53 offen offset:0 sc1
buffer_load_dwordx4 v[184:187], v18, s[32:35], s53 offen offset:1024 sc1
buffer_load_dwordx4 v[188:191], v18, s[32:35], s53 offen offset:2048 sc1
buffer_load_dwordx4 v[192:195], v18, s[32:35], s53 offen offset:3072 sc1
s_add_u32 s53, s53, 4096
buffer_load_dwordx4 v[196:199], v18, s[32:35], s53 offen offset:0 sc1
buffer_load_dwordx4 v[200:203], v18, s[32:35], s53 offen offset:1024 sc1
buffer_load_dwordx4 v[204:207], v18, s[32:35], s53 offen offset:2048 sc1
buffer_load_dwordx4 v[208:211], v18, s[32:35], s53 offen offset:3072 sc1
s_add_u32 s53, s53, 4096
buffer_load_dwordx4 v[212:215], v18, s[32:35], s53 offen offset:0 sc1
buffer_load_dwordx4 v[216:219], v18, s[32:35], s53 offen offset:1024 sc1
buffer_load_dwordx4 v[220:223], v18, s[32:35], s53 offen offset:2048 sc1
buffer_load_dwordx4 v[224:227], v18, s[32:35], s53 offen offset:3072 sc1
s_add_u32 s53, s53, 4096
buffer_load_dwordx4 v[228:231], v18, s[32:35], s53 offen offset:0 sc1
buffer_load_dwordx4 v[232:235], v18, s[32:35], s53 offen offset:1024 sc1
buffer_load_dwordx4 v[236:239], v18, s[32:35], s53 offen offset:2048 sc1
buffer_load_dwordx4 v[240:243], v18, s[32:35], s53 offen offset:3072 sc1
s_add_u32 s53, s53, 4096
buffer_load_dwordx4 v[244:247], v18, s[32:35], s53 offen offset:0 sc1
buffer_load_dwordx4 v[248:251], v18, s[32:35], s53 offen offset:1024 sc1
buffer_load_dwordx4 v[124:127], v18, s[32:35], s53 offen offset:2048 sc1
buffer_load_dwordx4 v[128:131], v18, s[32:35], s53 offen offset:3072 sc1
s_add_u32 s53, s53, 4096
buffer_load_dwordx4 v[132:135], v18, s[32:35], s53 offen offset:0 sc1
buffer_load_dwordx4 v[136:139], v18, s[32:35], s53 offen offset:1024 sc1
buffer_load_dwordx4 v[140:143], v18, s[32:35], s53 offen offset:2048 sc1
buffer_load_dwordx4 v[144:147], v18, s[32:35], s53 offen offset:3072 sc1
buffer_load_dwordx4 v[20:23], v18, s[32:35], s54 offen sc1
s_waitcnt vmcnt(29)
v_mfma_f32_16x16x32_bf16 v[32:35], v[26:29], v[148:151], 0
v_mfma_f32_16x16x32_bf16 v[36:39], v[24:27], v[148:151], 0
v_mfma_f32_16x16x32_bf16 v[32:35], v[26:29], v[152:155], v[32:35]
v_mfma_f32_16x16x32_bf16 v[36:39], v[24:27], v[152:155], v[36:39]
v_mfma_f32_16x16x32_bf16 v[32:35], v[26:29], v[156:159], v[32:35]
v_mfma_f32_16x16x32_bf16 v[36:39], v[24:27], v[156:159], v[36:39]
v_mfma_f32_16x16x32_bf16 v[32:35], v[26:29], v[160:163], v[32:35]
v_mfma_f32_16x16x32_bf16 v[36:39], v[24:27], v[160:163], v[36:39]
s_waitcnt vmcnt(25)
v_mfma_f32_16x16x32_bf16 v[32:35], v[26:29], v[164:167], v[32:35]
v_mfma_f32_16x16x32_bf16 v[36:39], v[24:27], v[164:167], v[36:39]
v_mfma_f32_16x16x32_bf16 v[32:35], v[26:29], v[168:171], v[32:35]
v_mfma_f32_16x16x32_bf16 v[36:39], v[24:27], v[168:171], v[36:39]
v_mfma_f32_16x16x32_bf16 v[32:35], v[26:29], v[172:175], v[32:35]
v_mfma_f32_16x16x32_bf16 v[36:39], v[24:27], v[172:175], v[36:39]
v_mfma_f32_16x16x32_bf16 v[32:35], v[26:29], v[176:179], v[32:35]
v_mfma_f32_16x16x32_bf16 v[36:39], v[24:27], v[176:179], v[36:39]
s_waitcnt vmcnt(21)
v_mfma_f32_16x16x32_bf16 v[32:35], v[26:29], v[180:183], v[32:35]
v_mfma_f32_16x16x32_bf16 v[36:39], v[24:27], v[180:183], v[36:39]
v_mfma_f32_16x16x32_bf16 v[32:35], v[26:29], v[184:187], v[32:35]
v_mfma_f32_16x16x32_bf16 v[36:39], v[24:27], v[184:187], v[36:39]
v_mfma_f32_16x16x32_bf16 v[32:35], v[26:29], v[188:191], v[32:35]
v_mfma_f32_16x16x32_bf16 v[36:39], v[24:27], v[188:191], v[36:39]
v_mfma_f32_16x16x32_bf16 v[32:35], v[26:29], v[192:195], v[32:35]
v_mfma_f32_16x16x32_bf16 v[36:39], v[24:27], v[192:195], v[36:39]
s_waitcnt vmcnt(17)
v_mfma_f32_16x16x32_bf16 v[32:35], v[26:29], v[196:199], v[32:35]
v_mfma_f32_16x16x32_bf16 v[36:39], v[24:27], v[196:199], v[36:39]
v_mfma_f32_16x16x32_bf16 v[32:35], v[26:29], v[200:203], v[32:35]
v_mfma_f32_16x16x32_bf16 v[36:39], v[24:27], v[200:203], v[36:39]
v_mfma_f32_16x16x32_bf16 v[32:35], v[26:29], v[204:207], v[32:35]
v_mfma_f32_16x16x32_bf16 v[36:39], v[24:27], v[204:207], v[36:39]
v_mfma_f32_16x16x32_bf16 v[32:35], v[26:29], v[208:211], v[32:35]
v_mfma_f32_16x16x32_bf16 v[36:39], v[24:27], v[208:211], v[36:39]
s_waitcnt vmcnt(13)
v_mfma_f32_16x16x32_bf16 v[40:43], v[26:29], v[212:215], 0
v_mfma_f32_16x16x32_bf16 v[44:47], v[24:27], v[212:215], 0
v_mfma_f32_16x16x32_bf16 v[40:43], v[26:29], v[216:219], v[40:43]
v_mfma_f32_16x16x32_bf16 v[44:47], v[24:27], v[216:219], v[44:47]
v_mfma_f32_16x16x32_bf16 v[40:43], v[26:29], v[220:223], v[40:43]
v_mfma_f32_16x16x32_bf16 v[44:47], v[24:27], v[220:223], v[44:47]
v_mfma_f32_16x16x32_bf16 v[40:43], v[26:29], v[224:227], v[40:43]
v_mfma_f32_16x16x32_bf16 v[44:47], v[24:27], v[224:227], v[44:47]
s_waitcnt vmcnt(9)
v_mfma_f32_16x16x32_bf16 v[40:43], v[26:29], v[228:231], v[40:43]
v_mfma_f32_16x16x32_bf16 v[44:47], v[24:27], v[228:231], v[44:47]
v_mfma_f32_16x16x32_bf16 v[40:43], v[26:29], v[232:235], v[40:43]
v_mfma_f32_16x16x32_bf16 v[44:47], v[24:27], v[232:235], v[44:47]
v_mfma_f32_16x16x32_bf16 v[40:43], v[26:29], v[236:239], v[40:43]
v_mfma_f32_16x16x32_bf16 v[44:47], v[24:27], v[236:239], v[44:47]
v_mfma_f32_16x16x32_bf16 v[40:43], v[26:29], v[240:243], v[40:43]
v_mfma_f32_16x16x32_bf16 v[44:47], v[24:27], v[240:243], v[44:47]
s_waitcnt vmcnt(5)
v_mfma_f32_16x16x32_bf16 v[40:43], v[26:29], v[244:247], v[40:43]
v_mfma_f32_16x16x32_bf16 v[44:47], v[24:27], v[244:247], v[44:47]
v_mfma_f32_16x16x32_bf16 v[40:43], v[26:29], v[248:251], v[40:43]
v_mfma_f32_16x16x32_bf16 v[44:47], v[24:27], v[248:251], v[44:47]
v_mfma_f32_16x16x32_bf16 v[40:43], v[26:29], v[124:127], v[40:43]
v_mfma_f32_16x16x32_bf16 v[44:47], v[24:27], v[124:127], v[44:47]
v_mfma_f32_16x16x32_bf16 v[40:43], v[26:29], v[128:131], v[40:43]
v_mfma_f32_16x16x32_bf16 v[44:47], v[24:27], v[128:131], v[44:47]
s_waitcnt vmcnt(1)
v_mfma_f32_16x16x32_bf16 v[40:43], v[26:29], v[132:135], v[40:43]
v_mfma_f32_16x16x32_bf16 v[44:47], v[24:27], v[132:135], v[44:47]
v_mfma_f32_16x16x32_bf16 v[40:43], v[26:29], v[136:139], v[40:43]
v_mfma_f32_16x16x32_bf16 v[44:47], v[24:27], v[136:139], v[44:47]
v_mfma_f32_16x16x32_bf16 v[40:43], v[26:29], v[140:143], v[40:43]
v_mfma_f32_16x16x32_bf16 v[44:47], v[24:27], v[140:143], v[44:47]
v_mfma_f32_16x16x32_bf16 v[40:43], v[26:29], v[144:147], v[40:43]
v_mfma_f32_16x16x32_bf16 v[44:47], v[24:27], v[144:147], v[44:47]
s_lshl_b32 s48, s40, 11
s_add_u32 s48, s48, 155648
v_add_u32 v5, s48, v18
s_lshl_b32 s48, s40, 10
s_add_u32 s48, s48, 135168
v_add_u32 v6, s48, v18
s_waitcnt vmcnt(0)
ds_write_b128 v6, v[20:23]
v_cvt_pk_bf16_f32 v32, v32, v33
v_cvt_pk_bf16_f32 v33, v34, v35
v_cvt_pk_bf16_f32 v34, v36, v37
v_cvt_pk_bf16_f32 v35, v38, v39
ds_write_b128 v5, v[32:35] offset:0
v_cvt_pk_bf16_f32 v40, v40, v41
v_cvt_pk_bf16_f32 v41, v42, v43
v_cvt_pk_bf16_f32 v42, v44, v45
v_cvt_pk_bf16_f32 v43, v46, v47
ds_write_b128 v5, v[40:43] offset:1024
s_lshl_b32 s48, s43, 11
s_add_u32 s48, s48, 155648
v_add_u32 v5, s48, v18
s_lshl_b32 s48, s43, 10
s_add_u32 s48, s48, 135168
v_add_u32 v6, s48, v18
s_waitcnt lgkmcnt(0)
s_barrier
ds_read_b128 v[20:23], v6 offset:0
ds_read_b128 v[24:27], v6 offset:2048
ds_read_b128 v[28:31], v5 offset:0
ds_read_b128 v[32:35], v5 offset:1024
ds_read_b128 v[36:39], v5 offset:4096
ds_read_b128 v[40:43], v5 offset:5120
s_waitcnt lgkmcnt(4)
v_mfma_f32_16x16x32_bf16 v[148:151], v[20:23], v[60:63], 0
v_mfma_f32_16x16x32_bf16 v[152:155], v[20:23], v[68:71], 0
v_mfma_f32_16x16x32_bf16 v[156:159], v[20:23], v[76:79], 0
v_mfma_f32_16x16x32_bf16 v[160:163], v[20:23], v[84:87], 0
v_mfma_f32_16x16x32_bf16 v[148:151], v[24:27], v[92:95], v[148:151]
v_mfma_f32_16x16x32_bf16 v[152:155], v[24:27], v[100:103], v[152:155]
v_mfma_f32_16x16x32_bf16 v[156:159], v[24:27], v[108:111], v[156:159]
v_mfma_f32_16x16x32_bf16 v[160:163], v[24:27], v[116:119], v[160:163]
s_waitcnt lgkmcnt(0)
v_mfma_f32_16x16x32_bf16 v[164:167], v[28:31], v[60:63], 0
v_mfma_f32_16x16x32_bf16 v[168:171], v[32:35], v[60:63], 0
v_mfma_f32_16x16x32_bf16 v[172:175], v[28:31], v[68:71], 0
v_mfma_f32_16x16x32_bf16 v[176:179], v[32:35], v[68:71], 0
v_mfma_f32_16x16x32_bf16 v[180:183], v[28:31], v[76:79], 0
v_mfma_f32_16x16x32_bf16 v[184:187], v[32:35], v[76:79], 0
v_mfma_f32_16x16x32_bf16 v[188:191], v[28:31], v[84:87], 0
v_mfma_f32_16x16x32_bf16 v[192:195], v[32:35], v[84:87], 0
v_mfma_f32_16x16x32_bf16 v[164:167], v[36:39], v[92:95], v[164:167]
v_mfma_f32_16x16x32_bf16 v[168:171], v[40:43], v[92:95], v[168:171]
v_mfma_f32_16x16x32_bf16 v[172:175], v[36:39], v[100:103], v[172:175]
v_mfma_f32_16x16x32_bf16 v[176:179], v[40:43], v[100:103], v[176:179]
v_mfma_f32_16x16x32_bf16 v[180:183], v[36:39], v[108:111], v[180:183]
v_mfma_f32_16x16x32_bf16 v[184:187], v[40:43], v[108:111], v[184:187]
v_mfma_f32_16x16x32_bf16 v[188:191], v[36:39], v[116:119], v[188:191]
v_mfma_f32_16x16x32_bf16 v[192:195], v[40:43], v[116:119], v[192:195]
v_add_f32 v48, v148, v149
v_add_f32 v150, v150, v151
v_add_f32 v48, v48, v150
v_add_f32 v49, v152, v153
v_add_f32 v154, v154, v155
v_add_f32 v49, v49, v154
v_add_f32 v50, v156, v157
v_add_f32 v158, v158, v159
v_add_f32 v50, v50, v158
v_add_f32 v51, v160, v161
v_add_f32 v162, v162, v163
v_add_f32 v51, v51, v162
s_nop 1
v_permlane32_swap_b32 v48, v49
v_permlane32_swap_b32 v50, v51
s_nop 0
v_add_f32 v48, v48, v49
v_add_f32 v50, v50, v51
s_nop 1
v_permlane16_swap_b32 v48, v50
s_nop 0
v_add_f32 v48, v48, v50
v_add_f32 v48, 0x358637bd, v48
v_rcp_f32 v48, v48
s_nop 0
v_mov_b32 v50, v48
s_nop 1
v_permlane16_swap_b32 v48, v50
s_nop 0
v_mov_b32 v49, v48
v_mov_b32 v51, v50
s_nop 1
v_permlane32_swap_b32 v48, v49
v_permlane32_swap_b32 v50, v51
s_nop 0
s_lshl_b32 s48, s41, 3
s_lshl_b32 s49, s44, 2
s_add_u32 s48, s48, s49
s_lshl_b32 s48, s48, 5
s_add_u32 s48, s48, s45
s_lshl_b32 s48, s48, 10
s_add_u32 s48, s48, 4194304
s_add_u32 s49, s48, 32768
s_add_u32 s50, s48, 65536
s_add_u32 s51, s48, 98304
s_lshl_b32 s52, s41, 2
s_add_u32 s52, s52, s44
s_lshl_b32 s52, s52, 7
s_add_u32 s52, s52, 14155776
s_cmp_eq_u32 s46, 0
s_cbranch_scc1 slow_11
v_pk_mul_f32 v[164:165], v[164:165], v[48:49] op_sel:[0,0] op_sel_hi:[1,0]
v_pk_mul_f32 v[166:167], v[166:167], v[48:49] op_sel:[0,0] op_sel_hi:[1,0]
v_pk_mul_f32 v[168:169], v[168:169], v[48:49] op_sel:[0,0] op_sel_hi:[1,0]
v_pk_mul_f32 v[170:171], v[170:171], v[48:49] op_sel:[0,0] op_sel_hi:[1,0]
v_cvt_pk_bf16_f32 v164, v164, v165
v_cvt_pk_bf16_f32 v165, v166, v167
v_cvt_pk_bf16_f32 v166, v168, v169
v_cvt_pk_bf16_f32 v167, v170, v171
buffer_store_dwordx4 v[164:167], v18, s[32:35], s48 offen
v_pk_mul_f32 v[172:173], v[172:173], v[48:49] op_sel:[0,1] op_sel_hi:[1,1]
v_pk_mul_f32 v[174:175], v[174:175], v[48:49] op_sel:[0,1] op_sel_hi:[1,1]
v_pk_mul_f32 v[176:177], v[176:177], v[48:49] op_sel:[0,1] op_sel_hi:[1,1]
v_pk_mul_f32 v[178:179], v[178:179], v[48:49] op_sel:[0,1] op_sel_hi:[1,1]
v_cvt_pk_bf16_f32 v172, v172, v173
v_cvt_pk_bf16_f32 v173, v174, v175
v_cvt_pk_bf16_f32 v174, v176, v177
v_cvt_pk_bf16_f32 v175, v178, v179
buffer_store_dwordx4 v[172:175], v18, s[32:35], s49 offen
v_pk_mul_f32 v[180:181], v[180:181], v[50:51] op_sel:[0,0] op_sel_hi:[1,0]
v_pk_mul_f32 v[182:183], v[182:183], v[50:51] op_sel:[0,0] op_sel_hi:[1,0]
v_pk_mul_f32 v[184:185], v[184:185], v[50:51] op_sel:[0,0] op_sel_hi:[1,0]
v_pk_mul_f32 v[186:187], v[186:187], v[50:51] op_sel:[0,0] op_sel_hi:[1,0]
v_cvt_pk_bf16_f32 v180, v180, v181
v_cvt_pk_bf16_f32 v181, v182, v183
v_cvt_pk_bf16_f32 v182, v184, v185
v_cvt_pk_bf16_f32 v183, v186, v187
buffer_store_dwordx4 v[180:183], v18, s[32:35], s50 offen
v_pk_mul_f32 v[188:189], v[188:189], v[50:51] op_sel:[0,1] op_sel_hi:[1,1]
v_pk_mul_f32 v[190:191], v[190:191], v[50:51] op_sel:[0,1] op_sel_hi:[1,1]
v_pk_mul_f32 v[192:193], v[192:193], v[50:51] op_sel:[0,1] op_sel_hi:[1,1]
v_pk_mul_f32 v[194:195], v[194:195], v[50:51] op_sel:[0,1] op_sel_hi:[1,1]
v_cvt_pk_bf16_f32 v188, v188, v189
v_cvt_pk_bf16_f32 v189, v190, v191
v_cvt_pk_bf16_f32 v190, v192, v193
v_cvt_pk_bf16_f32 v191, v194, v195
buffer_store_dwordx4 v[188:191], v18, s[32:35], s51 offen
s_waitcnt vmcnt(0)
s_lshl_b32 s62, s45, 2
v_mov_b32 v4, s62
v_mov_b32 v5, 2
s_mov_b64 exec, 1
buffer_store_dword v5, v4, s[32:35], s52 offen
s_mov_b64 exec, -1
back_12:
s_lshl_b32 s48, s41, 3
s_lshl_b32 s49, s40, 1
s_add_u32 s48, s48, s49
s_lshl_b32 s48, s48, 15
s_lshl_b32 s49, s42, 11
s_add_u32 s48, s48, s49
s_add_u32 s49, s48, 32768
buffer_load_dwordx4 v[88:91], v18, s[32:35], s48 offen offset:0 sc1
buffer_load_dwordx4 v[92:95], v18, s[32:35], s48 offen offset:1024 sc1
buffer_load_dwordx4 v[96:99], v18, s[32:35], s49 offen offset:0 sc1
buffer_load_dwordx4 v[100:103], v18, s[32:35], s49 offen offset:1024 sc1
v_lshrrev_b32 v4, 2, v2
v_and_b32 v5, 3, v0
v_lshl_add_u32 v6, v3, 3, v4
v_lshlrev_b32 v6, 7, v6
v_lshl_add_u32 v6, v5, 3, v6
v_lshrrev_b32 v7, 1, v4
v_and_b32 v8, 1, v3
v_lshl_add_u32 v7, v8, 1, v7
v_lshl_add_u32 v14, v7, 5, v6
v_xor_b32 v15, 32, v14
v_xor_b32 v16, 64, v14
v_xor_b32 v17, 96, v14
s_lshl_b32 s48, s41, 3
s_lshl_b32 s49, s40, 1
s_add_u32 s56, s48, s49
s_lshl_b32 s48, s56, 15
s_add_u32 s48, s48, 4194304
v_add_u32 v12, s48, v18
v_add_u32 v13, 32768, v12
v_mov_b32 v20, 0
v_mov_b32 v21, 0
v_mov_b32 v22, 0
v_mov_b32 v23, 0
v_mov_b32 v24, 0
v_mov_b32 v25, 0
v_mov_b32 v26, 0
v_mov_b32 v27, 0
v_mov_b32 v28, 0
v_mov_b32 v29, 0
v_mov_b32 v30, 0
v_mov_b32 v31, 0
v_mov_b32 v32, 0
v_mov_b32 v33, 0
v_mov_b32 v34, 0
v_mov_b32 v35, 0
v_mov_b32 v36, 0
v_mov_b32 v37, 0
v_mov_b32 v38, 0
v_mov_b32 v39, 0
v_mov_b32 v40, 0
v_mov_b32 v41, 0
v_mov_b32 v42, 0
v_mov_b32 v43, 0
v_mov_b32 v44, 0
v_mov_b32 v45, 0
v_mov_b32 v46, 0
v_mov_b32 v47, 0
v_mov_b32 v48, 0
v_mov_b32 v49, 0
v_mov_b32 v50, 0
v_mov_b32 v51, 0
s_lshl_b32 s57, s47, 11
s_lshl_b32 s52, s41, 2
s_add_u32 s52, s52, s44
s_lshl_b32 s52, s52, 7
s_add_u32 s52, s52, 14155776
v_and_b32 v4, 31, v0
v_lshlrev_b32 v4, 2, v4
buffer_load_dword v5, v4, s[32:35], s52 offen sc1
s_barrier
ds_read_b64_tr_b16 v[212:213], v14 offset:0
ds_read_b64_tr_b16 v[214:215], v14 offset:512
ds_read_b64_tr_b16 v[216:217], v15 offset:0
ds_read_b64_tr_b16 v[218:219], v15 offset:512
ds_read_b64_tr_b16 v[220:221], v16 offset:0
ds_read_b64_tr_b16 v[222:223], v16 offset:512
ds_read_b64_tr_b16 v[224:225], v17 offset:0
ds_read_b64_tr_b16 v[226:227], v17 offset:512
s_mov_b32 s63, 0
s_waitcnt vmcnt(0)
poll_13:
v_cmp_gt_u32 vcc, 2, v5
s_cbranch_vccz polled_14
buffer_load_dword v5, v4, s[32:35], s52 offen sc1
s_add_u32 s63, s63, 1
s_cmp_lt_u32 s63, 0x80000
s_waitcnt vmcnt(0)
s_cbranch_scc1 poll_13
polled_14:
buffer_load_dwordx4 v[148:151], v12, s[32:35], s57 offen sc1
buffer_load_dwordx4 v[152:155], v13, s[32:35], s57 offen sc1
buffer_load_dwordx4 v[156:159], v12, s[32:35], s57 offen offset:1024 sc1
buffer_load_dwordx4 v[160:163], v13, s[32:35], s57 offen offset:1024 sc1
s_add_u32 s57, s57, 2048
s_and_b32 s57, s57, 0x7fff
buffer_load_dwordx4 v[164:167], v12, s[32:35], s57 offen sc1
buffer_load_dwordx4 v[168:171], v13, s[32:35], s57 offen sc1
buffer_load_dwordx4 v[172:175], v12, s[32:35], s57 offen offset:1024 sc1
buffer_load_dwordx4 v[176:179], v13, s[32:35], s57 offen offset:1024 sc1
s_add_u32 s57, s57, 2048
s_and_b32 s57, s57, 0x7fff
buffer_load_dwordx4 v[180:183], v12, s[32:35], s57 offen sc1
buffer_load_dwordx4 v[184:187], v13, s[32:35], s57 offen sc1
buffer_load_dwordx4 v[188:191], v12, s[32:35], s57 offen offset:1024 sc1
buffer_load_dwordx4 v[192:195], v13, s[32:35], s57 offen offset:1024 sc1
s_add_u32 s57, s57, 2048
s_and_b32 s57, s57, 0x7fff
s_waitcnt vmcnt(10) lgkmcnt(0)
v_mfma_f32_16x16x32_bf16 v[20:23], v[212:215], v[148:151], v[20:23]
ds_read_b64_tr_b16 v[228:229], v14 offset:4096
ds_read_b64_tr_b16 v[230:231], v14 offset:4608
v_mfma_f32_16x16x32_bf16 v[36:39], v[212:215], v[152:155], v[36:39]
ds_read_b64_tr_b16 v[232:233], v15 offset:4096
v_mfma_f32_16x16x32_bf16 v[24:27], v[216:219], v[148:151], v[24:27]
ds_read_b64_tr_b16 v[234:235], v15 offset:4608
ds_read_b64_tr_b16 v[236:237], v16 offset:4096
v_mfma_f32_16x16x32_bf16 v[40:43], v[216:219], v[152:155], v[40:43]
ds_read_b64_tr_b16 v[238:239], v16 offset:4608
v_mfma_f32_16x16x32_bf16 v[28:31], v[220:223], v[148:151], v[28:31]
ds_read_b64_tr_b16 v[240:241], v17 offset:4096
ds_read_b64_tr_b16 v[242:243], v17 offset:4608
v_mfma_f32_16x16x32_bf16 v[44:47], v[220:223], v[152:155], v[44:47]
buffer_load_dwordx4 v[196:199], v12, s[32:35], s57 offen sc1
v_mfma_f32_16x16x32_bf16 v[32:35], v[224:227], v[148:151], v[32:35]
buffer_load_dwordx4 v[200:203], v13, s[32:35], s57 offen sc1
buffer_load_dwordx4 v[204:207], v12, s[32:35], s57 offen offset:1024 sc1
v_mfma_f32_16x16x32_bf16 v[48:51], v[224:227], v[152:155], v[48:51]
buffer_load_dwordx4 v[208:211], v13, s[32:35], s57 offen offset:1024 sc1
s_add_u32 s57, s57, 2048
s_and_b32 s57, s57, 0x7fff
s_waitcnt vmcnt(12) lgkmcnt(0)
v_mfma_f32_16x16x32_bf16 v[20:23], v[228:231], v[156:159], v[20:23]
ds_read_b64_tr_b16 v[212:213], v14 offset:8192
v_mfma_f32_16x16x32_bf16 v[36:39], v[228:231], v[160:163], v[36:39]
ds_read_b64_tr_b16 v[214:215], v14 offset:8704
v_mfma_f32_16x16x32_bf16 v[24:27], v[232:235], v[156:159], v[24:27]
ds_read_b64_tr_b16 v[216:217], v15 offset:8192
v_mfma_f32_16x16x32_bf16 v[40:43], v[232:235], v[160:163], v[40:43]
ds_read_b64_tr_b16 v[218:219], v15 offset:8704
v_mfma_f32_16x16x32_bf16 v[28:31], v[236:239], v[156:159], v[28:31]
ds_read_b64_tr_b16 v[220:221], v16 offset:8192
v_mfma_f32_16x16x32_bf16 v[44:47], v[236:239], v[160:163], v[44:47]
ds_read_b64_tr_b16 v[222:223], v16 offset:8704
v_mfma_f32_16x16x32_bf16 v[32:35], v[240:243], v[156:159], v[32:35]
ds_read_b64_tr_b16 v[224:225], v17 offset:8192
v_mfma_f32_16x16x32_bf16 v[48:51], v[240:243], v[160:163], v[48:51]
ds_read_b64_tr_b16 v[226:227], v17 offset:8704
s_waitcnt vmcnt(10) lgkmcnt(0)
v_mfma_f32_16x16x32_bf16 v[20:23], v[212:215], v[164:167], v[20:23]
ds_read_b64_tr_b16 v[228:229], v14 offset:12288
ds_read_b64_tr_b16 v[230:231], v14 offset:12800
v_mfma_f32_16x16x32_bf16 v[36:39], v[212:215], v[168:171], v[36:39]
ds_read_b64_tr_b16 v[232:233], v15 offset:12288
v_mfma_f32_16x16x32_bf16 v[24:27], v[216:219], v[164:167], v[24:27]
ds_read_b64_tr_b16 v[234:235], v15 offset:12800
ds_read_b64_tr_b16 v[236:237], v16 offset:12288
v_mfma_f32_16x16x32_bf16 v[40:43], v[216:219], v[168:171], v[40:43]
ds_read_b64_tr_b16 v[238:239], v16 offset:12800
v_mfma_f32_16x16x32_bf16 v[28:31], v[220:223], v[164:167], v[28:31]
ds_read_b64_tr_b16 v[240:241], v17 offset:12288
ds_read_b64_tr_b16 v[242:243], v17 offset:12800
v_mfma_f32_16x16x32_bf16 v[44:47], v[220:223], v[168:171], v[44:47]
buffer_load_dwordx4 v[148:151], v12, s[32:35], s57 offen sc1
v_mfma_f32_16x16x32_bf16 v[32:35], v[224:227], v[164:167], v[32:35]
buffer_load_dwordx4 v[152:155], v13, s[32:35], s57 offen sc1
buffer_load_dwordx4 v[156:159], v12, s[32:35], s57 offen offset:1024 sc1
v_mfma_f32_16x16x32_bf16 v[48:51], v[224:227], v[168:171], v[48:51]
buffer_load_dwordx4 v[160:163], v13, s[32:35], s57 offen offset:1024 sc1
s_add_u32 s57, s57, 2048
s_and_b32 s57, s57, 0x7fff
s_waitcnt vmcnt(12) lgkmcnt(0)
v_mfma_f32_16x16x32_bf16 v[20:23], v[228:231], v[172:175], v[20:23]
ds_read_b64_tr_b16 v[212:213], v14 offset:16384
v_mfma_f32_16x16x32_bf16 v[36:39], v[228:231], v[176:179], v[36:39]
ds_read_b64_tr_b16 v[214:215], v14 offset:16896
v_mfma_f32_16x16x32_bf16 v[24:27], v[232:235], v[172:175], v[24:27]
ds_read_b64_tr_b16 v[216:217], v15 offset:16384
v_mfma_f32_16x16x32_bf16 v[40:43], v[232:235], v[176:179], v[40:43]
ds_read_b64_tr_b16 v[218:219], v15 offset:16896
v_mfma_f32_16x16x32_bf16 v[28:31], v[236:239], v[172:175], v[28:31]
ds_read_b64_tr_b16 v[220:221], v16 offset:16384
v_mfma_f32_16x16x32_bf16 v[44:47], v[236:239], v[176:179], v[44:47]
ds_read_b64_tr_b16 v[222:223], v16 offset:16896
v_mfma_f32_16x16x32_bf16 v[32:35], v[240:243], v[172:175], v[32:35]
ds_read_b64_tr_b16 v[224:225], v17 offset:16384
v_mfma_f32_16x16x32_bf16 v[48:51], v[240:243], v[176:179], v[48:51]
ds_read_b64_tr_b16 v[226:227], v17 offset:16896
s_waitcnt vmcnt(10) lgkmcnt(0)
v_mfma_f32_16x16x32_bf16 v[20:23], v[212:215], v[180:183], v[20:23]
ds_read_b64_tr_b16 v[228:229], v14 offset:20480
ds_read_b64_tr_b16 v[230:231], v14 offset:20992
v_mfma_f32_16x16x32_bf16 v[36:39], v[212:215], v[184:187], v[36:39]
ds_read_b64_tr_b16 v[232:233], v15 offset:20480
v_mfma_f32_16x16x32_bf16 v[24:27], v[216:219], v[180:183], v[24:27]
ds_read_b64_tr_b16 v[234:235], v15 offset:20992
ds_read_b64_tr_b16 v[236:237], v16 offset:20480
v_mfma_f32_16x16x32_bf16 v[40:43], v[216:219], v[184:187], v[40:43]
ds_read_b64_tr_b16 v[238:239], v16 offset:20992
v_mfma_f32_16x16x32_bf16 v[28:31], v[220:223], v[180:183], v[28:31]
ds_read_b64_tr_b16 v[240:241], v17 offset:20480
ds_read_b64_tr_b16 v[242:243], v17 offset:20992
v_mfma_f32_16x16x32_bf16 v[44:47], v[220:223], v[184:187], v[44:47]
buffer_load_dwordx4 v[164:167], v12, s[32:35], s57 offen sc1
v_mfma_f32_16x16x32_bf16 v[32:35], v[224:227], v[180:183], v[32:35]
buffer_load_dwordx4 v[168:171], v13, s[32:35], s57 offen sc1
buffer_load_dwordx4 v[172:175], v12, s[32:35], s57 offen offset:1024 sc1
v_mfma_f32_16x16x32_bf16 v[48:51], v[224:227], v[184:187], v[48:51]
buffer_load_dwordx4 v[176:179], v13, s[32:35], s57 offen offset:1024 sc1
s_add_u32 s57, s57, 2048
s_and_b32 s57, s57, 0x7fff
s_waitcnt vmcnt(12) lgkmcnt(0)
v_mfma_f32_16x16x32_bf16 v[20:23], v[228:231], v[188:191], v[20:23]
ds_read_b64_tr_b16 v[212:213], v14 offset:24576
v_mfma_f32_16x16x32_bf16 v[36:39], v[228:231], v[192:195], v[36:39]
ds_read_b64_tr_b16 v[214:215], v14 offset:25088
v_mfma_f32_16x16x32_bf16 v[24:27], v[232:235], v[188:191], v[24:27]
ds_read_b64_tr_b16 v[216:217], v15 offset:24576
v_mfma_f32_16x16x32_bf16 v[40:43], v[232:235], v[192:195], v[40:43]
ds_read_b64_tr_b16 v[218:219], v15 offset:25088
v_mfma_f32_16x16x32_bf16 v[28:31], v[236:239], v[188:191], v[28:31]
ds_read_b64_tr_b16 v[220:221], v16 offset:24576
v_mfma_f32_16x16x32_bf16 v[44:47], v[236:239], v[192:195], v[44:47]
ds_read_b64_tr_b16 v[222:223], v16 offset:25088
v_mfma_f32_16x16x32_bf16 v[32:35], v[240:243], v[188:191], v[32:35]
ds_read_b64_tr_b16 v[224:225], v17 offset:24576
v_mfma_f32_16x16x32_bf16 v[48:51], v[240:243], v[192:195], v[48:51]
ds_read_b64_tr_b16 v[226:227], v17 offset:25088
s_waitcnt vmcnt(10) lgkmcnt(0)
v_mfma_f32_16x16x32_bf16 v[20:23], v[212:215], v[196:199], v[20:23]
ds_read_b64_tr_b16 v[228:229], v14 offset:28672
ds_read_b64_tr_b16 v[230:231], v14 offset:29184
v_mfma_f32_16x16x32_bf16 v[36:39], v[212:215], v[200:203], v[36:39]
ds_read_b64_tr_b16 v[232:233], v15 offset:28672
v_mfma_f32_16x16x32_bf16 v[24:27], v[216:219], v[196:199], v[24:27]
ds_read_b64_tr_b16 v[234:235], v15 offset:29184
ds_read_b64_tr_b16 v[236:237], v16 offset:28672
v_mfma_f32_16x16x32_bf16 v[40:43], v[216:219], v[200:203], v[40:43]
ds_read_b64_tr_b16 v[238:239], v16 offset:29184
v_mfma_f32_16x16x32_bf16 v[28:31], v[220:223], v[196:199], v[28:31]
ds_read_b64_tr_b16 v[240:241], v17 offset:28672
ds_read_b64_tr_b16 v[242:243], v17 offset:29184
v_mfma_f32_16x16x32_bf16 v[44:47], v[220:223], v[200:203], v[44:47]
buffer_load_dwordx4 v[180:183], v12, s[32:35], s57 offen sc1
v_mfma_f32_16x16x32_bf16 v[32:35], v[224:227], v[196:199], v[32:35]
buffer_load_dwordx4 v[184:187], v13, s[32:35], s57 offen sc1
buffer_load_dwordx4 v[188:191], v12, s[32:35], s57 offen offset:1024 sc1
v_mfma_f32_16x16x32_bf16 v[48:51], v[224:227], v[200:203], v[48:51]
buffer_load_dwordx4 v[192:195], v13, s[32:35], s57 offen offset:1024 sc1
s_add_u32 s57, s57, 2048
s_and_b32 s57, s57, 0x7fff
s_waitcnt vmcnt(12) lgkmcnt(0)
v_mfma_f32_16x16x32_bf16 v[20:23], v[228:231], v[204:207], v[20:23]
ds_read_b64_tr_b16 v[212:213], v14 offset:32768
v_mfma_f32_16x16x32_bf16 v[36:39], v[228:231], v[208:211], v[36:39]
ds_read_b64_tr_b16 v[214:215], v14 offset:33280
v_mfma_f32_16x16x32_bf16 v[24:27], v[232:235], v[204:207], v[24:27]
ds_read_b64_tr_b16 v[216:217], v15 offset:32768
v_mfma_f32_16x16x32_bf16 v[40:43], v[232:235], v[208:211], v[40:43]
ds_read_b64_tr_b16 v[218:219], v15 offset:33280
v_mfma_f32_16x16x32_bf16 v[28:31], v[236:239], v[204:207], v[28:31]
ds_read_b64_tr_b16 v[220:221], v16 offset:32768
v_mfma_f32_16x16x32_bf16 v[44:47], v[236:239], v[208:211], v[44:47]
ds_read_b64_tr_b16 v[222:223], v16 offset:33280
v_mfma_f32_16x16x32_bf16 v[32:35], v[240:243], v[204:207], v[32:35]
ds_read_b64_tr_b16 v[224:225], v17 offset:32768
v_mfma_f32_16x16x32_bf16 v[48:51], v[240:243], v[208:211], v[48:51]
ds_read_b64_tr_b16 v[226:227], v17 offset:33280
s_waitcnt vmcnt(10) lgkmcnt(0)
v_mfma_f32_16x16x32_bf16 v[20:23], v[212:215], v[148:151], v[20:23]
ds_read_b64_tr_b16 v[228:229], v14 offset:36864
ds_read_b64_tr_b16 v[230:231], v14 offset:37376
v_mfma_f32_16x16x32_bf16 v[36:39], v[212:215], v[152:155], v[36:39]
ds_read_b64_tr_b16 v[232:233], v15 offset:36864
v_mfma_f32_16x16x32_bf16 v[24:27], v[216:219], v[148:151], v[24:27]
ds_read_b64_tr_b16 v[234:235], v15 offset:37376
ds_read_b64_tr_b16 v[236:237], v16 offset:36864
v_mfma_f32_16x16x32_bf16 v[40:43], v[216:219], v[152:155], v[40:43]
ds_read_b64_tr_b16 v[238:239], v16 offset:37376
v_mfma_f32_16x16x32_bf16 v[28:31], v[220:223], v[148:151], v[28:31]
ds_read_b64_tr_b16 v[240:241], v17 offset:36864
ds_read_b64_tr_b16 v[242:243], v17 offset:37376
v_mfma_f32_16x16x32_bf16 v[44:47], v[220:223], v[152:155], v[44:47]
buffer_load_dwordx4 v[196:199], v12, s[32:35], s57 offen sc1
v_mfma_f32_16x16x32_bf16 v[32:35], v[224:227], v[148:151], v[32:35]
buffer_load_dwordx4 v[200:203], v13, s[32:35], s57 offen sc1
buffer_load_dwordx4 v[204:207], v12, s[32:35], s57 offen offset:1024 sc1
v_mfma_f32_16x16x32_bf16 v[48:51], v[224:227], v[152:155], v[48:51]
buffer_load_dwordx4 v[208:211], v13, s[32:35], s57 offen offset:1024 sc1
s_add_u32 s57, s57, 2048
s_and_b32 s57, s57, 0x7fff
s_waitcnt vmcnt(12) lgkmcnt(0)
v_mfma_f32_16x16x32_bf16 v[20:23], v[228:231], v[156:159], v[20:23]
ds_read_b64_tr_b16 v[212:213], v14 offset:40960
v_mfma_f32_16x16x32_bf16 v[36:39], v[228:231], v[160:163], v[36:39]
ds_read_b64_tr_b16 v[214:215], v14 offset:41472
v_mfma_f32_16x16x32_bf16 v[24:27], v[232:235], v[156:159], v[24:27]
ds_read_b64_tr_b16 v[216:217], v15 offset:40960
v_mfma_f32_16x16x32_bf16 v[40:43], v[232:235], v[160:163], v[40:43]
ds_read_b64_tr_b16 v[218:219], v15 offset:41472
v_mfma_f32_16x16x32_bf16 v[28:31], v[236:239], v[156:159], v[28:31]
ds_read_b64_tr_b16 v[220:221], v16 offset:40960
v_mfma_f32_16x16x32_bf16 v[44:47], v[236:239], v[160:163], v[44:47]
ds_read_b64_tr_b16 v[222:223], v16 offset:41472
v_mfma_f32_16x16x32_bf16 v[32:35], v[240:243], v[156:159], v[32:35]
ds_read_b64_tr_b16 v[224:225], v17 offset:40960
v_mfma_f32_16x16x32_bf16 v[48:51], v[240:243], v[160:163], v[48:51]
ds_read_b64_tr_b16 v[226:227], v17 offset:41472
s_waitcnt vmcnt(10) lgkmcnt(0)
v_mfma_f32_16x16x32_bf16 v[20:23], v[212:215], v[164:167], v[20:23]
ds_read_b64_tr_b16 v[228:229], v14 offset:45056
ds_read_b64_tr_b16 v[230:231], v14 offset:45568
v_mfma_f32_16x16x32_bf16 v[36:39], v[212:215], v[168:171], v[36:39]
ds_read_b64_tr_b16 v[232:233], v15 offset:45056
v_mfma_f32_16x16x32_bf16 v[24:27], v[216:219], v[164:167], v[24:27]
ds_read_b64_tr_b16 v[234:235], v15 offset:45568
ds_read_b64_tr_b16 v[236:237], v16 offset:45056
v_mfma_f32_16x16x32_bf16 v[40:43], v[216:219], v[168:171], v[40:43]
ds_read_b64_tr_b16 v[238:239], v16 offset:45568
v_mfma_f32_16x16x32_bf16 v[28:31], v[220:223], v[164:167], v[28:31]
ds_read_b64_tr_b16 v[240:241], v17 offset:45056
ds_read_b64_tr_b16 v[242:243], v17 offset:45568
v_mfma_f32_16x16x32_bf16 v[44:47], v[220:223], v[168:171], v[44:47]
buffer_load_dwordx4 v[148:151], v12, s[32:35], s57 offen sc1
v_mfma_f32_16x16x32_bf16 v[32:35], v[224:227], v[164:167], v[32:35]
buffer_load_dwordx4 v[152:155], v13, s[32:35], s57 offen sc1
buffer_load_dwordx4 v[156:159], v12, s[32:35], s57 offen offset:1024 sc1
v_mfma_f32_16x16x32_bf16 v[48:51], v[224:227], v[168:171], v[48:51]
buffer_load_dwordx4 v[160:163], v13, s[32:35], s57 offen offset:1024 sc1
s_add_u32 s57, s57, 2048
s_and_b32 s57, s57, 0x7fff
s_waitcnt vmcnt(12) lgkmcnt(0)
v_mfma_f32_16x16x32_bf16 v[20:23], v[228:231], v[172:175], v[20:23]
ds_read_b64_tr_b16 v[212:213], v14 offset:49152
v_mfma_f32_16x16x32_bf16 v[36:39], v[228:231], v[176:179], v[36:39]
ds_read_b64_tr_b16 v[214:215], v14 offset:49664
v_mfma_f32_16x16x32_bf16 v[24:27], v[232:235], v[172:175], v[24:27]
ds_read_b64_tr_b16 v[216:217], v15 offset:49152
v_mfma_f32_16x16x32_bf16 v[40:43], v[232:235], v[176:179], v[40:43]
ds_read_b64_tr_b16 v[218:219], v15 offset:49664
v_mfma_f32_16x16x32_bf16 v[28:31], v[236:239], v[172:175], v[28:31]
ds_read_b64_tr_b16 v[220:221], v16 offset:49152
v_mfma_f32_16x16x32_bf16 v[44:47], v[236:239], v[176:179], v[44:47]
ds_read_b64_tr_b16 v[222:223], v16 offset:49664
v_mfma_f32_16x16x32_bf16 v[32:35], v[240:243], v[172:175], v[32:35]
ds_read_b64_tr_b16 v[224:225], v17 offset:49152
v_mfma_f32_16x16x32_bf16 v[48:51], v[240:243], v[176:179], v[48:51]
ds_read_b64_tr_b16 v[226:227], v17 offset:49664
s_waitcnt vmcnt(10) lgkmcnt(0)
v_mfma_f32_16x16x32_bf16 v[20:23], v[212:215], v[180:183], v[20:23]
ds_read_b64_tr_b16 v[228:229], v14 offset:53248
ds_read_b64_tr_b16 v[230:231], v14 offset:53760
v_mfma_f32_16x16x32_bf16 v[36:39], v[212:215], v[184:187], v[36:39]
ds_read_b64_tr_b16 v[232:233], v15 offset:53248
v_mfma_f32_16x16x32_bf16 v[24:27], v[216:219], v[180:183], v[24:27]
ds_read_b64_tr_b16 v[234:235], v15 offset:53760
ds_read_b64_tr_b16 v[236:237], v16 offset:53248
v_mfma_f32_16x16x32_bf16 v[40:43], v[216:219], v[184:187], v[40:43]
ds_read_b64_tr_b16 v[238:239], v16 offset:53760
v_mfma_f32_16x16x32_bf16 v[28:31], v[220:223], v[180:183], v[28:31]
ds_read_b64_tr_b16 v[240:241], v17 offset:53248
ds_read_b64_tr_b16 v[242:243], v17 offset:53760
v_mfma_f32_16x16x32_bf16 v[44:47], v[220:223], v[184:187], v[44:47]
buffer_load_dwordx4 v[164:167], v12, s[32:35], s57 offen sc1
v_mfma_f32_16x16x32_bf16 v[32:35], v[224:227], v[180:183], v[32:35]
buffer_load_dwordx4 v[168:171], v13, s[32:35], s57 offen sc1
buffer_load_dwordx4 v[172:175], v12, s[32:35], s57 offen offset:1024 sc1
v_mfma_f32_16x16x32_bf16 v[48:51], v[224:227], v[184:187], v[48:51]
buffer_load_dwordx4 v[176:179], v13, s[32:35], s57 offen offset:1024 sc1
s_add_u32 s57, s57, 2048
s_and_b32 s57, s57, 0x7fff
s_waitcnt vmcnt(12) lgkmcnt(0)
v_mfma_f32_16x16x32_bf16 v[20:23], v[228:231], v[188:191], v[20:23]
ds_read_b64_tr_b16 v[212:213], v14 offset:57344
v_mfma_f32_16x16x32_bf16 v[36:39], v[228:231], v[192:195], v[36:39]
ds_read_b64_tr_b16 v[214:215], v14 offset:57856
v_mfma_f32_16x16x32_bf16 v[24:27], v[232:235], v[188:191], v[24:27]
ds_read_b64_tr_b16 v[216:217], v15 offset:57344
v_mfma_f32_16x16x32_bf16 v[40:43], v[232:235], v[192:195], v[40:43]
ds_read_b64_tr_b16 v[218:219], v15 offset:57856
v_mfma_f32_16x16x32_bf16 v[28:31], v[236:239], v[188:191], v[28:31]
ds_read_b64_tr_b16 v[220:221], v16 offset:57344
v_mfma_f32_16x16x32_bf16 v[44:47], v[236:239], v[192:195], v[44:47]
ds_read_b64_tr_b16 v[222:223], v16 offset:57856
v_mfma_f32_16x16x32_bf16 v[32:35], v[240:243], v[188:191], v[32:35]
ds_read_b64_tr_b16 v[224:225], v17 offset:57344
v_mfma_f32_16x16x32_bf16 v[48:51], v[240:243], v[192:195], v[48:51]
ds_read_b64_tr_b16 v[226:227], v17 offset:57856
s_waitcnt vmcnt(10) lgkmcnt(0)
v_mfma_f32_16x16x32_bf16 v[20:23], v[212:215], v[196:199], v[20:23]
ds_read_b64_tr_b16 v[228:229], v14 offset:61440
ds_read_b64_tr_b16 v[230:231], v14 offset:61952
v_mfma_f32_16x16x32_bf16 v[36:39], v[212:215], v[200:203], v[36:39]
ds_read_b64_tr_b16 v[232:233], v15 offset:61440
v_mfma_f32_16x16x32_bf16 v[24:27], v[216:219], v[196:199], v[24:27]
ds_read_b64_tr_b16 v[234:235], v15 offset:61952
ds_read_b64_tr_b16 v[236:237], v16 offset:61440
v_mfma_f32_16x16x32_bf16 v[40:43], v[216:219], v[200:203], v[40:43]
ds_read_b64_tr_b16 v[238:239], v16 offset:61952
v_mfma_f32_16x16x32_bf16 v[28:31], v[220:223], v[196:199], v[28:31]
ds_read_b64_tr_b16 v[240:241], v17 offset:61440
ds_read_b64_tr_b16 v[242:243], v17 offset:61952
v_mfma_f32_16x16x32_bf16 v[44:47], v[220:223], v[200:203], v[44:47]
buffer_load_dwordx4 v[180:183], v12, s[32:35], s57 offen sc1
v_mfma_f32_16x16x32_bf16 v[32:35], v[224:227], v[196:199], v[32:35]
buffer_load_dwordx4 v[184:187], v13, s[32:35], s57 offen sc1
buffer_load_dwordx4 v[188:191], v12, s[32:35], s57 offen offset:1024 sc1
v_mfma_f32_16x16x32_bf16 v[48:51], v[224:227], v[200:203], v[48:51]
buffer_load_dwordx4 v[192:195], v13, s[32:35], s57 offen offset:1024 sc1
s_add_u32 s57, s57, 2048
s_and_b32 s57, s57, 0x7fff
s_waitcnt vmcnt(12) lgkmcnt(0)
v_add_u32 v14, 0x10000, v14
v_add_u32 v15, 0x10000, v15
v_add_u32 v16, 0x10000, v16
v_add_u32 v17, 0x10000, v17
v_mfma_f32_16x16x32_bf16 v[20:23], v[228:231], v[204:207], v[20:23]
ds_read_b64_tr_b16 v[212:213], v14 offset:0
v_mfma_f32_16x16x32_bf16 v[36:39], v[228:231], v[208:211], v[36:39]
ds_read_b64_tr_b16 v[214:215], v14 offset:512
v_mfma_f32_16x16x32_bf16 v[24:27], v[232:235], v[204:207], v[24:27]
ds_read_b64_tr_b16 v[216:217], v15 offset:0
v_mfma_f32_16x16x32_bf16 v[40:43], v[232:235], v[208:211], v[40:43]
ds_read_b64_tr_b16 v[218:219], v15 offset:512
v_mfma_f32_16x16x32_bf16 v[28:31], v[236:239], v[204:207], v[28:31]
ds_read_b64_tr_b16 v[220:221], v16 offset:0
v_mfma_f32_16x16x32_bf16 v[44:47], v[236:239], v[208:211], v[44:47]
ds_read_b64_tr_b16 v[222:223], v16 offset:512
v_mfma_f32_16x16x32_bf16 v[32:35], v[240:243], v[204:207], v[32:35]
ds_read_b64_tr_b16 v[224:225], v17 offset:0
v_mfma_f32_16x16x32_bf16 v[48:51], v[240:243], v[208:211], v[48:51]
ds_read_b64_tr_b16 v[226:227], v17 offset:512
s_waitcnt vmcnt(10) lgkmcnt(0)
v_mfma_f32_16x16x32_bf16 v[20:23], v[212:215], v[148:151], v[20:23]
ds_read_b64_tr_b16 v[228:229], v14 offset:4096
ds_read_b64_tr_b16 v[230:231], v14 offset:4608
v_mfma_f32_16x16x32_bf16 v[36:39], v[212:215], v[152:155], v[36:39]
ds_read_b64_tr_b16 v[232:233], v15 offset:4096
v_mfma_f32_16x16x32_bf16 v[24:27], v[216:219], v[148:151], v[24:27]
ds_read_b64_tr_b16 v[234:235], v15 offset:4608
ds_read_b64_tr_b16 v[236:237], v16 offset:4096
v_mfma_f32_16x16x32_bf16 v[40:43], v[216:219], v[152:155], v[40:43]
ds_read_b64_tr_b16 v[238:239], v16 offset:4608
v_mfma_f32_16x16x32_bf16 v[28:31], v[220:223], v[148:151], v[28:31]
ds_read_b64_tr_b16 v[240:241], v17 offset:4096
ds_read_b64_tr_b16 v[242:243], v17 offset:4608
v_mfma_f32_16x16x32_bf16 v[44:47], v[220:223], v[152:155], v[44:47]
buffer_load_dwordx4 v[196:199], v12, s[32:35], s57 offen sc1
v_mfma_f32_16x16x32_bf16 v[32:35], v[224:227], v[148:151], v[32:35]
buffer_load_dwordx4 v[200:203], v13, s[32:35], s57 offen sc1
buffer_load_dwordx4 v[204:207], v12, s[32:35], s57 offen offset:1024 sc1
v_mfma_f32_16x16x32_bf16 v[48:51], v[224:227], v[152:155], v[48:51]
buffer_load_dwordx4 v[208:211], v13, s[32:35], s57 offen offset:1024 sc1
s_add_u32 s57, s57, 2048
s_and_b32 s57, s57, 0x7fff
s_waitcnt vmcnt(12) lgkmcnt(0)
v_mfma_f32_16x16x32_bf16 v[20:23], v[228:231], v[156:159], v[20:23]
ds_read_b64_tr_b16 v[212:213], v14 offset:8192
v_mfma_f32_16x16x32_bf16 v[36:39], v[228:231], v[160:163], v[36:39]
ds_read_b64_tr_b16 v[214:215], v14 offset:8704
v_mfma_f32_16x16x32_bf16 v[24:27], v[232:235], v[156:159], v[24:27]
ds_read_b64_tr_b16 v[216:217], v15 offset:8192
v_mfma_f32_16x16x32_bf16 v[40:43], v[232:235], v[160:163], v[40:43]
ds_read_b64_tr_b16 v[218:219], v15 offset:8704
v_mfma_f32_16x16x32_bf16 v[28:31], v[236:239], v[156:159], v[28:31]
ds_read_b64_tr_b16 v[220:221], v16 offset:8192
v_mfma_f32_16x16x32_bf16 v[44:47], v[236:239], v[160:163], v[44:47]
ds_read_b64_tr_b16 v[222:223], v16 offset:8704
v_mfma_f32_16x16x32_bf16 v[32:35], v[240:243], v[156:159], v[32:35]
ds_read_b64_tr_b16 v[224:225], v17 offset:8192
v_mfma_f32_16x16x32_bf16 v[48:51], v[240:243], v[160:163], v[48:51]
ds_read_b64_tr_b16 v[226:227], v17 offset:8704
s_waitcnt vmcnt(10) lgkmcnt(0)
v_mfma_f32_16x16x32_bf16 v[20:23], v[212:215], v[164:167], v[20:23]
ds_read_b64_tr_b16 v[228:229], v14 offset:12288
ds_read_b64_tr_b16 v[230:231], v14 offset:12800
v_mfma_f32_16x16x32_bf16 v[36:39], v[212:215], v[168:171], v[36:39]
ds_read_b64_tr_b16 v[232:233], v15 offset:12288
v_mfma_f32_16x16x32_bf16 v[24:27], v[216:219], v[164:167], v[24:27]
ds_read_b64_tr_b16 v[234:235], v15 offset:12800
ds_read_b64_tr_b16 v[236:237], v16 offset:12288
v_mfma_f32_16x16x32_bf16 v[40:43], v[216:219], v[168:171], v[40:43]
ds_read_b64_tr_b16 v[238:239], v16 offset:12800
v_mfma_f32_16x16x32_bf16 v[28:31], v[220:223], v[164:167], v[28:31]
ds_read_b64_tr_b16 v[240:241], v17 offset:12288
ds_read_b64_tr_b16 v[242:243], v17 offset:12800
v_mfma_f32_16x16x32_bf16 v[44:47], v[220:223], v[168:171], v[44:47]
buffer_load_dwordx4 v[148:151], v12, s[32:35], s57 offen sc1
v_mfma_f32_16x16x32_bf16 v[32:35], v[224:227], v[164:167], v[32:35]
buffer_load_dwordx4 v[152:155], v13, s[32:35], s57 offen sc1
buffer_load_dwordx4 v[156:159], v12, s[32:35], s57 offen offset:1024 sc1
v_mfma_f32_16x16x32_bf16 v[48:51], v[224:227], v[168:171], v[48:51]
buffer_load_dwordx4 v[160:163], v13, s[32:35], s57 offen offset:1024 sc1
s_add_u32 s57, s57, 2048
s_and_b32 s57, s57, 0x7fff
s_waitcnt vmcnt(12) lgkmcnt(0)
v_mfma_f32_16x16x32_bf16 v[20:23], v[228:231], v[172:175], v[20:23]
ds_read_b64_tr_b16 v[212:213], v14 offset:16384
v_mfma_f32_16x16x32_bf16 v[36:39], v[228:231], v[176:179], v[36:39]
ds_read_b64_tr_b16 v[214:215], v14 offset:16896
v_mfma_f32_16x16x32_bf16 v[24:27], v[232:235], v[172:175], v[24:27]
ds_read_b64_tr_b16 v[216:217], v15 offset:16384
v_mfma_f32_16x16x32_bf16 v[40:43], v[232:235], v[176:179], v[40:43]
ds_read_b64_tr_b16 v[218:219], v15 offset:16896
v_mfma_f32_16x16x32_bf16 v[28:31], v[236:239], v[172:175], v[28:31]
ds_read_b64_tr_b16 v[220:221], v16 offset:16384
v_mfma_f32_16x16x32_bf16 v[44:47], v[236:239], v[176:179], v[44:47]
ds_read_b64_tr_b16 v[222:223], v16 offset:16896
v_mfma_f32_16x16x32_bf16 v[32:35], v[240:243], v[172:175], v[32:35]
ds_read_b64_tr_b16 v[224:225], v17 offset:16384
v_mfma_f32_16x16x32_bf16 v[48:51], v[240:243], v[176:179], v[48:51]
ds_read_b64_tr_b16 v[226:227], v17 offset:16896
s_waitcnt vmcnt(10) lgkmcnt(0)
v_mfma_f32_16x16x32_bf16 v[20:23], v[212:215], v[180:183], v[20:23]
ds_read_b64_tr_b16 v[228:229], v14 offset:20480
ds_read_b64_tr_b16 v[230:231], v14 offset:20992
v_mfma_f32_16x16x32_bf16 v[36:39], v[212:215], v[184:187], v[36:39]
ds_read_b64_tr_b16 v[232:233], v15 offset:20480
v_mfma_f32_16x16x32_bf16 v[24:27], v[216:219], v[180:183], v[24:27]
ds_read_b64_tr_b16 v[234:235], v15 offset:20992
ds_read_b64_tr_b16 v[236:237], v16 offset:20480
v_mfma_f32_16x16x32_bf16 v[40:43], v[216:219], v[184:187], v[40:43]
ds_read_b64_tr_b16 v[238:239], v16 offset:20992
v_mfma_f32_16x16x32_bf16 v[28:31], v[220:223], v[180:183], v[28:31]
ds_read_b64_tr_b16 v[240:241], v17 offset:20480
ds_read_b64_tr_b16 v[242:243], v17 offset:20992
v_mfma_f32_16x16x32_bf16 v[44:47], v[220:223], v[184:187], v[44:47]
buffer_load_dwordx4 v[164:167], v12, s[32:35], s57 offen sc1
v_mfma_f32_16x16x32_bf16 v[32:35], v[224:227], v[180:183], v[32:35]
buffer_load_dwordx4 v[168:171], v13, s[32:35], s57 offen sc1
buffer_load_dwordx4 v[172:175], v12, s[32:35], s57 offen offset:1024 sc1
v_mfma_f32_16x16x32_bf16 v[48:51], v[224:227], v[184:187], v[48:51]
buffer_load_dwordx4 v[176:179], v13, s[32:35], s57 offen offset:1024 sc1
s_add_u32 s57, s57, 2048
s_and_b32 s57, s57, 0x7fff
s_waitcnt vmcnt(12) lgkmcnt(0)
v_mfma_f32_16x16x32_bf16 v[20:23], v[228:231], v[188:191], v[20:23]
ds_read_b64_tr_b16 v[212:213], v14 offset:24576
v_mfma_f32_16x16x32_bf16 v[36:39], v[228:231], v[192:195], v[36:39]
ds_read_b64_tr_b16 v[214:215], v14 offset:25088
v_mfma_f32_16x16x32_bf16 v[24:27], v[232:235], v[188:191], v[24:27]
ds_read_b64_tr_b16 v[216:217], v15 offset:24576
v_mfma_f32_16x16x32_bf16 v[40:43], v[232:235], v[192:195], v[40:43]
ds_read_b64_tr_b16 v[218:219], v15 offset:25088
v_mfma_f32_16x16x32_bf16 v[28:31], v[236:239], v[188:191], v[28:31]
ds_read_b64_tr_b16 v[220:221], v16 offset:24576
v_mfma_f32_16x16x32_bf16 v[44:47], v[236:239], v[192:195], v[44:47]
ds_read_b64_tr_b16 v[222:223], v16 offset:25088
v_mfma_f32_16x16x32_bf16 v[32:35], v[240:243], v[188:191], v[32:35]
ds_read_b64_tr_b16 v[224:225], v17 offset:24576
v_mfma_f32_16x16x32_bf16 v[48:51], v[240:243], v[192:195], v[48:51]
ds_read_b64_tr_b16 v[226:227], v17 offset:25088
s_waitcnt vmcnt(10) lgkmcnt(0)
v_mfma_f32_16x16x32_bf16 v[20:23], v[212:215], v[196:199], v[20:23]
ds_read_b64_tr_b16 v[228:229], v14 offset:28672
ds_read_b64_tr_b16 v[230:231], v14 offset:29184
v_mfma_f32_16x16x32_bf16 v[36:39], v[212:215], v[200:203], v[36:39]
ds_read_b64_tr_b16 v[232:233], v15 offset:28672
v_mfma_f32_16x16x32_bf16 v[24:27], v[216:219], v[196:199], v[24:27]
ds_read_b64_tr_b16 v[234:235], v15 offset:29184
ds_read_b64_tr_b16 v[236:237], v16 offset:28672
v_mfma_f32_16x16x32_bf16 v[40:43], v[216:219], v[200:203], v[40:43]
ds_read_b64_tr_b16 v[238:239], v16 offset:29184
v_mfma_f32_16x16x32_bf16 v[28:31], v[220:223], v[196:199], v[28:31]
ds_read_b64_tr_b16 v[240:241], v17 offset:28672
ds_read_b64_tr_b16 v[242:243], v17 offset:29184
v_mfma_f32_16x16x32_bf16 v[44:47], v[220:223], v[200:203], v[44:47]
buffer_load_dwordx4 v[180:183], v12, s[32:35], s57 offen sc1
v_mfma_f32_16x16x32_bf16 v[32:35], v[224:227], v[196:199], v[32:35]
buffer_load_dwordx4 v[184:187], v13, s[32:35], s57 offen sc1
buffer_load_dwordx4 v[188:191], v12, s[32:35], s57 offen offset:1024 sc1
v_mfma_f32_16x16x32_bf16 v[48:51], v[224:227], v[200:203], v[48:51]
buffer_load_dwordx4 v[192:195], v13, s[32:35], s57 offen offset:1024 sc1
s_add_u32 s57, s57, 2048
s_and_b32 s57, s57, 0x7fff
s_waitcnt vmcnt(12) lgkmcnt(0)
v_mfma_f32_16x16x32_bf16 v[20:23], v[228:231], v[204:207], v[20:23]
ds_read_b64_tr_b16 v[212:213], v14 offset:32768
v_mfma_f32_16x16x32_bf16 v[36:39], v[228:231], v[208:211], v[36:39]
ds_read_b64_tr_b16 v[214:215], v14 offset:33280
v_mfma_f32_16x16x32_bf16 v[24:27], v[232:235], v[204:207], v[24:27]
ds_read_b64_tr_b16 v[216:217], v15 offset:32768
v_mfma_f32_16x16x32_bf16 v[40:43], v[232:235], v[208:211], v[40:43]
ds_read_b64_tr_b16 v[218:219], v15 offset:33280
v_mfma_f32_16x16x32_bf16 v[28:31], v[236:239], v[204:207], v[28:31]
ds_read_b64_tr_b16 v[220:221], v16 offset:32768
v_mfma_f32_16x16x32_bf16 v[44:47], v[236:239], v[208:211], v[44:47]
ds_read_b64_tr_b16 v[222:223], v16 offset:33280
v_mfma_f32_16x16x32_bf16 v[32:35], v[240:243], v[204:207], v[32:35]
ds_read_b64_tr_b16 v[224:225], v17 offset:32768
v_mfma_f32_16x16x32_bf16 v[48:51], v[240:243], v[208:211], v[48:51]
ds_read_b64_tr_b16 v[226:227], v17 offset:33280
s_waitcnt vmcnt(10) lgkmcnt(0)
v_mfma_f32_16x16x32_bf16 v[20:23], v[212:215], v[148:151], v[20:23]
ds_read_b64_tr_b16 v[228:229], v14 offset:36864
ds_read_b64_tr_b16 v[230:231], v14 offset:37376
v_mfma_f32_16x16x32_bf16 v[36:39], v[212:215], v[152:155], v[36:39]
ds_read_b64_tr_b16 v[232:233], v15 offset:36864
v_mfma_f32_16x16x32_bf16 v[24:27], v[216:219], v[148:151], v[24:27]
ds_read_b64_tr_b16 v[234:235], v15 offset:37376
ds_read_b64_tr_b16 v[236:237], v16 offset:36864
v_mfma_f32_16x16x32_bf16 v[40:43], v[216:219], v[152:155], v[40:43]
ds_read_b64_tr_b16 v[238:239], v16 offset:37376
v_mfma_f32_16x16x32_bf16 v[28:31], v[220:223], v[148:151], v[28:31]
ds_read_b64_tr_b16 v[240:241], v17 offset:36864
ds_read_b64_tr_b16 v[242:243], v17 offset:37376
v_mfma_f32_16x16x32_bf16 v[44:47], v[220:223], v[152:155], v[44:47]
buffer_load_dwordx4 v[196:199], v12, s[32:35], s57 offen sc1
v_mfma_f32_16x16x32_bf16 v[32:35], v[224:227], v[148:151], v[32:35]
buffer_load_dwordx4 v[200:203], v13, s[32:35], s57 offen sc1
buffer_load_dwordx4 v[204:207], v12, s[32:35], s57 offen offset:1024 sc1
v_mfma_f32_16x16x32_bf16 v[48:51], v[224:227], v[152:155], v[48:51]
buffer_load_dwordx4 v[208:211], v13, s[32:35], s57 offen offset:1024 sc1
s_add_u32 s57, s57, 2048
s_and_b32 s57, s57, 0x7fff
s_waitcnt vmcnt(12) lgkmcnt(0)
v_mfma_f32_16x16x32_bf16 v[20:23], v[228:231], v[156:159], v[20:23]
ds_read_b64_tr_b16 v[212:213], v14 offset:40960
v_mfma_f32_16x16x32_bf16 v[36:39], v[228:231], v[160:163], v[36:39]
ds_read_b64_tr_b16 v[214:215], v14 offset:41472
v_mfma_f32_16x16x32_bf16 v[24:27], v[232:235], v[156:159], v[24:27]
ds_read_b64_tr_b16 v[216:217], v15 offset:40960
v_mfma_f32_16x16x32_bf16 v[40:43], v[232:235], v[160:163], v[40:43]
ds_read_b64_tr_b16 v[218:219], v15 offset:41472
v_mfma_f32_16x16x32_bf16 v[28:31], v[236:239], v[156:159], v[28:31]
ds_read_b64_tr_b16 v[220:221], v16 offset:40960
v_mfma_f32_16x16x32_bf16 v[44:47], v[236:239], v[160:163], v[44:47]
ds_read_b64_tr_b16 v[222:223], v16 offset:41472
v_mfma_f32_16x16x32_bf16 v[32:35], v[240:243], v[156:159], v[32:35]
ds_read_b64_tr_b16 v[224:225], v17 offset:40960
v_mfma_f32_16x16x32_bf16 v[48:51], v[240:243], v[160:163], v[48:51]
ds_read_b64_tr_b16 v[226:227], v17 offset:41472
s_waitcnt vmcnt(10) lgkmcnt(0)
v_mfma_f32_16x16x32_bf16 v[20:23], v[212:215], v[164:167], v[20:23]
ds_read_b64_tr_b16 v[228:229], v14 offset:45056
v_mfma_f32_16x16x32_bf16 v[36:39], v[212:215], v[168:171], v[36:39]
ds_read_b64_tr_b16 v[230:231], v14 offset:45568
v_mfma_f32_16x16x32_bf16 v[24:27], v[216:219], v[164:167], v[24:27]
ds_read_b64_tr_b16 v[232:233], v15 offset:45056
v_mfma_f32_16x16x32_bf16 v[40:43], v[216:219], v[168:171], v[40:43]
ds_read_b64_tr_b16 v[234:235], v15 offset:45568
v_mfma_f32_16x16x32_bf16 v[28:31], v[220:223], v[164:167], v[28:31]
ds_read_b64_tr_b16 v[236:237], v16 offset:45056
v_mfma_f32_16x16x32_bf16 v[44:47], v[220:223], v[168:171], v[44:47]
ds_read_b64_tr_b16 v[238:239], v16 offset:45568
v_mfma_f32_16x16x32_bf16 v[32:35], v[224:227], v[164:167], v[32:35]
ds_read_b64_tr_b16 v[240:241], v17 offset:45056
v_mfma_f32_16x16x32_bf16 v[48:51], v[224:227], v[168:171], v[48:51]
ds_read_b64_tr_b16 v[242:243], v17 offset:45568
s_waitcnt vmcnt(8) lgkmcnt(0)
v_mfma_f32_16x16x32_bf16 v[20:23], v[228:231], v[172:175], v[20:23]
ds_read_b64_tr_b16 v[212:213], v14 offset:49152
v_mfma_f32_16x16x32_bf16 v[36:39], v[228:231], v[176:179], v[36:39]
ds_read_b64_tr_b16 v[214:215], v14 offset:49664
v_mfma_f32_16x16x32_bf16 v[24:27], v[232:235], v[172:175], v[24:27]
ds_read_b64_tr_b16 v[216:217], v15 offset:49152
v_mfma_f32_16x16x32_bf16 v[40:43], v[232:235], v[176:179], v[40:43]
ds_read_b64_tr_b16 v[218:219], v15 offset:49664
v_mfma_f32_16x16x32_bf16 v[28:31], v[236:239], v[172:175], v[28:31]
ds_read_b64_tr_b16 v[220:221], v16 offset:49152
v_mfma_f32_16x16x32_bf16 v[44:47], v[236:239], v[176:179], v[44:47]
ds_read_b64_tr_b16 v[222:223], v16 offset:49664
v_mfma_f32_16x16x32_bf16 v[32:35], v[240:243], v[172:175], v[32:35]
ds_read_b64_tr_b16 v[224:225], v17 offset:49152
v_mfma_f32_16x16x32_bf16 v[48:51], v[240:243], v[176:179], v[48:51]
ds_read_b64_tr_b16 v[226:227], v17 offset:49664
s_waitcnt vmcnt(6) lgkmcnt(0)
v_mfma_f32_16x16x32_bf16 v[20:23], v[212:215], v[180:183], v[20:23]
ds_read_b64_tr_b16 v[228:229], v14 offset:53248
v_mfma_f32_16x16x32_bf16 v[36:39], v[212:215], v[184:187], v[36:39]
ds_read_b64_tr_b16 v[230:231], v14 offset:53760
v_mfma_f32_16x16x32_bf16 v[24:27], v[216:219], v[180:183], v[24:27]
ds_read_b64_tr_b16 v[232:233], v15 offset:53248
v_mfma_f32_16x16x32_bf16 v[40:43], v[216:219], v[184:187], v[40:43]
ds_read_b64_tr_b16 v[234:235], v15 offset:53760
v_mfma_f32_16x16x32_bf16 v[28:31], v[220:223], v[180:183], v[28:31]
ds_read_b64_tr_b16 v[236:237], v16 offset:53248
v_mfma_f32_16x16x32_bf16 v[44:47], v[220:223], v[184:187], v[44:47]
ds_read_b64_tr_b16 v[238:239], v16 offset:53760
v_mfma_f32_16x16x32_bf16 v[32:35], v[224:227], v[180:183], v[32:35]
ds_read_b64_tr_b16 v[240:241], v17 offset:53248
v_mfma_f32_16x16x32_bf16 v[48:51], v[224:227], v[184:187], v[48:51]
ds_read_b64_tr_b16 v[242:243], v17 offset:53760
s_waitcnt vmcnt(4) lgkmcnt(0)
v_mfma_f32_16x16x32_bf16 v[20:23], v[228:231], v[188:191], v[20:23]
ds_read_b64_tr_b16 v[212:213], v14 offset:57344
v_mfma_f32_16x16x32_bf16 v[36:39], v[228:231], v[192:195], v[36:39]
ds_read_b64_tr_b16 v[214:215], v14 offset:57856
v_mfma_f32_16x16x32_bf16 v[24:27], v[232:235], v[188:191], v[24:27]
ds_read_b64_tr_b16 v[216:217], v15 offset:57344
v_mfma_f32_16x16x32_bf16 v[40:43], v[232:235], v[192:195], v[40:43]
ds_read_b64_tr_b16 v[218:219], v15 offset:57856
v_mfma_f32_16x16x32_bf16 v[28:31], v[236:239], v[188:191], v[28:31]
ds_read_b64_tr_b16 v[220:221], v16 offset:57344
v_mfma_f32_16x16x32_bf16 v[44:47], v[236:239], v[192:195], v[44:47]
ds_read_b64_tr_b16 v[222:223], v16 offset:57856
v_mfma_f32_16x16x32_bf16 v[32:35], v[240:243], v[188:191], v[32:35]
ds_read_b64_tr_b16 v[224:225], v17 offset:57344
v_mfma_f32_16x16x32_bf16 v[48:51], v[240:243], v[192:195], v[48:51]
ds_read_b64_tr_b16 v[226:227], v17 offset:57856
s_waitcnt vmcnt(2) lgkmcnt(0)
v_mfma_f32_16x16x32_bf16 v[20:23], v[212:215], v[196:199], v[20:23]
ds_read_b64_tr_b16 v[228:229], v14 offset:61440
v_mfma_f32_16x16x32_bf16 v[36:39], v[212:215], v[200:203], v[36:39]
ds_read_b64_tr_b16 v[230:231], v14 offset:61952
v_mfma_f32_16x16x32_bf16 v[24:27], v[216:219], v[196:199], v[24:27]
ds_read_b64_tr_b16 v[232:233], v15 offset:61440
v_mfma_f32_16x16x32_bf16 v[40:43], v[216:219], v[200:203], v[40:43]
ds_read_b64_tr_b16 v[234:235], v15 offset:61952
v_mfma_f32_16x16x32_bf16 v[28:31], v[220:223], v[196:199], v[28:31]
ds_read_b64_tr_b16 v[236:237], v16 offset:61440
v_mfma_f32_16x16x32_bf16 v[44:47], v[220:223], v[200:203], v[44:47]
ds_read_b64_tr_b16 v[238:239], v16 offset:61952
v_mfma_f32_16x16x32_bf16 v[32:35], v[224:227], v[196:199], v[32:35]
ds_read_b64_tr_b16 v[240:241], v17 offset:61440
v_mfma_f32_16x16x32_bf16 v[48:51], v[224:227], v[200:203], v[48:51]
ds_read_b64_tr_b16 v[242:243], v17 offset:61952
s_waitcnt vmcnt(0) lgkmcnt(0)
s_barrier
v_mfma_f32_16x16x32_bf16 v[20:23], v[228:231], v[204:207], v[20:23]
v_mfma_f32_16x16x32_bf16 v[36:39], v[228:231], v[208:211], v[36:39]
v_mfma_f32_16x16x32_bf16 v[24:27], v[232:235], v[204:207], v[24:27]
v_mfma_f32_16x16x32_bf16 v[40:43], v[232:235], v[208:211], v[40:43]
v_mfma_f32_16x16x32_bf16 v[28:31], v[236:239], v[204:207], v[28:31]
v_mfma_f32_16x16x32_bf16 v[44:47], v[236:239], v[208:211], v[44:47]
v_mfma_f32_16x16x32_bf16 v[32:35], v[240:243], v[204:207], v[32:35]
v_mfma_f32_16x16x32_bf16 v[48:51], v[240:243], v[208:211], v[48:51]
s_lshl_b32 s48, s56, 15
s_lshl_b32 s49, s42, 11
s_add_u32 s48, s48, s49
s_add_u32 s49, s48, 32768
s_lshl_b32 s50, s41, 2
s_add_u32 s50, s50, s40
s_lshl_b32 s50, s50, 4
s_add_u32 s50, s50, s42
s_lshl_b32 s50, s50, 8
s_add_u32 s50, s50, 13238272
s_lshl_b32 s52, s41, 2
s_add_u32 s52, s52, s40
s_lshl_b32 s52, s52, 7
s_add_u32 s52, s52, 14163968
v_lshlrev_b32 v19, 2, v0
v_mov_b32 v10, 0x3f803f80
v_mov_b32 v6, 0
v_mov_b32 v7, 0
v_mov_b32 v8, 0
v_mov_b32 v9, 0
s_nop 2
s_cmp_eq_u32 s46, 0
s_cbranch_scc1 slow_15
v_lshlrev_b32 v4, 16, v88
v_and_b32 v5, 0xffff0000, v88
v_pk_add_f32 v[20:21], v[20:21], v[4:5]
v_lshlrev_b32 v4, 16, v89
v_and_b32 v5, 0xffff0000, v89
v_pk_add_f32 v[22:23], v[22:23], v[4:5]
v_lshlrev_b32 v4, 16, v90
v_and_b32 v5, 0xffff0000, v90
v_pk_add_f32 v[24:25], v[24:25], v[4:5]
v_lshlrev_b32 v4, 16, v91
v_and_b32 v5, 0xffff0000, v91
v_pk_add_f32 v[26:27], v[26:27], v[4:5]
v_cvt_pk_bf16_f32 v20, v20, v21
v_cvt_pk_bf16_f32 v21, v22, v23
v_cvt_pk_bf16_f32 v22, v24, v25
v_cvt_pk_bf16_f32 v23, v26, v27
buffer_store_dwordx4 v[20:23], v18, s[32:35], s48 offen offset:0
v_lshlrev_b32 v4, 16, v92
v_and_b32 v5, 0xffff0000, v92
v_pk_add_f32 v[28:29], v[28:29], v[4:5]
v_lshlrev_b32 v4, 16, v93
v_and_b32 v5, 0xffff0000, v93
v_pk_add_f32 v[30:31], v[30:31], v[4:5]
v_lshlrev_b32 v4, 16, v94
v_and_b32 v5, 0xffff0000, v94
v_pk_add_f32 v[32:33], v[32:33], v[4:5]
v_lshlrev_b32 v4, 16, v95
v_and_b32 v5, 0xffff0000, v95
v_pk_add_f32 v[34:35], v[34:35], v[4:5]
v_cvt_pk_bf16_f32 v28, v28, v29
v_cvt_pk_bf16_f32 v29, v30, v31
v_cvt_pk_bf16_f32 v30, v32, v33
v_cvt_pk_bf16_f32 v31, v34, v35
buffer_store_dwordx4 v[28:31], v18, s[32:35], s48 offen offset:1024
v_lshlrev_b32 v4, 16, v96
v_and_b32 v5, 0xffff0000, v96
v_pk_add_f32 v[36:37], v[36:37], v[4:5]
v_lshlrev_b32 v4, 16, v97
v_and_b32 v5, 0xffff0000, v97
v_pk_add_f32 v[38:39], v[38:39], v[4:5]
v_lshlrev_b32 v4, 16, v98
v_and_b32 v5, 0xffff0000, v98
v_pk_add_f32 v[40:41], v[40:41], v[4:5]
v_lshlrev_b32 v4, 16, v99
v_and_b32 v5, 0xffff0000, v99
v_pk_add_f32 v[42:43], v[42:43], v[4:5]
v_cvt_pk_bf16_f32 v36, v36, v37
v_cvt_pk_bf16_f32 v37, v38, v39
v_cvt_pk_bf16_f32 v38, v40, v41
v_cvt_pk_bf16_f32 v39, v42, v43
buffer_store_dwordx4 v[36:39], v18, s[32:35], s49 offen offset:0
v_lshlrev_b32 v4, 16, v100
v_and_b32 v5, 0xffff0000, v100
v_pk_add_f32 v[44:45], v[44:45], v[4:5]
v_lshlrev_b32 v4, 16, v101
v_and_b32 v5, 0xffff0000, v101
v_pk_add_f32 v[46:47], v[46:47], v[4:5]
v_lshlrev_b32 v4, 16, v102
v_and_b32 v5, 0xffff0000, v102
v_pk_add_f32 v[48:49], v[48:49], v[4:5]
v_lshlrev_b32 v4, 16, v103
v_and_b32 v5, 0xffff0000, v103
v_pk_add_f32 v[50:51], v[50:51], v[4:5]
v_cvt_pk_bf16_f32 v44, v44, v45
v_cvt_pk_bf16_f32 v45, v46, v47
v_cvt_pk_bf16_f32 v46, v48, v49
v_cvt_pk_bf16_f32 v47, v50, v51
buffer_store_dwordx4 v[44:47], v18, s[32:35], s49 offen offset:1024
v_dot2c_f32_bf16 v6, v20, v10
v_dot2c_f32_bf16 v8, v20, v20
v_dot2c_f32_bf16 v7, v36, v10
v_dot2c_f32_bf16 v9, v36, v36
v_dot2c_f32_bf16 v6, v21, v10
v_dot2c_f32_bf16 v8, v21, v21
v_dot2c_f32_bf16 v7, v37, v10
v_dot2c_f32_bf16 v9, v37, v37
v_dot2c_f32_bf16 v6, v22, v10
v_dot2c_f32_bf16 v8, v22, v22
v_dot2c_f32_bf16 v7, v38, v10
v_dot2c_f32_bf16 v9, v38, v38
v_dot2c_f32_bf16 v6, v23, v10
v_dot2c_f32_bf16 v8, v23, v23
v_dot2c_f32_bf16 v7, v39, v10
v_dot2c_f32_bf16 v9, v39, v39
v_dot2c_f32_bf16 v6, v28, v10
v_dot2c_f32_bf16 v8, v28, v28
v_dot2c_f32_bf16 v7, v44, v10
v_dot2c_f32_bf16 v9, v44, v44
v_dot2c_f32_bf16 v6, v29, v10
v_dot2c_f32_bf16 v8, v29, v29
v_dot2c_f32_bf16 v7, v45, v10
v_dot2c_f32_bf16 v9, v45, v45
v_dot2c_f32_bf16 v6, v30, v10
v_dot2c_f32_bf16 v8, v30, v30
v_dot2c_f32_bf16 v7, v46, v10
v_dot2c_f32_bf16 v9, v46, v46
v_dot2c_f32_bf16 v6, v31, v10
v_dot2c_f32_bf16 v8, v31, v31
v_dot2c_f32_bf16 v7, v47, v10
v_dot2c_f32_bf16 v9, v47, v47
s_nop 1
s_nop 1
v_permlane32_swap_b32 v6, v7
v_permlane32_swap_b32 v8, v9
s_nop 0
v_add_f32 v6, v6, v7
v_add_f32 v8, v8, v9
s_nop 1
v_permlane16_swap_b32 v6, v8
s_nop 0
v_add_f32 v6, v6, v8
buffer_store_dword v6, v19, s[32:35], s50 offen
s_cmp_lg_u32 s40, 3
s_cbranch_scc1 nohalo_17
s_lshl_b32 s53, s41, 15
s_lshl_b32 s54, s42, 11
s_add_u32 s53, s53, s54
s_add_u32 s53, s53, 12713984
buffer_store_dwordx4 v[36:39], v18, s[32:35], s53 offen offset:0 sc1
buffer_store_dwordx4 v[44:47], v18, s[32:35], s53 offen offset:1024 sc1
s_lshl_b32 s53, s41, 4
s_add_u32 s53, s53, s42
s_lshl_b32 s53, s53, 8
s_add_u32 s53, s53, 13565952
buffer_store_dword v6, v19, s[32:35], s53 offen sc1
s_waitcnt vmcnt(3)
s_lshl_b32 s62, s42, 2
v_mov_b32 v4, s62
v_mov_b32 v5, 2
s_mov_b64 exec, 1
buffer_store_dword v5, v4, s[32:35], s52 offen
s_mov_b64 exec, -1
s_lshl_b32 s53, s41, 2
s_add_u32 s53, s53, 0
s_lshl_b32 s53, s53, 7
s_add_u32 s53, s53, 14196736
s_waitcnt vmcnt(0)
s_lshl_b32 s62, s42, 2
v_mov_b32 v4, s62
v_mov_b32 v5, 1
s_mov_b64 exec, 1
buffer_store_dword v5, v4, s[32:35], s53 offen sc1
s_mov_b64 exec, -1
nohalo_17:
s_waitcnt vmcnt(0)
s_lshl_b32 s62, s42, 2
v_mov_b32 v4, s62
v_mov_b32 v5, 2
s_mov_b64 exec, 1
buffer_store_dword v5, v4, s[32:35], s52 offen
s_mov_b64 exec, -1
back_16:
v_mov_b32 v10, v18
v_add_u32 v11, 1024, v18
s_lshl_b32 s48, s43, 1
v_lshrrev_b32 v4, 2, v2
v_and_b32 v5, 3, v0
v_lshl_add_u32 v6, v3, 3, v4
v_lshlrev_b32 v6, 7, v6
v_lshl_add_u32 v6, v5, 3, v6
v_lshrrev_b32 v7, 1, v4
v_and_b32 v8, 1, v3
v_lshl_add_u32 v7, v8, 1, v7
v_xor_b32 v7, s48, v7
v_lshl_add_u32 v12, v7, 5, v6
v_add_u32 v12, 18432, v12
v_xor_b32 v13, 32, v12
v_mov_b32 v14, v10
v_mov_b32 v15, v11
v_mov_b32 v16, v12
v_mov_b32 v17, v13
v_mov_b32 v148, 0
v_mov_b32 v149, 0
v_mov_b32 v150, 0
v_mov_b32 v151, 0
v_mov_b32 v152, 0
v_mov_b32 v153, 0
v_mov_b32 v154, 0
v_mov_b32 v155, 0
v_mov_b32 v156, 0
v_mov_b32 v157, 0
v_mov_b32 v158, 0
v_mov_b32 v159, 0
v_mov_b32 v160, 0
v_mov_b32 v161, 0
v_mov_b32 v162, 0
v_mov_b32 v163, 0
v_mov_b32 v164, 0
v_mov_b32 v165, 0
v_mov_b32 v166, 0
v_mov_b32 v167, 0
v_mov_b32 v168, 0
v_mov_b32 v169, 0
v_mov_b32 v170, 0
v_mov_b32 v171, 0
v_mov_b32 v172, 0
v_mov_b32 v173, 0
v_mov_b32 v174, 0
v_mov_b32 v175, 0
v_mov_b32 v176, 0
v_mov_b32 v177, 0
v_mov_b32 v178, 0
v_mov_b32 v179, 0
v_mov_b32 v180, 0
v_mov_b32 v181, 0
v_mov_b32 v182, 0
v_mov_b32 v183, 0
v_mov_b32 v184, 0
v_mov_b32 v185, 0
v_mov_b32 v186, 0
v_mov_b32 v187, 0
v_mov_b32 v188, 0
v_mov_b32 v189, 0
v_mov_b32 v190, 0
v_mov_b32 v191, 0
v_mov_b32 v192, 0
v_mov_b32 v193, 0
v_mov_b32 v194, 0
v_mov_b32 v195, 0
v_mov_b32 v196, 0
v_mov_b32 v197, 0
v_mov_b32 v198, 0
v_mov_b32 v199, 0
v_mov_b32 v200, 0
v_mov_b32 v201, 0
v_mov_b32 v202, 0
v_mov_b32 v203, 0
v_mov_b32 v204, 0
v_mov_b32 v205, 0
v_mov_b32 v206, 0
v_mov_b32 v207, 0
v_mov_b32 v208, 0
v_mov_b32 v209, 0
v_mov_b32 v210, 0
v_mov_b32 v211, 0
v_mov_b32 v212, 0
v_mov_b32 v213, 0
v_mov_b32 v214, 0
v_mov_b32 v215, 0
v_mov_b32 v216, 0
v_mov_b32 v217, 0
v_mov_b32 v218, 0
v_mov_b32 v219, 0
v_mov_b32 v220, 0
v_mov_b32 v221, 0
v_mov_b32 v222, 0
v_mov_b32 v223, 0
v_mov_b32 v224, 0
v_mov_b32 v225, 0
v_mov_b32 v226, 0
v_mov_b32 v227, 0
v_mov_b32 v228, 0
v_mov_b32 v229, 0
v_mov_b32 v230, 0
v_mov_b32 v231, 0
v_mov_b32 v232, 0
v_mov_b32 v233, 0
v_mov_b32 v234, 0
v_mov_b32 v235, 0
v_mov_b32 v236, 0
v_mov_b32 v237, 0
v_mov_b32 v238, 0
v_mov_b32 v239, 0
v_mov_b32 v240, 0
v_mov_b32 v241, 0
v_mov_b32 v242, 0
v_mov_b32 v243, 0
v_mov_b32 v244, 0
v_mov_b32 v245, 0
v_mov_b32 v246, 0
v_mov_b32 v247, 0
v_mov_b32 v248, 0
v_mov_b32 v249, 0
v_mov_b32 v250, 0
v_mov_b32 v251, 0
s_mov_b32 s64, 0
s_mov_b32 s65, 0
s_barrier
s_cmp_eq_u32 s44, 1
s_cbranch_scc1 c2_th1
ds_read_b128 v[60:63], v14 offset:2048
ds_read_b128 v[64:67], v14 offset:4096
ds_read_b128 v[68:71], v14 offset:6144
ds_read_b128 v[72:75], v14 offset:8192
ds_read_b128 v[76:79], v14
ds_read_b64_tr_b16 v[80:81], v16 offset:0
ds_read_b64_tr_b16 v[82:83], v16 offset:512
ds_read_b64_tr_b16 v[84:85], v17 offset:0
ds_read_b64_tr_b16 v[86:87], v17 offset:512
ds_read_b64_tr_b16 v[88:89], v16 offset:8192
ds_read_b64_tr_b16 v[90:91], v16 offset:8704
ds_read_b64_tr_b16 v[92:93], v17 offset:8192
ds_read_b64_tr_b16 v[94:95], v17 offset:8704
ds_read_b64_tr_b16 v[96:97], v16 offset:16384
ds_read_b64_tr_b16 v[98:99], v16 offset:16896
ds_read_b64_tr_b16 v[100:101], v17 offset:16384
ds_read_b64_tr_b16 v[102:103], v17 offset:16896
c2_loop0:
s_add_u32 s65, s65, 43008
s_cmp_eq_u32 s65, 129024
s_cselect_b32 s65, 0, s65
s_waitcnt lgkmcnt(0)
v_mfma_f32_16x16x32_bf16 v[244:247], v[88:91], v[76:79], v[244:247]
ds_read_b128 v[104:107], v15 offset:2048
v_mfma_f32_16x16x32_bf16 v[248:251], v[76:79], v[96:99], v[248:251]
ds_read_b128 v[108:111], v15 offset:4096
v_mfma_f32_16x16x32_bf16 v[204:207], v[88:91], v[72:75], v[204:207]
ds_read_b128 v[112:115], v15 offset:6144
v_mfma_f32_16x16x32_bf16 v[196:199], v[88:91], v[68:71], v[196:199]
ds_read_b128 v[116:119], v15 offset:8192
v_mfma_f32_16x16x32_bf16 v[188:191], v[88:91], v[64:67], v[188:191]
ds_read_b128 v[120:123], v15
v_mfma_f32_16x16x32_bf16 v[180:183], v[88:91], v[60:63], v[180:183]
ds_read_b64_tr_b16 v[124:125], v16 offset:4096
v_mfma_f32_16x16x32_bf16 v[184:187], v[92:95], v[60:63], v[184:187]
ds_read_b64_tr_b16 v[126:127], v16 offset:4608
v_mfma_f32_16x16x32_bf16 v[192:195], v[92:95], v[64:67], v[192:195]
ds_read_b64_tr_b16 v[128:129], v17 offset:4096
v_mfma_f32_16x16x32_bf16 v[200:203], v[92:95], v[68:71], v[200:203]
ds_read_b64_tr_b16 v[130:131], v17 offset:4608
v_mfma_f32_16x16x32_bf16 v[208:211], v[92:95], v[72:75], v[208:211]
ds_read_b64_tr_b16 v[132:133], v16 offset:12288
v_mfma_f32_16x16x32_bf16 v[236:239], v[72:75], v[96:99], v[236:239]
ds_read_b64_tr_b16 v[134:135], v16 offset:12800
v_mfma_f32_16x16x32_bf16 v[228:231], v[68:71], v[96:99], v[228:231]
ds_read_b64_tr_b16 v[136:137], v17 offset:12288
v_mfma_f32_16x16x32_bf16 v[220:223], v[64:67], v[96:99], v[220:223]
ds_read_b64_tr_b16 v[138:139], v17 offset:12800
v_mfma_f32_16x16x32_bf16 v[212:215], v[60:63], v[96:99], v[212:215]
ds_read_b64_tr_b16 v[140:141], v16 offset:20480
v_mfma_f32_16x16x32_bf16 v[216:219], v[60:63], v[100:103], v[216:219]
ds_read_b64_tr_b16 v[142:143], v16 offset:20992
v_mfma_f32_16x16x32_bf16 v[224:227], v[64:67], v[100:103], v[224:227]
ds_read_b64_tr_b16 v[144:145], v17 offset:20480
v_mfma_f32_16x16x32_bf16 v[232:235], v[68:71], v[100:103], v[232:235]
ds_read_b64_tr_b16 v[146:147], v17 offset:20992
v_mfma_f32_16x16x32_bf16 v[240:243], v[72:75], v[100:103], v[240:243]
v_mfma_f32_16x16x32_bf16 v[172:175], v[80:83], v[72:75], v[172:175]
v_mfma_f32_16x16x32_bf16 v[164:167], v[80:83], v[68:71], v[164:167]
v_mfma_f32_16x16x32_bf16 v[156:159], v[80:83], v[64:67], v[156:159]
v_mfma_f32_16x16x32_bf16 v[148:151], v[80:83], v[60:63], v[148:151]
v_mfma_f32_16x16x32_bf16 v[152:155], v[84:87], v[60:63], v[152:155]
v_mfma_f32_16x16x32_bf16 v[160:163], v[84:87], v[64:67], v[160:163]
v_mfma_f32_16x16x32_bf16 v[168:171], v[84:87], v[68:71], v[168:171]
v_mfma_f32_16x16x32_bf16 v[176:179], v[84:87], v[72:75], v[176:179]
s_waitcnt lgkmcnt(0)
s_barrier
v_mfma_f32_16x16x32_bf16 v[244:247], v[132:135], v[120:123], v[244:247]
v_add_u32 v14, s65, v10
v_mfma_f32_16x16x32_bf16 v[248:251], v[120:123], v[140:143], v[248:251]
v_add_u32 v16, s65, v12
v_add_u32 v17, s65, v13
v_mfma_f32_16x16x32_bf16 v[204:207], v[132:135], v[116:119], v[204:207]
ds_read_b128 v[60:63], v14 offset:2048
v_mfma_f32_16x16x32_bf16 v[196:199], v[132:135], v[112:115], v[196:199]
ds_read_b128 v[64:67], v14 offset:4096
v_mfma_f32_16x16x32_bf16 v[188:191], v[132:135], v[108:111], v[188:191]
ds_read_b128 v[68:71], v14 offset:6144
v_mfma_f32_16x16x32_bf16 v[180:183], v[132:135], v[104:107], v[180:183]
ds_read_b128 v[72:75], v14 offset:8192
v_mfma_f32_16x16x32_bf16 v[184:187], v[136:139], v[104:107], v[184:187]
ds_read_b128 v[76:79], v14
v_mfma_f32_16x16x32_bf16 v[192:195], v[136:139], v[108:111], v[192:195]
ds_read_b64_tr_b16 v[80:81], v16 offset:0
v_mfma_f32_16x16x32_bf16 v[200:203], v[136:139], v[112:115], v[200:203]
ds_read_b64_tr_b16 v[82:83], v16 offset:512
v_mfma_f32_16x16x32_bf16 v[208:211], v[136:139], v[116:119], v[208:211]
ds_read_b64_tr_b16 v[84:85], v17 offset:0
v_mfma_f32_16x16x32_bf16 v[236:239], v[116:119], v[140:143], v[236:239]
ds_read_b64_tr_b16 v[86:87], v17 offset:512
v_mfma_f32_16x16x32_bf16 v[228:231], v[112:115], v[140:143], v[228:231]
ds_read_b64_tr_b16 v[88:89], v16 offset:8192
v_mfma_f32_16x16x32_bf16 v[220:223], v[108:111], v[140:143], v[220:223]
ds_read_b64_tr_b16 v[90:91], v16 offset:8704
v_mfma_f32_16x16x32_bf16 v[212:215], v[104:107], v[140:143], v[212:215]
ds_read_b64_tr_b16 v[92:93], v17 offset:8192
v_mfma_f32_16x16x32_bf16 v[216:219], v[104:107], v[144:147], v[216:219]
ds_read_b64_tr_b16 v[94:95], v17 offset:8704
v_mfma_f32_16x16x32_bf16 v[224:227], v[108:111], v[144:147], v[224:227]
ds_read_b64_tr_b16 v[96:97], v16 offset:16384
v_mfma_f32_16x16x32_bf16 v[232:235], v[112:115], v[144:147], v[232:235]
ds_read_b64_tr_b16 v[98:99], v16 offset:16896
v_mfma_f32_16x16x32_bf16 v[240:243], v[116:119], v[144:147], v[240:243]
ds_read_b64_tr_b16 v[100:101], v17 offset:16384
v_mfma_f32_16x16x32_bf16 v[172:175], v[124:127], v[116:119], v[172:175]
ds_read_b64_tr_b16 v[102:103], v17 offset:16896
v_mfma_f32_16x16x32_bf16 v[164:167], v[124:127], v[112:115], v[164:167]
v_add_u32 v15, s65, v11
v_mfma_f32_16x16x32_bf16 v[156:159], v[124:127], v[108:111], v[156:159]
s_add_u32 s64, s64, 1
v_mfma_f32_16x16x32_bf16 v[148:151], v[124:127], v[104:107], v[148:151]
s_cmp_lt_u32 s64, 16
v_mfma_f32_16x16x32_bf16 v[152:155], v[128:131], v[104:107], v[152:155]
v_mfma_f32_16x16x32_bf16 v[160:163], v[128:131], v[108:111], v[160:163]
v_mfma_f32_16x16x32_bf16 v[168:171], v[128:131], v[112:115], v[168:171]
v_mfma_f32_16x16x32_bf16 v[176:179], v[128:131], v[116:119], v[176:179]
s_cbranch_scc1 c2_loop0
s_branch c2_epi
c2_th1:
ds_read_b128 v[60:63], v14 offset:10240
ds_read_b128 v[64:67], v14 offset:12288
ds_read_b128 v[68:71], v14 offset:14336
ds_read_b128 v[72:75], v14 offset:16384
ds_read_b128 v[76:79], v14
ds_read_b64_tr_b16 v[80:81], v16 offset:0
ds_read_b64_tr_b16 v[82:83], v16 offset:512
ds_read_b64_tr_b16 v[84:85], v17 offset:0
ds_read_b64_tr_b16 v[86:87], v17 offset:512
ds_read_b64_tr_b16 v[88:89], v16 offset:8192
ds_read_b64_tr_b16 v[90:91], v16 offset:8704
ds_read_b64_tr_b16 v[92:93], v17 offset:8192
ds_read_b64_tr_b16 v[94:95], v17 offset:8704
ds_read_b64_tr_b16 v[96:97], v16 offset:16384
ds_read_b64_tr_b16 v[98:99], v16 offset:16896
ds_read_b64_tr_b16 v[100:101], v17 offset:16384
ds_read_b64_tr_b16 v[102:103], v17 offset:16896
c2_loop1:
s_add_u32 s65, s65, 43008
s_cmp_eq_u32 s65, 129024
s_cselect_b32 s65, 0, s65
s_waitcnt lgkmcnt(0)
v_mfma_f32_16x16x32_bf16 v[244:247], v[92:95], v[76:79], v[244:247]
ds_read_b128 v[104:107], v15 offset:10240
v_mfma_f32_16x16x32_bf16 v[248:251], v[76:79], v[100:103], v[248:251]
ds_read_b128 v[108:111], v15 offset:12288
v_mfma_f32_16x16x32_bf16 v[204:207], v[88:91], v[72:75], v[204:207]
ds_read_b128 v[112:115], v15 offset:14336
v_mfma_f32_16x16x32_bf16 v[196:199], v[88:91], v[68:71], v[196:199]
ds_read_b128 v[116:119], v15 offset:16384
v_mfma_f32_16x16x32_bf16 v[188:191], v[88:91], v[64:67], v[188:191]
ds_read_b128 v[120:123], v15
v_mfma_f32_16x16x32_bf16 v[180:183], v[88:91], v[60:63], v[180:183]
ds_read_b64_tr_b16 v[124:125], v16 offset:4096
v_mfma_f32_16x16x32_bf16 v[184:187], v[92:95], v[60:63], v[184:187]
ds_read_b64_tr_b16 v[126:127], v16 offset:4608
v_mfma_f32_16x16x32_bf16 v[192:195], v[92:95], v[64:67], v[192:195]
ds_read_b64_tr_b16 v[128:129], v17 offset:4096
v_mfma_f32_16x16x32_bf16 v[200:203], v[92:95], v[68:71], v[200:203]
ds_read_b64_tr_b16 v[130:131], v17 offset:4608
v_mfma_f32_16x16x32_bf16 v[208:211], v[92:95], v[72:75], v[208:211]
ds_read_b64_tr_b16 v[132:133], v16 offset:12288
v_mfma_f32_16x16x32_bf16 v[236:239], v[72:75], v[96:99], v[236:239]
ds_read_b64_tr_b16 v[134:135], v16 offset:12800
v_mfma_f32_16x16x32_bf16 v[228:231], v[68:71], v[96:99], v[228:231]
ds_read_b64_tr_b16 v[136:137], v17 offset:12288
v_mfma_f32_16x16x32_bf16 v[220:223], v[64:67], v[96:99], v[220:223]
ds_read_b64_tr_b16 v[138:139], v17 offset:12800
v_mfma_f32_16x16x32_bf16 v[212:215], v[60:63], v[96:99], v[212:215]
ds_read_b64_tr_b16 v[140:141], v16 offset:20480
v_mfma_f32_16x16x32_bf16 v[216:219], v[60:63], v[100:103], v[216:219]
ds_read_b64_tr_b16 v[142:143], v16 offset:20992
v_mfma_f32_16x16x32_bf16 v[224:227], v[64:67], v[100:103], v[224:227]
ds_read_b64_tr_b16 v[144:145], v17 offset:20480
v_mfma_f32_16x16x32_bf16 v[232:235], v[68:71], v[100:103], v[232:235]
ds_read_b64_tr_b16 v[146:147], v17 offset:20992
v_mfma_f32_16x16x32_bf16 v[240:243], v[72:75], v[100:103], v[240:243]
v_mfma_f32_16x16x32_bf16 v[172:175], v[80:83], v[72:75], v[172:175]
v_mfma_f32_16x16x32_bf16 v[164:167], v[80:83], v[68:71], v[164:167]
v_mfma_f32_16x16x32_bf16 v[156:159], v[80:83], v[64:67], v[156:159]
v_mfma_f32_16x16x32_bf16 v[148:151], v[80:83], v[60:63], v[148:151]
v_mfma_f32_16x16x32_bf16 v[152:155], v[84:87], v[60:63], v[152:155]
v_mfma_f32_16x16x32_bf16 v[160:163], v[84:87], v[64:67], v[160:163]
v_mfma_f32_16x16x32_bf16 v[168:171], v[84:87], v[68:71], v[168:171]
v_mfma_f32_16x16x32_bf16 v[176:179], v[84:87], v[72:75], v[176:179]
s_waitcnt lgkmcnt(0)
s_barrier
v_mfma_f32_16x16x32_bf16 v[244:247], v[136:139], v[120:123], v[244:247]
v_add_u32 v14, s65, v10
v_mfma_f32_16x16x32_bf16 v[248:251], v[120:123], v[144:147], v[248:251]
v_add_u32 v16, s65, v12
v_add_u32 v17, s65, v13
v_mfma_f32_16x16x32_bf16 v[204:207], v[132:135], v[116:119], v[204:207]
ds_read_b128 v[60:63], v14 offset:10240
v_mfma_f32_16x16x32_bf16 v[196:199], v[132:135], v[112:115], v[196:199]
ds_read_b128 v[64:67], v14 offset:12288
v_mfma_f32_16x16x32_bf16 v[188:191], v[132:135], v[108:111], v[188:191]
ds_read_b128 v[68:71], v14 offset:14336
v_mfma_f32_16x16x32_bf16 v[180:183], v[132:135], v[104:107], v[180:183]
ds_read_b128 v[72:75], v14 offset:16384
v_mfma_f32_16x16x32_bf16 v[184:187], v[136:139], v[104:107], v[184:187]
ds_read_b128 v[76:79], v14
v_mfma_f32_16x16x32_bf16 v[192:195], v[136:139], v[108:111], v[192:195]
ds_read_b64_tr_b16 v[80:81], v16 offset:0
v_mfma_f32_16x16x32_bf16 v[200:203], v[136:139], v[112:115], v[200:203]
ds_read_b64_tr_b16 v[82:83], v16 offset:512
v_mfma_f32_16x16x32_bf16 v[208:211], v[136:139], v[116:119], v[208:211]
ds_read_b64_tr_b16 v[84:85], v17 offset:0
v_mfma_f32_16x16x32_bf16 v[236:239], v[116:119], v[140:143], v[236:239]
ds_read_b64_tr_b16 v[86:87], v17 offset:512
v_mfma_f32_16x16x32_bf16 v[228:231], v[112:115], v[140:143], v[228:231]
ds_read_b64_tr_b16 v[88:89], v16 offset:8192
v_mfma_f32_16x16x32_bf16 v[220:223], v[108:111], v[140:143], v[220:223]
ds_read_b64_tr_b16 v[90:91], v16 offset:8704
v_mfma_f32_16x16x32_bf16 v[212:215], v[104:107], v[140:143], v[212:215]
ds_read_b64_tr_b16 v[92:93], v17 offset:8192
v_mfma_f32_16x16x32_bf16 v[216:219], v[104:107], v[144:147], v[216:219]
ds_read_b64_tr_b16 v[94:95], v17 offset:8704
v_mfma_f32_16x16x32_bf16 v[224:227], v[108:111], v[144:147], v[224:227]
ds_read_b64_tr_b16 v[96:97], v16 offset:16384
v_mfma_f32_16x16x32_bf16 v[232:235], v[112:115], v[144:147], v[232:235]
ds_read_b64_tr_b16 v[98:99], v16 offset:16896
v_mfma_f32_16x16x32_bf16 v[240:243], v[116:119], v[144:147], v[240:243]
ds_read_b64_tr_b16 v[100:101], v17 offset:16384
v_mfma_f32_16x16x32_bf16 v[172:175], v[124:127], v[116:119], v[172:175]
ds_read_b64_tr_b16 v[102:103], v17 offset:16896
v_mfma_f32_16x16x32_bf16 v[164:167], v[124:127], v[112:115], v[164:167]
v_add_u32 v15, s65, v11
v_mfma_f32_16x16x32_bf16 v[156:159], v[124:127], v[108:111], v[156:159]
s_add_u32 s64, s64, 1
v_mfma_f32_16x16x32_bf16 v[148:151], v[124:127], v[104:107], v[148:151]
s_cmp_lt_u32 s64, 16
v_mfma_f32_16x16x32_bf16 v[152:155], v[128:131], v[104:107], v[152:155]
v_mfma_f32_16x16x32_bf16 v[160:163], v[128:131], v[108:111], v[160:163]
v_mfma_f32_16x16x32_bf16 v[168:171], v[128:131], v[112:115], v[168:171]
v_mfma_f32_16x16x32_bf16 v[176:179], v[128:131], v[116:119], v[176:179]
s_cbranch_scc1 c2_loop1
c2_epi:
s_waitcnt lgkmcnt(0)
s_lshl_b32 s48, s43, 12
s_add_u32 s48, s48, 139264
s_lshl_b32 s49, s44, 11
s_add_u32 s49, s49, s48
v_add_u32 v5, s49, v18
ds_write_b128 v5, v[244:247]
ds_write_b128 v5, v[248:251] offset:1024
s_cmp_eq_u32 s44, 1
s_cbranch_scc1 c2_nodump
ds_write_b128 v5, v[204:207] offset:8192
ds_write_b128 v5, v[236:239] offset:9216
ds_write_b128 v5, v[208:211] offset:10240
ds_write_b128 v5, v[240:243] offset:11264
c2_nodump:
s_lshl_b32 s49, s44, 13
s_add_u32 s49, s49, s48
v_add_u32 v5, s49, v18
s_lshl_b32 s48, s43, 7
s_add_u32 s48, s48, 133376
v_lshl_add_u32 v6, v3, 4, s48
v_lshl_add_u32 v7, v2, 2, s48
s_lshl_b32 s49, s44, 6
v_add_u32 v8, s49, v2
v_lshlrev_b32 v8, 3, v8
v_add_u32 v8, 131072, v8
v_lshl_add_u32 v9, v3, 2, s49
v_lshlrev_b32 v9, 2, v9
v_add_u32 v9, 132224, v9
s_waitcnt lgkmcnt(0)
s_barrier
ds_read_b128 v[60:63], v6 offset:0
ds_read_b128 v[64:67], v6 offset:64
ds_read_b128 v[68:71], v6 offset:256
ds_read_b128 v[72:75], v6 offset:320
ds_read_b64 v[78:79], v8 offset:0
ds_read_b64 v[80:81], v8 offset:128
ds_read_b64 v[82:83], v8 offset:256
ds_read_b64 v[84:85], v8 offset:384
ds_read_b64 v[86:87], v8 offset:512
ds_read_b128 v[128:131], v5 offset:0
ds_read_b128 v[132:135], v5 offset:2048
ds_read_b32 v76, v7 offset:512
ds_read_b32 v77, v7 offset:576
ds_read_b128 v[136:139], v5 offset:1024
ds_read_b128 v[140:143], v5 offset:3072
ds_read_b128 v[88:91], v9 offset:0
ds_read_b128 v[108:111], v9 offset:576
ds_read_b128 v[92:95], v9 offset:64
ds_read_b128 v[112:115], v9 offset:640
ds_read_b128 v[96:99], v9 offset:128
ds_read_b128 v[116:119], v9 offset:704
ds_read_b128 v[100:103], v9 offset:192
ds_read_b128 v[120:123], v9 offset:768
ds_read_b128 v[104:107], v9 offset:256
ds_read_b128 v[124:127], v9 offset:832
s_waitcnt lgkmcnt(14)
v_pk_fma_f32 v[148:149], v[60:61], v[80:81], v[148:149] op_sel:[0,1,0] op_sel_hi:[1,1,1]
v_pk_fma_f32 v[150:151], v[62:63], v[80:81], v[150:151] op_sel:[0,1,0] op_sel_hi:[1,1,1]
v_pk_fma_f32 v[152:153], v[64:65], v[80:81], v[152:153] op_sel:[0,1,0] op_sel_hi:[1,1,1]
v_pk_fma_f32 v[154:155], v[66:67], v[80:81], v[154:155] op_sel:[0,1,0] op_sel_hi:[1,1,1]
v_pk_mul_f32 v[148:149], v[148:149], v[80:81] op_sel:[0,0] op_sel_hi:[1,0]
v_pk_mul_f32 v[150:151], v[150:151], v[80:81] op_sel:[0,0] op_sel_hi:[1,0]
v_pk_mul_f32 v[152:153], v[152:153], v[80:81] op_sel:[0,0] op_sel_hi:[1,0]
v_pk_mul_f32 v[154:155], v[154:155], v[80:81] op_sel:[0,0] op_sel_hi:[1,0]
v_cvt_pk_bf16_f32 v148, v148, v149
v_cvt_pk_bf16_f32 v149, v150, v151
v_cvt_pk_bf16_f32 v150, v152, v153
v_cvt_pk_bf16_f32 v151, v154, v155
v_pk_fma_f32 v[156:157], v[60:61], v[82:83], v[156:157] op_sel:[0,1,0] op_sel_hi:[1,1,1]
v_pk_fma_f32 v[158:159], v[62:63], v[82:83], v[158:159] op_sel:[0,1,0] op_sel_hi:[1,1,1]
v_pk_fma_f32 v[160:161], v[64:65], v[82:83], v[160:161] op_sel:[0,1,0] op_sel_hi:[1,1,1]
v_pk_fma_f32 v[162:163], v[66:67], v[82:83], v[162:163] op_sel:[0,1,0] op_sel_hi:[1,1,1]
v_pk_mul_f32 v[156:157], v[156:157], v[82:83] op_sel:[0,0] op_sel_hi:[1,0]
v_pk_mul_f32 v[158:159], v[158:159], v[82:83] op_sel:[0,0] op_sel_hi:[1,0]
v_pk_mul_f32 v[160:161], v[160:161], v[82:83] op_sel:[0,0] op_sel_hi:[1,0]
v_pk_mul_f32 v[162:163], v[162:163], v[82:83] op_sel:[0,0] op_sel_hi:[1,0]
v_cvt_pk_bf16_f32 v156, v156, v157
v_cvt_pk_bf16_f32 v157, v158, v159
v_cvt_pk_bf16_f32 v158, v160, v161
v_cvt_pk_bf16_f32 v159, v162, v163
v_pk_fma_f32 v[164:165], v[60:61], v[84:85], v[164:165] op_sel:[0,1,0] op_sel_hi:[1,1,1]
v_pk_fma_f32 v[166:167], v[62:63], v[84:85], v[166:167] op_sel:[0,1,0] op_sel_hi:[1,1,1]
v_pk_fma_f32 v[168:169], v[64:65], v[84:85], v[168:169] op_sel:[0,1,0] op_sel_hi:[1,1,1]
v_pk_fma_f32 v[170:171], v[66:67], v[84:85], v[170:171] op_sel:[0,1,0] op_sel_hi:[1,1,1]
v_pk_mul_f32 v[164:165], v[164:165], v[84:85] op_sel:[0,0] op_sel_hi:[1,0]
v_pk_mul_f32 v[166:167], v[166:167], v[84:85] op_sel:[0,0] op_sel_hi:[1,0]
v_pk_mul_f32 v[168:169], v[168:169], v[84:85] op_sel:[0,0] op_sel_hi:[1,0]
v_pk_mul_f32 v[170:171], v[170:171], v[84:85] op_sel:[0,0] op_sel_hi:[1,0]
v_cvt_pk_bf16_f32 v164, v164, v165
v_cvt_pk_bf16_f32 v165, v166, v167
v_cvt_pk_bf16_f32 v166, v168, v169
v_cvt_pk_bf16_f32 v167, v170, v171
v_pk_fma_f32 v[172:173], v[60:61], v[86:87], v[172:173] op_sel:[0,1,0] op_sel_hi:[1,1,1]
v_pk_fma_f32 v[174:175], v[62:63], v[86:87], v[174:175] op_sel:[0,1,0] op_sel_hi:[1,1,1]
v_pk_fma_f32 v[176:177], v[64:65], v[86:87], v[176:177] op_sel:[0,1,0] op_sel_hi:[1,1,1]
v_pk_fma_f32 v[178:179], v[66:67], v[86:87], v[178:179] op_sel:[0,1,0] op_sel_hi:[1,1,1]
v_pk_mul_f32 v[172:173], v[172:173], v[86:87] op_sel:[0,0] op_sel_hi:[1,0]
v_pk_mul_f32 v[174:175], v[174:175], v[86:87] op_sel:[0,0] op_sel_hi:[1,0]
v_pk_mul_f32 v[176:177], v[176:177], v[86:87] op_sel:[0,0] op_sel_hi:[1,0]
v_pk_mul_f32 v[178:179], v[178:179], v[86:87] op_sel:[0,0] op_sel_hi:[1,0]
v_cvt_pk_bf16_f32 v172, v172, v173
v_cvt_pk_bf16_f32 v173, v174, v175
v_cvt_pk_bf16_f32 v174, v176, v177
v_cvt_pk_bf16_f32 v175, v178, v179
v_pk_fma_f32 v[128:129], v[68:69], v[78:79], v[128:129] op_sel:[0,1,0] op_sel_hi:[1,1,1]
v_pk_fma_f32 v[130:131], v[70:71], v[78:79], v[130:131] op_sel:[0,1,0] op_sel_hi:[1,1,1]
v_pk_fma_f32 v[132:133], v[72:73], v[78:79], v[132:133] op_sel:[0,1,0] op_sel_hi:[1,1,1]
v_pk_fma_f32 v[134:135], v[74:75], v[78:79], v[134:135] op_sel:[0,1,0] op_sel_hi:[1,1,1]
v_pk_mul_f32 v[128:129], v[128:129], v[78:79] op_sel:[0,0] op_sel_hi:[1,0]
v_pk_mul_f32 v[130:131], v[130:131], v[78:79] op_sel:[0,0] op_sel_hi:[1,0]
v_pk_mul_f32 v[132:133], v[132:133], v[78:79] op_sel:[0,0] op_sel_hi:[1,0]
v_pk_mul_f32 v[134:135], v[134:135], v[78:79] op_sel:[0,0] op_sel_hi:[1,0]
v_cvt_pk_bf16_f32 v128, v128, v129
v_cvt_pk_bf16_f32 v129, v130, v131
v_cvt_pk_bf16_f32 v130, v132, v133
v_cvt_pk_bf16_f32 v131, v134, v135
v_pk_fma_f32 v[180:181], v[68:69], v[80:81], v[180:181] op_sel:[0,1,0] op_sel_hi:[1,1,1]
v_pk_fma_f32 v[182:183], v[70:71], v[80:81], v[182:183] op_sel:[0,1,0] op_sel_hi:[1,1,1]
v_pk_fma_f32 v[184:185], v[72:73], v[80:81], v[184:185] op_sel:[0,1,0] op_sel_hi:[1,1,1]
v_pk_fma_f32 v[186:187], v[74:75], v[80:81], v[186:187] op_sel:[0,1,0] op_sel_hi:[1,1,1]
v_pk_mul_f32 v[180:181], v[180:181], v[80:81] op_sel:[0,0] op_sel_hi:[1,0]
v_pk_mul_f32 v[182:183], v[182:183], v[80:81] op_sel:[0,0] op_sel_hi:[1,0]
v_pk_mul_f32 v[184:185], v[184:185], v[80:81] op_sel:[0,0] op_sel_hi:[1,0]
v_pk_mul_f32 v[186:187], v[186:187], v[80:81] op_sel:[0,0] op_sel_hi:[1,0]
v_cvt_pk_bf16_f32 v180, v180, v181
v_cvt_pk_bf16_f32 v181, v182, v183
v_cvt_pk_bf16_f32 v182, v184, v185
v_cvt_pk_bf16_f32 v183, v186, v187
v_pk_fma_f32 v[188:189], v[68:69], v[82:83], v[188:189] op_sel:[0,1,0] op_sel_hi:[1,1,1]
v_pk_fma_f32 v[190:191], v[70:71], v[82:83], v[190:191] op_sel:[0,1,0] op_sel_hi:[1,1,1]
v_pk_fma_f32 v[192:193], v[72:73], v[82:83], v[192:193] op_sel:[0,1,0] op_sel_hi:[1,1,1]
v_pk_fma_f32 v[194:195], v[74:75], v[82:83], v[194:195] op_sel:[0,1,0] op_sel_hi:[1,1,1]
v_pk_mul_f32 v[188:189], v[188:189], v[82:83] op_sel:[0,0] op_sel_hi:[1,0]
v_pk_mul_f32 v[190:191], v[190:191], v[82:83] op_sel:[0,0] op_sel_hi:[1,0]
v_pk_mul_f32 v[192:193], v[192:193], v[82:83] op_sel:[0,0] op_sel_hi:[1,0]
v_pk_mul_f32 v[194:195], v[194:195], v[82:83] op_sel:[0,0] op_sel_hi:[1,0]
v_cvt_pk_bf16_f32 v188, v188, v189
v_cvt_pk_bf16_f32 v189, v190, v191
v_cvt_pk_bf16_f32 v190, v192, v193
v_cvt_pk_bf16_f32 v191, v194, v195
v_pk_fma_f32 v[196:197], v[68:69], v[84:85], v[196:197] op_sel:[0,1,0] op_sel_hi:[1,1,1]
v_pk_fma_f32 v[198:199], v[70:71], v[84:85], v[198:199] op_sel:[0,1,0] op_sel_hi:[1,1,1]
v_pk_fma_f32 v[200:201], v[72:73], v[84:85], v[200:201] op_sel:[0,1,0] op_sel_hi:[1,1,1]
v_pk_fma_f32 v[202:203], v[74:75], v[84:85], v[202:203] op_sel:[0,1,0] op_sel_hi:[1,1,1]
v_pk_mul_f32 v[196:197], v[196:197], v[84:85] op_sel:[0,0] op_sel_hi:[1,0]
v_pk_mul_f32 v[198:199], v[198:199], v[84:85] op_sel:[0,0] op_sel_hi:[1,0]
v_pk_mul_f32 v[200:201], v[200:201], v[84:85] op_sel:[0,0] op_sel_hi:[1,0]
v_pk_mul_f32 v[202:203], v[202:203], v[84:85] op_sel:[0,0] op_sel_hi:[1,0]
v_cvt_pk_bf16_f32 v196, v196, v197
v_cvt_pk_bf16_f32 v197, v198, v199
v_cvt_pk_bf16_f32 v198, v200, v201
v_cvt_pk_bf16_f32 v199, v202, v203
v_pk_fma_f32 v[204:205], v[68:69], v[86:87], v[204:205] op_sel:[0,1,0] op_sel_hi:[1,1,1]
v_pk_fma_f32 v[206:207], v[70:71], v[86:87], v[206:207] op_sel:[0,1,0] op_sel_hi:[1,1,1]
v_pk_fma_f32 v[208:209], v[72:73], v[86:87], v[208:209] op_sel:[0,1,0] op_sel_hi:[1,1,1]
v_pk_fma_f32 v[210:211], v[74:75], v[86:87], v[210:211] op_sel:[0,1,0] op_sel_hi:[1,1,1]
v_pk_mul_f32 v[204:205], v[204:205], v[86:87] op_sel:[0,0] op_sel_hi:[1,0]
v_pk_mul_f32 v[206:207], v[206:207], v[86:87] op_sel:[0,0] op_sel_hi:[1,0]
v_pk_mul_f32 v[208:209], v[208:209], v[86:87] op_sel:[0,0] op_sel_hi:[1,0]
v_pk_mul_f32 v[210:211], v[210:211], v[86:87] op_sel:[0,0] op_sel_hi:[1,0]
v_cvt_pk_bf16_f32 v204, v204, v205
v_cvt_pk_bf16_f32 v205, v206, v207
v_cvt_pk_bf16_f32 v206, v208, v209
v_cvt_pk_bf16_f32 v207, v210, v211
s_mov_b32 s48, 0xf149f2ca
v_mov_b32 v53, s48
v_lshlrev_b32 v4, 2, v3
v_sub_u32 v4, v2, v4
v_subrev_u32 v5, 0, v4
v_and_b32 v6, 0x80000001, v5
v_cmp_eq_u32 vcc, 0, v6
v_add_u32 v5, 1, v5
v_and_b32 v6, 0x80000001, v5
v_cndmask_b32 v44, v53, 0, vcc
v_cmp_eq_u32 vcc, 0x80000001, v6
s_nop 1
v_cndmask_b32 v40, v53, 0, vcc
v_subrev_u32 v5, 1, v4
v_and_b32 v6, 0x80000001, v5
v_cmp_eq_u32 vcc, 0, v6
v_add_u32 v5, 1, v5
v_and_b32 v6, 0x80000001, v5
v_cndmask_b32 v45, v53, 0, vcc
v_cmp_eq_u32 vcc, 0x80000001, v6
s_nop 1
v_cndmask_b32 v41, v53, 0, vcc
v_subrev_u32 v5, 2, v4
v_and_b32 v6, 0x80000001, v5
v_cmp_eq_u32 vcc, 0, v6
v_add_u32 v5, 1, v5
v_and_b32 v6, 0x80000001, v5
v_cndmask_b32 v46, v53, 0, vcc
v_cmp_eq_u32 vcc, 0x80000001, v6
s_nop 1
v_cndmask_b32 v42, v53, 0, vcc
v_subrev_u32 v5, 3, v4
v_and_b32 v6, 0x80000001, v5
v_cmp_eq_u32 vcc, 0, v6
v_add_u32 v5, 1, v5
v_and_b32 v6, 0x80000001, v5
v_cndmask_b32 v47, v53, 0, vcc
v_cmp_eq_u32 vcc, 0x80000001, v6
s_nop 1
v_cndmask_b32 v43, v53, 0, vcc
s_or_b32 s48, s41, s44
s_cmp_eq_u32 s48, 0
s_cselect_b64 vcc, -1, 0
v_cndmask_b32 v48, v40, v53, vcc
v_cndmask_b32 v49, v41, v53, vcc
v_cndmask_b32 v50, v42, v53, vcc
v_cndmask_b32 v51, v43, v53, vcc
v_and_b32 v4, 1, v2
v_lshlrev_b32 v4, 4, v4
v_mov_b32 v5, 0xffff
v_lshlrev_b32 v52, v4, v5
v_mov_b32 v56, 0x3f803f80
v_mov_b32 v57, 0x3f803f80
v_mov_b32 v58, 0x3f803f80
v_mov_b32 v59, 0x3f803f80
v_mfma_f32_16x16x32_bf16 v[152:155], v[128:131], v[148:151], v[48:51]
v_mfma_f32_16x16x32_bf16 v[184:187], v[180:183], v[148:151], v[44:47]
v_mfma_f32_16x16x32_bf16 v[160:163], v[180:183], v[156:159], v[40:43]
v_mfma_f32_16x16x32_bf16 v[192:195], v[188:191], v[156:159], v[44:47]
v_mfma_f32_16x16x32_bf16 v[168:171], v[188:191], v[164:167], v[40:43]
v_mfma_f32_16x16x32_bf16 v[200:203], v[196:199], v[164:167], v[44:47]
v_mfma_f32_16x16x32_bf16 v[176:179], v[196:199], v[172:175], v[40:43]
v_mfma_f32_16x16x32_bf16 v[208:211], v[204:207], v[172:175], v[44:47]
s_waitcnt lgkmcnt(0)
v_pk_fma_f32 v[136:137], v[108:109], v[76:77], v[136:137] op_sel:[0,0,0] op_sel_hi:[1,0,1]
v_pk_fma_f32 v[138:139], v[110:111], v[76:77], v[138:139] op_sel:[0,0,0] op_sel_hi:[1,0,1]
v_pk_mul_f32 v[136:137], v[136:137], v[88:89]
v_pk_mul_f32 v[138:139], v[138:139], v[90:91]
v_cvt_pk_bf16_f32 v20, v136, v137
v_cvt_pk_bf16_f32 v21, v138, v139
v_pk_fma_f32 v[212:213], v[112:113], v[76:77], v[212:213] op_sel:[0,0,0] op_sel_hi:[1,0,1]
v_pk_fma_f32 v[214:215], v[114:115], v[76:77], v[214:215] op_sel:[0,0,0] op_sel_hi:[1,0,1]
v_pk_mul_f32 v[212:213], v[212:213], v[92:93]
v_pk_mul_f32 v[214:215], v[214:215], v[94:95]
v_cvt_pk_bf16_f32 v22, v212, v213
v_cvt_pk_bf16_f32 v23, v214, v215
v_pk_fma_f32 v[220:221], v[116:117], v[76:77], v[220:221] op_sel:[0,0,0] op_sel_hi:[1,0,1]
v_pk_fma_f32 v[222:223], v[118:119], v[76:77], v[222:223] op_sel:[0,0,0] op_sel_hi:[1,0,1]
v_pk_mul_f32 v[220:221], v[220:221], v[96:97]
v_pk_mul_f32 v[222:223], v[222:223], v[98:99]
v_cvt_pk_bf16_f32 v24, v220, v221
v_cvt_pk_bf16_f32 v25, v222, v223
v_pk_fma_f32 v[228:229], v[120:121], v[76:77], v[228:229] op_sel:[0,0,0] op_sel_hi:[1,0,1]
v_pk_fma_f32 v[230:231], v[122:123], v[76:77], v[230:231] op_sel:[0,0,0] op_sel_hi:[1,0,1]
v_pk_mul_f32 v[228:229], v[228:229], v[100:101]
v_pk_mul_f32 v[230:231], v[230:231], v[102:103]
v_cvt_pk_bf16_f32 v26, v228, v229
v_cvt_pk_bf16_f32 v27, v230, v231
v_pk_fma_f32 v[236:237], v[124:125], v[76:77], v[236:237] op_sel:[0,0,0] op_sel_hi:[1,0,1]
v_pk_fma_f32 v[238:239], v[126:127], v[76:77], v[238:239] op_sel:[0,0,0] op_sel_hi:[1,0,1]
v_pk_mul_f32 v[236:237], v[236:237], v[104:105]
v_pk_mul_f32 v[238:239], v[238:239], v[106:107]
v_cvt_pk_bf16_f32 v28, v236, v237
v_cvt_pk_bf16_f32 v29, v238, v239
v_pk_fma_f32 v[140:141], v[108:109], v[76:77], v[140:141] op_sel:[0,1,0] op_sel_hi:[1,1,1]
v_pk_fma_f32 v[142:143], v[110:111], v[76:77], v[142:143] op_sel:[0,1,0] op_sel_hi:[1,1,1]
v_pk_mul_f32 v[140:141], v[140:141], v[88:89]
v_pk_mul_f32 v[142:143], v[142:143], v[90:91]
v_cvt_pk_bf16_f32 v30, v140, v141
v_cvt_pk_bf16_f32 v31, v142, v143
v_pk_fma_f32 v[216:217], v[112:113], v[76:77], v[216:217] op_sel:[0,1,0] op_sel_hi:[1,1,1]
v_pk_fma_f32 v[218:219], v[114:115], v[76:77], v[218:219] op_sel:[0,1,0] op_sel_hi:[1,1,1]
v_pk_mul_f32 v[216:217], v[216:217], v[92:93]
v_pk_mul_f32 v[218:219], v[218:219], v[94:95]
v_cvt_pk_bf16_f32 v32, v216, v217
v_cvt_pk_bf16_f32 v33, v218, v219
v_pk_fma_f32 v[224:225], v[116:117], v[76:77], v[224:225] op_sel:[0,1,0] op_sel_hi:[1,1,1]
v_pk_fma_f32 v[226:227], v[118:119], v[76:77], v[226:227] op_sel:[0,1,0] op_sel_hi:[1,1,1]
v_pk_mul_f32 v[224:225], v[224:225], v[96:97]
v_pk_mul_f32 v[226:227], v[226:227], v[98:99]
v_cvt_pk_bf16_f32 v34, v224, v225
v_cvt_pk_bf16_f32 v35, v226, v227
v_pk_fma_f32 v[232:233], v[120:121], v[76:77], v[232:233] op_sel:[0,1,0] op_sel_hi:[1,1,1]
v_pk_fma_f32 v[234:235], v[122:123], v[76:77], v[234:235] op_sel:[0,1,0] op_sel_hi:[1,1,1]
v_pk_mul_f32 v[232:233], v[232:233], v[100:101]
v_pk_mul_f32 v[234:235], v[234:235], v[102:103]
v_cvt_pk_bf16_f32 v36, v232, v233
v_cvt_pk_bf16_f32 v37, v234, v235
v_pk_fma_f32 v[240:241], v[124:125], v[76:77], v[240:241] op_sel:[0,1,0] op_sel_hi:[1,1,1]
v_pk_fma_f32 v[242:243], v[126:127], v[76:77], v[242:243] op_sel:[0,1,0] op_sel_hi:[1,1,1]
v_pk_mul_f32 v[240:241], v[240:241], v[104:105]
v_pk_mul_f32 v[242:243], v[242:243], v[106:107]
v_cvt_pk_bf16_f32 v38, v240, v241
v_cvt_pk_bf16_f32 v39, v242, v243
s_mov_b32 s66, 0x3e8293ee
v_max_f32 v148, v152, v153
v_max_f32 v149, v154, v155
v_max_f32 v150, v184, v185
v_max_f32 v151, v186, v187
v_max3_f32 v60, v148, v149, v150
v_max_f32 v60, v60, v151
v_max_f32 v156, v160, v161
v_max_f32 v157, v162, v163
v_max_f32 v158, v192, v193
v_max_f32 v159, v194, v195
v_max3_f32 v61, v156, v157, v158
v_max_f32 v61, v61, v159
v_max_f32 v164, v168, v169
v_max_f32 v165, v170, v171
v_max_f32 v166, v200, v201
v_max_f32 v167, v202, v203
v_max3_f32 v62, v164, v165, v166
v_max_f32 v62, v62, v167
v_max_f32 v172, v176, v177
v_max_f32 v173, v178, v179
v_max_f32 v174, v208, v209
v_max_f32 v175, v210, v211
v_max3_f32 v63, v172, v173, v174
v_max_f32 v63, v63, v175
s_nop 1
v_permlane32_swap_b32 v60, v61
v_permlane32_swap_b32 v62, v63
s_nop 0
v_max_f32 v60, v60, v61
v_max_f32 v62, v62, v63
s_nop 1
v_permlane16_swap_b32 v60, v62
s_nop 0
v_max_f32 v60, v60, v62
v_mul_f32 v60, s66, v60
v_mov_b32 v62, v60
s_nop 1
v_permlane16_swap_b32 v60, v62
s_nop 0
v_mov_b32 v61, v60
v_mov_b32 v63, v62
s_nop 1
v_permlane32_swap_b32 v60, v61
v_permlane32_swap_b32 v62, v63
s_nop 0
v_fma_f32 v148, v148, s66, -v60
v_fma_f32 v149, v149, s66, -v60
v_fma_f32 v150, v150, s66, -v60
v_fma_f32 v151, v151, s66, -v60
v_exp_f32 v148, v148
v_exp_f32 v149, v149
v_exp_f32 v150, v150
v_exp_f32 v151, v151
v_fma_f32 v156, v156, s66, -v61
v_fma_f32 v157, v157, s66, -v61
v_fma_f32 v158, v158, s66, -v61
v_fma_f32 v159, v159, s66, -v61
v_exp_f32 v156, v156
v_exp_f32 v157, v157
v_exp_f32 v158, v158
v_exp_f32 v159, v159
v_fma_f32 v164, v164, s66, -v62
v_fma_f32 v165, v165, s66, -v62
v_fma_f32 v166, v166, s66, -v62
v_fma_f32 v167, v167, s66, -v62
v_exp_f32 v164, v164
v_exp_f32 v165, v165
v_exp_f32 v166, v166
v_exp_f32 v167, v167
v_fma_f32 v172, v172, s66, -v63
v_fma_f32 v173, v173, s66, -v63
v_fma_f32 v174, v174, s66, -v63
v_fma_f32 v175, v175, s66, -v63
v_exp_f32 v172, v172
v_exp_f32 v173, v173
v_exp_f32 v174, v174
v_exp_f32 v175, v175
v_cvt_pk_bf16_f32 v148, v148, v148
v_cvt_pk_bf16_f32 v149, v149, v149
v_cvt_pk_bf16_f32 v150, v150, v150
v_cvt_pk_bf16_f32 v151, v151, v151
v_and_b32 v148, v52, v148
v_and_b32 v149, v52, v149
v_and_b32 v150, v52, v150
v_and_b32 v151, v52, v151
v_cvt_pk_bf16_f32 v156, v156, v156
v_cvt_pk_bf16_f32 v157, v157, v157
v_cvt_pk_bf16_f32 v158, v158, v158
v_cvt_pk_bf16_f32 v159, v159, v159
v_and_b32 v156, v52, v156
v_and_b32 v157, v52, v157
v_and_b32 v158, v52, v158
v_and_b32 v159, v52, v159
v_cvt_pk_bf16_f32 v164, v164, v164
v_cvt_pk_bf16_f32 v165, v165, v165
v_cvt_pk_bf16_f32 v166, v166, v166
v_cvt_pk_bf16_f32 v167, v167, v167
v_and_b32 v164, v52, v164
v_and_b32 v165, v52, v165
v_and_b32 v166, v52, v166
v_and_b32 v167, v52, v167
v_cvt_pk_bf16_f32 v172, v172, v172
v_cvt_pk_bf16_f32 v173, v173, v173
v_cvt_pk_bf16_f32 v174, v174, v174
v_cvt_pk_bf16_f32 v175, v175, v175
v_and_b32 v172, v52, v172
v_and_b32 v173, v52, v173
v_and_b32 v174, v52, v174
v_and_b32 v175, v52, v175
s_nop 1
v_mfma_f32_16x16x32_bf16 v[152:155], v[56:59], v[148:151], 0
v_mfma_f32_16x16x32_bf16 v[160:163], v[56:59], v[156:159], 0
v_mfma_f32_16x16x32_bf16 v[168:171], v[56:59], v[164:167], 0
v_mfma_f32_16x16x32_bf16 v[176:179], v[56:59], v[172:175], 0
v_mfma_f32_16x16x32_bf16 v[212:215], v[20:23], v[148:151], 0
v_mfma_f32_16x16x32_bf16 v[216:219], v[30:33], v[148:151], 0
v_mfma_f32_16x16x32_bf16 v[220:223], v[22:25], v[156:159], 0
v_mfma_f32_16x16x32_bf16 v[224:227], v[32:35], v[156:159], 0
v_mfma_f32_16x16x32_bf16 v[228:231], v[24:27], v[164:167], 0
v_mfma_f32_16x16x32_bf16 v[232:235], v[34:37], v[164:167], 0
v_mfma_f32_16x16x32_bf16 v[236:239], v[26:29], v[172:175], 0
v_mfma_f32_16x16x32_bf16 v[240:243], v[36:39], v[172:175], 0
v_rcp_f32 v152, v152
v_rcp_f32 v160, v160
v_rcp_f32 v168, v168
v_rcp_f32 v176, v176
s_lshl_b32 s48, s41, 3
s_lshl_b32 s49, s44, 2
s_add_u32 s48, s48, s49
s_lshl_b32 s48, s48, 5
s_add_u32 s48, s48, s45
s_lshl_b32 s48, s48, 10
s_add_u32 s48, s48, 4194304
s_add_u32 s49, s48, 32768
s_add_u32 s50, s48, 65536
s_add_u32 s51, s48, 98304
s_lshl_b32 s52, s41, 2
s_add_u32 s52, s52, s44
s_lshl_b32 s52, s52, 7
s_add_u32 s52, s52, 14155776
s_cmp_eq_u32 s46, 0
s_cbranch_scc1 slow_18
v_pk_mul_f32 v[212:213], v[212:213], v[152:153] op_sel:[0,0] op_sel_hi:[1,0]
v_pk_mul_f32 v[214:215], v[214:215], v[152:153] op_sel:[0,0] op_sel_hi:[1,0]
v_pk_mul_f32 v[216:217], v[216:217], v[152:153] op_sel:[0,0] op_sel_hi:[1,0]
v_pk_mul_f32 v[218:219], v[218:219], v[152:153] op_sel:[0,0] op_sel_hi:[1,0]
v_cvt_pk_bf16_f32 v212, v212, v213
v_cvt_pk_bf16_f32 v213, v214, v215
v_cvt_pk_bf16_f32 v214, v216, v217
v_cvt_pk_bf16_f32 v215, v218, v219
buffer_store_dwordx4 v[212:215], v18, s[32:35], s48 offen
v_pk_mul_f32 v[220:221], v[220:221], v[160:161] op_sel:[0,0] op_sel_hi:[1,0]
v_pk_mul_f32 v[222:223], v[222:223], v[160:161] op_sel:[0,0] op_sel_hi:[1,0]
v_pk_mul_f32 v[224:225], v[224:225], v[160:161] op_sel:[0,0] op_sel_hi:[1,0]
v_pk_mul_f32 v[226:227], v[226:227], v[160:161] op_sel:[0,0] op_sel_hi:[1,0]
v_cvt_pk_bf16_f32 v220, v220, v221
v_cvt_pk_bf16_f32 v221, v222, v223
v_cvt_pk_bf16_f32 v222, v224, v225
v_cvt_pk_bf16_f32 v223, v226, v227
buffer_store_dwordx4 v[220:223], v18, s[32:35], s49 offen
v_pk_mul_f32 v[228:229], v[228:229], v[168:169] op_sel:[0,0] op_sel_hi:[1,0]
v_pk_mul_f32 v[230:231], v[230:231], v[168:169] op_sel:[0,0] op_sel_hi:[1,0]
v_pk_mul_f32 v[232:233], v[232:233], v[168:169] op_sel:[0,0] op_sel_hi:[1,0]
v_pk_mul_f32 v[234:235], v[234:235], v[168:169] op_sel:[0,0] op_sel_hi:[1,0]
v_cvt_pk_bf16_f32 v228, v228, v229
v_cvt_pk_bf16_f32 v229, v230, v231
v_cvt_pk_bf16_f32 v230, v232, v233
v_cvt_pk_bf16_f32 v231, v234, v235
buffer_store_dwordx4 v[228:231], v18, s[32:35], s50 offen
v_pk_mul_f32 v[236:237], v[236:237], v[176:177] op_sel:[0,0] op_sel_hi:[1,0]
v_pk_mul_f32 v[238:239], v[238:239], v[176:177] op_sel:[0,0] op_sel_hi:[1,0]
v_pk_mul_f32 v[240:241], v[240:241], v[176:177] op_sel:[0,0] op_sel_hi:[1,0]
v_pk_mul_f32 v[242:243], v[242:243], v[176:177] op_sel:[0,0] op_sel_hi:[1,0]
v_cvt_pk_bf16_f32 v236, v236, v237
v_cvt_pk_bf16_f32 v237, v238, v239
v_cvt_pk_bf16_f32 v238, v240, v241
v_cvt_pk_bf16_f32 v239, v242, v243
buffer_store_dwordx4 v[236:239], v18, s[32:35], s51 offen
s_waitcnt vmcnt(0)
s_lshl_b32 s62, s45, 2
v_mov_b32 v4, s62
v_mov_b32 v5, 3
s_mov_b64 exec, 1
buffer_store_dword v5, v4, s[32:35], s52 offen
s_mov_b64 exec, -1
back_19:
s_lshl_b32 s48, s41, 3
s_lshl_b32 s49, s40, 1
s_add_u32 s48, s48, s49
s_lshl_b32 s48, s48, 15
s_lshl_b32 s49, s42, 11
s_add_u32 s48, s48, s49
s_add_u32 s49, s48, 32768
buffer_load_dwordx4 v[88:91], v18, s[32:35], s48 offen offset:0 sc1
buffer_load_dwordx4 v[92:95], v18, s[32:35], s48 offen offset:1024 sc1
buffer_load_dwordx4 v[96:99], v18, s[32:35], s49 offen offset:0 sc1
buffer_load_dwordx4 v[100:103], v18, s[32:35], s49 offen offset:1024 sc1
v_lshrrev_b32 v4, 2, v2
v_and_b32 v5, 3, v0
v_lshl_add_u32 v6, v3, 3, v4
v_lshlrev_b32 v6, 7, v6
v_lshl_add_u32 v6, v5, 3, v6
v_lshrrev_b32 v7, 1, v4
v_and_b32 v8, 1, v3
v_lshl_add_u32 v7, v8, 1, v7
v_lshl_add_u32 v14, v7, 5, v6
v_xor_b32 v15, 32, v14
v_xor_b32 v16, 64, v14
v_xor_b32 v17, 96, v14
s_lshl_b32 s48, s41, 3
s_lshl_b32 s49, s40, 1
s_add_u32 s56, s48, s49
s_lshl_b32 s48, s56, 15
s_add_u32 s48, s48, 4194304
v_add_u32 v12, s48, v18
v_add_u32 v13, 32768, v12
v_mov_b32 v20, 0
v_mov_b32 v21, 0
v_mov_b32 v22, 0
v_mov_b32 v23, 0
v_mov_b32 v24, 0
v_mov_b32 v25, 0
v_mov_b32 v26, 0
v_mov_b32 v27, 0
v_mov_b32 v28, 0
v_mov_b32 v29, 0
v_mov_b32 v30, 0
v_mov_b32 v31, 0
v_mov_b32 v32, 0
v_mov_b32 v33, 0
v_mov_b32 v34, 0
v_mov_b32 v35, 0
v_mov_b32 v36, 0
v_mov_b32 v37, 0
v_mov_b32 v38, 0
v_mov_b32 v39, 0
v_mov_b32 v40, 0
v_mov_b32 v41, 0
v_mov_b32 v42, 0
v_mov_b32 v43, 0
v_mov_b32 v44, 0
v_mov_b32 v45, 0
v_mov_b32 v46, 0
v_mov_b32 v47, 0
v_mov_b32 v48, 0
v_mov_b32 v49, 0
v_mov_b32 v50, 0
v_mov_b32 v51, 0
s_lshl_b32 s57, s47, 11
s_lshl_b32 s52, s41, 2
s_add_u32 s52, s52, s44
s_lshl_b32 s52, s52, 7
s_add_u32 s52, s52, 14155776
v_and_b32 v4, 31, v0
v_lshlrev_b32 v4, 2, v4
buffer_load_dword v5, v4, s[32:35], s52 offen sc1
s_barrier
ds_read_b64_tr_b16 v[212:213], v14 offset:0
ds_read_b64_tr_b16 v[214:215], v14 offset:512
ds_read_b64_tr_b16 v[216:217], v15 offset:0
ds_read_b64_tr_b16 v[218:219], v15 offset:512
ds_read_b64_tr_b16 v[220:221], v16 offset:0
ds_read_b64_tr_b16 v[222:223], v16 offset:512
ds_read_b64_tr_b16 v[224:225], v17 offset:0
ds_read_b64_tr_b16 v[226:227], v17 offset:512
s_mov_b32 s63, 0
s_waitcnt vmcnt(0)
poll_20:
v_cmp_gt_u32 vcc, 3, v5
s_cbranch_vccz polled_21
buffer_load_dword v5, v4, s[32:35], s52 offen sc1
s_add_u32 s63, s63, 1
s_cmp_lt_u32 s63, 0x80000
s_waitcnt vmcnt(0)
s_cbranch_scc1 poll_20
polled_21:
buffer_load_dwordx4 v[148:151], v12, s[32:35], s57 offen sc1
buffer_load_dwordx4 v[152:155], v13, s[32:35], s57 offen sc1
buffer_load_dwordx4 v[156:159], v12, s[32:35], s57 offen offset:1024 sc1
buffer_load_dwordx4 v[160:163], v13, s[32:35], s57 offen offset:1024 sc1
s_add_u32 s57, s57, 2048
s_and_b32 s57, s57, 0x7fff
buffer_load_dwordx4 v[164:167], v12, s[32:35], s57 offen sc1
buffer_load_dwordx4 v[168:171], v13, s[32:35], s57 offen sc1
buffer_load_dwordx4 v[172:175], v12, s[32:35], s57 offen offset:1024 sc1
buffer_load_dwordx4 v[176:179], v13, s[32:35], s57 offen offset:1024 sc1
s_add_u32 s57, s57, 2048
s_and_b32 s57, s57, 0x7fff
buffer_load_dwordx4 v[180:183], v12, s[32:35], s57 offen sc1
buffer_load_dwordx4 v[184:187], v13, s[32:35], s57 offen sc1
buffer_load_dwordx4 v[188:191], v12, s[32:35], s57 offen offset:1024 sc1
buffer_load_dwordx4 v[192:195], v13, s[32:35], s57 offen offset:1024 sc1
s_add_u32 s57, s57, 2048
s_and_b32 s57, s57, 0x7fff
s_waitcnt vmcnt(10) lgkmcnt(0)
v_mfma_f32_16x16x32_bf16 v[20:23], v[212:215], v[148:151], v[20:23]
ds_read_b64_tr_b16 v[228:229], v14 offset:4096
ds_read_b64_tr_b16 v[230:231], v14 offset:4608
v_mfma_f32_16x16x32_bf16 v[36:39], v[212:215], v[152:155], v[36:39]
ds_read_b64_tr_b16 v[232:233], v15 offset:4096
v_mfma_f32_16x16x32_bf16 v[24:27], v[216:219], v[148:151], v[24:27]
ds_read_b64_tr_b16 v[234:235], v15 offset:4608
ds_read_b64_tr_b16 v[236:237], v16 offset:4096
v_mfma_f32_16x16x32_bf16 v[40:43], v[216:219], v[152:155], v[40:43]
ds_read_b64_tr_b16 v[238:239], v16 offset:4608
v_mfma_f32_16x16x32_bf16 v[28:31], v[220:223], v[148:151], v[28:31]
ds_read_b64_tr_b16 v[240:241], v17 offset:4096
ds_read_b64_tr_b16 v[242:243], v17 offset:4608
v_mfma_f32_16x16x32_bf16 v[44:47], v[220:223], v[152:155], v[44:47]
buffer_load_dwordx4 v[196:199], v12, s[32:35], s57 offen sc1
v_mfma_f32_16x16x32_bf16 v[32:35], v[224:227], v[148:151], v[32:35]
buffer_load_dwordx4 v[200:203], v13, s[32:35], s57 offen sc1
buffer_load_dwordx4 v[204:207], v12, s[32:35], s57 offen offset:1024 sc1
v_mfma_f32_16x16x32_bf16 v[48:51], v[224:227], v[152:155], v[48:51]
buffer_load_dwordx4 v[208:211], v13, s[32:35], s57 offen offset:1024 sc1
s_add_u32 s57, s57, 2048
s_and_b32 s57, s57, 0x7fff
s_waitcnt vmcnt(12) lgkmcnt(0)
v_mfma_f32_16x16x32_bf16 v[20:23], v[228:231], v[156:159], v[20:23]
ds_read_b64_tr_b16 v[212:213], v14 offset:8192
v_mfma_f32_16x16x32_bf16 v[36:39], v[228:231], v[160:163], v[36:39]
ds_read_b64_tr_b16 v[214:215], v14 offset:8704
v_mfma_f32_16x16x32_bf16 v[24:27], v[232:235], v[156:159], v[24:27]
ds_read_b64_tr_b16 v[216:217], v15 offset:8192
v_mfma_f32_16x16x32_bf16 v[40:43], v[232:235], v[160:163], v[40:43]
ds_read_b64_tr_b16 v[218:219], v15 offset:8704
v_mfma_f32_16x16x32_bf16 v[28:31], v[236:239], v[156:159], v[28:31]
ds_read_b64_tr_b16 v[220:221], v16 offset:8192
v_mfma_f32_16x16x32_bf16 v[44:47], v[236:239], v[160:163], v[44:47]
ds_read_b64_tr_b16 v[222:223], v16 offset:8704
v_mfma_f32_16x16x32_bf16 v[32:35], v[240:243], v[156:159], v[32:35]
ds_read_b64_tr_b16 v[224:225], v17 offset:8192
v_mfma_f32_16x16x32_bf16 v[48:51], v[240:243], v[160:163], v[48:51]
ds_read_b64_tr_b16 v[226:227], v17 offset:8704
s_waitcnt vmcnt(10) lgkmcnt(0)
v_mfma_f32_16x16x32_bf16 v[20:23], v[212:215], v[164:167], v[20:23]
ds_read_b64_tr_b16 v[228:229], v14 offset:12288
ds_read_b64_tr_b16 v[230:231], v14 offset:12800
v_mfma_f32_16x16x32_bf16 v[36:39], v[212:215], v[168:171], v[36:39]
ds_read_b64_tr_b16 v[232:233], v15 offset:12288
v_mfma_f32_16x16x32_bf16 v[24:27], v[216:219], v[164:167], v[24:27]
ds_read_b64_tr_b16 v[234:235], v15 offset:12800
ds_read_b64_tr_b16 v[236:237], v16 offset:12288
v_mfma_f32_16x16x32_bf16 v[40:43], v[216:219], v[168:171], v[40:43]
ds_read_b64_tr_b16 v[238:239], v16 offset:12800
v_mfma_f32_16x16x32_bf16 v[28:31], v[220:223], v[164:167], v[28:31]
ds_read_b64_tr_b16 v[240:241], v17 offset:12288
ds_read_b64_tr_b16 v[242:243], v17 offset:12800
v_mfma_f32_16x16x32_bf16 v[44:47], v[220:223], v[168:171], v[44:47]
buffer_load_dwordx4 v[148:151], v12, s[32:35], s57 offen sc1
v_mfma_f32_16x16x32_bf16 v[32:35], v[224:227], v[164:167], v[32:35]
buffer_load_dwordx4 v[152:155], v13, s[32:35], s57 offen sc1
buffer_load_dwordx4 v[156:159], v12, s[32:35], s57 offen offset:1024 sc1
v_mfma_f32_16x16x32_bf16 v[48:51], v[224:227], v[168:171], v[48:51]
buffer_load_dwordx4 v[160:163], v13, s[32:35], s57 offen offset:1024 sc1
s_add_u32 s57, s57, 2048
s_and_b32 s57, s57, 0x7fff
s_waitcnt vmcnt(12) lgkmcnt(0)
v_mfma_f32_16x16x32_bf16 v[20:23], v[228:231], v[172:175], v[20:23]
ds_read_b64_tr_b16 v[212:213], v14 offset:16384
v_mfma_f32_16x16x32_bf16 v[36:39], v[228:231], v[176:179], v[36:39]
ds_read_b64_tr_b16 v[214:215], v14 offset:16896
v_mfma_f32_16x16x32_bf16 v[24:27], v[232:235], v[172:175], v[24:27]
ds_read_b64_tr_b16 v[216:217], v15 offset:16384
v_mfma_f32_16x16x32_bf16 v[40:43], v[232:235], v[176:179], v[40:43]
ds_read_b64_tr_b16 v[218:219], v15 offset:16896
v_mfma_f32_16x16x32_bf16 v[28:31], v[236:239], v[172:175], v[28:31]
ds_read_b64_tr_b16 v[220:221], v16 offset:16384
v_mfma_f32_16x16x32_bf16 v[44:47], v[236:239], v[176:179], v[44:47]
ds_read_b64_tr_b16 v[222:223], v16 offset:16896
v_mfma_f32_16x16x32_bf16 v[32:35], v[240:243], v[172:175], v[32:35]
ds_read_b64_tr_b16 v[224:225], v17 offset:16384
v_mfma_f32_16x16x32_bf16 v[48:51], v[240:243], v[176:179], v[48:51]
ds_read_b64_tr_b16 v[226:227], v17 offset:16896
s_waitcnt vmcnt(10) lgkmcnt(0)
v_mfma_f32_16x16x32_bf16 v[20:23], v[212:215], v[180:183], v[20:23]
ds_read_b64_tr_b16 v[228:229], v14 offset:20480
ds_read_b64_tr_b16 v[230:231], v14 offset:20992
v_mfma_f32_16x16x32_bf16 v[36:39], v[212:215], v[184:187], v[36:39]
ds_read_b64_tr_b16 v[232:233], v15 offset:20480
v_mfma_f32_16x16x32_bf16 v[24:27], v[216:219], v[180:183], v[24:27]
ds_read_b64_tr_b16 v[234:235], v15 offset:20992
ds_read_b64_tr_b16 v[236:237], v16 offset:20480
v_mfma_f32_16x16x32_bf16 v[40:43], v[216:219], v[184:187], v[40:43]
ds_read_b64_tr_b16 v[238:239], v16 offset:20992
v_mfma_f32_16x16x32_bf16 v[28:31], v[220:223], v[180:183], v[28:31]
ds_read_b64_tr_b16 v[240:241], v17 offset:20480
ds_read_b64_tr_b16 v[242:243], v17 offset:20992
v_mfma_f32_16x16x32_bf16 v[44:47], v[220:223], v[184:187], v[44:47]
buffer_load_dwordx4 v[164:167], v12, s[32:35], s57 offen sc1
v_mfma_f32_16x16x32_bf16 v[32:35], v[224:227], v[180:183], v[32:35]
buffer_load_dwordx4 v[168:171], v13, s[32:35], s57 offen sc1
buffer_load_dwordx4 v[172:175], v12, s[32:35], s57 offen offset:1024 sc1
v_mfma_f32_16x16x32_bf16 v[48:51], v[224:227], v[184:187], v[48:51]
buffer_load_dwordx4 v[176:179], v13, s[32:35], s57 offen offset:1024 sc1
s_add_u32 s57, s57, 2048
s_and_b32 s57, s57, 0x7fff
s_waitcnt vmcnt(12) lgkmcnt(0)
v_mfma_f32_16x16x32_bf16 v[20:23], v[228:231], v[188:191], v[20:23]
ds_read_b64_tr_b16 v[212:213], v14 offset:24576
v_mfma_f32_16x16x32_bf16 v[36:39], v[228:231], v[192:195], v[36:39]
ds_read_b64_tr_b16 v[214:215], v14 offset:25088
v_mfma_f32_16x16x32_bf16 v[24:27], v[232:235], v[188:191], v[24:27]
ds_read_b64_tr_b16 v[216:217], v15 offset:24576
v_mfma_f32_16x16x32_bf16 v[40:43], v[232:235], v[192:195], v[40:43]
ds_read_b64_tr_b16 v[218:219], v15 offset:25088
v_mfma_f32_16x16x32_bf16 v[28:31], v[236:239], v[188:191], v[28:31]
ds_read_b64_tr_b16 v[220:221], v16 offset:24576
v_mfma_f32_16x16x32_bf16 v[44:47], v[236:239], v[192:195], v[44:47]
ds_read_b64_tr_b16 v[222:223], v16 offset:25088
v_mfma_f32_16x16x32_bf16 v[32:35], v[240:243], v[188:191], v[32:35]
ds_read_b64_tr_b16 v[224:225], v17 offset:24576
v_mfma_f32_16x16x32_bf16 v[48:51], v[240:243], v[192:195], v[48:51]
ds_read_b64_tr_b16 v[226:227], v17 offset:25088
s_waitcnt vmcnt(10) lgkmcnt(0)
v_mfma_f32_16x16x32_bf16 v[20:23], v[212:215], v[196:199], v[20:23]
ds_read_b64_tr_b16 v[228:229], v14 offset:28672
ds_read_b64_tr_b16 v[230:231], v14 offset:29184
v_mfma_f32_16x16x32_bf16 v[36:39], v[212:215], v[200:203], v[36:39]
ds_read_b64_tr_b16 v[232:233], v15 offset:28672
v_mfma_f32_16x16x32_bf16 v[24:27], v[216:219], v[196:199], v[24:27]
ds_read_b64_tr_b16 v[234:235], v15 offset:29184
ds_read_b64_tr_b16 v[236:237], v16 offset:28672
v_mfma_f32_16x16x32_bf16 v[40:43], v[216:219], v[200:203], v[40:43]
ds_read_b64_tr_b16 v[238:239], v16 offset:29184
v_mfma_f32_16x16x32_bf16 v[28:31], v[220:223], v[196:199], v[28:31]
ds_read_b64_tr_b16 v[240:241], v17 offset:28672
ds_read_b64_tr_b16 v[242:243], v17 offset:29184
v_mfma_f32_16x16x32_bf16 v[44:47], v[220:223], v[200:203], v[44:47]
buffer_load_dwordx4 v[180:183], v12, s[32:35], s57 offen sc1
v_mfma_f32_16x16x32_bf16 v[32:35], v[224:227], v[196:199], v[32:35]
buffer_load_dwordx4 v[184:187], v13, s[32:35], s57 offen sc1
buffer_load_dwordx4 v[188:191], v12, s[32:35], s57 offen offset:1024 sc1
v_mfma_f32_16x16x32_bf16 v[48:51], v[224:227], v[200:203], v[48:51]
buffer_load_dwordx4 v[192:195], v13, s[32:35], s57 offen offset:1024 sc1
s_add_u32 s57, s57, 2048
s_and_b32 s57, s57, 0x7fff
s_waitcnt vmcnt(12) lgkmcnt(0)
v_mfma_f32_16x16x32_bf16 v[20:23], v[228:231], v[204:207], v[20:23]
ds_read_b64_tr_b16 v[212:213], v14 offset:32768
v_mfma_f32_16x16x32_bf16 v[36:39], v[228:231], v[208:211], v[36:39]
ds_read_b64_tr_b16 v[214:215], v14 offset:33280
v_mfma_f32_16x16x32_bf16 v[24:27], v[232:235], v[204:207], v[24:27]
ds_read_b64_tr_b16 v[216:217], v15 offset:32768
v_mfma_f32_16x16x32_bf16 v[40:43], v[232:235], v[208:211], v[40:43]
ds_read_b64_tr_b16 v[218:219], v15 offset:33280
v_mfma_f32_16x16x32_bf16 v[28:31], v[236:239], v[204:207], v[28:31]
ds_read_b64_tr_b16 v[220:221], v16 offset:32768
v_mfma_f32_16x16x32_bf16 v[44:47], v[236:239], v[208:211], v[44:47]
ds_read_b64_tr_b16 v[222:223], v16 offset:33280
v_mfma_f32_16x16x32_bf16 v[32:35], v[240:243], v[204:207], v[32:35]
ds_read_b64_tr_b16 v[224:225], v17 offset:32768
v_mfma_f32_16x16x32_bf16 v[48:51], v[240:243], v[208:211], v[48:51]
ds_read_b64_tr_b16 v[226:227], v17 offset:33280
s_waitcnt vmcnt(10) lgkmcnt(0)
v_mfma_f32_16x16x32_bf16 v[20:23], v[212:215], v[148:151], v[20:23]
ds_read_b64_tr_b16 v[228:229], v14 offset:36864
ds_read_b64_tr_b16 v[230:231], v14 offset:37376
v_mfma_f32_16x16x32_bf16 v[36:39], v[212:215], v[152:155], v[36:39]
ds_read_b64_tr_b16 v[232:233], v15 offset:36864
v_mfma_f32_16x16x32_bf16 v[24:27], v[216:219], v[148:151], v[24:27]
ds_read_b64_tr_b16 v[234:235], v15 offset:37376
ds_read_b64_tr_b16 v[236:237], v16 offset:36864
v_mfma_f32_16x16x32_bf16 v[40:43], v[216:219], v[152:155], v[40:43]
ds_read_b64_tr_b16 v[238:239], v16 offset:37376
v_mfma_f32_16x16x32_bf16 v[28:31], v[220:223], v[148:151], v[28:31]
ds_read_b64_tr_b16 v[240:241], v17 offset:36864
ds_read_b64_tr_b16 v[242:243], v17 offset:37376
v_mfma_f32_16x16x32_bf16 v[44:47], v[220:223], v[152:155], v[44:47]
buffer_load_dwordx4 v[196:199], v12, s[32:35], s57 offen sc1
v_mfma_f32_16x16x32_bf16 v[32:35], v[224:227], v[148:151], v[32:35]
buffer_load_dwordx4 v[200:203], v13, s[32:35], s57 offen sc1
buffer_load_dwordx4 v[204:207], v12, s[32:35], s57 offen offset:1024 sc1
v_mfma_f32_16x16x32_bf16 v[48:51], v[224:227], v[152:155], v[48:51]
buffer_load_dwordx4 v[208:211], v13, s[32:35], s57 offen offset:1024 sc1
s_add_u32 s57, s57, 2048
s_and_b32 s57, s57, 0x7fff
s_waitcnt vmcnt(12) lgkmcnt(0)
v_mfma_f32_16x16x32_bf16 v[20:23], v[228:231], v[156:159], v[20:23]
ds_read_b64_tr_b16 v[212:213], v14 offset:40960
v_mfma_f32_16x16x32_bf16 v[36:39], v[228:231], v[160:163], v[36:39]
ds_read_b64_tr_b16 v[214:215], v14 offset:41472
v_mfma_f32_16x16x32_bf16 v[24:27], v[232:235], v[156:159], v[24:27]
ds_read_b64_tr_b16 v[216:217], v15 offset:40960
v_mfma_f32_16x16x32_bf16 v[40:43], v[232:235], v[160:163], v[40:43]
ds_read_b64_tr_b16 v[218:219], v15 offset:41472
v_mfma_f32_16x16x32_bf16 v[28:31], v[236:239], v[156:159], v[28:31]
ds_read_b64_tr_b16 v[220:221], v16 offset:40960
v_mfma_f32_16x16x32_bf16 v[44:47], v[236:239], v[160:163], v[44:47]
ds_read_b64_tr_b16 v[222:223], v16 offset:41472
v_mfma_f32_16x16x32_bf16 v[32:35], v[240:243], v[156:159], v[32:35]
ds_read_b64_tr_b16 v[224:225], v17 offset:40960
v_mfma_f32_16x16x32_bf16 v[48:51], v[240:243], v[160:163], v[48:51]
ds_read_b64_tr_b16 v[226:227], v17 offset:41472
s_waitcnt vmcnt(10) lgkmcnt(0)
v_mfma_f32_16x16x32_bf16 v[20:23], v[212:215], v[164:167], v[20:23]
ds_read_b64_tr_b16 v[228:229], v14 offset:45056
ds_read_b64_tr_b16 v[230:231], v14 offset:45568
v_mfma_f32_16x16x32_bf16 v[36:39], v[212:215], v[168:171], v[36:39]
ds_read_b64_tr_b16 v[232:233], v15 offset:45056
v_mfma_f32_16x16x32_bf16 v[24:27], v[216:219], v[164:167], v[24:27]
ds_read_b64_tr_b16 v[234:235], v15 offset:45568
ds_read_b64_tr_b16 v[236:237], v16 offset:45056
v_mfma_f32_16x16x32_bf16 v[40:43], v[216:219], v[168:171], v[40:43]
ds_read_b64_tr_b16 v[238:239], v16 offset:45568
v_mfma_f32_16x16x32_bf16 v[28:31], v[220:223], v[164:167], v[28:31]
ds_read_b64_tr_b16 v[240:241], v17 offset:45056
ds_read_b64_tr_b16 v[242:243], v17 offset:45568
v_mfma_f32_16x16x32_bf16 v[44:47], v[220:223], v[168:171], v[44:47]
buffer_load_dwordx4 v[148:151], v12, s[32:35], s57 offen sc1
v_mfma_f32_16x16x32_bf16 v[32:35], v[224:227], v[164:167], v[32:35]
buffer_load_dwordx4 v[152:155], v13, s[32:35], s57 offen sc1
buffer_load_dwordx4 v[156:159], v12, s[32:35], s57 offen offset:1024 sc1
v_mfma_f32_16x16x32_bf16 v[48:51], v[224:227], v[168:171], v[48:51]
buffer_load_dwordx4 v[160:163], v13, s[32:35], s57 offen offset:1024 sc1
s_add_u32 s57, s57, 2048
s_and_b32 s57, s57, 0x7fff
s_waitcnt vmcnt(12) lgkmcnt(0)
v_mfma_f32_16x16x32_bf16 v[20:23], v[228:231], v[172:175], v[20:23]
ds_read_b64_tr_b16 v[212:213], v14 offset:49152
v_mfma_f32_16x16x32_bf16 v[36:39], v[228:231], v[176:179], v[36:39]
ds_read_b64_tr_b16 v[214:215], v14 offset:49664
v_mfma_f32_16x16x32_bf16 v[24:27], v[232:235], v[172:175], v[24:27]
ds_read_b64_tr_b16 v[216:217], v15 offset:49152
v_mfma_f32_16x16x32_bf16 v[40:43], v[232:235], v[176:179], v[40:43]
ds_read_b64_tr_b16 v[218:219], v15 offset:49664
v_mfma_f32_16x16x32_bf16 v[28:31], v[236:239], v[172:175], v[28:31]
ds_read_b64_tr_b16 v[220:221], v16 offset:49152
v_mfma_f32_16x16x32_bf16 v[44:47], v[236:239], v[176:179], v[44:47]
ds_read_b64_tr_b16 v[222:223], v16 offset:49664
v_mfma_f32_16x16x32_bf16 v[32:35], v[240:243], v[172:175], v[32:35]
ds_read_b64_tr_b16 v[224:225], v17 offset:49152
v_mfma_f32_16x16x32_bf16 v[48:51], v[240:243], v[176:179], v[48:51]
ds_read_b64_tr_b16 v[226:227], v17 offset:49664
s_waitcnt vmcnt(10) lgkmcnt(0)
v_mfma_f32_16x16x32_bf16 v[20:23], v[212:215], v[180:183], v[20:23]
ds_read_b64_tr_b16 v[228:229], v14 offset:53248
ds_read_b64_tr_b16 v[230:231], v14 offset:53760
v_mfma_f32_16x16x32_bf16 v[36:39], v[212:215], v[184:187], v[36:39]
ds_read_b64_tr_b16 v[232:233], v15 offset:53248
v_mfma_f32_16x16x32_bf16 v[24:27], v[216:219], v[180:183], v[24:27]
ds_read_b64_tr_b16 v[234:235], v15 offset:53760
ds_read_b64_tr_b16 v[236:237], v16 offset:53248
v_mfma_f32_16x16x32_bf16 v[40:43], v[216:219], v[184:187], v[40:43]
ds_read_b64_tr_b16 v[238:239], v16 offset:53760
v_mfma_f32_16x16x32_bf16 v[28:31], v[220:223], v[180:183], v[28:31]
ds_read_b64_tr_b16 v[240:241], v17 offset:53248
ds_read_b64_tr_b16 v[242:243], v17 offset:53760
v_mfma_f32_16x16x32_bf16 v[44:47], v[220:223], v[184:187], v[44:47]
buffer_load_dwordx4 v[164:167], v12, s[32:35], s57 offen sc1
v_mfma_f32_16x16x32_bf16 v[32:35], v[224:227], v[180:183], v[32:35]
buffer_load_dwordx4 v[168:171], v13, s[32:35], s57 offen sc1
buffer_load_dwordx4 v[172:175], v12, s[32:35], s57 offen offset:1024 sc1
v_mfma_f32_16x16x32_bf16 v[48:51], v[224:227], v[184:187], v[48:51]
buffer_load_dwordx4 v[176:179], v13, s[32:35], s57 offen offset:1024 sc1
s_add_u32 s57, s57, 2048
s_and_b32 s57, s57, 0x7fff
s_waitcnt vmcnt(12) lgkmcnt(0)
v_mfma_f32_16x16x32_bf16 v[20:23], v[228:231], v[188:191], v[20:23]
ds_read_b64_tr_b16 v[212:213], v14 offset:57344
v_mfma_f32_16x16x32_bf16 v[36:39], v[228:231], v[192:195], v[36:39]
ds_read_b64_tr_b16 v[214:215], v14 offset:57856
v_mfma_f32_16x16x32_bf16 v[24:27], v[232:235], v[188:191], v[24:27]
ds_read_b64_tr_b16 v[216:217], v15 offset:57344
v_mfma_f32_16x16x32_bf16 v[40:43], v[232:235], v[192:195], v[40:43]
ds_read_b64_tr_b16 v[218:219], v15 offset:57856
v_mfma_f32_16x16x32_bf16 v[28:31], v[236:239], v[188:191], v[28:31]
ds_read_b64_tr_b16 v[220:221], v16 offset:57344
v_mfma_f32_16x16x32_bf16 v[44:47], v[236:239], v[192:195], v[44:47]
ds_read_b64_tr_b16 v[222:223], v16 offset:57856
v_mfma_f32_16x16x32_bf16 v[32:35], v[240:243], v[188:191], v[32:35]
ds_read_b64_tr_b16 v[224:225], v17 offset:57344
v_mfma_f32_16x16x32_bf16 v[48:51], v[240:243], v[192:195], v[48:51]
ds_read_b64_tr_b16 v[226:227], v17 offset:57856
s_waitcnt vmcnt(10) lgkmcnt(0)
v_mfma_f32_16x16x32_bf16 v[20:23], v[212:215], v[196:199], v[20:23]
ds_read_b64_tr_b16 v[228:229], v14 offset:61440
ds_read_b64_tr_b16 v[230:231], v14 offset:61952
v_mfma_f32_16x16x32_bf16 v[36:39], v[212:215], v[200:203], v[36:39]
ds_read_b64_tr_b16 v[232:233], v15 offset:61440
v_mfma_f32_16x16x32_bf16 v[24:27], v[216:219], v[196:199], v[24:27]
ds_read_b64_tr_b16 v[234:235], v15 offset:61952
ds_read_b64_tr_b16 v[236:237], v16 offset:61440
v_mfma_f32_16x16x32_bf16 v[40:43], v[216:219], v[200:203], v[40:43]
ds_read_b64_tr_b16 v[238:239], v16 offset:61952
v_mfma_f32_16x16x32_bf16 v[28:31], v[220:223], v[196:199], v[28:31]
ds_read_b64_tr_b16 v[240:241], v17 offset:61440
ds_read_b64_tr_b16 v[242:243], v17 offset:61952
v_mfma_f32_16x16x32_bf16 v[44:47], v[220:223], v[200:203], v[44:47]
buffer_load_dwordx4 v[180:183], v12, s[32:35], s57 offen sc1
v_mfma_f32_16x16x32_bf16 v[32:35], v[224:227], v[196:199], v[32:35]
buffer_load_dwordx4 v[184:187], v13, s[32:35], s57 offen sc1
buffer_load_dwordx4 v[188:191], v12, s[32:35], s57 offen offset:1024 sc1
v_mfma_f32_16x16x32_bf16 v[48:51], v[224:227], v[200:203], v[48:51]
buffer_load_dwordx4 v[192:195], v13, s[32:35], s57 offen offset:1024 sc1
s_add_u32 s57, s57, 2048
s_and_b32 s57, s57, 0x7fff
s_waitcnt vmcnt(12) lgkmcnt(0)
v_add_u32 v14, 0x10000, v14
v_add_u32 v15, 0x10000, v15
v_add_u32 v16, 0x10000, v16
v_add_u32 v17, 0x10000, v17
v_mfma_f32_16x16x32_bf16 v[20:23], v[228:231], v[204:207], v[20:23]
ds_read_b64_tr_b16 v[212:213], v14 offset:0
v_mfma_f32_16x16x32_bf16 v[36:39], v[228:231], v[208:211], v[36:39]
ds_read_b64_tr_b16 v[214:215], v14 offset:512
v_mfma_f32_16x16x32_bf16 v[24:27], v[232:235], v[204:207], v[24:27]
ds_read_b64_tr_b16 v[216:217], v15 offset:0
v_mfma_f32_16x16x32_bf16 v[40:43], v[232:235], v[208:211], v[40:43]
ds_read_b64_tr_b16 v[218:219], v15 offset:512
v_mfma_f32_16x16x32_bf16 v[28:31], v[236:239], v[204:207], v[28:31]
ds_read_b64_tr_b16 v[220:221], v16 offset:0
v_mfma_f32_16x16x32_bf16 v[44:47], v[236:239], v[208:211], v[44:47]
ds_read_b64_tr_b16 v[222:223], v16 offset:512
v_mfma_f32_16x16x32_bf16 v[32:35], v[240:243], v[204:207], v[32:35]
ds_read_b64_tr_b16 v[224:225], v17 offset:0
v_mfma_f32_16x16x32_bf16 v[48:51], v[240:243], v[208:211], v[48:51]
ds_read_b64_tr_b16 v[226:227], v17 offset:512
s_waitcnt vmcnt(10) lgkmcnt(0)
v_mfma_f32_16x16x32_bf16 v[20:23], v[212:215], v[148:151], v[20:23]
ds_read_b64_tr_b16 v[228:229], v14 offset:4096
ds_read_b64_tr_b16 v[230:231], v14 offset:4608
v_mfma_f32_16x16x32_bf16 v[36:39], v[212:215], v[152:155], v[36:39]
ds_read_b64_tr_b16 v[232:233], v15 offset:4096
v_mfma_f32_16x16x32_bf16 v[24:27], v[216:219], v[148:151], v[24:27]
ds_read_b64_tr_b16 v[234:235], v15 offset:4608
ds_read_b64_tr_b16 v[236:237], v16 offset:4096
v_mfma_f32_16x16x32_bf16 v[40:43], v[216:219], v[152:155], v[40:43]
ds_read_b64_tr_b16 v[238:239], v16 offset:4608
v_mfma_f32_16x16x32_bf16 v[28:31], v[220:223], v[148:151], v[28:31]
ds_read_b64_tr_b16 v[240:241], v17 offset:4096
ds_read_b64_tr_b16 v[242:243], v17 offset:4608
v_mfma_f32_16x16x32_bf16 v[44:47], v[220:223], v[152:155], v[44:47]
buffer_load_dwordx4 v[196:199], v12, s[32:35], s57 offen sc1
v_mfma_f32_16x16x32_bf16 v[32:35], v[224:227], v[148:151], v[32:35]
buffer_load_dwordx4 v[200:203], v13, s[32:35], s57 offen sc1
buffer_load_dwordx4 v[204:207], v12, s[32:35], s57 offen offset:1024 sc1
v_mfma_f32_16x16x32_bf16 v[48:51], v[224:227], v[152:155], v[48:51]
buffer_load_dwordx4 v[208:211], v13, s[32:35], s57 offen offset:1024 sc1
s_add_u32 s57, s57, 2048
s_and_b32 s57, s57, 0x7fff
s_waitcnt vmcnt(12) lgkmcnt(0)
v_mfma_f32_16x16x32_bf16 v[20:23], v[228:231], v[156:159], v[20:23]
ds_read_b64_tr_b16 v[212:213], v14 offset:8192
v_mfma_f32_16x16x32_bf16 v[36:39], v[228:231], v[160:163], v[36:39]
ds_read_b64_tr_b16 v[214:215], v14 offset:8704
v_mfma_f32_16x16x32_bf16 v[24:27], v[232:235], v[156:159], v[24:27]
ds_read_b64_tr_b16 v[216:217], v15 offset:8192
v_mfma_f32_16x16x32_bf16 v[40:43], v[232:235], v[160:163], v[40:43]
ds_read_b64_tr_b16 v[218:219], v15 offset:8704
v_mfma_f32_16x16x32_bf16 v[28:31], v[236:239], v[156:159], v[28:31]
ds_read_b64_tr_b16 v[220:221], v16 offset:8192
v_mfma_f32_16x16x32_bf16 v[44:47], v[236:239], v[160:163], v[44:47]
ds_read_b64_tr_b16 v[222:223], v16 offset:8704
v_mfma_f32_16x16x32_bf16 v[32:35], v[240:243], v[156:159], v[32:35]
ds_read_b64_tr_b16 v[224:225], v17 offset:8192
v_mfma_f32_16x16x32_bf16 v[48:51], v[240:243], v[160:163], v[48:51]
ds_read_b64_tr_b16 v[226:227], v17 offset:8704
s_waitcnt vmcnt(10) lgkmcnt(0)
v_mfma_f32_16x16x32_bf16 v[20:23], v[212:215], v[164:167], v[20:23]
ds_read_b64_tr_b16 v[228:229], v14 offset:12288
ds_read_b64_tr_b16 v[230:231], v14 offset:12800
v_mfma_f32_16x16x32_bf16 v[36:39], v[212:215], v[168:171], v[36:39]
ds_read_b64_tr_b16 v[232:233], v15 offset:12288
v_mfma_f32_16x16x32_bf16 v[24:27], v[216:219], v[164:167], v[24:27]
ds_read_b64_tr_b16 v[234:235], v15 offset:12800
ds_read_b64_tr_b16 v[236:237], v16 offset:12288
v_mfma_f32_16x16x32_bf16 v[40:43], v[216:219], v[168:171], v[40:43]
ds_read_b64_tr_b16 v[238:239], v16 offset:12800
v_mfma_f32_16x16x32_bf16 v[28:31], v[220:223], v[164:167], v[28:31]
ds_read_b64_tr_b16 v[240:241], v17 offset:12288
ds_read_b64_tr_b16 v[242:243], v17 offset:12800
v_mfma_f32_16x16x32_bf16 v[44:47], v[220:223], v[168:171], v[44:47]
buffer_load_dwordx4 v[148:151], v12, s[32:35], s57 offen sc1
v_mfma_f32_16x16x32_bf16 v[32:35], v[224:227], v[164:167], v[32:35]
buffer_load_dwordx4 v[152:155], v13, s[32:35], s57 offen sc1
buffer_load_dwordx4 v[156:159], v12, s[32:35], s57 offen offset:1024 sc1
v_mfma_f32_16x16x32_bf16 v[48:51], v[224:227], v[168:171], v[48:51]
buffer_load_dwordx4 v[160:163], v13, s[32:35], s57 offen offset:1024 sc1
s_add_u32 s57, s57, 2048
s_and_b32 s57, s57, 0x7fff
s_waitcnt vmcnt(12) lgkmcnt(0)
v_mfma_f32_16x16x32_bf16 v[20:23], v[228:231], v[172:175], v[20:23]
ds_read_b64_tr_b16 v[212:213], v14 offset:16384
v_mfma_f32_16x16x32_bf16 v[36:39], v[228:231], v[176:179], v[36:39]
ds_read_b64_tr_b16 v[214:215], v14 offset:16896
v_mfma_f32_16x16x32_bf16 v[24:27], v[232:235], v[172:175], v[24:27]
ds_read_b64_tr_b16 v[216:217], v15 offset:16384
v_mfma_f32_16x16x32_bf16 v[40:43], v[232:235], v[176:179], v[40:43]
ds_read_b64_tr_b16 v[218:219], v15 offset:16896
v_mfma_f32_16x16x32_bf16 v[28:31], v[236:239], v[172:175], v[28:31]
ds_read_b64_tr_b16 v[220:221], v16 offset:16384
v_mfma_f32_16x16x32_bf16 v[44:47], v[236:239], v[176:179], v[44:47]
ds_read_b64_tr_b16 v[222:223], v16 offset:16896
v_mfma_f32_16x16x32_bf16 v[32:35], v[240:243], v[172:175], v[32:35]
ds_read_b64_tr_b16 v[224:225], v17 offset:16384
v_mfma_f32_16x16x32_bf16 v[48:51], v[240:243], v[176:179], v[48:51]
ds_read_b64_tr_b16 v[226:227], v17 offset:16896
s_waitcnt vmcnt(10) lgkmcnt(0)
v_mfma_f32_16x16x32_bf16 v[20:23], v[212:215], v[180:183], v[20:23]
ds_read_b64_tr_b16 v[228:229], v14 offset:20480
ds_read_b64_tr_b16 v[230:231], v14 offset:20992
v_mfma_f32_16x16x32_bf16 v[36:39], v[212:215], v[184:187], v[36:39]
ds_read_b64_tr_b16 v[232:233], v15 offset:20480
v_mfma_f32_16x16x32_bf16 v[24:27], v[216:219], v[180:183], v[24:27]
ds_read_b64_tr_b16 v[234:235], v15 offset:20992
ds_read_b64_tr_b16 v[236:237], v16 offset:20480
v_mfma_f32_16x16x32_bf16 v[40:43], v[216:219], v[184:187], v[40:43]
ds_read_b64_tr_b16 v[238:239], v16 offset:20992
v_mfma_f32_16x16x32_bf16 v[28:31], v[220:223], v[180:183], v[28:31]
ds_read_b64_tr_b16 v[240:241], v17 offset:20480
ds_read_b64_tr_b16 v[242:243], v17 offset:20992
v_mfma_f32_16x16x32_bf16 v[44:47], v[220:223], v[184:187], v[44:47]
buffer_load_dwordx4 v[164:167], v12, s[32:35], s57 offen sc1
v_mfma_f32_16x16x32_bf16 v[32:35], v[224:227], v[180:183], v[32:35]
buffer_load_dwordx4 v[168:171], v13, s[32:35], s57 offen sc1
buffer_load_dwordx4 v[172:175], v12, s[32:35], s57 offen offset:1024 sc1
v_mfma_f32_16x16x32_bf16 v[48:51], v[224:227], v[184:187], v[48:51]
buffer_load_dwordx4 v[176:179], v13, s[32:35], s57 offen offset:1024 sc1
s_add_u32 s57, s57, 2048
s_and_b32 s57, s57, 0x7fff
s_waitcnt vmcnt(12) lgkmcnt(0)
v_mfma_f32_16x16x32_bf16 v[20:23], v[228:231], v[188:191], v[20:23]
ds_read_b64_tr_b16 v[212:213], v14 offset:24576
v_mfma_f32_16x16x32_bf16 v[36:39], v[228:231], v[192:195], v[36:39]
ds_read_b64_tr_b16 v[214:215], v14 offset:25088
v_mfma_f32_16x16x32_bf16 v[24:27], v[232:235], v[188:191], v[24:27]
ds_read_b64_tr_b16 v[216:217], v15 offset:24576
v_mfma_f32_16x16x32_bf16 v[40:43], v[232:235], v[192:195], v[40:43]
ds_read_b64_tr_b16 v[218:219], v15 offset:25088
v_mfma_f32_16x16x32_bf16 v[28:31], v[236:239], v[188:191], v[28:31]
ds_read_b64_tr_b16 v[220:221], v16 offset:24576
v_mfma_f32_16x16x32_bf16 v[44:47], v[236:239], v[192:195], v[44:47]
ds_read_b64_tr_b16 v[222:223], v16 offset:25088
v_mfma_f32_16x16x32_bf16 v[32:35], v[240:243], v[188:191], v[32:35]
ds_read_b64_tr_b16 v[224:225], v17 offset:24576
v_mfma_f32_16x16x32_bf16 v[48:51], v[240:243], v[192:195], v[48:51]
ds_read_b64_tr_b16 v[226:227], v17 offset:25088
s_waitcnt vmcnt(10) lgkmcnt(0)
v_mfma_f32_16x16x32_bf16 v[20:23], v[212:215], v[196:199], v[20:23]
ds_read_b64_tr_b16 v[228:229], v14 offset:28672
ds_read_b64_tr_b16 v[230:231], v14 offset:29184
v_mfma_f32_16x16x32_bf16 v[36:39], v[212:215], v[200:203], v[36:39]
ds_read_b64_tr_b16 v[232:233], v15 offset:28672
v_mfma_f32_16x16x32_bf16 v[24:27], v[216:219], v[196:199], v[24:27]
ds_read_b64_tr_b16 v[234:235], v15 offset:29184
ds_read_b64_tr_b16 v[236:237], v16 offset:28672
v_mfma_f32_16x16x32_bf16 v[40:43], v[216:219], v[200:203], v[40:43]
ds_read_b64_tr_b16 v[238:239], v16 offset:29184
v_mfma_f32_16x16x32_bf16 v[28:31], v[220:223], v[196:199], v[28:31]
ds_read_b64_tr_b16 v[240:241], v17 offset:28672
ds_read_b64_tr_b16 v[242:243], v17 offset:29184
v_mfma_f32_16x16x32_bf16 v[44:47], v[220:223], v[200:203], v[44:47]
buffer_load_dwordx4 v[180:183], v12, s[32:35], s57 offen sc1
v_mfma_f32_16x16x32_bf16 v[32:35], v[224:227], v[196:199], v[32:35]
buffer_load_dwordx4 v[184:187], v13, s[32:35], s57 offen sc1
buffer_load_dwordx4 v[188:191], v12, s[32:35], s57 offen offset:1024 sc1
v_mfma_f32_16x16x32_bf16 v[48:51], v[224:227], v[200:203], v[48:51]
buffer_load_dwordx4 v[192:195], v13, s[32:35], s57 offen offset:1024 sc1
s_add_u32 s57, s57, 2048
s_and_b32 s57, s57, 0x7fff
s_waitcnt vmcnt(12) lgkmcnt(0)
v_mfma_f32_16x16x32_bf16 v[20:23], v[228:231], v[204:207], v[20:23]
ds_read_b64_tr_b16 v[212:213], v14 offset:32768
v_mfma_f32_16x16x32_bf16 v[36:39], v[228:231], v[208:211], v[36:39]
ds_read_b64_tr_b16 v[214:215], v14 offset:33280
v_mfma_f32_16x16x32_bf16 v[24:27], v[232:235], v[204:207], v[24:27]
ds_read_b64_tr_b16 v[216:217], v15 offset:32768
v_mfma_f32_16x16x32_bf16 v[40:43], v[232:235], v[208:211], v[40:43]
ds_read_b64_tr_b16 v[218:219], v15 offset:33280
v_mfma_f32_16x16x32_bf16 v[28:31], v[236:239], v[204:207], v[28:31]
ds_read_b64_tr_b16 v[220:221], v16 offset:32768
v_mfma_f32_16x16x32_bf16 v[44:47], v[236:239], v[208:211], v[44:47]
ds_read_b64_tr_b16 v[222:223], v16 offset:33280
v_mfma_f32_16x16x32_bf16 v[32:35], v[240:243], v[204:207], v[32:35]
ds_read_b64_tr_b16 v[224:225], v17 offset:32768
v_mfma_f32_16x16x32_bf16 v[48:51], v[240:243], v[208:211], v[48:51]
ds_read_b64_tr_b16 v[226:227], v17 offset:33280
s_waitcnt vmcnt(10) lgkmcnt(0)
v_mfma_f32_16x16x32_bf16 v[20:23], v[212:215], v[148:151], v[20:23]
ds_read_b64_tr_b16 v[228:229], v14 offset:36864
ds_read_b64_tr_b16 v[230:231], v14 offset:37376
v_mfma_f32_16x16x32_bf16 v[36:39], v[212:215], v[152:155], v[36:39]
ds_read_b64_tr_b16 v[232:233], v15 offset:36864
v_mfma_f32_16x16x32_bf16 v[24:27], v[216:219], v[148:151], v[24:27]
ds_read_b64_tr_b16 v[234:235], v15 offset:37376
ds_read_b64_tr_b16 v[236:237], v16 offset:36864
v_mfma_f32_16x16x32_bf16 v[40:43], v[216:219], v[152:155], v[40:43]
ds_read_b64_tr_b16 v[238:239], v16 offset:37376
v_mfma_f32_16x16x32_bf16 v[28:31], v[220:223], v[148:151], v[28:31]
ds_read_b64_tr_b16 v[240:241], v17 offset:36864
ds_read_b64_tr_b16 v[242:243], v17 offset:37376
v_mfma_f32_16x16x32_bf16 v[44:47], v[220:223], v[152:155], v[44:47]
buffer_load_dwordx4 v[196:199], v12, s[32:35], s57 offen sc1
v_mfma_f32_16x16x32_bf16 v[32:35], v[224:227], v[148:151], v[32:35]
buffer_load_dwordx4 v[200:203], v13, s[32:35], s57 offen sc1
buffer_load_dwordx4 v[204:207], v12, s[32:35], s57 offen offset:1024 sc1
v_mfma_f32_16x16x32_bf16 v[48:51], v[224:227], v[152:155], v[48:51]
buffer_load_dwordx4 v[208:211], v13, s[32:35], s57 offen offset:1024 sc1
s_add_u32 s57, s57, 2048
s_and_b32 s57, s57, 0x7fff
s_waitcnt vmcnt(12) lgkmcnt(0)
v_mfma_f32_16x16x32_bf16 v[20:23], v[228:231], v[156:159], v[20:23]
ds_read_b64_tr_b16 v[212:213], v14 offset:40960
v_mfma_f32_16x16x32_bf16 v[36:39], v[228:231], v[160:163], v[36:39]
ds_read_b64_tr_b16 v[214:215], v14 offset:41472
v_mfma_f32_16x16x32_bf16 v[24:27], v[232:235], v[156:159], v[24:27]
ds_read_b64_tr_b16 v[216:217], v15 offset:40960
v_mfma_f32_16x16x32_bf16 v[40:43], v[232:235], v[160:163], v[40:43]
ds_read_b64_tr_b16 v[218:219], v15 offset:41472
v_mfma_f32_16x16x32_bf16 v[28:31], v[236:239], v[156:159], v[28:31]
ds_read_b64_tr_b16 v[220:221], v16 offset:40960
v_mfma_f32_16x16x32_bf16 v[44:47], v[236:239], v[160:163], v[44:47]
ds_read_b64_tr_b16 v[222:223], v16 offset:41472
v_mfma_f32_16x16x32_bf16 v[32:35], v[240:243], v[156:159], v[32:35]
ds_read_b64_tr_b16 v[224:225], v17 offset:40960
v_mfma_f32_16x16x32_bf16 v[48:51], v[240:243], v[160:163], v[48:51]
ds_read_b64_tr_b16 v[226:227], v17 offset:41472
s_waitcnt vmcnt(10) lgkmcnt(0)
v_mfma_f32_16x16x32_bf16 v[20:23], v[212:215], v[164:167], v[20:23]
ds_read_b64_tr_b16 v[228:229], v14 offset:45056
v_mfma_f32_16x16x32_bf16 v[36:39], v[212:215], v[168:171], v[36:39]
ds_read_b64_tr_b16 v[230:231], v14 offset:45568
v_mfma_f32_16x16x32_bf16 v[24:27], v[216:219], v[164:167], v[24:27]
ds_read_b64_tr_b16 v[232:233], v15 offset:45056
v_mfma_f32_16x16x32_bf16 v[40:43], v[216:219], v[168:171], v[40:43]
ds_read_b64_tr_b16 v[234:235], v15 offset:45568
v_mfma_f32_16x16x32_bf16 v[28:31], v[220:223], v[164:167], v[28:31]
ds_read_b64_tr_b16 v[236:237], v16 offset:45056
v_mfma_f32_16x16x32_bf16 v[44:47], v[220:223], v[168:171], v[44:47]
ds_read_b64_tr_b16 v[238:239], v16 offset:45568
v_mfma_f32_16x16x32_bf16 v[32:35], v[224:227], v[164:167], v[32:35]
ds_read_b64_tr_b16 v[240:241], v17 offset:45056
v_mfma_f32_16x16x32_bf16 v[48:51], v[224:227], v[168:171], v[48:51]
ds_read_b64_tr_b16 v[242:243], v17 offset:45568
s_waitcnt vmcnt(8) lgkmcnt(0)
v_mfma_f32_16x16x32_bf16 v[20:23], v[228:231], v[172:175], v[20:23]
ds_read_b64_tr_b16 v[212:213], v14 offset:49152
v_mfma_f32_16x16x32_bf16 v[36:39], v[228:231], v[176:179], v[36:39]
ds_read_b64_tr_b16 v[214:215], v14 offset:49664
v_mfma_f32_16x16x32_bf16 v[24:27], v[232:235], v[172:175], v[24:27]
ds_read_b64_tr_b16 v[216:217], v15 offset:49152
v_mfma_f32_16x16x32_bf16 v[40:43], v[232:235], v[176:179], v[40:43]
ds_read_b64_tr_b16 v[218:219], v15 offset:49664
v_mfma_f32_16x16x32_bf16 v[28:31], v[236:239], v[172:175], v[28:31]
ds_read_b64_tr_b16 v[220:221], v16 offset:49152
v_mfma_f32_16x16x32_bf16 v[44:47], v[236:239], v[176:179], v[44:47]
ds_read_b64_tr_b16 v[222:223], v16 offset:49664
v_mfma_f32_16x16x32_bf16 v[32:35], v[240:243], v[172:175], v[32:35]
ds_read_b64_tr_b16 v[224:225], v17 offset:49152
v_mfma_f32_16x16x32_bf16 v[48:51], v[240:243], v[176:179], v[48:51]
ds_read_b64_tr_b16 v[226:227], v17 offset:49664
s_waitcnt vmcnt(6) lgkmcnt(0)
v_mfma_f32_16x16x32_bf16 v[20:23], v[212:215], v[180:183], v[20:23]
ds_read_b64_tr_b16 v[228:229], v14 offset:53248
v_mfma_f32_16x16x32_bf16 v[36:39], v[212:215], v[184:187], v[36:39]
ds_read_b64_tr_b16 v[230:231], v14 offset:53760
v_mfma_f32_16x16x32_bf16 v[24:27], v[216:219], v[180:183], v[24:27]
ds_read_b64_tr_b16 v[232:233], v15 offset:53248
v_mfma_f32_16x16x32_bf16 v[40:43], v[216:219], v[184:187], v[40:43]
ds_read_b64_tr_b16 v[234:235], v15 offset:53760
v_mfma_f32_16x16x32_bf16 v[28:31], v[220:223], v[180:183], v[28:31]
ds_read_b64_tr_b16 v[236:237], v16 offset:53248
v_mfma_f32_16x16x32_bf16 v[44:47], v[220:223], v[184:187], v[44:47]
ds_read_b64_tr_b16 v[238:239], v16 offset:53760
v_mfma_f32_16x16x32_bf16 v[32:35], v[224:227], v[180:183], v[32:35]
ds_read_b64_tr_b16 v[240:241], v17 offset:53248
v_mfma_f32_16x16x32_bf16 v[48:51], v[224:227], v[184:187], v[48:51]
ds_read_b64_tr_b16 v[242:243], v17 offset:53760
s_waitcnt vmcnt(4) lgkmcnt(0)
v_mfma_f32_16x16x32_bf16 v[20:23], v[228:231], v[188:191], v[20:23]
ds_read_b64_tr_b16 v[212:213], v14 offset:57344
v_mfma_f32_16x16x32_bf16 v[36:39], v[228:231], v[192:195], v[36:39]
ds_read_b64_tr_b16 v[214:215], v14 offset:57856
v_mfma_f32_16x16x32_bf16 v[24:27], v[232:235], v[188:191], v[24:27]
ds_read_b64_tr_b16 v[216:217], v15 offset:57344
v_mfma_f32_16x16x32_bf16 v[40:43], v[232:235], v[192:195], v[40:43]
ds_read_b64_tr_b16 v[218:219], v15 offset:57856
v_mfma_f32_16x16x32_bf16 v[28:31], v[236:239], v[188:191], v[28:31]
ds_read_b64_tr_b16 v[220:221], v16 offset:57344
v_mfma_f32_16x16x32_bf16 v[44:47], v[236:239], v[192:195], v[44:47]
ds_read_b64_tr_b16 v[222:223], v16 offset:57856
v_mfma_f32_16x16x32_bf16 v[32:35], v[240:243], v[188:191], v[32:35]
ds_read_b64_tr_b16 v[224:225], v17 offset:57344
v_mfma_f32_16x16x32_bf16 v[48:51], v[240:243], v[192:195], v[48:51]
ds_read_b64_tr_b16 v[226:227], v17 offset:57856
s_waitcnt vmcnt(2) lgkmcnt(0)
v_mfma_f32_16x16x32_bf16 v[20:23], v[212:215], v[196:199], v[20:23]
ds_read_b64_tr_b16 v[228:229], v14 offset:61440
v_mfma_f32_16x16x32_bf16 v[36:39], v[212:215], v[200:203], v[36:39]
ds_read_b64_tr_b16 v[230:231], v14 offset:61952
v_mfma_f32_16x16x32_bf16 v[24:27], v[216:219], v[196:199], v[24:27]
ds_read_b64_tr_b16 v[232:233], v15 offset:61440
v_mfma_f32_16x16x32_bf16 v[40:43], v[216:219], v[200:203], v[40:43]
ds_read_b64_tr_b16 v[234:235], v15 offset:61952
v_mfma_f32_16x16x32_bf16 v[28:31], v[220:223], v[196:199], v[28:31]
ds_read_b64_tr_b16 v[236:237], v16 offset:61440
v_mfma_f32_16x16x32_bf16 v[44:47], v[220:223], v[200:203], v[44:47]
ds_read_b64_tr_b16 v[238:239], v16 offset:61952
v_mfma_f32_16x16x32_bf16 v[32:35], v[224:227], v[196:199], v[32:35]
ds_read_b64_tr_b16 v[240:241], v17 offset:61440
v_mfma_f32_16x16x32_bf16 v[48:51], v[224:227], v[200:203], v[48:51]
ds_read_b64_tr_b16 v[242:243], v17 offset:61952
s_waitcnt vmcnt(0) lgkmcnt(0)
s_barrier
v_mfma_f32_16x16x32_bf16 v[20:23], v[228:231], v[204:207], v[20:23]
v_mfma_f32_16x16x32_bf16 v[36:39], v[228:231], v[208:211], v[36:39]
v_mfma_f32_16x16x32_bf16 v[24:27], v[232:235], v[204:207], v[24:27]
v_mfma_f32_16x16x32_bf16 v[40:43], v[232:235], v[208:211], v[40:43]
v_mfma_f32_16x16x32_bf16 v[28:31], v[236:239], v[204:207], v[28:31]
v_mfma_f32_16x16x32_bf16 v[44:47], v[236:239], v[208:211], v[44:47]
v_mfma_f32_16x16x32_bf16 v[32:35], v[240:243], v[204:207], v[32:35]
v_mfma_f32_16x16x32_bf16 v[48:51], v[240:243], v[208:211], v[48:51]
s_lshl_b32 s48, s56, 15
s_lshl_b32 s49, s42, 11
s_add_u32 s48, s48, s49
s_add_u32 s49, s48, 32768
s_lshl_b32 s50, s41, 2
s_add_u32 s50, s50, s40
s_lshl_b32 s50, s50, 4
s_add_u32 s50, s50, s42
s_lshl_b32 s50, s50, 8
s_add_u32 s50, s50, 13238272
s_lshl_b32 s52, s41, 2
s_add_u32 s52, s52, s40
s_lshl_b32 s52, s52, 7
s_add_u32 s52, s52, 14163968
v_lshlrev_b32 v19, 2, v0
v_mov_b32 v10, 0x3f803f80
v_mov_b32 v6, 0
v_mov_b32 v7, 0
v_mov_b32 v8, 0
v_mov_b32 v9, 0
s_nop 2
s_cmp_eq_u32 s46, 0
s_cbranch_scc1 slow_22
v_lshlrev_b32 v4, 16, v88
v_and_b32 v5, 0xffff0000, v88
v_pk_add_f32 v[20:21], v[20:21], v[4:5]
v_lshlrev_b32 v4, 16, v89
v_and_b32 v5, 0xffff0000, v89
v_pk_add_f32 v[22:23], v[22:23], v[4:5]
v_lshlrev_b32 v4, 16, v90
v_and_b32 v5, 0xffff0000, v90
v_pk_add_f32 v[24:25], v[24:25], v[4:5]
v_lshlrev_b32 v4, 16, v91
v_and_b32 v5, 0xffff0000, v91
v_pk_add_f32 v[26:27], v[26:27], v[4:5]
v_cvt_pk_bf16_f32 v20, v20, v21
v_cvt_pk_bf16_f32 v21, v22, v23
v_cvt_pk_bf16_f32 v22, v24, v25
v_cvt_pk_bf16_f32 v23, v26, v27
buffer_store_dwordx4 v[20:23], v18, s[32:35], s48 offen offset:0
v_lshlrev_b32 v4, 16, v92
v_and_b32 v5, 0xffff0000, v92
v_pk_add_f32 v[28:29], v[28:29], v[4:5]
v_lshlrev_b32 v4, 16, v93
v_and_b32 v5, 0xffff0000, v93
v_pk_add_f32 v[30:31], v[30:31], v[4:5]
v_lshlrev_b32 v4, 16, v94
v_and_b32 v5, 0xffff0000, v94
v_pk_add_f32 v[32:33], v[32:33], v[4:5]
v_lshlrev_b32 v4, 16, v95
v_and_b32 v5, 0xffff0000, v95
v_pk_add_f32 v[34:35], v[34:35], v[4:5]
v_cvt_pk_bf16_f32 v28, v28, v29
v_cvt_pk_bf16_f32 v29, v30, v31
v_cvt_pk_bf16_f32 v30, v32, v33
v_cvt_pk_bf16_f32 v31, v34, v35
buffer_store_dwordx4 v[28:31], v18, s[32:35], s48 offen offset:1024
v_lshlrev_b32 v4, 16, v96
v_and_b32 v5, 0xffff0000, v96
v_pk_add_f32 v[36:37], v[36:37], v[4:5]
v_lshlrev_b32 v4, 16, v97
v_and_b32 v5, 0xffff0000, v97
v_pk_add_f32 v[38:39], v[38:39], v[4:5]
v_lshlrev_b32 v4, 16, v98
v_and_b32 v5, 0xffff0000, v98
v_pk_add_f32 v[40:41], v[40:41], v[4:5]
v_lshlrev_b32 v4, 16, v99
v_and_b32 v5, 0xffff0000, v99
v_pk_add_f32 v[42:43], v[42:43], v[4:5]
v_cvt_pk_bf16_f32 v36, v36, v37
v_cvt_pk_bf16_f32 v37, v38, v39
v_cvt_pk_bf16_f32 v38, v40, v41
v_cvt_pk_bf16_f32 v39, v42, v43
buffer_store_dwordx4 v[36:39], v18, s[32:35], s49 offen offset:0
v_lshlrev_b32 v4, 16, v100
v_and_b32 v5, 0xffff0000, v100
v_pk_add_f32 v[44:45], v[44:45], v[4:5]
v_lshlrev_b32 v4, 16, v101
v_and_b32 v5, 0xffff0000, v101
v_pk_add_f32 v[46:47], v[46:47], v[4:5]
v_lshlrev_b32 v4, 16, v102
v_and_b32 v5, 0xffff0000, v102
v_pk_add_f32 v[48:49], v[48:49], v[4:5]
v_lshlrev_b32 v4, 16, v103
v_and_b32 v5, 0xffff0000, v103
v_pk_add_f32 v[50:51], v[50:51], v[4:5]
v_cvt_pk_bf16_f32 v44, v44, v45
v_cvt_pk_bf16_f32 v45, v46, v47
v_cvt_pk_bf16_f32 v46, v48, v49
v_cvt_pk_bf16_f32 v47, v50, v51
buffer_store_dwordx4 v[44:47], v18, s[32:35], s49 offen offset:1024
v_dot2c_f32_bf16 v6, v20, v10
v_dot2c_f32_bf16 v8, v20, v20
v_dot2c_f32_bf16 v7, v36, v10
v_dot2c_f32_bf16 v9, v36, v36
v_dot2c_f32_bf16 v6, v21, v10
v_dot2c_f32_bf16 v8, v21, v21
v_dot2c_f32_bf16 v7, v37, v10
v_dot2c_f32_bf16 v9, v37, v37
v_dot2c_f32_bf16 v6, v22, v10
v_dot2c_f32_bf16 v8, v22, v22
v_dot2c_f32_bf16 v7, v38, v10
v_dot2c_f32_bf16 v9, v38, v38
v_dot2c_f32_bf16 v6, v23, v10
v_dot2c_f32_bf16 v8, v23, v23
v_dot2c_f32_bf16 v7, v39, v10
v_dot2c_f32_bf16 v9, v39, v39
v_dot2c_f32_bf16 v6, v28, v10
v_dot2c_f32_bf16 v8, v28, v28
v_dot2c_f32_bf16 v7, v44, v10
v_dot2c_f32_bf16 v9, v44, v44
v_dot2c_f32_bf16 v6, v29, v10
v_dot2c_f32_bf16 v8, v29, v29
v_dot2c_f32_bf16 v7, v45, v10
v_dot2c_f32_bf16 v9, v45, v45
v_dot2c_f32_bf16 v6, v30, v10
v_dot2c_f32_bf16 v8, v30, v30
v_dot2c_f32_bf16 v7, v46, v10
v_dot2c_f32_bf16 v9, v46, v46
v_dot2c_f32_bf16 v6, v31, v10
v_dot2c_f32_bf16 v8, v31, v31
v_dot2c_f32_bf16 v7, v47, v10
v_dot2c_f32_bf16 v9, v47, v47
s_nop 1
s_nop 1
v_permlane32_swap_b32 v6, v7
v_permlane32_swap_b32 v8, v9
s_nop 0
v_add_f32 v6, v6, v7
v_add_f32 v8, v8, v9
s_nop 1
v_permlane16_swap_b32 v6, v8
s_nop 0
v_add_f32 v6, v6, v8
buffer_store_dword v6, v19, s[32:35], s50 offen
s_waitcnt vmcnt(0)
s_lshl_b32 s62, s42, 2
v_mov_b32 v4, s62
v_mov_b32 v5, 3
s_mov_b64 exec, 1
buffer_store_dword v5, v4, s[32:35], s52 offen
s_mov_b64 exec, -1
back_23:
v_mov_b32 v10, v18
v_add_u32 v11, 1024, v18
s_lshl_b32 s48, s43, 1
v_lshrrev_b32 v4, 2, v2
v_and_b32 v5, 3, v0
v_lshl_add_u32 v6, v3, 3, v4
v_lshlrev_b32 v6, 7, v6
v_lshl_add_u32 v6, v5, 3, v6
v_lshrrev_b32 v7, 1, v4
v_and_b32 v8, 1, v3
v_lshl_add_u32 v7, v8, 1, v7
v_xor_b32 v7, s48, v7
v_lshl_add_u32 v12, v7, 5, v6
v_add_u32 v12, 18432, v12
v_xor_b32 v13, 32, v12
v_mov_b32 v14, v10
v_mov_b32 v15, v11
v_mov_b32 v16, v12
v_mov_b32 v17, v13
v_mov_b32 v148, 0
v_mov_b32 v149, 0
v_mov_b32 v150, 0
v_mov_b32 v151, 0
v_mov_b32 v152, 0
v_mov_b32 v153, 0
v_mov_b32 v154, 0
v_mov_b32 v155, 0
v_mov_b32 v156, 0
v_mov_b32 v157, 0
v_mov_b32 v158, 0
v_mov_b32 v159, 0
v_mov_b32 v160, 0
v_mov_b32 v161, 0
v_mov_b32 v162, 0
v_mov_b32 v163, 0
v_mov_b32 v164, 0
v_mov_b32 v165, 0
v_mov_b32 v166, 0
v_mov_b32 v167, 0
v_mov_b32 v168, 0
v_mov_b32 v169, 0
v_mov_b32 v170, 0
v_mov_b32 v171, 0
v_mov_b32 v172, 0
v_mov_b32 v173, 0
v_mov_b32 v174, 0
v_mov_b32 v175, 0
v_mov_b32 v176, 0
v_mov_b32 v177, 0
v_mov_b32 v178, 0
v_mov_b32 v179, 0
v_mov_b32 v180, 0
v_mov_b32 v181, 0
v_mov_b32 v182, 0
v_mov_b32 v183, 0
v_mov_b32 v184, 0
v_mov_b32 v185, 0
v_mov_b32 v186, 0
v_mov_b32 v187, 0
v_mov_b32 v188, 0
v_mov_b32 v189, 0
v_mov_b32 v190, 0
v_mov_b32 v191, 0
v_mov_b32 v192, 0
v_mov_b32 v193, 0
v_mov_b32 v194, 0
v_mov_b32 v195, 0
v_mov_b32 v196, 0
v_mov_b32 v197, 0
v_mov_b32 v198, 0
v_mov_b32 v199, 0
v_mov_b32 v200, 0
v_mov_b32 v201, 0
v_mov_b32 v202, 0
v_mov_b32 v203, 0
v_mov_b32 v204, 0
v_mov_b32 v205, 0
v_mov_b32 v206, 0
v_mov_b32 v207, 0
v_mov_b32 v208, 0
v_mov_b32 v209, 0
v_mov_b32 v210, 0
v_mov_b32 v211, 0
v_mov_b32 v212, 0
v_mov_b32 v213, 0
v_mov_b32 v214, 0
v_mov_b32 v215, 0
v_mov_b32 v216, 0
v_mov_b32 v217, 0
v_mov_b32 v218, 0
v_mov_b32 v219, 0
v_mov_b32 v220, 0
v_mov_b32 v221, 0
v_mov_b32 v222, 0
v_mov_b32 v223, 0
v_mov_b32 v224, 0
v_mov_b32 v225, 0
v_mov_b32 v226, 0
v_mov_b32 v227, 0
v_mov_b32 v228, 0
v_mov_b32 v229, 0
v_mov_b32 v230, 0
v_mov_b32 v231, 0
v_mov_b32 v232, 0
v_mov_b32 v233, 0
v_mov_b32 v234, 0
v_mov_b32 v235, 0
v_mov_b32 v236, 0
v_mov_b32 v237, 0
v_mov_b32 v238, 0
v_mov_b32 v239, 0
v_mov_b32 v240, 0
v_mov_b32 v241, 0
v_mov_b32 v242, 0
v_mov_b32 v243, 0
s_mov_b32 s64, 0
s_mov_b32 s65, 0
s_barrier
s_lshl_b32 s48, s44, 13
v_add_u32 v10, s48, v10
v_add_u32 v11, s48, v11
v_add_u32 v14, s48, v14
v_add_u32 v15, s48, v15
ds_read_b128 v[60:63], v14 offset:2048
ds_read_b128 v[64:67], v14 offset:4096
ds_read_b128 v[68:71], v14 offset:6144
ds_read_b128 v[72:75], v14 offset:8192
ds_read_b64_tr_b16 v[80:81], v16 offset:0
ds_read_b64_tr_b16 v[82:83], v16 offset:512
ds_read_b64_tr_b16 v[84:85], v17 offset:0
ds_read_b64_tr_b16 v[86:87], v17 offset:512
ds_read_b64_tr_b16 v[88:89], v16 offset:8192
ds_read_b64_tr_b16 v[90:91], v16 offset:8704
ds_read_b64_tr_b16 v[92:93], v17 offset:8192
ds_read_b64_tr_b16 v[94:95], v17 offset:8704
ds_read_b64_tr_b16 v[96:97], v16 offset:16384
ds_read_b64_tr_b16 v[98:99], v16 offset:16896
ds_read_b64_tr_b16 v[100:101], v17 offset:16384
ds_read_b64_tr_b16 v[102:103], v17 offset:16896
c3_loop0:
s_add_u32 s65, s65, 43008
s_cmp_eq_u32 s65, 129024
s_cselect_b32 s65, 0, s65
s_waitcnt lgkmcnt(0)
v_mfma_f32_16x16x32_bf16 v[204:207], v[88:91], v[72:75], v[204:207]
ds_read_b128 v[104:107], v15 offset:2048
v_mfma_f32_16x16x32_bf16 v[196:199], v[88:91], v[68:71], v[196:199]
ds_read_b128 v[108:111], v15 offset:4096
v_mfma_f32_16x16x32_bf16 v[188:191], v[88:91], v[64:67], v[188:191]
ds_read_b128 v[112:115], v15 offset:6144
v_mfma_f32_16x16x32_bf16 v[180:183], v[88:91], v[60:63], v[180:183]
ds_read_b128 v[116:119], v15 offset:8192
v_mfma_f32_16x16x32_bf16 v[184:187], v[92:95], v[60:63], v[184:187]
ds_read_b64_tr_b16 v[124:125], v16 offset:4096
v_mfma_f32_16x16x32_bf16 v[192:195], v[92:95], v[64:67], v[192:195]
ds_read_b64_tr_b16 v[126:127], v16 offset:4608
v_mfma_f32_16x16x32_bf16 v[200:203], v[92:95], v[68:71], v[200:203]
ds_read_b64_tr_b16 v[128:129], v17 offset:4096
v_mfma_f32_16x16x32_bf16 v[208:211], v[92:95], v[72:75], v[208:211]
ds_read_b64_tr_b16 v[130:131], v17 offset:4608
v_mfma_f32_16x16x32_bf16 v[236:239], v[72:75], v[96:99], v[236:239]
ds_read_b64_tr_b16 v[132:133], v16 offset:12288
v_mfma_f32_16x16x32_bf16 v[228:231], v[68:71], v[96:99], v[228:231]
ds_read_b64_tr_b16 v[134:135], v16 offset:12800
v_mfma_f32_16x16x32_bf16 v[220:223], v[64:67], v[96:99], v[220:223]
ds_read_b64_tr_b16 v[136:137], v17 offset:12288
v_mfma_f32_16x16x32_bf16 v[212:215], v[60:63], v[96:99], v[212:215]
ds_read_b64_tr_b16 v[138:139], v17 offset:12800
v_mfma_f32_16x16x32_bf16 v[216:219], v[60:63], v[100:103], v[216:219]
ds_read_b64_tr_b16 v[140:141], v16 offset:20480
v_mfma_f32_16x16x32_bf16 v[224:227], v[64:67], v[100:103], v[224:227]
ds_read_b64_tr_b16 v[142:143], v16 offset:20992
v_mfma_f32_16x16x32_bf16 v[232:235], v[68:71], v[100:103], v[232:235]
ds_read_b64_tr_b16 v[144:145], v17 offset:20480
v_mfma_f32_16x16x32_bf16 v[240:243], v[72:75], v[100:103], v[240:243]
ds_read_b64_tr_b16 v[146:147], v17 offset:20992
v_mfma_f32_16x16x32_bf16 v[172:175], v[80:83], v[72:75], v[172:175]
v_mfma_f32_16x16x32_bf16 v[164:167], v[80:83], v[68:71], v[164:167]
v_mfma_f32_16x16x32_bf16 v[156:159], v[80:83], v[64:67], v[156:159]
v_mfma_f32_16x16x32_bf16 v[148:151], v[80:83], v[60:63], v[148:151]
v_mfma_f32_16x16x32_bf16 v[152:155], v[84:87], v[60:63], v[152:155]
v_mfma_f32_16x16x32_bf16 v[160:163], v[84:87], v[64:67], v[160:163]
v_mfma_f32_16x16x32_bf16 v[168:171], v[84:87], v[68:71], v[168:171]
v_mfma_f32_16x16x32_bf16 v[176:179], v[84:87], v[72:75], v[176:179]
s_waitcnt lgkmcnt(0)
s_barrier
v_mfma_f32_16x16x32_bf16 v[204:207], v[132:135], v[116:119], v[204:207]
v_add_u32 v14, s65, v10
v_mfma_f32_16x16x32_bf16 v[196:199], v[132:135], v[112:115], v[196:199]
v_add_u32 v16, s65, v12
v_add_u32 v17, s65, v13
v_mfma_f32_16x16x32_bf16 v[188:191], v[132:135], v[108:111], v[188:191]
ds_read_b128 v[60:63], v14 offset:2048
v_mfma_f32_16x16x32_bf16 v[180:183], v[132:135], v[104:107], v[180:183]
ds_read_b128 v[64:67], v14 offset:4096
v_mfma_f32_16x16x32_bf16 v[184:187], v[136:139], v[104:107], v[184:187]
ds_read_b128 v[68:71], v14 offset:6144
v_mfma_f32_16x16x32_bf16 v[192:195], v[136:139], v[108:111], v[192:195]
ds_read_b128 v[72:75], v14 offset:8192
v_mfma_f32_16x16x32_bf16 v[200:203], v[136:139], v[112:115], v[200:203]
ds_read_b64_tr_b16 v[80:81], v16 offset:0
v_mfma_f32_16x16x32_bf16 v[208:211], v[136:139], v[116:119], v[208:211]
ds_read_b64_tr_b16 v[82:83], v16 offset:512
v_mfma_f32_16x16x32_bf16 v[236:239], v[116:119], v[140:143], v[236:239]
ds_read_b64_tr_b16 v[84:85], v17 offset:0
v_mfma_f32_16x16x32_bf16 v[228:231], v[112:115], v[140:143], v[228:231]
ds_read_b64_tr_b16 v[86:87], v17 offset:512
v_mfma_f32_16x16x32_bf16 v[220:223], v[108:111], v[140:143], v[220:223]
ds_read_b64_tr_b16 v[88:89], v16 offset:8192
v_mfma_f32_16x16x32_bf16 v[212:215], v[104:107], v[140:143], v[212:215]
ds_read_b64_tr_b16 v[90:91], v16 offset:8704
v_mfma_f32_16x16x32_bf16 v[216:219], v[104:107], v[144:147], v[216:219]
ds_read_b64_tr_b16 v[92:93], v17 offset:8192
v_mfma_f32_16x16x32_bf16 v[224:227], v[108:111], v[144:147], v[224:227]
ds_read_b64_tr_b16 v[94:95], v17 offset:8704
v_mfma_f32_16x16x32_bf16 v[232:235], v[112:115], v[144:147], v[232:235]
ds_read_b64_tr_b16 v[96:97], v16 offset:16384
v_mfma_f32_16x16x32_bf16 v[240:243], v[116:119], v[144:147], v[240:243]
ds_read_b64_tr_b16 v[98:99], v16 offset:16896
v_mfma_f32_16x16x32_bf16 v[172:175], v[124:127], v[116:119], v[172:175]
ds_read_b64_tr_b16 v[100:101], v17 offset:16384
v_mfma_f32_16x16x32_bf16 v[164:167], v[124:127], v[112:115], v[164:167]
ds_read_b64_tr_b16 v[102:103], v17 offset:16896
v_mfma_f32_16x16x32_bf16 v[156:159], v[124:127], v[108:111], v[156:159]
v_add_u32 v15, s65, v11
v_mfma_f32_16x16x32_bf16 v[148:151], v[124:127], v[104:107], v[148:151]
s_add_u32 s64, s64, 1
v_mfma_f32_16x16x32_bf16 v[152:155], v[128:131], v[104:107], v[152:155]
s_cmp_lt_u32 s64, 16
v_mfma_f32_16x16x32_bf16 v[160:163], v[128:131], v[108:111], v[160:163]
v_mfma_f32_16x16x32_bf16 v[168:171], v[128:131], v[112:115], v[168:171]
v_mfma_f32_16x16x32_bf16 v[176:179], v[128:131], v[116:119], v[176:179]
s_cbranch_scc1 c3_loop0
c3_epi:
s_waitcnt lgkmcnt(0)
s_lshl_b32 s48, s43, 7
s_add_u32 s48, s48, 134144
v_lshl_add_u32 v6, v3, 4, s48
v_lshl_add_u32 v7, v2, 2, s48
s_lshl_b32 s49, s44, 6
v_add_u32 v8, s49, v2
v_lshlrev_b32 v8, 3, v8
v_add_u32 v8, 131072, v8
v_lshl_add_u32 v9, v3, 2, s49
v_lshlrev_b32 v9, 2, v9
v_add_u32 v9, 132224, v9
s_waitcnt lgkmcnt(0)
s_barrier
ds_read_b128 v[68:71], v6 offset:256
ds_read_b128 v[72:75], v6 offset:320
ds_read_b128 v[128:131], v6 offset:0
ds_read_b128 v[132:135], v6 offset:64
ds_read_b64 v[138:139], v8 offset:128
ds_read_b64 v[140:141], v8 offset:256
ds_read_b64 v[142:143], v8 offset:384
ds_read_b64 v[144:145], v8 offset:512
ds_read_b32 v76, v7 offset:512
ds_read_b32 v77, v7 offset:576
ds_read_b128 v[92:95], v9 offset:64
ds_read_b128 v[112:115], v9 offset:640
ds_read_b128 v[96:99], v9 offset:128
ds_read_b128 v[116:119], v9 offset:704
ds_read_b128 v[100:103], v9 offset:192
ds_read_b128 v[120:123], v9 offset:768
ds_read_b128 v[104:107], v9 offset:256
ds_read_b128 v[124:127], v9 offset:832
v_lshrrev_b32 v4, 2, v2
v_lshl_add_u32 v4, v3, 2, v4
v_lshlrev_b32 v4, 6, v4
v_and_b32 v5, 3, v0
v_lshl_add_u32 v4, v5, 3, v4
s_lshl_b32 s48, s43, 11
s_add_u32 s48, s48, 135168
v_add_u32 v4, s48, v4
ds_read_b64_tr_b16 v[40:41], v4 offset:0
ds_read_b64_tr_b16 v[42:43], v4 offset:1024
ds_read_b64_tr_b16 v[44:45], v4 offset:32
ds_read_b64_tr_b16 v[46:47], v4 offset:1056
s_waitcnt lgkmcnt(14)
v_pk_fma_f32 v[180:181], v[68:69], v[138:139], v[180:181] op_sel:[0,1,0] op_sel_hi:[1,1,1]
v_pk_fma_f32 v[182:183], v[70:71], v[138:139], v[182:183] op_sel:[0,1,0] op_sel_hi:[1,1,1]
v_pk_fma_f32 v[184:185], v[72:73], v[138:139], v[184:185] op_sel:[0,1,0] op_sel_hi:[1,1,1]
v_pk_fma_f32 v[186:187], v[74:75], v[138:139], v[186:187] op_sel:[0,1,0] op_sel_hi:[1,1,1]
v_pk_mul_f32 v[180:181], v[180:181], v[138:139] op_sel:[0,0] op_sel_hi:[1,0]
v_pk_mul_f32 v[182:183], v[182:183], v[138:139] op_sel:[0,0] op_sel_hi:[1,0]
v_pk_mul_f32 v[184:185], v[184:185], v[138:139] op_sel:[0,0] op_sel_hi:[1,0]
v_pk_mul_f32 v[186:187], v[186:187], v[138:139] op_sel:[0,0] op_sel_hi:[1,0]
v_cvt_pk_bf16_f32 v180, v180, v181
v_cvt_pk_bf16_f32 v181, v182, v183
v_cvt_pk_bf16_f32 v182, v184, v185
v_cvt_pk_bf16_f32 v183, v186, v187
v_pk_fma_f32 v[188:189], v[68:69], v[140:141], v[188:189] op_sel:[0,1,0] op_sel_hi:[1,1,1]
v_pk_fma_f32 v[190:191], v[70:71], v[140:141], v[190:191] op_sel:[0,1,0] op_sel_hi:[1,1,1]
v_pk_fma_f32 v[192:193], v[72:73], v[140:141], v[192:193] op_sel:[0,1,0] op_sel_hi:[1,1,1]
v_pk_fma_f32 v[194:195], v[74:75], v[140:141], v[194:195] op_sel:[0,1,0] op_sel_hi:[1,1,1]
v_pk_mul_f32 v[188:189], v[188:189], v[140:141] op_sel:[0,0] op_sel_hi:[1,0]
v_pk_mul_f32 v[190:191], v[190:191], v[140:141] op_sel:[0,0] op_sel_hi:[1,0]
v_pk_mul_f32 v[192:193], v[192:193], v[140:141] op_sel:[0,0] op_sel_hi:[1,0]
v_pk_mul_f32 v[194:195], v[194:195], v[140:141] op_sel:[0,0] op_sel_hi:[1,0]
v_cvt_pk_bf16_f32 v188, v188, v189
v_cvt_pk_bf16_f32 v189, v190, v191
v_cvt_pk_bf16_f32 v190, v192, v193
v_cvt_pk_bf16_f32 v191, v194, v195
v_pk_fma_f32 v[196:197], v[68:69], v[142:143], v[196:197] op_sel:[0,1,0] op_sel_hi:[1,1,1]
v_pk_fma_f32 v[198:199], v[70:71], v[142:143], v[198:199] op_sel:[0,1,0] op_sel_hi:[1,1,1]
v_pk_fma_f32 v[200:201], v[72:73], v[142:143], v[200:201] op_sel:[0,1,0] op_sel_hi:[1,1,1]
v_pk_fma_f32 v[202:203], v[74:75], v[142:143], v[202:203] op_sel:[0,1,0] op_sel_hi:[1,1,1]
v_pk_mul_f32 v[196:197], v[196:197], v[142:143] op_sel:[0,0] op_sel_hi:[1,0]
v_pk_mul_f32 v[198:199], v[198:199], v[142:143] op_sel:[0,0] op_sel_hi:[1,0]
v_pk_mul_f32 v[200:201], v[200:201], v[142:143] op_sel:[0,0] op_sel_hi:[1,0]
v_pk_mul_f32 v[202:203], v[202:203], v[142:143] op_sel:[0,0] op_sel_hi:[1,0]
v_cvt_pk_bf16_f32 v196, v196, v197
v_cvt_pk_bf16_f32 v197, v198, v199
v_cvt_pk_bf16_f32 v198, v200, v201
v_cvt_pk_bf16_f32 v199, v202, v203
v_pk_fma_f32 v[204:205], v[68:69], v[144:145], v[204:205] op_sel:[0,1,0] op_sel_hi:[1,1,1]
v_pk_fma_f32 v[206:207], v[70:71], v[144:145], v[206:207] op_sel:[0,1,0] op_sel_hi:[1,1,1]
v_pk_fma_f32 v[208:209], v[72:73], v[144:145], v[208:209] op_sel:[0,1,0] op_sel_hi:[1,1,1]
v_pk_fma_f32 v[210:211], v[74:75], v[144:145], v[210:211] op_sel:[0,1,0] op_sel_hi:[1,1,1]
v_pk_mul_f32 v[204:205], v[204:205], v[144:145] op_sel:[0,0] op_sel_hi:[1,0]
v_pk_mul_f32 v[206:207], v[206:207], v[144:145] op_sel:[0,0] op_sel_hi:[1,0]
v_pk_mul_f32 v[208:209], v[208:209], v[144:145] op_sel:[0,0] op_sel_hi:[1,0]
v_pk_mul_f32 v[210:211], v[210:211], v[144:145] op_sel:[0,0] op_sel_hi:[1,0]
v_cvt_pk_bf16_f32 v204, v204, v205
v_cvt_pk_bf16_f32 v205, v206, v207
v_cvt_pk_bf16_f32 v206, v208, v209
v_cvt_pk_bf16_f32 v207, v210, v211
s_waitcnt lgkmcnt(0)
v_pk_fma_f32 v[212:213], v[112:113], v[76:77], v[212:213] op_sel:[0,0,0] op_sel_hi:[1,0,1]
v_pk_fma_f32 v[214:215], v[114:115], v[76:77], v[214:215] op_sel:[0,0,0] op_sel_hi:[1,0,1]
v_pk_mul_f32 v[212:213], v[212:213], v[92:93]
v_pk_mul_f32 v[214:215], v[214:215], v[94:95]
v_cvt_pk_bf16_f32 v22, v212, v213
v_cvt_pk_bf16_f32 v23, v214, v215
v_pk_fma_f32 v[220:221], v[116:117], v[76:77], v[220:221] op_sel:[0,0,0] op_sel_hi:[1,0,1]
v_pk_fma_f32 v[222:223], v[118:119], v[76:77], v[222:223] op_sel:[0,0,0] op_sel_hi:[1,0,1]
v_pk_mul_f32 v[220:221], v[220:221], v[96:97]
v_pk_mul_f32 v[222:223], v[222:223], v[98:99]
v_cvt_pk_bf16_f32 v24, v220, v221
v_cvt_pk_bf16_f32 v25, v222, v223
v_pk_fma_f32 v[228:229], v[120:121], v[76:77], v[228:229] op_sel:[0,0,0] op_sel_hi:[1,0,1]
v_pk_fma_f32 v[230:231], v[122:123], v[76:77], v[230:231] op_sel:[0,0,0] op_sel_hi:[1,0,1]
v_pk_mul_f32 v[228:229], v[228:229], v[100:101]
v_pk_mul_f32 v[230:231], v[230:231], v[102:103]
v_cvt_pk_bf16_f32 v26, v228, v229
v_cvt_pk_bf16_f32 v27, v230, v231
v_pk_fma_f32 v[236:237], v[124:125], v[76:77], v[236:237] op_sel:[0,0,0] op_sel_hi:[1,0,1]
v_pk_fma_f32 v[238:239], v[126:127], v[76:77], v[238:239] op_sel:[0,0,0] op_sel_hi:[1,0,1]
v_pk_mul_f32 v[236:237], v[236:237], v[104:105]
v_pk_mul_f32 v[238:239], v[238:239], v[106:107]
v_cvt_pk_bf16_f32 v28, v236, v237
v_cvt_pk_bf16_f32 v29, v238, v239
v_pk_fma_f32 v[216:217], v[112:113], v[76:77], v[216:217] op_sel:[0,1,0] op_sel_hi:[1,1,1]
v_pk_fma_f32 v[218:219], v[114:115], v[76:77], v[218:219] op_sel:[0,1,0] op_sel_hi:[1,1,1]
v_pk_mul_f32 v[216:217], v[216:217], v[92:93]
v_pk_mul_f32 v[218:219], v[218:219], v[94:95]
v_cvt_pk_bf16_f32 v32, v216, v217
v_cvt_pk_bf16_f32 v33, v218, v219
v_pk_fma_f32 v[224:225], v[116:117], v[76:77], v[224:225] op_sel:[0,1,0] op_sel_hi:[1,1,1]
v_pk_fma_f32 v[226:227], v[118:119], v[76:77], v[226:227] op_sel:[0,1,0] op_sel_hi:[1,1,1]
v_pk_mul_f32 v[224:225], v[224:225], v[96:97]
v_pk_mul_f32 v[226:227], v[226:227], v[98:99]
v_cvt_pk_bf16_f32 v34, v224, v225
v_cvt_pk_bf16_f32 v35, v226, v227
v_pk_fma_f32 v[232:233], v[120:121], v[76:77], v[232:233] op_sel:[0,1,0] op_sel_hi:[1,1,1]
v_pk_fma_f32 v[234:235], v[122:123], v[76:77], v[234:235] op_sel:[0,1,0] op_sel_hi:[1,1,1]
v_pk_mul_f32 v[232:233], v[232:233], v[100:101]
v_pk_mul_f32 v[234:235], v[234:235], v[102:103]
v_cvt_pk_bf16_f32 v36, v232, v233
v_cvt_pk_bf16_f32 v37, v234, v235
v_pk_fma_f32 v[240:241], v[124:125], v[76:77], v[240:241] op_sel:[0,1,0] op_sel_hi:[1,1,1]
v_pk_fma_f32 v[242:243], v[126:127], v[76:77], v[242:243] op_sel:[0,1,0] op_sel_hi:[1,1,1]
v_pk_mul_f32 v[240:241], v[240:241], v[104:105]
v_pk_mul_f32 v[242:243], v[242:243], v[106:107]
v_cvt_pk_bf16_f32 v38, v240, v241
v_cvt_pk_bf16_f32 v39, v242, v243
s_mov_b32 s66, 0x3fb8aa3b
s_lshl_b32 s48, s40, 12
s_add_u32 s48, s48, 139264
v_add_u32 v5, s48, v18
ds_write_b128 v5, v[22:25] offset:0
ds_write_b128 v5, v[26:29] offset:1024
ds_write_b128 v5, v[32:35] offset:2048
ds_write_b128 v5, v[36:39] offset:3072
v_mfma_f32_16x16x32_bf16 v[60:63], v[40:43], v[180:183], 0
v_mfma_f32_16x16x32_bf16 v[64:67], v[44:47], v[180:183], 0
v_mfma_f32_16x16x32_bf16 v[68:71], v[40:43], v[188:191], 0
v_mfma_f32_16x16x32_bf16 v[72:75], v[44:47], v[188:191], 0
v_mfma_f32_16x16x32_bf16 v[76:79], v[40:43], v[196:199], 0
v_mfma_f32_16x16x32_bf16 v[80:83], v[44:47], v[196:199], 0
v_mfma_f32_16x16x32_bf16 v[84:87], v[40:43], v[204:207], 0
v_mfma_f32_16x16x32_bf16 v[88:91], v[44:47], v[204:207], 0
s_nop 4
v_max3_f32 v48, v60, v61, v62
v_min3_f32 v52, v60, v61, v62
v_max3_f32 v48, v48, v63, v64
v_min3_f32 v52, v52, v63, v64
v_max3_f32 v48, v48, v65, v66
v_min3_f32 v52, v52, v65, v66
v_max_f32 v48, v48, v67
v_min_f32 v52, v52, v67
v_max3_f32 v49, v68, v69, v70
v_min3_f32 v53, v68, v69, v70
v_max3_f32 v49, v49, v71, v72
v_min3_f32 v53, v53, v71, v72
v_max3_f32 v49, v49, v73, v74
v_min3_f32 v53, v53, v73, v74
v_max_f32 v49, v49, v75
v_min_f32 v53, v53, v75
v_max3_f32 v50, v76, v77, v78
v_min3_f32 v54, v76, v77, v78
v_max3_f32 v50, v50, v79, v80
v_min3_f32 v54, v54, v79, v80
v_max3_f32 v50, v50, v81, v82
v_min3_f32 v54, v54, v81, v82
v_max_f32 v50, v50, v83
v_min_f32 v54, v54, v83
v_max3_f32 v51, v84, v85, v86
v_min3_f32 v55, v84, v85, v86
v_max3_f32 v51, v51, v87, v88
v_min3_f32 v55, v55, v87, v88
v_max3_f32 v51, v51, v89, v90
v_min3_f32 v55, v55, v89, v90
v_max_f32 v51, v51, v91
v_min_f32 v55, v55, v91
s_nop 1
v_permlane32_swap_b32 v48, v49
v_permlane32_swap_b32 v50, v51
s_nop 0
v_max_f32 v48, v48, v49
v_max_f32 v50, v50, v51
s_nop 1
v_permlane16_swap_b32 v48, v50
s_nop 0
v_max_f32 v48, v48, v50
v_mul_f32 v48, s66, v48
v_mov_b32 v50, v48
s_nop 1
v_permlane16_swap_b32 v48, v50
s_nop 0
v_mov_b32 v49, v48
v_mov_b32 v51, v50
s_nop 1
v_permlane32_swap_b32 v48, v49
v_permlane32_swap_b32 v50, v51
s_nop 0
s_nop 1
v_permlane32_swap_b32 v52, v53
v_permlane32_swap_b32 v54, v55
s_nop 0
v_min_f32 v52, v52, v53
v_min_f32 v54, v54, v55
s_nop 1
v_permlane16_swap_b32 v52, v54
s_nop 0
v_min_f32 v52, v52, v54
v_mul_f32 v52, s66, v52
v_mov_b32 v54, v52
s_nop 1
v_permlane16_swap_b32 v52, v54
s_nop 0
v_mov_b32 v53, v52
v_mov_b32 v55, v54
s_nop 1
v_permlane32_swap_b32 v52, v53
v_permlane32_swap_b32 v54, v55
s_nop 0
v_fma_f32 v92, -v60, s66, v52
v_fma_f32 v60, v60, s66, -v48
v_fma_f32 v93, -v61, s66, v52
v_fma_f32 v61, v61, s66, -v48
v_fma_f32 v94, -v62, s66, v52
v_fma_f32 v62, v62, s66, -v48
v_fma_f32 v95, -v63, s66, v52
v_fma_f32 v63, v63, s66, -v48
v_fma_f32 v96, -v64, s66, v52
v_fma_f32 v64, v64, s66, -v48
v_fma_f32 v97, -v65, s66, v52
v_fma_f32 v65, v65, s66, -v48
v_fma_f32 v98, -v66, s66, v52
v_fma_f32 v66, v66, s66, -v48
v_fma_f32 v99, -v67, s66, v52
v_fma_f32 v67, v67, s66, -v48
v_exp_f32 v92, v92
v_exp_f32 v60, v60
v_exp_f32 v93, v93
v_exp_f32 v61, v61
v_exp_f32 v94, v94
v_exp_f32 v62, v62
v_exp_f32 v95, v95
v_exp_f32 v63, v63
v_exp_f32 v96, v96
v_exp_f32 v64, v64
v_exp_f32 v97, v97
v_exp_f32 v65, v65
v_exp_f32 v98, v98
v_exp_f32 v66, v66
v_exp_f32 v99, v99
v_exp_f32 v67, v67
v_fma_f32 v100, -v68, s66, v53
v_fma_f32 v68, v68, s66, -v49
v_fma_f32 v101, -v69, s66, v53
v_fma_f32 v69, v69, s66, -v49
v_fma_f32 v102, -v70, s66, v53
v_fma_f32 v70, v70, s66, -v49
v_fma_f32 v103, -v71, s66, v53
v_fma_f32 v71, v71, s66, -v49
v_fma_f32 v104, -v72, s66, v53
v_fma_f32 v72, v72, s66, -v49
v_fma_f32 v105, -v73, s66, v53
v_fma_f32 v73, v73, s66, -v49
v_fma_f32 v106, -v74, s66, v53
v_fma_f32 v74, v74, s66, -v49
v_fma_f32 v107, -v75, s66, v53
v_fma_f32 v75, v75, s66, -v49
v_exp_f32 v100, v100
v_exp_f32 v68, v68
v_exp_f32 v101, v101
v_exp_f32 v69, v69
v_exp_f32 v102, v102
v_exp_f32 v70, v70
v_exp_f32 v103, v103
v_exp_f32 v71, v71
v_exp_f32 v104, v104
v_exp_f32 v72, v72
v_exp_f32 v105, v105
v_exp_f32 v73, v73
v_exp_f32 v106, v106
v_exp_f32 v74, v74
v_exp_f32 v107, v107
v_exp_f32 v75, v75
v_fma_f32 v108, -v76, s66, v54
v_fma_f32 v76, v76, s66, -v50
v_fma_f32 v109, -v77, s66, v54
v_fma_f32 v77, v77, s66, -v50
v_fma_f32 v110, -v78, s66, v54
v_fma_f32 v78, v78, s66, -v50
v_fma_f32 v111, -v79, s66, v54
v_fma_f32 v79, v79, s66, -v50
v_fma_f32 v112, -v80, s66, v54
v_fma_f32 v80, v80, s66, -v50
v_fma_f32 v113, -v81, s66, v54
v_fma_f32 v81, v81, s66, -v50
v_fma_f32 v114, -v82, s66, v54
v_fma_f32 v82, v82, s66, -v50
v_fma_f32 v115, -v83, s66, v54
v_fma_f32 v83, v83, s66, -v50
v_exp_f32 v108, v108
v_exp_f32 v76, v76
v_exp_f32 v109, v109
v_exp_f32 v77, v77
v_exp_f32 v110, v110
v_exp_f32 v78, v78
v_exp_f32 v111, v111
v_exp_f32 v79, v79
v_exp_f32 v112, v112
v_exp_f32 v80, v80
v_exp_f32 v113, v113
v_exp_f32 v81, v81
v_exp_f32 v114, v114
v_exp_f32 v82, v82
v_exp_f32 v115, v115
v_exp_f32 v83, v83
v_fma_f32 v116, -v84, s66, v55
v_fma_f32 v84, v84, s66, -v51
v_fma_f32 v117, -v85, s66, v55
v_fma_f32 v85, v85, s66, -v51
v_fma_f32 v118, -v86, s66, v55
v_fma_f32 v86, v86, s66, -v51
v_fma_f32 v119, -v87, s66, v55
v_fma_f32 v87, v87, s66, -v51
v_fma_f32 v120, -v88, s66, v55
v_fma_f32 v88, v88, s66, -v51
v_fma_f32 v121, -v89, s66, v55
v_fma_f32 v89, v89, s66, -v51
v_fma_f32 v122, -v90, s66, v55
v_fma_f32 v90, v90, s66, -v51
v_fma_f32 v123, -v91, s66, v55
v_fma_f32 v91, v91, s66, -v51
v_exp_f32 v116, v116
v_exp_f32 v84, v84
v_exp_f32 v117, v117
v_exp_f32 v85, v85
v_exp_f32 v118, v118
v_exp_f32 v86, v86
v_exp_f32 v119, v119
v_exp_f32 v87, v87
v_exp_f32 v120, v120
v_exp_f32 v88, v88
v_exp_f32 v121, v121
v_exp_f32 v89, v89
v_exp_f32 v122, v122
v_exp_f32 v90, v90
v_exp_f32 v123, v123
v_exp_f32 v91, v91
s_nop 0
v_add_f32 v48, v60, v61
v_add_f32 v52, v92, v93
v_add_f32 v48, v48, v62
v_add_f32 v52, v52, v94
v_add_f32 v48, v48, v63
v_add_f32 v52, v52, v95
v_add_f32 v48, v48, v64
v_add_f32 v52, v52, v96
v_add_f32 v48, v48, v65
v_add_f32 v52, v52, v97
v_add_f32 v48, v48, v66
v_add_f32 v52, v52, v98
v_add_f32 v48, v48, v67
v_add_f32 v52, v52, v99
v_add_f32 v49, v68, v69
v_add_f32 v53, v100, v101
v_add_f32 v49, v49, v70
v_add_f32 v53, v53, v102
v_add_f32 v49, v49, v71
v_add_f32 v53, v53, v103
v_add_f32 v49, v49, v72
v_add_f32 v53, v53, v104
v_add_f32 v49, v49, v73
v_add_f32 v53, v53, v105
v_add_f32 v49, v49, v74
v_add_f32 v53, v53, v106
v_add_f32 v49, v49, v75
v_add_f32 v53, v53, v107
v_add_f32 v50, v76, v77
v_add_f32 v54, v108, v109
v_add_f32 v50, v50, v78
v_add_f32 v54, v54, v110
v_add_f32 v50, v50, v79
v_add_f32 v54, v54, v111
v_add_f32 v50, v50, v80
v_add_f32 v54, v54, v112
v_add_f32 v50, v50, v81
v_add_f32 v54, v54, v113
v_add_f32 v50, v50, v82
v_add_f32 v54, v54, v114
v_add_f32 v50, v50, v83
v_add_f32 v54, v54, v115
v_add_f32 v51, v84, v85
v_add_f32 v55, v116, v117
v_add_f32 v51, v51, v86
v_add_f32 v55, v55, v118
v_add_f32 v51, v51, v87
v_add_f32 v55, v55, v119
v_add_f32 v51, v51, v88
v_add_f32 v55, v55, v120
v_add_f32 v51, v51, v89
v_add_f32 v55, v55, v121
v_add_f32 v51, v51, v90
v_add_f32 v55, v55, v122
v_add_f32 v51, v51, v91
v_add_f32 v55, v55, v123
s_nop 1
v_permlane32_swap_b32 v48, v49
v_permlane32_swap_b32 v50, v51
s_nop 0
v_add_f32 v48, v48, v49
v_add_f32 v50, v50, v51
s_nop 1
v_permlane16_swap_b32 v48, v50
s_nop 0
v_add_f32 v48, v48, v50
v_rcp_f32 v48, v48
s_nop 0
v_mov_b32 v50, v48
s_nop 1
v_permlane16_swap_b32 v48, v50
s_nop 0
v_mov_b32 v49, v48
v_mov_b32 v51, v50
s_nop 1
v_permlane32_swap_b32 v48, v49
v_permlane32_swap_b32 v50, v51
s_nop 0
s_nop 1
v_permlane32_swap_b32 v52, v53
v_permlane32_swap_b32 v54, v55
s_nop 0
v_add_f32 v52, v52, v53
v_add_f32 v54, v54, v55
s_nop 1
v_permlane16_swap_b32 v52, v54
s_nop 0
v_add_f32 v52, v52, v54
v_rcp_f32 v52, v52
s_nop 0
v_mov_b32 v54, v52
s_nop 1
v_permlane16_swap_b32 v52, v54
s_nop 0
v_mov_b32 v53, v52
v_mov_b32 v55, v54
s_nop 1
v_permlane32_swap_b32 v52, v53
v_permlane32_swap_b32 v54, v55
s_nop 0
v_pk_mul_f32 v[60:61], v[60:61], v[48:49] op_sel:[0,0] op_sel_hi:[1,0]
v_pk_mul_f32 v[62:63], v[62:63], v[48:49] op_sel:[0,0] op_sel_hi:[1,0]
v_pk_mul_f32 v[64:65], v[64:65], v[48:49] op_sel:[0,0] op_sel_hi:[1,0]
v_pk_mul_f32 v[66:67], v[66:67], v[48:49] op_sel:[0,0] op_sel_hi:[1,0]
v_pk_mul_f32 v[92:93], v[92:93], v[52:53] op_sel:[0,0] op_sel_hi:[1,0]
v_pk_mul_f32 v[94:95], v[94:95], v[52:53] op_sel:[0,0] op_sel_hi:[1,0]
v_pk_mul_f32 v[96:97], v[96:97], v[52:53] op_sel:[0,0] op_sel_hi:[1,0]
v_pk_mul_f32 v[98:99], v[98:99], v[52:53] op_sel:[0,0] op_sel_hi:[1,0]
v_cvt_pk_bf16_f32 v60, v60, v61
v_cvt_pk_bf16_f32 v61, v62, v63
v_cvt_pk_bf16_f32 v62, v64, v65
v_cvt_pk_bf16_f32 v63, v66, v67
v_cvt_pk_bf16_f32 v92, v92, v93
v_cvt_pk_bf16_f32 v93, v94, v95
v_cvt_pk_bf16_f32 v94, v96, v97
v_cvt_pk_bf16_f32 v95, v98, v99
v_pk_mul_f32 v[68:69], v[68:69], v[48:49] op_sel:[0,1] op_sel_hi:[1,1]
v_pk_mul_f32 v[70:71], v[70:71], v[48:49] op_sel:[0,1] op_sel_hi:[1,1]
v_pk_mul_f32 v[72:73], v[72:73], v[48:49] op_sel:[0,1] op_sel_hi:[1,1]
v_pk_mul_f32 v[74:75], v[74:75], v[48:49] op_sel:[0,1] op_sel_hi:[1,1]
v_pk_mul_f32 v[100:101], v[100:101], v[52:53] op_sel:[0,1] op_sel_hi:[1,1]
v_pk_mul_f32 v[102:103], v[102:103], v[52:53] op_sel:[0,1] op_sel_hi:[1,1]
v_pk_mul_f32 v[104:105], v[104:105], v[52:53] op_sel:[0,1] op_sel_hi:[1,1]
v_pk_mul_f32 v[106:107], v[106:107], v[52:53] op_sel:[0,1] op_sel_hi:[1,1]
v_cvt_pk_bf16_f32 v68, v68, v69
v_cvt_pk_bf16_f32 v69, v70, v71
v_cvt_pk_bf16_f32 v70, v72, v73
v_cvt_pk_bf16_f32 v71, v74, v75
v_cvt_pk_bf16_f32 v100, v100, v101
v_cvt_pk_bf16_f32 v101, v102, v103
v_cvt_pk_bf16_f32 v102, v104, v105
v_cvt_pk_bf16_f32 v103, v106, v107
v_pk_mul_f32 v[76:77], v[76:77], v[50:51] op_sel:[0,0] op_sel_hi:[1,0]
v_pk_mul_f32 v[78:79], v[78:79], v[50:51] op_sel:[0,0] op_sel_hi:[1,0]
v_pk_mul_f32 v[80:81], v[80:81], v[50:51] op_sel:[0,0] op_sel_hi:[1,0]
v_pk_mul_f32 v[82:83], v[82:83], v[50:51] op_sel:[0,0] op_sel_hi:[1,0]
v_pk_mul_f32 v[108:109], v[108:109], v[54:55] op_sel:[0,0] op_sel_hi:[1,0]
v_pk_mul_f32 v[110:111], v[110:111], v[54:55] op_sel:[0,0] op_sel_hi:[1,0]
v_pk_mul_f32 v[112:113], v[112:113], v[54:55] op_sel:[0,0] op_sel_hi:[1,0]
v_pk_mul_f32 v[114:115], v[114:115], v[54:55] op_sel:[0,0] op_sel_hi:[1,0]
v_cvt_pk_bf16_f32 v76, v76, v77
v_cvt_pk_bf16_f32 v77, v78, v79
v_cvt_pk_bf16_f32 v78, v80, v81
v_cvt_pk_bf16_f32 v79, v82, v83
v_cvt_pk_bf16_f32 v108, v108, v109
v_cvt_pk_bf16_f32 v109, v110, v111
v_cvt_pk_bf16_f32 v110, v112, v113
v_cvt_pk_bf16_f32 v111, v114, v115
v_pk_mul_f32 v[84:85], v[84:85], v[50:51] op_sel:[0,1] op_sel_hi:[1,1]
v_pk_mul_f32 v[86:87], v[86:87], v[50:51] op_sel:[0,1] op_sel_hi:[1,1]
v_pk_mul_f32 v[88:89], v[88:89], v[50:51] op_sel:[0,1] op_sel_hi:[1,1]
v_pk_mul_f32 v[90:91], v[90:91], v[50:51] op_sel:[0,1] op_sel_hi:[1,1]
v_pk_mul_f32 v[116:117], v[116:117], v[54:55] op_sel:[0,1] op_sel_hi:[1,1]
v_pk_mul_f32 v[118:119], v[118:119], v[54:55] op_sel:[0,1] op_sel_hi:[1,1]
v_pk_mul_f32 v[120:121], v[120:121], v[54:55] op_sel:[0,1] op_sel_hi:[1,1]
v_pk_mul_f32 v[122:123], v[122:123], v[54:55] op_sel:[0,1] op_sel_hi:[1,1]
v_cvt_pk_bf16_f32 v84, v84, v85
v_cvt_pk_bf16_f32 v85, v86, v87
v_cvt_pk_bf16_f32 v86, v88, v89
v_cvt_pk_bf16_f32 v87, v90, v91
v_cvt_pk_bf16_f32 v116, v116, v117
v_cvt_pk_bf16_f32 v117, v118, v119
v_cvt_pk_bf16_f32 v118, v120, v121
v_cvt_pk_bf16_f32 v119, v122, v123
s_lshl_b32 s48, s43, 14
s_lshl_b32 s49, s44, 12
s_add_u32 s48, s48, s49
v_add_u32 v5, s48, v18
ds_write_b128 v5, v[60:63] offset:0
ds_write_b128 v5, v[92:95] offset:8192
ds_write_b128 v5, v[68:71] offset:1024
ds_write_b128 v5, v[100:103] offset:9216
ds_write_b128 v5, v[76:79] offset:2048
ds_write_b128 v5, v[108:111] offset:10240
ds_write_b128 v5, v[84:87] offset:3072
ds_write_b128 v5, v[116:119] offset:11264
v_and_b32 v4, 3, v0
v_lshlrev_b32 v4, 4, v4
v_lshrrev_b32 v6, 2, v2
v_lshl_add_u32 v6, v3, 2, v6
v_add_u32 v4, v4, v6
v_lshlrev_b32 v4, 4, v4
s_lshl_b32 s49, s44, 13
s_add_u32 s48, s48, s49
v_add_u32 v6, s48, v4
v_xor_b32 v7, 4096, v6
s_xor_b32 s48, s40, 2
s_lshl_b32 s48, s48, 12
s_add_u32 s48, s48, 139264
v_add_u32 v5, s48, v18
v_mov_b32 v56, 0x3f803f80
v_mov_b32 v57, 0x3f803f80
v_mov_b32 v58, 0x3f803f80
v_mov_b32 v59, 0x3f803f80
s_waitcnt lgkmcnt(0)
s_barrier
ds_read_b64_tr_b16 v[60:61], v6 offset:0
ds_read_b64_tr_b16 v[62:63], v6 offset:1024
ds_read_b64_tr_b16 v[64:65], v6 offset:8
ds_read_b64_tr_b16 v[66:67], v6 offset:1032
ds_read_b64_tr_b16 v[68:69], v6 offset:2048
ds_read_b64_tr_b16 v[70:71], v6 offset:3072
ds_read_b64_tr_b16 v[72:73], v6 offset:2056
ds_read_b64_tr_b16 v[74:75], v6 offset:3080
ds_read_b128 v[92:95], v5 offset:0
ds_read_b128 v[96:99], v5 offset:1024
ds_read_b128 v[100:103], v5 offset:2048
ds_read_b128 v[104:107], v5 offset:3072
s_waitcnt lgkmcnt(4)
ds_read_b64_tr_b16 v[76:77], v7 offset:0
ds_read_b64_tr_b16 v[78:79], v7 offset:1024
ds_read_b64_tr_b16 v[80:81], v7 offset:8
ds_read_b64_tr_b16 v[82:83], v7 offset:1032
ds_read_b64_tr_b16 v[84:85], v7 offset:2048
ds_read_b64_tr_b16 v[86:87], v7 offset:3072
ds_read_b64_tr_b16 v[88:89], v7 offset:2056
ds_read_b64_tr_b16 v[90:91], v7 offset:3080
v_mfma_f32_16x16x32_bf16 v[180:183], v[60:63], v[22:25], 0
v_mfma_f32_16x16x32_bf16 v[188:191], v[60:63], v[32:35], 0
v_mfma_f32_16x16x32_bf16 v[196:199], v[60:63], v[56:59], 0
v_mfma_f32_16x16x32_bf16 v[184:187], v[64:67], v[22:25], 0
v_mfma_f32_16x16x32_bf16 v[192:195], v[64:67], v[32:35], 0
v_mfma_f32_16x16x32_bf16 v[200:203], v[64:67], v[56:59], 0
v_mfma_f32_16x16x32_bf16 v[180:183], v[68:71], v[26:29], v[180:183]
v_mfma_f32_16x16x32_bf16 v[188:191], v[68:71], v[36:39], v[188:191]
v_mfma_f32_16x16x32_bf16 v[196:199], v[68:71], v[56:59], v[196:199]
v_mfma_f32_16x16x32_bf16 v[184:187], v[72:75], v[26:29], v[184:187]
v_mfma_f32_16x16x32_bf16 v[192:195], v[72:75], v[36:39], v[192:195]
v_mfma_f32_16x16x32_bf16 v[200:203], v[72:75], v[56:59], v[200:203]
s_waitcnt lgkmcnt(0)
v_mfma_f32_16x16x32_bf16 v[180:183], v[76:79], v[92:95], v[180:183]
v_mfma_f32_16x16x32_bf16 v[188:191], v[76:79], v[100:103], v[188:191]
v_mfma_f32_16x16x32_bf16 v[196:199], v[76:79], v[56:59], v[196:199]
v_mfma_f32_16x16x32_bf16 v[184:187], v[80:83], v[92:95], v[184:187]
v_mfma_f32_16x16x32_bf16 v[192:195], v[80:83], v[100:103], v[192:195]
v_mfma_f32_16x16x32_bf16 v[200:203], v[80:83], v[56:59], v[200:203]
v_mfma_f32_16x16x32_bf16 v[180:183], v[84:87], v[96:99], v[180:183]
v_mfma_f32_16x16x32_bf16 v[188:191], v[84:87], v[104:107], v[188:191]
v_mfma_f32_16x16x32_bf16 v[196:199], v[84:87], v[56:59], v[196:199]
v_mfma_f32_16x16x32_bf16 v[184:187], v[88:91], v[96:99], v[184:187]
v_mfma_f32_16x16x32_bf16 v[192:195], v[88:91], v[104:107], v[192:195]
v_mfma_f32_16x16x32_bf16 v[200:203], v[88:91], v[56:59], v[200:203]
s_lshl_b32 s48, s45, 1
s_add_u32 s48, s48, s44
s_lshl_b32 s53, s48, 15
s_add_u32 s53, s53, 10485760
s_lshl_b32 s50, s41, 10
s_add_u32 s49, s53, s50
s_add_u32 s50, s49, 16384
s_lshl_b32 s54, s48, 10
s_add_u32 s54, s54, 12648448
v_cmp_eq_u32 vcc, s41, v2
s_nop 1
v_cvt_pk_bf16_f32 v180, v180, v181
v_cvt_pk_bf16_f32 v181, v182, v183
v_cvt_pk_bf16_f32 v182, v184, v185
v_cvt_pk_bf16_f32 v183, v186, v187
v_cvt_pk_bf16_f32 v188, v188, v189
v_cvt_pk_bf16_f32 v189, v190, v191
v_cvt_pk_bf16_f32 v190, v192, v193
v_cvt_pk_bf16_f32 v191, v194, v195
v_cvt_pk_bf16_f32 v196, v196, v197
v_cvt_pk_bf16_f32 v197, v198, v199
v_cvt_pk_bf16_f32 v198, v200, v201
v_cvt_pk_bf16_f32 v199, v202, v203
buffer_store_dwordx4 v[180:183], v18, s[32:35], s49 offen sc1
buffer_store_dwordx4 v[188:191], v18, s[32:35], s50 offen sc1
s_mov_b64 exec, vcc
buffer_store_dwordx4 v[196:199], v18, s[32:35], s54 offen sc1
s_mov_b64 exec, -1
s_barrier
v_pk_fma_f32 v[148:149], v[128:129], v[138:139], v[148:149] op_sel:[0,1,0] op_sel_hi:[1,1,1]
v_pk_fma_f32 v[150:151], v[130:131], v[138:139], v[150:151] op_sel:[0,1,0] op_sel_hi:[1,1,1]
v_pk_fma_f32 v[152:153], v[132:133], v[138:139], v[152:153] op_sel:[0,1,0] op_sel_hi:[1,1,1]
v_pk_fma_f32 v[154:155], v[134:135], v[138:139], v[154:155] op_sel:[0,1,0] op_sel_hi:[1,1,1]
v_pk_mul_f32 v[148:149], v[148:149], v[138:139] op_sel:[0,0] op_sel_hi:[1,0]
v_pk_mul_f32 v[150:151], v[150:151], v[138:139] op_sel:[0,0] op_sel_hi:[1,0]
v_pk_mul_f32 v[152:153], v[152:153], v[138:139] op_sel:[0,0] op_sel_hi:[1,0]
v_pk_mul_f32 v[154:155], v[154:155], v[138:139] op_sel:[0,0] op_sel_hi:[1,0]
v_cvt_pk_bf16_f32 v148, v148, v149
v_cvt_pk_bf16_f32 v149, v150, v151
v_cvt_pk_bf16_f32 v150, v152, v153
v_cvt_pk_bf16_f32 v151, v154, v155
v_pk_fma_f32 v[156:157], v[128:129], v[140:141], v[156:157] op_sel:[0,1,0] op_sel_hi:[1,1,1]
v_pk_fma_f32 v[158:159], v[130:131], v[140:141], v[158:159] op_sel:[0,1,0] op_sel_hi:[1,1,1]
v_pk_fma_f32 v[160:161], v[132:133], v[140:141], v[160:161] op_sel:[0,1,0] op_sel_hi:[1,1,1]
v_pk_fma_f32 v[162:163], v[134:135], v[140:141], v[162:163] op_sel:[0,1,0] op_sel_hi:[1,1,1]
v_pk_mul_f32 v[156:157], v[156:157], v[140:141] op_sel:[0,0] op_sel_hi:[1,0]
v_pk_mul_f32 v[158:159], v[158:159], v[140:141] op_sel:[0,0] op_sel_hi:[1,0]
v_pk_mul_f32 v[160:161], v[160:161], v[140:141] op_sel:[0,0] op_sel_hi:[1,0]
v_pk_mul_f32 v[162:163], v[162:163], v[140:141] op_sel:[0,0] op_sel_hi:[1,0]
v_cvt_pk_bf16_f32 v156, v156, v157
v_cvt_pk_bf16_f32 v157, v158, v159
v_cvt_pk_bf16_f32 v158, v160, v161
v_cvt_pk_bf16_f32 v159, v162, v163
v_pk_fma_f32 v[164:165], v[128:129], v[142:143], v[164:165] op_sel:[0,1,0] op_sel_hi:[1,1,1]
v_pk_fma_f32 v[166:167], v[130:131], v[142:143], v[166:167] op_sel:[0,1,0] op_sel_hi:[1,1,1]
v_pk_fma_f32 v[168:169], v[132:133], v[142:143], v[168:169] op_sel:[0,1,0] op_sel_hi:[1,1,1]
v_pk_fma_f32 v[170:171], v[134:135], v[142:143], v[170:171] op_sel:[0,1,0] op_sel_hi:[1,1,1]
v_pk_mul_f32 v[164:165], v[164:165], v[142:143] op_sel:[0,0] op_sel_hi:[1,0]
v_pk_mul_f32 v[166:167], v[166:167], v[142:143] op_sel:[0,0] op_sel_hi:[1,0]
v_pk_mul_f32 v[168:169], v[168:169], v[142:143] op_sel:[0,0] op_sel_hi:[1,0]
v_pk_mul_f32 v[170:171], v[170:171], v[142:143] op_sel:[0,0] op_sel_hi:[1,0]
v_cvt_pk_bf16_f32 v164, v164, v165
v_cvt_pk_bf16_f32 v165, v166, v167
v_cvt_pk_bf16_f32 v166, v168, v169
v_cvt_pk_bf16_f32 v167, v170, v171
v_pk_fma_f32 v[172:173], v[128:129], v[144:145], v[172:173] op_sel:[0,1,0] op_sel_hi:[1,1,1]
v_pk_fma_f32 v[174:175], v[130:131], v[144:145], v[174:175] op_sel:[0,1,0] op_sel_hi:[1,1,1]
v_pk_fma_f32 v[176:177], v[132:133], v[144:145], v[176:177] op_sel:[0,1,0] op_sel_hi:[1,1,1]
v_pk_fma_f32 v[178:179], v[134:135], v[144:145], v[178:179] op_sel:[0,1,0] op_sel_hi:[1,1,1]
v_pk_mul_f32 v[172:173], v[172:173], v[144:145] op_sel:[0,0] op_sel_hi:[1,0]
v_pk_mul_f32 v[174:175], v[174:175], v[144:145] op_sel:[0,0] op_sel_hi:[1,0]
v_pk_mul_f32 v[176:177], v[176:177], v[144:145] op_sel:[0,0] op_sel_hi:[1,0]
v_pk_mul_f32 v[178:179], v[178:179], v[144:145] op_sel:[0,0] op_sel_hi:[1,0]
v_cvt_pk_bf16_f32 v172, v172, v173
v_cvt_pk_bf16_f32 v173, v174, v175
v_cvt_pk_bf16_f32 v174, v176, v177
v_cvt_pk_bf16_f32 v175, v178, v179
s_lshl_b32 s55, s42, 2
s_add_u32 s55, s55, s40
s_lshl_b32 s55, s55, 7
s_add_u32 s55, s55, 14172160
s_waitcnt vmcnt(0)
s_lshl_b32 s62, s41, 2
v_mov_b32 v4, s62
v_mov_b32 v5, 2
s_mov_b64 exec, 1
buffer_store_dword v5, v4, s[32:35], s55 offen sc1
s_mov_b64 exec, -1
v_mfma_f32_16x16x32_bf16 v[60:63], v[40:43], v[148:151], 0
v_mfma_f32_16x16x32_bf16 v[64:67], v[44:47], v[148:151], 0
v_mfma_f32_16x16x32_bf16 v[68:71], v[40:43], v[156:159], 0
v_mfma_f32_16x16x32_bf16 v[72:75], v[44:47], v[156:159], 0
v_mfma_f32_16x16x32_bf16 v[76:79], v[40:43], v[164:167], 0
v_mfma_f32_16x16x32_bf16 v[80:83], v[44:47], v[164:167], 0
v_mfma_f32_16x16x32_bf16 v[84:87], v[40:43], v[172:175], 0
v_mfma_f32_16x16x32_bf16 v[88:91], v[44:47], v[172:175], 0
s_nop 4
v_max3_f32 v48, v60, v61, v62
v_min3_f32 v52, v60, v61, v62
v_max3_f32 v48, v48, v63, v64
v_min3_f32 v52, v52, v63, v64
v_max3_f32 v48, v48, v65, v66
v_min3_f32 v52, v52, v65, v66
v_max_f32 v48, v48, v67
v_min_f32 v52, v52, v67
v_max3_f32 v49, v68, v69, v70
v_min3_f32 v53, v68, v69, v70
v_max3_f32 v49, v49, v71, v72
v_min3_f32 v53, v53, v71, v72
v_max3_f32 v49, v49, v73, v74
v_min3_f32 v53, v53, v73, v74
v_max_f32 v49, v49, v75
v_min_f32 v53, v53, v75
v_max3_f32 v50, v76, v77, v78
v_min3_f32 v54, v76, v77, v78
v_max3_f32 v50, v50, v79, v80
v_min3_f32 v54, v54, v79, v80
v_max3_f32 v50, v50, v81, v82
v_min3_f32 v54, v54, v81, v82
v_max_f32 v50, v50, v83
v_min_f32 v54, v54, v83
v_max3_f32 v51, v84, v85, v86
v_min3_f32 v55, v84, v85, v86
v_max3_f32 v51, v51, v87, v88
v_min3_f32 v55, v55, v87, v88
v_max3_f32 v51, v51, v89, v90
v_min3_f32 v55, v55, v89, v90
v_max_f32 v51, v51, v91
v_min_f32 v55, v55, v91
s_nop 1
v_permlane32_swap_b32 v48, v49
v_permlane32_swap_b32 v50, v51
s_nop 0
v_max_f32 v48, v48, v49
v_max_f32 v50, v50, v51
s_nop 1
v_permlane16_swap_b32 v48, v50
s_nop 0
v_max_f32 v48, v48, v50
v_mul_f32 v48, s66, v48
v_mov_b32 v50, v48
s_nop 1
v_permlane16_swap_b32 v48, v50
s_nop 0
v_mov_b32 v49, v48
v_mov_b32 v51, v50
s_nop 1
v_permlane32_swap_b32 v48, v49
v_permlane32_swap_b32 v50, v51
s_nop 0
s_nop 1
v_permlane32_swap_b32 v52, v53
v_permlane32_swap_b32 v54, v55
s_nop 0
v_min_f32 v52, v52, v53
v_min_f32 v54, v54, v55
s_nop 1
v_permlane16_swap_b32 v52, v54
s_nop 0
v_min_f32 v52, v52, v54
v_mul_f32 v52, s66, v52
v_mov_b32 v54, v52
s_nop 1
v_permlane16_swap_b32 v52, v54
s_nop 0
v_mov_b32 v53, v52
v_mov_b32 v55, v54
s_nop 1
v_permlane32_swap_b32 v52, v53
v_permlane32_swap_b32 v54, v55
s_nop 0
v_fma_f32 v92, -v60, s66, v52
v_fma_f32 v60, v60, s66, -v48
v_fma_f32 v93, -v61, s66, v52
v_fma_f32 v61, v61, s66, -v48
v_fma_f32 v94, -v62, s66, v52
v_fma_f32 v62, v62, s66, -v48
v_fma_f32 v95, -v63, s66, v52
v_fma_f32 v63, v63, s66, -v48
v_fma_f32 v96, -v64, s66, v52
v_fma_f32 v64, v64, s66, -v48
v_fma_f32 v97, -v65, s66, v52
v_fma_f32 v65, v65, s66, -v48
v_fma_f32 v98, -v66, s66, v52
v_fma_f32 v66, v66, s66, -v48
v_fma_f32 v99, -v67, s66, v52
v_fma_f32 v67, v67, s66, -v48
v_exp_f32 v92, v92
v_exp_f32 v60, v60
v_exp_f32 v93, v93
v_exp_f32 v61, v61
v_exp_f32 v94, v94
v_exp_f32 v62, v62
v_exp_f32 v95, v95
v_exp_f32 v63, v63
v_exp_f32 v96, v96
v_exp_f32 v64, v64
v_exp_f32 v97, v97
v_exp_f32 v65, v65
v_exp_f32 v98, v98
v_exp_f32 v66, v66
v_exp_f32 v99, v99
v_exp_f32 v67, v67
v_fma_f32 v100, -v68, s66, v53
v_fma_f32 v68, v68, s66, -v49
v_fma_f32 v101, -v69, s66, v53
v_fma_f32 v69, v69, s66, -v49
v_fma_f32 v102, -v70, s66, v53
v_fma_f32 v70, v70, s66, -v49
v_fma_f32 v103, -v71, s66, v53
v_fma_f32 v71, v71, s66, -v49
v_fma_f32 v104, -v72, s66, v53
v_fma_f32 v72, v72, s66, -v49
v_fma_f32 v105, -v73, s66, v53
v_fma_f32 v73, v73, s66, -v49
v_fma_f32 v106, -v74, s66, v53
v_fma_f32 v74, v74, s66, -v49
v_fma_f32 v107, -v75, s66, v53
v_fma_f32 v75, v75, s66, -v49
v_exp_f32 v100, v100
v_exp_f32 v68, v68
v_exp_f32 v101, v101
v_exp_f32 v69, v69
v_exp_f32 v102, v102
v_exp_f32 v70, v70
v_exp_f32 v103, v103
v_exp_f32 v71, v71
v_exp_f32 v104, v104
v_exp_f32 v72, v72
v_exp_f32 v105, v105
v_exp_f32 v73, v73
v_exp_f32 v106, v106
v_exp_f32 v74, v74
v_exp_f32 v107, v107
v_exp_f32 v75, v75
v_fma_f32 v108, -v76, s66, v54
v_fma_f32 v76, v76, s66, -v50
v_fma_f32 v109, -v77, s66, v54
v_fma_f32 v77, v77, s66, -v50
v_fma_f32 v110, -v78, s66, v54
v_fma_f32 v78, v78, s66, -v50
v_fma_f32 v111, -v79, s66, v54
v_fma_f32 v79, v79, s66, -v50
v_fma_f32 v112, -v80, s66, v54
v_fma_f32 v80, v80, s66, -v50
v_fma_f32 v113, -v81, s66, v54
v_fma_f32 v81, v81, s66, -v50
v_fma_f32 v114, -v82, s66, v54
v_fma_f32 v82, v82, s66, -v50
v_fma_f32 v115, -v83, s66, v54
v_fma_f32 v83, v83, s66, -v50
v_exp_f32 v108, v108
v_exp_f32 v76, v76
v_exp_f32 v109, v109
v_exp_f32 v77, v77
v_exp_f32 v110, v110
v_exp_f32 v78, v78
v_exp_f32 v111, v111
v_exp_f32 v79, v79
v_exp_f32 v112, v112
v_exp_f32 v80, v80
v_exp_f32 v113, v113
v_exp_f32 v81, v81
v_exp_f32 v114, v114
v_exp_f32 v82, v82
v_exp_f32 v115, v115
v_exp_f32 v83, v83
v_fma_f32 v116, -v84, s66, v55
v_fma_f32 v84, v84, s66, -v51
v_fma_f32 v117, -v85, s66, v55
v_fma_f32 v85, v85, s66, -v51
v_fma_f32 v118, -v86, s66, v55
v_fma_f32 v86, v86, s66, -v51
v_fma_f32 v119, -v87, s66, v55
v_fma_f32 v87, v87, s66, -v51
v_fma_f32 v120, -v88, s66, v55
v_fma_f32 v88, v88, s66, -v51
v_fma_f32 v121, -v89, s66, v55
v_fma_f32 v89, v89, s66, -v51
v_fma_f32 v122, -v90, s66, v55
v_fma_f32 v90, v90, s66, -v51
v_fma_f32 v123, -v91, s66, v55
v_fma_f32 v91, v91, s66, -v51
v_exp_f32 v116, v116
v_exp_f32 v84, v84
v_exp_f32 v117, v117
v_exp_f32 v85, v85
v_exp_f32 v118, v118
v_exp_f32 v86, v86
v_exp_f32 v119, v119
v_exp_f32 v87, v87
v_exp_f32 v120, v120
v_exp_f32 v88, v88
v_exp_f32 v121, v121
v_exp_f32 v89, v89
v_exp_f32 v122, v122
v_exp_f32 v90, v90
v_exp_f32 v123, v123
v_exp_f32 v91, v91
s_nop 0
v_add_f32 v48, v60, v61
v_add_f32 v52, v92, v93
v_add_f32 v48, v48, v62
v_add_f32 v52, v52, v94
v_add_f32 v48, v48, v63
v_add_f32 v52, v52, v95
v_add_f32 v48, v48, v64
v_add_f32 v52, v52, v96
v_add_f32 v48, v48, v65
v_add_f32 v52, v52, v97
v_add_f32 v48, v48, v66
v_add_f32 v52, v52, v98
v_add_f32 v48, v48, v67
v_add_f32 v52, v52, v99
v_add_f32 v49, v68, v69
v_add_f32 v53, v100, v101
v_add_f32 v49, v49, v70
v_add_f32 v53, v53, v102
v_add_f32 v49, v49, v71
v_add_f32 v53, v53, v103
v_add_f32 v49, v49, v72
v_add_f32 v53, v53, v104
v_add_f32 v49, v49, v73
v_add_f32 v53, v53, v105
v_add_f32 v49, v49, v74
v_add_f32 v53, v53, v106
v_add_f32 v49, v49, v75
v_add_f32 v53, v53, v107
v_add_f32 v50, v76, v77
v_add_f32 v54, v108, v109
v_add_f32 v50, v50, v78
v_add_f32 v54, v54, v110
v_add_f32 v50, v50, v79
v_add_f32 v54, v54, v111
v_add_f32 v50, v50, v80
v_add_f32 v54, v54, v112
v_add_f32 v50, v50, v81
v_add_f32 v54, v54, v113
v_add_f32 v50, v50, v82
v_add_f32 v54, v54, v114
v_add_f32 v50, v50, v83
v_add_f32 v54, v54, v115
v_add_f32 v51, v84, v85
v_add_f32 v55, v116, v117
v_add_f32 v51, v51, v86
v_add_f32 v55, v55, v118
v_add_f32 v51, v51, v87
v_add_f32 v55, v55, v119
v_add_f32 v51, v51, v88
v_add_f32 v55, v55, v120
v_add_f32 v51, v51, v89
v_add_f32 v55, v55, v121
v_add_f32 v51, v51, v90
v_add_f32 v55, v55, v122
v_add_f32 v51, v51, v91
v_add_f32 v55, v55, v123
s_nop 1
v_permlane32_swap_b32 v48, v49
v_permlane32_swap_b32 v50, v51
s_nop 0
v_add_f32 v48, v48, v49
v_add_f32 v50, v50, v51
s_nop 1
v_permlane16_swap_b32 v48, v50
s_nop 0
v_add_f32 v48, v48, v50
v_rcp_f32 v48, v48
s_nop 0
v_mov_b32 v50, v48
s_nop 1
v_permlane16_swap_b32 v48, v50
s_nop 0
v_mov_b32 v49, v48
v_mov_b32 v51, v50
s_nop 1
v_permlane32_swap_b32 v48, v49
v_permlane32_swap_b32 v50, v51
s_nop 0
s_nop 1
v_permlane32_swap_b32 v52, v53
v_permlane32_swap_b32 v54, v55
s_nop 0
v_add_f32 v52, v52, v53
v_add_f32 v54, v54, v55
s_nop 1
v_permlane16_swap_b32 v52, v54
s_nop 0
v_add_f32 v52, v52, v54
v_rcp_f32 v52, v52
s_nop 0
v_mov_b32 v54, v52
s_nop 1
v_permlane16_swap_b32 v52, v54
s_nop 0
v_mov_b32 v53, v52
v_mov_b32 v55, v54
s_nop 1
v_permlane32_swap_b32 v52, v53
v_permlane32_swap_b32 v54, v55
s_nop 0
v_pk_mul_f32 v[60:61], v[60:61], v[48:49] op_sel:[0,0] op_sel_hi:[1,0]
v_pk_mul_f32 v[62:63], v[62:63], v[48:49] op_sel:[0,0] op_sel_hi:[1,0]
v_pk_mul_f32 v[64:65], v[64:65], v[48:49] op_sel:[0,0] op_sel_hi:[1,0]
v_pk_mul_f32 v[66:67], v[66:67], v[48:49] op_sel:[0,0] op_sel_hi:[1,0]
v_pk_mul_f32 v[92:93], v[92:93], v[52:53] op_sel:[0,0] op_sel_hi:[1,0]
v_pk_mul_f32 v[94:95], v[94:95], v[52:53] op_sel:[0,0] op_sel_hi:[1,0]
v_pk_mul_f32 v[96:97], v[96:97], v[52:53] op_sel:[0,0] op_sel_hi:[1,0]
v_pk_mul_f32 v[98:99], v[98:99], v[52:53] op_sel:[0,0] op_sel_hi:[1,0]
v_cvt_pk_bf16_f32 v60, v60, v61
v_cvt_pk_bf16_f32 v61, v62, v63
v_cvt_pk_bf16_f32 v62, v64, v65
v_cvt_pk_bf16_f32 v63, v66, v67
v_cvt_pk_bf16_f32 v92, v92, v93
v_cvt_pk_bf16_f32 v93, v94, v95
v_cvt_pk_bf16_f32 v94, v96, v97
v_cvt_pk_bf16_f32 v95, v98, v99
v_pk_mul_f32 v[68:69], v[68:69], v[48:49] op_sel:[0,1] op_sel_hi:[1,1]
v_pk_mul_f32 v[70:71], v[70:71], v[48:49] op_sel:[0,1] op_sel_hi:[1,1]
v_pk_mul_f32 v[72:73], v[72:73], v[48:49] op_sel:[0,1] op_sel_hi:[1,1]
v_pk_mul_f32 v[74:75], v[74:75], v[48:49] op_sel:[0,1] op_sel_hi:[1,1]
v_pk_mul_f32 v[100:101], v[100:101], v[52:53] op_sel:[0,1] op_sel_hi:[1,1]
v_pk_mul_f32 v[102:103], v[102:103], v[52:53] op_sel:[0,1] op_sel_hi:[1,1]
v_pk_mul_f32 v[104:105], v[104:105], v[52:53] op_sel:[0,1] op_sel_hi:[1,1]
v_pk_mul_f32 v[106:107], v[106:107], v[52:53] op_sel:[0,1] op_sel_hi:[1,1]
v_cvt_pk_bf16_f32 v68, v68, v69
v_cvt_pk_bf16_f32 v69, v70, v71
v_cvt_pk_bf16_f32 v70, v72, v73
v_cvt_pk_bf16_f32 v71, v74, v75
v_cvt_pk_bf16_f32 v100, v100, v101
v_cvt_pk_bf16_f32 v101, v102, v103
v_cvt_pk_bf16_f32 v102, v104, v105
v_cvt_pk_bf16_f32 v103, v106, v107
v_pk_mul_f32 v[76:77], v[76:77], v[50:51] op_sel:[0,0] op_sel_hi:[1,0]
v_pk_mul_f32 v[78:79], v[78:79], v[50:51] op_sel:[0,0] op_sel_hi:[1,0]
v_pk_mul_f32 v[80:81], v[80:81], v[50:51] op_sel:[0,0] op_sel_hi:[1,0]
v_pk_mul_f32 v[82:83], v[82:83], v[50:51] op_sel:[0,0] op_sel_hi:[1,0]
v_pk_mul_f32 v[108:109], v[108:109], v[54:55] op_sel:[0,0] op_sel_hi:[1,0]
v_pk_mul_f32 v[110:111], v[110:111], v[54:55] op_sel:[0,0] op_sel_hi:[1,0]
v_pk_mul_f32 v[112:113], v[112:113], v[54:55] op_sel:[0,0] op_sel_hi:[1,0]
v_pk_mul_f32 v[114:115], v[114:115], v[54:55] op_sel:[0,0] op_sel_hi:[1,0]
v_cvt_pk_bf16_f32 v76, v76, v77
v_cvt_pk_bf16_f32 v77, v78, v79
v_cvt_pk_bf16_f32 v78, v80, v81
v_cvt_pk_bf16_f32 v79, v82, v83
v_cvt_pk_bf16_f32 v108, v108, v109
v_cvt_pk_bf16_f32 v109, v110, v111
v_cvt_pk_bf16_f32 v110, v112, v113
v_cvt_pk_bf16_f32 v111, v114, v115
v_pk_mul_f32 v[84:85], v[84:85], v[50:51] op_sel:[0,1] op_sel_hi:[1,1]
v_pk_mul_f32 v[86:87], v[86:87], v[50:51] op_sel:[0,1] op_sel_hi:[1,1]
v_pk_mul_f32 v[88:89], v[88:89], v[50:51] op_sel:[0,1] op_sel_hi:[1,1]
v_pk_mul_f32 v[90:91], v[90:91], v[50:51] op_sel:[0,1] op_sel_hi:[1,1]
v_pk_mul_f32 v[116:117], v[116:117], v[54:55] op_sel:[0,1] op_sel_hi:[1,1]
v_pk_mul_f32 v[118:119], v[118:119], v[54:55] op_sel:[0,1] op_sel_hi:[1,1]
v_pk_mul_f32 v[120:121], v[120:121], v[54:55] op_sel:[0,1] op_sel_hi:[1,1]
v_pk_mul_f32 v[122:123], v[122:123], v[54:55] op_sel:[0,1] op_sel_hi:[1,1]
v_cvt_pk_bf16_f32 v84, v84, v85
v_cvt_pk_bf16_f32 v85, v86, v87
v_cvt_pk_bf16_f32 v86, v88, v89
v_cvt_pk_bf16_f32 v87, v90, v91
v_cvt_pk_bf16_f32 v116, v116, v117
v_cvt_pk_bf16_f32 v117, v118, v119
v_cvt_pk_bf16_f32 v118, v120, v121
v_cvt_pk_bf16_f32 v119, v122, v123
v_lshrrev_b32 v6, 2, v2
v_cmp_eq_u32 vcc, v6, v3
v_and_b32 v7, 1, v0
v_lshlrev_b32 v7, 4, v7
v_mov_b32 v8, 0x3f80
v_lshlrev_b32 v7, v7, v8
v_cndmask_b32 v7, 0, v7, vcc
v_and_b32 v6, 2, v0
v_cmp_eq_u32 vcc, 0, v6
v_mov_b32 v24, 0
v_mov_b32 v25, 0
v_mov_b32 v28, 0
v_mov_b32 v29, 0
v_cndmask_b32 v26, 0, v7, vcc
v_cndmask_b32 v27, v7, 0, vcc
v_and_b32 v4, 15, v0
v_lshlrev_b32 v4, 2, v4
buffer_load_dword v5, v4, s[32:35], s55 offen sc1
s_mov_b32 s63, 0
s_waitcnt vmcnt(0)
poll_24:
v_cmp_gt_u32 vcc, 2, v5
s_cbranch_vccz polled_25
buffer_load_dword v5, v4, s[32:35], s55 offen sc1
s_add_u32 s63, s63, 1
s_cmp_lt_u32 s63, 0x80000
s_waitcnt vmcnt(0)
s_cbranch_scc1 poll_24
polled_25:
buffer_load_dwordx4 v[148:151], v18, s[32:35], s53 offen offset:0 sc1
buffer_load_dwordx4 v[152:155], v18, s[32:35], s53 offen offset:1024 sc1
buffer_load_dwordx4 v[156:159], v18, s[32:35], s53 offen offset:2048 sc1
buffer_load_dwordx4 v[160:163], v18, s[32:35], s53 offen offset:3072 sc1
s_add_u32 s53, s53, 4096
buffer_load_dwordx4 v[164:167], v18, s[32:35], s53 offen offset:0 sc1
buffer_load_dwordx4 v[168:171], v18, s[32:35], s53 offen offset:1024 sc1
buffer_load_dwordx4 v[172:175], v18, s[32:35], s53 offen offset:2048 sc1
buffer_load_dwordx4 v[176:179], v18, s[32:35], s53 offen offset:3072 sc1
s_add_u32 s53, s53, 4096
buffer_load_dwordx4 v[180:183], v18, s[32:35], s53 offen offset:0 sc1
buffer_load_dwordx4 v[184:187], v18, s[32:35], s53 offen offset:1024 sc1
buffer_load_dwordx4 v[188:191], v18, s[32:35], s53 offen offset:2048 sc1
buffer_load_dwordx4 v[192:195], v18, s[32:35], s53 offen offset:3072 sc1
s_add_u32 s53, s53, 4096
buffer_load_dwordx4 v[196:199], v18, s[32:35], s53 offen offset:0 sc1
buffer_load_dwordx4 v[200:203], v18, s[32:35], s53 offen offset:1024 sc1
buffer_load_dwordx4 v[204:207], v18, s[32:35], s53 offen offset:2048 sc1
buffer_load_dwordx4 v[208:211], v18, s[32:35], s53 offen offset:3072 sc1
s_add_u32 s53, s53, 4096
buffer_load_dwordx4 v[212:215], v18, s[32:35], s53 offen offset:0 sc1
buffer_load_dwordx4 v[216:219], v18, s[32:35], s53 offen offset:1024 sc1
buffer_load_dwordx4 v[220:223], v18, s[32:35], s53 offen offset:2048 sc1
buffer_load_dwordx4 v[224:227], v18, s[32:35], s53 offen offset:3072 sc1
s_add_u32 s53, s53, 4096
buffer_load_dwordx4 v[228:231], v18, s[32:35], s53 offen offset:0 sc1
buffer_load_dwordx4 v[232:235], v18, s[32:35], s53 offen offset:1024 sc1
buffer_load_dwordx4 v[236:239], v18, s[32:35], s53 offen offset:2048 sc1
buffer_load_dwordx4 v[240:243], v18, s[32:35], s53 offen offset:3072 sc1
s_add_u32 s53, s53, 4096
buffer_load_dwordx4 v[244:247], v18, s[32:35], s53 offen offset:0 sc1
buffer_load_dwordx4 v[248:251], v18, s[32:35], s53 offen offset:1024 sc1
buffer_load_dwordx4 v[124:127], v18, s[32:35], s53 offen offset:2048 sc1
buffer_load_dwordx4 v[128:131], v18, s[32:35], s53 offen offset:3072 sc1
s_add_u32 s53, s53, 4096
buffer_load_dwordx4 v[132:135], v18, s[32:35], s53 offen offset:0 sc1
buffer_load_dwordx4 v[136:139], v18, s[32:35], s53 offen offset:1024 sc1
buffer_load_dwordx4 v[140:143], v18, s[32:35], s53 offen offset:2048 sc1
buffer_load_dwordx4 v[144:147], v18, s[32:35], s53 offen offset:3072 sc1
buffer_load_dwordx4 v[20:23], v18, s[32:35], s54 offen sc1
s_waitcnt vmcnt(29)
v_mfma_f32_16x16x32_bf16 v[32:35], v[26:29], v[148:151], 0
v_mfma_f32_16x16x32_bf16 v[36:39], v[24:27], v[148:151], 0
v_mfma_f32_16x16x32_bf16 v[32:35], v[26:29], v[152:155], v[32:35]
v_mfma_f32_16x16x32_bf16 v[36:39], v[24:27], v[152:155], v[36:39]
v_mfma_f32_16x16x32_bf16 v[32:35], v[26:29], v[156:159], v[32:35]
v_mfma_f32_16x16x32_bf16 v[36:39], v[24:27], v[156:159], v[36:39]
v_mfma_f32_16x16x32_bf16 v[32:35], v[26:29], v[160:163], v[32:35]
v_mfma_f32_16x16x32_bf16 v[36:39], v[24:27], v[160:163], v[36:39]
s_waitcnt vmcnt(25)
v_mfma_f32_16x16x32_bf16 v[32:35], v[26:29], v[164:167], v[32:35]
v_mfma_f32_16x16x32_bf16 v[36:39], v[24:27], v[164:167], v[36:39]
v_mfma_f32_16x16x32_bf16 v[32:35], v[26:29], v[168:171], v[32:35]
v_mfma_f32_16x16x32_bf16 v[36:39], v[24:27], v[168:171], v[36:39]
v_mfma_f32_16x16x32_bf16 v[32:35], v[26:29], v[172:175], v[32:35]
v_mfma_f32_16x16x32_bf16 v[36:39], v[24:27], v[172:175], v[36:39]
v_mfma_f32_16x16x32_bf16 v[32:35], v[26:29], v[176:179], v[32:35]
v_mfma_f32_16x16x32_bf16 v[36:39], v[24:27], v[176:179], v[36:39]
s_waitcnt vmcnt(21)
v_mfma_f32_16x16x32_bf16 v[32:35], v[26:29], v[180:183], v[32:35]
v_mfma_f32_16x16x32_bf16 v[36:39], v[24:27], v[180:183], v[36:39]
v_mfma_f32_16x16x32_bf16 v[32:35], v[26:29], v[184:187], v[32:35]
v_mfma_f32_16x16x32_bf16 v[36:39], v[24:27], v[184:187], v[36:39]
v_mfma_f32_16x16x32_bf16 v[32:35], v[26:29], v[188:191], v[32:35]
v_mfma_f32_16x16x32_bf16 v[36:39], v[24:27], v[188:191], v[36:39]
v_mfma_f32_16x16x32_bf16 v[32:35], v[26:29], v[192:195], v[32:35]
v_mfma_f32_16x16x32_bf16 v[36:39], v[24:27], v[192:195], v[36:39]
s_waitcnt vmcnt(17)
v_mfma_f32_16x16x32_bf16 v[32:35], v[26:29], v[196:199], v[32:35]
v_mfma_f32_16x16x32_bf16 v[36:39], v[24:27], v[196:199], v[36:39]
v_mfma_f32_16x16x32_bf16 v[32:35], v[26:29], v[200:203], v[32:35]
v_mfma_f32_16x16x32_bf16 v[36:39], v[24:27], v[200:203], v[36:39]
v_mfma_f32_16x16x32_bf16 v[32:35], v[26:29], v[204:207], v[32:35]
v_mfma_f32_16x16x32_bf16 v[36:39], v[24:27], v[204:207], v[36:39]
v_mfma_f32_16x16x32_bf16 v[32:35], v[26:29], v[208:211], v[32:35]
v_mfma_f32_16x16x32_bf16 v[36:39], v[24:27], v[208:211], v[36:39]
s_waitcnt vmcnt(13)
v_mfma_f32_16x16x32_bf16 v[40:43], v[26:29], v[212:215], 0
v_mfma_f32_16x16x32_bf16 v[44:47], v[24:27], v[212:215], 0
v_mfma_f32_16x16x32_bf16 v[40:43], v[26:29], v[216:219], v[40:43]
v_mfma_f32_16x16x32_bf16 v[44:47], v[24:27], v[216:219], v[44:47]
v_mfma_f32_16x16x32_bf16 v[40:43], v[26:29], v[220:223], v[40:43]
v_mfma_f32_16x16x32_bf16 v[44:47], v[24:27], v[220:223], v[44:47]
v_mfma_f32_16x16x32_bf16 v[40:43], v[26:29], v[224:227], v[40:43]
v_mfma_f32_16x16x32_bf16 v[44:47], v[24:27], v[224:227], v[44:47]
s_waitcnt vmcnt(9)
v_mfma_f32_16x16x32_bf16 v[40:43], v[26:29], v[228:231], v[40:43]
v_mfma_f32_16x16x32_bf16 v[44:47], v[24:27], v[228:231], v[44:47]
v_mfma_f32_16x16x32_bf16 v[40:43], v[26:29], v[232:235], v[40:43]
v_mfma_f32_16x16x32_bf16 v[44:47], v[24:27], v[232:235], v[44:47]
v_mfma_f32_16x16x32_bf16 v[40:43], v[26:29], v[236:239], v[40:43]
v_mfma_f32_16x16x32_bf16 v[44:47], v[24:27], v[236:239], v[44:47]
v_mfma_f32_16x16x32_bf16 v[40:43], v[26:29], v[240:243], v[40:43]
v_mfma_f32_16x16x32_bf16 v[44:47], v[24:27], v[240:243], v[44:47]
s_waitcnt vmcnt(5)
v_mfma_f32_16x16x32_bf16 v[40:43], v[26:29], v[244:247], v[40:43]
v_mfma_f32_16x16x32_bf16 v[44:47], v[24:27], v[244:247], v[44:47]
v_mfma_f32_16x16x32_bf16 v[40:43], v[26:29], v[248:251], v[40:43]
v_mfma_f32_16x16x32_bf16 v[44:47], v[24:27], v[248:251], v[44:47]
v_mfma_f32_16x16x32_bf16 v[40:43], v[26:29], v[124:127], v[40:43]
v_mfma_f32_16x16x32_bf16 v[44:47], v[24:27], v[124:127], v[44:47]
v_mfma_f32_16x16x32_bf16 v[40:43], v[26:29], v[128:131], v[40:43]
v_mfma_f32_16x16x32_bf16 v[44:47], v[24:27], v[128:131], v[44:47]
s_waitcnt vmcnt(1)
v_mfma_f32_16x16x32_bf16 v[40:43], v[26:29], v[132:135], v[40:43]
v_mfma_f32_16x16x32_bf16 v[44:47], v[24:27], v[132:135], v[44:47]
v_mfma_f32_16x16x32_bf16 v[40:43], v[26:29], v[136:139], v[40:43]
v_mfma_f32_16x16x32_bf16 v[44:47], v[24:27], v[136:139], v[44:47]
v_mfma_f32_16x16x32_bf16 v[40:43], v[26:29], v[140:143], v[40:43]
v_mfma_f32_16x16x32_bf16 v[44:47], v[24:27], v[140:143], v[44:47]
v_mfma_f32_16x16x32_bf16 v[40:43], v[26:29], v[144:147], v[40:43]
v_mfma_f32_16x16x32_bf16 v[44:47], v[24:27], v[144:147], v[44:47]
s_lshl_b32 s48, s40, 11
s_add_u32 s48, s48, 155648
v_add_u32 v5, s48, v18
s_lshl_b32 s48, s40, 10
s_add_u32 s48, s48, 135168
v_add_u32 v6, s48, v18
s_waitcnt vmcnt(0)
ds_write_b128 v6, v[20:23]
v_cvt_pk_bf16_f32 v32, v32, v33
v_cvt_pk_bf16_f32 v33, v34, v35
v_cvt_pk_bf16_f32 v34, v36, v37
v_cvt_pk_bf16_f32 v35, v38, v39
ds_write_b128 v5, v[32:35] offset:0
v_cvt_pk_bf16_f32 v40, v40, v41
v_cvt_pk_bf16_f32 v41, v42, v43
v_cvt_pk_bf16_f32 v42, v44, v45
v_cvt_pk_bf16_f32 v43, v46, v47
ds_write_b128 v5, v[40:43] offset:1024
s_lshl_b32 s48, s43, 11
s_add_u32 s48, s48, 155648
v_add_u32 v5, s48, v18
s_lshl_b32 s48, s43, 10
s_add_u32 s48, s48, 135168
v_add_u32 v6, s48, v18
s_waitcnt lgkmcnt(0)
s_barrier
ds_read_b128 v[20:23], v6 offset:0
ds_read_b128 v[24:27], v6 offset:2048
ds_read_b128 v[28:31], v5 offset:0
ds_read_b128 v[32:35], v5 offset:1024
ds_read_b128 v[36:39], v5 offset:4096
ds_read_b128 v[40:43], v5 offset:5120
s_waitcnt lgkmcnt(4)
v_mfma_f32_16x16x32_bf16 v[148:151], v[20:23], v[60:63], 0
v_mfma_f32_16x16x32_bf16 v[152:155], v[20:23], v[68:71], 0
v_mfma_f32_16x16x32_bf16 v[156:159], v[20:23], v[76:79], 0
v_mfma_f32_16x16x32_bf16 v[160:163], v[20:23], v[84:87], 0
v_mfma_f32_16x16x32_bf16 v[148:151], v[24:27], v[92:95], v[148:151]
v_mfma_f32_16x16x32_bf16 v[152:155], v[24:27], v[100:103], v[152:155]
v_mfma_f32_16x16x32_bf16 v[156:159], v[24:27], v[108:111], v[156:159]
v_mfma_f32_16x16x32_bf16 v[160:163], v[24:27], v[116:119], v[160:163]
s_waitcnt lgkmcnt(0)
v_mfma_f32_16x16x32_bf16 v[164:167], v[28:31], v[60:63], 0
v_mfma_f32_16x16x32_bf16 v[168:171], v[32:35], v[60:63], 0
v_mfma_f32_16x16x32_bf16 v[172:175], v[28:31], v[68:71], 0
v_mfma_f32_16x16x32_bf16 v[176:179], v[32:35], v[68:71], 0
v_mfma_f32_16x16x32_bf16 v[180:183], v[28:31], v[76:79], 0
v_mfma_f32_16x16x32_bf16 v[184:187], v[32:35], v[76:79], 0
v_mfma_f32_16x16x32_bf16 v[188:191], v[28:31], v[84:87], 0
v_mfma_f32_16x16x32_bf16 v[192:195], v[32:35], v[84:87], 0
v_mfma_f32_16x16x32_bf16 v[164:167], v[36:39], v[92:95], v[164:167]
v_mfma_f32_16x16x32_bf16 v[168:171], v[40:43], v[92:95], v[168:171]
v_mfma_f32_16x16x32_bf16 v[172:175], v[36:39], v[100:103], v[172:175]
v_mfma_f32_16x16x32_bf16 v[176:179], v[40:43], v[100:103], v[176:179]
v_mfma_f32_16x16x32_bf16 v[180:183], v[36:39], v[108:111], v[180:183]
v_mfma_f32_16x16x32_bf16 v[184:187], v[40:43], v[108:111], v[184:187]
v_mfma_f32_16x16x32_bf16 v[188:191], v[36:39], v[116:119], v[188:191]
v_mfma_f32_16x16x32_bf16 v[192:195], v[40:43], v[116:119], v[192:195]
v_add_f32 v48, v148, v149
v_add_f32 v150, v150, v151
v_add_f32 v48, v48, v150
v_add_f32 v49, v152, v153
v_add_f32 v154, v154, v155
v_add_f32 v49, v49, v154
v_add_f32 v50, v156, v157
v_add_f32 v158, v158, v159
v_add_f32 v50, v50, v158
v_add_f32 v51, v160, v161
v_add_f32 v162, v162, v163
v_add_f32 v51, v51, v162
s_nop 1
v_permlane32_swap_b32 v48, v49
v_permlane32_swap_b32 v50, v51
s_nop 0
v_add_f32 v48, v48, v49
v_add_f32 v50, v50, v51
s_nop 1
v_permlane16_swap_b32 v48, v50
s_nop 0
v_add_f32 v48, v48, v50
v_add_f32 v48, 0x358637bd, v48
v_rcp_f32 v48, v48
s_nop 0
v_mov_b32 v50, v48
s_nop 1
v_permlane16_swap_b32 v48, v50
s_nop 0
v_mov_b32 v49, v48
v_mov_b32 v51, v50
s_nop 1
v_permlane32_swap_b32 v48, v49
v_permlane32_swap_b32 v50, v51
s_nop 0
s_lshl_b32 s48, s41, 3
s_lshl_b32 s49, s44, 2
s_add_u32 s48, s48, s49
s_lshl_b32 s48, s48, 5
s_add_u32 s48, s48, s45
s_lshl_b32 s48, s48, 10
s_add_u32 s48, s48, 4194304
s_add_u32 s49, s48, 32768
s_add_u32 s50, s48, 65536
s_add_u32 s51, s48, 98304
s_lshl_b32 s52, s41, 2
s_add_u32 s52, s52, s44
s_lshl_b32 s52, s52, 7
s_add_u32 s52, s52, 14155776
s_cmp_eq_u32 s46, 0
s_cbranch_scc1 slow_26
v_pk_mul_f32 v[164:165], v[164:165], v[48:49] op_sel:[0,0] op_sel_hi:[1,0]
v_pk_mul_f32 v[166:167], v[166:167], v[48:49] op_sel:[0,0] op_sel_hi:[1,0]
v_pk_mul_f32 v[168:169], v[168:169], v[48:49] op_sel:[0,0] op_sel_hi:[1,0]
v_pk_mul_f32 v[170:171], v[170:171], v[48:49] op_sel:[0,0] op_sel_hi:[1,0]
v_cvt_pk_bf16_f32 v164, v164, v165
v_cvt_pk_bf16_f32 v165, v166, v167
v_cvt_pk_bf16_f32 v166, v168, v169
v_cvt_pk_bf16_f32 v167, v170, v171
buffer_store_dwordx4 v[164:167], v18, s[32:35], s48 offen
v_pk_mul_f32 v[172:173], v[172:173], v[48:49] op_sel:[0,1] op_sel_hi:[1,1]
v_pk_mul_f32 v[174:175], v[174:175], v[48:49] op_sel:[0,1] op_sel_hi:[1,1]
v_pk_mul_f32 v[176:177], v[176:177], v[48:49] op_sel:[0,1] op_sel_hi:[1,1]
v_pk_mul_f32 v[178:179], v[178:179], v[48:49] op_sel:[0,1] op_sel_hi:[1,1]
v_cvt_pk_bf16_f32 v172, v172, v173
v_cvt_pk_bf16_f32 v173, v174, v175
v_cvt_pk_bf16_f32 v174, v176, v177
v_cvt_pk_bf16_f32 v175, v178, v179
buffer_store_dwordx4 v[172:175], v18, s[32:35], s49 offen
v_pk_mul_f32 v[180:181], v[180:181], v[50:51] op_sel:[0,0] op_sel_hi:[1,0]
v_pk_mul_f32 v[182:183], v[182:183], v[50:51] op_sel:[0,0] op_sel_hi:[1,0]
v_pk_mul_f32 v[184:185], v[184:185], v[50:51] op_sel:[0,0] op_sel_hi:[1,0]
v_pk_mul_f32 v[186:187], v[186:187], v[50:51] op_sel:[0,0] op_sel_hi:[1,0]
v_cvt_pk_bf16_f32 v180, v180, v181
v_cvt_pk_bf16_f32 v181, v182, v183
v_cvt_pk_bf16_f32 v182, v184, v185
v_cvt_pk_bf16_f32 v183, v186, v187
buffer_store_dwordx4 v[180:183], v18, s[32:35], s50 offen
v_pk_mul_f32 v[188:189], v[188:189], v[50:51] op_sel:[0,1] op_sel_hi:[1,1]
v_pk_mul_f32 v[190:191], v[190:191], v[50:51] op_sel:[0,1] op_sel_hi:[1,1]
v_pk_mul_f32 v[192:193], v[192:193], v[50:51] op_sel:[0,1] op_sel_hi:[1,1]
v_pk_mul_f32 v[194:195], v[194:195], v[50:51] op_sel:[0,1] op_sel_hi:[1,1]
v_cvt_pk_bf16_f32 v188, v188, v189
v_cvt_pk_bf16_f32 v189, v190, v191
v_cvt_pk_bf16_f32 v190, v192, v193
v_cvt_pk_bf16_f32 v191, v194, v195
buffer_store_dwordx4 v[188:191], v18, s[32:35], s51 offen
s_waitcnt vmcnt(0)
s_lshl_b32 s62, s45, 2
v_mov_b32 v4, s62
v_mov_b32 v5, 4
s_mov_b64 exec, 1
buffer_store_dword v5, v4, s[32:35], s52 offen
s_mov_b64 exec, -1
back_27:
s_lshl_b32 s48, s41, 3
s_lshl_b32 s49, s40, 1
s_add_u32 s48, s48, s49
s_lshl_b32 s48, s48, 15
s_lshl_b32 s49, s42, 11
s_add_u32 s48, s48, s49
s_add_u32 s49, s48, 32768
buffer_load_dwordx4 v[88:91], v18, s[32:35], s48 offen offset:0 sc1
buffer_load_dwordx4 v[92:95], v18, s[32:35], s48 offen offset:1024 sc1
buffer_load_dwordx4 v[96:99], v18, s[32:35], s49 offen offset:0 sc1
buffer_load_dwordx4 v[100:103], v18, s[32:35], s49 offen offset:1024 sc1
v_lshrrev_b32 v4, 2, v2
v_and_b32 v5, 3, v0
v_lshl_add_u32 v6, v3, 3, v4
v_lshlrev_b32 v6, 7, v6
v_lshl_add_u32 v6, v5, 3, v6
v_lshrrev_b32 v7, 1, v4
v_and_b32 v8, 1, v3
v_lshl_add_u32 v7, v8, 1, v7
v_lshl_add_u32 v14, v7, 5, v6
v_xor_b32 v15, 32, v14
v_xor_b32 v16, 64, v14
v_xor_b32 v17, 96, v14
s_lshl_b32 s48, s41, 3
s_lshl_b32 s49, s40, 1
s_add_u32 s56, s48, s49
s_lshl_b32 s48, s56, 15
s_add_u32 s48, s48, 4194304
v_add_u32 v12, s48, v18
v_add_u32 v13, 32768, v12
v_mov_b32 v20, 0
v_mov_b32 v21, 0
v_mov_b32 v22, 0
v_mov_b32 v23, 0
v_mov_b32 v24, 0
v_mov_b32 v25, 0
v_mov_b32 v26, 0
v_mov_b32 v27, 0
v_mov_b32 v28, 0
v_mov_b32 v29, 0
v_mov_b32 v30, 0
v_mov_b32 v31, 0
v_mov_b32 v32, 0
v_mov_b32 v33, 0
v_mov_b32 v34, 0
v_mov_b32 v35, 0
v_mov_b32 v36, 0
v_mov_b32 v37, 0
v_mov_b32 v38, 0
v_mov_b32 v39, 0
v_mov_b32 v40, 0
v_mov_b32 v41, 0
v_mov_b32 v42, 0
v_mov_b32 v43, 0
v_mov_b32 v44, 0
v_mov_b32 v45, 0
v_mov_b32 v46, 0
v_mov_b32 v47, 0
v_mov_b32 v48, 0
v_mov_b32 v49, 0
v_mov_b32 v50, 0
v_mov_b32 v51, 0
s_lshl_b32 s57, s47, 11
s_lshl_b32 s52, s41, 2
s_add_u32 s52, s52, s44
s_lshl_b32 s52, s52, 7
s_add_u32 s52, s52, 14155776
v_and_b32 v4, 31, v0
v_lshlrev_b32 v4, 2, v4
buffer_load_dword v5, v4, s[32:35], s52 offen sc1
s_barrier
ds_read_b64_tr_b16 v[212:213], v14 offset:0
ds_read_b64_tr_b16 v[214:215], v14 offset:512
ds_read_b64_tr_b16 v[216:217], v15 offset:0
ds_read_b64_tr_b16 v[218:219], v15 offset:512
ds_read_b64_tr_b16 v[220:221], v16 offset:0
ds_read_b64_tr_b16 v[222:223], v16 offset:512
ds_read_b64_tr_b16 v[224:225], v17 offset:0
ds_read_b64_tr_b16 v[226:227], v17 offset:512
s_mov_b32 s63, 0
s_waitcnt vmcnt(0)
poll_28:
v_cmp_gt_u32 vcc, 4, v5
s_cbranch_vccz polled_29
buffer_load_dword v5, v4, s[32:35], s52 offen sc1
s_add_u32 s63, s63, 1
s_cmp_lt_u32 s63, 0x80000
s_waitcnt vmcnt(0)
s_cbranch_scc1 poll_28
polled_29:
buffer_load_dwordx4 v[148:151], v12, s[32:35], s57 offen sc1
buffer_load_dwordx4 v[152:155], v13, s[32:35], s57 offen sc1
buffer_load_dwordx4 v[156:159], v12, s[32:35], s57 offen offset:1024 sc1
buffer_load_dwordx4 v[160:163], v13, s[32:35], s57 offen offset:1024 sc1
s_add_u32 s57, s57, 2048
s_and_b32 s57, s57, 0x7fff
buffer_load_dwordx4 v[164:167], v12, s[32:35], s57 offen sc1
buffer_load_dwordx4 v[168:171], v13, s[32:35], s57 offen sc1
buffer_load_dwordx4 v[172:175], v12, s[32:35], s57 offen offset:1024 sc1
buffer_load_dwordx4 v[176:179], v13, s[32:35], s57 offen offset:1024 sc1
s_add_u32 s57, s57, 2048
s_and_b32 s57, s57, 0x7fff
buffer_load_dwordx4 v[180:183], v12, s[32:35], s57 offen sc1
buffer_load_dwordx4 v[184:187], v13, s[32:35], s57 offen sc1
buffer_load_dwordx4 v[188:191], v12, s[32:35], s57 offen offset:1024 sc1
buffer_load_dwordx4 v[192:195], v13, s[32:35], s57 offen offset:1024 sc1
s_add_u32 s57, s57, 2048
s_and_b32 s57, s57, 0x7fff
s_waitcnt vmcnt(10) lgkmcnt(0)
v_mfma_f32_16x16x32_bf16 v[20:23], v[212:215], v[148:151], v[20:23]
ds_read_b64_tr_b16 v[228:229], v14 offset:4096
ds_read_b64_tr_b16 v[230:231], v14 offset:4608
v_mfma_f32_16x16x32_bf16 v[36:39], v[212:215], v[152:155], v[36:39]
ds_read_b64_tr_b16 v[232:233], v15 offset:4096
v_mfma_f32_16x16x32_bf16 v[24:27], v[216:219], v[148:151], v[24:27]
ds_read_b64_tr_b16 v[234:235], v15 offset:4608
ds_read_b64_tr_b16 v[236:237], v16 offset:4096
v_mfma_f32_16x16x32_bf16 v[40:43], v[216:219], v[152:155], v[40:43]
ds_read_b64_tr_b16 v[238:239], v16 offset:4608
v_mfma_f32_16x16x32_bf16 v[28:31], v[220:223], v[148:151], v[28:31]
ds_read_b64_tr_b16 v[240:241], v17 offset:4096
ds_read_b64_tr_b16 v[242:243], v17 offset:4608
v_mfma_f32_16x16x32_bf16 v[44:47], v[220:223], v[152:155], v[44:47]
buffer_load_dwordx4 v[196:199], v12, s[32:35], s57 offen sc1
v_mfma_f32_16x16x32_bf16 v[32:35], v[224:227], v[148:151], v[32:35]
buffer_load_dwordx4 v[200:203], v13, s[32:35], s57 offen sc1
buffer_load_dwordx4 v[204:207], v12, s[32:35], s57 offen offset:1024 sc1
v_mfma_f32_16x16x32_bf16 v[48:51], v[224:227], v[152:155], v[48:51]
buffer_load_dwordx4 v[208:211], v13, s[32:35], s57 offen offset:1024 sc1
s_add_u32 s57, s57, 2048
s_and_b32 s57, s57, 0x7fff
s_waitcnt vmcnt(12) lgkmcnt(0)
v_mfma_f32_16x16x32_bf16 v[20:23], v[228:231], v[156:159], v[20:23]
ds_read_b64_tr_b16 v[212:213], v14 offset:8192
v_mfma_f32_16x16x32_bf16 v[36:39], v[228:231], v[160:163], v[36:39]
ds_read_b64_tr_b16 v[214:215], v14 offset:8704
v_mfma_f32_16x16x32_bf16 v[24:27], v[232:235], v[156:159], v[24:27]
ds_read_b64_tr_b16 v[216:217], v15 offset:8192
v_mfma_f32_16x16x32_bf16 v[40:43], v[232:235], v[160:163], v[40:43]
ds_read_b64_tr_b16 v[218:219], v15 offset:8704
v_mfma_f32_16x16x32_bf16 v[28:31], v[236:239], v[156:159], v[28:31]
ds_read_b64_tr_b16 v[220:221], v16 offset:8192
v_mfma_f32_16x16x32_bf16 v[44:47], v[236:239], v[160:163], v[44:47]
ds_read_b64_tr_b16 v[222:223], v16 offset:8704
v_mfma_f32_16x16x32_bf16 v[32:35], v[240:243], v[156:159], v[32:35]
ds_read_b64_tr_b16 v[224:225], v17 offset:8192
v_mfma_f32_16x16x32_bf16 v[48:51], v[240:243], v[160:163], v[48:51]
ds_read_b64_tr_b16 v[226:227], v17 offset:8704
s_waitcnt vmcnt(10) lgkmcnt(0)
v_mfma_f32_16x16x32_bf16 v[20:23], v[212:215], v[164:167], v[20:23]
ds_read_b64_tr_b16 v[228:229], v14 offset:12288
ds_read_b64_tr_b16 v[230:231], v14 offset:12800
v_mfma_f32_16x16x32_bf16 v[36:39], v[212:215], v[168:171], v[36:39]
ds_read_b64_tr_b16 v[232:233], v15 offset:12288
v_mfma_f32_16x16x32_bf16 v[24:27], v[216:219], v[164:167], v[24:27]
ds_read_b64_tr_b16 v[234:235], v15 offset:12800
ds_read_b64_tr_b16 v[236:237], v16 offset:12288
v_mfma_f32_16x16x32_bf16 v[40:43], v[216:219], v[168:171], v[40:43]
ds_read_b64_tr_b16 v[238:239], v16 offset:12800
v_mfma_f32_16x16x32_bf16 v[28:31], v[220:223], v[164:167], v[28:31]
ds_read_b64_tr_b16 v[240:241], v17 offset:12288
ds_read_b64_tr_b16 v[242:243], v17 offset:12800
v_mfma_f32_16x16x32_bf16 v[44:47], v[220:223], v[168:171], v[44:47]
buffer_load_dwordx4 v[148:151], v12, s[32:35], s57 offen sc1
v_mfma_f32_16x16x32_bf16 v[32:35], v[224:227], v[164:167], v[32:35]
buffer_load_dwordx4 v[152:155], v13, s[32:35], s57 offen sc1
buffer_load_dwordx4 v[156:159], v12, s[32:35], s57 offen offset:1024 sc1
v_mfma_f32_16x16x32_bf16 v[48:51], v[224:227], v[168:171], v[48:51]
buffer_load_dwordx4 v[160:163], v13, s[32:35], s57 offen offset:1024 sc1
s_add_u32 s57, s57, 2048
s_and_b32 s57, s57, 0x7fff
s_waitcnt vmcnt(12) lgkmcnt(0)
v_mfma_f32_16x16x32_bf16 v[20:23], v[228:231], v[172:175], v[20:23]
ds_read_b64_tr_b16 v[212:213], v14 offset:16384
v_mfma_f32_16x16x32_bf16 v[36:39], v[228:231], v[176:179], v[36:39]
ds_read_b64_tr_b16 v[214:215], v14 offset:16896
v_mfma_f32_16x16x32_bf16 v[24:27], v[232:235], v[172:175], v[24:27]
ds_read_b64_tr_b16 v[216:217], v15 offset:16384
v_mfma_f32_16x16x32_bf16 v[40:43], v[232:235], v[176:179], v[40:43]
ds_read_b64_tr_b16 v[218:219], v15 offset:16896
v_mfma_f32_16x16x32_bf16 v[28:31], v[236:239], v[172:175], v[28:31]
ds_read_b64_tr_b16 v[220:221], v16 offset:16384
v_mfma_f32_16x16x32_bf16 v[44:47], v[236:239], v[176:179], v[44:47]
ds_read_b64_tr_b16 v[222:223], v16 offset:16896
v_mfma_f32_16x16x32_bf16 v[32:35], v[240:243], v[172:175], v[32:35]
ds_read_b64_tr_b16 v[224:225], v17 offset:16384
v_mfma_f32_16x16x32_bf16 v[48:51], v[240:243], v[176:179], v[48:51]
ds_read_b64_tr_b16 v[226:227], v17 offset:16896
s_waitcnt vmcnt(10) lgkmcnt(0)
v_mfma_f32_16x16x32_bf16 v[20:23], v[212:215], v[180:183], v[20:23]
ds_read_b64_tr_b16 v[228:229], v14 offset:20480
ds_read_b64_tr_b16 v[230:231], v14 offset:20992
v_mfma_f32_16x16x32_bf16 v[36:39], v[212:215], v[184:187], v[36:39]
ds_read_b64_tr_b16 v[232:233], v15 offset:20480
v_mfma_f32_16x16x32_bf16 v[24:27], v[216:219], v[180:183], v[24:27]
ds_read_b64_tr_b16 v[234:235], v15 offset:20992
ds_read_b64_tr_b16 v[236:237], v16 offset:20480
v_mfma_f32_16x16x32_bf16 v[40:43], v[216:219], v[184:187], v[40:43]
ds_read_b64_tr_b16 v[238:239], v16 offset:20992
v_mfma_f32_16x16x32_bf16 v[28:31], v[220:223], v[180:183], v[28:31]
ds_read_b64_tr_b16 v[240:241], v17 offset:20480
ds_read_b64_tr_b16 v[242:243], v17 offset:20992
v_mfma_f32_16x16x32_bf16 v[44:47], v[220:223], v[184:187], v[44:47]
buffer_load_dwordx4 v[164:167], v12, s[32:35], s57 offen sc1
v_mfma_f32_16x16x32_bf16 v[32:35], v[224:227], v[180:183], v[32:35]
buffer_load_dwordx4 v[168:171], v13, s[32:35], s57 offen sc1
buffer_load_dwordx4 v[172:175], v12, s[32:35], s57 offen offset:1024 sc1
v_mfma_f32_16x16x32_bf16 v[48:51], v[224:227], v[184:187], v[48:51]
buffer_load_dwordx4 v[176:179], v13, s[32:35], s57 offen offset:1024 sc1
s_add_u32 s57, s57, 2048
s_and_b32 s57, s57, 0x7fff
s_waitcnt vmcnt(12) lgkmcnt(0)
v_mfma_f32_16x16x32_bf16 v[20:23], v[228:231], v[188:191], v[20:23]
ds_read_b64_tr_b16 v[212:213], v14 offset:24576
v_mfma_f32_16x16x32_bf16 v[36:39], v[228:231], v[192:195], v[36:39]
ds_read_b64_tr_b16 v[214:215], v14 offset:25088
v_mfma_f32_16x16x32_bf16 v[24:27], v[232:235], v[188:191], v[24:27]
ds_read_b64_tr_b16 v[216:217], v15 offset:24576
v_mfma_f32_16x16x32_bf16 v[40:43], v[232:235], v[192:195], v[40:43]
ds_read_b64_tr_b16 v[218:219], v15 offset:25088
v_mfma_f32_16x16x32_bf16 v[28:31], v[236:239], v[188:191], v[28:31]
ds_read_b64_tr_b16 v[220:221], v16 offset:24576
v_mfma_f32_16x16x32_bf16 v[44:47], v[236:239], v[192:195], v[44:47]
ds_read_b64_tr_b16 v[222:223], v16 offset:25088
v_mfma_f32_16x16x32_bf16 v[32:35], v[240:243], v[188:191], v[32:35]
ds_read_b64_tr_b16 v[224:225], v17 offset:24576
v_mfma_f32_16x16x32_bf16 v[48:51], v[240:243], v[192:195], v[48:51]
ds_read_b64_tr_b16 v[226:227], v17 offset:25088
s_waitcnt vmcnt(10) lgkmcnt(0)
v_mfma_f32_16x16x32_bf16 v[20:23], v[212:215], v[196:199], v[20:23]
ds_read_b64_tr_b16 v[228:229], v14 offset:28672
ds_read_b64_tr_b16 v[230:231], v14 offset:29184
v_mfma_f32_16x16x32_bf16 v[36:39], v[212:215], v[200:203], v[36:39]
ds_read_b64_tr_b16 v[232:233], v15 offset:28672
v_mfma_f32_16x16x32_bf16 v[24:27], v[216:219], v[196:199], v[24:27]
ds_read_b64_tr_b16 v[234:235], v15 offset:29184
ds_read_b64_tr_b16 v[236:237], v16 offset:28672
v_mfma_f32_16x16x32_bf16 v[40:43], v[216:219], v[200:203], v[40:43]
ds_read_b64_tr_b16 v[238:239], v16 offset:29184
v_mfma_f32_16x16x32_bf16 v[28:31], v[220:223], v[196:199], v[28:31]
ds_read_b64_tr_b16 v[240:241], v17 offset:28672
ds_read_b64_tr_b16 v[242:243], v17 offset:29184
v_mfma_f32_16x16x32_bf16 v[44:47], v[220:223], v[200:203], v[44:47]
buffer_load_dwordx4 v[180:183], v12, s[32:35], s57 offen sc1
v_mfma_f32_16x16x32_bf16 v[32:35], v[224:227], v[196:199], v[32:35]
buffer_load_dwordx4 v[184:187], v13, s[32:35], s57 offen sc1
buffer_load_dwordx4 v[188:191], v12, s[32:35], s57 offen offset:1024 sc1
v_mfma_f32_16x16x32_bf16 v[48:51], v[224:227], v[200:203], v[48:51]
buffer_load_dwordx4 v[192:195], v13, s[32:35], s57 offen offset:1024 sc1
s_add_u32 s57, s57, 2048
s_and_b32 s57, s57, 0x7fff
s_waitcnt vmcnt(12) lgkmcnt(0)
v_mfma_f32_16x16x32_bf16 v[20:23], v[228:231], v[204:207], v[20:23]
ds_read_b64_tr_b16 v[212:213], v14 offset:32768
v_mfma_f32_16x16x32_bf16 v[36:39], v[228:231], v[208:211], v[36:39]
ds_read_b64_tr_b16 v[214:215], v14 offset:33280
v_mfma_f32_16x16x32_bf16 v[24:27], v[232:235], v[204:207], v[24:27]
ds_read_b64_tr_b16 v[216:217], v15 offset:32768
v_mfma_f32_16x16x32_bf16 v[40:43], v[232:235], v[208:211], v[40:43]
ds_read_b64_tr_b16 v[218:219], v15 offset:33280
v_mfma_f32_16x16x32_bf16 v[28:31], v[236:239], v[204:207], v[28:31]
ds_read_b64_tr_b16 v[220:221], v16 offset:32768
v_mfma_f32_16x16x32_bf16 v[44:47], v[236:239], v[208:211], v[44:47]
ds_read_b64_tr_b16 v[222:223], v16 offset:33280
v_mfma_f32_16x16x32_bf16 v[32:35], v[240:243], v[204:207], v[32:35]
ds_read_b64_tr_b16 v[224:225], v17 offset:32768
v_mfma_f32_16x16x32_bf16 v[48:51], v[240:243], v[208:211], v[48:51]
ds_read_b64_tr_b16 v[226:227], v17 offset:33280
s_waitcnt vmcnt(10) lgkmcnt(0)
v_mfma_f32_16x16x32_bf16 v[20:23], v[212:215], v[148:151], v[20:23]
ds_read_b64_tr_b16 v[228:229], v14 offset:36864
ds_read_b64_tr_b16 v[230:231], v14 offset:37376
v_mfma_f32_16x16x32_bf16 v[36:39], v[212:215], v[152:155], v[36:39]
ds_read_b64_tr_b16 v[232:233], v15 offset:36864
v_mfma_f32_16x16x32_bf16 v[24:27], v[216:219], v[148:151], v[24:27]
ds_read_b64_tr_b16 v[234:235], v15 offset:37376
ds_read_b64_tr_b16 v[236:237], v16 offset:36864
v_mfma_f32_16x16x32_bf16 v[40:43], v[216:219], v[152:155], v[40:43]
ds_read_b64_tr_b16 v[238:239], v16 offset:37376
v_mfma_f32_16x16x32_bf16 v[28:31], v[220:223], v[148:151], v[28:31]
ds_read_b64_tr_b16 v[240:241], v17 offset:36864
ds_read_b64_tr_b16 v[242:243], v17 offset:37376
v_mfma_f32_16x16x32_bf16 v[44:47], v[220:223], v[152:155], v[44:47]
buffer_load_dwordx4 v[196:199], v12, s[32:35], s57 offen sc1
v_mfma_f32_16x16x32_bf16 v[32:35], v[224:227], v[148:151], v[32:35]
buffer_load_dwordx4 v[200:203], v13, s[32:35], s57 offen sc1
buffer_load_dwordx4 v[204:207], v12, s[32:35], s57 offen offset:1024 sc1
v_mfma_f32_16x16x32_bf16 v[48:51], v[224:227], v[152:155], v[48:51]
buffer_load_dwordx4 v[208:211], v13, s[32:35], s57 offen offset:1024 sc1
s_add_u32 s57, s57, 2048
s_and_b32 s57, s57, 0x7fff
s_waitcnt vmcnt(12) lgkmcnt(0)
v_mfma_f32_16x16x32_bf16 v[20:23], v[228:231], v[156:159], v[20:23]
ds_read_b64_tr_b16 v[212:213], v14 offset:40960
v_mfma_f32_16x16x32_bf16 v[36:39], v[228:231], v[160:163], v[36:39]
ds_read_b64_tr_b16 v[214:215], v14 offset:41472
v_mfma_f32_16x16x32_bf16 v[24:27], v[232:235], v[156:159], v[24:27]
ds_read_b64_tr_b16 v[216:217], v15 offset:40960
v_mfma_f32_16x16x32_bf16 v[40:43], v[232:235], v[160:163], v[40:43]
ds_read_b64_tr_b16 v[218:219], v15 offset:41472
v_mfma_f32_16x16x32_bf16 v[28:31], v[236:239], v[156:159], v[28:31]
ds_read_b64_tr_b16 v[220:221], v16 offset:40960
v_mfma_f32_16x16x32_bf16 v[44:47], v[236:239], v[160:163], v[44:47]
ds_read_b64_tr_b16 v[222:223], v16 offset:41472
v_mfma_f32_16x16x32_bf16 v[32:35], v[240:243], v[156:159], v[32:35]
ds_read_b64_tr_b16 v[224:225], v17 offset:40960
v_mfma_f32_16x16x32_bf16 v[48:51], v[240:243], v[160:163], v[48:51]
ds_read_b64_tr_b16 v[226:227], v17 offset:41472
s_waitcnt vmcnt(10) lgkmcnt(0)
v_mfma_f32_16x16x32_bf16 v[20:23], v[212:215], v[164:167], v[20:23]
ds_read_b64_tr_b16 v[228:229], v14 offset:45056
ds_read_b64_tr_b16 v[230:231], v14 offset:45568
v_mfma_f32_16x16x32_bf16 v[36:39], v[212:215], v[168:171], v[36:39]
ds_read_b64_tr_b16 v[232:233], v15 offset:45056
v_mfma_f32_16x16x32_bf16 v[24:27], v[216:219], v[164:167], v[24:27]
ds_read_b64_tr_b16 v[234:235], v15 offset:45568
ds_read_b64_tr_b16 v[236:237], v16 offset:45056
v_mfma_f32_16x16x32_bf16 v[40:43], v[216:219], v[168:171], v[40:43]
ds_read_b64_tr_b16 v[238:239], v16 offset:45568
v_mfma_f32_16x16x32_bf16 v[28:31], v[220:223], v[164:167], v[28:31]
ds_read_b64_tr_b16 v[240:241], v17 offset:45056
ds_read_b64_tr_b16 v[242:243], v17 offset:45568
v_mfma_f32_16x16x32_bf16 v[44:47], v[220:223], v[168:171], v[44:47]
buffer_load_dwordx4 v[148:151], v12, s[32:35], s57 offen sc1
v_mfma_f32_16x16x32_bf16 v[32:35], v[224:227], v[164:167], v[32:35]
buffer_load_dwordx4 v[152:155], v13, s[32:35], s57 offen sc1
buffer_load_dwordx4 v[156:159], v12, s[32:35], s57 offen offset:1024 sc1
v_mfma_f32_16x16x32_bf16 v[48:51], v[224:227], v[168:171], v[48:51]
buffer_load_dwordx4 v[160:163], v13, s[32:35], s57 offen offset:1024 sc1
s_add_u32 s57, s57, 2048
s_and_b32 s57, s57, 0x7fff
s_waitcnt vmcnt(12) lgkmcnt(0)
v_mfma_f32_16x16x32_bf16 v[20:23], v[228:231], v[172:175], v[20:23]
ds_read_b64_tr_b16 v[212:213], v14 offset:49152
v_mfma_f32_16x16x32_bf16 v[36:39], v[228:231], v[176:179], v[36:39]
ds_read_b64_tr_b16 v[214:215], v14 offset:49664
v_mfma_f32_16x16x32_bf16 v[24:27], v[232:235], v[172:175], v[24:27]
ds_read_b64_tr_b16 v[216:217], v15 offset:49152
v_mfma_f32_16x16x32_bf16 v[40:43], v[232:235], v[176:179], v[40:43]
ds_read_b64_tr_b16 v[218:219], v15 offset:49664
v_mfma_f32_16x16x32_bf16 v[28:31], v[236:239], v[172:175], v[28:31]
ds_read_b64_tr_b16 v[220:221], v16 offset:49152
v_mfma_f32_16x16x32_bf16 v[44:47], v[236:239], v[176:179], v[44:47]
ds_read_b64_tr_b16 v[222:223], v16 offset:49664
v_mfma_f32_16x16x32_bf16 v[32:35], v[240:243], v[172:175], v[32:35]
ds_read_b64_tr_b16 v[224:225], v17 offset:49152
v_mfma_f32_16x16x32_bf16 v[48:51], v[240:243], v[176:179], v[48:51]
ds_read_b64_tr_b16 v[226:227], v17 offset:49664
s_waitcnt vmcnt(10) lgkmcnt(0)
v_mfma_f32_16x16x32_bf16 v[20:23], v[212:215], v[180:183], v[20:23]
ds_read_b64_tr_b16 v[228:229], v14 offset:53248
ds_read_b64_tr_b16 v[230:231], v14 offset:53760
v_mfma_f32_16x16x32_bf16 v[36:39], v[212:215], v[184:187], v[36:39]
ds_read_b64_tr_b16 v[232:233], v15 offset:53248
v_mfma_f32_16x16x32_bf16 v[24:27], v[216:219], v[180:183], v[24:27]
ds_read_b64_tr_b16 v[234:235], v15 offset:53760
ds_read_b64_tr_b16 v[236:237], v16 offset:53248
v_mfma_f32_16x16x32_bf16 v[40:43], v[216:219], v[184:187], v[40:43]
ds_read_b64_tr_b16 v[238:239], v16 offset:53760
v_mfma_f32_16x16x32_bf16 v[28:31], v[220:223], v[180:183], v[28:31]
ds_read_b64_tr_b16 v[240:241], v17 offset:53248
ds_read_b64_tr_b16 v[242:243], v17 offset:53760
v_mfma_f32_16x16x32_bf16 v[44:47], v[220:223], v[184:187], v[44:47]
buffer_load_dwordx4 v[164:167], v12, s[32:35], s57 offen sc1
v_mfma_f32_16x16x32_bf16 v[32:35], v[224:227], v[180:183], v[32:35]
buffer_load_dwordx4 v[168:171], v13, s[32:35], s57 offen sc1
buffer_load_dwordx4 v[172:175], v12, s[32:35], s57 offen offset:1024 sc1
v_mfma_f32_16x16x32_bf16 v[48:51], v[224:227], v[184:187], v[48:51]
buffer_load_dwordx4 v[176:179], v13, s[32:35], s57 offen offset:1024 sc1
s_add_u32 s57, s57, 2048
s_and_b32 s57, s57, 0x7fff
s_waitcnt vmcnt(12) lgkmcnt(0)
v_mfma_f32_16x16x32_bf16 v[20:23], v[228:231], v[188:191], v[20:23]
ds_read_b64_tr_b16 v[212:213], v14 offset:57344
v_mfma_f32_16x16x32_bf16 v[36:39], v[228:231], v[192:195], v[36:39]
ds_read_b64_tr_b16 v[214:215], v14 offset:57856
v_mfma_f32_16x16x32_bf16 v[24:27], v[232:235], v[188:191], v[24:27]
ds_read_b64_tr_b16 v[216:217], v15 offset:57344
v_mfma_f32_16x16x32_bf16 v[40:43], v[232:235], v[192:195], v[40:43]
ds_read_b64_tr_b16 v[218:219], v15 offset:57856
v_mfma_f32_16x16x32_bf16 v[28:31], v[236:239], v[188:191], v[28:31]
ds_read_b64_tr_b16 v[220:221], v16 offset:57344
v_mfma_f32_16x16x32_bf16 v[44:47], v[236:239], v[192:195], v[44:47]
ds_read_b64_tr_b16 v[222:223], v16 offset:57856
v_mfma_f32_16x16x32_bf16 v[32:35], v[240:243], v[188:191], v[32:35]
ds_read_b64_tr_b16 v[224:225], v17 offset:57344
v_mfma_f32_16x16x32_bf16 v[48:51], v[240:243], v[192:195], v[48:51]
ds_read_b64_tr_b16 v[226:227], v17 offset:57856
s_waitcnt vmcnt(10) lgkmcnt(0)
v_mfma_f32_16x16x32_bf16 v[20:23], v[212:215], v[196:199], v[20:23]
ds_read_b64_tr_b16 v[228:229], v14 offset:61440
ds_read_b64_tr_b16 v[230:231], v14 offset:61952
v_mfma_f32_16x16x32_bf16 v[36:39], v[212:215], v[200:203], v[36:39]
ds_read_b64_tr_b16 v[232:233], v15 offset:61440
v_mfma_f32_16x16x32_bf16 v[24:27], v[216:219], v[196:199], v[24:27]
ds_read_b64_tr_b16 v[234:235], v15 offset:61952
ds_read_b64_tr_b16 v[236:237], v16 offset:61440
v_mfma_f32_16x16x32_bf16 v[40:43], v[216:219], v[200:203], v[40:43]
ds_read_b64_tr_b16 v[238:239], v16 offset:61952
v_mfma_f32_16x16x32_bf16 v[28:31], v[220:223], v[196:199], v[28:31]
ds_read_b64_tr_b16 v[240:241], v17 offset:61440
ds_read_b64_tr_b16 v[242:243], v17 offset:61952
v_mfma_f32_16x16x32_bf16 v[44:47], v[220:223], v[200:203], v[44:47]
buffer_load_dwordx4 v[180:183], v12, s[32:35], s57 offen sc1
v_mfma_f32_16x16x32_bf16 v[32:35], v[224:227], v[196:199], v[32:35]
buffer_load_dwordx4 v[184:187], v13, s[32:35], s57 offen sc1
buffer_load_dwordx4 v[188:191], v12, s[32:35], s57 offen offset:1024 sc1
v_mfma_f32_16x16x32_bf16 v[48:51], v[224:227], v[200:203], v[48:51]
buffer_load_dwordx4 v[192:195], v13, s[32:35], s57 offen offset:1024 sc1
s_add_u32 s57, s57, 2048
s_and_b32 s57, s57, 0x7fff
s_waitcnt vmcnt(12) lgkmcnt(0)
v_add_u32 v14, 0x10000, v14
v_add_u32 v15, 0x10000, v15
v_add_u32 v16, 0x10000, v16
v_add_u32 v17, 0x10000, v17
v_mfma_f32_16x16x32_bf16 v[20:23], v[228:231], v[204:207], v[20:23]
ds_read_b64_tr_b16 v[212:213], v14 offset:0
v_mfma_f32_16x16x32_bf16 v[36:39], v[228:231], v[208:211], v[36:39]
ds_read_b64_tr_b16 v[214:215], v14 offset:512
v_mfma_f32_16x16x32_bf16 v[24:27], v[232:235], v[204:207], v[24:27]
ds_read_b64_tr_b16 v[216:217], v15 offset:0
v_mfma_f32_16x16x32_bf16 v[40:43], v[232:235], v[208:211], v[40:43]
ds_read_b64_tr_b16 v[218:219], v15 offset:512
v_mfma_f32_16x16x32_bf16 v[28:31], v[236:239], v[204:207], v[28:31]
ds_read_b64_tr_b16 v[220:221], v16 offset:0
v_mfma_f32_16x16x32_bf16 v[44:47], v[236:239], v[208:211], v[44:47]
ds_read_b64_tr_b16 v[222:223], v16 offset:512
v_mfma_f32_16x16x32_bf16 v[32:35], v[240:243], v[204:207], v[32:35]
ds_read_b64_tr_b16 v[224:225], v17 offset:0
v_mfma_f32_16x16x32_bf16 v[48:51], v[240:243], v[208:211], v[48:51]
ds_read_b64_tr_b16 v[226:227], v17 offset:512
s_waitcnt vmcnt(10) lgkmcnt(0)
v_mfma_f32_16x16x32_bf16 v[20:23], v[212:215], v[148:151], v[20:23]
ds_read_b64_tr_b16 v[228:229], v14 offset:4096
ds_read_b64_tr_b16 v[230:231], v14 offset:4608
v_mfma_f32_16x16x32_bf16 v[36:39], v[212:215], v[152:155], v[36:39]
ds_read_b64_tr_b16 v[232:233], v15 offset:4096
v_mfma_f32_16x16x32_bf16 v[24:27], v[216:219], v[148:151], v[24:27]
ds_read_b64_tr_b16 v[234:235], v15 offset:4608
ds_read_b64_tr_b16 v[236:237], v16 offset:4096
v_mfma_f32_16x16x32_bf16 v[40:43], v[216:219], v[152:155], v[40:43]
ds_read_b64_tr_b16 v[238:239], v16 offset:4608
v_mfma_f32_16x16x32_bf16 v[28:31], v[220:223], v[148:151], v[28:31]
ds_read_b64_tr_b16 v[240:241], v17 offset:4096
ds_read_b64_tr_b16 v[242:243], v17 offset:4608
v_mfma_f32_16x16x32_bf16 v[44:47], v[220:223], v[152:155], v[44:47]
buffer_load_dwordx4 v[196:199], v12, s[32:35], s57 offen sc1
v_mfma_f32_16x16x32_bf16 v[32:35], v[224:227], v[148:151], v[32:35]
buffer_load_dwordx4 v[200:203], v13, s[32:35], s57 offen sc1
buffer_load_dwordx4 v[204:207], v12, s[32:35], s57 offen offset:1024 sc1
v_mfma_f32_16x16x32_bf16 v[48:51], v[224:227], v[152:155], v[48:51]
buffer_load_dwordx4 v[208:211], v13, s[32:35], s57 offen offset:1024 sc1
s_add_u32 s57, s57, 2048
s_and_b32 s57, s57, 0x7fff
s_waitcnt vmcnt(12) lgkmcnt(0)
v_mfma_f32_16x16x32_bf16 v[20:23], v[228:231], v[156:159], v[20:23]
ds_read_b64_tr_b16 v[212:213], v14 offset:8192
v_mfma_f32_16x16x32_bf16 v[36:39], v[228:231], v[160:163], v[36:39]
ds_read_b64_tr_b16 v[214:215], v14 offset:8704
v_mfma_f32_16x16x32_bf16 v[24:27], v[232:235], v[156:159], v[24:27]
ds_read_b64_tr_b16 v[216:217], v15 offset:8192
v_mfma_f32_16x16x32_bf16 v[40:43], v[232:235], v[160:163], v[40:43]
ds_read_b64_tr_b16 v[218:219], v15 offset:8704
v_mfma_f32_16x16x32_bf16 v[28:31], v[236:239], v[156:159], v[28:31]
ds_read_b64_tr_b16 v[220:221], v16 offset:8192
v_mfma_f32_16x16x32_bf16 v[44:47], v[236:239], v[160:163], v[44:47]
ds_read_b64_tr_b16 v[222:223], v16 offset:8704
v_mfma_f32_16x16x32_bf16 v[32:35], v[240:243], v[156:159], v[32:35]
ds_read_b64_tr_b16 v[224:225], v17 offset:8192
v_mfma_f32_16x16x32_bf16 v[48:51], v[240:243], v[160:163], v[48:51]
ds_read_b64_tr_b16 v[226:227], v17 offset:8704
s_waitcnt vmcnt(10) lgkmcnt(0)
v_mfma_f32_16x16x32_bf16 v[20:23], v[212:215], v[164:167], v[20:23]
ds_read_b64_tr_b16 v[228:229], v14 offset:12288
ds_read_b64_tr_b16 v[230:231], v14 offset:12800
v_mfma_f32_16x16x32_bf16 v[36:39], v[212:215], v[168:171], v[36:39]
ds_read_b64_tr_b16 v[232:233], v15 offset:12288
v_mfma_f32_16x16x32_bf16 v[24:27], v[216:219], v[164:167], v[24:27]
ds_read_b64_tr_b16 v[234:235], v15 offset:12800
ds_read_b64_tr_b16 v[236:237], v16 offset:12288
v_mfma_f32_16x16x32_bf16 v[40:43], v[216:219], v[168:171], v[40:43]
ds_read_b64_tr_b16 v[238:239], v16 offset:12800
v_mfma_f32_16x16x32_bf16 v[28:31], v[220:223], v[164:167], v[28:31]
ds_read_b64_tr_b16 v[240:241], v17 offset:12288
ds_read_b64_tr_b16 v[242:243], v17 offset:12800
v_mfma_f32_16x16x32_bf16 v[44:47], v[220:223], v[168:171], v[44:47]
buffer_load_dwordx4 v[148:151], v12, s[32:35], s57 offen sc1
v_mfma_f32_16x16x32_bf16 v[32:35], v[224:227], v[164:167], v[32:35]
buffer_load_dwordx4 v[152:155], v13, s[32:35], s57 offen sc1
buffer_load_dwordx4 v[156:159], v12, s[32:35], s57 offen offset:1024 sc1
v_mfma_f32_16x16x32_bf16 v[48:51], v[224:227], v[168:171], v[48:51]
buffer_load_dwordx4 v[160:163], v13, s[32:35], s57 offen offset:1024 sc1
s_add_u32 s57, s57, 2048
s_and_b32 s57, s57, 0x7fff
s_waitcnt vmcnt(12) lgkmcnt(0)
v_mfma_f32_16x16x32_bf16 v[20:23], v[228:231], v[172:175], v[20:23]
ds_read_b64_tr_b16 v[212:213], v14 offset:16384
v_mfma_f32_16x16x32_bf16 v[36:39], v[228:231], v[176:179], v[36:39]
ds_read_b64_tr_b16 v[214:215], v14 offset:16896
v_mfma_f32_16x16x32_bf16 v[24:27], v[232:235], v[172:175], v[24:27]
ds_read_b64_tr_b16 v[216:217], v15 offset:16384
v_mfma_f32_16x16x32_bf16 v[40:43], v[232:235], v[176:179], v[40:43]
ds_read_b64_tr_b16 v[218:219], v15 offset:16896
v_mfma_f32_16x16x32_bf16 v[28:31], v[236:239], v[172:175], v[28:31]
ds_read_b64_tr_b16 v[220:221], v16 offset:16384
v_mfma_f32_16x16x32_bf16 v[44:47], v[236:239], v[176:179], v[44:47]
ds_read_b64_tr_b16 v[222:223], v16 offset:16896
v_mfma_f32_16x16x32_bf16 v[32:35], v[240:243], v[172:175], v[32:35]
ds_read_b64_tr_b16 v[224:225], v17 offset:16384
v_mfma_f32_16x16x32_bf16 v[48:51], v[240:243], v[176:179], v[48:51]
ds_read_b64_tr_b16 v[226:227], v17 offset:16896
s_waitcnt vmcnt(10) lgkmcnt(0)
v_mfma_f32_16x16x32_bf16 v[20:23], v[212:215], v[180:183], v[20:23]
ds_read_b64_tr_b16 v[228:229], v14 offset:20480
ds_read_b64_tr_b16 v[230:231], v14 offset:20992
v_mfma_f32_16x16x32_bf16 v[36:39], v[212:215], v[184:187], v[36:39]
ds_read_b64_tr_b16 v[232:233], v15 offset:20480
v_mfma_f32_16x16x32_bf16 v[24:27], v[216:219], v[180:183], v[24:27]
ds_read_b64_tr_b16 v[234:235], v15 offset:20992
ds_read_b64_tr_b16 v[236:237], v16 offset:20480
v_mfma_f32_16x16x32_bf16 v[40:43], v[216:219], v[184:187], v[40:43]
ds_read_b64_tr_b16 v[238:239], v16 offset:20992
v_mfma_f32_16x16x32_bf16 v[28:31], v[220:223], v[180:183], v[28:31]
ds_read_b64_tr_b16 v[240:241], v17 offset:20480
ds_read_b64_tr_b16 v[242:243], v17 offset:20992
v_mfma_f32_16x16x32_bf16 v[44:47], v[220:223], v[184:187], v[44:47]
buffer_load_dwordx4 v[164:167], v12, s[32:35], s57 offen sc1
v_mfma_f32_16x16x32_bf16 v[32:35], v[224:227], v[180:183], v[32:35]
buffer_load_dwordx4 v[168:171], v13, s[32:35], s57 offen sc1
buffer_load_dwordx4 v[172:175], v12, s[32:35], s57 offen offset:1024 sc1
v_mfma_f32_16x16x32_bf16 v[48:51], v[224:227], v[184:187], v[48:51]
buffer_load_dwordx4 v[176:179], v13, s[32:35], s57 offen offset:1024 sc1
s_add_u32 s57, s57, 2048
s_and_b32 s57, s57, 0x7fff
s_waitcnt vmcnt(12) lgkmcnt(0)
v_mfma_f32_16x16x32_bf16 v[20:23], v[228:231], v[188:191], v[20:23]
ds_read_b64_tr_b16 v[212:213], v14 offset:24576
v_mfma_f32_16x16x32_bf16 v[36:39], v[228:231], v[192:195], v[36:39]
ds_read_b64_tr_b16 v[214:215], v14 offset:25088
v_mfma_f32_16x16x32_bf16 v[24:27], v[232:235], v[188:191], v[24:27]
ds_read_b64_tr_b16 v[216:217], v15 offset:24576
v_mfma_f32_16x16x32_bf16 v[40:43], v[232:235], v[192:195], v[40:43]
ds_read_b64_tr_b16 v[218:219], v15 offset:25088
v_mfma_f32_16x16x32_bf16 v[28:31], v[236:239], v[188:191], v[28:31]
ds_read_b64_tr_b16 v[220:221], v16 offset:24576
v_mfma_f32_16x16x32_bf16 v[44:47], v[236:239], v[192:195], v[44:47]
ds_read_b64_tr_b16 v[222:223], v16 offset:25088
v_mfma_f32_16x16x32_bf16 v[32:35], v[240:243], v[188:191], v[32:35]
ds_read_b64_tr_b16 v[224:225], v17 offset:24576
v_mfma_f32_16x16x32_bf16 v[48:51], v[240:243], v[192:195], v[48:51]
ds_read_b64_tr_b16 v[226:227], v17 offset:25088
s_waitcnt vmcnt(10) lgkmcnt(0)
v_mfma_f32_16x16x32_bf16 v[20:23], v[212:215], v[196:199], v[20:23]
ds_read_b64_tr_b16 v[228:229], v14 offset:28672
ds_read_b64_tr_b16 v[230:231], v14 offset:29184
v_mfma_f32_16x16x32_bf16 v[36:39], v[212:215], v[200:203], v[36:39]
ds_read_b64_tr_b16 v[232:233], v15 offset:28672
v_mfma_f32_16x16x32_bf16 v[24:27], v[216:219], v[196:199], v[24:27]
ds_read_b64_tr_b16 v[234:235], v15 offset:29184
ds_read_b64_tr_b16 v[236:237], v16 offset:28672
v_mfma_f32_16x16x32_bf16 v[40:43], v[216:219], v[200:203], v[40:43]
ds_read_b64_tr_b16 v[238:239], v16 offset:29184
v_mfma_f32_16x16x32_bf16 v[28:31], v[220:223], v[196:199], v[28:31]
ds_read_b64_tr_b16 v[240:241], v17 offset:28672
ds_read_b64_tr_b16 v[242:243], v17 offset:29184
v_mfma_f32_16x16x32_bf16 v[44:47], v[220:223], v[200:203], v[44:47]
buffer_load_dwordx4 v[180:183], v12, s[32:35], s57 offen sc1
v_mfma_f32_16x16x32_bf16 v[32:35], v[224:227], v[196:199], v[32:35]
buffer_load_dwordx4 v[184:187], v13, s[32:35], s57 offen sc1
buffer_load_dwordx4 v[188:191], v12, s[32:35], s57 offen offset:1024 sc1
v_mfma_f32_16x16x32_bf16 v[48:51], v[224:227], v[200:203], v[48:51]
buffer_load_dwordx4 v[192:195], v13, s[32:35], s57 offen offset:1024 sc1
s_add_u32 s57, s57, 2048
s_and_b32 s57, s57, 0x7fff
s_waitcnt vmcnt(12) lgkmcnt(0)
v_mfma_f32_16x16x32_bf16 v[20:23], v[228:231], v[204:207], v[20:23]
ds_read_b64_tr_b16 v[212:213], v14 offset:32768
v_mfma_f32_16x16x32_bf16 v[36:39], v[228:231], v[208:211], v[36:39]
ds_read_b64_tr_b16 v[214:215], v14 offset:33280
v_mfma_f32_16x16x32_bf16 v[24:27], v[232:235], v[204:207], v[24:27]
ds_read_b64_tr_b16 v[216:217], v15 offset:32768
v_mfma_f32_16x16x32_bf16 v[40:43], v[232:235], v[208:211], v[40:43]
ds_read_b64_tr_b16 v[218:219], v15 offset:33280
v_mfma_f32_16x16x32_bf16 v[28:31], v[236:239], v[204:207], v[28:31]
ds_read_b64_tr_b16 v[220:221], v16 offset:32768
v_mfma_f32_16x16x32_bf16 v[44:47], v[236:239], v[208:211], v[44:47]
ds_read_b64_tr_b16 v[222:223], v16 offset:33280
v_mfma_f32_16x16x32_bf16 v[32:35], v[240:243], v[204:207], v[32:35]
ds_read_b64_tr_b16 v[224:225], v17 offset:32768
v_mfma_f32_16x16x32_bf16 v[48:51], v[240:243], v[208:211], v[48:51]
ds_read_b64_tr_b16 v[226:227], v17 offset:33280
s_waitcnt vmcnt(10) lgkmcnt(0)
v_mfma_f32_16x16x32_bf16 v[20:23], v[212:215], v[148:151], v[20:23]
ds_read_b64_tr_b16 v[228:229], v14 offset:36864
ds_read_b64_tr_b16 v[230:231], v14 offset:37376
v_mfma_f32_16x16x32_bf16 v[36:39], v[212:215], v[152:155], v[36:39]
ds_read_b64_tr_b16 v[232:233], v15 offset:36864
v_mfma_f32_16x16x32_bf16 v[24:27], v[216:219], v[148:151], v[24:27]
ds_read_b64_tr_b16 v[234:235], v15 offset:37376
ds_read_b64_tr_b16 v[236:237], v16 offset:36864
v_mfma_f32_16x16x32_bf16 v[40:43], v[216:219], v[152:155], v[40:43]
ds_read_b64_tr_b16 v[238:239], v16 offset:37376
v_mfma_f32_16x16x32_bf16 v[28:31], v[220:223], v[148:151], v[28:31]
ds_read_b64_tr_b16 v[240:241], v17 offset:36864
ds_read_b64_tr_b16 v[242:243], v17 offset:37376
v_mfma_f32_16x16x32_bf16 v[44:47], v[220:223], v[152:155], v[44:47]
buffer_load_dwordx4 v[196:199], v12, s[32:35], s57 offen sc1
v_mfma_f32_16x16x32_bf16 v[32:35], v[224:227], v[148:151], v[32:35]
buffer_load_dwordx4 v[200:203], v13, s[32:35], s57 offen sc1
buffer_load_dwordx4 v[204:207], v12, s[32:35], s57 offen offset:1024 sc1
v_mfma_f32_16x16x32_bf16 v[48:51], v[224:227], v[152:155], v[48:51]
buffer_load_dwordx4 v[208:211], v13, s[32:35], s57 offen offset:1024 sc1
s_add_u32 s57, s57, 2048
s_and_b32 s57, s57, 0x7fff
s_waitcnt vmcnt(12) lgkmcnt(0)
v_mfma_f32_16x16x32_bf16 v[20:23], v[228:231], v[156:159], v[20:23]
ds_read_b64_tr_b16 v[212:213], v14 offset:40960
v_mfma_f32_16x16x32_bf16 v[36:39], v[228:231], v[160:163], v[36:39]
ds_read_b64_tr_b16 v[214:215], v14 offset:41472
v_mfma_f32_16x16x32_bf16 v[24:27], v[232:235], v[156:159], v[24:27]
ds_read_b64_tr_b16 v[216:217], v15 offset:40960
v_mfma_f32_16x16x32_bf16 v[40:43], v[232:235], v[160:163], v[40:43]
ds_read_b64_tr_b16 v[218:219], v15 offset:41472
v_mfma_f32_16x16x32_bf16 v[28:31], v[236:239], v[156:159], v[28:31]
ds_read_b64_tr_b16 v[220:221], v16 offset:40960
v_mfma_f32_16x16x32_bf16 v[44:47], v[236:239], v[160:163], v[44:47]
ds_read_b64_tr_b16 v[222:223], v16 offset:41472
v_mfma_f32_16x16x32_bf16 v[32:35], v[240:243], v[156:159], v[32:35]
ds_read_b64_tr_b16 v[224:225], v17 offset:40960
v_mfma_f32_16x16x32_bf16 v[48:51], v[240:243], v[160:163], v[48:51]
ds_read_b64_tr_b16 v[226:227], v17 offset:41472
s_waitcnt vmcnt(10) lgkmcnt(0)
v_mfma_f32_16x16x32_bf16 v[20:23], v[212:215], v[164:167], v[20:23]
ds_read_b64_tr_b16 v[228:229], v14 offset:45056
v_mfma_f32_16x16x32_bf16 v[36:39], v[212:215], v[168:171], v[36:39]
ds_read_b64_tr_b16 v[230:231], v14 offset:45568
v_mfma_f32_16x16x32_bf16 v[24:27], v[216:219], v[164:167], v[24:27]
ds_read_b64_tr_b16 v[232:233], v15 offset:45056
v_mfma_f32_16x16x32_bf16 v[40:43], v[216:219], v[168:171], v[40:43]
ds_read_b64_tr_b16 v[234:235], v15 offset:45568
v_mfma_f32_16x16x32_bf16 v[28:31], v[220:223], v[164:167], v[28:31]
ds_read_b64_tr_b16 v[236:237], v16 offset:45056
v_mfma_f32_16x16x32_bf16 v[44:47], v[220:223], v[168:171], v[44:47]
ds_read_b64_tr_b16 v[238:239], v16 offset:45568
v_mfma_f32_16x16x32_bf16 v[32:35], v[224:227], v[164:167], v[32:35]
ds_read_b64_tr_b16 v[240:241], v17 offset:45056
v_mfma_f32_16x16x32_bf16 v[48:51], v[224:227], v[168:171], v[48:51]
ds_read_b64_tr_b16 v[242:243], v17 offset:45568
s_waitcnt vmcnt(8) lgkmcnt(0)
v_mfma_f32_16x16x32_bf16 v[20:23], v[228:231], v[172:175], v[20:23]
ds_read_b64_tr_b16 v[212:213], v14 offset:49152
v_mfma_f32_16x16x32_bf16 v[36:39], v[228:231], v[176:179], v[36:39]
ds_read_b64_tr_b16 v[214:215], v14 offset:49664
v_mfma_f32_16x16x32_bf16 v[24:27], v[232:235], v[172:175], v[24:27]
ds_read_b64_tr_b16 v[216:217], v15 offset:49152
v_mfma_f32_16x16x32_bf16 v[40:43], v[232:235], v[176:179], v[40:43]
ds_read_b64_tr_b16 v[218:219], v15 offset:49664
v_mfma_f32_16x16x32_bf16 v[28:31], v[236:239], v[172:175], v[28:31]
ds_read_b64_tr_b16 v[220:221], v16 offset:49152
v_mfma_f32_16x16x32_bf16 v[44:47], v[236:239], v[176:179], v[44:47]
ds_read_b64_tr_b16 v[222:223], v16 offset:49664
v_mfma_f32_16x16x32_bf16 v[32:35], v[240:243], v[172:175], v[32:35]
ds_read_b64_tr_b16 v[224:225], v17 offset:49152
v_mfma_f32_16x16x32_bf16 v[48:51], v[240:243], v[176:179], v[48:51]
ds_read_b64_tr_b16 v[226:227], v17 offset:49664
s_waitcnt vmcnt(6) lgkmcnt(0)
v_mfma_f32_16x16x32_bf16 v[20:23], v[212:215], v[180:183], v[20:23]
ds_read_b64_tr_b16 v[228:229], v14 offset:53248
v_mfma_f32_16x16x32_bf16 v[36:39], v[212:215], v[184:187], v[36:39]
ds_read_b64_tr_b16 v[230:231], v14 offset:53760
v_mfma_f32_16x16x32_bf16 v[24:27], v[216:219], v[180:183], v[24:27]
ds_read_b64_tr_b16 v[232:233], v15 offset:53248
v_mfma_f32_16x16x32_bf16 v[40:43], v[216:219], v[184:187], v[40:43]
ds_read_b64_tr_b16 v[234:235], v15 offset:53760
v_mfma_f32_16x16x32_bf16 v[28:31], v[220:223], v[180:183], v[28:31]
ds_read_b64_tr_b16 v[236:237], v16 offset:53248
v_mfma_f32_16x16x32_bf16 v[44:47], v[220:223], v[184:187], v[44:47]
ds_read_b64_tr_b16 v[238:239], v16 offset:53760
v_mfma_f32_16x16x32_bf16 v[32:35], v[224:227], v[180:183], v[32:35]
ds_read_b64_tr_b16 v[240:241], v17 offset:53248
v_mfma_f32_16x16x32_bf16 v[48:51], v[224:227], v[184:187], v[48:51]
ds_read_b64_tr_b16 v[242:243], v17 offset:53760
s_waitcnt vmcnt(4) lgkmcnt(0)
v_mfma_f32_16x16x32_bf16 v[20:23], v[228:231], v[188:191], v[20:23]
ds_read_b64_tr_b16 v[212:213], v14 offset:57344
v_mfma_f32_16x16x32_bf16 v[36:39], v[228:231], v[192:195], v[36:39]
ds_read_b64_tr_b16 v[214:215], v14 offset:57856
v_mfma_f32_16x16x32_bf16 v[24:27], v[232:235], v[188:191], v[24:27]
ds_read_b64_tr_b16 v[216:217], v15 offset:57344
v_mfma_f32_16x16x32_bf16 v[40:43], v[232:235], v[192:195], v[40:43]
ds_read_b64_tr_b16 v[218:219], v15 offset:57856
v_mfma_f32_16x16x32_bf16 v[28:31], v[236:239], v[188:191], v[28:31]
ds_read_b64_tr_b16 v[220:221], v16 offset:57344
v_mfma_f32_16x16x32_bf16 v[44:47], v[236:239], v[192:195], v[44:47]
ds_read_b64_tr_b16 v[222:223], v16 offset:57856
v_mfma_f32_16x16x32_bf16 v[32:35], v[240:243], v[188:191], v[32:35]
ds_read_b64_tr_b16 v[224:225], v17 offset:57344
v_mfma_f32_16x16x32_bf16 v[48:51], v[240:243], v[192:195], v[48:51]
ds_read_b64_tr_b16 v[226:227], v17 offset:57856
s_waitcnt vmcnt(2) lgkmcnt(0)
v_mfma_f32_16x16x32_bf16 v[20:23], v[212:215], v[196:199], v[20:23]
ds_read_b64_tr_b16 v[228:229], v14 offset:61440
v_mfma_f32_16x16x32_bf16 v[36:39], v[212:215], v[200:203], v[36:39]
ds_read_b64_tr_b16 v[230:231], v14 offset:61952
v_mfma_f32_16x16x32_bf16 v[24:27], v[216:219], v[196:199], v[24:27]
ds_read_b64_tr_b16 v[232:233], v15 offset:61440
v_mfma_f32_16x16x32_bf16 v[40:43], v[216:219], v[200:203], v[40:43]
ds_read_b64_tr_b16 v[234:235], v15 offset:61952
v_mfma_f32_16x16x32_bf16 v[28:31], v[220:223], v[196:199], v[28:31]
ds_read_b64_tr_b16 v[236:237], v16 offset:61440
v_mfma_f32_16x16x32_bf16 v[44:47], v[220:223], v[200:203], v[44:47]
ds_read_b64_tr_b16 v[238:239], v16 offset:61952
v_mfma_f32_16x16x32_bf16 v[32:35], v[224:227], v[196:199], v[32:35]
ds_read_b64_tr_b16 v[240:241], v17 offset:61440
v_mfma_f32_16x16x32_bf16 v[48:51], v[224:227], v[200:203], v[48:51]
ds_read_b64_tr_b16 v[242:243], v17 offset:61952
s_waitcnt vmcnt(0) lgkmcnt(0)
v_mfma_f32_16x16x32_bf16 v[20:23], v[228:231], v[204:207], v[20:23]
v_mfma_f32_16x16x32_bf16 v[36:39], v[228:231], v[208:211], v[36:39]
v_mfma_f32_16x16x32_bf16 v[24:27], v[232:235], v[204:207], v[24:27]
v_mfma_f32_16x16x32_bf16 v[40:43], v[232:235], v[208:211], v[40:43]
v_mfma_f32_16x16x32_bf16 v[28:31], v[236:239], v[204:207], v[28:31]
v_mfma_f32_16x16x32_bf16 v[44:47], v[236:239], v[208:211], v[44:47]
v_mfma_f32_16x16x32_bf16 v[32:35], v[240:243], v[204:207], v[32:35]
v_mfma_f32_16x16x32_bf16 v[48:51], v[240:243], v[208:211], v[48:51]
s_mov_b32 s24, s18
s_and_b32 s25, s19, 0xffff
s_mov_b32 s26, 4194304
s_mov_b32 s27, 0x00020000
s_mov_b32 s48, s56
s_lshl_b32 s49, s48, 4
v_add_u32 v4, s49, v2
v_lshlrev_b32 v4, 11, v4
v_and_b32 v5, 1, v3
v_lshl_add_u32 v4, v5, 5, v4
v_lshrrev_b32 v5, 1, v3
v_lshl_add_u32 v4, v5, 4, v4
s_lshl_b32 s49, s42, 7
v_add_u32 v12, s49, v4
v_add_u32 v13, 32768, v12
s_nop 2
v_lshlrev_b32 v4, 16, v88
v_and_b32 v5, 0xffff0000, v88
v_pk_add_f32 v[20:21], v[20:21], v[4:5]
v_lshlrev_b32 v4, 16, v89
v_and_b32 v5, 0xffff0000, v89
v_pk_add_f32 v[22:23], v[22:23], v[4:5]
v_lshlrev_b32 v4, 16, v90
v_and_b32 v5, 0xffff0000, v90
v_pk_add_f32 v[24:25], v[24:25], v[4:5]
v_lshlrev_b32 v4, 16, v91
v_and_b32 v5, 0xffff0000, v91
v_pk_add_f32 v[26:27], v[26:27], v[4:5]
v_cvt_pk_bf16_f32 v20, v20, v21
v_cvt_pk_bf16_f32 v21, v22, v23
v_cvt_pk_bf16_f32 v22, v24, v25
v_cvt_pk_bf16_f32 v23, v26, v27
s_nop 1
v_permlane16_swap_b32 v20, v22
v_permlane16_swap_b32 v21, v23
buffer_store_dwordx4 v[20:23], v12, s[24:27], 0 offen offset:0
v_lshlrev_b32 v4, 16, v92
v_and_b32 v5, 0xffff0000, v92
v_pk_add_f32 v[28:29], v[28:29], v[4:5]
v_lshlrev_b32 v4, 16, v93
v_and_b32 v5, 0xffff0000, v93
v_pk_add_f32 v[30:31], v[30:31], v[4:5]
v_lshlrev_b32 v4, 16, v94
v_and_b32 v5, 0xffff0000, v94
v_pk_add_f32 v[32:33], v[32:33], v[4:5]
v_lshlrev_b32 v4, 16, v95
v_and_b32 v5, 0xffff0000, v95
v_pk_add_f32 v[34:35], v[34:35], v[4:5]
v_cvt_pk_bf16_f32 v28, v28, v29
v_cvt_pk_bf16_f32 v29, v30, v31
v_cvt_pk_bf16_f32 v30, v32, v33
v_cvt_pk_bf16_f32 v31, v34, v35
s_nop 1
v_permlane16_swap_b32 v28, v30
v_permlane16_swap_b32 v29, v31
buffer_store_dwordx4 v[28:31], v12, s[24:27], 0 offen offset:64
v_lshlrev_b32 v4, 16, v96
v_and_b32 v5, 0xffff0000, v96
v_pk_add_f32 v[36:37], v[36:37], v[4:5]
v_lshlrev_b32 v4, 16, v97
v_and_b32 v5, 0xffff0000, v97
v_pk_add_f32 v[38:39], v[38:39], v[4:5]
v_lshlrev_b32 v4, 16, v98
v_and_b32 v5, 0xffff0000, v98
v_pk_add_f32 v[40:41], v[40:41], v[4:5]
v_lshlrev_b32 v4, 16, v99
v_and_b32 v5, 0xffff0000, v99
v_pk_add_f32 v[42:43], v[42:43], v[4:5]
v_cvt_pk_bf16_f32 v36, v36, v37
v_cvt_pk_bf16_f32 v37, v38, v39
v_cvt_pk_bf16_f32 v38, v40, v41
v_cvt_pk_bf16_f32 v39, v42, v43
s_nop 1
v_permlane16_swap_b32 v36, v38
v_permlane16_swap_b32 v37, v39
buffer_store_dwordx4 v[36:39], v13, s[24:27], 0 offen offset:0
v_lshlrev_b32 v4, 16, v100
v_and_b32 v5, 0xffff0000, v100
v_pk_add_f32 v[44:45], v[44:45], v[4:5]
v_lshlrev_b32 v4, 16, v101
v_and_b32 v5, 0xffff0000, v101
v_pk_add_f32 v[46:47], v[46:47], v[4:5]
v_lshlrev_b32 v4, 16, v102
v_and_b32 v5, 0xffff0000, v102
v_pk_add_f32 v[48:49], v[48:49], v[4:5]
v_lshlrev_b32 v4, 16, v103
v_and_b32 v5, 0xffff0000, v103
v_pk_add_f32 v[50:51], v[50:51], v[4:5]
v_cvt_pk_bf16_f32 v44, v44, v45
v_cvt_pk_bf16_f32 v45, v46, v47
v_cvt_pk_bf16_f32 v46, v48, v49
v_cvt_pk_bf16_f32 v47, v50, v51
s_nop 1
v_permlane16_swap_b32 v44, v46
v_permlane16_swap_b32 v45, v47
buffer_store_dwordx4 v[44:47], v13, s[24:27], 0 offen offset:64
s_endpgm
L_helper:
s_sub_u32 s43, s40, 4
s_lshl_b32 s70, s43, 12
s_add_u32 s70, s70, 2048
s_lshl_b32 s71, s43, 11
s_add_u32 s71, s71, 18432
v_mov_b32 v30, 0
v_mov_b32 v31, 0
v_mov_b32 v32, 0
v_mov_b32 v33, 0
v_mov_b32 v34, 0
v_mov_b32 v35, 0
s_mov_b32 s28, s6
s_and_b32 s29, s7, 0xffff
s_mov_b32 s30, 6291456
s_mov_b32 s31, 0x00020000
v_lshrrev_b32 v4, 3, v0
v_and_b32 v5, 7, v0
s_lshl_b32 s48, s43, 4
v_add_u32 v6, s48, v4
v_mul_u32_u24 v6, 6144, v6
v_and_b32 v7, 2, v4
v_xor_b32 v7, v7, v5
s_lshl_b32 s48, s42, 7
v_lshl_add_u32 v26, v7, 4, v6
v_add_u32 v26, s48, v26
v_xor_b32 v27, 64, v26
v_add_u32 v27, 48128, v27
v_lshrrev_b32 v4, 3, v0
v_and_b32 v5, 7, v0
s_lshl_b32 s48, s41, 7
s_lshl_b32 s49, s43, 5
s_add_u32 s48, s48, s49
v_add_u32 v6, s48, v4
v_lshlrev_b32 v6, 11, v6
v_lshrrev_b32 v7, 1, v4
v_xor_b32 v7, v7, v5
v_lshl_add_u32 v20, v7, 4, v6
v_xor_b32 v21, 64, v20
v_add_u32 v21, 15360, v21
v_add_u32 v22, 30720, v20
v_add_u32 v23, 30720, v21
v_subrev_u32 v24, 32768, v20
v_subrev_u32 v25, 32768, v21
s_add_u32 s69, s47, 0
s_and_b32 s69, s69, 15
s_mul_i32 s67, s69, 128
s_mul_i32 s68, s69, 393216
s_cmp_lg_u32 s43, 0
s_cbranch_scc1 nohalo_30
s_mov_b32 m0, 0
s_nop 0
buffer_load_dwordx4 v24, s[24:27], s67 offen  lds
buffer_load_dwordx4 v25, s[24:27], s67 offen offset:1024  lds
nohalo_30:
s_add_u32 m0, s70, 0
s_nop 0
buffer_load_dwordx4 v20, s[24:27], s67 offen offset:0  lds
buffer_load_dwordx4 v21, s[24:27], s67 offen offset:1024  lds
buffer_load_dwordx4 v22, s[24:27], s67 offen offset:2048  lds
buffer_load_dwordx4 v23, s[24:27], s67 offen offset:3072  lds
s_add_u32 s48, s71, 0
s_add_u32 m0, s48, 0
s_add_u32 s49, s68, 0
buffer_load_dwordx4 v26, s[28:31], s49 offen lds
buffer_load_dwordx4 v27, s[28:31], s49 offen offset:1024 lds
s_add_u32 m0, s48, 8192
s_add_u32 s49, s68, 2048
buffer_load_dwordx4 v26, s[28:31], s49 offen lds
buffer_load_dwordx4 v27, s[28:31], s49 offen offset:1024 lds
s_add_u32 m0, s48, 16384
s_add_u32 s49, s68, 4096
buffer_load_dwordx4 v26, s[28:31], s49 offen lds
buffer_load_dwordx4 v27, s[28:31], s49 offen offset:1024 lds
s_add_u32 s69, s47, 1
s_and_b32 s69, s69, 15
s_mul_i32 s67, s69, 128
s_mul_i32 s68, s69, 393216
s_cmp_lg_u32 s43, 0
s_cbranch_scc1 nohalo_31
s_mov_b32 m0, 43008
s_nop 0
buffer_load_dwordx4 v24, s[24:27], s67 offen  lds
buffer_load_dwordx4 v25, s[24:27], s67 offen offset:1024  lds
nohalo_31:
s_add_u32 m0, s70, 43008
s_nop 0
buffer_load_dwordx4 v20, s[24:27], s67 offen offset:0  lds
buffer_load_dwordx4 v21, s[24:27], s67 offen offset:1024  lds
buffer_load_dwordx4 v22, s[24:27], s67 offen offset:2048  lds
buffer_load_dwordx4 v23, s[24:27], s67 offen offset:3072  lds
s_add_u32 s48, s71, 43008
s_add_u32 m0, s48, 0
s_add_u32 s49, s68, 0
buffer_load_dwordx4 v26, s[28:31], s49 offen lds
buffer_load_dwordx4 v27, s[28:31], s49 offen offset:1024 lds
s_add_u32 m0, s48, 8192
s_add_u32 s49, s68, 2048
buffer_load_dwordx4 v26, s[28:31], s49 offen lds
buffer_load_dwordx4 v27, s[28:31], s49 offen offset:1024 lds
s_add_u32 m0, s48, 16384
s_add_u32 s49, s68, 4096
buffer_load_dwordx4 v26, s[28:31], s49 offen lds
buffer_load_dwordx4 v27, s[28:31], s49 offen offset:1024 lds
s_waitcnt vmcnt(10)
s_barrier
s_add_u32 s69, s47, 2
s_and_b32 s69, s69, 15
s_mul_i32 s67, s69, 128
s_mul_i32 s68, s69, 393216
s_cmp_lg_u32 s43, 0
s_cbranch_scc1 nohalo_32
s_mov_b32 m0, 86016
s_nop 0
buffer_load_dwordx4 v24, s[24:27], s67 offen  lds
buffer_load_dwordx4 v25, s[24:27], s67 offen offset:1024  lds
nohalo_32:
s_add_u32 m0, s70, 86016
s_nop 0
buffer_load_dwordx4 v20, s[24:27], s67 offen offset:0  lds
buffer_load_dwordx4 v21, s[24:27], s67 offen offset:1024  lds
buffer_load_dwordx4 v22, s[24:27], s67 offen offset:2048  lds
buffer_load_dwordx4 v23, s[24:27], s67 offen offset:3072  lds
s_add_u32 s48, s71, 86016
s_add_u32 m0, s48, 0
s_add_u32 s49, s68, 0
buffer_load_dwordx4 v26, s[28:31], s49 offen lds
buffer_load_dwordx4 v27, s[28:31], s49 offen offset:1024 lds
s_add_u32 m0, s48, 8192
s_add_u32 s49, s68, 2048
buffer_load_dwordx4 v26, s[28:31], s49 offen lds
buffer_load_dwordx4 v27, s[28:31], s49 offen offset:1024 lds
s_add_u32 m0, s48, 16384
s_add_u32 s49, s68, 4096
buffer_load_dwordx4 v26, s[28:31], s49 offen lds
buffer_load_dwordx4 v27, s[28:31], s49 offen offset:1024 lds
s_mov_b32 s64, 0
s_mov_b32 s65, 0
h0_loop:
s_waitcnt vmcnt(10)
s_barrier
s_cmp_eq_u32 s64, s74
s_cbranch_scc1 h0_hook0
s_cmp_eq_u32 s64, 2
s_cbranch_scc1 h0_hook1
s_cmp_eq_u32 s64, 3
s_cbranch_scc1 h0_hook2
s_cmp_eq_u32 s64, 7
s_cbranch_scc1 h0_hook3
s_cmp_eq_u32 s64, 8
s_cbranch_scc1 h0_hook4
s_cmp_eq_u32 s64, 9
s_cbranch_scc1 h0_hook5
s_cmp_eq_u32 s64, 10
s_cbranch_scc1 h0_hook6
s_cmp_eq_u32 s64, 11
s_cbranch_scc1 h0_hook7
s_cmp_eq_u32 s64, 12
s_cbranch_scc1 h0_hook8
h0_ret:
s_add_u32 s69, s69, 1
s_and_b32 s69, s69, 15
s_mul_i32 s67, s69, 128
s_mul_i32 s68, s69, 393216
s_cmp_lg_u32 s43, 0
s_cbranch_scc1 nohalo_33
s_mov_b32 m0, s65
s_nop 0
buffer_load_dwordx4 v24, s[24:27], s67 offen  lds
buffer_load_dwordx4 v25, s[24:27], s67 offen offset:1024  lds
nohalo_33:
s_add_u32 m0, s70, s65
s_nop 0
buffer_load_dwordx4 v20, s[24:27], s67 offen offset:0  lds
buffer_load_dwordx4 v21, s[24:27], s67 offen offset:1024  lds
buffer_load_dwordx4 v22, s[24:27], s67 offen offset:2048  lds
buffer_load_dwordx4 v23, s[24:27], s67 offen offset:3072  lds
s_add_u32 s48, s71, s65
s_add_u32 m0, s48, 0
s_add_u32 s49, s68, 0
buffer_load_dwordx4 v26, s[28:31], s49 offen lds
buffer_load_dwordx4 v27, s[28:31], s49 offen offset:1024 lds
s_add_u32 m0, s48, 8192
s_add_u32 s49, s68, 2048
buffer_load_dwordx4 v26, s[28:31], s49 offen lds
buffer_load_dwordx4 v27, s[28:31], s49 offen offset:1024 lds
s_add_u32 m0, s48, 16384
s_add_u32 s49, s68, 4096
buffer_load_dwordx4 v26, s[28:31], s49 offen lds
buffer_load_dwordx4 v27, s[28:31], s49 offen offset:1024 lds
s_add_u32 s65, s65, 43008
s_cmp_eq_u32 s65, 129024
s_cselect_b32 s65, 0, s65
s_add_u32 s64, s64, 1
s_cmp_lt_u32 s64, 13
s_cbranch_scc1 h0_loop
s_mov_b32 s28, s8
s_and_b32 s29, s9, 0xffff
s_mov_b32 s30, 2097152
s_mov_b32 s31, 0x00020000
v_lshrrev_b32 v4, 3, v0
v_and_b32 v5, 7, v0
s_lshr_b32 s48, s43, 1
s_lshl_b32 s48, s48, 5
s_and_b32 s49, s43, 1
s_lshl_b32 s49, s49, 3
s_add_u32 s48, s48, s49
v_lshrrev_b32 v6, 2, v4
v_lshlrev_b32 v6, 4, v6
v_and_b32 v7, 3, v4
v_add3_u32 v6, v6, v7, s48
v_mul_u32_u24 v6, 2048, v6
v_and_b32 v7, 2, v4
v_xor_b32 v7, v7, v5
s_lshl_b32 s48, s42, 7
v_lshl_add_u32 v28, v7, 4, v6
v_add_u32 v28, s48, v28
v_xor_b32 v29, 64, v28
v_add_u32 v29, 7168, v29
s_waitcnt vmcnt(10)
s_barrier
s_lshl_b32 s48, s41, 3
s_lshl_b32 s49, s43, 1
s_add_u32 s48, s48, s49
s_lshl_b32 s48, s48, 15
s_lshl_b32 s49, s42, 11
s_add_u32 s48, s48, s49
s_add_u32 s48, s48, 4194304
s_add_u32 s49, s48, 32768
buffer_load_dwordx4 v[64:67], v18, s[32:35], s48 offen offset:0 sc1
buffer_load_dwordx4 v[68:71], v18, s[32:35], s48 offen offset:1024 sc1
buffer_load_dwordx4 v[72:75], v18, s[32:35], s49 offen offset:0 sc1
buffer_load_dwordx4 v[76:79], v18, s[32:35], s49 offen offset:1024 sc1
s_lshl_b32 s48, s41, 3
s_lshl_b32 s49, s43, 1
s_add_u32 s48, s48, s49
s_lshl_b32 s48, s48, 15
s_lshl_b32 s49, s42, 11
s_add_u32 s48, s48, s49
s_add_u32 s48, s48, 0
s_add_u32 s49, s48, 32768
buffer_load_dwordx4 v[80:83], v18, s[32:35], s48 offen offset:0 sc1
buffer_load_dwordx4 v[84:87], v18, s[32:35], s48 offen offset:1024 sc1
buffer_load_dwordx4 v[88:91], v18, s[32:35], s49 offen offset:0 sc1
buffer_load_dwordx4 v[92:95], v18, s[32:35], s49 offen offset:1024 sc1
s_add_u32 s48, s47, 6
s_and_b32 s48, s48, 15
s_lshl_b32 s48, s48, 17
s_lshl_b32 s49, s43, 11
s_add_u32 m0, s49, 49152
s_nop 0
buffer_load_dwordx4 v28, s[28:31], s48 offen lds
buffer_load_dwordx4 v29, s[28:31], s48 offen offset:1024 lds
s_add_u32 s48, s47, 7
s_and_b32 s48, s48, 15
s_lshl_b32 s48, s48, 17
s_lshl_b32 s49, s43, 11
s_add_u32 m0, s49, 57344
s_nop 0
buffer_load_dwordx4 v28, s[28:31], s48 offen lds
buffer_load_dwordx4 v29, s[28:31], s48 offen offset:1024 lds
s_add_u32 s48, s47, 8
s_and_b32 s48, s48, 15
s_lshl_b32 s48, s48, 17
s_lshl_b32 s49, s43, 11
s_add_u32 m0, s49, 65536
s_nop 0
buffer_load_dwordx4 v28, s[28:31], s48 offen lds
buffer_load_dwordx4 v29, s[28:31], s48 offen offset:1024 lds
s_add_u32 s48, s47, 9
s_and_b32 s48, s48, 15
s_lshl_b32 s48, s48, 17
s_lshl_b32 s49, s43, 11
s_add_u32 m0, s49, 73728
s_nop 0
buffer_load_dwordx4 v28, s[28:31], s48 offen lds
buffer_load_dwordx4 v29, s[28:31], s48 offen offset:1024 lds
s_waitcnt vmcnt(8)
s_barrier
s_add_u32 s48, s47, 10
s_and_b32 s48, s48, 15
s_lshl_b32 s48, s48, 17
s_lshl_b32 s49, s43, 11
s_add_u32 m0, s49, 81920
s_nop 0
buffer_load_dwordx4 v28, s[28:31], s48 offen lds
buffer_load_dwordx4 v29, s[28:31], s48 offen offset:1024 lds
s_add_u32 s48, s47, 11
s_and_b32 s48, s48, 15
s_lshl_b32 s48, s48, 17
s_lshl_b32 s49, s43, 11
s_add_u32 m0, s49, 90112
s_nop 0
buffer_load_dwordx4 v28, s[28:31], s48 offen lds
buffer_load_dwordx4 v29, s[28:31], s48 offen offset:1024 lds
s_add_u32 s48, s47, 12
s_and_b32 s48, s48, 15
s_lshl_b32 s48, s48, 17
s_lshl_b32 s49, s43, 11
s_add_u32 m0, s49, 98304
s_nop 0
buffer_load_dwordx4 v28, s[28:31], s48 offen lds
buffer_load_dwordx4 v29, s[28:31], s48 offen offset:1024 lds
s_add_u32 s48, s47, 13
s_and_b32 s48, s48, 15
s_lshl_b32 s48, s48, 17
s_lshl_b32 s49, s43, 11
s_add_u32 m0, s49, 106496
s_nop 0
buffer_load_dwordx4 v28, s[28:31], s48 offen lds
buffer_load_dwordx4 v29, s[28:31], s48 offen offset:1024 lds
s_barrier
s_barrier
s_add_u32 s48, s47, 14
s_and_b32 s48, s48, 15
s_lshl_b32 s48, s48, 17
s_lshl_b32 s49, s43, 11
s_add_u32 m0, s49, 114688
s_nop 0
buffer_load_dwordx4 v28, s[28:31], s48 offen lds
buffer_load_dwordx4 v29, s[28:31], s48 offen offset:1024 lds
s_add_u32 s48, s47, 15
s_and_b32 s48, s48, 15
s_lshl_b32 s48, s48, 17
s_lshl_b32 s49, s43, 11
s_add_u32 m0, s49, 122880
s_nop 0
buffer_load_dwordx4 v28, s[28:31], s48 offen lds
buffer_load_dwordx4 v29, s[28:31], s48 offen offset:1024 lds
s_add_u32 s48, s47, 0
s_and_b32 s48, s48, 15
s_lshl_b32 s48, s48, 17
s_lshl_b32 s49, s43, 11
s_add_u32 m0, s49, 0
s_nop 0
buffer_load_dwordx4 v28, s[28:31], s48 offen lds
buffer_load_dwordx4 v29, s[28:31], s48 offen offset:1024 lds
s_add_u32 s48, s47, 1
s_and_b32 s48, s48, 15
s_lshl_b32 s48, s48, 17
s_lshl_b32 s49, s43, 11
s_add_u32 m0, s49, 8192
s_nop 0
buffer_load_dwordx4 v28, s[28:31], s48 offen lds
buffer_load_dwordx4 v29, s[28:31], s48 offen offset:1024 lds
s_add_u32 s48, s47, 2
s_and_b32 s48, s48, 15
s_lshl_b32 s48, s48, 17
s_lshl_b32 s49, s43, 11
s_add_u32 m0, s49, 16384
s_nop 0
buffer_load_dwordx4 v28, s[28:31], s48 offen lds
buffer_load_dwordx4 v29, s[28:31], s48 offen offset:1024 lds
s_add_u32 s48, s47, 3
s_and_b32 s48, s48, 15
s_lshl_b32 s48, s48, 17
s_lshl_b32 s49, s43, 11
s_add_u32 m0, s49, 24576
s_nop 0
buffer_load_dwordx4 v28, s[28:31], s48 offen lds
buffer_load_dwordx4 v29, s[28:31], s48 offen offset:1024 lds
s_add_u32 s48, s47, 4
s_and_b32 s48, s48, 15
s_lshl_b32 s48, s48, 17
s_lshl_b32 s49, s43, 11
s_add_u32 m0, s49, 32768
s_nop 0
buffer_load_dwordx4 v28, s[28:31], s48 offen lds
buffer_load_dwordx4 v29, s[28:31], s48 offen offset:1024 lds
s_add_u32 s48, s47, 5
s_and_b32 s48, s48, 15
s_lshl_b32 s48, s48, 17
s_lshl_b32 s49, s43, 11
s_add_u32 m0, s49, 40960
s_nop 0
buffer_load_dwordx4 v28, s[28:31], s48 offen lds
buffer_load_dwordx4 v29, s[28:31], s48 offen offset:1024 lds
s_waitcnt vmcnt(0)
s_barrier
s_mov_b32 s28, s12
s_and_b32 s29, s13, 0xffff
s_mov_b32 s30, 6291456
s_mov_b32 s31, 0x00020000
v_lshrrev_b32 v4, 3, v0
v_and_b32 v5, 7, v0
s_lshr_b32 s48, s43, 1
s_lshl_b32 s48, s48, 5
s_and_b32 s49, s43, 1
s_lshl_b32 s49, s49, 3
s_add_u32 s48, s48, s49
v_lshrrev_b32 v6, 2, v4
v_lshlrev_b32 v6, 4, v6
v_and_b32 v7, 3, v4
v_add3_u32 v6, v6, v7, s48
v_mul_u32_u24 v6, 6144, v6
v_and_b32 v7, 2, v4
v_xor_b32 v7, v7, v5
s_lshl_b32 s48, s42, 7
v_lshl_add_u32 v26, v7, 4, v6
v_add_u32 v26, s48, v26
v_xor_b32 v27, 64, v26
v_add_u32 v27, 23552, v27
s_lshl_b32 s48, s41, 3
s_lshl_b32 s49, s43, 1
s_add_u32 s48, s48, s49
s_lshl_b32 s48, s48, 15
v_add_u32 v20, s48, v18
v_mov_b32 v21, v20
v_add_u32 v22, 30720, v20
v_mov_b32 v23, v22
s_barrier
s_mov_b32 s36, s14
s_and_b32 s37, s15, 0xffff
s_mov_b32 s38, 65536
s_mov_b32 s39, 0x00020000
s_lshl_b32 s48, s42, 12
s_lshl_b32 s49, s43, 10
s_add_u32 s48, s48, s49
s_add_u32 m0, s49, 135168
s_nop 0
buffer_load_dwordx4 v18, s[36:39], s48 offen lds
s_add_u32 s69, s47, 0
s_and_b32 s69, s69, 15
s_mul_i32 s67, s69, 2048
s_mul_i32 s68, s69, 393216
s_add_u32 s48, s71, 0
s_add_u32 m0, s48, 0
s_add_u32 s49, s68, 0
buffer_load_dwordx4 v26, s[28:31], s49 offen lds
buffer_load_dwordx4 v27, s[28:31], s49 offen offset:1024 lds
s_add_u32 m0, s48, 8192
s_add_u32 s49, s68, 2048
buffer_load_dwordx4 v26, s[28:31], s49 offen lds
buffer_load_dwordx4 v27, s[28:31], s49 offen offset:1024 lds
s_add_u32 m0, s48, 16384
s_add_u32 s49, s68, 4096
buffer_load_dwordx4 v26, s[28:31], s49 offen lds
buffer_load_dwordx4 v27, s[28:31], s49 offen offset:1024 lds
s_add_u32 s69, s47, 1
s_and_b32 s69, s69, 15
s_mul_i32 s67, s69, 2048
s_mul_i32 s68, s69, 393216
s_add_u32 s48, s71, 43008
s_add_u32 m0, s48, 0
s_add_u32 s49, s68, 0
buffer_load_dwordx4 v26, s[28:31], s49 offen lds
buffer_load_dwordx4 v27, s[28:31], s49 offen offset:1024 lds
s_add_u32 m0, s48, 8192
s_add_u32 s49, s68, 2048
buffer_load_dwordx4 v26, s[28:31], s49 offen lds
buffer_load_dwordx4 v27, s[28:31], s49 offen offset:1024 lds
s_add_u32 m0, s48, 16384
s_add_u32 s49, s68, 4096
buffer_load_dwordx4 v26, s[28:31], s49 offen lds
buffer_load_dwordx4 v27, s[28:31], s49 offen offset:1024 lds
s_lshl_b32 s52, s41, 2
s_add_u32 s52, s52, s43
s_lshl_b32 s52, s52, 7
s_add_u32 s52, s52, 14163968
v_and_b32 v4, 15, v0
v_lshlrev_b32 v4, 2, v4
buffer_load_dword v5, v4, s[32:35], s52 offen sc1
s_mov_b32 s63, 0
s_waitcnt vmcnt(0)
poll_34:
v_cmp_gt_u32 vcc, 1, v5
s_cbranch_vccz polled_35
buffer_load_dword v5, v4, s[32:35], s52 offen sc1
s_add_u32 s63, s63, 1
s_cmp_lt_u32 s63, 0x80000
s_waitcnt vmcnt(0)
s_cbranch_scc1 poll_34
polled_35:
s_add_u32 s69, s47, 0
s_and_b32 s69, s69, 15
s_mul_i32 s67, s69, 2048
s_mul_i32 s68, s69, 393216
s_add_u32 m0, s70, 0
s_nop 0
buffer_load_dwordx4 v20, s[32:35], s67 offen offset:0 sc1 lds
buffer_load_dwordx4 v21, s[32:35], s67 offen offset:1024 sc1 lds
buffer_load_dwordx4 v22, s[32:35], s67 offen offset:2048 sc1 lds
buffer_load_dwordx4 v23, s[32:35], s67 offen offset:3072 sc1 lds
s_add_u32 s69, s47, 1
s_and_b32 s69, s69, 15
s_mul_i32 s67, s69, 2048
s_mul_i32 s68, s69, 393216
s_add_u32 m0, s70, 43008
s_nop 0
buffer_load_dwordx4 v20, s[32:35], s67 offen offset:0 sc1 lds
buffer_load_dwordx4 v21, s[32:35], s67 offen offset:1024 sc1 lds
buffer_load_dwordx4 v22, s[32:35], s67 offen offset:2048 sc1 lds
buffer_load_dwordx4 v23, s[32:35], s67 offen offset:3072 sc1 lds
s_waitcnt vmcnt(4)
s_barrier
s_add_u32 s69, s47, 2
s_and_b32 s69, s69, 15
s_mul_i32 s67, s69, 2048
s_mul_i32 s68, s69, 393216
s_add_u32 m0, s70, 86016
s_nop 0
buffer_load_dwordx4 v20, s[32:35], s67 offen offset:0 sc1 lds
buffer_load_dwordx4 v21, s[32:35], s67 offen offset:1024 sc1 lds
buffer_load_dwordx4 v22, s[32:35], s67 offen offset:2048 sc1 lds
buffer_load_dwordx4 v23, s[32:35], s67 offen offset:3072 sc1 lds
s_add_u32 s48, s71, 86016
s_add_u32 m0, s48, 0
s_add_u32 s49, s68, 0
buffer_load_dwordx4 v26, s[28:31], s49 offen lds
buffer_load_dwordx4 v27, s[28:31], s49 offen offset:1024 lds
s_add_u32 m0, s48, 8192
s_add_u32 s49, s68, 2048
buffer_load_dwordx4 v26, s[28:31], s49 offen lds
buffer_load_dwordx4 v27, s[28:31], s49 offen offset:1024 lds
s_add_u32 m0, s48, 16384
s_add_u32 s49, s68, 4096
buffer_load_dwordx4 v26, s[28:31], s49 offen lds
buffer_load_dwordx4 v27, s[28:31], s49 offen offset:1024 lds
s_mov_b32 s64, 0
s_mov_b32 s65, 0
h1_loop:
s_waitcnt vmcnt(10)
s_barrier
s_cmp_eq_u32 s64, s74
s_cbranch_scc1 h1_hook0
s_cmp_eq_u32 s64, 2
s_cbranch_scc1 h1_hook1
s_cmp_eq_u32 s64, 3
s_cbranch_scc1 h1_hook2
s_cmp_eq_u32 s64, 8
s_cbranch_scc1 h1_hook3
s_cmp_eq_u32 s64, 9
s_cbranch_scc1 h1_hook4
s_cmp_eq_u32 s64, 10
s_cbranch_scc1 h1_hook5
h1_ret:
s_add_u32 s69, s69, 1
s_and_b32 s69, s69, 15
s_mul_i32 s67, s69, 2048
s_mul_i32 s68, s69, 393216
s_add_u32 m0, s70, s65
s_nop 0
buffer_load_dwordx4 v20, s[32:35], s67 offen offset:0 sc1 lds
buffer_load_dwordx4 v21, s[32:35], s67 offen offset:1024 sc1 lds
buffer_load_dwordx4 v22, s[32:35], s67 offen offset:2048 sc1 lds
buffer_load_dwordx4 v23, s[32:35], s67 offen offset:3072 sc1 lds
s_add_u32 s48, s71, s65
s_add_u32 m0, s48, 0
s_add_u32 s49, s68, 0
buffer_load_dwordx4 v26, s[28:31], s49 offen lds
buffer_load_dwordx4 v27, s[28:31], s49 offen offset:1024 lds
s_add_u32 m0, s48, 8192
s_add_u32 s49, s68, 2048
buffer_load_dwordx4 v26, s[28:31], s49 offen lds
buffer_load_dwordx4 v27, s[28:31], s49 offen offset:1024 lds
s_add_u32 m0, s48, 16384
s_add_u32 s49, s68, 4096
buffer_load_dwordx4 v26, s[28:31], s49 offen lds
buffer_load_dwordx4 v27, s[28:31], s49 offen offset:1024 lds
s_add_u32 s65, s65, 43008
s_cmp_eq_u32 s65, 129024
s_cselect_b32 s65, 0, s65
s_add_u32 s64, s64, 1
s_cmp_lt_u32 s64, 13
s_cbranch_scc1 h1_loop
s_mov_b32 s28, s16
s_and_b32 s29, s17, 0xffff
s_mov_b32 s30, 2097152
s_mov_b32 s31, 0x00020000
s_waitcnt vmcnt(10)
s_barrier
s_lshl_b32 s48, s41, 3
s_lshl_b32 s49, s43, 1
s_add_u32 s48, s48, s49
s_lshl_b32 s48, s48, 15
s_lshl_b32 s49, s42, 11
s_add_u32 s48, s48, s49
s_add_u32 s48, s48, 4194304
s_add_u32 s49, s48, 32768
buffer_load_dwordx4 v[64:67], v18, s[32:35], s48 offen offset:0 sc1
buffer_load_dwordx4 v[68:71], v18, s[32:35], s48 offen offset:1024 sc1
buffer_load_dwordx4 v[72:75], v18, s[32:35], s49 offen offset:0 sc1
buffer_load_dwordx4 v[76:79], v18, s[32:35], s49 offen offset:1024 sc1
s_add_u32 s48, s47, 6
s_and_b32 s48, s48, 15
s_lshl_b32 s48, s48, 17
s_lshl_b32 s49, s43, 11
s_add_u32 m0, s49, 49152
s_nop 0
buffer_load_dwordx4 v28, s[28:31], s48 offen lds
buffer_load_dwordx4 v29, s[28:31], s48 offen offset:1024 lds
s_add_u32 s48, s47, 7
s_and_b32 s48, s48, 15
s_lshl_b32 s48, s48, 17
s_lshl_b32 s49, s43, 11
s_add_u32 m0, s49, 57344
s_nop 0
buffer_load_dwordx4 v28, s[28:31], s48 offen lds
buffer_load_dwordx4 v29, s[28:31], s48 offen offset:1024 lds
s_add_u32 s48, s47, 8
s_and_b32 s48, s48, 15
s_lshl_b32 s48, s48, 17
s_lshl_b32 s49, s43, 11
s_add_u32 m0, s49, 65536
s_nop 0
buffer_load_dwordx4 v28, s[28:31], s48 offen lds
buffer_load_dwordx4 v29, s[28:31], s48 offen offset:1024 lds
s_add_u32 s48, s47, 9
s_and_b32 s48, s48, 15
s_lshl_b32 s48, s48, 17
s_lshl_b32 s49, s43, 11
s_add_u32 m0, s49, 73728
s_nop 0
buffer_load_dwordx4 v28, s[28:31], s48 offen lds
buffer_load_dwordx4 v29, s[28:31], s48 offen offset:1024 lds
s_waitcnt vmcnt(8)
s_barrier
s_add_u32 s48, s47, 10
s_and_b32 s48, s48, 15
s_lshl_b32 s48, s48, 17
s_lshl_b32 s49, s43, 11
s_add_u32 m0, s49, 81920
s_nop 0
buffer_load_dwordx4 v28, s[28:31], s48 offen lds
buffer_load_dwordx4 v29, s[28:31], s48 offen offset:1024 lds
s_add_u32 s48, s47, 11
s_and_b32 s48, s48, 15
s_lshl_b32 s48, s48, 17
s_lshl_b32 s49, s43, 11
s_add_u32 m0, s49, 90112
s_nop 0
buffer_load_dwordx4 v28, s[28:31], s48 offen lds
buffer_load_dwordx4 v29, s[28:31], s48 offen offset:1024 lds
s_add_u32 s48, s47, 12
s_and_b32 s48, s48, 15
s_lshl_b32 s48, s48, 17
s_lshl_b32 s49, s43, 11
s_add_u32 m0, s49, 98304
s_nop 0
buffer_load_dwordx4 v28, s[28:31], s48 offen lds
buffer_load_dwordx4 v29, s[28:31], s48 offen offset:1024 lds
s_add_u32 s48, s47, 13
s_and_b32 s48, s48, 15
s_lshl_b32 s48, s48, 17
s_lshl_b32 s49, s43, 11
s_add_u32 m0, s49, 106496
s_nop 0
buffer_load_dwordx4 v28, s[28:31], s48 offen lds
buffer_load_dwordx4 v29, s[28:31], s48 offen offset:1024 lds
s_barrier
s_barrier
s_add_u32 s48, s47, 14
s_and_b32 s48, s48, 15
s_lshl_b32 s48, s48, 17
s_lshl_b32 s49, s43, 11
s_add_u32 m0, s49, 114688
s_nop 0
buffer_load_dwordx4 v28, s[28:31], s48 offen lds
buffer_load_dwordx4 v29, s[28:31], s48 offen offset:1024 lds
s_add_u32 s48, s47, 15
s_and_b32 s48, s48, 15
s_lshl_b32 s48, s48, 17
s_lshl_b32 s49, s43, 11
s_add_u32 m0, s49, 122880
s_nop 0
buffer_load_dwordx4 v28, s[28:31], s48 offen lds
buffer_load_dwordx4 v29, s[28:31], s48 offen offset:1024 lds
s_barrier
s_barrier
s_add_u32 s48, s47, 0
s_and_b32 s48, s48, 15
s_lshl_b32 s48, s48, 17
s_lshl_b32 s49, s43, 11
s_add_u32 m0, s49, 0
s_nop 0
buffer_load_dwordx4 v28, s[28:31], s48 offen lds
buffer_load_dwordx4 v29, s[28:31], s48 offen offset:1024 lds
s_add_u32 s48, s47, 1
s_and_b32 s48, s48, 15
s_lshl_b32 s48, s48, 17
s_lshl_b32 s49, s43, 11
s_add_u32 m0, s49, 8192
s_nop 0
buffer_load_dwordx4 v28, s[28:31], s48 offen lds
buffer_load_dwordx4 v29, s[28:31], s48 offen offset:1024 lds
s_add_u32 s48, s47, 2
s_and_b32 s48, s48, 15
s_lshl_b32 s48, s48, 17
s_lshl_b32 s49, s43, 11
s_add_u32 m0, s49, 16384
s_nop 0
buffer_load_dwordx4 v28, s[28:31], s48 offen lds
buffer_load_dwordx4 v29, s[28:31], s48 offen offset:1024 lds
s_add_u32 s48, s47, 3
s_and_b32 s48, s48, 15
s_lshl_b32 s48, s48, 17
s_lshl_b32 s49, s43, 11
s_add_u32 m0, s49, 24576
s_nop 0
buffer_load_dwordx4 v28, s[28:31], s48 offen lds
buffer_load_dwordx4 v29, s[28:31], s48 offen offset:1024 lds
s_add_u32 s48, s47, 4
s_and_b32 s48, s48, 15
s_lshl_b32 s48, s48, 17
s_lshl_b32 s49, s43, 11
s_add_u32 m0, s49, 32768
s_nop 0
buffer_load_dwordx4 v28, s[28:31], s48 offen lds
buffer_load_dwordx4 v29, s[28:31], s48 offen offset:1024 lds
s_add_u32 s48, s47, 5
s_and_b32 s48, s48, 15
s_lshl_b32 s48, s48, 17
s_lshl_b32 s49, s43, 11
s_add_u32 m0, s49, 40960
s_nop 0
buffer_load_dwordx4 v28, s[28:31], s48 offen lds
buffer_load_dwordx4 v29, s[28:31], s48 offen offset:1024 lds
s_waitcnt vmcnt(0)
s_barrier
s_barrier
s_mov_b32 s28, s6
s_and_b32 s29, s7, 0xffff
s_mov_b32 s30, 6291456
s_mov_b32 s31, 0x00020000
s_sub_u32 s48, s41, 1
s_lshl_b32 s48, s48, 15
s_add_u32 s48, s48, 12713984
s_cmp_eq_u32 s41, 0
s_cselect_b32 s48, 0xf0000000, s48
v_add_u32 v24, s48, v18
v_mov_b32 v25, v24
s_barrier
s_add_u32 s69, s47, 0
s_and_b32 s69, s69, 15
s_mul_i32 s67, s69, 2048
s_mul_i32 s68, s69, 393216
s_add_u32 s48, s71, 0
s_add_u32 m0, s48, 0
s_add_u32 s49, s68, 0
buffer_load_dwordx4 v26, s[28:31], s49 offen lds
buffer_load_dwordx4 v27, s[28:31], s49 offen offset:1024 lds
s_add_u32 m0, s48, 8192
s_add_u32 s49, s68, 2048
buffer_load_dwordx4 v26, s[28:31], s49 offen lds
buffer_load_dwordx4 v27, s[28:31], s49 offen offset:1024 lds
s_add_u32 m0, s48, 16384
s_add_u32 s49, s68, 4096
buffer_load_dwordx4 v26, s[28:31], s49 offen lds
buffer_load_dwordx4 v27, s[28:31], s49 offen offset:1024 lds
s_add_u32 s69, s47, 1
s_and_b32 s69, s69, 15
s_mul_i32 s67, s69, 2048
s_mul_i32 s68, s69, 393216
s_add_u32 s48, s71, 43008
s_add_u32 m0, s48, 0
s_add_u32 s49, s68, 0
buffer_load_dwordx4 v26, s[28:31], s49 offen lds
buffer_load_dwordx4 v27, s[28:31], s49 offen offset:1024 lds
s_add_u32 m0, s48, 8192
s_add_u32 s49, s68, 2048
buffer_load_dwordx4 v26, s[28:31], s49 offen lds
buffer_load_dwordx4 v27, s[28:31], s49 offen offset:1024 lds
s_add_u32 m0, s48, 16384
s_add_u32 s49, s68, 4096
buffer_load_dwordx4 v26, s[28:31], s49 offen lds
buffer_load_dwordx4 v27, s[28:31], s49 offen offset:1024 lds
s_lshl_b32 s52, s41, 2
s_add_u32 s52, s52, s43
s_lshl_b32 s52, s52, 7
s_add_u32 s52, s52, 14163968
v_and_b32 v4, 15, v0
v_lshlrev_b32 v4, 2, v4
buffer_load_dword v5, v4, s[32:35], s52 offen sc1
s_mov_b32 s63, 0
s_waitcnt vmcnt(0)
poll_36:
v_cmp_gt_u32 vcc, 2, v5
s_cbranch_vccz polled_37
buffer_load_dword v5, v4, s[32:35], s52 offen sc1
s_add_u32 s63, s63, 1
s_cmp_lt_u32 s63, 0x80000
s_waitcnt vmcnt(0)
s_cbranch_scc1 poll_36
polled_37:
s_cmp_lg_u32 s43, 0
s_cbranch_scc1 nohp_38
s_cmp_eq_u32 s41, 0
s_cbranch_scc1 nohp_38
s_sub_u32 s53, s41, 1
s_lshl_b32 s52, s53, 2
s_add_u32 s52, s52, 0
s_lshl_b32 s52, s52, 7
s_add_u32 s52, s52, 14196736
v_and_b32 v4, 15, v0
v_lshlrev_b32 v4, 2, v4
buffer_load_dword v5, v4, s[32:35], s52 offen sc1
s_mov_b32 s63, 0
s_waitcnt vmcnt(0)
poll_39:
v_cmp_gt_u32 vcc, 1, v5
s_cbranch_vccz polled_40
buffer_load_dword v5, v4, s[32:35], s52 offen sc1
s_add_u32 s63, s63, 1
s_cmp_lt_u32 s63, 0x80000
s_waitcnt vmcnt(0)
s_cbranch_scc1 poll_39
polled_40:
nohp_38:
s_add_u32 s69, s47, 0
s_and_b32 s69, s69, 15
s_mul_i32 s67, s69, 2048
s_mul_i32 s68, s69, 393216
s_cmp_lg_u32 s43, 0
s_cbranch_scc1 nohalo_41
s_mov_b32 m0, 0
s_nop 0
buffer_load_dwordx4 v24, s[32:35], s67 offen sc1 lds
buffer_load_dwordx4 v25, s[32:35], s67 offen offset:1024 sc1 lds
nohalo_41:
s_add_u32 m0, s70, 0
s_nop 0
buffer_load_dwordx4 v20, s[32:35], s67 offen offset:0 sc1 lds
buffer_load_dwordx4 v21, s[32:35], s67 offen offset:1024 sc1 lds
buffer_load_dwordx4 v22, s[32:35], s67 offen offset:2048 sc1 lds
buffer_load_dwordx4 v23, s[32:35], s67 offen offset:3072 sc1 lds
s_add_u32 s69, s47, 1
s_and_b32 s69, s69, 15
s_mul_i32 s67, s69, 2048
s_mul_i32 s68, s69, 393216
s_cmp_lg_u32 s43, 0
s_cbranch_scc1 nohalo_42
s_mov_b32 m0, 43008
s_nop 0
buffer_load_dwordx4 v24, s[32:35], s67 offen sc1 lds
buffer_load_dwordx4 v25, s[32:35], s67 offen offset:1024 sc1 lds
nohalo_42:
s_add_u32 m0, s70, 43008
s_nop 0
buffer_load_dwordx4 v20, s[32:35], s67 offen offset:0 sc1 lds
buffer_load_dwordx4 v21, s[32:35], s67 offen offset:1024 sc1 lds
buffer_load_dwordx4 v22, s[32:35], s67 offen offset:2048 sc1 lds
buffer_load_dwordx4 v23, s[32:35], s67 offen offset:3072 sc1 lds
s_waitcnt vmcnt(4)
s_barrier
s_add_u32 s69, s47, 2
s_and_b32 s69, s69, 15
s_mul_i32 s67, s69, 2048
s_mul_i32 s68, s69, 393216
s_cmp_lg_u32 s43, 0
s_cbranch_scc1 nohalo_43
s_mov_b32 m0, 86016
s_nop 0
buffer_load_dwordx4 v24, s[32:35], s67 offen sc1 lds
buffer_load_dwordx4 v25, s[32:35], s67 offen offset:1024 sc1 lds
nohalo_43:
s_add_u32 m0, s70, 86016
s_nop 0
buffer_load_dwordx4 v20, s[32:35], s67 offen offset:0 sc1 lds
buffer_load_dwordx4 v21, s[32:35], s67 offen offset:1024 sc1 lds
buffer_load_dwordx4 v22, s[32:35], s67 offen offset:2048 sc1 lds
buffer_load_dwordx4 v23, s[32:35], s67 offen offset:3072 sc1 lds
s_add_u32 s48, s71, 86016
s_add_u32 m0, s48, 0
s_add_u32 s49, s68, 0
buffer_load_dwordx4 v26, s[28:31], s49 offen lds
buffer_load_dwordx4 v27, s[28:31], s49 offen offset:1024 lds
s_add_u32 m0, s48, 8192
s_add_u32 s49, s68, 2048
buffer_load_dwordx4 v26, s[28:31], s49 offen lds
buffer_load_dwordx4 v27, s[28:31], s49 offen offset:1024 lds
s_add_u32 m0, s48, 16384
s_add_u32 s49, s68, 4096
buffer_load_dwordx4 v26, s[28:31], s49 offen lds
buffer_load_dwordx4 v27, s[28:31], s49 offen offset:1024 lds
s_mov_b32 s64, 0
s_mov_b32 s65, 0
h2_loop:
s_waitcnt vmcnt(10)
s_barrier
s_cmp_eq_u32 s64, 2
s_cbranch_scc1 h2_hook0
s_cmp_eq_u32 s64, 3
s_cbranch_scc1 h2_hook1
s_cmp_eq_u32 s64, 4
s_cbranch_scc1 h2_hook2
h2_ret:
s_add_u32 s69, s69, 1
s_and_b32 s69, s69, 15
s_mul_i32 s67, s69, 2048
s_mul_i32 s68, s69, 393216
s_cmp_lg_u32 s43, 0
s_cbranch_scc1 nohalo_44
s_mov_b32 m0, s65
s_nop 0
buffer_load_dwordx4 v24, s[32:35], s67 offen sc1 lds
buffer_load_dwordx4 v25, s[32:35], s67 offen offset:1024 sc1 lds
nohalo_44:
s_add_u32 m0, s70, s65
s_nop 0
buffer_load_dwordx4 v20, s[32:35], s67 offen offset:0 sc1 lds
buffer_load_dwordx4 v21, s[32:35], s67 offen offset:1024 sc1 lds
buffer_load_dwordx4 v22, s[32:35], s67 offen offset:2048 sc1 lds
buffer_load_dwordx4 v23, s[32:35], s67 offen offset:3072 sc1 lds
s_add_u32 s48, s71, s65
s_add_u32 m0, s48, 0
s_add_u32 s49, s68, 0
buffer_load_dwordx4 v26, s[28:31], s49 offen lds
buffer_load_dwordx4 v27, s[28:31], s49 offen offset:1024 lds
s_add_u32 m0, s48, 8192
s_add_u32 s49, s68, 2048
buffer_load_dwordx4 v26, s[28:31], s49 offen lds
buffer_load_dwordx4 v27, s[28:31], s49 offen offset:1024 lds
s_add_u32 m0, s48, 16384
s_add_u32 s49, s68, 4096
buffer_load_dwordx4 v26, s[28:31], s49 offen lds
buffer_load_dwordx4 v27, s[28:31], s49 offen offset:1024 lds
s_add_u32 s65, s65, 43008
s_cmp_eq_u32 s65, 129024
s_cselect_b32 s65, 0, s65
s_add_u32 s64, s64, 1
s_cmp_lt_u32 s64, 13
s_cbranch_scc1 h2_loop
s_mov_b32 s28, s8
s_and_b32 s29, s9, 0xffff
s_mov_b32 s30, 2097152
s_mov_b32 s31, 0x00020000
s_waitcnt vmcnt(10)
s_barrier
s_lshl_b32 s48, s41, 3
s_lshl_b32 s49, s43, 1
s_add_u32 s48, s48, s49
s_lshl_b32 s48, s48, 15
s_lshl_b32 s49, s42, 11
s_add_u32 s48, s48, s49
s_add_u32 s48, s48, 4194304
s_add_u32 s49, s48, 32768
buffer_load_dwordx4 v[64:67], v18, s[32:35], s48 offen offset:0 sc1
buffer_load_dwordx4 v[68:71], v18, s[32:35], s48 offen offset:1024 sc1
buffer_load_dwordx4 v[72:75], v18, s[32:35], s49 offen offset:0 sc1
buffer_load_dwordx4 v[76:79], v18, s[32:35], s49 offen offset:1024 sc1
s_add_u32 s48, s47, 6
s_and_b32 s48, s48, 15
s_lshl_b32 s48, s48, 17
s_lshl_b32 s49, s43, 11
s_add_u32 m0, s49, 49152
s_nop 0
buffer_load_dwordx4 v28, s[28:31], s48 offen lds
buffer_load_dwordx4 v29, s[28:31], s48 offen offset:1024 lds
s_add_u32 s48, s47, 7
s_and_b32 s48, s48, 15
s_lshl_b32 s48, s48, 17
s_lshl_b32 s49, s43, 11
s_add_u32 m0, s49, 57344
s_nop 0
buffer_load_dwordx4 v28, s[28:31], s48 offen lds
buffer_load_dwordx4 v29, s[28:31], s48 offen offset:1024 lds
s_add_u32 s48, s47, 8
s_and_b32 s48, s48, 15
s_lshl_b32 s48, s48, 17
s_lshl_b32 s49, s43, 11
s_add_u32 m0, s49, 65536
s_nop 0
buffer_load_dwordx4 v28, s[28:31], s48 offen lds
buffer_load_dwordx4 v29, s[28:31], s48 offen offset:1024 lds
s_add_u32 s48, s47, 9
s_and_b32 s48, s48, 15
s_lshl_b32 s48, s48, 17
s_lshl_b32 s49, s43, 11
s_add_u32 m0, s49, 73728
s_nop 0
buffer_load_dwordx4 v28, s[28:31], s48 offen lds
buffer_load_dwordx4 v29, s[28:31], s48 offen offset:1024 lds
s_waitcnt vmcnt(8)
s_barrier
s_add_u32 s48, s47, 10
s_and_b32 s48, s48, 15
s_lshl_b32 s48, s48, 17
s_lshl_b32 s49, s43, 11
s_add_u32 m0, s49, 81920
s_nop 0
buffer_load_dwordx4 v28, s[28:31], s48 offen lds
buffer_load_dwordx4 v29, s[28:31], s48 offen offset:1024 lds
s_add_u32 s48, s47, 11
s_and_b32 s48, s48, 15
s_lshl_b32 s48, s48, 17
s_lshl_b32 s49, s43, 11
s_add_u32 m0, s49, 90112
s_nop 0
buffer_load_dwordx4 v28, s[28:31], s48 offen lds
buffer_load_dwordx4 v29, s[28:31], s48 offen offset:1024 lds
s_add_u32 s48, s47, 12
s_and_b32 s48, s48, 15
s_lshl_b32 s48, s48, 17
s_lshl_b32 s49, s43, 11
s_add_u32 m0, s49, 98304
s_nop 0
buffer_load_dwordx4 v28, s[28:31], s48 offen lds
buffer_load_dwordx4 v29, s[28:31], s48 offen offset:1024 lds
s_add_u32 s48, s47, 13
s_and_b32 s48, s48, 15
s_lshl_b32 s48, s48, 17
s_lshl_b32 s49, s43, 11
s_add_u32 m0, s49, 106496
s_nop 0
buffer_load_dwordx4 v28, s[28:31], s48 offen lds
buffer_load_dwordx4 v29, s[28:31], s48 offen offset:1024 lds
s_barrier
s_barrier
s_add_u32 s48, s47, 14
s_and_b32 s48, s48, 15
s_lshl_b32 s48, s48, 17
s_lshl_b32 s49, s43, 11
s_add_u32 m0, s49, 114688
s_nop 0
buffer_load_dwordx4 v28, s[28:31], s48 offen lds
buffer_load_dwordx4 v29, s[28:31], s48 offen offset:1024 lds
s_add_u32 s48, s47, 15
s_and_b32 s48, s48, 15
s_lshl_b32 s48, s48, 17
s_lshl_b32 s49, s43, 11
s_add_u32 m0, s49, 122880
s_nop 0
buffer_load_dwordx4 v28, s[28:31], s48 offen lds
buffer_load_dwordx4 v29, s[28:31], s48 offen offset:1024 lds
s_add_u32 s48, s47, 0
s_and_b32 s48, s48, 15
s_lshl_b32 s48, s48, 17
s_lshl_b32 s49, s43, 11
s_add_u32 m0, s49, 0
s_nop 0
buffer_load_dwordx4 v28, s[28:31], s48 offen lds
buffer_load_dwordx4 v29, s[28:31], s48 offen offset:1024 lds
s_add_u32 s48, s47, 1
s_and_b32 s48, s48, 15
s_lshl_b32 s48, s48, 17
s_lshl_b32 s49, s43, 11
s_add_u32 m0, s49, 8192
s_nop 0
buffer_load_dwordx4 v28, s[28:31], s48 offen lds
buffer_load_dwordx4 v29, s[28:31], s48 offen offset:1024 lds
s_add_u32 s48, s47, 2
s_and_b32 s48, s48, 15
s_lshl_b32 s48, s48, 17
s_lshl_b32 s49, s43, 11
s_add_u32 m0, s49, 16384
s_nop 0
buffer_load_dwordx4 v28, s[28:31], s48 offen lds
buffer_load_dwordx4 v29, s[28:31], s48 offen offset:1024 lds
s_add_u32 s48, s47, 3
s_and_b32 s48, s48, 15
s_lshl_b32 s48, s48, 17
s_lshl_b32 s49, s43, 11
s_add_u32 m0, s49, 24576
s_nop 0
buffer_load_dwordx4 v28, s[28:31], s48 offen lds
buffer_load_dwordx4 v29, s[28:31], s48 offen offset:1024 lds
s_add_u32 s48, s47, 4
s_and_b32 s48, s48, 15
s_lshl_b32 s48, s48, 17
s_lshl_b32 s49, s43, 11
s_add_u32 m0, s49, 32768
s_nop 0
buffer_load_dwordx4 v28, s[28:31], s48 offen lds
buffer_load_dwordx4 v29, s[28:31], s48 offen offset:1024 lds
s_add_u32 s48, s47, 5
s_and_b32 s48, s48, 15
s_lshl_b32 s48, s48, 17
s_lshl_b32 s49, s43, 11
s_add_u32 m0, s49, 40960
s_nop 0
buffer_load_dwordx4 v28, s[28:31], s48 offen lds
buffer_load_dwordx4 v29, s[28:31], s48 offen offset:1024 lds
s_waitcnt vmcnt(0)
s_barrier
s_mov_b32 s28, s12
s_and_b32 s29, s13, 0xffff
s_mov_b32 s30, 6291456
s_mov_b32 s31, 0x00020000
s_barrier
s_mov_b32 s36, s14
s_and_b32 s37, s15, 0xffff
s_mov_b32 s38, 65536
s_mov_b32 s39, 0x00020000
s_lshl_b32 s48, s42, 12
s_lshl_b32 s49, s43, 10
s_add_u32 s48, s48, s49
s_add_u32 m0, s49, 135168
s_nop 0
buffer_load_dwordx4 v18, s[36:39], s48 offen lds
s_add_u32 s69, s47, 0
s_and_b32 s69, s69, 15
s_mul_i32 s67, s69, 2048
s_mul_i32 s68, s69, 393216
s_add_u32 s48, s71, 0
s_add_u32 m0, s48, 0
s_add_u32 s49, s68, 0
buffer_load_dwordx4 v26, s[28:31], s49 offen lds
buffer_load_dwordx4 v27, s[28:31], s49 offen offset:1024 lds
s_add_u32 m0, s48, 8192
s_add_u32 s49, s68, 2048
buffer_load_dwordx4 v26, s[28:31], s49 offen lds
buffer_load_dwordx4 v27, s[28:31], s49 offen offset:1024 lds
s_add_u32 m0, s48, 16384
s_add_u32 s49, s68, 4096
buffer_load_dwordx4 v26, s[28:31], s49 offen lds
buffer_load_dwordx4 v27, s[28:31], s49 offen offset:1024 lds
s_add_u32 s69, s47, 1
s_and_b32 s69, s69, 15
s_mul_i32 s67, s69, 2048
s_mul_i32 s68, s69, 393216
s_add_u32 s48, s71, 43008
s_add_u32 m0, s48, 0
s_add_u32 s49, s68, 0
buffer_load_dwordx4 v26, s[28:31], s49 offen lds
buffer_load_dwordx4 v27, s[28:31], s49 offen offset:1024 lds
s_add_u32 m0, s48, 8192
s_add_u32 s49, s68, 2048
buffer_load_dwordx4 v26, s[28:31], s49 offen lds
buffer_load_dwordx4 v27, s[28:31], s49 offen offset:1024 lds
s_add_u32 m0, s48, 16384
s_add_u32 s49, s68, 4096
buffer_load_dwordx4 v26, s[28:31], s49 offen lds
buffer_load_dwordx4 v27, s[28:31], s49 offen offset:1024 lds
s_lshl_b32 s52, s41, 2
s_add_u32 s52, s52, s43
s_lshl_b32 s52, s52, 7
s_add_u32 s52, s52, 14163968
v_and_b32 v4, 15, v0
v_lshlrev_b32 v4, 2, v4
buffer_load_dword v5, v4, s[32:35], s52 offen sc1
s_mov_b32 s63, 0
s_waitcnt vmcnt(0)
poll_45:
v_cmp_gt_u32 vcc, 3, v5
s_cbranch_vccz polled_46
buffer_load_dword v5, v4, s[32:35], s52 offen sc1
s_add_u32 s63, s63, 1
s_cmp_lt_u32 s63, 0x80000
s_waitcnt vmcnt(0)
s_cbranch_scc1 poll_45
polled_46:
s_add_u32 s69, s47, 0
s_and_b32 s69, s69, 15
s_mul_i32 s67, s69, 2048
s_mul_i32 s68, s69, 393216
s_add_u32 m0, s70, 0
s_nop 0
buffer_load_dwordx4 v20, s[32:35], s67 offen offset:0 sc1 lds
buffer_load_dwordx4 v21, s[32:35], s67 offen offset:1024 sc1 lds
buffer_load_dwordx4 v22, s[32:35], s67 offen offset:2048 sc1 lds
buffer_load_dwordx4 v23, s[32:35], s67 offen offset:3072 sc1 lds
s_add_u32 s69, s47, 1
s_and_b32 s69, s69, 15
s_mul_i32 s67, s69, 2048
s_mul_i32 s68, s69, 393216
s_add_u32 m0, s70, 43008
s_nop 0
buffer_load_dwordx4 v20, s[32:35], s67 offen offset:0 sc1 lds
buffer_load_dwordx4 v21, s[32:35], s67 offen offset:1024 sc1 lds
buffer_load_dwordx4 v22, s[32:35], s67 offen offset:2048 sc1 lds
buffer_load_dwordx4 v23, s[32:35], s67 offen offset:3072 sc1 lds
s_waitcnt vmcnt(4)
s_barrier
s_add_u32 s69, s47, 2
s_and_b32 s69, s69, 15
s_mul_i32 s67, s69, 2048
s_mul_i32 s68, s69, 393216
s_add_u32 m0, s70, 86016
s_nop 0
buffer_load_dwordx4 v20, s[32:35], s67 offen offset:0 sc1 lds
buffer_load_dwordx4 v21, s[32:35], s67 offen offset:1024 sc1 lds
buffer_load_dwordx4 v22, s[32:35], s67 offen offset:2048 sc1 lds
buffer_load_dwordx4 v23, s[32:35], s67 offen offset:3072 sc1 lds
s_add_u32 s48, s71, 86016
s_add_u32 m0, s48, 0
s_add_u32 s49, s68, 0
buffer_load_dwordx4 v26, s[28:31], s49 offen lds
buffer_load_dwordx4 v27, s[28:31], s49 offen offset:1024 lds
s_add_u32 m0, s48, 8192
s_add_u32 s49, s68, 2048
buffer_load_dwordx4 v26, s[28:31], s49 offen lds
buffer_load_dwordx4 v27, s[28:31], s49 offen offset:1024 lds
s_add_u32 m0, s48, 16384
s_add_u32 s49, s68, 4096
buffer_load_dwordx4 v26, s[28:31], s49 offen lds
buffer_load_dwordx4 v27, s[28:31], s49 offen offset:1024 lds
s_mov_b32 s64, 0
s_mov_b32 s65, 0
h3_loop:
s_waitcnt vmcnt(10)
s_barrier
s_cmp_eq_u32 s64, 2
s_cbranch_scc1 h3_hook0
s_cmp_eq_u32 s64, 3
s_cbranch_scc1 h3_hook1
h3_ret:
s_add_u32 s69, s69, 1
s_and_b32 s69, s69, 15
s_mul_i32 s67, s69, 2048
s_mul_i32 s68, s69, 393216
s_add_u32 m0, s70, s65
s_nop 0
buffer_load_dwordx4 v20, s[32:35], s67 offen offset:0 sc1 lds
buffer_load_dwordx4 v21, s[32:35], s67 offen offset:1024 sc1 lds
buffer_load_dwordx4 v22, s[32:35], s67 offen offset:2048 sc1 lds
buffer_load_dwordx4 v23, s[32:35], s67 offen offset:3072 sc1 lds
s_add_u32 s48, s71, s65
s_add_u32 m0, s48, 0
s_add_u32 s49, s68, 0
buffer_load_dwordx4 v26, s[28:31], s49 offen lds
buffer_load_dwordx4 v27, s[28:31], s49 offen offset:1024 lds
s_add_u32 m0, s48, 8192
s_add_u32 s49, s68, 2048
buffer_load_dwordx4 v26, s[28:31], s49 offen lds
buffer_load_dwordx4 v27, s[28:31], s49 offen offset:1024 lds
s_add_u32 m0, s48, 16384
s_add_u32 s49, s68, 4096
buffer_load_dwordx4 v26, s[28:31], s49 offen lds
buffer_load_dwordx4 v27, s[28:31], s49 offen offset:1024 lds
s_add_u32 s65, s65, 43008
s_cmp_eq_u32 s65, 129024
s_cselect_b32 s65, 0, s65
s_add_u32 s64, s64, 1
s_cmp_lt_u32 s64, 13
s_cbranch_scc1 h3_loop
s_mov_b32 s28, s16
s_and_b32 s29, s17, 0xffff
s_mov_b32 s30, 2097152
s_mov_b32 s31, 0x00020000
s_waitcnt vmcnt(10)
s_barrier
s_lshl_b32 s48, s41, 3
s_lshl_b32 s49, s43, 1
s_add_u32 s48, s48, s49
s_lshl_b32 s48, s48, 15
s_lshl_b32 s49, s42, 11
s_add_u32 s48, s48, s49
s_add_u32 s48, s48, 4194304
s_add_u32 s49, s48, 32768
buffer_load_dwordx4 v[64:67], v18, s[32:35], s48 offen offset:0 sc1
buffer_load_dwordx4 v[68:71], v18, s[32:35], s48 offen offset:1024 sc1
buffer_load_dwordx4 v[72:75], v18, s[32:35], s49 offen offset:0 sc1
buffer_load_dwordx4 v[76:79], v18, s[32:35], s49 offen offset:1024 sc1
s_add_u32 s48, s47, 6
s_and_b32 s48, s48, 15
s_lshl_b32 s48, s48, 17
s_lshl_b32 s49, s43, 11
s_add_u32 m0, s49, 49152
s_nop 0
buffer_load_dwordx4 v28, s[28:31], s48 offen lds
buffer_load_dwordx4 v29, s[28:31], s48 offen offset:1024 lds
s_add_u32 s48, s47, 7
s_and_b32 s48, s48, 15
s_lshl_b32 s48, s48, 17
s_lshl_b32 s49, s43, 11
s_add_u32 m0, s49, 57344
s_nop 0
buffer_load_dwordx4 v28, s[28:31], s48 offen lds
buffer_load_dwordx4 v29, s[28:31], s48 offen offset:1024 lds
s_add_u32 s48, s47, 8
s_and_b32 s48, s48, 15
s_lshl_b32 s48, s48, 17
s_lshl_b32 s49, s43, 11
s_add_u32 m0, s49, 65536
s_nop 0
buffer_load_dwordx4 v28, s[28:31], s48 offen lds
buffer_load_dwordx4 v29, s[28:31], s48 offen offset:1024 lds
s_add_u32 s48, s47, 9
s_and_b32 s48, s48, 15
s_lshl_b32 s48, s48, 17
s_lshl_b32 s49, s43, 11
s_add_u32 m0, s49, 73728
s_nop 0
buffer_load_dwordx4 v28, s[28:31], s48 offen lds
buffer_load_dwordx4 v29, s[28:31], s48 offen offset:1024 lds
s_waitcnt vmcnt(8)
s_barrier
s_add_u32 s48, s47, 10
s_and_b32 s48, s48, 15
s_lshl_b32 s48, s48, 17
s_lshl_b32 s49, s43, 11
s_add_u32 m0, s49, 81920
s_nop 0
buffer_load_dwordx4 v28, s[28:31], s48 offen lds
buffer_load_dwordx4 v29, s[28:31], s48 offen offset:1024 lds
s_add_u32 s48, s47, 11
s_and_b32 s48, s48, 15
s_lshl_b32 s48, s48, 17
s_lshl_b32 s49, s43, 11
s_add_u32 m0, s49, 90112
s_nop 0
buffer_load_dwordx4 v28, s[28:31], s48 offen lds
buffer_load_dwordx4 v29, s[28:31], s48 offen offset:1024 lds
s_add_u32 s48, s47, 12
s_and_b32 s48, s48, 15
s_lshl_b32 s48, s48, 17
s_lshl_b32 s49, s43, 11
s_add_u32 m0, s49, 98304
s_nop 0
buffer_load_dwordx4 v28, s[28:31], s48 offen lds
buffer_load_dwordx4 v29, s[28:31], s48 offen offset:1024 lds
s_add_u32 s48, s47, 13
s_and_b32 s48, s48, 15
s_lshl_b32 s48, s48, 17
s_lshl_b32 s49, s43, 11
s_add_u32 m0, s49, 106496
s_nop 0
buffer_load_dwordx4 v28, s[28:31], s48 offen lds
buffer_load_dwordx4 v29, s[28:31], s48 offen offset:1024 lds
s_barrier
s_barrier
s_add_u32 s48, s47, 14
s_and_b32 s48, s48, 15
s_lshl_b32 s48, s48, 17
s_lshl_b32 s49, s43, 11
s_add_u32 m0, s49, 114688
s_nop 0
buffer_load_dwordx4 v28, s[28:31], s48 offen lds
buffer_load_dwordx4 v29, s[28:31], s48 offen offset:1024 lds
s_add_u32 s48, s47, 15
s_and_b32 s48, s48, 15
s_lshl_b32 s48, s48, 17
s_lshl_b32 s49, s43, 11
s_add_u32 m0, s49, 122880
s_nop 0
buffer_load_dwordx4 v28, s[28:31], s48 offen lds
buffer_load_dwordx4 v29, s[28:31], s48 offen offset:1024 lds
s_barrier
s_barrier
s_add_u32 s48, s47, 0
s_and_b32 s48, s48, 15
s_lshl_b32 s48, s48, 17
s_lshl_b32 s49, s43, 11
s_add_u32 m0, s49, 0
s_nop 0
buffer_load_dwordx4 v28, s[28:31], s48 offen lds
buffer_load_dwordx4 v29, s[28:31], s48 offen offset:1024 lds
s_add_u32 s48, s47, 1
s_and_b32 s48, s48, 15
s_lshl_b32 s48, s48, 17
s_lshl_b32 s49, s43, 11
s_add_u32 m0, s49, 8192
s_nop 0
buffer_load_dwordx4 v28, s[28:31], s48 offen lds
buffer_load_dwordx4 v29, s[28:31], s48 offen offset:1024 lds
s_add_u32 s48, s47, 2
s_and_b32 s48, s48, 15
s_lshl_b32 s48, s48, 17
s_lshl_b32 s49, s43, 11
s_add_u32 m0, s49, 16384
s_nop 0
buffer_load_dwordx4 v28, s[28:31], s48 offen lds
buffer_load_dwordx4 v29, s[28:31], s48 offen offset:1024 lds
s_add_u32 s48, s47, 3
s_and_b32 s48, s48, 15
s_lshl_b32 s48, s48, 17
s_lshl_b32 s49, s43, 11
s_add_u32 m0, s49, 24576
s_nop 0
buffer_load_dwordx4 v28, s[28:31], s48 offen lds
buffer_load_dwordx4 v29, s[28:31], s48 offen offset:1024 lds
s_add_u32 s48, s47, 4
s_and_b32 s48, s48, 15
s_lshl_b32 s48, s48, 17
s_lshl_b32 s49, s43, 11
s_add_u32 m0, s49, 32768
s_nop 0
buffer_load_dwordx4 v28, s[28:31], s48 offen lds
buffer_load_dwordx4 v29, s[28:31], s48 offen offset:1024 lds
s_add_u32 s48, s47, 5
s_and_b32 s48, s48, 15
s_lshl_b32 s48, s48, 17
s_lshl_b32 s49, s43, 11
s_add_u32 m0, s49, 40960
s_nop 0
buffer_load_dwordx4 v28, s[28:31], s48 offen lds
buffer_load_dwordx4 v29, s[28:31], s48 offen offset:1024 lds
s_waitcnt vmcnt(0)
s_barrier
s_barrier
L_end:
s_endpgm
slow_3:
v_pk_mul_f32 v[212:213], v[212:213], v[152:153] op_sel:[0,0] op_sel_hi:[1,0]
v_pk_mul_f32 v[214:215], v[214:215], v[152:153] op_sel:[0,0] op_sel_hi:[1,0]
v_pk_mul_f32 v[216:217], v[216:217], v[152:153] op_sel:[0,0] op_sel_hi:[1,0]
v_pk_mul_f32 v[218:219], v[218:219], v[152:153] op_sel:[0,0] op_sel_hi:[1,0]
v_cvt_pk_bf16_f32 v212, v212, v213
v_cvt_pk_bf16_f32 v213, v214, v215
v_cvt_pk_bf16_f32 v214, v216, v217
v_cvt_pk_bf16_f32 v215, v218, v219
buffer_store_dwordx4 v[212:215], v18, s[32:35], s48 offen sc1
v_pk_mul_f32 v[220:221], v[220:221], v[160:161] op_sel:[0,0] op_sel_hi:[1,0]
v_pk_mul_f32 v[222:223], v[222:223], v[160:161] op_sel:[0,0] op_sel_hi:[1,0]
v_pk_mul_f32 v[224:225], v[224:225], v[160:161] op_sel:[0,0] op_sel_hi:[1,0]
v_pk_mul_f32 v[226:227], v[226:227], v[160:161] op_sel:[0,0] op_sel_hi:[1,0]
v_cvt_pk_bf16_f32 v220, v220, v221
v_cvt_pk_bf16_f32 v221, v222, v223
v_cvt_pk_bf16_f32 v222, v224, v225
v_cvt_pk_bf16_f32 v223, v226, v227
buffer_store_dwordx4 v[220:223], v18, s[32:35], s49 offen sc1
v_pk_mul_f32 v[228:229], v[228:229], v[168:169] op_sel:[0,0] op_sel_hi:[1,0]
v_pk_mul_f32 v[230:231], v[230:231], v[168:169] op_sel:[0,0] op_sel_hi:[1,0]
v_pk_mul_f32 v[232:233], v[232:233], v[168:169] op_sel:[0,0] op_sel_hi:[1,0]
v_pk_mul_f32 v[234:235], v[234:235], v[168:169] op_sel:[0,0] op_sel_hi:[1,0]
v_cvt_pk_bf16_f32 v228, v228, v229
v_cvt_pk_bf16_f32 v229, v230, v231
v_cvt_pk_bf16_f32 v230, v232, v233
v_cvt_pk_bf16_f32 v231, v234, v235
buffer_store_dwordx4 v[228:231], v18, s[32:35], s50 offen sc1
v_pk_mul_f32 v[236:237], v[236:237], v[176:177] op_sel:[0,0] op_sel_hi:[1,0]
v_pk_mul_f32 v[238:239], v[238:239], v[176:177] op_sel:[0,0] op_sel_hi:[1,0]
v_pk_mul_f32 v[240:241], v[240:241], v[176:177] op_sel:[0,0] op_sel_hi:[1,0]
v_pk_mul_f32 v[242:243], v[242:243], v[176:177] op_sel:[0,0] op_sel_hi:[1,0]
v_cvt_pk_bf16_f32 v236, v236, v237
v_cvt_pk_bf16_f32 v237, v238, v239
v_cvt_pk_bf16_f32 v238, v240, v241
v_cvt_pk_bf16_f32 v239, v242, v243
buffer_store_dwordx4 v[236:239], v18, s[32:35], s51 offen sc1
s_waitcnt vmcnt(0)
s_lshl_b32 s62, s45, 2
v_mov_b32 v4, s62
v_mov_b32 v5, 1
s_mov_b64 exec, 1
buffer_store_dword v5, v4, s[32:35], s52 offen sc1
s_mov_b64 exec, -1
s_branch back_4

slow_7:
v_lshlrev_b32 v4, 16, v88
v_and_b32 v5, 0xffff0000, v88
v_pk_add_f32 v[20:21], v[20:21], v[4:5]
v_lshlrev_b32 v4, 16, v89
v_and_b32 v5, 0xffff0000, v89
v_pk_add_f32 v[22:23], v[22:23], v[4:5]
v_lshlrev_b32 v4, 16, v90
v_and_b32 v5, 0xffff0000, v90
v_pk_add_f32 v[24:25], v[24:25], v[4:5]
v_lshlrev_b32 v4, 16, v91
v_and_b32 v5, 0xffff0000, v91
v_pk_add_f32 v[26:27], v[26:27], v[4:5]
v_cvt_pk_bf16_f32 v20, v20, v21
v_cvt_pk_bf16_f32 v21, v22, v23
v_cvt_pk_bf16_f32 v22, v24, v25
v_cvt_pk_bf16_f32 v23, v26, v27
buffer_store_dwordx4 v[20:23], v18, s[32:35], s48 offen offset:0 sc1
v_lshlrev_b32 v4, 16, v92
v_and_b32 v5, 0xffff0000, v92
v_pk_add_f32 v[28:29], v[28:29], v[4:5]
v_lshlrev_b32 v4, 16, v93
v_and_b32 v5, 0xffff0000, v93
v_pk_add_f32 v[30:31], v[30:31], v[4:5]
v_lshlrev_b32 v4, 16, v94
v_and_b32 v5, 0xffff0000, v94
v_pk_add_f32 v[32:33], v[32:33], v[4:5]
v_lshlrev_b32 v4, 16, v95
v_and_b32 v5, 0xffff0000, v95
v_pk_add_f32 v[34:35], v[34:35], v[4:5]
v_cvt_pk_bf16_f32 v28, v28, v29
v_cvt_pk_bf16_f32 v29, v30, v31
v_cvt_pk_bf16_f32 v30, v32, v33
v_cvt_pk_bf16_f32 v31, v34, v35
buffer_store_dwordx4 v[28:31], v18, s[32:35], s48 offen offset:1024 sc1
v_lshlrev_b32 v4, 16, v96
v_and_b32 v5, 0xffff0000, v96
v_pk_add_f32 v[36:37], v[36:37], v[4:5]
v_lshlrev_b32 v4, 16, v97
v_and_b32 v5, 0xffff0000, v97
v_pk_add_f32 v[38:39], v[38:39], v[4:5]
v_lshlrev_b32 v4, 16, v98
v_and_b32 v5, 0xffff0000, v98
v_pk_add_f32 v[40:41], v[40:41], v[4:5]
v_lshlrev_b32 v4, 16, v99
v_and_b32 v5, 0xffff0000, v99
v_pk_add_f32 v[42:43], v[42:43], v[4:5]
v_cvt_pk_bf16_f32 v36, v36, v37
v_cvt_pk_bf16_f32 v37, v38, v39
v_cvt_pk_bf16_f32 v38, v40, v41
v_cvt_pk_bf16_f32 v39, v42, v43
buffer_store_dwordx4 v[36:39], v18, s[32:35], s49 offen offset:0 sc1
v_lshlrev_b32 v4, 16, v100
v_and_b32 v5, 0xffff0000, v100
v_pk_add_f32 v[44:45], v[44:45], v[4:5]
v_lshlrev_b32 v4, 16, v101
v_and_b32 v5, 0xffff0000, v101
v_pk_add_f32 v[46:47], v[46:47], v[4:5]
v_lshlrev_b32 v4, 16, v102
v_and_b32 v5, 0xffff0000, v102
v_pk_add_f32 v[48:49], v[48:49], v[4:5]
v_lshlrev_b32 v4, 16, v103
v_and_b32 v5, 0xffff0000, v103
v_pk_add_f32 v[50:51], v[50:51], v[4:5]
v_cvt_pk_bf16_f32 v44, v44, v45
v_cvt_pk_bf16_f32 v45, v46, v47
v_cvt_pk_bf16_f32 v46, v48, v49
v_cvt_pk_bf16_f32 v47, v50, v51
buffer_store_dwordx4 v[44:47], v18, s[32:35], s49 offen offset:1024 sc1
v_dot2c_f32_bf16 v6, v20, v10
v_dot2c_f32_bf16 v8, v20, v20
v_dot2c_f32_bf16 v7, v36, v10
v_dot2c_f32_bf16 v9, v36, v36
v_dot2c_f32_bf16 v6, v21, v10
v_dot2c_f32_bf16 v8, v21, v21
v_dot2c_f32_bf16 v7, v37, v10
v_dot2c_f32_bf16 v9, v37, v37
v_dot2c_f32_bf16 v6, v22, v10
v_dot2c_f32_bf16 v8, v22, v22
v_dot2c_f32_bf16 v7, v38, v10
v_dot2c_f32_bf16 v9, v38, v38
v_dot2c_f32_bf16 v6, v23, v10
v_dot2c_f32_bf16 v8, v23, v23
v_dot2c_f32_bf16 v7, v39, v10
v_dot2c_f32_bf16 v9, v39, v39
v_dot2c_f32_bf16 v6, v28, v10
v_dot2c_f32_bf16 v8, v28, v28
v_dot2c_f32_bf16 v7, v44, v10
v_dot2c_f32_bf16 v9, v44, v44
v_dot2c_f32_bf16 v6, v29, v10
v_dot2c_f32_bf16 v8, v29, v29
v_dot2c_f32_bf16 v7, v45, v10
v_dot2c_f32_bf16 v9, v45, v45
v_dot2c_f32_bf16 v6, v30, v10
v_dot2c_f32_bf16 v8, v30, v30
v_dot2c_f32_bf16 v7, v46, v10
v_dot2c_f32_bf16 v9, v46, v46
v_dot2c_f32_bf16 v6, v31, v10
v_dot2c_f32_bf16 v8, v31, v31
v_dot2c_f32_bf16 v7, v47, v10
v_dot2c_f32_bf16 v9, v47, v47
s_nop 1
s_nop 1
v_permlane32_swap_b32 v6, v7
v_permlane32_swap_b32 v8, v9
s_nop 0
v_add_f32 v6, v6, v7
v_add_f32 v8, v8, v9
s_nop 1
v_permlane16_swap_b32 v6, v8
s_nop 0
v_add_f32 v6, v6, v8
buffer_store_dword v6, v19, s[32:35], s50 offen sc1
s_waitcnt vmcnt(0)
s_lshl_b32 s62, s42, 2
v_mov_b32 v4, s62
v_mov_b32 v5, 1
s_mov_b64 exec, 1
buffer_store_dword v5, v4, s[32:35], s52 offen sc1
s_mov_b64 exec, -1
s_branch back_8

slow_11:
v_pk_mul_f32 v[164:165], v[164:165], v[48:49] op_sel:[0,0] op_sel_hi:[1,0]
v_pk_mul_f32 v[166:167], v[166:167], v[48:49] op_sel:[0,0] op_sel_hi:[1,0]
v_pk_mul_f32 v[168:169], v[168:169], v[48:49] op_sel:[0,0] op_sel_hi:[1,0]
v_pk_mul_f32 v[170:171], v[170:171], v[48:49] op_sel:[0,0] op_sel_hi:[1,0]
v_cvt_pk_bf16_f32 v164, v164, v165
v_cvt_pk_bf16_f32 v165, v166, v167
v_cvt_pk_bf16_f32 v166, v168, v169
v_cvt_pk_bf16_f32 v167, v170, v171
buffer_store_dwordx4 v[164:167], v18, s[32:35], s48 offen sc1
v_pk_mul_f32 v[172:173], v[172:173], v[48:49] op_sel:[0,1] op_sel_hi:[1,1]
v_pk_mul_f32 v[174:175], v[174:175], v[48:49] op_sel:[0,1] op_sel_hi:[1,1]
v_pk_mul_f32 v[176:177], v[176:177], v[48:49] op_sel:[0,1] op_sel_hi:[1,1]
v_pk_mul_f32 v[178:179], v[178:179], v[48:49] op_sel:[0,1] op_sel_hi:[1,1]
v_cvt_pk_bf16_f32 v172, v172, v173
v_cvt_pk_bf16_f32 v173, v174, v175
v_cvt_pk_bf16_f32 v174, v176, v177
v_cvt_pk_bf16_f32 v175, v178, v179
buffer_store_dwordx4 v[172:175], v18, s[32:35], s49 offen sc1
v_pk_mul_f32 v[180:181], v[180:181], v[50:51] op_sel:[0,0] op_sel_hi:[1,0]
v_pk_mul_f32 v[182:183], v[182:183], v[50:51] op_sel:[0,0] op_sel_hi:[1,0]
v_pk_mul_f32 v[184:185], v[184:185], v[50:51] op_sel:[0,0] op_sel_hi:[1,0]
v_pk_mul_f32 v[186:187], v[186:187], v[50:51] op_sel:[0,0] op_sel_hi:[1,0]
v_cvt_pk_bf16_f32 v180, v180, v181
v_cvt_pk_bf16_f32 v181, v182, v183
v_cvt_pk_bf16_f32 v182, v184, v185
v_cvt_pk_bf16_f32 v183, v186, v187
buffer_store_dwordx4 v[180:183], v18, s[32:35], s50 offen sc1
v_pk_mul_f32 v[188:189], v[188:189], v[50:51] op_sel:[0,1] op_sel_hi:[1,1]
v_pk_mul_f32 v[190:191], v[190:191], v[50:51] op_sel:[0,1] op_sel_hi:[1,1]
v_pk_mul_f32 v[192:193], v[192:193], v[50:51] op_sel:[0,1] op_sel_hi:[1,1]
v_pk_mul_f32 v[194:195], v[194:195], v[50:51] op_sel:[0,1] op_sel_hi:[1,1]
v_cvt_pk_bf16_f32 v188, v188, v189
v_cvt_pk_bf16_f32 v189, v190, v191
v_cvt_pk_bf16_f32 v190, v192, v193
v_cvt_pk_bf16_f32 v191, v194, v195
buffer_store_dwordx4 v[188:191], v18, s[32:35], s51 offen sc1
s_waitcnt vmcnt(0)
s_lshl_b32 s62, s45, 2
v_mov_b32 v4, s62
v_mov_b32 v5, 2
s_mov_b64 exec, 1
buffer_store_dword v5, v4, s[32:35], s52 offen sc1
s_mov_b64 exec, -1
s_branch back_12

slow_15:
v_lshlrev_b32 v4, 16, v88
v_and_b32 v5, 0xffff0000, v88
v_pk_add_f32 v[20:21], v[20:21], v[4:5]
v_lshlrev_b32 v4, 16, v89
v_and_b32 v5, 0xffff0000, v89
v_pk_add_f32 v[22:23], v[22:23], v[4:5]
v_lshlrev_b32 v4, 16, v90
v_and_b32 v5, 0xffff0000, v90
v_pk_add_f32 v[24:25], v[24:25], v[4:5]
v_lshlrev_b32 v4, 16, v91
v_and_b32 v5, 0xffff0000, v91
v_pk_add_f32 v[26:27], v[26:27], v[4:5]
v_cvt_pk_bf16_f32 v20, v20, v21
v_cvt_pk_bf16_f32 v21, v22, v23
v_cvt_pk_bf16_f32 v22, v24, v25
v_cvt_pk_bf16_f32 v23, v26, v27
buffer_store_dwordx4 v[20:23], v18, s[32:35], s48 offen offset:0 sc1
v_lshlrev_b32 v4, 16, v92
v_and_b32 v5, 0xffff0000, v92
v_pk_add_f32 v[28:29], v[28:29], v[4:5]
v_lshlrev_b32 v4, 16, v93
v_and_b32 v5, 0xffff0000, v93
v_pk_add_f32 v[30:31], v[30:31], v[4:5]
v_lshlrev_b32 v4, 16, v94
v_and_b32 v5, 0xffff0000, v94
v_pk_add_f32 v[32:33], v[32:33], v[4:5]
v_lshlrev_b32 v4, 16, v95
v_and_b32 v5, 0xffff0000, v95
v_pk_add_f32 v[34:35], v[34:35], v[4:5]
v_cvt_pk_bf16_f32 v28, v28, v29
v_cvt_pk_bf16_f32 v29, v30, v31
v_cvt_pk_bf16_f32 v30, v32, v33
v_cvt_pk_bf16_f32 v31, v34, v35
buffer_store_dwordx4 v[28:31], v18, s[32:35], s48 offen offset:1024 sc1
v_lshlrev_b32 v4, 16, v96
v_and_b32 v5, 0xffff0000, v96
v_pk_add_f32 v[36:37], v[36:37], v[4:5]
v_lshlrev_b32 v4, 16, v97
v_and_b32 v5, 0xffff0000, v97
v_pk_add_f32 v[38:39], v[38:39], v[4:5]
v_lshlrev_b32 v4, 16, v98
v_and_b32 v5, 0xffff0000, v98
v_pk_add_f32 v[40:41], v[40:41], v[4:5]
v_lshlrev_b32 v4, 16, v99
v_and_b32 v5, 0xffff0000, v99
v_pk_add_f32 v[42:43], v[42:43], v[4:5]
v_cvt_pk_bf16_f32 v36, v36, v37
v_cvt_pk_bf16_f32 v37, v38, v39
v_cvt_pk_bf16_f32 v38, v40, v41
v_cvt_pk_bf16_f32 v39, v42, v43
buffer_store_dwordx4 v[36:39], v18, s[32:35], s49 offen offset:0 sc1
v_lshlrev_b32 v4, 16, v100
v_and_b32 v5, 0xffff0000, v100
v_pk_add_f32 v[44:45], v[44:45], v[4:5]
v_lshlrev_b32 v4, 16, v101
v_and_b32 v5, 0xffff0000, v101
v_pk_add_f32 v[46:47], v[46:47], v[4:5]
v_lshlrev_b32 v4, 16, v102
v_and_b32 v5, 0xffff0000, v102
v_pk_add_f32 v[48:49], v[48:49], v[4:5]
v_lshlrev_b32 v4, 16, v103
v_and_b32 v5, 0xffff0000, v103
v_pk_add_f32 v[50:51], v[50:51], v[4:5]
v_cvt_pk_bf16_f32 v44, v44, v45
v_cvt_pk_bf16_f32 v45, v46, v47
v_cvt_pk_bf16_f32 v46, v48, v49
v_cvt_pk_bf16_f32 v47, v50, v51
buffer_store_dwordx4 v[44:47], v18, s[32:35], s49 offen offset:1024 sc1
v_dot2c_f32_bf16 v6, v20, v10
v_dot2c_f32_bf16 v8, v20, v20
v_dot2c_f32_bf16 v7, v36, v10
v_dot2c_f32_bf16 v9, v36, v36
v_dot2c_f32_bf16 v6, v21, v10
v_dot2c_f32_bf16 v8, v21, v21
v_dot2c_f32_bf16 v7, v37, v10
v_dot2c_f32_bf16 v9, v37, v37
v_dot2c_f32_bf16 v6, v22, v10
v_dot2c_f32_bf16 v8, v22, v22
v_dot2c_f32_bf16 v7, v38, v10
v_dot2c_f32_bf16 v9, v38, v38
v_dot2c_f32_bf16 v6, v23, v10
v_dot2c_f32_bf16 v8, v23, v23
v_dot2c_f32_bf16 v7, v39, v10
v_dot2c_f32_bf16 v9, v39, v39
v_dot2c_f32_bf16 v6, v28, v10
v_dot2c_f32_bf16 v8, v28, v28
v_dot2c_f32_bf16 v7, v44, v10
v_dot2c_f32_bf16 v9, v44, v44
v_dot2c_f32_bf16 v6, v29, v10
v_dot2c_f32_bf16 v8, v29, v29
v_dot2c_f32_bf16 v7, v45, v10
v_dot2c_f32_bf16 v9, v45, v45
v_dot2c_f32_bf16 v6, v30, v10
v_dot2c_f32_bf16 v8, v30, v30
v_dot2c_f32_bf16 v7, v46, v10
v_dot2c_f32_bf16 v9, v46, v46
v_dot2c_f32_bf16 v6, v31, v10
v_dot2c_f32_bf16 v8, v31, v31
v_dot2c_f32_bf16 v7, v47, v10
v_dot2c_f32_bf16 v9, v47, v47
s_nop 1
s_nop 1
v_permlane32_swap_b32 v6, v7
v_permlane32_swap_b32 v8, v9
s_nop 0
v_add_f32 v6, v6, v7
v_add_f32 v8, v8, v9
s_nop 1
v_permlane16_swap_b32 v6, v8
s_nop 0
v_add_f32 v6, v6, v8
buffer_store_dword v6, v19, s[32:35], s50 offen sc1
s_cmp_lg_u32 s40, 3
s_cbranch_scc1 nohalo_100018
s_lshl_b32 s53, s41, 15
s_lshl_b32 s54, s42, 11
s_add_u32 s53, s53, s54
s_add_u32 s53, s53, 12713984
buffer_store_dwordx4 v[36:39], v18, s[32:35], s53 offen offset:0 sc1
buffer_store_dwordx4 v[44:47], v18, s[32:35], s53 offen offset:1024 sc1
s_lshl_b32 s53, s41, 4
s_add_u32 s53, s53, s42
s_lshl_b32 s53, s53, 8
s_add_u32 s53, s53, 13565952
buffer_store_dword v6, v19, s[32:35], s53 offen sc1
s_waitcnt vmcnt(3)
s_lshl_b32 s62, s42, 2
v_mov_b32 v4, s62
v_mov_b32 v5, 2
s_mov_b64 exec, 1
buffer_store_dword v5, v4, s[32:35], s52 offen sc1
s_mov_b64 exec, -1
s_lshl_b32 s53, s41, 2
s_add_u32 s53, s53, 0
s_lshl_b32 s53, s53, 7
s_add_u32 s53, s53, 14196736
s_waitcnt vmcnt(0)
s_lshl_b32 s62, s42, 2
v_mov_b32 v4, s62
v_mov_b32 v5, 1
s_mov_b64 exec, 1
buffer_store_dword v5, v4, s[32:35], s53 offen sc1
s_mov_b64 exec, -1
nohalo_100018:
s_waitcnt vmcnt(0)
s_lshl_b32 s62, s42, 2
v_mov_b32 v4, s62
v_mov_b32 v5, 2
s_mov_b64 exec, 1
buffer_store_dword v5, v4, s[32:35], s52 offen sc1
s_mov_b64 exec, -1
s_branch back_16

slow_18:
v_pk_mul_f32 v[212:213], v[212:213], v[152:153] op_sel:[0,0] op_sel_hi:[1,0]
v_pk_mul_f32 v[214:215], v[214:215], v[152:153] op_sel:[0,0] op_sel_hi:[1,0]
v_pk_mul_f32 v[216:217], v[216:217], v[152:153] op_sel:[0,0] op_sel_hi:[1,0]
v_pk_mul_f32 v[218:219], v[218:219], v[152:153] op_sel:[0,0] op_sel_hi:[1,0]
v_cvt_pk_bf16_f32 v212, v212, v213
v_cvt_pk_bf16_f32 v213, v214, v215
v_cvt_pk_bf16_f32 v214, v216, v217
v_cvt_pk_bf16_f32 v215, v218, v219
buffer_store_dwordx4 v[212:215], v18, s[32:35], s48 offen sc1
v_pk_mul_f32 v[220:221], v[220:221], v[160:161] op_sel:[0,0] op_sel_hi:[1,0]
v_pk_mul_f32 v[222:223], v[222:223], v[160:161] op_sel:[0,0] op_sel_hi:[1,0]
v_pk_mul_f32 v[224:225], v[224:225], v[160:161] op_sel:[0,0] op_sel_hi:[1,0]
v_pk_mul_f32 v[226:227], v[226:227], v[160:161] op_sel:[0,0] op_sel_hi:[1,0]
v_cvt_pk_bf16_f32 v220, v220, v221
v_cvt_pk_bf16_f32 v221, v222, v223
v_cvt_pk_bf16_f32 v222, v224, v225
v_cvt_pk_bf16_f32 v223, v226, v227
buffer_store_dwordx4 v[220:223], v18, s[32:35], s49 offen sc1
v_pk_mul_f32 v[228:229], v[228:229], v[168:169] op_sel:[0,0] op_sel_hi:[1,0]
v_pk_mul_f32 v[230:231], v[230:231], v[168:169] op_sel:[0,0] op_sel_hi:[1,0]
v_pk_mul_f32 v[232:233], v[232:233], v[168:169] op_sel:[0,0] op_sel_hi:[1,0]
v_pk_mul_f32 v[234:235], v[234:235], v[168:169] op_sel:[0,0] op_sel_hi:[1,0]
v_cvt_pk_bf16_f32 v228, v228, v229
v_cvt_pk_bf16_f32 v229, v230, v231
v_cvt_pk_bf16_f32 v230, v232, v233
v_cvt_pk_bf16_f32 v231, v234, v235
buffer_store_dwordx4 v[228:231], v18, s[32:35], s50 offen sc1
v_pk_mul_f32 v[236:237], v[236:237], v[176:177] op_sel:[0,0] op_sel_hi:[1,0]
v_pk_mul_f32 v[238:239], v[238:239], v[176:177] op_sel:[0,0] op_sel_hi:[1,0]
v_pk_mul_f32 v[240:241], v[240:241], v[176:177] op_sel:[0,0] op_sel_hi:[1,0]
v_pk_mul_f32 v[242:243], v[242:243], v[176:177] op_sel:[0,0] op_sel_hi:[1,0]
v_cvt_pk_bf16_f32 v236, v236, v237
v_cvt_pk_bf16_f32 v237, v238, v239
v_cvt_pk_bf16_f32 v238, v240, v241
v_cvt_pk_bf16_f32 v239, v242, v243
buffer_store_dwordx4 v[236:239], v18, s[32:35], s51 offen sc1
s_waitcnt vmcnt(0)
s_lshl_b32 s62, s45, 2
v_mov_b32 v4, s62
v_mov_b32 v5, 3
s_mov_b64 exec, 1
buffer_store_dword v5, v4, s[32:35], s52 offen sc1
s_mov_b64 exec, -1
s_branch back_19

slow_22:
v_lshlrev_b32 v4, 16, v88
v_and_b32 v5, 0xffff0000, v88
v_pk_add_f32 v[20:21], v[20:21], v[4:5]
v_lshlrev_b32 v4, 16, v89
v_and_b32 v5, 0xffff0000, v89
v_pk_add_f32 v[22:23], v[22:23], v[4:5]
v_lshlrev_b32 v4, 16, v90
v_and_b32 v5, 0xffff0000, v90
v_pk_add_f32 v[24:25], v[24:25], v[4:5]
v_lshlrev_b32 v4, 16, v91
v_and_b32 v5, 0xffff0000, v91
v_pk_add_f32 v[26:27], v[26:27], v[4:5]
v_cvt_pk_bf16_f32 v20, v20, v21
v_cvt_pk_bf16_f32 v21, v22, v23
v_cvt_pk_bf16_f32 v22, v24, v25
v_cvt_pk_bf16_f32 v23, v26, v27
buffer_store_dwordx4 v[20:23], v18, s[32:35], s48 offen offset:0 sc1
v_lshlrev_b32 v4, 16, v92
v_and_b32 v5, 0xffff0000, v92
v_pk_add_f32 v[28:29], v[28:29], v[4:5]
v_lshlrev_b32 v4, 16, v93
v_and_b32 v5, 0xffff0000, v93
v_pk_add_f32 v[30:31], v[30:31], v[4:5]
v_lshlrev_b32 v4, 16, v94
v_and_b32 v5, 0xffff0000, v94
v_pk_add_f32 v[32:33], v[32:33], v[4:5]
v_lshlrev_b32 v4, 16, v95
v_and_b32 v5, 0xffff0000, v95
v_pk_add_f32 v[34:35], v[34:35], v[4:5]
v_cvt_pk_bf16_f32 v28, v28, v29
v_cvt_pk_bf16_f32 v29, v30, v31
v_cvt_pk_bf16_f32 v30, v32, v33
v_cvt_pk_bf16_f32 v31, v34, v35
buffer_store_dwordx4 v[28:31], v18, s[32:35], s48 offen offset:1024 sc1
v_lshlrev_b32 v4, 16, v96
v_and_b32 v5, 0xffff0000, v96
v_pk_add_f32 v[36:37], v[36:37], v[4:5]
v_lshlrev_b32 v4, 16, v97
v_and_b32 v5, 0xffff0000, v97
v_pk_add_f32 v[38:39], v[38:39], v[4:5]
v_lshlrev_b32 v4, 16, v98
v_and_b32 v5, 0xffff0000, v98
v_pk_add_f32 v[40:41], v[40:41], v[4:5]
v_lshlrev_b32 v4, 16, v99
v_and_b32 v5, 0xffff0000, v99
v_pk_add_f32 v[42:43], v[42:43], v[4:5]
v_cvt_pk_bf16_f32 v36, v36, v37
v_cvt_pk_bf16_f32 v37, v38, v39
v_cvt_pk_bf16_f32 v38, v40, v41
v_cvt_pk_bf16_f32 v39, v42, v43
buffer_store_dwordx4 v[36:39], v18, s[32:35], s49 offen offset:0 sc1
v_lshlrev_b32 v4, 16, v100
v_and_b32 v5, 0xffff0000, v100
v_pk_add_f32 v[44:45], v[44:45], v[4:5]
v_lshlrev_b32 v4, 16, v101
v_and_b32 v5, 0xffff0000, v101
v_pk_add_f32 v[46:47], v[46:47], v[4:5]
v_lshlrev_b32 v4, 16, v102
v_and_b32 v5, 0xffff0000, v102
v_pk_add_f32 v[48:49], v[48:49], v[4:5]
v_lshlrev_b32 v4, 16, v103
v_and_b32 v5, 0xffff0000, v103
v_pk_add_f32 v[50:51], v[50:51], v[4:5]
v_cvt_pk_bf16_f32 v44, v44, v45
v_cvt_pk_bf16_f32 v45, v46, v47
v_cvt_pk_bf16_f32 v46, v48, v49
v_cvt_pk_bf16_f32 v47, v50, v51
buffer_store_dwordx4 v[44:47], v18, s[32:35], s49 offen offset:1024 sc1
v_dot2c_f32_bf16 v6, v20, v10
v_dot2c_f32_bf16 v8, v20, v20
v_dot2c_f32_bf16 v7, v36, v10
v_dot2c_f32_bf16 v9, v36, v36
v_dot2c_f32_bf16 v6, v21, v10
v_dot2c_f32_bf16 v8, v21, v21
v_dot2c_f32_bf16 v7, v37, v10
v_dot2c_f32_bf16 v9, v37, v37
v_dot2c_f32_bf16 v6, v22, v10
v_dot2c_f32_bf16 v8, v22, v22
v_dot2c_f32_bf16 v7, v38, v10
v_dot2c_f32_bf16 v9, v38, v38
v_dot2c_f32_bf16 v6, v23, v10
v_dot2c_f32_bf16 v8, v23, v23
v_dot2c_f32_bf16 v7, v39, v10
v_dot2c_f32_bf16 v9, v39, v39
v_dot2c_f32_bf16 v6, v28, v10
v_dot2c_f32_bf16 v8, v28, v28
v_dot2c_f32_bf16 v7, v44, v10
v_dot2c_f32_bf16 v9, v44, v44
v_dot2c_f32_bf16 v6, v29, v10
v_dot2c_f32_bf16 v8, v29, v29
v_dot2c_f32_bf16 v7, v45, v10
v_dot2c_f32_bf16 v9, v45, v45
v_dot2c_f32_bf16 v6, v30, v10
v_dot2c_f32_bf16 v8, v30, v30
v_dot2c_f32_bf16 v7, v46, v10
v_dot2c_f32_bf16 v9, v46, v46
v_dot2c_f32_bf16 v6, v31, v10
v_dot2c_f32_bf16 v8, v31, v31
v_dot2c_f32_bf16 v7, v47, v10
v_dot2c_f32_bf16 v9, v47, v47
s_nop 1
s_nop 1
v_permlane32_swap_b32 v6, v7
v_permlane32_swap_b32 v8, v9
s_nop 0
v_add_f32 v6, v6, v7
v_add_f32 v8, v8, v9
s_nop 1
v_permlane16_swap_b32 v6, v8
s_nop 0
v_add_f32 v6, v6, v8
buffer_store_dword v6, v19, s[32:35], s50 offen sc1
s_waitcnt vmcnt(0)
s_lshl_b32 s62, s42, 2
v_mov_b32 v4, s62
v_mov_b32 v5, 3
s_mov_b64 exec, 1
buffer_store_dword v5, v4, s[32:35], s52 offen sc1
s_mov_b64 exec, -1
s_branch back_23

slow_26:
v_pk_mul_f32 v[164:165], v[164:165], v[48:49] op_sel:[0,0] op_sel_hi:[1,0]
v_pk_mul_f32 v[166:167], v[166:167], v[48:49] op_sel:[0,0] op_sel_hi:[1,0]
v_pk_mul_f32 v[168:169], v[168:169], v[48:49] op_sel:[0,0] op_sel_hi:[1,0]
v_pk_mul_f32 v[170:171], v[170:171], v[48:49] op_sel:[0,0] op_sel_hi:[1,0]
v_cvt_pk_bf16_f32 v164, v164, v165
v_cvt_pk_bf16_f32 v165, v166, v167
v_cvt_pk_bf16_f32 v166, v168, v169
v_cvt_pk_bf16_f32 v167, v170, v171
buffer_store_dwordx4 v[164:167], v18, s[32:35], s48 offen sc1
v_pk_mul_f32 v[172:173], v[172:173], v[48:49] op_sel:[0,1] op_sel_hi:[1,1]
v_pk_mul_f32 v[174:175], v[174:175], v[48:49] op_sel:[0,1] op_sel_hi:[1,1]
v_pk_mul_f32 v[176:177], v[176:177], v[48:49] op_sel:[0,1] op_sel_hi:[1,1]
v_pk_mul_f32 v[178:179], v[178:179], v[48:49] op_sel:[0,1] op_sel_hi:[1,1]
v_cvt_pk_bf16_f32 v172, v172, v173
v_cvt_pk_bf16_f32 v173, v174, v175
v_cvt_pk_bf16_f32 v174, v176, v177
v_cvt_pk_bf16_f32 v175, v178, v179
buffer_store_dwordx4 v[172:175], v18, s[32:35], s49 offen sc1
v_pk_mul_f32 v[180:181], v[180:181], v[50:51] op_sel:[0,0] op_sel_hi:[1,0]
v_pk_mul_f32 v[182:183], v[182:183], v[50:51] op_sel:[0,0] op_sel_hi:[1,0]
v_pk_mul_f32 v[184:185], v[184:185], v[50:51] op_sel:[0,0] op_sel_hi:[1,0]
v_pk_mul_f32 v[186:187], v[186:187], v[50:51] op_sel:[0,0] op_sel_hi:[1,0]
v_cvt_pk_bf16_f32 v180, v180, v181
v_cvt_pk_bf16_f32 v181, v182, v183
v_cvt_pk_bf16_f32 v182, v184, v185
v_cvt_pk_bf16_f32 v183, v186, v187
buffer_store_dwordx4 v[180:183], v18, s[32:35], s50 offen sc1
v_pk_mul_f32 v[188:189], v[188:189], v[50:51] op_sel:[0,1] op_sel_hi:[1,1]
v_pk_mul_f32 v[190:191], v[190:191], v[50:51] op_sel:[0,1] op_sel_hi:[1,1]
v_pk_mul_f32 v[192:193], v[192:193], v[50:51] op_sel:[0,1] op_sel_hi:[1,1]
v_pk_mul_f32 v[194:195], v[194:195], v[50:51] op_sel:[0,1] op_sel_hi:[1,1]
v_cvt_pk_bf16_f32 v188, v188, v189
v_cvt_pk_bf16_f32 v189, v190, v191
v_cvt_pk_bf16_f32 v190, v192, v193
v_cvt_pk_bf16_f32 v191, v194, v195
buffer_store_dwordx4 v[188:191], v18, s[32:35], s51 offen sc1
s_waitcnt vmcnt(0)
s_lshl_b32 s62, s45, 2
v_mov_b32 v4, s62
v_mov_b32 v5, 4
s_mov_b64 exec, 1
buffer_store_dword v5, v4, s[32:35], s52 offen sc1
s_mov_b64 exec, -1
s_branch back_27

h0_hook0:
s_add_u32 s50, s65, 43008
s_cmp_eq_u32 s50, 129024
s_cselect_b32 s50, 0, s50
s_and_b32 s48, s43, 1
s_lshl_b32 s48, s48, 1
s_lshr_b32 s49, s43, 1
s_add_u32 s48, s48, s49
v_lshrrev_b32 v4, 2, v2
v_and_b32 v5, 3, v0
v_lshl_add_u32 v6, v3, 3, v4
v_lshlrev_b32 v6, 7, v6
v_lshl_add_u32 v6, v5, 3, v6
v_lshrrev_b32 v7, 1, v4
v_and_b32 v8, 1, v3
v_lshl_add_u32 v7, v8, 1, v7
v_xor_b32 v7, s48, v7
v_lshl_add_u32 v12, v7, 5, v6
s_add_u32 s50, s50, 18432
v_add_u32 v12, s50, v12
ds_read_b64_tr_b16 v[64:65], v12 offset:0
ds_read_b64_tr_b16 v[66:67], v12 offset:512
ds_read_b64_tr_b16 v[68:69], v12 offset:4096
ds_read_b64_tr_b16 v[70:71], v12 offset:4608
ds_read_b64_tr_b16 v[72:73], v12 offset:8192
ds_read_b64_tr_b16 v[74:75], v12 offset:8704
ds_read_b64_tr_b16 v[76:77], v12 offset:12288
ds_read_b64_tr_b16 v[78:79], v12 offset:12800
ds_read_b64_tr_b16 v[80:81], v12 offset:16384
ds_read_b64_tr_b16 v[82:83], v12 offset:16896
ds_read_b64_tr_b16 v[84:85], v12 offset:20480
ds_read_b64_tr_b16 v[86:87], v12 offset:20992
v_mov_b32 v40, 0x3f803f80
v_mov_b32 v41, 0x3f803f80
v_mov_b32 v42, 0x3f803f80
v_mov_b32 v43, 0x3f803f80
s_lshl_b32 s50, s42, 2
s_add_u32 s50, s50, s43
s_lshl_b32 s50, s50, 12
s_add_u32 s50, s50, 13631488
s_lshl_b32 s49, s41, 8
s_add_u32 s50, s50, s49
s_waitcnt lgkmcnt(0)
v_mfma_f32_16x16x32_bf16 v[44:47], v[40:43], v[64:67], 0
v_mfma_f32_16x16x32_bf16 v[48:51], v[40:43], v[72:75], 0
v_mfma_f32_16x16x32_bf16 v[52:55], v[40:43], v[80:83], 0
v_mfma_f32_16x16x32_bf16 v[44:47], v[40:43], v[68:71], v[44:47]
v_mfma_f32_16x16x32_bf16 v[48:51], v[40:43], v[76:79], v[48:51]
v_mfma_f32_16x16x32_bf16 v[52:55], v[40:43], v[84:87], v[52:55]
v_cmp_eq_u32 vcc, 0, v3
v_cmp_eq_u32 s[48:49], 1, v3
v_lshlrev_b32 v19, 2, v0
s_nop 5
v_cndmask_b32 v4, v52, v48, s[48:49]
v_cndmask_b32 v4, v4, v44, vcc
buffer_store_dword v4, v19, s[32:35], s50 offen sc1
s_branch h0_ret

h0_hook1:
s_lshl_b32 s52, s42, 2
s_add_u32 s52, s52, s43
s_lshl_b32 s52, s52, 7
s_add_u32 s52, s52, 14188544
s_lshl_b32 s62, s41, 2
v_mov_b32 v4, s62
v_mov_b32 v5, 1
s_mov_b64 exec, 1
buffer_store_dword v5, v4, s[32:35], s52 offen sc1
s_mov_b64 exec, -1
s_add_u32 s50, s65, 43008
s_cmp_eq_u32 s50, 129024
s_cselect_b32 s50, 0, s50
v_lshrrev_b32 v4, 1, v2
v_xor_b32 v4, v4, v3
v_lshlrev_b32 v4, 4, v4
v_lshl_add_u32 v10, v2, 7, v4
v_xor_b32 v11, 64, v10
v_add_u32 v12, s50, v10
v_add_u32 v13, s50, v11
v_add_u32 v10, s70, v12
v_add_u32 v11, s70, v13
ds_read_b128 v[64:67], v10 offset:0
ds_read_b128 v[68:71], v11 offset:0
ds_read_b128 v[72:75], v10 offset:2048
ds_read_b128 v[76:79], v11 offset:2048
ds_read_b128 v[80:83], v12
ds_read_b128 v[84:87], v13
v_mov_b32 v40, 0
v_mov_b32 v41, 0
v_mov_b32 v42, 0
v_mov_b32 v43, 0
v_mov_b32 v44, 0
v_mov_b32 v45, 0
v_mov_b32 v46, 0
v_mov_b32 v47, 0
v_mov_b32 v9, 0x3f803f80
v_lshlrev_b32 v19, 2, v0
s_lshl_b32 s50, s41, 2
s_add_u32 s50, s50, s43
s_lshl_b32 s50, s50, 12
s_add_u32 s50, s50, 13238272
s_lshl_b32 s51, s41, 12
s_add_u32 s51, s51, 13500416
s_lshl_b32 s49, s42, 8
s_add_u32 s50, s50, s49
s_add_u32 s51, s51, s49
s_waitcnt lgkmcnt(0)
v_dot2c_f32_bf16 v40, v64, v9
v_dot2c_f32_bf16 v42, v64, v64
v_dot2c_f32_bf16 v41, v72, v9
v_dot2c_f32_bf16 v43, v72, v72
v_dot2c_f32_bf16 v40, v65, v9
v_dot2c_f32_bf16 v42, v65, v65
v_dot2c_f32_bf16 v41, v73, v9
v_dot2c_f32_bf16 v43, v73, v73
v_dot2c_f32_bf16 v40, v66, v9
v_dot2c_f32_bf16 v42, v66, v66
v_dot2c_f32_bf16 v41, v74, v9
v_dot2c_f32_bf16 v43, v74, v74
v_dot2c_f32_bf16 v40, v67, v9
v_dot2c_f32_bf16 v42, v67, v67
v_dot2c_f32_bf16 v41, v75, v9
v_dot2c_f32_bf16 v43, v75, v75
v_dot2c_f32_bf16 v40, v68, v9
v_dot2c_f32_bf16 v42, v68, v68
v_dot2c_f32_bf16 v41, v76, v9
v_dot2c_f32_bf16 v43, v76, v76
v_dot2c_f32_bf16 v40, v69, v9
v_dot2c_f32_bf16 v42, v69, v69
v_dot2c_f32_bf16 v41, v77, v9
v_dot2c_f32_bf16 v43, v77, v77
v_dot2c_f32_bf16 v40, v70, v9
v_dot2c_f32_bf16 v42, v70, v70
v_dot2c_f32_bf16 v41, v78, v9
v_dot2c_f32_bf16 v43, v78, v78
v_dot2c_f32_bf16 v40, v71, v9
v_dot2c_f32_bf16 v42, v71, v71
v_dot2c_f32_bf16 v41, v79, v9
v_dot2c_f32_bf16 v43, v79, v79
s_nop 1
s_nop 1
v_permlane32_swap_b32 v40, v41
v_permlane32_swap_b32 v42, v43
s_nop 0
v_add_f32 v40, v40, v41
v_add_f32 v42, v42, v43
s_nop 1
v_permlane16_swap_b32 v40, v42
s_nop 0
v_add_f32 v40, v40, v42
buffer_store_dword v40, v19, s[32:35], s50 offen sc1
s_cmp_lg_u32 s43, 0
s_cbranch_scc1 nohs_202034
v_dot2c_f32_bf16 v45, v80, v9
v_dot2c_f32_bf16 v47, v80, v80
v_dot2c_f32_bf16 v45, v81, v9
v_dot2c_f32_bf16 v47, v81, v81
v_dot2c_f32_bf16 v45, v82, v9
v_dot2c_f32_bf16 v47, v82, v82
v_dot2c_f32_bf16 v45, v83, v9
v_dot2c_f32_bf16 v47, v83, v83
v_dot2c_f32_bf16 v45, v84, v9
v_dot2c_f32_bf16 v47, v84, v84
v_dot2c_f32_bf16 v45, v85, v9
v_dot2c_f32_bf16 v47, v85, v85
v_dot2c_f32_bf16 v45, v86, v9
v_dot2c_f32_bf16 v47, v86, v86
v_dot2c_f32_bf16 v45, v87, v9
v_dot2c_f32_bf16 v47, v87, v87
s_nop 1
s_nop 1
v_permlane32_swap_b32 v44, v45
v_permlane32_swap_b32 v46, v47
s_nop 0
v_add_f32 v44, v44, v45
v_add_f32 v46, v46, v47
s_nop 1
v_permlane16_swap_b32 v44, v46
s_nop 0
v_add_f32 v44, v44, v46
buffer_store_dword v44, v19, s[32:35], s51 offen sc1
nohs_202034:
s_branch h0_ret

h0_hook2:
s_lshl_b32 s52, s41, 2
s_add_u32 s52, s52, s43
s_lshl_b32 s52, s52, 7
s_add_u32 s52, s52, 14180352
s_lshl_b32 s62, s42, 2
v_mov_b32 v4, s62
v_mov_b32 v5, 1
s_mov_b64 exec, 1
buffer_store_dword v5, v4, s[32:35], s52 offen sc1
s_mov_b64 exec, -1
s_branch h0_ret

h0_hook3:
v_and_b32 v32, 15, v0
v_lshlrev_b32 v32, 2, v32
global_load_dword v33, v32, s[20:21] sc1
s_branch h0_ret

h0_hook4:
s_mov_b32 s63, 0
ipoll_205034:
v_readlane_b32 s48, v33, 0
s_nop 3
s_cmp_ge_u32 s48, 256
s_cbranch_scc1 ipolled_205035
global_load_dword v33, v32, s[20:21] sc1
s_add_u32 s63, s63, 1
s_cmp_lt_u32 s63, 0x80000
s_waitcnt vmcnt(0)
s_cbranch_scc1 ipoll_205034
ipolled_205035:
s_and_b32 s49, s2, 7
s_add_u32 s49, s49, 1
v_readlane_b32 s48, v33, s49
s_nop 3
s_bcnt1_i32_b32 s48, s48
s_cmp_eq_u32 s48, 1
s_cselect_b32 s48, 1, 0
v_mov_b32 v4, 134912
v_mov_b32 v5, s48
ds_write_b32 v4, v5
s_waitcnt lgkmcnt(0)
s_lshl_b32 s72, s42, 2
s_add_u32 s72, s72, s43
s_lshl_b32 s72, s72, 7
s_add_u32 s72, s72, 14188544
v_and_b32 v30, 15, v0
v_lshlrev_b32 v30, 2, v30
buffer_load_dword v31, v30, s[32:35], s72 offen sc1
s_lshl_b32 s73, s41, 2
s_add_u32 s73, s73, s43
s_lshl_b32 s73, s73, 7
s_add_u32 s73, s73, 14180352
v_and_b32 v34, 15, v0
v_lshlrev_b32 v34, 2, v34
buffer_load_dword v35, v34, s[32:35], s73 offen sc1
s_branch h0_ret

h0_hook5:
s_mov_b32 s63, 0
poll_206034:
v_cmp_gt_u32 vcc, 1, v31
s_cbranch_vccz polled_206035
buffer_load_dword v31, v30, s[32:35], s72 offen sc1
s_add_u32 s63, s63, 1
s_cmp_lt_u32 s63, 0x80000
s_waitcnt vmcnt(0)
s_cbranch_scc1 poll_206034
polled_206035:
s_lshl_b32 s50, s42, 2
s_add_u32 s50, s50, s43
s_lshl_b32 s50, s50, 12
s_add_u32 s50, s50, 13631488
v_lshl_add_u32 v19, v0, 2, s50
buffer_load_dword v64, v19, s[32:35], 0 offen offset:0 sc1
buffer_load_dword v65, v19, s[32:35], 0 offen offset:256 sc1
buffer_load_dword v66, v19, s[32:35], 0 offen offset:512 sc1
buffer_load_dword v67, v19, s[32:35], 0 offen offset:768 sc1
buffer_load_dword v68, v19, s[32:35], 0 offen offset:1024 sc1
buffer_load_dword v69, v19, s[32:35], 0 offen offset:1280 sc1
buffer_load_dword v70, v19, s[32:35], 0 offen offset:1536 sc1
buffer_load_dword v71, v19, s[32:35], 0 offen offset:1792 sc1
buffer_load_dword v72, v19, s[32:35], 0 offen offset:2048 sc1
buffer_load_dword v73, v19, s[32:35], 0 offen offset:2304 sc1
buffer_load_dword v74, v19, s[32:35], 0 offen offset:2560 sc1
buffer_load_dword v75, v19, s[32:35], 0 offen offset:2816 sc1
buffer_load_dword v76, v19, s[32:35], 0 offen offset:3072 sc1
buffer_load_dword v77, v19, s[32:35], 0 offen offset:3328 sc1
buffer_load_dword v78, v19, s[32:35], 0 offen offset:3584 sc1
buffer_load_dword v79, v19, s[32:35], 0 offen offset:3840 sc1
s_branch h0_ret

h0_hook6:
v_add_f32 v64, v64, v72
v_add_f32 v65, v65, v73
v_add_f32 v66, v66, v74
v_add_f32 v67, v67, v75
v_add_f32 v68, v68, v76
v_add_f32 v69, v69, v77
v_add_f32 v70, v70, v78
v_add_f32 v71, v71, v79
v_add_f32 v64, v64, v68
v_add_f32 v65, v65, v69
v_add_f32 v66, v66, v70
v_add_f32 v67, v67, v71
v_add_f32 v64, v64, v66
v_add_f32 v65, v65, v67
v_add_f32 v64, v64, v65
v_min_u32 v4, 2, v3
v_lshlrev_b32 v4, 8, v4
v_lshl_add_u32 v4, v2, 2, v4
s_and_b32 s48, s43, 1
s_lshl_b32 s48, s48, 7
s_lshr_b32 s49, s43, 1
s_lshl_b32 s49, s49, 6
s_add_u32 s48, s48, s49
s_add_u32 s48, s48, 133376
v_add_u32 v4, s48, v4
ds_write_b32 v4, v64
s_waitcnt lgkmcnt(0)
s_mov_b32 s63, 0
poll_207034:
v_cmp_gt_u32 vcc, 1, v35
s_cbranch_vccz polled_207035
buffer_load_dword v35, v34, s[32:35], s73 offen sc1
s_add_u32 s63, s63, 1
s_cmp_lt_u32 s63, 0x80000
s_waitcnt vmcnt(0)
s_cbranch_scc1 poll_207034
polled_207035:
s_lshl_b32 s50, s41, 2
s_add_u32 s50, s50, s43
s_lshl_b32 s50, s50, 12
s_add_u32 s50, s50, 13238272
v_lshl_add_u32 v19, v0, 2, s50
buffer_load_dword v64, v19, s[32:35], 0 offen offset:0 sc1
buffer_load_dword v65, v19, s[32:35], 0 offen offset:256 sc1
buffer_load_dword v66, v19, s[32:35], 0 offen offset:512 sc1
buffer_load_dword v67, v19, s[32:35], 0 offen offset:768 sc1
buffer_load_dword v68, v19, s[32:35], 0 offen offset:1024 sc1
buffer_load_dword v69, v19, s[32:35], 0 offen offset:1280 sc1
buffer_load_dword v70, v19, s[32:35], 0 offen offset:1536 sc1
buffer_load_dword v71, v19, s[32:35], 0 offen offset:1792 sc1
buffer_load_dword v72, v19, s[32:35], 0 offen offset:2048 sc1
buffer_load_dword v73, v19, s[32:35], 0 offen offset:2304 sc1
buffer_load_dword v74, v19, s[32:35], 0 offen offset:2560 sc1
buffer_load_dword v75, v19, s[32:35], 0 offen offset:2816 sc1
buffer_load_dword v76, v19, s[32:35], 0 offen offset:3072 sc1
buffer_load_dword v77, v19, s[32:35], 0 offen offset:3328 sc1
buffer_load_dword v78, v19, s[32:35], 0 offen offset:3584 sc1
buffer_load_dword v79, v19, s[32:35], 0 offen offset:3840 sc1
s_branch h0_ret

h0_hook7:
v_add_f32 v64, v64, v72
v_add_f32 v65, v65, v73
v_add_f32 v66, v66, v74
v_add_f32 v67, v67, v75
v_add_f32 v68, v68, v76
v_add_f32 v69, v69, v77
v_add_f32 v70, v70, v78
v_add_f32 v71, v71, v79
v_add_f32 v64, v64, v68
v_add_f32 v65, v65, v69
v_add_f32 v66, v66, v70
v_add_f32 v67, v67, v71
v_add_f32 v64, v64, v66
v_add_f32 v65, v65, v67
v_add_f32 v64, v64, v65
v_mul_f32 v40, 0x3a800000, v64
v_mov_b32 v41, v40
s_nop 1
v_permlane16_swap_b32 v40, v41
s_nop 0
v_fma_f32 v41, -v40, v40, v41
v_max_f32 v41, 0, v41
v_add_f32 v41, 0x3727c5ac, v41
v_rsq_f32 v42, v41
v_sub_f32 v43, 0, v40
v_lshrrev_b32 v4, 5, v0
v_lshl_add_u32 v4, v4, 4, v2
s_lshl_b32 s48, s43, 5
s_add_u32 s48, s48, 16
v_add_u32 v4, s48, v4
v_lshlrev_b32 v5, 3, v4
v_add_u32 v5, 131072, v5
v_lshlrev_b32 v4, 2, v4
v_add_u32 v4, 132224, v4
ds_write_b64 v5, v[42:43]
ds_write_b32 v4, v42
ds_write_b32 v4, v43 offset:576
s_mov_b64 exec, -1
s_waitcnt lgkmcnt(0)
s_cmp_lg_u32 s43, 0
s_cbranch_scc1 lw0_208034
s_lshl_b32 s50, s41, 12
s_add_u32 s50, s50, 13500416
v_lshl_add_u32 v19, v0, 2, s50
buffer_load_dword v64, v19, s[32:35], 0 offen offset:0 sc1
buffer_load_dword v65, v19, s[32:35], 0 offen offset:256 sc1
buffer_load_dword v66, v19, s[32:35], 0 offen offset:512 sc1
buffer_load_dword v67, v19, s[32:35], 0 offen offset:768 sc1
buffer_load_dword v68, v19, s[32:35], 0 offen offset:1024 sc1
buffer_load_dword v69, v19, s[32:35], 0 offen offset:1280 sc1
buffer_load_dword v70, v19, s[32:35], 0 offen offset:1536 sc1
buffer_load_dword v71, v19, s[32:35], 0 offen offset:1792 sc1
buffer_load_dword v72, v19, s[32:35], 0 offen offset:2048 sc1
buffer_load_dword v73, v19, s[32:35], 0 offen offset:2304 sc1
buffer_load_dword v74, v19, s[32:35], 0 offen offset:2560 sc1
buffer_load_dword v75, v19, s[32:35], 0 offen offset:2816 sc1
buffer_load_dword v76, v19, s[32:35], 0 offen offset:3072 sc1
buffer_load_dword v77, v19, s[32:35], 0 offen offset:3328 sc1
buffer_load_dword v78, v19, s[32:35], 0 offen offset:3584 sc1
buffer_load_dword v79, v19, s[32:35], 0 offen offset:3840 sc1
lw0_208034:
s_branch h0_ret

h0_hook8:
s_cmp_lg_u32 s43, 0
s_cbranch_scc1 lw0_209034
v_add_f32 v64, v64, v72
v_add_f32 v65, v65, v73
v_add_f32 v66, v66, v74
v_add_f32 v67, v67, v75
v_add_f32 v68, v68, v76
v_add_f32 v69, v69, v77
v_add_f32 v70, v70, v78
v_add_f32 v71, v71, v79
v_add_f32 v64, v64, v68
v_add_f32 v65, v65, v69
v_add_f32 v66, v66, v70
v_add_f32 v67, v67, v71
v_add_f32 v64, v64, v66
v_add_f32 v65, v65, v67
v_add_f32 v64, v64, v65
v_mul_f32 v40, 0x3a800000, v64
v_mov_b32 v41, v40
s_nop 1
v_permlane16_swap_b32 v40, v41
s_nop 0
v_fma_f32 v41, -v40, v40, v41
v_max_f32 v41, 0, v41
v_add_f32 v41, 0x3727c5ac, v41
v_rsq_f32 v42, v41
v_sub_f32 v43, 0, v40
v_mov_b32 v4, v2
s_mov_b32 exec_lo, 0
v_lshlrev_b32 v5, 3, v4
v_add_u32 v5, 131072, v5
v_lshlrev_b32 v4, 2, v4
v_add_u32 v4, 132224, v4
ds_write_b64 v5, v[42:43]
ds_write_b32 v4, v42
ds_write_b32 v4, v43 offset:576
s_mov_b64 exec, -1
s_waitcnt lgkmcnt(0)
lw0_209034:
s_branch h0_ret

h1_hook0:
s_add_u32 s50, s65, 43008
s_cmp_eq_u32 s50, 129024
s_cselect_b32 s50, 0, s50
s_and_b32 s48, s43, 1
s_lshl_b32 s48, s48, 1
s_lshr_b32 s49, s43, 1
s_add_u32 s48, s48, s49
v_lshrrev_b32 v4, 2, v2
v_and_b32 v5, 3, v0
v_lshl_add_u32 v6, v3, 3, v4
v_lshlrev_b32 v6, 7, v6
v_lshl_add_u32 v6, v5, 3, v6
v_lshrrev_b32 v7, 1, v4
v_and_b32 v8, 1, v3
v_lshl_add_u32 v7, v8, 1, v7
v_xor_b32 v7, s48, v7
v_lshl_add_u32 v12, v7, 5, v6
s_add_u32 s50, s50, 18432
v_add_u32 v12, s50, v12
ds_read_b64_tr_b16 v[64:65], v12 offset:0
ds_read_b64_tr_b16 v[66:67], v12 offset:512
ds_read_b64_tr_b16 v[68:69], v12 offset:4096
ds_read_b64_tr_b16 v[70:71], v12 offset:4608
ds_read_b64_tr_b16 v[72:73], v12 offset:8192
ds_read_b64_tr_b16 v[74:75], v12 offset:8704
ds_read_b64_tr_b16 v[76:77], v12 offset:12288
ds_read_b64_tr_b16 v[78:79], v12 offset:12800
ds_read_b64_tr_b16 v[80:81], v12 offset:16384
ds_read_b64_tr_b16 v[82:83], v12 offset:16896
ds_read_b64_tr_b16 v[84:85], v12 offset:20480
ds_read_b64_tr_b16 v[86:87], v12 offset:20992
v_mov_b32 v40, 0x3f803f80
v_mov_b32 v41, 0x3f803f80
v_mov_b32 v42, 0x3f803f80
v_mov_b32 v43, 0x3f803f80
s_lshl_b32 s50, s42, 2
s_add_u32 s50, s50, s43
s_lshl_b32 s50, s50, 12
s_add_u32 s50, s50, 13893632
s_lshl_b32 s49, s41, 8
s_add_u32 s50, s50, s49
s_waitcnt lgkmcnt(0)
v_mfma_f32_16x16x32_bf16 v[44:47], v[40:43], v[64:67], 0
v_mfma_f32_16x16x32_bf16 v[48:51], v[40:43], v[72:75], 0
v_mfma_f32_16x16x32_bf16 v[52:55], v[40:43], v[80:83], 0
v_mfma_f32_16x16x32_bf16 v[44:47], v[40:43], v[68:71], v[44:47]
v_mfma_f32_16x16x32_bf16 v[48:51], v[40:43], v[76:79], v[48:51]
v_mfma_f32_16x16x32_bf16 v[52:55], v[40:43], v[84:87], v[52:55]
v_cmp_eq_u32 vcc, 0, v3
v_cmp_eq_u32 s[48:49], 1, v3
v_lshlrev_b32 v19, 2, v0
s_nop 5
v_cndmask_b32 v4, v52, v48, s[48:49]
v_cndmask_b32 v4, v4, v44, vcc
buffer_store_dword v4, v19, s[32:35], s50 offen sc1
s_branch h1_ret

h1_hook1:
s_lshl_b32 s52, s42, 2
s_add_u32 s52, s52, s43
s_lshl_b32 s52, s52, 7
s_add_u32 s52, s52, 14188544
s_lshl_b32 s62, s41, 2
v_mov_b32 v4, s62
v_mov_b32 v5, 2
s_mov_b64 exec, 1
buffer_store_dword v5, v4, s[32:35], s52 offen sc1
s_mov_b64 exec, -1
s_lshl_b32 s50, s41, 2
s_add_u32 s50, s50, s43
s_lshl_b32 s50, s50, 12
s_add_u32 s50, s50, 13238272
v_lshl_add_u32 v19, v0, 2, s50
buffer_load_dword v64, v19, s[32:35], 0 offen offset:0 sc1
buffer_load_dword v65, v19, s[32:35], 0 offen offset:256 sc1
buffer_load_dword v66, v19, s[32:35], 0 offen offset:512 sc1
buffer_load_dword v67, v19, s[32:35], 0 offen offset:768 sc1
buffer_load_dword v68, v19, s[32:35], 0 offen offset:1024 sc1
buffer_load_dword v69, v19, s[32:35], 0 offen offset:1280 sc1
buffer_load_dword v70, v19, s[32:35], 0 offen offset:1536 sc1
buffer_load_dword v71, v19, s[32:35], 0 offen offset:1792 sc1
buffer_load_dword v72, v19, s[32:35], 0 offen offset:2048 sc1
buffer_load_dword v73, v19, s[32:35], 0 offen offset:2304 sc1
buffer_load_dword v74, v19, s[32:35], 0 offen offset:2560 sc1
buffer_load_dword v75, v19, s[32:35], 0 offen offset:2816 sc1
buffer_load_dword v76, v19, s[32:35], 0 offen offset:3072 sc1
buffer_load_dword v77, v19, s[32:35], 0 offen offset:3328 sc1
buffer_load_dword v78, v19, s[32:35], 0 offen offset:3584 sc1
buffer_load_dword v79, v19, s[32:35], 0 offen offset:3840 sc1
s_branch h1_ret

h1_hook2:
v_add_f32 v64, v64, v72
v_add_f32 v65, v65, v73
v_add_f32 v66, v66, v74
v_add_f32 v67, v67, v75
v_add_f32 v68, v68, v76
v_add_f32 v69, v69, v77
v_add_f32 v70, v70, v78
v_add_f32 v71, v71, v79
v_add_f32 v64, v64, v68
v_add_f32 v65, v65, v69
v_add_f32 v66, v66, v70
v_add_f32 v67, v67, v71
v_add_f32 v64, v64, v66
v_add_f32 v65, v65, v67
v_add_f32 v64, v64, v65
v_mul_f32 v40, 0x3a800000, v64
v_mov_b32 v41, v40
s_nop 1
v_permlane16_swap_b32 v40, v41
s_nop 0
v_fma_f32 v41, -v40, v40, v41
v_max_f32 v41, 0, v41
v_add_f32 v41, 0x3727c5ac, v41
v_rsq_f32 v42, v41
v_sub_f32 v43, 0, v40
v_lshrrev_b32 v4, 5, v0
v_lshl_add_u32 v4, v4, 4, v2
s_lshl_b32 s48, s43, 5
s_add_u32 s48, s48, 16
v_add_u32 v4, s48, v4
v_lshlrev_b32 v5, 3, v4
v_add_u32 v5, 131072, v5
v_lshlrev_b32 v4, 2, v4
v_add_u32 v4, 132224, v4
ds_write_b64 v5, v[42:43]
ds_write_b32 v4, v42
ds_write_b32 v4, v43 offset:576
s_mov_b64 exec, -1
s_waitcnt lgkmcnt(0)
s_branch h1_ret

h1_hook3:
s_lshl_b32 s72, s42, 2
s_add_u32 s72, s72, s43
s_lshl_b32 s72, s72, 7
s_add_u32 s72, s72, 14188544
v_and_b32 v30, 15, v0
v_lshlrev_b32 v30, 2, v30
buffer_load_dword v31, v30, s[32:35], s72 offen sc1
s_branch h1_ret

h1_hook4:
s_mov_b32 s63, 0
poll_405036:
v_cmp_gt_u32 vcc, 2, v31
s_cbranch_vccz polled_405037
buffer_load_dword v31, v30, s[32:35], s72 offen sc1
s_add_u32 s63, s63, 1
s_cmp_lt_u32 s63, 0x80000
s_waitcnt vmcnt(0)
s_cbranch_scc1 poll_405036
polled_405037:
s_lshl_b32 s50, s42, 2
s_add_u32 s50, s50, s43
s_lshl_b32 s50, s50, 12
s_add_u32 s50, s50, 13893632
v_lshl_add_u32 v19, v0, 2, s50
buffer_load_dword v64, v19, s[32:35], 0 offen offset:0 sc1
buffer_load_dword v65, v19, s[32:35], 0 offen offset:256 sc1
buffer_load_dword v66, v19, s[32:35], 0 offen offset:512 sc1
buffer_load_dword v67, v19, s[32:35], 0 offen offset:768 sc1
buffer_load_dword v68, v19, s[32:35], 0 offen offset:1024 sc1
buffer_load_dword v69, v19, s[32:35], 0 offen offset:1280 sc1
buffer_load_dword v70, v19, s[32:35], 0 offen offset:1536 sc1
buffer_load_dword v71, v19, s[32:35], 0 offen offset:1792 sc1
buffer_load_dword v72, v19, s[32:35], 0 offen offset:2048 sc1
buffer_load_dword v73, v19, s[32:35], 0 offen offset:2304 sc1
buffer_load_dword v74, v19, s[32:35], 0 offen offset:2560 sc1
buffer_load_dword v75, v19, s[32:35], 0 offen offset:2816 sc1
buffer_load_dword v76, v19, s[32:35], 0 offen offset:3072 sc1
buffer_load_dword v77, v19, s[32:35], 0 offen offset:3328 sc1
buffer_load_dword v78, v19, s[32:35], 0 offen offset:3584 sc1
buffer_load_dword v79, v19, s[32:35], 0 offen offset:3840 sc1
s_branch h1_ret

h1_hook5:
v_add_f32 v64, v64, v72
v_add_f32 v65, v65, v73
v_add_f32 v66, v66, v74
v_add_f32 v67, v67, v75
v_add_f32 v68, v68, v76
v_add_f32 v69, v69, v77
v_add_f32 v70, v70, v78
v_add_f32 v71, v71, v79
v_add_f32 v64, v64, v68
v_add_f32 v65, v65, v69
v_add_f32 v66, v66, v70
v_add_f32 v67, v67, v71
v_add_f32 v64, v64, v66
v_add_f32 v65, v65, v67
v_add_f32 v64, v64, v65
v_min_u32 v4, 2, v3
v_lshlrev_b32 v4, 8, v4
v_lshl_add_u32 v4, v2, 2, v4
s_and_b32 s48, s43, 1
s_lshl_b32 s48, s48, 7
s_lshr_b32 s49, s43, 1
s_lshl_b32 s49, s49, 6
s_add_u32 s48, s48, s49
s_add_u32 s48, s48, 134144
v_add_u32 v4, s48, v4
ds_write_b32 v4, v64
s_waitcnt lgkmcnt(0)
s_branch h1_ret

h2_hook0:
s_lshl_b32 s50, s41, 2
s_add_u32 s50, s50, s43
s_lshl_b32 s50, s50, 12
s_add_u32 s50, s50, 13238272
v_lshl_add_u32 v19, v0, 2, s50
buffer_load_dword v64, v19, s[32:35], 0 offen offset:0 sc1
buffer_load_dword v65, v19, s[32:35], 0 offen offset:256 sc1
buffer_load_dword v66, v19, s[32:35], 0 offen offset:512 sc1
buffer_load_dword v67, v19, s[32:35], 0 offen offset:768 sc1
buffer_load_dword v68, v19, s[32:35], 0 offen offset:1024 sc1
buffer_load_dword v69, v19, s[32:35], 0 offen offset:1280 sc1
buffer_load_dword v70, v19, s[32:35], 0 offen offset:1536 sc1
buffer_load_dword v71, v19, s[32:35], 0 offen offset:1792 sc1
buffer_load_dword v72, v19, s[32:35], 0 offen offset:2048 sc1
buffer_load_dword v73, v19, s[32:35], 0 offen offset:2304 sc1
buffer_load_dword v74, v19, s[32:35], 0 offen offset:2560 sc1
buffer_load_dword v75, v19, s[32:35], 0 offen offset:2816 sc1
buffer_load_dword v76, v19, s[32:35], 0 offen offset:3072 sc1
buffer_load_dword v77, v19, s[32:35], 0 offen offset:3328 sc1
buffer_load_dword v78, v19, s[32:35], 0 offen offset:3584 sc1
buffer_load_dword v79, v19, s[32:35], 0 offen offset:3840 sc1
s_branch h2_ret

h2_hook1:
v_add_f32 v64, v64, v72
v_add_f32 v65, v65, v73
v_add_f32 v66, v66, v74
v_add_f32 v67, v67, v75
v_add_f32 v68, v68, v76
v_add_f32 v69, v69, v77
v_add_f32 v70, v70, v78
v_add_f32 v71, v71, v79
v_add_f32 v64, v64, v68
v_add_f32 v65, v65, v69
v_add_f32 v66, v66, v70
v_add_f32 v67, v67, v71
v_add_f32 v64, v64, v66
v_add_f32 v65, v65, v67
v_add_f32 v64, v64, v65
v_mul_f32 v40, 0x3a800000, v64
v_mov_b32 v41, v40
s_nop 1
v_permlane16_swap_b32 v40, v41
s_nop 0
v_fma_f32 v41, -v40, v40, v41
v_max_f32 v41, 0, v41
v_add_f32 v41, 0x3727c5ac, v41
v_rsq_f32 v42, v41
v_sub_f32 v43, 0, v40
v_lshrrev_b32 v4, 5, v0
v_lshl_add_u32 v4, v4, 4, v2
s_lshl_b32 s48, s43, 5
s_add_u32 s48, s48, 16
v_add_u32 v4, s48, v4
v_lshlrev_b32 v5, 3, v4
v_add_u32 v5, 131072, v5
v_lshlrev_b32 v4, 2, v4
v_add_u32 v4, 132224, v4
ds_write_b64 v5, v[42:43]
ds_write_b32 v4, v42
ds_write_b32 v4, v43 offset:576
s_mov_b64 exec, -1
s_waitcnt lgkmcnt(0)
s_cmp_lg_u32 s43, 0
s_cbranch_scc1 lw0_602045
s_sub_u32 s50, s41, 1
s_lshl_b32 s50, s50, 12
s_add_u32 s50, s50, 13565952
s_cmp_eq_u32 s41, 0
s_cselect_b32 s50, 0xf0000000, s50
v_lshl_add_u32 v19, v0, 2, s50
buffer_load_dword v64, v19, s[32:35], 0 offen offset:0 sc1
buffer_load_dword v65, v19, s[32:35], 0 offen offset:256 sc1
buffer_load_dword v66, v19, s[32:35], 0 offen offset:512 sc1
buffer_load_dword v67, v19, s[32:35], 0 offen offset:768 sc1
buffer_load_dword v68, v19, s[32:35], 0 offen offset:1024 sc1
buffer_load_dword v69, v19, s[32:35], 0 offen offset:1280 sc1
buffer_load_dword v70, v19, s[32:35], 0 offen offset:1536 sc1
buffer_load_dword v71, v19, s[32:35], 0 offen offset:1792 sc1
buffer_load_dword v72, v19, s[32:35], 0 offen offset:2048 sc1
buffer_load_dword v73, v19, s[32:35], 0 offen offset:2304 sc1
buffer_load_dword v74, v19, s[32:35], 0 offen offset:2560 sc1
buffer_load_dword v75, v19, s[32:35], 0 offen offset:2816 sc1
buffer_load_dword v76, v19, s[32:35], 0 offen offset:3072 sc1
buffer_load_dword v77, v19, s[32:35], 0 offen offset:3328 sc1
buffer_load_dword v78, v19, s[32:35], 0 offen offset:3584 sc1
buffer_load_dword v79, v19, s[32:35], 0 offen offset:3840 sc1
lw0_602045:
s_branch h2_ret

h2_hook2:
s_cmp_lg_u32 s43, 0
s_cbranch_scc1 lw0_603045
v_add_f32 v64, v64, v72
v_add_f32 v65, v65, v73
v_add_f32 v66, v66, v74
v_add_f32 v67, v67, v75
v_add_f32 v68, v68, v76
v_add_f32 v69, v69, v77
v_add_f32 v70, v70, v78
v_add_f32 v71, v71, v79
v_add_f32 v64, v64, v68
v_add_f32 v65, v65, v69
v_add_f32 v66, v66, v70
v_add_f32 v67, v67, v71
v_add_f32 v64, v64, v66
v_add_f32 v65, v65, v67
v_add_f32 v64, v64, v65
v_mul_f32 v40, 0x3a800000, v64
v_mov_b32 v41, v40
s_nop 1
v_permlane16_swap_b32 v40, v41
s_nop 0
v_fma_f32 v41, -v40, v40, v41
v_max_f32 v41, 0, v41
v_add_f32 v41, 0x3727c5ac, v41
v_rsq_f32 v42, v41
v_sub_f32 v43, 0, v40
v_mov_b32 v4, v2
s_mov_b32 exec_lo, 0
v_lshlrev_b32 v5, 3, v4
v_add_u32 v5, 131072, v5
v_lshlrev_b32 v4, 2, v4
v_add_u32 v4, 132224, v4
ds_write_b64 v5, v[42:43]
ds_write_b32 v4, v42
ds_write_b32 v4, v43 offset:576
s_mov_b64 exec, -1
s_waitcnt lgkmcnt(0)
lw0_603045:
s_branch h2_ret

h3_hook0:
s_lshl_b32 s50, s41, 2
s_add_u32 s50, s50, s43
s_lshl_b32 s50, s50, 12
s_add_u32 s50, s50, 13238272
v_lshl_add_u32 v19, v0, 2, s50
buffer_load_dword v64, v19, s[32:35], 0 offen offset:0 sc1
buffer_load_dword v65, v19, s[32:35], 0 offen offset:256 sc1
buffer_load_dword v66, v19, s[32:35], 0 offen offset:512 sc1
buffer_load_dword v67, v19, s[32:35], 0 offen offset:768 sc1
buffer_load_dword v68, v19, s[32:35], 0 offen offset:1024 sc1
buffer_load_dword v69, v19, s[32:35], 0 offen offset:1280 sc1
buffer_load_dword v70, v19, s[32:35], 0 offen offset:1536 sc1
buffer_load_dword v71, v19, s[32:35], 0 offen offset:1792 sc1
buffer_load_dword v72, v19, s[32:35], 0 offen offset:2048 sc1
buffer_load_dword v73, v19, s[32:35], 0 offen offset:2304 sc1
buffer_load_dword v74, v19, s[32:35], 0 offen offset:2560 sc1
buffer_load_dword v75, v19, s[32:35], 0 offen offset:2816 sc1
buffer_load_dword v76, v19, s[32:35], 0 offen offset:3072 sc1
buffer_load_dword v77, v19, s[32:35], 0 offen offset:3328 sc1
buffer_load_dword v78, v19, s[32:35], 0 offen offset:3584 sc1
buffer_load_dword v79, v19, s[32:35], 0 offen offset:3840 sc1
s_branch h3_ret

h3_hook1:
v_add_f32 v64, v64, v72
v_add_f32 v65, v65, v73
v_add_f32 v66, v66, v74
v_add_f32 v67, v67, v75
v_add_f32 v68, v68, v76
v_add_f32 v69, v69, v77
v_add_f32 v70, v70, v78
v_add_f32 v71, v71, v79
v_add_f32 v64, v64, v68
v_add_f32 v65, v65, v69
v_add_f32 v66, v66, v70
v_add_f32 v67, v67, v71
v_add_f32 v64, v64, v66
v_add_f32 v65, v65, v67
v_add_f32 v64, v64, v65
v_mul_f32 v40, 0x3a800000, v64
v_mov_b32 v41, v40
s_nop 1
v_permlane16_swap_b32 v40, v41
s_nop 0
v_fma_f32 v41, -v40, v40, v41
v_max_f32 v41, 0, v41
v_add_f32 v41, 0x3727c5ac, v41
v_rsq_f32 v42, v41
v_sub_f32 v43, 0, v40
v_lshrrev_b32 v4, 5, v0
v_lshl_add_u32 v4, v4, 4, v2
s_lshl_b32 s48, s43, 5
s_add_u32 s48, s48, 16
v_add_u32 v4, s48, v4
v_lshlrev_b32 v5, 3, v4
v_add_u32 v5, 131072, v5
v_lshlrev_b32 v4, 2, v4
v_add_u32 v4, 132224, v4
ds_write_b64 v5, v[42:43]
ds_write_b32 v4, v42
ds_write_b32 v4, v43 offset:576
s_mov_b64 exec, -1
s_waitcnt lgkmcnt(0)
s_branch h3_ret

L_code_end:
s_endpgm
.section .rodata,"a"
.p2align 6
.amdhsa_kernel interleave_layers__sliding_local_dilated__linear_kernel_hedgehog__prompt_kernel
  .amdhsa_next_free_vgpr 256
  .amdhsa_next_free_sgpr 102
  .amdhsa_accum_offset 256
  .amdhsa_group_segment_fixed_size 0
  .amdhsa_kernarg_size 80
  .amdhsa_user_sgpr_count 2
  .amdhsa_user_sgpr_kernarg_segment_ptr 1
  .amdhsa_system_sgpr_workgroup_id_x 1
.end_amdhsa_kernel
```

```asm
; @launch grid=(256,1,1) block=(512,1,1) lds=163840
.amdgcn_target "amdgcn-amd-amdhsa--gfx950"
.text
.globl interleave_layers__sliding_local_dilated__linear_kernel_hedgehog__prompt_kernel
.p2align 8
.type interleave_layers__sliding_local_dilated__linear_kernel_hedgehog__prompt_kernel,@function
interleave_layers__sliding_local_dilated__linear_kernel_hedgehog__prompt_kernel:
s_cmp_ge_u32 s2, 256
s_cbranch_scc1 L_end
s_load_dwordx16 s[4:19], s[0:1], 0
s_load_dwordx4 s[20:23], s[0:1], 64
v_lshrrev_b32 v1, 6, v0
v_and_b32 v0, 63, v0
v_readfirstlane_b32 s40, v1
v_and_b32 v2, 15, v0
v_lshrrev_b32 v3, 4, v0
v_lshlrev_b32 v18, 4, v0
s_and_b32 s48, s2, 7
s_lshr_b32 s49, s2, 3
s_and_b32 s74, s49, 1
s_lshl_b32 s41, s48, 1
s_add_u32 s41, s41, s74
s_lshr_b32 s42, s49, 1
s_and_b32 s48, s2, 7
s_lshl_b32 s48, s48, 1
s_add_u32 s47, s42, s48
s_and_b32 s47, s47, 15
s_mov_b32 s46, 0
s_and_b32 s43, s40, 3
s_lshl_b32 s70, s43, 12
s_add_u32 s70, s70, 2048
s_lshl_b32 s71, s43, 11
s_add_u32 s71, s71, 18432
s_waitcnt lgkmcnt(0)
s_mov_b32 s24, s4
s_and_b32 s25, s5, 0xffff
s_mov_b32 s26, 4194304
s_mov_b32 s27, 0x00020000
s_mov_b32 s32, s22
s_and_b32 s33, s23, 0xffff
s_mov_b32 s34, 268435456
s_mov_b32 s35, 0x00020000
s_cmp_lt_u32 s40, 4
s_cbranch_scc1 L_compute
s_mov_b32 s28, s6
s_and_b32 s29, s7, 0xffff
s_mov_b32 s30, 6291456
s_mov_b32 s31, 0x00020000
v_lshrrev_b32 v4, 3, v0
v_and_b32 v5, 7, v0
s_lshl_b32 s48, s43, 4
v_add_u32 v6, s48, v4
v_mul_u32_u24 v6, 6144, v6
v_and_b32 v7, 2, v4
v_xor_b32 v7, v7, v5
s_lshl_b32 s48, s42, 7
v_lshl_add_u32 v26, v7, 4, v6
v_add_u32 v26, s48, v26
v_xor_b32 v27, 64, v26
v_add_u32 v27, 48128, v27
s_lshl_b32 s48, s41, 7
s_lshl_b32 s49, s43, 5
s_add_u32 s48, s48, s49
v_add_u32 v6, s48, v4
v_lshlrev_b32 v6, 11, v6
v_lshrrev_b32 v7, 1, v4
v_xor_b32 v7, v7, v5
v_lshl_add_u32 v20, v7, 4, v6
v_xor_b32 v21, 64, v20
v_add_u32 v21, 15360, v21
v_add_u32 v22, 30720, v20
v_add_u32 v23, 30720, v21
v_subrev_u32 v24, 32768, v20
v_subrev_u32 v25, 32768, v21
s_add_u32 s69, s47, 0
s_and_b32 s69, s69, 15
s_mul_i32 s67, s69, 128
s_mul_i32 s68, s69, 393216
s_cmp_lg_u32 s43, 0
s_cbranch_scc1 nohalo_1
s_mov_b32 m0, 0
s_nop 0
buffer_load_dwordx4 v24, s[24:27], s67 offen  lds
buffer_load_dwordx4 v25, s[24:27], s67 offen offset:1024  lds
nohalo_1:
s_add_u32 m0, s70, 0
s_nop 0
buffer_load_dwordx4 v20, s[24:27], s67 offen offset:0  lds
buffer_load_dwordx4 v21, s[24:27], s67 offen offset:1024  lds
buffer_load_dwordx4 v22, s[24:27], s67 offen offset:2048  lds
buffer_load_dwordx4 v23, s[24:27], s67 offen offset:3072  lds
s_add_u32 s48, s71, 0
s_add_u32 m0, s48, 0
s_add_u32 s49, s68, 0
buffer_load_dwordx4 v26, s[28:31], s49 offen  lds
buffer_load_dwordx4 v27, s[28:31], s49 offen offset:1024  lds
s_add_u32 m0, s48, 8192
s_add_u32 s49, s68, 2048
buffer_load_dwordx4 v26, s[28:31], s49 offen  lds
buffer_load_dwordx4 v27, s[28:31], s49 offen offset:1024  lds
s_add_u32 m0, s48, 16384
s_add_u32 s49, s68, 4096
buffer_load_dwordx4 v26, s[28:31], s49 offen  lds
buffer_load_dwordx4 v27, s[28:31], s49 offen offset:1024  lds
s_and_b32 s51, s42, 7
s_cmp_gt_u32 s51, 3
s_cselect_b32 s49, 1, 0
s_sub_u32 s49, s51, s49
s_lshl_b32 s49, s49, 1
s_add_u32 s49, s49, s74
s_lshl_b32 s49, s49, 2
s_add_u32 s49, s49, s43
s_lshr_b32 s50, s49, 4
s_lshl_b32 s50, s50, 11
s_and_b32 s49, s49, 15
s_mul_i32 s49, s49, 24576
s_add_u32 s49, s49, s50
s_and_b32 s50, s42, 8
s_or_b32 s50, s50, 3
s_and_b32 s48, s2, 7
s_lshl_b32 s48, s48, 1
s_add_u32 s76, s50, s48
s_and_b32 s76, s76, 15
s_lshl_b32 s50, s50, 7
s_add_u32 s49, s49, s50
s_and_b32 s51, s51, 3
s_cmp_eq_u32 s51, 3
s_cselect_b32 s49, 0x70000000, s49
v_mul_u32_u24 v4, 6144, v4
v_lshl_add_u32 v4, v5, 4, v4
v_lshrrev_b32 v5, 5, v0
v_lshlrev_b32 v5, 30, v5
v_add3_u32 v36, v4, v5, s49
v_lshrrev_b32 v4, 3, v0
v_and_b32 v5, 7, v0
s_lshr_b32 s48, s43, 1
s_lshl_b32 s48, s48, 5
s_and_b32 s49, s43, 1
s_lshl_b32 s49, s49, 3
s_add_u32 s48, s48, s49
v_lshrrev_b32 v6, 2, v4
v_lshlrev_b32 v6, 4, v6
v_and_b32 v7, 3, v4
v_add3_u32 v6, v6, v7, s48
v_mul_u32_u24 v6, 2048, v6
v_and_b32 v7, 2, v4
v_xor_b32 v7, v7, v5
s_lshl_b32 s48, s42, 7
v_lshl_add_u32 v28, v7, 4, v6
v_add_u32 v28, s48, v28
v_xor_b32 v29, 64, v28
v_add_u32 v29, 7168, v29
v_lshlrev_b32 v30, 2, v2
v_and_b32 v32, 7, v0
v_lshlrev_b32 v32, 3, v32
s_lshl_b32 s50, s41, 2
s_add_u32 s50, s50, s43
s_lshl_b32 s50, s50, 12
s_add_u32 s50, s50, 17432576
v_add_u32 v37, s50, v18
v_lshrrev_b32 v4, 5, v0
v_lshl_add_u32 v4, v4, 4, v2
s_lshl_b32 s48, s43, 5
s_add_u32 s48, s48, 16
v_add_u32 v4, s48, v4
v_lshlrev_b32 v49, 3, v4
v_add_u32 v49, 131072, v49
v_lshlrev_b32 v50, 2, v4
v_add_u32 v50, 132224, v50
v_lshlrev_b32 v51, 3, v2
v_add_u32 v51, 131072, v51
v_add_u32 v52, 132224, v30
s_getreg_b32 s50, hwreg(HW_REG_XCC_ID)
s_and_b32 s50, s50, 7
s_lshl_b32 s50, s50, 3
s_lshl_b64 s[94:95], 1, s50
s_and_b32 s96, s2, 7
s_lshl_b32 s96, s96, 3
s_cmp_eq_u32 s43, 1
s_cselect_b32 s97, 3, 99
s_lshl_b32 s72, s41, 2
s_add_u32 s72, s72, s43
s_lshl_b32 s72, s72, 7
s_add_u32 s72, s72, 18374656
s_lshl_b32 s50, s42, 2
s_add_u32 s50, s50, s43
s_lshl_b32 s50, s50, 12
s_add_u32 s50, s50, 17825792
v_add_u32 v38, s50, v18
v_min_u32 v4, 2, v3
v_lshlrev_b32 v4, 8, v4
v_lshl_add_u32 v4, v2, 2, v4
s_and_b32 s48, s43, 1
s_lshl_b32 s48, s48, 7
s_lshr_b32 s49, s43, 1
s_lshl_b32 s49, s49, 6
s_add_u32 s48, s48, s49
s_add_u32 s48, s48, 133376
v_add_u32 v53, s48, v4
s_lshl_b32 s50, s41, 12
s_add_u32 s50, s50, 17694720
v_add_u32 v39, s50, v18
s_getpc_b64 s[98:99]
pc_2:
s_add_u32 s98, s98, c0_epi - pc_2
s_addc_u32 s99, s99, 0
s_lshr_b32 s50, s2, 3
s_lshl_b32 s50, s50, 2
s_add_u32 s50, s50, s43
s_lshl_b32 s50, s50, 7
v_and_b32 v4, 1, v0
v_lshl_add_u32 v4, v4, 6, s50
v_min_u32 v54, L_code_end - c0_epi, v4
s_add_u32 s69, s47, 1
s_and_b32 s69, s69, 15
s_mul_i32 s67, s69, 128
s_mul_i32 s68, s69, 393216
s_cmp_lg_u32 s43, 0
s_cbranch_scc1 nohalo_3
s_mov_b32 m0, 43008
s_nop 0
buffer_load_dwordx4 v24, s[24:27], s67 offen  lds
buffer_load_dwordx4 v25, s[24:27], s67 offen offset:1024  lds
nohalo_3:
s_add_u32 m0, s70, 43008
s_nop 0
buffer_load_dwordx4 v20, s[24:27], s67 offen offset:0  lds
buffer_load_dwordx4 v21, s[24:27], s67 offen offset:1024  lds
buffer_load_dwordx4 v22, s[24:27], s67 offen offset:2048  lds
buffer_load_dwordx4 v23, s[24:27], s67 offen offset:3072  lds
s_add_u32 s48, s71, 43008
s_add_u32 m0, s48, 0
s_add_u32 s49, s68, 0
buffer_load_dwordx4 v26, s[28:31], s49 offen  lds
buffer_load_dwordx4 v27, s[28:31], s49 offen offset:1024  lds
s_add_u32 m0, s48, 8192
s_add_u32 s49, s68, 2048
buffer_load_dwordx4 v26, s[28:31], s49 offen  lds
buffer_load_dwordx4 v27, s[28:31], s49 offen offset:1024  lds
s_add_u32 m0, s48, 16384
s_add_u32 s49, s68, 4096
buffer_load_dwordx4 v26, s[28:31], s49 offen  lds
buffer_load_dwordx4 v27, s[28:31], s49 offen offset:1024  lds
s_waitcnt vmcnt(10)
s_barrier
s_add_u32 s49, s76, 2
s_and_b32 s49, s49, 15
s_mul_i32 s49, s49, 393216
buffer_load_dwordx4 v[40:43], v36, s[28:31], s49 offen
s_add_u32 s49, s76, 3
s_and_b32 s49, s49, 15
s_mul_i32 s49, s49, 393216
buffer_load_dwordx4 v[40:43], v36, s[28:31], s49 offen
s_add_u32 s69, s47, 2
s_and_b32 s69, s69, 15
s_mul_i32 s67, s69, 128
s_mul_i32 s68, s69, 393216
s_cmp_lg_u32 s43, 0
s_cbranch_scc1 nohalo_4
s_mov_b32 m0, 86016
s_nop 0
buffer_load_dwordx4 v24, s[24:27], s67 offen  lds
buffer_load_dwordx4 v25, s[24:27], s67 offen offset:1024  lds
nohalo_4:
s_add_u32 m0, s70, 86016
s_nop 0
buffer_load_dwordx4 v20, s[24:27], s67 offen offset:0  lds
buffer_load_dwordx4 v21, s[24:27], s67 offen offset:1024  lds
buffer_load_dwordx4 v22, s[24:27], s67 offen offset:2048  lds
buffer_load_dwordx4 v23, s[24:27], s67 offen offset:3072  lds
s_add_u32 s48, s71, 86016
s_add_u32 m0, s48, 0
s_add_u32 s49, s68, 0
buffer_load_dwordx4 v26, s[28:31], s49 offen  lds
buffer_load_dwordx4 v27, s[28:31], s49 offen offset:1024  lds
s_add_u32 m0, s48, 8192
s_add_u32 s49, s68, 2048
buffer_load_dwordx4 v26, s[28:31], s49 offen  lds
buffer_load_dwordx4 v27, s[28:31], s49 offen offset:1024  lds
s_add_u32 m0, s48, 16384
s_add_u32 s49, s68, 4096
buffer_load_dwordx4 v26, s[28:31], s49 offen  lds
buffer_load_dwordx4 v27, s[28:31], s49 offen offset:1024  lds
s_add_u32 s49, s76, 4
s_and_b32 s49, s49, 15
s_mul_i32 s49, s49, 393216
buffer_load_dwordx4 v[40:43], v36, s[28:31], s49 offen
s_mov_b32 s64, 0
s_mov_b32 s65, 0
h0_loop:
s_waitcnt vmcnt(11)
s_barrier
s_cmp_lg_u32 s64, s97
s_cbranch_scc1 h0_noarr
s_atomic_add_x2 s[94:95], s[20:21], s96
h0_noarr:
s_add_u32 s69, s69, 1
s_and_b32 s69, s69, 15
s_mul_i32 s67, s69, 128
s_mul_i32 s68, s69, 393216
s_cmp_lg_u32 s43, 0
s_cbranch_scc1 nohalo_5
s_mov_b32 m0, s65
s_nop 0
buffer_load_dwordx4 v24, s[24:27], s67 offen  lds
buffer_load_dwordx4 v25, s[24:27], s67 offen offset:1024  lds
nohalo_5:
s_add_u32 m0, s70, s65
s_nop 0
buffer_load_dwordx4 v20, s[24:27], s67 offen offset:0  lds
buffer_load_dwordx4 v21, s[24:27], s67 offen offset:1024  lds
buffer_load_dwordx4 v22, s[24:27], s67 offen offset:2048  lds
buffer_load_dwordx4 v23, s[24:27], s67 offen offset:3072  lds
s_add_u32 s48, s71, s65
s_add_u32 m0, s48, 0
s_add_u32 s49, s68, 0
buffer_load_dwordx4 v26, s[28:31], s49 offen  lds
buffer_load_dwordx4 v27, s[28:31], s49 offen offset:1024  lds
s_add_u32 m0, s48, 8192
s_add_u32 s49, s68, 2048
buffer_load_dwordx4 v26, s[28:31], s49 offen  lds
buffer_load_dwordx4 v27, s[28:31], s49 offen offset:1024  lds
s_add_u32 m0, s48, 16384
s_add_u32 s49, s68, 4096
buffer_load_dwordx4 v26, s[28:31], s49 offen  lds
buffer_load_dwordx4 v27, s[28:31], s49 offen offset:1024  lds
s_add_u32 s48, s64, 5
s_min_u32 s48, s48, 15
s_add_u32 s49, s48, s76
s_and_b32 s49, s49, 15
s_mul_i32 s49, s49, 393216
buffer_load_dwordx4 v[40:43], v36, s[28:31], s49 offen
s_add_u32 s65, s65, 43008
s_cmp_eq_u32 s65, 129024
s_cselect_b32 s65, 0, s65
s_add_u32 s64, s64, 1
s_cmp_lt_u32 s64, 12
s_cbranch_scc1 h0_loop
s_waitcnt vmcnt(11)
s_barrier
global_load_dwordx2 v[34:35], v32, s[20:21] sc1
global_load_dword v48, v54, s[98:99]
s_add_u32 s69, s69, 1
s_and_b32 s69, s69, 15
s_mul_i32 s67, s69, 128
s_mul_i32 s68, s69, 393216
s_cmp_lg_u32 s43, 0
s_cbranch_scc1 nohalo_6
s_mov_b32 m0, s65
s_nop 0
buffer_load_dwordx4 v24, s[24:27], s67 offen  lds
buffer_load_dwordx4 v25, s[24:27], s67 offen offset:1024  lds
nohalo_6:
s_add_u32 m0, s70, s65
s_nop 0
buffer_load_dwordx4 v20, s[24:27], s67 offen offset:0  lds
buffer_load_dwordx4 v21, s[24:27], s67 offen offset:1024  lds
buffer_load_dwordx4 v22, s[24:27], s67 offen offset:2048  lds
buffer_load_dwordx4 v23, s[24:27], s67 offen offset:3072  lds
s_add_u32 s48, s71, s65
s_add_u32 m0, s48, 0
s_add_u32 s49, s68, 0
buffer_load_dwordx4 v26, s[28:31], s49 offen  lds
buffer_load_dwordx4 v27, s[28:31], s49 offen offset:1024  lds
s_add_u32 m0, s48, 8192
s_add_u32 s49, s68, 2048
buffer_load_dwordx4 v26, s[28:31], s49 offen  lds
buffer_load_dwordx4 v27, s[28:31], s49 offen offset:1024  lds
s_add_u32 m0, s48, 16384
s_add_u32 s49, s68, 4096
buffer_load_dwordx4 v26, s[28:31], s49 offen  lds
buffer_load_dwordx4 v27, s[28:31], s49 offen offset:1024  lds
s_add_u32 s48, s64, 5
s_min_u32 s48, s48, 15
s_add_u32 s49, s48, s76
s_and_b32 s49, s49, 15
s_mul_i32 s49, s49, 393216
buffer_load_dwordx4 v[40:43], v36, s[28:31], s49 offen
s_add_u32 s65, s65, 43008
s_cmp_eq_u32 s65, 129024
s_cselect_b32 s65, 0, s65
s_add_u32 s64, s64, 1
s_mov_b32 s36, s8
s_and_b32 s37, s9, 0xffff
s_mov_b32 s38, 2097152
s_mov_b32 s39, 0x00020000
s_waitcnt vmcnt(11)
s_barrier
s_setprio 2
s_mov_b32 s63, 0
ipoll_7:
v_sad_u8 v4, v34, 0, 0
v_sad_u8 v4, v35, 0, v4
v_cmp_ne_u32 vcc, 32, v4
s_cbranch_vccz ipolled_8
global_load_dwordx2 v[34:35], v32, s[20:21] sc1
s_add_u32 s63, s63, 1
s_cmp_lt_u32 s63, 0x80000
s_waitcnt vmcnt(0)
s_cbranch_scc1 ipoll_7
ipolled_8:
s_cmp_lg_u32 s43, 3
s_cbranch_scc1 lw_9
buffer_load_dwordx4 v[96:99], v39, s[32:35], 0 offen offset:0 sc1
buffer_load_dwordx4 v[100:103], v39, s[32:35], 0 offen offset:1024 sc1
buffer_load_dwordx4 v[104:107], v39, s[32:35], 0 offen offset:2048 sc1
buffer_load_dwordx4 v[108:111], v39, s[32:35], 0 offen offset:3072 sc1
lw_9:
buffer_load_dwordx4 v[80:83], v37, s[32:35], 0 offen offset:0 sc1
buffer_load_dwordx4 v[84:87], v37, s[32:35], 0 offen offset:1024 sc1
buffer_load_dwordx4 v[88:91], v37, s[32:35], 0 offen offset:2048 sc1
buffer_load_dwordx4 v[92:95], v37, s[32:35], 0 offen offset:3072 sc1
buffer_load_dwordx4 v[64:67], v38, s[32:35], 0 offen offset:0 sc1
buffer_load_dwordx4 v[68:71], v38, s[32:35], 0 offen offset:1024 sc1
buffer_load_dwordx4 v[72:75], v38, s[32:35], 0 offen offset:2048 sc1
buffer_load_dwordx4 v[76:79], v38, s[32:35], 0 offen offset:3072 sc1
s_add_u32 s48, s47, 6
s_and_b32 s48, s48, 15
s_lshl_b32 s48, s48, 17
s_lshl_b32 s49, s43, 11
s_add_u32 m0, s49, 49152
s_nop 0
buffer_load_dwordx4 v28, s[36:39], s48 offen  lds
buffer_load_dwordx4 v29, s[36:39], s48 offen offset:1024  lds
s_add_u32 s48, s47, 7
s_and_b32 s48, s48, 15
s_lshl_b32 s48, s48, 17
s_lshl_b32 s49, s43, 11
s_add_u32 m0, s49, 57344
s_nop 0
buffer_load_dwordx4 v28, s[36:39], s48 offen  lds
buffer_load_dwordx4 v29, s[36:39], s48 offen offset:1024  lds
s_and_b32 s50, s2, 7
v_readlane_b32 s52, v34, s50
v_readlane_b32 s53, v35, s50
s_lshl_b64 s[48:49], s[94:95], 5
v_mov_b32 v4, 134912
s_nop 1
s_cmp_eq_u64 s[48:49], s[52:53]
s_cselect_b32 s48, 1, 0
v_mov_b32 v5, s48
ds_write_b32 v4, v5
s_waitcnt vmcnt(12)
s_barrier
s_add_u32 s48, s47, 8
s_and_b32 s48, s48, 15
s_lshl_b32 s48, s48, 17
s_lshl_b32 s49, s43, 11
s_add_u32 m0, s49, 65536
s_nop 0
buffer_load_dwordx4 v28, s[36:39], s48 offen  lds
buffer_load_dwordx4 v29, s[36:39], s48 offen offset:1024  lds
s_add_u32 s48, s47, 9
s_and_b32 s48, s48, 15
s_lshl_b32 s48, s48, 17
s_lshl_b32 s49, s43, 11
s_add_u32 m0, s49, 73728
s_nop 0
buffer_load_dwordx4 v28, s[36:39], s48 offen  lds
buffer_load_dwordx4 v29, s[36:39], s48 offen offset:1024  lds
s_waitcnt vmcnt(8)
v_pk_add_f32 v[80:81], v[80:81], v[88:89]
v_pk_add_f32 v[82:83], v[82:83], v[90:91]
v_pk_add_f32 v[84:85], v[84:85], v[92:93]
v_pk_add_f32 v[86:87], v[86:87], v[94:95]
v_pk_add_f32 v[80:81], v[80:81], v[84:85]
v_pk_add_f32 v[82:83], v[82:83], v[86:87]
s_nop 1
v_permlane32_swap_b32 v80, v81
v_permlane32_swap_b32 v82, v83
s_nop 0
v_add_f32 v80, v80, v81
v_add_f32 v82, v82, v83
s_nop 1
v_permlane16_swap_b32 v80, v82
s_nop 0
v_add_f32 v80, v80, v82
v_mul_f32 v44, 0x3a800000, v80
v_mov_b32 v45, v44
s_nop 1
v_permlane16_swap_b32 v44, v45
s_nop 0
v_fma_f32 v45, -v44, v44, v45
v_max_f32 v45, 0, v45
v_add_f32 v45, 0x3727c5ac, v45
v_rsq_f32 v46, v45
v_sub_f32 v47, 0, v44
ds_write_b32 v50, v47 offset:576
ds_write_b64 v49, v[46:47]
ds_write_b32 v50, v46
v_pk_add_f32 v[64:65], v[64:65], v[72:73]
v_pk_add_f32 v[66:67], v[66:67], v[74:75]
v_pk_add_f32 v[68:69], v[68:69], v[76:77]
v_pk_add_f32 v[70:71], v[70:71], v[78:79]
v_pk_add_f32 v[64:65], v[64:65], v[68:69]
v_pk_add_f32 v[66:67], v[66:67], v[70:71]
s_nop 1
v_permlane32_swap_b32 v64, v65
v_permlane32_swap_b32 v66, v67
s_nop 0
v_add_f32 v64, v64, v65
v_add_f32 v66, v66, v67
s_nop 1
v_permlane16_swap_b32 v64, v66
s_nop 0
v_add_f32 v64, v64, v66
ds_write_b32 v53, v64
s_cmp_lg_u32 s43, 3
s_cbranch_scc1 lw_10
v_pk_add_f32 v[96:97], v[96:97], v[104:105]
v_pk_add_f32 v[98:99], v[98:99], v[106:107]
v_pk_add_f32 v[100:101], v[100:101], v[108:109]
v_pk_add_f32 v[102:103], v[102:103], v[110:111]
v_pk_add_f32 v[96:97], v[96:97], v[100:101]
v_pk_add_f32 v[98:99], v[98:99], v[102:103]
s_nop 1
v_permlane32_swap_b32 v96, v97
v_permlane32_swap_b32 v98, v99
s_nop 0
v_add_f32 v96, v96, v97
v_add_f32 v98, v98, v99
s_nop 1
v_permlane16_swap_b32 v96, v98
s_nop 0
v_add_f32 v96, v96, v98
v_mul_f32 v44, 0x3a800000, v96
v_mov_b32 v45, v44
s_nop 1
v_permlane16_swap_b32 v44, v45
s_nop 0
v_fma_f32 v45, -v44, v44, v45
v_max_f32 v45, 0, v45
v_add_f32 v45, 0x3727c5ac, v45
v_rsq_f32 v46, v45
v_sub_f32 v47, 0, v44
s_mov_b32 exec_lo, 0
ds_write_b32 v52, v47 offset:576
ds_write_b64 v51, v[46:47]
ds_write_b32 v52, v46
s_mov_b64 exec, -1
lw_10:
s_add_u32 s48, s47, 10
s_and_b32 s48, s48, 15
s_lshl_b32 s48, s48, 17
s_lshl_b32 s49, s43, 11
s_add_u32 m0, s49, 81920
s_nop 0
buffer_load_dwordx4 v28, s[36:39], s48 offen  lds
buffer_load_dwordx4 v29, s[36:39], s48 offen offset:1024  lds
s_add_u32 s48, s47, 11
s_and_b32 s48, s48, 15
s_lshl_b32 s48, s48, 17
s_lshl_b32 s49, s43, 11
s_add_u32 m0, s49, 90112
s_nop 0
buffer_load_dwordx4 v28, s[36:39], s48 offen  lds
buffer_load_dwordx4 v29, s[36:39], s48 offen offset:1024  lds
s_setprio 0
s_waitcnt lgkmcnt(0)
s_barrier
s_add_u32 s48, s47, 12
s_and_b32 s48, s48, 15
s_lshl_b32 s48, s48, 17
s_lshl_b32 s49, s43, 11
s_add_u32 m0, s49, 98304
s_nop 0
buffer_load_dwordx4 v28, s[36:39], s48 offen  lds
buffer_load_dwordx4 v29, s[36:39], s48 offen offset:1024  lds
s_add_u32 s48, s47, 13
s_and_b32 s48, s48, 15
s_lshl_b32 s48, s48, 17
s_lshl_b32 s49, s43, 11
s_add_u32 m0, s49, 106496
s_nop 0
buffer_load_dwordx4 v28, s[36:39], s48 offen  lds
buffer_load_dwordx4 v29, s[36:39], s48 offen offset:1024  lds
s_barrier
s_add_u32 s48, s47, 14
s_and_b32 s48, s48, 15
s_lshl_b32 s48, s48, 17
s_lshl_b32 s49, s43, 11
s_add_u32 m0, s49, 114688
s_waitcnt vmcnt(4)
buffer_load_dwordx4 v28, s[36:39], s48 offen  lds
buffer_load_dwordx4 v29, s[36:39], s48 offen offset:1024  lds
s_add_u32 s48, s47, 15
s_and_b32 s48, s48, 15
s_lshl_b32 s48, s48, 17
s_lshl_b32 s49, s43, 11
s_add_u32 m0, s49, 122880
s_waitcnt vmcnt(4)
buffer_load_dwordx4 v28, s[36:39], s48 offen  lds
buffer_load_dwordx4 v29, s[36:39], s48 offen offset:1024  lds
s_add_u32 s48, s47, 0
s_and_b32 s48, s48, 15
s_lshl_b32 s48, s48, 17
s_lshl_b32 s49, s43, 11
s_add_u32 m0, s49, 0
s_waitcnt vmcnt(4)
buffer_load_dwordx4 v28, s[36:39], s48 offen  lds
buffer_load_dwordx4 v29, s[36:39], s48 offen offset:1024  lds
s_add_u32 s48, s47, 1
s_and_b32 s48, s48, 15
s_lshl_b32 s48, s48, 17
s_lshl_b32 s49, s43, 11
s_add_u32 m0, s49, 8192
s_waitcnt vmcnt(4)
buffer_load_dwordx4 v28, s[36:39], s48 offen  lds
buffer_load_dwordx4 v29, s[36:39], s48 offen offset:1024  lds
s_add_u32 s48, s47, 2
s_and_b32 s48, s48, 15
s_lshl_b32 s48, s48, 17
s_lshl_b32 s49, s43, 11
s_add_u32 m0, s49, 16384
s_waitcnt vmcnt(4)
buffer_load_dwordx4 v28, s[36:39], s48 offen  lds
buffer_load_dwordx4 v29, s[36:39], s48 offen offset:1024  lds
s_add_u32 s48, s47, 3
s_and_b32 s48, s48, 15
s_lshl_b32 s48, s48, 17
s_lshl_b32 s49, s43, 11
s_add_u32 m0, s49, 24576
s_waitcnt vmcnt(4)
buffer_load_dwordx4 v28, s[36:39], s48 offen  lds
buffer_load_dwordx4 v29, s[36:39], s48 offen offset:1024  lds
s_add_u32 s48, s47, 4
s_and_b32 s48, s48, 15
s_lshl_b32 s48, s48, 17
s_lshl_b32 s49, s43, 11
s_add_u32 m0, s49, 32768
s_waitcnt vmcnt(4)
buffer_load_dwordx4 v28, s[36:39], s48 offen  lds
buffer_load_dwordx4 v29, s[36:39], s48 offen offset:1024  lds
s_add_u32 s48, s47, 5
s_and_b32 s48, s48, 15
s_lshl_b32 s48, s48, 17
s_lshl_b32 s49, s43, 11
s_add_u32 m0, s49, 40960
s_waitcnt vmcnt(4)
buffer_load_dwordx4 v28, s[36:39], s48 offen  lds
buffer_load_dwordx4 v29, s[36:39], s48 offen offset:1024  lds
s_mov_b32 s28, s12
s_and_b32 s29, s13, 0xffff
s_mov_b32 s30, 6291456
s_mov_b32 s31, 0x00020000
v_lshrrev_b32 v4, 3, v0
v_and_b32 v5, 7, v0
s_lshr_b32 s48, s43, 1
s_lshl_b32 s48, s48, 5
s_and_b32 s49, s43, 1
s_lshl_b32 s49, s49, 3
s_add_u32 s48, s48, s49
v_lshrrev_b32 v6, 2, v4
v_lshlrev_b32 v6, 4, v6
v_and_b32 v7, 3, v4
v_add3_u32 v6, v6, v7, s48
v_mul_u32_u24 v6, 6144, v6
v_and_b32 v7, 2, v4
v_xor_b32 v7, v7, v5
s_lshl_b32 s48, s42, 7
v_lshl_add_u32 v26, v7, 4, v6
v_add_u32 v26, s48, v26
v_xor_b32 v27, 64, v26
v_add_u32 v27, 23552, v27
s_add_u32 s69, s47, 0
s_and_b32 s69, s69, 15
s_mul_i32 s67, s69, 128
s_mul_i32 s68, s69, 393216
s_waitcnt vmcnt(0)
s_barrier
s_add_u32 s48, s71, 120832
s_add_u32 m0, s48, 0
s_add_u32 s49, s68, 0
buffer_load_dwordx4 v26, s[28:31], s49 offen  lds
buffer_load_dwordx4 v27, s[28:31], s49 offen offset:1024  lds
s_add_u32 m0, s48, 8192
s_add_u32 s49, s68, 2048
buffer_load_dwordx4 v26, s[28:31], s49 offen  lds
buffer_load_dwordx4 v27, s[28:31], s49 offen offset:1024  lds
s_add_u32 m0, s48, 16384
s_add_u32 s49, s68, 4096
buffer_load_dwordx4 v26, s[28:31], s49 offen  lds
buffer_load_dwordx4 v27, s[28:31], s49 offen offset:1024  lds
s_mov_b32 s36, s14
s_and_b32 s37, s15, 0xffff
s_mov_b32 s38, 65536
s_mov_b32 s39, 0x00020000
s_lshl_b32 s48, s42, 12
s_lshl_b32 s49, s43, 10
s_add_u32 s48, s48, s49
s_add_u32 m0, s49, 135168
s_nop 0
buffer_load_dwordx4 v18, s[36:39], s48 offen lds
s_lshl_b32 s48, s41, 3
s_lshl_b32 s49, s43, 1
s_add_u32 s48, s48, s49
s_lshl_b32 s48, s48, 15
v_add_u32 v20, s48, v18
v_mov_b32 v21, v20
v_add_u32 v22, 30720, v20
v_mov_b32 v23, v22
s_lshl_b32 s50, s42, 2
s_add_u32 s50, s50, s43
s_lshl_b32 s50, s50, 12
s_add_u32 s50, s50, 18087936
v_add_u32 v38, s50, v18
v_min_u32 v4, 2, v3
v_lshlrev_b32 v4, 8, v4
v_lshl_add_u32 v4, v2, 2, v4
s_and_b32 s48, s43, 1
s_lshl_b32 s48, s48, 7
s_lshr_b32 s49, s43, 1
s_lshl_b32 s49, s49, 6
s_add_u32 s48, s48, s49
s_add_u32 s48, s48, 134144
v_add_u32 v53, s48, v4
s_lshl_b32 s73, s42, 2
s_add_u32 s73, s73, s43
s_lshl_b32 s73, s73, 7
s_add_u32 s73, s73, 18382848
s_getpc_b64 s[98:99]
pc_11:
s_add_u32 s98, s98, c1_epi - pc_11
s_addc_u32 s99, s99, 0
s_lshr_b32 s50, s2, 3
s_lshl_b32 s50, s50, 2
s_add_u32 s50, s50, s43
s_lshl_b32 s50, s50, 7
v_and_b32 v4, 1, v0
v_lshl_add_u32 v4, v4, 6, s50
v_min_u32 v54, L_code_end - c1_epi, v4
s_lshl_b32 s52, s41, 2
s_add_u32 s52, s52, s43
s_lshl_b32 s52, s52, 7
s_add_u32 s52, s52, 18358272
s_add_u32 s69, s47, 1
s_and_b32 s69, s69, 15
s_mul_i32 s67, s69, 2048
s_mul_i32 s68, s69, 393216
s_barrier
s_add_u32 s48, s71, 43008
s_add_u32 m0, s48, 0
s_add_u32 s49, s68, 0
buffer_load_dwordx4 v26, s[28:31], s49 offen  lds
buffer_load_dwordx4 v27, s[28:31], s49 offen offset:1024  lds
s_add_u32 m0, s48, 8192
s_add_u32 s49, s68, 2048
buffer_load_dwordx4 v26, s[28:31], s49 offen  lds
buffer_load_dwordx4 v27, s[28:31], s49 offen offset:1024  lds
s_add_u32 m0, s48, 16384
s_add_u32 s49, s68, 4096
buffer_load_dwordx4 v26, s[28:31], s49 offen  lds
buffer_load_dwordx4 v27, s[28:31], s49 offen offset:1024  lds
v_and_b32 v4, 15, v0
v_lshlrev_b32 v4, 2, v4
buffer_load_dword v5, v4, s[32:35], s52 offen sc1
s_mov_b32 s63, 0
s_waitcnt vmcnt(0)
poll_12:
v_cmp_gt_u32 vcc, 1, v5
s_cbranch_vccz polled_13
buffer_load_dword v5, v4, s[32:35], s52 offen sc1
s_add_u32 s63, s63, 1
s_cmp_lt_u32 s63, 0x80000
s_waitcnt vmcnt(0)
s_cbranch_scc1 poll_12
polled_13:
s_add_u32 s69, s47, 0
s_and_b32 s69, s69, 15
s_mul_i32 s67, s69, 2048
s_mul_i32 s68, s69, 393216
s_add_u32 m0, s70, 0
s_nop 0
buffer_load_dwordx4 v20, s[32:35], s67 offen offset:0 sc1 lds
buffer_load_dwordx4 v21, s[32:35], s67 offen offset:1024 sc1 lds
buffer_load_dwordx4 v22, s[32:35], s67 offen offset:2048 sc1 lds
buffer_load_dwordx4 v23, s[32:35], s67 offen offset:3072 sc1 lds
s_add_u32 s69, s47, 1
s_and_b32 s69, s69, 15
s_mul_i32 s67, s69, 2048
s_mul_i32 s68, s69, 393216
s_add_u32 m0, s70, 43008
s_nop 0
buffer_load_dwordx4 v20, s[32:35], s67 offen offset:0 sc1 lds
buffer_load_dwordx4 v21, s[32:35], s67 offen offset:1024 sc1 lds
buffer_load_dwordx4 v22, s[32:35], s67 offen offset:2048 sc1 lds
buffer_load_dwordx4 v23, s[32:35], s67 offen offset:3072 sc1 lds
s_waitcnt vmcnt(4)
s_barrier
s_add_u32 s49, s76, 2
s_and_b32 s49, s49, 15
s_mul_i32 s49, s49, 393216
buffer_load_dwordx4 v[40:43], v36, s[28:31], s49 offen
s_add_u32 s49, s76, 3
s_and_b32 s49, s49, 15
s_mul_i32 s49, s49, 393216
buffer_load_dwordx4 v[40:43], v36, s[28:31], s49 offen
s_add_u32 s69, s47, 2
s_and_b32 s69, s69, 15
s_mul_i32 s67, s69, 2048
s_mul_i32 s68, s69, 393216
s_add_u32 m0, s70, 86016
s_nop 0
buffer_load_dwordx4 v20, s[32:35], s67 offen offset:0 sc1 lds
buffer_load_dwordx4 v21, s[32:35], s67 offen offset:1024 sc1 lds
buffer_load_dwordx4 v22, s[32:35], s67 offen offset:2048 sc1 lds
buffer_load_dwordx4 v23, s[32:35], s67 offen offset:3072 sc1 lds
s_add_u32 s48, s71, 86016
s_add_u32 m0, s48, 0
s_add_u32 s49, s68, 0
buffer_load_dwordx4 v26, s[28:31], s49 offen  lds
buffer_load_dwordx4 v27, s[28:31], s49 offen offset:1024  lds
s_add_u32 m0, s48, 8192
s_add_u32 s49, s68, 2048
buffer_load_dwordx4 v26, s[28:31], s49 offen  lds
buffer_load_dwordx4 v27, s[28:31], s49 offen offset:1024  lds
s_add_u32 m0, s48, 16384
s_add_u32 s49, s68, 4096
buffer_load_dwordx4 v26, s[28:31], s49 offen  lds
buffer_load_dwordx4 v27, s[28:31], s49 offen offset:1024  lds
s_add_u32 s49, s76, 4
s_and_b32 s49, s49, 15
s_mul_i32 s49, s49, 393216
buffer_load_dwordx4 v[40:43], v36, s[28:31], s49 offen
s_mov_b32 s64, 0
s_mov_b32 s65, 0
h1_loop:
s_waitcnt vmcnt(11)
s_barrier
s_add_u32 s69, s69, 1
s_and_b32 s69, s69, 15
s_mul_i32 s67, s69, 2048
s_mul_i32 s68, s69, 393216
s_add_u32 m0, s70, s65
s_nop 0
buffer_load_dwordx4 v20, s[32:35], s67 offen offset:0 sc1 lds
buffer_load_dwordx4 v21, s[32:35], s67 offen offset:1024 sc1 lds
buffer_load_dwordx4 v22, s[32:35], s67 offen offset:2048 sc1 lds
buffer_load_dwordx4 v23, s[32:35], s67 offen offset:3072 sc1 lds
s_add_u32 s48, s71, s65
s_add_u32 m0, s48, 0
s_add_u32 s49, s68, 0
buffer_load_dwordx4 v26, s[28:31], s49 offen  lds
buffer_load_dwordx4 v27, s[28:31], s49 offen offset:1024  lds
s_add_u32 m0, s48, 8192
s_add_u32 s49, s68, 2048
buffer_load_dwordx4 v26, s[28:31], s49 offen  lds
buffer_load_dwordx4 v27, s[28:31], s49 offen offset:1024  lds
s_add_u32 m0, s48, 16384
s_add_u32 s49, s68, 4096
buffer_load_dwordx4 v26, s[28:31], s49 offen  lds
buffer_load_dwordx4 v27, s[28:31], s49 offen offset:1024  lds
s_add_u32 s48, s64, 5
s_min_u32 s48, s48, 15
s_add_u32 s49, s48, s76
s_and_b32 s49, s49, 15
s_mul_i32 s49, s49, 393216
buffer_load_dwordx4 v[40:43], v36, s[28:31], s49 offen
s_add_u32 s65, s65, 43008
s_cmp_eq_u32 s65, 129024
s_cselect_b32 s65, 0, s65
s_add_u32 s64, s64, 1
s_cmp_lt_u32 s64, 12
s_cbranch_scc1 h1_loop
s_waitcnt vmcnt(11)
s_barrier
buffer_load_dword v31, v30, s[32:35], s72 offen sc1
buffer_load_dword v33, v30, s[32:35], s73 offen sc1
global_load_dword v48, v54, s[98:99]
s_add_u32 s69, s69, 1
s_and_b32 s69, s69, 15
s_mul_i32 s67, s69, 2048
s_mul_i32 s68, s69, 393216
s_add_u32 m0, s70, s65
s_nop 0
buffer_load_dwordx4 v20, s[32:35], s67 offen offset:0 sc1 lds
buffer_load_dwordx4 v21, s[32:35], s67 offen offset:1024 sc1 lds
buffer_load_dwordx4 v22, s[32:35], s67 offen offset:2048 sc1 lds
buffer_load_dwordx4 v23, s[32:35], s67 offen offset:3072 sc1 lds
s_add_u32 s48, s71, s65
s_add_u32 m0, s48, 0
s_add_u32 s49, s68, 0
buffer_load_dwordx4 v26, s[28:31], s49 offen  lds
buffer_load_dwordx4 v27, s[28:31], s49 offen offset:1024  lds
s_add_u32 m0, s48, 8192
s_add_u32 s49, s68, 2048
buffer_load_dwordx4 v26, s[28:31], s49 offen  lds
buffer_load_dwordx4 v27, s[28:31], s49 offen offset:1024  lds
s_add_u32 m0, s48, 16384
s_add_u32 s49, s68, 4096
buffer_load_dwordx4 v26, s[28:31], s49 offen  lds
buffer_load_dwordx4 v27, s[28:31], s49 offen offset:1024  lds
s_add_u32 s48, s64, 5
s_min_u32 s48, s48, 15
s_add_u32 s49, s48, s76
s_and_b32 s49, s49, 15
s_mul_i32 s49, s49, 393216
buffer_load_dwordx4 v[40:43], v36, s[28:31], s49 offen
s_add_u32 s65, s65, 43008
s_cmp_eq_u32 s65, 129024
s_cselect_b32 s65, 0, s65
s_add_u32 s64, s64, 1
s_mov_b32 s36, s16
s_and_b32 s37, s17, 0xffff
s_mov_b32 s38, 2097152
s_mov_b32 s39, 0x00020000
s_waitcnt vmcnt(11)
s_barrier
s_setprio 2
s_mov_b32 s63, 0
poll_14:
v_cmp_gt_u32 vcc, 1, v31
s_cbranch_vccz polled_15
buffer_load_dword v31, v30, s[32:35], s72 offen sc1
s_add_u32 s63, s63, 1
s_cmp_lt_u32 s63, 0x80000
s_waitcnt vmcnt(0)
s_cbranch_scc1 poll_14
polled_15:
s_mov_b32 s63, 0
poll_16:
v_cmp_gt_u32 vcc, 1, v33
s_cbranch_vccz polled_17
buffer_load_dword v33, v30, s[32:35], s73 offen sc1
s_add_u32 s63, s63, 1
s_cmp_lt_u32 s63, 0x80000
s_waitcnt vmcnt(0)
s_cbranch_scc1 poll_16
polled_17:
buffer_load_dwordx4 v[80:83], v37, s[32:35], 0 offen offset:0 sc1
buffer_load_dwordx4 v[84:87], v37, s[32:35], 0 offen offset:1024 sc1
buffer_load_dwordx4 v[88:91], v37, s[32:35], 0 offen offset:2048 sc1
buffer_load_dwordx4 v[92:95], v37, s[32:35], 0 offen offset:3072 sc1
buffer_load_dwordx4 v[64:67], v38, s[32:35], 0 offen offset:0 sc1
buffer_load_dwordx4 v[68:71], v38, s[32:35], 0 offen offset:1024 sc1
buffer_load_dwordx4 v[72:75], v38, s[32:35], 0 offen offset:2048 sc1
buffer_load_dwordx4 v[76:79], v38, s[32:35], 0 offen offset:3072 sc1
s_add_u32 s48, s47, 6
s_and_b32 s48, s48, 15
s_lshl_b32 s48, s48, 17
s_lshl_b32 s49, s43, 11
s_add_u32 m0, s49, 49152
s_nop 0
buffer_load_dwordx4 v28, s[36:39], s48 offen  lds
buffer_load_dwordx4 v29, s[36:39], s48 offen offset:1024  lds
s_add_u32 s48, s47, 7
s_and_b32 s48, s48, 15
s_lshl_b32 s48, s48, 17
s_lshl_b32 s49, s43, 11
s_add_u32 m0, s49, 57344
s_nop 0
buffer_load_dwordx4 v28, s[36:39], s48 offen  lds
buffer_load_dwordx4 v29, s[36:39], s48 offen offset:1024  lds
s_waitcnt vmcnt(12)
s_barrier
s_add_u32 s48, s47, 8
s_and_b32 s48, s48, 15
s_lshl_b32 s48, s48, 17
s_lshl_b32 s49, s43, 11
s_add_u32 m0, s49, 65536
s_nop 0
buffer_load_dwordx4 v28, s[36:39], s48 offen  lds
buffer_load_dwordx4 v29, s[36:39], s48 offen offset:1024  lds
s_add_u32 s48, s47, 9
s_and_b32 s48, s48, 15
s_lshl_b32 s48, s48, 17
s_lshl_b32 s49, s43, 11
s_add_u32 m0, s49, 73728
s_nop 0
buffer_load_dwordx4 v28, s[36:39], s48 offen  lds
buffer_load_dwordx4 v29, s[36:39], s48 offen offset:1024  lds
s_waitcnt vmcnt(8)
v_pk_add_f32 v[80:81], v[80:81], v[88:89]
v_pk_add_f32 v[82:83], v[82:83], v[90:91]
v_pk_add_f32 v[84:85], v[84:85], v[92:93]
v_pk_add_f32 v[86:87], v[86:87], v[94:95]
v_pk_add_f32 v[80:81], v[80:81], v[84:85]
v_pk_add_f32 v[82:83], v[82:83], v[86:87]
s_nop 1
v_permlane32_swap_b32 v80, v81
v_permlane32_swap_b32 v82, v83
s_nop 0
v_add_f32 v80, v80, v81
v_add_f32 v82, v82, v83
s_nop 1
v_permlane16_swap_b32 v80, v82
s_nop 0
v_add_f32 v80, v80, v82
v_mul_f32 v44, 0x3a800000, v80
v_mov_b32 v45, v44
s_nop 1
v_permlane16_swap_b32 v44, v45
s_nop 0
v_fma_f32 v45, -v44, v44, v45
v_max_f32 v45, 0, v45
v_add_f32 v45, 0x3727c5ac, v45
v_rsq_f32 v46, v45
v_sub_f32 v47, 0, v44
ds_write_b32 v50, v47 offset:576
ds_write_b64 v49, v[46:47]
ds_write_b32 v50, v46
v_pk_add_f32 v[64:65], v[64:65], v[72:73]
v_pk_add_f32 v[66:67], v[66:67], v[74:75]
v_pk_add_f32 v[68:69], v[68:69], v[76:77]
v_pk_add_f32 v[70:71], v[70:71], v[78:79]
v_pk_add_f32 v[64:65], v[64:65], v[68:69]
v_pk_add_f32 v[66:67], v[66:67], v[70:71]
s_nop 1
v_permlane32_swap_b32 v64, v65
v_permlane32_swap_b32 v66, v67
s_nop 0
v_add_f32 v64, v64, v65
v_add_f32 v66, v66, v67
s_nop 1
v_permlane16_swap_b32 v64, v66
s_nop 0
v_add_f32 v64, v64, v66
ds_write_b32 v53, v64
s_add_u32 s48, s47, 10
s_and_b32 s48, s48, 15
s_lshl_b32 s48, s48, 17
s_lshl_b32 s49, s43, 11
s_add_u32 m0, s49, 81920
s_nop 0
buffer_load_dwordx4 v28, s[36:39], s48 offen  lds
buffer_load_dwordx4 v29, s[36:39], s48 offen offset:1024  lds
s_add_u32 s48, s47, 11
s_and_b32 s48, s48, 15
s_lshl_b32 s48, s48, 17
s_lshl_b32 s49, s43, 11
s_add_u32 m0, s49, 90112
s_nop 0
buffer_load_dwordx4 v28, s[36:39], s48 offen  lds
buffer_load_dwordx4 v29, s[36:39], s48 offen offset:1024  lds
s_setprio 0
s_waitcnt lgkmcnt(0)
s_barrier
s_add_u32 s48, s47, 12
s_and_b32 s48, s48, 15
s_lshl_b32 s48, s48, 17
s_lshl_b32 s49, s43, 11
s_add_u32 m0, s49, 98304
s_waitcnt vmcnt(4)
buffer_load_dwordx4 v28, s[36:39], s48 offen  lds
buffer_load_dwordx4 v29, s[36:39], s48 offen offset:1024  lds
s_add_u32 s48, s47, 13
s_and_b32 s48, s48, 15
s_lshl_b32 s48, s48, 17
s_lshl_b32 s49, s43, 11
s_add_u32 m0, s49, 106496
s_waitcnt vmcnt(4)
buffer_load_dwordx4 v28, s[36:39], s48 offen  lds
buffer_load_dwordx4 v29, s[36:39], s48 offen offset:1024  lds
s_add_u32 s48, s47, 14
s_and_b32 s48, s48, 15
s_lshl_b32 s48, s48, 17
s_lshl_b32 s49, s43, 11
s_add_u32 m0, s49, 114688
s_waitcnt vmcnt(4)
buffer_load_dwordx4 v28, s[36:39], s48 offen  lds
buffer_load_dwordx4 v29, s[36:39], s48 offen offset:1024  lds
s_add_u32 s48, s47, 15
s_and_b32 s48, s48, 15
s_lshl_b32 s48, s48, 17
s_lshl_b32 s49, s43, 11
s_add_u32 m0, s49, 122880
s_waitcnt vmcnt(4)
buffer_load_dwordx4 v28, s[36:39], s48 offen  lds
buffer_load_dwordx4 v29, s[36:39], s48 offen offset:1024  lds
s_add_u32 s48, s47, 0
s_and_b32 s48, s48, 15
s_lshl_b32 s48, s48, 17
s_lshl_b32 s49, s43, 11
s_add_u32 m0, s49, 0
s_waitcnt vmcnt(4)
buffer_load_dwordx4 v28, s[36:39], s48 offen  lds
buffer_load_dwordx4 v29, s[36:39], s48 offen offset:1024  lds
s_add_u32 s48, s47, 1
s_and_b32 s48, s48, 15
s_lshl_b32 s48, s48, 17
s_lshl_b32 s49, s43, 11
s_add_u32 m0, s49, 8192
s_waitcnt vmcnt(4)
buffer_load_dwordx4 v28, s[36:39], s48 offen  lds
buffer_load_dwordx4 v29, s[36:39], s48 offen offset:1024  lds
s_add_u32 s48, s47, 2
s_and_b32 s48, s48, 15
s_lshl_b32 s48, s48, 17
s_lshl_b32 s49, s43, 11
s_add_u32 m0, s49, 16384
s_waitcnt vmcnt(4)
buffer_load_dwordx4 v28, s[36:39], s48 offen  lds
buffer_load_dwordx4 v29, s[36:39], s48 offen offset:1024  lds
s_add_u32 s48, s47, 3
s_and_b32 s48, s48, 15
s_lshl_b32 s48, s48, 17
s_lshl_b32 s49, s43, 11
s_add_u32 m0, s49, 24576
s_waitcnt vmcnt(4)
buffer_load_dwordx4 v28, s[36:39], s48 offen  lds
buffer_load_dwordx4 v29, s[36:39], s48 offen offset:1024  lds
s_add_u32 s48, s47, 4
s_and_b32 s48, s48, 15
s_lshl_b32 s48, s48, 17
s_lshl_b32 s49, s43, 11
s_add_u32 m0, s49, 32768
s_waitcnt vmcnt(4)
buffer_load_dwordx4 v28, s[36:39], s48 offen  lds
buffer_load_dwordx4 v29, s[36:39], s48 offen offset:1024  lds
s_add_u32 s48, s47, 5
s_and_b32 s48, s48, 15
s_lshl_b32 s48, s48, 17
s_lshl_b32 s49, s43, 11
s_add_u32 m0, s49, 40960
s_waitcnt vmcnt(4)
buffer_load_dwordx4 v28, s[36:39], s48 offen  lds
buffer_load_dwordx4 v29, s[36:39], s48 offen offset:1024  lds
s_mov_b32 s28, s6
s_and_b32 s29, s7, 0xffff
s_mov_b32 s30, 6291456
s_mov_b32 s31, 0x00020000
s_add_u32 s69, s47, 0
s_and_b32 s69, s69, 15
s_mul_i32 s67, s69, 2048
s_mul_i32 s68, s69, 393216
s_waitcnt vmcnt(0)
s_barrier
s_add_u32 s48, s71, 120832
s_add_u32 m0, s48, 0
s_add_u32 s49, s68, 0
buffer_load_dwordx4 v26, s[28:31], s49 offen  lds
buffer_load_dwordx4 v27, s[28:31], s49 offen offset:1024  lds
s_add_u32 m0, s48, 8192
s_add_u32 s49, s68, 2048
buffer_load_dwordx4 v26, s[28:31], s49 offen  lds
buffer_load_dwordx4 v27, s[28:31], s49 offen offset:1024  lds
s_add_u32 m0, s48, 16384
s_add_u32 s49, s68, 4096
buffer_load_dwordx4 v26, s[28:31], s49 offen  lds
buffer_load_dwordx4 v27, s[28:31], s49 offen offset:1024  lds
s_sub_u32 s48, s41, 1
s_lshl_b32 s48, s48, 15
s_add_u32 s48, s48, 16908288
s_cmp_eq_u32 s41, 0
s_cselect_b32 s48, 0xf0000000, s48
v_add_u32 v24, s48, v18
v_mov_b32 v25, v24
s_sub_u32 s50, s41, 1
s_lshl_b32 s50, s50, 12
s_add_u32 s50, s50, 17760256
s_cmp_eq_u32 s41, 0
s_cselect_b32 s50, 0xf0000000, s50
v_add_u32 v39, s50, v18
s_sub_u32 s53, s41, 1
s_max_i32 s53, s53, 0
s_lshl_b32 s73, s53, 2
s_add_u32 s73, s73, 1
s_lshl_b32 s73, s73, 7
s_add_u32 s73, s73, 18391040
s_getpc_b64 s[98:99]
pc_18:
s_add_u32 s98, s98, c2_epi - pc_18
s_addc_u32 s99, s99, 0
s_lshr_b32 s50, s2, 3
s_lshl_b32 s50, s50, 2
s_add_u32 s50, s50, s43
s_lshl_b32 s50, s50, 7
v_and_b32 v4, 1, v0
v_lshl_add_u32 v4, v4, 6, s50
v_min_u32 v54, L_code_end - c2_epi, v4
s_lshl_b32 s52, s41, 2
s_add_u32 s52, s52, s43
s_lshl_b32 s52, s52, 7
s_add_u32 s52, s52, 18358272
s_add_u32 s69, s47, 1
s_and_b32 s69, s69, 15
s_mul_i32 s67, s69, 2048
s_mul_i32 s68, s69, 393216
s_barrier
s_add_u32 s48, s71, 43008
s_add_u32 m0, s48, 0
s_add_u32 s49, s68, 0
buffer_load_dwordx4 v26, s[28:31], s49 offen  lds
buffer_load_dwordx4 v27, s[28:31], s49 offen offset:1024  lds
s_add_u32 m0, s48, 8192
s_add_u32 s49, s68, 2048
buffer_load_dwordx4 v26, s[28:31], s49 offen  lds
buffer_load_dwordx4 v27, s[28:31], s49 offen offset:1024  lds
s_add_u32 m0, s48, 16384
s_add_u32 s49, s68, 4096
buffer_load_dwordx4 v26, s[28:31], s49 offen  lds
buffer_load_dwordx4 v27, s[28:31], s49 offen offset:1024  lds
v_and_b32 v4, 15, v0
v_lshlrev_b32 v4, 2, v4
buffer_load_dword v5, v4, s[32:35], s52 offen sc1
s_mov_b32 s63, 0
s_waitcnt vmcnt(0)
poll_19:
v_cmp_gt_u32 vcc, 2, v5
s_cbranch_vccz polled_20
buffer_load_dword v5, v4, s[32:35], s52 offen sc1
s_add_u32 s63, s63, 1
s_cmp_lt_u32 s63, 0x80000
s_waitcnt vmcnt(0)
s_cbranch_scc1 poll_19
polled_20:
s_cmp_lg_u32 s43, 0
s_cbranch_scc1 lw_21
s_cmp_eq_u32 s41, 0
s_cbranch_scc1 nohp_22
s_sub_u32 s53, s41, 1
s_lshl_b32 s52, s53, 2
s_add_u32 s52, s52, 0
s_lshl_b32 s52, s52, 7
s_add_u32 s52, s52, 18391040
v_and_b32 v4, 15, v0
v_lshlrev_b32 v4, 2, v4
buffer_load_dword v5, v4, s[32:35], s52 offen sc1
s_mov_b32 s63, 0
s_waitcnt vmcnt(0)
poll_23:
v_cmp_gt_u32 vcc, 1, v5
s_cbranch_vccz polled_24
buffer_load_dword v5, v4, s[32:35], s52 offen sc1
s_add_u32 s63, s63, 1
s_cmp_lt_u32 s63, 0x80000
s_waitcnt vmcnt(0)
s_cbranch_scc1 poll_23
polled_24:
nohp_22:
lw_21:
s_add_u32 s69, s47, 0
s_and_b32 s69, s69, 15
s_mul_i32 s67, s69, 2048
s_mul_i32 s68, s69, 393216
s_cmp_lg_u32 s43, 0
s_cbranch_scc1 nohalo_25
s_mov_b32 m0, 0
s_nop 0
buffer_load_dwordx4 v24, s[32:35], s67 offen sc1 lds
buffer_load_dwordx4 v25, s[32:35], s67 offen offset:1024 sc1 lds
nohalo_25:
s_add_u32 m0, s70, 0
s_nop 0
buffer_load_dwordx4 v20, s[32:35], s67 offen offset:0 sc1 lds
buffer_load_dwordx4 v21, s[32:35], s67 offen offset:1024 sc1 lds
buffer_load_dwordx4 v22, s[32:35], s67 offen offset:2048 sc1 lds
buffer_load_dwordx4 v23, s[32:35], s67 offen offset:3072 sc1 lds
s_add_u32 s69, s47, 1
s_and_b32 s69, s69, 15
s_mul_i32 s67, s69, 2048
s_mul_i32 s68, s69, 393216
s_cmp_lg_u32 s43, 0
s_cbranch_scc1 nohalo_26
s_mov_b32 m0, 43008
s_nop 0
buffer_load_dwordx4 v24, s[32:35], s67 offen sc1 lds
buffer_load_dwordx4 v25, s[32:35], s67 offen offset:1024 sc1 lds
nohalo_26:
s_add_u32 m0, s70, 43008
s_nop 0
buffer_load_dwordx4 v20, s[32:35], s67 offen offset:0 sc1 lds
buffer_load_dwordx4 v21, s[32:35], s67 offen offset:1024 sc1 lds
buffer_load_dwordx4 v22, s[32:35], s67 offen offset:2048 sc1 lds
buffer_load_dwordx4 v23, s[32:35], s67 offen offset:3072 sc1 lds
s_waitcnt vmcnt(4)
s_barrier
s_add_u32 s49, s76, 2
s_and_b32 s49, s49, 15
s_mul_i32 s49, s49, 393216
buffer_load_dwordx4 v[40:43], v36, s[28:31], s49 offen
s_add_u32 s49, s76, 3
s_and_b32 s49, s49, 15
s_mul_i32 s49, s49, 393216
buffer_load_dwordx4 v[40:43], v36, s[28:31], s49 offen
s_add_u32 s69, s47, 2
s_and_b32 s69, s69, 15
s_mul_i32 s67, s69, 2048
s_mul_i32 s68, s69, 393216
s_cmp_lg_u32 s43, 0
s_cbranch_scc1 nohalo_27
s_mov_b32 m0, 86016
s_nop 0
buffer_load_dwordx4 v24, s[32:35], s67 offen sc1 lds
buffer_load_dwordx4 v25, s[32:35], s67 offen offset:1024 sc1 lds
nohalo_27:
s_add_u32 m0, s70, 86016
s_nop 0
buffer_load_dwordx4 v20, s[32:35], s67 offen offset:0 sc1 lds
buffer_load_dwordx4 v21, s[32:35], s67 offen offset:1024 sc1 lds
buffer_load_dwordx4 v22, s[32:35], s67 offen offset:2048 sc1 lds
buffer_load_dwordx4 v23, s[32:35], s67 offen offset:3072 sc1 lds
s_add_u32 s48, s71, 86016
s_add_u32 m0, s48, 0
s_add_u32 s49, s68, 0
buffer_load_dwordx4 v26, s[28:31], s49 offen  lds
buffer_load_dwordx4 v27, s[28:31], s49 offen offset:1024  lds
s_add_u32 m0, s48, 8192
s_add_u32 s49, s68, 2048
buffer_load_dwordx4 v26, s[28:31], s49 offen  lds
buffer_load_dwordx4 v27, s[28:31], s49 offen offset:1024  lds
s_add_u32 m0, s48, 16384
s_add_u32 s49, s68, 4096
buffer_load_dwordx4 v26, s[28:31], s49 offen  lds
buffer_load_dwordx4 v27, s[28:31], s49 offen offset:1024  lds
s_add_u32 s49, s76, 4
s_and_b32 s49, s49, 15
s_mul_i32 s49, s49, 393216
buffer_load_dwordx4 v[40:43], v36, s[28:31], s49 offen
s_mov_b32 s64, 0
s_mov_b32 s65, 0
h2_loop:
s_waitcnt vmcnt(11)
s_barrier
s_add_u32 s69, s69, 1
s_and_b32 s69, s69, 15
s_mul_i32 s67, s69, 2048
s_mul_i32 s68, s69, 393216
s_cmp_lg_u32 s43, 0
s_cbranch_scc1 nohalo_28
s_mov_b32 m0, s65
s_nop 0
buffer_load_dwordx4 v24, s[32:35], s67 offen sc1 lds
buffer_load_dwordx4 v25, s[32:35], s67 offen offset:1024 sc1 lds
nohalo_28:
s_add_u32 m0, s70, s65
s_nop 0
buffer_load_dwordx4 v20, s[32:35], s67 offen offset:0 sc1 lds
buffer_load_dwordx4 v21, s[32:35], s67 offen offset:1024 sc1 lds
buffer_load_dwordx4 v22, s[32:35], s67 offen offset:2048 sc1 lds
buffer_load_dwordx4 v23, s[32:35], s67 offen offset:3072 sc1 lds
s_add_u32 s48, s71, s65
s_add_u32 m0, s48, 0
s_add_u32 s49, s68, 0
buffer_load_dwordx4 v26, s[28:31], s49 offen  lds
buffer_load_dwordx4 v27, s[28:31], s49 offen offset:1024  lds
s_add_u32 m0, s48, 8192
s_add_u32 s49, s68, 2048
buffer_load_dwordx4 v26, s[28:31], s49 offen  lds
buffer_load_dwordx4 v27, s[28:31], s49 offen offset:1024  lds
s_add_u32 m0, s48, 16384
s_add_u32 s49, s68, 4096
buffer_load_dwordx4 v26, s[28:31], s49 offen  lds
buffer_load_dwordx4 v27, s[28:31], s49 offen offset:1024  lds
s_add_u32 s48, s64, 5
s_min_u32 s48, s48, 15
s_add_u32 s49, s48, s76
s_and_b32 s49, s49, 15
s_mul_i32 s49, s49, 393216
buffer_load_dwordx4 v[40:43], v36, s[28:31], s49 offen
s_add_u32 s65, s65, 43008
s_cmp_eq_u32 s65, 129024
s_cselect_b32 s65, 0, s65
s_add_u32 s64, s64, 1
s_cmp_lt_u32 s64, 12
s_cbranch_scc1 h2_loop
s_waitcnt vmcnt(11)
s_barrier
buffer_load_dword v31, v30, s[32:35], s72 offen sc1
buffer_load_dword v33, v30, s[32:35], s73 offen sc1
global_load_dword v48, v54, s[98:99]
s_add_u32 s69, s69, 1
s_and_b32 s69, s69, 15
s_mul_i32 s67, s69, 2048
s_mul_i32 s68, s69, 393216
s_cmp_lg_u32 s43, 0
s_cbranch_scc1 nohalo_29
s_mov_b32 m0, s65
s_nop 0
buffer_load_dwordx4 v24, s[32:35], s67 offen sc1 lds
buffer_load_dwordx4 v25, s[32:35], s67 offen offset:1024 sc1 lds
nohalo_29:
s_add_u32 m0, s70, s65
s_nop 0
buffer_load_dwordx4 v20, s[32:35], s67 offen offset:0 sc1 lds
buffer_load_dwordx4 v21, s[32:35], s67 offen offset:1024 sc1 lds
buffer_load_dwordx4 v22, s[32:35], s67 offen offset:2048 sc1 lds
buffer_load_dwordx4 v23, s[32:35], s67 offen offset:3072 sc1 lds
s_add_u32 s48, s71, s65
s_add_u32 m0, s48, 0
s_add_u32 s49, s68, 0
buffer_load_dwordx4 v26, s[28:31], s49 offen  lds
buffer_load_dwordx4 v27, s[28:31], s49 offen offset:1024  lds
s_add_u32 m0, s48, 8192
s_add_u32 s49, s68, 2048
buffer_load_dwordx4 v26, s[28:31], s49 offen  lds
buffer_load_dwordx4 v27, s[28:31], s49 offen offset:1024  lds
s_add_u32 m0, s48, 16384
s_add_u32 s49, s68, 4096
buffer_load_dwordx4 v26, s[28:31], s49 offen  lds
buffer_load_dwordx4 v27, s[28:31], s49 offen offset:1024  lds
s_add_u32 s48, s64, 5
s_min_u32 s48, s48, 15
s_add_u32 s49, s48, s76
s_and_b32 s49, s49, 15
s_mul_i32 s49, s49, 393216
buffer_load_dwordx4 v[40:43], v36, s[28:31], s49 offen
s_add_u32 s65, s65, 43008
s_cmp_eq_u32 s65, 129024
s_cselect_b32 s65, 0, s65
s_add_u32 s64, s64, 1
s_mov_b32 s36, s8
s_and_b32 s37, s9, 0xffff
s_mov_b32 s38, 2097152
s_mov_b32 s39, 0x00020000
s_waitcnt vmcnt(11)
s_barrier
s_setprio 2
s_mov_b32 s63, 0
poll_30:
v_cmp_gt_u32 vcc, 2, v31
s_cbranch_vccz polled_31
buffer_load_dword v31, v30, s[32:35], s72 offen sc1
s_add_u32 s63, s63, 1
s_cmp_lt_u32 s63, 0x80000
s_waitcnt vmcnt(0)
s_cbranch_scc1 poll_30
polled_31:
s_mov_b32 s63, 0
poll_32:
v_cmp_gt_u32 vcc, 1, v33
s_cbranch_vccz polled_33
buffer_load_dword v33, v30, s[32:35], s73 offen sc1
s_add_u32 s63, s63, 1
s_cmp_lt_u32 s63, 0x80000
s_waitcnt vmcnt(0)
s_cbranch_scc1 poll_32
polled_33:
s_cmp_lg_u32 s43, 3
s_cbranch_scc1 lw_34
buffer_load_dwordx4 v[96:99], v39, s[32:35], 0 offen offset:0 sc1
buffer_load_dwordx4 v[100:103], v39, s[32:35], 0 offen offset:1024 sc1
buffer_load_dwordx4 v[104:107], v39, s[32:35], 0 offen offset:2048 sc1
buffer_load_dwordx4 v[108:111], v39, s[32:35], 0 offen offset:3072 sc1
lw_34:
buffer_load_dwordx4 v[80:83], v37, s[32:35], 0 offen offset:0 sc1
buffer_load_dwordx4 v[84:87], v37, s[32:35], 0 offen offset:1024 sc1
buffer_load_dwordx4 v[88:91], v37, s[32:35], 0 offen offset:2048 sc1
buffer_load_dwordx4 v[92:95], v37, s[32:35], 0 offen offset:3072 sc1
s_add_u32 s48, s47, 6
s_and_b32 s48, s48, 15
s_lshl_b32 s48, s48, 17
s_lshl_b32 s49, s43, 11
s_add_u32 m0, s49, 49152
s_nop 0
buffer_load_dwordx4 v28, s[36:39], s48 offen  lds
buffer_load_dwordx4 v29, s[36:39], s48 offen offset:1024  lds
s_add_u32 s48, s47, 7
s_and_b32 s48, s48, 15
s_lshl_b32 s48, s48, 17
s_lshl_b32 s49, s43, 11
s_add_u32 m0, s49, 57344
s_nop 0
buffer_load_dwordx4 v28, s[36:39], s48 offen  lds
buffer_load_dwordx4 v29, s[36:39], s48 offen offset:1024  lds
s_add_u32 s48, s47, 8
s_and_b32 s48, s48, 15
s_lshl_b32 s48, s48, 17
s_lshl_b32 s49, s43, 11
s_add_u32 m0, s49, 65536
s_nop 0
buffer_load_dwordx4 v28, s[36:39], s48 offen  lds
buffer_load_dwordx4 v29, s[36:39], s48 offen offset:1024  lds
s_add_u32 s48, s47, 9
s_and_b32 s48, s48, 15
s_lshl_b32 s48, s48, 17
s_lshl_b32 s49, s43, 11
s_add_u32 m0, s49, 73728
s_nop 0
buffer_load_dwordx4 v28, s[36:39], s48 offen  lds
buffer_load_dwordx4 v29, s[36:39], s48 offen offset:1024  lds
s_waitcnt vmcnt(12)
s_barrier
s_add_u32 s48, s47, 10
s_and_b32 s48, s48, 15
s_lshl_b32 s48, s48, 17
s_lshl_b32 s49, s43, 11
s_add_u32 m0, s49, 81920
s_nop 0
buffer_load_dwordx4 v28, s[36:39], s48 offen  lds
buffer_load_dwordx4 v29, s[36:39], s48 offen offset:1024  lds
s_add_u32 s48, s47, 11
s_and_b32 s48, s48, 15
s_lshl_b32 s48, s48, 17
s_lshl_b32 s49, s43, 11
s_add_u32 m0, s49, 90112
s_nop 0
buffer_load_dwordx4 v28, s[36:39], s48 offen  lds
buffer_load_dwordx4 v29, s[36:39], s48 offen offset:1024  lds
s_waitcnt vmcnt(12)
v_pk_add_f32 v[80:81], v[80:81], v[88:89]
v_pk_add_f32 v[82:83], v[82:83], v[90:91]
v_pk_add_f32 v[84:85], v[84:85], v[92:93]
v_pk_add_f32 v[86:87], v[86:87], v[94:95]
v_pk_add_f32 v[80:81], v[80:81], v[84:85]
v_pk_add_f32 v[82:83], v[82:83], v[86:87]
s_nop 1
v_permlane32_swap_b32 v80, v81
v_permlane32_swap_b32 v82, v83
s_nop 0
v_add_f32 v80, v80, v81
v_add_f32 v82, v82, v83
s_nop 1
v_permlane16_swap_b32 v80, v82
s_nop 0
v_add_f32 v80, v80, v82
v_mul_f32 v44, 0x3a800000, v80
v_mov_b32 v45, v44
s_nop 1
v_permlane16_swap_b32 v44, v45
s_nop 0
v_fma_f32 v45, -v44, v44, v45
v_max_f32 v45, 0, v45
v_add_f32 v45, 0x3727c5ac, v45
v_rsq_f32 v46, v45
v_sub_f32 v47, 0, v44
ds_write_b32 v50, v47 offset:576
ds_write_b64 v49, v[46:47]
ds_write_b32 v50, v46
s_cmp_lg_u32 s43, 3
s_cbranch_scc1 lw_35
v_pk_add_f32 v[96:97], v[96:97], v[104:105]
v_pk_add_f32 v[98:99], v[98:99], v[106:107]
v_pk_add_f32 v[100:101], v[100:101], v[108:109]
v_pk_add_f32 v[102:103], v[102:103], v[110:111]
v_pk_add_f32 v[96:97], v[96:97], v[100:101]
v_pk_add_f32 v[98:99], v[98:99], v[102:103]
s_nop 1
v_permlane32_swap_b32 v96, v97
v_permlane32_swap_b32 v98, v99
s_nop 0
v_add_f32 v96, v96, v97
v_add_f32 v98, v98, v99
s_nop 1
v_permlane16_swap_b32 v96, v98
s_nop 0
v_add_f32 v96, v96, v98
v_mul_f32 v44, 0x3a800000, v96
v_mov_b32 v45, v44
s_nop 1
v_permlane16_swap_b32 v44, v45
s_nop 0
v_fma_f32 v45, -v44, v44, v45
v_max_f32 v45, 0, v45
v_add_f32 v45, 0x3727c5ac, v45
v_rsq_f32 v46, v45
v_sub_f32 v47, 0, v44
s_mov_b32 exec_lo, 0
ds_write_b32 v52, v47 offset:576
ds_write_b64 v51, v[46:47]
ds_write_b32 v52, v46
s_mov_b64 exec, -1
lw_35:
s_add_u32 s48, s47, 12
s_and_b32 s48, s48, 15
s_lshl_b32 s48, s48, 17
s_lshl_b32 s49, s43, 11
s_add_u32 m0, s49, 98304
s_nop 0
buffer_load_dwordx4 v28, s[36:39], s48 offen  lds
buffer_load_dwordx4 v29, s[36:39], s48 offen offset:1024  lds
s_add_u32 s48, s47, 13
s_and_b32 s48, s48, 15
s_lshl_b32 s48, s48, 17
s_lshl_b32 s49, s43, 11
s_add_u32 m0, s49, 106496
s_nop 0
buffer_load_dwordx4 v28, s[36:39], s48 offen  lds
buffer_load_dwordx4 v29, s[36:39], s48 offen offset:1024  lds
s_setprio 0
s_waitcnt lgkmcnt(0)
s_barrier
s_add_u32 s48, s47, 14
s_and_b32 s48, s48, 15
s_lshl_b32 s48, s48, 17
s_lshl_b32 s49, s43, 11
s_add_u32 m0, s49, 114688
s_nop 0
buffer_load_dwordx4 v28, s[36:39], s48 offen  lds
buffer_load_dwordx4 v29, s[36:39], s48 offen offset:1024  lds
s_add_u32 s48, s47, 15
s_and_b32 s48, s48, 15
s_lshl_b32 s48, s48, 17
s_lshl_b32 s49, s43, 11
s_add_u32 m0, s49, 122880
s_nop 0
buffer_load_dwordx4 v28, s[36:39], s48 offen  lds
buffer_load_dwordx4 v29, s[36:39], s48 offen offset:1024  lds
s_barrier
s_add_u32 s48, s47, 0
s_and_b32 s48, s48, 15
s_lshl_b32 s48, s48, 17
s_lshl_b32 s49, s43, 11
s_add_u32 m0, s49, 0
s_waitcnt vmcnt(4)
buffer_load_dwordx4 v28, s[36:39], s48 offen  lds
buffer_load_dwordx4 v29, s[36:39], s48 offen offset:1024  lds
s_add_u32 s48, s47, 1
s_and_b32 s48, s48, 15
s_lshl_b32 s48, s48, 17
s_lshl_b32 s49, s43, 11
s_add_u32 m0, s49, 8192
s_waitcnt vmcnt(4)
buffer_load_dwordx4 v28, s[36:39], s48 offen  lds
buffer_load_dwordx4 v29, s[36:39], s48 offen offset:1024  lds
s_add_u32 s48, s47, 2
s_and_b32 s48, s48, 15
s_lshl_b32 s48, s48, 17
s_lshl_b32 s49, s43, 11
s_add_u32 m0, s49, 16384
s_waitcnt vmcnt(4)
buffer_load_dwordx4 v28, s[36:39], s48 offen  lds
buffer_load_dwordx4 v29, s[36:39], s48 offen offset:1024  lds
s_add_u32 s48, s47, 3
s_and_b32 s48, s48, 15
s_lshl_b32 s48, s48, 17
s_lshl_b32 s49, s43, 11
s_add_u32 m0, s49, 24576
s_waitcnt vmcnt(4)
buffer_load_dwordx4 v28, s[36:39], s48 offen  lds
buffer_load_dwordx4 v29, s[36:39], s48 offen offset:1024  lds
s_add_u32 s48, s47, 4
s_and_b32 s48, s48, 15
s_lshl_b32 s48, s48, 17
s_lshl_b32 s49, s43, 11
s_add_u32 m0, s49, 32768
s_waitcnt vmcnt(4)
buffer_load_dwordx4 v28, s[36:39], s48 offen  lds
buffer_load_dwordx4 v29, s[36:39], s48 offen offset:1024  lds
s_add_u32 s48, s47, 5
s_and_b32 s48, s48, 15
s_lshl_b32 s48, s48, 17
s_lshl_b32 s49, s43, 11
s_add_u32 m0, s49, 40960
s_waitcnt vmcnt(4)
buffer_load_dwordx4 v28, s[36:39], s48 offen  lds
buffer_load_dwordx4 v29, s[36:39], s48 offen offset:1024  lds
s_mov_b32 s28, s12
s_and_b32 s29, s13, 0xffff
s_mov_b32 s30, 6291456
s_mov_b32 s31, 0x00020000
s_add_u32 s69, s47, 0
s_and_b32 s69, s69, 15
s_mul_i32 s67, s69, 2048
s_mul_i32 s68, s69, 393216
s_waitcnt vmcnt(0)
s_barrier
s_add_u32 s48, s71, 120832
s_add_u32 m0, s48, 0
s_add_u32 s49, s68, 0
buffer_load_dwordx4 v26, s[28:31], s49 offen  lds
buffer_load_dwordx4 v27, s[28:31], s49 offen offset:1024  lds
s_add_u32 m0, s48, 8192
s_add_u32 s49, s68, 2048
buffer_load_dwordx4 v26, s[28:31], s49 offen  lds
buffer_load_dwordx4 v27, s[28:31], s49 offen offset:1024  lds
s_add_u32 m0, s48, 16384
s_add_u32 s49, s68, 4096
buffer_load_dwordx4 v26, s[28:31], s49 offen  lds
buffer_load_dwordx4 v27, s[28:31], s49 offen offset:1024  lds
s_mov_b32 s36, s14
s_and_b32 s37, s15, 0xffff
s_mov_b32 s38, 65536
s_mov_b32 s39, 0x00020000
s_lshl_b32 s48, s42, 12
s_lshl_b32 s49, s43, 10
s_add_u32 s48, s48, s49
s_add_u32 m0, s49, 135168
s_nop 0
buffer_load_dwordx4 v18, s[36:39], s48 offen lds
s_getpc_b64 s[98:99]
pc_36:
s_add_u32 s98, s98, c3_epi - pc_36
s_addc_u32 s99, s99, 0
s_lshr_b32 s50, s2, 3
s_lshl_b32 s50, s50, 2
s_add_u32 s50, s50, s43
s_lshl_b32 s50, s50, 7
v_and_b32 v4, 1, v0
v_lshl_add_u32 v4, v4, 6, s50
v_min_u32 v54, L_code_end - c3_epi, v4
s_lshl_b32 s52, s41, 2
s_add_u32 s52, s52, s43
s_lshl_b32 s52, s52, 7
s_add_u32 s52, s52, 18358272
s_add_u32 s69, s47, 1
s_and_b32 s69, s69, 15
s_mul_i32 s67, s69, 2048
s_mul_i32 s68, s69, 393216
s_barrier
s_add_u32 s48, s71, 43008
s_add_u32 m0, s48, 0
s_add_u32 s49, s68, 0
buffer_load_dwordx4 v26, s[28:31], s49 offen  lds
buffer_load_dwordx4 v27, s[28:31], s49 offen offset:1024  lds
s_add_u32 m0, s48, 8192
s_add_u32 s49, s68, 2048
buffer_load_dwordx4 v26, s[28:31], s49 offen  lds
buffer_load_dwordx4 v27, s[28:31], s49 offen offset:1024  lds
s_add_u32 m0, s48, 16384
s_add_u32 s49, s68, 4096
buffer_load_dwordx4 v26, s[28:31], s49 offen  lds
buffer_load_dwordx4 v27, s[28:31], s49 offen offset:1024  lds
v_and_b32 v4, 15, v0
v_lshlrev_b32 v4, 2, v4
buffer_load_dword v5, v4, s[32:35], s52 offen sc1
s_mov_b32 s63, 0
s_waitcnt vmcnt(0)
poll_37:
v_cmp_gt_u32 vcc, 3, v5
s_cbranch_vccz polled_38
buffer_load_dword v5, v4, s[32:35], s52 offen sc1
s_add_u32 s63, s63, 1
s_cmp_lt_u32 s63, 0x80000
s_waitcnt vmcnt(0)
s_cbranch_scc1 poll_37
polled_38:
s_add_u32 s69, s47, 0
s_and_b32 s69, s69, 15
s_mul_i32 s67, s69, 2048
s_mul_i32 s68, s69, 393216
s_add_u32 m0, s70, 0
s_nop 0
buffer_load_dwordx4 v20, s[32:35], s67 offen offset:0 sc1 lds
buffer_load_dwordx4 v21, s[32:35], s67 offen offset:1024 sc1 lds
buffer_load_dwordx4 v22, s[32:35], s67 offen offset:2048 sc1 lds
buffer_load_dwordx4 v23, s[32:35], s67 offen offset:3072 sc1 lds
s_add_u32 s69, s47, 1
s_and_b32 s69, s69, 15
s_mul_i32 s67, s69, 2048
s_mul_i32 s68, s69, 393216
s_add_u32 m0, s70, 43008
s_nop 0
buffer_load_dwordx4 v20, s[32:35], s67 offen offset:0 sc1 lds
buffer_load_dwordx4 v21, s[32:35], s67 offen offset:1024 sc1 lds
buffer_load_dwordx4 v22, s[32:35], s67 offen offset:2048 sc1 lds
buffer_load_dwordx4 v23, s[32:35], s67 offen offset:3072 sc1 lds
s_waitcnt vmcnt(4)
s_barrier
s_add_u32 s49, s76, 2
s_and_b32 s49, s49, 15
s_mul_i32 s49, s49, 393216
buffer_load_dwordx4 v[40:43], v36, s[28:31], s49 offen
s_add_u32 s49, s76, 3
s_and_b32 s49, s49, 15
s_mul_i32 s49, s49, 393216
buffer_load_dwordx4 v[40:43], v36, s[28:31], s49 offen
s_add_u32 s69, s47, 2
s_and_b32 s69, s69, 15
s_mul_i32 s67, s69, 2048
s_mul_i32 s68, s69, 393216
s_add_u32 m0, s70, 86016
s_nop 0
buffer_load_dwordx4 v20, s[32:35], s67 offen offset:0 sc1 lds
buffer_load_dwordx4 v21, s[32:35], s67 offen offset:1024 sc1 lds
buffer_load_dwordx4 v22, s[32:35], s67 offen offset:2048 sc1 lds
buffer_load_dwordx4 v23, s[32:35], s67 offen offset:3072 sc1 lds
s_add_u32 s48, s71, 86016
s_add_u32 m0, s48, 0
s_add_u32 s49, s68, 0
buffer_load_dwordx4 v26, s[28:31], s49 offen  lds
buffer_load_dwordx4 v27, s[28:31], s49 offen offset:1024  lds
s_add_u32 m0, s48, 8192
s_add_u32 s49, s68, 2048
buffer_load_dwordx4 v26, s[28:31], s49 offen  lds
buffer_load_dwordx4 v27, s[28:31], s49 offen offset:1024  lds
s_add_u32 m0, s48, 16384
s_add_u32 s49, s68, 4096
buffer_load_dwordx4 v26, s[28:31], s49 offen  lds
buffer_load_dwordx4 v27, s[28:31], s49 offen offset:1024  lds
s_add_u32 s49, s76, 4
s_and_b32 s49, s49, 15
s_mul_i32 s49, s49, 393216
buffer_load_dwordx4 v[40:43], v36, s[28:31], s49 offen
s_mov_b32 s64, 0
s_mov_b32 s65, 0
h3_loop:
s_waitcnt vmcnt(11)
s_barrier
s_add_u32 s69, s69, 1
s_and_b32 s69, s69, 15
s_mul_i32 s67, s69, 2048
s_mul_i32 s68, s69, 393216
s_add_u32 m0, s70, s65
s_nop 0
buffer_load_dwordx4 v20, s[32:35], s67 offen offset:0 sc1 lds
buffer_load_dwordx4 v21, s[32:35], s67 offen offset:1024 sc1 lds
buffer_load_dwordx4 v22, s[32:35], s67 offen offset:2048 sc1 lds
buffer_load_dwordx4 v23, s[32:35], s67 offen offset:3072 sc1 lds
s_add_u32 s48, s71, s65
s_add_u32 m0, s48, 0
s_add_u32 s49, s68, 0
buffer_load_dwordx4 v26, s[28:31], s49 offen  lds
buffer_load_dwordx4 v27, s[28:31], s49 offen offset:1024  lds
s_add_u32 m0, s48, 8192
s_add_u32 s49, s68, 2048
buffer_load_dwordx4 v26, s[28:31], s49 offen  lds
buffer_load_dwordx4 v27, s[28:31], s49 offen offset:1024  lds
s_add_u32 m0, s48, 16384
s_add_u32 s49, s68, 4096
buffer_load_dwordx4 v26, s[28:31], s49 offen  lds
buffer_load_dwordx4 v27, s[28:31], s49 offen offset:1024  lds
s_add_u32 s48, s64, 5
s_min_u32 s48, s48, 15
s_add_u32 s49, s48, s76
s_and_b32 s49, s49, 15
s_mul_i32 s49, s49, 393216
buffer_load_dwordx4 v[40:43], v36, s[28:31], s49 offen
s_add_u32 s65, s65, 43008
s_cmp_eq_u32 s65, 129024
s_cselect_b32 s65, 0, s65
s_add_u32 s64, s64, 1
s_cmp_lt_u32 s64, 12
s_cbranch_scc1 h3_loop
s_waitcnt vmcnt(11)
s_barrier
buffer_load_dword v31, v30, s[32:35], s72 offen sc1
global_load_dword v48, v54, s[98:99]
s_add_u32 s69, s69, 1
s_and_b32 s69, s69, 15
s_mul_i32 s67, s69, 2048
s_mul_i32 s68, s69, 393216
s_add_u32 m0, s70, s65
s_nop 0
buffer_load_dwordx4 v20, s[32:35], s67 offen offset:0 sc1 lds
buffer_load_dwordx4 v21, s[32:35], s67 offen offset:1024 sc1 lds
buffer_load_dwordx4 v22, s[32:35], s67 offen offset:2048 sc1 lds
buffer_load_dwordx4 v23, s[32:35], s67 offen offset:3072 sc1 lds
s_add_u32 s48, s71, s65
s_add_u32 m0, s48, 0
s_add_u32 s49, s68, 0
buffer_load_dwordx4 v26, s[28:31], s49 offen  lds
buffer_load_dwordx4 v27, s[28:31], s49 offen offset:1024  lds
s_add_u32 m0, s48, 8192
s_add_u32 s49, s68, 2048
buffer_load_dwordx4 v26, s[28:31], s49 offen  lds
buffer_load_dwordx4 v27, s[28:31], s49 offen offset:1024  lds
s_add_u32 m0, s48, 16384
s_add_u32 s49, s68, 4096
buffer_load_dwordx4 v26, s[28:31], s49 offen  lds
buffer_load_dwordx4 v27, s[28:31], s49 offen offset:1024  lds
s_add_u32 s48, s64, 5
s_min_u32 s48, s48, 15
s_add_u32 s49, s48, s76
s_and_b32 s49, s49, 15
s_mul_i32 s49, s49, 393216
buffer_load_dwordx4 v[40:43], v36, s[28:31], s49 offen
s_add_u32 s65, s65, 43008
s_cmp_eq_u32 s65, 129024
s_cselect_b32 s65, 0, s65
s_add_u32 s64, s64, 1
s_mov_b32 s36, s16
s_and_b32 s37, s17, 0xffff
s_mov_b32 s38, 2097152
s_mov_b32 s39, 0x00020000
s_waitcnt vmcnt(11)
s_barrier
s_setprio 2
s_mov_b32 s63, 0
poll_39:
v_cmp_gt_u32 vcc, 3, v31
s_cbranch_vccz polled_40
buffer_load_dword v31, v30, s[32:35], s72 offen sc1
s_add_u32 s63, s63, 1
s_cmp_lt_u32 s63, 0x80000
s_waitcnt vmcnt(0)
s_cbranch_scc1 poll_39
polled_40:
buffer_load_dwordx4 v[80:83], v37, s[32:35], 0 offen offset:0 sc1
buffer_load_dwordx4 v[84:87], v37, s[32:35], 0 offen offset:1024 sc1
buffer_load_dwordx4 v[88:91], v37, s[32:35], 0 offen offset:2048 sc1
buffer_load_dwordx4 v[92:95], v37, s[32:35], 0 offen offset:3072 sc1
s_add_u32 s48, s47, 6
s_and_b32 s48, s48, 15
s_lshl_b32 s48, s48, 17
s_lshl_b32 s49, s43, 11
s_add_u32 m0, s49, 49152
s_nop 0
buffer_load_dwordx4 v28, s[36:39], s48 offen  lds
buffer_load_dwordx4 v29, s[36:39], s48 offen offset:1024  lds
s_add_u32 s48, s47, 7
s_and_b32 s48, s48, 15
s_lshl_b32 s48, s48, 17
s_lshl_b32 s49, s43, 11
s_add_u32 m0, s49, 57344
s_nop 0
buffer_load_dwordx4 v28, s[36:39], s48 offen  lds
buffer_load_dwordx4 v29, s[36:39], s48 offen offset:1024  lds
s_add_u32 s48, s47, 8
s_and_b32 s48, s48, 15
s_lshl_b32 s48, s48, 17
s_lshl_b32 s49, s43, 11
s_add_u32 m0, s49, 65536
s_nop 0
buffer_load_dwordx4 v28, s[36:39], s48 offen  lds
buffer_load_dwordx4 v29, s[36:39], s48 offen offset:1024  lds
s_add_u32 s48, s47, 9
s_and_b32 s48, s48, 15
s_lshl_b32 s48, s48, 17
s_lshl_b32 s49, s43, 11
s_add_u32 m0, s49, 73728
s_nop 0
buffer_load_dwordx4 v28, s[36:39], s48 offen  lds
buffer_load_dwordx4 v29, s[36:39], s48 offen offset:1024  lds
s_waitcnt vmcnt(12)
s_barrier
s_add_u32 s48, s47, 10
s_and_b32 s48, s48, 15
s_lshl_b32 s48, s48, 17
s_lshl_b32 s49, s43, 11
s_add_u32 m0, s49, 81920
s_nop 0
buffer_load_dwordx4 v28, s[36:39], s48 offen  lds
buffer_load_dwordx4 v29, s[36:39], s48 offen offset:1024  lds
s_add_u32 s48, s47, 11
s_and_b32 s48, s48, 15
s_lshl_b32 s48, s48, 17
s_lshl_b32 s49, s43, 11
s_add_u32 m0, s49, 90112
s_nop 0
buffer_load_dwordx4 v28, s[36:39], s48 offen  lds
buffer_load_dwordx4 v29, s[36:39], s48 offen offset:1024  lds
s_waitcnt vmcnt(12)
v_pk_add_f32 v[80:81], v[80:81], v[88:89]
v_pk_add_f32 v[82:83], v[82:83], v[90:91]
v_pk_add_f32 v[84:85], v[84:85], v[92:93]
v_pk_add_f32 v[86:87], v[86:87], v[94:95]
v_pk_add_f32 v[80:81], v[80:81], v[84:85]
v_pk_add_f32 v[82:83], v[82:83], v[86:87]
s_nop 1
v_permlane32_swap_b32 v80, v81
v_permlane32_swap_b32 v82, v83
s_nop 0
v_add_f32 v80, v80, v81
v_add_f32 v82, v82, v83
s_nop 1
v_permlane16_swap_b32 v80, v82
s_nop 0
v_add_f32 v80, v80, v82
v_mul_f32 v44, 0x3a800000, v80
v_mov_b32 v45, v44
s_nop 1
v_permlane16_swap_b32 v44, v45
s_nop 0
v_fma_f32 v45, -v44, v44, v45
v_max_f32 v45, 0, v45
v_add_f32 v45, 0x3727c5ac, v45
v_rsq_f32 v46, v45
v_sub_f32 v47, 0, v44
ds_write_b32 v50, v47 offset:576
ds_write_b64 v49, v[46:47]
ds_write_b32 v50, v46
s_add_u32 s48, s47, 12
s_and_b32 s48, s48, 15
s_lshl_b32 s48, s48, 17
s_lshl_b32 s49, s43, 11
s_add_u32 m0, s49, 98304
s_nop 0
buffer_load_dwordx4 v28, s[36:39], s48 offen  lds
buffer_load_dwordx4 v29, s[36:39], s48 offen offset:1024  lds
s_add_u32 s48, s47, 13
s_and_b32 s48, s48, 15
s_lshl_b32 s48, s48, 17
s_lshl_b32 s49, s43, 11
s_add_u32 m0, s49, 106496
s_nop 0
buffer_load_dwordx4 v28, s[36:39], s48 offen  lds
buffer_load_dwordx4 v29, s[36:39], s48 offen offset:1024  lds
s_setprio 0
s_waitcnt lgkmcnt(0)
s_barrier
s_add_u32 s48, s47, 14
s_and_b32 s48, s48, 15
s_lshl_b32 s48, s48, 17
s_lshl_b32 s49, s43, 11
s_add_u32 m0, s49, 114688
s_waitcnt vmcnt(4)
buffer_load_dwordx4 v28, s[36:39], s48 offen  lds
buffer_load_dwordx4 v29, s[36:39], s48 offen offset:1024  lds
s_add_u32 s48, s47, 15
s_and_b32 s48, s48, 15
s_lshl_b32 s48, s48, 17
s_lshl_b32 s49, s43, 11
s_add_u32 m0, s49, 122880
s_waitcnt vmcnt(4)
buffer_load_dwordx4 v28, s[36:39], s48 offen  lds
buffer_load_dwordx4 v29, s[36:39], s48 offen offset:1024  lds
s_add_u32 s48, s47, 0
s_and_b32 s48, s48, 15
s_lshl_b32 s48, s48, 17
s_lshl_b32 s49, s43, 11
s_add_u32 m0, s49, 0
s_waitcnt vmcnt(4)
buffer_load_dwordx4 v28, s[36:39], s48 offen  lds
buffer_load_dwordx4 v29, s[36:39], s48 offen offset:1024  lds
s_add_u32 s48, s47, 1
s_and_b32 s48, s48, 15
s_lshl_b32 s48, s48, 17
s_lshl_b32 s49, s43, 11
s_add_u32 m0, s49, 8192
s_waitcnt vmcnt(4)
buffer_load_dwordx4 v28, s[36:39], s48 offen  lds
buffer_load_dwordx4 v29, s[36:39], s48 offen offset:1024  lds
s_add_u32 s48, s47, 2
s_and_b32 s48, s48, 15
s_lshl_b32 s48, s48, 17
s_lshl_b32 s49, s43, 11
s_add_u32 m0, s49, 16384
s_waitcnt vmcnt(4)
buffer_load_dwordx4 v28, s[36:39], s48 offen  lds
buffer_load_dwordx4 v29, s[36:39], s48 offen offset:1024  lds
s_add_u32 s48, s47, 3
s_and_b32 s48, s48, 15
s_lshl_b32 s48, s48, 17
s_lshl_b32 s49, s43, 11
s_add_u32 m0, s49, 24576
s_waitcnt vmcnt(4)
buffer_load_dwordx4 v28, s[36:39], s48 offen  lds
buffer_load_dwordx4 v29, s[36:39], s48 offen offset:1024  lds
s_add_u32 s48, s47, 4
s_and_b32 s48, s48, 15
s_lshl_b32 s48, s48, 17
s_lshl_b32 s49, s43, 11
s_add_u32 m0, s49, 32768
s_waitcnt vmcnt(4)
buffer_load_dwordx4 v28, s[36:39], s48 offen  lds
buffer_load_dwordx4 v29, s[36:39], s48 offen offset:1024  lds
s_add_u32 s48, s47, 5
s_and_b32 s48, s48, 15
s_lshl_b32 s48, s48, 17
s_lshl_b32 s49, s43, 11
s_add_u32 m0, s49, 40960
s_waitcnt vmcnt(4)
buffer_load_dwordx4 v28, s[36:39], s48 offen  lds
buffer_load_dwordx4 v29, s[36:39], s48 offen offset:1024  lds
s_waitcnt vmcnt(0)
s_barrier
L_end:
s_endpgm
L_compute:
s_setprio 1
s_and_b32 s43, s40, 1
s_lshr_b32 s44, s40, 1
s_lshl_b32 s45, s42, 1
s_add_u32 s45, s45, s43
s_mov_b32 s77, s74
s_lshr_b32 s78, s42, 4
s_lshl_b32 s48, s41, 1
s_add_u32 s48, s48, s44
s_lshl_b32 s48, s48, 7
s_lshl_b32 s49, s45, 12
s_add_u32 s48, s48, s49
s_add_u32 s48, s48, 19136512
v_lshrrev_b32 v4, 5, v0
v_lshlrev_b32 v4, 17, v4
v_and_b32 v5, 31, v0
v_lshl_add_u32 v4, v5, 2, v4
v_mov_b32 v5, -1
buffer_store_dword v5, v4, s[32:35], s48 offen sc1
s_cmp_lg_u32 s40, 0
s_cbranch_scc1 noinit_41
s_lshl_b32 s48, s2, 8
s_add_u32 s48, s48, 18350080
v_lshlrev_b32 v6, 2, v0
v_mov_b32 v7, 0
buffer_store_dword v7, v6, s[32:35], s48 offen sc1
noinit_41:
s_cmp_lg_u32 s40, 1
s_cbranch_scc1 nopf_42
s_getpc_b64 s[48:49]
L_pc:
s_sub_u32 s48, s48, L_pc - interleave_layers__sliding_local_dilated__linear_kernel_hedgehog__prompt_kernel
s_subb_u32 s49, s49, 0
s_lshr_b32 s50, s2, 3
s_lshl_b32 s50, s50, 12
v_lshl_add_u32 v8, v0, 6, s50
v_cmp_gt_u32 vcc, L_code_end - interleave_layers__sliding_local_dilated__linear_kernel_hedgehog__prompt_kernel, v8
s_and_saveexec_b64 s[50:51], vcc
s_cbranch_execz nopf_42
global_load_dword v254, v8, s[48:49]
nopf_42:
s_mov_b64 exec, -1
s_lshl_b32 s48, s40, 2
s_add_u32 s48, s48, 134928
v_mov_b32 v10, s48
v_mov_b32 v11, 0
ds_write_b32 v10, v11
v_lshrrev_b32 v9, 1, v3
v_lshl_add_u32 v9, v2, 2, v9
v_and_b32 v1, 1, v3
v_lshl_add_u32 v9, v1, 1, v9
v_lshlrev_b32 v9, 2, v9
v_mov_b32 v1, v9
s_lshl_b32 s48, s41, 3
s_lshl_b32 s49, s44, 2
s_add_u32 s48, s48, s49
s_lshl_b32 s48, s48, 5
s_add_u32 s48, s48, s45
s_lshl_b32 s48, s48, 10
s_add_u32 s80, s48, 4194304
s_add_u32 s81, s80, 32768
s_add_u32 s82, s80, 65536
s_add_u32 s83, s80, 98304
s_lshl_b32 s84, s41, 2
s_add_u32 s84, s84, s44
s_lshl_b32 s84, s84, 7
s_add_u32 s84, s84, 18350080
s_lshl_b32 s48, s41, 3
s_lshl_b32 s49, s40, 1
s_add_u32 s48, s48, s49
s_lshl_b32 s48, s48, 15
s_lshl_b32 s49, s42, 11
s_add_u32 s85, s48, s49
s_add_u32 s86, s85, 32768
s_lshl_b32 s50, s41, 2
s_add_u32 s50, s50, s40
s_lshl_b32 s50, s50, 4
s_add_u32 s50, s50, s42
s_lshl_b32 s50, s50, 8
s_add_u32 s87, s50, 17432576
s_lshl_b32 s88, s41, 2
s_add_u32 s88, s88, s40
s_lshl_b32 s88, s88, 7
s_add_u32 s88, s88, 18358272
s_lshl_b32 s89, s41, 2
s_add_u32 s89, s89, s40
s_lshl_b32 s89, s89, 7
s_add_u32 s89, s89, 18374656
v_lshrrev_b32 v4, 1, v2
v_xor_b32 v4, v4, v3
v_lshlrev_b32 v4, 4, v4
v_lshl_add_u32 v10, v2, 7, v4
v_xor_b32 v11, 64, v10
s_lshl_b32 s48, s43, 1
v_lshrrev_b32 v4, 2, v2
v_and_b32 v5, 3, v0
v_lshl_add_u32 v6, v3, 3, v4
v_lshlrev_b32 v6, 7, v6
v_lshl_add_u32 v6, v5, 3, v6
v_lshrrev_b32 v7, 1, v4
v_and_b32 v8, 1, v3
v_lshl_add_u32 v7, v8, 1, v7
v_xor_b32 v7, s48, v7
v_lshl_add_u32 v12, v7, 5, v6
v_add_u32 v12, 18432, v12
v_xor_b32 v13, 32, v12
v_mov_b32 v14, v10
v_mov_b32 v15, v11
v_add_u32 v16, 0, v12
v_add_u32 v17, 0, v13
v_mov_b32 v148, 0
v_mov_b32 v149, 0
v_mov_b32 v150, 0
v_mov_b32 v151, 0
v_mov_b32 v152, 0
v_mov_b32 v153, 0
v_mov_b32 v154, 0
v_mov_b32 v155, 0
v_mov_b32 v156, 0
v_mov_b32 v157, 0
v_mov_b32 v158, 0
v_mov_b32 v159, 0
v_mov_b32 v160, 0
v_mov_b32 v161, 0
v_mov_b32 v162, 0
v_mov_b32 v163, 0
v_mov_b32 v164, 0
v_mov_b32 v165, 0
v_mov_b32 v166, 0
v_mov_b32 v167, 0
v_mov_b32 v168, 0
v_mov_b32 v169, 0
v_mov_b32 v170, 0
v_mov_b32 v171, 0
v_mov_b32 v172, 0
v_mov_b32 v173, 0
v_mov_b32 v174, 0
v_mov_b32 v175, 0
v_mov_b32 v176, 0
v_mov_b32 v177, 0
v_mov_b32 v178, 0
v_mov_b32 v179, 0
v_mov_b32 v180, 0
v_mov_b32 v181, 0
v_mov_b32 v182, 0
v_mov_b32 v183, 0
v_mov_b32 v184, 0
v_mov_b32 v185, 0
v_mov_b32 v186, 0
v_mov_b32 v187, 0
v_mov_b32 v188, 0
v_mov_b32 v189, 0
v_mov_b32 v190, 0
v_mov_b32 v191, 0
v_mov_b32 v192, 0
v_mov_b32 v193, 0
v_mov_b32 v194, 0
v_mov_b32 v195, 0
v_mov_b32 v196, 0
v_mov_b32 v197, 0
v_mov_b32 v198, 0
v_mov_b32 v199, 0
v_mov_b32 v200, 0
v_mov_b32 v201, 0
v_mov_b32 v202, 0
v_mov_b32 v203, 0
v_mov_b32 v204, 0
v_mov_b32 v205, 0
v_mov_b32 v206, 0
v_mov_b32 v207, 0
v_mov_b32 v208, 0
v_mov_b32 v209, 0
v_mov_b32 v210, 0
v_mov_b32 v211, 0
v_mov_b32 v212, 0
v_mov_b32 v213, 0
v_mov_b32 v214, 0
v_mov_b32 v215, 0
v_mov_b32 v216, 0
v_mov_b32 v217, 0
v_mov_b32 v218, 0
v_mov_b32 v219, 0
v_mov_b32 v220, 0
v_mov_b32 v221, 0
v_mov_b32 v222, 0
v_mov_b32 v223, 0
v_mov_b32 v224, 0
v_mov_b32 v225, 0
v_mov_b32 v226, 0
v_mov_b32 v227, 0
v_mov_b32 v228, 0
v_mov_b32 v229, 0
v_mov_b32 v230, 0
v_mov_b32 v231, 0
v_mov_b32 v232, 0
v_mov_b32 v233, 0
v_mov_b32 v234, 0
v_mov_b32 v235, 0
v_mov_b32 v236, 0
v_mov_b32 v237, 0
v_mov_b32 v238, 0
v_mov_b32 v239, 0
v_mov_b32 v240, 0
v_mov_b32 v241, 0
v_mov_b32 v242, 0
v_mov_b32 v243, 0
v_mov_b32 v244, 0
v_mov_b32 v245, 0
v_mov_b32 v246, 0
v_mov_b32 v247, 0
v_mov_b32 v248, 0
v_mov_b32 v249, 0
v_mov_b32 v250, 0
v_mov_b32 v251, 0
v_mov_b32 v56, 0x3f803f80
v_mov_b32 v57, 0x3f803f80
v_mov_b32 v58, 0x3f803f80
v_mov_b32 v59, 0x3f803f80
s_mov_b32 s48, 0xf149f2ca
v_mov_b32 v53, s48
v_lshlrev_b32 v4, 2, v3
v_sub_u32 v4, v2, v4
v_subrev_u32 v5, 0, v4
v_and_b32 v6, 0x80000001, v5
v_cmp_eq_u32 vcc, 0, v6
v_add_u32 v5, 1, v5
v_and_b32 v6, 0x80000001, v5
v_cndmask_b32 v44, v53, 0, vcc
v_cmp_eq_u32 vcc, 0x80000001, v6
s_nop 1
v_cndmask_b32 v40, v53, 0, vcc
v_subrev_u32 v5, 1, v4
v_and_b32 v6, 0x80000001, v5
v_cmp_eq_u32 vcc, 0, v6
v_add_u32 v5, 1, v5
v_and_b32 v6, 0x80000001, v5
v_cndmask_b32 v45, v53, 0, vcc
v_cmp_eq_u32 vcc, 0x80000001, v6
s_nop 1
v_cndmask_b32 v41, v53, 0, vcc
v_subrev_u32 v5, 2, v4
v_and_b32 v6, 0x80000001, v5
v_cmp_eq_u32 vcc, 0, v6
v_add_u32 v5, 1, v5
v_and_b32 v6, 0x80000001, v5
v_cndmask_b32 v46, v53, 0, vcc
v_cmp_eq_u32 vcc, 0x80000001, v6
s_nop 1
v_cndmask_b32 v42, v53, 0, vcc
v_subrev_u32 v5, 3, v4
v_and_b32 v6, 0x80000001, v5
v_cmp_eq_u32 vcc, 0, v6
v_add_u32 v5, 1, v5
v_and_b32 v6, 0x80000001, v5
v_cndmask_b32 v47, v53, 0, vcc
v_cmp_eq_u32 vcc, 0x80000001, v6
s_nop 1
v_cndmask_b32 v43, v53, 0, vcc
s_or_b32 s48, s41, s44
s_cmp_eq_u32 s48, 0
s_cselect_b64 vcc, -1, 0
v_cndmask_b32 v48, v40, v53, vcc
v_cndmask_b32 v49, v41, v53, vcc
v_cndmask_b32 v50, v42, v53, vcc
v_cndmask_b32 v51, v43, v53, vcc
v_and_b32 v4, 1, v2
v_lshlrev_b32 v4, 4, v4
v_mov_b32 v5, 0xffff
v_lshlrev_b32 v52, v4, v5
s_lshl_b32 s48, s43, 12
s_add_u32 s48, s48, 139264
s_lshl_b32 s49, s44, 11
s_add_u32 s49, s49, s48
v_add_u32 v53, s49, v18
s_lshl_b32 s49, s44, 13
s_add_u32 s49, s49, s48
v_add_u32 v54, s49, v18
s_lshl_b32 s48, s43, 7
s_add_u32 s48, s48, 133376
v_lshl_add_u32 v7, v3, 4, s48
v_lshl_add_u32 v55, v2, 2, s48
s_lshl_b32 s49, s44, 6
v_add_u32 v8, s49, v2
v_lshlrev_b32 v8, 3, v8
v_add_u32 v8, 131072, v8
v_lshl_add_u32 v9, v3, 2, s49
v_lshlrev_b32 v9, 2, v9
v_add_u32 v9, 132224, v9
s_mov_b32 s64, 0
s_mov_b32 s65, 0
s_lshl_b32 s75, 1, s77
s_or_b32 s75, s75, 8
s_lshl_b32 s48, 1, s78
s_or_b32 s75, s75, s48
s_barrier
s_cmp_eq_u32 s44, 1
s_cbranch_scc1 c0_th1
ds_read_b128 v[60:63], v14 offset:2048
ds_read_b128 v[64:67], v14 offset:4096
ds_read_b128 v[68:71], v14 offset:6144
ds_read_b128 v[72:75], v14 offset:8192
ds_read_b128 v[76:79], v14
ds_read_b64_tr_b16 v[80:81], v16 offset:0
ds_read_b64_tr_b16 v[82:83], v16 offset:512
ds_read_b64_tr_b16 v[84:85], v17 offset:0
ds_read_b64_tr_b16 v[86:87], v17 offset:512
ds_read_b64_tr_b16 v[88:89], v16 offset:8192
ds_read_b64_tr_b16 v[90:91], v16 offset:8704
ds_read_b64_tr_b16 v[92:93], v17 offset:8192
ds_read_b64_tr_b16 v[94:95], v17 offset:8704
ds_read_b64_tr_b16 v[96:97], v16 offset:16384
ds_read_b64_tr_b16 v[98:99], v16 offset:16896
ds_read_b64_tr_b16 v[100:101], v17 offset:16384
ds_read_b64_tr_b16 v[102:103], v17 offset:16896
c0_loop0:
s_waitcnt lgkmcnt(0)
v_mfma_f32_16x16x32_bf16 v[244:247], v[88:91], v[76:79], v[244:247]
ds_read_b128 v[104:107], v15 offset:2048
v_mfma_f32_16x16x32_bf16 v[248:251], v[76:79], v[96:99], v[248:251]
ds_read_b128 v[108:111], v15 offset:4096
v_mfma_f32_16x16x32_bf16 v[204:207], v[88:91], v[72:75], v[204:207]
ds_read_b128 v[112:115], v15 offset:6144
v_mfma_f32_16x16x32_bf16 v[196:199], v[88:91], v[68:71], v[196:199]
ds_read_b128 v[116:119], v15 offset:8192
v_mfma_f32_16x16x32_bf16 v[188:191], v[88:91], v[64:67], v[188:191]
ds_read_b128 v[120:123], v15
v_mfma_f32_16x16x32_bf16 v[180:183], v[88:91], v[60:63], v[180:183]
ds_read_b64_tr_b16 v[124:125], v16 offset:4096
v_mfma_f32_16x16x32_bf16 v[184:187], v[92:95], v[60:63], v[184:187]
ds_read_b64_tr_b16 v[126:127], v16 offset:4608
v_mfma_f32_16x16x32_bf16 v[192:195], v[92:95], v[64:67], v[192:195]
ds_read_b64_tr_b16 v[128:129], v17 offset:4096
v_mfma_f32_16x16x32_bf16 v[200:203], v[92:95], v[68:71], v[200:203]
ds_read_b64_tr_b16 v[130:131], v17 offset:4608
v_mfma_f32_16x16x32_bf16 v[208:211], v[92:95], v[72:75], v[208:211]
ds_read_b64_tr_b16 v[132:133], v16 offset:12288
v_mfma_f32_16x16x32_bf16 v[236:239], v[72:75], v[96:99], v[236:239]
ds_read_b64_tr_b16 v[134:135], v16 offset:12800
v_mfma_f32_16x16x32_bf16 v[228:231], v[68:71], v[96:99], v[228:231]
ds_read_b64_tr_b16 v[136:137], v17 offset:12288
v_mfma_f32_16x16x32_bf16 v[220:223], v[64:67], v[96:99], v[220:223]
ds_read_b64_tr_b16 v[138:139], v17 offset:12800
v_mfma_f32_16x16x32_bf16 v[212:215], v[60:63], v[96:99], v[212:215]
ds_read_b64_tr_b16 v[140:141], v16 offset:20480
v_mfma_f32_16x16x32_bf16 v[216:219], v[60:63], v[100:103], v[216:219]
ds_read_b64_tr_b16 v[142:143], v16 offset:20992
v_mfma_f32_16x16x32_bf16 v[224:227], v[64:67], v[100:103], v[224:227]
ds_read_b64_tr_b16 v[144:145], v17 offset:20480
v_mfma_f32_16x16x32_bf16 v[232:235], v[68:71], v[100:103], v[232:235]
ds_read_b64_tr_b16 v[146:147], v17 offset:20992
v_mfma_f32_16x16x32_bf16 v[240:243], v[72:75], v[100:103], v[240:243]
s_bitcmp1_b32 s75, s64
s_cbranch_scc1 c0_hook0
c0_hook0_ret:
v_mfma_f32_16x16x32_bf16 v[172:175], v[80:83], v[72:75], v[172:175]
s_add_u32 s65, s65, 43008
v_mfma_f32_16x16x32_bf16 v[164:167], v[80:83], v[68:71], v[164:167]
s_cmp_eq_u32 s65, 129024
s_cselect_b32 s65, 0, s65
v_mfma_f32_16x16x32_bf16 v[156:159], v[80:83], v[64:67], v[156:159]
v_add_u32 v14, s65, v10
v_add_u32 v15, s65, v11
v_mfma_f32_16x16x32_bf16 v[148:151], v[80:83], v[60:63], v[148:151]
v_add_u32 v16, s65, v12
v_add_u32 v17, s65, v13
v_mfma_f32_16x16x32_bf16 v[152:155], v[84:87], v[60:63], v[152:155]
s_add_u32 s64, s64, 1
s_cmp_eq_u32 s64, 16
v_mfma_f32_16x16x32_bf16 v[160:163], v[84:87], v[64:67], v[160:163]
v_mfma_f32_16x16x32_bf16 v[168:171], v[84:87], v[68:71], v[168:171]
v_mfma_f32_16x16x32_bf16 v[176:179], v[84:87], v[72:75], v[176:179]
s_waitcnt lgkmcnt(0)
s_barrier
s_cbranch_scc1 c0_last0
v_mfma_f32_16x16x32_bf16 v[244:247], v[132:135], v[120:123], v[244:247]
ds_read_b128 v[60:63], v14 offset:2048
v_mfma_f32_16x16x32_bf16 v[248:251], v[120:123], v[140:143], v[248:251]
ds_read_b128 v[64:67], v14 offset:4096
v_mfma_f32_16x16x32_bf16 v[204:207], v[132:135], v[116:119], v[204:207]
ds_read_b128 v[68:71], v14 offset:6144
v_mfma_f32_16x16x32_bf16 v[196:199], v[132:135], v[112:115], v[196:199]
ds_read_b128 v[72:75], v14 offset:8192
v_mfma_f32_16x16x32_bf16 v[188:191], v[132:135], v[108:111], v[188:191]
ds_read_b128 v[76:79], v14
v_mfma_f32_16x16x32_bf16 v[180:183], v[132:135], v[104:107], v[180:183]
ds_read_b64_tr_b16 v[80:81], v16 offset:0
v_mfma_f32_16x16x32_bf16 v[184:187], v[136:139], v[104:107], v[184:187]
ds_read_b64_tr_b16 v[82:83], v16 offset:512
v_mfma_f32_16x16x32_bf16 v[192:195], v[136:139], v[108:111], v[192:195]
ds_read_b64_tr_b16 v[84:85], v17 offset:0
v_mfma_f32_16x16x32_bf16 v[200:203], v[136:139], v[112:115], v[200:203]
ds_read_b64_tr_b16 v[86:87], v17 offset:512
v_mfma_f32_16x16x32_bf16 v[208:211], v[136:139], v[116:119], v[208:211]
ds_read_b64_tr_b16 v[88:89], v16 offset:8192
v_mfma_f32_16x16x32_bf16 v[236:239], v[116:119], v[140:143], v[236:239]
ds_read_b64_tr_b16 v[90:91], v16 offset:8704
v_mfma_f32_16x16x32_bf16 v[228:231], v[112:115], v[140:143], v[228:231]
ds_read_b64_tr_b16 v[92:93], v17 offset:8192
v_mfma_f32_16x16x32_bf16 v[220:223], v[108:111], v[140:143], v[220:223]
ds_read_b64_tr_b16 v[94:95], v17 offset:8704
v_mfma_f32_16x16x32_bf16 v[212:215], v[104:107], v[140:143], v[212:215]
ds_read_b64_tr_b16 v[96:97], v16 offset:16384
v_mfma_f32_16x16x32_bf16 v[216:219], v[104:107], v[144:147], v[216:219]
ds_read_b64_tr_b16 v[98:99], v16 offset:16896
v_mfma_f32_16x16x32_bf16 v[224:227], v[108:111], v[144:147], v[224:227]
ds_read_b64_tr_b16 v[100:101], v17 offset:16384
v_mfma_f32_16x16x32_bf16 v[232:235], v[112:115], v[144:147], v[232:235]
ds_read_b64_tr_b16 v[102:103], v17 offset:16896
v_mfma_f32_16x16x32_bf16 v[240:243], v[116:119], v[144:147], v[240:243]
v_mfma_f32_16x16x32_bf16 v[172:175], v[124:127], v[116:119], v[172:175]
v_mfma_f32_16x16x32_bf16 v[164:167], v[124:127], v[112:115], v[164:167]
v_mfma_f32_16x16x32_bf16 v[156:159], v[124:127], v[108:111], v[156:159]
v_mfma_f32_16x16x32_bf16 v[148:151], v[124:127], v[104:107], v[148:151]
v_mfma_f32_16x16x32_bf16 v[152:155], v[128:131], v[104:107], v[152:155]
v_mfma_f32_16x16x32_bf16 v[160:163], v[128:131], v[108:111], v[160:163]
v_mfma_f32_16x16x32_bf16 v[168:171], v[128:131], v[112:115], v[168:171]
v_mfma_f32_16x16x32_bf16 v[176:179], v[128:131], v[116:119], v[176:179]
s_branch c0_loop0
c0_hook0:
s_waitcnt lgkmcnt(0)
s_cmp_lg_u32 s64, s77
s_cbranch_scc1 hk_500043
v_mfma_f32_16x16x32_bf16 v[20:23], v[56:59], v[80:83], 0
v_mfma_f32_16x16x32_bf16 v[24:27], v[56:59], v[88:91], 0
v_mfma_f32_16x16x32_bf16 v[28:31], v[56:59], v[96:99], 0
v_mfma_f32_16x16x32_bf16 v[20:23], v[56:59], v[124:127], v[20:23]
v_mfma_f32_16x16x32_bf16 v[24:27], v[56:59], v[132:135], v[24:27]
v_mfma_f32_16x16x32_bf16 v[28:31], v[56:59], v[140:143], v[28:31]
s_lshl_b32 s50, s42, 2
s_add_u32 s50, s50, s40
s_lshl_b32 s50, s50, 4
s_add_u32 s50, s50, s41
s_lshl_b32 s50, s50, 8
s_add_u32 s50, s50, 17825792
v_cmp_eq_u32 vcc, 0, v3
v_cmp_eq_u32 s[48:49], 1, v3
s_nop 1
v_cndmask_b32 v4, v28, v24, s[48:49]
v_cndmask_b32 v4, v4, v20, vcc
buffer_store_dword v4, v1, s[32:35], s50 offen sc1
hk_500043:
s_cmp_lg_u32 s64, s78
s_cbranch_scc1 hk_500044
v_mov_b32 v32, 0
v_mov_b32 v33, 0
v_mov_b32 v34, 0
v_mov_b32 v35, 0
v_mov_b32 v36, 0
v_mov_b32 v37, 0
v_mov_b32 v38, 0
v_mov_b32 v39, 0
s_cmp_eq_u32 s43, 1
s_cbranch_scc1 hk_500045
v_dot2c_f32_bf16 v32, v60, v56
v_dot2c_f32_bf16 v34, v60, v60
v_dot2c_f32_bf16 v33, v64, v56
v_dot2c_f32_bf16 v35, v64, v64
v_dot2c_f32_bf16 v32, v61, v56
v_dot2c_f32_bf16 v34, v61, v61
v_dot2c_f32_bf16 v33, v65, v56
v_dot2c_f32_bf16 v35, v65, v65
v_dot2c_f32_bf16 v32, v62, v56
v_dot2c_f32_bf16 v34, v62, v62
v_dot2c_f32_bf16 v33, v66, v56
v_dot2c_f32_bf16 v35, v66, v66
v_dot2c_f32_bf16 v32, v63, v56
v_dot2c_f32_bf16 v34, v63, v63
v_dot2c_f32_bf16 v33, v67, v56
v_dot2c_f32_bf16 v35, v67, v67
v_dot2c_f32_bf16 v32, v104, v56
v_dot2c_f32_bf16 v34, v104, v104
v_dot2c_f32_bf16 v33, v108, v56
v_dot2c_f32_bf16 v35, v108, v108
v_dot2c_f32_bf16 v32, v105, v56
v_dot2c_f32_bf16 v34, v105, v105
v_dot2c_f32_bf16 v33, v109, v56
v_dot2c_f32_bf16 v35, v109, v109
v_dot2c_f32_bf16 v32, v106, v56
v_dot2c_f32_bf16 v34, v106, v106
v_dot2c_f32_bf16 v33, v110, v56
v_dot2c_f32_bf16 v35, v110, v110
v_dot2c_f32_bf16 v32, v107, v56
v_dot2c_f32_bf16 v34, v107, v107
v_dot2c_f32_bf16 v33, v111, v56
v_dot2c_f32_bf16 v35, v111, v111
s_branch hk_500046
hk_500045:
v_dot2c_f32_bf16 v32, v68, v56
v_dot2c_f32_bf16 v34, v68, v68
v_dot2c_f32_bf16 v33, v72, v56
v_dot2c_f32_bf16 v35, v72, v72
v_dot2c_f32_bf16 v32, v69, v56
v_dot2c_f32_bf16 v34, v69, v69
v_dot2c_f32_bf16 v33, v73, v56
v_dot2c_f32_bf16 v35, v73, v73
v_dot2c_f32_bf16 v32, v70, v56
v_dot2c_f32_bf16 v34, v70, v70
v_dot2c_f32_bf16 v33, v74, v56
v_dot2c_f32_bf16 v35, v74, v74
v_dot2c_f32_bf16 v32, v71, v56
v_dot2c_f32_bf16 v34, v71, v71
v_dot2c_f32_bf16 v33, v75, v56
v_dot2c_f32_bf16 v35, v75, v75
v_dot2c_f32_bf16 v32, v112, v56
v_dot2c_f32_bf16 v34, v112, v112
v_dot2c_f32_bf16 v33, v116, v56
v_dot2c_f32_bf16 v35, v116, v116
v_dot2c_f32_bf16 v32, v113, v56
v_dot2c_f32_bf16 v34, v113, v113
v_dot2c_f32_bf16 v33, v117, v56
v_dot2c_f32_bf16 v35, v117, v117
v_dot2c_f32_bf16 v32, v114, v56
v_dot2c_f32_bf16 v34, v114, v114
v_dot2c_f32_bf16 v33, v118, v56
v_dot2c_f32_bf16 v35, v118, v118
v_dot2c_f32_bf16 v32, v115, v56
v_dot2c_f32_bf16 v34, v115, v115
v_dot2c_f32_bf16 v33, v119, v56
v_dot2c_f32_bf16 v35, v119, v119
hk_500046:
s_lshl_b32 s50, s41, 2
s_add_u32 s50, s50, s40
s_lshl_b32 s50, s50, 4
s_add_u32 s50, s50, s42
s_lshl_b32 s50, s50, 8
s_add_u32 s50, s50, 17432576
s_nop 1
v_permlane32_swap_b32 v32, v33
v_permlane32_swap_b32 v34, v35
s_nop 0
v_add_f32 v32, v32, v33
v_add_f32 v34, v34, v35
s_nop 1
v_permlane16_swap_b32 v32, v34
s_nop 0
v_add_f32 v32, v32, v34
buffer_store_dword v32, v1, s[32:35], s50 offen sc1
s_cmp_lg_u32 s40, 0
s_cbranch_scc1 hk_500044
v_dot2c_f32_bf16 v37, v76, v56
v_dot2c_f32_bf16 v39, v76, v76
v_dot2c_f32_bf16 v37, v77, v56
v_dot2c_f32_bf16 v39, v77, v77
v_dot2c_f32_bf16 v37, v78, v56
v_dot2c_f32_bf16 v39, v78, v78
v_dot2c_f32_bf16 v37, v79, v56
v_dot2c_f32_bf16 v39, v79, v79
v_dot2c_f32_bf16 v37, v120, v56
v_dot2c_f32_bf16 v39, v120, v120
v_dot2c_f32_bf16 v37, v121, v56
v_dot2c_f32_bf16 v39, v121, v121
v_dot2c_f32_bf16 v37, v122, v56
v_dot2c_f32_bf16 v39, v122, v122
v_dot2c_f32_bf16 v37, v123, v56
v_dot2c_f32_bf16 v39, v123, v123
s_lshl_b32 s50, s41, 4
s_add_u32 s50, s50, s42
s_lshl_b32 s50, s50, 8
s_add_u32 s50, s50, 17694720
s_nop 1
v_permlane32_swap_b32 v36, v37
v_permlane32_swap_b32 v38, v39
s_nop 0
v_add_f32 v36, v36, v37
v_add_f32 v38, v38, v39
s_nop 1
v_permlane16_swap_b32 v36, v38
s_nop 0
v_add_f32 v36, v36, v38
buffer_store_dword v36, v1, s[32:35], s50 offen sc1
hk_500044:
s_cmp_lg_u32 s64, 3
s_cbranch_scc1 hk_500047
s_waitcnt vmcnt(0)
hk_500047:
s_branch c0_hook0_ret

c0_last0:
v_mfma_f32_16x16x32_bf16 v[244:247], v[132:135], v[120:123], v[244:247]
ds_read_b128 v[60:63], v7 offset:0
v_mfma_f32_16x16x32_bf16 v[248:251], v[120:123], v[140:143], v[248:251]
ds_read_b128 v[64:67], v7 offset:64
v_mfma_f32_16x16x32_bf16 v[204:207], v[132:135], v[116:119], v[204:207]
ds_read_b128 v[68:71], v7 offset:256
v_mfma_f32_16x16x32_bf16 v[208:211], v[136:139], v[116:119], v[208:211]
ds_read_b128 v[72:75], v7 offset:320
v_mfma_f32_16x16x32_bf16 v[236:239], v[116:119], v[140:143], v[236:239]
ds_read_b64 v[78:79], v8 offset:0
v_mfma_f32_16x16x32_bf16 v[240:243], v[116:119], v[144:147], v[240:243]
ds_read_b64 v[80:81], v8 offset:128
v_mfma_f32_16x16x32_bf16 v[148:151], v[124:127], v[104:107], v[148:151]
ds_read_b64 v[82:83], v8 offset:256
v_mfma_f32_16x16x32_bf16 v[152:155], v[128:131], v[104:107], v[152:155]
ds_read_b64 v[84:85], v8 offset:384
v_mfma_f32_16x16x32_bf16 v[156:159], v[124:127], v[108:111], v[156:159]
ds_write_b128 v53, v[244:247]
v_mfma_f32_16x16x32_bf16 v[160:163], v[128:131], v[108:111], v[160:163]
ds_write_b128 v53, v[248:251] offset:1024
v_mfma_f32_16x16x32_bf16 v[164:167], v[124:127], v[112:115], v[164:167]
ds_write_b128 v53, v[204:207] offset:8192
v_mfma_f32_16x16x32_bf16 v[168:171], v[128:131], v[112:115], v[168:171]
ds_write_b128 v53, v[208:211] offset:10240
v_mfma_f32_16x16x32_bf16 v[172:175], v[124:127], v[116:119], v[172:175]
ds_write_b128 v53, v[236:239] offset:9216
v_mfma_f32_16x16x32_bf16 v[176:179], v[128:131], v[116:119], v[176:179]
ds_write_b128 v53, v[240:243] offset:11264
v_mfma_f32_16x16x32_bf16 v[180:183], v[132:135], v[104:107], v[180:183]
ds_read_b64 v[86:87], v8 offset:512
v_mfma_f32_16x16x32_bf16 v[184:187], v[136:139], v[104:107], v[184:187]
ds_read2_b32 v[76:77], v55 offset0:128 offset1:144
v_mfma_f32_16x16x32_bf16 v[188:191], v[132:135], v[108:111], v[188:191]
ds_read_b128 v[88:91], v9 offset:0
v_mfma_f32_16x16x32_bf16 v[192:195], v[136:139], v[108:111], v[192:195]
ds_read_b128 v[92:95], v9 offset:64
v_mfma_f32_16x16x32_bf16 v[196:199], v[132:135], v[112:115], v[196:199]
ds_read_b128 v[96:99], v9 offset:128
v_mfma_f32_16x16x32_bf16 v[200:203], v[136:139], v[112:115], v[200:203]
ds_read_b128 v[100:103], v9 offset:192
v_mfma_f32_16x16x32_bf16 v[212:215], v[104:107], v[140:143], v[212:215]
v_mov_b32 v19, 134912
ds_read_b32 v19, v19
v_mfma_f32_16x16x32_bf16 v[216:219], v[104:107], v[144:147], v[216:219]
v_mfma_f32_16x16x32_bf16 v[220:223], v[108:111], v[140:143], v[220:223]
v_mfma_f32_16x16x32_bf16 v[224:227], v[108:111], v[144:147], v[224:227]
v_mfma_f32_16x16x32_bf16 v[228:231], v[112:115], v[140:143], v[228:231]
v_mfma_f32_16x16x32_bf16 v[232:235], v[112:115], v[144:147], v[232:235]
s_branch c0_epi
c0_th1:
ds_read_b128 v[60:63], v14 offset:10240
ds_read_b128 v[64:67], v14 offset:12288
ds_read_b128 v[68:71], v14 offset:14336
ds_read_b128 v[72:75], v14 offset:16384
ds_read_b128 v[76:79], v14
ds_read_b64_tr_b16 v[80:81], v16 offset:0
ds_read_b64_tr_b16 v[82:83], v16 offset:512
ds_read_b64_tr_b16 v[84:85], v17 offset:0
ds_read_b64_tr_b16 v[86:87], v17 offset:512
ds_read_b64_tr_b16 v[88:89], v16 offset:8192
ds_read_b64_tr_b16 v[90:91], v16 offset:8704
ds_read_b64_tr_b16 v[92:93], v17 offset:8192
ds_read_b64_tr_b16 v[94:95], v17 offset:8704
ds_read_b64_tr_b16 v[96:97], v16 offset:16384
ds_read_b64_tr_b16 v[98:99], v16 offset:16896
ds_read_b64_tr_b16 v[100:101], v17 offset:16384
ds_read_b64_tr_b16 v[102:103], v17 offset:16896
c0_loop1:
s_waitcnt lgkmcnt(0)
v_mfma_f32_16x16x32_bf16 v[244:247], v[92:95], v[76:79], v[244:247]
ds_read_b128 v[104:107], v15 offset:10240
v_mfma_f32_16x16x32_bf16 v[248:251], v[76:79], v[100:103], v[248:251]
ds_read_b128 v[108:111], v15 offset:12288
v_mfma_f32_16x16x32_bf16 v[204:207], v[88:91], v[72:75], v[204:207]
ds_read_b128 v[112:115], v15 offset:14336
v_mfma_f32_16x16x32_bf16 v[196:199], v[88:91], v[68:71], v[196:199]
ds_read_b128 v[116:119], v15 offset:16384
v_mfma_f32_16x16x32_bf16 v[188:191], v[88:91], v[64:67], v[188:191]
ds_read_b128 v[120:123], v15
v_mfma_f32_16x16x32_bf16 v[180:183], v[88:91], v[60:63], v[180:183]
ds_read_b64_tr_b16 v[124:125], v16 offset:4096
v_mfma_f32_16x16x32_bf16 v[184:187], v[92:95], v[60:63], v[184:187]
ds_read_b64_tr_b16 v[126:127], v16 offset:4608
v_mfma_f32_16x16x32_bf16 v[192:195], v[92:95], v[64:67], v[192:195]
ds_read_b64_tr_b16 v[128:129], v17 offset:4096
v_mfma_f32_16x16x32_bf16 v[200:203], v[92:95], v[68:71], v[200:203]
ds_read_b64_tr_b16 v[130:131], v17 offset:4608
v_mfma_f32_16x16x32_bf16 v[208:211], v[92:95], v[72:75], v[208:211]
ds_read_b64_tr_b16 v[132:133], v16 offset:12288
v_mfma_f32_16x16x32_bf16 v[236:239], v[72:75], v[96:99], v[236:239]
ds_read_b64_tr_b16 v[134:135], v16 offset:12800
v_mfma_f32_16x16x32_bf16 v[228:231], v[68:71], v[96:99], v[228:231]
ds_read_b64_tr_b16 v[136:137], v17 offset:12288
v_mfma_f32_16x16x32_bf16 v[220:223], v[64:67], v[96:99], v[220:223]
ds_read_b64_tr_b16 v[138:139], v17 offset:12800
v_mfma_f32_16x16x32_bf16 v[212:215], v[60:63], v[96:99], v[212:215]
ds_read_b64_tr_b16 v[140:141], v16 offset:20480
v_mfma_f32_16x16x32_bf16 v[216:219], v[60:63], v[100:103], v[216:219]
ds_read_b64_tr_b16 v[142:143], v16 offset:20992
v_mfma_f32_16x16x32_bf16 v[224:227], v[64:67], v[100:103], v[224:227]
ds_read_b64_tr_b16 v[144:145], v17 offset:20480
v_mfma_f32_16x16x32_bf16 v[232:235], v[68:71], v[100:103], v[232:235]
ds_read_b64_tr_b16 v[146:147], v17 offset:20992
v_mfma_f32_16x16x32_bf16 v[240:243], v[72:75], v[100:103], v[240:243]
s_bitcmp1_b32 s75, s64
s_cbranch_scc1 c0_hook1
c0_hook1_ret:
v_mfma_f32_16x16x32_bf16 v[172:175], v[80:83], v[72:75], v[172:175]
s_add_u32 s65, s65, 43008
v_mfma_f32_16x16x32_bf16 v[164:167], v[80:83], v[68:71], v[164:167]
s_cmp_eq_u32 s65, 129024
s_cselect_b32 s65, 0, s65
v_mfma_f32_16x16x32_bf16 v[156:159], v[80:83], v[64:67], v[156:159]
v_add_u32 v14, s65, v10
v_add_u32 v15, s65, v11
v_mfma_f32_16x16x32_bf16 v[148:151], v[80:83], v[60:63], v[148:151]
v_add_u32 v16, s65, v12
v_add_u32 v17, s65, v13
v_mfma_f32_16x16x32_bf16 v[152:155], v[84:87], v[60:63], v[152:155]
s_add_u32 s64, s64, 1
s_cmp_eq_u32 s64, 16
v_mfma_f32_16x16x32_bf16 v[160:163], v[84:87], v[64:67], v[160:163]
v_mfma_f32_16x16x32_bf16 v[168:171], v[84:87], v[68:71], v[168:171]
v_mfma_f32_16x16x32_bf16 v[176:179], v[84:87], v[72:75], v[176:179]
s_waitcnt lgkmcnt(0)
s_barrier
s_cbranch_scc1 c0_last1
v_mfma_f32_16x16x32_bf16 v[244:247], v[136:139], v[120:123], v[244:247]
ds_read_b128 v[60:63], v14 offset:10240
v_mfma_f32_16x16x32_bf16 v[248:251], v[120:123], v[144:147], v[248:251]
ds_read_b128 v[64:67], v14 offset:12288
v_mfma_f32_16x16x32_bf16 v[204:207], v[132:135], v[116:119], v[204:207]
ds_read_b128 v[68:71], v14 offset:14336
v_mfma_f32_16x16x32_bf16 v[196:199], v[132:135], v[112:115], v[196:199]
ds_read_b128 v[72:75], v14 offset:16384
v_mfma_f32_16x16x32_bf16 v[188:191], v[132:135], v[108:111], v[188:191]
ds_read_b128 v[76:79], v14
v_mfma_f32_16x16x32_bf16 v[180:183], v[132:135], v[104:107], v[180:183]
ds_read_b64_tr_b16 v[80:81], v16 offset:0
v_mfma_f32_16x16x32_bf16 v[184:187], v[136:139], v[104:107], v[184:187]
ds_read_b64_tr_b16 v[82:83], v16 offset:512
v_mfma_f32_16x16x32_bf16 v[192:195], v[136:139], v[108:111], v[192:195]
ds_read_b64_tr_b16 v[84:85], v17 offset:0
v_mfma_f32_16x16x32_bf16 v[200:203], v[136:139], v[112:115], v[200:203]
ds_read_b64_tr_b16 v[86:87], v17 offset:512
v_mfma_f32_16x16x32_bf16 v[208:211], v[136:139], v[116:119], v[208:211]
ds_read_b64_tr_b16 v[88:89], v16 offset:8192
v_mfma_f32_16x16x32_bf16 v[236:239], v[116:119], v[140:143], v[236:239]
ds_read_b64_tr_b16 v[90:91], v16 offset:8704
v_mfma_f32_16x16x32_bf16 v[228:231], v[112:115], v[140:143], v[228:231]
ds_read_b64_tr_b16 v[92:93], v17 offset:8192
v_mfma_f32_16x16x32_bf16 v[220:223], v[108:111], v[140:143], v[220:223]
ds_read_b64_tr_b16 v[94:95], v17 offset:8704
v_mfma_f32_16x16x32_bf16 v[212:215], v[104:107], v[140:143], v[212:215]
ds_read_b64_tr_b16 v[96:97], v16 offset:16384
v_mfma_f32_16x16x32_bf16 v[216:219], v[104:107], v[144:147], v[216:219]
ds_read_b64_tr_b16 v[98:99], v16 offset:16896
v_mfma_f32_16x16x32_bf16 v[224:227], v[108:111], v[144:147], v[224:227]
ds_read_b64_tr_b16 v[100:101], v17 offset:16384
v_mfma_f32_16x16x32_bf16 v[232:235], v[112:115], v[144:147], v[232:235]
ds_read_b64_tr_b16 v[102:103], v17 offset:16896
v_mfma_f32_16x16x32_bf16 v[240:243], v[116:119], v[144:147], v[240:243]
v_mfma_f32_16x16x32_bf16 v[172:175], v[124:127], v[116:119], v[172:175]
v_mfma_f32_16x16x32_bf16 v[164:167], v[124:127], v[112:115], v[164:167]
v_mfma_f32_16x16x32_bf16 v[156:159], v[124:127], v[108:111], v[156:159]
v_mfma_f32_16x16x32_bf16 v[148:151], v[124:127], v[104:107], v[148:151]
v_mfma_f32_16x16x32_bf16 v[152:155], v[128:131], v[104:107], v[152:155]
v_mfma_f32_16x16x32_bf16 v[160:163], v[128:131], v[108:111], v[160:163]
v_mfma_f32_16x16x32_bf16 v[168:171], v[128:131], v[112:115], v[168:171]
v_mfma_f32_16x16x32_bf16 v[176:179], v[128:131], v[116:119], v[176:179]
s_branch c0_loop1
c0_hook1:
s_waitcnt lgkmcnt(0)
s_cmp_lg_u32 s64, s77
s_cbranch_scc1 hk_501043
v_mfma_f32_16x16x32_bf16 v[20:23], v[56:59], v[84:87], 0
v_mfma_f32_16x16x32_bf16 v[24:27], v[56:59], v[92:95], 0
v_mfma_f32_16x16x32_bf16 v[28:31], v[56:59], v[100:103], 0
v_mfma_f32_16x16x32_bf16 v[20:23], v[56:59], v[128:131], v[20:23]
v_mfma_f32_16x16x32_bf16 v[24:27], v[56:59], v[136:139], v[24:27]
v_mfma_f32_16x16x32_bf16 v[28:31], v[56:59], v[144:147], v[28:31]
s_lshl_b32 s50, s42, 2
s_add_u32 s50, s50, s40
s_lshl_b32 s50, s50, 4
s_add_u32 s50, s50, s41
s_lshl_b32 s50, s50, 8
s_add_u32 s50, s50, 17825792
v_cmp_eq_u32 vcc, 0, v3
v_cmp_eq_u32 s[48:49], 1, v3
s_nop 1
v_cndmask_b32 v4, v28, v24, s[48:49]
v_cndmask_b32 v4, v4, v20, vcc
buffer_store_dword v4, v1, s[32:35], s50 offen sc1
hk_501043:
s_cmp_lg_u32 s64, s78
s_cbranch_scc1 hk_501044
v_mov_b32 v32, 0
v_mov_b32 v33, 0
v_mov_b32 v34, 0
v_mov_b32 v35, 0
v_mov_b32 v36, 0
v_mov_b32 v37, 0
v_mov_b32 v38, 0
v_mov_b32 v39, 0
s_cmp_eq_u32 s43, 1
s_cbranch_scc1 hk_501045
v_dot2c_f32_bf16 v32, v60, v56
v_dot2c_f32_bf16 v34, v60, v60
v_dot2c_f32_bf16 v33, v64, v56
v_dot2c_f32_bf16 v35, v64, v64
v_dot2c_f32_bf16 v32, v61, v56
v_dot2c_f32_bf16 v34, v61, v61
v_dot2c_f32_bf16 v33, v65, v56
v_dot2c_f32_bf16 v35, v65, v65
v_dot2c_f32_bf16 v32, v62, v56
v_dot2c_f32_bf16 v34, v62, v62
v_dot2c_f32_bf16 v33, v66, v56
v_dot2c_f32_bf16 v35, v66, v66
v_dot2c_f32_bf16 v32, v63, v56
v_dot2c_f32_bf16 v34, v63, v63
v_dot2c_f32_bf16 v33, v67, v56
v_dot2c_f32_bf16 v35, v67, v67
v_dot2c_f32_bf16 v32, v104, v56
v_dot2c_f32_bf16 v34, v104, v104
v_dot2c_f32_bf16 v33, v108, v56
v_dot2c_f32_bf16 v35, v108, v108
v_dot2c_f32_bf16 v32, v105, v56
v_dot2c_f32_bf16 v34, v105, v105
v_dot2c_f32_bf16 v33, v109, v56
v_dot2c_f32_bf16 v35, v109, v109
v_dot2c_f32_bf16 v32, v106, v56
v_dot2c_f32_bf16 v34, v106, v106
v_dot2c_f32_bf16 v33, v110, v56
v_dot2c_f32_bf16 v35, v110, v110
v_dot2c_f32_bf16 v32, v107, v56
v_dot2c_f32_bf16 v34, v107, v107
v_dot2c_f32_bf16 v33, v111, v56
v_dot2c_f32_bf16 v35, v111, v111
s_branch hk_501046
hk_501045:
v_dot2c_f32_bf16 v32, v68, v56
v_dot2c_f32_bf16 v34, v68, v68
v_dot2c_f32_bf16 v33, v72, v56
v_dot2c_f32_bf16 v35, v72, v72
v_dot2c_f32_bf16 v32, v69, v56
v_dot2c_f32_bf16 v34, v69, v69
v_dot2c_f32_bf16 v33, v73, v56
v_dot2c_f32_bf16 v35, v73, v73
v_dot2c_f32_bf16 v32, v70, v56
v_dot2c_f32_bf16 v34, v70, v70
v_dot2c_f32_bf16 v33, v74, v56
v_dot2c_f32_bf16 v35, v74, v74
v_dot2c_f32_bf16 v32, v71, v56
v_dot2c_f32_bf16 v34, v71, v71
v_dot2c_f32_bf16 v33, v75, v56
v_dot2c_f32_bf16 v35, v75, v75
v_dot2c_f32_bf16 v32, v112, v56
v_dot2c_f32_bf16 v34, v112, v112
v_dot2c_f32_bf16 v33, v116, v56
v_dot2c_f32_bf16 v35, v116, v116
v_dot2c_f32_bf16 v32, v113, v56
v_dot2c_f32_bf16 v34, v113, v113
v_dot2c_f32_bf16 v33, v117, v56
v_dot2c_f32_bf16 v35, v117, v117
v_dot2c_f32_bf16 v32, v114, v56
v_dot2c_f32_bf16 v34, v114, v114
v_dot2c_f32_bf16 v33, v118, v56
v_dot2c_f32_bf16 v35, v118, v118
v_dot2c_f32_bf16 v32, v115, v56
v_dot2c_f32_bf16 v34, v115, v115
v_dot2c_f32_bf16 v33, v119, v56
v_dot2c_f32_bf16 v35, v119, v119
hk_501046:
s_lshl_b32 s50, s41, 2
s_add_u32 s50, s50, s40
s_lshl_b32 s50, s50, 4
s_add_u32 s50, s50, s42
s_lshl_b32 s50, s50, 8
s_add_u32 s50, s50, 17432576
s_nop 1
v_permlane32_swap_b32 v32, v33
v_permlane32_swap_b32 v34, v35
s_nop 0
v_add_f32 v32, v32, v33
v_add_f32 v34, v34, v35
s_nop 1
v_permlane16_swap_b32 v32, v34
s_nop 0
v_add_f32 v32, v32, v34
buffer_store_dword v32, v1, s[32:35], s50 offen sc1
hk_501044:
s_cmp_lg_u32 s64, 3
s_cbranch_scc1 hk_501047
s_waitcnt vmcnt(0)
hk_501047:
s_branch c0_hook1_ret

c0_last1:
v_mfma_f32_16x16x32_bf16 v[244:247], v[136:139], v[120:123], v[244:247]
ds_read_b128 v[60:63], v7 offset:0
v_mfma_f32_16x16x32_bf16 v[248:251], v[120:123], v[144:147], v[248:251]
ds_read_b128 v[64:67], v7 offset:64
v_mfma_f32_16x16x32_bf16 v[204:207], v[132:135], v[116:119], v[204:207]
ds_read_b128 v[68:71], v7 offset:256
v_mfma_f32_16x16x32_bf16 v[208:211], v[136:139], v[116:119], v[208:211]
ds_read_b128 v[72:75], v7 offset:320
v_mfma_f32_16x16x32_bf16 v[236:239], v[116:119], v[140:143], v[236:239]
ds_read_b64 v[78:79], v8 offset:0
v_mfma_f32_16x16x32_bf16 v[240:243], v[116:119], v[144:147], v[240:243]
ds_read_b64 v[80:81], v8 offset:128
v_mfma_f32_16x16x32_bf16 v[148:151], v[124:127], v[104:107], v[148:151]
ds_read_b64 v[82:83], v8 offset:256
v_mfma_f32_16x16x32_bf16 v[152:155], v[128:131], v[104:107], v[152:155]
ds_read_b64 v[84:85], v8 offset:384
v_mfma_f32_16x16x32_bf16 v[156:159], v[124:127], v[108:111], v[156:159]
ds_write_b128 v53, v[244:247]
v_mfma_f32_16x16x32_bf16 v[160:163], v[128:131], v[108:111], v[160:163]
ds_write_b128 v53, v[248:251] offset:1024
v_mfma_f32_16x16x32_bf16 v[164:167], v[124:127], v[112:115], v[164:167]
ds_read_b64 v[86:87], v8 offset:512
v_mfma_f32_16x16x32_bf16 v[168:171], v[128:131], v[112:115], v[168:171]
ds_read2_b32 v[76:77], v55 offset0:128 offset1:144
v_mfma_f32_16x16x32_bf16 v[172:175], v[124:127], v[116:119], v[172:175]
ds_read_b128 v[88:91], v9 offset:0
v_mfma_f32_16x16x32_bf16 v[176:179], v[128:131], v[116:119], v[176:179]
ds_read_b128 v[92:95], v9 offset:64
v_mfma_f32_16x16x32_bf16 v[180:183], v[132:135], v[104:107], v[180:183]
ds_read_b128 v[96:99], v9 offset:128
v_mfma_f32_16x16x32_bf16 v[184:187], v[136:139], v[104:107], v[184:187]
ds_read_b128 v[100:103], v9 offset:192
v_mfma_f32_16x16x32_bf16 v[188:191], v[132:135], v[108:111], v[188:191]
v_mov_b32 v19, 134912
ds_read_b32 v19, v19
v_mfma_f32_16x16x32_bf16 v[192:195], v[136:139], v[108:111], v[192:195]
v_mfma_f32_16x16x32_bf16 v[196:199], v[132:135], v[112:115], v[196:199]
v_mfma_f32_16x16x32_bf16 v[200:203], v[136:139], v[112:115], v[200:203]
v_mfma_f32_16x16x32_bf16 v[212:215], v[104:107], v[140:143], v[212:215]
v_mfma_f32_16x16x32_bf16 v[216:219], v[104:107], v[144:147], v[216:219]
v_mfma_f32_16x16x32_bf16 v[220:223], v[108:111], v[140:143], v[220:223]
v_mfma_f32_16x16x32_bf16 v[224:227], v[108:111], v[144:147], v[224:227]
v_mfma_f32_16x16x32_bf16 v[228:231], v[112:115], v[140:143], v[228:231]
v_mfma_f32_16x16x32_bf16 v[232:235], v[112:115], v[144:147], v[232:235]
c0_epi:
s_waitcnt lgkmcnt(0)
s_barrier
ds_read_b128 v[128:131], v54 offset:0
ds_read_b128 v[132:135], v54 offset:2048
ds_read_b128 v[136:139], v54 offset:1024
ds_read_b128 v[140:143], v54 offset:3072
ds_read_b128 v[104:107], v9 offset:256
ds_read_b128 v[108:111], v9 offset:576
ds_read_b128 v[112:115], v9 offset:640
ds_read_b128 v[116:119], v9 offset:704
ds_read_b128 v[120:123], v9 offset:768
ds_read_b128 v[124:127], v9 offset:832
v_readfirstlane_b32 s46, v19
s_mov_b32 s66, 0x3e8293ee
v_mul_f32 v10, s66, v80
v_mul_f32 v11, s66, v82
v_mul_f32 v12, s66, v84
v_mul_f32 v13, s66, v86
.p2align 3
v_pk_fma_f32 v[148:149], v[60:61], v[80:81], v[148:149] op_sel:[0,1,0] op_sel_hi:[1,1,1]
v_pk_fma_f32 v[150:151], v[62:63], v[80:81], v[150:151] op_sel:[0,1,0] op_sel_hi:[1,1,1]
v_pk_fma_f32 v[152:153], v[64:65], v[80:81], v[152:153] op_sel:[0,1,0] op_sel_hi:[1,1,1]
v_pk_fma_f32 v[154:155], v[66:67], v[80:81], v[154:155] op_sel:[0,1,0] op_sel_hi:[1,1,1]
v_cvt_pk_bf16_f32 v148, v148, v149
v_cvt_pk_bf16_f32 v149, v150, v151
v_cvt_pk_bf16_f32 v150, v152, v153
v_cvt_pk_bf16_f32 v151, v154, v155
v_pk_fma_f32 v[156:157], v[60:61], v[82:83], v[156:157] op_sel:[0,1,0] op_sel_hi:[1,1,1]
v_pk_fma_f32 v[158:159], v[62:63], v[82:83], v[158:159] op_sel:[0,1,0] op_sel_hi:[1,1,1]
v_pk_fma_f32 v[160:161], v[64:65], v[82:83], v[160:161] op_sel:[0,1,0] op_sel_hi:[1,1,1]
v_pk_fma_f32 v[162:163], v[66:67], v[82:83], v[162:163] op_sel:[0,1,0] op_sel_hi:[1,1,1]
v_cvt_pk_bf16_f32 v156, v156, v157
v_cvt_pk_bf16_f32 v157, v158, v159
v_cvt_pk_bf16_f32 v158, v160, v161
v_cvt_pk_bf16_f32 v159, v162, v163
v_pk_fma_f32 v[164:165], v[60:61], v[84:85], v[164:165] op_sel:[0,1,0] op_sel_hi:[1,1,1]
v_pk_fma_f32 v[166:167], v[62:63], v[84:85], v[166:167] op_sel:[0,1,0] op_sel_hi:[1,1,1]
v_pk_fma_f32 v[168:169], v[64:65], v[84:85], v[168:169] op_sel:[0,1,0] op_sel_hi:[1,1,1]
v_pk_fma_f32 v[170:171], v[66:67], v[84:85], v[170:171] op_sel:[0,1,0] op_sel_hi:[1,1,1]
v_cvt_pk_bf16_f32 v164, v164, v165
v_cvt_pk_bf16_f32 v165, v166, v167
v_cvt_pk_bf16_f32 v166, v168, v169
v_cvt_pk_bf16_f32 v167, v170, v171
v_pk_fma_f32 v[172:173], v[60:61], v[86:87], v[172:173] op_sel:[0,1,0] op_sel_hi:[1,1,1]
v_pk_fma_f32 v[174:175], v[62:63], v[86:87], v[174:175] op_sel:[0,1,0] op_sel_hi:[1,1,1]
v_pk_fma_f32 v[176:177], v[64:65], v[86:87], v[176:177] op_sel:[0,1,0] op_sel_hi:[1,1,1]
v_pk_fma_f32 v[178:179], v[66:67], v[86:87], v[178:179] op_sel:[0,1,0] op_sel_hi:[1,1,1]
v_cvt_pk_bf16_f32 v172, v172, v173
v_cvt_pk_bf16_f32 v173, v174, v175
v_cvt_pk_bf16_f32 v174, v176, v177
v_cvt_pk_bf16_f32 v175, v178, v179
v_pk_fma_f32 v[204:205], v[68:69], v[86:87], v[204:205] op_sel:[0,1,0] op_sel_hi:[1,1,1]
v_pk_fma_f32 v[206:207], v[70:71], v[86:87], v[206:207] op_sel:[0,1,0] op_sel_hi:[1,1,1]
v_pk_fma_f32 v[208:209], v[72:73], v[86:87], v[208:209] op_sel:[0,1,0] op_sel_hi:[1,1,1]
v_pk_fma_f32 v[210:211], v[74:75], v[86:87], v[210:211] op_sel:[0,1,0] op_sel_hi:[1,1,1]
v_pk_mul_f32 v[204:205], v[204:205], v[86:87] op_sel:[0,0] op_sel_hi:[1,0]
v_pk_mul_f32 v[206:207], v[206:207], v[86:87] op_sel:[0,0] op_sel_hi:[1,0]
v_pk_mul_f32 v[208:209], v[208:209], v[86:87] op_sel:[0,0] op_sel_hi:[1,0]
v_pk_mul_f32 v[210:211], v[210:211], v[86:87] op_sel:[0,0] op_sel_hi:[1,0]
v_cvt_pk_bf16_f32 v204, v204, v205
v_cvt_pk_bf16_f32 v205, v206, v207
v_cvt_pk_bf16_f32 v206, v208, v209
v_cvt_pk_bf16_f32 v207, v210, v211
v_pk_fma_f32 v[180:181], v[68:69], v[80:81], v[180:181] op_sel:[0,1,0] op_sel_hi:[1,1,1]
v_pk_fma_f32 v[182:183], v[70:71], v[80:81], v[182:183] op_sel:[0,1,0] op_sel_hi:[1,1,1]
v_pk_fma_f32 v[184:185], v[72:73], v[80:81], v[184:185] op_sel:[0,1,0] op_sel_hi:[1,1,1]
v_pk_fma_f32 v[186:187], v[74:75], v[80:81], v[186:187] op_sel:[0,1,0] op_sel_hi:[1,1,1]
v_pk_mul_f32 v[180:181], v[180:181], v[80:81] op_sel:[0,0] op_sel_hi:[1,0]
v_pk_mul_f32 v[182:183], v[182:183], v[80:81] op_sel:[0,0] op_sel_hi:[1,0]
v_pk_mul_f32 v[184:185], v[184:185], v[80:81] op_sel:[0,0] op_sel_hi:[1,0]
v_pk_mul_f32 v[186:187], v[186:187], v[80:81] op_sel:[0,0] op_sel_hi:[1,0]
v_cvt_pk_bf16_f32 v180, v180, v181
v_cvt_pk_bf16_f32 v181, v182, v183
v_cvt_pk_bf16_f32 v182, v184, v185
v_cvt_pk_bf16_f32 v183, v186, v187
v_pk_fma_f32 v[188:189], v[68:69], v[82:83], v[188:189] op_sel:[0,1,0] op_sel_hi:[1,1,1]
v_pk_fma_f32 v[190:191], v[70:71], v[82:83], v[190:191] op_sel:[0,1,0] op_sel_hi:[1,1,1]
v_pk_fma_f32 v[192:193], v[72:73], v[82:83], v[192:193] op_sel:[0,1,0] op_sel_hi:[1,1,1]
v_pk_fma_f32 v[194:195], v[74:75], v[82:83], v[194:195] op_sel:[0,1,0] op_sel_hi:[1,1,1]
v_pk_mul_f32 v[188:189], v[188:189], v[82:83] op_sel:[0,0] op_sel_hi:[1,0]
v_pk_mul_f32 v[190:191], v[190:191], v[82:83] op_sel:[0,0] op_sel_hi:[1,0]
v_pk_mul_f32 v[192:193], v[192:193], v[82:83] op_sel:[0,0] op_sel_hi:[1,0]
v_pk_mul_f32 v[194:195], v[194:195], v[82:83] op_sel:[0,0] op_sel_hi:[1,0]
v_cvt_pk_bf16_f32 v188, v188, v189
v_cvt_pk_bf16_f32 v189, v190, v191
v_cvt_pk_bf16_f32 v190, v192, v193
v_cvt_pk_bf16_f32 v191, v194, v195
v_pk_fma_f32 v[196:197], v[68:69], v[84:85], v[196:197] op_sel:[0,1,0] op_sel_hi:[1,1,1]
v_pk_fma_f32 v[198:199], v[70:71], v[84:85], v[198:199] op_sel:[0,1,0] op_sel_hi:[1,1,1]
v_pk_fma_f32 v[200:201], v[72:73], v[84:85], v[200:201] op_sel:[0,1,0] op_sel_hi:[1,1,1]
v_pk_fma_f32 v[202:203], v[74:75], v[84:85], v[202:203] op_sel:[0,1,0] op_sel_hi:[1,1,1]
v_pk_mul_f32 v[196:197], v[196:197], v[84:85] op_sel:[0,0] op_sel_hi:[1,0]
v_pk_mul_f32 v[198:199], v[198:199], v[84:85] op_sel:[0,0] op_sel_hi:[1,0]
v_pk_mul_f32 v[200:201], v[200:201], v[84:85] op_sel:[0,0] op_sel_hi:[1,0]
v_pk_mul_f32 v[202:203], v[202:203], v[84:85] op_sel:[0,0] op_sel_hi:[1,0]
v_cvt_pk_bf16_f32 v196, v196, v197
v_cvt_pk_bf16_f32 v197, v198, v199
v_cvt_pk_bf16_f32 v198, v200, v201
v_cvt_pk_bf16_f32 v199, v202, v203
s_waitcnt lgkmcnt(0)
s_nop 0
v_pk_fma_f32 v[128:129], v[68:69], v[78:79], v[128:129] op_sel:[0,1,0] op_sel_hi:[1,1,1]
v_pk_fma_f32 v[130:131], v[70:71], v[78:79], v[130:131] op_sel:[0,1,0] op_sel_hi:[1,1,1]
v_pk_fma_f32 v[132:133], v[72:73], v[78:79], v[132:133] op_sel:[0,1,0] op_sel_hi:[1,1,1]
v_pk_fma_f32 v[134:135], v[74:75], v[78:79], v[134:135] op_sel:[0,1,0] op_sel_hi:[1,1,1]
v_pk_mul_f32 v[128:129], v[128:129], v[78:79] op_sel:[0,0] op_sel_hi:[1,0]
v_pk_mul_f32 v[130:131], v[130:131], v[78:79] op_sel:[0,0] op_sel_hi:[1,0]
v_pk_mul_f32 v[132:133], v[132:133], v[78:79] op_sel:[0,0] op_sel_hi:[1,0]
v_pk_mul_f32 v[134:135], v[134:135], v[78:79] op_sel:[0,0] op_sel_hi:[1,0]
v_cvt_pk_bf16_f32 v128, v128, v129
v_cvt_pk_bf16_f32 v129, v130, v131
v_cvt_pk_bf16_f32 v130, v132, v133
v_cvt_pk_bf16_f32 v131, v134, v135
v_pk_fma_f32 v[136:137], v[108:109], v[76:77], v[136:137] op_sel:[0,0,0] op_sel_hi:[1,0,1]
v_pk_fma_f32 v[138:139], v[110:111], v[76:77], v[138:139] op_sel:[0,0,0] op_sel_hi:[1,0,1]
v_pk_mul_f32 v[136:137], v[136:137], v[88:89]
v_pk_mul_f32 v[138:139], v[138:139], v[90:91]
v_cvt_pk_bf16_f32 v20, v136, v137
v_mfma_f32_16x16x32_bf16 v[192:195], v[188:191], v[156:159], v[44:47]
v_cvt_pk_bf16_f32 v21, v138, v139
v_pk_fma_f32 v[212:213], v[112:113], v[76:77], v[212:213] op_sel:[0,0,0] op_sel_hi:[1,0,1]
v_pk_fma_f32 v[214:215], v[114:115], v[76:77], v[214:215] op_sel:[0,0,0] op_sel_hi:[1,0,1]
v_pk_mul_f32 v[212:213], v[212:213], v[92:93]
v_pk_mul_f32 v[214:215], v[214:215], v[94:95]
v_cvt_pk_bf16_f32 v22, v212, v213
v_mfma_f32_16x16x32_bf16 v[160:163], v[180:183], v[156:159], v[40:43]
v_cvt_pk_bf16_f32 v23, v214, v215
v_pk_fma_f32 v[220:221], v[116:117], v[76:77], v[220:221] op_sel:[0,0,0] op_sel_hi:[1,0,1]
v_pk_fma_f32 v[222:223], v[118:119], v[76:77], v[222:223] op_sel:[0,0,0] op_sel_hi:[1,0,1]
v_pk_mul_f32 v[220:221], v[220:221], v[96:97]
v_pk_mul_f32 v[222:223], v[222:223], v[98:99]
v_cvt_pk_bf16_f32 v24, v220, v221
v_mfma_f32_16x16x32_bf16 v[200:203], v[196:199], v[164:167], v[44:47]
v_cvt_pk_bf16_f32 v25, v222, v223
v_pk_fma_f32 v[228:229], v[120:121], v[76:77], v[228:229] op_sel:[0,0,0] op_sel_hi:[1,0,1]
v_pk_fma_f32 v[230:231], v[122:123], v[76:77], v[230:231] op_sel:[0,0,0] op_sel_hi:[1,0,1]
v_pk_mul_f32 v[228:229], v[228:229], v[100:101]
v_pk_mul_f32 v[230:231], v[230:231], v[102:103]
v_cvt_pk_bf16_f32 v26, v228, v229
v_mfma_f32_16x16x32_bf16 v[168:171], v[188:191], v[164:167], v[40:43]
v_cvt_pk_bf16_f32 v27, v230, v231
v_pk_fma_f32 v[236:237], v[124:125], v[76:77], v[236:237] op_sel:[0,0,0] op_sel_hi:[1,0,1]
v_pk_fma_f32 v[238:239], v[126:127], v[76:77], v[238:239] op_sel:[0,0,0] op_sel_hi:[1,0,1]
v_pk_mul_f32 v[236:237], v[236:237], v[104:105]
v_pk_mul_f32 v[238:239], v[238:239], v[106:107]
v_cvt_pk_bf16_f32 v28, v236, v237
v_mfma_f32_16x16x32_bf16 v[208:211], v[204:207], v[172:175], v[44:47]
v_cvt_pk_bf16_f32 v29, v238, v239
v_pk_fma_f32 v[140:141], v[108:109], v[76:77], v[140:141] op_sel:[0,1,0] op_sel_hi:[1,1,1]
v_pk_fma_f32 v[142:143], v[110:111], v[76:77], v[142:143] op_sel:[0,1,0] op_sel_hi:[1,1,1]
v_pk_mul_f32 v[140:141], v[140:141], v[88:89]
v_pk_mul_f32 v[142:143], v[142:143], v[90:91]
v_cvt_pk_bf16_f32 v30, v140, v141
v_mfma_f32_16x16x32_bf16 v[176:179], v[196:199], v[172:175], v[40:43]
v_cvt_pk_bf16_f32 v31, v142, v143
v_pk_fma_f32 v[216:217], v[112:113], v[76:77], v[216:217] op_sel:[0,1,0] op_sel_hi:[1,1,1]
v_pk_fma_f32 v[218:219], v[114:115], v[76:77], v[218:219] op_sel:[0,1,0] op_sel_hi:[1,1,1]
v_pk_mul_f32 v[216:217], v[216:217], v[92:93]
v_pk_mul_f32 v[218:219], v[218:219], v[94:95]
v_cvt_pk_bf16_f32 v32, v216, v217
v_mfma_f32_16x16x32_bf16 v[184:187], v[180:183], v[148:151], v[44:47]
v_cvt_pk_bf16_f32 v33, v218, v219
v_pk_fma_f32 v[224:225], v[116:117], v[76:77], v[224:225] op_sel:[0,1,0] op_sel_hi:[1,1,1]
v_pk_fma_f32 v[226:227], v[118:119], v[76:77], v[226:227] op_sel:[0,1,0] op_sel_hi:[1,1,1]
v_pk_mul_f32 v[224:225], v[224:225], v[96:97]
v_pk_mul_f32 v[226:227], v[226:227], v[98:99]
v_cvt_pk_bf16_f32 v34, v224, v225
v_mfma_f32_16x16x32_bf16 v[152:155], v[128:131], v[148:151], v[48:51]
v_cvt_pk_bf16_f32 v35, v226, v227
v_pk_fma_f32 v[232:233], v[120:121], v[76:77], v[232:233] op_sel:[0,1,0] op_sel_hi:[1,1,1]
v_pk_fma_f32 v[234:235], v[122:123], v[76:77], v[234:235] op_sel:[0,1,0] op_sel_hi:[1,1,1]
v_pk_mul_f32 v[232:233], v[232:233], v[100:101]
v_pk_mul_f32 v[234:235], v[234:235], v[102:103]
v_cvt_pk_bf16_f32 v36, v232, v233
v_cvt_pk_bf16_f32 v37, v234, v235
v_pk_fma_f32 v[240:241], v[124:125], v[76:77], v[240:241] op_sel:[0,1,0] op_sel_hi:[1,1,1]
v_pk_fma_f32 v[242:243], v[126:127], v[76:77], v[242:243] op_sel:[0,1,0] op_sel_hi:[1,1,1]
v_pk_mul_f32 v[240:241], v[240:241], v[104:105]
v_pk_mul_f32 v[242:243], v[242:243], v[106:107]
v_cvt_pk_bf16_f32 v38, v240, v241
v_cvt_pk_bf16_f32 v39, v242, v243
v_max_f32 v148, v152, v153
v_max_f32 v149, v154, v155
v_max_f32 v150, v184, v185
v_max_f32 v151, v186, v187
v_max3_f32 v14, v148, v149, v150
v_max_f32 v14, v14, v151
v_max_f32 v156, v160, v161
v_max_f32 v157, v162, v163
v_max_f32 v158, v192, v193
v_max_f32 v159, v194, v195
v_max3_f32 v15, v156, v157, v158
v_max_f32 v15, v15, v159
v_max_f32 v164, v168, v169
v_max_f32 v165, v170, v171
v_max_f32 v166, v200, v201
v_max_f32 v167, v202, v203
v_max3_f32 v16, v164, v165, v166
v_max_f32 v16, v16, v167
v_max_f32 v172, v176, v177
v_max_f32 v173, v178, v179
v_max_f32 v174, v208, v209
v_max_f32 v175, v210, v211
v_max3_f32 v17, v172, v173, v174
v_max_f32 v17, v17, v175
s_nop 1
v_permlane32_swap_b32 v14, v15
v_permlane32_swap_b32 v16, v17
s_nop 0
v_max_f32 v14, v14, v15
v_max_f32 v16, v16, v17
s_nop 1
v_permlane16_swap_b32 v14, v16
s_nop 0
v_max_f32 v14, v14, v16
v_mov_b32 v16, v14
s_nop 1
v_permlane16_swap_b32 v14, v16
s_nop 0
v_mov_b32 v15, v14
v_mov_b32 v17, v16
s_nop 1
v_permlane32_swap_b32 v14, v15
v_permlane32_swap_b32 v16, v17
s_nop 0
v_pk_mul_f32 v[14:15], v[14:15], v[10:11]
v_pk_mul_f32 v[16:17], v[16:17], v[12:13]
v_pk_fma_f32 v[148:149], v[148:149], v[10:11], v[14:15] op_sel:[0,0,0] op_sel_hi:[1,0,0] neg_lo:[0,0,1] neg_hi:[0,0,1]
v_pk_fma_f32 v[150:151], v[150:151], v[10:11], v[14:15] op_sel:[0,0,0] op_sel_hi:[1,0,0] neg_lo:[0,0,1] neg_hi:[0,0,1]
v_exp_f32 v148, v148
v_exp_f32 v149, v149
v_exp_f32 v150, v150
v_exp_f32 v151, v151
v_cvt_pk_bf16_f32 v148, v148, v148
v_cvt_pk_bf16_f32 v149, v149, v149
v_cvt_pk_bf16_f32 v150, v150, v150
v_cvt_pk_bf16_f32 v151, v151, v151
v_and_b32 v148, v52, v148
v_and_b32 v149, v52, v149
v_and_b32 v150, v52, v150
v_and_b32 v151, v52, v151
v_pk_fma_f32 v[156:157], v[156:157], v[10:11], v[14:15] op_sel:[0,1,1] op_sel_hi:[1,1,1] neg_lo:[0,0,1] neg_hi:[0,0,1]
v_pk_fma_f32 v[158:159], v[158:159], v[10:11], v[14:15] op_sel:[0,1,1] op_sel_hi:[1,1,1] neg_lo:[0,0,1] neg_hi:[0,0,1]
v_exp_f32 v156, v156
v_mfma_f32_16x16x32_bf16 v[152:155], v[56:59], v[148:151], 0
v_exp_f32 v157, v157
v_exp_f32 v158, v158
v_exp_f32 v159, v159
v_cvt_pk_bf16_f32 v156, v156, v156
v_mfma_f32_16x16x32_bf16 v[212:215], v[20:23], v[148:151], 0
v_cvt_pk_bf16_f32 v157, v157, v157
v_cvt_pk_bf16_f32 v158, v158, v158
v_cvt_pk_bf16_f32 v159, v159, v159
v_and_b32 v156, v52, v156
v_mfma_f32_16x16x32_bf16 v[216:219], v[30:33], v[148:151], 0
v_and_b32 v157, v52, v157
v_and_b32 v158, v52, v158
v_and_b32 v159, v52, v159
v_pk_fma_f32 v[164:165], v[164:165], v[12:13], v[16:17] op_sel:[0,0,0] op_sel_hi:[1,0,0] neg_lo:[0,0,1] neg_hi:[0,0,1]
v_pk_fma_f32 v[166:167], v[166:167], v[12:13], v[16:17] op_sel:[0,0,0] op_sel_hi:[1,0,0] neg_lo:[0,0,1] neg_hi:[0,0,1]
v_exp_f32 v164, v164
v_mfma_f32_16x16x32_bf16 v[160:163], v[56:59], v[156:159], 0
v_exp_f32 v165, v165
v_exp_f32 v166, v166
v_exp_f32 v167, v167
v_cvt_pk_bf16_f32 v164, v164, v164
v_mfma_f32_16x16x32_bf16 v[220:223], v[22:25], v[156:159], 0
v_cvt_pk_bf16_f32 v165, v165, v165
v_cvt_pk_bf16_f32 v166, v166, v166
v_cvt_pk_bf16_f32 v167, v167, v167
v_and_b32 v164, v52, v164
v_mfma_f32_16x16x32_bf16 v[224:227], v[32:35], v[156:159], 0
v_and_b32 v165, v52, v165
v_and_b32 v166, v52, v166
v_and_b32 v167, v52, v167
v_pk_fma_f32 v[172:173], v[172:173], v[12:13], v[16:17] op_sel:[0,1,1] op_sel_hi:[1,1,1] neg_lo:[0,0,1] neg_hi:[0,0,1]
v_pk_fma_f32 v[174:175], v[174:175], v[12:13], v[16:17] op_sel:[0,1,1] op_sel_hi:[1,1,1] neg_lo:[0,0,1] neg_hi:[0,0,1]
v_exp_f32 v172, v172
v_mfma_f32_16x16x32_bf16 v[168:171], v[56:59], v[164:167], 0
v_exp_f32 v173, v173
v_exp_f32 v174, v174
v_exp_f32 v175, v175
v_cvt_pk_bf16_f32 v172, v172, v172
v_mfma_f32_16x16x32_bf16 v[228:231], v[24:27], v[164:167], 0
v_cvt_pk_bf16_f32 v173, v173, v173
v_cvt_pk_bf16_f32 v174, v174, v174
v_cvt_pk_bf16_f32 v175, v175, v175
v_and_b32 v172, v52, v172
v_mfma_f32_16x16x32_bf16 v[232:235], v[34:37], v[164:167], 0
v_and_b32 v173, v52, v173
v_and_b32 v174, v52, v174
v_and_b32 v175, v52, v175
s_nop 1
v_mfma_f32_16x16x32_bf16 v[176:179], v[56:59], v[172:175], 0
v_mfma_f32_16x16x32_bf16 v[236:239], v[26:29], v[172:175], 0
v_mfma_f32_16x16x32_bf16 v[240:243], v[36:39], v[172:175], 0
v_rcp_f32 v152, v152
v_rcp_f32 v160, v160
v_rcp_f32 v168, v168
s_nop 2
v_rcp_f32 v176, v176
s_cmp_eq_u32 s46, 0
s_cbranch_scc1 slow_43
.p2align 3
v_pk_mul_f32 v[212:213], v[212:213], v[152:153] op_sel:[0,0] op_sel_hi:[1,0]
v_pk_mul_f32 v[214:215], v[214:215], v[152:153] op_sel:[0,0] op_sel_hi:[1,0]
v_pk_mul_f32 v[216:217], v[216:217], v[152:153] op_sel:[0,0] op_sel_hi:[1,0]
v_pk_mul_f32 v[218:219], v[218:219], v[152:153] op_sel:[0,0] op_sel_hi:[1,0]
v_cvt_pk_bf16_f32 v212, v212, v213
v_cvt_pk_bf16_f32 v213, v214, v215
v_cvt_pk_bf16_f32 v214, v216, v217
v_cvt_pk_bf16_f32 v215, v218, v219
buffer_store_dwordx4 v[212:215], v18, s[32:35], s80 offen
v_pk_mul_f32 v[220:221], v[220:221], v[160:161] op_sel:[0,0] op_sel_hi:[1,0]
v_pk_mul_f32 v[222:223], v[222:223], v[160:161] op_sel:[0,0] op_sel_hi:[1,0]
v_pk_mul_f32 v[224:225], v[224:225], v[160:161] op_sel:[0,0] op_sel_hi:[1,0]
v_pk_mul_f32 v[226:227], v[226:227], v[160:161] op_sel:[0,0] op_sel_hi:[1,0]
v_cvt_pk_bf16_f32 v220, v220, v221
v_cvt_pk_bf16_f32 v221, v222, v223
v_cvt_pk_bf16_f32 v222, v224, v225
v_cvt_pk_bf16_f32 v223, v226, v227
buffer_store_dwordx4 v[220:223], v18, s[32:35], s81 offen
v_pk_mul_f32 v[228:229], v[228:229], v[168:169] op_sel:[0,0] op_sel_hi:[1,0]
v_pk_mul_f32 v[230:231], v[230:231], v[168:169] op_sel:[0,0] op_sel_hi:[1,0]
v_pk_mul_f32 v[232:233], v[232:233], v[168:169] op_sel:[0,0] op_sel_hi:[1,0]
v_pk_mul_f32 v[234:235], v[234:235], v[168:169] op_sel:[0,0] op_sel_hi:[1,0]
v_cvt_pk_bf16_f32 v228, v228, v229
v_cvt_pk_bf16_f32 v229, v230, v231
v_cvt_pk_bf16_f32 v230, v232, v233
v_cvt_pk_bf16_f32 v231, v234, v235
buffer_store_dwordx4 v[228:231], v18, s[32:35], s82 offen
v_pk_mul_f32 v[236:237], v[236:237], v[176:177] op_sel:[0,0] op_sel_hi:[1,0]
v_pk_mul_f32 v[238:239], v[238:239], v[176:177] op_sel:[0,0] op_sel_hi:[1,0]
v_pk_mul_f32 v[240:241], v[240:241], v[176:177] op_sel:[0,0] op_sel_hi:[1,0]
v_pk_mul_f32 v[242:243], v[242:243], v[176:177] op_sel:[0,0] op_sel_hi:[1,0]
v_cvt_pk_bf16_f32 v236, v236, v237
v_cvt_pk_bf16_f32 v237, v238, v239
v_cvt_pk_bf16_f32 v238, v240, v241
v_cvt_pk_bf16_f32 v239, v242, v243
buffer_store_dwordx4 v[236:239], v18, s[32:35], s83 offen
s_barrier
s_lshl_b32 s62, s45, 2
v_mov_b32 v4, s62
v_mov_b32 v5, 1
s_mov_b64 exec, 1
s_waitcnt vmcnt(0)
buffer_store_dword v5, v4, s[32:35], s84 offen
s_mov_b64 exec, -1
back_44:
s_lshl_b32 s48, s41, 3
s_lshl_b32 s49, s40, 1
s_add_u32 s48, s48, s49
s_lshl_b32 s49, s48, 4
v_add_u32 v4, s49, v2
v_lshlrev_b32 v4, 11, v4
v_and_b32 v5, 1, v3
v_lshl_add_u32 v4, v5, 5, v4
v_lshrrev_b32 v5, 1, v3
v_lshl_add_u32 v4, v5, 4, v4
s_lshl_b32 s49, s42, 7
v_add_u32 v12, s49, v4
v_add_u32 v13, 32768, v12
buffer_load_dwordx4 v[88:91], v12, s[24:27], 0 offen offset:0
buffer_load_dwordx4 v[92:95], v12, s[24:27], 0 offen offset:64
buffer_load_dwordx4 v[96:99], v13, s[24:27], 0 offen offset:0
buffer_load_dwordx4 v[100:103], v13, s[24:27], 0 offen offset:64
v_and_b32 v10, 31, v0
v_lshlrev_b32 v10, 2, v10
buffer_load_dword v11, v10, s[32:35], s84 offen sc1
v_lshrrev_b32 v4, 2, v2
v_and_b32 v5, 3, v0
v_lshl_add_u32 v6, v3, 3, v4
v_lshlrev_b32 v6, 7, v6
v_lshl_add_u32 v6, v5, 3, v6
v_lshrrev_b32 v7, 1, v4
v_and_b32 v8, 1, v3
v_lshl_add_u32 v7, v8, 1, v7
v_lshl_add_u32 v14, v7, 5, v6
v_xor_b32 v15, 32, v14
v_xor_b32 v16, 64, v14
v_xor_b32 v17, 96, v14
v_add_u32 v52, 0x10000, v14
v_add_u32 v53, 0x10000, v15
v_add_u32 v54, 0x10000, v16
v_add_u32 v55, 0x10000, v17
ds_read_b64_tr_b16 v[212:213], v14 offset:0
ds_read_b64_tr_b16 v[214:215], v14 offset:512
ds_read_b64_tr_b16 v[216:217], v15 offset:0
ds_read_b64_tr_b16 v[218:219], v15 offset:512
ds_read_b64_tr_b16 v[220:221], v16 offset:0
ds_read_b64_tr_b16 v[222:223], v16 offset:512
ds_read_b64_tr_b16 v[224:225], v17 offset:0
ds_read_b64_tr_b16 v[226:227], v17 offset:512
ds_read_b64_tr_b16 v[228:229], v14 offset:4096
ds_read_b64_tr_b16 v[230:231], v14 offset:4608
ds_read_b64_tr_b16 v[232:233], v15 offset:4096
ds_read_b64_tr_b16 v[234:235], v15 offset:4608
ds_read_b64_tr_b16 v[236:237], v16 offset:4096
ds_read_b64_tr_b16 v[238:239], v16 offset:4608
ds_read_b64_tr_b16 v[240:241], v17 offset:4096
ds_read_b64_tr_b16 v[242:243], v17 offset:4608
s_lshl_b32 s48, s41, 3
s_lshl_b32 s49, s40, 1
s_add_u32 s56, s48, s49
s_lshl_b32 s48, s56, 15
s_add_u32 s48, s48, 4194304
v_add_u32 v12, s48, v18
v_add_u32 v13, 32768, v12
s_lshl_b32 s57, s47, 11
s_mov_b32 s63, 0
s_waitcnt vmcnt(0)
poll_45:
v_cmp_gt_u32 vcc, 1, v11
s_cbranch_vccz polled_46
buffer_load_dword v11, v10, s[32:35], s84 offen sc1
s_add_u32 s63, s63, 1
s_cmp_lt_u32 s63, 0x80000
s_waitcnt vmcnt(0)
s_cbranch_scc1 poll_45
polled_46:
buffer_load_dwordx4 v[148:151], v12, s[32:35], s57 offen sc1
buffer_load_dwordx4 v[152:155], v13, s[32:35], s57 offen sc1
buffer_load_dwordx4 v[156:159], v12, s[32:35], s57 offen offset:1024 sc1
buffer_load_dwordx4 v[160:163], v13, s[32:35], s57 offen offset:1024 sc1
s_add_u32 s57, s57, 2048
s_and_b32 s57, s57, 0x7fff
buffer_load_dwordx4 v[164:167], v12, s[32:35], s57 offen sc1
buffer_load_dwordx4 v[168:171], v13, s[32:35], s57 offen sc1
buffer_load_dwordx4 v[172:175], v12, s[32:35], s57 offen offset:1024 sc1
buffer_load_dwordx4 v[176:179], v13, s[32:35], s57 offen offset:1024 sc1
s_add_u32 s57, s57, 2048
s_and_b32 s57, s57, 0x7fff
buffer_load_dwordx4 v[180:183], v12, s[32:35], s57 offen sc1
buffer_load_dwordx4 v[184:187], v13, s[32:35], s57 offen sc1
buffer_load_dwordx4 v[188:191], v12, s[32:35], s57 offen offset:1024 sc1
buffer_load_dwordx4 v[192:195], v13, s[32:35], s57 offen offset:1024 sc1
s_add_u32 s57, s57, 2048
s_and_b32 s57, s57, 0x7fff
v_permlane16_swap_b32 v88, v90
v_permlane16_swap_b32 v89, v91
v_permlane16_swap_b32 v92, v94
v_permlane16_swap_b32 v93, v95
v_permlane16_swap_b32 v96, v98
v_permlane16_swap_b32 v97, v99
v_permlane16_swap_b32 v100, v102
v_permlane16_swap_b32 v101, v103
v_lshlrev_b32 v20, 16, v88
v_and_b32 v21, 0xffff0000, v88
v_lshlrev_b32 v22, 16, v89
v_and_b32 v23, 0xffff0000, v89
v_lshlrev_b32 v24, 16, v90
v_and_b32 v25, 0xffff0000, v90
v_lshlrev_b32 v26, 16, v91
v_and_b32 v27, 0xffff0000, v91
v_lshlrev_b32 v28, 16, v92
v_and_b32 v29, 0xffff0000, v92
v_lshlrev_b32 v30, 16, v93
v_and_b32 v31, 0xffff0000, v93
v_lshlrev_b32 v32, 16, v94
v_and_b32 v33, 0xffff0000, v94
v_lshlrev_b32 v34, 16, v95
v_and_b32 v35, 0xffff0000, v95
v_lshlrev_b32 v36, 16, v96
v_and_b32 v37, 0xffff0000, v96
v_lshlrev_b32 v38, 16, v97
v_and_b32 v39, 0xffff0000, v97
v_lshlrev_b32 v40, 16, v98
v_and_b32 v41, 0xffff0000, v98
v_lshlrev_b32 v42, 16, v99
v_and_b32 v43, 0xffff0000, v99
v_lshlrev_b32 v44, 16, v100
v_and_b32 v45, 0xffff0000, v100
v_lshlrev_b32 v46, 16, v101
v_and_b32 v47, 0xffff0000, v101
v_lshlrev_b32 v48, 16, v102
v_and_b32 v49, 0xffff0000, v102
v_lshlrev_b32 v50, 16, v103
v_and_b32 v51, 0xffff0000, v103
v_mov_b32 v10, 0x3f803f80
v_mov_b32 v6, 0
v_mov_b32 v7, 0
v_mov_b32 v8, 0
v_mov_b32 v9, 0
s_lshl_b32 s62, s42, 2
v_mov_b32 v4, s62
v_mov_b32 v5, 1
s_waitcnt vmcnt(10) lgkmcnt(8)
v_mfma_f32_16x16x32_bf16 v[20:23], v[212:215], v[148:151], v[20:23]
ds_read_b64_tr_b16 v[104:105], v14 offset:8192
ds_read_b64_tr_b16 v[106:107], v14 offset:8704
v_mfma_f32_16x16x32_bf16 v[36:39], v[212:215], v[152:155], v[36:39]
buffer_load_dwordx4 v[196:199], v12, s[32:35], s57 offen sc1
v_mfma_f32_16x16x32_bf16 v[24:27], v[216:219], v[148:151], v[24:27]
ds_read_b64_tr_b16 v[108:109], v15 offset:8192
v_mfma_f32_16x16x32_bf16 v[40:43], v[216:219], v[152:155], v[40:43]
ds_read_b64_tr_b16 v[110:111], v15 offset:8704
v_mfma_f32_16x16x32_bf16 v[28:31], v[220:223], v[148:151], v[28:31]
ds_read_b64_tr_b16 v[112:113], v16 offset:8192
buffer_load_dwordx4 v[200:203], v13, s[32:35], s57 offen sc1
v_mfma_f32_16x16x32_bf16 v[44:47], v[220:223], v[152:155], v[44:47]
ds_read_b64_tr_b16 v[114:115], v16 offset:8704
v_mfma_f32_16x16x32_bf16 v[32:35], v[224:227], v[148:151], v[32:35]
ds_read_b64_tr_b16 v[116:117], v17 offset:8192
v_mfma_f32_16x16x32_bf16 v[48:51], v[224:227], v[152:155], v[48:51]
ds_read_b64_tr_b16 v[118:119], v17 offset:8704
s_waitcnt vmcnt(10) lgkmcnt(8)
v_mfma_f32_16x16x32_bf16 v[20:23], v[228:231], v[156:159], v[20:23]
ds_read_b64_tr_b16 v[212:213], v14 offset:12288
ds_read_b64_tr_b16 v[214:215], v14 offset:12800
v_mfma_f32_16x16x32_bf16 v[36:39], v[228:231], v[160:163], v[36:39]
buffer_load_dwordx4 v[204:207], v12, s[32:35], s57 offen offset:1024 sc1
v_mfma_f32_16x16x32_bf16 v[24:27], v[232:235], v[156:159], v[24:27]
ds_read_b64_tr_b16 v[216:217], v15 offset:12288
v_mfma_f32_16x16x32_bf16 v[40:43], v[232:235], v[160:163], v[40:43]
ds_read_b64_tr_b16 v[218:219], v15 offset:12800
v_mfma_f32_16x16x32_bf16 v[28:31], v[236:239], v[156:159], v[28:31]
ds_read_b64_tr_b16 v[220:221], v16 offset:12288
buffer_load_dwordx4 v[208:211], v13, s[32:35], s57 offen offset:1024 sc1
s_add_u32 s57, s57, 2048
s_and_b32 s57, s57, 0x7fff
v_mfma_f32_16x16x32_bf16 v[44:47], v[236:239], v[160:163], v[44:47]
ds_read_b64_tr_b16 v[222:223], v16 offset:12800
v_mfma_f32_16x16x32_bf16 v[32:35], v[240:243], v[156:159], v[32:35]
ds_read_b64_tr_b16 v[224:225], v17 offset:12288
v_mfma_f32_16x16x32_bf16 v[48:51], v[240:243], v[160:163], v[48:51]
ds_read_b64_tr_b16 v[226:227], v17 offset:12800
s_waitcnt vmcnt(10) lgkmcnt(8)
v_mfma_f32_16x16x32_bf16 v[20:23], v[104:107], v[164:167], v[20:23]
ds_read_b64_tr_b16 v[228:229], v14 offset:16384
ds_read_b64_tr_b16 v[230:231], v14 offset:16896
v_mfma_f32_16x16x32_bf16 v[36:39], v[104:107], v[168:171], v[36:39]
buffer_load_dwordx4 v[148:151], v12, s[32:35], s57 offen sc1
v_mfma_f32_16x16x32_bf16 v[24:27], v[108:111], v[164:167], v[24:27]
ds_read_b64_tr_b16 v[232:233], v15 offset:16384
v_mfma_f32_16x16x32_bf16 v[40:43], v[108:111], v[168:171], v[40:43]
ds_read_b64_tr_b16 v[234:235], v15 offset:16896
v_mfma_f32_16x16x32_bf16 v[28:31], v[112:115], v[164:167], v[28:31]
ds_read_b64_tr_b16 v[236:237], v16 offset:16384
buffer_load_dwordx4 v[152:155], v13, s[32:35], s57 offen sc1
v_mfma_f32_16x16x32_bf16 v[44:47], v[112:115], v[168:171], v[44:47]
ds_read_b64_tr_b16 v[238:239], v16 offset:16896
v_mfma_f32_16x16x32_bf16 v[32:35], v[116:119], v[164:167], v[32:35]
ds_read_b64_tr_b16 v[240:241], v17 offset:16384
v_mfma_f32_16x16x32_bf16 v[48:51], v[116:119], v[168:171], v[48:51]
ds_read_b64_tr_b16 v[242:243], v17 offset:16896
s_waitcnt vmcnt(10) lgkmcnt(8)
v_mfma_f32_16x16x32_bf16 v[20:23], v[212:215], v[172:175], v[20:23]
ds_read_b64_tr_b16 v[104:105], v14 offset:20480
ds_read_b64_tr_b16 v[106:107], v14 offset:20992
v_mfma_f32_16x16x32_bf16 v[36:39], v[212:215], v[176:179], v[36:39]
buffer_load_dwordx4 v[156:159], v12, s[32:35], s57 offen offset:1024 sc1
v_mfma_f32_16x16x32_bf16 v[24:27], v[216:219], v[172:175], v[24:27]
ds_read_b64_tr_b16 v[108:109], v15 offset:20480
v_mfma_f32_16x16x32_bf16 v[40:43], v[216:219], v[176:179], v[40:43]
ds_read_b64_tr_b16 v[110:111], v15 offset:20992
v_mfma_f32_16x16x32_bf16 v[28:31], v[220:223], v[172:175], v[28:31]
ds_read_b64_tr_b16 v[112:113], v16 offset:20480
buffer_load_dwordx4 v[160:163], v13, s[32:35], s57 offen offset:1024 sc1
s_add_u32 s57, s57, 2048
s_and_b32 s57, s57, 0x7fff
v_mfma_f32_16x16x32_bf16 v[44:47], v[220:223], v[176:179], v[44:47]
ds_read_b64_tr_b16 v[114:115], v16 offset:20992
v_mfma_f32_16x16x32_bf16 v[32:35], v[224:227], v[172:175], v[32:35]
ds_read_b64_tr_b16 v[116:117], v17 offset:20480
v_mfma_f32_16x16x32_bf16 v[48:51], v[224:227], v[176:179], v[48:51]
ds_read_b64_tr_b16 v[118:119], v17 offset:20992
s_waitcnt vmcnt(10) lgkmcnt(8)
v_mfma_f32_16x16x32_bf16 v[20:23], v[228:231], v[180:183], v[20:23]
ds_read_b64_tr_b16 v[212:213], v14 offset:24576
ds_read_b64_tr_b16 v[214:215], v14 offset:25088
v_mfma_f32_16x16x32_bf16 v[36:39], v[228:231], v[184:187], v[36:39]
buffer_load_dwordx4 v[164:167], v12, s[32:35], s57 offen sc1
v_mfma_f32_16x16x32_bf16 v[24:27], v[232:235], v[180:183], v[24:27]
ds_read_b64_tr_b16 v[216:217], v15 offset:24576
v_mfma_f32_16x16x32_bf16 v[40:43], v[232:235], v[184:187], v[40:43]
ds_read_b64_tr_b16 v[218:219], v15 offset:25088
v_mfma_f32_16x16x32_bf16 v[28:31], v[236:239], v[180:183], v[28:31]
ds_read_b64_tr_b16 v[220:221], v16 offset:24576
buffer_load_dwordx4 v[168:171], v13, s[32:35], s57 offen sc1
v_mfma_f32_16x16x32_bf16 v[44:47], v[236:239], v[184:187], v[44:47]
ds_read_b64_tr_b16 v[222:223], v16 offset:25088
v_mfma_f32_16x16x32_bf16 v[32:35], v[240:243], v[180:183], v[32:35]
ds_read_b64_tr_b16 v[224:225], v17 offset:24576
v_mfma_f32_16x16x32_bf16 v[48:51], v[240:243], v[184:187], v[48:51]
ds_read_b64_tr_b16 v[226:227], v17 offset:25088
s_waitcnt vmcnt(10) lgkmcnt(8)
v_mfma_f32_16x16x32_bf16 v[20:23], v[104:107], v[188:191], v[20:23]
ds_read_b64_tr_b16 v[228:229], v14 offset:28672
ds_read_b64_tr_b16 v[230:231], v14 offset:29184
v_mfma_f32_16x16x32_bf16 v[36:39], v[104:107], v[192:195], v[36:39]
buffer_load_dwordx4 v[172:175], v12, s[32:35], s57 offen offset:1024 sc1
v_mfma_f32_16x16x32_bf16 v[24:27], v[108:111], v[188:191], v[24:27]
ds_read_b64_tr_b16 v[232:233], v15 offset:28672
v_mfma_f32_16x16x32_bf16 v[40:43], v[108:111], v[192:195], v[40:43]
ds_read_b64_tr_b16 v[234:235], v15 offset:29184
v_mfma_f32_16x16x32_bf16 v[28:31], v[112:115], v[188:191], v[28:31]
ds_read_b64_tr_b16 v[236:237], v16 offset:28672
buffer_load_dwordx4 v[176:179], v13, s[32:35], s57 offen offset:1024 sc1
s_add_u32 s57, s57, 2048
s_and_b32 s57, s57, 0x7fff
v_mfma_f32_16x16x32_bf16 v[44:47], v[112:115], v[192:195], v[44:47]
ds_read_b64_tr_b16 v[238:239], v16 offset:29184
v_mfma_f32_16x16x32_bf16 v[32:35], v[116:119], v[188:191], v[32:35]
ds_read_b64_tr_b16 v[240:241], v17 offset:28672
v_mfma_f32_16x16x32_bf16 v[48:51], v[116:119], v[192:195], v[48:51]
ds_read_b64_tr_b16 v[242:243], v17 offset:29184
s_waitcnt vmcnt(10) lgkmcnt(8)
v_mfma_f32_16x16x32_bf16 v[20:23], v[212:215], v[196:199], v[20:23]
ds_read_b64_tr_b16 v[104:105], v14 offset:32768
ds_read_b64_tr_b16 v[106:107], v14 offset:33280
v_mfma_f32_16x16x32_bf16 v[36:39], v[212:215], v[200:203], v[36:39]
buffer_load_dwordx4 v[180:183], v12, s[32:35], s57 offen sc1
v_mfma_f32_16x16x32_bf16 v[24:27], v[216:219], v[196:199], v[24:27]
ds_read_b64_tr_b16 v[108:109], v15 offset:32768
v_mfma_f32_16x16x32_bf16 v[40:43], v[216:219], v[200:203], v[40:43]
ds_read_b64_tr_b16 v[110:111], v15 offset:33280
v_mfma_f32_16x16x32_bf16 v[28:31], v[220:223], v[196:199], v[28:31]
ds_read_b64_tr_b16 v[112:113], v16 offset:32768
buffer_load_dwordx4 v[184:187], v13, s[32:35], s57 offen sc1
v_mfma_f32_16x16x32_bf16 v[44:47], v[220:223], v[200:203], v[44:47]
ds_read_b64_tr_b16 v[114:115], v16 offset:33280
v_mfma_f32_16x16x32_bf16 v[32:35], v[224:227], v[196:199], v[32:35]
ds_read_b64_tr_b16 v[116:117], v17 offset:32768
v_mfma_f32_16x16x32_bf16 v[48:51], v[224:227], v[200:203], v[48:51]
ds_read_b64_tr_b16 v[118:119], v17 offset:33280
s_waitcnt vmcnt(10) lgkmcnt(8)
v_mfma_f32_16x16x32_bf16 v[20:23], v[228:231], v[204:207], v[20:23]
ds_read_b64_tr_b16 v[212:213], v14 offset:36864
ds_read_b64_tr_b16 v[214:215], v14 offset:37376
v_mfma_f32_16x16x32_bf16 v[36:39], v[228:231], v[208:211], v[36:39]
buffer_load_dwordx4 v[188:191], v12, s[32:35], s57 offen offset:1024 sc1
v_mfma_f32_16x16x32_bf16 v[24:27], v[232:235], v[204:207], v[24:27]
ds_read_b64_tr_b16 v[216:217], v15 offset:36864
v_mfma_f32_16x16x32_bf16 v[40:43], v[232:235], v[208:211], v[40:43]
ds_read_b64_tr_b16 v[218:219], v15 offset:37376
v_mfma_f32_16x16x32_bf16 v[28:31], v[236:239], v[204:207], v[28:31]
ds_read_b64_tr_b16 v[220:221], v16 offset:36864
buffer_load_dwordx4 v[192:195], v13, s[32:35], s57 offen offset:1024 sc1
s_add_u32 s57, s57, 2048
s_and_b32 s57, s57, 0x7fff
v_mfma_f32_16x16x32_bf16 v[44:47], v[236:239], v[208:211], v[44:47]
ds_read_b64_tr_b16 v[222:223], v16 offset:37376
v_mfma_f32_16x16x32_bf16 v[32:35], v[240:243], v[204:207], v[32:35]
ds_read_b64_tr_b16 v[224:225], v17 offset:36864
v_mfma_f32_16x16x32_bf16 v[48:51], v[240:243], v[208:211], v[48:51]
ds_read_b64_tr_b16 v[226:227], v17 offset:37376
s_waitcnt vmcnt(10) lgkmcnt(8)
v_mfma_f32_16x16x32_bf16 v[20:23], v[104:107], v[148:151], v[20:23]
ds_read_b64_tr_b16 v[228:229], v14 offset:40960
ds_read_b64_tr_b16 v[230:231], v14 offset:41472
v_mfma_f32_16x16x32_bf16 v[36:39], v[104:107], v[152:155], v[36:39]
buffer_load_dwordx4 v[196:199], v12, s[32:35], s57 offen sc1
v_mfma_f32_16x16x32_bf16 v[24:27], v[108:111], v[148:151], v[24:27]
ds_read_b64_tr_b16 v[232:233], v15 offset:40960
v_mfma_f32_16x16x32_bf16 v[40:43], v[108:111], v[152:155], v[40:43]
ds_read_b64_tr_b16 v[234:235], v15 offset:41472
v_mfma_f32_16x16x32_bf16 v[28:31], v[112:115], v[148:151], v[28:31]
ds_read_b64_tr_b16 v[236:237], v16 offset:40960
buffer_load_dwordx4 v[200:203], v13, s[32:35], s57 offen sc1
v_mfma_f32_16x16x32_bf16 v[44:47], v[112:115], v[152:155], v[44:47]
ds_read_b64_tr_b16 v[238:239], v16 offset:41472
v_mfma_f32_16x16x32_bf16 v[32:35], v[116:119], v[148:151], v[32:35]
ds_read_b64_tr_b16 v[240:241], v17 offset:40960
v_mfma_f32_16x16x32_bf16 v[48:51], v[116:119], v[152:155], v[48:51]
ds_read_b64_tr_b16 v[242:243], v17 offset:41472
s_waitcnt vmcnt(10) lgkmcnt(8)
v_mfma_f32_16x16x32_bf16 v[20:23], v[212:215], v[156:159], v[20:23]
ds_read_b64_tr_b16 v[104:105], v14 offset:45056
ds_read_b64_tr_b16 v[106:107], v14 offset:45568
v_mfma_f32_16x16x32_bf16 v[36:39], v[212:215], v[160:163], v[36:39]
buffer_load_dwordx4 v[204:207], v12, s[32:35], s57 offen offset:1024 sc1
v_mfma_f32_16x16x32_bf16 v[24:27], v[216:219], v[156:159], v[24:27]
ds_read_b64_tr_b16 v[108:109], v15 offset:45056
v_mfma_f32_16x16x32_bf16 v[40:43], v[216:219], v[160:163], v[40:43]
ds_read_b64_tr_b16 v[110:111], v15 offset:45568
v_mfma_f32_16x16x32_bf16 v[28:31], v[220:223], v[156:159], v[28:31]
ds_read_b64_tr_b16 v[112:113], v16 offset:45056
buffer_load_dwordx4 v[208:211], v13, s[32:35], s57 offen offset:1024 sc1
s_add_u32 s57, s57, 2048
s_and_b32 s57, s57, 0x7fff
v_mfma_f32_16x16x32_bf16 v[44:47], v[220:223], v[160:163], v[44:47]
ds_read_b64_tr_b16 v[114:115], v16 offset:45568
v_mfma_f32_16x16x32_bf16 v[32:35], v[224:227], v[156:159], v[32:35]
ds_read_b64_tr_b16 v[116:117], v17 offset:45056
v_mfma_f32_16x16x32_bf16 v[48:51], v[224:227], v[160:163], v[48:51]
ds_read_b64_tr_b16 v[118:119], v17 offset:45568
s_waitcnt vmcnt(10) lgkmcnt(8)
v_mfma_f32_16x16x32_bf16 v[20:23], v[228:231], v[164:167], v[20:23]
ds_read_b64_tr_b16 v[212:213], v14 offset:49152
ds_read_b64_tr_b16 v[214:215], v14 offset:49664
v_mfma_f32_16x16x32_bf16 v[36:39], v[228:231], v[168:171], v[36:39]
buffer_load_dwordx4 v[148:151], v12, s[32:35], s57 offen sc1
v_mfma_f32_16x16x32_bf16 v[24:27], v[232:235], v[164:167], v[24:27]
ds_read_b64_tr_b16 v[216:217], v15 offset:49152
v_mfma_f32_16x16x32_bf16 v[40:43], v[232:235], v[168:171], v[40:43]
ds_read_b64_tr_b16 v[218:219], v15 offset:49664
v_mfma_f32_16x16x32_bf16 v[28:31], v[236:239], v[164:167], v[28:31]
ds_read_b64_tr_b16 v[220:221], v16 offset:49152
buffer_load_dwordx4 v[152:155], v13, s[32:35], s57 offen sc1
v_mfma_f32_16x16x32_bf16 v[44:47], v[236:239], v[168:171], v[44:47]
ds_read_b64_tr_b16 v[222:223], v16 offset:49664
v_mfma_f32_16x16x32_bf16 v[32:35], v[240:243], v[164:167], v[32:35]
ds_read_b64_tr_b16 v[224:225], v17 offset:49152
v_mfma_f32_16x16x32_bf16 v[48:51], v[240:243], v[168:171], v[48:51]
ds_read_b64_tr_b16 v[226:227], v17 offset:49664
s_waitcnt vmcnt(10) lgkmcnt(8)
v_mfma_f32_16x16x32_bf16 v[20:23], v[104:107], v[172:175], v[20:23]
ds_read_b64_tr_b16 v[228:229], v14 offset:53248
ds_read_b64_tr_b16 v[230:231], v14 offset:53760
v_mfma_f32_16x16x32_bf16 v[36:39], v[104:107], v[176:179], v[36:39]
buffer_load_dwordx4 v[156:159], v12, s[32:35], s57 offen offset:1024 sc1
v_mfma_f32_16x16x32_bf16 v[24:27], v[108:111], v[172:175], v[24:27]
ds_read_b64_tr_b16 v[232:233], v15 offset:53248
v_mfma_f32_16x16x32_bf16 v[40:43], v[108:111], v[176:179], v[40:43]
ds_read_b64_tr_b16 v[234:235], v15 offset:53760
v_mfma_f32_16x16x32_bf16 v[28:31], v[112:115], v[172:175], v[28:31]
ds_read_b64_tr_b16 v[236:237], v16 offset:53248
buffer_load_dwordx4 v[160:163], v13, s[32:35], s57 offen offset:1024 sc1
s_add_u32 s57, s57, 2048
s_and_b32 s57, s57, 0x7fff
v_mfma_f32_16x16x32_bf16 v[44:47], v[112:115], v[176:179], v[44:47]
ds_read_b64_tr_b16 v[238:239], v16 offset:53760
v_mfma_f32_16x16x32_bf16 v[32:35], v[116:119], v[172:175], v[32:35]
ds_read_b64_tr_b16 v[240:241], v17 offset:53248
v_mfma_f32_16x16x32_bf16 v[48:51], v[116:119], v[176:179], v[48:51]
ds_read_b64_tr_b16 v[242:243], v17 offset:53760
s_waitcnt vmcnt(10) lgkmcnt(8)
v_mfma_f32_16x16x32_bf16 v[20:23], v[212:215], v[180:183], v[20:23]
ds_read_b64_tr_b16 v[104:105], v14 offset:57344
ds_read_b64_tr_b16 v[106:107], v14 offset:57856
v_mfma_f32_16x16x32_bf16 v[36:39], v[212:215], v[184:187], v[36:39]
buffer_load_dwordx4 v[164:167], v12, s[32:35], s57 offen sc1
v_mfma_f32_16x16x32_bf16 v[24:27], v[216:219], v[180:183], v[24:27]
ds_read_b64_tr_b16 v[108:109], v15 offset:57344
v_mfma_f32_16x16x32_bf16 v[40:43], v[216:219], v[184:187], v[40:43]
ds_read_b64_tr_b16 v[110:111], v15 offset:57856
v_mfma_f32_16x16x32_bf16 v[28:31], v[220:223], v[180:183], v[28:31]
ds_read_b64_tr_b16 v[112:113], v16 offset:57344
buffer_load_dwordx4 v[168:171], v13, s[32:35], s57 offen sc1
v_mfma_f32_16x16x32_bf16 v[44:47], v[220:223], v[184:187], v[44:47]
ds_read_b64_tr_b16 v[114:115], v16 offset:57856
v_mfma_f32_16x16x32_bf16 v[32:35], v[224:227], v[180:183], v[32:35]
ds_read_b64_tr_b16 v[116:117], v17 offset:57344
v_mfma_f32_16x16x32_bf16 v[48:51], v[224:227], v[184:187], v[48:51]
ds_read_b64_tr_b16 v[118:119], v17 offset:57856
s_waitcnt vmcnt(10) lgkmcnt(8)
v_mfma_f32_16x16x32_bf16 v[20:23], v[228:231], v[188:191], v[20:23]
ds_read_b64_tr_b16 v[212:213], v14 offset:61440
ds_read_b64_tr_b16 v[214:215], v14 offset:61952
v_mfma_f32_16x16x32_bf16 v[36:39], v[228:231], v[192:195], v[36:39]
buffer_load_dwordx4 v[172:175], v12, s[32:35], s57 offen offset:1024 sc1
v_mfma_f32_16x16x32_bf16 v[24:27], v[232:235], v[188:191], v[24:27]
ds_read_b64_tr_b16 v[216:217], v15 offset:61440
v_mfma_f32_16x16x32_bf16 v[40:43], v[232:235], v[192:195], v[40:43]
ds_read_b64_tr_b16 v[218:219], v15 offset:61952
v_mfma_f32_16x16x32_bf16 v[28:31], v[236:239], v[188:191], v[28:31]
ds_read_b64_tr_b16 v[220:221], v16 offset:61440
buffer_load_dwordx4 v[176:179], v13, s[32:35], s57 offen offset:1024 sc1
s_add_u32 s57, s57, 2048
s_and_b32 s57, s57, 0x7fff
v_mfma_f32_16x16x32_bf16 v[44:47], v[236:239], v[192:195], v[44:47]
ds_read_b64_tr_b16 v[222:223], v16 offset:61952
v_mfma_f32_16x16x32_bf16 v[32:35], v[240:243], v[188:191], v[32:35]
ds_read_b64_tr_b16 v[224:225], v17 offset:61440
v_mfma_f32_16x16x32_bf16 v[48:51], v[240:243], v[192:195], v[48:51]
ds_read_b64_tr_b16 v[226:227], v17 offset:61952
s_waitcnt vmcnt(10) lgkmcnt(8)
v_mfma_f32_16x16x32_bf16 v[20:23], v[104:107], v[196:199], v[20:23]
ds_read_b64_tr_b16 v[228:229], v52 offset:0
ds_read_b64_tr_b16 v[230:231], v52 offset:512
v_mfma_f32_16x16x32_bf16 v[36:39], v[104:107], v[200:203], v[36:39]
buffer_load_dwordx4 v[180:183], v12, s[32:35], s57 offen sc1
v_mfma_f32_16x16x32_bf16 v[24:27], v[108:111], v[196:199], v[24:27]
ds_read_b64_tr_b16 v[232:233], v53 offset:0
v_mfma_f32_16x16x32_bf16 v[40:43], v[108:111], v[200:203], v[40:43]
ds_read_b64_tr_b16 v[234:235], v53 offset:512
v_mfma_f32_16x16x32_bf16 v[28:31], v[112:115], v[196:199], v[28:31]
ds_read_b64_tr_b16 v[236:237], v54 offset:0
buffer_load_dwordx4 v[184:187], v13, s[32:35], s57 offen sc1
v_mfma_f32_16x16x32_bf16 v[44:47], v[112:115], v[200:203], v[44:47]
ds_read_b64_tr_b16 v[238:239], v54 offset:512
v_mfma_f32_16x16x32_bf16 v[32:35], v[116:119], v[196:199], v[32:35]
ds_read_b64_tr_b16 v[240:241], v55 offset:0
v_mfma_f32_16x16x32_bf16 v[48:51], v[116:119], v[200:203], v[48:51]
ds_read_b64_tr_b16 v[242:243], v55 offset:512
s_waitcnt vmcnt(10) lgkmcnt(8)
v_mfma_f32_16x16x32_bf16 v[20:23], v[212:215], v[204:207], v[20:23]
ds_read_b64_tr_b16 v[104:105], v52 offset:4096
ds_read_b64_tr_b16 v[106:107], v52 offset:4608
v_mfma_f32_16x16x32_bf16 v[36:39], v[212:215], v[208:211], v[36:39]
buffer_load_dwordx4 v[188:191], v12, s[32:35], s57 offen offset:1024 sc1
v_mfma_f32_16x16x32_bf16 v[24:27], v[216:219], v[204:207], v[24:27]
ds_read_b64_tr_b16 v[108:109], v53 offset:4096
v_mfma_f32_16x16x32_bf16 v[40:43], v[216:219], v[208:211], v[40:43]
ds_read_b64_tr_b16 v[110:111], v53 offset:4608
v_mfma_f32_16x16x32_bf16 v[28:31], v[220:223], v[204:207], v[28:31]
ds_read_b64_tr_b16 v[112:113], v54 offset:4096
buffer_load_dwordx4 v[192:195], v13, s[32:35], s57 offen offset:1024 sc1
s_add_u32 s57, s57, 2048
s_and_b32 s57, s57, 0x7fff
v_mfma_f32_16x16x32_bf16 v[44:47], v[220:223], v[208:211], v[44:47]
ds_read_b64_tr_b16 v[114:115], v54 offset:4608
v_mfma_f32_16x16x32_bf16 v[32:35], v[224:227], v[204:207], v[32:35]
ds_read_b64_tr_b16 v[116:117], v55 offset:4096
v_mfma_f32_16x16x32_bf16 v[48:51], v[224:227], v[208:211], v[48:51]
ds_read_b64_tr_b16 v[118:119], v55 offset:4608
s_waitcnt vmcnt(10) lgkmcnt(8)
v_mfma_f32_16x16x32_bf16 v[20:23], v[228:231], v[148:151], v[20:23]
ds_read_b64_tr_b16 v[212:213], v52 offset:8192
ds_read_b64_tr_b16 v[214:215], v52 offset:8704
v_mfma_f32_16x16x32_bf16 v[36:39], v[228:231], v[152:155], v[36:39]
buffer_load_dwordx4 v[196:199], v12, s[32:35], s57 offen sc1
v_mfma_f32_16x16x32_bf16 v[24:27], v[232:235], v[148:151], v[24:27]
ds_read_b64_tr_b16 v[216:217], v53 offset:8192
v_mfma_f32_16x16x32_bf16 v[40:43], v[232:235], v[152:155], v[40:43]
ds_read_b64_tr_b16 v[218:219], v53 offset:8704
v_mfma_f32_16x16x32_bf16 v[28:31], v[236:239], v[148:151], v[28:31]
ds_read_b64_tr_b16 v[220:221], v54 offset:8192
buffer_load_dwordx4 v[200:203], v13, s[32:35], s57 offen sc1
v_mfma_f32_16x16x32_bf16 v[44:47], v[236:239], v[152:155], v[44:47]
ds_read_b64_tr_b16 v[222:223], v54 offset:8704
v_mfma_f32_16x16x32_bf16 v[32:35], v[240:243], v[148:151], v[32:35]
ds_read_b64_tr_b16 v[224:225], v55 offset:8192
v_mfma_f32_16x16x32_bf16 v[48:51], v[240:243], v[152:155], v[48:51]
ds_read_b64_tr_b16 v[226:227], v55 offset:8704
s_waitcnt vmcnt(10) lgkmcnt(8)
v_mfma_f32_16x16x32_bf16 v[20:23], v[104:107], v[156:159], v[20:23]
ds_read_b64_tr_b16 v[228:229], v52 offset:12288
ds_read_b64_tr_b16 v[230:231], v52 offset:12800
v_mfma_f32_16x16x32_bf16 v[36:39], v[104:107], v[160:163], v[36:39]
buffer_load_dwordx4 v[204:207], v12, s[32:35], s57 offen offset:1024 sc1
v_mfma_f32_16x16x32_bf16 v[24:27], v[108:111], v[156:159], v[24:27]
ds_read_b64_tr_b16 v[232:233], v53 offset:12288
v_mfma_f32_16x16x32_bf16 v[40:43], v[108:111], v[160:163], v[40:43]
ds_read_b64_tr_b16 v[234:235], v53 offset:12800
v_mfma_f32_16x16x32_bf16 v[28:31], v[112:115], v[156:159], v[28:31]
ds_read_b64_tr_b16 v[236:237], v54 offset:12288
buffer_load_dwordx4 v[208:211], v13, s[32:35], s57 offen offset:1024 sc1
s_add_u32 s57, s57, 2048
s_and_b32 s57, s57, 0x7fff
v_mfma_f32_16x16x32_bf16 v[44:47], v[112:115], v[160:163], v[44:47]
ds_read_b64_tr_b16 v[238:239], v54 offset:12800
v_mfma_f32_16x16x32_bf16 v[32:35], v[116:119], v[156:159], v[32:35]
ds_read_b64_tr_b16 v[240:241], v55 offset:12288
v_mfma_f32_16x16x32_bf16 v[48:51], v[116:119], v[160:163], v[48:51]
ds_read_b64_tr_b16 v[242:243], v55 offset:12800
s_waitcnt vmcnt(10) lgkmcnt(8)
v_mfma_f32_16x16x32_bf16 v[20:23], v[212:215], v[164:167], v[20:23]
ds_read_b64_tr_b16 v[104:105], v52 offset:16384
ds_read_b64_tr_b16 v[106:107], v52 offset:16896
v_mfma_f32_16x16x32_bf16 v[36:39], v[212:215], v[168:171], v[36:39]
buffer_load_dwordx4 v[148:151], v12, s[32:35], s57 offen sc1
v_mfma_f32_16x16x32_bf16 v[24:27], v[216:219], v[164:167], v[24:27]
ds_read_b64_tr_b16 v[108:109], v53 offset:16384
v_mfma_f32_16x16x32_bf16 v[40:43], v[216:219], v[168:171], v[40:43]
ds_read_b64_tr_b16 v[110:111], v53 offset:16896
v_mfma_f32_16x16x32_bf16 v[28:31], v[220:223], v[164:167], v[28:31]
ds_read_b64_tr_b16 v[112:113], v54 offset:16384
buffer_load_dwordx4 v[152:155], v13, s[32:35], s57 offen sc1
v_mfma_f32_16x16x32_bf16 v[44:47], v[220:223], v[168:171], v[44:47]
ds_read_b64_tr_b16 v[114:115], v54 offset:16896
v_mfma_f32_16x16x32_bf16 v[32:35], v[224:227], v[164:167], v[32:35]
ds_read_b64_tr_b16 v[116:117], v55 offset:16384
v_mfma_f32_16x16x32_bf16 v[48:51], v[224:227], v[168:171], v[48:51]
ds_read_b64_tr_b16 v[118:119], v55 offset:16896
s_waitcnt vmcnt(10) lgkmcnt(8)
v_mfma_f32_16x16x32_bf16 v[20:23], v[228:231], v[172:175], v[20:23]
ds_read_b64_tr_b16 v[212:213], v52 offset:20480
ds_read_b64_tr_b16 v[214:215], v52 offset:20992
v_mfma_f32_16x16x32_bf16 v[36:39], v[228:231], v[176:179], v[36:39]
buffer_load_dwordx4 v[156:159], v12, s[32:35], s57 offen offset:1024 sc1
v_mfma_f32_16x16x32_bf16 v[24:27], v[232:235], v[172:175], v[24:27]
ds_read_b64_tr_b16 v[216:217], v53 offset:20480
v_mfma_f32_16x16x32_bf16 v[40:43], v[232:235], v[176:179], v[40:43]
ds_read_b64_tr_b16 v[218:219], v53 offset:20992
v_mfma_f32_16x16x32_bf16 v[28:31], v[236:239], v[172:175], v[28:31]
ds_read_b64_tr_b16 v[220:221], v54 offset:20480
buffer_load_dwordx4 v[160:163], v13, s[32:35], s57 offen offset:1024 sc1
s_add_u32 s57, s57, 2048
s_and_b32 s57, s57, 0x7fff
v_mfma_f32_16x16x32_bf16 v[44:47], v[236:239], v[176:179], v[44:47]
ds_read_b64_tr_b16 v[222:223], v54 offset:20992
v_mfma_f32_16x16x32_bf16 v[32:35], v[240:243], v[172:175], v[32:35]
ds_read_b64_tr_b16 v[224:225], v55 offset:20480
v_mfma_f32_16x16x32_bf16 v[48:51], v[240:243], v[176:179], v[48:51]
ds_read_b64_tr_b16 v[226:227], v55 offset:20992
s_waitcnt vmcnt(10) lgkmcnt(8)
v_mfma_f32_16x16x32_bf16 v[20:23], v[104:107], v[180:183], v[20:23]
ds_read_b64_tr_b16 v[228:229], v52 offset:24576
ds_read_b64_tr_b16 v[230:231], v52 offset:25088
v_mfma_f32_16x16x32_bf16 v[36:39], v[104:107], v[184:187], v[36:39]
buffer_load_dwordx4 v[164:167], v12, s[32:35], s57 offen sc1
v_mfma_f32_16x16x32_bf16 v[24:27], v[108:111], v[180:183], v[24:27]
ds_read_b64_tr_b16 v[232:233], v53 offset:24576
v_mfma_f32_16x16x32_bf16 v[40:43], v[108:111], v[184:187], v[40:43]
ds_read_b64_tr_b16 v[234:235], v53 offset:25088
v_mfma_f32_16x16x32_bf16 v[28:31], v[112:115], v[180:183], v[28:31]
ds_read_b64_tr_b16 v[236:237], v54 offset:24576
buffer_load_dwordx4 v[168:171], v13, s[32:35], s57 offen sc1
v_mfma_f32_16x16x32_bf16 v[44:47], v[112:115], v[184:187], v[44:47]
ds_read_b64_tr_b16 v[238:239], v54 offset:25088
v_mfma_f32_16x16x32_bf16 v[32:35], v[116:119], v[180:183], v[32:35]
ds_read_b64_tr_b16 v[240:241], v55 offset:24576
v_mfma_f32_16x16x32_bf16 v[48:51], v[116:119], v[184:187], v[48:51]
ds_read_b64_tr_b16 v[242:243], v55 offset:25088
s_waitcnt vmcnt(10) lgkmcnt(8)
v_mfma_f32_16x16x32_bf16 v[20:23], v[212:215], v[188:191], v[20:23]
ds_read_b64_tr_b16 v[104:105], v52 offset:28672
ds_read_b64_tr_b16 v[106:107], v52 offset:29184
v_mfma_f32_16x16x32_bf16 v[36:39], v[212:215], v[192:195], v[36:39]
buffer_load_dwordx4 v[172:175], v12, s[32:35], s57 offen offset:1024 sc1
v_mfma_f32_16x16x32_bf16 v[24:27], v[216:219], v[188:191], v[24:27]
ds_read_b64_tr_b16 v[108:109], v53 offset:28672
v_mfma_f32_16x16x32_bf16 v[40:43], v[216:219], v[192:195], v[40:43]
ds_read_b64_tr_b16 v[110:111], v53 offset:29184
v_mfma_f32_16x16x32_bf16 v[28:31], v[220:223], v[188:191], v[28:31]
ds_read_b64_tr_b16 v[112:113], v54 offset:28672
buffer_load_dwordx4 v[176:179], v13, s[32:35], s57 offen offset:1024 sc1
s_add_u32 s57, s57, 2048
s_and_b32 s57, s57, 0x7fff
v_mfma_f32_16x16x32_bf16 v[44:47], v[220:223], v[192:195], v[44:47]
ds_read_b64_tr_b16 v[114:115], v54 offset:29184
v_mfma_f32_16x16x32_bf16 v[32:35], v[224:227], v[188:191], v[32:35]
ds_read_b64_tr_b16 v[116:117], v55 offset:28672
v_mfma_f32_16x16x32_bf16 v[48:51], v[224:227], v[192:195], v[48:51]
ds_read_b64_tr_b16 v[118:119], v55 offset:29184
s_waitcnt vmcnt(10) lgkmcnt(8)
v_mfma_f32_16x16x32_bf16 v[20:23], v[228:231], v[196:199], v[20:23]
ds_read_b64_tr_b16 v[212:213], v52 offset:32768
ds_read_b64_tr_b16 v[214:215], v52 offset:33280
v_mfma_f32_16x16x32_bf16 v[36:39], v[228:231], v[200:203], v[36:39]
buffer_load_dwordx4 v[180:183], v12, s[32:35], s57 offen sc1
v_mfma_f32_16x16x32_bf16 v[24:27], v[232:235], v[196:199], v[24:27]
ds_read_b64_tr_b16 v[216:217], v53 offset:32768
v_mfma_f32_16x16x32_bf16 v[40:43], v[232:235], v[200:203], v[40:43]
ds_read_b64_tr_b16 v[218:219], v53 offset:33280
v_mfma_f32_16x16x32_bf16 v[28:31], v[236:239], v[196:199], v[28:31]
ds_read_b64_tr_b16 v[220:221], v54 offset:32768
buffer_load_dwordx4 v[184:187], v13, s[32:35], s57 offen sc1
v_mfma_f32_16x16x32_bf16 v[44:47], v[236:239], v[200:203], v[44:47]
ds_read_b64_tr_b16 v[222:223], v54 offset:33280
v_mfma_f32_16x16x32_bf16 v[32:35], v[240:243], v[196:199], v[32:35]
ds_read_b64_tr_b16 v[224:225], v55 offset:32768
v_mfma_f32_16x16x32_bf16 v[48:51], v[240:243], v[200:203], v[48:51]
ds_read_b64_tr_b16 v[226:227], v55 offset:33280
s_waitcnt vmcnt(10) lgkmcnt(8)
v_mfma_f32_16x16x32_bf16 v[20:23], v[104:107], v[204:207], v[20:23]
ds_read_b64_tr_b16 v[228:229], v52 offset:36864
ds_read_b64_tr_b16 v[230:231], v52 offset:37376
v_mfma_f32_16x16x32_bf16 v[36:39], v[104:107], v[208:211], v[36:39]
buffer_load_dwordx4 v[188:191], v12, s[32:35], s57 offen offset:1024 sc1
v_mfma_f32_16x16x32_bf16 v[24:27], v[108:111], v[204:207], v[24:27]
ds_read_b64_tr_b16 v[232:233], v53 offset:36864
v_mfma_f32_16x16x32_bf16 v[40:43], v[108:111], v[208:211], v[40:43]
ds_read_b64_tr_b16 v[234:235], v53 offset:37376
v_mfma_f32_16x16x32_bf16 v[28:31], v[112:115], v[204:207], v[28:31]
ds_read_b64_tr_b16 v[236:237], v54 offset:36864
buffer_load_dwordx4 v[192:195], v13, s[32:35], s57 offen offset:1024 sc1
s_add_u32 s57, s57, 2048
s_and_b32 s57, s57, 0x7fff
v_mfma_f32_16x16x32_bf16 v[44:47], v[112:115], v[208:211], v[44:47]
ds_read_b64_tr_b16 v[238:239], v54 offset:37376
v_mfma_f32_16x16x32_bf16 v[32:35], v[116:119], v[204:207], v[32:35]
ds_read_b64_tr_b16 v[240:241], v55 offset:36864
v_mfma_f32_16x16x32_bf16 v[48:51], v[116:119], v[208:211], v[48:51]
ds_read_b64_tr_b16 v[242:243], v55 offset:37376
s_waitcnt vmcnt(10) lgkmcnt(8)
v_mfma_f32_16x16x32_bf16 v[20:23], v[212:215], v[148:151], v[20:23]
ds_read_b64_tr_b16 v[104:105], v52 offset:40960
ds_read_b64_tr_b16 v[106:107], v52 offset:41472
v_mfma_f32_16x16x32_bf16 v[36:39], v[212:215], v[152:155], v[36:39]
buffer_load_dwordx4 v[196:199], v12, s[32:35], s57 offen sc1
v_mfma_f32_16x16x32_bf16 v[24:27], v[216:219], v[148:151], v[24:27]
ds_read_b64_tr_b16 v[108:109], v53 offset:40960
v_mfma_f32_16x16x32_bf16 v[40:43], v[216:219], v[152:155], v[40:43]
ds_read_b64_tr_b16 v[110:111], v53 offset:41472
v_mfma_f32_16x16x32_bf16 v[28:31], v[220:223], v[148:151], v[28:31]
ds_read_b64_tr_b16 v[112:113], v54 offset:40960
buffer_load_dwordx4 v[200:203], v13, s[32:35], s57 offen sc1
v_mfma_f32_16x16x32_bf16 v[44:47], v[220:223], v[152:155], v[44:47]
ds_read_b64_tr_b16 v[114:115], v54 offset:41472
v_mfma_f32_16x16x32_bf16 v[32:35], v[224:227], v[148:151], v[32:35]
ds_read_b64_tr_b16 v[116:117], v55 offset:40960
v_mfma_f32_16x16x32_bf16 v[48:51], v[224:227], v[152:155], v[48:51]
ds_read_b64_tr_b16 v[118:119], v55 offset:41472
s_waitcnt vmcnt(10) lgkmcnt(8)
v_mfma_f32_16x16x32_bf16 v[20:23], v[228:231], v[156:159], v[20:23]
ds_read_b64_tr_b16 v[212:213], v52 offset:45056
ds_read_b64_tr_b16 v[214:215], v52 offset:45568
v_mfma_f32_16x16x32_bf16 v[36:39], v[228:231], v[160:163], v[36:39]
buffer_load_dwordx4 v[204:207], v12, s[32:35], s57 offen offset:1024 sc1
v_mfma_f32_16x16x32_bf16 v[24:27], v[232:235], v[156:159], v[24:27]
ds_read_b64_tr_b16 v[216:217], v53 offset:45056
v_mfma_f32_16x16x32_bf16 v[40:43], v[232:235], v[160:163], v[40:43]
ds_read_b64_tr_b16 v[218:219], v53 offset:45568
v_mfma_f32_16x16x32_bf16 v[28:31], v[236:239], v[156:159], v[28:31]
ds_read_b64_tr_b16 v[220:221], v54 offset:45056
buffer_load_dwordx4 v[208:211], v13, s[32:35], s57 offen offset:1024 sc1
s_add_u32 s57, s57, 2048
s_and_b32 s57, s57, 0x7fff
v_mfma_f32_16x16x32_bf16 v[44:47], v[236:239], v[160:163], v[44:47]
ds_read_b64_tr_b16 v[222:223], v54 offset:45568
v_mfma_f32_16x16x32_bf16 v[32:35], v[240:243], v[156:159], v[32:35]
ds_read_b64_tr_b16 v[224:225], v55 offset:45056
v_mfma_f32_16x16x32_bf16 v[48:51], v[240:243], v[160:163], v[48:51]
ds_read_b64_tr_b16 v[226:227], v55 offset:45568
s_waitcnt vmcnt(10) lgkmcnt(8)
v_mfma_f32_16x16x32_bf16 v[20:23], v[104:107], v[164:167], v[20:23]
ds_read_b64_tr_b16 v[228:229], v52 offset:49152
v_mfma_f32_16x16x32_bf16 v[36:39], v[104:107], v[168:171], v[36:39]
ds_read_b64_tr_b16 v[230:231], v52 offset:49664
v_mfma_f32_16x16x32_bf16 v[24:27], v[108:111], v[164:167], v[24:27]
ds_read_b64_tr_b16 v[232:233], v53 offset:49152
v_mfma_f32_16x16x32_bf16 v[40:43], v[108:111], v[168:171], v[40:43]
ds_read_b64_tr_b16 v[234:235], v53 offset:49664
v_mfma_f32_16x16x32_bf16 v[28:31], v[112:115], v[164:167], v[28:31]
ds_read_b64_tr_b16 v[236:237], v54 offset:49152
v_mfma_f32_16x16x32_bf16 v[44:47], v[112:115], v[168:171], v[44:47]
ds_read_b64_tr_b16 v[238:239], v54 offset:49664
v_mfma_f32_16x16x32_bf16 v[32:35], v[116:119], v[164:167], v[32:35]
ds_read_b64_tr_b16 v[240:241], v55 offset:49152
v_mfma_f32_16x16x32_bf16 v[48:51], v[116:119], v[168:171], v[48:51]
ds_read_b64_tr_b16 v[242:243], v55 offset:49664
s_waitcnt vmcnt(8) lgkmcnt(8)
v_mfma_f32_16x16x32_bf16 v[20:23], v[212:215], v[172:175], v[20:23]
ds_read_b64_tr_b16 v[104:105], v52 offset:53248
v_mfma_f32_16x16x32_bf16 v[36:39], v[212:215], v[176:179], v[36:39]
ds_read_b64_tr_b16 v[106:107], v52 offset:53760
v_mfma_f32_16x16x32_bf16 v[24:27], v[216:219], v[172:175], v[24:27]
ds_read_b64_tr_b16 v[108:109], v53 offset:53248
v_mfma_f32_16x16x32_bf16 v[40:43], v[216:219], v[176:179], v[40:43]
ds_read_b64_tr_b16 v[110:111], v53 offset:53760
v_mfma_f32_16x16x32_bf16 v[28:31], v[220:223], v[172:175], v[28:31]
ds_read_b64_tr_b16 v[112:113], v54 offset:53248
v_mfma_f32_16x16x32_bf16 v[44:47], v[220:223], v[176:179], v[44:47]
ds_read_b64_tr_b16 v[114:115], v54 offset:53760
v_mfma_f32_16x16x32_bf16 v[32:35], v[224:227], v[172:175], v[32:35]
ds_read_b64_tr_b16 v[116:117], v55 offset:53248
v_mfma_f32_16x16x32_bf16 v[48:51], v[224:227], v[176:179], v[48:51]
ds_read_b64_tr_b16 v[118:119], v55 offset:53760
s_waitcnt vmcnt(6) lgkmcnt(8)
v_mfma_f32_16x16x32_bf16 v[20:23], v[228:231], v[180:183], v[20:23]
ds_read_b64_tr_b16 v[212:213], v52 offset:57344
v_mfma_f32_16x16x32_bf16 v[36:39], v[228:231], v[184:187], v[36:39]
ds_read_b64_tr_b16 v[214:215], v52 offset:57856
v_mfma_f32_16x16x32_bf16 v[24:27], v[232:235], v[180:183], v[24:27]
ds_read_b64_tr_b16 v[216:217], v53 offset:57344
v_mfma_f32_16x16x32_bf16 v[40:43], v[232:235], v[184:187], v[40:43]
ds_read_b64_tr_b16 v[218:219], v53 offset:57856
v_mfma_f32_16x16x32_bf16 v[28:31], v[236:239], v[180:183], v[28:31]
ds_read_b64_tr_b16 v[220:221], v54 offset:57344
v_mfma_f32_16x16x32_bf16 v[44:47], v[236:239], v[184:187], v[44:47]
ds_read_b64_tr_b16 v[222:223], v54 offset:57856
v_mfma_f32_16x16x32_bf16 v[32:35], v[240:243], v[180:183], v[32:35]
ds_read_b64_tr_b16 v[224:225], v55 offset:57344
v_mfma_f32_16x16x32_bf16 v[48:51], v[240:243], v[184:187], v[48:51]
ds_read_b64_tr_b16 v[226:227], v55 offset:57856
s_waitcnt vmcnt(4) lgkmcnt(8)
v_mfma_f32_16x16x32_bf16 v[20:23], v[104:107], v[188:191], v[20:23]
ds_read_b64_tr_b16 v[228:229], v52 offset:61440
v_mfma_f32_16x16x32_bf16 v[36:39], v[104:107], v[192:195], v[36:39]
ds_read_b64_tr_b16 v[230:231], v52 offset:61952
v_mfma_f32_16x16x32_bf16 v[24:27], v[108:111], v[188:191], v[24:27]
ds_read_b64_tr_b16 v[232:233], v53 offset:61440
v_mfma_f32_16x16x32_bf16 v[40:43], v[108:111], v[192:195], v[40:43]
ds_read_b64_tr_b16 v[234:235], v53 offset:61952
v_mfma_f32_16x16x32_bf16 v[28:31], v[112:115], v[188:191], v[28:31]
ds_read_b64_tr_b16 v[236:237], v54 offset:61440
v_mfma_f32_16x16x32_bf16 v[44:47], v[112:115], v[192:195], v[44:47]
ds_read_b64_tr_b16 v[238:239], v54 offset:61952
v_mfma_f32_16x16x32_bf16 v[32:35], v[116:119], v[188:191], v[32:35]
ds_read_b64_tr_b16 v[240:241], v55 offset:61440
v_mfma_f32_16x16x32_bf16 v[48:51], v[116:119], v[192:195], v[48:51]
ds_read_b64_tr_b16 v[242:243], v55 offset:61952
s_waitcnt vmcnt(2) lgkmcnt(8)
v_mfma_f32_16x16x32_bf16 v[20:23], v[212:215], v[196:199], v[20:23]
v_mfma_f32_16x16x32_bf16 v[36:39], v[212:215], v[200:203], v[36:39]
v_mfma_f32_16x16x32_bf16 v[24:27], v[216:219], v[196:199], v[24:27]
v_mfma_f32_16x16x32_bf16 v[40:43], v[216:219], v[200:203], v[40:43]
v_mfma_f32_16x16x32_bf16 v[28:31], v[220:223], v[196:199], v[28:31]
v_mfma_f32_16x16x32_bf16 v[44:47], v[220:223], v[200:203], v[44:47]
v_mfma_f32_16x16x32_bf16 v[32:35], v[224:227], v[196:199], v[32:35]
v_mfma_f32_16x16x32_bf16 v[48:51], v[224:227], v[200:203], v[48:51]
s_waitcnt vmcnt(0) lgkmcnt(0)
v_mfma_f32_16x16x32_bf16 v[20:23], v[228:231], v[204:207], v[20:23]
v_mfma_f32_16x16x32_bf16 v[24:27], v[232:235], v[204:207], v[24:27]
v_mfma_f32_16x16x32_bf16 v[28:31], v[236:239], v[204:207], v[28:31]
v_mfma_f32_16x16x32_bf16 v[32:35], v[240:243], v[204:207], v[32:35]
v_mfma_f32_16x16x32_bf16 v[36:39], v[228:231], v[208:211], v[36:39]
v_mfma_f32_16x16x32_bf16 v[40:43], v[232:235], v[208:211], v[40:43]
v_mfma_f32_16x16x32_bf16 v[44:47], v[236:239], v[208:211], v[44:47]
v_mfma_f32_16x16x32_bf16 v[48:51], v[240:243], v[208:211], v[48:51]
s_cmp_eq_u32 s46, 0
s_cbranch_scc1 slow_47
s_nop 0
v_cvt_pk_bf16_f32 v20, v20, v21
v_cvt_pk_bf16_f32 v21, v22, v23
v_cvt_pk_bf16_f32 v22, v24, v25
v_cvt_pk_bf16_f32 v23, v26, v27
buffer_store_dwordx4 v[20:23], v18, s[32:35], s85 offen offset:0
v_cvt_pk_bf16_f32 v28, v28, v29
v_cvt_pk_bf16_f32 v29, v30, v31
v_cvt_pk_bf16_f32 v30, v32, v33
v_cvt_pk_bf16_f32 v31, v34, v35
buffer_store_dwordx4 v[28:31], v18, s[32:35], s85 offen offset:1024
v_cvt_pk_bf16_f32 v36, v36, v37
v_cvt_pk_bf16_f32 v37, v38, v39
v_cvt_pk_bf16_f32 v38, v40, v41
v_cvt_pk_bf16_f32 v39, v42, v43
buffer_store_dwordx4 v[36:39], v18, s[32:35], s86 offen offset:0
v_cvt_pk_bf16_f32 v44, v44, v45
v_cvt_pk_bf16_f32 v45, v46, v47
v_cvt_pk_bf16_f32 v46, v48, v49
v_cvt_pk_bf16_f32 v47, v50, v51
buffer_store_dwordx4 v[44:47], v18, s[32:35], s86 offen offset:1024
s_barrier
v_dot2c_f32_bf16 v6, v20, v10
v_dot2c_f32_bf16 v8, v20, v20
v_dot2c_f32_bf16 v7, v36, v10
v_dot2c_f32_bf16 v9, v36, v36
v_dot2c_f32_bf16 v6, v21, v10
v_dot2c_f32_bf16 v8, v21, v21
v_dot2c_f32_bf16 v7, v37, v10
v_dot2c_f32_bf16 v9, v37, v37
v_dot2c_f32_bf16 v6, v22, v10
v_dot2c_f32_bf16 v8, v22, v22
v_dot2c_f32_bf16 v7, v38, v10
v_dot2c_f32_bf16 v9, v38, v38
v_dot2c_f32_bf16 v6, v23, v10
v_dot2c_f32_bf16 v8, v23, v23
v_dot2c_f32_bf16 v7, v39, v10
v_dot2c_f32_bf16 v9, v39, v39
v_dot2c_f32_bf16 v6, v28, v10
v_dot2c_f32_bf16 v8, v28, v28
v_dot2c_f32_bf16 v7, v44, v10
v_dot2c_f32_bf16 v9, v44, v44
v_dot2c_f32_bf16 v6, v29, v10
v_dot2c_f32_bf16 v8, v29, v29
v_dot2c_f32_bf16 v7, v45, v10
v_dot2c_f32_bf16 v9, v45, v45
v_dot2c_f32_bf16 v6, v30, v10
v_dot2c_f32_bf16 v8, v30, v30
v_dot2c_f32_bf16 v7, v46, v10
v_dot2c_f32_bf16 v9, v46, v46
v_dot2c_f32_bf16 v6, v31, v10
v_dot2c_f32_bf16 v8, v31, v31
v_dot2c_f32_bf16 v7, v47, v10
v_dot2c_f32_bf16 v9, v47, v47
s_nop 1
s_nop 1
v_permlane32_swap_b32 v6, v7
v_permlane32_swap_b32 v8, v9
s_nop 0
v_add_f32 v6, v6, v7
v_add_f32 v8, v8, v9
s_nop 1
v_permlane16_swap_b32 v6, v8
s_nop 0
v_add_f32 v6, v6, v8
s_waitcnt vmcnt(0)
s_mov_b64 exec, 1
buffer_store_dword v5, v4, s[32:35], s88 offen
s_mov_b64 exec, -1
buffer_store_dword v6, v1, s[32:35], s87 offen
back_48:
v_mov_b32 v10, v18
v_add_u32 v11, 1024, v18
s_lshl_b32 s48, s43, 1
v_lshrrev_b32 v4, 2, v2
v_and_b32 v5, 3, v0
v_lshl_add_u32 v6, v3, 3, v4
v_lshlrev_b32 v6, 7, v6
v_lshl_add_u32 v6, v5, 3, v6
v_lshrrev_b32 v7, 1, v4
v_and_b32 v8, 1, v3
v_lshl_add_u32 v7, v8, 1, v7
v_xor_b32 v7, s48, v7
v_lshl_add_u32 v12, v7, 5, v6
v_add_u32 v12, 18432, v12
v_xor_b32 v13, 32, v12
s_lshl_b32 s48, s44, 13
v_add_u32 v10, s48, v10
v_add_u32 v11, s48, v11
v_mov_b32 v14, v10
v_mov_b32 v15, v11
v_add_u32 v16, 120832, v12
v_add_u32 v17, 120832, v13
v_mov_b32 v148, 0
v_mov_b32 v149, 0
v_mov_b32 v150, 0
v_mov_b32 v151, 0
v_mov_b32 v152, 0
v_mov_b32 v153, 0
v_mov_b32 v154, 0
v_mov_b32 v155, 0
v_mov_b32 v156, 0
v_mov_b32 v157, 0
v_mov_b32 v158, 0
v_mov_b32 v159, 0
v_mov_b32 v160, 0
v_mov_b32 v161, 0
v_mov_b32 v162, 0
v_mov_b32 v163, 0
v_mov_b32 v164, 0
v_mov_b32 v165, 0
v_mov_b32 v166, 0
v_mov_b32 v167, 0
v_mov_b32 v168, 0
v_mov_b32 v169, 0
v_mov_b32 v170, 0
v_mov_b32 v171, 0
v_mov_b32 v172, 0
v_mov_b32 v173, 0
v_mov_b32 v174, 0
v_mov_b32 v175, 0
v_mov_b32 v176, 0
v_mov_b32 v177, 0
v_mov_b32 v178, 0
v_mov_b32 v179, 0
v_mov_b32 v180, 0
v_mov_b32 v181, 0
v_mov_b32 v182, 0
v_mov_b32 v183, 0
v_mov_b32 v184, 0
v_mov_b32 v185, 0
v_mov_b32 v186, 0
v_mov_b32 v187, 0
v_mov_b32 v188, 0
v_mov_b32 v189, 0
v_mov_b32 v190, 0
v_mov_b32 v191, 0
v_mov_b32 v192, 0
v_mov_b32 v193, 0
v_mov_b32 v194, 0
v_mov_b32 v195, 0
v_mov_b32 v196, 0
v_mov_b32 v197, 0
v_mov_b32 v198, 0
v_mov_b32 v199, 0
v_mov_b32 v200, 0
v_mov_b32 v201, 0
v_mov_b32 v202, 0
v_mov_b32 v203, 0
v_mov_b32 v204, 0
v_mov_b32 v205, 0
v_mov_b32 v206, 0
v_mov_b32 v207, 0
v_mov_b32 v208, 0
v_mov_b32 v209, 0
v_mov_b32 v210, 0
v_mov_b32 v211, 0
v_mov_b32 v212, 0
v_mov_b32 v213, 0
v_mov_b32 v214, 0
v_mov_b32 v215, 0
v_mov_b32 v216, 0
v_mov_b32 v217, 0
v_mov_b32 v218, 0
v_mov_b32 v219, 0
v_mov_b32 v220, 0
v_mov_b32 v221, 0
v_mov_b32 v222, 0
v_mov_b32 v223, 0
v_mov_b32 v224, 0
v_mov_b32 v225, 0
v_mov_b32 v226, 0
v_mov_b32 v227, 0
v_mov_b32 v228, 0
v_mov_b32 v229, 0
v_mov_b32 v230, 0
v_mov_b32 v231, 0
v_mov_b32 v232, 0
v_mov_b32 v233, 0
v_mov_b32 v234, 0
v_mov_b32 v235, 0
v_mov_b32 v236, 0
v_mov_b32 v237, 0
v_mov_b32 v238, 0
v_mov_b32 v239, 0
v_mov_b32 v240, 0
v_mov_b32 v241, 0
v_mov_b32 v242, 0
v_mov_b32 v243, 0
v_mov_b32 v56, 0x3f803f80
v_mov_b32 v57, 0x3f803f80
v_mov_b32 v58, 0x3f803f80
v_mov_b32 v59, 0x3f803f80
v_lshrrev_b32 v6, 2, v2
v_cmp_eq_u32 vcc, v6, v3
v_and_b32 v7, 1, v0
v_lshlrev_b32 v7, 4, v7
v_mov_b32 v8, 0x3f80
v_lshlrev_b32 v7, v7, v8
v_cndmask_b32 v7, 0, v7, vcc
v_and_b32 v6, 2, v0
v_cmp_eq_u32 vcc, 0, v6
v_mov_b32 v48, 0
v_mov_b32 v49, 0
v_mov_b32 v52, 0
v_mov_b32 v53, 0
v_cndmask_b32 v50, 0, v7, vcc
v_cndmask_b32 v51, v7, 0, vcc
v_lshrrev_b32 v4, 2, v2
v_lshl_add_u32 v4, v3, 2, v4
v_lshlrev_b32 v4, 6, v4
v_and_b32 v5, 3, v0
v_lshl_add_u32 v4, v5, 3, v4
s_lshl_b32 s48, s43, 11
s_add_u32 s48, s48, 135168
v_add_u32 v54, s48, v4
s_lshl_b32 s48, s43, 7
s_add_u32 s48, s48, 134144
v_lshl_add_u32 v7, v3, 4, s48
v_lshl_add_u32 v55, v2, 2, s48
s_lshl_b32 s49, s44, 6
v_add_u32 v8, s49, v2
v_lshlrev_b32 v8, 3, v8
v_add_u32 v8, 131072, v8
v_lshl_add_u32 v9, v3, 2, s49
v_lshlrev_b32 v9, 2, v9
v_add_u32 v9, 132224, v9
s_mov_b32 s64, 0
s_mov_b32 s65, 0
s_lshl_b32 s75, 1, s77
s_or_b32 s75, s75, 8
s_waitcnt vmcnt(0)
s_cmp_eq_u32 s46, 0
s_cbranch_scc1 slow_51
s_lshl_b32 s62, s42, 2
v_mov_b32 v4, s62
v_mov_b32 v5, 1
s_mov_b64 exec, 1
buffer_store_dword v5, v4, s[32:35], s89 offen
s_mov_b64 exec, -1
back_52:
s_barrier
ds_read_b128 v[60:63], v14 offset:2048
ds_read_b128 v[64:67], v14 offset:4096
ds_read_b128 v[68:71], v14 offset:6144
ds_read_b128 v[72:75], v14 offset:8192
ds_read_b64_tr_b16 v[80:81], v16 offset:0
ds_read_b64_tr_b16 v[82:83], v16 offset:512
ds_read_b64_tr_b16 v[84:85], v17 offset:0
ds_read_b64_tr_b16 v[86:87], v17 offset:512
ds_read_b64_tr_b16 v[88:89], v16 offset:8192
ds_read_b64_tr_b16 v[90:91], v16 offset:8704
ds_read_b64_tr_b16 v[92:93], v17 offset:8192
ds_read_b64_tr_b16 v[94:95], v17 offset:8704
ds_read_b64_tr_b16 v[96:97], v16 offset:16384
ds_read_b64_tr_b16 v[98:99], v16 offset:16896
ds_read_b64_tr_b16 v[100:101], v17 offset:16384
ds_read_b64_tr_b16 v[102:103], v17 offset:16896
c1_loop0:
s_waitcnt lgkmcnt(0)
v_mfma_f32_16x16x32_bf16 v[204:207], v[88:91], v[72:75], v[204:207]
ds_read_b128 v[104:107], v15 offset:2048
v_mfma_f32_16x16x32_bf16 v[196:199], v[88:91], v[68:71], v[196:199]
ds_read_b128 v[108:111], v15 offset:4096
v_mfma_f32_16x16x32_bf16 v[188:191], v[88:91], v[64:67], v[188:191]
ds_read_b128 v[112:115], v15 offset:6144
v_mfma_f32_16x16x32_bf16 v[180:183], v[88:91], v[60:63], v[180:183]
ds_read_b128 v[116:119], v15 offset:8192
v_mfma_f32_16x16x32_bf16 v[184:187], v[92:95], v[60:63], v[184:187]
ds_read_b64_tr_b16 v[124:125], v16 offset:4096
v_mfma_f32_16x16x32_bf16 v[192:195], v[92:95], v[64:67], v[192:195]
ds_read_b64_tr_b16 v[126:127], v16 offset:4608
v_mfma_f32_16x16x32_bf16 v[200:203], v[92:95], v[68:71], v[200:203]
ds_read_b64_tr_b16 v[128:129], v17 offset:4096
v_mfma_f32_16x16x32_bf16 v[208:211], v[92:95], v[72:75], v[208:211]
ds_read_b64_tr_b16 v[130:131], v17 offset:4608
v_mfma_f32_16x16x32_bf16 v[236:239], v[72:75], v[96:99], v[236:239]
ds_read_b64_tr_b16 v[132:133], v16 offset:12288
v_mfma_f32_16x16x32_bf16 v[228:231], v[68:71], v[96:99], v[228:231]
ds_read_b64_tr_b16 v[134:135], v16 offset:12800
v_mfma_f32_16x16x32_bf16 v[220:223], v[64:67], v[96:99], v[220:223]
ds_read_b64_tr_b16 v[136:137], v17 offset:12288
v_mfma_f32_16x16x32_bf16 v[212:215], v[60:63], v[96:99], v[212:215]
ds_read_b64_tr_b16 v[138:139], v17 offset:12800
v_mfma_f32_16x16x32_bf16 v[216:219], v[60:63], v[100:103], v[216:219]
ds_read_b64_tr_b16 v[140:141], v16 offset:20480
v_mfma_f32_16x16x32_bf16 v[224:227], v[64:67], v[100:103], v[224:227]
ds_read_b64_tr_b16 v[142:143], v16 offset:20992
v_mfma_f32_16x16x32_bf16 v[232:235], v[68:71], v[100:103], v[232:235]
ds_read_b64_tr_b16 v[144:145], v17 offset:20480
v_mfma_f32_16x16x32_bf16 v[240:243], v[72:75], v[100:103], v[240:243]
ds_read_b64_tr_b16 v[146:147], v17 offset:20992
v_mfma_f32_16x16x32_bf16 v[172:175], v[80:83], v[72:75], v[172:175]
s_bitcmp1_b32 s75, s64
s_cbranch_scc1 c1_hook0
c1_hook0_ret:
v_mfma_f32_16x16x32_bf16 v[164:167], v[80:83], v[68:71], v[164:167]
s_add_u32 s65, s65, 43008
v_mfma_f32_16x16x32_bf16 v[156:159], v[80:83], v[64:67], v[156:159]
s_cmp_eq_u32 s65, 129024
s_cselect_b32 s65, 0, s65
v_mfma_f32_16x16x32_bf16 v[148:151], v[80:83], v[60:63], v[148:151]
v_add_u32 v14, s65, v10
v_add_u32 v15, s65, v11
v_mfma_f32_16x16x32_bf16 v[152:155], v[84:87], v[60:63], v[152:155]
v_add_u32 v16, s65, v12
v_add_u32 v17, s65, v13
v_mfma_f32_16x16x32_bf16 v[160:163], v[84:87], v[64:67], v[160:163]
s_add_u32 s64, s64, 1
s_cmp_eq_u32 s64, 16
v_mfma_f32_16x16x32_bf16 v[168:171], v[84:87], v[68:71], v[168:171]
v_mfma_f32_16x16x32_bf16 v[176:179], v[84:87], v[72:75], v[176:179]
s_waitcnt lgkmcnt(0)
s_barrier
s_cbranch_scc1 c1_last0
v_mfma_f32_16x16x32_bf16 v[204:207], v[132:135], v[116:119], v[204:207]
ds_read_b128 v[60:63], v14 offset:2048
v_mfma_f32_16x16x32_bf16 v[196:199], v[132:135], v[112:115], v[196:199]
ds_read_b128 v[64:67], v14 offset:4096
v_mfma_f32_16x16x32_bf16 v[188:191], v[132:135], v[108:111], v[188:191]
ds_read_b128 v[68:71], v14 offset:6144
v_mfma_f32_16x16x32_bf16 v[180:183], v[132:135], v[104:107], v[180:183]
ds_read_b128 v[72:75], v14 offset:8192
v_mfma_f32_16x16x32_bf16 v[184:187], v[136:139], v[104:107], v[184:187]
ds_read_b64_tr_b16 v[80:81], v16 offset:0
v_mfma_f32_16x16x32_bf16 v[192:195], v[136:139], v[108:111], v[192:195]
ds_read_b64_tr_b16 v[82:83], v16 offset:512
v_mfma_f32_16x16x32_bf16 v[200:203], v[136:139], v[112:115], v[200:203]
ds_read_b64_tr_b16 v[84:85], v17 offset:0
v_mfma_f32_16x16x32_bf16 v[208:211], v[136:139], v[116:119], v[208:211]
ds_read_b64_tr_b16 v[86:87], v17 offset:512
v_mfma_f32_16x16x32_bf16 v[236:239], v[116:119], v[140:143], v[236:239]
ds_read_b64_tr_b16 v[88:89], v16 offset:8192
v_mfma_f32_16x16x32_bf16 v[228:231], v[112:115], v[140:143], v[228:231]
ds_read_b64_tr_b16 v[90:91], v16 offset:8704
v_mfma_f32_16x16x32_bf16 v[220:223], v[108:111], v[140:143], v[220:223]
ds_read_b64_tr_b16 v[92:93], v17 offset:8192
v_mfma_f32_16x16x32_bf16 v[212:215], v[104:107], v[140:143], v[212:215]
ds_read_b64_tr_b16 v[94:95], v17 offset:8704
v_mfma_f32_16x16x32_bf16 v[216:219], v[104:107], v[144:147], v[216:219]
ds_read_b64_tr_b16 v[96:97], v16 offset:16384
v_mfma_f32_16x16x32_bf16 v[224:227], v[108:111], v[144:147], v[224:227]
ds_read_b64_tr_b16 v[98:99], v16 offset:16896
v_mfma_f32_16x16x32_bf16 v[232:235], v[112:115], v[144:147], v[232:235]
ds_read_b64_tr_b16 v[100:101], v17 offset:16384
v_mfma_f32_16x16x32_bf16 v[240:243], v[116:119], v[144:147], v[240:243]
ds_read_b64_tr_b16 v[102:103], v17 offset:16896
v_mfma_f32_16x16x32_bf16 v[172:175], v[124:127], v[116:119], v[172:175]
v_mfma_f32_16x16x32_bf16 v[164:167], v[124:127], v[112:115], v[164:167]
v_mfma_f32_16x16x32_bf16 v[156:159], v[124:127], v[108:111], v[156:159]
v_mfma_f32_16x16x32_bf16 v[148:151], v[124:127], v[104:107], v[148:151]
v_mfma_f32_16x16x32_bf16 v[152:155], v[128:131], v[104:107], v[152:155]
v_mfma_f32_16x16x32_bf16 v[160:163], v[128:131], v[108:111], v[160:163]
v_mfma_f32_16x16x32_bf16 v[168:171], v[128:131], v[112:115], v[168:171]
v_mfma_f32_16x16x32_bf16 v[176:179], v[128:131], v[116:119], v[176:179]
s_branch c1_loop0
c1_hook0:
s_waitcnt lgkmcnt(0)
s_cmp_lg_u32 s64, s77
s_cbranch_scc1 hk_502053
s_cmp_eq_u32 s44, 1
s_cbranch_scc1 hk_502054
v_mfma_f32_16x16x32_bf16 v[20:23], v[56:59], v[80:83], 0
v_mfma_f32_16x16x32_bf16 v[24:27], v[56:59], v[88:91], 0
v_mfma_f32_16x16x32_bf16 v[28:31], v[56:59], v[96:99], 0
v_mfma_f32_16x16x32_bf16 v[20:23], v[56:59], v[124:127], v[20:23]
v_mfma_f32_16x16x32_bf16 v[24:27], v[56:59], v[132:135], v[24:27]
v_mfma_f32_16x16x32_bf16 v[28:31], v[56:59], v[140:143], v[28:31]
s_branch hk_502055
hk_502054:
v_mfma_f32_16x16x32_bf16 v[20:23], v[56:59], v[84:87], 0
v_mfma_f32_16x16x32_bf16 v[24:27], v[56:59], v[92:95], 0
v_mfma_f32_16x16x32_bf16 v[28:31], v[56:59], v[100:103], 0
v_mfma_f32_16x16x32_bf16 v[20:23], v[56:59], v[128:131], v[20:23]
v_mfma_f32_16x16x32_bf16 v[24:27], v[56:59], v[136:139], v[24:27]
v_mfma_f32_16x16x32_bf16 v[28:31], v[56:59], v[144:147], v[28:31]
hk_502055:
s_lshl_b32 s50, s42, 2
s_add_u32 s50, s50, s40
s_lshl_b32 s50, s50, 4
s_add_u32 s50, s50, s41
s_lshl_b32 s50, s50, 8
s_add_u32 s50, s50, 18087936
v_cmp_eq_u32 vcc, 0, v3
v_cmp_eq_u32 s[48:49], 1, v3
s_nop 1
v_cndmask_b32 v4, v28, v24, s[48:49]
v_cndmask_b32 v4, v4, v20, vcc
buffer_store_dword v4, v1, s[32:35], s50 offen sc1
hk_502053:
s_cmp_lg_u32 s64, 3
s_cbranch_scc1 hk_502056
s_waitcnt vmcnt(0)
s_lshl_b32 s52, s42, 2
s_add_u32 s52, s52, s40
s_lshl_b32 s52, s52, 7
s_add_u32 s52, s52, 18382848
s_lshl_b32 s62, s41, 2
v_mov_b32 v4, s62
v_mov_b32 v5, 1
s_mov_b64 exec, 1
buffer_store_dword v5, v4, s[32:35], s52 offen sc1
s_mov_b64 exec, -1
hk_502056:
s_branch c1_hook0_ret

c1_last0:
v_mfma_f32_16x16x32_bf16 v[204:207], v[132:135], v[116:119], v[204:207]
ds_read_b128 v[244:247], v7 offset:0
v_mfma_f32_16x16x32_bf16 v[196:199], v[132:135], v[112:115], v[196:199]
ds_read_b128 v[248:251], v7 offset:64
v_mfma_f32_16x16x32_bf16 v[188:191], v[132:135], v[108:111], v[188:191]
ds_read_b128 v[60:63], v7 offset:256
v_mfma_f32_16x16x32_bf16 v[180:183], v[132:135], v[104:107], v[180:183]
ds_read_b128 v[64:67], v7 offset:320
v_mfma_f32_16x16x32_bf16 v[184:187], v[136:139], v[104:107], v[184:187]
ds_read_b64 v[30:31], v8 offset:128
v_mfma_f32_16x16x32_bf16 v[192:195], v[136:139], v[108:111], v[192:195]
ds_read_b64 v[32:33], v8 offset:256
v_mfma_f32_16x16x32_bf16 v[200:203], v[136:139], v[112:115], v[200:203]
ds_read_b64 v[34:35], v8 offset:384
v_mfma_f32_16x16x32_bf16 v[208:211], v[136:139], v[116:119], v[208:211]
ds_read_b64 v[36:37], v8 offset:512
v_mfma_f32_16x16x32_bf16 v[236:239], v[116:119], v[140:143], v[236:239]
ds_read2_b32 v[68:69], v55 offset0:128 offset1:144
v_mfma_f32_16x16x32_bf16 v[228:231], v[112:115], v[140:143], v[228:231]
ds_read_b64_tr_b16 v[40:41], v54 offset:0
v_mfma_f32_16x16x32_bf16 v[220:223], v[108:111], v[140:143], v[220:223]
ds_read_b64_tr_b16 v[42:43], v54 offset:1024
v_mfma_f32_16x16x32_bf16 v[212:215], v[104:107], v[140:143], v[212:215]
ds_read_b64_tr_b16 v[44:45], v54 offset:32
v_mfma_f32_16x16x32_bf16 v[216:219], v[104:107], v[144:147], v[216:219]
ds_read_b64_tr_b16 v[46:47], v54 offset:1056
v_mfma_f32_16x16x32_bf16 v[224:227], v[108:111], v[144:147], v[224:227]
ds_read_b128 v[72:75], v9 offset:64
v_mfma_f32_16x16x32_bf16 v[232:235], v[112:115], v[144:147], v[232:235]
ds_read_b128 v[76:79], v9 offset:128
v_mfma_f32_16x16x32_bf16 v[240:243], v[116:119], v[144:147], v[240:243]
ds_read_b128 v[80:83], v9 offset:192
v_mfma_f32_16x16x32_bf16 v[172:175], v[124:127], v[116:119], v[172:175]
ds_read_b128 v[84:87], v9 offset:256
v_mfma_f32_16x16x32_bf16 v[164:167], v[124:127], v[112:115], v[164:167]
ds_read_b128 v[88:91], v9 offset:640
v_mfma_f32_16x16x32_bf16 v[156:159], v[124:127], v[108:111], v[156:159]
ds_read_b128 v[92:95], v9 offset:704
v_mfma_f32_16x16x32_bf16 v[148:151], v[124:127], v[104:107], v[148:151]
ds_read_b128 v[96:99], v9 offset:768
v_mfma_f32_16x16x32_bf16 v[152:155], v[128:131], v[104:107], v[152:155]
ds_read_b128 v[100:103], v9 offset:832
v_mfma_f32_16x16x32_bf16 v[160:163], v[128:131], v[108:111], v[160:163]
v_mfma_f32_16x16x32_bf16 v[168:171], v[128:131], v[112:115], v[168:171]
v_mfma_f32_16x16x32_bf16 v[176:179], v[128:131], v[116:119], v[176:179]
c1_epi:
s_waitcnt lgkmcnt(0)
s_mov_b32 s66, 0x3fb8aa3b
s_mul_i32 s48, s44, 0x80008000
v_mul_f32 v20, s66, v30
v_mul_f32 v21, s66, v32
v_mul_f32 v22, s66, v34
v_mul_f32 v23, s66, v36
v_xor_b32 v40, s48, v40
v_xor_b32 v41, s48, v41
v_xor_b32 v42, s48, v42
v_xor_b32 v43, s48, v43
v_xor_b32 v44, s48, v44
v_xor_b32 v45, s48, v45
v_xor_b32 v46, s48, v46
v_xor_b32 v47, s48, v47
.p2align 3
v_pk_fma_f32 v[180:181], v[60:61], v[30:31], v[180:181] op_sel:[0,1,0] op_sel_hi:[1,1,1]
v_pk_fma_f32 v[182:183], v[62:63], v[30:31], v[182:183] op_sel:[0,1,0] op_sel_hi:[1,1,1]
v_pk_fma_f32 v[184:185], v[64:65], v[30:31], v[184:185] op_sel:[0,1,0] op_sel_hi:[1,1,1]
v_pk_fma_f32 v[186:187], v[66:67], v[30:31], v[186:187] op_sel:[0,1,0] op_sel_hi:[1,1,1]
v_cvt_pk_bf16_f32 v180, v180, v181
v_cvt_pk_bf16_f32 v181, v182, v183
v_cvt_pk_bf16_f32 v182, v184, v185
v_cvt_pk_bf16_f32 v183, v186, v187
v_pk_fma_f32 v[188:189], v[60:61], v[32:33], v[188:189] op_sel:[0,1,0] op_sel_hi:[1,1,1]
v_pk_fma_f32 v[190:191], v[62:63], v[32:33], v[190:191] op_sel:[0,1,0] op_sel_hi:[1,1,1]
v_pk_fma_f32 v[192:193], v[64:65], v[32:33], v[192:193] op_sel:[0,1,0] op_sel_hi:[1,1,1]
v_pk_fma_f32 v[194:195], v[66:67], v[32:33], v[194:195] op_sel:[0,1,0] op_sel_hi:[1,1,1]
v_cvt_pk_bf16_f32 v188, v188, v189
v_cvt_pk_bf16_f32 v189, v190, v191
v_cvt_pk_bf16_f32 v190, v192, v193
v_cvt_pk_bf16_f32 v191, v194, v195
v_pk_fma_f32 v[196:197], v[60:61], v[34:35], v[196:197] op_sel:[0,1,0] op_sel_hi:[1,1,1]
v_pk_fma_f32 v[198:199], v[62:63], v[34:35], v[198:199] op_sel:[0,1,0] op_sel_hi:[1,1,1]
v_pk_fma_f32 v[200:201], v[64:65], v[34:35], v[200:201] op_sel:[0,1,0] op_sel_hi:[1,1,1]
v_pk_fma_f32 v[202:203], v[66:67], v[34:35], v[202:203] op_sel:[0,1,0] op_sel_hi:[1,1,1]
v_cvt_pk_bf16_f32 v196, v196, v197
v_cvt_pk_bf16_f32 v197, v198, v199
v_cvt_pk_bf16_f32 v198, v200, v201
v_cvt_pk_bf16_f32 v199, v202, v203
v_pk_fma_f32 v[204:205], v[60:61], v[36:37], v[204:205] op_sel:[0,1,0] op_sel_hi:[1,1,1]
v_pk_fma_f32 v[206:207], v[62:63], v[36:37], v[206:207] op_sel:[0,1,0] op_sel_hi:[1,1,1]
v_pk_fma_f32 v[208:209], v[64:65], v[36:37], v[208:209] op_sel:[0,1,0] op_sel_hi:[1,1,1]
v_pk_fma_f32 v[210:211], v[66:67], v[36:37], v[210:211] op_sel:[0,1,0] op_sel_hi:[1,1,1]
v_cvt_pk_bf16_f32 v204, v204, v205
v_cvt_pk_bf16_f32 v205, v206, v207
v_cvt_pk_bf16_f32 v206, v208, v209
v_cvt_pk_bf16_f32 v207, v210, v211
v_pk_fma_f32 v[212:213], v[88:89], v[68:69], v[212:213] op_sel:[0,0,0] op_sel_hi:[1,0,1]
v_pk_fma_f32 v[214:215], v[90:91], v[68:69], v[214:215] op_sel:[0,0,0] op_sel_hi:[1,0,1]
v_pk_mul_f32 v[212:213], v[212:213], v[72:73]
v_pk_mul_f32 v[214:215], v[214:215], v[74:75]
v_cvt_pk_bf16_f32 v116, v212, v213
v_cvt_pk_bf16_f32 v117, v214, v215
v_pk_fma_f32 v[220:221], v[92:93], v[68:69], v[220:221] op_sel:[0,0,0] op_sel_hi:[1,0,1]
v_pk_fma_f32 v[222:223], v[94:95], v[68:69], v[222:223] op_sel:[0,0,0] op_sel_hi:[1,0,1]
v_pk_mul_f32 v[220:221], v[220:221], v[76:77]
v_pk_mul_f32 v[222:223], v[222:223], v[78:79]
v_cvt_pk_bf16_f32 v118, v220, v221
v_cvt_pk_bf16_f32 v119, v222, v223
v_pk_fma_f32 v[228:229], v[96:97], v[68:69], v[228:229] op_sel:[0,0,0] op_sel_hi:[1,0,1]
v_pk_fma_f32 v[230:231], v[98:99], v[68:69], v[230:231] op_sel:[0,0,0] op_sel_hi:[1,0,1]
v_pk_mul_f32 v[228:229], v[228:229], v[80:81]
v_pk_mul_f32 v[230:231], v[230:231], v[82:83]
v_cvt_pk_bf16_f32 v120, v228, v229
v_cvt_pk_bf16_f32 v121, v230, v231
v_pk_fma_f32 v[236:237], v[100:101], v[68:69], v[236:237] op_sel:[0,0,0] op_sel_hi:[1,0,1]
v_pk_fma_f32 v[238:239], v[102:103], v[68:69], v[238:239] op_sel:[0,0,0] op_sel_hi:[1,0,1]
v_pk_mul_f32 v[236:237], v[236:237], v[84:85]
v_pk_mul_f32 v[238:239], v[238:239], v[86:87]
v_cvt_pk_bf16_f32 v122, v236, v237
v_cvt_pk_bf16_f32 v123, v238, v239
v_pk_fma_f32 v[216:217], v[88:89], v[68:69], v[216:217] op_sel:[0,1,0] op_sel_hi:[1,1,1]
v_pk_fma_f32 v[218:219], v[90:91], v[68:69], v[218:219] op_sel:[0,1,0] op_sel_hi:[1,1,1]
v_pk_mul_f32 v[216:217], v[216:217], v[72:73]
v_pk_mul_f32 v[218:219], v[218:219], v[74:75]
v_cvt_pk_bf16_f32 v124, v216, v217
v_cvt_pk_bf16_f32 v125, v218, v219
v_pk_fma_f32 v[224:225], v[92:93], v[68:69], v[224:225] op_sel:[0,1,0] op_sel_hi:[1,1,1]
v_pk_fma_f32 v[226:227], v[94:95], v[68:69], v[226:227] op_sel:[0,1,0] op_sel_hi:[1,1,1]
v_pk_mul_f32 v[224:225], v[224:225], v[76:77]
v_pk_mul_f32 v[226:227], v[226:227], v[78:79]
v_cvt_pk_bf16_f32 v126, v224, v225
v_cvt_pk_bf16_f32 v127, v226, v227
v_pk_fma_f32 v[232:233], v[96:97], v[68:69], v[232:233] op_sel:[0,1,0] op_sel_hi:[1,1,1]
v_pk_fma_f32 v[234:235], v[98:99], v[68:69], v[234:235] op_sel:[0,1,0] op_sel_hi:[1,1,1]
v_pk_mul_f32 v[232:233], v[232:233], v[80:81]
v_pk_mul_f32 v[234:235], v[234:235], v[82:83]
v_cvt_pk_bf16_f32 v128, v232, v233
v_cvt_pk_bf16_f32 v129, v234, v235
v_pk_fma_f32 v[240:241], v[100:101], v[68:69], v[240:241] op_sel:[0,1,0] op_sel_hi:[1,1,1]
v_pk_fma_f32 v[242:243], v[102:103], v[68:69], v[242:243] op_sel:[0,1,0] op_sel_hi:[1,1,1]
v_pk_mul_f32 v[240:241], v[240:241], v[84:85]
v_pk_mul_f32 v[242:243], v[242:243], v[86:87]
v_cvt_pk_bf16_f32 v130, v240, v241
v_cvt_pk_bf16_f32 v131, v242, v243
v_mfma_f32_16x16x32_bf16 v[60:63], v[40:43], v[180:183], 0
v_mfma_f32_16x16x32_bf16 v[64:67], v[44:47], v[180:183], 0
v_mfma_f32_16x16x32_bf16 v[68:71], v[40:43], v[188:191], 0
v_mfma_f32_16x16x32_bf16 v[72:75], v[44:47], v[188:191], 0
v_mfma_f32_16x16x32_bf16 v[76:79], v[40:43], v[196:199], 0
v_mfma_f32_16x16x32_bf16 v[80:83], v[44:47], v[196:199], 0
v_mfma_f32_16x16x32_bf16 v[84:87], v[40:43], v[204:207], 0
v_mfma_f32_16x16x32_bf16 v[88:91], v[44:47], v[204:207], 0
s_nop 1
v_max3_f32 v104, v60, v61, v62
v_min3_f32 v108, v60, v61, v62
v_max3_f32 v104, v104, v63, v64
v_min3_f32 v108, v108, v63, v64
v_max3_f32 v104, v104, v65, v66
v_min3_f32 v108, v108, v65, v66
v_max_f32 v104, v104, v67
v_min_f32 v108, v108, v67
v_max3_f32 v105, v68, v69, v70
v_min3_f32 v109, v68, v69, v70
v_max3_f32 v105, v105, v71, v72
v_min3_f32 v109, v109, v71, v72
v_max3_f32 v105, v105, v73, v74
v_min3_f32 v109, v109, v73, v74
v_max_f32 v105, v105, v75
v_min_f32 v109, v109, v75
v_max3_f32 v106, v76, v77, v78
v_min3_f32 v110, v76, v77, v78
v_max3_f32 v106, v106, v79, v80
v_min3_f32 v110, v110, v79, v80
v_max3_f32 v106, v106, v81, v82
v_min3_f32 v110, v110, v81, v82
v_max_f32 v106, v106, v83
v_min_f32 v110, v110, v83
v_max3_f32 v107, v84, v85, v86
v_min3_f32 v111, v84, v85, v86
v_max3_f32 v107, v107, v87, v88
v_min3_f32 v111, v111, v87, v88
v_max3_f32 v107, v107, v89, v90
v_min3_f32 v111, v111, v89, v90
v_max_f32 v107, v107, v91
v_min_f32 v111, v111, v91
s_nop 1
v_permlane32_swap_b32 v104, v105
v_permlane32_swap_b32 v106, v107
v_permlane32_swap_b32 v108, v109
v_permlane32_swap_b32 v110, v111
v_max_f32 v104, v104, v105
v_max_f32 v106, v106, v107
v_min_f32 v108, v108, v109
v_min_f32 v110, v110, v111
v_permlane16_swap_b32 v104, v106
s_nop 0
v_permlane16_swap_b32 v108, v110
v_max_f32 v104, v104, v106
v_min_f32 v108, v108, v110
v_mov_b32 v106, v104
v_mov_b32 v110, v108
s_nop 0
v_permlane16_swap_b32 v104, v106
v_permlane16_swap_b32 v108, v110
v_mov_b32 v105, v104
v_mov_b32 v107, v106
v_mov_b32 v109, v108
v_mov_b32 v111, v110
v_permlane32_swap_b32 v104, v105
v_permlane32_swap_b32 v106, v107
v_permlane32_swap_b32 v108, v109
v_permlane32_swap_b32 v110, v111
v_pk_mul_f32 v[104:105], v[104:105], v[20:21]
v_pk_mul_f32 v[106:107], v[106:107], v[22:23]
v_pk_mul_f32 v[108:109], v[108:109], v[20:21]
v_pk_mul_f32 v[110:111], v[110:111], v[22:23]
v_pk_fma_f32 v[212:213], v[60:61], v[20:21], v[108:109] op_sel:[0,0,0] op_sel_hi:[1,0,0] neg_lo:[1,0,0] neg_hi:[1,0,0]
v_pk_fma_f32 v[60:61], v[60:61], v[20:21], v[104:105] op_sel:[0,0,0] op_sel_hi:[1,0,0] neg_lo:[0,0,1] neg_hi:[0,0,1]
v_exp_f32 v212, v212
v_exp_f32 v60, v60
v_exp_f32 v213, v213
v_exp_f32 v61, v61
v_pk_fma_f32 v[214:215], v[62:63], v[20:21], v[108:109] op_sel:[0,0,0] op_sel_hi:[1,0,0] neg_lo:[1,0,0] neg_hi:[1,0,0]
v_pk_fma_f32 v[62:63], v[62:63], v[20:21], v[104:105] op_sel:[0,0,0] op_sel_hi:[1,0,0] neg_lo:[0,0,1] neg_hi:[0,0,1]
v_exp_f32 v214, v214
v_exp_f32 v62, v62
v_exp_f32 v215, v215
v_exp_f32 v63, v63
v_pk_fma_f32 v[216:217], v[64:65], v[20:21], v[108:109] op_sel:[0,0,0] op_sel_hi:[1,0,0] neg_lo:[1,0,0] neg_hi:[1,0,0]
v_pk_fma_f32 v[64:65], v[64:65], v[20:21], v[104:105] op_sel:[0,0,0] op_sel_hi:[1,0,0] neg_lo:[0,0,1] neg_hi:[0,0,1]
v_exp_f32 v216, v216
v_exp_f32 v64, v64
v_exp_f32 v217, v217
v_exp_f32 v65, v65
v_pk_fma_f32 v[218:219], v[66:67], v[20:21], v[108:109] op_sel:[0,0,0] op_sel_hi:[1,0,0] neg_lo:[1,0,0] neg_hi:[1,0,0]
v_pk_fma_f32 v[66:67], v[66:67], v[20:21], v[104:105] op_sel:[0,0,0] op_sel_hi:[1,0,0] neg_lo:[0,0,1] neg_hi:[0,0,1]
v_exp_f32 v218, v218
v_exp_f32 v66, v66
v_exp_f32 v219, v219
v_exp_f32 v67, v67
v_pk_fma_f32 v[220:221], v[68:69], v[20:21], v[108:109] op_sel:[0,1,1] op_sel_hi:[1,1,1] neg_lo:[1,0,0] neg_hi:[1,0,0]
v_pk_fma_f32 v[68:69], v[68:69], v[20:21], v[104:105] op_sel:[0,1,1] op_sel_hi:[1,1,1] neg_lo:[0,0,1] neg_hi:[0,0,1]
v_exp_f32 v220, v220
v_exp_f32 v68, v68
v_exp_f32 v221, v221
v_exp_f32 v69, v69
v_pk_fma_f32 v[222:223], v[70:71], v[20:21], v[108:109] op_sel:[0,1,1] op_sel_hi:[1,1,1] neg_lo:[1,0,0] neg_hi:[1,0,0]
v_pk_fma_f32 v[70:71], v[70:71], v[20:21], v[104:105] op_sel:[0,1,1] op_sel_hi:[1,1,1] neg_lo:[0,0,1] neg_hi:[0,0,1]
v_exp_f32 v222, v222
v_exp_f32 v70, v70
v_exp_f32 v223, v223
v_exp_f32 v71, v71
v_pk_fma_f32 v[224:225], v[72:73], v[20:21], v[108:109] op_sel:[0,1,1] op_sel_hi:[1,1,1] neg_lo:[1,0,0] neg_hi:[1,0,0]
v_pk_fma_f32 v[72:73], v[72:73], v[20:21], v[104:105] op_sel:[0,1,1] op_sel_hi:[1,1,1] neg_lo:[0,0,1] neg_hi:[0,0,1]
v_exp_f32 v224, v224
v_exp_f32 v72, v72
v_exp_f32 v225, v225
v_exp_f32 v73, v73
v_pk_fma_f32 v[226:227], v[74:75], v[20:21], v[108:109] op_sel:[0,1,1] op_sel_hi:[1,1,1] neg_lo:[1,0,0] neg_hi:[1,0,0]
v_pk_fma_f32 v[74:75], v[74:75], v[20:21], v[104:105] op_sel:[0,1,1] op_sel_hi:[1,1,1] neg_lo:[0,0,1] neg_hi:[0,0,1]
v_exp_f32 v226, v226
v_exp_f32 v74, v74
v_exp_f32 v227, v227
v_exp_f32 v75, v75
v_pk_fma_f32 v[228:229], v[76:77], v[22:23], v[110:111] op_sel:[0,0,0] op_sel_hi:[1,0,0] neg_lo:[1,0,0] neg_hi:[1,0,0]
v_pk_fma_f32 v[76:77], v[76:77], v[22:23], v[106:107] op_sel:[0,0,0] op_sel_hi:[1,0,0] neg_lo:[0,0,1] neg_hi:[0,0,1]
v_exp_f32 v228, v228
v_exp_f32 v76, v76
v_exp_f32 v229, v229
v_exp_f32 v77, v77
v_pk_fma_f32 v[230:231], v[78:79], v[22:23], v[110:111] op_sel:[0,0,0] op_sel_hi:[1,0,0] neg_lo:[1,0,0] neg_hi:[1,0,0]
v_pk_fma_f32 v[78:79], v[78:79], v[22:23], v[106:107] op_sel:[0,0,0] op_sel_hi:[1,0,0] neg_lo:[0,0,1] neg_hi:[0,0,1]
v_exp_f32 v230, v230
v_exp_f32 v78, v78
v_exp_f32 v231, v231
v_exp_f32 v79, v79
v_pk_fma_f32 v[232:233], v[80:81], v[22:23], v[110:111] op_sel:[0,0,0] op_sel_hi:[1,0,0] neg_lo:[1,0,0] neg_hi:[1,0,0]
v_pk_fma_f32 v[80:81], v[80:81], v[22:23], v[106:107] op_sel:[0,0,0] op_sel_hi:[1,0,0] neg_lo:[0,0,1] neg_hi:[0,0,1]
v_exp_f32 v232, v232
v_exp_f32 v80, v80
v_exp_f32 v233, v233
v_exp_f32 v81, v81
v_pk_fma_f32 v[234:235], v[82:83], v[22:23], v[110:111] op_sel:[0,0,0] op_sel_hi:[1,0,0] neg_lo:[1,0,0] neg_hi:[1,0,0]
v_pk_fma_f32 v[82:83], v[82:83], v[22:23], v[106:107] op_sel:[0,0,0] op_sel_hi:[1,0,0] neg_lo:[0,0,1] neg_hi:[0,0,1]
v_exp_f32 v234, v234
v_exp_f32 v82, v82
v_exp_f32 v235, v235
v_exp_f32 v83, v83
v_pk_fma_f32 v[236:237], v[84:85], v[22:23], v[110:111] op_sel:[0,1,1] op_sel_hi:[1,1,1] neg_lo:[1,0,0] neg_hi:[1,0,0]
v_pk_fma_f32 v[84:85], v[84:85], v[22:23], v[106:107] op_sel:[0,1,1] op_sel_hi:[1,1,1] neg_lo:[0,0,1] neg_hi:[0,0,1]
v_exp_f32 v236, v236
v_exp_f32 v84, v84
v_exp_f32 v237, v237
v_exp_f32 v85, v85
v_pk_fma_f32 v[238:239], v[86:87], v[22:23], v[110:111] op_sel:[0,1,1] op_sel_hi:[1,1,1] neg_lo:[1,0,0] neg_hi:[1,0,0]
v_pk_fma_f32 v[86:87], v[86:87], v[22:23], v[106:107] op_sel:[0,1,1] op_sel_hi:[1,1,1] neg_lo:[0,0,1] neg_hi:[0,0,1]
v_exp_f32 v238, v238
v_exp_f32 v86, v86
v_exp_f32 v239, v239
v_exp_f32 v87, v87
v_pk_fma_f32 v[240:241], v[88:89], v[22:23], v[110:111] op_sel:[0,1,1] op_sel_hi:[1,1,1] neg_lo:[1,0,0] neg_hi:[1,0,0]
v_pk_fma_f32 v[88:89], v[88:89], v[22:23], v[106:107] op_sel:[0,1,1] op_sel_hi:[1,1,1] neg_lo:[0,0,1] neg_hi:[0,0,1]
v_exp_f32 v240, v240
v_exp_f32 v88, v88
v_exp_f32 v241, v241
v_exp_f32 v89, v89
v_pk_fma_f32 v[242:243], v[90:91], v[22:23], v[110:111] op_sel:[0,1,1] op_sel_hi:[1,1,1] neg_lo:[1,0,0] neg_hi:[1,0,0]
v_pk_fma_f32 v[90:91], v[90:91], v[22:23], v[106:107] op_sel:[0,1,1] op_sel_hi:[1,1,1] neg_lo:[0,0,1] neg_hi:[0,0,1]
v_exp_f32 v242, v242
v_exp_f32 v90, v90
v_exp_f32 v243, v243
v_exp_f32 v91, v91
s_nop 0
v_pk_add_f32 v[112:113], v[60:61], v[62:63]
v_pk_add_f32 v[114:115], v[212:213], v[214:215]
v_pk_add_f32 v[112:113], v[112:113], v[64:65]
v_pk_add_f32 v[114:115], v[114:115], v[216:217]
v_pk_add_f32 v[112:113], v[112:113], v[66:67]
v_pk_add_f32 v[114:115], v[114:115], v[218:219]
v_add_f32 v104, v112, v113
v_add_f32 v108, v114, v115
v_pk_add_f32 v[112:113], v[68:69], v[70:71]
v_pk_add_f32 v[114:115], v[220:221], v[222:223]
v_pk_add_f32 v[112:113], v[112:113], v[72:73]
v_pk_add_f32 v[114:115], v[114:115], v[224:225]
v_pk_add_f32 v[112:113], v[112:113], v[74:75]
v_pk_add_f32 v[114:115], v[114:115], v[226:227]
v_add_f32 v105, v112, v113
v_add_f32 v109, v114, v115
v_pk_add_f32 v[112:113], v[76:77], v[78:79]
v_pk_add_f32 v[114:115], v[228:229], v[230:231]
v_pk_add_f32 v[112:113], v[112:113], v[80:81]
v_pk_add_f32 v[114:115], v[114:115], v[232:233]
v_pk_add_f32 v[112:113], v[112:113], v[82:83]
v_pk_add_f32 v[114:115], v[114:115], v[234:235]
v_add_f32 v106, v112, v113
v_add_f32 v110, v114, v115
v_pk_add_f32 v[112:113], v[84:85], v[86:87]
v_pk_add_f32 v[114:115], v[236:237], v[238:239]
v_pk_add_f32 v[112:113], v[112:113], v[88:89]
v_pk_add_f32 v[114:115], v[114:115], v[240:241]
v_pk_add_f32 v[112:113], v[112:113], v[90:91]
v_pk_add_f32 v[114:115], v[114:115], v[242:243]
v_add_f32 v107, v112, v113
v_add_f32 v111, v114, v115
s_nop 1
v_permlane32_swap_b32 v104, v105
v_permlane32_swap_b32 v106, v107
v_permlane32_swap_b32 v108, v109
v_permlane32_swap_b32 v110, v111
v_add_f32 v104, v104, v105
v_add_f32 v106, v106, v107
v_add_f32 v108, v108, v109
v_add_f32 v110, v110, v111
v_permlane16_swap_b32 v104, v106
s_nop 0
v_permlane16_swap_b32 v108, v110
v_add_f32 v104, v104, v106
v_add_f32 v108, v108, v110
v_rcp_f32 v104, v104
v_rcp_f32 v108, v108
s_nop 0
v_mov_b32 v106, v104
v_mov_b32 v110, v108
s_nop 0
v_permlane16_swap_b32 v104, v106
v_permlane16_swap_b32 v108, v110
v_mov_b32 v105, v104
v_mov_b32 v107, v106
v_mov_b32 v109, v108
v_mov_b32 v111, v110
v_permlane32_swap_b32 v104, v105
v_permlane32_swap_b32 v106, v107
v_permlane32_swap_b32 v108, v109
v_permlane32_swap_b32 v110, v111
.p2align 3
v_pk_mul_f32 v[60:61], v[60:61], v[104:105] op_sel:[0,0] op_sel_hi:[1,0]
v_pk_mul_f32 v[62:63], v[62:63], v[104:105] op_sel:[0,0] op_sel_hi:[1,0]
v_pk_mul_f32 v[64:65], v[64:65], v[104:105] op_sel:[0,0] op_sel_hi:[1,0]
v_pk_mul_f32 v[66:67], v[66:67], v[104:105] op_sel:[0,0] op_sel_hi:[1,0]
v_pk_mul_f32 v[212:213], v[212:213], v[108:109] op_sel:[0,0] op_sel_hi:[1,0]
v_pk_mul_f32 v[214:215], v[214:215], v[108:109] op_sel:[0,0] op_sel_hi:[1,0]
v_pk_mul_f32 v[216:217], v[216:217], v[108:109] op_sel:[0,0] op_sel_hi:[1,0]
v_pk_mul_f32 v[218:219], v[218:219], v[108:109] op_sel:[0,0] op_sel_hi:[1,0]
v_cvt_pk_bf16_f32 v60, v60, v61
v_cvt_pk_bf16_f32 v61, v62, v63
v_cvt_pk_bf16_f32 v62, v64, v65
v_cvt_pk_bf16_f32 v63, v66, v67
v_cvt_pk_bf16_f32 v212, v212, v213
v_cvt_pk_bf16_f32 v213, v214, v215
v_cvt_pk_bf16_f32 v214, v216, v217
v_cvt_pk_bf16_f32 v215, v218, v219
v_pk_mul_f32 v[68:69], v[68:69], v[104:105] op_sel:[0,1] op_sel_hi:[1,1]
v_pk_mul_f32 v[70:71], v[70:71], v[104:105] op_sel:[0,1] op_sel_hi:[1,1]
v_pk_mul_f32 v[72:73], v[72:73], v[104:105] op_sel:[0,1] op_sel_hi:[1,1]
v_pk_mul_f32 v[74:75], v[74:75], v[104:105] op_sel:[0,1] op_sel_hi:[1,1]
v_pk_mul_f32 v[220:221], v[220:221], v[108:109] op_sel:[0,1] op_sel_hi:[1,1]
v_pk_mul_f32 v[222:223], v[222:223], v[108:109] op_sel:[0,1] op_sel_hi:[1,1]
v_pk_mul_f32 v[224:225], v[224:225], v[108:109] op_sel:[0,1] op_sel_hi:[1,1]
v_pk_mul_f32 v[226:227], v[226:227], v[108:109] op_sel:[0,1] op_sel_hi:[1,1]
v_cvt_pk_bf16_f32 v68, v68, v69
v_mfma_f32_16x16x32_bf16 v[196:199], v[60:63], v[50:53], 0
v_cvt_pk_bf16_f32 v69, v70, v71
v_cvt_pk_bf16_f32 v70, v72, v73
v_mfma_f32_16x16x32_bf16 v[200:203], v[60:63], v[48:51], 0
v_cvt_pk_bf16_f32 v71, v74, v75
v_cvt_pk_bf16_f32 v220, v220, v221
v_mfma_f32_16x16x32_bf16 v[204:207], v[212:215], v[50:53], 0
v_cvt_pk_bf16_f32 v221, v222, v223
v_cvt_pk_bf16_f32 v222, v224, v225
v_mfma_f32_16x16x32_bf16 v[208:211], v[212:215], v[48:51], 0
v_cvt_pk_bf16_f32 v223, v226, v227
v_pk_mul_f32 v[76:77], v[76:77], v[106:107] op_sel:[0,0] op_sel_hi:[1,0]
v_pk_mul_f32 v[78:79], v[78:79], v[106:107] op_sel:[0,0] op_sel_hi:[1,0]
v_pk_mul_f32 v[80:81], v[80:81], v[106:107] op_sel:[0,0] op_sel_hi:[1,0]
v_pk_mul_f32 v[82:83], v[82:83], v[106:107] op_sel:[0,0] op_sel_hi:[1,0]
v_pk_mul_f32 v[228:229], v[228:229], v[110:111] op_sel:[0,0] op_sel_hi:[1,0]
v_pk_mul_f32 v[230:231], v[230:231], v[110:111] op_sel:[0,0] op_sel_hi:[1,0]
v_pk_mul_f32 v[232:233], v[232:233], v[110:111] op_sel:[0,0] op_sel_hi:[1,0]
v_pk_mul_f32 v[234:235], v[234:235], v[110:111] op_sel:[0,0] op_sel_hi:[1,0]
v_cvt_pk_bf16_f32 v76, v76, v77
v_mfma_f32_16x16x32_bf16 v[180:183], v[68:71], v[50:53], 0
v_mfma_f32_16x16x32_bf16 v[184:187], v[68:71], v[48:51], 0
v_cvt_pk_bf16_f32 v77, v78, v79
v_mfma_f32_16x16x32_bf16 v[188:191], v[220:223], v[50:53], 0
v_cvt_pk_bf16_f32 v78, v80, v81
v_mfma_f32_16x16x32_bf16 v[192:195], v[220:223], v[48:51], 0
v_cvt_pk_bf16_f32 v64, v196, v197
v_cvt_pk_bf16_f32 v79, v82, v83
v_cvt_pk_bf16_f32 v65, v198, v199
v_cvt_pk_bf16_f32 v228, v228, v229
v_cvt_pk_bf16_f32 v72, v200, v201
v_cvt_pk_bf16_f32 v73, v202, v203
v_cvt_pk_bf16_f32 v229, v230, v231
v_cvt_pk_bf16_f32 v216, v204, v205
v_cvt_pk_bf16_f32 v230, v232, v233
v_cvt_pk_bf16_f32 v217, v206, v207
v_cvt_pk_bf16_f32 v224, v208, v209
v_cvt_pk_bf16_f32 v231, v234, v235
v_cvt_pk_bf16_f32 v225, v210, v211
v_pk_mul_f32 v[84:85], v[84:85], v[106:107] op_sel:[0,1] op_sel_hi:[1,1]
v_pk_mul_f32 v[86:87], v[86:87], v[106:107] op_sel:[0,1] op_sel_hi:[1,1]
v_pk_mul_f32 v[88:89], v[88:89], v[106:107] op_sel:[0,1] op_sel_hi:[1,1]
v_pk_mul_f32 v[90:91], v[90:91], v[106:107] op_sel:[0,1] op_sel_hi:[1,1]
v_pk_mul_f32 v[236:237], v[236:237], v[110:111] op_sel:[0,1] op_sel_hi:[1,1]
v_pk_mul_f32 v[238:239], v[238:239], v[110:111] op_sel:[0,1] op_sel_hi:[1,1]
v_pk_mul_f32 v[240:241], v[240:241], v[110:111] op_sel:[0,1] op_sel_hi:[1,1]
v_pk_mul_f32 v[242:243], v[242:243], v[110:111] op_sel:[0,1] op_sel_hi:[1,1]
v_cvt_pk_bf16_f32 v84, v84, v85
v_mfma_f32_16x16x32_bf16 v[196:199], v[76:79], v[50:53], 0
v_mfma_f32_16x16x32_bf16 v[200:203], v[76:79], v[48:51], 0
v_cvt_pk_bf16_f32 v85, v86, v87
v_mfma_f32_16x16x32_bf16 v[204:207], v[228:231], v[50:53], 0
v_cvt_pk_bf16_f32 v86, v88, v89
v_mfma_f32_16x16x32_bf16 v[208:211], v[228:231], v[48:51], 0
v_cvt_pk_bf16_f32 v66, v180, v181
v_cvt_pk_bf16_f32 v87, v90, v91
v_cvt_pk_bf16_f32 v67, v182, v183
v_cvt_pk_bf16_f32 v236, v236, v237
v_cvt_pk_bf16_f32 v74, v184, v185
v_cvt_pk_bf16_f32 v75, v186, v187
v_cvt_pk_bf16_f32 v237, v238, v239
v_cvt_pk_bf16_f32 v218, v188, v189
v_cvt_pk_bf16_f32 v238, v240, v241
v_cvt_pk_bf16_f32 v219, v190, v191
v_cvt_pk_bf16_f32 v226, v192, v193
v_cvt_pk_bf16_f32 v239, v242, v243
v_cvt_pk_bf16_f32 v227, v194, v195
s_mul_i32 s48, s40, 3072
s_add_u32 s48, s48, 139264
v_mfma_f32_16x16x32_bf16 v[180:183], v[84:87], v[50:53], 0
v_mfma_f32_16x16x32_bf16 v[184:187], v[84:87], v[48:51], 0
v_mfma_f32_16x16x32_bf16 v[188:191], v[236:239], v[50:53], 0
v_mfma_f32_16x16x32_bf16 v[192:195], v[236:239], v[48:51], 0
v_mfma_f32_16x16x32_bf16 v[132:135], v[216:219], v[116:119], 0
v_cvt_pk_bf16_f32 v80, v196, v197
v_cvt_pk_bf16_f32 v81, v198, v199
v_mfma_f32_16x16x32_bf16 v[136:139], v[224:227], v[116:119], 0
v_cvt_pk_bf16_f32 v88, v200, v201
v_mfma_f32_16x16x32_bf16 v[140:143], v[216:219], v[124:127], 0
v_cvt_pk_bf16_f32 v89, v202, v203
v_mfma_f32_16x16x32_bf16 v[144:147], v[224:227], v[124:127], 0
v_cvt_pk_bf16_f32 v232, v204, v205
v_cvt_pk_bf16_f32 v233, v206, v207
v_mfma_f32_16x16x32_bf16 v[10:13], v[216:219], v[56:59], 0
v_cvt_pk_bf16_f32 v240, v208, v209
v_mfma_f32_16x16x32_bf16 v[14:17], v[224:227], v[56:59], 0
v_cvt_pk_bf16_f32 v241, v210, v211
v_mfma_f32_16x16x32_bf16 v[92:95], v[64:67], v[116:119], 0
v_cvt_pk_bf16_f32 v82, v180, v181
v_cvt_pk_bf16_f32 v83, v182, v183
v_mfma_f32_16x16x32_bf16 v[96:99], v[72:75], v[116:119], 0
v_cvt_pk_bf16_f32 v90, v184, v185
v_mfma_f32_16x16x32_bf16 v[100:103], v[64:67], v[124:127], 0
v_cvt_pk_bf16_f32 v91, v186, v187
v_mfma_f32_16x16x32_bf16 v[104:107], v[72:75], v[124:127], 0
v_cvt_pk_bf16_f32 v234, v188, v189
v_cvt_pk_bf16_f32 v235, v190, v191
v_mfma_f32_16x16x32_bf16 v[108:111], v[64:67], v[56:59], 0
v_cvt_pk_bf16_f32 v242, v192, v193
v_mfma_f32_16x16x32_bf16 v[112:115], v[72:75], v[56:59], 0
v_cvt_pk_bf16_f32 v243, v194, v195
v_add_u32 v4, s48, v18
s_xor_b32 s49, s40, 2
v_mfma_f32_16x16x32_bf16 v[132:135], v[232:235], v[120:123], v[132:135]
s_mul_i32 s48, s49, 3072
s_add_u32 s48, s48, 139264
v_mfma_f32_16x16x32_bf16 v[136:139], v[240:243], v[120:123], v[136:139]
v_add_u32 v5, s48, v18
s_lshl_b32 s49, s49, 2
v_mfma_f32_16x16x32_bf16 v[140:143], v[232:235], v[128:131], v[140:143]
v_mfma_f32_16x16x32_bf16 v[144:147], v[240:243], v[128:131], v[144:147]
s_add_u32 s49, s49, 134928
v_mov_b32 v7, s49
v_mfma_f32_16x16x32_bf16 v[10:13], v[232:235], v[56:59], v[10:13]
v_xor_b32 v8, 8, v7
v_mov_b32 v9, 1
v_mfma_f32_16x16x32_bf16 v[14:17], v[240:243], v[56:59], v[14:17]
v_mfma_f32_16x16x32_bf16 v[92:95], v[80:83], v[120:123], v[92:95]
v_mfma_f32_16x16x32_bf16 v[96:99], v[88:91], v[120:123], v[96:99]
v_mfma_f32_16x16x32_bf16 v[100:103], v[80:83], v[128:131], v[100:103]
v_cvt_pk_bf16_f32 v132, v132, v133
v_cvt_pk_bf16_f32 v133, v134, v135
v_cvt_pk_bf16_f32 v134, v136, v137
v_mfma_f32_16x16x32_bf16 v[104:107], v[88:91], v[128:131], v[104:107]
v_cvt_pk_bf16_f32 v135, v138, v139
ds_write_b128 v4, v[132:135] offset:0
v_mfma_f32_16x16x32_bf16 v[108:111], v[80:83], v[56:59], v[108:111]
v_cvt_pk_bf16_f32 v140, v140, v141
v_cvt_pk_bf16_f32 v141, v142, v143
v_cvt_pk_bf16_f32 v142, v144, v145
v_mfma_f32_16x16x32_bf16 v[112:115], v[88:91], v[56:59], v[112:115]
v_cvt_pk_bf16_f32 v143, v146, v147
ds_write_b128 v4, v[140:143] offset:1024
v_cvt_pk_bf16_f32 v10, v10, v11
v_cvt_pk_bf16_f32 v11, v12, v13
v_cvt_pk_bf16_f32 v12, v14, v15
v_cvt_pk_bf16_f32 v13, v16, v17
ds_write_b128 v4, v[10:13] offset:2048
ds_write_b32 v8, v9
s_lshl_b32 s53, s41, 1
s_add_u32 s53, s53, s44
s_lshl_b32 s54, s45, 16
s_lshl_b32 s48, s44, 15
s_add_u32 s54, s54, s48
s_add_u32 s54, s54, 8388608
s_mov_b32 s63, 0
px_53:
ds_read_b32 v9, v7
ds_read_b128 v[180:183], v5 offset:0
ds_read_b128 v[184:187], v5 offset:1024
ds_read_b128 v[188:191], v5 offset:2048
s_add_u32 s63, s63, 1
s_cmp_lt_u32 s63, 0x400000
s_waitcnt lgkmcnt(0)
v_cmp_ne_u32 vcc, 1, v9
s_cbranch_vccz pxd_54
s_cbranch_scc1 px_53
pxd_54:
v_mfma_f32_16x16x32_bf16 v[92:95], v[50:53], v[180:183], v[92:95]
s_lshl_b32 s48, s41, 7
s_add_u32 s48, s48, s54
v_mfma_f32_16x16x32_bf16 v[96:99], v[48:51], v[180:183], v[96:99]
s_add_u32 s50, s48, 16384
v_lshrrev_b32 v4, 3, v0
v_mfma_f32_16x16x32_bf16 v[100:103], v[50:53], v[184:187], v[100:103]
v_and_b32 v5, 7, v0
v_lshlrev_b32 v4, 11, v4
v_mfma_f32_16x16x32_bf16 v[104:107], v[48:51], v[184:187], v[104:107]
v_lshl_add_u32 v6, v5, 4, v4
s_lshl_b32 s55, s45, 11
v_mfma_f32_16x16x32_bf16 v[108:111], v[50:53], v[188:191], v[108:111]
s_add_u32 s55, s55, 18874368
s_lshl_b32 s49, s44, 10
v_mfma_f32_16x16x32_bf16 v[112:115], v[48:51], v[188:191], v[112:115]
s_add_u32 s55, s55, s49
v_lshlrev_b32 v7, 6, v2
v_lshl_add_u32 v7, v3, 4, v7
v_cmp_eq_u32 vcc, s41, v2
v_cvt_pk_bf16_f32 v92, v92, v93
v_cvt_pk_bf16_f32 v93, v94, v95
v_cvt_pk_bf16_f32 v94, v96, v97
v_cvt_pk_bf16_f32 v95, v98, v99
buffer_store_dwordx4 v[92:95], v6, s[32:35], s48 offen sc1
v_cvt_pk_bf16_f32 v100, v100, v101
v_cvt_pk_bf16_f32 v101, v102, v103
v_cvt_pk_bf16_f32 v102, v104, v105
v_cvt_pk_bf16_f32 v103, v106, v107
buffer_store_dwordx4 v[100:103], v6, s[32:35], s50 offen sc1
v_cvt_pk_bf16_f32 v108, v108, v109
v_cvt_pk_bf16_f32 v109, v110, v111
v_cvt_pk_bf16_f32 v110, v112, v113
v_cvt_pk_bf16_f32 v111, v114, v115
s_mov_b64 exec, vcc
buffer_store_dwordx4 v[108:111], v7, s[32:35], s55 offen sc1
s_mov_b64 exec, -1
s_lshl_b32 s56, s45, 7
s_add_u32 s56, s56, 18366464
.p2align 3
v_pk_fma_f32 v[148:149], v[244:245], v[30:31], v[148:149] op_sel:[0,1,0] op_sel_hi:[1,1,1]
v_pk_fma_f32 v[150:151], v[246:247], v[30:31], v[150:151] op_sel:[0,1,0] op_sel_hi:[1,1,1]
v_pk_fma_f32 v[152:153], v[248:249], v[30:31], v[152:153] op_sel:[0,1,0] op_sel_hi:[1,1,1]
v_pk_fma_f32 v[154:155], v[250:251], v[30:31], v[154:155] op_sel:[0,1,0] op_sel_hi:[1,1,1]
v_cvt_pk_bf16_f32 v148, v148, v149
v_cvt_pk_bf16_f32 v149, v150, v151
v_cvt_pk_bf16_f32 v150, v152, v153
v_cvt_pk_bf16_f32 v151, v154, v155
v_pk_fma_f32 v[156:157], v[244:245], v[32:33], v[156:157] op_sel:[0,1,0] op_sel_hi:[1,1,1]
v_pk_fma_f32 v[158:159], v[246:247], v[32:33], v[158:159] op_sel:[0,1,0] op_sel_hi:[1,1,1]
v_pk_fma_f32 v[160:161], v[248:249], v[32:33], v[160:161] op_sel:[0,1,0] op_sel_hi:[1,1,1]
v_pk_fma_f32 v[162:163], v[250:251], v[32:33], v[162:163] op_sel:[0,1,0] op_sel_hi:[1,1,1]
v_cvt_pk_bf16_f32 v156, v156, v157
v_cvt_pk_bf16_f32 v157, v158, v159
v_cvt_pk_bf16_f32 v158, v160, v161
v_cvt_pk_bf16_f32 v159, v162, v163
v_pk_fma_f32 v[164:165], v[244:245], v[34:35], v[164:165] op_sel:[0,1,0] op_sel_hi:[1,1,1]
v_pk_fma_f32 v[166:167], v[246:247], v[34:35], v[166:167] op_sel:[0,1,0] op_sel_hi:[1,1,1]
v_pk_fma_f32 v[168:169], v[248:249], v[34:35], v[168:169] op_sel:[0,1,0] op_sel_hi:[1,1,1]
v_pk_fma_f32 v[170:171], v[250:251], v[34:35], v[170:171] op_sel:[0,1,0] op_sel_hi:[1,1,1]
v_cvt_pk_bf16_f32 v164, v164, v165
v_cvt_pk_bf16_f32 v165, v166, v167
v_cvt_pk_bf16_f32 v166, v168, v169
v_cvt_pk_bf16_f32 v167, v170, v171
v_pk_fma_f32 v[172:173], v[244:245], v[36:37], v[172:173] op_sel:[0,1,0] op_sel_hi:[1,1,1]
v_pk_fma_f32 v[174:175], v[246:247], v[36:37], v[174:175] op_sel:[0,1,0] op_sel_hi:[1,1,1]
v_pk_fma_f32 v[176:177], v[248:249], v[36:37], v[176:177] op_sel:[0,1,0] op_sel_hi:[1,1,1]
v_pk_fma_f32 v[178:179], v[250:251], v[36:37], v[178:179] op_sel:[0,1,0] op_sel_hi:[1,1,1]
v_cvt_pk_bf16_f32 v172, v172, v173
v_cvt_pk_bf16_f32 v173, v174, v175
v_cvt_pk_bf16_f32 v174, v176, v177
v_cvt_pk_bf16_f32 v175, v178, v179
v_and_b32 v9, 1, v0
v_lshlrev_b32 v9, 4, v9
v_mov_b32 v8, 0x3f80
v_lshlrev_b32 v9, v9, v8
v_lshrrev_b32 v8, 1, v2
v_cmp_eq_u32 vcc, 0, v8
s_nop 1
v_cndmask_b32 v24, 0, v9, vcc
v_cmp_eq_u32 vcc, 1, v8
s_nop 1
v_cndmask_b32 v25, 0, v9, vcc
v_cmp_eq_u32 vcc, 2, v8
s_nop 1
v_cndmask_b32 v26, 0, v9, vcc
v_cmp_eq_u32 vcc, 3, v8
s_nop 1
v_cndmask_b32 v27, 0, v9, vcc
v_mfma_f32_16x16x32_bf16 v[60:63], v[40:43], v[148:151], 0
v_mfma_f32_16x16x32_bf16 v[64:67], v[44:47], v[148:151], 0
v_mfma_f32_16x16x32_bf16 v[68:71], v[40:43], v[156:159], 0
v_mfma_f32_16x16x32_bf16 v[72:75], v[44:47], v[156:159], 0
v_mfma_f32_16x16x32_bf16 v[76:79], v[40:43], v[164:167], 0
v_mfma_f32_16x16x32_bf16 v[80:83], v[44:47], v[164:167], 0
v_mfma_f32_16x16x32_bf16 v[84:87], v[40:43], v[172:175], 0
v_mfma_f32_16x16x32_bf16 v[88:91], v[44:47], v[172:175], 0
s_nop 1
v_max3_f32 v104, v60, v61, v62
v_min3_f32 v108, v60, v61, v62
v_max3_f32 v104, v104, v63, v64
v_min3_f32 v108, v108, v63, v64
v_max3_f32 v104, v104, v65, v66
v_min3_f32 v108, v108, v65, v66
v_max_f32 v104, v104, v67
v_min_f32 v108, v108, v67
v_max3_f32 v105, v68, v69, v70
v_min3_f32 v109, v68, v69, v70
v_max3_f32 v105, v105, v71, v72
v_min3_f32 v109, v109, v71, v72
v_max3_f32 v105, v105, v73, v74
v_min3_f32 v109, v109, v73, v74
v_max_f32 v105, v105, v75
v_min_f32 v109, v109, v75
v_max3_f32 v106, v76, v77, v78
v_min3_f32 v110, v76, v77, v78
v_max3_f32 v106, v106, v79, v80
v_min3_f32 v110, v110, v79, v80
v_max3_f32 v106, v106, v81, v82
v_min3_f32 v110, v110, v81, v82
v_max_f32 v106, v106, v83
v_min_f32 v110, v110, v83
v_max3_f32 v107, v84, v85, v86
v_min3_f32 v111, v84, v85, v86
v_max3_f32 v107, v107, v87, v88
v_min3_f32 v111, v111, v87, v88
v_max3_f32 v107, v107, v89, v90
v_min3_f32 v111, v111, v89, v90
v_max_f32 v107, v107, v91
v_min_f32 v111, v111, v91
s_nop 1
v_permlane32_swap_b32 v104, v105
v_permlane32_swap_b32 v106, v107
v_permlane32_swap_b32 v108, v109
v_permlane32_swap_b32 v110, v111
v_max_f32 v104, v104, v105
v_max_f32 v106, v106, v107
v_min_f32 v108, v108, v109
v_min_f32 v110, v110, v111
v_permlane16_swap_b32 v104, v106
s_nop 0
v_permlane16_swap_b32 v108, v110
v_max_f32 v104, v104, v106
v_min_f32 v108, v108, v110
v_mov_b32 v106, v104
v_mov_b32 v110, v108
s_nop 0
v_permlane16_swap_b32 v104, v106
v_permlane16_swap_b32 v108, v110
v_mov_b32 v105, v104
v_mov_b32 v107, v106
v_mov_b32 v109, v108
v_mov_b32 v111, v110
v_permlane32_swap_b32 v104, v105
v_permlane32_swap_b32 v106, v107
v_permlane32_swap_b32 v108, v109
v_permlane32_swap_b32 v110, v111
v_pk_mul_f32 v[104:105], v[104:105], v[20:21]
v_pk_mul_f32 v[106:107], v[106:107], v[22:23]
v_pk_mul_f32 v[108:109], v[108:109], v[20:21]
v_pk_mul_f32 v[110:111], v[110:111], v[22:23]
v_pk_fma_f32 v[212:213], v[60:61], v[20:21], v[108:109] op_sel:[0,0,0] op_sel_hi:[1,0,0] neg_lo:[1,0,0] neg_hi:[1,0,0]
v_pk_fma_f32 v[60:61], v[60:61], v[20:21], v[104:105] op_sel:[0,0,0] op_sel_hi:[1,0,0] neg_lo:[0,0,1] neg_hi:[0,0,1]
v_exp_f32 v212, v212
v_exp_f32 v60, v60
v_exp_f32 v213, v213
v_exp_f32 v61, v61
v_pk_fma_f32 v[214:215], v[62:63], v[20:21], v[108:109] op_sel:[0,0,0] op_sel_hi:[1,0,0] neg_lo:[1,0,0] neg_hi:[1,0,0]
v_pk_fma_f32 v[62:63], v[62:63], v[20:21], v[104:105] op_sel:[0,0,0] op_sel_hi:[1,0,0] neg_lo:[0,0,1] neg_hi:[0,0,1]
v_exp_f32 v214, v214
v_exp_f32 v62, v62
v_exp_f32 v215, v215
v_exp_f32 v63, v63
v_pk_fma_f32 v[216:217], v[64:65], v[20:21], v[108:109] op_sel:[0,0,0] op_sel_hi:[1,0,0] neg_lo:[1,0,0] neg_hi:[1,0,0]
v_pk_fma_f32 v[64:65], v[64:65], v[20:21], v[104:105] op_sel:[0,0,0] op_sel_hi:[1,0,0] neg_lo:[0,0,1] neg_hi:[0,0,1]
v_exp_f32 v216, v216
v_exp_f32 v64, v64
v_exp_f32 v217, v217
v_exp_f32 v65, v65
v_pk_fma_f32 v[218:219], v[66:67], v[20:21], v[108:109] op_sel:[0,0,0] op_sel_hi:[1,0,0] neg_lo:[1,0,0] neg_hi:[1,0,0]
v_pk_fma_f32 v[66:67], v[66:67], v[20:21], v[104:105] op_sel:[0,0,0] op_sel_hi:[1,0,0] neg_lo:[0,0,1] neg_hi:[0,0,1]
v_exp_f32 v218, v218
v_exp_f32 v66, v66
v_exp_f32 v219, v219
v_exp_f32 v67, v67
v_pk_fma_f32 v[220:221], v[68:69], v[20:21], v[108:109] op_sel:[0,1,1] op_sel_hi:[1,1,1] neg_lo:[1,0,0] neg_hi:[1,0,0]
v_pk_fma_f32 v[68:69], v[68:69], v[20:21], v[104:105] op_sel:[0,1,1] op_sel_hi:[1,1,1] neg_lo:[0,0,1] neg_hi:[0,0,1]
v_exp_f32 v220, v220
v_exp_f32 v68, v68
v_exp_f32 v221, v221
v_exp_f32 v69, v69
v_pk_fma_f32 v[222:223], v[70:71], v[20:21], v[108:109] op_sel:[0,1,1] op_sel_hi:[1,1,1] neg_lo:[1,0,0] neg_hi:[1,0,0]
v_pk_fma_f32 v[70:71], v[70:71], v[20:21], v[104:105] op_sel:[0,1,1] op_sel_hi:[1,1,1] neg_lo:[0,0,1] neg_hi:[0,0,1]
v_exp_f32 v222, v222
v_exp_f32 v70, v70
v_exp_f32 v223, v223
v_exp_f32 v71, v71
v_pk_fma_f32 v[224:225], v[72:73], v[20:21], v[108:109] op_sel:[0,1,1] op_sel_hi:[1,1,1] neg_lo:[1,0,0] neg_hi:[1,0,0]
v_pk_fma_f32 v[72:73], v[72:73], v[20:21], v[104:105] op_sel:[0,1,1] op_sel_hi:[1,1,1] neg_lo:[0,0,1] neg_hi:[0,0,1]
v_exp_f32 v224, v224
v_exp_f32 v72, v72
v_exp_f32 v225, v225
v_exp_f32 v73, v73
v_pk_fma_f32 v[226:227], v[74:75], v[20:21], v[108:109] op_sel:[0,1,1] op_sel_hi:[1,1,1] neg_lo:[1,0,0] neg_hi:[1,0,0]
v_pk_fma_f32 v[74:75], v[74:75], v[20:21], v[104:105] op_sel:[0,1,1] op_sel_hi:[1,1,1] neg_lo:[0,0,1] neg_hi:[0,0,1]
v_exp_f32 v226, v226
v_exp_f32 v74, v74
v_exp_f32 v227, v227
v_exp_f32 v75, v75
s_waitcnt vmcnt(0)
s_lshl_b32 s62, s53, 2
v_mov_b32 v4, s62
v_mov_b32 v5, 1
s_mov_b64 exec, 1
buffer_store_dword v5, v4, s[32:35], s56 offen sc1
s_mov_b64 exec, -1
v_pk_fma_f32 v[228:229], v[76:77], v[22:23], v[110:111] op_sel:[0,0,0] op_sel_hi:[1,0,0] neg_lo:[1,0,0] neg_hi:[1,0,0]
v_pk_fma_f32 v[76:77], v[76:77], v[22:23], v[106:107] op_sel:[0,0,0] op_sel_hi:[1,0,0] neg_lo:[0,0,1] neg_hi:[0,0,1]
v_exp_f32 v228, v228
v_exp_f32 v76, v76
v_exp_f32 v229, v229
v_exp_f32 v77, v77
v_pk_fma_f32 v[230:231], v[78:79], v[22:23], v[110:111] op_sel:[0,0,0] op_sel_hi:[1,0,0] neg_lo:[1,0,0] neg_hi:[1,0,0]
v_pk_fma_f32 v[78:79], v[78:79], v[22:23], v[106:107] op_sel:[0,0,0] op_sel_hi:[1,0,0] neg_lo:[0,0,1] neg_hi:[0,0,1]
v_exp_f32 v230, v230
v_exp_f32 v78, v78
v_exp_f32 v231, v231
v_exp_f32 v79, v79
v_pk_fma_f32 v[232:233], v[80:81], v[22:23], v[110:111] op_sel:[0,0,0] op_sel_hi:[1,0,0] neg_lo:[1,0,0] neg_hi:[1,0,0]
v_pk_fma_f32 v[80:81], v[80:81], v[22:23], v[106:107] op_sel:[0,0,0] op_sel_hi:[1,0,0] neg_lo:[0,0,1] neg_hi:[0,0,1]
v_exp_f32 v232, v232
v_exp_f32 v80, v80
v_exp_f32 v233, v233
v_exp_f32 v81, v81
v_pk_fma_f32 v[234:235], v[82:83], v[22:23], v[110:111] op_sel:[0,0,0] op_sel_hi:[1,0,0] neg_lo:[1,0,0] neg_hi:[1,0,0]
v_pk_fma_f32 v[82:83], v[82:83], v[22:23], v[106:107] op_sel:[0,0,0] op_sel_hi:[1,0,0] neg_lo:[0,0,1] neg_hi:[0,0,1]
v_exp_f32 v234, v234
v_exp_f32 v82, v82
v_exp_f32 v235, v235
v_exp_f32 v83, v83
v_pk_fma_f32 v[236:237], v[84:85], v[22:23], v[110:111] op_sel:[0,1,1] op_sel_hi:[1,1,1] neg_lo:[1,0,0] neg_hi:[1,0,0]
v_pk_fma_f32 v[84:85], v[84:85], v[22:23], v[106:107] op_sel:[0,1,1] op_sel_hi:[1,1,1] neg_lo:[0,0,1] neg_hi:[0,0,1]
v_exp_f32 v236, v236
v_exp_f32 v84, v84
v_exp_f32 v237, v237
v_exp_f32 v85, v85
v_pk_fma_f32 v[238:239], v[86:87], v[22:23], v[110:111] op_sel:[0,1,1] op_sel_hi:[1,1,1] neg_lo:[1,0,0] neg_hi:[1,0,0]
v_pk_fma_f32 v[86:87], v[86:87], v[22:23], v[106:107] op_sel:[0,1,1] op_sel_hi:[1,1,1] neg_lo:[0,0,1] neg_hi:[0,0,1]
v_exp_f32 v238, v238
v_exp_f32 v86, v86
v_exp_f32 v239, v239
v_exp_f32 v87, v87
v_pk_fma_f32 v[240:241], v[88:89], v[22:23], v[110:111] op_sel:[0,1,1] op_sel_hi:[1,1,1] neg_lo:[1,0,0] neg_hi:[1,0,0]
v_pk_fma_f32 v[88:89], v[88:89], v[22:23], v[106:107] op_sel:[0,1,1] op_sel_hi:[1,1,1] neg_lo:[0,0,1] neg_hi:[0,0,1]
v_exp_f32 v240, v240
v_exp_f32 v88, v88
v_exp_f32 v241, v241
v_exp_f32 v89, v89
v_pk_fma_f32 v[242:243], v[90:91], v[22:23], v[110:111] op_sel:[0,1,1] op_sel_hi:[1,1,1] neg_lo:[1,0,0] neg_hi:[1,0,0]
v_pk_fma_f32 v[90:91], v[90:91], v[22:23], v[106:107] op_sel:[0,1,1] op_sel_hi:[1,1,1] neg_lo:[0,0,1] neg_hi:[0,0,1]
v_exp_f32 v242, v242
v_exp_f32 v90, v90
v_exp_f32 v243, v243
v_exp_f32 v91, v91
s_nop 0
v_pk_add_f32 v[112:113], v[60:61], v[62:63]
v_pk_add_f32 v[114:115], v[212:213], v[214:215]
v_pk_add_f32 v[112:113], v[112:113], v[64:65]
v_pk_add_f32 v[114:115], v[114:115], v[216:217]
v_pk_add_f32 v[112:113], v[112:113], v[66:67]
v_pk_add_f32 v[114:115], v[114:115], v[218:219]
v_add_f32 v104, v112, v113
v_add_f32 v108, v114, v115
v_pk_add_f32 v[112:113], v[68:69], v[70:71]
v_pk_add_f32 v[114:115], v[220:221], v[222:223]
v_pk_add_f32 v[112:113], v[112:113], v[72:73]
v_pk_add_f32 v[114:115], v[114:115], v[224:225]
v_pk_add_f32 v[112:113], v[112:113], v[74:75]
v_pk_add_f32 v[114:115], v[114:115], v[226:227]
v_add_f32 v105, v112, v113
v_add_f32 v109, v114, v115
v_pk_add_f32 v[112:113], v[76:77], v[78:79]
v_pk_add_f32 v[114:115], v[228:229], v[230:231]
v_pk_add_f32 v[112:113], v[112:113], v[80:81]
v_pk_add_f32 v[114:115], v[114:115], v[232:233]
v_pk_add_f32 v[112:113], v[112:113], v[82:83]
v_pk_add_f32 v[114:115], v[114:115], v[234:235]
v_add_f32 v106, v112, v113
v_add_f32 v110, v114, v115
v_pk_add_f32 v[112:113], v[84:85], v[86:87]
v_pk_add_f32 v[114:115], v[236:237], v[238:239]
v_pk_add_f32 v[112:113], v[112:113], v[88:89]
v_pk_add_f32 v[114:115], v[114:115], v[240:241]
v_pk_add_f32 v[112:113], v[112:113], v[90:91]
v_pk_add_f32 v[114:115], v[114:115], v[242:243]
v_add_f32 v107, v112, v113
v_add_f32 v111, v114, v115
s_nop 1
v_permlane32_swap_b32 v104, v105
v_permlane32_swap_b32 v106, v107
v_permlane32_swap_b32 v108, v109
v_permlane32_swap_b32 v110, v111
v_add_f32 v104, v104, v105
v_add_f32 v106, v106, v107
v_add_f32 v108, v108, v109
v_add_f32 v110, v110, v111
v_permlane16_swap_b32 v104, v106
s_nop 0
v_permlane16_swap_b32 v108, v110
v_add_f32 v104, v104, v106
v_add_f32 v108, v108, v110
v_rcp_f32 v104, v104
v_rcp_f32 v108, v108
s_nop 0
v_mov_b32 v106, v104
v_mov_b32 v110, v108
s_nop 0
v_permlane16_swap_b32 v104, v106
v_permlane16_swap_b32 v108, v110
v_mov_b32 v105, v104
v_mov_b32 v107, v106
v_mov_b32 v109, v108
v_mov_b32 v111, v110
v_permlane32_swap_b32 v104, v105
v_permlane32_swap_b32 v106, v107
v_permlane32_swap_b32 v108, v109
v_permlane32_swap_b32 v110, v111
.p2align 3
v_pk_mul_f32 v[60:61], v[60:61], v[104:105] op_sel:[0,0] op_sel_hi:[1,0]
v_pk_mul_f32 v[62:63], v[62:63], v[104:105] op_sel:[0,0] op_sel_hi:[1,0]
v_pk_mul_f32 v[64:65], v[64:65], v[104:105] op_sel:[0,0] op_sel_hi:[1,0]
v_pk_mul_f32 v[66:67], v[66:67], v[104:105] op_sel:[0,0] op_sel_hi:[1,0]
v_pk_mul_f32 v[212:213], v[212:213], v[108:109] op_sel:[0,0] op_sel_hi:[1,0]
v_pk_mul_f32 v[214:215], v[214:215], v[108:109] op_sel:[0,0] op_sel_hi:[1,0]
v_pk_mul_f32 v[216:217], v[216:217], v[108:109] op_sel:[0,0] op_sel_hi:[1,0]
v_pk_mul_f32 v[218:219], v[218:219], v[108:109] op_sel:[0,0] op_sel_hi:[1,0]
v_cvt_pk_bf16_f32 v60, v60, v61
v_cvt_pk_bf16_f32 v61, v62, v63
v_cvt_pk_bf16_f32 v62, v64, v65
v_cvt_pk_bf16_f32 v63, v66, v67
v_cvt_pk_bf16_f32 v212, v212, v213
v_cvt_pk_bf16_f32 v213, v214, v215
v_cvt_pk_bf16_f32 v214, v216, v217
v_cvt_pk_bf16_f32 v215, v218, v219
v_pk_mul_f32 v[68:69], v[68:69], v[104:105] op_sel:[0,1] op_sel_hi:[1,1]
v_pk_mul_f32 v[70:71], v[70:71], v[104:105] op_sel:[0,1] op_sel_hi:[1,1]
v_pk_mul_f32 v[72:73], v[72:73], v[104:105] op_sel:[0,1] op_sel_hi:[1,1]
v_pk_mul_f32 v[74:75], v[74:75], v[104:105] op_sel:[0,1] op_sel_hi:[1,1]
v_pk_mul_f32 v[220:221], v[220:221], v[108:109] op_sel:[0,1] op_sel_hi:[1,1]
v_pk_mul_f32 v[222:223], v[222:223], v[108:109] op_sel:[0,1] op_sel_hi:[1,1]
v_pk_mul_f32 v[224:225], v[224:225], v[108:109] op_sel:[0,1] op_sel_hi:[1,1]
v_pk_mul_f32 v[226:227], v[226:227], v[108:109] op_sel:[0,1] op_sel_hi:[1,1]
v_cvt_pk_bf16_f32 v68, v68, v69
v_cvt_pk_bf16_f32 v69, v70, v71
v_cvt_pk_bf16_f32 v70, v72, v73
v_cvt_pk_bf16_f32 v71, v74, v75
v_cvt_pk_bf16_f32 v220, v220, v221
v_cvt_pk_bf16_f32 v221, v222, v223
v_cvt_pk_bf16_f32 v222, v224, v225
v_cvt_pk_bf16_f32 v223, v226, v227
v_pk_mul_f32 v[76:77], v[76:77], v[106:107] op_sel:[0,0] op_sel_hi:[1,0]
v_pk_mul_f32 v[78:79], v[78:79], v[106:107] op_sel:[0,0] op_sel_hi:[1,0]
v_pk_mul_f32 v[80:81], v[80:81], v[106:107] op_sel:[0,0] op_sel_hi:[1,0]
v_pk_mul_f32 v[82:83], v[82:83], v[106:107] op_sel:[0,0] op_sel_hi:[1,0]
v_pk_mul_f32 v[228:229], v[228:229], v[110:111] op_sel:[0,0] op_sel_hi:[1,0]
v_pk_mul_f32 v[230:231], v[230:231], v[110:111] op_sel:[0,0] op_sel_hi:[1,0]
v_pk_mul_f32 v[232:233], v[232:233], v[110:111] op_sel:[0,0] op_sel_hi:[1,0]
v_pk_mul_f32 v[234:235], v[234:235], v[110:111] op_sel:[0,0] op_sel_hi:[1,0]
v_cvt_pk_bf16_f32 v76, v76, v77
v_cvt_pk_bf16_f32 v77, v78, v79
v_cvt_pk_bf16_f32 v78, v80, v81
v_cvt_pk_bf16_f32 v79, v82, v83
v_cvt_pk_bf16_f32 v228, v228, v229
v_cvt_pk_bf16_f32 v229, v230, v231
v_cvt_pk_bf16_f32 v230, v232, v233
v_cvt_pk_bf16_f32 v231, v234, v235
v_pk_mul_f32 v[84:85], v[84:85], v[106:107] op_sel:[0,1] op_sel_hi:[1,1]
v_pk_mul_f32 v[86:87], v[86:87], v[106:107] op_sel:[0,1] op_sel_hi:[1,1]
v_pk_mul_f32 v[88:89], v[88:89], v[106:107] op_sel:[0,1] op_sel_hi:[1,1]
v_pk_mul_f32 v[90:91], v[90:91], v[106:107] op_sel:[0,1] op_sel_hi:[1,1]
v_pk_mul_f32 v[236:237], v[236:237], v[110:111] op_sel:[0,1] op_sel_hi:[1,1]
v_pk_mul_f32 v[238:239], v[238:239], v[110:111] op_sel:[0,1] op_sel_hi:[1,1]
v_pk_mul_f32 v[240:241], v[240:241], v[110:111] op_sel:[0,1] op_sel_hi:[1,1]
v_pk_mul_f32 v[242:243], v[242:243], v[110:111] op_sel:[0,1] op_sel_hi:[1,1]
v_cvt_pk_bf16_f32 v84, v84, v85
v_cvt_pk_bf16_f32 v85, v86, v87
v_cvt_pk_bf16_f32 v86, v88, v89
v_cvt_pk_bf16_f32 v87, v90, v91
v_cvt_pk_bf16_f32 v236, v236, v237
v_cvt_pk_bf16_f32 v237, v238, v239
v_cvt_pk_bf16_f32 v238, v240, v241
v_cvt_pk_bf16_f32 v239, v242, v243
v_and_b32 v4, 31, v0
v_lshlrev_b32 v4, 2, v4
buffer_load_dword v5, v4, s[32:35], s56 offen sc1
s_lshl_b32 s48, s41, 11
s_add_u32 s48, s48, s54
s_lshl_b32 s57, s45, 12
s_lshl_b32 s49, s44, 11
s_add_u32 s57, s57, s49
s_add_u32 s57, s57, 19136512
s_xor_b32 s58, s57, 2048
s_lshl_b32 s49, s41, 7
s_add_u32 s49, s49, s57
s_xor_b32 s59, s55, 1024
v_lshlrev_b32 v6, 4, v2
v_lshl_add_u32 v6, v3, 3, v6
s_mov_b32 s63, 0
s_waitcnt vmcnt(0)
poll_55:
v_cmp_gt_u32 vcc, 1, v5
s_cbranch_vccz polled_56
buffer_load_dword v5, v4, s[32:35], s56 offen sc1
s_add_u32 s63, s63, 1
s_cmp_lt_u32 s63, 0x80000
s_waitcnt vmcnt(0)
s_cbranch_scc1 poll_55
polled_56:
buffer_load_dwordx4 v[180:183], v18, s[32:35], s48 offen offset:0 sc1
buffer_load_dwordx4 v[184:187], v18, s[32:35], s48 offen offset:1024 sc1
buffer_load_dwordx4 v[196:199], v7, s[32:35], s55 offen sc1
buffer_load_dwordx4 v[200:203], v7, s[32:35], s59 offen sc1
s_waitcnt vmcnt(3)
v_mfma_f32_16x16x32_bf16 v[92:95], v[24:27], v[180:183], 0
s_waitcnt vmcnt(2)
v_mfma_f32_16x16x32_bf16 v[92:95], v[24:27], v[184:187], v[92:95]
s_nop 7
v_add_f32_dpp v92, v92, v92 row_ror:8 row_mask:0xf bank_mask:0xf
v_add_f32_dpp v93, v93, v93 row_ror:8 row_mask:0xf bank_mask:0xf
v_add_f32_dpp v94, v94, v94 row_ror:8 row_mask:0xf bank_mask:0xf
v_add_f32_dpp v95, v95, v95 row_ror:8 row_mask:0xf bank_mask:0xf
v_cvt_pk_bf16_f32 v92, v92, v93
v_cvt_pk_bf16_f32 v93, v94, v95
v_min_u32 v92, -2, v92
v_min_u32 v93, -2, v93
s_mov_b64 exec, 0x00ff00ff
buffer_store_dwordx2 v[92:93], v6, s[32:35], s49 offen sc1
s_mov_b64 exec, -1
s_waitcnt vmcnt(1)
v_mfma_f32_16x16x32_bf16 v[132:135], v[196:199], v[60:63], 0
v_mfma_f32_16x16x32_bf16 v[136:139], v[196:199], v[68:71], 0
v_mfma_f32_16x16x32_bf16 v[140:143], v[196:199], v[76:79], 0
v_mfma_f32_16x16x32_bf16 v[144:147], v[196:199], v[84:87], 0
v_mfma_f32_16x16x32_bf16 v[132:135], v[200:203], v[212:215], v[132:135]
v_mfma_f32_16x16x32_bf16 v[136:139], v[200:203], v[220:223], v[136:139]
v_mfma_f32_16x16x32_bf16 v[140:143], v[200:203], v[228:231], v[140:143]
v_mfma_f32_16x16x32_bf16 v[144:147], v[200:203], v[236:239], v[144:147]
s_nop 4
v_add_f32 v104, v132, v133
v_add_f32 v134, v134, v135
v_add_f32 v104, v104, v134
v_add_f32 v105, v136, v137
v_add_f32 v138, v138, v139
v_add_f32 v105, v105, v138
v_add_f32 v106, v140, v141
v_add_f32 v142, v142, v143
v_add_f32 v106, v106, v142
v_add_f32 v107, v144, v145
v_add_f32 v146, v146, v147
v_add_f32 v107, v107, v146
s_nop 1
v_permlane32_swap_b32 v104, v105
v_permlane32_swap_b32 v106, v107
s_nop 0
v_add_f32 v104, v104, v105
v_add_f32 v106, v106, v107
s_nop 1
v_permlane16_swap_b32 v104, v106
s_nop 0
v_add_f32 v104, v104, v106
v_add_f32 v104, 0x358637bd, v104
v_rcp_f32 v104, v104
s_nop 0
v_mov_b32 v106, v104
s_nop 1
v_permlane16_swap_b32 v104, v106
s_nop 0
v_mov_b32 v105, v104
v_mov_b32 v107, v106
s_nop 1
v_permlane32_swap_b32 v104, v105
v_permlane32_swap_b32 v106, v107
s_nop 0
s_mov_b32 s63, 0
kvr_57:
buffer_load_dwordx4 v[180:183], v18, s[32:35], s57 offen offset:0 sc1
buffer_load_dwordx4 v[184:187], v18, s[32:35], s57 offen offset:1024 sc1
buffer_load_dwordx4 v[188:191], v18, s[32:35], s58 offen offset:0 sc1
buffer_load_dwordx4 v[192:195], v18, s[32:35], s58 offen offset:1024 sc1
s_add_u32 s63, s63, 1
s_cmp_lt_u32 s63, 0x80000
s_waitcnt vmcnt(2)
v_max3_u32 v4, v180, v181, v182
v_max3_u32 v5, v183, v184, v185
v_max3_u32 v4, v4, v186, v187
s_waitcnt vmcnt(0)
v_max3_u32 v5, v5, v188, v189
v_max3_u32 v4, v4, v190, v191
v_max3_u32 v5, v5, v192, v193
v_max3_u32 v4, v4, v194, v195
v_max_u32 v4, v4, v5
v_cmp_eq_u32 vcc, -1, v4
s_cbranch_vccz kvrd_58
s_cbranch_scc1 kvr_57
kvrd_58:
v_mfma_f32_16x16x32_bf16 v[148:151], v[180:183], v[60:63], 0
v_mfma_f32_16x16x32_bf16 v[152:155], v[184:187], v[60:63], 0
v_mfma_f32_16x16x32_bf16 v[148:151], v[188:191], v[212:215], v[148:151]
v_mfma_f32_16x16x32_bf16 v[152:155], v[192:195], v[212:215], v[152:155]
v_mfma_f32_16x16x32_bf16 v[156:159], v[180:183], v[68:71], 0
v_mfma_f32_16x16x32_bf16 v[160:163], v[184:187], v[68:71], 0
v_mfma_f32_16x16x32_bf16 v[156:159], v[188:191], v[220:223], v[156:159]
v_mfma_f32_16x16x32_bf16 v[160:163], v[192:195], v[220:223], v[160:163]
v_mfma_f32_16x16x32_bf16 v[164:167], v[180:183], v[76:79], 0
v_mfma_f32_16x16x32_bf16 v[168:171], v[184:187], v[76:79], 0
v_mfma_f32_16x16x32_bf16 v[164:167], v[188:191], v[228:231], v[164:167]
v_mfma_f32_16x16x32_bf16 v[168:171], v[192:195], v[228:231], v[168:171]
v_mfma_f32_16x16x32_bf16 v[172:175], v[180:183], v[84:87], 0
v_mfma_f32_16x16x32_bf16 v[176:179], v[184:187], v[84:87], 0
v_mfma_f32_16x16x32_bf16 v[172:175], v[188:191], v[236:239], v[172:175]
v_mfma_f32_16x16x32_bf16 v[176:179], v[192:195], v[236:239], v[176:179]
s_cmp_eq_u32 s46, 0
s_cbranch_scc1 slow_59
.p2align 3
v_pk_mul_f32 v[148:149], v[148:149], v[104:105] op_sel:[0,0] op_sel_hi:[1,0]
v_pk_mul_f32 v[150:151], v[150:151], v[104:105] op_sel:[0,0] op_sel_hi:[1,0]
v_pk_mul_f32 v[152:153], v[152:153], v[104:105] op_sel:[0,0] op_sel_hi:[1,0]
v_pk_mul_f32 v[154:155], v[154:155], v[104:105] op_sel:[0,0] op_sel_hi:[1,0]
v_cvt_pk_bf16_f32 v148, v148, v149
v_cvt_pk_bf16_f32 v149, v150, v151
v_cvt_pk_bf16_f32 v150, v152, v153
v_cvt_pk_bf16_f32 v151, v154, v155
buffer_store_dwordx4 v[148:151], v18, s[32:35], s80 offen
v_pk_mul_f32 v[156:157], v[156:157], v[104:105] op_sel:[0,1] op_sel_hi:[1,1]
v_pk_mul_f32 v[158:159], v[158:159], v[104:105] op_sel:[0,1] op_sel_hi:[1,1]
v_pk_mul_f32 v[160:161], v[160:161], v[104:105] op_sel:[0,1] op_sel_hi:[1,1]
v_pk_mul_f32 v[162:163], v[162:163], v[104:105] op_sel:[0,1] op_sel_hi:[1,1]
v_cvt_pk_bf16_f32 v156, v156, v157
v_cvt_pk_bf16_f32 v157, v158, v159
v_cvt_pk_bf16_f32 v158, v160, v161
v_cvt_pk_bf16_f32 v159, v162, v163
buffer_store_dwordx4 v[156:159], v18, s[32:35], s81 offen
v_pk_mul_f32 v[164:165], v[164:165], v[106:107] op_sel:[0,0] op_sel_hi:[1,0]
v_pk_mul_f32 v[166:167], v[166:167], v[106:107] op_sel:[0,0] op_sel_hi:[1,0]
v_pk_mul_f32 v[168:169], v[168:169], v[106:107] op_sel:[0,0] op_sel_hi:[1,0]
v_pk_mul_f32 v[170:171], v[170:171], v[106:107] op_sel:[0,0] op_sel_hi:[1,0]
v_cvt_pk_bf16_f32 v164, v164, v165
v_cvt_pk_bf16_f32 v165, v166, v167
v_cvt_pk_bf16_f32 v166, v168, v169
v_cvt_pk_bf16_f32 v167, v170, v171
buffer_store_dwordx4 v[164:167], v18, s[32:35], s82 offen
v_pk_mul_f32 v[172:173], v[172:173], v[106:107] op_sel:[0,1] op_sel_hi:[1,1]
v_pk_mul_f32 v[174:175], v[174:175], v[106:107] op_sel:[0,1] op_sel_hi:[1,1]
v_pk_mul_f32 v[176:177], v[176:177], v[106:107] op_sel:[0,1] op_sel_hi:[1,1]
v_pk_mul_f32 v[178:179], v[178:179], v[106:107] op_sel:[0,1] op_sel_hi:[1,1]
v_cvt_pk_bf16_f32 v172, v172, v173
v_cvt_pk_bf16_f32 v173, v174, v175
v_cvt_pk_bf16_f32 v174, v176, v177
v_cvt_pk_bf16_f32 v175, v178, v179
buffer_store_dwordx4 v[172:175], v18, s[32:35], s83 offen
s_barrier
s_lshl_b32 s62, s45, 2
v_mov_b32 v4, s62
v_mov_b32 v5, 2
s_mov_b64 exec, 1
s_waitcnt vmcnt(0)
buffer_store_dword v5, v4, s[32:35], s84 offen
s_mov_b64 exec, -1
back_60:
buffer_load_dwordx4 v[88:91], v18, s[32:35], s85 offen offset:0 sc1
buffer_load_dwordx4 v[92:95], v18, s[32:35], s85 offen offset:1024 sc1
buffer_load_dwordx4 v[96:99], v18, s[32:35], s86 offen offset:0 sc1
buffer_load_dwordx4 v[100:103], v18, s[32:35], s86 offen offset:1024 sc1
v_and_b32 v10, 31, v0
v_lshlrev_b32 v10, 2, v10
buffer_load_dword v11, v10, s[32:35], s84 offen sc1
v_lshrrev_b32 v4, 2, v2
v_and_b32 v5, 3, v0
v_lshl_add_u32 v6, v3, 3, v4
v_lshlrev_b32 v6, 7, v6
v_lshl_add_u32 v6, v5, 3, v6
v_lshrrev_b32 v7, 1, v4
v_and_b32 v8, 1, v3
v_lshl_add_u32 v7, v8, 1, v7
v_lshl_add_u32 v14, v7, 5, v6
v_xor_b32 v15, 32, v14
v_xor_b32 v16, 64, v14
v_xor_b32 v17, 96, v14
v_add_u32 v52, 0x10000, v14
v_add_u32 v53, 0x10000, v15
v_add_u32 v54, 0x10000, v16
v_add_u32 v55, 0x10000, v17
ds_read_b64_tr_b16 v[212:213], v14 offset:0
ds_read_b64_tr_b16 v[214:215], v14 offset:512
ds_read_b64_tr_b16 v[216:217], v15 offset:0
ds_read_b64_tr_b16 v[218:219], v15 offset:512
ds_read_b64_tr_b16 v[220:221], v16 offset:0
ds_read_b64_tr_b16 v[222:223], v16 offset:512
ds_read_b64_tr_b16 v[224:225], v17 offset:0
ds_read_b64_tr_b16 v[226:227], v17 offset:512
ds_read_b64_tr_b16 v[228:229], v14 offset:4096
ds_read_b64_tr_b16 v[230:231], v14 offset:4608
ds_read_b64_tr_b16 v[232:233], v15 offset:4096
ds_read_b64_tr_b16 v[234:235], v15 offset:4608
ds_read_b64_tr_b16 v[236:237], v16 offset:4096
ds_read_b64_tr_b16 v[238:239], v16 offset:4608
ds_read_b64_tr_b16 v[240:241], v17 offset:4096
ds_read_b64_tr_b16 v[242:243], v17 offset:4608
s_lshl_b32 s48, s41, 3
s_lshl_b32 s49, s40, 1
s_add_u32 s56, s48, s49
s_lshl_b32 s48, s56, 15
s_add_u32 s48, s48, 4194304
v_add_u32 v12, s48, v18
v_add_u32 v13, 32768, v12
s_lshl_b32 s57, s47, 11
s_mov_b32 s63, 0
s_waitcnt vmcnt(0)
poll_61:
v_cmp_gt_u32 vcc, 2, v11
s_cbranch_vccz polled_62
buffer_load_dword v11, v10, s[32:35], s84 offen sc1
s_add_u32 s63, s63, 1
s_cmp_lt_u32 s63, 0x80000
s_waitcnt vmcnt(0)
s_cbranch_scc1 poll_61
polled_62:
buffer_load_dwordx4 v[148:151], v12, s[32:35], s57 offen sc1
buffer_load_dwordx4 v[152:155], v13, s[32:35], s57 offen sc1
buffer_load_dwordx4 v[156:159], v12, s[32:35], s57 offen offset:1024 sc1
buffer_load_dwordx4 v[160:163], v13, s[32:35], s57 offen offset:1024 sc1
s_add_u32 s57, s57, 2048
s_and_b32 s57, s57, 0x7fff
buffer_load_dwordx4 v[164:167], v12, s[32:35], s57 offen sc1
buffer_load_dwordx4 v[168:171], v13, s[32:35], s57 offen sc1
buffer_load_dwordx4 v[172:175], v12, s[32:35], s57 offen offset:1024 sc1
buffer_load_dwordx4 v[176:179], v13, s[32:35], s57 offen offset:1024 sc1
s_add_u32 s57, s57, 2048
s_and_b32 s57, s57, 0x7fff
buffer_load_dwordx4 v[180:183], v12, s[32:35], s57 offen sc1
buffer_load_dwordx4 v[184:187], v13, s[32:35], s57 offen sc1
buffer_load_dwordx4 v[188:191], v12, s[32:35], s57 offen offset:1024 sc1
buffer_load_dwordx4 v[192:195], v13, s[32:35], s57 offen offset:1024 sc1
s_add_u32 s57, s57, 2048
s_and_b32 s57, s57, 0x7fff
v_lshlrev_b32 v20, 16, v88
v_and_b32 v21, 0xffff0000, v88
v_lshlrev_b32 v22, 16, v89
v_and_b32 v23, 0xffff0000, v89
v_lshlrev_b32 v24, 16, v90
v_and_b32 v25, 0xffff0000, v90
v_lshlrev_b32 v26, 16, v91
v_and_b32 v27, 0xffff0000, v91
v_lshlrev_b32 v28, 16, v92
v_and_b32 v29, 0xffff0000, v92
v_lshlrev_b32 v30, 16, v93
v_and_b32 v31, 0xffff0000, v93
v_lshlrev_b32 v32, 16, v94
v_and_b32 v33, 0xffff0000, v94
v_lshlrev_b32 v34, 16, v95
v_and_b32 v35, 0xffff0000, v95
v_lshlrev_b32 v36, 16, v96
v_and_b32 v37, 0xffff0000, v96
v_lshlrev_b32 v38, 16, v97
v_and_b32 v39, 0xffff0000, v97
v_lshlrev_b32 v40, 16, v98
v_and_b32 v41, 0xffff0000, v98
v_lshlrev_b32 v42, 16, v99
v_and_b32 v43, 0xffff0000, v99
v_lshlrev_b32 v44, 16, v100
v_and_b32 v45, 0xffff0000, v100
v_lshlrev_b32 v46, 16, v101
v_and_b32 v47, 0xffff0000, v101
v_lshlrev_b32 v48, 16, v102
v_and_b32 v49, 0xffff0000, v102
v_lshlrev_b32 v50, 16, v103
v_and_b32 v51, 0xffff0000, v103
v_mov_b32 v10, 0x3f803f80
v_mov_b32 v6, 0
v_mov_b32 v7, 0
v_mov_b32 v8, 0
v_mov_b32 v9, 0
s_lshl_b32 s62, s42, 2
v_mov_b32 v4, s62
v_mov_b32 v5, 2
s_waitcnt vmcnt(10) lgkmcnt(8)
v_mfma_f32_16x16x32_bf16 v[20:23], v[212:215], v[148:151], v[20:23]
ds_read_b64_tr_b16 v[104:105], v14 offset:8192
ds_read_b64_tr_b16 v[106:107], v14 offset:8704
v_mfma_f32_16x16x32_bf16 v[36:39], v[212:215], v[152:155], v[36:39]
buffer_load_dwordx4 v[196:199], v12, s[32:35], s57 offen sc1
v_mfma_f32_16x16x32_bf16 v[24:27], v[216:219], v[148:151], v[24:27]
ds_read_b64_tr_b16 v[108:109], v15 offset:8192
v_mfma_f32_16x16x32_bf16 v[40:43], v[216:219], v[152:155], v[40:43]
ds_read_b64_tr_b16 v[110:111], v15 offset:8704
v_mfma_f32_16x16x32_bf16 v[28:31], v[220:223], v[148:151], v[28:31]
ds_read_b64_tr_b16 v[112:113], v16 offset:8192
buffer_load_dwordx4 v[200:203], v13, s[32:35], s57 offen sc1
v_mfma_f32_16x16x32_bf16 v[44:47], v[220:223], v[152:155], v[44:47]
ds_read_b64_tr_b16 v[114:115], v16 offset:8704
v_mfma_f32_16x16x32_bf16 v[32:35], v[224:227], v[148:151], v[32:35]
ds_read_b64_tr_b16 v[116:117], v17 offset:8192
v_mfma_f32_16x16x32_bf16 v[48:51], v[224:227], v[152:155], v[48:51]
ds_read_b64_tr_b16 v[118:119], v17 offset:8704
s_waitcnt vmcnt(10) lgkmcnt(8)
v_mfma_f32_16x16x32_bf16 v[20:23], v[228:231], v[156:159], v[20:23]
ds_read_b64_tr_b16 v[212:213], v14 offset:12288
ds_read_b64_tr_b16 v[214:215], v14 offset:12800
v_mfma_f32_16x16x32_bf16 v[36:39], v[228:231], v[160:163], v[36:39]
buffer_load_dwordx4 v[204:207], v12, s[32:35], s57 offen offset:1024 sc1
v_mfma_f32_16x16x32_bf16 v[24:27], v[232:235], v[156:159], v[24:27]
ds_read_b64_tr_b16 v[216:217], v15 offset:12288
v_mfma_f32_16x16x32_bf16 v[40:43], v[232:235], v[160:163], v[40:43]
ds_read_b64_tr_b16 v[218:219], v15 offset:12800
v_mfma_f32_16x16x32_bf16 v[28:31], v[236:239], v[156:159], v[28:31]
ds_read_b64_tr_b16 v[220:221], v16 offset:12288
buffer_load_dwordx4 v[208:211], v13, s[32:35], s57 offen offset:1024 sc1
s_add_u32 s57, s57, 2048
s_and_b32 s57, s57, 0x7fff
v_mfma_f32_16x16x32_bf16 v[44:47], v[236:239], v[160:163], v[44:47]
ds_read_b64_tr_b16 v[222:223], v16 offset:12800
v_mfma_f32_16x16x32_bf16 v[32:35], v[240:243], v[156:159], v[32:35]
ds_read_b64_tr_b16 v[224:225], v17 offset:12288
v_mfma_f32_16x16x32_bf16 v[48:51], v[240:243], v[160:163], v[48:51]
ds_read_b64_tr_b16 v[226:227], v17 offset:12800
s_waitcnt vmcnt(10) lgkmcnt(8)
v_mfma_f32_16x16x32_bf16 v[20:23], v[104:107], v[164:167], v[20:23]
ds_read_b64_tr_b16 v[228:229], v14 offset:16384
ds_read_b64_tr_b16 v[230:231], v14 offset:16896
v_mfma_f32_16x16x32_bf16 v[36:39], v[104:107], v[168:171], v[36:39]
buffer_load_dwordx4 v[148:151], v12, s[32:35], s57 offen sc1
v_mfma_f32_16x16x32_bf16 v[24:27], v[108:111], v[164:167], v[24:27]
ds_read_b64_tr_b16 v[232:233], v15 offset:16384
v_mfma_f32_16x16x32_bf16 v[40:43], v[108:111], v[168:171], v[40:43]
ds_read_b64_tr_b16 v[234:235], v15 offset:16896
v_mfma_f32_16x16x32_bf16 v[28:31], v[112:115], v[164:167], v[28:31]
ds_read_b64_tr_b16 v[236:237], v16 offset:16384
buffer_load_dwordx4 v[152:155], v13, s[32:35], s57 offen sc1
v_mfma_f32_16x16x32_bf16 v[44:47], v[112:115], v[168:171], v[44:47]
ds_read_b64_tr_b16 v[238:239], v16 offset:16896
v_mfma_f32_16x16x32_bf16 v[32:35], v[116:119], v[164:167], v[32:35]
ds_read_b64_tr_b16 v[240:241], v17 offset:16384
v_mfma_f32_16x16x32_bf16 v[48:51], v[116:119], v[168:171], v[48:51]
ds_read_b64_tr_b16 v[242:243], v17 offset:16896
s_waitcnt vmcnt(10) lgkmcnt(8)
v_mfma_f32_16x16x32_bf16 v[20:23], v[212:215], v[172:175], v[20:23]
ds_read_b64_tr_b16 v[104:105], v14 offset:20480
ds_read_b64_tr_b16 v[106:107], v14 offset:20992
v_mfma_f32_16x16x32_bf16 v[36:39], v[212:215], v[176:179], v[36:39]
buffer_load_dwordx4 v[156:159], v12, s[32:35], s57 offen offset:1024 sc1
v_mfma_f32_16x16x32_bf16 v[24:27], v[216:219], v[172:175], v[24:27]
ds_read_b64_tr_b16 v[108:109], v15 offset:20480
v_mfma_f32_16x16x32_bf16 v[40:43], v[216:219], v[176:179], v[40:43]
ds_read_b64_tr_b16 v[110:111], v15 offset:20992
v_mfma_f32_16x16x32_bf16 v[28:31], v[220:223], v[172:175], v[28:31]
ds_read_b64_tr_b16 v[112:113], v16 offset:20480
buffer_load_dwordx4 v[160:163], v13, s[32:35], s57 offen offset:1024 sc1
s_add_u32 s57, s57, 2048
s_and_b32 s57, s57, 0x7fff
v_mfma_f32_16x16x32_bf16 v[44:47], v[220:223], v[176:179], v[44:47]
ds_read_b64_tr_b16 v[114:115], v16 offset:20992
v_mfma_f32_16x16x32_bf16 v[32:35], v[224:227], v[172:175], v[32:35]
ds_read_b64_tr_b16 v[116:117], v17 offset:20480
v_mfma_f32_16x16x32_bf16 v[48:51], v[224:227], v[176:179], v[48:51]
ds_read_b64_tr_b16 v[118:119], v17 offset:20992
s_waitcnt vmcnt(10) lgkmcnt(8)
v_mfma_f32_16x16x32_bf16 v[20:23], v[228:231], v[180:183], v[20:23]
ds_read_b64_tr_b16 v[212:213], v14 offset:24576
ds_read_b64_tr_b16 v[214:215], v14 offset:25088
v_mfma_f32_16x16x32_bf16 v[36:39], v[228:231], v[184:187], v[36:39]
buffer_load_dwordx4 v[164:167], v12, s[32:35], s57 offen sc1
v_mfma_f32_16x16x32_bf16 v[24:27], v[232:235], v[180:183], v[24:27]
ds_read_b64_tr_b16 v[216:217], v15 offset:24576
v_mfma_f32_16x16x32_bf16 v[40:43], v[232:235], v[184:187], v[40:43]
ds_read_b64_tr_b16 v[218:219], v15 offset:25088
v_mfma_f32_16x16x32_bf16 v[28:31], v[236:239], v[180:183], v[28:31]
ds_read_b64_tr_b16 v[220:221], v16 offset:24576
buffer_load_dwordx4 v[168:171], v13, s[32:35], s57 offen sc1
v_mfma_f32_16x16x32_bf16 v[44:47], v[236:239], v[184:187], v[44:47]
ds_read_b64_tr_b16 v[222:223], v16 offset:25088
v_mfma_f32_16x16x32_bf16 v[32:35], v[240:243], v[180:183], v[32:35]
ds_read_b64_tr_b16 v[224:225], v17 offset:24576
v_mfma_f32_16x16x32_bf16 v[48:51], v[240:243], v[184:187], v[48:51]
ds_read_b64_tr_b16 v[226:227], v17 offset:25088
s_waitcnt vmcnt(10) lgkmcnt(8)
v_mfma_f32_16x16x32_bf16 v[20:23], v[104:107], v[188:191], v[20:23]
ds_read_b64_tr_b16 v[228:229], v14 offset:28672
ds_read_b64_tr_b16 v[230:231], v14 offset:29184
v_mfma_f32_16x16x32_bf16 v[36:39], v[104:107], v[192:195], v[36:39]
buffer_load_dwordx4 v[172:175], v12, s[32:35], s57 offen offset:1024 sc1
v_mfma_f32_16x16x32_bf16 v[24:27], v[108:111], v[188:191], v[24:27]
ds_read_b64_tr_b16 v[232:233], v15 offset:28672
v_mfma_f32_16x16x32_bf16 v[40:43], v[108:111], v[192:195], v[40:43]
ds_read_b64_tr_b16 v[234:235], v15 offset:29184
v_mfma_f32_16x16x32_bf16 v[28:31], v[112:115], v[188:191], v[28:31]
ds_read_b64_tr_b16 v[236:237], v16 offset:28672
buffer_load_dwordx4 v[176:179], v13, s[32:35], s57 offen offset:1024 sc1
s_add_u32 s57, s57, 2048
s_and_b32 s57, s57, 0x7fff
v_mfma_f32_16x16x32_bf16 v[44:47], v[112:115], v[192:195], v[44:47]
ds_read_b64_tr_b16 v[238:239], v16 offset:29184
v_mfma_f32_16x16x32_bf16 v[32:35], v[116:119], v[188:191], v[32:35]
ds_read_b64_tr_b16 v[240:241], v17 offset:28672
v_mfma_f32_16x16x32_bf16 v[48:51], v[116:119], v[192:195], v[48:51]
ds_read_b64_tr_b16 v[242:243], v17 offset:29184
s_waitcnt vmcnt(10) lgkmcnt(8)
v_mfma_f32_16x16x32_bf16 v[20:23], v[212:215], v[196:199], v[20:23]
ds_read_b64_tr_b16 v[104:105], v14 offset:32768
ds_read_b64_tr_b16 v[106:107], v14 offset:33280
v_mfma_f32_16x16x32_bf16 v[36:39], v[212:215], v[200:203], v[36:39]
buffer_load_dwordx4 v[180:183], v12, s[32:35], s57 offen sc1
v_mfma_f32_16x16x32_bf16 v[24:27], v[216:219], v[196:199], v[24:27]
ds_read_b64_tr_b16 v[108:109], v15 offset:32768
v_mfma_f32_16x16x32_bf16 v[40:43], v[216:219], v[200:203], v[40:43]
ds_read_b64_tr_b16 v[110:111], v15 offset:33280
v_mfma_f32_16x16x32_bf16 v[28:31], v[220:223], v[196:199], v[28:31]
ds_read_b64_tr_b16 v[112:113], v16 offset:32768
buffer_load_dwordx4 v[184:187], v13, s[32:35], s57 offen sc1
v_mfma_f32_16x16x32_bf16 v[44:47], v[220:223], v[200:203], v[44:47]
ds_read_b64_tr_b16 v[114:115], v16 offset:33280
v_mfma_f32_16x16x32_bf16 v[32:35], v[224:227], v[196:199], v[32:35]
ds_read_b64_tr_b16 v[116:117], v17 offset:32768
v_mfma_f32_16x16x32_bf16 v[48:51], v[224:227], v[200:203], v[48:51]
ds_read_b64_tr_b16 v[118:119], v17 offset:33280
s_waitcnt vmcnt(10) lgkmcnt(8)
v_mfma_f32_16x16x32_bf16 v[20:23], v[228:231], v[204:207], v[20:23]
ds_read_b64_tr_b16 v[212:213], v14 offset:36864
ds_read_b64_tr_b16 v[214:215], v14 offset:37376
v_mfma_f32_16x16x32_bf16 v[36:39], v[228:231], v[208:211], v[36:39]
buffer_load_dwordx4 v[188:191], v12, s[32:35], s57 offen offset:1024 sc1
v_mfma_f32_16x16x32_bf16 v[24:27], v[232:235], v[204:207], v[24:27]
ds_read_b64_tr_b16 v[216:217], v15 offset:36864
v_mfma_f32_16x16x32_bf16 v[40:43], v[232:235], v[208:211], v[40:43]
ds_read_b64_tr_b16 v[218:219], v15 offset:37376
v_mfma_f32_16x16x32_bf16 v[28:31], v[236:239], v[204:207], v[28:31]
ds_read_b64_tr_b16 v[220:221], v16 offset:36864
buffer_load_dwordx4 v[192:195], v13, s[32:35], s57 offen offset:1024 sc1
s_add_u32 s57, s57, 2048
s_and_b32 s57, s57, 0x7fff
v_mfma_f32_16x16x32_bf16 v[44:47], v[236:239], v[208:211], v[44:47]
ds_read_b64_tr_b16 v[222:223], v16 offset:37376
v_mfma_f32_16x16x32_bf16 v[32:35], v[240:243], v[204:207], v[32:35]
ds_read_b64_tr_b16 v[224:225], v17 offset:36864
v_mfma_f32_16x16x32_bf16 v[48:51], v[240:243], v[208:211], v[48:51]
ds_read_b64_tr_b16 v[226:227], v17 offset:37376
s_waitcnt vmcnt(10) lgkmcnt(8)
v_mfma_f32_16x16x32_bf16 v[20:23], v[104:107], v[148:151], v[20:23]
ds_read_b64_tr_b16 v[228:229], v14 offset:40960
ds_read_b64_tr_b16 v[230:231], v14 offset:41472
v_mfma_f32_16x16x32_bf16 v[36:39], v[104:107], v[152:155], v[36:39]
buffer_load_dwordx4 v[196:199], v12, s[32:35], s57 offen sc1
v_mfma_f32_16x16x32_bf16 v[24:27], v[108:111], v[148:151], v[24:27]
ds_read_b64_tr_b16 v[232:233], v15 offset:40960
v_mfma_f32_16x16x32_bf16 v[40:43], v[108:111], v[152:155], v[40:43]
ds_read_b64_tr_b16 v[234:235], v15 offset:41472
v_mfma_f32_16x16x32_bf16 v[28:31], v[112:115], v[148:151], v[28:31]
ds_read_b64_tr_b16 v[236:237], v16 offset:40960
buffer_load_dwordx4 v[200:203], v13, s[32:35], s57 offen sc1
v_mfma_f32_16x16x32_bf16 v[44:47], v[112:115], v[152:155], v[44:47]
ds_read_b64_tr_b16 v[238:239], v16 offset:41472
v_mfma_f32_16x16x32_bf16 v[32:35], v[116:119], v[148:151], v[32:35]
ds_read_b64_tr_b16 v[240:241], v17 offset:40960
v_mfma_f32_16x16x32_bf16 v[48:51], v[116:119], v[152:155], v[48:51]
ds_read_b64_tr_b16 v[242:243], v17 offset:41472
s_waitcnt vmcnt(10) lgkmcnt(8)
v_mfma_f32_16x16x32_bf16 v[20:23], v[212:215], v[156:159], v[20:23]
ds_read_b64_tr_b16 v[104:105], v14 offset:45056
ds_read_b64_tr_b16 v[106:107], v14 offset:45568
v_mfma_f32_16x16x32_bf16 v[36:39], v[212:215], v[160:163], v[36:39]
buffer_load_dwordx4 v[204:207], v12, s[32:35], s57 offen offset:1024 sc1
v_mfma_f32_16x16x32_bf16 v[24:27], v[216:219], v[156:159], v[24:27]
ds_read_b64_tr_b16 v[108:109], v15 offset:45056
v_mfma_f32_16x16x32_bf16 v[40:43], v[216:219], v[160:163], v[40:43]
ds_read_b64_tr_b16 v[110:111], v15 offset:45568
v_mfma_f32_16x16x32_bf16 v[28:31], v[220:223], v[156:159], v[28:31]
ds_read_b64_tr_b16 v[112:113], v16 offset:45056
buffer_load_dwordx4 v[208:211], v13, s[32:35], s57 offen offset:1024 sc1
s_add_u32 s57, s57, 2048
s_and_b32 s57, s57, 0x7fff
v_mfma_f32_16x16x32_bf16 v[44:47], v[220:223], v[160:163], v[44:47]
ds_read_b64_tr_b16 v[114:115], v16 offset:45568
v_mfma_f32_16x16x32_bf16 v[32:35], v[224:227], v[156:159], v[32:35]
ds_read_b64_tr_b16 v[116:117], v17 offset:45056
v_mfma_f32_16x16x32_bf16 v[48:51], v[224:227], v[160:163], v[48:51]
ds_read_b64_tr_b16 v[118:119], v17 offset:45568
s_waitcnt vmcnt(10) lgkmcnt(8)
v_mfma_f32_16x16x32_bf16 v[20:23], v[228:231], v[164:167], v[20:23]
ds_read_b64_tr_b16 v[212:213], v14 offset:49152
ds_read_b64_tr_b16 v[214:215], v14 offset:49664
v_mfma_f32_16x16x32_bf16 v[36:39], v[228:231], v[168:171], v[36:39]
buffer_load_dwordx4 v[148:151], v12, s[32:35], s57 offen sc1
v_mfma_f32_16x16x32_bf16 v[24:27], v[232:235], v[164:167], v[24:27]
ds_read_b64_tr_b16 v[216:217], v15 offset:49152
v_mfma_f32_16x16x32_bf16 v[40:43], v[232:235], v[168:171], v[40:43]
ds_read_b64_tr_b16 v[218:219], v15 offset:49664
v_mfma_f32_16x16x32_bf16 v[28:31], v[236:239], v[164:167], v[28:31]
ds_read_b64_tr_b16 v[220:221], v16 offset:49152
buffer_load_dwordx4 v[152:155], v13, s[32:35], s57 offen sc1
v_mfma_f32_16x16x32_bf16 v[44:47], v[236:239], v[168:171], v[44:47]
ds_read_b64_tr_b16 v[222:223], v16 offset:49664
v_mfma_f32_16x16x32_bf16 v[32:35], v[240:243], v[164:167], v[32:35]
ds_read_b64_tr_b16 v[224:225], v17 offset:49152
v_mfma_f32_16x16x32_bf16 v[48:51], v[240:243], v[168:171], v[48:51]
ds_read_b64_tr_b16 v[226:227], v17 offset:49664
s_waitcnt vmcnt(10) lgkmcnt(8)
v_mfma_f32_16x16x32_bf16 v[20:23], v[104:107], v[172:175], v[20:23]
ds_read_b64_tr_b16 v[228:229], v14 offset:53248
ds_read_b64_tr_b16 v[230:231], v14 offset:53760
v_mfma_f32_16x16x32_bf16 v[36:39], v[104:107], v[176:179], v[36:39]
buffer_load_dwordx4 v[156:159], v12, s[32:35], s57 offen offset:1024 sc1
v_mfma_f32_16x16x32_bf16 v[24:27], v[108:111], v[172:175], v[24:27]
ds_read_b64_tr_b16 v[232:233], v15 offset:53248
v_mfma_f32_16x16x32_bf16 v[40:43], v[108:111], v[176:179], v[40:43]
ds_read_b64_tr_b16 v[234:235], v15 offset:53760
v_mfma_f32_16x16x32_bf16 v[28:31], v[112:115], v[172:175], v[28:31]
ds_read_b64_tr_b16 v[236:237], v16 offset:53248
buffer_load_dwordx4 v[160:163], v13, s[32:35], s57 offen offset:1024 sc1
s_add_u32 s57, s57, 2048
s_and_b32 s57, s57, 0x7fff
v_mfma_f32_16x16x32_bf16 v[44:47], v[112:115], v[176:179], v[44:47]
ds_read_b64_tr_b16 v[238:239], v16 offset:53760
v_mfma_f32_16x16x32_bf16 v[32:35], v[116:119], v[172:175], v[32:35]
ds_read_b64_tr_b16 v[240:241], v17 offset:53248
v_mfma_f32_16x16x32_bf16 v[48:51], v[116:119], v[176:179], v[48:51]
ds_read_b64_tr_b16 v[242:243], v17 offset:53760
s_waitcnt vmcnt(10) lgkmcnt(8)
v_mfma_f32_16x16x32_bf16 v[20:23], v[212:215], v[180:183], v[20:23]
ds_read_b64_tr_b16 v[104:105], v14 offset:57344
ds_read_b64_tr_b16 v[106:107], v14 offset:57856
v_mfma_f32_16x16x32_bf16 v[36:39], v[212:215], v[184:187], v[36:39]
buffer_load_dwordx4 v[164:167], v12, s[32:35], s57 offen sc1
v_mfma_f32_16x16x32_bf16 v[24:27], v[216:219], v[180:183], v[24:27]
ds_read_b64_tr_b16 v[108:109], v15 offset:57344
v_mfma_f32_16x16x32_bf16 v[40:43], v[216:219], v[184:187], v[40:43]
ds_read_b64_tr_b16 v[110:111], v15 offset:57856
v_mfma_f32_16x16x32_bf16 v[28:31], v[220:223], v[180:183], v[28:31]
ds_read_b64_tr_b16 v[112:113], v16 offset:57344
buffer_load_dwordx4 v[168:171], v13, s[32:35], s57 offen sc1
v_mfma_f32_16x16x32_bf16 v[44:47], v[220:223], v[184:187], v[44:47]
ds_read_b64_tr_b16 v[114:115], v16 offset:57856
v_mfma_f32_16x16x32_bf16 v[32:35], v[224:227], v[180:183], v[32:35]
ds_read_b64_tr_b16 v[116:117], v17 offset:57344
v_mfma_f32_16x16x32_bf16 v[48:51], v[224:227], v[184:187], v[48:51]
ds_read_b64_tr_b16 v[118:119], v17 offset:57856
s_waitcnt vmcnt(10) lgkmcnt(8)
v_mfma_f32_16x16x32_bf16 v[20:23], v[228:231], v[188:191], v[20:23]
ds_read_b64_tr_b16 v[212:213], v14 offset:61440
ds_read_b64_tr_b16 v[214:215], v14 offset:61952
v_mfma_f32_16x16x32_bf16 v[36:39], v[228:231], v[192:195], v[36:39]
buffer_load_dwordx4 v[172:175], v12, s[32:35], s57 offen offset:1024 sc1
v_mfma_f32_16x16x32_bf16 v[24:27], v[232:235], v[188:191], v[24:27]
ds_read_b64_tr_b16 v[216:217], v15 offset:61440
v_mfma_f32_16x16x32_bf16 v[40:43], v[232:235], v[192:195], v[40:43]
ds_read_b64_tr_b16 v[218:219], v15 offset:61952
v_mfma_f32_16x16x32_bf16 v[28:31], v[236:239], v[188:191], v[28:31]
ds_read_b64_tr_b16 v[220:221], v16 offset:61440
buffer_load_dwordx4 v[176:179], v13, s[32:35], s57 offen offset:1024 sc1
s_add_u32 s57, s57, 2048
s_and_b32 s57, s57, 0x7fff
v_mfma_f32_16x16x32_bf16 v[44:47], v[236:239], v[192:195], v[44:47]
ds_read_b64_tr_b16 v[222:223], v16 offset:61952
v_mfma_f32_16x16x32_bf16 v[32:35], v[240:243], v[188:191], v[32:35]
ds_read_b64_tr_b16 v[224:225], v17 offset:61440
v_mfma_f32_16x16x32_bf16 v[48:51], v[240:243], v[192:195], v[48:51]
ds_read_b64_tr_b16 v[226:227], v17 offset:61952
s_waitcnt vmcnt(10) lgkmcnt(8)
v_mfma_f32_16x16x32_bf16 v[20:23], v[104:107], v[196:199], v[20:23]
ds_read_b64_tr_b16 v[228:229], v52 offset:0
ds_read_b64_tr_b16 v[230:231], v52 offset:512
v_mfma_f32_16x16x32_bf16 v[36:39], v[104:107], v[200:203], v[36:39]
buffer_load_dwordx4 v[180:183], v12, s[32:35], s57 offen sc1
v_mfma_f32_16x16x32_bf16 v[24:27], v[108:111], v[196:199], v[24:27]
ds_read_b64_tr_b16 v[232:233], v53 offset:0
v_mfma_f32_16x16x32_bf16 v[40:43], v[108:111], v[200:203], v[40:43]
ds_read_b64_tr_b16 v[234:235], v53 offset:512
v_mfma_f32_16x16x32_bf16 v[28:31], v[112:115], v[196:199], v[28:31]
ds_read_b64_tr_b16 v[236:237], v54 offset:0
buffer_load_dwordx4 v[184:187], v13, s[32:35], s57 offen sc1
v_mfma_f32_16x16x32_bf16 v[44:47], v[112:115], v[200:203], v[44:47]
ds_read_b64_tr_b16 v[238:239], v54 offset:512
v_mfma_f32_16x16x32_bf16 v[32:35], v[116:119], v[196:199], v[32:35]
ds_read_b64_tr_b16 v[240:241], v55 offset:0
v_mfma_f32_16x16x32_bf16 v[48:51], v[116:119], v[200:203], v[48:51]
ds_read_b64_tr_b16 v[242:243], v55 offset:512
s_waitcnt vmcnt(10) lgkmcnt(8)
v_mfma_f32_16x16x32_bf16 v[20:23], v[212:215], v[204:207], v[20:23]
ds_read_b64_tr_b16 v[104:105], v52 offset:4096
ds_read_b64_tr_b16 v[106:107], v52 offset:4608
v_mfma_f32_16x16x32_bf16 v[36:39], v[212:215], v[208:211], v[36:39]
buffer_load_dwordx4 v[188:191], v12, s[32:35], s57 offen offset:1024 sc1
v_mfma_f32_16x16x32_bf16 v[24:27], v[216:219], v[204:207], v[24:27]
ds_read_b64_tr_b16 v[108:109], v53 offset:4096
v_mfma_f32_16x16x32_bf16 v[40:43], v[216:219], v[208:211], v[40:43]
ds_read_b64_tr_b16 v[110:111], v53 offset:4608
v_mfma_f32_16x16x32_bf16 v[28:31], v[220:223], v[204:207], v[28:31]
ds_read_b64_tr_b16 v[112:113], v54 offset:4096
buffer_load_dwordx4 v[192:195], v13, s[32:35], s57 offen offset:1024 sc1
s_add_u32 s57, s57, 2048
s_and_b32 s57, s57, 0x7fff
v_mfma_f32_16x16x32_bf16 v[44:47], v[220:223], v[208:211], v[44:47]
ds_read_b64_tr_b16 v[114:115], v54 offset:4608
v_mfma_f32_16x16x32_bf16 v[32:35], v[224:227], v[204:207], v[32:35]
ds_read_b64_tr_b16 v[116:117], v55 offset:4096
v_mfma_f32_16x16x32_bf16 v[48:51], v[224:227], v[208:211], v[48:51]
ds_read_b64_tr_b16 v[118:119], v55 offset:4608
s_waitcnt vmcnt(10) lgkmcnt(8)
v_mfma_f32_16x16x32_bf16 v[20:23], v[228:231], v[148:151], v[20:23]
ds_read_b64_tr_b16 v[212:213], v52 offset:8192
ds_read_b64_tr_b16 v[214:215], v52 offset:8704
v_mfma_f32_16x16x32_bf16 v[36:39], v[228:231], v[152:155], v[36:39]
buffer_load_dwordx4 v[196:199], v12, s[32:35], s57 offen sc1
v_mfma_f32_16x16x32_bf16 v[24:27], v[232:235], v[148:151], v[24:27]
ds_read_b64_tr_b16 v[216:217], v53 offset:8192
v_mfma_f32_16x16x32_bf16 v[40:43], v[232:235], v[152:155], v[40:43]
ds_read_b64_tr_b16 v[218:219], v53 offset:8704
v_mfma_f32_16x16x32_bf16 v[28:31], v[236:239], v[148:151], v[28:31]
ds_read_b64_tr_b16 v[220:221], v54 offset:8192
buffer_load_dwordx4 v[200:203], v13, s[32:35], s57 offen sc1
v_mfma_f32_16x16x32_bf16 v[44:47], v[236:239], v[152:155], v[44:47]
ds_read_b64_tr_b16 v[222:223], v54 offset:8704
v_mfma_f32_16x16x32_bf16 v[32:35], v[240:243], v[148:151], v[32:35]
ds_read_b64_tr_b16 v[224:225], v55 offset:8192
v_mfma_f32_16x16x32_bf16 v[48:51], v[240:243], v[152:155], v[48:51]
ds_read_b64_tr_b16 v[226:227], v55 offset:8704
s_waitcnt vmcnt(10) lgkmcnt(8)
v_mfma_f32_16x16x32_bf16 v[20:23], v[104:107], v[156:159], v[20:23]
ds_read_b64_tr_b16 v[228:229], v52 offset:12288
ds_read_b64_tr_b16 v[230:231], v52 offset:12800
v_mfma_f32_16x16x32_bf16 v[36:39], v[104:107], v[160:163], v[36:39]
buffer_load_dwordx4 v[204:207], v12, s[32:35], s57 offen offset:1024 sc1
v_mfma_f32_16x16x32_bf16 v[24:27], v[108:111], v[156:159], v[24:27]
ds_read_b64_tr_b16 v[232:233], v53 offset:12288
v_mfma_f32_16x16x32_bf16 v[40:43], v[108:111], v[160:163], v[40:43]
ds_read_b64_tr_b16 v[234:235], v53 offset:12800
v_mfma_f32_16x16x32_bf16 v[28:31], v[112:115], v[156:159], v[28:31]
ds_read_b64_tr_b16 v[236:237], v54 offset:12288
buffer_load_dwordx4 v[208:211], v13, s[32:35], s57 offen offset:1024 sc1
s_add_u32 s57, s57, 2048
s_and_b32 s57, s57, 0x7fff
v_mfma_f32_16x16x32_bf16 v[44:47], v[112:115], v[160:163], v[44:47]
ds_read_b64_tr_b16 v[238:239], v54 offset:12800
v_mfma_f32_16x16x32_bf16 v[32:35], v[116:119], v[156:159], v[32:35]
ds_read_b64_tr_b16 v[240:241], v55 offset:12288
v_mfma_f32_16x16x32_bf16 v[48:51], v[116:119], v[160:163], v[48:51]
ds_read_b64_tr_b16 v[242:243], v55 offset:12800
s_waitcnt vmcnt(10) lgkmcnt(8)
v_mfma_f32_16x16x32_bf16 v[20:23], v[212:215], v[164:167], v[20:23]
ds_read_b64_tr_b16 v[104:105], v52 offset:16384
ds_read_b64_tr_b16 v[106:107], v52 offset:16896
v_mfma_f32_16x16x32_bf16 v[36:39], v[212:215], v[168:171], v[36:39]
buffer_load_dwordx4 v[148:151], v12, s[32:35], s57 offen sc1
v_mfma_f32_16x16x32_bf16 v[24:27], v[216:219], v[164:167], v[24:27]
ds_read_b64_tr_b16 v[108:109], v53 offset:16384
v_mfma_f32_16x16x32_bf16 v[40:43], v[216:219], v[168:171], v[40:43]
ds_read_b64_tr_b16 v[110:111], v53 offset:16896
v_mfma_f32_16x16x32_bf16 v[28:31], v[220:223], v[164:167], v[28:31]
ds_read_b64_tr_b16 v[112:113], v54 offset:16384
buffer_load_dwordx4 v[152:155], v13, s[32:35], s57 offen sc1
v_mfma_f32_16x16x32_bf16 v[44:47], v[220:223], v[168:171], v[44:47]
ds_read_b64_tr_b16 v[114:115], v54 offset:16896
v_mfma_f32_16x16x32_bf16 v[32:35], v[224:227], v[164:167], v[32:35]
ds_read_b64_tr_b16 v[116:117], v55 offset:16384
v_mfma_f32_16x16x32_bf16 v[48:51], v[224:227], v[168:171], v[48:51]
ds_read_b64_tr_b16 v[118:119], v55 offset:16896
s_waitcnt vmcnt(10) lgkmcnt(8)
v_mfma_f32_16x16x32_bf16 v[20:23], v[228:231], v[172:175], v[20:23]
ds_read_b64_tr_b16 v[212:213], v52 offset:20480
ds_read_b64_tr_b16 v[214:215], v52 offset:20992
v_mfma_f32_16x16x32_bf16 v[36:39], v[228:231], v[176:179], v[36:39]
buffer_load_dwordx4 v[156:159], v12, s[32:35], s57 offen offset:1024 sc1
v_mfma_f32_16x16x32_bf16 v[24:27], v[232:235], v[172:175], v[24:27]
ds_read_b64_tr_b16 v[216:217], v53 offset:20480
v_mfma_f32_16x16x32_bf16 v[40:43], v[232:235], v[176:179], v[40:43]
ds_read_b64_tr_b16 v[218:219], v53 offset:20992
v_mfma_f32_16x16x32_bf16 v[28:31], v[236:239], v[172:175], v[28:31]
ds_read_b64_tr_b16 v[220:221], v54 offset:20480
buffer_load_dwordx4 v[160:163], v13, s[32:35], s57 offen offset:1024 sc1
s_add_u32 s57, s57, 2048
s_and_b32 s57, s57, 0x7fff
v_mfma_f32_16x16x32_bf16 v[44:47], v[236:239], v[176:179], v[44:47]
ds_read_b64_tr_b16 v[222:223], v54 offset:20992
v_mfma_f32_16x16x32_bf16 v[32:35], v[240:243], v[172:175], v[32:35]
ds_read_b64_tr_b16 v[224:225], v55 offset:20480
v_mfma_f32_16x16x32_bf16 v[48:51], v[240:243], v[176:179], v[48:51]
ds_read_b64_tr_b16 v[226:227], v55 offset:20992
s_waitcnt vmcnt(10) lgkmcnt(8)
v_mfma_f32_16x16x32_bf16 v[20:23], v[104:107], v[180:183], v[20:23]
ds_read_b64_tr_b16 v[228:229], v52 offset:24576
ds_read_b64_tr_b16 v[230:231], v52 offset:25088
v_mfma_f32_16x16x32_bf16 v[36:39], v[104:107], v[184:187], v[36:39]
buffer_load_dwordx4 v[164:167], v12, s[32:35], s57 offen sc1
v_mfma_f32_16x16x32_bf16 v[24:27], v[108:111], v[180:183], v[24:27]
ds_read_b64_tr_b16 v[232:233], v53 offset:24576
v_mfma_f32_16x16x32_bf16 v[40:43], v[108:111], v[184:187], v[40:43]
ds_read_b64_tr_b16 v[234:235], v53 offset:25088
v_mfma_f32_16x16x32_bf16 v[28:31], v[112:115], v[180:183], v[28:31]
ds_read_b64_tr_b16 v[236:237], v54 offset:24576
buffer_load_dwordx4 v[168:171], v13, s[32:35], s57 offen sc1
v_mfma_f32_16x16x32_bf16 v[44:47], v[112:115], v[184:187], v[44:47]
ds_read_b64_tr_b16 v[238:239], v54 offset:25088
v_mfma_f32_16x16x32_bf16 v[32:35], v[116:119], v[180:183], v[32:35]
ds_read_b64_tr_b16 v[240:241], v55 offset:24576
v_mfma_f32_16x16x32_bf16 v[48:51], v[116:119], v[184:187], v[48:51]
ds_read_b64_tr_b16 v[242:243], v55 offset:25088
s_waitcnt vmcnt(10) lgkmcnt(8)
v_mfma_f32_16x16x32_bf16 v[20:23], v[212:215], v[188:191], v[20:23]
ds_read_b64_tr_b16 v[104:105], v52 offset:28672
ds_read_b64_tr_b16 v[106:107], v52 offset:29184
v_mfma_f32_16x16x32_bf16 v[36:39], v[212:215], v[192:195], v[36:39]
buffer_load_dwordx4 v[172:175], v12, s[32:35], s57 offen offset:1024 sc1
v_mfma_f32_16x16x32_bf16 v[24:27], v[216:219], v[188:191], v[24:27]
ds_read_b64_tr_b16 v[108:109], v53 offset:28672
v_mfma_f32_16x16x32_bf16 v[40:43], v[216:219], v[192:195], v[40:43]
ds_read_b64_tr_b16 v[110:111], v53 offset:29184
v_mfma_f32_16x16x32_bf16 v[28:31], v[220:223], v[188:191], v[28:31]
ds_read_b64_tr_b16 v[112:113], v54 offset:28672
buffer_load_dwordx4 v[176:179], v13, s[32:35], s57 offen offset:1024 sc1
s_add_u32 s57, s57, 2048
s_and_b32 s57, s57, 0x7fff
v_mfma_f32_16x16x32_bf16 v[44:47], v[220:223], v[192:195], v[44:47]
ds_read_b64_tr_b16 v[114:115], v54 offset:29184
v_mfma_f32_16x16x32_bf16 v[32:35], v[224:227], v[188:191], v[32:35]
ds_read_b64_tr_b16 v[116:117], v55 offset:28672
v_mfma_f32_16x16x32_bf16 v[48:51], v[224:227], v[192:195], v[48:51]
ds_read_b64_tr_b16 v[118:119], v55 offset:29184
s_waitcnt vmcnt(10) lgkmcnt(8)
v_mfma_f32_16x16x32_bf16 v[20:23], v[228:231], v[196:199], v[20:23]
ds_read_b64_tr_b16 v[212:213], v52 offset:32768
ds_read_b64_tr_b16 v[214:215], v52 offset:33280
v_mfma_f32_16x16x32_bf16 v[36:39], v[228:231], v[200:203], v[36:39]
buffer_load_dwordx4 v[180:183], v12, s[32:35], s57 offen sc1
v_mfma_f32_16x16x32_bf16 v[24:27], v[232:235], v[196:199], v[24:27]
ds_read_b64_tr_b16 v[216:217], v53 offset:32768
v_mfma_f32_16x16x32_bf16 v[40:43], v[232:235], v[200:203], v[40:43]
ds_read_b64_tr_b16 v[218:219], v53 offset:33280
v_mfma_f32_16x16x32_bf16 v[28:31], v[236:239], v[196:199], v[28:31]
ds_read_b64_tr_b16 v[220:221], v54 offset:32768
buffer_load_dwordx4 v[184:187], v13, s[32:35], s57 offen sc1
v_mfma_f32_16x16x32_bf16 v[44:47], v[236:239], v[200:203], v[44:47]
ds_read_b64_tr_b16 v[222:223], v54 offset:33280
v_mfma_f32_16x16x32_bf16 v[32:35], v[240:243], v[196:199], v[32:35]
ds_read_b64_tr_b16 v[224:225], v55 offset:32768
v_mfma_f32_16x16x32_bf16 v[48:51], v[240:243], v[200:203], v[48:51]
ds_read_b64_tr_b16 v[226:227], v55 offset:33280
s_waitcnt vmcnt(10) lgkmcnt(8)
v_mfma_f32_16x16x32_bf16 v[20:23], v[104:107], v[204:207], v[20:23]
ds_read_b64_tr_b16 v[228:229], v52 offset:36864
ds_read_b64_tr_b16 v[230:231], v52 offset:37376
v_mfma_f32_16x16x32_bf16 v[36:39], v[104:107], v[208:211], v[36:39]
buffer_load_dwordx4 v[188:191], v12, s[32:35], s57 offen offset:1024 sc1
v_mfma_f32_16x16x32_bf16 v[24:27], v[108:111], v[204:207], v[24:27]
ds_read_b64_tr_b16 v[232:233], v53 offset:36864
v_mfma_f32_16x16x32_bf16 v[40:43], v[108:111], v[208:211], v[40:43]
ds_read_b64_tr_b16 v[234:235], v53 offset:37376
v_mfma_f32_16x16x32_bf16 v[28:31], v[112:115], v[204:207], v[28:31]
ds_read_b64_tr_b16 v[236:237], v54 offset:36864
buffer_load_dwordx4 v[192:195], v13, s[32:35], s57 offen offset:1024 sc1
s_add_u32 s57, s57, 2048
s_and_b32 s57, s57, 0x7fff
v_mfma_f32_16x16x32_bf16 v[44:47], v[112:115], v[208:211], v[44:47]
ds_read_b64_tr_b16 v[238:239], v54 offset:37376
v_mfma_f32_16x16x32_bf16 v[32:35], v[116:119], v[204:207], v[32:35]
ds_read_b64_tr_b16 v[240:241], v55 offset:36864
v_mfma_f32_16x16x32_bf16 v[48:51], v[116:119], v[208:211], v[48:51]
ds_read_b64_tr_b16 v[242:243], v55 offset:37376
s_waitcnt vmcnt(10) lgkmcnt(8)
v_mfma_f32_16x16x32_bf16 v[20:23], v[212:215], v[148:151], v[20:23]
ds_read_b64_tr_b16 v[104:105], v52 offset:40960
ds_read_b64_tr_b16 v[106:107], v52 offset:41472
v_mfma_f32_16x16x32_bf16 v[36:39], v[212:215], v[152:155], v[36:39]
buffer_load_dwordx4 v[196:199], v12, s[32:35], s57 offen sc1
v_mfma_f32_16x16x32_bf16 v[24:27], v[216:219], v[148:151], v[24:27]
ds_read_b64_tr_b16 v[108:109], v53 offset:40960
v_mfma_f32_16x16x32_bf16 v[40:43], v[216:219], v[152:155], v[40:43]
ds_read_b64_tr_b16 v[110:111], v53 offset:41472
v_mfma_f32_16x16x32_bf16 v[28:31], v[220:223], v[148:151], v[28:31]
ds_read_b64_tr_b16 v[112:113], v54 offset:40960
buffer_load_dwordx4 v[200:203], v13, s[32:35], s57 offen sc1
v_mfma_f32_16x16x32_bf16 v[44:47], v[220:223], v[152:155], v[44:47]
ds_read_b64_tr_b16 v[114:115], v54 offset:41472
v_mfma_f32_16x16x32_bf16 v[32:35], v[224:227], v[148:151], v[32:35]
ds_read_b64_tr_b16 v[116:117], v55 offset:40960
v_mfma_f32_16x16x32_bf16 v[48:51], v[224:227], v[152:155], v[48:51]
ds_read_b64_tr_b16 v[118:119], v55 offset:41472
s_waitcnt vmcnt(10) lgkmcnt(8)
v_mfma_f32_16x16x32_bf16 v[20:23], v[228:231], v[156:159], v[20:23]
ds_read_b64_tr_b16 v[212:213], v52 offset:45056
ds_read_b64_tr_b16 v[214:215], v52 offset:45568
v_mfma_f32_16x16x32_bf16 v[36:39], v[228:231], v[160:163], v[36:39]
buffer_load_dwordx4 v[204:207], v12, s[32:35], s57 offen offset:1024 sc1
v_mfma_f32_16x16x32_bf16 v[24:27], v[232:235], v[156:159], v[24:27]
ds_read_b64_tr_b16 v[216:217], v53 offset:45056
v_mfma_f32_16x16x32_bf16 v[40:43], v[232:235], v[160:163], v[40:43]
ds_read_b64_tr_b16 v[218:219], v53 offset:45568
v_mfma_f32_16x16x32_bf16 v[28:31], v[236:239], v[156:159], v[28:31]
ds_read_b64_tr_b16 v[220:221], v54 offset:45056
buffer_load_dwordx4 v[208:211], v13, s[32:35], s57 offen offset:1024 sc1
s_add_u32 s57, s57, 2048
s_and_b32 s57, s57, 0x7fff
v_mfma_f32_16x16x32_bf16 v[44:47], v[236:239], v[160:163], v[44:47]
ds_read_b64_tr_b16 v[222:223], v54 offset:45568
v_mfma_f32_16x16x32_bf16 v[32:35], v[240:243], v[156:159], v[32:35]
ds_read_b64_tr_b16 v[224:225], v55 offset:45056
v_mfma_f32_16x16x32_bf16 v[48:51], v[240:243], v[160:163], v[48:51]
ds_read_b64_tr_b16 v[226:227], v55 offset:45568
s_waitcnt vmcnt(10) lgkmcnt(8)
v_mfma_f32_16x16x32_bf16 v[20:23], v[104:107], v[164:167], v[20:23]
ds_read_b64_tr_b16 v[228:229], v52 offset:49152
v_mfma_f32_16x16x32_bf16 v[36:39], v[104:107], v[168:171], v[36:39]
ds_read_b64_tr_b16 v[230:231], v52 offset:49664
v_mfma_f32_16x16x32_bf16 v[24:27], v[108:111], v[164:167], v[24:27]
ds_read_b64_tr_b16 v[232:233], v53 offset:49152
v_mfma_f32_16x16x32_bf16 v[40:43], v[108:111], v[168:171], v[40:43]
ds_read_b64_tr_b16 v[234:235], v53 offset:49664
v_mfma_f32_16x16x32_bf16 v[28:31], v[112:115], v[164:167], v[28:31]
ds_read_b64_tr_b16 v[236:237], v54 offset:49152
v_mfma_f32_16x16x32_bf16 v[44:47], v[112:115], v[168:171], v[44:47]
ds_read_b64_tr_b16 v[238:239], v54 offset:49664
v_mfma_f32_16x16x32_bf16 v[32:35], v[116:119], v[164:167], v[32:35]
ds_read_b64_tr_b16 v[240:241], v55 offset:49152
v_mfma_f32_16x16x32_bf16 v[48:51], v[116:119], v[168:171], v[48:51]
ds_read_b64_tr_b16 v[242:243], v55 offset:49664
s_waitcnt vmcnt(8) lgkmcnt(8)
v_mfma_f32_16x16x32_bf16 v[20:23], v[212:215], v[172:175], v[20:23]
ds_read_b64_tr_b16 v[104:105], v52 offset:53248
v_mfma_f32_16x16x32_bf16 v[36:39], v[212:215], v[176:179], v[36:39]
ds_read_b64_tr_b16 v[106:107], v52 offset:53760
v_mfma_f32_16x16x32_bf16 v[24:27], v[216:219], v[172:175], v[24:27]
ds_read_b64_tr_b16 v[108:109], v53 offset:53248
v_mfma_f32_16x16x32_bf16 v[40:43], v[216:219], v[176:179], v[40:43]
ds_read_b64_tr_b16 v[110:111], v53 offset:53760
v_mfma_f32_16x16x32_bf16 v[28:31], v[220:223], v[172:175], v[28:31]
ds_read_b64_tr_b16 v[112:113], v54 offset:53248
v_mfma_f32_16x16x32_bf16 v[44:47], v[220:223], v[176:179], v[44:47]
ds_read_b64_tr_b16 v[114:115], v54 offset:53760
v_mfma_f32_16x16x32_bf16 v[32:35], v[224:227], v[172:175], v[32:35]
ds_read_b64_tr_b16 v[116:117], v55 offset:53248
v_mfma_f32_16x16x32_bf16 v[48:51], v[224:227], v[176:179], v[48:51]
ds_read_b64_tr_b16 v[118:119], v55 offset:53760
s_waitcnt vmcnt(6) lgkmcnt(8)
v_mfma_f32_16x16x32_bf16 v[20:23], v[228:231], v[180:183], v[20:23]
ds_read_b64_tr_b16 v[212:213], v52 offset:57344
v_mfma_f32_16x16x32_bf16 v[36:39], v[228:231], v[184:187], v[36:39]
ds_read_b64_tr_b16 v[214:215], v52 offset:57856
v_mfma_f32_16x16x32_bf16 v[24:27], v[232:235], v[180:183], v[24:27]
ds_read_b64_tr_b16 v[216:217], v53 offset:57344
v_mfma_f32_16x16x32_bf16 v[40:43], v[232:235], v[184:187], v[40:43]
ds_read_b64_tr_b16 v[218:219], v53 offset:57856
v_mfma_f32_16x16x32_bf16 v[28:31], v[236:239], v[180:183], v[28:31]
ds_read_b64_tr_b16 v[220:221], v54 offset:57344
v_mfma_f32_16x16x32_bf16 v[44:47], v[236:239], v[184:187], v[44:47]
ds_read_b64_tr_b16 v[222:223], v54 offset:57856
v_mfma_f32_16x16x32_bf16 v[32:35], v[240:243], v[180:183], v[32:35]
ds_read_b64_tr_b16 v[224:225], v55 offset:57344
v_mfma_f32_16x16x32_bf16 v[48:51], v[240:243], v[184:187], v[48:51]
ds_read_b64_tr_b16 v[226:227], v55 offset:57856
s_waitcnt vmcnt(4) lgkmcnt(8)
v_mfma_f32_16x16x32_bf16 v[20:23], v[104:107], v[188:191], v[20:23]
ds_read_b64_tr_b16 v[228:229], v52 offset:61440
v_mfma_f32_16x16x32_bf16 v[36:39], v[104:107], v[192:195], v[36:39]
ds_read_b64_tr_b16 v[230:231], v52 offset:61952
v_mfma_f32_16x16x32_bf16 v[24:27], v[108:111], v[188:191], v[24:27]
ds_read_b64_tr_b16 v[232:233], v53 offset:61440
v_mfma_f32_16x16x32_bf16 v[40:43], v[108:111], v[192:195], v[40:43]
ds_read_b64_tr_b16 v[234:235], v53 offset:61952
v_mfma_f32_16x16x32_bf16 v[28:31], v[112:115], v[188:191], v[28:31]
ds_read_b64_tr_b16 v[236:237], v54 offset:61440
v_mfma_f32_16x16x32_bf16 v[44:47], v[112:115], v[192:195], v[44:47]
ds_read_b64_tr_b16 v[238:239], v54 offset:61952
v_mfma_f32_16x16x32_bf16 v[32:35], v[116:119], v[188:191], v[32:35]
ds_read_b64_tr_b16 v[240:241], v55 offset:61440
v_mfma_f32_16x16x32_bf16 v[48:51], v[116:119], v[192:195], v[48:51]
ds_read_b64_tr_b16 v[242:243], v55 offset:61952
s_waitcnt vmcnt(2) lgkmcnt(8)
v_mfma_f32_16x16x32_bf16 v[20:23], v[212:215], v[196:199], v[20:23]
v_mfma_f32_16x16x32_bf16 v[36:39], v[212:215], v[200:203], v[36:39]
v_mfma_f32_16x16x32_bf16 v[24:27], v[216:219], v[196:199], v[24:27]
v_mfma_f32_16x16x32_bf16 v[40:43], v[216:219], v[200:203], v[40:43]
v_mfma_f32_16x16x32_bf16 v[28:31], v[220:223], v[196:199], v[28:31]
v_mfma_f32_16x16x32_bf16 v[44:47], v[220:223], v[200:203], v[44:47]
v_mfma_f32_16x16x32_bf16 v[32:35], v[224:227], v[196:199], v[32:35]
v_mfma_f32_16x16x32_bf16 v[48:51], v[224:227], v[200:203], v[48:51]
s_waitcnt vmcnt(0) lgkmcnt(0)
v_mfma_f32_16x16x32_bf16 v[20:23], v[228:231], v[204:207], v[20:23]
v_mfma_f32_16x16x32_bf16 v[24:27], v[232:235], v[204:207], v[24:27]
v_mfma_f32_16x16x32_bf16 v[28:31], v[236:239], v[204:207], v[28:31]
v_mfma_f32_16x16x32_bf16 v[32:35], v[240:243], v[204:207], v[32:35]
v_mfma_f32_16x16x32_bf16 v[36:39], v[228:231], v[208:211], v[36:39]
v_mfma_f32_16x16x32_bf16 v[40:43], v[232:235], v[208:211], v[40:43]
v_mfma_f32_16x16x32_bf16 v[44:47], v[236:239], v[208:211], v[44:47]
v_mfma_f32_16x16x32_bf16 v[48:51], v[240:243], v[208:211], v[48:51]
s_cmp_eq_u32 s46, 0
s_cbranch_scc1 slow_63
s_nop 0
v_cvt_pk_bf16_f32 v20, v20, v21
v_cvt_pk_bf16_f32 v21, v22, v23
v_cvt_pk_bf16_f32 v22, v24, v25
v_cvt_pk_bf16_f32 v23, v26, v27
buffer_store_dwordx4 v[20:23], v18, s[32:35], s85 offen offset:0
v_cvt_pk_bf16_f32 v28, v28, v29
v_cvt_pk_bf16_f32 v29, v30, v31
v_cvt_pk_bf16_f32 v30, v32, v33
v_cvt_pk_bf16_f32 v31, v34, v35
buffer_store_dwordx4 v[28:31], v18, s[32:35], s85 offen offset:1024
v_cvt_pk_bf16_f32 v36, v36, v37
v_cvt_pk_bf16_f32 v37, v38, v39
v_cvt_pk_bf16_f32 v38, v40, v41
v_cvt_pk_bf16_f32 v39, v42, v43
buffer_store_dwordx4 v[36:39], v18, s[32:35], s86 offen offset:0
v_cvt_pk_bf16_f32 v44, v44, v45
v_cvt_pk_bf16_f32 v45, v46, v47
v_cvt_pk_bf16_f32 v46, v48, v49
v_cvt_pk_bf16_f32 v47, v50, v51
buffer_store_dwordx4 v[44:47], v18, s[32:35], s86 offen offset:1024
s_cmp_eq_u32 s40, 3
s_cbranch_scc1 w3_65
s_barrier
v_dot2c_f32_bf16 v6, v20, v10
v_dot2c_f32_bf16 v8, v20, v20
v_dot2c_f32_bf16 v7, v36, v10
v_dot2c_f32_bf16 v9, v36, v36
v_dot2c_f32_bf16 v6, v21, v10
v_dot2c_f32_bf16 v8, v21, v21
v_dot2c_f32_bf16 v7, v37, v10
v_dot2c_f32_bf16 v9, v37, v37
v_dot2c_f32_bf16 v6, v22, v10
v_dot2c_f32_bf16 v8, v22, v22
v_dot2c_f32_bf16 v7, v38, v10
v_dot2c_f32_bf16 v9, v38, v38
v_dot2c_f32_bf16 v6, v23, v10
v_dot2c_f32_bf16 v8, v23, v23
v_dot2c_f32_bf16 v7, v39, v10
v_dot2c_f32_bf16 v9, v39, v39
v_dot2c_f32_bf16 v6, v28, v10
v_dot2c_f32_bf16 v8, v28, v28
v_dot2c_f32_bf16 v7, v44, v10
v_dot2c_f32_bf16 v9, v44, v44
v_dot2c_f32_bf16 v6, v29, v10
v_dot2c_f32_bf16 v8, v29, v29
v_dot2c_f32_bf16 v7, v45, v10
v_dot2c_f32_bf16 v9, v45, v45
v_dot2c_f32_bf16 v6, v30, v10
v_dot2c_f32_bf16 v8, v30, v30
v_dot2c_f32_bf16 v7, v46, v10
v_dot2c_f32_bf16 v9, v46, v46
v_dot2c_f32_bf16 v6, v31, v10
v_dot2c_f32_bf16 v8, v31, v31
v_dot2c_f32_bf16 v7, v47, v10
v_dot2c_f32_bf16 v9, v47, v47
s_nop 1
s_nop 1
v_permlane32_swap_b32 v6, v7
v_permlane32_swap_b32 v8, v9
s_nop 0
v_add_f32 v6, v6, v7
v_add_f32 v8, v8, v9
s_nop 1
v_permlane16_swap_b32 v6, v8
s_nop 0
v_add_f32 v6, v6, v8
s_waitcnt vmcnt(0)
s_mov_b64 exec, 1
buffer_store_dword v5, v4, s[32:35], s88 offen
s_mov_b64 exec, -1
buffer_store_dword v6, v1, s[32:35], s87 offen
s_branch fin_66
w3_65:
s_lshl_b32 s53, s41, 15
s_lshl_b32 s54, s42, 11
s_add_u32 s53, s53, s54
s_add_u32 s53, s53, 16908288
buffer_store_dwordx4 v[36:39], v18, s[32:35], s53 offen offset:0 sc1
buffer_store_dwordx4 v[44:47], v18, s[32:35], s53 offen offset:1024 sc1
s_barrier
v_dot2c_f32_bf16 v6, v20, v10
v_dot2c_f32_bf16 v8, v20, v20
v_dot2c_f32_bf16 v7, v36, v10
v_dot2c_f32_bf16 v9, v36, v36
v_dot2c_f32_bf16 v6, v21, v10
v_dot2c_f32_bf16 v8, v21, v21
v_dot2c_f32_bf16 v7, v37, v10
v_dot2c_f32_bf16 v9, v37, v37
v_dot2c_f32_bf16 v6, v22, v10
v_dot2c_f32_bf16 v8, v22, v22
v_dot2c_f32_bf16 v7, v38, v10
v_dot2c_f32_bf16 v9, v38, v38
v_dot2c_f32_bf16 v6, v23, v10
v_dot2c_f32_bf16 v8, v23, v23
v_dot2c_f32_bf16 v7, v39, v10
v_dot2c_f32_bf16 v9, v39, v39
v_dot2c_f32_bf16 v6, v28, v10
v_dot2c_f32_bf16 v8, v28, v28
v_dot2c_f32_bf16 v7, v44, v10
v_dot2c_f32_bf16 v9, v44, v44
v_dot2c_f32_bf16 v6, v29, v10
v_dot2c_f32_bf16 v8, v29, v29
v_dot2c_f32_bf16 v7, v45, v10
v_dot2c_f32_bf16 v9, v45, v45
v_dot2c_f32_bf16 v6, v30, v10
v_dot2c_f32_bf16 v8, v30, v30
v_dot2c_f32_bf16 v7, v46, v10
v_dot2c_f32_bf16 v9, v46, v46
v_dot2c_f32_bf16 v6, v31, v10
v_dot2c_f32_bf16 v8, v31, v31
v_dot2c_f32_bf16 v7, v47, v10
v_dot2c_f32_bf16 v9, v47, v47
s_nop 1
s_nop 1
v_permlane32_swap_b32 v6, v7
v_permlane32_swap_b32 v8, v9
s_nop 0
v_add_f32 v6, v6, v7
v_add_f32 v8, v8, v9
s_nop 1
v_permlane16_swap_b32 v6, v8
s_nop 0
v_add_f32 v6, v6, v8
s_lshl_b32 s54, s41, 4
s_add_u32 s54, s54, s42
s_lshl_b32 s54, s54, 8
s_add_u32 s54, s54, 17760256
s_lshl_b32 s53, s41, 2
s_add_u32 s53, s53, 0
s_lshl_b32 s53, s53, 7
s_add_u32 s53, s53, 18391040
s_waitcnt vmcnt(2)
s_mov_b64 exec, 1
buffer_store_dword v5, v4, s[32:35], s88 offen
s_mov_b64 exec, -1
s_waitcnt vmcnt(1)
s_mov_b64 exec, 1
buffer_store_dword v5, v4, s[32:35], s53 offen sc1
s_mov_b64 exec, -1
buffer_store_dword v6, v1, s[32:35], s87 offen
buffer_store_dword v6, v1, s[32:35], s54 offen sc1
fin_66:
back_64:
v_mov_b32 v10, v18
v_add_u32 v11, 1024, v18
s_lshl_b32 s48, s43, 1
v_lshrrev_b32 v4, 2, v2
v_and_b32 v5, 3, v0
v_lshl_add_u32 v6, v3, 3, v4
v_lshlrev_b32 v6, 7, v6
v_lshl_add_u32 v6, v5, 3, v6
v_lshrrev_b32 v7, 1, v4
v_and_b32 v8, 1, v3
v_lshl_add_u32 v7, v8, 1, v7
v_xor_b32 v7, s48, v7
v_lshl_add_u32 v12, v7, 5, v6
v_add_u32 v12, 18432, v12
v_xor_b32 v13, 32, v12
v_mov_b32 v14, v10
v_mov_b32 v15, v11
v_add_u32 v16, 120832, v12
v_add_u32 v17, 120832, v13
v_mov_b32 v148, 0
v_mov_b32 v149, 0
v_mov_b32 v150, 0
v_mov_b32 v151, 0
v_mov_b32 v152, 0
v_mov_b32 v153, 0
v_mov_b32 v154, 0
v_mov_b32 v155, 0
v_mov_b32 v156, 0
v_mov_b32 v157, 0
v_mov_b32 v158, 0
v_mov_b32 v159, 0
v_mov_b32 v160, 0
v_mov_b32 v161, 0
v_mov_b32 v162, 0
v_mov_b32 v163, 0
v_mov_b32 v164, 0
v_mov_b32 v165, 0
v_mov_b32 v166, 0
v_mov_b32 v167, 0
v_mov_b32 v168, 0
v_mov_b32 v169, 0
v_mov_b32 v170, 0
v_mov_b32 v171, 0
v_mov_b32 v172, 0
v_mov_b32 v173, 0
v_mov_b32 v174, 0
v_mov_b32 v175, 0
v_mov_b32 v176, 0
v_mov_b32 v177, 0
v_mov_b32 v178, 0
v_mov_b32 v179, 0
v_mov_b32 v180, 0
v_mov_b32 v181, 0
v_mov_b32 v182, 0
v_mov_b32 v183, 0
v_mov_b32 v184, 0
v_mov_b32 v185, 0
v_mov_b32 v186, 0
v_mov_b32 v187, 0
v_mov_b32 v188, 0
v_mov_b32 v189, 0
v_mov_b32 v190, 0
v_mov_b32 v191, 0
v_mov_b32 v192, 0
v_mov_b32 v193, 0
v_mov_b32 v194, 0
v_mov_b32 v195, 0
v_mov_b32 v196, 0
v_mov_b32 v197, 0
v_mov_b32 v198, 0
v_mov_b32 v199, 0
v_mov_b32 v200, 0
v_mov_b32 v201, 0
v_mov_b32 v202, 0
v_mov_b32 v203, 0
v_mov_b32 v204, 0
v_mov_b32 v205, 0
v_mov_b32 v206, 0
v_mov_b32 v207, 0
v_mov_b32 v208, 0
v_mov_b32 v209, 0
v_mov_b32 v210, 0
v_mov_b32 v211, 0
v_mov_b32 v212, 0
v_mov_b32 v213, 0
v_mov_b32 v214, 0
v_mov_b32 v215, 0
v_mov_b32 v216, 0
v_mov_b32 v217, 0
v_mov_b32 v218, 0
v_mov_b32 v219, 0
v_mov_b32 v220, 0
v_mov_b32 v221, 0
v_mov_b32 v222, 0
v_mov_b32 v223, 0
v_mov_b32 v224, 0
v_mov_b32 v225, 0
v_mov_b32 v226, 0
v_mov_b32 v227, 0
v_mov_b32 v228, 0
v_mov_b32 v229, 0
v_mov_b32 v230, 0
v_mov_b32 v231, 0
v_mov_b32 v232, 0
v_mov_b32 v233, 0
v_mov_b32 v234, 0
v_mov_b32 v235, 0
v_mov_b32 v236, 0
v_mov_b32 v237, 0
v_mov_b32 v238, 0
v_mov_b32 v239, 0
v_mov_b32 v240, 0
v_mov_b32 v241, 0
v_mov_b32 v242, 0
v_mov_b32 v243, 0
v_mov_b32 v244, 0
v_mov_b32 v245, 0
v_mov_b32 v246, 0
v_mov_b32 v247, 0
v_mov_b32 v248, 0
v_mov_b32 v249, 0
v_mov_b32 v250, 0
v_mov_b32 v251, 0
v_mov_b32 v56, 0x3f803f80
v_mov_b32 v57, 0x3f803f80
v_mov_b32 v58, 0x3f803f80
v_mov_b32 v59, 0x3f803f80
s_mov_b32 s48, 0xf149f2ca
v_mov_b32 v53, s48
v_lshlrev_b32 v4, 2, v3
v_sub_u32 v4, v2, v4
v_subrev_u32 v5, 0, v4
v_and_b32 v6, 0x80000001, v5
v_cmp_eq_u32 vcc, 0, v6
v_add_u32 v5, 1, v5
v_and_b32 v6, 0x80000001, v5
v_cndmask_b32 v44, v53, 0, vcc
v_cmp_eq_u32 vcc, 0x80000001, v6
s_nop 1
v_cndmask_b32 v40, v53, 0, vcc
v_subrev_u32 v5, 1, v4
v_and_b32 v6, 0x80000001, v5
v_cmp_eq_u32 vcc, 0, v6
v_add_u32 v5, 1, v5
v_and_b32 v6, 0x80000001, v5
v_cndmask_b32 v45, v53, 0, vcc
v_cmp_eq_u32 vcc, 0x80000001, v6
s_nop 1
v_cndmask_b32 v41, v53, 0, vcc
v_subrev_u32 v5, 2, v4
v_and_b32 v6, 0x80000001, v5
v_cmp_eq_u32 vcc, 0, v6
v_add_u32 v5, 1, v5
v_and_b32 v6, 0x80000001, v5
v_cndmask_b32 v46, v53, 0, vcc
v_cmp_eq_u32 vcc, 0x80000001, v6
s_nop 1
v_cndmask_b32 v42, v53, 0, vcc
v_subrev_u32 v5, 3, v4
v_and_b32 v6, 0x80000001, v5
v_cmp_eq_u32 vcc, 0, v6
v_add_u32 v5, 1, v5
v_and_b32 v6, 0x80000001, v5
v_cndmask_b32 v47, v53, 0, vcc
v_cmp_eq_u32 vcc, 0x80000001, v6
s_nop 1
v_cndmask_b32 v43, v53, 0, vcc
s_or_b32 s48, s41, s44
s_cmp_eq_u32 s48, 0
s_cselect_b64 vcc, -1, 0
v_cndmask_b32 v48, v40, v53, vcc
v_cndmask_b32 v49, v41, v53, vcc
v_cndmask_b32 v50, v42, v53, vcc
v_cndmask_b32 v51, v43, v53, vcc
v_and_b32 v4, 1, v2
v_lshlrev_b32 v4, 4, v4
v_mov_b32 v5, 0xffff
v_lshlrev_b32 v52, v4, v5
s_lshl_b32 s48, s43, 12
s_add_u32 s48, s48, 139264
s_lshl_b32 s49, s44, 11
s_add_u32 s49, s49, s48
v_add_u32 v53, s49, v18
s_lshl_b32 s49, s44, 13
s_add_u32 s49, s49, s48
v_add_u32 v54, s49, v18
s_lshl_b32 s48, s43, 7
s_add_u32 s48, s48, 133376
v_lshl_add_u32 v7, v3, 4, s48
v_lshl_add_u32 v55, v2, 2, s48
s_lshl_b32 s49, s44, 6
v_add_u32 v8, s49, v2
v_lshlrev_b32 v8, 3, v8
v_add_u32 v8, 131072, v8
v_lshl_add_u32 v9, v3, 2, s49
v_lshlrev_b32 v9, 2, v9
v_add_u32 v9, 132224, v9
s_mov_b32 s64, 0
s_mov_b32 s65, 0
s_waitcnt vmcnt(0)
s_cmp_eq_u32 s46, 0
s_cbranch_scc1 slow_67
s_lshl_b32 s62, s42, 2
v_mov_b32 v4, s62
v_mov_b32 v5, 2
s_mov_b64 exec, 1
buffer_store_dword v5, v4, s[32:35], s89 offen
s_mov_b64 exec, -1
back_68:
s_cmp_lg_u32 s40, 3
s_cbranch_scc1 nw3_69
s_lshl_b32 s53, s41, 2
s_add_u32 s53, s53, 1
s_lshl_b32 s53, s53, 7
s_add_u32 s53, s53, 18391040
s_lshl_b32 s62, s42, 2
v_mov_b32 v4, s62
v_mov_b32 v5, 1
s_mov_b64 exec, 1
buffer_store_dword v5, v4, s[32:35], s53 offen sc1
s_mov_b64 exec, -1
nw3_69:
s_barrier
s_cmp_eq_u32 s44, 1
s_cbranch_scc1 c2_th1
ds_read_b128 v[60:63], v14 offset:2048
ds_read_b128 v[64:67], v14 offset:4096
ds_read_b128 v[68:71], v14 offset:6144
ds_read_b128 v[72:75], v14 offset:8192
ds_read_b128 v[76:79], v14
ds_read_b64_tr_b16 v[80:81], v16 offset:0
ds_read_b64_tr_b16 v[82:83], v16 offset:512
ds_read_b64_tr_b16 v[84:85], v17 offset:0
ds_read_b64_tr_b16 v[86:87], v17 offset:512
ds_read_b64_tr_b16 v[88:89], v16 offset:8192
ds_read_b64_tr_b16 v[90:91], v16 offset:8704
ds_read_b64_tr_b16 v[92:93], v17 offset:8192
ds_read_b64_tr_b16 v[94:95], v17 offset:8704
ds_read_b64_tr_b16 v[96:97], v16 offset:16384
ds_read_b64_tr_b16 v[98:99], v16 offset:16896
ds_read_b64_tr_b16 v[100:101], v17 offset:16384
ds_read_b64_tr_b16 v[102:103], v17 offset:16896
c2_loop0:
s_waitcnt lgkmcnt(0)
v_mfma_f32_16x16x32_bf16 v[244:247], v[88:91], v[76:79], v[244:247]
ds_read_b128 v[104:107], v15 offset:2048
v_mfma_f32_16x16x32_bf16 v[248:251], v[76:79], v[96:99], v[248:251]
ds_read_b128 v[108:111], v15 offset:4096
v_mfma_f32_16x16x32_bf16 v[204:207], v[88:91], v[72:75], v[204:207]
ds_read_b128 v[112:115], v15 offset:6144
v_mfma_f32_16x16x32_bf16 v[196:199], v[88:91], v[68:71], v[196:199]
ds_read_b128 v[116:119], v15 offset:8192
v_mfma_f32_16x16x32_bf16 v[188:191], v[88:91], v[64:67], v[188:191]
ds_read_b128 v[120:123], v15
v_mfma_f32_16x16x32_bf16 v[180:183], v[88:91], v[60:63], v[180:183]
ds_read_b64_tr_b16 v[124:125], v16 offset:4096
v_mfma_f32_16x16x32_bf16 v[184:187], v[92:95], v[60:63], v[184:187]
ds_read_b64_tr_b16 v[126:127], v16 offset:4608
v_mfma_f32_16x16x32_bf16 v[192:195], v[92:95], v[64:67], v[192:195]
ds_read_b64_tr_b16 v[128:129], v17 offset:4096
v_mfma_f32_16x16x32_bf16 v[200:203], v[92:95], v[68:71], v[200:203]
ds_read_b64_tr_b16 v[130:131], v17 offset:4608
v_mfma_f32_16x16x32_bf16 v[208:211], v[92:95], v[72:75], v[208:211]
ds_read_b64_tr_b16 v[132:133], v16 offset:12288
v_mfma_f32_16x16x32_bf16 v[236:239], v[72:75], v[96:99], v[236:239]
ds_read_b64_tr_b16 v[134:135], v16 offset:12800
v_mfma_f32_16x16x32_bf16 v[228:231], v[68:71], v[96:99], v[228:231]
ds_read_b64_tr_b16 v[136:137], v17 offset:12288
v_mfma_f32_16x16x32_bf16 v[220:223], v[64:67], v[96:99], v[220:223]
ds_read_b64_tr_b16 v[138:139], v17 offset:12800
v_mfma_f32_16x16x32_bf16 v[212:215], v[60:63], v[96:99], v[212:215]
ds_read_b64_tr_b16 v[140:141], v16 offset:20480
v_mfma_f32_16x16x32_bf16 v[216:219], v[60:63], v[100:103], v[216:219]
ds_read_b64_tr_b16 v[142:143], v16 offset:20992
v_mfma_f32_16x16x32_bf16 v[224:227], v[64:67], v[100:103], v[224:227]
ds_read_b64_tr_b16 v[144:145], v17 offset:20480
v_mfma_f32_16x16x32_bf16 v[232:235], v[68:71], v[100:103], v[232:235]
ds_read_b64_tr_b16 v[146:147], v17 offset:20992
v_mfma_f32_16x16x32_bf16 v[240:243], v[72:75], v[100:103], v[240:243]
s_add_u32 s65, s65, 43008
v_mfma_f32_16x16x32_bf16 v[172:175], v[80:83], v[72:75], v[172:175]
s_cmp_eq_u32 s65, 129024
s_cselect_b32 s65, 0, s65
v_mfma_f32_16x16x32_bf16 v[164:167], v[80:83], v[68:71], v[164:167]
v_add_u32 v14, s65, v10
v_add_u32 v15, s65, v11
v_mfma_f32_16x16x32_bf16 v[156:159], v[80:83], v[64:67], v[156:159]
v_add_u32 v16, s65, v12
v_add_u32 v17, s65, v13
v_mfma_f32_16x16x32_bf16 v[148:151], v[80:83], v[60:63], v[148:151]
s_add_u32 s64, s64, 1
s_cmp_eq_u32 s64, 16
v_mfma_f32_16x16x32_bf16 v[152:155], v[84:87], v[60:63], v[152:155]
v_mfma_f32_16x16x32_bf16 v[160:163], v[84:87], v[64:67], v[160:163]
v_mfma_f32_16x16x32_bf16 v[168:171], v[84:87], v[68:71], v[168:171]
v_mfma_f32_16x16x32_bf16 v[176:179], v[84:87], v[72:75], v[176:179]
s_waitcnt lgkmcnt(0)
s_barrier
s_cbranch_scc1 c2_last0
v_mfma_f32_16x16x32_bf16 v[244:247], v[132:135], v[120:123], v[244:247]
ds_read_b128 v[60:63], v14 offset:2048
v_mfma_f32_16x16x32_bf16 v[248:251], v[120:123], v[140:143], v[248:251]
ds_read_b128 v[64:67], v14 offset:4096
v_mfma_f32_16x16x32_bf16 v[204:207], v[132:135], v[116:119], v[204:207]
ds_read_b128 v[68:71], v14 offset:6144
v_mfma_f32_16x16x32_bf16 v[196:199], v[132:135], v[112:115], v[196:199]
ds_read_b128 v[72:75], v14 offset:8192
v_mfma_f32_16x16x32_bf16 v[188:191], v[132:135], v[108:111], v[188:191]
ds_read_b128 v[76:79], v14
v_mfma_f32_16x16x32_bf16 v[180:183], v[132:135], v[104:107], v[180:183]
ds_read_b64_tr_b16 v[80:81], v16 offset:0
v_mfma_f32_16x16x32_bf16 v[184:187], v[136:139], v[104:107], v[184:187]
ds_read_b64_tr_b16 v[82:83], v16 offset:512
v_mfma_f32_16x16x32_bf16 v[192:195], v[136:139], v[108:111], v[192:195]
ds_read_b64_tr_b16 v[84:85], v17 offset:0
v_mfma_f32_16x16x32_bf16 v[200:203], v[136:139], v[112:115], v[200:203]
ds_read_b64_tr_b16 v[86:87], v17 offset:512
v_mfma_f32_16x16x32_bf16 v[208:211], v[136:139], v[116:119], v[208:211]
ds_read_b64_tr_b16 v[88:89], v16 offset:8192
v_mfma_f32_16x16x32_bf16 v[236:239], v[116:119], v[140:143], v[236:239]
ds_read_b64_tr_b16 v[90:91], v16 offset:8704
v_mfma_f32_16x16x32_bf16 v[228:231], v[112:115], v[140:143], v[228:231]
ds_read_b64_tr_b16 v[92:93], v17 offset:8192
v_mfma_f32_16x16x32_bf16 v[220:223], v[108:111], v[140:143], v[220:223]
ds_read_b64_tr_b16 v[94:95], v17 offset:8704
v_mfma_f32_16x16x32_bf16 v[212:215], v[104:107], v[140:143], v[212:215]
ds_read_b64_tr_b16 v[96:97], v16 offset:16384
v_mfma_f32_16x16x32_bf16 v[216:219], v[104:107], v[144:147], v[216:219]
ds_read_b64_tr_b16 v[98:99], v16 offset:16896
v_mfma_f32_16x16x32_bf16 v[224:227], v[108:111], v[144:147], v[224:227]
ds_read_b64_tr_b16 v[100:101], v17 offset:16384
v_mfma_f32_16x16x32_bf16 v[232:235], v[112:115], v[144:147], v[232:235]
ds_read_b64_tr_b16 v[102:103], v17 offset:16896
v_mfma_f32_16x16x32_bf16 v[240:243], v[116:119], v[144:147], v[240:243]
v_mfma_f32_16x16x32_bf16 v[172:175], v[124:127], v[116:119], v[172:175]
v_mfma_f32_16x16x32_bf16 v[164:167], v[124:127], v[112:115], v[164:167]
v_mfma_f32_16x16x32_bf16 v[156:159], v[124:127], v[108:111], v[156:159]
v_mfma_f32_16x16x32_bf16 v[148:151], v[124:127], v[104:107], v[148:151]
v_mfma_f32_16x16x32_bf16 v[152:155], v[128:131], v[104:107], v[152:155]
v_mfma_f32_16x16x32_bf16 v[160:163], v[128:131], v[108:111], v[160:163]
v_mfma_f32_16x16x32_bf16 v[168:171], v[128:131], v[112:115], v[168:171]
v_mfma_f32_16x16x32_bf16 v[176:179], v[128:131], v[116:119], v[176:179]
s_branch c2_loop0
c2_last0:
v_mfma_f32_16x16x32_bf16 v[244:247], v[132:135], v[120:123], v[244:247]
ds_read_b128 v[60:63], v7 offset:0
v_mfma_f32_16x16x32_bf16 v[248:251], v[120:123], v[140:143], v[248:251]
ds_read_b128 v[64:67], v7 offset:64
v_mfma_f32_16x16x32_bf16 v[204:207], v[132:135], v[116:119], v[204:207]
ds_read_b128 v[68:71], v7 offset:256
v_mfma_f32_16x16x32_bf16 v[208:211], v[136:139], v[116:119], v[208:211]
ds_read_b128 v[72:75], v7 offset:320
v_mfma_f32_16x16x32_bf16 v[236:239], v[116:119], v[140:143], v[236:239]
ds_read_b64 v[78:79], v8 offset:0
v_mfma_f32_16x16x32_bf16 v[240:243], v[116:119], v[144:147], v[240:243]
ds_read_b64 v[80:81], v8 offset:128
v_mfma_f32_16x16x32_bf16 v[148:151], v[124:127], v[104:107], v[148:151]
ds_read_b64 v[82:83], v8 offset:256
v_mfma_f32_16x16x32_bf16 v[152:155], v[128:131], v[104:107], v[152:155]
ds_read_b64 v[84:85], v8 offset:384
v_mfma_f32_16x16x32_bf16 v[156:159], v[124:127], v[108:111], v[156:159]
ds_write_b128 v53, v[244:247]
v_mfma_f32_16x16x32_bf16 v[160:163], v[128:131], v[108:111], v[160:163]
ds_write_b128 v53, v[248:251] offset:1024
v_mfma_f32_16x16x32_bf16 v[164:167], v[124:127], v[112:115], v[164:167]
ds_write_b128 v53, v[204:207] offset:8192
v_mfma_f32_16x16x32_bf16 v[168:171], v[128:131], v[112:115], v[168:171]
ds_write_b128 v53, v[208:211] offset:10240
v_mfma_f32_16x16x32_bf16 v[172:175], v[124:127], v[116:119], v[172:175]
ds_write_b128 v53, v[236:239] offset:9216
v_mfma_f32_16x16x32_bf16 v[176:179], v[128:131], v[116:119], v[176:179]
ds_write_b128 v53, v[240:243] offset:11264
v_mfma_f32_16x16x32_bf16 v[180:183], v[132:135], v[104:107], v[180:183]
ds_read_b64 v[86:87], v8 offset:512
v_mfma_f32_16x16x32_bf16 v[184:187], v[136:139], v[104:107], v[184:187]
ds_read2_b32 v[76:77], v55 offset0:128 offset1:144
v_mfma_f32_16x16x32_bf16 v[188:191], v[132:135], v[108:111], v[188:191]
ds_read_b128 v[88:91], v9 offset:0
v_mfma_f32_16x16x32_bf16 v[192:195], v[136:139], v[108:111], v[192:195]
ds_read_b128 v[92:95], v9 offset:64
v_mfma_f32_16x16x32_bf16 v[196:199], v[132:135], v[112:115], v[196:199]
ds_read_b128 v[96:99], v9 offset:128
v_mfma_f32_16x16x32_bf16 v[200:203], v[136:139], v[112:115], v[200:203]
ds_read_b128 v[100:103], v9 offset:192
v_mfma_f32_16x16x32_bf16 v[212:215], v[104:107], v[140:143], v[212:215]
v_mfma_f32_16x16x32_bf16 v[216:219], v[104:107], v[144:147], v[216:219]
v_mfma_f32_16x16x32_bf16 v[220:223], v[108:111], v[140:143], v[220:223]
v_mfma_f32_16x16x32_bf16 v[224:227], v[108:111], v[144:147], v[224:227]
v_mfma_f32_16x16x32_bf16 v[228:231], v[112:115], v[140:143], v[228:231]
v_mfma_f32_16x16x32_bf16 v[232:235], v[112:115], v[144:147], v[232:235]
s_branch c2_epi
c2_th1:
ds_read_b128 v[60:63], v14 offset:10240
ds_read_b128 v[64:67], v14 offset:12288
ds_read_b128 v[68:71], v14 offset:14336
ds_read_b128 v[72:75], v14 offset:16384
ds_read_b128 v[76:79], v14
ds_read_b64_tr_b16 v[80:81], v16 offset:0
ds_read_b64_tr_b16 v[82:83], v16 offset:512
ds_read_b64_tr_b16 v[84:85], v17 offset:0
ds_read_b64_tr_b16 v[86:87], v17 offset:512
ds_read_b64_tr_b16 v[88:89], v16 offset:8192
ds_read_b64_tr_b16 v[90:91], v16 offset:8704
ds_read_b64_tr_b16 v[92:93], v17 offset:8192
ds_read_b64_tr_b16 v[94:95], v17 offset:8704
ds_read_b64_tr_b16 v[96:97], v16 offset:16384
ds_read_b64_tr_b16 v[98:99], v16 offset:16896
ds_read_b64_tr_b16 v[100:101], v17 offset:16384
ds_read_b64_tr_b16 v[102:103], v17 offset:16896
c2_loop1:
s_waitcnt lgkmcnt(0)
v_mfma_f32_16x16x32_bf16 v[244:247], v[92:95], v[76:79], v[244:247]
ds_read_b128 v[104:107], v15 offset:10240
v_mfma_f32_16x16x32_bf16 v[248:251], v[76:79], v[100:103], v[248:251]
ds_read_b128 v[108:111], v15 offset:12288
v_mfma_f32_16x16x32_bf16 v[204:207], v[88:91], v[72:75], v[204:207]
ds_read_b128 v[112:115], v15 offset:14336
v_mfma_f32_16x16x32_bf16 v[196:199], v[88:91], v[68:71], v[196:199]
ds_read_b128 v[116:119], v15 offset:16384
v_mfma_f32_16x16x32_bf16 v[188:191], v[88:91], v[64:67], v[188:191]
ds_read_b128 v[120:123], v15
v_mfma_f32_16x16x32_bf16 v[180:183], v[88:91], v[60:63], v[180:183]
ds_read_b64_tr_b16 v[124:125], v16 offset:4096
v_mfma_f32_16x16x32_bf16 v[184:187], v[92:95], v[60:63], v[184:187]
ds_read_b64_tr_b16 v[126:127], v16 offset:4608
v_mfma_f32_16x16x32_bf16 v[192:195], v[92:95], v[64:67], v[192:195]
ds_read_b64_tr_b16 v[128:129], v17 offset:4096
v_mfma_f32_16x16x32_bf16 v[200:203], v[92:95], v[68:71], v[200:203]
ds_read_b64_tr_b16 v[130:131], v17 offset:4608
v_mfma_f32_16x16x32_bf16 v[208:211], v[92:95], v[72:75], v[208:211]
ds_read_b64_tr_b16 v[132:133], v16 offset:12288
v_mfma_f32_16x16x32_bf16 v[236:239], v[72:75], v[96:99], v[236:239]
ds_read_b64_tr_b16 v[134:135], v16 offset:12800
v_mfma_f32_16x16x32_bf16 v[228:231], v[68:71], v[96:99], v[228:231]
ds_read_b64_tr_b16 v[136:137], v17 offset:12288
v_mfma_f32_16x16x32_bf16 v[220:223], v[64:67], v[96:99], v[220:223]
ds_read_b64_tr_b16 v[138:139], v17 offset:12800
v_mfma_f32_16x16x32_bf16 v[212:215], v[60:63], v[96:99], v[212:215]
ds_read_b64_tr_b16 v[140:141], v16 offset:20480
v_mfma_f32_16x16x32_bf16 v[216:219], v[60:63], v[100:103], v[216:219]
ds_read_b64_tr_b16 v[142:143], v16 offset:20992
v_mfma_f32_16x16x32_bf16 v[224:227], v[64:67], v[100:103], v[224:227]
ds_read_b64_tr_b16 v[144:145], v17 offset:20480
v_mfma_f32_16x16x32_bf16 v[232:235], v[68:71], v[100:103], v[232:235]
ds_read_b64_tr_b16 v[146:147], v17 offset:20992
v_mfma_f32_16x16x32_bf16 v[240:243], v[72:75], v[100:103], v[240:243]
s_add_u32 s65, s65, 43008
v_mfma_f32_16x16x32_bf16 v[172:175], v[80:83], v[72:75], v[172:175]
s_cmp_eq_u32 s65, 129024
s_cselect_b32 s65, 0, s65
v_mfma_f32_16x16x32_bf16 v[164:167], v[80:83], v[68:71], v[164:167]
v_add_u32 v14, s65, v10
v_add_u32 v15, s65, v11
v_mfma_f32_16x16x32_bf16 v[156:159], v[80:83], v[64:67], v[156:159]
v_add_u32 v16, s65, v12
v_add_u32 v17, s65, v13
v_mfma_f32_16x16x32_bf16 v[148:151], v[80:83], v[60:63], v[148:151]
s_add_u32 s64, s64, 1
s_cmp_eq_u32 s64, 16
v_mfma_f32_16x16x32_bf16 v[152:155], v[84:87], v[60:63], v[152:155]
v_mfma_f32_16x16x32_bf16 v[160:163], v[84:87], v[64:67], v[160:163]
v_mfma_f32_16x16x32_bf16 v[168:171], v[84:87], v[68:71], v[168:171]
v_mfma_f32_16x16x32_bf16 v[176:179], v[84:87], v[72:75], v[176:179]
s_waitcnt lgkmcnt(0)
s_barrier
s_cbranch_scc1 c2_last1
v_mfma_f32_16x16x32_bf16 v[244:247], v[136:139], v[120:123], v[244:247]
ds_read_b128 v[60:63], v14 offset:10240
v_mfma_f32_16x16x32_bf16 v[248:251], v[120:123], v[144:147], v[248:251]
ds_read_b128 v[64:67], v14 offset:12288
v_mfma_f32_16x16x32_bf16 v[204:207], v[132:135], v[116:119], v[204:207]
ds_read_b128 v[68:71], v14 offset:14336
v_mfma_f32_16x16x32_bf16 v[196:199], v[132:135], v[112:115], v[196:199]
ds_read_b128 v[72:75], v14 offset:16384
v_mfma_f32_16x16x32_bf16 v[188:191], v[132:135], v[108:111], v[188:191]
ds_read_b128 v[76:79], v14
v_mfma_f32_16x16x32_bf16 v[180:183], v[132:135], v[104:107], v[180:183]
ds_read_b64_tr_b16 v[80:81], v16 offset:0
v_mfma_f32_16x16x32_bf16 v[184:187], v[136:139], v[104:107], v[184:187]
ds_read_b64_tr_b16 v[82:83], v16 offset:512
v_mfma_f32_16x16x32_bf16 v[192:195], v[136:139], v[108:111], v[192:195]
ds_read_b64_tr_b16 v[84:85], v17 offset:0
v_mfma_f32_16x16x32_bf16 v[200:203], v[136:139], v[112:115], v[200:203]
ds_read_b64_tr_b16 v[86:87], v17 offset:512
v_mfma_f32_16x16x32_bf16 v[208:211], v[136:139], v[116:119], v[208:211]
ds_read_b64_tr_b16 v[88:89], v16 offset:8192
v_mfma_f32_16x16x32_bf16 v[236:239], v[116:119], v[140:143], v[236:239]
ds_read_b64_tr_b16 v[90:91], v16 offset:8704
v_mfma_f32_16x16x32_bf16 v[228:231], v[112:115], v[140:143], v[228:231]
ds_read_b64_tr_b16 v[92:93], v17 offset:8192
v_mfma_f32_16x16x32_bf16 v[220:223], v[108:111], v[140:143], v[220:223]
ds_read_b64_tr_b16 v[94:95], v17 offset:8704
v_mfma_f32_16x16x32_bf16 v[212:215], v[104:107], v[140:143], v[212:215]
ds_read_b64_tr_b16 v[96:97], v16 offset:16384
v_mfma_f32_16x16x32_bf16 v[216:219], v[104:107], v[144:147], v[216:219]
ds_read_b64_tr_b16 v[98:99], v16 offset:16896
v_mfma_f32_16x16x32_bf16 v[224:227], v[108:111], v[144:147], v[224:227]
ds_read_b64_tr_b16 v[100:101], v17 offset:16384
v_mfma_f32_16x16x32_bf16 v[232:235], v[112:115], v[144:147], v[232:235]
ds_read_b64_tr_b16 v[102:103], v17 offset:16896
v_mfma_f32_16x16x32_bf16 v[240:243], v[116:119], v[144:147], v[240:243]
v_mfma_f32_16x16x32_bf16 v[172:175], v[124:127], v[116:119], v[172:175]
v_mfma_f32_16x16x32_bf16 v[164:167], v[124:127], v[112:115], v[164:167]
v_mfma_f32_16x16x32_bf16 v[156:159], v[124:127], v[108:111], v[156:159]
v_mfma_f32_16x16x32_bf16 v[148:151], v[124:127], v[104:107], v[148:151]
v_mfma_f32_16x16x32_bf16 v[152:155], v[128:131], v[104:107], v[152:155]
v_mfma_f32_16x16x32_bf16 v[160:163], v[128:131], v[108:111], v[160:163]
v_mfma_f32_16x16x32_bf16 v[168:171], v[128:131], v[112:115], v[168:171]
v_mfma_f32_16x16x32_bf16 v[176:179], v[128:131], v[116:119], v[176:179]
s_branch c2_loop1
c2_last1:
v_mfma_f32_16x16x32_bf16 v[244:247], v[136:139], v[120:123], v[244:247]
ds_read_b128 v[60:63], v7 offset:0
v_mfma_f32_16x16x32_bf16 v[248:251], v[120:123], v[144:147], v[248:251]
ds_read_b128 v[64:67], v7 offset:64
v_mfma_f32_16x16x32_bf16 v[204:207], v[132:135], v[116:119], v[204:207]
ds_read_b128 v[68:71], v7 offset:256
v_mfma_f32_16x16x32_bf16 v[208:211], v[136:139], v[116:119], v[208:211]
ds_read_b128 v[72:75], v7 offset:320
v_mfma_f32_16x16x32_bf16 v[236:239], v[116:119], v[140:143], v[236:239]
ds_read_b64 v[78:79], v8 offset:0
v_mfma_f32_16x16x32_bf16 v[240:243], v[116:119], v[144:147], v[240:243]
ds_read_b64 v[80:81], v8 offset:128
v_mfma_f32_16x16x32_bf16 v[148:151], v[124:127], v[104:107], v[148:151]
ds_read_b64 v[82:83], v8 offset:256
v_mfma_f32_16x16x32_bf16 v[152:155], v[128:131], v[104:107], v[152:155]
ds_read_b64 v[84:85], v8 offset:384
v_mfma_f32_16x16x32_bf16 v[156:159], v[124:127], v[108:111], v[156:159]
ds_write_b128 v53, v[244:247]
v_mfma_f32_16x16x32_bf16 v[160:163], v[128:131], v[108:111], v[160:163]
ds_write_b128 v53, v[248:251] offset:1024
v_mfma_f32_16x16x32_bf16 v[164:167], v[124:127], v[112:115], v[164:167]
ds_read_b64 v[86:87], v8 offset:512
v_mfma_f32_16x16x32_bf16 v[168:171], v[128:131], v[112:115], v[168:171]
ds_read2_b32 v[76:77], v55 offset0:128 offset1:144
v_mfma_f32_16x16x32_bf16 v[172:175], v[124:127], v[116:119], v[172:175]
ds_read_b128 v[88:91], v9 offset:0
v_mfma_f32_16x16x32_bf16 v[176:179], v[128:131], v[116:119], v[176:179]
ds_read_b128 v[92:95], v9 offset:64
v_mfma_f32_16x16x32_bf16 v[180:183], v[132:135], v[104:107], v[180:183]
ds_read_b128 v[96:99], v9 offset:128
v_mfma_f32_16x16x32_bf16 v[184:187], v[136:139], v[104:107], v[184:187]
ds_read_b128 v[100:103], v9 offset:192
v_mfma_f32_16x16x32_bf16 v[188:191], v[132:135], v[108:111], v[188:191]
v_mfma_f32_16x16x32_bf16 v[192:195], v[136:139], v[108:111], v[192:195]
v_mfma_f32_16x16x32_bf16 v[196:199], v[132:135], v[112:115], v[196:199]
v_mfma_f32_16x16x32_bf16 v[200:203], v[136:139], v[112:115], v[200:203]
v_mfma_f32_16x16x32_bf16 v[212:215], v[104:107], v[140:143], v[212:215]
v_mfma_f32_16x16x32_bf16 v[216:219], v[104:107], v[144:147], v[216:219]
v_mfma_f32_16x16x32_bf16 v[220:223], v[108:111], v[140:143], v[220:223]
v_mfma_f32_16x16x32_bf16 v[224:227], v[108:111], v[144:147], v[224:227]
v_mfma_f32_16x16x32_bf16 v[228:231], v[112:115], v[140:143], v[228:231]
v_mfma_f32_16x16x32_bf16 v[232:235], v[112:115], v[144:147], v[232:235]
c2_epi:
s_waitcnt lgkmcnt(0)
s_barrier
ds_read_b128 v[128:131], v54 offset:0
ds_read_b128 v[132:135], v54 offset:2048
ds_read_b128 v[136:139], v54 offset:1024
ds_read_b128 v[140:143], v54 offset:3072
ds_read_b128 v[104:107], v9 offset:256
ds_read_b128 v[108:111], v9 offset:576
ds_read_b128 v[112:115], v9 offset:640
ds_read_b128 v[116:119], v9 offset:704
ds_read_b128 v[120:123], v9 offset:768
ds_read_b128 v[124:127], v9 offset:832
s_mov_b32 s66, 0x3e8293ee
v_mul_f32 v10, s66, v80
v_mul_f32 v11, s66, v82
v_mul_f32 v12, s66, v84
v_mul_f32 v13, s66, v86
.p2align 3
v_pk_fma_f32 v[148:149], v[60:61], v[80:81], v[148:149] op_sel:[0,1,0] op_sel_hi:[1,1,1]
v_pk_fma_f32 v[150:151], v[62:63], v[80:81], v[150:151] op_sel:[0,1,0] op_sel_hi:[1,1,1]
v_pk_fma_f32 v[152:153], v[64:65], v[80:81], v[152:153] op_sel:[0,1,0] op_sel_hi:[1,1,1]
v_pk_fma_f32 v[154:155], v[66:67], v[80:81], v[154:155] op_sel:[0,1,0] op_sel_hi:[1,1,1]
v_cvt_pk_bf16_f32 v148, v148, v149
v_cvt_pk_bf16_f32 v149, v150, v151
v_cvt_pk_bf16_f32 v150, v152, v153
v_cvt_pk_bf16_f32 v151, v154, v155
v_pk_fma_f32 v[156:157], v[60:61], v[82:83], v[156:157] op_sel:[0,1,0] op_sel_hi:[1,1,1]
v_pk_fma_f32 v[158:159], v[62:63], v[82:83], v[158:159] op_sel:[0,1,0] op_sel_hi:[1,1,1]
v_pk_fma_f32 v[160:161], v[64:65], v[82:83], v[160:161] op_sel:[0,1,0] op_sel_hi:[1,1,1]
v_pk_fma_f32 v[162:163], v[66:67], v[82:83], v[162:163] op_sel:[0,1,0] op_sel_hi:[1,1,1]
v_cvt_pk_bf16_f32 v156, v156, v157
v_cvt_pk_bf16_f32 v157, v158, v159
v_cvt_pk_bf16_f32 v158, v160, v161
v_cvt_pk_bf16_f32 v159, v162, v163
v_pk_fma_f32 v[164:165], v[60:61], v[84:85], v[164:165] op_sel:[0,1,0] op_sel_hi:[1,1,1]
v_pk_fma_f32 v[166:167], v[62:63], v[84:85], v[166:167] op_sel:[0,1,0] op_sel_hi:[1,1,1]
v_pk_fma_f32 v[168:169], v[64:65], v[84:85], v[168:169] op_sel:[0,1,0] op_sel_hi:[1,1,1]
v_pk_fma_f32 v[170:171], v[66:67], v[84:85], v[170:171] op_sel:[0,1,0] op_sel_hi:[1,1,1]
v_cvt_pk_bf16_f32 v164, v164, v165
v_cvt_pk_bf16_f32 v165, v166, v167
v_cvt_pk_bf16_f32 v166, v168, v169
v_cvt_pk_bf16_f32 v167, v170, v171
v_pk_fma_f32 v[172:173], v[60:61], v[86:87], v[172:173] op_sel:[0,1,0] op_sel_hi:[1,1,1]
v_pk_fma_f32 v[174:175], v[62:63], v[86:87], v[174:175] op_sel:[0,1,0] op_sel_hi:[1,1,1]
v_pk_fma_f32 v[176:177], v[64:65], v[86:87], v[176:177] op_sel:[0,1,0] op_sel_hi:[1,1,1]
v_pk_fma_f32 v[178:179], v[66:67], v[86:87], v[178:179] op_sel:[0,1,0] op_sel_hi:[1,1,1]
v_cvt_pk_bf16_f32 v172, v172, v173
v_cvt_pk_bf16_f32 v173, v174, v175
v_cvt_pk_bf16_f32 v174, v176, v177
v_cvt_pk_bf16_f32 v175, v178, v179
v_pk_fma_f32 v[204:205], v[68:69], v[86:87], v[204:205] op_sel:[0,1,0] op_sel_hi:[1,1,1]
v_pk_fma_f32 v[206:207], v[70:71], v[86:87], v[206:207] op_sel:[0,1,0] op_sel_hi:[1,1,1]
v_pk_fma_f32 v[208:209], v[72:73], v[86:87], v[208:209] op_sel:[0,1,0] op_sel_hi:[1,1,1]
v_pk_fma_f32 v[210:211], v[74:75], v[86:87], v[210:211] op_sel:[0,1,0] op_sel_hi:[1,1,1]
v_pk_mul_f32 v[204:205], v[204:205], v[86:87] op_sel:[0,0] op_sel_hi:[1,0]
v_pk_mul_f32 v[206:207], v[206:207], v[86:87] op_sel:[0,0] op_sel_hi:[1,0]
v_pk_mul_f32 v[208:209], v[208:209], v[86:87] op_sel:[0,0] op_sel_hi:[1,0]
v_pk_mul_f32 v[210:211], v[210:211], v[86:87] op_sel:[0,0] op_sel_hi:[1,0]
v_cvt_pk_bf16_f32 v204, v204, v205
v_cvt_pk_bf16_f32 v205, v206, v207
v_cvt_pk_bf16_f32 v206, v208, v209
v_cvt_pk_bf16_f32 v207, v210, v211
v_pk_fma_f32 v[180:181], v[68:69], v[80:81], v[180:181] op_sel:[0,1,0] op_sel_hi:[1,1,1]
v_pk_fma_f32 v[182:183], v[70:71], v[80:81], v[182:183] op_sel:[0,1,0] op_sel_hi:[1,1,1]
v_pk_fma_f32 v[184:185], v[72:73], v[80:81], v[184:185] op_sel:[0,1,0] op_sel_hi:[1,1,1]
v_pk_fma_f32 v[186:187], v[74:75], v[80:81], v[186:187] op_sel:[0,1,0] op_sel_hi:[1,1,1]
v_pk_mul_f32 v[180:181], v[180:181], v[80:81] op_sel:[0,0] op_sel_hi:[1,0]
v_pk_mul_f32 v[182:183], v[182:183], v[80:81] op_sel:[0,0] op_sel_hi:[1,0]
v_pk_mul_f32 v[184:185], v[184:185], v[80:81] op_sel:[0,0] op_sel_hi:[1,0]
v_pk_mul_f32 v[186:187], v[186:187], v[80:81] op_sel:[0,0] op_sel_hi:[1,0]
v_cvt_pk_bf16_f32 v180, v180, v181
v_cvt_pk_bf16_f32 v181, v182, v183
v_cvt_pk_bf16_f32 v182, v184, v185
v_cvt_pk_bf16_f32 v183, v186, v187
v_pk_fma_f32 v[188:189], v[68:69], v[82:83], v[188:189] op_sel:[0,1,0] op_sel_hi:[1,1,1]
v_pk_fma_f32 v[190:191], v[70:71], v[82:83], v[190:191] op_sel:[0,1,0] op_sel_hi:[1,1,1]
v_pk_fma_f32 v[192:193], v[72:73], v[82:83], v[192:193] op_sel:[0,1,0] op_sel_hi:[1,1,1]
v_pk_fma_f32 v[194:195], v[74:75], v[82:83], v[194:195] op_sel:[0,1,0] op_sel_hi:[1,1,1]
v_pk_mul_f32 v[188:189], v[188:189], v[82:83] op_sel:[0,0] op_sel_hi:[1,0]
v_pk_mul_f32 v[190:191], v[190:191], v[82:83] op_sel:[0,0] op_sel_hi:[1,0]
v_pk_mul_f32 v[192:193], v[192:193], v[82:83] op_sel:[0,0] op_sel_hi:[1,0]
v_pk_mul_f32 v[194:195], v[194:195], v[82:83] op_sel:[0,0] op_sel_hi:[1,0]
v_cvt_pk_bf16_f32 v188, v188, v189
v_cvt_pk_bf16_f32 v189, v190, v191
v_cvt_pk_bf16_f32 v190, v192, v193
v_cvt_pk_bf16_f32 v191, v194, v195
v_pk_fma_f32 v[196:197], v[68:69], v[84:85], v[196:197] op_sel:[0,1,0] op_sel_hi:[1,1,1]
v_pk_fma_f32 v[198:199], v[70:71], v[84:85], v[198:199] op_sel:[0,1,0] op_sel_hi:[1,1,1]
v_pk_fma_f32 v[200:201], v[72:73], v[84:85], v[200:201] op_sel:[0,1,0] op_sel_hi:[1,1,1]
v_pk_fma_f32 v[202:203], v[74:75], v[84:85], v[202:203] op_sel:[0,1,0] op_sel_hi:[1,1,1]
v_pk_mul_f32 v[196:197], v[196:197], v[84:85] op_sel:[0,0] op_sel_hi:[1,0]
v_pk_mul_f32 v[198:199], v[198:199], v[84:85] op_sel:[0,0] op_sel_hi:[1,0]
v_pk_mul_f32 v[200:201], v[200:201], v[84:85] op_sel:[0,0] op_sel_hi:[1,0]
v_pk_mul_f32 v[202:203], v[202:203], v[84:85] op_sel:[0,0] op_sel_hi:[1,0]
v_cvt_pk_bf16_f32 v196, v196, v197
v_cvt_pk_bf16_f32 v197, v198, v199
v_cvt_pk_bf16_f32 v198, v200, v201
v_cvt_pk_bf16_f32 v199, v202, v203
s_waitcnt lgkmcnt(0)
s_nop 0
v_pk_fma_f32 v[128:129], v[68:69], v[78:79], v[128:129] op_sel:[0,1,0] op_sel_hi:[1,1,1]
v_pk_fma_f32 v[130:131], v[70:71], v[78:79], v[130:131] op_sel:[0,1,0] op_sel_hi:[1,1,1]
v_pk_fma_f32 v[132:133], v[72:73], v[78:79], v[132:133] op_sel:[0,1,0] op_sel_hi:[1,1,1]
v_pk_fma_f32 v[134:135], v[74:75], v[78:79], v[134:135] op_sel:[0,1,0] op_sel_hi:[1,1,1]
v_pk_mul_f32 v[128:129], v[128:129], v[78:79] op_sel:[0,0] op_sel_hi:[1,0]
v_pk_mul_f32 v[130:131], v[130:131], v[78:79] op_sel:[0,0] op_sel_hi:[1,0]
v_pk_mul_f32 v[132:133], v[132:133], v[78:79] op_sel:[0,0] op_sel_hi:[1,0]
v_pk_mul_f32 v[134:135], v[134:135], v[78:79] op_sel:[0,0] op_sel_hi:[1,0]
v_cvt_pk_bf16_f32 v128, v128, v129
v_cvt_pk_bf16_f32 v129, v130, v131
v_cvt_pk_bf16_f32 v130, v132, v133
v_cvt_pk_bf16_f32 v131, v134, v135
v_pk_fma_f32 v[136:137], v[108:109], v[76:77], v[136:137] op_sel:[0,0,0] op_sel_hi:[1,0,1]
v_pk_fma_f32 v[138:139], v[110:111], v[76:77], v[138:139] op_sel:[0,0,0] op_sel_hi:[1,0,1]
v_pk_mul_f32 v[136:137], v[136:137], v[88:89]
v_pk_mul_f32 v[138:139], v[138:139], v[90:91]
v_cvt_pk_bf16_f32 v20, v136, v137
v_mfma_f32_16x16x32_bf16 v[192:195], v[188:191], v[156:159], v[44:47]
v_cvt_pk_bf16_f32 v21, v138, v139
v_pk_fma_f32 v[212:213], v[112:113], v[76:77], v[212:213] op_sel:[0,0,0] op_sel_hi:[1,0,1]
v_pk_fma_f32 v[214:215], v[114:115], v[76:77], v[214:215] op_sel:[0,0,0] op_sel_hi:[1,0,1]
v_pk_mul_f32 v[212:213], v[212:213], v[92:93]
v_pk_mul_f32 v[214:215], v[214:215], v[94:95]
v_cvt_pk_bf16_f32 v22, v212, v213
v_mfma_f32_16x16x32_bf16 v[160:163], v[180:183], v[156:159], v[40:43]
v_cvt_pk_bf16_f32 v23, v214, v215
v_pk_fma_f32 v[220:221], v[116:117], v[76:77], v[220:221] op_sel:[0,0,0] op_sel_hi:[1,0,1]
v_pk_fma_f32 v[222:223], v[118:119], v[76:77], v[222:223] op_sel:[0,0,0] op_sel_hi:[1,0,1]
v_pk_mul_f32 v[220:221], v[220:221], v[96:97]
v_pk_mul_f32 v[222:223], v[222:223], v[98:99]
v_cvt_pk_bf16_f32 v24, v220, v221
v_mfma_f32_16x16x32_bf16 v[200:203], v[196:199], v[164:167], v[44:47]
v_cvt_pk_bf16_f32 v25, v222, v223
v_pk_fma_f32 v[228:229], v[120:121], v[76:77], v[228:229] op_sel:[0,0,0] op_sel_hi:[1,0,1]
v_pk_fma_f32 v[230:231], v[122:123], v[76:77], v[230:231] op_sel:[0,0,0] op_sel_hi:[1,0,1]
v_pk_mul_f32 v[228:229], v[228:229], v[100:101]
v_pk_mul_f32 v[230:231], v[230:231], v[102:103]
v_cvt_pk_bf16_f32 v26, v228, v229
v_mfma_f32_16x16x32_bf16 v[168:171], v[188:191], v[164:167], v[40:43]
v_cvt_pk_bf16_f32 v27, v230, v231
v_pk_fma_f32 v[236:237], v[124:125], v[76:77], v[236:237] op_sel:[0,0,0] op_sel_hi:[1,0,1]
v_pk_fma_f32 v[238:239], v[126:127], v[76:77], v[238:239] op_sel:[0,0,0] op_sel_hi:[1,0,1]
v_pk_mul_f32 v[236:237], v[236:237], v[104:105]
v_pk_mul_f32 v[238:239], v[238:239], v[106:107]
v_cvt_pk_bf16_f32 v28, v236, v237
v_mfma_f32_16x16x32_bf16 v[208:211], v[204:207], v[172:175], v[44:47]
v_cvt_pk_bf16_f32 v29, v238, v239
v_pk_fma_f32 v[140:141], v[108:109], v[76:77], v[140:141] op_sel:[0,1,0] op_sel_hi:[1,1,1]
v_pk_fma_f32 v[142:143], v[110:111], v[76:77], v[142:143] op_sel:[0,1,0] op_sel_hi:[1,1,1]
v_pk_mul_f32 v[140:141], v[140:141], v[88:89]
v_pk_mul_f32 v[142:143], v[142:143], v[90:91]
v_cvt_pk_bf16_f32 v30, v140, v141
v_mfma_f32_16x16x32_bf16 v[176:179], v[196:199], v[172:175], v[40:43]
v_cvt_pk_bf16_f32 v31, v142, v143
v_pk_fma_f32 v[216:217], v[112:113], v[76:77], v[216:217] op_sel:[0,1,0] op_sel_hi:[1,1,1]
v_pk_fma_f32 v[218:219], v[114:115], v[76:77], v[218:219] op_sel:[0,1,0] op_sel_hi:[1,1,1]
v_pk_mul_f32 v[216:217], v[216:217], v[92:93]
v_pk_mul_f32 v[218:219], v[218:219], v[94:95]
v_cvt_pk_bf16_f32 v32, v216, v217
v_mfma_f32_16x16x32_bf16 v[184:187], v[180:183], v[148:151], v[44:47]
v_cvt_pk_bf16_f32 v33, v218, v219
v_pk_fma_f32 v[224:225], v[116:117], v[76:77], v[224:225] op_sel:[0,1,0] op_sel_hi:[1,1,1]
v_pk_fma_f32 v[226:227], v[118:119], v[76:77], v[226:227] op_sel:[0,1,0] op_sel_hi:[1,1,1]
v_pk_mul_f32 v[224:225], v[224:225], v[96:97]
v_pk_mul_f32 v[226:227], v[226:227], v[98:99]
v_cvt_pk_bf16_f32 v34, v224, v225
v_mfma_f32_16x16x32_bf16 v[152:155], v[128:131], v[148:151], v[48:51]
v_cvt_pk_bf16_f32 v35, v226, v227
v_pk_fma_f32 v[232:233], v[120:121], v[76:77], v[232:233] op_sel:[0,1,0] op_sel_hi:[1,1,1]
v_pk_fma_f32 v[234:235], v[122:123], v[76:77], v[234:235] op_sel:[0,1,0] op_sel_hi:[1,1,1]
v_pk_mul_f32 v[232:233], v[232:233], v[100:101]
v_pk_mul_f32 v[234:235], v[234:235], v[102:103]
v_cvt_pk_bf16_f32 v36, v232, v233
v_cvt_pk_bf16_f32 v37, v234, v235
v_pk_fma_f32 v[240:241], v[124:125], v[76:77], v[240:241] op_sel:[0,1,0] op_sel_hi:[1,1,1]
v_pk_fma_f32 v[242:243], v[126:127], v[76:77], v[242:243] op_sel:[0,1,0] op_sel_hi:[1,1,1]
v_pk_mul_f32 v[240:241], v[240:241], v[104:105]
v_pk_mul_f32 v[242:243], v[242:243], v[106:107]
v_cvt_pk_bf16_f32 v38, v240, v241
v_cvt_pk_bf16_f32 v39, v242, v243
v_max_f32 v148, v152, v153
v_max_f32 v149, v154, v155
v_max_f32 v150, v184, v185
v_max_f32 v151, v186, v187
v_max3_f32 v14, v148, v149, v150
v_max_f32 v14, v14, v151
v_max_f32 v156, v160, v161
v_max_f32 v157, v162, v163
v_max_f32 v158, v192, v193
v_max_f32 v159, v194, v195
v_max3_f32 v15, v156, v157, v158
v_max_f32 v15, v15, v159
v_max_f32 v164, v168, v169
v_max_f32 v165, v170, v171
v_max_f32 v166, v200, v201
v_max_f32 v167, v202, v203
v_max3_f32 v16, v164, v165, v166
v_max_f32 v16, v16, v167
v_max_f32 v172, v176, v177
v_max_f32 v173, v178, v179
v_max_f32 v174, v208, v209
v_max_f32 v175, v210, v211
v_max3_f32 v17, v172, v173, v174
v_max_f32 v17, v17, v175
s_nop 1
v_permlane32_swap_b32 v14, v15
v_permlane32_swap_b32 v16, v17
s_nop 0
v_max_f32 v14, v14, v15
v_max_f32 v16, v16, v17
s_nop 1
v_permlane16_swap_b32 v14, v16
s_nop 0
v_max_f32 v14, v14, v16
v_mov_b32 v16, v14
s_nop 1
v_permlane16_swap_b32 v14, v16
s_nop 0
v_mov_b32 v15, v14
v_mov_b32 v17, v16
s_nop 1
v_permlane32_swap_b32 v14, v15
v_permlane32_swap_b32 v16, v17
s_nop 0
v_pk_mul_f32 v[14:15], v[14:15], v[10:11]
v_pk_mul_f32 v[16:17], v[16:17], v[12:13]
v_pk_fma_f32 v[148:149], v[148:149], v[10:11], v[14:15] op_sel:[0,0,0] op_sel_hi:[1,0,0] neg_lo:[0,0,1] neg_hi:[0,0,1]
v_pk_fma_f32 v[150:151], v[150:151], v[10:11], v[14:15] op_sel:[0,0,0] op_sel_hi:[1,0,0] neg_lo:[0,0,1] neg_hi:[0,0,1]
v_exp_f32 v148, v148
v_exp_f32 v149, v149
v_exp_f32 v150, v150
v_exp_f32 v151, v151
v_cvt_pk_bf16_f32 v148, v148, v148
v_cvt_pk_bf16_f32 v149, v149, v149
v_cvt_pk_bf16_f32 v150, v150, v150
v_cvt_pk_bf16_f32 v151, v151, v151
v_and_b32 v148, v52, v148
v_and_b32 v149, v52, v149
v_and_b32 v150, v52, v150
v_and_b32 v151, v52, v151
v_pk_fma_f32 v[156:157], v[156:157], v[10:11], v[14:15] op_sel:[0,1,1] op_sel_hi:[1,1,1] neg_lo:[0,0,1] neg_hi:[0,0,1]
v_pk_fma_f32 v[158:159], v[158:159], v[10:11], v[14:15] op_sel:[0,1,1] op_sel_hi:[1,1,1] neg_lo:[0,0,1] neg_hi:[0,0,1]
v_exp_f32 v156, v156
v_mfma_f32_16x16x32_bf16 v[152:155], v[56:59], v[148:151], 0
v_exp_f32 v157, v157
v_exp_f32 v158, v158
v_exp_f32 v159, v159
v_cvt_pk_bf16_f32 v156, v156, v156
v_mfma_f32_16x16x32_bf16 v[212:215], v[20:23], v[148:151], 0
v_cvt_pk_bf16_f32 v157, v157, v157
v_cvt_pk_bf16_f32 v158, v158, v158
v_cvt_pk_bf16_f32 v159, v159, v159
v_and_b32 v156, v52, v156
v_mfma_f32_16x16x32_bf16 v[216:219], v[30:33], v[148:151], 0
v_and_b32 v157, v52, v157
v_and_b32 v158, v52, v158
v_and_b32 v159, v52, v159
v_pk_fma_f32 v[164:165], v[164:165], v[12:13], v[16:17] op_sel:[0,0,0] op_sel_hi:[1,0,0] neg_lo:[0,0,1] neg_hi:[0,0,1]
v_pk_fma_f32 v[166:167], v[166:167], v[12:13], v[16:17] op_sel:[0,0,0] op_sel_hi:[1,0,0] neg_lo:[0,0,1] neg_hi:[0,0,1]
v_exp_f32 v164, v164
v_mfma_f32_16x16x32_bf16 v[160:163], v[56:59], v[156:159], 0
v_exp_f32 v165, v165
v_exp_f32 v166, v166
v_exp_f32 v167, v167
v_cvt_pk_bf16_f32 v164, v164, v164
v_mfma_f32_16x16x32_bf16 v[220:223], v[22:25], v[156:159], 0
v_cvt_pk_bf16_f32 v165, v165, v165
v_cvt_pk_bf16_f32 v166, v166, v166
v_cvt_pk_bf16_f32 v167, v167, v167
v_and_b32 v164, v52, v164
v_mfma_f32_16x16x32_bf16 v[224:227], v[32:35], v[156:159], 0
v_and_b32 v165, v52, v165
v_and_b32 v166, v52, v166
v_and_b32 v167, v52, v167
v_pk_fma_f32 v[172:173], v[172:173], v[12:13], v[16:17] op_sel:[0,1,1] op_sel_hi:[1,1,1] neg_lo:[0,0,1] neg_hi:[0,0,1]
v_pk_fma_f32 v[174:175], v[174:175], v[12:13], v[16:17] op_sel:[0,1,1] op_sel_hi:[1,1,1] neg_lo:[0,0,1] neg_hi:[0,0,1]
v_exp_f32 v172, v172
v_mfma_f32_16x16x32_bf16 v[168:171], v[56:59], v[164:167], 0
v_exp_f32 v173, v173
v_exp_f32 v174, v174
v_exp_f32 v175, v175
v_cvt_pk_bf16_f32 v172, v172, v172
v_mfma_f32_16x16x32_bf16 v[228:231], v[24:27], v[164:167], 0
v_cvt_pk_bf16_f32 v173, v173, v173
v_cvt_pk_bf16_f32 v174, v174, v174
v_cvt_pk_bf16_f32 v175, v175, v175
v_and_b32 v172, v52, v172
v_mfma_f32_16x16x32_bf16 v[232:235], v[34:37], v[164:167], 0
v_and_b32 v173, v52, v173
v_and_b32 v174, v52, v174
v_and_b32 v175, v52, v175
s_nop 1
v_mfma_f32_16x16x32_bf16 v[176:179], v[56:59], v[172:175], 0
v_mfma_f32_16x16x32_bf16 v[236:239], v[26:29], v[172:175], 0
v_mfma_f32_16x16x32_bf16 v[240:243], v[36:39], v[172:175], 0
v_rcp_f32 v152, v152
v_rcp_f32 v160, v160
v_rcp_f32 v168, v168
s_nop 2
v_rcp_f32 v176, v176
s_cmp_eq_u32 s46, 0
s_cbranch_scc1 slow_70
.p2align 3
v_pk_mul_f32 v[212:213], v[212:213], v[152:153] op_sel:[0,0] op_sel_hi:[1,0]
v_pk_mul_f32 v[214:215], v[214:215], v[152:153] op_sel:[0,0] op_sel_hi:[1,0]
v_pk_mul_f32 v[216:217], v[216:217], v[152:153] op_sel:[0,0] op_sel_hi:[1,0]
v_pk_mul_f32 v[218:219], v[218:219], v[152:153] op_sel:[0,0] op_sel_hi:[1,0]
v_cvt_pk_bf16_f32 v212, v212, v213
v_cvt_pk_bf16_f32 v213, v214, v215
v_cvt_pk_bf16_f32 v214, v216, v217
v_cvt_pk_bf16_f32 v215, v218, v219
buffer_store_dwordx4 v[212:215], v18, s[32:35], s80 offen
v_pk_mul_f32 v[220:221], v[220:221], v[160:161] op_sel:[0,0] op_sel_hi:[1,0]
v_pk_mul_f32 v[222:223], v[222:223], v[160:161] op_sel:[0,0] op_sel_hi:[1,0]
v_pk_mul_f32 v[224:225], v[224:225], v[160:161] op_sel:[0,0] op_sel_hi:[1,0]
v_pk_mul_f32 v[226:227], v[226:227], v[160:161] op_sel:[0,0] op_sel_hi:[1,0]
v_cvt_pk_bf16_f32 v220, v220, v221
v_cvt_pk_bf16_f32 v221, v222, v223
v_cvt_pk_bf16_f32 v222, v224, v225
v_cvt_pk_bf16_f32 v223, v226, v227
buffer_store_dwordx4 v[220:223], v18, s[32:35], s81 offen
v_pk_mul_f32 v[228:229], v[228:229], v[168:169] op_sel:[0,0] op_sel_hi:[1,0]
v_pk_mul_f32 v[230:231], v[230:231], v[168:169] op_sel:[0,0] op_sel_hi:[1,0]
v_pk_mul_f32 v[232:233], v[232:233], v[168:169] op_sel:[0,0] op_sel_hi:[1,0]
v_pk_mul_f32 v[234:235], v[234:235], v[168:169] op_sel:[0,0] op_sel_hi:[1,0]
v_cvt_pk_bf16_f32 v228, v228, v229
v_cvt_pk_bf16_f32 v229, v230, v231
v_cvt_pk_bf16_f32 v230, v232, v233
v_cvt_pk_bf16_f32 v231, v234, v235
buffer_store_dwordx4 v[228:231], v18, s[32:35], s82 offen
v_pk_mul_f32 v[236:237], v[236:237], v[176:177] op_sel:[0,0] op_sel_hi:[1,0]
v_pk_mul_f32 v[238:239], v[238:239], v[176:177] op_sel:[0,0] op_sel_hi:[1,0]
v_pk_mul_f32 v[240:241], v[240:241], v[176:177] op_sel:[0,0] op_sel_hi:[1,0]
v_pk_mul_f32 v[242:243], v[242:243], v[176:177] op_sel:[0,0] op_sel_hi:[1,0]
v_cvt_pk_bf16_f32 v236, v236, v237
v_cvt_pk_bf16_f32 v237, v238, v239
v_cvt_pk_bf16_f32 v238, v240, v241
v_cvt_pk_bf16_f32 v239, v242, v243
buffer_store_dwordx4 v[236:239], v18, s[32:35], s83 offen
s_barrier
s_lshl_b32 s62, s45, 2
v_mov_b32 v4, s62
v_mov_b32 v5, 3
s_mov_b64 exec, 1
s_waitcnt vmcnt(0)
buffer_store_dword v5, v4, s[32:35], s84 offen
s_mov_b64 exec, -1
back_71:
buffer_load_dwordx4 v[88:91], v18, s[32:35], s85 offen offset:0 sc1
buffer_load_dwordx4 v[92:95], v18, s[32:35], s85 offen offset:1024 sc1
buffer_load_dwordx4 v[96:99], v18, s[32:35], s86 offen offset:0 sc1
buffer_load_dwordx4 v[100:103], v18, s[32:35], s86 offen offset:1024 sc1
v_and_b32 v10, 31, v0
v_lshlrev_b32 v10, 2, v10
buffer_load_dword v11, v10, s[32:35], s84 offen sc1
v_lshrrev_b32 v4, 2, v2
v_and_b32 v5, 3, v0
v_lshl_add_u32 v6, v3, 3, v4
v_lshlrev_b32 v6, 7, v6
v_lshl_add_u32 v6, v5, 3, v6
v_lshrrev_b32 v7, 1, v4
v_and_b32 v8, 1, v3
v_lshl_add_u32 v7, v8, 1, v7
v_lshl_add_u32 v14, v7, 5, v6
v_xor_b32 v15, 32, v14
v_xor_b32 v16, 64, v14
v_xor_b32 v17, 96, v14
v_add_u32 v52, 0x10000, v14
v_add_u32 v53, 0x10000, v15
v_add_u32 v54, 0x10000, v16
v_add_u32 v55, 0x10000, v17
ds_read_b64_tr_b16 v[212:213], v14 offset:0
ds_read_b64_tr_b16 v[214:215], v14 offset:512
ds_read_b64_tr_b16 v[216:217], v15 offset:0
ds_read_b64_tr_b16 v[218:219], v15 offset:512
ds_read_b64_tr_b16 v[220:221], v16 offset:0
ds_read_b64_tr_b16 v[222:223], v16 offset:512
ds_read_b64_tr_b16 v[224:225], v17 offset:0
ds_read_b64_tr_b16 v[226:227], v17 offset:512
ds_read_b64_tr_b16 v[228:229], v14 offset:4096
ds_read_b64_tr_b16 v[230:231], v14 offset:4608
ds_read_b64_tr_b16 v[232:233], v15 offset:4096
ds_read_b64_tr_b16 v[234:235], v15 offset:4608
ds_read_b64_tr_b16 v[236:237], v16 offset:4096
ds_read_b64_tr_b16 v[238:239], v16 offset:4608
ds_read_b64_tr_b16 v[240:241], v17 offset:4096
ds_read_b64_tr_b16 v[242:243], v17 offset:4608
s_lshl_b32 s48, s41, 3
s_lshl_b32 s49, s40, 1
s_add_u32 s56, s48, s49
s_lshl_b32 s48, s56, 15
s_add_u32 s48, s48, 4194304
v_add_u32 v12, s48, v18
v_add_u32 v13, 32768, v12
s_lshl_b32 s57, s47, 11
s_mov_b32 s63, 0
s_waitcnt vmcnt(0)
poll_72:
v_cmp_gt_u32 vcc, 3, v11
s_cbranch_vccz polled_73
buffer_load_dword v11, v10, s[32:35], s84 offen sc1
s_add_u32 s63, s63, 1
s_cmp_lt_u32 s63, 0x80000
s_waitcnt vmcnt(0)
s_cbranch_scc1 poll_72
polled_73:
buffer_load_dwordx4 v[148:151], v12, s[32:35], s57 offen sc1
buffer_load_dwordx4 v[152:155], v13, s[32:35], s57 offen sc1
buffer_load_dwordx4 v[156:159], v12, s[32:35], s57 offen offset:1024 sc1
buffer_load_dwordx4 v[160:163], v13, s[32:35], s57 offen offset:1024 sc1
s_add_u32 s57, s57, 2048
s_and_b32 s57, s57, 0x7fff
buffer_load_dwordx4 v[164:167], v12, s[32:35], s57 offen sc1
buffer_load_dwordx4 v[168:171], v13, s[32:35], s57 offen sc1
buffer_load_dwordx4 v[172:175], v12, s[32:35], s57 offen offset:1024 sc1
buffer_load_dwordx4 v[176:179], v13, s[32:35], s57 offen offset:1024 sc1
s_add_u32 s57, s57, 2048
s_and_b32 s57, s57, 0x7fff
buffer_load_dwordx4 v[180:183], v12, s[32:35], s57 offen sc1
buffer_load_dwordx4 v[184:187], v13, s[32:35], s57 offen sc1
buffer_load_dwordx4 v[188:191], v12, s[32:35], s57 offen offset:1024 sc1
buffer_load_dwordx4 v[192:195], v13, s[32:35], s57 offen offset:1024 sc1
s_add_u32 s57, s57, 2048
s_and_b32 s57, s57, 0x7fff
v_lshlrev_b32 v20, 16, v88
v_and_b32 v21, 0xffff0000, v88
v_lshlrev_b32 v22, 16, v89
v_and_b32 v23, 0xffff0000, v89
v_lshlrev_b32 v24, 16, v90
v_and_b32 v25, 0xffff0000, v90
v_lshlrev_b32 v26, 16, v91
v_and_b32 v27, 0xffff0000, v91
v_lshlrev_b32 v28, 16, v92
v_and_b32 v29, 0xffff0000, v92
v_lshlrev_b32 v30, 16, v93
v_and_b32 v31, 0xffff0000, v93
v_lshlrev_b32 v32, 16, v94
v_and_b32 v33, 0xffff0000, v94
v_lshlrev_b32 v34, 16, v95
v_and_b32 v35, 0xffff0000, v95
v_lshlrev_b32 v36, 16, v96
v_and_b32 v37, 0xffff0000, v96
v_lshlrev_b32 v38, 16, v97
v_and_b32 v39, 0xffff0000, v97
v_lshlrev_b32 v40, 16, v98
v_and_b32 v41, 0xffff0000, v98
v_lshlrev_b32 v42, 16, v99
v_and_b32 v43, 0xffff0000, v99
v_lshlrev_b32 v44, 16, v100
v_and_b32 v45, 0xffff0000, v100
v_lshlrev_b32 v46, 16, v101
v_and_b32 v47, 0xffff0000, v101
v_lshlrev_b32 v48, 16, v102
v_and_b32 v49, 0xffff0000, v102
v_lshlrev_b32 v50, 16, v103
v_and_b32 v51, 0xffff0000, v103
v_mov_b32 v10, 0x3f803f80
v_mov_b32 v6, 0
v_mov_b32 v7, 0
v_mov_b32 v8, 0
v_mov_b32 v9, 0
s_lshl_b32 s62, s42, 2
v_mov_b32 v4, s62
v_mov_b32 v5, 3
s_waitcnt vmcnt(10) lgkmcnt(8)
v_mfma_f32_16x16x32_bf16 v[20:23], v[212:215], v[148:151], v[20:23]
ds_read_b64_tr_b16 v[104:105], v14 offset:8192
ds_read_b64_tr_b16 v[106:107], v14 offset:8704
v_mfma_f32_16x16x32_bf16 v[36:39], v[212:215], v[152:155], v[36:39]
buffer_load_dwordx4 v[196:199], v12, s[32:35], s57 offen sc1
v_mfma_f32_16x16x32_bf16 v[24:27], v[216:219], v[148:151], v[24:27]
ds_read_b64_tr_b16 v[108:109], v15 offset:8192
v_mfma_f32_16x16x32_bf16 v[40:43], v[216:219], v[152:155], v[40:43]
ds_read_b64_tr_b16 v[110:111], v15 offset:8704
v_mfma_f32_16x16x32_bf16 v[28:31], v[220:223], v[148:151], v[28:31]
ds_read_b64_tr_b16 v[112:113], v16 offset:8192
buffer_load_dwordx4 v[200:203], v13, s[32:35], s57 offen sc1
v_mfma_f32_16x16x32_bf16 v[44:47], v[220:223], v[152:155], v[44:47]
ds_read_b64_tr_b16 v[114:115], v16 offset:8704
v_mfma_f32_16x16x32_bf16 v[32:35], v[224:227], v[148:151], v[32:35]
ds_read_b64_tr_b16 v[116:117], v17 offset:8192
v_mfma_f32_16x16x32_bf16 v[48:51], v[224:227], v[152:155], v[48:51]
ds_read_b64_tr_b16 v[118:119], v17 offset:8704
s_waitcnt vmcnt(10) lgkmcnt(8)
v_mfma_f32_16x16x32_bf16 v[20:23], v[228:231], v[156:159], v[20:23]
ds_read_b64_tr_b16 v[212:213], v14 offset:12288
ds_read_b64_tr_b16 v[214:215], v14 offset:12800
v_mfma_f32_16x16x32_bf16 v[36:39], v[228:231], v[160:163], v[36:39]
buffer_load_dwordx4 v[204:207], v12, s[32:35], s57 offen offset:1024 sc1
v_mfma_f32_16x16x32_bf16 v[24:27], v[232:235], v[156:159], v[24:27]
ds_read_b64_tr_b16 v[216:217], v15 offset:12288
v_mfma_f32_16x16x32_bf16 v[40:43], v[232:235], v[160:163], v[40:43]
ds_read_b64_tr_b16 v[218:219], v15 offset:12800
v_mfma_f32_16x16x32_bf16 v[28:31], v[236:239], v[156:159], v[28:31]
ds_read_b64_tr_b16 v[220:221], v16 offset:12288
buffer_load_dwordx4 v[208:211], v13, s[32:35], s57 offen offset:1024 sc1
s_add_u32 s57, s57, 2048
s_and_b32 s57, s57, 0x7fff
v_mfma_f32_16x16x32_bf16 v[44:47], v[236:239], v[160:163], v[44:47]
ds_read_b64_tr_b16 v[222:223], v16 offset:12800
v_mfma_f32_16x16x32_bf16 v[32:35], v[240:243], v[156:159], v[32:35]
ds_read_b64_tr_b16 v[224:225], v17 offset:12288
v_mfma_f32_16x16x32_bf16 v[48:51], v[240:243], v[160:163], v[48:51]
ds_read_b64_tr_b16 v[226:227], v17 offset:12800
s_waitcnt vmcnt(10) lgkmcnt(8)
v_mfma_f32_16x16x32_bf16 v[20:23], v[104:107], v[164:167], v[20:23]
ds_read_b64_tr_b16 v[228:229], v14 offset:16384
ds_read_b64_tr_b16 v[230:231], v14 offset:16896
v_mfma_f32_16x16x32_bf16 v[36:39], v[104:107], v[168:171], v[36:39]
buffer_load_dwordx4 v[148:151], v12, s[32:35], s57 offen sc1
v_mfma_f32_16x16x32_bf16 v[24:27], v[108:111], v[164:167], v[24:27]
ds_read_b64_tr_b16 v[232:233], v15 offset:16384
v_mfma_f32_16x16x32_bf16 v[40:43], v[108:111], v[168:171], v[40:43]
ds_read_b64_tr_b16 v[234:235], v15 offset:16896
v_mfma_f32_16x16x32_bf16 v[28:31], v[112:115], v[164:167], v[28:31]
ds_read_b64_tr_b16 v[236:237], v16 offset:16384
buffer_load_dwordx4 v[152:155], v13, s[32:35], s57 offen sc1
v_mfma_f32_16x16x32_bf16 v[44:47], v[112:115], v[168:171], v[44:47]
ds_read_b64_tr_b16 v[238:239], v16 offset:16896
v_mfma_f32_16x16x32_bf16 v[32:35], v[116:119], v[164:167], v[32:35]
ds_read_b64_tr_b16 v[240:241], v17 offset:16384
v_mfma_f32_16x16x32_bf16 v[48:51], v[116:119], v[168:171], v[48:51]
ds_read_b64_tr_b16 v[242:243], v17 offset:16896
s_waitcnt vmcnt(10) lgkmcnt(8)
v_mfma_f32_16x16x32_bf16 v[20:23], v[212:215], v[172:175], v[20:23]
ds_read_b64_tr_b16 v[104:105], v14 offset:20480
ds_read_b64_tr_b16 v[106:107], v14 offset:20992
v_mfma_f32_16x16x32_bf16 v[36:39], v[212:215], v[176:179], v[36:39]
buffer_load_dwordx4 v[156:159], v12, s[32:35], s57 offen offset:1024 sc1
v_mfma_f32_16x16x32_bf16 v[24:27], v[216:219], v[172:175], v[24:27]
ds_read_b64_tr_b16 v[108:109], v15 offset:20480
v_mfma_f32_16x16x32_bf16 v[40:43], v[216:219], v[176:179], v[40:43]
ds_read_b64_tr_b16 v[110:111], v15 offset:20992
v_mfma_f32_16x16x32_bf16 v[28:31], v[220:223], v[172:175], v[28:31]
ds_read_b64_tr_b16 v[112:113], v16 offset:20480
buffer_load_dwordx4 v[160:163], v13, s[32:35], s57 offen offset:1024 sc1
s_add_u32 s57, s57, 2048
s_and_b32 s57, s57, 0x7fff
v_mfma_f32_16x16x32_bf16 v[44:47], v[220:223], v[176:179], v[44:47]
ds_read_b64_tr_b16 v[114:115], v16 offset:20992
v_mfma_f32_16x16x32_bf16 v[32:35], v[224:227], v[172:175], v[32:35]
ds_read_b64_tr_b16 v[116:117], v17 offset:20480
v_mfma_f32_16x16x32_bf16 v[48:51], v[224:227], v[176:179], v[48:51]
ds_read_b64_tr_b16 v[118:119], v17 offset:20992
s_waitcnt vmcnt(10) lgkmcnt(8)
v_mfma_f32_16x16x32_bf16 v[20:23], v[228:231], v[180:183], v[20:23]
ds_read_b64_tr_b16 v[212:213], v14 offset:24576
ds_read_b64_tr_b16 v[214:215], v14 offset:25088
v_mfma_f32_16x16x32_bf16 v[36:39], v[228:231], v[184:187], v[36:39]
buffer_load_dwordx4 v[164:167], v12, s[32:35], s57 offen sc1
v_mfma_f32_16x16x32_bf16 v[24:27], v[232:235], v[180:183], v[24:27]
ds_read_b64_tr_b16 v[216:217], v15 offset:24576
v_mfma_f32_16x16x32_bf16 v[40:43], v[232:235], v[184:187], v[40:43]
ds_read_b64_tr_b16 v[218:219], v15 offset:25088
v_mfma_f32_16x16x32_bf16 v[28:31], v[236:239], v[180:183], v[28:31]
ds_read_b64_tr_b16 v[220:221], v16 offset:24576
buffer_load_dwordx4 v[168:171], v13, s[32:35], s57 offen sc1
v_mfma_f32_16x16x32_bf16 v[44:47], v[236:239], v[184:187], v[44:47]
ds_read_b64_tr_b16 v[222:223], v16 offset:25088
v_mfma_f32_16x16x32_bf16 v[32:35], v[240:243], v[180:183], v[32:35]
ds_read_b64_tr_b16 v[224:225], v17 offset:24576
v_mfma_f32_16x16x32_bf16 v[48:51], v[240:243], v[184:187], v[48:51]
ds_read_b64_tr_b16 v[226:227], v17 offset:25088
s_waitcnt vmcnt(10) lgkmcnt(8)
v_mfma_f32_16x16x32_bf16 v[20:23], v[104:107], v[188:191], v[20:23]
ds_read_b64_tr_b16 v[228:229], v14 offset:28672
ds_read_b64_tr_b16 v[230:231], v14 offset:29184
v_mfma_f32_16x16x32_bf16 v[36:39], v[104:107], v[192:195], v[36:39]
buffer_load_dwordx4 v[172:175], v12, s[32:35], s57 offen offset:1024 sc1
v_mfma_f32_16x16x32_bf16 v[24:27], v[108:111], v[188:191], v[24:27]
ds_read_b64_tr_b16 v[232:233], v15 offset:28672
v_mfma_f32_16x16x32_bf16 v[40:43], v[108:111], v[192:195], v[40:43]
ds_read_b64_tr_b16 v[234:235], v15 offset:29184
v_mfma_f32_16x16x32_bf16 v[28:31], v[112:115], v[188:191], v[28:31]
ds_read_b64_tr_b16 v[236:237], v16 offset:28672
buffer_load_dwordx4 v[176:179], v13, s[32:35], s57 offen offset:1024 sc1
s_add_u32 s57, s57, 2048
s_and_b32 s57, s57, 0x7fff
v_mfma_f32_16x16x32_bf16 v[44:47], v[112:115], v[192:195], v[44:47]
ds_read_b64_tr_b16 v[238:239], v16 offset:29184
v_mfma_f32_16x16x32_bf16 v[32:35], v[116:119], v[188:191], v[32:35]
ds_read_b64_tr_b16 v[240:241], v17 offset:28672
v_mfma_f32_16x16x32_bf16 v[48:51], v[116:119], v[192:195], v[48:51]
ds_read_b64_tr_b16 v[242:243], v17 offset:29184
s_waitcnt vmcnt(10) lgkmcnt(8)
v_mfma_f32_16x16x32_bf16 v[20:23], v[212:215], v[196:199], v[20:23]
ds_read_b64_tr_b16 v[104:105], v14 offset:32768
ds_read_b64_tr_b16 v[106:107], v14 offset:33280
v_mfma_f32_16x16x32_bf16 v[36:39], v[212:215], v[200:203], v[36:39]
buffer_load_dwordx4 v[180:183], v12, s[32:35], s57 offen sc1
v_mfma_f32_16x16x32_bf16 v[24:27], v[216:219], v[196:199], v[24:27]
ds_read_b64_tr_b16 v[108:109], v15 offset:32768
v_mfma_f32_16x16x32_bf16 v[40:43], v[216:219], v[200:203], v[40:43]
ds_read_b64_tr_b16 v[110:111], v15 offset:33280
v_mfma_f32_16x16x32_bf16 v[28:31], v[220:223], v[196:199], v[28:31]
ds_read_b64_tr_b16 v[112:113], v16 offset:32768
buffer_load_dwordx4 v[184:187], v13, s[32:35], s57 offen sc1
v_mfma_f32_16x16x32_bf16 v[44:47], v[220:223], v[200:203], v[44:47]
ds_read_b64_tr_b16 v[114:115], v16 offset:33280
v_mfma_f32_16x16x32_bf16 v[32:35], v[224:227], v[196:199], v[32:35]
ds_read_b64_tr_b16 v[116:117], v17 offset:32768
v_mfma_f32_16x16x32_bf16 v[48:51], v[224:227], v[200:203], v[48:51]
ds_read_b64_tr_b16 v[118:119], v17 offset:33280
s_waitcnt vmcnt(10) lgkmcnt(8)
v_mfma_f32_16x16x32_bf16 v[20:23], v[228:231], v[204:207], v[20:23]
ds_read_b64_tr_b16 v[212:213], v14 offset:36864
ds_read_b64_tr_b16 v[214:215], v14 offset:37376
v_mfma_f32_16x16x32_bf16 v[36:39], v[228:231], v[208:211], v[36:39]
buffer_load_dwordx4 v[188:191], v12, s[32:35], s57 offen offset:1024 sc1
v_mfma_f32_16x16x32_bf16 v[24:27], v[232:235], v[204:207], v[24:27]
ds_read_b64_tr_b16 v[216:217], v15 offset:36864
v_mfma_f32_16x16x32_bf16 v[40:43], v[232:235], v[208:211], v[40:43]
ds_read_b64_tr_b16 v[218:219], v15 offset:37376
v_mfma_f32_16x16x32_bf16 v[28:31], v[236:239], v[204:207], v[28:31]
ds_read_b64_tr_b16 v[220:221], v16 offset:36864
buffer_load_dwordx4 v[192:195], v13, s[32:35], s57 offen offset:1024 sc1
s_add_u32 s57, s57, 2048
s_and_b32 s57, s57, 0x7fff
v_mfma_f32_16x16x32_bf16 v[44:47], v[236:239], v[208:211], v[44:47]
ds_read_b64_tr_b16 v[222:223], v16 offset:37376
v_mfma_f32_16x16x32_bf16 v[32:35], v[240:243], v[204:207], v[32:35]
ds_read_b64_tr_b16 v[224:225], v17 offset:36864
v_mfma_f32_16x16x32_bf16 v[48:51], v[240:243], v[208:211], v[48:51]
ds_read_b64_tr_b16 v[226:227], v17 offset:37376
s_waitcnt vmcnt(10) lgkmcnt(8)
v_mfma_f32_16x16x32_bf16 v[20:23], v[104:107], v[148:151], v[20:23]
ds_read_b64_tr_b16 v[228:229], v14 offset:40960
ds_read_b64_tr_b16 v[230:231], v14 offset:41472
v_mfma_f32_16x16x32_bf16 v[36:39], v[104:107], v[152:155], v[36:39]
buffer_load_dwordx4 v[196:199], v12, s[32:35], s57 offen sc1
v_mfma_f32_16x16x32_bf16 v[24:27], v[108:111], v[148:151], v[24:27]
ds_read_b64_tr_b16 v[232:233], v15 offset:40960
v_mfma_f32_16x16x32_bf16 v[40:43], v[108:111], v[152:155], v[40:43]
ds_read_b64_tr_b16 v[234:235], v15 offset:41472
v_mfma_f32_16x16x32_bf16 v[28:31], v[112:115], v[148:151], v[28:31]
ds_read_b64_tr_b16 v[236:237], v16 offset:40960
buffer_load_dwordx4 v[200:203], v13, s[32:35], s57 offen sc1
v_mfma_f32_16x16x32_bf16 v[44:47], v[112:115], v[152:155], v[44:47]
ds_read_b64_tr_b16 v[238:239], v16 offset:41472
v_mfma_f32_16x16x32_bf16 v[32:35], v[116:119], v[148:151], v[32:35]
ds_read_b64_tr_b16 v[240:241], v17 offset:40960
v_mfma_f32_16x16x32_bf16 v[48:51], v[116:119], v[152:155], v[48:51]
ds_read_b64_tr_b16 v[242:243], v17 offset:41472
s_waitcnt vmcnt(10) lgkmcnt(8)
v_mfma_f32_16x16x32_bf16 v[20:23], v[212:215], v[156:159], v[20:23]
ds_read_b64_tr_b16 v[104:105], v14 offset:45056
ds_read_b64_tr_b16 v[106:107], v14 offset:45568
v_mfma_f32_16x16x32_bf16 v[36:39], v[212:215], v[160:163], v[36:39]
buffer_load_dwordx4 v[204:207], v12, s[32:35], s57 offen offset:1024 sc1
v_mfma_f32_16x16x32_bf16 v[24:27], v[216:219], v[156:159], v[24:27]
ds_read_b64_tr_b16 v[108:109], v15 offset:45056
v_mfma_f32_16x16x32_bf16 v[40:43], v[216:219], v[160:163], v[40:43]
ds_read_b64_tr_b16 v[110:111], v15 offset:45568
v_mfma_f32_16x16x32_bf16 v[28:31], v[220:223], v[156:159], v[28:31]
ds_read_b64_tr_b16 v[112:113], v16 offset:45056
buffer_load_dwordx4 v[208:211], v13, s[32:35], s57 offen offset:1024 sc1
s_add_u32 s57, s57, 2048
s_and_b32 s57, s57, 0x7fff
v_mfma_f32_16x16x32_bf16 v[44:47], v[220:223], v[160:163], v[44:47]
ds_read_b64_tr_b16 v[114:115], v16 offset:45568
v_mfma_f32_16x16x32_bf16 v[32:35], v[224:227], v[156:159], v[32:35]
ds_read_b64_tr_b16 v[116:117], v17 offset:45056
v_mfma_f32_16x16x32_bf16 v[48:51], v[224:227], v[160:163], v[48:51]
ds_read_b64_tr_b16 v[118:119], v17 offset:45568
s_waitcnt vmcnt(10) lgkmcnt(8)
v_mfma_f32_16x16x32_bf16 v[20:23], v[228:231], v[164:167], v[20:23]
ds_read_b64_tr_b16 v[212:213], v14 offset:49152
ds_read_b64_tr_b16 v[214:215], v14 offset:49664
v_mfma_f32_16x16x32_bf16 v[36:39], v[228:231], v[168:171], v[36:39]
buffer_load_dwordx4 v[148:151], v12, s[32:35], s57 offen sc1
v_mfma_f32_16x16x32_bf16 v[24:27], v[232:235], v[164:167], v[24:27]
ds_read_b64_tr_b16 v[216:217], v15 offset:49152
v_mfma_f32_16x16x32_bf16 v[40:43], v[232:235], v[168:171], v[40:43]
ds_read_b64_tr_b16 v[218:219], v15 offset:49664
v_mfma_f32_16x16x32_bf16 v[28:31], v[236:239], v[164:167], v[28:31]
ds_read_b64_tr_b16 v[220:221], v16 offset:49152
buffer_load_dwordx4 v[152:155], v13, s[32:35], s57 offen sc1
v_mfma_f32_16x16x32_bf16 v[44:47], v[236:239], v[168:171], v[44:47]
ds_read_b64_tr_b16 v[222:223], v16 offset:49664
v_mfma_f32_16x16x32_bf16 v[32:35], v[240:243], v[164:167], v[32:35]
ds_read_b64_tr_b16 v[224:225], v17 offset:49152
v_mfma_f32_16x16x32_bf16 v[48:51], v[240:243], v[168:171], v[48:51]
ds_read_b64_tr_b16 v[226:227], v17 offset:49664
s_waitcnt vmcnt(10) lgkmcnt(8)
v_mfma_f32_16x16x32_bf16 v[20:23], v[104:107], v[172:175], v[20:23]
ds_read_b64_tr_b16 v[228:229], v14 offset:53248
ds_read_b64_tr_b16 v[230:231], v14 offset:53760
v_mfma_f32_16x16x32_bf16 v[36:39], v[104:107], v[176:179], v[36:39]
buffer_load_dwordx4 v[156:159], v12, s[32:35], s57 offen offset:1024 sc1
v_mfma_f32_16x16x32_bf16 v[24:27], v[108:111], v[172:175], v[24:27]
ds_read_b64_tr_b16 v[232:233], v15 offset:53248
v_mfma_f32_16x16x32_bf16 v[40:43], v[108:111], v[176:179], v[40:43]
ds_read_b64_tr_b16 v[234:235], v15 offset:53760
v_mfma_f32_16x16x32_bf16 v[28:31], v[112:115], v[172:175], v[28:31]
ds_read_b64_tr_b16 v[236:237], v16 offset:53248
buffer_load_dwordx4 v[160:163], v13, s[32:35], s57 offen offset:1024 sc1
s_add_u32 s57, s57, 2048
s_and_b32 s57, s57, 0x7fff
v_mfma_f32_16x16x32_bf16 v[44:47], v[112:115], v[176:179], v[44:47]
ds_read_b64_tr_b16 v[238:239], v16 offset:53760
v_mfma_f32_16x16x32_bf16 v[32:35], v[116:119], v[172:175], v[32:35]
ds_read_b64_tr_b16 v[240:241], v17 offset:53248
v_mfma_f32_16x16x32_bf16 v[48:51], v[116:119], v[176:179], v[48:51]
ds_read_b64_tr_b16 v[242:243], v17 offset:53760
s_waitcnt vmcnt(10) lgkmcnt(8)
v_mfma_f32_16x16x32_bf16 v[20:23], v[212:215], v[180:183], v[20:23]
ds_read_b64_tr_b16 v[104:105], v14 offset:57344
ds_read_b64_tr_b16 v[106:107], v14 offset:57856
v_mfma_f32_16x16x32_bf16 v[36:39], v[212:215], v[184:187], v[36:39]
buffer_load_dwordx4 v[164:167], v12, s[32:35], s57 offen sc1
v_mfma_f32_16x16x32_bf16 v[24:27], v[216:219], v[180:183], v[24:27]
ds_read_b64_tr_b16 v[108:109], v15 offset:57344
v_mfma_f32_16x16x32_bf16 v[40:43], v[216:219], v[184:187], v[40:43]
ds_read_b64_tr_b16 v[110:111], v15 offset:57856
v_mfma_f32_16x16x32_bf16 v[28:31], v[220:223], v[180:183], v[28:31]
ds_read_b64_tr_b16 v[112:113], v16 offset:57344
buffer_load_dwordx4 v[168:171], v13, s[32:35], s57 offen sc1
v_mfma_f32_16x16x32_bf16 v[44:47], v[220:223], v[184:187], v[44:47]
ds_read_b64_tr_b16 v[114:115], v16 offset:57856
v_mfma_f32_16x16x32_bf16 v[32:35], v[224:227], v[180:183], v[32:35]
ds_read_b64_tr_b16 v[116:117], v17 offset:57344
v_mfma_f32_16x16x32_bf16 v[48:51], v[224:227], v[184:187], v[48:51]
ds_read_b64_tr_b16 v[118:119], v17 offset:57856
s_waitcnt vmcnt(10) lgkmcnt(8)
v_mfma_f32_16x16x32_bf16 v[20:23], v[228:231], v[188:191], v[20:23]
ds_read_b64_tr_b16 v[212:213], v14 offset:61440
ds_read_b64_tr_b16 v[214:215], v14 offset:61952
v_mfma_f32_16x16x32_bf16 v[36:39], v[228:231], v[192:195], v[36:39]
buffer_load_dwordx4 v[172:175], v12, s[32:35], s57 offen offset:1024 sc1
v_mfma_f32_16x16x32_bf16 v[24:27], v[232:235], v[188:191], v[24:27]
ds_read_b64_tr_b16 v[216:217], v15 offset:61440
v_mfma_f32_16x16x32_bf16 v[40:43], v[232:235], v[192:195], v[40:43]
ds_read_b64_tr_b16 v[218:219], v15 offset:61952
v_mfma_f32_16x16x32_bf16 v[28:31], v[236:239], v[188:191], v[28:31]
ds_read_b64_tr_b16 v[220:221], v16 offset:61440
buffer_load_dwordx4 v[176:179], v13, s[32:35], s57 offen offset:1024 sc1
s_add_u32 s57, s57, 2048
s_and_b32 s57, s57, 0x7fff
v_mfma_f32_16x16x32_bf16 v[44:47], v[236:239], v[192:195], v[44:47]
ds_read_b64_tr_b16 v[222:223], v16 offset:61952
v_mfma_f32_16x16x32_bf16 v[32:35], v[240:243], v[188:191], v[32:35]
ds_read_b64_tr_b16 v[224:225], v17 offset:61440
v_mfma_f32_16x16x32_bf16 v[48:51], v[240:243], v[192:195], v[48:51]
ds_read_b64_tr_b16 v[226:227], v17 offset:61952
s_waitcnt vmcnt(10) lgkmcnt(8)
v_mfma_f32_16x16x32_bf16 v[20:23], v[104:107], v[196:199], v[20:23]
ds_read_b64_tr_b16 v[228:229], v52 offset:0
ds_read_b64_tr_b16 v[230:231], v52 offset:512
v_mfma_f32_16x16x32_bf16 v[36:39], v[104:107], v[200:203], v[36:39]
buffer_load_dwordx4 v[180:183], v12, s[32:35], s57 offen sc1
v_mfma_f32_16x16x32_bf16 v[24:27], v[108:111], v[196:199], v[24:27]
ds_read_b64_tr_b16 v[232:233], v53 offset:0
v_mfma_f32_16x16x32_bf16 v[40:43], v[108:111], v[200:203], v[40:43]
ds_read_b64_tr_b16 v[234:235], v53 offset:512
v_mfma_f32_16x16x32_bf16 v[28:31], v[112:115], v[196:199], v[28:31]
ds_read_b64_tr_b16 v[236:237], v54 offset:0
buffer_load_dwordx4 v[184:187], v13, s[32:35], s57 offen sc1
v_mfma_f32_16x16x32_bf16 v[44:47], v[112:115], v[200:203], v[44:47]
ds_read_b64_tr_b16 v[238:239], v54 offset:512
v_mfma_f32_16x16x32_bf16 v[32:35], v[116:119], v[196:199], v[32:35]
ds_read_b64_tr_b16 v[240:241], v55 offset:0
v_mfma_f32_16x16x32_bf16 v[48:51], v[116:119], v[200:203], v[48:51]
ds_read_b64_tr_b16 v[242:243], v55 offset:512
s_waitcnt vmcnt(10) lgkmcnt(8)
v_mfma_f32_16x16x32_bf16 v[20:23], v[212:215], v[204:207], v[20:23]
ds_read_b64_tr_b16 v[104:105], v52 offset:4096
ds_read_b64_tr_b16 v[106:107], v52 offset:4608
v_mfma_f32_16x16x32_bf16 v[36:39], v[212:215], v[208:211], v[36:39]
buffer_load_dwordx4 v[188:191], v12, s[32:35], s57 offen offset:1024 sc1
v_mfma_f32_16x16x32_bf16 v[24:27], v[216:219], v[204:207], v[24:27]
ds_read_b64_tr_b16 v[108:109], v53 offset:4096
v_mfma_f32_16x16x32_bf16 v[40:43], v[216:219], v[208:211], v[40:43]
ds_read_b64_tr_b16 v[110:111], v53 offset:4608
v_mfma_f32_16x16x32_bf16 v[28:31], v[220:223], v[204:207], v[28:31]
ds_read_b64_tr_b16 v[112:113], v54 offset:4096
buffer_load_dwordx4 v[192:195], v13, s[32:35], s57 offen offset:1024 sc1
s_add_u32 s57, s57, 2048
s_and_b32 s57, s57, 0x7fff
v_mfma_f32_16x16x32_bf16 v[44:47], v[220:223], v[208:211], v[44:47]
ds_read_b64_tr_b16 v[114:115], v54 offset:4608
v_mfma_f32_16x16x32_bf16 v[32:35], v[224:227], v[204:207], v[32:35]
ds_read_b64_tr_b16 v[116:117], v55 offset:4096
v_mfma_f32_16x16x32_bf16 v[48:51], v[224:227], v[208:211], v[48:51]
ds_read_b64_tr_b16 v[118:119], v55 offset:4608
s_waitcnt vmcnt(10) lgkmcnt(8)
v_mfma_f32_16x16x32_bf16 v[20:23], v[228:231], v[148:151], v[20:23]
ds_read_b64_tr_b16 v[212:213], v52 offset:8192
ds_read_b64_tr_b16 v[214:215], v52 offset:8704
v_mfma_f32_16x16x32_bf16 v[36:39], v[228:231], v[152:155], v[36:39]
buffer_load_dwordx4 v[196:199], v12, s[32:35], s57 offen sc1
v_mfma_f32_16x16x32_bf16 v[24:27], v[232:235], v[148:151], v[24:27]
ds_read_b64_tr_b16 v[216:217], v53 offset:8192
v_mfma_f32_16x16x32_bf16 v[40:43], v[232:235], v[152:155], v[40:43]
ds_read_b64_tr_b16 v[218:219], v53 offset:8704
v_mfma_f32_16x16x32_bf16 v[28:31], v[236:239], v[148:151], v[28:31]
ds_read_b64_tr_b16 v[220:221], v54 offset:8192
buffer_load_dwordx4 v[200:203], v13, s[32:35], s57 offen sc1
v_mfma_f32_16x16x32_bf16 v[44:47], v[236:239], v[152:155], v[44:47]
ds_read_b64_tr_b16 v[222:223], v54 offset:8704
v_mfma_f32_16x16x32_bf16 v[32:35], v[240:243], v[148:151], v[32:35]
ds_read_b64_tr_b16 v[224:225], v55 offset:8192
v_mfma_f32_16x16x32_bf16 v[48:51], v[240:243], v[152:155], v[48:51]
ds_read_b64_tr_b16 v[226:227], v55 offset:8704
s_waitcnt vmcnt(10) lgkmcnt(8)
v_mfma_f32_16x16x32_bf16 v[20:23], v[104:107], v[156:159], v[20:23]
ds_read_b64_tr_b16 v[228:229], v52 offset:12288
ds_read_b64_tr_b16 v[230:231], v52 offset:12800
v_mfma_f32_16x16x32_bf16 v[36:39], v[104:107], v[160:163], v[36:39]
buffer_load_dwordx4 v[204:207], v12, s[32:35], s57 offen offset:1024 sc1
v_mfma_f32_16x16x32_bf16 v[24:27], v[108:111], v[156:159], v[24:27]
ds_read_b64_tr_b16 v[232:233], v53 offset:12288
v_mfma_f32_16x16x32_bf16 v[40:43], v[108:111], v[160:163], v[40:43]
ds_read_b64_tr_b16 v[234:235], v53 offset:12800
v_mfma_f32_16x16x32_bf16 v[28:31], v[112:115], v[156:159], v[28:31]
ds_read_b64_tr_b16 v[236:237], v54 offset:12288
buffer_load_dwordx4 v[208:211], v13, s[32:35], s57 offen offset:1024 sc1
s_add_u32 s57, s57, 2048
s_and_b32 s57, s57, 0x7fff
v_mfma_f32_16x16x32_bf16 v[44:47], v[112:115], v[160:163], v[44:47]
ds_read_b64_tr_b16 v[238:239], v54 offset:12800
v_mfma_f32_16x16x32_bf16 v[32:35], v[116:119], v[156:159], v[32:35]
ds_read_b64_tr_b16 v[240:241], v55 offset:12288
v_mfma_f32_16x16x32_bf16 v[48:51], v[116:119], v[160:163], v[48:51]
ds_read_b64_tr_b16 v[242:243], v55 offset:12800
s_waitcnt vmcnt(10) lgkmcnt(8)
v_mfma_f32_16x16x32_bf16 v[20:23], v[212:215], v[164:167], v[20:23]
ds_read_b64_tr_b16 v[104:105], v52 offset:16384
ds_read_b64_tr_b16 v[106:107], v52 offset:16896
v_mfma_f32_16x16x32_bf16 v[36:39], v[212:215], v[168:171], v[36:39]
buffer_load_dwordx4 v[148:151], v12, s[32:35], s57 offen sc1
v_mfma_f32_16x16x32_bf16 v[24:27], v[216:219], v[164:167], v[24:27]
ds_read_b64_tr_b16 v[108:109], v53 offset:16384
v_mfma_f32_16x16x32_bf16 v[40:43], v[216:219], v[168:171], v[40:43]
ds_read_b64_tr_b16 v[110:111], v53 offset:16896
v_mfma_f32_16x16x32_bf16 v[28:31], v[220:223], v[164:167], v[28:31]
ds_read_b64_tr_b16 v[112:113], v54 offset:16384
buffer_load_dwordx4 v[152:155], v13, s[32:35], s57 offen sc1
v_mfma_f32_16x16x32_bf16 v[44:47], v[220:223], v[168:171], v[44:47]
ds_read_b64_tr_b16 v[114:115], v54 offset:16896
v_mfma_f32_16x16x32_bf16 v[32:35], v[224:227], v[164:167], v[32:35]
ds_read_b64_tr_b16 v[116:117], v55 offset:16384
v_mfma_f32_16x16x32_bf16 v[48:51], v[224:227], v[168:171], v[48:51]
ds_read_b64_tr_b16 v[118:119], v55 offset:16896
s_waitcnt vmcnt(10) lgkmcnt(8)
v_mfma_f32_16x16x32_bf16 v[20:23], v[228:231], v[172:175], v[20:23]
ds_read_b64_tr_b16 v[212:213], v52 offset:20480
ds_read_b64_tr_b16 v[214:215], v52 offset:20992
v_mfma_f32_16x16x32_bf16 v[36:39], v[228:231], v[176:179], v[36:39]
buffer_load_dwordx4 v[156:159], v12, s[32:35], s57 offen offset:1024 sc1
v_mfma_f32_16x16x32_bf16 v[24:27], v[232:235], v[172:175], v[24:27]
ds_read_b64_tr_b16 v[216:217], v53 offset:20480
v_mfma_f32_16x16x32_bf16 v[40:43], v[232:235], v[176:179], v[40:43]
ds_read_b64_tr_b16 v[218:219], v53 offset:20992
v_mfma_f32_16x16x32_bf16 v[28:31], v[236:239], v[172:175], v[28:31]
ds_read_b64_tr_b16 v[220:221], v54 offset:20480
buffer_load_dwordx4 v[160:163], v13, s[32:35], s57 offen offset:1024 sc1
s_add_u32 s57, s57, 2048
s_and_b32 s57, s57, 0x7fff
v_mfma_f32_16x16x32_bf16 v[44:47], v[236:239], v[176:179], v[44:47]
ds_read_b64_tr_b16 v[222:223], v54 offset:20992
v_mfma_f32_16x16x32_bf16 v[32:35], v[240:243], v[172:175], v[32:35]
ds_read_b64_tr_b16 v[224:225], v55 offset:20480
v_mfma_f32_16x16x32_bf16 v[48:51], v[240:243], v[176:179], v[48:51]
ds_read_b64_tr_b16 v[226:227], v55 offset:20992
s_waitcnt vmcnt(10) lgkmcnt(8)
v_mfma_f32_16x16x32_bf16 v[20:23], v[104:107], v[180:183], v[20:23]
ds_read_b64_tr_b16 v[228:229], v52 offset:24576
ds_read_b64_tr_b16 v[230:231], v52 offset:25088
v_mfma_f32_16x16x32_bf16 v[36:39], v[104:107], v[184:187], v[36:39]
buffer_load_dwordx4 v[164:167], v12, s[32:35], s57 offen sc1
v_mfma_f32_16x16x32_bf16 v[24:27], v[108:111], v[180:183], v[24:27]
ds_read_b64_tr_b16 v[232:233], v53 offset:24576
v_mfma_f32_16x16x32_bf16 v[40:43], v[108:111], v[184:187], v[40:43]
ds_read_b64_tr_b16 v[234:235], v53 offset:25088
v_mfma_f32_16x16x32_bf16 v[28:31], v[112:115], v[180:183], v[28:31]
ds_read_b64_tr_b16 v[236:237], v54 offset:24576
buffer_load_dwordx4 v[168:171], v13, s[32:35], s57 offen sc1
v_mfma_f32_16x16x32_bf16 v[44:47], v[112:115], v[184:187], v[44:47]
ds_read_b64_tr_b16 v[238:239], v54 offset:25088
v_mfma_f32_16x16x32_bf16 v[32:35], v[116:119], v[180:183], v[32:35]
ds_read_b64_tr_b16 v[240:241], v55 offset:24576
v_mfma_f32_16x16x32_bf16 v[48:51], v[116:119], v[184:187], v[48:51]
ds_read_b64_tr_b16 v[242:243], v55 offset:25088
s_waitcnt vmcnt(10) lgkmcnt(8)
v_mfma_f32_16x16x32_bf16 v[20:23], v[212:215], v[188:191], v[20:23]
ds_read_b64_tr_b16 v[104:105], v52 offset:28672
ds_read_b64_tr_b16 v[106:107], v52 offset:29184
v_mfma_f32_16x16x32_bf16 v[36:39], v[212:215], v[192:195], v[36:39]
buffer_load_dwordx4 v[172:175], v12, s[32:35], s57 offen offset:1024 sc1
v_mfma_f32_16x16x32_bf16 v[24:27], v[216:219], v[188:191], v[24:27]
ds_read_b64_tr_b16 v[108:109], v53 offset:28672
v_mfma_f32_16x16x32_bf16 v[40:43], v[216:219], v[192:195], v[40:43]
ds_read_b64_tr_b16 v[110:111], v53 offset:29184
v_mfma_f32_16x16x32_bf16 v[28:31], v[220:223], v[188:191], v[28:31]
ds_read_b64_tr_b16 v[112:113], v54 offset:28672
buffer_load_dwordx4 v[176:179], v13, s[32:35], s57 offen offset:1024 sc1
s_add_u32 s57, s57, 2048
s_and_b32 s57, s57, 0x7fff
v_mfma_f32_16x16x32_bf16 v[44:47], v[220:223], v[192:195], v[44:47]
ds_read_b64_tr_b16 v[114:115], v54 offset:29184
v_mfma_f32_16x16x32_bf16 v[32:35], v[224:227], v[188:191], v[32:35]
ds_read_b64_tr_b16 v[116:117], v55 offset:28672
v_mfma_f32_16x16x32_bf16 v[48:51], v[224:227], v[192:195], v[48:51]
ds_read_b64_tr_b16 v[118:119], v55 offset:29184
s_waitcnt vmcnt(10) lgkmcnt(8)
v_mfma_f32_16x16x32_bf16 v[20:23], v[228:231], v[196:199], v[20:23]
ds_read_b64_tr_b16 v[212:213], v52 offset:32768
ds_read_b64_tr_b16 v[214:215], v52 offset:33280
v_mfma_f32_16x16x32_bf16 v[36:39], v[228:231], v[200:203], v[36:39]
buffer_load_dwordx4 v[180:183], v12, s[32:35], s57 offen sc1
v_mfma_f32_16x16x32_bf16 v[24:27], v[232:235], v[196:199], v[24:27]
ds_read_b64_tr_b16 v[216:217], v53 offset:32768
v_mfma_f32_16x16x32_bf16 v[40:43], v[232:235], v[200:203], v[40:43]
ds_read_b64_tr_b16 v[218:219], v53 offset:33280
v_mfma_f32_16x16x32_bf16 v[28:31], v[236:239], v[196:199], v[28:31]
ds_read_b64_tr_b16 v[220:221], v54 offset:32768
buffer_load_dwordx4 v[184:187], v13, s[32:35], s57 offen sc1
v_mfma_f32_16x16x32_bf16 v[44:47], v[236:239], v[200:203], v[44:47]
ds_read_b64_tr_b16 v[222:223], v54 offset:33280
v_mfma_f32_16x16x32_bf16 v[32:35], v[240:243], v[196:199], v[32:35]
ds_read_b64_tr_b16 v[224:225], v55 offset:32768
v_mfma_f32_16x16x32_bf16 v[48:51], v[240:243], v[200:203], v[48:51]
ds_read_b64_tr_b16 v[226:227], v55 offset:33280
s_waitcnt vmcnt(10) lgkmcnt(8)
v_mfma_f32_16x16x32_bf16 v[20:23], v[104:107], v[204:207], v[20:23]
ds_read_b64_tr_b16 v[228:229], v52 offset:36864
ds_read_b64_tr_b16 v[230:231], v52 offset:37376
v_mfma_f32_16x16x32_bf16 v[36:39], v[104:107], v[208:211], v[36:39]
buffer_load_dwordx4 v[188:191], v12, s[32:35], s57 offen offset:1024 sc1
v_mfma_f32_16x16x32_bf16 v[24:27], v[108:111], v[204:207], v[24:27]
ds_read_b64_tr_b16 v[232:233], v53 offset:36864
v_mfma_f32_16x16x32_bf16 v[40:43], v[108:111], v[208:211], v[40:43]
ds_read_b64_tr_b16 v[234:235], v53 offset:37376
v_mfma_f32_16x16x32_bf16 v[28:31], v[112:115], v[204:207], v[28:31]
ds_read_b64_tr_b16 v[236:237], v54 offset:36864
buffer_load_dwordx4 v[192:195], v13, s[32:35], s57 offen offset:1024 sc1
s_add_u32 s57, s57, 2048
s_and_b32 s57, s57, 0x7fff
v_mfma_f32_16x16x32_bf16 v[44:47], v[112:115], v[208:211], v[44:47]
ds_read_b64_tr_b16 v[238:239], v54 offset:37376
v_mfma_f32_16x16x32_bf16 v[32:35], v[116:119], v[204:207], v[32:35]
ds_read_b64_tr_b16 v[240:241], v55 offset:36864
v_mfma_f32_16x16x32_bf16 v[48:51], v[116:119], v[208:211], v[48:51]
ds_read_b64_tr_b16 v[242:243], v55 offset:37376
s_waitcnt vmcnt(10) lgkmcnt(8)
v_mfma_f32_16x16x32_bf16 v[20:23], v[212:215], v[148:151], v[20:23]
ds_read_b64_tr_b16 v[104:105], v52 offset:40960
ds_read_b64_tr_b16 v[106:107], v52 offset:41472
v_mfma_f32_16x16x32_bf16 v[36:39], v[212:215], v[152:155], v[36:39]
buffer_load_dwordx4 v[196:199], v12, s[32:35], s57 offen sc1
v_mfma_f32_16x16x32_bf16 v[24:27], v[216:219], v[148:151], v[24:27]
ds_read_b64_tr_b16 v[108:109], v53 offset:40960
v_mfma_f32_16x16x32_bf16 v[40:43], v[216:219], v[152:155], v[40:43]
ds_read_b64_tr_b16 v[110:111], v53 offset:41472
v_mfma_f32_16x16x32_bf16 v[28:31], v[220:223], v[148:151], v[28:31]
ds_read_b64_tr_b16 v[112:113], v54 offset:40960
buffer_load_dwordx4 v[200:203], v13, s[32:35], s57 offen sc1
v_mfma_f32_16x16x32_bf16 v[44:47], v[220:223], v[152:155], v[44:47]
ds_read_b64_tr_b16 v[114:115], v54 offset:41472
v_mfma_f32_16x16x32_bf16 v[32:35], v[224:227], v[148:151], v[32:35]
ds_read_b64_tr_b16 v[116:117], v55 offset:40960
v_mfma_f32_16x16x32_bf16 v[48:51], v[224:227], v[152:155], v[48:51]
ds_read_b64_tr_b16 v[118:119], v55 offset:41472
s_waitcnt vmcnt(10) lgkmcnt(8)
v_mfma_f32_16x16x32_bf16 v[20:23], v[228:231], v[156:159], v[20:23]
ds_read_b64_tr_b16 v[212:213], v52 offset:45056
ds_read_b64_tr_b16 v[214:215], v52 offset:45568
v_mfma_f32_16x16x32_bf16 v[36:39], v[228:231], v[160:163], v[36:39]
buffer_load_dwordx4 v[204:207], v12, s[32:35], s57 offen offset:1024 sc1
v_mfma_f32_16x16x32_bf16 v[24:27], v[232:235], v[156:159], v[24:27]
ds_read_b64_tr_b16 v[216:217], v53 offset:45056
v_mfma_f32_16x16x32_bf16 v[40:43], v[232:235], v[160:163], v[40:43]
ds_read_b64_tr_b16 v[218:219], v53 offset:45568
v_mfma_f32_16x16x32_bf16 v[28:31], v[236:239], v[156:159], v[28:31]
ds_read_b64_tr_b16 v[220:221], v54 offset:45056
buffer_load_dwordx4 v[208:211], v13, s[32:35], s57 offen offset:1024 sc1
s_add_u32 s57, s57, 2048
s_and_b32 s57, s57, 0x7fff
v_mfma_f32_16x16x32_bf16 v[44:47], v[236:239], v[160:163], v[44:47]
ds_read_b64_tr_b16 v[222:223], v54 offset:45568
v_mfma_f32_16x16x32_bf16 v[32:35], v[240:243], v[156:159], v[32:35]
ds_read_b64_tr_b16 v[224:225], v55 offset:45056
v_mfma_f32_16x16x32_bf16 v[48:51], v[240:243], v[160:163], v[48:51]
ds_read_b64_tr_b16 v[226:227], v55 offset:45568
s_waitcnt vmcnt(10) lgkmcnt(8)
v_mfma_f32_16x16x32_bf16 v[20:23], v[104:107], v[164:167], v[20:23]
ds_read_b64_tr_b16 v[228:229], v52 offset:49152
v_mfma_f32_16x16x32_bf16 v[36:39], v[104:107], v[168:171], v[36:39]
ds_read_b64_tr_b16 v[230:231], v52 offset:49664
v_mfma_f32_16x16x32_bf16 v[24:27], v[108:111], v[164:167], v[24:27]
ds_read_b64_tr_b16 v[232:233], v53 offset:49152
v_mfma_f32_16x16x32_bf16 v[40:43], v[108:111], v[168:171], v[40:43]
ds_read_b64_tr_b16 v[234:235], v53 offset:49664
v_mfma_f32_16x16x32_bf16 v[28:31], v[112:115], v[164:167], v[28:31]
ds_read_b64_tr_b16 v[236:237], v54 offset:49152
v_mfma_f32_16x16x32_bf16 v[44:47], v[112:115], v[168:171], v[44:47]
ds_read_b64_tr_b16 v[238:239], v54 offset:49664
v_mfma_f32_16x16x32_bf16 v[32:35], v[116:119], v[164:167], v[32:35]
ds_read_b64_tr_b16 v[240:241], v55 offset:49152
v_mfma_f32_16x16x32_bf16 v[48:51], v[116:119], v[168:171], v[48:51]
ds_read_b64_tr_b16 v[242:243], v55 offset:49664
s_waitcnt vmcnt(8) lgkmcnt(8)
v_mfma_f32_16x16x32_bf16 v[20:23], v[212:215], v[172:175], v[20:23]
ds_read_b64_tr_b16 v[104:105], v52 offset:53248
v_mfma_f32_16x16x32_bf16 v[36:39], v[212:215], v[176:179], v[36:39]
ds_read_b64_tr_b16 v[106:107], v52 offset:53760
v_mfma_f32_16x16x32_bf16 v[24:27], v[216:219], v[172:175], v[24:27]
ds_read_b64_tr_b16 v[108:109], v53 offset:53248
v_mfma_f32_16x16x32_bf16 v[40:43], v[216:219], v[176:179], v[40:43]
ds_read_b64_tr_b16 v[110:111], v53 offset:53760
v_mfma_f32_16x16x32_bf16 v[28:31], v[220:223], v[172:175], v[28:31]
ds_read_b64_tr_b16 v[112:113], v54 offset:53248
v_mfma_f32_16x16x32_bf16 v[44:47], v[220:223], v[176:179], v[44:47]
ds_read_b64_tr_b16 v[114:115], v54 offset:53760
v_mfma_f32_16x16x32_bf16 v[32:35], v[224:227], v[172:175], v[32:35]
ds_read_b64_tr_b16 v[116:117], v55 offset:53248
v_mfma_f32_16x16x32_bf16 v[48:51], v[224:227], v[176:179], v[48:51]
ds_read_b64_tr_b16 v[118:119], v55 offset:53760
s_waitcnt vmcnt(6) lgkmcnt(8)
v_mfma_f32_16x16x32_bf16 v[20:23], v[228:231], v[180:183], v[20:23]
ds_read_b64_tr_b16 v[212:213], v52 offset:57344
v_mfma_f32_16x16x32_bf16 v[36:39], v[228:231], v[184:187], v[36:39]
ds_read_b64_tr_b16 v[214:215], v52 offset:57856
v_mfma_f32_16x16x32_bf16 v[24:27], v[232:235], v[180:183], v[24:27]
ds_read_b64_tr_b16 v[216:217], v53 offset:57344
v_mfma_f32_16x16x32_bf16 v[40:43], v[232:235], v[184:187], v[40:43]
ds_read_b64_tr_b16 v[218:219], v53 offset:57856
v_mfma_f32_16x16x32_bf16 v[28:31], v[236:239], v[180:183], v[28:31]
ds_read_b64_tr_b16 v[220:221], v54 offset:57344
v_mfma_f32_16x16x32_bf16 v[44:47], v[236:239], v[184:187], v[44:47]
ds_read_b64_tr_b16 v[222:223], v54 offset:57856
v_mfma_f32_16x16x32_bf16 v[32:35], v[240:243], v[180:183], v[32:35]
ds_read_b64_tr_b16 v[224:225], v55 offset:57344
v_mfma_f32_16x16x32_bf16 v[48:51], v[240:243], v[184:187], v[48:51]
ds_read_b64_tr_b16 v[226:227], v55 offset:57856
s_waitcnt vmcnt(4) lgkmcnt(8)
v_mfma_f32_16x16x32_bf16 v[20:23], v[104:107], v[188:191], v[20:23]
ds_read_b64_tr_b16 v[228:229], v52 offset:61440
v_mfma_f32_16x16x32_bf16 v[36:39], v[104:107], v[192:195], v[36:39]
ds_read_b64_tr_b16 v[230:231], v52 offset:61952
v_mfma_f32_16x16x32_bf16 v[24:27], v[108:111], v[188:191], v[24:27]
ds_read_b64_tr_b16 v[232:233], v53 offset:61440
v_mfma_f32_16x16x32_bf16 v[40:43], v[108:111], v[192:195], v[40:43]
ds_read_b64_tr_b16 v[234:235], v53 offset:61952
v_mfma_f32_16x16x32_bf16 v[28:31], v[112:115], v[188:191], v[28:31]
ds_read_b64_tr_b16 v[236:237], v54 offset:61440
v_mfma_f32_16x16x32_bf16 v[44:47], v[112:115], v[192:195], v[44:47]
ds_read_b64_tr_b16 v[238:239], v54 offset:61952
v_mfma_f32_16x16x32_bf16 v[32:35], v[116:119], v[188:191], v[32:35]
ds_read_b64_tr_b16 v[240:241], v55 offset:61440
v_mfma_f32_16x16x32_bf16 v[48:51], v[116:119], v[192:195], v[48:51]
ds_read_b64_tr_b16 v[242:243], v55 offset:61952
s_waitcnt vmcnt(2) lgkmcnt(8)
v_mfma_f32_16x16x32_bf16 v[20:23], v[212:215], v[196:199], v[20:23]
v_mfma_f32_16x16x32_bf16 v[36:39], v[212:215], v[200:203], v[36:39]
v_mfma_f32_16x16x32_bf16 v[24:27], v[216:219], v[196:199], v[24:27]
v_mfma_f32_16x16x32_bf16 v[40:43], v[216:219], v[200:203], v[40:43]
v_mfma_f32_16x16x32_bf16 v[28:31], v[220:223], v[196:199], v[28:31]
v_mfma_f32_16x16x32_bf16 v[44:47], v[220:223], v[200:203], v[44:47]
v_mfma_f32_16x16x32_bf16 v[32:35], v[224:227], v[196:199], v[32:35]
v_mfma_f32_16x16x32_bf16 v[48:51], v[224:227], v[200:203], v[48:51]
s_waitcnt vmcnt(0) lgkmcnt(0)
v_mfma_f32_16x16x32_bf16 v[20:23], v[228:231], v[204:207], v[20:23]
v_mfma_f32_16x16x32_bf16 v[24:27], v[232:235], v[204:207], v[24:27]
v_mfma_f32_16x16x32_bf16 v[28:31], v[236:239], v[204:207], v[28:31]
v_mfma_f32_16x16x32_bf16 v[32:35], v[240:243], v[204:207], v[32:35]
v_mfma_f32_16x16x32_bf16 v[36:39], v[228:231], v[208:211], v[36:39]
v_mfma_f32_16x16x32_bf16 v[40:43], v[232:235], v[208:211], v[40:43]
v_mfma_f32_16x16x32_bf16 v[44:47], v[236:239], v[208:211], v[44:47]
v_mfma_f32_16x16x32_bf16 v[48:51], v[240:243], v[208:211], v[48:51]
s_cmp_eq_u32 s46, 0
s_cbranch_scc1 slow_74
s_nop 0
v_cvt_pk_bf16_f32 v20, v20, v21
v_cvt_pk_bf16_f32 v21, v22, v23
v_cvt_pk_bf16_f32 v22, v24, v25
v_cvt_pk_bf16_f32 v23, v26, v27
buffer_store_dwordx4 v[20:23], v18, s[32:35], s85 offen offset:0
v_cvt_pk_bf16_f32 v28, v28, v29
v_cvt_pk_bf16_f32 v29, v30, v31
v_cvt_pk_bf16_f32 v30, v32, v33
v_cvt_pk_bf16_f32 v31, v34, v35
buffer_store_dwordx4 v[28:31], v18, s[32:35], s85 offen offset:1024
v_cvt_pk_bf16_f32 v36, v36, v37
v_cvt_pk_bf16_f32 v37, v38, v39
v_cvt_pk_bf16_f32 v38, v40, v41
v_cvt_pk_bf16_f32 v39, v42, v43
buffer_store_dwordx4 v[36:39], v18, s[32:35], s86 offen offset:0
v_cvt_pk_bf16_f32 v44, v44, v45
v_cvt_pk_bf16_f32 v45, v46, v47
v_cvt_pk_bf16_f32 v46, v48, v49
v_cvt_pk_bf16_f32 v47, v50, v51
buffer_store_dwordx4 v[44:47], v18, s[32:35], s86 offen offset:1024
s_barrier
v_dot2c_f32_bf16 v6, v20, v10
v_dot2c_f32_bf16 v8, v20, v20
v_dot2c_f32_bf16 v7, v36, v10
v_dot2c_f32_bf16 v9, v36, v36
v_dot2c_f32_bf16 v6, v21, v10
v_dot2c_f32_bf16 v8, v21, v21
v_dot2c_f32_bf16 v7, v37, v10
v_dot2c_f32_bf16 v9, v37, v37
v_dot2c_f32_bf16 v6, v22, v10
v_dot2c_f32_bf16 v8, v22, v22
v_dot2c_f32_bf16 v7, v38, v10
v_dot2c_f32_bf16 v9, v38, v38
v_dot2c_f32_bf16 v6, v23, v10
v_dot2c_f32_bf16 v8, v23, v23
v_dot2c_f32_bf16 v7, v39, v10
v_dot2c_f32_bf16 v9, v39, v39
v_dot2c_f32_bf16 v6, v28, v10
v_dot2c_f32_bf16 v8, v28, v28
v_dot2c_f32_bf16 v7, v44, v10
v_dot2c_f32_bf16 v9, v44, v44
v_dot2c_f32_bf16 v6, v29, v10
v_dot2c_f32_bf16 v8, v29, v29
v_dot2c_f32_bf16 v7, v45, v10
v_dot2c_f32_bf16 v9, v45, v45
v_dot2c_f32_bf16 v6, v30, v10
v_dot2c_f32_bf16 v8, v30, v30
v_dot2c_f32_bf16 v7, v46, v10
v_dot2c_f32_bf16 v9, v46, v46
v_dot2c_f32_bf16 v6, v31, v10
v_dot2c_f32_bf16 v8, v31, v31
v_dot2c_f32_bf16 v7, v47, v10
v_dot2c_f32_bf16 v9, v47, v47
s_nop 1
s_nop 1
v_permlane32_swap_b32 v6, v7
v_permlane32_swap_b32 v8, v9
s_nop 0
v_add_f32 v6, v6, v7
v_add_f32 v8, v8, v9
s_nop 1
v_permlane16_swap_b32 v6, v8
s_nop 0
v_add_f32 v6, v6, v8
s_waitcnt vmcnt(0)
s_mov_b64 exec, 1
buffer_store_dword v5, v4, s[32:35], s88 offen
s_mov_b64 exec, -1
buffer_store_dword v6, v1, s[32:35], s87 offen
back_75:
v_mov_b32 v10, v18
v_add_u32 v11, 1024, v18
s_lshl_b32 s48, s43, 1
v_lshrrev_b32 v4, 2, v2
v_and_b32 v5, 3, v0
v_lshl_add_u32 v6, v3, 3, v4
v_lshlrev_b32 v6, 7, v6
v_lshl_add_u32 v6, v5, 3, v6
v_lshrrev_b32 v7, 1, v4
v_and_b32 v8, 1, v3
v_lshl_add_u32 v7, v8, 1, v7
v_xor_b32 v7, s48, v7
v_lshl_add_u32 v12, v7, 5, v6
v_add_u32 v12, 18432, v12
v_xor_b32 v13, 32, v12
s_lshl_b32 s48, s44, 13
v_add_u32 v10, s48, v10
v_add_u32 v11, s48, v11
v_mov_b32 v14, v10
v_mov_b32 v15, v11
v_add_u32 v16, 120832, v12
v_add_u32 v17, 120832, v13
v_mov_b32 v148, 0
v_mov_b32 v149, 0
v_mov_b32 v150, 0
v_mov_b32 v151, 0
v_mov_b32 v152, 0
v_mov_b32 v153, 0
v_mov_b32 v154, 0
v_mov_b32 v155, 0
v_mov_b32 v156, 0
v_mov_b32 v157, 0
v_mov_b32 v158, 0
v_mov_b32 v159, 0
v_mov_b32 v160, 0
v_mov_b32 v161, 0
v_mov_b32 v162, 0
v_mov_b32 v163, 0
v_mov_b32 v164, 0
v_mov_b32 v165, 0
v_mov_b32 v166, 0
v_mov_b32 v167, 0
v_mov_b32 v168, 0
v_mov_b32 v169, 0
v_mov_b32 v170, 0
v_mov_b32 v171, 0
v_mov_b32 v172, 0
v_mov_b32 v173, 0
v_mov_b32 v174, 0
v_mov_b32 v175, 0
v_mov_b32 v176, 0
v_mov_b32 v177, 0
v_mov_b32 v178, 0
v_mov_b32 v179, 0
v_mov_b32 v180, 0
v_mov_b32 v181, 0
v_mov_b32 v182, 0
v_mov_b32 v183, 0
v_mov_b32 v184, 0
v_mov_b32 v185, 0
v_mov_b32 v186, 0
v_mov_b32 v187, 0
v_mov_b32 v188, 0
v_mov_b32 v189, 0
v_mov_b32 v190, 0
v_mov_b32 v191, 0
v_mov_b32 v192, 0
v_mov_b32 v193, 0
v_mov_b32 v194, 0
v_mov_b32 v195, 0
v_mov_b32 v196, 0
v_mov_b32 v197, 0
v_mov_b32 v198, 0
v_mov_b32 v199, 0
v_mov_b32 v200, 0
v_mov_b32 v201, 0
v_mov_b32 v202, 0
v_mov_b32 v203, 0
v_mov_b32 v204, 0
v_mov_b32 v205, 0
v_mov_b32 v206, 0
v_mov_b32 v207, 0
v_mov_b32 v208, 0
v_mov_b32 v209, 0
v_mov_b32 v210, 0
v_mov_b32 v211, 0
v_mov_b32 v212, 0
v_mov_b32 v213, 0
v_mov_b32 v214, 0
v_mov_b32 v215, 0
v_mov_b32 v216, 0
v_mov_b32 v217, 0
v_mov_b32 v218, 0
v_mov_b32 v219, 0
v_mov_b32 v220, 0
v_mov_b32 v221, 0
v_mov_b32 v222, 0
v_mov_b32 v223, 0
v_mov_b32 v224, 0
v_mov_b32 v225, 0
v_mov_b32 v226, 0
v_mov_b32 v227, 0
v_mov_b32 v228, 0
v_mov_b32 v229, 0
v_mov_b32 v230, 0
v_mov_b32 v231, 0
v_mov_b32 v232, 0
v_mov_b32 v233, 0
v_mov_b32 v234, 0
v_mov_b32 v235, 0
v_mov_b32 v236, 0
v_mov_b32 v237, 0
v_mov_b32 v238, 0
v_mov_b32 v239, 0
v_mov_b32 v240, 0
v_mov_b32 v241, 0
v_mov_b32 v242, 0
v_mov_b32 v243, 0
v_mov_b32 v56, 0x3f803f80
v_mov_b32 v57, 0x3f803f80
v_mov_b32 v58, 0x3f803f80
v_mov_b32 v59, 0x3f803f80
v_lshrrev_b32 v6, 2, v2
v_cmp_eq_u32 vcc, v6, v3
v_and_b32 v7, 1, v0
v_lshlrev_b32 v7, 4, v7
v_mov_b32 v8, 0x3f80
v_lshlrev_b32 v7, v7, v8
v_cndmask_b32 v7, 0, v7, vcc
v_and_b32 v6, 2, v0
v_cmp_eq_u32 vcc, 0, v6
v_mov_b32 v48, 0
v_mov_b32 v49, 0
v_mov_b32 v52, 0
v_mov_b32 v53, 0
v_cndmask_b32 v50, 0, v7, vcc
v_cndmask_b32 v51, v7, 0, vcc
v_lshrrev_b32 v4, 2, v2
v_lshl_add_u32 v4, v3, 2, v4
v_lshlrev_b32 v4, 6, v4
v_and_b32 v5, 3, v0
v_lshl_add_u32 v4, v5, 3, v4
s_lshl_b32 s48, s43, 11
s_add_u32 s48, s48, 135168
v_add_u32 v54, s48, v4
s_lshl_b32 s48, s43, 7
s_add_u32 s48, s48, 134144
v_lshl_add_u32 v7, v3, 4, s48
v_lshl_add_u32 v55, v2, 2, s48
s_lshl_b32 s49, s44, 6
v_add_u32 v8, s49, v2
v_lshlrev_b32 v8, 3, v8
v_add_u32 v8, 131072, v8
v_lshl_add_u32 v9, v3, 2, s49
v_lshlrev_b32 v9, 2, v9
v_add_u32 v9, 132224, v9
s_mov_b32 s64, 0
s_mov_b32 s65, 0
s_waitcnt vmcnt(0)
s_cmp_eq_u32 s46, 0
s_cbranch_scc1 slow_78
s_lshl_b32 s62, s42, 2
v_mov_b32 v4, s62
v_mov_b32 v5, 3
s_mov_b64 exec, 1
buffer_store_dword v5, v4, s[32:35], s89 offen
s_mov_b64 exec, -1
back_79:
s_barrier
ds_read_b128 v[60:63], v14 offset:2048
ds_read_b128 v[64:67], v14 offset:4096
ds_read_b128 v[68:71], v14 offset:6144
ds_read_b128 v[72:75], v14 offset:8192
ds_read_b64_tr_b16 v[80:81], v16 offset:0
ds_read_b64_tr_b16 v[82:83], v16 offset:512
ds_read_b64_tr_b16 v[84:85], v17 offset:0
ds_read_b64_tr_b16 v[86:87], v17 offset:512
ds_read_b64_tr_b16 v[88:89], v16 offset:8192
ds_read_b64_tr_b16 v[90:91], v16 offset:8704
ds_read_b64_tr_b16 v[92:93], v17 offset:8192
ds_read_b64_tr_b16 v[94:95], v17 offset:8704
ds_read_b64_tr_b16 v[96:97], v16 offset:16384
ds_read_b64_tr_b16 v[98:99], v16 offset:16896
ds_read_b64_tr_b16 v[100:101], v17 offset:16384
ds_read_b64_tr_b16 v[102:103], v17 offset:16896
c3_loop0:
s_waitcnt lgkmcnt(0)
v_mfma_f32_16x16x32_bf16 v[204:207], v[88:91], v[72:75], v[204:207]
ds_read_b128 v[104:107], v15 offset:2048
v_mfma_f32_16x16x32_bf16 v[196:199], v[88:91], v[68:71], v[196:199]
ds_read_b128 v[108:111], v15 offset:4096
v_mfma_f32_16x16x32_bf16 v[188:191], v[88:91], v[64:67], v[188:191]
ds_read_b128 v[112:115], v15 offset:6144
v_mfma_f32_16x16x32_bf16 v[180:183], v[88:91], v[60:63], v[180:183]
ds_read_b128 v[116:119], v15 offset:8192
v_mfma_f32_16x16x32_bf16 v[184:187], v[92:95], v[60:63], v[184:187]
ds_read_b64_tr_b16 v[124:125], v16 offset:4096
v_mfma_f32_16x16x32_bf16 v[192:195], v[92:95], v[64:67], v[192:195]
ds_read_b64_tr_b16 v[126:127], v16 offset:4608
v_mfma_f32_16x16x32_bf16 v[200:203], v[92:95], v[68:71], v[200:203]
ds_read_b64_tr_b16 v[128:129], v17 offset:4096
v_mfma_f32_16x16x32_bf16 v[208:211], v[92:95], v[72:75], v[208:211]
ds_read_b64_tr_b16 v[130:131], v17 offset:4608
v_mfma_f32_16x16x32_bf16 v[236:239], v[72:75], v[96:99], v[236:239]
ds_read_b64_tr_b16 v[132:133], v16 offset:12288
v_mfma_f32_16x16x32_bf16 v[228:231], v[68:71], v[96:99], v[228:231]
ds_read_b64_tr_b16 v[134:135], v16 offset:12800
v_mfma_f32_16x16x32_bf16 v[220:223], v[64:67], v[96:99], v[220:223]
ds_read_b64_tr_b16 v[136:137], v17 offset:12288
v_mfma_f32_16x16x32_bf16 v[212:215], v[60:63], v[96:99], v[212:215]
ds_read_b64_tr_b16 v[138:139], v17 offset:12800
v_mfma_f32_16x16x32_bf16 v[216:219], v[60:63], v[100:103], v[216:219]
ds_read_b64_tr_b16 v[140:141], v16 offset:20480
v_mfma_f32_16x16x32_bf16 v[224:227], v[64:67], v[100:103], v[224:227]
ds_read_b64_tr_b16 v[142:143], v16 offset:20992
v_mfma_f32_16x16x32_bf16 v[232:235], v[68:71], v[100:103], v[232:235]
ds_read_b64_tr_b16 v[144:145], v17 offset:20480
v_mfma_f32_16x16x32_bf16 v[240:243], v[72:75], v[100:103], v[240:243]
ds_read_b64_tr_b16 v[146:147], v17 offset:20992
v_mfma_f32_16x16x32_bf16 v[172:175], v[80:83], v[72:75], v[172:175]
s_add_u32 s65, s65, 43008
v_mfma_f32_16x16x32_bf16 v[164:167], v[80:83], v[68:71], v[164:167]
s_cmp_eq_u32 s65, 129024
s_cselect_b32 s65, 0, s65
v_mfma_f32_16x16x32_bf16 v[156:159], v[80:83], v[64:67], v[156:159]
v_add_u32 v14, s65, v10
v_add_u32 v15, s65, v11
v_mfma_f32_16x16x32_bf16 v[148:151], v[80:83], v[60:63], v[148:151]
v_add_u32 v16, s65, v12
v_add_u32 v17, s65, v13
v_mfma_f32_16x16x32_bf16 v[152:155], v[84:87], v[60:63], v[152:155]
s_add_u32 s64, s64, 1
s_cmp_eq_u32 s64, 16
v_mfma_f32_16x16x32_bf16 v[160:163], v[84:87], v[64:67], v[160:163]
v_mfma_f32_16x16x32_bf16 v[168:171], v[84:87], v[68:71], v[168:171]
v_mfma_f32_16x16x32_bf16 v[176:179], v[84:87], v[72:75], v[176:179]
s_waitcnt lgkmcnt(0)
s_barrier
s_cbranch_scc1 c3_last0
v_mfma_f32_16x16x32_bf16 v[204:207], v[132:135], v[116:119], v[204:207]
ds_read_b128 v[60:63], v14 offset:2048
v_mfma_f32_16x16x32_bf16 v[196:199], v[132:135], v[112:115], v[196:199]
ds_read_b128 v[64:67], v14 offset:4096
v_mfma_f32_16x16x32_bf16 v[188:191], v[132:135], v[108:111], v[188:191]
ds_read_b128 v[68:71], v14 offset:6144
v_mfma_f32_16x16x32_bf16 v[180:183], v[132:135], v[104:107], v[180:183]
ds_read_b128 v[72:75], v14 offset:8192
v_mfma_f32_16x16x32_bf16 v[184:187], v[136:139], v[104:107], v[184:187]
ds_read_b64_tr_b16 v[80:81], v16 offset:0
v_mfma_f32_16x16x32_bf16 v[192:195], v[136:139], v[108:111], v[192:195]
ds_read_b64_tr_b16 v[82:83], v16 offset:512
v_mfma_f32_16x16x32_bf16 v[200:203], v[136:139], v[112:115], v[200:203]
ds_read_b64_tr_b16 v[84:85], v17 offset:0
v_mfma_f32_16x16x32_bf16 v[208:211], v[136:139], v[116:119], v[208:211]
ds_read_b64_tr_b16 v[86:87], v17 offset:512
v_mfma_f32_16x16x32_bf16 v[236:239], v[116:119], v[140:143], v[236:239]
ds_read_b64_tr_b16 v[88:89], v16 offset:8192
v_mfma_f32_16x16x32_bf16 v[228:231], v[112:115], v[140:143], v[228:231]
ds_read_b64_tr_b16 v[90:91], v16 offset:8704
v_mfma_f32_16x16x32_bf16 v[220:223], v[108:111], v[140:143], v[220:223]
ds_read_b64_tr_b16 v[92:93], v17 offset:8192
v_mfma_f32_16x16x32_bf16 v[212:215], v[104:107], v[140:143], v[212:215]
ds_read_b64_tr_b16 v[94:95], v17 offset:8704
v_mfma_f32_16x16x32_bf16 v[216:219], v[104:107], v[144:147], v[216:219]
ds_read_b64_tr_b16 v[96:97], v16 offset:16384
v_mfma_f32_16x16x32_bf16 v[224:227], v[108:111], v[144:147], v[224:227]
ds_read_b64_tr_b16 v[98:99], v16 offset:16896
v_mfma_f32_16x16x32_bf16 v[232:235], v[112:115], v[144:147], v[232:235]
ds_read_b64_tr_b16 v[100:101], v17 offset:16384
v_mfma_f32_16x16x32_bf16 v[240:243], v[116:119], v[144:147], v[240:243]
ds_read_b64_tr_b16 v[102:103], v17 offset:16896
v_mfma_f32_16x16x32_bf16 v[172:175], v[124:127], v[116:119], v[172:175]
v_mfma_f32_16x16x32_bf16 v[164:167], v[124:127], v[112:115], v[164:167]
v_mfma_f32_16x16x32_bf16 v[156:159], v[124:127], v[108:111], v[156:159]
v_mfma_f32_16x16x32_bf16 v[148:151], v[124:127], v[104:107], v[148:151]
v_mfma_f32_16x16x32_bf16 v[152:155], v[128:131], v[104:107], v[152:155]
v_mfma_f32_16x16x32_bf16 v[160:163], v[128:131], v[108:111], v[160:163]
v_mfma_f32_16x16x32_bf16 v[168:171], v[128:131], v[112:115], v[168:171]
v_mfma_f32_16x16x32_bf16 v[176:179], v[128:131], v[116:119], v[176:179]
s_branch c3_loop0
c3_last0:
v_mfma_f32_16x16x32_bf16 v[204:207], v[132:135], v[116:119], v[204:207]
ds_read_b128 v[244:247], v7 offset:0
v_mfma_f32_16x16x32_bf16 v[196:199], v[132:135], v[112:115], v[196:199]
ds_read_b128 v[248:251], v7 offset:64
v_mfma_f32_16x16x32_bf16 v[188:191], v[132:135], v[108:111], v[188:191]
ds_read_b128 v[60:63], v7 offset:256
v_mfma_f32_16x16x32_bf16 v[180:183], v[132:135], v[104:107], v[180:183]
ds_read_b128 v[64:67], v7 offset:320
v_mfma_f32_16x16x32_bf16 v[184:187], v[136:139], v[104:107], v[184:187]
ds_read_b64 v[30:31], v8 offset:128
v_mfma_f32_16x16x32_bf16 v[192:195], v[136:139], v[108:111], v[192:195]
ds_read_b64 v[32:33], v8 offset:256
v_mfma_f32_16x16x32_bf16 v[200:203], v[136:139], v[112:115], v[200:203]
ds_read_b64 v[34:35], v8 offset:384
v_mfma_f32_16x16x32_bf16 v[208:211], v[136:139], v[116:119], v[208:211]
ds_read_b64 v[36:37], v8 offset:512
v_mfma_f32_16x16x32_bf16 v[236:239], v[116:119], v[140:143], v[236:239]
ds_read2_b32 v[68:69], v55 offset0:128 offset1:144
v_mfma_f32_16x16x32_bf16 v[228:231], v[112:115], v[140:143], v[228:231]
ds_read_b64_tr_b16 v[40:41], v54 offset:0
v_mfma_f32_16x16x32_bf16 v[220:223], v[108:111], v[140:143], v[220:223]
ds_read_b64_tr_b16 v[42:43], v54 offset:1024
v_mfma_f32_16x16x32_bf16 v[212:215], v[104:107], v[140:143], v[212:215]
ds_read_b64_tr_b16 v[44:45], v54 offset:32
v_mfma_f32_16x16x32_bf16 v[216:219], v[104:107], v[144:147], v[216:219]
ds_read_b64_tr_b16 v[46:47], v54 offset:1056
v_mfma_f32_16x16x32_bf16 v[224:227], v[108:111], v[144:147], v[224:227]
ds_read_b128 v[72:75], v9 offset:64
v_mfma_f32_16x16x32_bf16 v[232:235], v[112:115], v[144:147], v[232:235]
ds_read_b128 v[76:79], v9 offset:128
v_mfma_f32_16x16x32_bf16 v[240:243], v[116:119], v[144:147], v[240:243]
ds_read_b128 v[80:83], v9 offset:192
v_mfma_f32_16x16x32_bf16 v[172:175], v[124:127], v[116:119], v[172:175]
ds_read_b128 v[84:87], v9 offset:256
v_mfma_f32_16x16x32_bf16 v[164:167], v[124:127], v[112:115], v[164:167]
ds_read_b128 v[88:91], v9 offset:640
v_mfma_f32_16x16x32_bf16 v[156:159], v[124:127], v[108:111], v[156:159]
ds_read_b128 v[92:95], v9 offset:704
v_mfma_f32_16x16x32_bf16 v[148:151], v[124:127], v[104:107], v[148:151]
ds_read_b128 v[96:99], v9 offset:768
v_mfma_f32_16x16x32_bf16 v[152:155], v[128:131], v[104:107], v[152:155]
ds_read_b128 v[100:103], v9 offset:832
v_mfma_f32_16x16x32_bf16 v[160:163], v[128:131], v[108:111], v[160:163]
v_mfma_f32_16x16x32_bf16 v[168:171], v[128:131], v[112:115], v[168:171]
v_mfma_f32_16x16x32_bf16 v[176:179], v[128:131], v[116:119], v[176:179]
c3_epi:
s_waitcnt lgkmcnt(0)
s_mov_b32 s66, 0x3fb8aa3b
s_mul_i32 s48, s44, 0x80008000
v_mul_f32 v20, s66, v30
v_mul_f32 v21, s66, v32
v_mul_f32 v22, s66, v34
v_mul_f32 v23, s66, v36
v_xor_b32 v40, s48, v40
v_xor_b32 v41, s48, v41
v_xor_b32 v42, s48, v42
v_xor_b32 v43, s48, v43
v_xor_b32 v44, s48, v44
v_xor_b32 v45, s48, v45
v_xor_b32 v46, s48, v46
v_xor_b32 v47, s48, v47
.p2align 3
v_pk_fma_f32 v[180:181], v[60:61], v[30:31], v[180:181] op_sel:[0,1,0] op_sel_hi:[1,1,1]
v_pk_fma_f32 v[182:183], v[62:63], v[30:31], v[182:183] op_sel:[0,1,0] op_sel_hi:[1,1,1]
v_pk_fma_f32 v[184:185], v[64:65], v[30:31], v[184:185] op_sel:[0,1,0] op_sel_hi:[1,1,1]
v_pk_fma_f32 v[186:187], v[66:67], v[30:31], v[186:187] op_sel:[0,1,0] op_sel_hi:[1,1,1]
v_cvt_pk_bf16_f32 v180, v180, v181
v_cvt_pk_bf16_f32 v181, v182, v183
v_cvt_pk_bf16_f32 v182, v184, v185
v_cvt_pk_bf16_f32 v183, v186, v187
v_pk_fma_f32 v[188:189], v[60:61], v[32:33], v[188:189] op_sel:[0,1,0] op_sel_hi:[1,1,1]
v_pk_fma_f32 v[190:191], v[62:63], v[32:33], v[190:191] op_sel:[0,1,0] op_sel_hi:[1,1,1]
v_pk_fma_f32 v[192:193], v[64:65], v[32:33], v[192:193] op_sel:[0,1,0] op_sel_hi:[1,1,1]
v_pk_fma_f32 v[194:195], v[66:67], v[32:33], v[194:195] op_sel:[0,1,0] op_sel_hi:[1,1,1]
v_cvt_pk_bf16_f32 v188, v188, v189
v_cvt_pk_bf16_f32 v189, v190, v191
v_cvt_pk_bf16_f32 v190, v192, v193
v_cvt_pk_bf16_f32 v191, v194, v195
v_pk_fma_f32 v[196:197], v[60:61], v[34:35], v[196:197] op_sel:[0,1,0] op_sel_hi:[1,1,1]
v_pk_fma_f32 v[198:199], v[62:63], v[34:35], v[198:199] op_sel:[0,1,0] op_sel_hi:[1,1,1]
v_pk_fma_f32 v[200:201], v[64:65], v[34:35], v[200:201] op_sel:[0,1,0] op_sel_hi:[1,1,1]
v_pk_fma_f32 v[202:203], v[66:67], v[34:35], v[202:203] op_sel:[0,1,0] op_sel_hi:[1,1,1]
v_cvt_pk_bf16_f32 v196, v196, v197
v_cvt_pk_bf16_f32 v197, v198, v199
v_cvt_pk_bf16_f32 v198, v200, v201
v_cvt_pk_bf16_f32 v199, v202, v203
v_pk_fma_f32 v[204:205], v[60:61], v[36:37], v[204:205] op_sel:[0,1,0] op_sel_hi:[1,1,1]
v_pk_fma_f32 v[206:207], v[62:63], v[36:37], v[206:207] op_sel:[0,1,0] op_sel_hi:[1,1,1]
v_pk_fma_f32 v[208:209], v[64:65], v[36:37], v[208:209] op_sel:[0,1,0] op_sel_hi:[1,1,1]
v_pk_fma_f32 v[210:211], v[66:67], v[36:37], v[210:211] op_sel:[0,1,0] op_sel_hi:[1,1,1]
v_cvt_pk_bf16_f32 v204, v204, v205
v_cvt_pk_bf16_f32 v205, v206, v207
v_cvt_pk_bf16_f32 v206, v208, v209
v_cvt_pk_bf16_f32 v207, v210, v211
v_pk_fma_f32 v[212:213], v[88:89], v[68:69], v[212:213] op_sel:[0,0,0] op_sel_hi:[1,0,1]
v_pk_fma_f32 v[214:215], v[90:91], v[68:69], v[214:215] op_sel:[0,0,0] op_sel_hi:[1,0,1]
v_pk_mul_f32 v[212:213], v[212:213], v[72:73]
v_pk_mul_f32 v[214:215], v[214:215], v[74:75]
v_cvt_pk_bf16_f32 v116, v212, v213
v_cvt_pk_bf16_f32 v117, v214, v215
v_pk_fma_f32 v[220:221], v[92:93], v[68:69], v[220:221] op_sel:[0,0,0] op_sel_hi:[1,0,1]
v_pk_fma_f32 v[222:223], v[94:95], v[68:69], v[222:223] op_sel:[0,0,0] op_sel_hi:[1,0,1]
v_pk_mul_f32 v[220:221], v[220:221], v[76:77]
v_pk_mul_f32 v[222:223], v[222:223], v[78:79]
v_cvt_pk_bf16_f32 v118, v220, v221
v_cvt_pk_bf16_f32 v119, v222, v223
v_pk_fma_f32 v[228:229], v[96:97], v[68:69], v[228:229] op_sel:[0,0,0] op_sel_hi:[1,0,1]
v_pk_fma_f32 v[230:231], v[98:99], v[68:69], v[230:231] op_sel:[0,0,0] op_sel_hi:[1,0,1]
v_pk_mul_f32 v[228:229], v[228:229], v[80:81]
v_pk_mul_f32 v[230:231], v[230:231], v[82:83]
v_cvt_pk_bf16_f32 v120, v228, v229
v_cvt_pk_bf16_f32 v121, v230, v231
v_pk_fma_f32 v[236:237], v[100:101], v[68:69], v[236:237] op_sel:[0,0,0] op_sel_hi:[1,0,1]
v_pk_fma_f32 v[238:239], v[102:103], v[68:69], v[238:239] op_sel:[0,0,0] op_sel_hi:[1,0,1]
v_pk_mul_f32 v[236:237], v[236:237], v[84:85]
v_pk_mul_f32 v[238:239], v[238:239], v[86:87]
v_cvt_pk_bf16_f32 v122, v236, v237
v_cvt_pk_bf16_f32 v123, v238, v239
v_pk_fma_f32 v[216:217], v[88:89], v[68:69], v[216:217] op_sel:[0,1,0] op_sel_hi:[1,1,1]
v_pk_fma_f32 v[218:219], v[90:91], v[68:69], v[218:219] op_sel:[0,1,0] op_sel_hi:[1,1,1]
v_pk_mul_f32 v[216:217], v[216:217], v[72:73]
v_pk_mul_f32 v[218:219], v[218:219], v[74:75]
v_cvt_pk_bf16_f32 v124, v216, v217
v_cvt_pk_bf16_f32 v125, v218, v219
v_pk_fma_f32 v[224:225], v[92:93], v[68:69], v[224:225] op_sel:[0,1,0] op_sel_hi:[1,1,1]
v_pk_fma_f32 v[226:227], v[94:95], v[68:69], v[226:227] op_sel:[0,1,0] op_sel_hi:[1,1,1]
v_pk_mul_f32 v[224:225], v[224:225], v[76:77]
v_pk_mul_f32 v[226:227], v[226:227], v[78:79]
v_cvt_pk_bf16_f32 v126, v224, v225
v_cvt_pk_bf16_f32 v127, v226, v227
v_pk_fma_f32 v[232:233], v[96:97], v[68:69], v[232:233] op_sel:[0,1,0] op_sel_hi:[1,1,1]
v_pk_fma_f32 v[234:235], v[98:99], v[68:69], v[234:235] op_sel:[0,1,0] op_sel_hi:[1,1,1]
v_pk_mul_f32 v[232:233], v[232:233], v[80:81]
v_pk_mul_f32 v[234:235], v[234:235], v[82:83]
v_cvt_pk_bf16_f32 v128, v232, v233
v_cvt_pk_bf16_f32 v129, v234, v235
v_pk_fma_f32 v[240:241], v[100:101], v[68:69], v[240:241] op_sel:[0,1,0] op_sel_hi:[1,1,1]
v_pk_fma_f32 v[242:243], v[102:103], v[68:69], v[242:243] op_sel:[0,1,0] op_sel_hi:[1,1,1]
v_pk_mul_f32 v[240:241], v[240:241], v[84:85]
v_pk_mul_f32 v[242:243], v[242:243], v[86:87]
v_cvt_pk_bf16_f32 v130, v240, v241
v_cvt_pk_bf16_f32 v131, v242, v243
v_mfma_f32_16x16x32_bf16 v[60:63], v[40:43], v[180:183], 0
v_mfma_f32_16x16x32_bf16 v[64:67], v[44:47], v[180:183], 0
v_mfma_f32_16x16x32_bf16 v[68:71], v[40:43], v[188:191], 0
v_mfma_f32_16x16x32_bf16 v[72:75], v[44:47], v[188:191], 0
v_mfma_f32_16x16x32_bf16 v[76:79], v[40:43], v[196:199], 0
v_mfma_f32_16x16x32_bf16 v[80:83], v[44:47], v[196:199], 0
v_mfma_f32_16x16x32_bf16 v[84:87], v[40:43], v[204:207], 0
v_mfma_f32_16x16x32_bf16 v[88:91], v[44:47], v[204:207], 0
s_nop 1
v_max3_f32 v104, v60, v61, v62
v_min3_f32 v108, v60, v61, v62
v_max3_f32 v104, v104, v63, v64
v_min3_f32 v108, v108, v63, v64
v_max3_f32 v104, v104, v65, v66
v_min3_f32 v108, v108, v65, v66
v_max_f32 v104, v104, v67
v_min_f32 v108, v108, v67
v_max3_f32 v105, v68, v69, v70
v_min3_f32 v109, v68, v69, v70
v_max3_f32 v105, v105, v71, v72
v_min3_f32 v109, v109, v71, v72
v_max3_f32 v105, v105, v73, v74
v_min3_f32 v109, v109, v73, v74
v_max_f32 v105, v105, v75
v_min_f32 v109, v109, v75
v_max3_f32 v106, v76, v77, v78
v_min3_f32 v110, v76, v77, v78
v_max3_f32 v106, v106, v79, v80
v_min3_f32 v110, v110, v79, v80
v_max3_f32 v106, v106, v81, v82
v_min3_f32 v110, v110, v81, v82
v_max_f32 v106, v106, v83
v_min_f32 v110, v110, v83
v_max3_f32 v107, v84, v85, v86
v_min3_f32 v111, v84, v85, v86
v_max3_f32 v107, v107, v87, v88
v_min3_f32 v111, v111, v87, v88
v_max3_f32 v107, v107, v89, v90
v_min3_f32 v111, v111, v89, v90
v_max_f32 v107, v107, v91
v_min_f32 v111, v111, v91
s_nop 1
v_permlane32_swap_b32 v104, v105
v_permlane32_swap_b32 v106, v107
v_permlane32_swap_b32 v108, v109
v_permlane32_swap_b32 v110, v111
v_max_f32 v104, v104, v105
v_max_f32 v106, v106, v107
v_min_f32 v108, v108, v109
v_min_f32 v110, v110, v111
v_permlane16_swap_b32 v104, v106
s_nop 0
v_permlane16_swap_b32 v108, v110
v_max_f32 v104, v104, v106
v_min_f32 v108, v108, v110
v_mov_b32 v106, v104
v_mov_b32 v110, v108
s_nop 0
v_permlane16_swap_b32 v104, v106
v_permlane16_swap_b32 v108, v110
v_mov_b32 v105, v104
v_mov_b32 v107, v106
v_mov_b32 v109, v108
v_mov_b32 v111, v110
v_permlane32_swap_b32 v104, v105
v_permlane32_swap_b32 v106, v107
v_permlane32_swap_b32 v108, v109
v_permlane32_swap_b32 v110, v111
v_pk_mul_f32 v[104:105], v[104:105], v[20:21]
v_pk_mul_f32 v[106:107], v[106:107], v[22:23]
v_pk_mul_f32 v[108:109], v[108:109], v[20:21]
v_pk_mul_f32 v[110:111], v[110:111], v[22:23]
v_pk_fma_f32 v[212:213], v[60:61], v[20:21], v[108:109] op_sel:[0,0,0] op_sel_hi:[1,0,0] neg_lo:[1,0,0] neg_hi:[1,0,0]
v_pk_fma_f32 v[60:61], v[60:61], v[20:21], v[104:105] op_sel:[0,0,0] op_sel_hi:[1,0,0] neg_lo:[0,0,1] neg_hi:[0,0,1]
v_exp_f32 v212, v212
v_exp_f32 v60, v60
v_exp_f32 v213, v213
v_exp_f32 v61, v61
v_pk_fma_f32 v[214:215], v[62:63], v[20:21], v[108:109] op_sel:[0,0,0] op_sel_hi:[1,0,0] neg_lo:[1,0,0] neg_hi:[1,0,0]
v_pk_fma_f32 v[62:63], v[62:63], v[20:21], v[104:105] op_sel:[0,0,0] op_sel_hi:[1,0,0] neg_lo:[0,0,1] neg_hi:[0,0,1]
v_exp_f32 v214, v214
v_exp_f32 v62, v62
v_exp_f32 v215, v215
v_exp_f32 v63, v63
v_pk_fma_f32 v[216:217], v[64:65], v[20:21], v[108:109] op_sel:[0,0,0] op_sel_hi:[1,0,0] neg_lo:[1,0,0] neg_hi:[1,0,0]
v_pk_fma_f32 v[64:65], v[64:65], v[20:21], v[104:105] op_sel:[0,0,0] op_sel_hi:[1,0,0] neg_lo:[0,0,1] neg_hi:[0,0,1]
v_exp_f32 v216, v216
v_exp_f32 v64, v64
v_exp_f32 v217, v217
v_exp_f32 v65, v65
v_pk_fma_f32 v[218:219], v[66:67], v[20:21], v[108:109] op_sel:[0,0,0] op_sel_hi:[1,0,0] neg_lo:[1,0,0] neg_hi:[1,0,0]
v_pk_fma_f32 v[66:67], v[66:67], v[20:21], v[104:105] op_sel:[0,0,0] op_sel_hi:[1,0,0] neg_lo:[0,0,1] neg_hi:[0,0,1]
v_exp_f32 v218, v218
v_exp_f32 v66, v66
v_exp_f32 v219, v219
v_exp_f32 v67, v67
v_pk_fma_f32 v[220:221], v[68:69], v[20:21], v[108:109] op_sel:[0,1,1] op_sel_hi:[1,1,1] neg_lo:[1,0,0] neg_hi:[1,0,0]
v_pk_fma_f32 v[68:69], v[68:69], v[20:21], v[104:105] op_sel:[0,1,1] op_sel_hi:[1,1,1] neg_lo:[0,0,1] neg_hi:[0,0,1]
v_exp_f32 v220, v220
v_exp_f32 v68, v68
v_exp_f32 v221, v221
v_exp_f32 v69, v69
v_pk_fma_f32 v[222:223], v[70:71], v[20:21], v[108:109] op_sel:[0,1,1] op_sel_hi:[1,1,1] neg_lo:[1,0,0] neg_hi:[1,0,0]
v_pk_fma_f32 v[70:71], v[70:71], v[20:21], v[104:105] op_sel:[0,1,1] op_sel_hi:[1,1,1] neg_lo:[0,0,1] neg_hi:[0,0,1]
v_exp_f32 v222, v222
v_exp_f32 v70, v70
v_exp_f32 v223, v223
v_exp_f32 v71, v71
v_pk_fma_f32 v[224:225], v[72:73], v[20:21], v[108:109] op_sel:[0,1,1] op_sel_hi:[1,1,1] neg_lo:[1,0,0] neg_hi:[1,0,0]
v_pk_fma_f32 v[72:73], v[72:73], v[20:21], v[104:105] op_sel:[0,1,1] op_sel_hi:[1,1,1] neg_lo:[0,0,1] neg_hi:[0,0,1]
v_exp_f32 v224, v224
v_exp_f32 v72, v72
v_exp_f32 v225, v225
v_exp_f32 v73, v73
v_pk_fma_f32 v[226:227], v[74:75], v[20:21], v[108:109] op_sel:[0,1,1] op_sel_hi:[1,1,1] neg_lo:[1,0,0] neg_hi:[1,0,0]
v_pk_fma_f32 v[74:75], v[74:75], v[20:21], v[104:105] op_sel:[0,1,1] op_sel_hi:[1,1,1] neg_lo:[0,0,1] neg_hi:[0,0,1]
v_exp_f32 v226, v226
v_exp_f32 v74, v74
v_exp_f32 v227, v227
v_exp_f32 v75, v75
v_pk_fma_f32 v[228:229], v[76:77], v[22:23], v[110:111] op_sel:[0,0,0] op_sel_hi:[1,0,0] neg_lo:[1,0,0] neg_hi:[1,0,0]
v_pk_fma_f32 v[76:77], v[76:77], v[22:23], v[106:107] op_sel:[0,0,0] op_sel_hi:[1,0,0] neg_lo:[0,0,1] neg_hi:[0,0,1]
v_exp_f32 v228, v228
v_exp_f32 v76, v76
v_exp_f32 v229, v229
v_exp_f32 v77, v77
v_pk_fma_f32 v[230:231], v[78:79], v[22:23], v[110:111] op_sel:[0,0,0] op_sel_hi:[1,0,0] neg_lo:[1,0,0] neg_hi:[1,0,0]
v_pk_fma_f32 v[78:79], v[78:79], v[22:23], v[106:107] op_sel:[0,0,0] op_sel_hi:[1,0,0] neg_lo:[0,0,1] neg_hi:[0,0,1]
v_exp_f32 v230, v230
v_exp_f32 v78, v78
v_exp_f32 v231, v231
v_exp_f32 v79, v79
v_pk_fma_f32 v[232:233], v[80:81], v[22:23], v[110:111] op_sel:[0,0,0] op_sel_hi:[1,0,0] neg_lo:[1,0,0] neg_hi:[1,0,0]
v_pk_fma_f32 v[80:81], v[80:81], v[22:23], v[106:107] op_sel:[0,0,0] op_sel_hi:[1,0,0] neg_lo:[0,0,1] neg_hi:[0,0,1]
v_exp_f32 v232, v232
v_exp_f32 v80, v80
v_exp_f32 v233, v233
v_exp_f32 v81, v81
v_pk_fma_f32 v[234:235], v[82:83], v[22:23], v[110:111] op_sel:[0,0,0] op_sel_hi:[1,0,0] neg_lo:[1,0,0] neg_hi:[1,0,0]
v_pk_fma_f32 v[82:83], v[82:83], v[22:23], v[106:107] op_sel:[0,0,0] op_sel_hi:[1,0,0] neg_lo:[0,0,1] neg_hi:[0,0,1]
v_exp_f32 v234, v234
v_exp_f32 v82, v82
v_exp_f32 v235, v235
v_exp_f32 v83, v83
v_pk_fma_f32 v[236:237], v[84:85], v[22:23], v[110:111] op_sel:[0,1,1] op_sel_hi:[1,1,1] neg_lo:[1,0,0] neg_hi:[1,0,0]
v_pk_fma_f32 v[84:85], v[84:85], v[22:23], v[106:107] op_sel:[0,1,1] op_sel_hi:[1,1,1] neg_lo:[0,0,1] neg_hi:[0,0,1]
v_exp_f32 v236, v236
v_exp_f32 v84, v84
v_exp_f32 v237, v237
v_exp_f32 v85, v85
v_pk_fma_f32 v[238:239], v[86:87], v[22:23], v[110:111] op_sel:[0,1,1] op_sel_hi:[1,1,1] neg_lo:[1,0,0] neg_hi:[1,0,0]
v_pk_fma_f32 v[86:87], v[86:87], v[22:23], v[106:107] op_sel:[0,1,1] op_sel_hi:[1,1,1] neg_lo:[0,0,1] neg_hi:[0,0,1]
v_exp_f32 v238, v238
v_exp_f32 v86, v86
v_exp_f32 v239, v239
v_exp_f32 v87, v87
v_pk_fma_f32 v[240:241], v[88:89], v[22:23], v[110:111] op_sel:[0,1,1] op_sel_hi:[1,1,1] neg_lo:[1,0,0] neg_hi:[1,0,0]
v_pk_fma_f32 v[88:89], v[88:89], v[22:23], v[106:107] op_sel:[0,1,1] op_sel_hi:[1,1,1] neg_lo:[0,0,1] neg_hi:[0,0,1]
v_exp_f32 v240, v240
v_exp_f32 v88, v88
v_exp_f32 v241, v241
v_exp_f32 v89, v89
v_pk_fma_f32 v[242:243], v[90:91], v[22:23], v[110:111] op_sel:[0,1,1] op_sel_hi:[1,1,1] neg_lo:[1,0,0] neg_hi:[1,0,0]
v_pk_fma_f32 v[90:91], v[90:91], v[22:23], v[106:107] op_sel:[0,1,1] op_sel_hi:[1,1,1] neg_lo:[0,0,1] neg_hi:[0,0,1]
v_exp_f32 v242, v242
v_exp_f32 v90, v90
v_exp_f32 v243, v243
v_exp_f32 v91, v91
s_nop 0
v_pk_add_f32 v[112:113], v[60:61], v[62:63]
v_pk_add_f32 v[114:115], v[212:213], v[214:215]
v_pk_add_f32 v[112:113], v[112:113], v[64:65]
v_pk_add_f32 v[114:115], v[114:115], v[216:217]
v_pk_add_f32 v[112:113], v[112:113], v[66:67]
v_pk_add_f32 v[114:115], v[114:115], v[218:219]
v_add_f32 v104, v112, v113
v_add_f32 v108, v114, v115
v_pk_add_f32 v[112:113], v[68:69], v[70:71]
v_pk_add_f32 v[114:115], v[220:221], v[222:223]
v_pk_add_f32 v[112:113], v[112:113], v[72:73]
v_pk_add_f32 v[114:115], v[114:115], v[224:225]
v_pk_add_f32 v[112:113], v[112:113], v[74:75]
v_pk_add_f32 v[114:115], v[114:115], v[226:227]
v_add_f32 v105, v112, v113
v_add_f32 v109, v114, v115
v_pk_add_f32 v[112:113], v[76:77], v[78:79]
v_pk_add_f32 v[114:115], v[228:229], v[230:231]
v_pk_add_f32 v[112:113], v[112:113], v[80:81]
v_pk_add_f32 v[114:115], v[114:115], v[232:233]
v_pk_add_f32 v[112:113], v[112:113], v[82:83]
v_pk_add_f32 v[114:115], v[114:115], v[234:235]
v_add_f32 v106, v112, v113
v_add_f32 v110, v114, v115
v_pk_add_f32 v[112:113], v[84:85], v[86:87]
v_pk_add_f32 v[114:115], v[236:237], v[238:239]
v_pk_add_f32 v[112:113], v[112:113], v[88:89]
v_pk_add_f32 v[114:115], v[114:115], v[240:241]
v_pk_add_f32 v[112:113], v[112:113], v[90:91]
v_pk_add_f32 v[114:115], v[114:115], v[242:243]
v_add_f32 v107, v112, v113
v_add_f32 v111, v114, v115
s_nop 1
v_permlane32_swap_b32 v104, v105
v_permlane32_swap_b32 v106, v107
v_permlane32_swap_b32 v108, v109
v_permlane32_swap_b32 v110, v111
v_add_f32 v104, v104, v105
v_add_f32 v106, v106, v107
v_add_f32 v108, v108, v109
v_add_f32 v110, v110, v111
v_permlane16_swap_b32 v104, v106
s_nop 0
v_permlane16_swap_b32 v108, v110
v_add_f32 v104, v104, v106
v_add_f32 v108, v108, v110
v_rcp_f32 v104, v104
v_rcp_f32 v108, v108
s_nop 0
v_mov_b32 v106, v104
v_mov_b32 v110, v108
s_nop 0
v_permlane16_swap_b32 v104, v106
v_permlane16_swap_b32 v108, v110
v_mov_b32 v105, v104
v_mov_b32 v107, v106
v_mov_b32 v109, v108
v_mov_b32 v111, v110
v_permlane32_swap_b32 v104, v105
v_permlane32_swap_b32 v106, v107
v_permlane32_swap_b32 v108, v109
v_permlane32_swap_b32 v110, v111
.p2align 3
v_pk_mul_f32 v[60:61], v[60:61], v[104:105] op_sel:[0,0] op_sel_hi:[1,0]
v_pk_mul_f32 v[62:63], v[62:63], v[104:105] op_sel:[0,0] op_sel_hi:[1,0]
v_pk_mul_f32 v[64:65], v[64:65], v[104:105] op_sel:[0,0] op_sel_hi:[1,0]
v_pk_mul_f32 v[66:67], v[66:67], v[104:105] op_sel:[0,0] op_sel_hi:[1,0]
v_pk_mul_f32 v[212:213], v[212:213], v[108:109] op_sel:[0,0] op_sel_hi:[1,0]
v_pk_mul_f32 v[214:215], v[214:215], v[108:109] op_sel:[0,0] op_sel_hi:[1,0]
v_pk_mul_f32 v[216:217], v[216:217], v[108:109] op_sel:[0,0] op_sel_hi:[1,0]
v_pk_mul_f32 v[218:219], v[218:219], v[108:109] op_sel:[0,0] op_sel_hi:[1,0]
v_cvt_pk_bf16_f32 v60, v60, v61
v_cvt_pk_bf16_f32 v61, v62, v63
v_cvt_pk_bf16_f32 v62, v64, v65
v_cvt_pk_bf16_f32 v63, v66, v67
v_cvt_pk_bf16_f32 v212, v212, v213
v_cvt_pk_bf16_f32 v213, v214, v215
v_cvt_pk_bf16_f32 v214, v216, v217
v_cvt_pk_bf16_f32 v215, v218, v219
v_pk_mul_f32 v[68:69], v[68:69], v[104:105] op_sel:[0,1] op_sel_hi:[1,1]
v_pk_mul_f32 v[70:71], v[70:71], v[104:105] op_sel:[0,1] op_sel_hi:[1,1]
v_pk_mul_f32 v[72:73], v[72:73], v[104:105] op_sel:[0,1] op_sel_hi:[1,1]
v_pk_mul_f32 v[74:75], v[74:75], v[104:105] op_sel:[0,1] op_sel_hi:[1,1]
v_pk_mul_f32 v[220:221], v[220:221], v[108:109] op_sel:[0,1] op_sel_hi:[1,1]
v_pk_mul_f32 v[222:223], v[222:223], v[108:109] op_sel:[0,1] op_sel_hi:[1,1]
v_pk_mul_f32 v[224:225], v[224:225], v[108:109] op_sel:[0,1] op_sel_hi:[1,1]
v_pk_mul_f32 v[226:227], v[226:227], v[108:109] op_sel:[0,1] op_sel_hi:[1,1]
v_cvt_pk_bf16_f32 v68, v68, v69
v_mfma_f32_16x16x32_bf16 v[196:199], v[60:63], v[50:53], 0
v_cvt_pk_bf16_f32 v69, v70, v71
v_cvt_pk_bf16_f32 v70, v72, v73
v_mfma_f32_16x16x32_bf16 v[200:203], v[60:63], v[48:51], 0
v_cvt_pk_bf16_f32 v71, v74, v75
v_cvt_pk_bf16_f32 v220, v220, v221
v_mfma_f32_16x16x32_bf16 v[204:207], v[212:215], v[50:53], 0
v_cvt_pk_bf16_f32 v221, v222, v223
v_cvt_pk_bf16_f32 v222, v224, v225
v_mfma_f32_16x16x32_bf16 v[208:211], v[212:215], v[48:51], 0
v_cvt_pk_bf16_f32 v223, v226, v227
v_pk_mul_f32 v[76:77], v[76:77], v[106:107] op_sel:[0,0] op_sel_hi:[1,0]
v_pk_mul_f32 v[78:79], v[78:79], v[106:107] op_sel:[0,0] op_sel_hi:[1,0]
v_pk_mul_f32 v[80:81], v[80:81], v[106:107] op_sel:[0,0] op_sel_hi:[1,0]
v_pk_mul_f32 v[82:83], v[82:83], v[106:107] op_sel:[0,0] op_sel_hi:[1,0]
v_pk_mul_f32 v[228:229], v[228:229], v[110:111] op_sel:[0,0] op_sel_hi:[1,0]
v_pk_mul_f32 v[230:231], v[230:231], v[110:111] op_sel:[0,0] op_sel_hi:[1,0]
v_pk_mul_f32 v[232:233], v[232:233], v[110:111] op_sel:[0,0] op_sel_hi:[1,0]
v_pk_mul_f32 v[234:235], v[234:235], v[110:111] op_sel:[0,0] op_sel_hi:[1,0]
v_cvt_pk_bf16_f32 v76, v76, v77
v_mfma_f32_16x16x32_bf16 v[180:183], v[68:71], v[50:53], 0
v_mfma_f32_16x16x32_bf16 v[184:187], v[68:71], v[48:51], 0
v_cvt_pk_bf16_f32 v77, v78, v79
v_mfma_f32_16x16x32_bf16 v[188:191], v[220:223], v[50:53], 0
v_cvt_pk_bf16_f32 v78, v80, v81
v_mfma_f32_16x16x32_bf16 v[192:195], v[220:223], v[48:51], 0
v_cvt_pk_bf16_f32 v64, v196, v197
v_cvt_pk_bf16_f32 v79, v82, v83
v_cvt_pk_bf16_f32 v65, v198, v199
v_cvt_pk_bf16_f32 v228, v228, v229
v_cvt_pk_bf16_f32 v72, v200, v201
v_cvt_pk_bf16_f32 v73, v202, v203
v_cvt_pk_bf16_f32 v229, v230, v231
v_cvt_pk_bf16_f32 v216, v204, v205
v_cvt_pk_bf16_f32 v230, v232, v233
v_cvt_pk_bf16_f32 v217, v206, v207
v_cvt_pk_bf16_f32 v224, v208, v209
v_cvt_pk_bf16_f32 v231, v234, v235
v_cvt_pk_bf16_f32 v225, v210, v211
v_pk_mul_f32 v[84:85], v[84:85], v[106:107] op_sel:[0,1] op_sel_hi:[1,1]
v_pk_mul_f32 v[86:87], v[86:87], v[106:107] op_sel:[0,1] op_sel_hi:[1,1]
v_pk_mul_f32 v[88:89], v[88:89], v[106:107] op_sel:[0,1] op_sel_hi:[1,1]
v_pk_mul_f32 v[90:91], v[90:91], v[106:107] op_sel:[0,1] op_sel_hi:[1,1]
v_pk_mul_f32 v[236:237], v[236:237], v[110:111] op_sel:[0,1] op_sel_hi:[1,1]
v_pk_mul_f32 v[238:239], v[238:239], v[110:111] op_sel:[0,1] op_sel_hi:[1,1]
v_pk_mul_f32 v[240:241], v[240:241], v[110:111] op_sel:[0,1] op_sel_hi:[1,1]
v_pk_mul_f32 v[242:243], v[242:243], v[110:111] op_sel:[0,1] op_sel_hi:[1,1]
v_cvt_pk_bf16_f32 v84, v84, v85
v_mfma_f32_16x16x32_bf16 v[196:199], v[76:79], v[50:53], 0
v_mfma_f32_16x16x32_bf16 v[200:203], v[76:79], v[48:51], 0
v_cvt_pk_bf16_f32 v85, v86, v87
v_mfma_f32_16x16x32_bf16 v[204:207], v[228:231], v[50:53], 0
v_cvt_pk_bf16_f32 v86, v88, v89
v_mfma_f32_16x16x32_bf16 v[208:211], v[228:231], v[48:51], 0
v_cvt_pk_bf16_f32 v66, v180, v181
v_cvt_pk_bf16_f32 v87, v90, v91
v_cvt_pk_bf16_f32 v67, v182, v183
v_cvt_pk_bf16_f32 v236, v236, v237
v_cvt_pk_bf16_f32 v74, v184, v185
v_cvt_pk_bf16_f32 v75, v186, v187
v_cvt_pk_bf16_f32 v237, v238, v239
v_cvt_pk_bf16_f32 v218, v188, v189
v_cvt_pk_bf16_f32 v238, v240, v241
v_cvt_pk_bf16_f32 v219, v190, v191
v_cvt_pk_bf16_f32 v226, v192, v193
v_cvt_pk_bf16_f32 v239, v242, v243
v_cvt_pk_bf16_f32 v227, v194, v195
s_mul_i32 s48, s40, 3072
s_add_u32 s48, s48, 139264
v_mfma_f32_16x16x32_bf16 v[180:183], v[84:87], v[50:53], 0
v_mfma_f32_16x16x32_bf16 v[184:187], v[84:87], v[48:51], 0
v_mfma_f32_16x16x32_bf16 v[188:191], v[236:239], v[50:53], 0
v_mfma_f32_16x16x32_bf16 v[192:195], v[236:239], v[48:51], 0
v_mfma_f32_16x16x32_bf16 v[132:135], v[216:219], v[116:119], 0
v_cvt_pk_bf16_f32 v80, v196, v197
v_cvt_pk_bf16_f32 v81, v198, v199
v_mfma_f32_16x16x32_bf16 v[136:139], v[224:227], v[116:119], 0
v_cvt_pk_bf16_f32 v88, v200, v201
v_mfma_f32_16x16x32_bf16 v[140:143], v[216:219], v[124:127], 0
v_cvt_pk_bf16_f32 v89, v202, v203
v_mfma_f32_16x16x32_bf16 v[144:147], v[224:227], v[124:127], 0
v_cvt_pk_bf16_f32 v232, v204, v205
v_cvt_pk_bf16_f32 v233, v206, v207
v_mfma_f32_16x16x32_bf16 v[10:13], v[216:219], v[56:59], 0
v_cvt_pk_bf16_f32 v240, v208, v209
v_mfma_f32_16x16x32_bf16 v[14:17], v[224:227], v[56:59], 0
v_cvt_pk_bf16_f32 v241, v210, v211
v_mfma_f32_16x16x32_bf16 v[92:95], v[64:67], v[116:119], 0
v_cvt_pk_bf16_f32 v82, v180, v181
v_cvt_pk_bf16_f32 v83, v182, v183
v_mfma_f32_16x16x32_bf16 v[96:99], v[72:75], v[116:119], 0
v_cvt_pk_bf16_f32 v90, v184, v185
v_mfma_f32_16x16x32_bf16 v[100:103], v[64:67], v[124:127], 0
v_cvt_pk_bf16_f32 v91, v186, v187
v_mfma_f32_16x16x32_bf16 v[104:107], v[72:75], v[124:127], 0
v_cvt_pk_bf16_f32 v234, v188, v189
v_cvt_pk_bf16_f32 v235, v190, v191
v_mfma_f32_16x16x32_bf16 v[108:111], v[64:67], v[56:59], 0
v_cvt_pk_bf16_f32 v242, v192, v193
v_mfma_f32_16x16x32_bf16 v[112:115], v[72:75], v[56:59], 0
v_cvt_pk_bf16_f32 v243, v194, v195
v_add_u32 v4, s48, v18
s_xor_b32 s49, s40, 2
v_mfma_f32_16x16x32_bf16 v[132:135], v[232:235], v[120:123], v[132:135]
s_mul_i32 s48, s49, 3072
s_add_u32 s48, s48, 139264
v_mfma_f32_16x16x32_bf16 v[136:139], v[240:243], v[120:123], v[136:139]
v_add_u32 v5, s48, v18
s_lshl_b32 s49, s49, 2
v_mfma_f32_16x16x32_bf16 v[140:143], v[232:235], v[128:131], v[140:143]
v_mfma_f32_16x16x32_bf16 v[144:147], v[240:243], v[128:131], v[144:147]
s_add_u32 s49, s49, 134928
v_mov_b32 v7, s49
v_mfma_f32_16x16x32_bf16 v[10:13], v[232:235], v[56:59], v[10:13]
v_xor_b32 v8, 8, v7
v_mov_b32 v9, 3
v_mfma_f32_16x16x32_bf16 v[14:17], v[240:243], v[56:59], v[14:17]
v_mfma_f32_16x16x32_bf16 v[92:95], v[80:83], v[120:123], v[92:95]
v_mfma_f32_16x16x32_bf16 v[96:99], v[88:91], v[120:123], v[96:99]
v_mfma_f32_16x16x32_bf16 v[100:103], v[80:83], v[128:131], v[100:103]
v_cvt_pk_bf16_f32 v132, v132, v133
v_cvt_pk_bf16_f32 v133, v134, v135
v_cvt_pk_bf16_f32 v134, v136, v137
v_mfma_f32_16x16x32_bf16 v[104:107], v[88:91], v[128:131], v[104:107]
v_cvt_pk_bf16_f32 v135, v138, v139
ds_write_b128 v4, v[132:135] offset:0
v_mfma_f32_16x16x32_bf16 v[108:111], v[80:83], v[56:59], v[108:111]
v_cvt_pk_bf16_f32 v140, v140, v141
v_cvt_pk_bf16_f32 v141, v142, v143
v_cvt_pk_bf16_f32 v142, v144, v145
v_mfma_f32_16x16x32_bf16 v[112:115], v[88:91], v[56:59], v[112:115]
v_cvt_pk_bf16_f32 v143, v146, v147
ds_write_b128 v4, v[140:143] offset:1024
v_cvt_pk_bf16_f32 v10, v10, v11
v_cvt_pk_bf16_f32 v11, v12, v13
v_cvt_pk_bf16_f32 v12, v14, v15
v_cvt_pk_bf16_f32 v13, v16, v17
ds_write_b128 v4, v[10:13] offset:2048
ds_write_b32 v8, v9
s_lshl_b32 s53, s41, 1
s_add_u32 s53, s53, s44
s_lshl_b32 s54, s45, 16
s_lshl_b32 s48, s44, 15
s_add_u32 s54, s54, s48
s_add_u32 s54, s54, 12582912
s_mov_b32 s63, 0
px_80:
ds_read_b32 v9, v7
ds_read_b128 v[180:183], v5 offset:0
ds_read_b128 v[184:187], v5 offset:1024
ds_read_b128 v[188:191], v5 offset:2048
s_add_u32 s63, s63, 1
s_cmp_lt_u32 s63, 0x400000
s_waitcnt lgkmcnt(0)
v_cmp_ne_u32 vcc, 3, v9
s_cbranch_vccz pxd_81
s_cbranch_scc1 px_80
pxd_81:
v_mfma_f32_16x16x32_bf16 v[92:95], v[50:53], v[180:183], v[92:95]
s_lshl_b32 s48, s41, 7
s_add_u32 s48, s48, s54
v_mfma_f32_16x16x32_bf16 v[96:99], v[48:51], v[180:183], v[96:99]
s_add_u32 s50, s48, 16384
v_lshrrev_b32 v4, 3, v0
v_mfma_f32_16x16x32_bf16 v[100:103], v[50:53], v[184:187], v[100:103]
v_and_b32 v5, 7, v0
v_lshlrev_b32 v4, 11, v4
v_mfma_f32_16x16x32_bf16 v[104:107], v[48:51], v[184:187], v[104:107]
v_lshl_add_u32 v6, v5, 4, v4
s_lshl_b32 s55, s45, 11
v_mfma_f32_16x16x32_bf16 v[108:111], v[50:53], v[188:191], v[108:111]
s_add_u32 s55, s55, 19005440
s_lshl_b32 s49, s44, 10
v_mfma_f32_16x16x32_bf16 v[112:115], v[48:51], v[188:191], v[112:115]
s_add_u32 s55, s55, s49
v_lshlrev_b32 v7, 6, v2
v_lshl_add_u32 v7, v3, 4, v7
v_cmp_eq_u32 vcc, s41, v2
v_cvt_pk_bf16_f32 v92, v92, v93
v_cvt_pk_bf16_f32 v93, v94, v95
v_cvt_pk_bf16_f32 v94, v96, v97
v_cvt_pk_bf16_f32 v95, v98, v99
buffer_store_dwordx4 v[92:95], v6, s[32:35], s48 offen sc1
v_cvt_pk_bf16_f32 v100, v100, v101
v_cvt_pk_bf16_f32 v101, v102, v103
v_cvt_pk_bf16_f32 v102, v104, v105
v_cvt_pk_bf16_f32 v103, v106, v107
buffer_store_dwordx4 v[100:103], v6, s[32:35], s50 offen sc1
v_cvt_pk_bf16_f32 v108, v108, v109
v_cvt_pk_bf16_f32 v109, v110, v111
v_cvt_pk_bf16_f32 v110, v112, v113
v_cvt_pk_bf16_f32 v111, v114, v115
s_mov_b64 exec, vcc
buffer_store_dwordx4 v[108:111], v7, s[32:35], s55 offen sc1
s_mov_b64 exec, -1
s_lshl_b32 s56, s45, 7
s_add_u32 s56, s56, 18366464
.p2align 3
v_pk_fma_f32 v[148:149], v[244:245], v[30:31], v[148:149] op_sel:[0,1,0] op_sel_hi:[1,1,1]
v_pk_fma_f32 v[150:151], v[246:247], v[30:31], v[150:151] op_sel:[0,1,0] op_sel_hi:[1,1,1]
v_pk_fma_f32 v[152:153], v[248:249], v[30:31], v[152:153] op_sel:[0,1,0] op_sel_hi:[1,1,1]
v_pk_fma_f32 v[154:155], v[250:251], v[30:31], v[154:155] op_sel:[0,1,0] op_sel_hi:[1,1,1]
v_cvt_pk_bf16_f32 v148, v148, v149
v_cvt_pk_bf16_f32 v149, v150, v151
v_cvt_pk_bf16_f32 v150, v152, v153
v_cvt_pk_bf16_f32 v151, v154, v155
v_pk_fma_f32 v[156:157], v[244:245], v[32:33], v[156:157] op_sel:[0,1,0] op_sel_hi:[1,1,1]
v_pk_fma_f32 v[158:159], v[246:247], v[32:33], v[158:159] op_sel:[0,1,0] op_sel_hi:[1,1,1]
v_pk_fma_f32 v[160:161], v[248:249], v[32:33], v[160:161] op_sel:[0,1,0] op_sel_hi:[1,1,1]
v_pk_fma_f32 v[162:163], v[250:251], v[32:33], v[162:163] op_sel:[0,1,0] op_sel_hi:[1,1,1]
v_cvt_pk_bf16_f32 v156, v156, v157
v_cvt_pk_bf16_f32 v157, v158, v159
v_cvt_pk_bf16_f32 v158, v160, v161
v_cvt_pk_bf16_f32 v159, v162, v163
v_pk_fma_f32 v[164:165], v[244:245], v[34:35], v[164:165] op_sel:[0,1,0] op_sel_hi:[1,1,1]
v_pk_fma_f32 v[166:167], v[246:247], v[34:35], v[166:167] op_sel:[0,1,0] op_sel_hi:[1,1,1]
v_pk_fma_f32 v[168:169], v[248:249], v[34:35], v[168:169] op_sel:[0,1,0] op_sel_hi:[1,1,1]
v_pk_fma_f32 v[170:171], v[250:251], v[34:35], v[170:171] op_sel:[0,1,0] op_sel_hi:[1,1,1]
v_cvt_pk_bf16_f32 v164, v164, v165
v_cvt_pk_bf16_f32 v165, v166, v167
v_cvt_pk_bf16_f32 v166, v168, v169
v_cvt_pk_bf16_f32 v167, v170, v171
v_pk_fma_f32 v[172:173], v[244:245], v[36:37], v[172:173] op_sel:[0,1,0] op_sel_hi:[1,1,1]
v_pk_fma_f32 v[174:175], v[246:247], v[36:37], v[174:175] op_sel:[0,1,0] op_sel_hi:[1,1,1]
v_pk_fma_f32 v[176:177], v[248:249], v[36:37], v[176:177] op_sel:[0,1,0] op_sel_hi:[1,1,1]
v_pk_fma_f32 v[178:179], v[250:251], v[36:37], v[178:179] op_sel:[0,1,0] op_sel_hi:[1,1,1]
v_cvt_pk_bf16_f32 v172, v172, v173
v_cvt_pk_bf16_f32 v173, v174, v175
v_cvt_pk_bf16_f32 v174, v176, v177
v_cvt_pk_bf16_f32 v175, v178, v179
v_and_b32 v9, 1, v0
v_lshlrev_b32 v9, 4, v9
v_mov_b32 v8, 0x3f80
v_lshlrev_b32 v9, v9, v8
v_lshrrev_b32 v8, 1, v2
v_cmp_eq_u32 vcc, 0, v8
s_nop 1
v_cndmask_b32 v24, 0, v9, vcc
v_cmp_eq_u32 vcc, 1, v8
s_nop 1
v_cndmask_b32 v25, 0, v9, vcc
v_cmp_eq_u32 vcc, 2, v8
s_nop 1
v_cndmask_b32 v26, 0, v9, vcc
v_cmp_eq_u32 vcc, 3, v8
s_nop 1
v_cndmask_b32 v27, 0, v9, vcc
v_mfma_f32_16x16x32_bf16 v[60:63], v[40:43], v[148:151], 0
v_mfma_f32_16x16x32_bf16 v[64:67], v[44:47], v[148:151], 0
v_mfma_f32_16x16x32_bf16 v[68:71], v[40:43], v[156:159], 0
v_mfma_f32_16x16x32_bf16 v[72:75], v[44:47], v[156:159], 0
v_mfma_f32_16x16x32_bf16 v[76:79], v[40:43], v[164:167], 0
v_mfma_f32_16x16x32_bf16 v[80:83], v[44:47], v[164:167], 0
v_mfma_f32_16x16x32_bf16 v[84:87], v[40:43], v[172:175], 0
v_mfma_f32_16x16x32_bf16 v[88:91], v[44:47], v[172:175], 0
s_nop 1
v_max3_f32 v104, v60, v61, v62
v_min3_f32 v108, v60, v61, v62
v_max3_f32 v104, v104, v63, v64
v_min3_f32 v108, v108, v63, v64
v_max3_f32 v104, v104, v65, v66
v_min3_f32 v108, v108, v65, v66
v_max_f32 v104, v104, v67
v_min_f32 v108, v108, v67
v_max3_f32 v105, v68, v69, v70
v_min3_f32 v109, v68, v69, v70
v_max3_f32 v105, v105, v71, v72
v_min3_f32 v109, v109, v71, v72
v_max3_f32 v105, v105, v73, v74
v_min3_f32 v109, v109, v73, v74
v_max_f32 v105, v105, v75
v_min_f32 v109, v109, v75
v_max3_f32 v106, v76, v77, v78
v_min3_f32 v110, v76, v77, v78
v_max3_f32 v106, v106, v79, v80
v_min3_f32 v110, v110, v79, v80
v_max3_f32 v106, v106, v81, v82
v_min3_f32 v110, v110, v81, v82
v_max_f32 v106, v106, v83
v_min_f32 v110, v110, v83
v_max3_f32 v107, v84, v85, v86
v_min3_f32 v111, v84, v85, v86
v_max3_f32 v107, v107, v87, v88
v_min3_f32 v111, v111, v87, v88
v_max3_f32 v107, v107, v89, v90
v_min3_f32 v111, v111, v89, v90
v_max_f32 v107, v107, v91
v_min_f32 v111, v111, v91
s_nop 1
v_permlane32_swap_b32 v104, v105
v_permlane32_swap_b32 v106, v107
v_permlane32_swap_b32 v108, v109
v_permlane32_swap_b32 v110, v111
v_max_f32 v104, v104, v105
v_max_f32 v106, v106, v107
v_min_f32 v108, v108, v109
v_min_f32 v110, v110, v111
v_permlane16_swap_b32 v104, v106
s_nop 0
v_permlane16_swap_b32 v108, v110
v_max_f32 v104, v104, v106
v_min_f32 v108, v108, v110
v_mov_b32 v106, v104
v_mov_b32 v110, v108
s_nop 0
v_permlane16_swap_b32 v104, v106
v_permlane16_swap_b32 v108, v110
v_mov_b32 v105, v104
v_mov_b32 v107, v106
v_mov_b32 v109, v108
v_mov_b32 v111, v110
v_permlane32_swap_b32 v104, v105
v_permlane32_swap_b32 v106, v107
v_permlane32_swap_b32 v108, v109
v_permlane32_swap_b32 v110, v111
v_pk_mul_f32 v[104:105], v[104:105], v[20:21]
v_pk_mul_f32 v[106:107], v[106:107], v[22:23]
v_pk_mul_f32 v[108:109], v[108:109], v[20:21]
v_pk_mul_f32 v[110:111], v[110:111], v[22:23]
v_pk_fma_f32 v[212:213], v[60:61], v[20:21], v[108:109] op_sel:[0,0,0] op_sel_hi:[1,0,0] neg_lo:[1,0,0] neg_hi:[1,0,0]
v_pk_fma_f32 v[60:61], v[60:61], v[20:21], v[104:105] op_sel:[0,0,0] op_sel_hi:[1,0,0] neg_lo:[0,0,1] neg_hi:[0,0,1]
v_exp_f32 v212, v212
v_exp_f32 v60, v60
v_exp_f32 v213, v213
v_exp_f32 v61, v61
v_pk_fma_f32 v[214:215], v[62:63], v[20:21], v[108:109] op_sel:[0,0,0] op_sel_hi:[1,0,0] neg_lo:[1,0,0] neg_hi:[1,0,0]
v_pk_fma_f32 v[62:63], v[62:63], v[20:21], v[104:105] op_sel:[0,0,0] op_sel_hi:[1,0,0] neg_lo:[0,0,1] neg_hi:[0,0,1]
v_exp_f32 v214, v214
v_exp_f32 v62, v62
v_exp_f32 v215, v215
v_exp_f32 v63, v63
v_pk_fma_f32 v[216:217], v[64:65], v[20:21], v[108:109] op_sel:[0,0,0] op_sel_hi:[1,0,0] neg_lo:[1,0,0] neg_hi:[1,0,0]
v_pk_fma_f32 v[64:65], v[64:65], v[20:21], v[104:105] op_sel:[0,0,0] op_sel_hi:[1,0,0] neg_lo:[0,0,1] neg_hi:[0,0,1]
v_exp_f32 v216, v216
v_exp_f32 v64, v64
v_exp_f32 v217, v217
v_exp_f32 v65, v65
v_pk_fma_f32 v[218:219], v[66:67], v[20:21], v[108:109] op_sel:[0,0,0] op_sel_hi:[1,0,0] neg_lo:[1,0,0] neg_hi:[1,0,0]
v_pk_fma_f32 v[66:67], v[66:67], v[20:21], v[104:105] op_sel:[0,0,0] op_sel_hi:[1,0,0] neg_lo:[0,0,1] neg_hi:[0,0,1]
v_exp_f32 v218, v218
v_exp_f32 v66, v66
v_exp_f32 v219, v219
v_exp_f32 v67, v67
v_pk_fma_f32 v[220:221], v[68:69], v[20:21], v[108:109] op_sel:[0,1,1] op_sel_hi:[1,1,1] neg_lo:[1,0,0] neg_hi:[1,0,0]
v_pk_fma_f32 v[68:69], v[68:69], v[20:21], v[104:105] op_sel:[0,1,1] op_sel_hi:[1,1,1] neg_lo:[0,0,1] neg_hi:[0,0,1]
v_exp_f32 v220, v220
v_exp_f32 v68, v68
v_exp_f32 v221, v221
v_exp_f32 v69, v69
v_pk_fma_f32 v[222:223], v[70:71], v[20:21], v[108:109] op_sel:[0,1,1] op_sel_hi:[1,1,1] neg_lo:[1,0,0] neg_hi:[1,0,0]
v_pk_fma_f32 v[70:71], v[70:71], v[20:21], v[104:105] op_sel:[0,1,1] op_sel_hi:[1,1,1] neg_lo:[0,0,1] neg_hi:[0,0,1]
v_exp_f32 v222, v222
v_exp_f32 v70, v70
v_exp_f32 v223, v223
v_exp_f32 v71, v71
v_pk_fma_f32 v[224:225], v[72:73], v[20:21], v[108:109] op_sel:[0,1,1] op_sel_hi:[1,1,1] neg_lo:[1,0,0] neg_hi:[1,0,0]
v_pk_fma_f32 v[72:73], v[72:73], v[20:21], v[104:105] op_sel:[0,1,1] op_sel_hi:[1,1,1] neg_lo:[0,0,1] neg_hi:[0,0,1]
v_exp_f32 v224, v224
v_exp_f32 v72, v72
v_exp_f32 v225, v225
v_exp_f32 v73, v73
v_pk_fma_f32 v[226:227], v[74:75], v[20:21], v[108:109] op_sel:[0,1,1] op_sel_hi:[1,1,1] neg_lo:[1,0,0] neg_hi:[1,0,0]
v_pk_fma_f32 v[74:75], v[74:75], v[20:21], v[104:105] op_sel:[0,1,1] op_sel_hi:[1,1,1] neg_lo:[0,0,1] neg_hi:[0,0,1]
v_exp_f32 v226, v226
v_exp_f32 v74, v74
v_exp_f32 v227, v227
v_exp_f32 v75, v75
s_waitcnt vmcnt(0)
s_lshl_b32 s62, s53, 2
v_mov_b32 v4, s62
v_mov_b32 v5, 2
s_mov_b64 exec, 1
buffer_store_dword v5, v4, s[32:35], s56 offen sc1
s_mov_b64 exec, -1
v_pk_fma_f32 v[228:229], v[76:77], v[22:23], v[110:111] op_sel:[0,0,0] op_sel_hi:[1,0,0] neg_lo:[1,0,0] neg_hi:[1,0,0]
v_pk_fma_f32 v[76:77], v[76:77], v[22:23], v[106:107] op_sel:[0,0,0] op_sel_hi:[1,0,0] neg_lo:[0,0,1] neg_hi:[0,0,1]
v_exp_f32 v228, v228
v_exp_f32 v76, v76
v_exp_f32 v229, v229
v_exp_f32 v77, v77
v_pk_fma_f32 v[230:231], v[78:79], v[22:23], v[110:111] op_sel:[0,0,0] op_sel_hi:[1,0,0] neg_lo:[1,0,0] neg_hi:[1,0,0]
v_pk_fma_f32 v[78:79], v[78:79], v[22:23], v[106:107] op_sel:[0,0,0] op_sel_hi:[1,0,0] neg_lo:[0,0,1] neg_hi:[0,0,1]
v_exp_f32 v230, v230
v_exp_f32 v78, v78
v_exp_f32 v231, v231
v_exp_f32 v79, v79
v_pk_fma_f32 v[232:233], v[80:81], v[22:23], v[110:111] op_sel:[0,0,0] op_sel_hi:[1,0,0] neg_lo:[1,0,0] neg_hi:[1,0,0]
v_pk_fma_f32 v[80:81], v[80:81], v[22:23], v[106:107] op_sel:[0,0,0] op_sel_hi:[1,0,0] neg_lo:[0,0,1] neg_hi:[0,0,1]
v_exp_f32 v232, v232
v_exp_f32 v80, v80
v_exp_f32 v233, v233
v_exp_f32 v81, v81
v_pk_fma_f32 v[234:235], v[82:83], v[22:23], v[110:111] op_sel:[0,0,0] op_sel_hi:[1,0,0] neg_lo:[1,0,0] neg_hi:[1,0,0]
v_pk_fma_f32 v[82:83], v[82:83], v[22:23], v[106:107] op_sel:[0,0,0] op_sel_hi:[1,0,0] neg_lo:[0,0,1] neg_hi:[0,0,1]
v_exp_f32 v234, v234
v_exp_f32 v82, v82
v_exp_f32 v235, v235
v_exp_f32 v83, v83
v_pk_fma_f32 v[236:237], v[84:85], v[22:23], v[110:111] op_sel:[0,1,1] op_sel_hi:[1,1,1] neg_lo:[1,0,0] neg_hi:[1,0,0]
v_pk_fma_f32 v[84:85], v[84:85], v[22:23], v[106:107] op_sel:[0,1,1] op_sel_hi:[1,1,1] neg_lo:[0,0,1] neg_hi:[0,0,1]
v_exp_f32 v236, v236
v_exp_f32 v84, v84
v_exp_f32 v237, v237
v_exp_f32 v85, v85
v_pk_fma_f32 v[238:239], v[86:87], v[22:23], v[110:111] op_sel:[0,1,1] op_sel_hi:[1,1,1] neg_lo:[1,0,0] neg_hi:[1,0,0]
v_pk_fma_f32 v[86:87], v[86:87], v[22:23], v[106:107] op_sel:[0,1,1] op_sel_hi:[1,1,1] neg_lo:[0,0,1] neg_hi:[0,0,1]
v_exp_f32 v238, v238
v_exp_f32 v86, v86
v_exp_f32 v239, v239
v_exp_f32 v87, v87
v_pk_fma_f32 v[240:241], v[88:89], v[22:23], v[110:111] op_sel:[0,1,1] op_sel_hi:[1,1,1] neg_lo:[1,0,0] neg_hi:[1,0,0]
v_pk_fma_f32 v[88:89], v[88:89], v[22:23], v[106:107] op_sel:[0,1,1] op_sel_hi:[1,1,1] neg_lo:[0,0,1] neg_hi:[0,0,1]
v_exp_f32 v240, v240
v_exp_f32 v88, v88
v_exp_f32 v241, v241
v_exp_f32 v89, v89
v_pk_fma_f32 v[242:243], v[90:91], v[22:23], v[110:111] op_sel:[0,1,1] op_sel_hi:[1,1,1] neg_lo:[1,0,0] neg_hi:[1,0,0]
v_pk_fma_f32 v[90:91], v[90:91], v[22:23], v[106:107] op_sel:[0,1,1] op_sel_hi:[1,1,1] neg_lo:[0,0,1] neg_hi:[0,0,1]
v_exp_f32 v242, v242
v_exp_f32 v90, v90
v_exp_f32 v243, v243
v_exp_f32 v91, v91
s_nop 0
v_pk_add_f32 v[112:113], v[60:61], v[62:63]
v_pk_add_f32 v[114:115], v[212:213], v[214:215]
v_pk_add_f32 v[112:113], v[112:113], v[64:65]
v_pk_add_f32 v[114:115], v[114:115], v[216:217]
v_pk_add_f32 v[112:113], v[112:113], v[66:67]
v_pk_add_f32 v[114:115], v[114:115], v[218:219]
v_add_f32 v104, v112, v113
v_add_f32 v108, v114, v115
v_pk_add_f32 v[112:113], v[68:69], v[70:71]
v_pk_add_f32 v[114:115], v[220:221], v[222:223]
v_pk_add_f32 v[112:113], v[112:113], v[72:73]
v_pk_add_f32 v[114:115], v[114:115], v[224:225]
v_pk_add_f32 v[112:113], v[112:113], v[74:75]
v_pk_add_f32 v[114:115], v[114:115], v[226:227]
v_add_f32 v105, v112, v113
v_add_f32 v109, v114, v115
v_pk_add_f32 v[112:113], v[76:77], v[78:79]
v_pk_add_f32 v[114:115], v[228:229], v[230:231]
v_pk_add_f32 v[112:113], v[112:113], v[80:81]
v_pk_add_f32 v[114:115], v[114:115], v[232:233]
v_pk_add_f32 v[112:113], v[112:113], v[82:83]
v_pk_add_f32 v[114:115], v[114:115], v[234:235]
v_add_f32 v106, v112, v113
v_add_f32 v110, v114, v115
v_pk_add_f32 v[112:113], v[84:85], v[86:87]
v_pk_add_f32 v[114:115], v[236:237], v[238:239]
v_pk_add_f32 v[112:113], v[112:113], v[88:89]
v_pk_add_f32 v[114:115], v[114:115], v[240:241]
v_pk_add_f32 v[112:113], v[112:113], v[90:91]
v_pk_add_f32 v[114:115], v[114:115], v[242:243]
v_add_f32 v107, v112, v113
v_add_f32 v111, v114, v115
s_nop 1
v_permlane32_swap_b32 v104, v105
v_permlane32_swap_b32 v106, v107
v_permlane32_swap_b32 v108, v109
v_permlane32_swap_b32 v110, v111
v_add_f32 v104, v104, v105
v_add_f32 v106, v106, v107
v_add_f32 v108, v108, v109
v_add_f32 v110, v110, v111
v_permlane16_swap_b32 v104, v106
s_nop 0
v_permlane16_swap_b32 v108, v110
v_add_f32 v104, v104, v106
v_add_f32 v108, v108, v110
v_rcp_f32 v104, v104
v_rcp_f32 v108, v108
s_nop 0
v_mov_b32 v106, v104
v_mov_b32 v110, v108
s_nop 0
v_permlane16_swap_b32 v104, v106
v_permlane16_swap_b32 v108, v110
v_mov_b32 v105, v104
v_mov_b32 v107, v106
v_mov_b32 v109, v108
v_mov_b32 v111, v110
v_permlane32_swap_b32 v104, v105
v_permlane32_swap_b32 v106, v107
v_permlane32_swap_b32 v108, v109
v_permlane32_swap_b32 v110, v111
.p2align 3
v_pk_mul_f32 v[60:61], v[60:61], v[104:105] op_sel:[0,0] op_sel_hi:[1,0]
v_pk_mul_f32 v[62:63], v[62:63], v[104:105] op_sel:[0,0] op_sel_hi:[1,0]
v_pk_mul_f32 v[64:65], v[64:65], v[104:105] op_sel:[0,0] op_sel_hi:[1,0]
v_pk_mul_f32 v[66:67], v[66:67], v[104:105] op_sel:[0,0] op_sel_hi:[1,0]
v_pk_mul_f32 v[212:213], v[212:213], v[108:109] op_sel:[0,0] op_sel_hi:[1,0]
v_pk_mul_f32 v[214:215], v[214:215], v[108:109] op_sel:[0,0] op_sel_hi:[1,0]
v_pk_mul_f32 v[216:217], v[216:217], v[108:109] op_sel:[0,0] op_sel_hi:[1,0]
v_pk_mul_f32 v[218:219], v[218:219], v[108:109] op_sel:[0,0] op_sel_hi:[1,0]
v_cvt_pk_bf16_f32 v60, v60, v61
v_cvt_pk_bf16_f32 v61, v62, v63
v_cvt_pk_bf16_f32 v62, v64, v65
v_cvt_pk_bf16_f32 v63, v66, v67
v_cvt_pk_bf16_f32 v212, v212, v213
v_cvt_pk_bf16_f32 v213, v214, v215
v_cvt_pk_bf16_f32 v214, v216, v217
v_cvt_pk_bf16_f32 v215, v218, v219
v_pk_mul_f32 v[68:69], v[68:69], v[104:105] op_sel:[0,1] op_sel_hi:[1,1]
v_pk_mul_f32 v[70:71], v[70:71], v[104:105] op_sel:[0,1] op_sel_hi:[1,1]
v_pk_mul_f32 v[72:73], v[72:73], v[104:105] op_sel:[0,1] op_sel_hi:[1,1]
v_pk_mul_f32 v[74:75], v[74:75], v[104:105] op_sel:[0,1] op_sel_hi:[1,1]
v_pk_mul_f32 v[220:221], v[220:221], v[108:109] op_sel:[0,1] op_sel_hi:[1,1]
v_pk_mul_f32 v[222:223], v[222:223], v[108:109] op_sel:[0,1] op_sel_hi:[1,1]
v_pk_mul_f32 v[224:225], v[224:225], v[108:109] op_sel:[0,1] op_sel_hi:[1,1]
v_pk_mul_f32 v[226:227], v[226:227], v[108:109] op_sel:[0,1] op_sel_hi:[1,1]
v_cvt_pk_bf16_f32 v68, v68, v69
v_cvt_pk_bf16_f32 v69, v70, v71
v_cvt_pk_bf16_f32 v70, v72, v73
v_cvt_pk_bf16_f32 v71, v74, v75
v_cvt_pk_bf16_f32 v220, v220, v221
v_cvt_pk_bf16_f32 v221, v222, v223
v_cvt_pk_bf16_f32 v222, v224, v225
v_cvt_pk_bf16_f32 v223, v226, v227
v_pk_mul_f32 v[76:77], v[76:77], v[106:107] op_sel:[0,0] op_sel_hi:[1,0]
v_pk_mul_f32 v[78:79], v[78:79], v[106:107] op_sel:[0,0] op_sel_hi:[1,0]
v_pk_mul_f32 v[80:81], v[80:81], v[106:107] op_sel:[0,0] op_sel_hi:[1,0]
v_pk_mul_f32 v[82:83], v[82:83], v[106:107] op_sel:[0,0] op_sel_hi:[1,0]
v_pk_mul_f32 v[228:229], v[228:229], v[110:111] op_sel:[0,0] op_sel_hi:[1,0]
v_pk_mul_f32 v[230:231], v[230:231], v[110:111] op_sel:[0,0] op_sel_hi:[1,0]
v_pk_mul_f32 v[232:233], v[232:233], v[110:111] op_sel:[0,0] op_sel_hi:[1,0]
v_pk_mul_f32 v[234:235], v[234:235], v[110:111] op_sel:[0,0] op_sel_hi:[1,0]
v_cvt_pk_bf16_f32 v76, v76, v77
v_cvt_pk_bf16_f32 v77, v78, v79
v_cvt_pk_bf16_f32 v78, v80, v81
v_cvt_pk_bf16_f32 v79, v82, v83
v_cvt_pk_bf16_f32 v228, v228, v229
v_cvt_pk_bf16_f32 v229, v230, v231
v_cvt_pk_bf16_f32 v230, v232, v233
v_cvt_pk_bf16_f32 v231, v234, v235
v_pk_mul_f32 v[84:85], v[84:85], v[106:107] op_sel:[0,1] op_sel_hi:[1,1]
v_pk_mul_f32 v[86:87], v[86:87], v[106:107] op_sel:[0,1] op_sel_hi:[1,1]
v_pk_mul_f32 v[88:89], v[88:89], v[106:107] op_sel:[0,1] op_sel_hi:[1,1]
v_pk_mul_f32 v[90:91], v[90:91], v[106:107] op_sel:[0,1] op_sel_hi:[1,1]
v_pk_mul_f32 v[236:237], v[236:237], v[110:111] op_sel:[0,1] op_sel_hi:[1,1]
v_pk_mul_f32 v[238:239], v[238:239], v[110:111] op_sel:[0,1] op_sel_hi:[1,1]
v_pk_mul_f32 v[240:241], v[240:241], v[110:111] op_sel:[0,1] op_sel_hi:[1,1]
v_pk_mul_f32 v[242:243], v[242:243], v[110:111] op_sel:[0,1] op_sel_hi:[1,1]
v_cvt_pk_bf16_f32 v84, v84, v85
v_cvt_pk_bf16_f32 v85, v86, v87
v_cvt_pk_bf16_f32 v86, v88, v89
v_cvt_pk_bf16_f32 v87, v90, v91
v_cvt_pk_bf16_f32 v236, v236, v237
v_cvt_pk_bf16_f32 v237, v238, v239
v_cvt_pk_bf16_f32 v238, v240, v241
v_cvt_pk_bf16_f32 v239, v242, v243
v_and_b32 v4, 31, v0
v_lshlrev_b32 v4, 2, v4
buffer_load_dword v5, v4, s[32:35], s56 offen sc1
s_lshl_b32 s48, s41, 11
s_add_u32 s48, s48, s54
s_lshl_b32 s57, s45, 12
s_lshl_b32 s49, s44, 11
s_add_u32 s57, s57, s49
s_add_u32 s57, s57, 19267584
s_xor_b32 s58, s57, 2048
s_lshl_b32 s49, s41, 7
s_add_u32 s49, s49, s57
s_xor_b32 s59, s55, 1024
v_lshlrev_b32 v6, 4, v2
v_lshl_add_u32 v6, v3, 3, v6
s_mov_b32 s63, 0
s_waitcnt vmcnt(0)
poll_82:
v_cmp_gt_u32 vcc, 2, v5
s_cbranch_vccz polled_83
buffer_load_dword v5, v4, s[32:35], s56 offen sc1
s_add_u32 s63, s63, 1
s_cmp_lt_u32 s63, 0x80000
s_waitcnt vmcnt(0)
s_cbranch_scc1 poll_82
polled_83:
buffer_load_dwordx4 v[180:183], v18, s[32:35], s48 offen offset:0 sc1
buffer_load_dwordx4 v[184:187], v18, s[32:35], s48 offen offset:1024 sc1
buffer_load_dwordx4 v[196:199], v7, s[32:35], s55 offen sc1
buffer_load_dwordx4 v[200:203], v7, s[32:35], s59 offen sc1
s_waitcnt vmcnt(3)
v_mfma_f32_16x16x32_bf16 v[92:95], v[24:27], v[180:183], 0
s_waitcnt vmcnt(2)
v_mfma_f32_16x16x32_bf16 v[92:95], v[24:27], v[184:187], v[92:95]
s_nop 7
v_add_f32_dpp v92, v92, v92 row_ror:8 row_mask:0xf bank_mask:0xf
v_add_f32_dpp v93, v93, v93 row_ror:8 row_mask:0xf bank_mask:0xf
v_add_f32_dpp v94, v94, v94 row_ror:8 row_mask:0xf bank_mask:0xf
v_add_f32_dpp v95, v95, v95 row_ror:8 row_mask:0xf bank_mask:0xf
v_cvt_pk_bf16_f32 v92, v92, v93
v_cvt_pk_bf16_f32 v93, v94, v95
v_min_u32 v92, -2, v92
v_min_u32 v93, -2, v93
s_mov_b64 exec, 0x00ff00ff
buffer_store_dwordx2 v[92:93], v6, s[32:35], s49 offen sc1
s_mov_b64 exec, -1
s_waitcnt vmcnt(1)
v_mfma_f32_16x16x32_bf16 v[132:135], v[196:199], v[60:63], 0
v_mfma_f32_16x16x32_bf16 v[136:139], v[196:199], v[68:71], 0
v_mfma_f32_16x16x32_bf16 v[140:143], v[196:199], v[76:79], 0
v_mfma_f32_16x16x32_bf16 v[144:147], v[196:199], v[84:87], 0
v_mfma_f32_16x16x32_bf16 v[132:135], v[200:203], v[212:215], v[132:135]
v_mfma_f32_16x16x32_bf16 v[136:139], v[200:203], v[220:223], v[136:139]
v_mfma_f32_16x16x32_bf16 v[140:143], v[200:203], v[228:231], v[140:143]
v_mfma_f32_16x16x32_bf16 v[144:147], v[200:203], v[236:239], v[144:147]
s_nop 4
v_add_f32 v104, v132, v133
v_add_f32 v134, v134, v135
v_add_f32 v104, v104, v134
v_add_f32 v105, v136, v137
v_add_f32 v138, v138, v139
v_add_f32 v105, v105, v138
v_add_f32 v106, v140, v141
v_add_f32 v142, v142, v143
v_add_f32 v106, v106, v142
v_add_f32 v107, v144, v145
v_add_f32 v146, v146, v147
v_add_f32 v107, v107, v146
s_nop 1
v_permlane32_swap_b32 v104, v105
v_permlane32_swap_b32 v106, v107
s_nop 0
v_add_f32 v104, v104, v105
v_add_f32 v106, v106, v107
s_nop 1
v_permlane16_swap_b32 v104, v106
s_nop 0
v_add_f32 v104, v104, v106
v_add_f32 v104, 0x358637bd, v104
v_rcp_f32 v104, v104
s_nop 0
v_mov_b32 v106, v104
s_nop 1
v_permlane16_swap_b32 v104, v106
s_nop 0
v_mov_b32 v105, v104
v_mov_b32 v107, v106
s_nop 1
v_permlane32_swap_b32 v104, v105
v_permlane32_swap_b32 v106, v107
s_nop 0
s_mov_b32 s63, 0
kvr_84:
buffer_load_dwordx4 v[180:183], v18, s[32:35], s57 offen offset:0 sc1
buffer_load_dwordx4 v[184:187], v18, s[32:35], s57 offen offset:1024 sc1
buffer_load_dwordx4 v[188:191], v18, s[32:35], s58 offen offset:0 sc1
buffer_load_dwordx4 v[192:195], v18, s[32:35], s58 offen offset:1024 sc1
s_add_u32 s63, s63, 1
s_cmp_lt_u32 s63, 0x80000
s_waitcnt vmcnt(2)
v_max3_u32 v4, v180, v181, v182
v_max3_u32 v5, v183, v184, v185
v_max3_u32 v4, v4, v186, v187
s_waitcnt vmcnt(0)
v_max3_u32 v5, v5, v188, v189
v_max3_u32 v4, v4, v190, v191
v_max3_u32 v5, v5, v192, v193
v_max3_u32 v4, v4, v194, v195
v_max_u32 v4, v4, v5
v_cmp_eq_u32 vcc, -1, v4
s_cbranch_vccz kvrd_85
s_cbranch_scc1 kvr_84
kvrd_85:
v_mfma_f32_16x16x32_bf16 v[148:151], v[180:183], v[60:63], 0
v_mfma_f32_16x16x32_bf16 v[152:155], v[184:187], v[60:63], 0
v_mfma_f32_16x16x32_bf16 v[148:151], v[188:191], v[212:215], v[148:151]
v_mfma_f32_16x16x32_bf16 v[152:155], v[192:195], v[212:215], v[152:155]
v_mfma_f32_16x16x32_bf16 v[156:159], v[180:183], v[68:71], 0
v_mfma_f32_16x16x32_bf16 v[160:163], v[184:187], v[68:71], 0
v_mfma_f32_16x16x32_bf16 v[156:159], v[188:191], v[220:223], v[156:159]
v_mfma_f32_16x16x32_bf16 v[160:163], v[192:195], v[220:223], v[160:163]
v_mfma_f32_16x16x32_bf16 v[164:167], v[180:183], v[76:79], 0
v_mfma_f32_16x16x32_bf16 v[168:171], v[184:187], v[76:79], 0
v_mfma_f32_16x16x32_bf16 v[164:167], v[188:191], v[228:231], v[164:167]
v_mfma_f32_16x16x32_bf16 v[168:171], v[192:195], v[228:231], v[168:171]
v_mfma_f32_16x16x32_bf16 v[172:175], v[180:183], v[84:87], 0
v_mfma_f32_16x16x32_bf16 v[176:179], v[184:187], v[84:87], 0
v_mfma_f32_16x16x32_bf16 v[172:175], v[188:191], v[236:239], v[172:175]
v_mfma_f32_16x16x32_bf16 v[176:179], v[192:195], v[236:239], v[176:179]
s_cmp_eq_u32 s46, 0
s_cbranch_scc1 slow_86
.p2align 3
v_pk_mul_f32 v[148:149], v[148:149], v[104:105] op_sel:[0,0] op_sel_hi:[1,0]
v_pk_mul_f32 v[150:151], v[150:151], v[104:105] op_sel:[0,0] op_sel_hi:[1,0]
v_pk_mul_f32 v[152:153], v[152:153], v[104:105] op_sel:[0,0] op_sel_hi:[1,0]
v_pk_mul_f32 v[154:155], v[154:155], v[104:105] op_sel:[0,0] op_sel_hi:[1,0]
v_cvt_pk_bf16_f32 v148, v148, v149
v_cvt_pk_bf16_f32 v149, v150, v151
v_cvt_pk_bf16_f32 v150, v152, v153
v_cvt_pk_bf16_f32 v151, v154, v155
buffer_store_dwordx4 v[148:151], v18, s[32:35], s80 offen
v_pk_mul_f32 v[156:157], v[156:157], v[104:105] op_sel:[0,1] op_sel_hi:[1,1]
v_pk_mul_f32 v[158:159], v[158:159], v[104:105] op_sel:[0,1] op_sel_hi:[1,1]
v_pk_mul_f32 v[160:161], v[160:161], v[104:105] op_sel:[0,1] op_sel_hi:[1,1]
v_pk_mul_f32 v[162:163], v[162:163], v[104:105] op_sel:[0,1] op_sel_hi:[1,1]
v_cvt_pk_bf16_f32 v156, v156, v157
v_cvt_pk_bf16_f32 v157, v158, v159
v_cvt_pk_bf16_f32 v158, v160, v161
v_cvt_pk_bf16_f32 v159, v162, v163
buffer_store_dwordx4 v[156:159], v18, s[32:35], s81 offen
v_pk_mul_f32 v[164:165], v[164:165], v[106:107] op_sel:[0,0] op_sel_hi:[1,0]
v_pk_mul_f32 v[166:167], v[166:167], v[106:107] op_sel:[0,0] op_sel_hi:[1,0]
v_pk_mul_f32 v[168:169], v[168:169], v[106:107] op_sel:[0,0] op_sel_hi:[1,0]
v_pk_mul_f32 v[170:171], v[170:171], v[106:107] op_sel:[0,0] op_sel_hi:[1,0]
v_cvt_pk_bf16_f32 v164, v164, v165
v_cvt_pk_bf16_f32 v165, v166, v167
v_cvt_pk_bf16_f32 v166, v168, v169
v_cvt_pk_bf16_f32 v167, v170, v171
buffer_store_dwordx4 v[164:167], v18, s[32:35], s82 offen
v_pk_mul_f32 v[172:173], v[172:173], v[106:107] op_sel:[0,1] op_sel_hi:[1,1]
v_pk_mul_f32 v[174:175], v[174:175], v[106:107] op_sel:[0,1] op_sel_hi:[1,1]
v_pk_mul_f32 v[176:177], v[176:177], v[106:107] op_sel:[0,1] op_sel_hi:[1,1]
v_pk_mul_f32 v[178:179], v[178:179], v[106:107] op_sel:[0,1] op_sel_hi:[1,1]
v_cvt_pk_bf16_f32 v172, v172, v173
v_cvt_pk_bf16_f32 v173, v174, v175
v_cvt_pk_bf16_f32 v174, v176, v177
v_cvt_pk_bf16_f32 v175, v178, v179
buffer_store_dwordx4 v[172:175], v18, s[32:35], s83 offen
s_barrier
s_lshl_b32 s62, s45, 2
v_mov_b32 v4, s62
v_mov_b32 v5, 4
s_mov_b64 exec, 1
s_waitcnt vmcnt(0)
buffer_store_dword v5, v4, s[32:35], s84 offen
s_mov_b64 exec, -1
back_87:
buffer_load_dwordx4 v[88:91], v18, s[32:35], s85 offen offset:0 sc1
buffer_load_dwordx4 v[92:95], v18, s[32:35], s85 offen offset:1024 sc1
buffer_load_dwordx4 v[96:99], v18, s[32:35], s86 offen offset:0 sc1
buffer_load_dwordx4 v[100:103], v18, s[32:35], s86 offen offset:1024 sc1
v_and_b32 v10, 31, v0
v_lshlrev_b32 v10, 2, v10
buffer_load_dword v11, v10, s[32:35], s84 offen sc1
v_lshrrev_b32 v4, 2, v2
v_and_b32 v5, 3, v0
v_lshl_add_u32 v6, v3, 3, v4
v_lshlrev_b32 v6, 7, v6
v_lshl_add_u32 v6, v5, 3, v6
v_lshrrev_b32 v7, 1, v4
v_and_b32 v8, 1, v3
v_lshl_add_u32 v7, v8, 1, v7
v_lshl_add_u32 v14, v7, 5, v6
v_xor_b32 v15, 32, v14
v_xor_b32 v16, 64, v14
v_xor_b32 v17, 96, v14
v_add_u32 v52, 0x10000, v14
v_add_u32 v53, 0x10000, v15
v_add_u32 v54, 0x10000, v16
v_add_u32 v55, 0x10000, v17
ds_read_b64_tr_b16 v[212:213], v14 offset:0
ds_read_b64_tr_b16 v[214:215], v14 offset:512
ds_read_b64_tr_b16 v[216:217], v15 offset:0
ds_read_b64_tr_b16 v[218:219], v15 offset:512
ds_read_b64_tr_b16 v[220:221], v16 offset:0
ds_read_b64_tr_b16 v[222:223], v16 offset:512
ds_read_b64_tr_b16 v[224:225], v17 offset:0
ds_read_b64_tr_b16 v[226:227], v17 offset:512
ds_read_b64_tr_b16 v[228:229], v14 offset:4096
ds_read_b64_tr_b16 v[230:231], v14 offset:4608
ds_read_b64_tr_b16 v[232:233], v15 offset:4096
ds_read_b64_tr_b16 v[234:235], v15 offset:4608
ds_read_b64_tr_b16 v[236:237], v16 offset:4096
ds_read_b64_tr_b16 v[238:239], v16 offset:4608
ds_read_b64_tr_b16 v[240:241], v17 offset:4096
ds_read_b64_tr_b16 v[242:243], v17 offset:4608
s_lshl_b32 s48, s41, 3
s_lshl_b32 s49, s40, 1
s_add_u32 s56, s48, s49
s_lshl_b32 s48, s56, 15
s_add_u32 s48, s48, 4194304
v_add_u32 v12, s48, v18
v_add_u32 v13, 32768, v12
s_lshl_b32 s57, s47, 11
s_mov_b32 s63, 0
s_waitcnt vmcnt(0)
poll_88:
v_cmp_gt_u32 vcc, 4, v11
s_cbranch_vccz polled_89
buffer_load_dword v11, v10, s[32:35], s84 offen sc1
s_add_u32 s63, s63, 1
s_cmp_lt_u32 s63, 0x80000
s_waitcnt vmcnt(0)
s_cbranch_scc1 poll_88
polled_89:
buffer_load_dwordx4 v[148:151], v12, s[32:35], s57 offen sc1
buffer_load_dwordx4 v[152:155], v13, s[32:35], s57 offen sc1
buffer_load_dwordx4 v[156:159], v12, s[32:35], s57 offen offset:1024 sc1
buffer_load_dwordx4 v[160:163], v13, s[32:35], s57 offen offset:1024 sc1
s_add_u32 s57, s57, 2048
s_and_b32 s57, s57, 0x7fff
buffer_load_dwordx4 v[164:167], v12, s[32:35], s57 offen sc1
buffer_load_dwordx4 v[168:171], v13, s[32:35], s57 offen sc1
buffer_load_dwordx4 v[172:175], v12, s[32:35], s57 offen offset:1024 sc1
buffer_load_dwordx4 v[176:179], v13, s[32:35], s57 offen offset:1024 sc1
s_add_u32 s57, s57, 2048
s_and_b32 s57, s57, 0x7fff
buffer_load_dwordx4 v[180:183], v12, s[32:35], s57 offen sc1
buffer_load_dwordx4 v[184:187], v13, s[32:35], s57 offen sc1
buffer_load_dwordx4 v[188:191], v12, s[32:35], s57 offen offset:1024 sc1
buffer_load_dwordx4 v[192:195], v13, s[32:35], s57 offen offset:1024 sc1
s_add_u32 s57, s57, 2048
s_and_b32 s57, s57, 0x7fff
v_lshlrev_b32 v20, 16, v88
v_and_b32 v21, 0xffff0000, v88
v_lshlrev_b32 v22, 16, v89
v_and_b32 v23, 0xffff0000, v89
v_lshlrev_b32 v24, 16, v90
v_and_b32 v25, 0xffff0000, v90
v_lshlrev_b32 v26, 16, v91
v_and_b32 v27, 0xffff0000, v91
v_lshlrev_b32 v28, 16, v92
v_and_b32 v29, 0xffff0000, v92
v_lshlrev_b32 v30, 16, v93
v_and_b32 v31, 0xffff0000, v93
v_lshlrev_b32 v32, 16, v94
v_and_b32 v33, 0xffff0000, v94
v_lshlrev_b32 v34, 16, v95
v_and_b32 v35, 0xffff0000, v95
v_lshlrev_b32 v36, 16, v96
v_and_b32 v37, 0xffff0000, v96
v_lshlrev_b32 v38, 16, v97
v_and_b32 v39, 0xffff0000, v97
v_lshlrev_b32 v40, 16, v98
v_and_b32 v41, 0xffff0000, v98
v_lshlrev_b32 v42, 16, v99
v_and_b32 v43, 0xffff0000, v99
v_lshlrev_b32 v44, 16, v100
v_and_b32 v45, 0xffff0000, v100
v_lshlrev_b32 v46, 16, v101
v_and_b32 v47, 0xffff0000, v101
v_lshlrev_b32 v48, 16, v102
v_and_b32 v49, 0xffff0000, v102
v_lshlrev_b32 v50, 16, v103
v_and_b32 v51, 0xffff0000, v103
s_mov_b32 s24, s18
s_and_b32 s25, s19, 0xffff
s_mov_b32 s26, 4194304
s_mov_b32 s27, 0x00020000
s_mov_b32 s48, s56
s_lshl_b32 s49, s48, 4
v_add_u32 v4, s49, v2
v_lshlrev_b32 v4, 11, v4
v_and_b32 v5, 1, v3
v_lshl_add_u32 v4, v5, 5, v4
v_lshrrev_b32 v5, 1, v3
v_lshl_add_u32 v4, v5, 4, v4
s_lshl_b32 s49, s42, 7
v_add_u32 v10, s49, v4
v_add_u32 v11, 32768, v10
s_waitcnt vmcnt(10) lgkmcnt(8)
v_mfma_f32_16x16x32_bf16 v[20:23], v[212:215], v[148:151], v[20:23]
ds_read_b64_tr_b16 v[104:105], v14 offset:8192
ds_read_b64_tr_b16 v[106:107], v14 offset:8704
v_mfma_f32_16x16x32_bf16 v[36:39], v[212:215], v[152:155], v[36:39]
buffer_load_dwordx4 v[196:199], v12, s[32:35], s57 offen sc1
v_mfma_f32_16x16x32_bf16 v[24:27], v[216:219], v[148:151], v[24:27]
ds_read_b64_tr_b16 v[108:109], v15 offset:8192
v_mfma_f32_16x16x32_bf16 v[40:43], v[216:219], v[152:155], v[40:43]
ds_read_b64_tr_b16 v[110:111], v15 offset:8704
v_mfma_f32_16x16x32_bf16 v[28:31], v[220:223], v[148:151], v[28:31]
ds_read_b64_tr_b16 v[112:113], v16 offset:8192
buffer_load_dwordx4 v[200:203], v13, s[32:35], s57 offen sc1
v_mfma_f32_16x16x32_bf16 v[44:47], v[220:223], v[152:155], v[44:47]
ds_read_b64_tr_b16 v[114:115], v16 offset:8704
v_mfma_f32_16x16x32_bf16 v[32:35], v[224:227], v[148:151], v[32:35]
ds_read_b64_tr_b16 v[116:117], v17 offset:8192
v_mfma_f32_16x16x32_bf16 v[48:51], v[224:227], v[152:155], v[48:51]
ds_read_b64_tr_b16 v[118:119], v17 offset:8704
s_waitcnt vmcnt(10) lgkmcnt(8)
v_mfma_f32_16x16x32_bf16 v[20:23], v[228:231], v[156:159], v[20:23]
ds_read_b64_tr_b16 v[212:213], v14 offset:12288
ds_read_b64_tr_b16 v[214:215], v14 offset:12800
v_mfma_f32_16x16x32_bf16 v[36:39], v[228:231], v[160:163], v[36:39]
buffer_load_dwordx4 v[204:207], v12, s[32:35], s57 offen offset:1024 sc1
v_mfma_f32_16x16x32_bf16 v[24:27], v[232:235], v[156:159], v[24:27]
ds_read_b64_tr_b16 v[216:217], v15 offset:12288
v_mfma_f32_16x16x32_bf16 v[40:43], v[232:235], v[160:163], v[40:43]
ds_read_b64_tr_b16 v[218:219], v15 offset:12800
v_mfma_f32_16x16x32_bf16 v[28:31], v[236:239], v[156:159], v[28:31]
ds_read_b64_tr_b16 v[220:221], v16 offset:12288
buffer_load_dwordx4 v[208:211], v13, s[32:35], s57 offen offset:1024 sc1
s_add_u32 s57, s57, 2048
s_and_b32 s57, s57, 0x7fff
v_mfma_f32_16x16x32_bf16 v[44:47], v[236:239], v[160:163], v[44:47]
ds_read_b64_tr_b16 v[222:223], v16 offset:12800
v_mfma_f32_16x16x32_bf16 v[32:35], v[240:243], v[156:159], v[32:35]
ds_read_b64_tr_b16 v[224:225], v17 offset:12288
v_mfma_f32_16x16x32_bf16 v[48:51], v[240:243], v[160:163], v[48:51]
ds_read_b64_tr_b16 v[226:227], v17 offset:12800
s_waitcnt vmcnt(10) lgkmcnt(8)
v_mfma_f32_16x16x32_bf16 v[20:23], v[104:107], v[164:167], v[20:23]
ds_read_b64_tr_b16 v[228:229], v14 offset:16384
ds_read_b64_tr_b16 v[230:231], v14 offset:16896
v_mfma_f32_16x16x32_bf16 v[36:39], v[104:107], v[168:171], v[36:39]
buffer_load_dwordx4 v[148:151], v12, s[32:35], s57 offen sc1
v_mfma_f32_16x16x32_bf16 v[24:27], v[108:111], v[164:167], v[24:27]
ds_read_b64_tr_b16 v[232:233], v15 offset:16384
v_mfma_f32_16x16x32_bf16 v[40:43], v[108:111], v[168:171], v[40:43]
ds_read_b64_tr_b16 v[234:235], v15 offset:16896
v_mfma_f32_16x16x32_bf16 v[28:31], v[112:115], v[164:167], v[28:31]
ds_read_b64_tr_b16 v[236:237], v16 offset:16384
buffer_load_dwordx4 v[152:155], v13, s[32:35], s57 offen sc1
v_mfma_f32_16x16x32_bf16 v[44:47], v[112:115], v[168:171], v[44:47]
ds_read_b64_tr_b16 v[238:239], v16 offset:16896
v_mfma_f32_16x16x32_bf16 v[32:35], v[116:119], v[164:167], v[32:35]
ds_read_b64_tr_b16 v[240:241], v17 offset:16384
v_mfma_f32_16x16x32_bf16 v[48:51], v[116:119], v[168:171], v[48:51]
ds_read_b64_tr_b16 v[242:243], v17 offset:16896
s_waitcnt vmcnt(10) lgkmcnt(8)
v_mfma_f32_16x16x32_bf16 v[20:23], v[212:215], v[172:175], v[20:23]
ds_read_b64_tr_b16 v[104:105], v14 offset:20480
ds_read_b64_tr_b16 v[106:107], v14 offset:20992
v_mfma_f32_16x16x32_bf16 v[36:39], v[212:215], v[176:179], v[36:39]
buffer_load_dwordx4 v[156:159], v12, s[32:35], s57 offen offset:1024 sc1
v_mfma_f32_16x16x32_bf16 v[24:27], v[216:219], v[172:175], v[24:27]
ds_read_b64_tr_b16 v[108:109], v15 offset:20480
v_mfma_f32_16x16x32_bf16 v[40:43], v[216:219], v[176:179], v[40:43]
ds_read_b64_tr_b16 v[110:111], v15 offset:20992
v_mfma_f32_16x16x32_bf16 v[28:31], v[220:223], v[172:175], v[28:31]
ds_read_b64_tr_b16 v[112:113], v16 offset:20480
buffer_load_dwordx4 v[160:163], v13, s[32:35], s57 offen offset:1024 sc1
s_add_u32 s57, s57, 2048
s_and_b32 s57, s57, 0x7fff
v_mfma_f32_16x16x32_bf16 v[44:47], v[220:223], v[176:179], v[44:47]
ds_read_b64_tr_b16 v[114:115], v16 offset:20992
v_mfma_f32_16x16x32_bf16 v[32:35], v[224:227], v[172:175], v[32:35]
ds_read_b64_tr_b16 v[116:117], v17 offset:20480
v_mfma_f32_16x16x32_bf16 v[48:51], v[224:227], v[176:179], v[48:51]
ds_read_b64_tr_b16 v[118:119], v17 offset:20992
s_waitcnt vmcnt(10) lgkmcnt(8)
v_mfma_f32_16x16x32_bf16 v[20:23], v[228:231], v[180:183], v[20:23]
ds_read_b64_tr_b16 v[212:213], v14 offset:24576
ds_read_b64_tr_b16 v[214:215], v14 offset:25088
v_mfma_f32_16x16x32_bf16 v[36:39], v[228:231], v[184:187], v[36:39]
buffer_load_dwordx4 v[164:167], v12, s[32:35], s57 offen sc1
v_mfma_f32_16x16x32_bf16 v[24:27], v[232:235], v[180:183], v[24:27]
ds_read_b64_tr_b16 v[216:217], v15 offset:24576
v_mfma_f32_16x16x32_bf16 v[40:43], v[232:235], v[184:187], v[40:43]
ds_read_b64_tr_b16 v[218:219], v15 offset:25088
v_mfma_f32_16x16x32_bf16 v[28:31], v[236:239], v[180:183], v[28:31]
ds_read_b64_tr_b16 v[220:221], v16 offset:24576
buffer_load_dwordx4 v[168:171], v13, s[32:35], s57 offen sc1
v_mfma_f32_16x16x32_bf16 v[44:47], v[236:239], v[184:187], v[44:47]
ds_read_b64_tr_b16 v[222:223], v16 offset:25088
v_mfma_f32_16x16x32_bf16 v[32:35], v[240:243], v[180:183], v[32:35]
ds_read_b64_tr_b16 v[224:225], v17 offset:24576
v_mfma_f32_16x16x32_bf16 v[48:51], v[240:243], v[184:187], v[48:51]
ds_read_b64_tr_b16 v[226:227], v17 offset:25088
s_waitcnt vmcnt(10) lgkmcnt(8)
v_mfma_f32_16x16x32_bf16 v[20:23], v[104:107], v[188:191], v[20:23]
ds_read_b64_tr_b16 v[228:229], v14 offset:28672
ds_read_b64_tr_b16 v[230:231], v14 offset:29184
v_mfma_f32_16x16x32_bf16 v[36:39], v[104:107], v[192:195], v[36:39]
buffer_load_dwordx4 v[172:175], v12, s[32:35], s57 offen offset:1024 sc1
v_mfma_f32_16x16x32_bf16 v[24:27], v[108:111], v[188:191], v[24:27]
ds_read_b64_tr_b16 v[232:233], v15 offset:28672
v_mfma_f32_16x16x32_bf16 v[40:43], v[108:111], v[192:195], v[40:43]
ds_read_b64_tr_b16 v[234:235], v15 offset:29184
v_mfma_f32_16x16x32_bf16 v[28:31], v[112:115], v[188:191], v[28:31]
ds_read_b64_tr_b16 v[236:237], v16 offset:28672
buffer_load_dwordx4 v[176:179], v13, s[32:35], s57 offen offset:1024 sc1
s_add_u32 s57, s57, 2048
s_and_b32 s57, s57, 0x7fff
v_mfma_f32_16x16x32_bf16 v[44:47], v[112:115], v[192:195], v[44:47]
ds_read_b64_tr_b16 v[238:239], v16 offset:29184
v_mfma_f32_16x16x32_bf16 v[32:35], v[116:119], v[188:191], v[32:35]
ds_read_b64_tr_b16 v[240:241], v17 offset:28672
v_mfma_f32_16x16x32_bf16 v[48:51], v[116:119], v[192:195], v[48:51]
ds_read_b64_tr_b16 v[242:243], v17 offset:29184
s_waitcnt vmcnt(10) lgkmcnt(8)
v_mfma_f32_16x16x32_bf16 v[20:23], v[212:215], v[196:199], v[20:23]
ds_read_b64_tr_b16 v[104:105], v14 offset:32768
ds_read_b64_tr_b16 v[106:107], v14 offset:33280
v_mfma_f32_16x16x32_bf16 v[36:39], v[212:215], v[200:203], v[36:39]
buffer_load_dwordx4 v[180:183], v12, s[32:35], s57 offen sc1
v_mfma_f32_16x16x32_bf16 v[24:27], v[216:219], v[196:199], v[24:27]
ds_read_b64_tr_b16 v[108:109], v15 offset:32768
v_mfma_f32_16x16x32_bf16 v[40:43], v[216:219], v[200:203], v[40:43]
ds_read_b64_tr_b16 v[110:111], v15 offset:33280
v_mfma_f32_16x16x32_bf16 v[28:31], v[220:223], v[196:199], v[28:31]
ds_read_b64_tr_b16 v[112:113], v16 offset:32768
buffer_load_dwordx4 v[184:187], v13, s[32:35], s57 offen sc1
v_mfma_f32_16x16x32_bf16 v[44:47], v[220:223], v[200:203], v[44:47]
ds_read_b64_tr_b16 v[114:115], v16 offset:33280
v_mfma_f32_16x16x32_bf16 v[32:35], v[224:227], v[196:199], v[32:35]
ds_read_b64_tr_b16 v[116:117], v17 offset:32768
v_mfma_f32_16x16x32_bf16 v[48:51], v[224:227], v[200:203], v[48:51]
ds_read_b64_tr_b16 v[118:119], v17 offset:33280
s_waitcnt vmcnt(10) lgkmcnt(8)
v_mfma_f32_16x16x32_bf16 v[20:23], v[228:231], v[204:207], v[20:23]
ds_read_b64_tr_b16 v[212:213], v14 offset:36864
ds_read_b64_tr_b16 v[214:215], v14 offset:37376
v_mfma_f32_16x16x32_bf16 v[36:39], v[228:231], v[208:211], v[36:39]
buffer_load_dwordx4 v[188:191], v12, s[32:35], s57 offen offset:1024 sc1
v_mfma_f32_16x16x32_bf16 v[24:27], v[232:235], v[204:207], v[24:27]
ds_read_b64_tr_b16 v[216:217], v15 offset:36864
v_mfma_f32_16x16x32_bf16 v[40:43], v[232:235], v[208:211], v[40:43]
ds_read_b64_tr_b16 v[218:219], v15 offset:37376
v_mfma_f32_16x16x32_bf16 v[28:31], v[236:239], v[204:207], v[28:31]
ds_read_b64_tr_b16 v[220:221], v16 offset:36864
buffer_load_dwordx4 v[192:195], v13, s[32:35], s57 offen offset:1024 sc1
s_add_u32 s57, s57, 2048
s_and_b32 s57, s57, 0x7fff
v_mfma_f32_16x16x32_bf16 v[44:47], v[236:239], v[208:211], v[44:47]
ds_read_b64_tr_b16 v[222:223], v16 offset:37376
v_mfma_f32_16x16x32_bf16 v[32:35], v[240:243], v[204:207], v[32:35]
ds_read_b64_tr_b16 v[224:225], v17 offset:36864
v_mfma_f32_16x16x32_bf16 v[48:51], v[240:243], v[208:211], v[48:51]
ds_read_b64_tr_b16 v[226:227], v17 offset:37376
s_waitcnt vmcnt(10) lgkmcnt(8)
v_mfma_f32_16x16x32_bf16 v[20:23], v[104:107], v[148:151], v[20:23]
ds_read_b64_tr_b16 v[228:229], v14 offset:40960
ds_read_b64_tr_b16 v[230:231], v14 offset:41472
v_mfma_f32_16x16x32_bf16 v[36:39], v[104:107], v[152:155], v[36:39]
buffer_load_dwordx4 v[196:199], v12, s[32:35], s57 offen sc1
v_mfma_f32_16x16x32_bf16 v[24:27], v[108:111], v[148:151], v[24:27]
ds_read_b64_tr_b16 v[232:233], v15 offset:40960
v_mfma_f32_16x16x32_bf16 v[40:43], v[108:111], v[152:155], v[40:43]
ds_read_b64_tr_b16 v[234:235], v15 offset:41472
v_mfma_f32_16x16x32_bf16 v[28:31], v[112:115], v[148:151], v[28:31]
ds_read_b64_tr_b16 v[236:237], v16 offset:40960
buffer_load_dwordx4 v[200:203], v13, s[32:35], s57 offen sc1
v_mfma_f32_16x16x32_bf16 v[44:47], v[112:115], v[152:155], v[44:47]
ds_read_b64_tr_b16 v[238:239], v16 offset:41472
v_mfma_f32_16x16x32_bf16 v[32:35], v[116:119], v[148:151], v[32:35]
ds_read_b64_tr_b16 v[240:241], v17 offset:40960
v_mfma_f32_16x16x32_bf16 v[48:51], v[116:119], v[152:155], v[48:51]
ds_read_b64_tr_b16 v[242:243], v17 offset:41472
s_waitcnt vmcnt(10) lgkmcnt(8)
v_mfma_f32_16x16x32_bf16 v[20:23], v[212:215], v[156:159], v[20:23]
ds_read_b64_tr_b16 v[104:105], v14 offset:45056
ds_read_b64_tr_b16 v[106:107], v14 offset:45568
v_mfma_f32_16x16x32_bf16 v[36:39], v[212:215], v[160:163], v[36:39]
buffer_load_dwordx4 v[204:207], v12, s[32:35], s57 offen offset:1024 sc1
v_mfma_f32_16x16x32_bf16 v[24:27], v[216:219], v[156:159], v[24:27]
ds_read_b64_tr_b16 v[108:109], v15 offset:45056
v_mfma_f32_16x16x32_bf16 v[40:43], v[216:219], v[160:163], v[40:43]
ds_read_b64_tr_b16 v[110:111], v15 offset:45568
v_mfma_f32_16x16x32_bf16 v[28:31], v[220:223], v[156:159], v[28:31]
ds_read_b64_tr_b16 v[112:113], v16 offset:45056
buffer_load_dwordx4 v[208:211], v13, s[32:35], s57 offen offset:1024 sc1
s_add_u32 s57, s57, 2048
s_and_b32 s57, s57, 0x7fff
v_mfma_f32_16x16x32_bf16 v[44:47], v[220:223], v[160:163], v[44:47]
ds_read_b64_tr_b16 v[114:115], v16 offset:45568
v_mfma_f32_16x16x32_bf16 v[32:35], v[224:227], v[156:159], v[32:35]
ds_read_b64_tr_b16 v[116:117], v17 offset:45056
v_mfma_f32_16x16x32_bf16 v[48:51], v[224:227], v[160:163], v[48:51]
ds_read_b64_tr_b16 v[118:119], v17 offset:45568
s_waitcnt vmcnt(10) lgkmcnt(8)
v_mfma_f32_16x16x32_bf16 v[20:23], v[228:231], v[164:167], v[20:23]
ds_read_b64_tr_b16 v[212:213], v14 offset:49152
ds_read_b64_tr_b16 v[214:215], v14 offset:49664
v_mfma_f32_16x16x32_bf16 v[36:39], v[228:231], v[168:171], v[36:39]
buffer_load_dwordx4 v[148:151], v12, s[32:35], s57 offen sc1
v_mfma_f32_16x16x32_bf16 v[24:27], v[232:235], v[164:167], v[24:27]
ds_read_b64_tr_b16 v[216:217], v15 offset:49152
v_mfma_f32_16x16x32_bf16 v[40:43], v[232:235], v[168:171], v[40:43]
ds_read_b64_tr_b16 v[218:219], v15 offset:49664
v_mfma_f32_16x16x32_bf16 v[28:31], v[236:239], v[164:167], v[28:31]
ds_read_b64_tr_b16 v[220:221], v16 offset:49152
buffer_load_dwordx4 v[152:155], v13, s[32:35], s57 offen sc1
v_mfma_f32_16x16x32_bf16 v[44:47], v[236:239], v[168:171], v[44:47]
ds_read_b64_tr_b16 v[222:223], v16 offset:49664
v_mfma_f32_16x16x32_bf16 v[32:35], v[240:243], v[164:167], v[32:35]
ds_read_b64_tr_b16 v[224:225], v17 offset:49152
v_mfma_f32_16x16x32_bf16 v[48:51], v[240:243], v[168:171], v[48:51]
ds_read_b64_tr_b16 v[226:227], v17 offset:49664
s_waitcnt vmcnt(10) lgkmcnt(8)
v_mfma_f32_16x16x32_bf16 v[20:23], v[104:107], v[172:175], v[20:23]
ds_read_b64_tr_b16 v[228:229], v14 offset:53248
ds_read_b64_tr_b16 v[230:231], v14 offset:53760
v_mfma_f32_16x16x32_bf16 v[36:39], v[104:107], v[176:179], v[36:39]
buffer_load_dwordx4 v[156:159], v12, s[32:35], s57 offen offset:1024 sc1
v_mfma_f32_16x16x32_bf16 v[24:27], v[108:111], v[172:175], v[24:27]
ds_read_b64_tr_b16 v[232:233], v15 offset:53248
v_mfma_f32_16x16x32_bf16 v[40:43], v[108:111], v[176:179], v[40:43]
ds_read_b64_tr_b16 v[234:235], v15 offset:53760
v_mfma_f32_16x16x32_bf16 v[28:31], v[112:115], v[172:175], v[28:31]
ds_read_b64_tr_b16 v[236:237], v16 offset:53248
buffer_load_dwordx4 v[160:163], v13, s[32:35], s57 offen offset:1024 sc1
s_add_u32 s57, s57, 2048
s_and_b32 s57, s57, 0x7fff
v_mfma_f32_16x16x32_bf16 v[44:47], v[112:115], v[176:179], v[44:47]
ds_read_b64_tr_b16 v[238:239], v16 offset:53760
v_mfma_f32_16x16x32_bf16 v[32:35], v[116:119], v[172:175], v[32:35]
ds_read_b64_tr_b16 v[240:241], v17 offset:53248
v_mfma_f32_16x16x32_bf16 v[48:51], v[116:119], v[176:179], v[48:51]
ds_read_b64_tr_b16 v[242:243], v17 offset:53760
s_waitcnt vmcnt(10) lgkmcnt(8)
v_mfma_f32_16x16x32_bf16 v[20:23], v[212:215], v[180:183], v[20:23]
ds_read_b64_tr_b16 v[104:105], v14 offset:57344
ds_read_b64_tr_b16 v[106:107], v14 offset:57856
v_mfma_f32_16x16x32_bf16 v[36:39], v[212:215], v[184:187], v[36:39]
buffer_load_dwordx4 v[164:167], v12, s[32:35], s57 offen sc1
v_mfma_f32_16x16x32_bf16 v[24:27], v[216:219], v[180:183], v[24:27]
ds_read_b64_tr_b16 v[108:109], v15 offset:57344
v_mfma_f32_16x16x32_bf16 v[40:43], v[216:219], v[184:187], v[40:43]
ds_read_b64_tr_b16 v[110:111], v15 offset:57856
v_mfma_f32_16x16x32_bf16 v[28:31], v[220:223], v[180:183], v[28:31]
ds_read_b64_tr_b16 v[112:113], v16 offset:57344
buffer_load_dwordx4 v[168:171], v13, s[32:35], s57 offen sc1
v_mfma_f32_16x16x32_bf16 v[44:47], v[220:223], v[184:187], v[44:47]
ds_read_b64_tr_b16 v[114:115], v16 offset:57856
v_mfma_f32_16x16x32_bf16 v[32:35], v[224:227], v[180:183], v[32:35]
ds_read_b64_tr_b16 v[116:117], v17 offset:57344
v_mfma_f32_16x16x32_bf16 v[48:51], v[224:227], v[184:187], v[48:51]
ds_read_b64_tr_b16 v[118:119], v17 offset:57856
s_waitcnt vmcnt(10) lgkmcnt(8)
v_mfma_f32_16x16x32_bf16 v[20:23], v[228:231], v[188:191], v[20:23]
ds_read_b64_tr_b16 v[212:213], v14 offset:61440
ds_read_b64_tr_b16 v[214:215], v14 offset:61952
v_mfma_f32_16x16x32_bf16 v[36:39], v[228:231], v[192:195], v[36:39]
buffer_load_dwordx4 v[172:175], v12, s[32:35], s57 offen offset:1024 sc1
v_mfma_f32_16x16x32_bf16 v[24:27], v[232:235], v[188:191], v[24:27]
ds_read_b64_tr_b16 v[216:217], v15 offset:61440
v_mfma_f32_16x16x32_bf16 v[40:43], v[232:235], v[192:195], v[40:43]
ds_read_b64_tr_b16 v[218:219], v15 offset:61952
v_mfma_f32_16x16x32_bf16 v[28:31], v[236:239], v[188:191], v[28:31]
ds_read_b64_tr_b16 v[220:221], v16 offset:61440
buffer_load_dwordx4 v[176:179], v13, s[32:35], s57 offen offset:1024 sc1
s_add_u32 s57, s57, 2048
s_and_b32 s57, s57, 0x7fff
v_mfma_f32_16x16x32_bf16 v[44:47], v[236:239], v[192:195], v[44:47]
ds_read_b64_tr_b16 v[222:223], v16 offset:61952
v_mfma_f32_16x16x32_bf16 v[32:35], v[240:243], v[188:191], v[32:35]
ds_read_b64_tr_b16 v[224:225], v17 offset:61440
v_mfma_f32_16x16x32_bf16 v[48:51], v[240:243], v[192:195], v[48:51]
ds_read_b64_tr_b16 v[226:227], v17 offset:61952
s_waitcnt vmcnt(10) lgkmcnt(8)
v_mfma_f32_16x16x32_bf16 v[20:23], v[104:107], v[196:199], v[20:23]
ds_read_b64_tr_b16 v[228:229], v52 offset:0
ds_read_b64_tr_b16 v[230:231], v52 offset:512
v_mfma_f32_16x16x32_bf16 v[36:39], v[104:107], v[200:203], v[36:39]
buffer_load_dwordx4 v[180:183], v12, s[32:35], s57 offen sc1
v_mfma_f32_16x16x32_bf16 v[24:27], v[108:111], v[196:199], v[24:27]
ds_read_b64_tr_b16 v[232:233], v53 offset:0
v_mfma_f32_16x16x32_bf16 v[40:43], v[108:111], v[200:203], v[40:43]
ds_read_b64_tr_b16 v[234:235], v53 offset:512
v_mfma_f32_16x16x32_bf16 v[28:31], v[112:115], v[196:199], v[28:31]
ds_read_b64_tr_b16 v[236:237], v54 offset:0
buffer_load_dwordx4 v[184:187], v13, s[32:35], s57 offen sc1
v_mfma_f32_16x16x32_bf16 v[44:47], v[112:115], v[200:203], v[44:47]
ds_read_b64_tr_b16 v[238:239], v54 offset:512
v_mfma_f32_16x16x32_bf16 v[32:35], v[116:119], v[196:199], v[32:35]
ds_read_b64_tr_b16 v[240:241], v55 offset:0
v_mfma_f32_16x16x32_bf16 v[48:51], v[116:119], v[200:203], v[48:51]
ds_read_b64_tr_b16 v[242:243], v55 offset:512
s_waitcnt vmcnt(10) lgkmcnt(8)
v_mfma_f32_16x16x32_bf16 v[20:23], v[212:215], v[204:207], v[20:23]
ds_read_b64_tr_b16 v[104:105], v52 offset:4096
ds_read_b64_tr_b16 v[106:107], v52 offset:4608
v_mfma_f32_16x16x32_bf16 v[36:39], v[212:215], v[208:211], v[36:39]
buffer_load_dwordx4 v[188:191], v12, s[32:35], s57 offen offset:1024 sc1
v_mfma_f32_16x16x32_bf16 v[24:27], v[216:219], v[204:207], v[24:27]
ds_read_b64_tr_b16 v[108:109], v53 offset:4096
v_mfma_f32_16x16x32_bf16 v[40:43], v[216:219], v[208:211], v[40:43]
ds_read_b64_tr_b16 v[110:111], v53 offset:4608
v_mfma_f32_16x16x32_bf16 v[28:31], v[220:223], v[204:207], v[28:31]
ds_read_b64_tr_b16 v[112:113], v54 offset:4096
buffer_load_dwordx4 v[192:195], v13, s[32:35], s57 offen offset:1024 sc1
s_add_u32 s57, s57, 2048
s_and_b32 s57, s57, 0x7fff
v_mfma_f32_16x16x32_bf16 v[44:47], v[220:223], v[208:211], v[44:47]
ds_read_b64_tr_b16 v[114:115], v54 offset:4608
v_mfma_f32_16x16x32_bf16 v[32:35], v[224:227], v[204:207], v[32:35]
ds_read_b64_tr_b16 v[116:117], v55 offset:4096
v_mfma_f32_16x16x32_bf16 v[48:51], v[224:227], v[208:211], v[48:51]
ds_read_b64_tr_b16 v[118:119], v55 offset:4608
s_waitcnt vmcnt(10) lgkmcnt(8)
v_mfma_f32_16x16x32_bf16 v[20:23], v[228:231], v[148:151], v[20:23]
ds_read_b64_tr_b16 v[212:213], v52 offset:8192
ds_read_b64_tr_b16 v[214:215], v52 offset:8704
v_mfma_f32_16x16x32_bf16 v[36:39], v[228:231], v[152:155], v[36:39]
buffer_load_dwordx4 v[196:199], v12, s[32:35], s57 offen sc1
v_mfma_f32_16x16x32_bf16 v[24:27], v[232:235], v[148:151], v[24:27]
ds_read_b64_tr_b16 v[216:217], v53 offset:8192
v_mfma_f32_16x16x32_bf16 v[40:43], v[232:235], v[152:155], v[40:43]
ds_read_b64_tr_b16 v[218:219], v53 offset:8704
v_mfma_f32_16x16x32_bf16 v[28:31], v[236:239], v[148:151], v[28:31]
ds_read_b64_tr_b16 v[220:221], v54 offset:8192
buffer_load_dwordx4 v[200:203], v13, s[32:35], s57 offen sc1
v_mfma_f32_16x16x32_bf16 v[44:47], v[236:239], v[152:155], v[44:47]
ds_read_b64_tr_b16 v[222:223], v54 offset:8704
v_mfma_f32_16x16x32_bf16 v[32:35], v[240:243], v[148:151], v[32:35]
ds_read_b64_tr_b16 v[224:225], v55 offset:8192
v_mfma_f32_16x16x32_bf16 v[48:51], v[240:243], v[152:155], v[48:51]
ds_read_b64_tr_b16 v[226:227], v55 offset:8704
s_waitcnt vmcnt(10) lgkmcnt(8)
v_mfma_f32_16x16x32_bf16 v[20:23], v[104:107], v[156:159], v[20:23]
ds_read_b64_tr_b16 v[228:229], v52 offset:12288
ds_read_b64_tr_b16 v[230:231], v52 offset:12800
v_mfma_f32_16x16x32_bf16 v[36:39], v[104:107], v[160:163], v[36:39]
buffer_load_dwordx4 v[204:207], v12, s[32:35], s57 offen offset:1024 sc1
v_mfma_f32_16x16x32_bf16 v[24:27], v[108:111], v[156:159], v[24:27]
ds_read_b64_tr_b16 v[232:233], v53 offset:12288
v_mfma_f32_16x16x32_bf16 v[40:43], v[108:111], v[160:163], v[40:43]
ds_read_b64_tr_b16 v[234:235], v53 offset:12800
v_mfma_f32_16x16x32_bf16 v[28:31], v[112:115], v[156:159], v[28:31]
ds_read_b64_tr_b16 v[236:237], v54 offset:12288
buffer_load_dwordx4 v[208:211], v13, s[32:35], s57 offen offset:1024 sc1
s_add_u32 s57, s57, 2048
s_and_b32 s57, s57, 0x7fff
v_mfma_f32_16x16x32_bf16 v[44:47], v[112:115], v[160:163], v[44:47]
ds_read_b64_tr_b16 v[238:239], v54 offset:12800
v_mfma_f32_16x16x32_bf16 v[32:35], v[116:119], v[156:159], v[32:35]
ds_read_b64_tr_b16 v[240:241], v55 offset:12288
v_mfma_f32_16x16x32_bf16 v[48:51], v[116:119], v[160:163], v[48:51]
ds_read_b64_tr_b16 v[242:243], v55 offset:12800
s_waitcnt vmcnt(10) lgkmcnt(8)
v_mfma_f32_16x16x32_bf16 v[20:23], v[212:215], v[164:167], v[20:23]
ds_read_b64_tr_b16 v[104:105], v52 offset:16384
ds_read_b64_tr_b16 v[106:107], v52 offset:16896
v_mfma_f32_16x16x32_bf16 v[36:39], v[212:215], v[168:171], v[36:39]
buffer_load_dwordx4 v[148:151], v12, s[32:35], s57 offen sc1
v_mfma_f32_16x16x32_bf16 v[24:27], v[216:219], v[164:167], v[24:27]
ds_read_b64_tr_b16 v[108:109], v53 offset:16384
v_mfma_f32_16x16x32_bf16 v[40:43], v[216:219], v[168:171], v[40:43]
ds_read_b64_tr_b16 v[110:111], v53 offset:16896
v_mfma_f32_16x16x32_bf16 v[28:31], v[220:223], v[164:167], v[28:31]
ds_read_b64_tr_b16 v[112:113], v54 offset:16384
buffer_load_dwordx4 v[152:155], v13, s[32:35], s57 offen sc1
v_mfma_f32_16x16x32_bf16 v[44:47], v[220:223], v[168:171], v[44:47]
ds_read_b64_tr_b16 v[114:115], v54 offset:16896
v_mfma_f32_16x16x32_bf16 v[32:35], v[224:227], v[164:167], v[32:35]
ds_read_b64_tr_b16 v[116:117], v55 offset:16384
v_mfma_f32_16x16x32_bf16 v[48:51], v[224:227], v[168:171], v[48:51]
ds_read_b64_tr_b16 v[118:119], v55 offset:16896
s_waitcnt vmcnt(10) lgkmcnt(8)
v_mfma_f32_16x16x32_bf16 v[20:23], v[228:231], v[172:175], v[20:23]
ds_read_b64_tr_b16 v[212:213], v52 offset:20480
ds_read_b64_tr_b16 v[214:215], v52 offset:20992
v_mfma_f32_16x16x32_bf16 v[36:39], v[228:231], v[176:179], v[36:39]
buffer_load_dwordx4 v[156:159], v12, s[32:35], s57 offen offset:1024 sc1
v_mfma_f32_16x16x32_bf16 v[24:27], v[232:235], v[172:175], v[24:27]
ds_read_b64_tr_b16 v[216:217], v53 offset:20480
v_mfma_f32_16x16x32_bf16 v[40:43], v[232:235], v[176:179], v[40:43]
ds_read_b64_tr_b16 v[218:219], v53 offset:20992
v_mfma_f32_16x16x32_bf16 v[28:31], v[236:239], v[172:175], v[28:31]
ds_read_b64_tr_b16 v[220:221], v54 offset:20480
buffer_load_dwordx4 v[160:163], v13, s[32:35], s57 offen offset:1024 sc1
s_add_u32 s57, s57, 2048
s_and_b32 s57, s57, 0x7fff
v_mfma_f32_16x16x32_bf16 v[44:47], v[236:239], v[176:179], v[44:47]
ds_read_b64_tr_b16 v[222:223], v54 offset:20992
v_mfma_f32_16x16x32_bf16 v[32:35], v[240:243], v[172:175], v[32:35]
ds_read_b64_tr_b16 v[224:225], v55 offset:20480
v_mfma_f32_16x16x32_bf16 v[48:51], v[240:243], v[176:179], v[48:51]
ds_read_b64_tr_b16 v[226:227], v55 offset:20992
s_waitcnt vmcnt(10) lgkmcnt(8)
v_mfma_f32_16x16x32_bf16 v[20:23], v[104:107], v[180:183], v[20:23]
ds_read_b64_tr_b16 v[228:229], v52 offset:24576
ds_read_b64_tr_b16 v[230:231], v52 offset:25088
v_mfma_f32_16x16x32_bf16 v[36:39], v[104:107], v[184:187], v[36:39]
buffer_load_dwordx4 v[164:167], v12, s[32:35], s57 offen sc1
v_mfma_f32_16x16x32_bf16 v[24:27], v[108:111], v[180:183], v[24:27]
ds_read_b64_tr_b16 v[232:233], v53 offset:24576
v_mfma_f32_16x16x32_bf16 v[40:43], v[108:111], v[184:187], v[40:43]
ds_read_b64_tr_b16 v[234:235], v53 offset:25088
v_mfma_f32_16x16x32_bf16 v[28:31], v[112:115], v[180:183], v[28:31]
ds_read_b64_tr_b16 v[236:237], v54 offset:24576
buffer_load_dwordx4 v[168:171], v13, s[32:35], s57 offen sc1
v_mfma_f32_16x16x32_bf16 v[44:47], v[112:115], v[184:187], v[44:47]
ds_read_b64_tr_b16 v[238:239], v54 offset:25088
v_mfma_f32_16x16x32_bf16 v[32:35], v[116:119], v[180:183], v[32:35]
ds_read_b64_tr_b16 v[240:241], v55 offset:24576
v_mfma_f32_16x16x32_bf16 v[48:51], v[116:119], v[184:187], v[48:51]
ds_read_b64_tr_b16 v[242:243], v55 offset:25088
s_waitcnt vmcnt(10) lgkmcnt(8)
v_mfma_f32_16x16x32_bf16 v[20:23], v[212:215], v[188:191], v[20:23]
ds_read_b64_tr_b16 v[104:105], v52 offset:28672
ds_read_b64_tr_b16 v[106:107], v52 offset:29184
v_mfma_f32_16x16x32_bf16 v[36:39], v[212:215], v[192:195], v[36:39]
buffer_load_dwordx4 v[172:175], v12, s[32:35], s57 offen offset:1024 sc1
v_mfma_f32_16x16x32_bf16 v[24:27], v[216:219], v[188:191], v[24:27]
ds_read_b64_tr_b16 v[108:109], v53 offset:28672
v_mfma_f32_16x16x32_bf16 v[40:43], v[216:219], v[192:195], v[40:43]
ds_read_b64_tr_b16 v[110:111], v53 offset:29184
v_mfma_f32_16x16x32_bf16 v[28:31], v[220:223], v[188:191], v[28:31]
ds_read_b64_tr_b16 v[112:113], v54 offset:28672
buffer_load_dwordx4 v[176:179], v13, s[32:35], s57 offen offset:1024 sc1
s_add_u32 s57, s57, 2048
s_and_b32 s57, s57, 0x7fff
v_mfma_f32_16x16x32_bf16 v[44:47], v[220:223], v[192:195], v[44:47]
ds_read_b64_tr_b16 v[114:115], v54 offset:29184
v_mfma_f32_16x16x32_bf16 v[32:35], v[224:227], v[188:191], v[32:35]
ds_read_b64_tr_b16 v[116:117], v55 offset:28672
v_mfma_f32_16x16x32_bf16 v[48:51], v[224:227], v[192:195], v[48:51]
ds_read_b64_tr_b16 v[118:119], v55 offset:29184
s_waitcnt vmcnt(10) lgkmcnt(8)
v_mfma_f32_16x16x32_bf16 v[20:23], v[228:231], v[196:199], v[20:23]
ds_read_b64_tr_b16 v[212:213], v52 offset:32768
ds_read_b64_tr_b16 v[214:215], v52 offset:33280
v_mfma_f32_16x16x32_bf16 v[36:39], v[228:231], v[200:203], v[36:39]
buffer_load_dwordx4 v[180:183], v12, s[32:35], s57 offen sc1
v_mfma_f32_16x16x32_bf16 v[24:27], v[232:235], v[196:199], v[24:27]
ds_read_b64_tr_b16 v[216:217], v53 offset:32768
v_mfma_f32_16x16x32_bf16 v[40:43], v[232:235], v[200:203], v[40:43]
ds_read_b64_tr_b16 v[218:219], v53 offset:33280
v_mfma_f32_16x16x32_bf16 v[28:31], v[236:239], v[196:199], v[28:31]
ds_read_b64_tr_b16 v[220:221], v54 offset:32768
buffer_load_dwordx4 v[184:187], v13, s[32:35], s57 offen sc1
v_mfma_f32_16x16x32_bf16 v[44:47], v[236:239], v[200:203], v[44:47]
ds_read_b64_tr_b16 v[222:223], v54 offset:33280
v_mfma_f32_16x16x32_bf16 v[32:35], v[240:243], v[196:199], v[32:35]
ds_read_b64_tr_b16 v[224:225], v55 offset:32768
v_mfma_f32_16x16x32_bf16 v[48:51], v[240:243], v[200:203], v[48:51]
ds_read_b64_tr_b16 v[226:227], v55 offset:33280
s_waitcnt vmcnt(10) lgkmcnt(8)
v_mfma_f32_16x16x32_bf16 v[20:23], v[104:107], v[204:207], v[20:23]
ds_read_b64_tr_b16 v[228:229], v52 offset:36864
ds_read_b64_tr_b16 v[230:231], v52 offset:37376
v_mfma_f32_16x16x32_bf16 v[36:39], v[104:107], v[208:211], v[36:39]
buffer_load_dwordx4 v[188:191], v12, s[32:35], s57 offen offset:1024 sc1
v_mfma_f32_16x16x32_bf16 v[24:27], v[108:111], v[204:207], v[24:27]
ds_read_b64_tr_b16 v[232:233], v53 offset:36864
v_mfma_f32_16x16x32_bf16 v[40:43], v[108:111], v[208:211], v[40:43]
ds_read_b64_tr_b16 v[234:235], v53 offset:37376
v_mfma_f32_16x16x32_bf16 v[28:31], v[112:115], v[204:207], v[28:31]
ds_read_b64_tr_b16 v[236:237], v54 offset:36864
buffer_load_dwordx4 v[192:195], v13, s[32:35], s57 offen offset:1024 sc1
s_add_u32 s57, s57, 2048
s_and_b32 s57, s57, 0x7fff
v_mfma_f32_16x16x32_bf16 v[44:47], v[112:115], v[208:211], v[44:47]
ds_read_b64_tr_b16 v[238:239], v54 offset:37376
v_mfma_f32_16x16x32_bf16 v[32:35], v[116:119], v[204:207], v[32:35]
ds_read_b64_tr_b16 v[240:241], v55 offset:36864
v_mfma_f32_16x16x32_bf16 v[48:51], v[116:119], v[208:211], v[48:51]
ds_read_b64_tr_b16 v[242:243], v55 offset:37376
s_waitcnt vmcnt(10) lgkmcnt(8)
v_mfma_f32_16x16x32_bf16 v[20:23], v[212:215], v[148:151], v[20:23]
ds_read_b64_tr_b16 v[104:105], v52 offset:40960
ds_read_b64_tr_b16 v[106:107], v52 offset:41472
v_mfma_f32_16x16x32_bf16 v[36:39], v[212:215], v[152:155], v[36:39]
buffer_load_dwordx4 v[196:199], v12, s[32:35], s57 offen sc1
v_mfma_f32_16x16x32_bf16 v[24:27], v[216:219], v[148:151], v[24:27]
ds_read_b64_tr_b16 v[108:109], v53 offset:40960
v_mfma_f32_16x16x32_bf16 v[40:43], v[216:219], v[152:155], v[40:43]
ds_read_b64_tr_b16 v[110:111], v53 offset:41472
v_mfma_f32_16x16x32_bf16 v[28:31], v[220:223], v[148:151], v[28:31]
ds_read_b64_tr_b16 v[112:113], v54 offset:40960
buffer_load_dwordx4 v[200:203], v13, s[32:35], s57 offen sc1
v_mfma_f32_16x16x32_bf16 v[44:47], v[220:223], v[152:155], v[44:47]
ds_read_b64_tr_b16 v[114:115], v54 offset:41472
v_mfma_f32_16x16x32_bf16 v[32:35], v[224:227], v[148:151], v[32:35]
ds_read_b64_tr_b16 v[116:117], v55 offset:40960
v_mfma_f32_16x16x32_bf16 v[48:51], v[224:227], v[152:155], v[48:51]
ds_read_b64_tr_b16 v[118:119], v55 offset:41472
s_waitcnt vmcnt(10) lgkmcnt(8)
v_mfma_f32_16x16x32_bf16 v[20:23], v[228:231], v[156:159], v[20:23]
ds_read_b64_tr_b16 v[212:213], v52 offset:45056
ds_read_b64_tr_b16 v[214:215], v52 offset:45568
v_mfma_f32_16x16x32_bf16 v[36:39], v[228:231], v[160:163], v[36:39]
buffer_load_dwordx4 v[204:207], v12, s[32:35], s57 offen offset:1024 sc1
v_mfma_f32_16x16x32_bf16 v[24:27], v[232:235], v[156:159], v[24:27]
ds_read_b64_tr_b16 v[216:217], v53 offset:45056
v_mfma_f32_16x16x32_bf16 v[40:43], v[232:235], v[160:163], v[40:43]
ds_read_b64_tr_b16 v[218:219], v53 offset:45568
v_mfma_f32_16x16x32_bf16 v[28:31], v[236:239], v[156:159], v[28:31]
ds_read_b64_tr_b16 v[220:221], v54 offset:45056
buffer_load_dwordx4 v[208:211], v13, s[32:35], s57 offen offset:1024 sc1
s_add_u32 s57, s57, 2048
s_and_b32 s57, s57, 0x7fff
v_mfma_f32_16x16x32_bf16 v[44:47], v[236:239], v[160:163], v[44:47]
ds_read_b64_tr_b16 v[222:223], v54 offset:45568
v_mfma_f32_16x16x32_bf16 v[32:35], v[240:243], v[156:159], v[32:35]
ds_read_b64_tr_b16 v[224:225], v55 offset:45056
v_mfma_f32_16x16x32_bf16 v[48:51], v[240:243], v[160:163], v[48:51]
ds_read_b64_tr_b16 v[226:227], v55 offset:45568
s_waitcnt vmcnt(10) lgkmcnt(8)
v_mfma_f32_16x16x32_bf16 v[20:23], v[104:107], v[164:167], v[20:23]
ds_read_b64_tr_b16 v[228:229], v52 offset:49152
v_mfma_f32_16x16x32_bf16 v[36:39], v[104:107], v[168:171], v[36:39]
ds_read_b64_tr_b16 v[230:231], v52 offset:49664
v_mfma_f32_16x16x32_bf16 v[24:27], v[108:111], v[164:167], v[24:27]
ds_read_b64_tr_b16 v[232:233], v53 offset:49152
v_mfma_f32_16x16x32_bf16 v[40:43], v[108:111], v[168:171], v[40:43]
ds_read_b64_tr_b16 v[234:235], v53 offset:49664
v_mfma_f32_16x16x32_bf16 v[28:31], v[112:115], v[164:167], v[28:31]
ds_read_b64_tr_b16 v[236:237], v54 offset:49152
v_mfma_f32_16x16x32_bf16 v[44:47], v[112:115], v[168:171], v[44:47]
ds_read_b64_tr_b16 v[238:239], v54 offset:49664
v_mfma_f32_16x16x32_bf16 v[32:35], v[116:119], v[164:167], v[32:35]
ds_read_b64_tr_b16 v[240:241], v55 offset:49152
v_mfma_f32_16x16x32_bf16 v[48:51], v[116:119], v[168:171], v[48:51]
ds_read_b64_tr_b16 v[242:243], v55 offset:49664
s_waitcnt vmcnt(8) lgkmcnt(8)
v_mfma_f32_16x16x32_bf16 v[20:23], v[212:215], v[172:175], v[20:23]
ds_read_b64_tr_b16 v[104:105], v52 offset:53248
v_mfma_f32_16x16x32_bf16 v[36:39], v[212:215], v[176:179], v[36:39]
ds_read_b64_tr_b16 v[106:107], v52 offset:53760
v_mfma_f32_16x16x32_bf16 v[24:27], v[216:219], v[172:175], v[24:27]
ds_read_b64_tr_b16 v[108:109], v53 offset:53248
v_mfma_f32_16x16x32_bf16 v[40:43], v[216:219], v[176:179], v[40:43]
ds_read_b64_tr_b16 v[110:111], v53 offset:53760
v_mfma_f32_16x16x32_bf16 v[28:31], v[220:223], v[172:175], v[28:31]
ds_read_b64_tr_b16 v[112:113], v54 offset:53248
v_mfma_f32_16x16x32_bf16 v[44:47], v[220:223], v[176:179], v[44:47]
ds_read_b64_tr_b16 v[114:115], v54 offset:53760
v_mfma_f32_16x16x32_bf16 v[32:35], v[224:227], v[172:175], v[32:35]
ds_read_b64_tr_b16 v[116:117], v55 offset:53248
v_mfma_f32_16x16x32_bf16 v[48:51], v[224:227], v[176:179], v[48:51]
ds_read_b64_tr_b16 v[118:119], v55 offset:53760
s_waitcnt vmcnt(6) lgkmcnt(8)
v_mfma_f32_16x16x32_bf16 v[20:23], v[228:231], v[180:183], v[20:23]
ds_read_b64_tr_b16 v[212:213], v52 offset:57344
v_mfma_f32_16x16x32_bf16 v[36:39], v[228:231], v[184:187], v[36:39]
ds_read_b64_tr_b16 v[214:215], v52 offset:57856
v_mfma_f32_16x16x32_bf16 v[24:27], v[232:235], v[180:183], v[24:27]
ds_read_b64_tr_b16 v[216:217], v53 offset:57344
v_mfma_f32_16x16x32_bf16 v[40:43], v[232:235], v[184:187], v[40:43]
ds_read_b64_tr_b16 v[218:219], v53 offset:57856
v_mfma_f32_16x16x32_bf16 v[28:31], v[236:239], v[180:183], v[28:31]
ds_read_b64_tr_b16 v[220:221], v54 offset:57344
v_mfma_f32_16x16x32_bf16 v[44:47], v[236:239], v[184:187], v[44:47]
ds_read_b64_tr_b16 v[222:223], v54 offset:57856
v_mfma_f32_16x16x32_bf16 v[32:35], v[240:243], v[180:183], v[32:35]
ds_read_b64_tr_b16 v[224:225], v55 offset:57344
v_mfma_f32_16x16x32_bf16 v[48:51], v[240:243], v[184:187], v[48:51]
ds_read_b64_tr_b16 v[226:227], v55 offset:57856
s_waitcnt vmcnt(4) lgkmcnt(8)
v_mfma_f32_16x16x32_bf16 v[20:23], v[104:107], v[188:191], v[20:23]
ds_read_b64_tr_b16 v[228:229], v52 offset:61440
v_mfma_f32_16x16x32_bf16 v[36:39], v[104:107], v[192:195], v[36:39]
ds_read_b64_tr_b16 v[230:231], v52 offset:61952
v_mfma_f32_16x16x32_bf16 v[24:27], v[108:111], v[188:191], v[24:27]
ds_read_b64_tr_b16 v[232:233], v53 offset:61440
v_mfma_f32_16x16x32_bf16 v[40:43], v[108:111], v[192:195], v[40:43]
ds_read_b64_tr_b16 v[234:235], v53 offset:61952
v_mfma_f32_16x16x32_bf16 v[28:31], v[112:115], v[188:191], v[28:31]
ds_read_b64_tr_b16 v[236:237], v54 offset:61440
v_mfma_f32_16x16x32_bf16 v[44:47], v[112:115], v[192:195], v[44:47]
ds_read_b64_tr_b16 v[238:239], v54 offset:61952
v_mfma_f32_16x16x32_bf16 v[32:35], v[116:119], v[188:191], v[32:35]
ds_read_b64_tr_b16 v[240:241], v55 offset:61440
v_mfma_f32_16x16x32_bf16 v[48:51], v[116:119], v[192:195], v[48:51]
ds_read_b64_tr_b16 v[242:243], v55 offset:61952
s_waitcnt vmcnt(2) lgkmcnt(8)
v_mfma_f32_16x16x32_bf16 v[20:23], v[212:215], v[196:199], v[20:23]
v_mfma_f32_16x16x32_bf16 v[36:39], v[212:215], v[200:203], v[36:39]
v_mfma_f32_16x16x32_bf16 v[24:27], v[216:219], v[196:199], v[24:27]
v_mfma_f32_16x16x32_bf16 v[40:43], v[216:219], v[200:203], v[40:43]
v_mfma_f32_16x16x32_bf16 v[28:31], v[220:223], v[196:199], v[28:31]
v_mfma_f32_16x16x32_bf16 v[44:47], v[220:223], v[200:203], v[44:47]
v_mfma_f32_16x16x32_bf16 v[32:35], v[224:227], v[196:199], v[32:35]
v_mfma_f32_16x16x32_bf16 v[48:51], v[224:227], v[200:203], v[48:51]
s_waitcnt vmcnt(0) lgkmcnt(0)
v_mfma_f32_16x16x32_bf16 v[20:23], v[228:231], v[204:207], v[20:23]
v_mfma_f32_16x16x32_bf16 v[24:27], v[232:235], v[204:207], v[24:27]
v_mfma_f32_16x16x32_bf16 v[28:31], v[236:239], v[204:207], v[28:31]
v_mfma_f32_16x16x32_bf16 v[32:35], v[240:243], v[204:207], v[32:35]
v_mfma_f32_16x16x32_bf16 v[36:39], v[228:231], v[208:211], v[36:39]
v_mfma_f32_16x16x32_bf16 v[40:43], v[232:235], v[208:211], v[40:43]
v_mfma_f32_16x16x32_bf16 v[44:47], v[236:239], v[208:211], v[44:47]
v_mfma_f32_16x16x32_bf16 v[48:51], v[240:243], v[208:211], v[48:51]
s_nop 0
v_cvt_pk_bf16_f32 v20, v20, v21
v_cvt_pk_bf16_f32 v21, v22, v23
v_cvt_pk_bf16_f32 v22, v24, v25
v_cvt_pk_bf16_f32 v23, v26, v27
s_nop 1
v_permlane16_swap_b32 v20, v22
v_permlane16_swap_b32 v21, v23
buffer_store_dwordx4 v[20:23], v10, s[24:27], 0 offen offset:0
v_cvt_pk_bf16_f32 v28, v28, v29
v_cvt_pk_bf16_f32 v29, v30, v31
v_cvt_pk_bf16_f32 v30, v32, v33
v_cvt_pk_bf16_f32 v31, v34, v35
s_nop 1
v_permlane16_swap_b32 v28, v30
v_permlane16_swap_b32 v29, v31
buffer_store_dwordx4 v[28:31], v10, s[24:27], 0 offen offset:64
v_cvt_pk_bf16_f32 v36, v36, v37
v_cvt_pk_bf16_f32 v37, v38, v39
v_cvt_pk_bf16_f32 v38, v40, v41
v_cvt_pk_bf16_f32 v39, v42, v43
s_nop 1
v_permlane16_swap_b32 v36, v38
v_permlane16_swap_b32 v37, v39
buffer_store_dwordx4 v[36:39], v11, s[24:27], 0 offen offset:0
v_cvt_pk_bf16_f32 v44, v44, v45
v_cvt_pk_bf16_f32 v45, v46, v47
v_cvt_pk_bf16_f32 v46, v48, v49
v_cvt_pk_bf16_f32 v47, v50, v51
s_nop 1
v_permlane16_swap_b32 v44, v46
v_permlane16_swap_b32 v45, v47
buffer_store_dwordx4 v[44:47], v11, s[24:27], 0 offen offset:64
s_endpgm
L_code_end:
slow_43:
.p2align 3
v_pk_mul_f32 v[212:213], v[212:213], v[152:153] op_sel:[0,0] op_sel_hi:[1,0]
v_pk_mul_f32 v[214:215], v[214:215], v[152:153] op_sel:[0,0] op_sel_hi:[1,0]
v_pk_mul_f32 v[216:217], v[216:217], v[152:153] op_sel:[0,0] op_sel_hi:[1,0]
v_pk_mul_f32 v[218:219], v[218:219], v[152:153] op_sel:[0,0] op_sel_hi:[1,0]
v_cvt_pk_bf16_f32 v212, v212, v213
v_cvt_pk_bf16_f32 v213, v214, v215
v_cvt_pk_bf16_f32 v214, v216, v217
v_cvt_pk_bf16_f32 v215, v218, v219
buffer_store_dwordx4 v[212:215], v18, s[32:35], s80 offen sc1
v_pk_mul_f32 v[220:221], v[220:221], v[160:161] op_sel:[0,0] op_sel_hi:[1,0]
v_pk_mul_f32 v[222:223], v[222:223], v[160:161] op_sel:[0,0] op_sel_hi:[1,0]
v_pk_mul_f32 v[224:225], v[224:225], v[160:161] op_sel:[0,0] op_sel_hi:[1,0]
v_pk_mul_f32 v[226:227], v[226:227], v[160:161] op_sel:[0,0] op_sel_hi:[1,0]
v_cvt_pk_bf16_f32 v220, v220, v221
v_cvt_pk_bf16_f32 v221, v222, v223
v_cvt_pk_bf16_f32 v222, v224, v225
v_cvt_pk_bf16_f32 v223, v226, v227
buffer_store_dwordx4 v[220:223], v18, s[32:35], s81 offen sc1
v_pk_mul_f32 v[228:229], v[228:229], v[168:169] op_sel:[0,0] op_sel_hi:[1,0]
v_pk_mul_f32 v[230:231], v[230:231], v[168:169] op_sel:[0,0] op_sel_hi:[1,0]
v_pk_mul_f32 v[232:233], v[232:233], v[168:169] op_sel:[0,0] op_sel_hi:[1,0]
v_pk_mul_f32 v[234:235], v[234:235], v[168:169] op_sel:[0,0] op_sel_hi:[1,0]
v_cvt_pk_bf16_f32 v228, v228, v229
v_cvt_pk_bf16_f32 v229, v230, v231
v_cvt_pk_bf16_f32 v230, v232, v233
v_cvt_pk_bf16_f32 v231, v234, v235
buffer_store_dwordx4 v[228:231], v18, s[32:35], s82 offen sc1
v_pk_mul_f32 v[236:237], v[236:237], v[176:177] op_sel:[0,0] op_sel_hi:[1,0]
v_pk_mul_f32 v[238:239], v[238:239], v[176:177] op_sel:[0,0] op_sel_hi:[1,0]
v_pk_mul_f32 v[240:241], v[240:241], v[176:177] op_sel:[0,0] op_sel_hi:[1,0]
v_pk_mul_f32 v[242:243], v[242:243], v[176:177] op_sel:[0,0] op_sel_hi:[1,0]
v_cvt_pk_bf16_f32 v236, v236, v237
v_cvt_pk_bf16_f32 v237, v238, v239
v_cvt_pk_bf16_f32 v238, v240, v241
v_cvt_pk_bf16_f32 v239, v242, v243
buffer_store_dwordx4 v[236:239], v18, s[32:35], s83 offen sc1
s_barrier
s_lshl_b32 s62, s45, 2
v_mov_b32 v4, s62
v_mov_b32 v5, 1
s_mov_b64 exec, 1
s_waitcnt vmcnt(0)
buffer_store_dword v5, v4, s[32:35], s84 offen sc1
s_mov_b64 exec, -1
s_branch back_44

slow_47:
s_nop 0
v_cvt_pk_bf16_f32 v20, v20, v21
v_cvt_pk_bf16_f32 v21, v22, v23
v_cvt_pk_bf16_f32 v22, v24, v25
v_cvt_pk_bf16_f32 v23, v26, v27
buffer_store_dwordx4 v[20:23], v18, s[32:35], s85 offen offset:0 sc1
v_cvt_pk_bf16_f32 v28, v28, v29
v_cvt_pk_bf16_f32 v29, v30, v31
v_cvt_pk_bf16_f32 v30, v32, v33
v_cvt_pk_bf16_f32 v31, v34, v35
buffer_store_dwordx4 v[28:31], v18, s[32:35], s85 offen offset:1024 sc1
v_cvt_pk_bf16_f32 v36, v36, v37
v_cvt_pk_bf16_f32 v37, v38, v39
v_cvt_pk_bf16_f32 v38, v40, v41
v_cvt_pk_bf16_f32 v39, v42, v43
buffer_store_dwordx4 v[36:39], v18, s[32:35], s86 offen offset:0 sc1
v_cvt_pk_bf16_f32 v44, v44, v45
v_cvt_pk_bf16_f32 v45, v46, v47
v_cvt_pk_bf16_f32 v46, v48, v49
v_cvt_pk_bf16_f32 v47, v50, v51
buffer_store_dwordx4 v[44:47], v18, s[32:35], s86 offen offset:1024 sc1
s_barrier
v_dot2c_f32_bf16 v6, v20, v10
v_dot2c_f32_bf16 v8, v20, v20
v_dot2c_f32_bf16 v7, v36, v10
v_dot2c_f32_bf16 v9, v36, v36
v_dot2c_f32_bf16 v6, v21, v10
v_dot2c_f32_bf16 v8, v21, v21
v_dot2c_f32_bf16 v7, v37, v10
v_dot2c_f32_bf16 v9, v37, v37
v_dot2c_f32_bf16 v6, v22, v10
v_dot2c_f32_bf16 v8, v22, v22
v_dot2c_f32_bf16 v7, v38, v10
v_dot2c_f32_bf16 v9, v38, v38
v_dot2c_f32_bf16 v6, v23, v10
v_dot2c_f32_bf16 v8, v23, v23
v_dot2c_f32_bf16 v7, v39, v10
v_dot2c_f32_bf16 v9, v39, v39
v_dot2c_f32_bf16 v6, v28, v10
v_dot2c_f32_bf16 v8, v28, v28
v_dot2c_f32_bf16 v7, v44, v10
v_dot2c_f32_bf16 v9, v44, v44
v_dot2c_f32_bf16 v6, v29, v10
v_dot2c_f32_bf16 v8, v29, v29
v_dot2c_f32_bf16 v7, v45, v10
v_dot2c_f32_bf16 v9, v45, v45
v_dot2c_f32_bf16 v6, v30, v10
v_dot2c_f32_bf16 v8, v30, v30
v_dot2c_f32_bf16 v7, v46, v10
v_dot2c_f32_bf16 v9, v46, v46
v_dot2c_f32_bf16 v6, v31, v10
v_dot2c_f32_bf16 v8, v31, v31
v_dot2c_f32_bf16 v7, v47, v10
v_dot2c_f32_bf16 v9, v47, v47
s_nop 1
s_nop 1
v_permlane32_swap_b32 v6, v7
v_permlane32_swap_b32 v8, v9
s_nop 0
v_add_f32 v6, v6, v7
v_add_f32 v8, v8, v9
s_nop 1
v_permlane16_swap_b32 v6, v8
s_nop 0
v_add_f32 v6, v6, v8
s_waitcnt vmcnt(0)
s_mov_b64 exec, 1
buffer_store_dword v5, v4, s[32:35], s88 offen sc1
s_mov_b64 exec, -1
buffer_store_dword v6, v1, s[32:35], s87 offen sc1
s_branch back_48

slow_51:
s_lshl_b32 s62, s42, 2
v_mov_b32 v4, s62
v_mov_b32 v5, 1
s_mov_b64 exec, 1
buffer_store_dword v5, v4, s[32:35], s89 offen sc1
s_mov_b64 exec, -1
s_branch back_52

slow_59:
.p2align 3
v_pk_mul_f32 v[148:149], v[148:149], v[104:105] op_sel:[0,0] op_sel_hi:[1,0]
v_pk_mul_f32 v[150:151], v[150:151], v[104:105] op_sel:[0,0] op_sel_hi:[1,0]
v_pk_mul_f32 v[152:153], v[152:153], v[104:105] op_sel:[0,0] op_sel_hi:[1,0]
v_pk_mul_f32 v[154:155], v[154:155], v[104:105] op_sel:[0,0] op_sel_hi:[1,0]
v_cvt_pk_bf16_f32 v148, v148, v149
v_cvt_pk_bf16_f32 v149, v150, v151
v_cvt_pk_bf16_f32 v150, v152, v153
v_cvt_pk_bf16_f32 v151, v154, v155
buffer_store_dwordx4 v[148:151], v18, s[32:35], s80 offen sc1
v_pk_mul_f32 v[156:157], v[156:157], v[104:105] op_sel:[0,1] op_sel_hi:[1,1]
v_pk_mul_f32 v[158:159], v[158:159], v[104:105] op_sel:[0,1] op_sel_hi:[1,1]
v_pk_mul_f32 v[160:161], v[160:161], v[104:105] op_sel:[0,1] op_sel_hi:[1,1]
v_pk_mul_f32 v[162:163], v[162:163], v[104:105] op_sel:[0,1] op_sel_hi:[1,1]
v_cvt_pk_bf16_f32 v156, v156, v157
v_cvt_pk_bf16_f32 v157, v158, v159
v_cvt_pk_bf16_f32 v158, v160, v161
v_cvt_pk_bf16_f32 v159, v162, v163
buffer_store_dwordx4 v[156:159], v18, s[32:35], s81 offen sc1
v_pk_mul_f32 v[164:165], v[164:165], v[106:107] op_sel:[0,0] op_sel_hi:[1,0]
v_pk_mul_f32 v[166:167], v[166:167], v[106:107] op_sel:[0,0] op_sel_hi:[1,0]
v_pk_mul_f32 v[168:169], v[168:169], v[106:107] op_sel:[0,0] op_sel_hi:[1,0]
v_pk_mul_f32 v[170:171], v[170:171], v[106:107] op_sel:[0,0] op_sel_hi:[1,0]
v_cvt_pk_bf16_f32 v164, v164, v165
v_cvt_pk_bf16_f32 v165, v166, v167
v_cvt_pk_bf16_f32 v166, v168, v169
v_cvt_pk_bf16_f32 v167, v170, v171
buffer_store_dwordx4 v[164:167], v18, s[32:35], s82 offen sc1
v_pk_mul_f32 v[172:173], v[172:173], v[106:107] op_sel:[0,1] op_sel_hi:[1,1]
v_pk_mul_f32 v[174:175], v[174:175], v[106:107] op_sel:[0,1] op_sel_hi:[1,1]
v_pk_mul_f32 v[176:177], v[176:177], v[106:107] op_sel:[0,1] op_sel_hi:[1,1]
v_pk_mul_f32 v[178:179], v[178:179], v[106:107] op_sel:[0,1] op_sel_hi:[1,1]
v_cvt_pk_bf16_f32 v172, v172, v173
v_cvt_pk_bf16_f32 v173, v174, v175
v_cvt_pk_bf16_f32 v174, v176, v177
v_cvt_pk_bf16_f32 v175, v178, v179
buffer_store_dwordx4 v[172:175], v18, s[32:35], s83 offen sc1
s_barrier
s_lshl_b32 s62, s45, 2
v_mov_b32 v4, s62
v_mov_b32 v5, 2
s_mov_b64 exec, 1
s_waitcnt vmcnt(0)
buffer_store_dword v5, v4, s[32:35], s84 offen sc1
s_mov_b64 exec, -1
s_branch back_60

slow_63:
s_nop 0
v_cvt_pk_bf16_f32 v20, v20, v21
v_cvt_pk_bf16_f32 v21, v22, v23
v_cvt_pk_bf16_f32 v22, v24, v25
v_cvt_pk_bf16_f32 v23, v26, v27
buffer_store_dwordx4 v[20:23], v18, s[32:35], s85 offen offset:0 sc1
v_cvt_pk_bf16_f32 v28, v28, v29
v_cvt_pk_bf16_f32 v29, v30, v31
v_cvt_pk_bf16_f32 v30, v32, v33
v_cvt_pk_bf16_f32 v31, v34, v35
buffer_store_dwordx4 v[28:31], v18, s[32:35], s85 offen offset:1024 sc1
v_cvt_pk_bf16_f32 v36, v36, v37
v_cvt_pk_bf16_f32 v37, v38, v39
v_cvt_pk_bf16_f32 v38, v40, v41
v_cvt_pk_bf16_f32 v39, v42, v43
buffer_store_dwordx4 v[36:39], v18, s[32:35], s86 offen offset:0 sc1
v_cvt_pk_bf16_f32 v44, v44, v45
v_cvt_pk_bf16_f32 v45, v46, v47
v_cvt_pk_bf16_f32 v46, v48, v49
v_cvt_pk_bf16_f32 v47, v50, v51
buffer_store_dwordx4 v[44:47], v18, s[32:35], s86 offen offset:1024 sc1
s_cmp_eq_u32 s40, 3
s_cbranch_scc1 w3_100067
s_barrier
v_dot2c_f32_bf16 v6, v20, v10
v_dot2c_f32_bf16 v8, v20, v20
v_dot2c_f32_bf16 v7, v36, v10
v_dot2c_f32_bf16 v9, v36, v36
v_dot2c_f32_bf16 v6, v21, v10
v_dot2c_f32_bf16 v8, v21, v21
v_dot2c_f32_bf16 v7, v37, v10
v_dot2c_f32_bf16 v9, v37, v37
v_dot2c_f32_bf16 v6, v22, v10
v_dot2c_f32_bf16 v8, v22, v22
v_dot2c_f32_bf16 v7, v38, v10
v_dot2c_f32_bf16 v9, v38, v38
v_dot2c_f32_bf16 v6, v23, v10
v_dot2c_f32_bf16 v8, v23, v23
v_dot2c_f32_bf16 v7, v39, v10
v_dot2c_f32_bf16 v9, v39, v39
v_dot2c_f32_bf16 v6, v28, v10
v_dot2c_f32_bf16 v8, v28, v28
v_dot2c_f32_bf16 v7, v44, v10
v_dot2c_f32_bf16 v9, v44, v44
v_dot2c_f32_bf16 v6, v29, v10
v_dot2c_f32_bf16 v8, v29, v29
v_dot2c_f32_bf16 v7, v45, v10
v_dot2c_f32_bf16 v9, v45, v45
v_dot2c_f32_bf16 v6, v30, v10
v_dot2c_f32_bf16 v8, v30, v30
v_dot2c_f32_bf16 v7, v46, v10
v_dot2c_f32_bf16 v9, v46, v46
v_dot2c_f32_bf16 v6, v31, v10
v_dot2c_f32_bf16 v8, v31, v31
v_dot2c_f32_bf16 v7, v47, v10
v_dot2c_f32_bf16 v9, v47, v47
s_nop 1
s_nop 1
v_permlane32_swap_b32 v6, v7
v_permlane32_swap_b32 v8, v9
s_nop 0
v_add_f32 v6, v6, v7
v_add_f32 v8, v8, v9
s_nop 1
v_permlane16_swap_b32 v6, v8
s_nop 0
v_add_f32 v6, v6, v8
s_waitcnt vmcnt(0)
s_mov_b64 exec, 1
buffer_store_dword v5, v4, s[32:35], s88 offen sc1
s_mov_b64 exec, -1
buffer_store_dword v6, v1, s[32:35], s87 offen sc1
s_branch fin_100068
w3_100067:
s_lshl_b32 s53, s41, 15
s_lshl_b32 s54, s42, 11
s_add_u32 s53, s53, s54
s_add_u32 s53, s53, 16908288
buffer_store_dwordx4 v[36:39], v18, s[32:35], s53 offen offset:0 sc1
buffer_store_dwordx4 v[44:47], v18, s[32:35], s53 offen offset:1024 sc1
s_barrier
v_dot2c_f32_bf16 v6, v20, v10
v_dot2c_f32_bf16 v8, v20, v20
v_dot2c_f32_bf16 v7, v36, v10
v_dot2c_f32_bf16 v9, v36, v36
v_dot2c_f32_bf16 v6, v21, v10
v_dot2c_f32_bf16 v8, v21, v21
v_dot2c_f32_bf16 v7, v37, v10
v_dot2c_f32_bf16 v9, v37, v37
v_dot2c_f32_bf16 v6, v22, v10
v_dot2c_f32_bf16 v8, v22, v22
v_dot2c_f32_bf16 v7, v38, v10
v_dot2c_f32_bf16 v9, v38, v38
v_dot2c_f32_bf16 v6, v23, v10
v_dot2c_f32_bf16 v8, v23, v23
v_dot2c_f32_bf16 v7, v39, v10
v_dot2c_f32_bf16 v9, v39, v39
v_dot2c_f32_bf16 v6, v28, v10
v_dot2c_f32_bf16 v8, v28, v28
v_dot2c_f32_bf16 v7, v44, v10
v_dot2c_f32_bf16 v9, v44, v44
v_dot2c_f32_bf16 v6, v29, v10
v_dot2c_f32_bf16 v8, v29, v29
v_dot2c_f32_bf16 v7, v45, v10
v_dot2c_f32_bf16 v9, v45, v45
v_dot2c_f32_bf16 v6, v30, v10
v_dot2c_f32_bf16 v8, v30, v30
v_dot2c_f32_bf16 v7, v46, v10
v_dot2c_f32_bf16 v9, v46, v46
v_dot2c_f32_bf16 v6, v31, v10
v_dot2c_f32_bf16 v8, v31, v31
v_dot2c_f32_bf16 v7, v47, v10
v_dot2c_f32_bf16 v9, v47, v47
s_nop 1
s_nop 1
v_permlane32_swap_b32 v6, v7
v_permlane32_swap_b32 v8, v9
s_nop 0
v_add_f32 v6, v6, v7
v_add_f32 v8, v8, v9
s_nop 1
v_permlane16_swap_b32 v6, v8
s_nop 0
v_add_f32 v6, v6, v8
s_lshl_b32 s54, s41, 4
s_add_u32 s54, s54, s42
s_lshl_b32 s54, s54, 8
s_add_u32 s54, s54, 17760256
s_lshl_b32 s53, s41, 2
s_add_u32 s53, s53, 0
s_lshl_b32 s53, s53, 7
s_add_u32 s53, s53, 18391040
s_waitcnt vmcnt(2)
s_mov_b64 exec, 1
buffer_store_dword v5, v4, s[32:35], s88 offen sc1
s_mov_b64 exec, -1
s_waitcnt vmcnt(1)
s_mov_b64 exec, 1
buffer_store_dword v5, v4, s[32:35], s53 offen sc1
s_mov_b64 exec, -1
buffer_store_dword v6, v1, s[32:35], s87 offen sc1
buffer_store_dword v6, v1, s[32:35], s54 offen sc1
fin_100068:
s_branch back_64

slow_67:
s_lshl_b32 s62, s42, 2
v_mov_b32 v4, s62
v_mov_b32 v5, 2
s_mov_b64 exec, 1
buffer_store_dword v5, v4, s[32:35], s89 offen sc1
s_mov_b64 exec, -1
s_branch back_68

slow_70:
.p2align 3
v_pk_mul_f32 v[212:213], v[212:213], v[152:153] op_sel:[0,0] op_sel_hi:[1,0]
v_pk_mul_f32 v[214:215], v[214:215], v[152:153] op_sel:[0,0] op_sel_hi:[1,0]
v_pk_mul_f32 v[216:217], v[216:217], v[152:153] op_sel:[0,0] op_sel_hi:[1,0]
v_pk_mul_f32 v[218:219], v[218:219], v[152:153] op_sel:[0,0] op_sel_hi:[1,0]
v_cvt_pk_bf16_f32 v212, v212, v213
v_cvt_pk_bf16_f32 v213, v214, v215
v_cvt_pk_bf16_f32 v214, v216, v217
v_cvt_pk_bf16_f32 v215, v218, v219
buffer_store_dwordx4 v[212:215], v18, s[32:35], s80 offen sc1
v_pk_mul_f32 v[220:221], v[220:221], v[160:161] op_sel:[0,0] op_sel_hi:[1,0]
v_pk_mul_f32 v[222:223], v[222:223], v[160:161] op_sel:[0,0] op_sel_hi:[1,0]
v_pk_mul_f32 v[224:225], v[224:225], v[160:161] op_sel:[0,0] op_sel_hi:[1,0]
v_pk_mul_f32 v[226:227], v[226:227], v[160:161] op_sel:[0,0] op_sel_hi:[1,0]
v_cvt_pk_bf16_f32 v220, v220, v221
v_cvt_pk_bf16_f32 v221, v222, v223
v_cvt_pk_bf16_f32 v222, v224, v225
v_cvt_pk_bf16_f32 v223, v226, v227
buffer_store_dwordx4 v[220:223], v18, s[32:35], s81 offen sc1
v_pk_mul_f32 v[228:229], v[228:229], v[168:169] op_sel:[0,0] op_sel_hi:[1,0]
v_pk_mul_f32 v[230:231], v[230:231], v[168:169] op_sel:[0,0] op_sel_hi:[1,0]
v_pk_mul_f32 v[232:233], v[232:233], v[168:169] op_sel:[0,0] op_sel_hi:[1,0]
v_pk_mul_f32 v[234:235], v[234:235], v[168:169] op_sel:[0,0] op_sel_hi:[1,0]
v_cvt_pk_bf16_f32 v228, v228, v229
v_cvt_pk_bf16_f32 v229, v230, v231
v_cvt_pk_bf16_f32 v230, v232, v233
v_cvt_pk_bf16_f32 v231, v234, v235
buffer_store_dwordx4 v[228:231], v18, s[32:35], s82 offen sc1
v_pk_mul_f32 v[236:237], v[236:237], v[176:177] op_sel:[0,0] op_sel_hi:[1,0]
v_pk_mul_f32 v[238:239], v[238:239], v[176:177] op_sel:[0,0] op_sel_hi:[1,0]
v_pk_mul_f32 v[240:241], v[240:241], v[176:177] op_sel:[0,0] op_sel_hi:[1,0]
v_pk_mul_f32 v[242:243], v[242:243], v[176:177] op_sel:[0,0] op_sel_hi:[1,0]
v_cvt_pk_bf16_f32 v236, v236, v237
v_cvt_pk_bf16_f32 v237, v238, v239
v_cvt_pk_bf16_f32 v238, v240, v241
v_cvt_pk_bf16_f32 v239, v242, v243
buffer_store_dwordx4 v[236:239], v18, s[32:35], s83 offen sc1
s_barrier
s_lshl_b32 s62, s45, 2
v_mov_b32 v4, s62
v_mov_b32 v5, 3
s_mov_b64 exec, 1
s_waitcnt vmcnt(0)
buffer_store_dword v5, v4, s[32:35], s84 offen sc1
s_mov_b64 exec, -1
s_branch back_71

slow_74:
s_nop 0
v_cvt_pk_bf16_f32 v20, v20, v21
v_cvt_pk_bf16_f32 v21, v22, v23
v_cvt_pk_bf16_f32 v22, v24, v25
v_cvt_pk_bf16_f32 v23, v26, v27
buffer_store_dwordx4 v[20:23], v18, s[32:35], s85 offen offset:0 sc1
v_cvt_pk_bf16_f32 v28, v28, v29
v_cvt_pk_bf16_f32 v29, v30, v31
v_cvt_pk_bf16_f32 v30, v32, v33
v_cvt_pk_bf16_f32 v31, v34, v35
buffer_store_dwordx4 v[28:31], v18, s[32:35], s85 offen offset:1024 sc1
v_cvt_pk_bf16_f32 v36, v36, v37
v_cvt_pk_bf16_f32 v37, v38, v39
v_cvt_pk_bf16_f32 v38, v40, v41
v_cvt_pk_bf16_f32 v39, v42, v43
buffer_store_dwordx4 v[36:39], v18, s[32:35], s86 offen offset:0 sc1
v_cvt_pk_bf16_f32 v44, v44, v45
v_cvt_pk_bf16_f32 v45, v46, v47
v_cvt_pk_bf16_f32 v46, v48, v49
v_cvt_pk_bf16_f32 v47, v50, v51
buffer_store_dwordx4 v[44:47], v18, s[32:35], s86 offen offset:1024 sc1
s_barrier
v_dot2c_f32_bf16 v6, v20, v10
v_dot2c_f32_bf16 v8, v20, v20
v_dot2c_f32_bf16 v7, v36, v10
v_dot2c_f32_bf16 v9, v36, v36
v_dot2c_f32_bf16 v6, v21, v10
v_dot2c_f32_bf16 v8, v21, v21
v_dot2c_f32_bf16 v7, v37, v10
v_dot2c_f32_bf16 v9, v37, v37
v_dot2c_f32_bf16 v6, v22, v10
v_dot2c_f32_bf16 v8, v22, v22
v_dot2c_f32_bf16 v7, v38, v10
v_dot2c_f32_bf16 v9, v38, v38
v_dot2c_f32_bf16 v6, v23, v10
v_dot2c_f32_bf16 v8, v23, v23
v_dot2c_f32_bf16 v7, v39, v10
v_dot2c_f32_bf16 v9, v39, v39
v_dot2c_f32_bf16 v6, v28, v10
v_dot2c_f32_bf16 v8, v28, v28
v_dot2c_f32_bf16 v7, v44, v10
v_dot2c_f32_bf16 v9, v44, v44
v_dot2c_f32_bf16 v6, v29, v10
v_dot2c_f32_bf16 v8, v29, v29
v_dot2c_f32_bf16 v7, v45, v10
v_dot2c_f32_bf16 v9, v45, v45
v_dot2c_f32_bf16 v6, v30, v10
v_dot2c_f32_bf16 v8, v30, v30
v_dot2c_f32_bf16 v7, v46, v10
v_dot2c_f32_bf16 v9, v46, v46
v_dot2c_f32_bf16 v6, v31, v10
v_dot2c_f32_bf16 v8, v31, v31
v_dot2c_f32_bf16 v7, v47, v10
v_dot2c_f32_bf16 v9, v47, v47
s_nop 1
s_nop 1
v_permlane32_swap_b32 v6, v7
v_permlane32_swap_b32 v8, v9
s_nop 0
v_add_f32 v6, v6, v7
v_add_f32 v8, v8, v9
s_nop 1
v_permlane16_swap_b32 v6, v8
s_nop 0
v_add_f32 v6, v6, v8
s_waitcnt vmcnt(0)
s_mov_b64 exec, 1
buffer_store_dword v5, v4, s[32:35], s88 offen sc1
s_mov_b64 exec, -1
buffer_store_dword v6, v1, s[32:35], s87 offen sc1
s_branch back_75

slow_78:
s_lshl_b32 s62, s42, 2
v_mov_b32 v4, s62
v_mov_b32 v5, 3
s_mov_b64 exec, 1
buffer_store_dword v5, v4, s[32:35], s89 offen sc1
s_mov_b64 exec, -1
s_branch back_79

slow_86:
.p2align 3
v_pk_mul_f32 v[148:149], v[148:149], v[104:105] op_sel:[0,0] op_sel_hi:[1,0]
v_pk_mul_f32 v[150:151], v[150:151], v[104:105] op_sel:[0,0] op_sel_hi:[1,0]
v_pk_mul_f32 v[152:153], v[152:153], v[104:105] op_sel:[0,0] op_sel_hi:[1,0]
v_pk_mul_f32 v[154:155], v[154:155], v[104:105] op_sel:[0,0] op_sel_hi:[1,0]
v_cvt_pk_bf16_f32 v148, v148, v149
v_cvt_pk_bf16_f32 v149, v150, v151
v_cvt_pk_bf16_f32 v150, v152, v153
v_cvt_pk_bf16_f32 v151, v154, v155
buffer_store_dwordx4 v[148:151], v18, s[32:35], s80 offen sc1
v_pk_mul_f32 v[156:157], v[156:157], v[104:105] op_sel:[0,1] op_sel_hi:[1,1]
v_pk_mul_f32 v[158:159], v[158:159], v[104:105] op_sel:[0,1] op_sel_hi:[1,1]
v_pk_mul_f32 v[160:161], v[160:161], v[104:105] op_sel:[0,1] op_sel_hi:[1,1]
v_pk_mul_f32 v[162:163], v[162:163], v[104:105] op_sel:[0,1] op_sel_hi:[1,1]
v_cvt_pk_bf16_f32 v156, v156, v157
v_cvt_pk_bf16_f32 v157, v158, v159
v_cvt_pk_bf16_f32 v158, v160, v161
v_cvt_pk_bf16_f32 v159, v162, v163
buffer_store_dwordx4 v[156:159], v18, s[32:35], s81 offen sc1
v_pk_mul_f32 v[164:165], v[164:165], v[106:107] op_sel:[0,0] op_sel_hi:[1,0]
v_pk_mul_f32 v[166:167], v[166:167], v[106:107] op_sel:[0,0] op_sel_hi:[1,0]
v_pk_mul_f32 v[168:169], v[168:169], v[106:107] op_sel:[0,0] op_sel_hi:[1,0]
v_pk_mul_f32 v[170:171], v[170:171], v[106:107] op_sel:[0,0] op_sel_hi:[1,0]
v_cvt_pk_bf16_f32 v164, v164, v165
v_cvt_pk_bf16_f32 v165, v166, v167
v_cvt_pk_bf16_f32 v166, v168, v169
v_cvt_pk_bf16_f32 v167, v170, v171
buffer_store_dwordx4 v[164:167], v18, s[32:35], s82 offen sc1
v_pk_mul_f32 v[172:173], v[172:173], v[106:107] op_sel:[0,1] op_sel_hi:[1,1]
v_pk_mul_f32 v[174:175], v[174:175], v[106:107] op_sel:[0,1] op_sel_hi:[1,1]
v_pk_mul_f32 v[176:177], v[176:177], v[106:107] op_sel:[0,1] op_sel_hi:[1,1]
v_pk_mul_f32 v[178:179], v[178:179], v[106:107] op_sel:[0,1] op_sel_hi:[1,1]
v_cvt_pk_bf16_f32 v172, v172, v173
v_cvt_pk_bf16_f32 v173, v174, v175
v_cvt_pk_bf16_f32 v174, v176, v177
v_cvt_pk_bf16_f32 v175, v178, v179
buffer_store_dwordx4 v[172:175], v18, s[32:35], s83 offen sc1
s_barrier
s_lshl_b32 s62, s45, 2
v_mov_b32 v4, s62
v_mov_b32 v5, 4
s_mov_b64 exec, 1
s_waitcnt vmcnt(0)
buffer_store_dword v5, v4, s[32:35], s84 offen sc1
s_mov_b64 exec, -1
s_branch back_87

s_endpgm
.section .rodata,"a"
.p2align 6
.amdhsa_kernel interleave_layers__sliding_local_dilated__linear_kernel_hedgehog__prompt_kernel
  .amdhsa_next_free_vgpr 256
  .amdhsa_next_free_sgpr 102
  .amdhsa_accum_offset 256
  .amdhsa_group_segment_fixed_size 0
  .amdhsa_kernarg_size 80
  .amdhsa_user_sgpr_count 2
  .amdhsa_user_sgpr_kernarg_segment_ptr 1
  .amdhsa_system_sgpr_workgroup_id_x 1
.end_amdhsa_kernel
```

```asm
; @launch grid=(256,1,1) block=(512,1,1) lds=163840
.amdgcn_target "amdgcn-amd-amdhsa--gfx950"
.text
.globl interleave_layers__sliding_local_dilated__linear_kernel_hedgehog__prompt_kernel
.p2align 8
.type interleave_layers__sliding_local_dilated__linear_kernel_hedgehog__prompt_kernel,@function
interleave_layers__sliding_local_dilated__linear_kernel_hedgehog__prompt_kernel:
s_cmp_ge_u32 s2, 256
s_cbranch_scc1 L_end
s_load_dwordx16 s[4:19], s[0:1], 0
s_load_dwordx4 s[20:23], s[0:1], 64
v_lshrrev_b32 v1, 6, v0
v_and_b32 v0, 63, v0
v_readfirstlane_b32 s40, v1
v_and_b32 v2, 15, v0
v_lshrrev_b32 v3, 4, v0
v_lshlrev_b32 v18, 4, v0
s_and_b32 s48, s2, 7
s_lshr_b32 s49, s2, 3
s_and_b32 s74, s49, 1
s_lshl_b32 s41, s48, 1
s_add_u32 s41, s41, s74
s_lshr_b32 s42, s49, 1
s_and_b32 s48, s2, 7
s_add_u32 s47, s42, s48
s_and_b32 s47, s47, 7
s_mul_i32 s47, s47, 2
s_mov_b32 s46, 0
s_and_b32 s43, s40, 3
s_lshl_b32 s70, s43, 12
s_lshl_b32 s71, s43, 11
s_add_u32 s71, s71, 16384
s_waitcnt lgkmcnt(0)
s_mov_b32 s24, s4
s_and_b32 s25, s5, 0xffff
s_mov_b32 s26, 4194304
s_mov_b32 s27, 0x00020000
s_mov_b32 s32, s22
s_and_b32 s33, s23, 0xffff
s_mov_b32 s34, 268435456
s_mov_b32 s35, 0x00020000
s_cmp_lt_u32 s40, 4
s_cbranch_scc1 L_compute
s_mov_b32 s28, s6
s_and_b32 s29, s7, 0xffff
s_mov_b32 s30, 6291456
s_mov_b32 s31, 0x00020000
v_lshrrev_b32 v4, 3, v0
v_and_b32 v5, 7, v0
s_lshl_b32 s48, s43, 4
v_add_u32 v6, s48, v4
v_mul_u32_u24 v6, 6144, v6
v_and_b32 v7, 2, v4
v_xor_b32 v7, v7, v5
s_lshl_b32 s48, s42, 7
v_lshl_add_u32 v26, v7, 4, v6
v_add_u32 v26, s48, v26
v_xor_b32 v27, 64, v26
v_add_u32 v27, 48128, v27
s_lshl_b32 s48, s41, 7
s_lshl_b32 s49, s43, 5
s_add_u32 s48, s48, s49
v_add_u32 v6, s48, v4
v_lshlrev_b32 v6, 11, v6
v_lshrrev_b32 v7, 1, v4
v_xor_b32 v7, v7, v5
v_lshl_add_u32 v20, v7, 4, v6
v_xor_b32 v21, 64, v20
v_add_u32 v21, 15360, v21
v_add_u32 v22, 30720, v20
v_add_u32 v23, 30720, v21
s_add_u32 s69, s47, 0
s_and_b32 s69, s69, 15
s_mul_i32 s67, s69, 128
s_mul_i32 s68, s69, 393216
s_add_u32 m0, s70, 0
s_nop 0
buffer_load_dwordx4 v20, s[24:27], s67 offen offset:0  lds
buffer_load_dwordx4 v21, s[24:27], s67 offen offset:1024  lds
buffer_load_dwordx4 v22, s[24:27], s67 offen offset:2048  lds
buffer_load_dwordx4 v23, s[24:27], s67 offen offset:3072  lds
s_add_u32 s60, s71, 0
s_add_u32 m0, s60, 0
s_add_u32 s61, s68, 0
buffer_load_dwordx4 v26, s[28:31], s61 offen lds
buffer_load_dwordx4 v27, s[28:31], s61 offen offset:1024 lds
s_add_u32 m0, s60, 8192
s_add_u32 s61, s68, 2048
buffer_load_dwordx4 v26, s[28:31], s61 offen lds
buffer_load_dwordx4 v27, s[28:31], s61 offen offset:1024 lds
s_add_u32 m0, s60, 16384
s_add_u32 s61, s68, 4096
buffer_load_dwordx4 v26, s[28:31], s61 offen lds
buffer_load_dwordx4 v27, s[28:31], s61 offen offset:1024 lds
s_and_b32 s51, s42, 7
s_cmp_gt_u32 s51, 3
s_cselect_b32 s49, 1, 0
s_sub_u32 s49, s51, s49
s_lshl_b32 s49, s49, 1
s_add_u32 s49, s49, s74
s_lshl_b32 s49, s49, 2
s_add_u32 s49, s49, s43
s_lshr_b32 s50, s49, 4
s_lshl_b32 s50, s50, 11
s_and_b32 s49, s49, 15
s_mul_i32 s49, s49, 24576
s_add_u32 s49, s49, s50
s_and_b32 s50, s42, 8
s_or_b32 s50, s50, 3
s_and_b32 s48, s2, 7
s_add_u32 s76, s50, s48
s_and_b32 s76, s76, 7
s_mul_i32 s76, s76, 2
s_lshl_b32 s50, s50, 7
s_add_u32 s49, s49, s50
s_and_b32 s51, s51, 3
s_cmp_eq_u32 s51, 3
s_cselect_b32 s49, 0x70000000, s49
v_mul_u32_u24 v4, 6144, v4
v_lshl_add_u32 v4, v5, 4, v4
v_lshrrev_b32 v5, 5, v0
v_lshlrev_b32 v5, 30, v5
v_add3_u32 v36, v4, v5, s49
v_lshrrev_b32 v4, 3, v0
v_and_b32 v5, 7, v0
s_lshr_b32 s48, s43, 1
s_lshl_b32 s48, s48, 5
s_and_b32 s49, s43, 1
s_lshl_b32 s49, s49, 3
s_add_u32 s48, s48, s49
v_lshrrev_b32 v6, 2, v4
v_lshlrev_b32 v6, 4, v6
v_and_b32 v7, 3, v4
v_add3_u32 v6, v6, v7, s48
v_mul_u32_u24 v6, 2048, v6
v_and_b32 v7, 2, v4
v_xor_b32 v7, v7, v5
s_lshl_b32 s48, s42, 7
v_lshl_add_u32 v28, v7, 4, v6
v_add_u32 v28, s48, v28
v_xor_b32 v29, 64, v28
v_add_u32 v29, 7168, v29
v_lshlrev_b32 v30, 2, v2
v_and_b32 v32, 7, v0
v_lshlrev_b32 v32, 3, v32
s_lshl_b32 s50, s41, 2
s_add_u32 s50, s50, s43
s_lshl_b32 s50, s50, 12
s_add_u32 s50, s50, 16777216
v_add_u32 v37, s50, v18
v_lshrrev_b32 v4, 5, v0
v_lshl_add_u32 v4, v4, 4, v2
s_lshl_b32 s48, s43, 5
v_add_u32 v4, s48, v4
v_lshlrev_b32 v49, 3, v4
v_add_u32 v49, 131072, v49
v_lshlrev_b32 v50, 2, v4
v_add_u32 v50, 132096, v50
s_getreg_b32 s50, hwreg(HW_REG_XCC_ID)
s_and_b32 s50, s50, 7
s_lshl_b32 s50, s50, 3
s_lshl_b64 s[94:95], 1, s50
s_and_b32 s96, s2, 7
s_lshl_b32 s96, s96, 3
s_cmp_eq_u32 s43, 1
s_cselect_b32 s97, 3, 99
s_lshl_b32 s72, s41, 2
s_add_u32 s72, s72, s43
s_lshl_b32 s72, s72, 7
s_add_u32 s72, s72, 17580032
s_lshl_b32 s73, s42, 2
s_add_u32 s73, s73, s43
s_lshl_b32 s73, s73, 7
s_add_u32 s73, s73, 17588224
s_lshl_b32 s79, s41, 2
s_add_u32 s79, s79, s43
s_lshl_b32 s79, s79, 7
s_add_u32 s79, s79, 17571840
s_lshl_b32 s48, s41, 3
s_lshl_b32 s49, s43, 1
s_add_u32 s48, s48, s49
s_lshl_b32 s80, s48, 15
s_lshl_b32 s49, s42, 11
s_add_u32 s81, s80, s49
s_add_u32 s81, s81, 4194304
s_add_u32 s82, s81, 32768
s_lshl_b32 s50, s42, 2
s_add_u32 s50, s50, s43
s_lshl_b32 s50, s50, 12
s_add_u32 s50, s50, 17039360
v_add_u32 v38, s50, v18
v_min_u32 v4, 2, v3
v_lshlrev_b32 v4, 8, v4
v_lshl_add_u32 v4, v2, 2, v4
s_and_b32 s48, s43, 1
s_lshl_b32 s48, s48, 7
s_lshr_b32 s49, s43, 1
s_lshl_b32 s49, s49, 6
s_add_u32 s48, s48, s49
s_add_u32 s48, s48, 133120
v_add_u32 v53, s48, v4
s_getpc_b64 s[98:99]
pc_1:
s_add_u32 s98, s98, c0_last - pc_1
s_addc_u32 s99, s99, 0
s_lshr_b32 s50, s2, 3
s_lshl_b32 s50, s50, 2
s_add_u32 s50, s50, s43
s_lshl_b32 s50, s50, 7
v_and_b32 v4, 1, v0
v_lshl_add_u32 v4, v4, 6, s50
v_min_u32 v54, L_code_end - c0_last, v4
s_add_u32 s69, s47, 1
s_and_b32 s69, s69, 15
s_mul_i32 s67, s69, 128
s_mul_i32 s68, s69, 393216
s_add_u32 m0, s70, 40960
s_nop 0
buffer_load_dwordx4 v20, s[24:27], s67 offen offset:0  lds
buffer_load_dwordx4 v21, s[24:27], s67 offen offset:1024  lds
buffer_load_dwordx4 v22, s[24:27], s67 offen offset:2048  lds
buffer_load_dwordx4 v23, s[24:27], s67 offen offset:3072  lds
s_add_u32 s60, s71, 40960
s_add_u32 m0, s60, 0
s_add_u32 s61, s68, 0
buffer_load_dwordx4 v26, s[28:31], s61 offen lds
buffer_load_dwordx4 v27, s[28:31], s61 offen offset:1024 lds
s_add_u32 m0, s60, 8192
s_add_u32 s61, s68, 2048
buffer_load_dwordx4 v26, s[28:31], s61 offen lds
buffer_load_dwordx4 v27, s[28:31], s61 offen offset:1024 lds
s_add_u32 m0, s60, 16384
s_add_u32 s61, s68, 4096
buffer_load_dwordx4 v26, s[28:31], s61 offen lds
buffer_load_dwordx4 v27, s[28:31], s61 offen offset:1024 lds
s_add_u32 s49, s76, 2
s_and_b32 s49, s49, 15
s_mul_i32 s49, s49, 393216
buffer_load_dwordx4 v[40:43], v36, s[28:31], s49 offen
s_add_u32 s49, s76, 3
s_and_b32 s49, s49, 15
s_mul_i32 s49, s49, 393216
buffer_load_dwordx4 v[40:43], v36, s[28:31], s49 offen
s_waitcnt vmcnt(12)
s_barrier
s_add_u32 s69, s47, 2
s_and_b32 s69, s69, 15
s_mul_i32 s67, s69, 128
s_mul_i32 s68, s69, 393216
s_add_u32 m0, s70, 81920
s_nop 0
buffer_load_dwordx4 v20, s[24:27], s67 offen offset:0  lds
buffer_load_dwordx4 v21, s[24:27], s67 offen offset:1024  lds
buffer_load_dwordx4 v22, s[24:27], s67 offen offset:2048  lds
buffer_load_dwordx4 v23, s[24:27], s67 offen offset:3072  lds
s_add_u32 s60, s71, 81920
s_add_u32 m0, s60, 0
s_add_u32 s61, s68, 0
buffer_load_dwordx4 v26, s[28:31], s61 offen lds
buffer_load_dwordx4 v27, s[28:31], s61 offen offset:1024 lds
s_add_u32 m0, s60, 8192
s_add_u32 s61, s68, 2048
buffer_load_dwordx4 v26, s[28:31], s61 offen lds
buffer_load_dwordx4 v27, s[28:31], s61 offen offset:1024 lds
s_add_u32 m0, s60, 16384
s_add_u32 s61, s68, 4096
buffer_load_dwordx4 v26, s[28:31], s61 offen lds
buffer_load_dwordx4 v27, s[28:31], s61 offen offset:1024 lds
s_add_u32 s49, s76, 4
s_and_b32 s49, s49, 15
s_mul_i32 s49, s49, 393216
buffer_load_dwordx4 v[40:43], v36, s[28:31], s49 offen
s_mov_b32 s64, 0
s_mov_b32 s65, 0
h0_loop:
s_waitcnt vmcnt(11)
s_barrier
s_cmp_lg_u32 s64, s97
s_cbranch_scc1 else_2
s_atomic_add_x2 s[94:95], s[20:21], s96
else_2:
s_add_u32 s69, s69, 1
s_and_b32 s69, s69, 15
s_mul_i32 s67, s69, 128
s_mul_i32 s68, s69, 393216
s_add_u32 m0, s70, s65
s_nop 0
buffer_load_dwordx4 v20, s[24:27], s67 offen offset:0  lds
buffer_load_dwordx4 v21, s[24:27], s67 offen offset:1024  lds
buffer_load_dwordx4 v22, s[24:27], s67 offen offset:2048  lds
buffer_load_dwordx4 v23, s[24:27], s67 offen offset:3072  lds
s_add_u32 s60, s71, s65
s_add_u32 m0, s60, 0
s_add_u32 s61, s68, 0
buffer_load_dwordx4 v26, s[28:31], s61 offen lds
buffer_load_dwordx4 v27, s[28:31], s61 offen offset:1024 lds
s_add_u32 m0, s60, 8192
s_add_u32 s61, s68, 2048
buffer_load_dwordx4 v26, s[28:31], s61 offen lds
buffer_load_dwordx4 v27, s[28:31], s61 offen offset:1024 lds
s_add_u32 m0, s60, 16384
s_add_u32 s61, s68, 4096
buffer_load_dwordx4 v26, s[28:31], s61 offen lds
buffer_load_dwordx4 v27, s[28:31], s61 offen offset:1024 lds
s_add_u32 s48, s64, 5
s_min_u32 s48, s48, 15
s_add_u32 s49, s48, s76
s_and_b32 s49, s49, 15
s_mul_i32 s49, s49, 393216
buffer_load_dwordx4 v[40:43], v36, s[28:31], s49 offen
s_add_u32 s65, s65, 40960
s_cmp_eq_u32 s65, 122880
s_cselect_b32 s65, 0, s65
s_add_u32 s64, s64, 1
s_cmp_lt_u32 s64, 11
s_cbranch_scc1 h0_loop
s_waitcnt vmcnt(11)
s_barrier
global_load_dwordx2 v[34:35], v32, s[20:21] sc1
global_load_dword v48, v54, s[98:99]
s_add_u32 s69, s69, 1
s_and_b32 s69, s69, 15
s_mul_i32 s67, s69, 128
s_mul_i32 s68, s69, 393216
s_add_u32 m0, s70, s65
s_nop 0
buffer_load_dwordx4 v20, s[24:27], s67 offen offset:0  lds
buffer_load_dwordx4 v21, s[24:27], s67 offen offset:1024  lds
buffer_load_dwordx4 v22, s[24:27], s67 offen offset:2048  lds
buffer_load_dwordx4 v23, s[24:27], s67 offen offset:3072  lds
s_add_u32 s60, s71, s65
s_add_u32 m0, s60, 0
s_add_u32 s61, s68, 0
buffer_load_dwordx4 v26, s[28:31], s61 offen lds
buffer_load_dwordx4 v27, s[28:31], s61 offen offset:1024 lds
s_add_u32 m0, s60, 8192
s_add_u32 s61, s68, 2048
buffer_load_dwordx4 v26, s[28:31], s61 offen lds
buffer_load_dwordx4 v27, s[28:31], s61 offen offset:1024 lds
s_add_u32 m0, s60, 16384
s_add_u32 s61, s68, 4096
buffer_load_dwordx4 v26, s[28:31], s61 offen lds
buffer_load_dwordx4 v27, s[28:31], s61 offen offset:1024 lds
s_add_u32 s65, s65, 40960
s_cmp_eq_u32 s65, 122880
s_cselect_b32 s65, 0, s65
s_add_u32 s64, s64, 1
s_mov_b32 s36, s8
s_and_b32 s37, s9, 0xffff
s_mov_b32 s38, 2097152
s_mov_b32 s39, 0x00020000
s_waitcnt vmcnt(10)
s_barrier
s_mov_b32 s63, 0
ipoll_4:
v_sad_u8 v4, v34, 0, 0
v_sad_u8 v4, v35, 0, v4
v_cmp_gt_u32 vcc, 32, v4
s_cbranch_vccz ipolled_5
global_load_dwordx2 v[34:35], v32, s[20:21] sc1
s_add_u32 s63, s63, 1
s_cmp_lt_u32 s63, 0x80000
s_waitcnt vmcnt(0)
s_cbranch_scc1 ipoll_4
ipolled_5:
buffer_load_dwordx4 v[80:83], v37, s[32:35], 0 offen offset:0 sc1
buffer_load_dwordx4 v[84:87], v37, s[32:35], 0 offen offset:1024 sc1
buffer_load_dwordx4 v[88:91], v37, s[32:35], 0 offen offset:2048 sc1
buffer_load_dwordx4 v[92:95], v37, s[32:35], 0 offen offset:3072 sc1
s_add_u32 s69, s47, 15
s_and_b32 s69, s69, 15
s_mul_i32 s67, s69, 128
s_mul_i32 s68, s69, 393216
s_add_u32 m0, s70, 0
s_nop 0
buffer_load_dwordx4 v20, s[24:27], s67 offen offset:0  lds
buffer_load_dwordx4 v21, s[24:27], s67 offen offset:1024  lds
buffer_load_dwordx4 v22, s[24:27], s67 offen offset:2048  lds
buffer_load_dwordx4 v23, s[24:27], s67 offen offset:3072  lds
s_add_u32 s60, s71, 0
s_add_u32 m0, s60, 0
s_add_u32 s61, s68, 0
buffer_load_dwordx4 v26, s[28:31], s61 offen lds
buffer_load_dwordx4 v27, s[28:31], s61 offen offset:1024 lds
s_waitcnt vmcnt(10)
s_barrier
s_setprio 2
s_add_u32 m0, s60, 8192
s_add_u32 s61, s68, 2048
buffer_load_dwordx4 v26, s[28:31], s61 offen lds
buffer_load_dwordx4 v27, s[28:31], s61 offen offset:1024 lds
s_waitcnt vmcnt(8)
s_add_u32 m0, s60, 16384
s_add_u32 s61, s68, 4096
buffer_load_dwordx4 v26, s[28:31], s61 offen lds
v_add_f32 v80, v80, v88
v_add_f32 v81, v81, v89
v_add_f32 v82, v82, v90
v_add_f32 v83, v83, v91
v_add_f32 v84, v84, v92
buffer_load_dwordx4 v27, s[28:31], s61 offen offset:1024 lds
v_add_f32 v85, v85, v93
v_add_f32 v86, v86, v94
v_add_f32 v87, v87, v95
v_add_f32 v80, v80, v84
buffer_load_dwordx4 v[64:67], v38, s[32:35], 0 offen offset:0 sc1
v_add_f32 v81, v81, v85
v_add_f32 v82, v82, v86
v_add_f32 v83, v83, v87
s_nop 1
buffer_load_dwordx4 v[68:71], v38, s[32:35], 0 offen offset:1024 sc1
v_permlane32_swap_b32 v80, v81
v_permlane32_swap_b32 v82, v83
v_add_f32 v80, v80, v81
v_add_f32 v82, v82, v83
buffer_load_dwordx4 v[72:75], v38, s[32:35], 0 offen offset:2048 sc1
s_nop 1
v_permlane16_swap_b32 v80, v82
s_nop 0
v_add_f32 v80, v80, v82
v_mul_f32 v44, 0x3a800000, v80
buffer_load_dwordx4 v[76:79], v38, s[32:35], 0 offen offset:3072 sc1
v_mov_b32 v45, v44
s_nop 1
v_permlane16_swap_b32 v44, v45
s_nop 0
s_add_u32 s48, s47, 15
s_and_b32 s48, s48, 15
s_lshl_b32 s48, s48, 17
s_add_u32 m0, s71, 106496
s_nop 0
buffer_load_dwordx4 v28, s[36:39], s48 offen lds
v_fma_f32 v45, -v44, v44, v45
v_max_f32 v45, 0, v45
v_add_f32 v45, 0x3727c5ac, v45
v_rsq_f32 v46, v45
buffer_load_dwordx4 v29, s[36:39], s48 offen offset:1024 lds
v_sub_f32 v47, 0, v44
ds_write_b32 v50, v47 offset:512
ds_write_b64 v49, v[46:47]
ds_write_b32 v50, v46
s_waitcnt vmcnt(6)
s_barrier
s_add_u32 s48, s47, 5
s_and_b32 s48, s48, 15
s_lshl_b32 s48, s48, 17
s_add_u32 m0, s71, 24576
s_nop 0
buffer_load_dwordx4 v28, s[36:39], s48 offen lds
buffer_load_dwordx4 v29, s[36:39], s48 offen offset:1024 lds
s_waitcnt vmcnt(4)
s_add_u32 s48, s47, 6
s_and_b32 s48, s48, 15
s_lshl_b32 s48, s48, 17
s_add_u32 m0, s71, 32768
s_nop 0
buffer_load_dwordx4 v28, s[36:39], s48 offen lds
v_add_f32 v64, v64, v72
v_add_f32 v65, v65, v73
v_add_f32 v66, v66, v74
v_add_f32 v67, v67, v75
buffer_load_dwordx4 v29, s[36:39], s48 offen offset:1024 lds
v_add_f32 v68, v68, v76
v_add_f32 v69, v69, v77
v_add_f32 v70, v70, v78
v_add_f32 v71, v71, v79
s_add_u32 s48, s47, 7
s_and_b32 s48, s48, 15
s_lshl_b32 s48, s48, 17
s_add_u32 m0, s71, 40960
s_nop 0
buffer_load_dwordx4 v28, s[36:39], s48 offen lds
v_add_f32 v64, v64, v68
v_add_f32 v65, v65, v69
v_add_f32 v66, v66, v70
buffer_load_dwordx4 v29, s[36:39], s48 offen offset:1024 lds
v_add_f32 v67, v67, v71
s_nop 1
v_permlane32_swap_b32 v64, v65
v_permlane32_swap_b32 v66, v67
s_add_u32 s48, s47, 8
s_and_b32 s48, s48, 15
s_lshl_b32 s48, s48, 17
s_add_u32 m0, s71, 49152
s_nop 0
buffer_load_dwordx4 v28, s[36:39], s48 offen lds
v_add_f32 v64, v64, v65
v_add_f32 v66, v66, v67
s_nop 1
v_permlane16_swap_b32 v64, v66
buffer_load_dwordx4 v29, s[36:39], s48 offen offset:1024 lds
s_nop 0
v_add_f32 v64, v64, v66
ds_write_b32 v53, v64
s_cmp_lg_u32 s43, 2
s_cbranch_scc1 else_6
s_and_b32 s50, s2, 7
v_readlane_b32 s52, v34, s50
v_readlane_b32 s53, v35, s50
s_lshl_b64 s[48:49], s[94:95], 5
v_mov_b32 v4, 134656
s_nop 1
s_cmp_eq_u64 s[48:49], s[52:53]
s_cselect_b32 s48, 1, 0
v_mov_b32 v5, s48
ds_write_b32 v4, v5
else_6:
s_setprio 0
s_waitcnt lgkmcnt(0)
s_waitcnt vmcnt(63)
s_barrier
s_add_u32 s48, s47, 9
s_and_b32 s48, s48, 15
s_lshl_b32 s48, s48, 17
s_add_u32 m0, s71, 57344
s_waitcnt vmcnt(4)
buffer_load_dwordx4 v28, s[36:39], s48 offen lds
buffer_load_dwordx4 v29, s[36:39], s48 offen offset:1024 lds
s_add_u32 s48, s47, 10
s_and_b32 s48, s48, 15
s_lshl_b32 s48, s48, 17
s_add_u32 m0, s71, 65536
s_waitcnt vmcnt(4)
buffer_load_dwordx4 v28, s[36:39], s48 offen lds
buffer_load_dwordx4 v29, s[36:39], s48 offen offset:1024 lds
s_add_u32 s48, s47, 11
s_and_b32 s48, s48, 15
s_lshl_b32 s48, s48, 17
s_add_u32 m0, s71, 73728
s_waitcnt vmcnt(4)
buffer_load_dwordx4 v28, s[36:39], s48 offen lds
buffer_load_dwordx4 v29, s[36:39], s48 offen offset:1024 lds
s_add_u32 s48, s47, 12
s_and_b32 s48, s48, 15
s_lshl_b32 s48, s48, 17
s_add_u32 m0, s71, 81920
s_waitcnt vmcnt(4)
buffer_load_dwordx4 v28, s[36:39], s48 offen lds
buffer_load_dwordx4 v29, s[36:39], s48 offen offset:1024 lds
s_add_u32 s48, s47, 13
s_and_b32 s48, s48, 15
s_lshl_b32 s48, s48, 17
s_add_u32 m0, s71, 90112
s_waitcnt vmcnt(4)
buffer_load_dwordx4 v28, s[36:39], s48 offen lds
buffer_load_dwordx4 v29, s[36:39], s48 offen offset:1024 lds
s_add_u32 s48, s47, 14
s_and_b32 s48, s48, 15
s_lshl_b32 s48, s48, 17
s_add_u32 m0, s71, 98304
s_waitcnt vmcnt(4)
buffer_load_dwordx4 v28, s[36:39], s48 offen lds
buffer_load_dwordx4 v29, s[36:39], s48 offen offset:1024 lds
s_add_u32 s48, s47, 0
s_and_b32 s48, s48, 15
s_lshl_b32 s48, s48, 17
s_add_u32 m0, s71, 4294950912
s_waitcnt vmcnt(4)
buffer_load_dwordx4 v28, s[36:39], s48 offen lds
buffer_load_dwordx4 v29, s[36:39], s48 offen offset:1024 lds
s_add_u32 s48, s47, 1
s_and_b32 s48, s48, 15
s_lshl_b32 s48, s48, 17
s_add_u32 m0, s71, 4294959104
s_waitcnt vmcnt(4)
buffer_load_dwordx4 v28, s[36:39], s48 offen lds
buffer_load_dwordx4 v29, s[36:39], s48 offen offset:1024 lds
s_add_u32 s48, s47, 2
s_and_b32 s48, s48, 15
s_lshl_b32 s48, s48, 17
s_add_u32 m0, s71, 0
s_waitcnt vmcnt(4)
buffer_load_dwordx4 v28, s[36:39], s48 offen lds
buffer_load_dwordx4 v29, s[36:39], s48 offen offset:1024 lds
s_add_u32 s48, s47, 3
s_and_b32 s48, s48, 15
s_lshl_b32 s48, s48, 17
s_add_u32 m0, s71, 8192
s_waitcnt vmcnt(4)
buffer_load_dwordx4 v28, s[36:39], s48 offen lds
buffer_load_dwordx4 v29, s[36:39], s48 offen offset:1024 lds
s_add_u32 s48, s47, 4
s_and_b32 s48, s48, 15
s_lshl_b32 s48, s48, 17
s_add_u32 m0, s71, 16384
s_waitcnt vmcnt(4)
buffer_load_dwordx4 v28, s[36:39], s48 offen lds
buffer_load_dwordx4 v29, s[36:39], s48 offen offset:1024 lds
s_mov_b32 s28, s12
s_and_b32 s29, s13, 0xffff
s_mov_b32 s30, 6291456
s_mov_b32 s31, 0x00020000
v_lshrrev_b32 v4, 3, v0
v_and_b32 v5, 7, v0
s_lshr_b32 s48, s43, 1
s_lshl_b32 s48, s48, 5
s_and_b32 s49, s43, 1
s_lshl_b32 s49, s49, 3
s_add_u32 s48, s48, s49
v_lshrrev_b32 v6, 2, v4
v_lshlrev_b32 v6, 4, v6
v_and_b32 v7, 3, v4
v_add3_u32 v6, v6, v7, s48
v_mul_u32_u24 v6, 6144, v6
v_and_b32 v7, 2, v4
v_xor_b32 v7, v7, v5
s_lshl_b32 s48, s42, 7
v_lshl_add_u32 v26, v7, 4, v6
v_add_u32 v26, s48, v26
v_xor_b32 v27, 64, v26
v_add_u32 v27, 23552, v27
s_add_u32 s69, s47, 0
s_and_b32 s69, s69, 15
s_mul_i32 s67, s69, 128
s_mul_i32 s68, s69, 393216
s_waitcnt vmcnt(0)
s_barrier
s_add_u32 s60, s71, 122880
s_add_u32 m0, s60, 0
s_add_u32 s61, s68, 0
buffer_load_dwordx4 v26, s[28:31], s61 offen lds
buffer_load_dwordx4 v27, s[28:31], s61 offen offset:1024 lds
s_add_u32 m0, s60, 8192
s_add_u32 s61, s68, 2048
buffer_load_dwordx4 v26, s[28:31], s61 offen lds
buffer_load_dwordx4 v27, s[28:31], s61 offen offset:1024 lds
s_add_u32 m0, s60, 16384
s_add_u32 s61, s68, 4096
buffer_load_dwordx4 v26, s[28:31], s61 offen lds
buffer_load_dwordx4 v27, s[28:31], s61 offen offset:1024 lds
s_mov_b32 s36, s14
s_and_b32 s37, s15, 0xffff
s_mov_b32 s38, 65536
s_mov_b32 s39, 0x00020000
s_lshl_b32 s48, s42, 12
s_lshl_b32 s49, s43, 10
s_add_u32 s48, s48, s49
s_add_u32 m0, s49, 135168
s_nop 0
buffer_load_dwordx4 v18, s[36:39], s48 offen lds
s_add_u32 s48, s80, 0
v_add_u32 v20, s48, v18
v_mov_b32 v21, v20
v_add_u32 v22, 30720, v20
v_mov_b32 v23, v22
s_lshl_b32 s50, s42, 2
s_add_u32 s50, s50, s43
s_lshl_b32 s50, s50, 12
s_add_u32 s50, s50, 17301504
v_add_u32 v38, s50, v18
v_min_u32 v4, 2, v3
v_lshlrev_b32 v4, 8, v4
v_lshl_add_u32 v4, v2, 2, v4
s_and_b32 s48, s43, 1
s_lshl_b32 s48, s48, 7
s_lshr_b32 s49, s43, 1
s_lshl_b32 s49, s49, 6
s_add_u32 s48, s48, s49
s_add_u32 s48, s48, 133888
v_add_u32 v53, s48, v4
s_getpc_b64 s[98:99]
pc_8:
s_add_u32 s98, s98, c1_last - pc_8
s_addc_u32 s99, s99, 0
s_lshr_b32 s50, s2, 3
s_lshl_b32 s50, s50, 2
s_add_u32 s50, s50, s43
s_lshl_b32 s50, s50, 7
v_and_b32 v4, 1, v0
v_lshl_add_u32 v4, v4, 6, s50
v_min_u32 v54, L_code_end - c1_last, v4
s_add_u32 s69, s47, 1
s_and_b32 s69, s69, 15
s_mul_i32 s67, s69, 2048
s_mul_i32 s68, s69, 393216
s_barrier
s_add_u32 s60, s71, 40960
s_add_u32 m0, s60, 0
s_add_u32 s61, s68, 0
buffer_load_dwordx4 v26, s[28:31], s61 offen lds
buffer_load_dwordx4 v27, s[28:31], s61 offen offset:1024 lds
s_add_u32 m0, s60, 8192
s_add_u32 s61, s68, 2048
buffer_load_dwordx4 v26, s[28:31], s61 offen lds
buffer_load_dwordx4 v27, s[28:31], s61 offen offset:1024 lds
s_add_u32 m0, s60, 16384
s_add_u32 s61, s68, 4096
buffer_load_dwordx4 v26, s[28:31], s61 offen lds
buffer_load_dwordx4 v27, s[28:31], s61 offen offset:1024 lds
s_add_u32 s49, s76, 2
s_and_b32 s49, s49, 15
s_mul_i32 s49, s49, 393216
buffer_load_dwordx4 v[40:43], v36, s[28:31], s49 offen
s_add_u32 s49, s76, 3
s_and_b32 s49, s49, 15
s_mul_i32 s49, s49, 393216
buffer_load_dwordx4 v[40:43], v36, s[28:31], s49 offen
buffer_load_dword v5, v30, s[32:35], s79 offen sc1
s_mov_b32 s63, 0
s_waitcnt vmcnt(0)
poll_9:
v_cmp_gt_u32 vcc, 1, v5
s_cbranch_vccz polled_10
buffer_load_dword v5, v30, s[32:35], s79 offen sc1
s_add_u32 s63, s63, 1
s_cmp_lt_u32 s63, 0x80000
s_waitcnt vmcnt(0)
s_cbranch_scc1 poll_9
polled_10:
s_add_u32 s69, s47, 0
s_and_b32 s69, s69, 15
s_mul_i32 s67, s69, 2048
s_mul_i32 s68, s69, 393216
s_add_u32 m0, s70, 0
s_nop 0
buffer_load_dwordx4 v20, s[32:35], s67 offen offset:0 sc1 lds
buffer_load_dwordx4 v21, s[32:35], s67 offen offset:1024 sc1 lds
buffer_load_dwordx4 v22, s[32:35], s67 offen offset:2048 sc1 lds
buffer_load_dwordx4 v23, s[32:35], s67 offen offset:3072 sc1 lds
s_add_u32 s69, s47, 1
s_and_b32 s69, s69, 15
s_mul_i32 s67, s69, 2048
s_mul_i32 s68, s69, 393216
s_add_u32 m0, s70, 40960
s_nop 0
buffer_load_dwordx4 v20, s[32:35], s67 offen offset:0 sc1 lds
buffer_load_dwordx4 v21, s[32:35], s67 offen offset:1024 sc1 lds
buffer_load_dwordx4 v22, s[32:35], s67 offen offset:2048 sc1 lds
buffer_load_dwordx4 v23, s[32:35], s67 offen offset:3072 sc1 lds
s_waitcnt vmcnt(4)
s_barrier
s_add_u32 s69, s47, 2
s_and_b32 s69, s69, 15
s_mul_i32 s67, s69, 2048
s_mul_i32 s68, s69, 393216
s_add_u32 m0, s70, 81920
s_nop 0
buffer_load_dwordx4 v20, s[32:35], s67 offen offset:0 sc1 lds
buffer_load_dwordx4 v21, s[32:35], s67 offen offset:1024 sc1 lds
buffer_load_dwordx4 v22, s[32:35], s67 offen offset:2048 sc1 lds
buffer_load_dwordx4 v23, s[32:35], s67 offen offset:3072 sc1 lds
s_add_u32 s60, s71, 81920
s_add_u32 m0, s60, 0
s_add_u32 s61, s68, 0
buffer_load_dwordx4 v26, s[28:31], s61 offen lds
buffer_load_dwordx4 v27, s[28:31], s61 offen offset:1024 lds
s_add_u32 m0, s60, 8192
s_add_u32 s61, s68, 2048
buffer_load_dwordx4 v26, s[28:31], s61 offen lds
buffer_load_dwordx4 v27, s[28:31], s61 offen offset:1024 lds
s_add_u32 m0, s60, 16384
s_add_u32 s61, s68, 4096
buffer_load_dwordx4 v26, s[28:31], s61 offen lds
buffer_load_dwordx4 v27, s[28:31], s61 offen offset:1024 lds
s_add_u32 s49, s76, 4
s_and_b32 s49, s49, 15
s_mul_i32 s49, s49, 393216
buffer_load_dwordx4 v[40:43], v36, s[28:31], s49 offen
s_mov_b32 s64, 0
s_mov_b32 s65, 0
h1_loop:
s_waitcnt vmcnt(11)
s_barrier
s_add_u32 s69, s69, 1
s_and_b32 s69, s69, 15
s_mul_i32 s67, s69, 2048
s_mul_i32 s68, s69, 393216
s_add_u32 m0, s70, s65
s_nop 0
buffer_load_dwordx4 v20, s[32:35], s67 offen offset:0 sc1 lds
buffer_load_dwordx4 v21, s[32:35], s67 offen offset:1024 sc1 lds
buffer_load_dwordx4 v22, s[32:35], s67 offen offset:2048 sc1 lds
buffer_load_dwordx4 v23, s[32:35], s67 offen offset:3072 sc1 lds
s_add_u32 s60, s71, s65
s_add_u32 m0, s60, 0
s_add_u32 s61, s68, 0
buffer_load_dwordx4 v26, s[28:31], s61 offen lds
buffer_load_dwordx4 v27, s[28:31], s61 offen offset:1024 lds
s_add_u32 m0, s60, 8192
s_add_u32 s61, s68, 2048
buffer_load_dwordx4 v26, s[28:31], s61 offen lds
buffer_load_dwordx4 v27, s[28:31], s61 offen offset:1024 lds
s_add_u32 m0, s60, 16384
s_add_u32 s61, s68, 4096
buffer_load_dwordx4 v26, s[28:31], s61 offen lds
buffer_load_dwordx4 v27, s[28:31], s61 offen offset:1024 lds
s_add_u32 s48, s64, 5
s_min_u32 s48, s48, 15
s_add_u32 s49, s48, s76
s_and_b32 s49, s49, 15
s_mul_i32 s49, s49, 393216
buffer_load_dwordx4 v[40:43], v36, s[28:31], s49 offen
s_add_u32 s65, s65, 40960
s_cmp_eq_u32 s65, 122880
s_cselect_b32 s65, 0, s65
s_add_u32 s64, s64, 1
s_cmp_lt_u32 s64, 11
s_cbranch_scc1 h1_loop
s_waitcnt vmcnt(11)
s_barrier
buffer_load_dword v31, v30, s[32:35], s72 offen sc1
buffer_load_dword v33, v30, s[32:35], s73 offen sc1
global_load_dword v48, v54, s[98:99]
s_add_u32 s69, s69, 1
s_and_b32 s69, s69, 15
s_mul_i32 s67, s69, 2048
s_mul_i32 s68, s69, 393216
s_add_u32 m0, s70, s65
s_nop 0
buffer_load_dwordx4 v20, s[32:35], s67 offen offset:0 sc1 lds
buffer_load_dwordx4 v21, s[32:35], s67 offen offset:1024 sc1 lds
buffer_load_dwordx4 v22, s[32:35], s67 offen offset:2048 sc1 lds
buffer_load_dwordx4 v23, s[32:35], s67 offen offset:3072 sc1 lds
s_add_u32 s60, s71, s65
s_add_u32 m0, s60, 0
s_add_u32 s61, s68, 0
buffer_load_dwordx4 v26, s[28:31], s61 offen lds
buffer_load_dwordx4 v27, s[28:31], s61 offen offset:1024 lds
s_add_u32 m0, s60, 8192
s_add_u32 s61, s68, 2048
buffer_load_dwordx4 v26, s[28:31], s61 offen lds
buffer_load_dwordx4 v27, s[28:31], s61 offen offset:1024 lds
s_add_u32 m0, s60, 16384
s_add_u32 s61, s68, 4096
buffer_load_dwordx4 v26, s[28:31], s61 offen lds
buffer_load_dwordx4 v27, s[28:31], s61 offen offset:1024 lds
s_add_u32 s65, s65, 40960
s_cmp_eq_u32 s65, 122880
s_cselect_b32 s65, 0, s65
s_add_u32 s64, s64, 1
s_mov_b32 s36, s16
s_and_b32 s37, s17, 0xffff
s_mov_b32 s38, 2097152
s_mov_b32 s39, 0x00020000
s_waitcnt vmcnt(10)
s_barrier
s_mov_b32 s63, 0
poll_11:
v_cmp_gt_u32 vcc, 1, v31
s_cbranch_vccz polled_12
buffer_load_dword v31, v30, s[32:35], s72 offen sc1
s_add_u32 s63, s63, 1
s_cmp_lt_u32 s63, 0x80000
s_waitcnt vmcnt(0)
s_cbranch_scc1 poll_11
polled_12:
s_mov_b32 s63, 0
poll_13:
v_cmp_gt_u32 vcc, 1, v33
s_cbranch_vccz polled_14
buffer_load_dword v33, v30, s[32:35], s73 offen sc1
s_add_u32 s63, s63, 1
s_cmp_lt_u32 s63, 0x80000
s_waitcnt vmcnt(0)
s_cbranch_scc1 poll_13
polled_14:
buffer_load_dwordx4 v[80:83], v37, s[32:35], 0 offen offset:0 sc1
buffer_load_dwordx4 v[84:87], v37, s[32:35], 0 offen offset:1024 sc1
buffer_load_dwordx4 v[88:91], v37, s[32:35], 0 offen offset:2048 sc1
buffer_load_dwordx4 v[92:95], v37, s[32:35], 0 offen offset:3072 sc1
s_add_u32 s69, s47, 15
s_and_b32 s69, s69, 15
s_mul_i32 s67, s69, 2048
s_mul_i32 s68, s69, 393216
s_add_u32 m0, s70, 0
s_nop 0
buffer_load_dwordx4 v20, s[32:35], s67 offen offset:0 sc1 lds
buffer_load_dwordx4 v21, s[32:35], s67 offen offset:1024 sc1 lds
buffer_load_dwordx4 v22, s[32:35], s67 offen offset:2048 sc1 lds
buffer_load_dwordx4 v23, s[32:35], s67 offen offset:3072 sc1 lds
s_add_u32 s60, s71, 0
s_add_u32 m0, s60, 0
s_add_u32 s61, s68, 0
buffer_load_dwordx4 v26, s[28:31], s61 offen lds
buffer_load_dwordx4 v27, s[28:31], s61 offen offset:1024 lds
s_waitcnt vmcnt(10)
s_barrier
s_setprio 2
s_add_u32 m0, s60, 8192
s_add_u32 s61, s68, 2048
buffer_load_dwordx4 v26, s[28:31], s61 offen lds
buffer_load_dwordx4 v27, s[28:31], s61 offen offset:1024 lds
s_waitcnt vmcnt(8)
s_add_u32 m0, s60, 16384
s_add_u32 s61, s68, 4096
buffer_load_dwordx4 v26, s[28:31], s61 offen lds
v_add_f32 v80, v80, v88
v_add_f32 v81, v81, v89
v_add_f32 v82, v82, v90
v_add_f32 v83, v83, v91
v_add_f32 v84, v84, v92
buffer_load_dwordx4 v27, s[28:31], s61 offen offset:1024 lds
v_add_f32 v85, v85, v93
v_add_f32 v86, v86, v94
v_add_f32 v87, v87, v95
v_add_f32 v80, v80, v84
buffer_load_dwordx4 v[64:67], v38, s[32:35], 0 offen offset:0 sc1
v_add_f32 v81, v81, v85
v_add_f32 v82, v82, v86
v_add_f32 v83, v83, v87
s_nop 1
buffer_load_dwordx4 v[68:71], v38, s[32:35], 0 offen offset:1024 sc1
v_permlane32_swap_b32 v80, v81
v_permlane32_swap_b32 v82, v83
v_add_f32 v80, v80, v81
v_add_f32 v82, v82, v83
buffer_load_dwordx4 v[72:75], v38, s[32:35], 0 offen offset:2048 sc1
s_nop 1
v_permlane16_swap_b32 v80, v82
s_nop 0
v_add_f32 v80, v80, v82
v_mul_f32 v44, 0x3a800000, v80
buffer_load_dwordx4 v[76:79], v38, s[32:35], 0 offen offset:3072 sc1
v_mov_b32 v45, v44
s_nop 1
v_permlane16_swap_b32 v44, v45
s_nop 0
s_add_u32 s48, s47, 15
s_and_b32 s48, s48, 15
s_lshl_b32 s48, s48, 17
s_add_u32 m0, s71, 106496
s_nop 0
buffer_load_dwordx4 v28, s[36:39], s48 offen lds
v_fma_f32 v45, -v44, v44, v45
v_max_f32 v45, 0, v45
v_add_f32 v45, 0x3727c5ac, v45
v_rsq_f32 v46, v45
buffer_load_dwordx4 v29, s[36:39], s48 offen offset:1024 lds
v_sub_f32 v47, 0, v44
ds_write_b32 v50, v47 offset:512
ds_write_b64 v49, v[46:47]
ds_write_b32 v50, v46
s_waitcnt vmcnt(6)
s_barrier
s_add_u32 s48, s47, 5
s_and_b32 s48, s48, 15
s_lshl_b32 s48, s48, 17
s_add_u32 m0, s71, 24576
s_nop 0
buffer_load_dwordx4 v28, s[36:39], s48 offen lds
buffer_load_dwordx4 v29, s[36:39], s48 offen offset:1024 lds
s_waitcnt vmcnt(4)
s_add_u32 s48, s47, 6
s_and_b32 s48, s48, 15
s_lshl_b32 s48, s48, 17
s_add_u32 m0, s71, 32768
s_nop 0
buffer_load_dwordx4 v28, s[36:39], s48 offen lds
v_add_f32 v64, v64, v72
v_add_f32 v65, v65, v73
v_add_f32 v66, v66, v74
v_add_f32 v67, v67, v75
buffer_load_dwordx4 v29, s[36:39], s48 offen offset:1024 lds
v_add_f32 v68, v68, v76
v_add_f32 v69, v69, v77
v_add_f32 v70, v70, v78
v_add_f32 v71, v71, v79
s_add_u32 s48, s47, 7
s_and_b32 s48, s48, 15
s_lshl_b32 s48, s48, 17
s_add_u32 m0, s71, 40960
s_nop 0
buffer_load_dwordx4 v28, s[36:39], s48 offen lds
v_add_f32 v64, v64, v68
v_add_f32 v65, v65, v69
v_add_f32 v66, v66, v70
buffer_load_dwordx4 v29, s[36:39], s48 offen offset:1024 lds
v_add_f32 v67, v67, v71
s_nop 1
v_permlane32_swap_b32 v64, v65
v_permlane32_swap_b32 v66, v67
s_add_u32 s48, s47, 8
s_and_b32 s48, s48, 15
s_lshl_b32 s48, s48, 17
s_add_u32 m0, s71, 49152
s_nop 0
buffer_load_dwordx4 v28, s[36:39], s48 offen lds
v_add_f32 v64, v64, v65
v_add_f32 v66, v66, v67
s_nop 1
v_permlane16_swap_b32 v64, v66
buffer_load_dwordx4 v29, s[36:39], s48 offen offset:1024 lds
s_nop 0
v_add_f32 v64, v64, v66
ds_write_b32 v53, v64
s_setprio 0
s_waitcnt lgkmcnt(0)
s_waitcnt vmcnt(63)
s_barrier
s_add_u32 s48, s47, 9
s_and_b32 s48, s48, 15
s_lshl_b32 s48, s48, 17
s_add_u32 m0, s71, 57344
s_waitcnt vmcnt(4)
buffer_load_dwordx4 v28, s[36:39], s48 offen lds
buffer_load_dwordx4 v29, s[36:39], s48 offen offset:1024 lds
s_add_u32 s48, s47, 10
s_and_b32 s48, s48, 15
s_lshl_b32 s48, s48, 17
s_add_u32 m0, s71, 65536
s_waitcnt vmcnt(4)
buffer_load_dwordx4 v28, s[36:39], s48 offen lds
buffer_load_dwordx4 v29, s[36:39], s48 offen offset:1024 lds
s_add_u32 s48, s47, 11
s_and_b32 s48, s48, 15
s_lshl_b32 s48, s48, 17
s_add_u32 m0, s71, 73728
s_waitcnt vmcnt(4)
buffer_load_dwordx4 v28, s[36:39], s48 offen lds
buffer_load_dwordx4 v29, s[36:39], s48 offen offset:1024 lds
s_add_u32 s48, s47, 12
s_and_b32 s48, s48, 15
s_lshl_b32 s48, s48, 17
s_add_u32 m0, s71, 81920
s_waitcnt vmcnt(4)
buffer_load_dwordx4 v28, s[36:39], s48 offen lds
buffer_load_dwordx4 v29, s[36:39], s48 offen offset:1024 lds
s_add_u32 s48, s47, 13
s_and_b32 s48, s48, 15
s_lshl_b32 s48, s48, 17
s_add_u32 m0, s71, 90112
s_waitcnt vmcnt(4)
buffer_load_dwordx4 v28, s[36:39], s48 offen lds
buffer_load_dwordx4 v29, s[36:39], s48 offen offset:1024 lds
s_add_u32 s48, s47, 14
s_and_b32 s48, s48, 15
s_lshl_b32 s48, s48, 17
s_add_u32 m0, s71, 98304
s_waitcnt vmcnt(4)
buffer_load_dwordx4 v28, s[36:39], s48 offen lds
buffer_load_dwordx4 v29, s[36:39], s48 offen offset:1024 lds
s_add_u32 s48, s47, 0
s_and_b32 s48, s48, 15
s_lshl_b32 s48, s48, 17
s_add_u32 m0, s71, 4294950912
s_waitcnt vmcnt(4)
buffer_load_dwordx4 v28, s[36:39], s48 offen lds
buffer_load_dwordx4 v29, s[36:39], s48 offen offset:1024 lds
s_add_u32 s48, s47, 1
s_and_b32 s48, s48, 15
s_lshl_b32 s48, s48, 17
s_add_u32 m0, s71, 4294959104
s_waitcnt vmcnt(4)
buffer_load_dwordx4 v28, s[36:39], s48 offen lds
buffer_load_dwordx4 v29, s[36:39], s48 offen offset:1024 lds
s_add_u32 s48, s47, 2
s_and_b32 s48, s48, 15
s_lshl_b32 s48, s48, 17
s_add_u32 m0, s71, 0
s_waitcnt vmcnt(4)
buffer_load_dwordx4 v28, s[36:39], s48 offen lds
buffer_load_dwordx4 v29, s[36:39], s48 offen offset:1024 lds
s_add_u32 s48, s47, 3
s_and_b32 s48, s48, 15
s_lshl_b32 s48, s48, 17
s_add_u32 m0, s71, 8192
s_waitcnt vmcnt(4)
buffer_load_dwordx4 v28, s[36:39], s48 offen lds
buffer_load_dwordx4 v29, s[36:39], s48 offen offset:1024 lds
s_add_u32 s48, s47, 4
s_and_b32 s48, s48, 15
s_lshl_b32 s48, s48, 17
s_add_u32 m0, s71, 16384
s_waitcnt vmcnt(4)
buffer_load_dwordx4 v28, s[36:39], s48 offen lds
buffer_load_dwordx4 v29, s[36:39], s48 offen offset:1024 lds
buffer_load_dwordx4 v[112:115], v18, s[32:35], s81 offen offset:0 sc1
buffer_load_dwordx4 v[116:119], v18, s[32:35], s81 offen offset:1024 sc1
buffer_load_dwordx4 v[120:123], v18, s[32:35], s82 offen offset:0 sc1
buffer_load_dwordx4 v[124:127], v18, s[32:35], s82 offen offset:1024 sc1
s_mov_b32 s28, s6
s_and_b32 s29, s7, 0xffff
s_mov_b32 s30, 6291456
s_mov_b32 s31, 0x00020000
s_add_u32 s69, s47, 0
s_and_b32 s69, s69, 15
s_mul_i32 s67, s69, 2048
s_mul_i32 s68, s69, 393216
s_waitcnt vmcnt(0)
s_barrier
s_add_u32 s60, s71, 122880
s_add_u32 m0, s60, 0
s_add_u32 s61, s68, 0
buffer_load_dwordx4 v26, s[28:31], s61 offen lds
buffer_load_dwordx4 v27, s[28:31], s61 offen offset:1024 lds
s_add_u32 m0, s60, 8192
s_add_u32 s61, s68, 2048
buffer_load_dwordx4 v26, s[28:31], s61 offen lds
buffer_load_dwordx4 v27, s[28:31], s61 offen offset:1024 lds
s_add_u32 m0, s60, 16384
s_add_u32 s61, s68, 4096
buffer_load_dwordx4 v26, s[28:31], s61 offen lds
buffer_load_dwordx4 v27, s[28:31], s61 offen offset:1024 lds
s_getpc_b64 s[98:99]
pc_15:
s_add_u32 s98, s98, c2_last - pc_15
s_addc_u32 s99, s99, 0
s_lshr_b32 s50, s2, 3
s_lshl_b32 s50, s50, 2
s_add_u32 s50, s50, s43
s_lshl_b32 s50, s50, 7
v_and_b32 v4, 1, v0
v_lshl_add_u32 v4, v4, 6, s50
v_min_u32 v54, L_code_end - c2_last, v4
s_add_u32 s69, s47, 1
s_and_b32 s69, s69, 15
s_mul_i32 s67, s69, 2048
s_mul_i32 s68, s69, 393216
s_barrier
s_add_u32 s60, s71, 40960
s_add_u32 m0, s60, 0
s_add_u32 s61, s68, 0
buffer_load_dwordx4 v26, s[28:31], s61 offen lds
buffer_load_dwordx4 v27, s[28:31], s61 offen offset:1024 lds
s_add_u32 m0, s60, 8192
s_add_u32 s61, s68, 2048
buffer_load_dwordx4 v26, s[28:31], s61 offen lds
buffer_load_dwordx4 v27, s[28:31], s61 offen offset:1024 lds
s_add_u32 m0, s60, 16384
s_add_u32 s61, s68, 4096
buffer_load_dwordx4 v26, s[28:31], s61 offen lds
buffer_load_dwordx4 v27, s[28:31], s61 offen offset:1024 lds
s_add_u32 s49, s76, 2
s_and_b32 s49, s49, 15
s_mul_i32 s49, s49, 393216
buffer_load_dwordx4 v[40:43], v36, s[28:31], s49 offen
s_add_u32 s49, s76, 3
s_and_b32 s49, s49, 15
s_mul_i32 s49, s49, 393216
buffer_load_dwordx4 v[40:43], v36, s[28:31], s49 offen
buffer_load_dword v5, v30, s[32:35], s79 offen sc1
s_mov_b32 s63, 0
s_waitcnt vmcnt(0)
poll_16:
v_cmp_gt_u32 vcc, 2, v5
s_cbranch_vccz polled_17
buffer_load_dword v5, v30, s[32:35], s79 offen sc1
s_add_u32 s63, s63, 1
s_cmp_lt_u32 s63, 0x80000
s_waitcnt vmcnt(0)
s_cbranch_scc1 poll_16
polled_17:
s_add_u32 s69, s47, 0
s_and_b32 s69, s69, 15
s_mul_i32 s67, s69, 2048
s_mul_i32 s68, s69, 393216
s_add_u32 m0, s70, 0
s_nop 0
buffer_load_dwordx4 v20, s[32:35], s67 offen offset:0 sc1 lds
buffer_load_dwordx4 v21, s[32:35], s67 offen offset:1024 sc1 lds
buffer_load_dwordx4 v22, s[32:35], s67 offen offset:2048 sc1 lds
buffer_load_dwordx4 v23, s[32:35], s67 offen offset:3072 sc1 lds
s_add_u32 s69, s47, 1
s_and_b32 s69, s69, 15
s_mul_i32 s67, s69, 2048
s_mul_i32 s68, s69, 393216
s_add_u32 m0, s70, 40960
s_nop 0
buffer_load_dwordx4 v20, s[32:35], s67 offen offset:0 sc1 lds
buffer_load_dwordx4 v21, s[32:35], s67 offen offset:1024 sc1 lds
buffer_load_dwordx4 v22, s[32:35], s67 offen offset:2048 sc1 lds
buffer_load_dwordx4 v23, s[32:35], s67 offen offset:3072 sc1 lds
s_waitcnt vmcnt(4)
s_barrier
s_add_u32 s69, s47, 2
s_and_b32 s69, s69, 15
s_mul_i32 s67, s69, 2048
s_mul_i32 s68, s69, 393216
s_add_u32 m0, s70, 81920
s_nop 0
buffer_load_dwordx4 v20, s[32:35], s67 offen offset:0 sc1 lds
buffer_load_dwordx4 v21, s[32:35], s67 offen offset:1024 sc1 lds
buffer_load_dwordx4 v22, s[32:35], s67 offen offset:2048 sc1 lds
buffer_load_dwordx4 v23, s[32:35], s67 offen offset:3072 sc1 lds
s_add_u32 s60, s71, 81920
s_add_u32 m0, s60, 0
s_add_u32 s61, s68, 0
buffer_load_dwordx4 v26, s[28:31], s61 offen lds
buffer_load_dwordx4 v27, s[28:31], s61 offen offset:1024 lds
s_add_u32 m0, s60, 8192
s_add_u32 s61, s68, 2048
buffer_load_dwordx4 v26, s[28:31], s61 offen lds
buffer_load_dwordx4 v27, s[28:31], s61 offen offset:1024 lds
s_add_u32 m0, s60, 16384
s_add_u32 s61, s68, 4096
buffer_load_dwordx4 v26, s[28:31], s61 offen lds
buffer_load_dwordx4 v27, s[28:31], s61 offen offset:1024 lds
s_add_u32 s49, s76, 4
s_and_b32 s49, s49, 15
s_mul_i32 s49, s49, 393216
buffer_load_dwordx4 v[40:43], v36, s[28:31], s49 offen
s_mov_b32 s64, 0
s_mov_b32 s65, 0
h2_loop:
s_waitcnt vmcnt(11)
s_barrier
s_add_u32 s69, s69, 1
s_and_b32 s69, s69, 15
s_mul_i32 s67, s69, 2048
s_mul_i32 s68, s69, 393216
s_add_u32 m0, s70, s65
s_nop 0
buffer_load_dwordx4 v20, s[32:35], s67 offen offset:0 sc1 lds
buffer_load_dwordx4 v21, s[32:35], s67 offen offset:1024 sc1 lds
buffer_load_dwordx4 v22, s[32:35], s67 offen offset:2048 sc1 lds
buffer_load_dwordx4 v23, s[32:35], s67 offen offset:3072 sc1 lds
s_add_u32 s60, s71, s65
s_add_u32 m0, s60, 0
s_add_u32 s61, s68, 0
buffer_load_dwordx4 v26, s[28:31], s61 offen lds
buffer_load_dwordx4 v27, s[28:31], s61 offen offset:1024 lds
s_add_u32 m0, s60, 8192
s_add_u32 s61, s68, 2048
buffer_load_dwordx4 v26, s[28:31], s61 offen lds
buffer_load_dwordx4 v27, s[28:31], s61 offen offset:1024 lds
s_add_u32 m0, s60, 16384
s_add_u32 s61, s68, 4096
buffer_load_dwordx4 v26, s[28:31], s61 offen lds
buffer_load_dwordx4 v27, s[28:31], s61 offen offset:1024 lds
s_add_u32 s48, s64, 5
s_min_u32 s48, s48, 15
s_add_u32 s49, s48, s76
s_and_b32 s49, s49, 15
s_mul_i32 s49, s49, 393216
buffer_load_dwordx4 v[40:43], v36, s[28:31], s49 offen
s_add_u32 s65, s65, 40960
s_cmp_eq_u32 s65, 122880
s_cselect_b32 s65, 0, s65
s_add_u32 s64, s64, 1
s_cmp_lt_u32 s64, 11
s_cbranch_scc1 h2_loop
s_waitcnt vmcnt(11)
s_barrier
buffer_load_dword v31, v30, s[32:35], s72 offen sc1
global_load_dword v48, v54, s[98:99]
s_add_u32 s69, s69, 1
s_and_b32 s69, s69, 15
s_mul_i32 s67, s69, 2048
s_mul_i32 s68, s69, 393216
s_add_u32 m0, s70, s65
s_nop 0
buffer_load_dwordx4 v20, s[32:35], s67 offen offset:0 sc1 lds
buffer_load_dwordx4 v21, s[32:35], s67 offen offset:1024 sc1 lds
buffer_load_dwordx4 v22, s[32:35], s67 offen offset:2048 sc1 lds
buffer_load_dwordx4 v23, s[32:35], s67 offen offset:3072 sc1 lds
s_add_u32 s60, s71, s65
s_add_u32 m0, s60, 0
s_add_u32 s61, s68, 0
buffer_load_dwordx4 v26, s[28:31], s61 offen lds
buffer_load_dwordx4 v27, s[28:31], s61 offen offset:1024 lds
s_add_u32 m0, s60, 8192
s_add_u32 s61, s68, 2048
buffer_load_dwordx4 v26, s[28:31], s61 offen lds
buffer_load_dwordx4 v27, s[28:31], s61 offen offset:1024 lds
s_add_u32 m0, s60, 16384
s_add_u32 s61, s68, 4096
buffer_load_dwordx4 v26, s[28:31], s61 offen lds
buffer_load_dwordx4 v27, s[28:31], s61 offen offset:1024 lds
s_add_u32 s65, s65, 40960
s_cmp_eq_u32 s65, 122880
s_cselect_b32 s65, 0, s65
s_add_u32 s64, s64, 1
s_mov_b32 s36, s8
s_and_b32 s37, s9, 0xffff
s_mov_b32 s38, 2097152
s_mov_b32 s39, 0x00020000
s_waitcnt vmcnt(10)
s_barrier
s_mov_b32 s63, 0
poll_18:
v_cmp_gt_u32 vcc, 2, v31
s_cbranch_vccz polled_19
buffer_load_dword v31, v30, s[32:35], s72 offen sc1
s_add_u32 s63, s63, 1
s_cmp_lt_u32 s63, 0x80000
s_waitcnt vmcnt(0)
s_cbranch_scc1 poll_18
polled_19:
buffer_load_dwordx4 v[80:83], v37, s[32:35], 0 offen offset:0 sc1
buffer_load_dwordx4 v[84:87], v37, s[32:35], 0 offen offset:1024 sc1
buffer_load_dwordx4 v[88:91], v37, s[32:35], 0 offen offset:2048 sc1
buffer_load_dwordx4 v[92:95], v37, s[32:35], 0 offen offset:3072 sc1
s_add_u32 s69, s47, 15
s_and_b32 s69, s69, 15
s_mul_i32 s67, s69, 2048
s_mul_i32 s68, s69, 393216
s_add_u32 m0, s70, 0
s_nop 0
buffer_load_dwordx4 v20, s[32:35], s67 offen offset:0 sc1 lds
buffer_load_dwordx4 v21, s[32:35], s67 offen offset:1024 sc1 lds
buffer_load_dwordx4 v22, s[32:35], s67 offen offset:2048 sc1 lds
buffer_load_dwordx4 v23, s[32:35], s67 offen offset:3072 sc1 lds
s_add_u32 s60, s71, 0
s_add_u32 m0, s60, 0
s_add_u32 s61, s68, 0
buffer_load_dwordx4 v26, s[28:31], s61 offen lds
buffer_load_dwordx4 v27, s[28:31], s61 offen offset:1024 lds
s_waitcnt vmcnt(10)
s_barrier
s_setprio 2
s_add_u32 m0, s60, 8192
s_add_u32 s61, s68, 2048
buffer_load_dwordx4 v26, s[28:31], s61 offen lds
buffer_load_dwordx4 v27, s[28:31], s61 offen offset:1024 lds
s_waitcnt vmcnt(8)
s_add_u32 m0, s60, 16384
s_add_u32 s61, s68, 4096
buffer_load_dwordx4 v26, s[28:31], s61 offen lds
v_add_f32 v80, v80, v88
v_add_f32 v81, v81, v89
buffer_load_dwordx4 v27, s[28:31], s61 offen offset:1024 lds
v_add_f32 v82, v82, v90
v_add_f32 v83, v83, v91
s_add_u32 s48, s47, 15
s_and_b32 s48, s48, 15
s_lshl_b32 s48, s48, 17
s_add_u32 m0, s71, 106496
s_nop 0
buffer_load_dwordx4 v28, s[36:39], s48 offen lds
v_add_f32 v84, v84, v92
v_add_f32 v85, v85, v93
buffer_load_dwordx4 v29, s[36:39], s48 offen offset:1024 lds
v_add_f32 v86, v86, v94
s_add_u32 s48, s47, 5
s_and_b32 s48, s48, 15
s_lshl_b32 s48, s48, 17
s_add_u32 m0, s71, 24576
s_nop 0
buffer_load_dwordx4 v28, s[36:39], s48 offen lds
v_add_f32 v87, v87, v95
v_add_f32 v80, v80, v84
buffer_load_dwordx4 v29, s[36:39], s48 offen offset:1024 lds
v_add_f32 v81, v81, v85
v_add_f32 v82, v82, v86
s_add_u32 s48, s47, 6
s_and_b32 s48, s48, 15
s_lshl_b32 s48, s48, 17
s_add_u32 m0, s71, 32768
s_nop 0
buffer_load_dwordx4 v28, s[36:39], s48 offen lds
v_add_f32 v83, v83, v87
s_nop 1
buffer_load_dwordx4 v29, s[36:39], s48 offen offset:1024 lds
v_permlane32_swap_b32 v80, v81
s_waitcnt vmcnt(6)
s_barrier
s_add_u32 s48, s47, 7
s_and_b32 s48, s48, 15
s_lshl_b32 s48, s48, 17
s_add_u32 m0, s71, 40960
s_nop 0
buffer_load_dwordx4 v28, s[36:39], s48 offen lds
v_permlane32_swap_b32 v82, v83
v_add_f32 v80, v80, v81
v_add_f32 v82, v82, v83
buffer_load_dwordx4 v29, s[36:39], s48 offen offset:1024 lds
s_nop 1
v_permlane16_swap_b32 v80, v82
s_add_u32 s48, s47, 8
s_and_b32 s48, s48, 15
s_lshl_b32 s48, s48, 17
s_add_u32 m0, s71, 49152
s_nop 0
buffer_load_dwordx4 v28, s[36:39], s48 offen lds
s_nop 0
v_add_f32 v80, v80, v82
v_mul_f32 v44, 0x3a800000, v80
buffer_load_dwordx4 v29, s[36:39], s48 offen offset:1024 lds
v_mov_b32 v45, v44
s_nop 1
s_add_u32 s48, s47, 9
s_and_b32 s48, s48, 15
s_lshl_b32 s48, s48, 17
s_add_u32 m0, s71, 57344
s_nop 0
buffer_load_dwordx4 v28, s[36:39], s48 offen lds
v_permlane16_swap_b32 v44, v45
s_nop 0
v_fma_f32 v45, -v44, v44, v45
buffer_load_dwordx4 v29, s[36:39], s48 offen offset:1024 lds
v_max_f32 v45, 0, v45
v_add_f32 v45, 0x3727c5ac, v45
s_add_u32 s48, s47, 10
s_and_b32 s48, s48, 15
s_lshl_b32 s48, s48, 17
s_add_u32 m0, s71, 65536
s_nop 0
buffer_load_dwordx4 v28, s[36:39], s48 offen lds
v_rsq_f32 v46, v45
v_sub_f32 v47, 0, v44
ds_write_b32 v50, v47 offset:512
buffer_load_dwordx4 v29, s[36:39], s48 offen offset:1024 lds
ds_write_b64 v49, v[46:47]
ds_write_b32 v50, v46
s_setprio 0
s_waitcnt lgkmcnt(0)
s_waitcnt vmcnt(63)
s_barrier
s_add_u32 s48, s47, 11
s_and_b32 s48, s48, 15
s_lshl_b32 s48, s48, 17
s_add_u32 m0, s71, 73728
s_waitcnt vmcnt(4)
buffer_load_dwordx4 v28, s[36:39], s48 offen lds
buffer_load_dwordx4 v29, s[36:39], s48 offen offset:1024 lds
s_add_u32 s48, s47, 12
s_and_b32 s48, s48, 15
s_lshl_b32 s48, s48, 17
s_add_u32 m0, s71, 81920
s_waitcnt vmcnt(4)
buffer_load_dwordx4 v28, s[36:39], s48 offen lds
buffer_load_dwordx4 v29, s[36:39], s48 offen offset:1024 lds
s_add_u32 s48, s47, 13
s_and_b32 s48, s48, 15
s_lshl_b32 s48, s48, 17
s_add_u32 m0, s71, 90112
s_waitcnt vmcnt(4)
buffer_load_dwordx4 v28, s[36:39], s48 offen lds
buffer_load_dwordx4 v29, s[36:39], s48 offen offset:1024 lds
s_add_u32 s48, s47, 14
s_and_b32 s48, s48, 15
s_lshl_b32 s48, s48, 17
s_add_u32 m0, s71, 98304
s_waitcnt vmcnt(4)
buffer_load_dwordx4 v28, s[36:39], s48 offen lds
buffer_load_dwordx4 v29, s[36:39], s48 offen offset:1024 lds
s_add_u32 s48, s47, 0
s_and_b32 s48, s48, 15
s_lshl_b32 s48, s48, 17
s_add_u32 m0, s71, 4294950912
s_waitcnt vmcnt(4)
buffer_load_dwordx4 v28, s[36:39], s48 offen lds
buffer_load_dwordx4 v29, s[36:39], s48 offen offset:1024 lds
s_add_u32 s48, s47, 1
s_and_b32 s48, s48, 15
s_lshl_b32 s48, s48, 17
s_add_u32 m0, s71, 4294959104
s_waitcnt vmcnt(4)
buffer_load_dwordx4 v28, s[36:39], s48 offen lds
buffer_load_dwordx4 v29, s[36:39], s48 offen offset:1024 lds
s_add_u32 s48, s47, 2
s_and_b32 s48, s48, 15
s_lshl_b32 s48, s48, 17
s_add_u32 m0, s71, 0
s_waitcnt vmcnt(4)
buffer_load_dwordx4 v28, s[36:39], s48 offen lds
buffer_load_dwordx4 v29, s[36:39], s48 offen offset:1024 lds
s_add_u32 s48, s47, 3
s_and_b32 s48, s48, 15
s_lshl_b32 s48, s48, 17
s_add_u32 m0, s71, 8192
s_waitcnt vmcnt(4)
buffer_load_dwordx4 v28, s[36:39], s48 offen lds
buffer_load_dwordx4 v29, s[36:39], s48 offen offset:1024 lds
s_add_u32 s48, s47, 4
s_and_b32 s48, s48, 15
s_lshl_b32 s48, s48, 17
s_add_u32 m0, s71, 16384
s_waitcnt vmcnt(4)
buffer_load_dwordx4 v28, s[36:39], s48 offen lds
buffer_load_dwordx4 v29, s[36:39], s48 offen offset:1024 lds
s_mov_b32 s28, s12
s_and_b32 s29, s13, 0xffff
s_mov_b32 s30, 6291456
s_mov_b32 s31, 0x00020000
s_add_u32 s69, s47, 0
s_and_b32 s69, s69, 15
s_mul_i32 s67, s69, 2048
s_mul_i32 s68, s69, 393216
s_waitcnt vmcnt(0)
s_barrier
s_add_u32 s60, s71, 122880
s_add_u32 m0, s60, 0
s_add_u32 s61, s68, 0
buffer_load_dwordx4 v26, s[28:31], s61 offen lds
buffer_load_dwordx4 v27, s[28:31], s61 offen offset:1024 lds
s_add_u32 m0, s60, 8192
s_add_u32 s61, s68, 2048
buffer_load_dwordx4 v26, s[28:31], s61 offen lds
buffer_load_dwordx4 v27, s[28:31], s61 offen offset:1024 lds
s_add_u32 m0, s60, 16384
s_add_u32 s61, s68, 4096
buffer_load_dwordx4 v26, s[28:31], s61 offen lds
buffer_load_dwordx4 v27, s[28:31], s61 offen offset:1024 lds
s_mov_b32 s36, s14
s_and_b32 s37, s15, 0xffff
s_mov_b32 s38, 65536
s_mov_b32 s39, 0x00020000
s_lshl_b32 s48, s42, 12
s_lshl_b32 s49, s43, 10
s_add_u32 s48, s48, s49
s_add_u32 m0, s49, 135168
s_nop 0
buffer_load_dwordx4 v18, s[36:39], s48 offen lds
s_getpc_b64 s[98:99]
pc_20:
s_add_u32 s98, s98, c3_last - pc_20
s_addc_u32 s99, s99, 0
s_lshr_b32 s50, s2, 3
s_lshl_b32 s50, s50, 2
s_add_u32 s50, s50, s43
s_lshl_b32 s50, s50, 7
v_and_b32 v4, 1, v0
v_lshl_add_u32 v4, v4, 6, s50
v_min_u32 v54, L_code_end - c3_last, v4
s_add_u32 s69, s47, 1
s_and_b32 s69, s69, 15
s_mul_i32 s67, s69, 2048
s_mul_i32 s68, s69, 393216
s_barrier
s_add_u32 s60, s71, 40960
s_add_u32 m0, s60, 0
s_add_u32 s61, s68, 0
buffer_load_dwordx4 v26, s[28:31], s61 offen lds
buffer_load_dwordx4 v27, s[28:31], s61 offen offset:1024 lds
s_add_u32 m0, s60, 8192
s_add_u32 s61, s68, 2048
buffer_load_dwordx4 v26, s[28:31], s61 offen lds
buffer_load_dwordx4 v27, s[28:31], s61 offen offset:1024 lds
s_add_u32 m0, s60, 16384
s_add_u32 s61, s68, 4096
buffer_load_dwordx4 v26, s[28:31], s61 offen lds
buffer_load_dwordx4 v27, s[28:31], s61 offen offset:1024 lds
s_add_u32 s49, s76, 2
s_and_b32 s49, s49, 15
s_mul_i32 s49, s49, 393216
buffer_load_dwordx4 v[40:43], v36, s[28:31], s49 offen
s_add_u32 s49, s76, 3
s_and_b32 s49, s49, 15
s_mul_i32 s49, s49, 393216
buffer_load_dwordx4 v[40:43], v36, s[28:31], s49 offen
buffer_load_dword v5, v30, s[32:35], s79 offen sc1
s_mov_b32 s63, 0
s_waitcnt vmcnt(0)
poll_21:
v_cmp_gt_u32 vcc, 3, v5
s_cbranch_vccz polled_22
buffer_load_dword v5, v30, s[32:35], s79 offen sc1
s_add_u32 s63, s63, 1
s_cmp_lt_u32 s63, 0x80000
s_waitcnt vmcnt(0)
s_cbranch_scc1 poll_21
polled_22:
s_add_u32 s69, s47, 0
s_and_b32 s69, s69, 15
s_mul_i32 s67, s69, 2048
s_mul_i32 s68, s69, 393216
s_add_u32 m0, s70, 0
s_nop 0
buffer_load_dwordx4 v20, s[32:35], s67 offen offset:0 sc1 lds
buffer_load_dwordx4 v21, s[32:35], s67 offen offset:1024 sc1 lds
buffer_load_dwordx4 v22, s[32:35], s67 offen offset:2048 sc1 lds
buffer_load_dwordx4 v23, s[32:35], s67 offen offset:3072 sc1 lds
s_add_u32 s69, s47, 1
s_and_b32 s69, s69, 15
s_mul_i32 s67, s69, 2048
s_mul_i32 s68, s69, 393216
s_add_u32 m0, s70, 40960
s_nop 0
buffer_load_dwordx4 v20, s[32:35], s67 offen offset:0 sc1 lds
buffer_load_dwordx4 v21, s[32:35], s67 offen offset:1024 sc1 lds
buffer_load_dwordx4 v22, s[32:35], s67 offen offset:2048 sc1 lds
buffer_load_dwordx4 v23, s[32:35], s67 offen offset:3072 sc1 lds
s_waitcnt vmcnt(4)
s_barrier
s_add_u32 s69, s47, 2
s_and_b32 s69, s69, 15
s_mul_i32 s67, s69, 2048
s_mul_i32 s68, s69, 393216
s_add_u32 m0, s70, 81920
s_nop 0
buffer_load_dwordx4 v20, s[32:35], s67 offen offset:0 sc1 lds
buffer_load_dwordx4 v21, s[32:35], s67 offen offset:1024 sc1 lds
buffer_load_dwordx4 v22, s[32:35], s67 offen offset:2048 sc1 lds
buffer_load_dwordx4 v23, s[32:35], s67 offen offset:3072 sc1 lds
s_add_u32 s60, s71, 81920
s_add_u32 m0, s60, 0
s_add_u32 s61, s68, 0
buffer_load_dwordx4 v26, s[28:31], s61 offen lds
buffer_load_dwordx4 v27, s[28:31], s61 offen offset:1024 lds
s_add_u32 m0, s60, 8192
s_add_u32 s61, s68, 2048
buffer_load_dwordx4 v26, s[28:31], s61 offen lds
buffer_load_dwordx4 v27, s[28:31], s61 offen offset:1024 lds
s_add_u32 m0, s60, 16384
s_add_u32 s61, s68, 4096
buffer_load_dwordx4 v26, s[28:31], s61 offen lds
buffer_load_dwordx4 v27, s[28:31], s61 offen offset:1024 lds
s_add_u32 s49, s76, 4
s_and_b32 s49, s49, 15
s_mul_i32 s49, s49, 393216
buffer_load_dwordx4 v[40:43], v36, s[28:31], s49 offen
s_mov_b32 s64, 0
s_mov_b32 s65, 0
h3_loop:
s_waitcnt vmcnt(11)
s_barrier
s_add_u32 s69, s69, 1
s_and_b32 s69, s69, 15
s_mul_i32 s67, s69, 2048
s_mul_i32 s68, s69, 393216
s_add_u32 m0, s70, s65
s_nop 0
buffer_load_dwordx4 v20, s[32:35], s67 offen offset:0 sc1 lds
buffer_load_dwordx4 v21, s[32:35], s67 offen offset:1024 sc1 lds
buffer_load_dwordx4 v22, s[32:35], s67 offen offset:2048 sc1 lds
buffer_load_dwordx4 v23, s[32:35], s67 offen offset:3072 sc1 lds
s_add_u32 s60, s71, s65
s_add_u32 m0, s60, 0
s_add_u32 s61, s68, 0
buffer_load_dwordx4 v26, s[28:31], s61 offen lds
buffer_load_dwordx4 v27, s[28:31], s61 offen offset:1024 lds
s_add_u32 m0, s60, 8192
s_add_u32 s61, s68, 2048
buffer_load_dwordx4 v26, s[28:31], s61 offen lds
buffer_load_dwordx4 v27, s[28:31], s61 offen offset:1024 lds
s_add_u32 m0, s60, 16384
s_add_u32 s61, s68, 4096
buffer_load_dwordx4 v26, s[28:31], s61 offen lds
buffer_load_dwordx4 v27, s[28:31], s61 offen offset:1024 lds
s_add_u32 s48, s64, 5
s_min_u32 s48, s48, 15
s_add_u32 s49, s48, s76
s_and_b32 s49, s49, 15
s_mul_i32 s49, s49, 393216
buffer_load_dwordx4 v[40:43], v36, s[28:31], s49 offen
s_add_u32 s65, s65, 40960
s_cmp_eq_u32 s65, 122880
s_cselect_b32 s65, 0, s65
s_add_u32 s64, s64, 1
s_cmp_lt_u32 s64, 11
s_cbranch_scc1 h3_loop
s_waitcnt vmcnt(11)
s_barrier
buffer_load_dword v31, v30, s[32:35], s72 offen sc1
global_load_dword v48, v54, s[98:99]
s_add_u32 s69, s69, 1
s_and_b32 s69, s69, 15
s_mul_i32 s67, s69, 2048
s_mul_i32 s68, s69, 393216
s_add_u32 m0, s70, s65
s_nop 0
buffer_load_dwordx4 v20, s[32:35], s67 offen offset:0 sc1 lds
buffer_load_dwordx4 v21, s[32:35], s67 offen offset:1024 sc1 lds
buffer_load_dwordx4 v22, s[32:35], s67 offen offset:2048 sc1 lds
buffer_load_dwordx4 v23, s[32:35], s67 offen offset:3072 sc1 lds
s_add_u32 s60, s71, s65
s_add_u32 m0, s60, 0
s_add_u32 s61, s68, 0
buffer_load_dwordx4 v26, s[28:31], s61 offen lds
buffer_load_dwordx4 v27, s[28:31], s61 offen offset:1024 lds
s_add_u32 m0, s60, 8192
s_add_u32 s61, s68, 2048
buffer_load_dwordx4 v26, s[28:31], s61 offen lds
buffer_load_dwordx4 v27, s[28:31], s61 offen offset:1024 lds
s_add_u32 m0, s60, 16384
s_add_u32 s61, s68, 4096
buffer_load_dwordx4 v26, s[28:31], s61 offen lds
buffer_load_dwordx4 v27, s[28:31], s61 offen offset:1024 lds
s_add_u32 s65, s65, 40960
s_cmp_eq_u32 s65, 122880
s_cselect_b32 s65, 0, s65
s_add_u32 s64, s64, 1
s_mov_b32 s36, s16
s_and_b32 s37, s17, 0xffff
s_mov_b32 s38, 2097152
s_mov_b32 s39, 0x00020000
s_waitcnt vmcnt(10)
s_barrier
s_mov_b32 s63, 0
poll_23:
v_cmp_gt_u32 vcc, 3, v31
s_cbranch_vccz polled_24
buffer_load_dword v31, v30, s[32:35], s72 offen sc1
s_add_u32 s63, s63, 1
s_cmp_lt_u32 s63, 0x80000
s_waitcnt vmcnt(0)
s_cbranch_scc1 poll_23
polled_24:
buffer_load_dwordx4 v[80:83], v37, s[32:35], 0 offen offset:0 sc1
buffer_load_dwordx4 v[84:87], v37, s[32:35], 0 offen offset:1024 sc1
buffer_load_dwordx4 v[88:91], v37, s[32:35], 0 offen offset:2048 sc1
buffer_load_dwordx4 v[92:95], v37, s[32:35], 0 offen offset:3072 sc1
s_add_u32 s69, s47, 15
s_and_b32 s69, s69, 15
s_mul_i32 s67, s69, 2048
s_mul_i32 s68, s69, 393216
s_add_u32 m0, s70, 0
s_nop 0
buffer_load_dwordx4 v20, s[32:35], s67 offen offset:0 sc1 lds
buffer_load_dwordx4 v21, s[32:35], s67 offen offset:1024 sc1 lds
buffer_load_dwordx4 v22, s[32:35], s67 offen offset:2048 sc1 lds
buffer_load_dwordx4 v23, s[32:35], s67 offen offset:3072 sc1 lds
s_add_u32 s60, s71, 0
s_add_u32 m0, s60, 0
s_add_u32 s61, s68, 0
buffer_load_dwordx4 v26, s[28:31], s61 offen lds
buffer_load_dwordx4 v27, s[28:31], s61 offen offset:1024 lds
s_waitcnt vmcnt(10)
s_barrier
s_setprio 2
s_add_u32 m0, s60, 8192
s_add_u32 s61, s68, 2048
buffer_load_dwordx4 v26, s[28:31], s61 offen lds
buffer_load_dwordx4 v27, s[28:31], s61 offen offset:1024 lds
s_waitcnt vmcnt(8)
s_add_u32 m0, s60, 16384
s_add_u32 s61, s68, 4096
buffer_load_dwordx4 v26, s[28:31], s61 offen lds
v_add_f32 v80, v80, v88
v_add_f32 v81, v81, v89
buffer_load_dwordx4 v27, s[28:31], s61 offen offset:1024 lds
v_add_f32 v82, v82, v90
v_add_f32 v83, v83, v91
s_add_u32 s48, s47, 15
s_and_b32 s48, s48, 15
s_lshl_b32 s48, s48, 17
s_add_u32 m0, s71, 106496
s_nop 0
buffer_load_dwordx4 v28, s[36:39], s48 offen lds
v_add_f32 v84, v84, v92
v_add_f32 v85, v85, v93
buffer_load_dwordx4 v29, s[36:39], s48 offen offset:1024 lds
v_add_f32 v86, v86, v94
s_add_u32 s48, s47, 5
s_and_b32 s48, s48, 15
s_lshl_b32 s48, s48, 17
s_add_u32 m0, s71, 24576
s_nop 0
buffer_load_dwordx4 v28, s[36:39], s48 offen lds
v_add_f32 v87, v87, v95
v_add_f32 v80, v80, v84
buffer_load_dwordx4 v29, s[36:39], s48 offen offset:1024 lds
v_add_f32 v81, v81, v85
v_add_f32 v82, v82, v86
s_add_u32 s48, s47, 6
s_and_b32 s48, s48, 15
s_lshl_b32 s48, s48, 17
s_add_u32 m0, s71, 32768
s_nop 0
buffer_load_dwordx4 v28, s[36:39], s48 offen lds
v_add_f32 v83, v83, v87
s_nop 1
buffer_load_dwordx4 v29, s[36:39], s48 offen offset:1024 lds
v_permlane32_swap_b32 v80, v81
s_waitcnt vmcnt(6)
s_barrier
s_add_u32 s48, s47, 7
s_and_b32 s48, s48, 15
s_lshl_b32 s48, s48, 17
s_add_u32 m0, s71, 40960
s_nop 0
buffer_load_dwordx4 v28, s[36:39], s48 offen lds
v_permlane32_swap_b32 v82, v83
v_add_f32 v80, v80, v81
v_add_f32 v82, v82, v83
buffer_load_dwordx4 v29, s[36:39], s48 offen offset:1024 lds
s_nop 1
v_permlane16_swap_b32 v80, v82
s_add_u32 s48, s47, 8
s_and_b32 s48, s48, 15
s_lshl_b32 s48, s48, 17
s_add_u32 m0, s71, 49152
s_nop 0
buffer_load_dwordx4 v28, s[36:39], s48 offen lds
s_nop 0
v_add_f32 v80, v80, v82
v_mul_f32 v44, 0x3a800000, v80
buffer_load_dwordx4 v29, s[36:39], s48 offen offset:1024 lds
v_mov_b32 v45, v44
s_nop 1
s_add_u32 s48, s47, 9
s_and_b32 s48, s48, 15
s_lshl_b32 s48, s48, 17
s_add_u32 m0, s71, 57344
s_nop 0
buffer_load_dwordx4 v28, s[36:39], s48 offen lds
v_permlane16_swap_b32 v44, v45
s_nop 0
v_fma_f32 v45, -v44, v44, v45
buffer_load_dwordx4 v29, s[36:39], s48 offen offset:1024 lds
v_max_f32 v45, 0, v45
v_add_f32 v45, 0x3727c5ac, v45
s_add_u32 s48, s47, 10
s_and_b32 s48, s48, 15
s_lshl_b32 s48, s48, 17
s_add_u32 m0, s71, 65536
s_nop 0
buffer_load_dwordx4 v28, s[36:39], s48 offen lds
v_rsq_f32 v46, v45
v_sub_f32 v47, 0, v44
ds_write_b32 v50, v47 offset:512
buffer_load_dwordx4 v29, s[36:39], s48 offen offset:1024 lds
ds_write_b64 v49, v[46:47]
ds_write_b32 v50, v46
s_setprio 0
s_waitcnt lgkmcnt(0)
s_waitcnt vmcnt(63)
s_barrier
s_add_u32 s48, s47, 11
s_and_b32 s48, s48, 15
s_lshl_b32 s48, s48, 17
s_add_u32 m0, s71, 73728
s_waitcnt vmcnt(4)
buffer_load_dwordx4 v28, s[36:39], s48 offen lds
buffer_load_dwordx4 v29, s[36:39], s48 offen offset:1024 lds
s_add_u32 s48, s47, 12
s_and_b32 s48, s48, 15
s_lshl_b32 s48, s48, 17
s_add_u32 m0, s71, 81920
s_waitcnt vmcnt(4)
buffer_load_dwordx4 v28, s[36:39], s48 offen lds
buffer_load_dwordx4 v29, s[36:39], s48 offen offset:1024 lds
s_add_u32 s48, s47, 13
s_and_b32 s48, s48, 15
s_lshl_b32 s48, s48, 17
s_add_u32 m0, s71, 90112
s_waitcnt vmcnt(4)
buffer_load_dwordx4 v28, s[36:39], s48 offen lds
buffer_load_dwordx4 v29, s[36:39], s48 offen offset:1024 lds
s_add_u32 s48, s47, 14
s_and_b32 s48, s48, 15
s_lshl_b32 s48, s48, 17
s_add_u32 m0, s71, 98304
s_waitcnt vmcnt(4)
buffer_load_dwordx4 v28, s[36:39], s48 offen lds
buffer_load_dwordx4 v29, s[36:39], s48 offen offset:1024 lds
s_add_u32 s48, s47, 0
s_and_b32 s48, s48, 15
s_lshl_b32 s48, s48, 17
s_add_u32 m0, s71, 4294950912
s_waitcnt vmcnt(4)
buffer_load_dwordx4 v28, s[36:39], s48 offen lds
buffer_load_dwordx4 v29, s[36:39], s48 offen offset:1024 lds
s_add_u32 s48, s47, 1
s_and_b32 s48, s48, 15
s_lshl_b32 s48, s48, 17
s_add_u32 m0, s71, 4294959104
s_waitcnt vmcnt(4)
buffer_load_dwordx4 v28, s[36:39], s48 offen lds
buffer_load_dwordx4 v29, s[36:39], s48 offen offset:1024 lds
s_add_u32 s48, s47, 2
s_and_b32 s48, s48, 15
s_lshl_b32 s48, s48, 17
s_add_u32 m0, s71, 0
s_waitcnt vmcnt(4)
buffer_load_dwordx4 v28, s[36:39], s48 offen lds
buffer_load_dwordx4 v29, s[36:39], s48 offen offset:1024 lds
s_add_u32 s48, s47, 3
s_and_b32 s48, s48, 15
s_lshl_b32 s48, s48, 17
s_add_u32 m0, s71, 8192
s_waitcnt vmcnt(4)
buffer_load_dwordx4 v28, s[36:39], s48 offen lds
buffer_load_dwordx4 v29, s[36:39], s48 offen offset:1024 lds
s_add_u32 s48, s47, 4
s_and_b32 s48, s48, 15
s_lshl_b32 s48, s48, 17
s_add_u32 m0, s71, 16384
s_waitcnt vmcnt(4)
buffer_load_dwordx4 v28, s[36:39], s48 offen lds
buffer_load_dwordx4 v29, s[36:39], s48 offen offset:1024 lds
buffer_load_dwordx4 v[112:115], v18, s[32:35], s81 offen offset:0 sc1
buffer_load_dwordx4 v[116:119], v18, s[32:35], s81 offen offset:1024 sc1
buffer_load_dwordx4 v[120:123], v18, s[32:35], s82 offen offset:0 sc1
buffer_load_dwordx4 v[124:127], v18, s[32:35], s82 offen offset:1024 sc1
s_waitcnt vmcnt(0)
s_barrier
L_end:
s_endpgm
L_compute:
s_setprio 1
s_and_b32 s43, s40, 1
s_lshr_b32 s44, s40, 1
s_lshl_b32 s45, s42, 1
s_add_u32 s45, s45, s43
s_mov_b32 s77, s74
s_lshr_b32 s78, s42, 3
s_cmp_lg_u32 s40, 1
s_cbranch_scc1 else_25
s_getpc_b64 s[48:49]
L_pc:
s_sub_u32 s48, s48, L_pc - interleave_layers__sliding_local_dilated__linear_kernel_hedgehog__prompt_kernel
s_subb_u32 s49, s49, 0
s_lshr_b32 s50, s2, 3
s_lshl_b32 s50, s50, 12
v_lshl_add_u32 v8, v0, 6, s50
v_cmp_gt_u32 vcc, L_code_end - interleave_layers__sliding_local_dilated__linear_kernel_hedgehog__prompt_kernel, v8
s_and_saveexec_b64 s[50:51], vcc
s_cbranch_execz nopf_27
global_load_dword v254, v8, s[48:49]
nopf_27:
s_mov_b64 exec, -1
else_25:
s_lshl_b32 s48, s41, 3
s_lshl_b32 s49, s44, 2
s_add_u32 s48, s48, s49
s_lshl_b32 s48, s48, 5
s_add_u32 s48, s48, s45
s_lshl_b32 s48, s48, 10
s_add_u32 s80, s48, 4194304
s_add_u32 s81, s80, 32768
s_add_u32 s82, s80, 65536
s_add_u32 s83, s80, 98304
s_lshl_b32 s84, s41, 2
s_add_u32 s84, s84, s44
s_lshl_b32 s84, s84, 7
s_add_u32 s84, s84, 17563648
s_lshl_b32 s48, s41, 3
s_lshl_b32 s49, s40, 1
s_add_u32 s48, s48, s49
s_lshl_b32 s48, s48, 15
s_lshl_b32 s49, s42, 11
s_add_u32 s85, s48, s49
s_add_u32 s86, s85, 32768
s_lshl_b32 s50, s41, 2
s_add_u32 s50, s50, s40
s_lshl_b32 s50, s50, 4
s_add_u32 s50, s50, s42
s_lshl_b32 s50, s50, 8
s_add_u32 s87, s50, 16777216
s_lshl_b32 s88, s41, 2
s_add_u32 s88, s88, s40
s_lshl_b32 s88, s88, 7
s_add_u32 s88, s88, 17571840
s_lshl_b32 s89, s41, 2
s_add_u32 s89, s89, s40
s_lshl_b32 s89, s89, 7
s_add_u32 s89, s89, 17580032
v_lshrrev_b32 v4, 1, v3
v_lshl_add_u32 v4, v2, 2, v4
v_and_b32 v5, 1, v3
v_lshl_add_u32 v4, v5, 1, v4
v_lshlrev_b32 v1, 2, v4
s_lshl_b32 s48, s40, 2
s_add_u32 s48, s48, 134672
v_mov_b32 v10, s48
v_mov_b32 v11, 0
ds_write_b32 v10, v11
s_cmp_lg_u32 s40, 0
s_cbranch_scc1 else_28
s_lshl_b32 s48, s2, 8
s_add_u32 s48, s48, 17563648
v_lshlrev_b32 v6, 2, v0
buffer_store_dword v11, v6, s[32:35], s48 offen sc1
else_28:
s_lshl_b32 s48, s41, 7
s_lshl_b32 s49, s40, 5
s_add_u32 s48, s48, s49
v_add_u32 v4, s48, v2
v_lshlrev_b32 v4, 11, v4
v_and_b32 v5, 1, v3
v_lshl_add_u32 v4, v5, 5, v4
v_lshrrev_b32 v5, 1, v3
v_lshl_add_u32 v4, v5, 4, v4
s_lshl_b32 s49, s42, 7
v_add_u32 v12, s49, v4
v_add_u32 v13, 32768, v12
buffer_load_dwordx4 v[20:23], v12, s[24:27], 0 offen offset:0
buffer_load_dwordx4 v[24:27], v12, s[24:27], 0 offen offset:64
buffer_load_dwordx4 v[28:31], v13, s[24:27], 0 offen offset:0
buffer_load_dwordx4 v[32:35], v13, s[24:27], 0 offen offset:64
v_mov_b32 v140, -1
v_mov_b32 v141, -1
v_mov_b32 v142, -1
v_mov_b32 v143, -1
s_lshl_b32 s48, s2, 2
s_add_u32 s49, s48, s40
s_lshl_b32 s48, s49, 10
s_add_u32 s48, s48, 8388608
buffer_store_dwordx4 v[140:143], v18, s[32:35], s48 offen sc1
s_add_u32 s48, s48, 1048576
buffer_store_dwordx4 v[140:143], v18, s[32:35], s48 offen sc1
s_add_u32 s48, s48, 1048576
buffer_store_dwordx4 v[140:143], v18, s[32:35], s48 offen sc1
s_add_u32 s48, s48, 1048576
buffer_store_dwordx4 v[140:143], v18, s[32:35], s48 offen sc1
s_add_u32 s48, s48, 1048576
buffer_store_dwordx4 v[140:143], v18, s[32:35], s48 offen sc1
s_add_u32 s48, s48, 1048576
buffer_store_dwordx4 v[140:143], v18, s[32:35], s48 offen sc1
s_add_u32 s48, s48, 1048576
s_lshl_b32 s48, s49, 9
s_add_u32 s48, s48, 14680064
v_lshlrev_b32 v6, 3, v0
buffer_store_dwordx2 v[140:141], v6, s[32:35], s48 offen sc1
s_lshl_b32 s49, s44, 13
v_lshrrev_b32 v4, 1, v2
v_xor_b32 v4, v4, v3
v_lshlrev_b32 v4, 4, v4
v_lshl_add_u32 v10, v2, 7, v4
v_add_u32 v10, s49, v10
v_xor_b32 v11, 64, v10
s_lshl_b32 s48, s43, 1
v_lshrrev_b32 v4, 2, v2
v_and_b32 v5, 3, v0
v_lshl_add_u32 v6, v3, 3, v4
v_lshlrev_b32 v6, 7, v6
v_lshl_add_u32 v6, v5, 3, v6
v_lshrrev_b32 v7, 1, v4
v_and_b32 v8, 1, v3
v_lshl_add_u32 v7, v8, 1, v7
v_xor_b32 v7, s48, v7
v_lshl_add_u32 v12, v7, 5, v6
v_add_u32 v12, 16384, v12
v_xor_b32 v13, 32, v12
v_mov_b32 v14, v10
v_mov_b32 v15, v11
v_add_u32 v16, 0, v12
v_add_u32 v17, 0, v13
v_mov_b32 v156, 0
v_mov_b32 v157, 0
v_mov_b32 v158, 0
v_mov_b32 v159, 0
v_mov_b32 v160, 0
v_mov_b32 v161, 0
v_mov_b32 v162, 0
v_mov_b32 v163, 0
v_mov_b32 v164, 0
v_mov_b32 v165, 0
v_mov_b32 v166, 0
v_mov_b32 v167, 0
v_mov_b32 v168, 0
v_mov_b32 v169, 0
v_mov_b32 v170, 0
v_mov_b32 v171, 0
v_mov_b32 v172, 0
v_mov_b32 v173, 0
v_mov_b32 v174, 0
v_mov_b32 v175, 0
v_mov_b32 v176, 0
v_mov_b32 v177, 0
v_mov_b32 v178, 0
v_mov_b32 v179, 0
v_mov_b32 v180, 0
v_mov_b32 v181, 0
v_mov_b32 v182, 0
v_mov_b32 v183, 0
v_mov_b32 v184, 0
v_mov_b32 v185, 0
v_mov_b32 v186, 0
v_mov_b32 v187, 0
v_mov_b32 v188, 0
v_mov_b32 v189, 0
v_mov_b32 v190, 0
v_mov_b32 v191, 0
v_mov_b32 v192, 0
v_mov_b32 v193, 0
v_mov_b32 v194, 0
v_mov_b32 v195, 0
v_mov_b32 v196, 0
v_mov_b32 v197, 0
v_mov_b32 v198, 0
v_mov_b32 v199, 0
v_mov_b32 v200, 0
v_mov_b32 v201, 0
v_mov_b32 v202, 0
v_mov_b32 v203, 0
v_mov_b32 v204, 0
v_mov_b32 v205, 0
v_mov_b32 v206, 0
v_mov_b32 v207, 0
v_mov_b32 v208, 0
v_mov_b32 v209, 0
v_mov_b32 v210, 0
v_mov_b32 v211, 0
v_mov_b32 v212, 0
v_mov_b32 v213, 0
v_mov_b32 v214, 0
v_mov_b32 v215, 0
v_mov_b32 v216, 0
v_mov_b32 v217, 0
v_mov_b32 v218, 0
v_mov_b32 v219, 0
v_mov_b32 v220, 0
v_mov_b32 v221, 0
v_mov_b32 v222, 0
v_mov_b32 v223, 0
v_mov_b32 v224, 0
v_mov_b32 v225, 0
v_mov_b32 v226, 0
v_mov_b32 v227, 0
v_mov_b32 v228, 0
v_mov_b32 v229, 0
v_mov_b32 v230, 0
v_mov_b32 v231, 0
v_mov_b32 v232, 0
v_mov_b32 v233, 0
v_mov_b32 v234, 0
v_mov_b32 v235, 0
v_mov_b32 v236, 0
v_mov_b32 v237, 0
v_mov_b32 v238, 0
v_mov_b32 v239, 0
v_mov_b32 v240, 0
v_mov_b32 v241, 0
v_mov_b32 v242, 0
v_mov_b32 v243, 0
v_mov_b32 v244, 0
v_mov_b32 v245, 0
v_mov_b32 v246, 0
v_mov_b32 v247, 0
v_mov_b32 v248, 0
v_mov_b32 v249, 0
v_mov_b32 v250, 0
v_mov_b32 v251, 0
v_mov_b32 v48, 0x3f803f80
v_mov_b32 v49, 0x3f803f80
v_mov_b32 v50, 0x3f803f80
v_mov_b32 v51, 0x3f803f80
s_mov_b32 s48, 0xf149f2ca
v_mov_b32 v9, s48
v_lshlrev_b32 v4, 2, v3
v_sub_u32 v4, v2, v4
v_subrev_u32 v5, 0, v4
v_and_b32 v6, 0x80000001, v5
v_cmp_eq_u32 vcc, 0, v6
v_add_u32 v5, 1, v5
v_and_b32 v6, 0x80000001, v5
v_cndmask_b32 v40, v9, 0, vcc
v_cmp_eq_u32 vcc, 0x80000001, v6
s_nop 1
v_cndmask_b32 v36, v9, 0, vcc
v_subrev_u32 v5, 1, v4
v_and_b32 v6, 0x80000001, v5
v_cmp_eq_u32 vcc, 0, v6
v_add_u32 v5, 1, v5
v_and_b32 v6, 0x80000001, v5
v_cndmask_b32 v41, v9, 0, vcc
v_cmp_eq_u32 vcc, 0x80000001, v6
s_nop 1
v_cndmask_b32 v37, v9, 0, vcc
v_subrev_u32 v5, 2, v4
v_and_b32 v6, 0x80000001, v5
v_cmp_eq_u32 vcc, 0, v6
v_add_u32 v5, 1, v5
v_and_b32 v6, 0x80000001, v5
v_cndmask_b32 v42, v9, 0, vcc
v_cmp_eq_u32 vcc, 0x80000001, v6
s_nop 1
v_cndmask_b32 v38, v9, 0, vcc
v_subrev_u32 v5, 3, v4
v_and_b32 v6, 0x80000001, v5
v_cmp_eq_u32 vcc, 0, v6
v_add_u32 v5, 1, v5
v_and_b32 v6, 0x80000001, v5
v_cndmask_b32 v43, v9, 0, vcc
v_cmp_eq_u32 vcc, 0x80000001, v6
s_nop 1
v_cndmask_b32 v39, v9, 0, vcc
s_or_b32 s48, s41, s44
s_cmp_eq_u32 s48, 0
s_cselect_b64 vcc, -1, 0
v_cndmask_b32 v44, v36, v9, vcc
v_cndmask_b32 v45, v37, v9, vcc
v_cndmask_b32 v46, v38, v9, vcc
v_cndmask_b32 v47, v39, v9, vcc
v_and_b32 v4, 1, v2
v_lshlrev_b32 v4, 4, v4
v_mov_b32 v5, 0xffff
v_lshlrev_b32 v52, v4, v5
s_lshl_b32 s48, s43, 11
s_add_u32 s48, s48, 135168
v_add_u32 v53, s48, v18
v_lshl_add_u32 v55, v0, 3, s48
s_add_u32 s48, s41, s44
s_sub_u32 s48, s48, 1
s_lshl_b32 s49, s48, 5
s_add_u32 s49, s49, s45
s_lshl_b32 s49, s49, 11
s_add_u32 s49, s49, 8388608
s_cmp_lt_i32 s48, 0
s_cselect_b32 s49, 0xf0000000, s49
v_add_u32 v58, s49, v18
v_lshl_add_u32 v59, v0, 3, s49
s_lshl_b32 s48, s43, 2
s_add_u32 s48, s48, 134672
v_mov_b32 v19, s48
s_lshl_b32 s48, s43, 7
s_add_u32 s48, s48, 133120
v_lshl_add_u32 v7, v3, 4, s48
v_lshl_add_u32 v54, v2, 2, s48
s_lshl_b32 s49, s44, 6
v_add_u32 v8, s49, v2
v_lshlrev_b32 v8, 3, v8
v_add_u32 v8, 131072, v8
v_lshl_add_u32 v9, v3, 2, s49
v_lshlrev_b32 v9, 2, v9
v_add_u32 v9, 132096, v9
s_mov_b32 s64, 0
s_mov_b32 s65, 0
s_mov_b32 s66, 0x3e8293ee
s_lshl_b32 s75, 1, s77
s_or_b32 s75, s75, 8
s_lshl_b32 s48, 1, s78
s_or_b32 s75, s75, s48
s_barrier
ds_read_b128 v[60:63], v14 offset:0
ds_read_b128 v[64:67], v14 offset:2048
ds_read_b128 v[68:71], v14 offset:4096
ds_read_b128 v[72:75], v14 offset:6144
ds_read_b64_tr_b16 v[84:85], v16 offset:8192
ds_read_b64_tr_b16 v[86:87], v16 offset:8704
ds_read_b64_tr_b16 v[88:89], v17 offset:8192
ds_read_b64_tr_b16 v[90:91], v17 offset:8704
ds_read_b64_tr_b16 v[92:93], v16 offset:16384
ds_read_b64_tr_b16 v[94:95], v16 offset:16896
ds_read_b64_tr_b16 v[96:97], v17 offset:16384
ds_read_b64_tr_b16 v[98:99], v17 offset:16896
ds_read_b64_tr_b16 v[76:77], v16 offset:0
ds_read_b64_tr_b16 v[78:79], v16 offset:512
ds_read_b64_tr_b16 v[80:81], v17 offset:0
ds_read_b64_tr_b16 v[82:83], v17 offset:512
s_waitcnt lgkmcnt(0)
c0_loop:
v_mfma_f32_16x16x32_bf16 v[212:215], v[84:87], v[72:75], v[212:215]
ds_read_b128 v[100:103], v15 offset:0
v_mfma_f32_16x16x32_bf16 v[204:207], v[84:87], v[68:71], v[204:207]
ds_read_b128 v[104:107], v15 offset:2048
v_mfma_f32_16x16x32_bf16 v[196:199], v[84:87], v[64:67], v[196:199]
ds_read_b128 v[108:111], v15 offset:4096
v_mfma_f32_16x16x32_bf16 v[188:191], v[84:87], v[60:63], v[188:191]
ds_read_b128 v[112:115], v15 offset:6144
v_mfma_f32_16x16x32_bf16 v[192:195], v[88:91], v[60:63], v[192:195]
ds_read_b64_tr_b16 v[124:125], v16 offset:12288
v_mfma_f32_16x16x32_bf16 v[200:203], v[88:91], v[64:67], v[200:203]
ds_read_b64_tr_b16 v[126:127], v16 offset:12800
v_mfma_f32_16x16x32_bf16 v[208:211], v[88:91], v[68:71], v[208:211]
ds_read_b64_tr_b16 v[128:129], v17 offset:12288
v_mfma_f32_16x16x32_bf16 v[216:219], v[88:91], v[72:75], v[216:219]
ds_read_b64_tr_b16 v[130:131], v17 offset:12800
v_mfma_f32_16x16x32_bf16 v[244:247], v[72:75], v[92:95], v[244:247]
ds_read_b64_tr_b16 v[132:133], v16 offset:20480
v_mfma_f32_16x16x32_bf16 v[236:239], v[68:71], v[92:95], v[236:239]
ds_read_b64_tr_b16 v[134:135], v16 offset:20992
v_mfma_f32_16x16x32_bf16 v[228:231], v[64:67], v[92:95], v[228:231]
ds_read_b64_tr_b16 v[136:137], v17 offset:20480
v_mfma_f32_16x16x32_bf16 v[220:223], v[60:63], v[92:95], v[220:223]
ds_read_b64_tr_b16 v[138:139], v17 offset:20992
v_mfma_f32_16x16x32_bf16 v[224:227], v[60:63], v[96:99], v[224:227]
ds_read_b64_tr_b16 v[116:117], v16 offset:4096
v_mfma_f32_16x16x32_bf16 v[232:235], v[64:67], v[96:99], v[232:235]
ds_read_b64_tr_b16 v[118:119], v16 offset:4608
v_mfma_f32_16x16x32_bf16 v[240:243], v[68:71], v[96:99], v[240:243]
ds_read_b64_tr_b16 v[120:121], v17 offset:4096
v_mfma_f32_16x16x32_bf16 v[248:251], v[72:75], v[96:99], v[248:251]
ds_read_b64_tr_b16 v[122:123], v17 offset:4608
v_mfma_f32_16x16x32_bf16 v[180:183], v[76:79], v[72:75], v[180:183]
s_bitcmp1_b32 s75, s64
s_cbranch_scc1 c0_hook
c0_hook_ret:
v_mfma_f32_16x16x32_bf16 v[172:175], v[76:79], v[68:71], v[172:175]
s_add_u32 s65, s65, 40960
s_cmp_eq_u32 s65, 122880
v_mfma_f32_16x16x32_bf16 v[164:167], v[76:79], v[64:67], v[164:167]
s_cselect_b32 s65, 0, s65
s_add_u32 s64, s64, 1
v_mfma_f32_16x16x32_bf16 v[156:159], v[76:79], v[60:63], v[156:159]
v_add_u32 v14, s65, v10
v_add_u32 v15, s65, v11
v_mfma_f32_16x16x32_bf16 v[160:163], v[80:83], v[60:63], v[160:163]
v_add_u32 v16, s65, v12
v_add_u32 v17, s65, v13
v_mfma_f32_16x16x32_bf16 v[168:171], v[80:83], v[64:67], v[168:171]
s_cmp_eq_u32 s64, 16
s_cbranch_scc1 c0_last
v_mfma_f32_16x16x32_bf16 v[176:179], v[80:83], v[68:71], v[176:179]
s_waitcnt lgkmcnt(0)
v_mfma_f32_16x16x32_bf16 v[184:187], v[80:83], v[72:75], v[184:187]
s_barrier
v_mfma_f32_16x16x32_bf16 v[212:215], v[124:127], v[112:115], v[212:215]
ds_read_b128 v[60:63], v14 offset:0
v_mfma_f32_16x16x32_bf16 v[204:207], v[124:127], v[108:111], v[204:207]
ds_read_b128 v[64:67], v14 offset:2048
v_mfma_f32_16x16x32_bf16 v[196:199], v[124:127], v[104:107], v[196:199]
ds_read_b128 v[68:71], v14 offset:4096
v_mfma_f32_16x16x32_bf16 v[188:191], v[124:127], v[100:103], v[188:191]
ds_read_b128 v[72:75], v14 offset:6144
v_mfma_f32_16x16x32_bf16 v[192:195], v[128:131], v[100:103], v[192:195]
ds_read_b64_tr_b16 v[84:85], v16 offset:8192
v_mfma_f32_16x16x32_bf16 v[200:203], v[128:131], v[104:107], v[200:203]
ds_read_b64_tr_b16 v[86:87], v16 offset:8704
v_mfma_f32_16x16x32_bf16 v[208:211], v[128:131], v[108:111], v[208:211]
ds_read_b64_tr_b16 v[88:89], v17 offset:8192
v_mfma_f32_16x16x32_bf16 v[216:219], v[128:131], v[112:115], v[216:219]
ds_read_b64_tr_b16 v[90:91], v17 offset:8704
v_mfma_f32_16x16x32_bf16 v[244:247], v[112:115], v[132:135], v[244:247]
ds_read_b64_tr_b16 v[92:93], v16 offset:16384
v_mfma_f32_16x16x32_bf16 v[236:239], v[108:111], v[132:135], v[236:239]
ds_read_b64_tr_b16 v[94:95], v16 offset:16896
v_mfma_f32_16x16x32_bf16 v[228:231], v[104:107], v[132:135], v[228:231]
ds_read_b64_tr_b16 v[96:97], v17 offset:16384
v_mfma_f32_16x16x32_bf16 v[220:223], v[100:103], v[132:135], v[220:223]
ds_read_b64_tr_b16 v[98:99], v17 offset:16896
v_mfma_f32_16x16x32_bf16 v[224:227], v[100:103], v[136:139], v[224:227]
ds_read_b64_tr_b16 v[76:77], v16 offset:0
v_mfma_f32_16x16x32_bf16 v[232:235], v[104:107], v[136:139], v[232:235]
ds_read_b64_tr_b16 v[78:79], v16 offset:512
v_mfma_f32_16x16x32_bf16 v[240:243], v[108:111], v[136:139], v[240:243]
ds_read_b64_tr_b16 v[80:81], v17 offset:0
v_mfma_f32_16x16x32_bf16 v[248:251], v[112:115], v[136:139], v[248:251]
ds_read_b64_tr_b16 v[82:83], v17 offset:512
v_mfma_f32_16x16x32_bf16 v[180:183], v[116:119], v[112:115], v[180:183]
v_mfma_f32_16x16x32_bf16 v[172:175], v[116:119], v[108:111], v[172:175]
v_mfma_f32_16x16x32_bf16 v[164:167], v[116:119], v[104:107], v[164:167]
v_mfma_f32_16x16x32_bf16 v[156:159], v[116:119], v[100:103], v[156:159]
v_mfma_f32_16x16x32_bf16 v[160:163], v[120:123], v[100:103], v[160:163]
v_mfma_f32_16x16x32_bf16 v[168:171], v[120:123], v[104:107], v[168:171]
v_mfma_f32_16x16x32_bf16 v[176:179], v[120:123], v[108:111], v[176:179]
s_waitcnt lgkmcnt(0)
v_mfma_f32_16x16x32_bf16 v[184:187], v[120:123], v[112:115], v[184:187]
s_branch c0_loop
c0_hook:
s_waitcnt lgkmcnt(0)
s_cmp_lg_u32 s64, s77
s_cbranch_scc1 else_30
s_cmp_lg_u32 s44, 0
s_cbranch_scc1 else_32
v_mfma_f32_16x16x32_bf16 v[140:143], v[48:51], v[76:79], 0
v_mfma_f32_16x16x32_bf16 v[144:147], v[48:51], v[84:87], 0
v_mfma_f32_16x16x32_bf16 v[148:151], v[48:51], v[92:95], 0
v_mfma_f32_16x16x32_bf16 v[140:143], v[48:51], v[116:119], v[140:143]
v_mfma_f32_16x16x32_bf16 v[144:147], v[48:51], v[124:127], v[144:147]
v_mfma_f32_16x16x32_bf16 v[148:151], v[48:51], v[132:135], v[148:151]
s_branch fi_33
else_32:
v_mfma_f32_16x16x32_bf16 v[140:143], v[48:51], v[80:83], 0
v_mfma_f32_16x16x32_bf16 v[144:147], v[48:51], v[88:91], 0
v_mfma_f32_16x16x32_bf16 v[148:151], v[48:51], v[96:99], 0
v_mfma_f32_16x16x32_bf16 v[140:143], v[48:51], v[120:123], v[140:143]
v_mfma_f32_16x16x32_bf16 v[144:147], v[48:51], v[128:131], v[144:147]
v_mfma_f32_16x16x32_bf16 v[148:151], v[48:51], v[136:139], v[148:151]
fi_33:
s_lshl_b32 s50, s42, 2
s_add_u32 s50, s50, s40
s_lshl_b32 s50, s50, 4
s_add_u32 s50, s50, s41
s_lshl_b32 s50, s50, 8
s_add_u32 s50, s50, 17039360
v_cmp_eq_u32 vcc, 0, v3
v_cmp_eq_u32 s[48:49], 1, v3
s_nop 1
v_cndmask_b32 v4, v148, v144, s[48:49]
v_cndmask_b32 v4, v4, v140, vcc
buffer_store_dword v4, v1, s[32:35], s50 offen sc1
else_30:
s_cmp_lg_u32 s64, s78
s_cbranch_scc1 else_34
v_mov_b32 v152, 0
v_mov_b32 v153, 0
v_mov_b32 v154, 0
v_mov_b32 v155, 0
s_cmp_lg_u32 s43, 0
s_cbranch_scc1 else_36
v_dot2c_f32_bf16 v152, v60, v48
v_dot2c_f32_bf16 v154, v60, v60
v_dot2c_f32_bf16 v153, v64, v48
v_dot2c_f32_bf16 v155, v64, v64
v_dot2c_f32_bf16 v152, v61, v48
v_dot2c_f32_bf16 v154, v61, v61
v_dot2c_f32_bf16 v153, v65, v48
v_dot2c_f32_bf16 v155, v65, v65
v_dot2c_f32_bf16 v152, v62, v48
v_dot2c_f32_bf16 v154, v62, v62
v_dot2c_f32_bf16 v153, v66, v48
v_dot2c_f32_bf16 v155, v66, v66
v_dot2c_f32_bf16 v152, v63, v48
v_dot2c_f32_bf16 v154, v63, v63
v_dot2c_f32_bf16 v153, v67, v48
v_dot2c_f32_bf16 v155, v67, v67
v_dot2c_f32_bf16 v152, v100, v48
v_dot2c_f32_bf16 v154, v100, v100
v_dot2c_f32_bf16 v153, v104, v48
v_dot2c_f32_bf16 v155, v104, v104
v_dot2c_f32_bf16 v152, v101, v48
v_dot2c_f32_bf16 v154, v101, v101
v_dot2c_f32_bf16 v153, v105, v48
v_dot2c_f32_bf16 v155, v105, v105
v_dot2c_f32_bf16 v152, v102, v48
v_dot2c_f32_bf16 v154, v102, v102
v_dot2c_f32_bf16 v153, v106, v48
v_dot2c_f32_bf16 v155, v106, v106
v_dot2c_f32_bf16 v152, v103, v48
v_dot2c_f32_bf16 v154, v103, v103
v_dot2c_f32_bf16 v153, v107, v48
v_dot2c_f32_bf16 v155, v107, v107
s_branch fi_37
else_36:
v_dot2c_f32_bf16 v152, v68, v48
v_dot2c_f32_bf16 v154, v68, v68
v_dot2c_f32_bf16 v153, v72, v48
v_dot2c_f32_bf16 v155, v72, v72
v_dot2c_f32_bf16 v152, v69, v48
v_dot2c_f32_bf16 v154, v69, v69
v_dot2c_f32_bf16 v153, v73, v48
v_dot2c_f32_bf16 v155, v73, v73
v_dot2c_f32_bf16 v152, v70, v48
v_dot2c_f32_bf16 v154, v70, v70
v_dot2c_f32_bf16 v153, v74, v48
v_dot2c_f32_bf16 v155, v74, v74
v_dot2c_f32_bf16 v152, v71, v48
v_dot2c_f32_bf16 v154, v71, v71
v_dot2c_f32_bf16 v153, v75, v48
v_dot2c_f32_bf16 v155, v75, v75
v_dot2c_f32_bf16 v152, v108, v48
v_dot2c_f32_bf16 v154, v108, v108
v_dot2c_f32_bf16 v153, v112, v48
v_dot2c_f32_bf16 v155, v112, v112
v_dot2c_f32_bf16 v152, v109, v48
v_dot2c_f32_bf16 v154, v109, v109
v_dot2c_f32_bf16 v153, v113, v48
v_dot2c_f32_bf16 v155, v113, v113
v_dot2c_f32_bf16 v152, v110, v48
v_dot2c_f32_bf16 v154, v110, v110
v_dot2c_f32_bf16 v153, v114, v48
v_dot2c_f32_bf16 v155, v114, v114
v_dot2c_f32_bf16 v152, v111, v48
v_dot2c_f32_bf16 v154, v111, v111
v_dot2c_f32_bf16 v153, v115, v48
v_dot2c_f32_bf16 v155, v115, v115
fi_37:
s_nop 0
s_nop 1
v_permlane32_swap_b32 v152, v153
v_permlane32_swap_b32 v154, v155
v_add_f32 v152, v152, v153
v_add_f32 v154, v154, v155
s_nop 1
v_permlane16_swap_b32 v152, v154
s_nop 0
v_add_f32 v152, v152, v154
buffer_store_dword v152, v1, s[32:35], s87 offen sc1
else_34:
s_cmp_lg_u32 s64, 3
s_cbranch_scc1 else_38
s_waitcnt vmcnt(0)
else_38:
s_branch c0_hook_ret
c0_last:
v_mfma_f32_16x16x32_bf16 v[176:179], v[80:83], v[68:71], v[176:179]
s_waitcnt lgkmcnt(0)
v_mfma_f32_16x16x32_bf16 v[184:187], v[80:83], v[72:75], v[184:187]
s_barrier
v_mfma_f32_16x16x32_bf16 v[212:215], v[124:127], v[112:115], v[212:215]
ds_read_b128 v[140:143], v7 offset:0
v_mfma_f32_16x16x32_bf16 v[204:207], v[124:127], v[108:111], v[204:207]
ds_read_b128 v[144:147], v7 offset:64
v_mfma_f32_16x16x32_bf16 v[196:199], v[124:127], v[104:107], v[196:199]
ds_read_b128 v[148:151], v7 offset:256
v_mfma_f32_16x16x32_bf16 v[188:191], v[124:127], v[100:103], v[188:191]
ds_read_b128 v[152:155], v7 offset:320
v_mfma_f32_16x16x32_bf16 v[192:195], v[128:131], v[100:103], v[192:195]
ds_read_b64 v[92:93], v8 offset:0
v_mfma_f32_16x16x32_bf16 v[200:203], v[128:131], v[104:107], v[200:203]
ds_read_b64 v[94:95], v8 offset:128
v_mfma_f32_16x16x32_bf16 v[208:211], v[128:131], v[108:111], v[208:211]
ds_read_b64 v[96:97], v8 offset:256
v_mfma_f32_16x16x32_bf16 v[216:219], v[128:131], v[112:115], v[216:219]
ds_read_b64 v[98:99], v8 offset:384
v_mfma_f32_16x16x32_bf16 v[244:247], v[112:115], v[132:135], v[244:247]
ds_read2_b32 v[56:57], v54 offset0:128 offset1:144
v_mfma_f32_16x16x32_bf16 v[236:239], v[108:111], v[132:135], v[236:239]
ds_read_b128 v[60:63], v9 offset:0
v_mfma_f32_16x16x32_bf16 v[228:231], v[104:107], v[132:135], v[228:231]
ds_read_b128 v[64:67], v9 offset:64
v_mfma_f32_16x16x32_bf16 v[220:223], v[100:103], v[132:135], v[220:223]
ds_read_b128 v[68:71], v9 offset:128
v_mfma_f32_16x16x32_bf16 v[224:227], v[100:103], v[136:139], v[224:227]
ds_read_b128 v[72:75], v9 offset:192
v_mfma_f32_16x16x32_bf16 v[232:235], v[104:107], v[136:139], v[232:235]
ds_read_b128 v[76:79], v9 offset:512
v_mfma_f32_16x16x32_bf16 v[240:243], v[108:111], v[136:139], v[240:243]
ds_read_b128 v[80:83], v9 offset:576
v_mfma_f32_16x16x32_bf16 v[248:251], v[112:115], v[136:139], v[248:251]
ds_read_b128 v[84:87], v9 offset:640
v_mfma_f32_16x16x32_bf16 v[180:183], v[116:119], v[112:115], v[180:183]
ds_read_b128 v[88:91], v9 offset:704
v_mfma_f32_16x16x32_bf16 v[172:175], v[116:119], v[108:111], v[172:175]
v_mov_b32 v6, 134656
ds_read_b32 v6, v6
v_mfma_f32_16x16x32_bf16 v[164:167], v[116:119], v[104:107], v[164:167]
v_mfma_f32_16x16x32_bf16 v[156:159], v[116:119], v[100:103], v[156:159]
v_mfma_f32_16x16x32_bf16 v[160:163], v[120:123], v[100:103], v[160:163]
v_mfma_f32_16x16x32_bf16 v[168:171], v[120:123], v[104:107], v[168:171]
v_mfma_f32_16x16x32_bf16 v[176:179], v[120:123], v[108:111], v[176:179]
v_mfma_f32_16x16x32_bf16 v[184:187], v[120:123], v[112:115], v[184:187]
c0_epi:
s_waitcnt lgkmcnt(0)
v_readfirstlane_b32 s46, v6
.p2align 3
v_pk_fma_f32 v[212:213], v[148:149], v[98:99], v[212:213] op_sel:[0,1,0] op_sel_hi:[1,1,1]
v_pk_fma_f32 v[214:215], v[150:151], v[98:99], v[214:215] op_sel:[0,1,0] op_sel_hi:[1,1,1]
v_pk_fma_f32 v[216:217], v[152:153], v[98:99], v[216:217] op_sel:[0,1,0] op_sel_hi:[1,1,1]
v_pk_fma_f32 v[218:219], v[154:155], v[98:99], v[218:219] op_sel:[0,1,0] op_sel_hi:[1,1,1]
v_pk_mul_f32 v[212:213], v[212:213], v[98:99] op_sel:[0,0] op_sel_hi:[1,0]
v_pk_mul_f32 v[214:215], v[214:215], v[98:99] op_sel:[0,0] op_sel_hi:[1,0]
v_pk_mul_f32 v[216:217], v[216:217], v[98:99] op_sel:[0,0] op_sel_hi:[1,0]
v_pk_mul_f32 v[218:219], v[218:219], v[98:99] op_sel:[0,0] op_sel_hi:[1,0]
v_cvt_pk_bf16_f32 v212, v212, v213
v_cvt_pk_bf16_f32 v213, v214, v215
v_cvt_pk_bf16_f32 v214, v216, v217
v_cvt_pk_bf16_f32 v215, v218, v219
v_pk_fma_f32 v[244:245], v[88:89], v[56:57], v[244:245] op_sel:[0,0,0] op_sel_hi:[1,0,1]
v_pk_fma_f32 v[246:247], v[90:91], v[56:57], v[246:247] op_sel:[0,0,0] op_sel_hi:[1,0,1]
v_pk_mul_f32 v[244:245], v[244:245], v[72:73]
v_pk_mul_f32 v[246:247], v[246:247], v[74:75]
v_cvt_pk_bf16_f32 v108, v244, v245
v_cvt_pk_bf16_f32 v109, v246, v247
v_pk_fma_f32 v[248:249], v[88:89], v[56:57], v[248:249] op_sel:[0,1,0] op_sel_hi:[1,1,1]
v_pk_fma_f32 v[250:251], v[90:91], v[56:57], v[250:251] op_sel:[0,1,0] op_sel_hi:[1,1,1]
v_pk_mul_f32 v[248:249], v[248:249], v[72:73]
v_pk_mul_f32 v[250:251], v[250:251], v[74:75]
v_cvt_pk_bf16_f32 v118, v248, v249
v_cvt_pk_bf16_f32 v119, v250, v251
s_cmp_lg_u32 s44, 1
s_cbranch_scc1 else_40
buffer_store_dwordx4 v[212:215], v58, s[32:35], 0 offen sc1
buffer_store_dwordx2 v[108:109], v59, s[32:35], 0 offen offset:1024 sc1
buffer_store_dwordx2 v[118:119], v59, s[32:35], 0 offen offset:1536 sc1
s_branch fi_41
else_40:
ds_write_b128 v53, v[212:215]
ds_write_b64 v55, v[108:109] offset:1024
ds_write_b64 v55, v[118:119] offset:1536
v_mov_b32 v4, 1
ds_write_b32 v19, v4
fi_41:
v_mul_f32 v124, s66, v92
v_mul_f32 v125, s66, v94
v_mul_f32 v126, s66, v96
v_mul_f32 v127, s66, v98
.p2align 3
v_pk_fma_f32 v[156:157], v[140:141], v[92:93], v[156:157] op_sel:[0,1,0] op_sel_hi:[1,1,1]
v_pk_fma_f32 v[158:159], v[142:143], v[92:93], v[158:159] op_sel:[0,1,0] op_sel_hi:[1,1,1]
v_pk_fma_f32 v[160:161], v[144:145], v[92:93], v[160:161] op_sel:[0,1,0] op_sel_hi:[1,1,1]
v_pk_fma_f32 v[162:163], v[146:147], v[92:93], v[162:163] op_sel:[0,1,0] op_sel_hi:[1,1,1]
v_cvt_pk_bf16_f32 v156, v156, v157
v_cvt_pk_bf16_f32 v157, v158, v159
v_cvt_pk_bf16_f32 v158, v160, v161
v_cvt_pk_bf16_f32 v159, v162, v163
v_pk_fma_f32 v[164:165], v[140:141], v[94:95], v[164:165] op_sel:[0,1,0] op_sel_hi:[1,1,1]
v_pk_fma_f32 v[166:167], v[142:143], v[94:95], v[166:167] op_sel:[0,1,0] op_sel_hi:[1,1,1]
v_pk_fma_f32 v[168:169], v[144:145], v[94:95], v[168:169] op_sel:[0,1,0] op_sel_hi:[1,1,1]
v_pk_fma_f32 v[170:171], v[146:147], v[94:95], v[170:171] op_sel:[0,1,0] op_sel_hi:[1,1,1]
v_cvt_pk_bf16_f32 v164, v164, v165
v_cvt_pk_bf16_f32 v165, v166, v167
v_cvt_pk_bf16_f32 v166, v168, v169
v_cvt_pk_bf16_f32 v167, v170, v171
v_pk_fma_f32 v[172:173], v[140:141], v[96:97], v[172:173] op_sel:[0,1,0] op_sel_hi:[1,1,1]
v_pk_fma_f32 v[174:175], v[142:143], v[96:97], v[174:175] op_sel:[0,1,0] op_sel_hi:[1,1,1]
v_pk_fma_f32 v[176:177], v[144:145], v[96:97], v[176:177] op_sel:[0,1,0] op_sel_hi:[1,1,1]
v_pk_fma_f32 v[178:179], v[146:147], v[96:97], v[178:179] op_sel:[0,1,0] op_sel_hi:[1,1,1]
v_cvt_pk_bf16_f32 v172, v172, v173
v_cvt_pk_bf16_f32 v173, v174, v175
v_cvt_pk_bf16_f32 v174, v176, v177
v_cvt_pk_bf16_f32 v175, v178, v179
v_pk_fma_f32 v[180:181], v[140:141], v[98:99], v[180:181] op_sel:[0,1,0] op_sel_hi:[1,1,1]
v_pk_fma_f32 v[182:183], v[142:143], v[98:99], v[182:183] op_sel:[0,1,0] op_sel_hi:[1,1,1]
v_pk_fma_f32 v[184:185], v[144:145], v[98:99], v[184:185] op_sel:[0,1,0] op_sel_hi:[1,1,1]
v_pk_fma_f32 v[186:187], v[146:147], v[98:99], v[186:187] op_sel:[0,1,0] op_sel_hi:[1,1,1]
v_cvt_pk_bf16_f32 v180, v180, v181
v_cvt_pk_bf16_f32 v181, v182, v183
v_cvt_pk_bf16_f32 v182, v184, v185
v_cvt_pk_bf16_f32 v183, v186, v187
v_pk_fma_f32 v[188:189], v[148:149], v[92:93], v[188:189] op_sel:[0,1,0] op_sel_hi:[1,1,1]
v_pk_fma_f32 v[190:191], v[150:151], v[92:93], v[190:191] op_sel:[0,1,0] op_sel_hi:[1,1,1]
v_pk_fma_f32 v[192:193], v[152:153], v[92:93], v[192:193] op_sel:[0,1,0] op_sel_hi:[1,1,1]
v_pk_fma_f32 v[194:195], v[154:155], v[92:93], v[194:195] op_sel:[0,1,0] op_sel_hi:[1,1,1]
v_pk_mul_f32 v[188:189], v[188:189], v[92:93] op_sel:[0,0] op_sel_hi:[1,0]
v_pk_mul_f32 v[190:191], v[190:191], v[92:93] op_sel:[0,0] op_sel_hi:[1,0]
v_pk_mul_f32 v[192:193], v[192:193], v[92:93] op_sel:[0,0] op_sel_hi:[1,0]
v_pk_mul_f32 v[194:195], v[194:195], v[92:93] op_sel:[0,0] op_sel_hi:[1,0]
v_cvt_pk_bf16_f32 v188, v188, v189
v_cvt_pk_bf16_f32 v189, v190, v191
v_cvt_pk_bf16_f32 v190, v192, v193
v_cvt_pk_bf16_f32 v191, v194, v195
v_pk_fma_f32 v[196:197], v[148:149], v[94:95], v[196:197] op_sel:[0,1,0] op_sel_hi:[1,1,1]
v_pk_fma_f32 v[198:199], v[150:151], v[94:95], v[198:199] op_sel:[0,1,0] op_sel_hi:[1,1,1]
v_pk_fma_f32 v[200:201], v[152:153], v[94:95], v[200:201] op_sel:[0,1,0] op_sel_hi:[1,1,1]
v_pk_fma_f32 v[202:203], v[154:155], v[94:95], v[202:203] op_sel:[0,1,0] op_sel_hi:[1,1,1]
v_pk_mul_f32 v[196:197], v[196:197], v[94:95] op_sel:[0,0] op_sel_hi:[1,0]
v_pk_mul_f32 v[198:199], v[198:199], v[94:95] op_sel:[0,0] op_sel_hi:[1,0]
v_pk_mul_f32 v[200:201], v[200:201], v[94:95] op_sel:[0,0] op_sel_hi:[1,0]
v_pk_mul_f32 v[202:203], v[202:203], v[94:95] op_sel:[0,0] op_sel_hi:[1,0]
v_cvt_pk_bf16_f32 v196, v196, v197
v_cvt_pk_bf16_f32 v197, v198, v199
v_cvt_pk_bf16_f32 v198, v200, v201
v_cvt_pk_bf16_f32 v199, v202, v203
v_pk_fma_f32 v[204:205], v[148:149], v[96:97], v[204:205] op_sel:[0,1,0] op_sel_hi:[1,1,1]
v_pk_fma_f32 v[206:207], v[150:151], v[96:97], v[206:207] op_sel:[0,1,0] op_sel_hi:[1,1,1]
v_pk_fma_f32 v[208:209], v[152:153], v[96:97], v[208:209] op_sel:[0,1,0] op_sel_hi:[1,1,1]
v_pk_fma_f32 v[210:211], v[154:155], v[96:97], v[210:211] op_sel:[0,1,0] op_sel_hi:[1,1,1]
v_pk_mul_f32 v[204:205], v[204:205], v[96:97] op_sel:[0,0] op_sel_hi:[1,0]
v_pk_mul_f32 v[206:207], v[206:207], v[96:97] op_sel:[0,0] op_sel_hi:[1,0]
v_pk_mul_f32 v[208:209], v[208:209], v[96:97] op_sel:[0,0] op_sel_hi:[1,0]
v_pk_mul_f32 v[210:211], v[210:211], v[96:97] op_sel:[0,0] op_sel_hi:[1,0]
v_cvt_pk_bf16_f32 v204, v204, v205
v_cvt_pk_bf16_f32 v205, v206, v207
v_cvt_pk_bf16_f32 v206, v208, v209
v_cvt_pk_bf16_f32 v207, v210, v211
s_cmp_lg_u32 s44, 0
s_cbranch_scc1 else_42
buffer_load_dwordx4 v[120:123], v58, s[32:35], 0 offen sc1
buffer_load_dwordx2 v[100:101], v59, s[32:35], 0 offen offset:1024 sc1
buffer_load_dwordx2 v[110:111], v59, s[32:35], 0 offen offset:1536 sc1
else_42:
.p2align 3
v_mfma_f32_16x16x32_bf16 v[216:219], v[212:215], v[180:183], v[40:43]
v_pk_fma_f32 v[220:221], v[76:77], v[56:57], v[220:221] op_sel:[0,0,0] op_sel_hi:[1,0,1]
v_pk_fma_f32 v[222:223], v[78:79], v[56:57], v[222:223] op_sel:[0,0,0] op_sel_hi:[1,0,1]
v_pk_mul_f32 v[220:221], v[220:221], v[60:61]
v_pk_mul_f32 v[222:223], v[222:223], v[62:63]
v_cvt_pk_bf16_f32 v102, v220, v221
v_mfma_f32_16x16x32_bf16 v[192:195], v[188:191], v[156:159], v[40:43]
v_cvt_pk_bf16_f32 v103, v222, v223
v_pk_fma_f32 v[224:225], v[76:77], v[56:57], v[224:225] op_sel:[0,1,0] op_sel_hi:[1,1,1]
v_pk_fma_f32 v[226:227], v[78:79], v[56:57], v[226:227] op_sel:[0,1,0] op_sel_hi:[1,1,1]
v_pk_mul_f32 v[224:225], v[224:225], v[60:61]
v_pk_mul_f32 v[226:227], v[226:227], v[62:63]
v_cvt_pk_bf16_f32 v112, v224, v225
v_mfma_f32_16x16x32_bf16 v[168:171], v[188:191], v[164:167], v[36:39]
v_cvt_pk_bf16_f32 v113, v226, v227
v_pk_fma_f32 v[228:229], v[80:81], v[56:57], v[228:229] op_sel:[0,0,0] op_sel_hi:[1,0,1]
v_pk_fma_f32 v[230:231], v[82:83], v[56:57], v[230:231] op_sel:[0,0,0] op_sel_hi:[1,0,1]
v_pk_mul_f32 v[228:229], v[228:229], v[64:65]
v_pk_mul_f32 v[230:231], v[230:231], v[66:67]
v_cvt_pk_bf16_f32 v104, v228, v229
v_mfma_f32_16x16x32_bf16 v[200:203], v[196:199], v[164:167], v[40:43]
v_cvt_pk_bf16_f32 v105, v230, v231
v_pk_fma_f32 v[232:233], v[80:81], v[56:57], v[232:233] op_sel:[0,1,0] op_sel_hi:[1,1,1]
v_pk_fma_f32 v[234:235], v[82:83], v[56:57], v[234:235] op_sel:[0,1,0] op_sel_hi:[1,1,1]
v_pk_mul_f32 v[232:233], v[232:233], v[64:65]
v_pk_mul_f32 v[234:235], v[234:235], v[66:67]
v_cvt_pk_bf16_f32 v114, v232, v233
v_mfma_f32_16x16x32_bf16 v[176:179], v[196:199], v[172:175], v[36:39]
v_cvt_pk_bf16_f32 v115, v234, v235
v_pk_fma_f32 v[236:237], v[84:85], v[56:57], v[236:237] op_sel:[0,0,0] op_sel_hi:[1,0,1]
v_pk_fma_f32 v[238:239], v[86:87], v[56:57], v[238:239] op_sel:[0,0,0] op_sel_hi:[1,0,1]
v_pk_mul_f32 v[236:237], v[236:237], v[68:69]
v_pk_mul_f32 v[238:239], v[238:239], v[70:71]
v_cvt_pk_bf16_f32 v106, v236, v237
v_mfma_f32_16x16x32_bf16 v[208:211], v[204:207], v[172:175], v[40:43]
v_cvt_pk_bf16_f32 v107, v238, v239
v_pk_fma_f32 v[240:241], v[84:85], v[56:57], v[240:241] op_sel:[0,1,0] op_sel_hi:[1,1,1]
v_pk_fma_f32 v[242:243], v[86:87], v[56:57], v[242:243] op_sel:[0,1,0] op_sel_hi:[1,1,1]
v_pk_mul_f32 v[240:241], v[240:241], v[68:69]
v_pk_mul_f32 v[242:243], v[242:243], v[70:71]
v_cvt_pk_bf16_f32 v116, v240, v241
v_mfma_f32_16x16x32_bf16 v[184:187], v[204:207], v[180:183], v[36:39]
v_cvt_pk_bf16_f32 v117, v242, v243
v_max_f32 v166, v200, v201
v_max_f32 v167, v202, v203
v_max_f32 v164, v168, v169
v_max_f32 v165, v170, v171
v_max3_f32 v129, v164, v165, v166
v_max_f32 v129, v129, v167
s_cmp_lg_u32 s44, 0
s_cbranch_scc1 else_44
s_mov_b32 s63, 0
sent_46:
s_waitcnt vmcnt(0)
v_max_u32 v4, v120, v121
v_max3_u32 v4, v4, v122, v123
v_max3_u32 v4, v4, v100, v101
v_max3_u32 v4, v4, v110, v111
v_cmp_eq_u32 vcc, -1, v4
s_cbranch_vccz sentd_47
buffer_load_dwordx4 v[120:123], v58, s[32:35], 0 offen sc1
buffer_load_dwordx2 v[100:101], v59, s[32:35], 0 offen offset:1024 sc1
buffer_load_dwordx2 v[110:111], v59, s[32:35], 0 offen offset:1536 sc1
s_add_u32 s63, s63, 1
s_cmp_lt_u32 s63, 0x80000
s_cbranch_scc1 sent_46
s_waitcnt vmcnt(0)
sentd_47:
s_branch fi_45
else_44:
s_mov_b32 s63, 0
px_48:
ds_read_b32 v4, v19
ds_read_b128 v[120:123], v53
ds_read_b64 v[100:101], v55 offset:1024
ds_read_b64 v[110:111], v55 offset:1536
s_add_u32 s63, s63, 1
s_cmp_lt_u32 s63, 0x400000
s_waitcnt lgkmcnt(0)
v_cmp_ne_u32 vcc, 1, v4
s_cbranch_vccz pxd_49
s_cbranch_scc1 px_48
pxd_49:
fi_45:
v_mfma_f32_16x16x32_bf16 v[160:163], v[120:123], v[156:159], v[44:47]
v_max_f32 v174, v208, v209
v_max_f32 v175, v210, v211
v_max_f32 v172, v176, v177
v_max_f32 v173, v178, v179
v_max3_f32 v130, v172, v173, v174
v_max_f32 v130, v130, v175
v_max_f32 v182, v216, v217
v_max_f32 v183, v218, v219
v_max_f32 v180, v184, v185
v_max_f32 v181, v186, v187
v_max3_f32 v131, v180, v181, v182
v_max_f32 v131, v131, v183
v_max_f32 v158, v192, v193
v_max_f32 v159, v194, v195
v_max_f32 v156, v160, v161
v_max_f32 v157, v162, v163
v_max3_f32 v128, v156, v157, v158
v_max_f32 v128, v128, v159
s_nop 1
v_permlane32_swap_b32 v128, v129
v_permlane32_swap_b32 v130, v131
v_max_f32 v128, v128, v129
v_max_f32 v130, v130, v131
s_nop 1
v_permlane16_swap_b32 v128, v130
s_nop 0
v_max_f32 v128, v128, v130
v_mov_b32 v130, v128
s_nop 1
v_permlane16_swap_b32 v128, v130
s_nop 0
v_mov_b32 v129, v128
v_mov_b32 v131, v130
s_nop 0
v_permlane32_swap_b32 v128, v129
v_permlane32_swap_b32 v130, v131
v_pk_mul_f32 v[128:129], v[128:129], v[124:125]
v_pk_mul_f32 v[130:131], v[130:131], v[126:127]
v_pk_fma_f32 v[156:157], v[156:157], v[124:125], v[128:129] op_sel:[0,0,0] op_sel_hi:[1,0,0] neg_lo:[0,0,1] neg_hi:[0,0,1]
v_pk_fma_f32 v[158:159], v[158:159], v[124:125], v[128:129] op_sel:[0,0,0] op_sel_hi:[1,0,0] neg_lo:[0,0,1] neg_hi:[0,0,1]
v_exp_f32 v156, v156
v_exp_f32 v157, v157
v_exp_f32 v158, v158
v_exp_f32 v159, v159
v_cvt_pk_bf16_f32 v156, v156, v156
v_cvt_pk_bf16_f32 v157, v157, v157
v_cvt_pk_bf16_f32 v158, v158, v158
v_cvt_pk_bf16_f32 v159, v159, v159
v_and_b32 v156, v52, v156
v_and_b32 v157, v52, v157
v_and_b32 v158, v52, v158
v_and_b32 v159, v52, v159
v_pk_fma_f32 v[164:165], v[164:165], v[124:125], v[128:129] op_sel:[0,1,1] op_sel_hi:[1,1,1] neg_lo:[0,0,1] neg_hi:[0,0,1]
v_pk_fma_f32 v[166:167], v[166:167], v[124:125], v[128:129] op_sel:[0,1,1] op_sel_hi:[1,1,1] neg_lo:[0,0,1] neg_hi:[0,0,1]
v_exp_f32 v164, v164
v_mfma_f32_16x16x32_bf16 v[160:163], v[48:51], v[156:159], 0
v_exp_f32 v165, v165
v_exp_f32 v166, v166
v_exp_f32 v167, v167
v_cvt_pk_bf16_f32 v164, v164, v164
v_mfma_f32_16x16x32_bf16 v[220:223], v[100:103], v[156:159], 0
v_cvt_pk_bf16_f32 v165, v165, v165
v_cvt_pk_bf16_f32 v166, v166, v166
v_cvt_pk_bf16_f32 v167, v167, v167
v_and_b32 v164, v52, v164
v_mfma_f32_16x16x32_bf16 v[224:227], v[110:113], v[156:159], 0
v_and_b32 v165, v52, v165
v_and_b32 v166, v52, v166
v_and_b32 v167, v52, v167
v_pk_fma_f32 v[172:173], v[172:173], v[126:127], v[130:131] op_sel:[0,0,0] op_sel_hi:[1,0,0] neg_lo:[0,0,1] neg_hi:[0,0,1]
v_pk_fma_f32 v[174:175], v[174:175], v[126:127], v[130:131] op_sel:[0,0,0] op_sel_hi:[1,0,0] neg_lo:[0,0,1] neg_hi:[0,0,1]
v_exp_f32 v172, v172
v_mfma_f32_16x16x32_bf16 v[168:171], v[48:51], v[164:167], 0
v_exp_f32 v173, v173
v_exp_f32 v174, v174
v_exp_f32 v175, v175
v_cvt_pk_bf16_f32 v172, v172, v172
v_mfma_f32_16x16x32_bf16 v[228:231], v[102:105], v[164:167], 0
v_cvt_pk_bf16_f32 v173, v173, v173
v_cvt_pk_bf16_f32 v174, v174, v174
v_cvt_pk_bf16_f32 v175, v175, v175
v_and_b32 v172, v52, v172
v_mfma_f32_16x16x32_bf16 v[232:235], v[112:115], v[164:167], 0
v_and_b32 v173, v52, v173
v_and_b32 v174, v52, v174
v_and_b32 v175, v52, v175
v_pk_fma_f32 v[180:181], v[180:181], v[126:127], v[130:131] op_sel:[0,1,1] op_sel_hi:[1,1,1] neg_lo:[0,0,1] neg_hi:[0,0,1]
v_pk_fma_f32 v[182:183], v[182:183], v[126:127], v[130:131] op_sel:[0,1,1] op_sel_hi:[1,1,1] neg_lo:[0,0,1] neg_hi:[0,0,1]
v_exp_f32 v180, v180
v_mfma_f32_16x16x32_bf16 v[176:179], v[48:51], v[172:175], 0
v_exp_f32 v181, v181
v_exp_f32 v182, v182
v_exp_f32 v183, v183
v_cvt_pk_bf16_f32 v180, v180, v180
v_mfma_f32_16x16x32_bf16 v[236:239], v[104:107], v[172:175], 0
v_cvt_pk_bf16_f32 v181, v181, v181
v_cvt_pk_bf16_f32 v182, v182, v182
v_cvt_pk_bf16_f32 v183, v183, v183
v_and_b32 v180, v52, v180
v_mfma_f32_16x16x32_bf16 v[240:243], v[114:117], v[172:175], 0
v_and_b32 v181, v52, v181
v_and_b32 v182, v52, v182
v_and_b32 v183, v52, v183
v_rcp_f32 v160, v160
v_rcp_f32 v168, v168
v_mfma_f32_16x16x32_bf16 v[184:187], v[48:51], v[180:183], 0
v_mfma_f32_16x16x32_bf16 v[244:247], v[106:109], v[180:183], 0
v_mfma_f32_16x16x32_bf16 v[248:251], v[116:119], v[180:183], 0
v_rcp_f32 v176, v176
s_nop 4
v_rcp_f32 v184, v184
s_cmp_eq_u32 s46, 0
s_cbranch_scc1 slow_50
.p2align 3
v_pk_mul_f32 v[220:221], v[220:221], v[160:161] op_sel:[0,0] op_sel_hi:[1,0]
v_pk_mul_f32 v[222:223], v[222:223], v[160:161] op_sel:[0,0] op_sel_hi:[1,0]
v_pk_mul_f32 v[224:225], v[224:225], v[160:161] op_sel:[0,0] op_sel_hi:[1,0]
v_pk_mul_f32 v[226:227], v[226:227], v[160:161] op_sel:[0,0] op_sel_hi:[1,0]
v_cvt_pk_bf16_f32 v220, v220, v221
v_cvt_pk_bf16_f32 v221, v222, v223
v_cvt_pk_bf16_f32 v222, v224, v225
v_cvt_pk_bf16_f32 v223, v226, v227
buffer_store_dwordx4 v[220:223], v18, s[32:35], s80 offen sc1
v_pk_mul_f32 v[228:229], v[228:229], v[168:169] op_sel:[0,0] op_sel_hi:[1,0]
v_pk_mul_f32 v[230:231], v[230:231], v[168:169] op_sel:[0,0] op_sel_hi:[1,0]
v_pk_mul_f32 v[232:233], v[232:233], v[168:169] op_sel:[0,0] op_sel_hi:[1,0]
v_pk_mul_f32 v[234:235], v[234:235], v[168:169] op_sel:[0,0] op_sel_hi:[1,0]
v_cvt_pk_bf16_f32 v228, v228, v229
v_cvt_pk_bf16_f32 v229, v230, v231
v_cvt_pk_bf16_f32 v230, v232, v233
v_cvt_pk_bf16_f32 v231, v234, v235
buffer_store_dwordx4 v[228:231], v18, s[32:35], s81 offen sc1
v_pk_mul_f32 v[236:237], v[236:237], v[176:177] op_sel:[0,0] op_sel_hi:[1,0]
v_pk_mul_f32 v[238:239], v[238:239], v[176:177] op_sel:[0,0] op_sel_hi:[1,0]
v_pk_mul_f32 v[240:241], v[240:241], v[176:177] op_sel:[0,0] op_sel_hi:[1,0]
v_pk_mul_f32 v[242:243], v[242:243], v[176:177] op_sel:[0,0] op_sel_hi:[1,0]
v_cvt_pk_bf16_f32 v236, v236, v237
v_cvt_pk_bf16_f32 v237, v238, v239
v_cvt_pk_bf16_f32 v238, v240, v241
v_cvt_pk_bf16_f32 v239, v242, v243
buffer_store_dwordx4 v[236:239], v18, s[32:35], s82 offen sc1
v_pk_mul_f32 v[244:245], v[244:245], v[184:185] op_sel:[0,0] op_sel_hi:[1,0]
v_pk_mul_f32 v[246:247], v[246:247], v[184:185] op_sel:[0,0] op_sel_hi:[1,0]
v_pk_mul_f32 v[248:249], v[248:249], v[184:185] op_sel:[0,0] op_sel_hi:[1,0]
v_pk_mul_f32 v[250:251], v[250:251], v[184:185] op_sel:[0,0] op_sel_hi:[1,0]
v_cvt_pk_bf16_f32 v244, v244, v245
v_cvt_pk_bf16_f32 v245, v246, v247
v_cvt_pk_bf16_f32 v246, v248, v249
v_cvt_pk_bf16_f32 v247, v250, v251
buffer_store_dwordx4 v[244:247], v18, s[32:35], s83 offen sc1
s_barrier
s_lshl_b32 s62, s45, 2
v_mov_b32 v4, s62
v_mov_b32 v5, 1
s_mov_b64 exec, 1
s_waitcnt vmcnt(0)
buffer_store_dword v5, v4, s[32:35], s84 offen
s_mov_b64 exec, -1
back_51:
v_and_b32 v36, 31, v0
v_lshlrev_b32 v36, 2, v36
buffer_load_dword v37, v36, s[32:35], s84 offen sc1
v_lshrrev_b32 v4, 2, v2
v_and_b32 v5, 3, v0
v_lshl_add_u32 v6, v3, 3, v4
v_lshlrev_b32 v6, 7, v6
v_lshl_add_u32 v6, v5, 3, v6
v_lshrrev_b32 v7, 1, v4
v_and_b32 v8, 1, v3
v_lshl_add_u32 v7, v8, 1, v7
v_lshl_add_u32 v10, v7, 5, v6
v_xor_b32 v11, 32, v10
v_xor_b32 v12, 64, v10
v_xor_b32 v13, 96, v10
v_add_u32 v14, 0x10000, v10
v_add_u32 v15, 0x10000, v11
v_add_u32 v16, 0x10000, v12
v_add_u32 v17, 0x10000, v13
ds_read_b64_tr_b16 v[220:221], v10 offset:0
ds_read_b64_tr_b16 v[222:223], v10 offset:512
ds_read_b64_tr_b16 v[224:225], v11 offset:0
ds_read_b64_tr_b16 v[226:227], v11 offset:512
ds_read_b64_tr_b16 v[228:229], v12 offset:0
ds_read_b64_tr_b16 v[230:231], v12 offset:512
ds_read_b64_tr_b16 v[232:233], v13 offset:0
ds_read_b64_tr_b16 v[234:235], v13 offset:512
ds_read_b64_tr_b16 v[236:237], v10 offset:4096
ds_read_b64_tr_b16 v[238:239], v10 offset:4608
ds_read_b64_tr_b16 v[240:241], v11 offset:4096
ds_read_b64_tr_b16 v[242:243], v11 offset:4608
ds_read_b64_tr_b16 v[244:245], v12 offset:4096
ds_read_b64_tr_b16 v[246:247], v12 offset:4608
ds_read_b64_tr_b16 v[248:249], v13 offset:4096
ds_read_b64_tr_b16 v[250:251], v13 offset:4608
s_lshl_b32 s48, s41, 3
s_lshl_b32 s49, s40, 1
s_add_u32 s48, s48, s49
s_lshl_b32 s48, s48, 15
s_add_u32 s48, s48, 4194304
v_add_u32 v38, s48, v18
v_add_u32 v39, 32768, v38
s_lshl_b32 s57, s47, 11
s_mov_b32 s63, 0
s_waitcnt vmcnt(0)
poll_52:
v_cmp_gt_u32 vcc, 1, v37
s_cbranch_vccz polled_53
buffer_load_dword v37, v36, s[32:35], s84 offen sc1
s_add_u32 s63, s63, 1
s_cmp_lt_u32 s63, 0x80000
s_waitcnt vmcnt(0)
s_cbranch_scc1 poll_52
polled_53:
buffer_load_dwordx4 v[156:159], v38, s[32:35], s57 offen sc1
buffer_load_dwordx4 v[160:163], v39, s[32:35], s57 offen sc1
buffer_load_dwordx4 v[164:167], v38, s[32:35], s57 offen offset:1024 sc1
buffer_load_dwordx4 v[168:171], v39, s[32:35], s57 offen offset:1024 sc1
s_add_u32 s57, s57, 2048
s_and_b32 s57, s57, 0x7fff
buffer_load_dwordx4 v[172:175], v38, s[32:35], s57 offen sc1
buffer_load_dwordx4 v[176:179], v39, s[32:35], s57 offen sc1
buffer_load_dwordx4 v[180:183], v38, s[32:35], s57 offen offset:1024 sc1
buffer_load_dwordx4 v[184:187], v39, s[32:35], s57 offen offset:1024 sc1
s_add_u32 s57, s57, 2048
s_and_b32 s57, s57, 0x7fff
v_permlane16_swap_b32 v20, v22
v_permlane16_swap_b32 v21, v23
v_permlane16_swap_b32 v24, v26
v_permlane16_swap_b32 v25, v27
v_permlane16_swap_b32 v28, v30
v_permlane16_swap_b32 v29, v31
v_permlane16_swap_b32 v32, v34
v_permlane16_swap_b32 v33, v35
v_lshlrev_b32 v60, 16, v20
v_and_b32 v61, 0xffff0000, v20
v_lshlrev_b32 v62, 16, v21
v_and_b32 v63, 0xffff0000, v21
v_lshlrev_b32 v64, 16, v22
v_and_b32 v65, 0xffff0000, v22
v_lshlrev_b32 v66, 16, v23
v_and_b32 v67, 0xffff0000, v23
v_lshlrev_b32 v68, 16, v24
v_and_b32 v69, 0xffff0000, v24
v_lshlrev_b32 v70, 16, v25
v_and_b32 v71, 0xffff0000, v25
v_lshlrev_b32 v72, 16, v26
v_and_b32 v73, 0xffff0000, v26
v_lshlrev_b32 v74, 16, v27
v_and_b32 v75, 0xffff0000, v27
v_lshlrev_b32 v76, 16, v28
v_and_b32 v77, 0xffff0000, v28
v_lshlrev_b32 v78, 16, v29
v_and_b32 v79, 0xffff0000, v29
v_lshlrev_b32 v80, 16, v30
v_and_b32 v81, 0xffff0000, v30
v_lshlrev_b32 v82, 16, v31
v_and_b32 v83, 0xffff0000, v31
v_lshlrev_b32 v84, 16, v32
v_and_b32 v85, 0xffff0000, v32
v_lshlrev_b32 v86, 16, v33
v_and_b32 v87, 0xffff0000, v33
v_lshlrev_b32 v88, 16, v34
v_and_b32 v89, 0xffff0000, v34
v_lshlrev_b32 v90, 16, v35
v_and_b32 v91, 0xffff0000, v35
v_mov_b32 v6, 0
v_mov_b32 v7, 0
v_mov_b32 v8, 0
v_mov_b32 v9, 0
s_lshl_b32 s62, s42, 2
v_mov_b32 v4, s62
v_mov_b32 v5, 1
buffer_load_dwordx4 v[188:191], v38, s[32:35], s57 offen sc1
buffer_load_dwordx4 v[192:195], v39, s[32:35], s57 offen sc1
buffer_load_dwordx4 v[196:199], v38, s[32:35], s57 offen offset:1024 sc1
buffer_load_dwordx4 v[200:203], v39, s[32:35], s57 offen offset:1024 sc1
s_add_u32 s57, s57, 2048
s_and_b32 s57, s57, 0x7fff
s_waitcnt vmcnt(10) lgkmcnt(8)
v_mfma_f32_16x16x32_bf16 v[60:63], v[220:223], v[156:159], v[60:63]
ds_read_b64_tr_b16 v[100:101], v10 offset:8192
ds_read_b64_tr_b16 v[102:103], v10 offset:8704
v_mfma_f32_16x16x32_bf16 v[76:79], v[220:223], v[160:163], v[76:79]
buffer_load_dwordx4 v[204:207], v38, s[32:35], s57 offen sc1
v_mfma_f32_16x16x32_bf16 v[64:67], v[224:227], v[156:159], v[64:67]
ds_read_b64_tr_b16 v[104:105], v11 offset:8192
v_mfma_f32_16x16x32_bf16 v[80:83], v[224:227], v[160:163], v[80:83]
ds_read_b64_tr_b16 v[106:107], v11 offset:8704
v_mfma_f32_16x16x32_bf16 v[68:71], v[228:231], v[156:159], v[68:71]
ds_read_b64_tr_b16 v[108:109], v12 offset:8192
buffer_load_dwordx4 v[208:211], v39, s[32:35], s57 offen sc1
v_mfma_f32_16x16x32_bf16 v[84:87], v[228:231], v[160:163], v[84:87]
ds_read_b64_tr_b16 v[110:111], v12 offset:8704
v_mfma_f32_16x16x32_bf16 v[72:75], v[232:235], v[156:159], v[72:75]
ds_read_b64_tr_b16 v[112:113], v13 offset:8192
v_mfma_f32_16x16x32_bf16 v[88:91], v[232:235], v[160:163], v[88:91]
ds_read_b64_tr_b16 v[114:115], v13 offset:8704
s_waitcnt vmcnt(10) lgkmcnt(8)
v_mfma_f32_16x16x32_bf16 v[60:63], v[236:239], v[164:167], v[60:63]
ds_read_b64_tr_b16 v[220:221], v10 offset:12288
ds_read_b64_tr_b16 v[222:223], v10 offset:12800
v_mfma_f32_16x16x32_bf16 v[76:79], v[236:239], v[168:171], v[76:79]
buffer_load_dwordx4 v[212:215], v38, s[32:35], s57 offen offset:1024 sc1
v_mfma_f32_16x16x32_bf16 v[64:67], v[240:243], v[164:167], v[64:67]
ds_read_b64_tr_b16 v[224:225], v11 offset:12288
v_mfma_f32_16x16x32_bf16 v[80:83], v[240:243], v[168:171], v[80:83]
ds_read_b64_tr_b16 v[226:227], v11 offset:12800
v_mfma_f32_16x16x32_bf16 v[68:71], v[244:247], v[164:167], v[68:71]
ds_read_b64_tr_b16 v[228:229], v12 offset:12288
buffer_load_dwordx4 v[216:219], v39, s[32:35], s57 offen offset:1024 sc1
s_add_u32 s57, s57, 2048
s_and_b32 s57, s57, 0x7fff
v_mfma_f32_16x16x32_bf16 v[84:87], v[244:247], v[168:171], v[84:87]
ds_read_b64_tr_b16 v[230:231], v12 offset:12800
v_mfma_f32_16x16x32_bf16 v[72:75], v[248:251], v[164:167], v[72:75]
ds_read_b64_tr_b16 v[232:233], v13 offset:12288
v_mfma_f32_16x16x32_bf16 v[88:91], v[248:251], v[168:171], v[88:91]
ds_read_b64_tr_b16 v[234:235], v13 offset:12800
s_waitcnt vmcnt(10) lgkmcnt(8)
v_mfma_f32_16x16x32_bf16 v[60:63], v[100:103], v[172:175], v[60:63]
ds_read_b64_tr_b16 v[236:237], v10 offset:16384
ds_read_b64_tr_b16 v[238:239], v10 offset:16896
v_mfma_f32_16x16x32_bf16 v[76:79], v[100:103], v[176:179], v[76:79]
buffer_load_dwordx4 v[156:159], v38, s[32:35], s57 offen sc1
v_mfma_f32_16x16x32_bf16 v[64:67], v[104:107], v[172:175], v[64:67]
ds_read_b64_tr_b16 v[240:241], v11 offset:16384
v_mfma_f32_16x16x32_bf16 v[80:83], v[104:107], v[176:179], v[80:83]
ds_read_b64_tr_b16 v[242:243], v11 offset:16896
v_mfma_f32_16x16x32_bf16 v[68:71], v[108:111], v[172:175], v[68:71]
ds_read_b64_tr_b16 v[244:245], v12 offset:16384
buffer_load_dwordx4 v[160:163], v39, s[32:35], s57 offen sc1
v_mfma_f32_16x16x32_bf16 v[84:87], v[108:111], v[176:179], v[84:87]
ds_read_b64_tr_b16 v[246:247], v12 offset:16896
v_mfma_f32_16x16x32_bf16 v[72:75], v[112:115], v[172:175], v[72:75]
ds_read_b64_tr_b16 v[248:249], v13 offset:16384
v_mfma_f32_16x16x32_bf16 v[88:91], v[112:115], v[176:179], v[88:91]
ds_read_b64_tr_b16 v[250:251], v13 offset:16896
s_waitcnt vmcnt(10) lgkmcnt(8)
v_mfma_f32_16x16x32_bf16 v[60:63], v[220:223], v[180:183], v[60:63]
ds_read_b64_tr_b16 v[100:101], v10 offset:20480
ds_read_b64_tr_b16 v[102:103], v10 offset:20992
v_mfma_f32_16x16x32_bf16 v[76:79], v[220:223], v[184:187], v[76:79]
buffer_load_dwordx4 v[164:167], v38, s[32:35], s57 offen offset:1024 sc1
v_mfma_f32_16x16x32_bf16 v[64:67], v[224:227], v[180:183], v[64:67]
ds_read_b64_tr_b16 v[104:105], v11 offset:20480
v_mfma_f32_16x16x32_bf16 v[80:83], v[224:227], v[184:187], v[80:83]
ds_read_b64_tr_b16 v[106:107], v11 offset:20992
v_mfma_f32_16x16x32_bf16 v[68:71], v[228:231], v[180:183], v[68:71]
ds_read_b64_tr_b16 v[108:109], v12 offset:20480
buffer_load_dwordx4 v[168:171], v39, s[32:35], s57 offen offset:1024 sc1
s_add_u32 s57, s57, 2048
s_and_b32 s57, s57, 0x7fff
v_mfma_f32_16x16x32_bf16 v[84:87], v[228:231], v[184:187], v[84:87]
ds_read_b64_tr_b16 v[110:111], v12 offset:20992
v_mfma_f32_16x16x32_bf16 v[72:75], v[232:235], v[180:183], v[72:75]
ds_read_b64_tr_b16 v[112:113], v13 offset:20480
v_mfma_f32_16x16x32_bf16 v[88:91], v[232:235], v[184:187], v[88:91]
ds_read_b64_tr_b16 v[114:115], v13 offset:20992
s_waitcnt vmcnt(10) lgkmcnt(8)
v_mfma_f32_16x16x32_bf16 v[60:63], v[236:239], v[188:191], v[60:63]
ds_read_b64_tr_b16 v[220:221], v10 offset:24576
ds_read_b64_tr_b16 v[222:223], v10 offset:25088
v_mfma_f32_16x16x32_bf16 v[76:79], v[236:239], v[192:195], v[76:79]
buffer_load_dwordx4 v[172:175], v38, s[32:35], s57 offen sc1
v_mfma_f32_16x16x32_bf16 v[64:67], v[240:243], v[188:191], v[64:67]
ds_read_b64_tr_b16 v[224:225], v11 offset:24576
v_mfma_f32_16x16x32_bf16 v[80:83], v[240:243], v[192:195], v[80:83]
ds_read_b64_tr_b16 v[226:227], v11 offset:25088
v_mfma_f32_16x16x32_bf16 v[68:71], v[244:247], v[188:191], v[68:71]
ds_read_b64_tr_b16 v[228:229], v12 offset:24576
buffer_load_dwordx4 v[176:179], v39, s[32:35], s57 offen sc1
v_mfma_f32_16x16x32_bf16 v[84:87], v[244:247], v[192:195], v[84:87]
ds_read_b64_tr_b16 v[230:231], v12 offset:25088
v_mfma_f32_16x16x32_bf16 v[72:75], v[248:251], v[188:191], v[72:75]
ds_read_b64_tr_b16 v[232:233], v13 offset:24576
v_mfma_f32_16x16x32_bf16 v[88:91], v[248:251], v[192:195], v[88:91]
ds_read_b64_tr_b16 v[234:235], v13 offset:25088
s_waitcnt vmcnt(10) lgkmcnt(8)
v_mfma_f32_16x16x32_bf16 v[60:63], v[100:103], v[196:199], v[60:63]
ds_read_b64_tr_b16 v[236:237], v10 offset:28672
ds_read_b64_tr_b16 v[238:239], v10 offset:29184
v_mfma_f32_16x16x32_bf16 v[76:79], v[100:103], v[200:203], v[76:79]
buffer_load_dwordx4 v[180:183], v38, s[32:35], s57 offen offset:1024 sc1
v_mfma_f32_16x16x32_bf16 v[64:67], v[104:107], v[196:199], v[64:67]
ds_read_b64_tr_b16 v[240:241], v11 offset:28672
v_mfma_f32_16x16x32_bf16 v[80:83], v[104:107], v[200:203], v[80:83]
ds_read_b64_tr_b16 v[242:243], v11 offset:29184
v_mfma_f32_16x16x32_bf16 v[68:71], v[108:111], v[196:199], v[68:71]
ds_read_b64_tr_b16 v[244:245], v12 offset:28672
buffer_load_dwordx4 v[184:187], v39, s[32:35], s57 offen offset:1024 sc1
s_add_u32 s57, s57, 2048
s_and_b32 s57, s57, 0x7fff
v_mfma_f32_16x16x32_bf16 v[84:87], v[108:111], v[200:203], v[84:87]
ds_read_b64_tr_b16 v[246:247], v12 offset:29184
v_mfma_f32_16x16x32_bf16 v[72:75], v[112:115], v[196:199], v[72:75]
ds_read_b64_tr_b16 v[248:249], v13 offset:28672
v_mfma_f32_16x16x32_bf16 v[88:91], v[112:115], v[200:203], v[88:91]
ds_read_b64_tr_b16 v[250:251], v13 offset:29184
s_waitcnt vmcnt(10) lgkmcnt(8)
v_mfma_f32_16x16x32_bf16 v[60:63], v[220:223], v[204:207], v[60:63]
ds_read_b64_tr_b16 v[100:101], v10 offset:32768
ds_read_b64_tr_b16 v[102:103], v10 offset:33280
v_mfma_f32_16x16x32_bf16 v[76:79], v[220:223], v[208:211], v[76:79]
buffer_load_dwordx4 v[188:191], v38, s[32:35], s57 offen sc1
v_mfma_f32_16x16x32_bf16 v[64:67], v[224:227], v[204:207], v[64:67]
ds_read_b64_tr_b16 v[104:105], v11 offset:32768
v_mfma_f32_16x16x32_bf16 v[80:83], v[224:227], v[208:211], v[80:83]
ds_read_b64_tr_b16 v[106:107], v11 offset:33280
v_mfma_f32_16x16x32_bf16 v[68:71], v[228:231], v[204:207], v[68:71]
ds_read_b64_tr_b16 v[108:109], v12 offset:32768
buffer_load_dwordx4 v[192:195], v39, s[32:35], s57 offen sc1
v_mfma_f32_16x16x32_bf16 v[84:87], v[228:231], v[208:211], v[84:87]
ds_read_b64_tr_b16 v[110:111], v12 offset:33280
v_mfma_f32_16x16x32_bf16 v[72:75], v[232:235], v[204:207], v[72:75]
ds_read_b64_tr_b16 v[112:113], v13 offset:32768
v_mfma_f32_16x16x32_bf16 v[88:91], v[232:235], v[208:211], v[88:91]
ds_read_b64_tr_b16 v[114:115], v13 offset:33280
s_waitcnt vmcnt(10) lgkmcnt(8)
v_mfma_f32_16x16x32_bf16 v[60:63], v[236:239], v[212:215], v[60:63]
ds_read_b64_tr_b16 v[220:221], v10 offset:36864
ds_read_b64_tr_b16 v[222:223], v10 offset:37376
v_mfma_f32_16x16x32_bf16 v[76:79], v[236:239], v[216:219], v[76:79]
buffer_load_dwordx4 v[196:199], v38, s[32:35], s57 offen offset:1024 sc1
v_mfma_f32_16x16x32_bf16 v[64:67], v[240:243], v[212:215], v[64:67]
ds_read_b64_tr_b16 v[224:225], v11 offset:36864
v_mfma_f32_16x16x32_bf16 v[80:83], v[240:243], v[216:219], v[80:83]
ds_read_b64_tr_b16 v[226:227], v11 offset:37376
v_mfma_f32_16x16x32_bf16 v[68:71], v[244:247], v[212:215], v[68:71]
ds_read_b64_tr_b16 v[228:229], v12 offset:36864
buffer_load_dwordx4 v[200:203], v39, s[32:35], s57 offen offset:1024 sc1
s_add_u32 s57, s57, 2048
s_and_b32 s57, s57, 0x7fff
v_mfma_f32_16x16x32_bf16 v[84:87], v[244:247], v[216:219], v[84:87]
ds_read_b64_tr_b16 v[230:231], v12 offset:37376
v_mfma_f32_16x16x32_bf16 v[72:75], v[248:251], v[212:215], v[72:75]
ds_read_b64_tr_b16 v[232:233], v13 offset:36864
v_mfma_f32_16x16x32_bf16 v[88:91], v[248:251], v[216:219], v[88:91]
ds_read_b64_tr_b16 v[234:235], v13 offset:37376
s_waitcnt vmcnt(10) lgkmcnt(8)
v_mfma_f32_16x16x32_bf16 v[60:63], v[100:103], v[156:159], v[60:63]
ds_read_b64_tr_b16 v[236:237], v10 offset:40960
ds_read_b64_tr_b16 v[238:239], v10 offset:41472
v_mfma_f32_16x16x32_bf16 v[76:79], v[100:103], v[160:163], v[76:79]
buffer_load_dwordx4 v[204:207], v38, s[32:35], s57 offen sc1
v_mfma_f32_16x16x32_bf16 v[64:67], v[104:107], v[156:159], v[64:67]
ds_read_b64_tr_b16 v[240:241], v11 offset:40960
v_mfma_f32_16x16x32_bf16 v[80:83], v[104:107], v[160:163], v[80:83]
ds_read_b64_tr_b16 v[242:243], v11 offset:41472
v_mfma_f32_16x16x32_bf16 v[68:71], v[108:111], v[156:159], v[68:71]
ds_read_b64_tr_b16 v[244:245], v12 offset:40960
buffer_load_dwordx4 v[208:211], v39, s[32:35], s57 offen sc1
v_mfma_f32_16x16x32_bf16 v[84:87], v[108:111], v[160:163], v[84:87]
ds_read_b64_tr_b16 v[246:247], v12 offset:41472
v_mfma_f32_16x16x32_bf16 v[72:75], v[112:115], v[156:159], v[72:75]
ds_read_b64_tr_b16 v[248:249], v13 offset:40960
v_mfma_f32_16x16x32_bf16 v[88:91], v[112:115], v[160:163], v[88:91]
ds_read_b64_tr_b16 v[250:251], v13 offset:41472
s_waitcnt vmcnt(10) lgkmcnt(8)
v_mfma_f32_16x16x32_bf16 v[60:63], v[220:223], v[164:167], v[60:63]
ds_read_b64_tr_b16 v[100:101], v10 offset:45056
ds_read_b64_tr_b16 v[102:103], v10 offset:45568
v_mfma_f32_16x16x32_bf16 v[76:79], v[220:223], v[168:171], v[76:79]
buffer_load_dwordx4 v[212:215], v38, s[32:35], s57 offen offset:1024 sc1
v_mfma_f32_16x16x32_bf16 v[64:67], v[224:227], v[164:167], v[64:67]
ds_read_b64_tr_b16 v[104:105], v11 offset:45056
v_mfma_f32_16x16x32_bf16 v[80:83], v[224:227], v[168:171], v[80:83]
ds_read_b64_tr_b16 v[106:107], v11 offset:45568
v_mfma_f32_16x16x32_bf16 v[68:71], v[228:231], v[164:167], v[68:71]
ds_read_b64_tr_b16 v[108:109], v12 offset:45056
buffer_load_dwordx4 v[216:219], v39, s[32:35], s57 offen offset:1024 sc1
s_add_u32 s57, s57, 2048
s_and_b32 s57, s57, 0x7fff
v_mfma_f32_16x16x32_bf16 v[84:87], v[228:231], v[168:171], v[84:87]
ds_read_b64_tr_b16 v[110:111], v12 offset:45568
v_mfma_f32_16x16x32_bf16 v[72:75], v[232:235], v[164:167], v[72:75]
ds_read_b64_tr_b16 v[112:113], v13 offset:45056
v_mfma_f32_16x16x32_bf16 v[88:91], v[232:235], v[168:171], v[88:91]
ds_read_b64_tr_b16 v[114:115], v13 offset:45568
s_waitcnt vmcnt(10) lgkmcnt(8)
v_mfma_f32_16x16x32_bf16 v[60:63], v[236:239], v[172:175], v[60:63]
ds_read_b64_tr_b16 v[220:221], v10 offset:49152
ds_read_b64_tr_b16 v[222:223], v10 offset:49664
v_mfma_f32_16x16x32_bf16 v[76:79], v[236:239], v[176:179], v[76:79]
buffer_load_dwordx4 v[156:159], v38, s[32:35], s57 offen sc1
v_mfma_f32_16x16x32_bf16 v[64:67], v[240:243], v[172:175], v[64:67]
ds_read_b64_tr_b16 v[224:225], v11 offset:49152
v_mfma_f32_16x16x32_bf16 v[80:83], v[240:243], v[176:179], v[80:83]
ds_read_b64_tr_b16 v[226:227], v11 offset:49664
v_mfma_f32_16x16x32_bf16 v[68:71], v[244:247], v[172:175], v[68:71]
ds_read_b64_tr_b16 v[228:229], v12 offset:49152
buffer_load_dwordx4 v[160:163], v39, s[32:35], s57 offen sc1
v_mfma_f32_16x16x32_bf16 v[84:87], v[244:247], v[176:179], v[84:87]
ds_read_b64_tr_b16 v[230:231], v12 offset:49664
v_mfma_f32_16x16x32_bf16 v[72:75], v[248:251], v[172:175], v[72:75]
ds_read_b64_tr_b16 v[232:233], v13 offset:49152
v_mfma_f32_16x16x32_bf16 v[88:91], v[248:251], v[176:179], v[88:91]
ds_read_b64_tr_b16 v[234:235], v13 offset:49664
s_waitcnt vmcnt(10) lgkmcnt(8)
v_mfma_f32_16x16x32_bf16 v[60:63], v[100:103], v[180:183], v[60:63]
ds_read_b64_tr_b16 v[236:237], v10 offset:53248
ds_read_b64_tr_b16 v[238:239], v10 offset:53760
v_mfma_f32_16x16x32_bf16 v[76:79], v[100:103], v[184:187], v[76:79]
buffer_load_dwordx4 v[164:167], v38, s[32:35], s57 offen offset:1024 sc1
v_mfma_f32_16x16x32_bf16 v[64:67], v[104:107], v[180:183], v[64:67]
ds_read_b64_tr_b16 v[240:241], v11 offset:53248
v_mfma_f32_16x16x32_bf16 v[80:83], v[104:107], v[184:187], v[80:83]
ds_read_b64_tr_b16 v[242:243], v11 offset:53760
v_mfma_f32_16x16x32_bf16 v[68:71], v[108:111], v[180:183], v[68:71]
ds_read_b64_tr_b16 v[244:245], v12 offset:53248
buffer_load_dwordx4 v[168:171], v39, s[32:35], s57 offen offset:1024 sc1
s_add_u32 s57, s57, 2048
s_and_b32 s57, s57, 0x7fff
v_mfma_f32_16x16x32_bf16 v[84:87], v[108:111], v[184:187], v[84:87]
ds_read_b64_tr_b16 v[246:247], v12 offset:53760
v_mfma_f32_16x16x32_bf16 v[72:75], v[112:115], v[180:183], v[72:75]
ds_read_b64_tr_b16 v[248:249], v13 offset:53248
v_mfma_f32_16x16x32_bf16 v[88:91], v[112:115], v[184:187], v[88:91]
ds_read_b64_tr_b16 v[250:251], v13 offset:53760
s_waitcnt vmcnt(10) lgkmcnt(8)
v_mfma_f32_16x16x32_bf16 v[60:63], v[220:223], v[188:191], v[60:63]
ds_read_b64_tr_b16 v[100:101], v10 offset:57344
ds_read_b64_tr_b16 v[102:103], v10 offset:57856
v_mfma_f32_16x16x32_bf16 v[76:79], v[220:223], v[192:195], v[76:79]
buffer_load_dwordx4 v[172:175], v38, s[32:35], s57 offen sc1
v_mfma_f32_16x16x32_bf16 v[64:67], v[224:227], v[188:191], v[64:67]
ds_read_b64_tr_b16 v[104:105], v11 offset:57344
v_mfma_f32_16x16x32_bf16 v[80:83], v[224:227], v[192:195], v[80:83]
ds_read_b64_tr_b16 v[106:107], v11 offset:57856
v_mfma_f32_16x16x32_bf16 v[68:71], v[228:231], v[188:191], v[68:71]
ds_read_b64_tr_b16 v[108:109], v12 offset:57344
buffer_load_dwordx4 v[176:179], v39, s[32:35], s57 offen sc1
v_mfma_f32_16x16x32_bf16 v[84:87], v[228:231], v[192:195], v[84:87]
ds_read_b64_tr_b16 v[110:111], v12 offset:57856
v_mfma_f32_16x16x32_bf16 v[72:75], v[232:235], v[188:191], v[72:75]
ds_read_b64_tr_b16 v[112:113], v13 offset:57344
v_mfma_f32_16x16x32_bf16 v[88:91], v[232:235], v[192:195], v[88:91]
ds_read_b64_tr_b16 v[114:115], v13 offset:57856
s_waitcnt vmcnt(10) lgkmcnt(8)
v_mfma_f32_16x16x32_bf16 v[60:63], v[236:239], v[196:199], v[60:63]
ds_read_b64_tr_b16 v[220:221], v10 offset:61440
ds_read_b64_tr_b16 v[222:223], v10 offset:61952
v_mfma_f32_16x16x32_bf16 v[76:79], v[236:239], v[200:203], v[76:79]
buffer_load_dwordx4 v[180:183], v38, s[32:35], s57 offen offset:1024 sc1
v_mfma_f32_16x16x32_bf16 v[64:67], v[240:243], v[196:199], v[64:67]
ds_read_b64_tr_b16 v[224:225], v11 offset:61440
v_mfma_f32_16x16x32_bf16 v[80:83], v[240:243], v[200:203], v[80:83]
ds_read_b64_tr_b16 v[226:227], v11 offset:61952
v_mfma_f32_16x16x32_bf16 v[68:71], v[244:247], v[196:199], v[68:71]
ds_read_b64_tr_b16 v[228:229], v12 offset:61440
buffer_load_dwordx4 v[184:187], v39, s[32:35], s57 offen offset:1024 sc1
s_add_u32 s57, s57, 2048
s_and_b32 s57, s57, 0x7fff
v_mfma_f32_16x16x32_bf16 v[84:87], v[244:247], v[200:203], v[84:87]
ds_read_b64_tr_b16 v[230:231], v12 offset:61952
v_mfma_f32_16x16x32_bf16 v[72:75], v[248:251], v[196:199], v[72:75]
ds_read_b64_tr_b16 v[232:233], v13 offset:61440
v_mfma_f32_16x16x32_bf16 v[88:91], v[248:251], v[200:203], v[88:91]
ds_read_b64_tr_b16 v[234:235], v13 offset:61952
s_waitcnt vmcnt(10) lgkmcnt(8)
v_mfma_f32_16x16x32_bf16 v[60:63], v[100:103], v[204:207], v[60:63]
ds_read_b64_tr_b16 v[236:237], v14 offset:0
ds_read_b64_tr_b16 v[238:239], v14 offset:512
v_mfma_f32_16x16x32_bf16 v[76:79], v[100:103], v[208:211], v[76:79]
buffer_load_dwordx4 v[188:191], v38, s[32:35], s57 offen sc1
v_mfma_f32_16x16x32_bf16 v[64:67], v[104:107], v[204:207], v[64:67]
ds_read_b64_tr_b16 v[240:241], v15 offset:0
v_mfma_f32_16x16x32_bf16 v[80:83], v[104:107], v[208:211], v[80:83]
ds_read_b64_tr_b16 v[242:243], v15 offset:512
v_mfma_f32_16x16x32_bf16 v[68:71], v[108:111], v[204:207], v[68:71]
ds_read_b64_tr_b16 v[244:245], v16 offset:0
buffer_load_dwordx4 v[192:195], v39, s[32:35], s57 offen sc1
v_mfma_f32_16x16x32_bf16 v[84:87], v[108:111], v[208:211], v[84:87]
ds_read_b64_tr_b16 v[246:247], v16 offset:512
v_mfma_f32_16x16x32_bf16 v[72:75], v[112:115], v[204:207], v[72:75]
ds_read_b64_tr_b16 v[248:249], v17 offset:0
v_mfma_f32_16x16x32_bf16 v[88:91], v[112:115], v[208:211], v[88:91]
ds_read_b64_tr_b16 v[250:251], v17 offset:512
s_waitcnt vmcnt(10) lgkmcnt(8)
v_mfma_f32_16x16x32_bf16 v[60:63], v[220:223], v[212:215], v[60:63]
ds_read_b64_tr_b16 v[100:101], v14 offset:4096
ds_read_b64_tr_b16 v[102:103], v14 offset:4608
v_mfma_f32_16x16x32_bf16 v[76:79], v[220:223], v[216:219], v[76:79]
buffer_load_dwordx4 v[196:199], v38, s[32:35], s57 offen offset:1024 sc1
v_mfma_f32_16x16x32_bf16 v[64:67], v[224:227], v[212:215], v[64:67]
ds_read_b64_tr_b16 v[104:105], v15 offset:4096
v_mfma_f32_16x16x32_bf16 v[80:83], v[224:227], v[216:219], v[80:83]
ds_read_b64_tr_b16 v[106:107], v15 offset:4608
v_mfma_f32_16x16x32_bf16 v[68:71], v[228:231], v[212:215], v[68:71]
ds_read_b64_tr_b16 v[108:109], v16 offset:4096
buffer_load_dwordx4 v[200:203], v39, s[32:35], s57 offen offset:1024 sc1
s_add_u32 s57, s57, 2048
s_and_b32 s57, s57, 0x7fff
v_mfma_f32_16x16x32_bf16 v[84:87], v[228:231], v[216:219], v[84:87]
ds_read_b64_tr_b16 v[110:111], v16 offset:4608
v_mfma_f32_16x16x32_bf16 v[72:75], v[232:235], v[212:215], v[72:75]
ds_read_b64_tr_b16 v[112:113], v17 offset:4096
v_mfma_f32_16x16x32_bf16 v[88:91], v[232:235], v[216:219], v[88:91]
ds_read_b64_tr_b16 v[114:115], v17 offset:4608
s_waitcnt vmcnt(10) lgkmcnt(8)
v_mfma_f32_16x16x32_bf16 v[60:63], v[236:239], v[156:159], v[60:63]
ds_read_b64_tr_b16 v[220:221], v14 offset:8192
ds_read_b64_tr_b16 v[222:223], v14 offset:8704
v_mfma_f32_16x16x32_bf16 v[76:79], v[236:239], v[160:163], v[76:79]
buffer_load_dwordx4 v[204:207], v38, s[32:35], s57 offen sc1
v_mfma_f32_16x16x32_bf16 v[64:67], v[240:243], v[156:159], v[64:67]
ds_read_b64_tr_b16 v[224:225], v15 offset:8192
v_mfma_f32_16x16x32_bf16 v[80:83], v[240:243], v[160:163], v[80:83]
ds_read_b64_tr_b16 v[226:227], v15 offset:8704
v_mfma_f32_16x16x32_bf16 v[68:71], v[244:247], v[156:159], v[68:71]
ds_read_b64_tr_b16 v[228:229], v16 offset:8192
buffer_load_dwordx4 v[208:211], v39, s[32:35], s57 offen sc1
v_mfma_f32_16x16x32_bf16 v[84:87], v[244:247], v[160:163], v[84:87]
ds_read_b64_tr_b16 v[230:231], v16 offset:8704
v_mfma_f32_16x16x32_bf16 v[72:75], v[248:251], v[156:159], v[72:75]
ds_read_b64_tr_b16 v[232:233], v17 offset:8192
v_mfma_f32_16x16x32_bf16 v[88:91], v[248:251], v[160:163], v[88:91]
ds_read_b64_tr_b16 v[234:235], v17 offset:8704
s_waitcnt vmcnt(10) lgkmcnt(8)
v_mfma_f32_16x16x32_bf16 v[60:63], v[100:103], v[164:167], v[60:63]
ds_read_b64_tr_b16 v[236:237], v14 offset:12288
ds_read_b64_tr_b16 v[238:239], v14 offset:12800
v_mfma_f32_16x16x32_bf16 v[76:79], v[100:103], v[168:171], v[76:79]
buffer_load_dwordx4 v[212:215], v38, s[32:35], s57 offen offset:1024 sc1
v_mfma_f32_16x16x32_bf16 v[64:67], v[104:107], v[164:167], v[64:67]
ds_read_b64_tr_b16 v[240:241], v15 offset:12288
v_mfma_f32_16x16x32_bf16 v[80:83], v[104:107], v[168:171], v[80:83]
ds_read_b64_tr_b16 v[242:243], v15 offset:12800
v_mfma_f32_16x16x32_bf16 v[68:71], v[108:111], v[164:167], v[68:71]
ds_read_b64_tr_b16 v[244:245], v16 offset:12288
buffer_load_dwordx4 v[216:219], v39, s[32:35], s57 offen offset:1024 sc1
s_add_u32 s57, s57, 2048
s_and_b32 s57, s57, 0x7fff
v_mfma_f32_16x16x32_bf16 v[84:87], v[108:111], v[168:171], v[84:87]
ds_read_b64_tr_b16 v[246:247], v16 offset:12800
v_mfma_f32_16x16x32_bf16 v[72:75], v[112:115], v[164:167], v[72:75]
ds_read_b64_tr_b16 v[248:249], v17 offset:12288
v_mfma_f32_16x16x32_bf16 v[88:91], v[112:115], v[168:171], v[88:91]
ds_read_b64_tr_b16 v[250:251], v17 offset:12800
s_waitcnt vmcnt(10) lgkmcnt(8)
v_mfma_f32_16x16x32_bf16 v[60:63], v[220:223], v[172:175], v[60:63]
ds_read_b64_tr_b16 v[100:101], v14 offset:16384
ds_read_b64_tr_b16 v[102:103], v14 offset:16896
v_mfma_f32_16x16x32_bf16 v[76:79], v[220:223], v[176:179], v[76:79]
buffer_load_dwordx4 v[156:159], v38, s[32:35], s57 offen sc1
v_mfma_f32_16x16x32_bf16 v[64:67], v[224:227], v[172:175], v[64:67]
ds_read_b64_tr_b16 v[104:105], v15 offset:16384
v_mfma_f32_16x16x32_bf16 v[80:83], v[224:227], v[176:179], v[80:83]
ds_read_b64_tr_b16 v[106:107], v15 offset:16896
v_mfma_f32_16x16x32_bf16 v[68:71], v[228:231], v[172:175], v[68:71]
ds_read_b64_tr_b16 v[108:109], v16 offset:16384
buffer_load_dwordx4 v[160:163], v39, s[32:35], s57 offen sc1
v_mfma_f32_16x16x32_bf16 v[84:87], v[228:231], v[176:179], v[84:87]
ds_read_b64_tr_b16 v[110:111], v16 offset:16896
v_mfma_f32_16x16x32_bf16 v[72:75], v[232:235], v[172:175], v[72:75]
ds_read_b64_tr_b16 v[112:113], v17 offset:16384
v_mfma_f32_16x16x32_bf16 v[88:91], v[232:235], v[176:179], v[88:91]
ds_read_b64_tr_b16 v[114:115], v17 offset:16896
s_waitcnt vmcnt(10) lgkmcnt(8)
v_mfma_f32_16x16x32_bf16 v[60:63], v[236:239], v[180:183], v[60:63]
ds_read_b64_tr_b16 v[220:221], v14 offset:20480
ds_read_b64_tr_b16 v[222:223], v14 offset:20992
v_mfma_f32_16x16x32_bf16 v[76:79], v[236:239], v[184:187], v[76:79]
buffer_load_dwordx4 v[164:167], v38, s[32:35], s57 offen offset:1024 sc1
v_mfma_f32_16x16x32_bf16 v[64:67], v[240:243], v[180:183], v[64:67]
ds_read_b64_tr_b16 v[224:225], v15 offset:20480
v_mfma_f32_16x16x32_bf16 v[80:83], v[240:243], v[184:187], v[80:83]
ds_read_b64_tr_b16 v[226:227], v15 offset:20992
v_mfma_f32_16x16x32_bf16 v[68:71], v[244:247], v[180:183], v[68:71]
ds_read_b64_tr_b16 v[228:229], v16 offset:20480
buffer_load_dwordx4 v[168:171], v39, s[32:35], s57 offen offset:1024 sc1
s_add_u32 s57, s57, 2048
s_and_b32 s57, s57, 0x7fff
v_mfma_f32_16x16x32_bf16 v[84:87], v[244:247], v[184:187], v[84:87]
ds_read_b64_tr_b16 v[230:231], v16 offset:20992
v_mfma_f32_16x16x32_bf16 v[72:75], v[248:251], v[180:183], v[72:75]
ds_read_b64_tr_b16 v[232:233], v17 offset:20480
v_mfma_f32_16x16x32_bf16 v[88:91], v[248:251], v[184:187], v[88:91]
ds_read_b64_tr_b16 v[234:235], v17 offset:20992
s_waitcnt vmcnt(10) lgkmcnt(8)
v_mfma_f32_16x16x32_bf16 v[60:63], v[100:103], v[188:191], v[60:63]
ds_read_b64_tr_b16 v[236:237], v14 offset:24576
ds_read_b64_tr_b16 v[238:239], v14 offset:25088
v_mfma_f32_16x16x32_bf16 v[76:79], v[100:103], v[192:195], v[76:79]
buffer_load_dwordx4 v[172:175], v38, s[32:35], s57 offen sc1
v_mfma_f32_16x16x32_bf16 v[64:67], v[104:107], v[188:191], v[64:67]
ds_read_b64_tr_b16 v[240:241], v15 offset:24576
v_mfma_f32_16x16x32_bf16 v[80:83], v[104:107], v[192:195], v[80:83]
ds_read_b64_tr_b16 v[242:243], v15 offset:25088
v_mfma_f32_16x16x32_bf16 v[68:71], v[108:111], v[188:191], v[68:71]
ds_read_b64_tr_b16 v[244:245], v16 offset:24576
buffer_load_dwordx4 v[176:179], v39, s[32:35], s57 offen sc1
v_mfma_f32_16x16x32_bf16 v[84:87], v[108:111], v[192:195], v[84:87]
ds_read_b64_tr_b16 v[246:247], v16 offset:25088
v_mfma_f32_16x16x32_bf16 v[72:75], v[112:115], v[188:191], v[72:75]
ds_read_b64_tr_b16 v[248:249], v17 offset:24576
v_mfma_f32_16x16x32_bf16 v[88:91], v[112:115], v[192:195], v[88:91]
ds_read_b64_tr_b16 v[250:251], v17 offset:25088
s_waitcnt vmcnt(10) lgkmcnt(8)
v_mfma_f32_16x16x32_bf16 v[60:63], v[220:223], v[196:199], v[60:63]
ds_read_b64_tr_b16 v[100:101], v14 offset:28672
ds_read_b64_tr_b16 v[102:103], v14 offset:29184
v_mfma_f32_16x16x32_bf16 v[76:79], v[220:223], v[200:203], v[76:79]
buffer_load_dwordx4 v[180:183], v38, s[32:35], s57 offen offset:1024 sc1
v_mfma_f32_16x16x32_bf16 v[64:67], v[224:227], v[196:199], v[64:67]
ds_read_b64_tr_b16 v[104:105], v15 offset:28672
v_mfma_f32_16x16x32_bf16 v[80:83], v[224:227], v[200:203], v[80:83]
ds_read_b64_tr_b16 v[106:107], v15 offset:29184
v_mfma_f32_16x16x32_bf16 v[68:71], v[228:231], v[196:199], v[68:71]
ds_read_b64_tr_b16 v[108:109], v16 offset:28672
buffer_load_dwordx4 v[184:187], v39, s[32:35], s57 offen offset:1024 sc1
s_add_u32 s57, s57, 2048
s_and_b32 s57, s57, 0x7fff
v_mfma_f32_16x16x32_bf16 v[84:87], v[228:231], v[200:203], v[84:87]
ds_read_b64_tr_b16 v[110:111], v16 offset:29184
v_mfma_f32_16x16x32_bf16 v[72:75], v[232:235], v[196:199], v[72:75]
ds_read_b64_tr_b16 v[112:113], v17 offset:28672
v_mfma_f32_16x16x32_bf16 v[88:91], v[232:235], v[200:203], v[88:91]
ds_read_b64_tr_b16 v[114:115], v17 offset:29184
s_waitcnt vmcnt(10) lgkmcnt(8)
v_mfma_f32_16x16x32_bf16 v[60:63], v[236:239], v[204:207], v[60:63]
ds_read_b64_tr_b16 v[220:221], v14 offset:32768
ds_read_b64_tr_b16 v[222:223], v14 offset:33280
v_mfma_f32_16x16x32_bf16 v[76:79], v[236:239], v[208:211], v[76:79]
buffer_load_dwordx4 v[188:191], v38, s[32:35], s57 offen sc1
v_mfma_f32_16x16x32_bf16 v[64:67], v[240:243], v[204:207], v[64:67]
ds_read_b64_tr_b16 v[224:225], v15 offset:32768
v_mfma_f32_16x16x32_bf16 v[80:83], v[240:243], v[208:211], v[80:83]
ds_read_b64_tr_b16 v[226:227], v15 offset:33280
v_mfma_f32_16x16x32_bf16 v[68:71], v[244:247], v[204:207], v[68:71]
ds_read_b64_tr_b16 v[228:229], v16 offset:32768
buffer_load_dwordx4 v[192:195], v39, s[32:35], s57 offen sc1
v_mfma_f32_16x16x32_bf16 v[84:87], v[244:247], v[208:211], v[84:87]
ds_read_b64_tr_b16 v[230:231], v16 offset:33280
v_mfma_f32_16x16x32_bf16 v[72:75], v[248:251], v[204:207], v[72:75]
ds_read_b64_tr_b16 v[232:233], v17 offset:32768
v_mfma_f32_16x16x32_bf16 v[88:91], v[248:251], v[208:211], v[88:91]
ds_read_b64_tr_b16 v[234:235], v17 offset:33280
s_waitcnt vmcnt(10) lgkmcnt(8)
v_mfma_f32_16x16x32_bf16 v[60:63], v[100:103], v[212:215], v[60:63]
ds_read_b64_tr_b16 v[236:237], v14 offset:36864
ds_read_b64_tr_b16 v[238:239], v14 offset:37376
v_mfma_f32_16x16x32_bf16 v[76:79], v[100:103], v[216:219], v[76:79]
buffer_load_dwordx4 v[196:199], v38, s[32:35], s57 offen offset:1024 sc1
v_mfma_f32_16x16x32_bf16 v[64:67], v[104:107], v[212:215], v[64:67]
ds_read_b64_tr_b16 v[240:241], v15 offset:36864
v_mfma_f32_16x16x32_bf16 v[80:83], v[104:107], v[216:219], v[80:83]
ds_read_b64_tr_b16 v[242:243], v15 offset:37376
v_mfma_f32_16x16x32_bf16 v[68:71], v[108:111], v[212:215], v[68:71]
ds_read_b64_tr_b16 v[244:245], v16 offset:36864
buffer_load_dwordx4 v[200:203], v39, s[32:35], s57 offen offset:1024 sc1
s_add_u32 s57, s57, 2048
s_and_b32 s57, s57, 0x7fff
v_mfma_f32_16x16x32_bf16 v[84:87], v[108:111], v[216:219], v[84:87]
ds_read_b64_tr_b16 v[246:247], v16 offset:37376
v_mfma_f32_16x16x32_bf16 v[72:75], v[112:115], v[212:215], v[72:75]
ds_read_b64_tr_b16 v[248:249], v17 offset:36864
v_mfma_f32_16x16x32_bf16 v[88:91], v[112:115], v[216:219], v[88:91]
ds_read_b64_tr_b16 v[250:251], v17 offset:37376
s_waitcnt vmcnt(10) lgkmcnt(8)
v_mfma_f32_16x16x32_bf16 v[60:63], v[220:223], v[156:159], v[60:63]
ds_read_b64_tr_b16 v[100:101], v14 offset:40960
ds_read_b64_tr_b16 v[102:103], v14 offset:41472
v_mfma_f32_16x16x32_bf16 v[76:79], v[220:223], v[160:163], v[76:79]
buffer_load_dwordx4 v[204:207], v38, s[32:35], s57 offen sc1
v_mfma_f32_16x16x32_bf16 v[64:67], v[224:227], v[156:159], v[64:67]
ds_read_b64_tr_b16 v[104:105], v15 offset:40960
v_mfma_f32_16x16x32_bf16 v[80:83], v[224:227], v[160:163], v[80:83]
ds_read_b64_tr_b16 v[106:107], v15 offset:41472
v_mfma_f32_16x16x32_bf16 v[68:71], v[228:231], v[156:159], v[68:71]
ds_read_b64_tr_b16 v[108:109], v16 offset:40960
buffer_load_dwordx4 v[208:211], v39, s[32:35], s57 offen sc1
v_mfma_f32_16x16x32_bf16 v[84:87], v[228:231], v[160:163], v[84:87]
ds_read_b64_tr_b16 v[110:111], v16 offset:41472
v_mfma_f32_16x16x32_bf16 v[72:75], v[232:235], v[156:159], v[72:75]
ds_read_b64_tr_b16 v[112:113], v17 offset:40960
v_mfma_f32_16x16x32_bf16 v[88:91], v[232:235], v[160:163], v[88:91]
ds_read_b64_tr_b16 v[114:115], v17 offset:41472
s_waitcnt vmcnt(10) lgkmcnt(8)
v_mfma_f32_16x16x32_bf16 v[60:63], v[236:239], v[164:167], v[60:63]
ds_read_b64_tr_b16 v[220:221], v14 offset:45056
ds_read_b64_tr_b16 v[222:223], v14 offset:45568
v_mfma_f32_16x16x32_bf16 v[76:79], v[236:239], v[168:171], v[76:79]
buffer_load_dwordx4 v[212:215], v38, s[32:35], s57 offen offset:1024 sc1
v_mfma_f32_16x16x32_bf16 v[64:67], v[240:243], v[164:167], v[64:67]
ds_read_b64_tr_b16 v[224:225], v15 offset:45056
v_mfma_f32_16x16x32_bf16 v[80:83], v[240:243], v[168:171], v[80:83]
ds_read_b64_tr_b16 v[226:227], v15 offset:45568
v_mfma_f32_16x16x32_bf16 v[68:71], v[244:247], v[164:167], v[68:71]
ds_read_b64_tr_b16 v[228:229], v16 offset:45056
buffer_load_dwordx4 v[216:219], v39, s[32:35], s57 offen offset:1024 sc1
s_add_u32 s57, s57, 2048
s_and_b32 s57, s57, 0x7fff
v_mfma_f32_16x16x32_bf16 v[84:87], v[244:247], v[168:171], v[84:87]
ds_read_b64_tr_b16 v[230:231], v16 offset:45568
v_mfma_f32_16x16x32_bf16 v[72:75], v[248:251], v[164:167], v[72:75]
ds_read_b64_tr_b16 v[232:233], v17 offset:45056
v_mfma_f32_16x16x32_bf16 v[88:91], v[248:251], v[168:171], v[88:91]
ds_read_b64_tr_b16 v[234:235], v17 offset:45568
s_waitcnt vmcnt(10) lgkmcnt(8)
v_mfma_f32_16x16x32_bf16 v[60:63], v[100:103], v[172:175], v[60:63]
ds_read_b64_tr_b16 v[236:237], v14 offset:49152
v_mfma_f32_16x16x32_bf16 v[76:79], v[100:103], v[176:179], v[76:79]
ds_read_b64_tr_b16 v[238:239], v14 offset:49664
v_mfma_f32_16x16x32_bf16 v[64:67], v[104:107], v[172:175], v[64:67]
ds_read_b64_tr_b16 v[240:241], v15 offset:49152
v_mfma_f32_16x16x32_bf16 v[80:83], v[104:107], v[176:179], v[80:83]
ds_read_b64_tr_b16 v[242:243], v15 offset:49664
v_mfma_f32_16x16x32_bf16 v[68:71], v[108:111], v[172:175], v[68:71]
ds_read_b64_tr_b16 v[244:245], v16 offset:49152
v_mfma_f32_16x16x32_bf16 v[84:87], v[108:111], v[176:179], v[84:87]
ds_read_b64_tr_b16 v[246:247], v16 offset:49664
v_mfma_f32_16x16x32_bf16 v[72:75], v[112:115], v[172:175], v[72:75]
ds_read_b64_tr_b16 v[248:249], v17 offset:49152
v_mfma_f32_16x16x32_bf16 v[88:91], v[112:115], v[176:179], v[88:91]
ds_read_b64_tr_b16 v[250:251], v17 offset:49664
s_waitcnt vmcnt(8) lgkmcnt(8)
v_mfma_f32_16x16x32_bf16 v[60:63], v[220:223], v[180:183], v[60:63]
ds_read_b64_tr_b16 v[100:101], v14 offset:53248
v_mfma_f32_16x16x32_bf16 v[76:79], v[220:223], v[184:187], v[76:79]
ds_read_b64_tr_b16 v[102:103], v14 offset:53760
v_mfma_f32_16x16x32_bf16 v[64:67], v[224:227], v[180:183], v[64:67]
ds_read_b64_tr_b16 v[104:105], v15 offset:53248
v_mfma_f32_16x16x32_bf16 v[80:83], v[224:227], v[184:187], v[80:83]
ds_read_b64_tr_b16 v[106:107], v15 offset:53760
v_mfma_f32_16x16x32_bf16 v[68:71], v[228:231], v[180:183], v[68:71]
ds_read_b64_tr_b16 v[108:109], v16 offset:53248
v_mfma_f32_16x16x32_bf16 v[84:87], v[228:231], v[184:187], v[84:87]
ds_read_b64_tr_b16 v[110:111], v16 offset:53760
v_mfma_f32_16x16x32_bf16 v[72:75], v[232:235], v[180:183], v[72:75]
ds_read_b64_tr_b16 v[112:113], v17 offset:53248
v_mfma_f32_16x16x32_bf16 v[88:91], v[232:235], v[184:187], v[88:91]
ds_read_b64_tr_b16 v[114:115], v17 offset:53760
s_waitcnt vmcnt(6) lgkmcnt(8)
v_mfma_f32_16x16x32_bf16 v[60:63], v[236:239], v[188:191], v[60:63]
ds_read_b64_tr_b16 v[220:221], v14 offset:57344
v_mfma_f32_16x16x32_bf16 v[76:79], v[236:239], v[192:195], v[76:79]
ds_read_b64_tr_b16 v[222:223], v14 offset:57856
v_mfma_f32_16x16x32_bf16 v[64:67], v[240:243], v[188:191], v[64:67]
ds_read_b64_tr_b16 v[224:225], v15 offset:57344
v_mfma_f32_16x16x32_bf16 v[80:83], v[240:243], v[192:195], v[80:83]
ds_read_b64_tr_b16 v[226:227], v15 offset:57856
v_mfma_f32_16x16x32_bf16 v[68:71], v[244:247], v[188:191], v[68:71]
ds_read_b64_tr_b16 v[228:229], v16 offset:57344
v_mfma_f32_16x16x32_bf16 v[84:87], v[244:247], v[192:195], v[84:87]
ds_read_b64_tr_b16 v[230:231], v16 offset:57856
v_mfma_f32_16x16x32_bf16 v[72:75], v[248:251], v[188:191], v[72:75]
ds_read_b64_tr_b16 v[232:233], v17 offset:57344
v_mfma_f32_16x16x32_bf16 v[88:91], v[248:251], v[192:195], v[88:91]
ds_read_b64_tr_b16 v[234:235], v17 offset:57856
s_waitcnt vmcnt(4) lgkmcnt(8)
v_mfma_f32_16x16x32_bf16 v[60:63], v[100:103], v[196:199], v[60:63]
ds_read_b64_tr_b16 v[236:237], v14 offset:61440
v_mfma_f32_16x16x32_bf16 v[76:79], v[100:103], v[200:203], v[76:79]
ds_read_b64_tr_b16 v[238:239], v14 offset:61952
v_mfma_f32_16x16x32_bf16 v[64:67], v[104:107], v[196:199], v[64:67]
ds_read_b64_tr_b16 v[240:241], v15 offset:61440
v_mfma_f32_16x16x32_bf16 v[80:83], v[104:107], v[200:203], v[80:83]
ds_read_b64_tr_b16 v[242:243], v15 offset:61952
v_mfma_f32_16x16x32_bf16 v[68:71], v[108:111], v[196:199], v[68:71]
ds_read_b64_tr_b16 v[244:245], v16 offset:61440
v_mfma_f32_16x16x32_bf16 v[84:87], v[108:111], v[200:203], v[84:87]
ds_read_b64_tr_b16 v[246:247], v16 offset:61952
v_mfma_f32_16x16x32_bf16 v[72:75], v[112:115], v[196:199], v[72:75]
ds_read_b64_tr_b16 v[248:249], v17 offset:61440
v_mfma_f32_16x16x32_bf16 v[88:91], v[112:115], v[200:203], v[88:91]
ds_read_b64_tr_b16 v[250:251], v17 offset:61952
s_waitcnt vmcnt(2) lgkmcnt(8)
v_mfma_f32_16x16x32_bf16 v[60:63], v[220:223], v[204:207], v[60:63]
v_mfma_f32_16x16x32_bf16 v[76:79], v[220:223], v[208:211], v[76:79]
v_mfma_f32_16x16x32_bf16 v[64:67], v[224:227], v[204:207], v[64:67]
v_mfma_f32_16x16x32_bf16 v[80:83], v[224:227], v[208:211], v[80:83]
v_mfma_f32_16x16x32_bf16 v[68:71], v[228:231], v[204:207], v[68:71]
v_mfma_f32_16x16x32_bf16 v[84:87], v[228:231], v[208:211], v[84:87]
v_mfma_f32_16x16x32_bf16 v[72:75], v[232:235], v[204:207], v[72:75]
v_mfma_f32_16x16x32_bf16 v[88:91], v[232:235], v[208:211], v[88:91]
s_waitcnt vmcnt(0) lgkmcnt(0)
v_mfma_f32_16x16x32_bf16 v[60:63], v[236:239], v[212:215], v[60:63]
v_mfma_f32_16x16x32_bf16 v[64:67], v[240:243], v[212:215], v[64:67]
v_mfma_f32_16x16x32_bf16 v[68:71], v[244:247], v[212:215], v[68:71]
v_mfma_f32_16x16x32_bf16 v[72:75], v[248:251], v[212:215], v[72:75]
v_mfma_f32_16x16x32_bf16 v[76:79], v[236:239], v[216:219], v[76:79]
v_mfma_f32_16x16x32_bf16 v[80:83], v[240:243], v[216:219], v[80:83]
v_mfma_f32_16x16x32_bf16 v[84:87], v[244:247], v[216:219], v[84:87]
v_mfma_f32_16x16x32_bf16 v[88:91], v[248:251], v[216:219], v[88:91]
s_cmp_eq_u32 s46, 0
s_cbranch_scc1 slow_54
s_nop 0
v_cvt_pk_bf16_f32 v20, v60, v61
v_cvt_pk_bf16_f32 v21, v62, v63
v_cvt_pk_bf16_f32 v22, v64, v65
v_cvt_pk_bf16_f32 v23, v66, v67
buffer_store_dwordx4 v[20:23], v18, s[32:35], s85 offen offset:0 sc1
v_cvt_pk_bf16_f32 v24, v68, v69
v_cvt_pk_bf16_f32 v25, v70, v71
v_cvt_pk_bf16_f32 v26, v72, v73
v_cvt_pk_bf16_f32 v27, v74, v75
buffer_store_dwordx4 v[24:27], v18, s[32:35], s85 offen offset:1024 sc1
v_cvt_pk_bf16_f32 v28, v76, v77
v_cvt_pk_bf16_f32 v29, v78, v79
v_cvt_pk_bf16_f32 v30, v80, v81
v_cvt_pk_bf16_f32 v31, v82, v83
buffer_store_dwordx4 v[28:31], v18, s[32:35], s86 offen offset:0 sc1
v_cvt_pk_bf16_f32 v32, v84, v85
v_cvt_pk_bf16_f32 v33, v86, v87
v_cvt_pk_bf16_f32 v34, v88, v89
v_cvt_pk_bf16_f32 v35, v90, v91
buffer_store_dwordx4 v[32:35], v18, s[32:35], s86 offen offset:1024 sc1
s_barrier
v_dot2c_f32_bf16 v6, v20, v48
v_dot2c_f32_bf16 v8, v20, v20
v_dot2c_f32_bf16 v7, v28, v48
v_dot2c_f32_bf16 v9, v28, v28
v_dot2c_f32_bf16 v6, v21, v48
v_dot2c_f32_bf16 v8, v21, v21
v_dot2c_f32_bf16 v7, v29, v48
v_dot2c_f32_bf16 v9, v29, v29
v_dot2c_f32_bf16 v6, v22, v48
v_dot2c_f32_bf16 v8, v22, v22
v_dot2c_f32_bf16 v7, v30, v48
v_dot2c_f32_bf16 v9, v30, v30
v_dot2c_f32_bf16 v6, v23, v48
v_dot2c_f32_bf16 v8, v23, v23
v_dot2c_f32_bf16 v7, v31, v48
v_dot2c_f32_bf16 v9, v31, v31
v_dot2c_f32_bf16 v6, v24, v48
v_dot2c_f32_bf16 v8, v24, v24
v_dot2c_f32_bf16 v7, v32, v48
v_dot2c_f32_bf16 v9, v32, v32
v_dot2c_f32_bf16 v6, v25, v48
v_dot2c_f32_bf16 v8, v25, v25
v_dot2c_f32_bf16 v7, v33, v48
v_dot2c_f32_bf16 v9, v33, v33
v_dot2c_f32_bf16 v6, v26, v48
v_dot2c_f32_bf16 v8, v26, v26
v_dot2c_f32_bf16 v7, v34, v48
v_dot2c_f32_bf16 v9, v34, v34
v_dot2c_f32_bf16 v6, v27, v48
v_dot2c_f32_bf16 v8, v27, v27
v_dot2c_f32_bf16 v7, v35, v48
v_dot2c_f32_bf16 v9, v35, v35
s_mov_b64 exec, 1
s_waitcnt vmcnt(0)
buffer_store_dword v5, v4, s[32:35], s88 offen
s_mov_b64 exec, -1
s_nop 1
v_permlane32_swap_b32 v6, v7
v_permlane32_swap_b32 v8, v9
v_add_f32 v6, v6, v7
v_add_f32 v8, v8, v9
s_nop 1
v_permlane16_swap_b32 v6, v8
s_nop 0
v_add_f32 v6, v6, v8
buffer_store_dword v6, v1, s[32:35], s87 offen
back_55:
s_lshl_b32 s49, s44, 13
v_add_u32 v10, s49, v18
v_add_u32 v11, 1024, v10
s_lshl_b32 s48, s43, 1
v_lshrrev_b32 v4, 2, v2
v_and_b32 v5, 3, v0
v_lshl_add_u32 v6, v3, 3, v4
v_lshlrev_b32 v6, 7, v6
v_lshl_add_u32 v6, v5, 3, v6
v_lshrrev_b32 v7, 1, v4
v_and_b32 v8, 1, v3
v_lshl_add_u32 v7, v8, 1, v7
v_xor_b32 v7, s48, v7
v_lshl_add_u32 v12, v7, 5, v6
v_add_u32 v12, 16384, v12
v_xor_b32 v13, 32, v12
v_mov_b32 v14, v10
v_mov_b32 v15, v11
v_add_u32 v16, 122880, v12
v_add_u32 v17, 122880, v13
v_mov_b32 v156, 0
v_mov_b32 v157, 0
v_mov_b32 v158, 0
v_mov_b32 v159, 0
v_mov_b32 v160, 0
v_mov_b32 v161, 0
v_mov_b32 v162, 0
v_mov_b32 v163, 0
v_mov_b32 v164, 0
v_mov_b32 v165, 0
v_mov_b32 v166, 0
v_mov_b32 v167, 0
v_mov_b32 v168, 0
v_mov_b32 v169, 0
v_mov_b32 v170, 0
v_mov_b32 v171, 0
v_mov_b32 v172, 0
v_mov_b32 v173, 0
v_mov_b32 v174, 0
v_mov_b32 v175, 0
v_mov_b32 v176, 0
v_mov_b32 v177, 0
v_mov_b32 v178, 0
v_mov_b32 v179, 0
v_mov_b32 v180, 0
v_mov_b32 v181, 0
v_mov_b32 v182, 0
v_mov_b32 v183, 0
v_mov_b32 v184, 0
v_mov_b32 v185, 0
v_mov_b32 v186, 0
v_mov_b32 v187, 0
v_mov_b32 v188, 0
v_mov_b32 v189, 0
v_mov_b32 v190, 0
v_mov_b32 v191, 0
v_mov_b32 v192, 0
v_mov_b32 v193, 0
v_mov_b32 v194, 0
v_mov_b32 v195, 0
v_mov_b32 v196, 0
v_mov_b32 v197, 0
v_mov_b32 v198, 0
v_mov_b32 v199, 0
v_mov_b32 v200, 0
v_mov_b32 v201, 0
v_mov_b32 v202, 0
v_mov_b32 v203, 0
v_mov_b32 v204, 0
v_mov_b32 v205, 0
v_mov_b32 v206, 0
v_mov_b32 v207, 0
v_mov_b32 v208, 0
v_mov_b32 v209, 0
v_mov_b32 v210, 0
v_mov_b32 v211, 0
v_mov_b32 v212, 0
v_mov_b32 v213, 0
v_mov_b32 v214, 0
v_mov_b32 v215, 0
v_mov_b32 v216, 0
v_mov_b32 v217, 0
v_mov_b32 v218, 0
v_mov_b32 v219, 0
v_mov_b32 v220, 0
v_mov_b32 v221, 0
v_mov_b32 v222, 0
v_mov_b32 v223, 0
v_mov_b32 v224, 0
v_mov_b32 v225, 0
v_mov_b32 v226, 0
v_mov_b32 v227, 0
v_mov_b32 v228, 0
v_mov_b32 v229, 0
v_mov_b32 v230, 0
v_mov_b32 v231, 0
v_mov_b32 v232, 0
v_mov_b32 v233, 0
v_mov_b32 v234, 0
v_mov_b32 v235, 0
v_mov_b32 v236, 0
v_mov_b32 v237, 0
v_mov_b32 v238, 0
v_mov_b32 v239, 0
v_mov_b32 v240, 0
v_mov_b32 v241, 0
v_mov_b32 v242, 0
v_mov_b32 v243, 0
v_mov_b32 v244, 0
v_mov_b32 v245, 0
v_mov_b32 v246, 0
v_mov_b32 v247, 0
v_mov_b32 v248, 0
v_mov_b32 v249, 0
v_mov_b32 v250, 0
v_mov_b32 v251, 0
v_lshrrev_b32 v6, 2, v2
v_cmp_eq_u32 vcc, v6, v3
v_and_b32 v7, 1, v0
v_lshlrev_b32 v7, 4, v7
v_mov_b32 v8, 0x3f80
v_lshlrev_b32 v9, v7, v8
v_cndmask_b32 v7, 0, v9, vcc
v_and_b32 v6, 2, v0
v_cmp_eq_u32 vcc, 0, v6
v_mov_b32 v36, 0
v_mov_b32 v37, 0
v_mov_b32 v40, 0
v_mov_b32 v41, 0
v_cndmask_b32 v38, 0, v7, vcc
v_cndmask_b32 v39, v7, 0, vcc
v_lshrrev_b32 v8, 1, v2
v_cmp_eq_u32 vcc, 0, v8
s_nop 1
v_cndmask_b32 v44, 0, v9, vcc
v_cmp_eq_u32 vcc, 1, v8
s_nop 1
v_cndmask_b32 v45, 0, v9, vcc
v_cmp_eq_u32 vcc, 2, v8
s_nop 1
v_cndmask_b32 v46, 0, v9, vcc
v_cmp_eq_u32 vcc, 3, v8
s_nop 1
v_cndmask_b32 v47, 0, v9, vcc
v_lshrrev_b32 v4, 2, v2
v_lshl_add_u32 v4, v3, 2, v4
v_lshlrev_b32 v4, 6, v4
v_and_b32 v5, 3, v0
v_lshl_add_u32 v4, v5, 3, v4
s_lshl_b32 s48, s43, 11
s_add_u32 s48, s48, 135168
v_add_u32 v53, s48, v4
s_mul_i32 s48, s40, 3072
s_add_u32 s48, s48, 139264
v_add_u32 v42, s48, v18
s_xor_b32 s49, s40, 2
s_mul_i32 s48, s49, 3072
s_add_u32 s48, s48, 139264
v_add_u32 v43, s48, v18
s_lshl_b32 s49, s49, 2
s_add_u32 s49, s49, 134672
v_mov_b32 v19, s49
v_xor_b32 v52, 8, v19
v_lshrrev_b32 v4, 3, v0
v_and_b32 v5, 7, v0
v_lshlrev_b32 v4, 11, v4
v_lshl_add_u32 v55, v5, 4, v4
v_lshlrev_b32 v4, 6, v2
v_lshl_add_u32 v58, v3, 4, v4
v_lshlrev_b32 v4, 4, v2
v_lshl_add_u32 v59, v3, 3, v4
s_lshl_b32 s48, s45, 16
s_lshl_b32 s49, s44, 15
s_add_u32 s48, s48, s49
s_add_u32 s48, s48, 10485760
s_lshl_b32 s49, s41, 7
s_add_u32 s53, s48, s49
s_add_u32 s54, s53, 16384
s_lshl_b32 s50, s41, 11
s_add_u32 s55, s48, s50
s_lshl_b32 s56, s45, 11
s_lshl_b32 s50, s44, 10
s_add_u32 s56, s56, s50
s_lshl_b32 s58, s56, 1
s_add_u32 s56, s56, 14680064
s_xor_b32 s57, s56, 1024
s_add_u32 s58, s58, 14811136
s_xor_b32 s59, s58, 2048
s_add_u32 s79, s58, s49
s_lshl_b32 s48, s43, 7
s_add_u32 s48, s48, 133888
v_lshl_add_u32 v7, v3, 4, s48
v_lshl_add_u32 v54, v2, 2, s48
s_lshl_b32 s49, s44, 6
v_add_u32 v8, s49, v2
v_lshlrev_b32 v8, 3, v8
v_add_u32 v8, 131072, v8
v_lshl_add_u32 v9, v3, 2, s49
v_lshlrev_b32 v9, 2, v9
v_add_u32 v9, 132096, v9
s_mov_b32 s64, 0
s_mov_b32 s65, 0
s_mov_b32 s66, 0x3fb8aa3b
s_lshl_b32 s75, 1, s77
s_or_b32 s75, s75, 8
s_waitcnt vmcnt(0)
s_cmp_eq_u32 s46, 0
s_cbranch_scc1 slow_56
s_lshl_b32 s62, s42, 2
v_mov_b32 v4, s62
v_mov_b32 v5, 1
s_mov_b64 exec, 1
buffer_store_dword v5, v4, s[32:35], s89 offen
s_mov_b64 exec, -1
back_57:
s_barrier
ds_read_b128 v[60:63], v14 offset:0
ds_read_b128 v[64:67], v14 offset:2048
ds_read_b128 v[68:71], v14 offset:4096
ds_read_b128 v[72:75], v14 offset:6144
ds_read_b64_tr_b16 v[84:85], v16 offset:8192
ds_read_b64_tr_b16 v[86:87], v16 offset:8704
ds_read_b64_tr_b16 v[88:89], v17 offset:8192
ds_read_b64_tr_b16 v[90:91], v17 offset:8704
ds_read_b64_tr_b16 v[92:93], v16 offset:16384
ds_read_b64_tr_b16 v[94:95], v16 offset:16896
ds_read_b64_tr_b16 v[96:97], v17 offset:16384
ds_read_b64_tr_b16 v[98:99], v17 offset:16896
ds_read_b64_tr_b16 v[76:77], v16 offset:0
ds_read_b64_tr_b16 v[78:79], v16 offset:512
ds_read_b64_tr_b16 v[80:81], v17 offset:0
ds_read_b64_tr_b16 v[82:83], v17 offset:512
s_waitcnt lgkmcnt(0)
c1_loop:
v_mfma_f32_16x16x32_bf16 v[212:215], v[84:87], v[72:75], v[212:215]
ds_read_b128 v[100:103], v15 offset:0
v_mfma_f32_16x16x32_bf16 v[204:207], v[84:87], v[68:71], v[204:207]
ds_read_b128 v[104:107], v15 offset:2048
v_mfma_f32_16x16x32_bf16 v[196:199], v[84:87], v[64:67], v[196:199]
ds_read_b128 v[108:111], v15 offset:4096
v_mfma_f32_16x16x32_bf16 v[188:191], v[84:87], v[60:63], v[188:191]
ds_read_b128 v[112:115], v15 offset:6144
v_mfma_f32_16x16x32_bf16 v[192:195], v[88:91], v[60:63], v[192:195]
ds_read_b64_tr_b16 v[124:125], v16 offset:12288
v_mfma_f32_16x16x32_bf16 v[200:203], v[88:91], v[64:67], v[200:203]
ds_read_b64_tr_b16 v[126:127], v16 offset:12800
v_mfma_f32_16x16x32_bf16 v[208:211], v[88:91], v[68:71], v[208:211]
ds_read_b64_tr_b16 v[128:129], v17 offset:12288
v_mfma_f32_16x16x32_bf16 v[216:219], v[88:91], v[72:75], v[216:219]
ds_read_b64_tr_b16 v[130:131], v17 offset:12800
v_mfma_f32_16x16x32_bf16 v[244:247], v[72:75], v[92:95], v[244:247]
ds_read_b64_tr_b16 v[132:133], v16 offset:20480
v_mfma_f32_16x16x32_bf16 v[236:239], v[68:71], v[92:95], v[236:239]
ds_read_b64_tr_b16 v[134:135], v16 offset:20992
v_mfma_f32_16x16x32_bf16 v[228:231], v[64:67], v[92:95], v[228:231]
ds_read_b64_tr_b16 v[136:137], v17 offset:20480
v_mfma_f32_16x16x32_bf16 v[220:223], v[60:63], v[92:95], v[220:223]
ds_read_b64_tr_b16 v[138:139], v17 offset:20992
v_mfma_f32_16x16x32_bf16 v[224:227], v[60:63], v[96:99], v[224:227]
ds_read_b64_tr_b16 v[116:117], v16 offset:4096
v_mfma_f32_16x16x32_bf16 v[232:235], v[64:67], v[96:99], v[232:235]
ds_read_b64_tr_b16 v[118:119], v16 offset:4608
v_mfma_f32_16x16x32_bf16 v[240:243], v[68:71], v[96:99], v[240:243]
ds_read_b64_tr_b16 v[120:121], v17 offset:4096
v_mfma_f32_16x16x32_bf16 v[248:251], v[72:75], v[96:99], v[248:251]
ds_read_b64_tr_b16 v[122:123], v17 offset:4608
v_mfma_f32_16x16x32_bf16 v[180:183], v[76:79], v[72:75], v[180:183]
s_bitcmp1_b32 s75, s64
s_cbranch_scc1 c1_hook
c1_hook_ret:
v_mfma_f32_16x16x32_bf16 v[172:175], v[76:79], v[68:71], v[172:175]
s_add_u32 s65, s65, 40960
s_cmp_eq_u32 s65, 122880
v_mfma_f32_16x16x32_bf16 v[164:167], v[76:79], v[64:67], v[164:167]
s_cselect_b32 s65, 0, s65
s_add_u32 s64, s64, 1
v_mfma_f32_16x16x32_bf16 v[156:159], v[76:79], v[60:63], v[156:159]
v_add_u32 v14, s65, v10
v_add_u32 v15, s65, v11
v_mfma_f32_16x16x32_bf16 v[160:163], v[80:83], v[60:63], v[160:163]
v_add_u32 v16, s65, v12
v_add_u32 v17, s65, v13
v_mfma_f32_16x16x32_bf16 v[168:171], v[80:83], v[64:67], v[168:171]
s_cmp_eq_u32 s64, 16
s_cbranch_scc1 c1_last
v_mfma_f32_16x16x32_bf16 v[176:179], v[80:83], v[68:71], v[176:179]
s_waitcnt lgkmcnt(0)
v_mfma_f32_16x16x32_bf16 v[184:187], v[80:83], v[72:75], v[184:187]
s_barrier
v_mfma_f32_16x16x32_bf16 v[212:215], v[124:127], v[112:115], v[212:215]
ds_read_b128 v[60:63], v14 offset:0
v_mfma_f32_16x16x32_bf16 v[204:207], v[124:127], v[108:111], v[204:207]
ds_read_b128 v[64:67], v14 offset:2048
v_mfma_f32_16x16x32_bf16 v[196:199], v[124:127], v[104:107], v[196:199]
ds_read_b128 v[68:71], v14 offset:4096
v_mfma_f32_16x16x32_bf16 v[188:191], v[124:127], v[100:103], v[188:191]
ds_read_b128 v[72:75], v14 offset:6144
v_mfma_f32_16x16x32_bf16 v[192:195], v[128:131], v[100:103], v[192:195]
ds_read_b64_tr_b16 v[84:85], v16 offset:8192
v_mfma_f32_16x16x32_bf16 v[200:203], v[128:131], v[104:107], v[200:203]
ds_read_b64_tr_b16 v[86:87], v16 offset:8704
v_mfma_f32_16x16x32_bf16 v[208:211], v[128:131], v[108:111], v[208:211]
ds_read_b64_tr_b16 v[88:89], v17 offset:8192
v_mfma_f32_16x16x32_bf16 v[216:219], v[128:131], v[112:115], v[216:219]
ds_read_b64_tr_b16 v[90:91], v17 offset:8704
v_mfma_f32_16x16x32_bf16 v[244:247], v[112:115], v[132:135], v[244:247]
ds_read_b64_tr_b16 v[92:93], v16 offset:16384
v_mfma_f32_16x16x32_bf16 v[236:239], v[108:111], v[132:135], v[236:239]
ds_read_b64_tr_b16 v[94:95], v16 offset:16896
v_mfma_f32_16x16x32_bf16 v[228:231], v[104:107], v[132:135], v[228:231]
ds_read_b64_tr_b16 v[96:97], v17 offset:16384
v_mfma_f32_16x16x32_bf16 v[220:223], v[100:103], v[132:135], v[220:223]
ds_read_b64_tr_b16 v[98:99], v17 offset:16896
v_mfma_f32_16x16x32_bf16 v[224:227], v[100:103], v[136:139], v[224:227]
ds_read_b64_tr_b16 v[76:77], v16 offset:0
v_mfma_f32_16x16x32_bf16 v[232:235], v[104:107], v[136:139], v[232:235]
ds_read_b64_tr_b16 v[78:79], v16 offset:512
v_mfma_f32_16x16x32_bf16 v[240:243], v[108:111], v[136:139], v[240:243]
ds_read_b64_tr_b16 v[80:81], v17 offset:0
v_mfma_f32_16x16x32_bf16 v[248:251], v[112:115], v[136:139], v[248:251]
ds_read_b64_tr_b16 v[82:83], v17 offset:512
v_mfma_f32_16x16x32_bf16 v[180:183], v[116:119], v[112:115], v[180:183]
v_mfma_f32_16x16x32_bf16 v[172:175], v[116:119], v[108:111], v[172:175]
v_mfma_f32_16x16x32_bf16 v[164:167], v[116:119], v[104:107], v[164:167]
v_mfma_f32_16x16x32_bf16 v[156:159], v[116:119], v[100:103], v[156:159]
v_mfma_f32_16x16x32_bf16 v[160:163], v[120:123], v[100:103], v[160:163]
v_mfma_f32_16x16x32_bf16 v[168:171], v[120:123], v[104:107], v[168:171]
v_mfma_f32_16x16x32_bf16 v[176:179], v[120:123], v[108:111], v[176:179]
s_waitcnt lgkmcnt(0)
v_mfma_f32_16x16x32_bf16 v[184:187], v[120:123], v[112:115], v[184:187]
s_branch c1_loop
c1_hook:
s_waitcnt lgkmcnt(0)
s_cmp_lg_u32 s64, s77
s_cbranch_scc1 else_58
s_cmp_lg_u32 s44, 0
s_cbranch_scc1 else_60
v_mfma_f32_16x16x32_bf16 v[140:143], v[48:51], v[76:79], 0
v_mfma_f32_16x16x32_bf16 v[144:147], v[48:51], v[84:87], 0
v_mfma_f32_16x16x32_bf16 v[148:151], v[48:51], v[92:95], 0
v_mfma_f32_16x16x32_bf16 v[140:143], v[48:51], v[116:119], v[140:143]
v_mfma_f32_16x16x32_bf16 v[144:147], v[48:51], v[124:127], v[144:147]
v_mfma_f32_16x16x32_bf16 v[148:151], v[48:51], v[132:135], v[148:151]
s_branch fi_61
else_60:
v_mfma_f32_16x16x32_bf16 v[140:143], v[48:51], v[80:83], 0
v_mfma_f32_16x16x32_bf16 v[144:147], v[48:51], v[88:91], 0
v_mfma_f32_16x16x32_bf16 v[148:151], v[48:51], v[96:99], 0
v_mfma_f32_16x16x32_bf16 v[140:143], v[48:51], v[120:123], v[140:143]
v_mfma_f32_16x16x32_bf16 v[144:147], v[48:51], v[128:131], v[144:147]
v_mfma_f32_16x16x32_bf16 v[148:151], v[48:51], v[136:139], v[148:151]
fi_61:
s_lshl_b32 s50, s42, 2
s_add_u32 s50, s50, s40
s_lshl_b32 s50, s50, 4
s_add_u32 s50, s50, s41
s_lshl_b32 s50, s50, 8
s_add_u32 s50, s50, 17301504
v_cmp_eq_u32 vcc, 0, v3
v_cmp_eq_u32 s[48:49], 1, v3
s_nop 1
v_cndmask_b32 v4, v148, v144, s[48:49]
v_cndmask_b32 v4, v4, v140, vcc
buffer_store_dword v4, v1, s[32:35], s50 offen sc1
else_58:
s_cmp_lg_u32 s64, 3
s_cbranch_scc1 else_62
s_waitcnt vmcnt(0)
s_lshl_b32 s52, s42, 2
s_add_u32 s52, s52, s40
s_lshl_b32 s52, s52, 7
s_add_u32 s52, s52, 17588224
s_lshl_b32 s62, s41, 2
v_mov_b32 v4, s62
v_mov_b32 v5, 1
s_mov_b64 exec, 1
buffer_store_dword v5, v4, s[32:35], s52 offen sc1
s_mov_b64 exec, -1
else_62:
s_branch c1_hook_ret
c1_last:
v_mfma_f32_16x16x32_bf16 v[176:179], v[80:83], v[68:71], v[176:179]
s_waitcnt lgkmcnt(0)
v_mfma_f32_16x16x32_bf16 v[184:187], v[80:83], v[72:75], v[184:187]
s_barrier
v_mfma_f32_16x16x32_bf16 v[212:215], v[124:127], v[112:115], v[212:215]
ds_read_b128 v[140:143], v7 offset:0
v_mfma_f32_16x16x32_bf16 v[204:207], v[124:127], v[108:111], v[204:207]
ds_read_b128 v[144:147], v7 offset:64
v_mfma_f32_16x16x32_bf16 v[196:199], v[124:127], v[104:107], v[196:199]
ds_read_b128 v[148:151], v7 offset:256
v_mfma_f32_16x16x32_bf16 v[188:191], v[124:127], v[100:103], v[188:191]
ds_read_b128 v[152:155], v7 offset:320
v_mfma_f32_16x16x32_bf16 v[192:195], v[128:131], v[100:103], v[192:195]
ds_read_b64 v[92:93], v8 offset:0
v_mfma_f32_16x16x32_bf16 v[200:203], v[128:131], v[104:107], v[200:203]
ds_read_b64 v[94:95], v8 offset:128
v_mfma_f32_16x16x32_bf16 v[208:211], v[128:131], v[108:111], v[208:211]
ds_read_b64 v[96:97], v8 offset:256
v_mfma_f32_16x16x32_bf16 v[216:219], v[128:131], v[112:115], v[216:219]
ds_read_b64 v[98:99], v8 offset:384
v_mfma_f32_16x16x32_bf16 v[244:247], v[112:115], v[132:135], v[244:247]
ds_read2_b32 v[56:57], v54 offset0:128 offset1:144
v_mfma_f32_16x16x32_bf16 v[236:239], v[108:111], v[132:135], v[236:239]
ds_read_b128 v[60:63], v9 offset:0
v_mfma_f32_16x16x32_bf16 v[228:231], v[104:107], v[132:135], v[228:231]
ds_read_b128 v[64:67], v9 offset:64
v_mfma_f32_16x16x32_bf16 v[220:223], v[100:103], v[132:135], v[220:223]
ds_read_b128 v[68:71], v9 offset:128
v_mfma_f32_16x16x32_bf16 v[224:227], v[100:103], v[136:139], v[224:227]
ds_read_b128 v[72:75], v9 offset:192
v_mfma_f32_16x16x32_bf16 v[232:235], v[104:107], v[136:139], v[232:235]
ds_read_b128 v[76:79], v9 offset:512
v_mfma_f32_16x16x32_bf16 v[240:243], v[108:111], v[136:139], v[240:243]
ds_read_b128 v[80:83], v9 offset:576
v_mfma_f32_16x16x32_bf16 v[248:251], v[112:115], v[136:139], v[248:251]
ds_read_b128 v[84:87], v9 offset:640
v_mfma_f32_16x16x32_bf16 v[180:183], v[116:119], v[112:115], v[180:183]
ds_read_b128 v[88:91], v9 offset:704
v_mfma_f32_16x16x32_bf16 v[172:175], v[116:119], v[108:111], v[172:175]
ds_read_b64_tr_b16 v[10:11], v53 offset:0
v_mfma_f32_16x16x32_bf16 v[164:167], v[116:119], v[104:107], v[164:167]
ds_read_b64_tr_b16 v[12:13], v53 offset:1024
v_mfma_f32_16x16x32_bf16 v[156:159], v[116:119], v[100:103], v[156:159]
ds_read_b64_tr_b16 v[14:15], v53 offset:32
v_mfma_f32_16x16x32_bf16 v[160:163], v[120:123], v[100:103], v[160:163]
ds_read_b64_tr_b16 v[16:17], v53 offset:1056
v_mfma_f32_16x16x32_bf16 v[168:171], v[120:123], v[104:107], v[168:171]
v_mfma_f32_16x16x32_bf16 v[176:179], v[120:123], v[108:111], v[176:179]
v_mfma_f32_16x16x32_bf16 v[184:187], v[120:123], v[112:115], v[184:187]
c1_epi:
s_waitcnt lgkmcnt(0)
s_mul_i32 s48, s44, 0x80008000
v_xor_b32 v10, s48, v10
v_xor_b32 v11, s48, v11
v_xor_b32 v12, s48, v12
v_xor_b32 v13, s48, v13
v_xor_b32 v14, s48, v14
v_xor_b32 v15, s48, v15
v_xor_b32 v16, s48, v16
v_xor_b32 v17, s48, v17
v_mul_f32 v128, s66, v92
v_mul_f32 v129, s66, v94
v_mul_f32 v130, s66, v96
v_mul_f32 v131, s66, v98
.p2align 3
v_pk_fma_f32 v[220:221], v[76:77], v[56:57], v[220:221] op_sel:[0,0,0] op_sel_hi:[1,0,1]
v_pk_fma_f32 v[222:223], v[78:79], v[56:57], v[222:223] op_sel:[0,0,0] op_sel_hi:[1,0,1]
v_pk_mul_f32 v[220:221], v[220:221], v[60:61]
v_pk_mul_f32 v[222:223], v[222:223], v[62:63]
v_cvt_pk_bf16_f32 v112, v220, v221
v_cvt_pk_bf16_f32 v113, v222, v223
v_pk_fma_f32 v[228:229], v[80:81], v[56:57], v[228:229] op_sel:[0,0,0] op_sel_hi:[1,0,1]
v_pk_fma_f32 v[230:231], v[82:83], v[56:57], v[230:231] op_sel:[0,0,0] op_sel_hi:[1,0,1]
v_pk_mul_f32 v[228:229], v[228:229], v[64:65]
v_pk_mul_f32 v[230:231], v[230:231], v[66:67]
v_cvt_pk_bf16_f32 v114, v228, v229
v_cvt_pk_bf16_f32 v115, v230, v231
v_pk_fma_f32 v[236:237], v[84:85], v[56:57], v[236:237] op_sel:[0,0,0] op_sel_hi:[1,0,1]
v_pk_fma_f32 v[238:239], v[86:87], v[56:57], v[238:239] op_sel:[0,0,0] op_sel_hi:[1,0,1]
v_pk_mul_f32 v[236:237], v[236:237], v[68:69]
v_pk_mul_f32 v[238:239], v[238:239], v[70:71]
v_cvt_pk_bf16_f32 v116, v236, v237
v_cvt_pk_bf16_f32 v117, v238, v239
v_pk_fma_f32 v[244:245], v[88:89], v[56:57], v[244:245] op_sel:[0,0,0] op_sel_hi:[1,0,1]
v_pk_fma_f32 v[246:247], v[90:91], v[56:57], v[246:247] op_sel:[0,0,0] op_sel_hi:[1,0,1]
v_pk_mul_f32 v[244:245], v[244:245], v[72:73]
v_pk_mul_f32 v[246:247], v[246:247], v[74:75]
v_cvt_pk_bf16_f32 v118, v244, v245
v_cvt_pk_bf16_f32 v119, v246, v247
v_pk_fma_f32 v[224:225], v[76:77], v[56:57], v[224:225] op_sel:[0,1,0] op_sel_hi:[1,1,1]
v_pk_fma_f32 v[226:227], v[78:79], v[56:57], v[226:227] op_sel:[0,1,0] op_sel_hi:[1,1,1]
v_pk_mul_f32 v[224:225], v[224:225], v[60:61]
v_pk_mul_f32 v[226:227], v[226:227], v[62:63]
v_cvt_pk_bf16_f32 v120, v224, v225
v_cvt_pk_bf16_f32 v121, v226, v227
v_pk_fma_f32 v[232:233], v[80:81], v[56:57], v[232:233] op_sel:[0,1,0] op_sel_hi:[1,1,1]
v_pk_fma_f32 v[234:235], v[82:83], v[56:57], v[234:235] op_sel:[0,1,0] op_sel_hi:[1,1,1]
v_pk_mul_f32 v[232:233], v[232:233], v[64:65]
v_pk_mul_f32 v[234:235], v[234:235], v[66:67]
v_cvt_pk_bf16_f32 v122, v232, v233
v_cvt_pk_bf16_f32 v123, v234, v235
v_pk_fma_f32 v[240:241], v[84:85], v[56:57], v[240:241] op_sel:[0,1,0] op_sel_hi:[1,1,1]
v_pk_fma_f32 v[242:243], v[86:87], v[56:57], v[242:243] op_sel:[0,1,0] op_sel_hi:[1,1,1]
v_pk_mul_f32 v[240:241], v[240:241], v[68:69]
v_pk_mul_f32 v[242:243], v[242:243], v[70:71]
v_cvt_pk_bf16_f32 v124, v240, v241
v_cvt_pk_bf16_f32 v125, v242, v243
v_pk_fma_f32 v[248:249], v[88:89], v[56:57], v[248:249] op_sel:[0,1,0] op_sel_hi:[1,1,1]
v_pk_fma_f32 v[250:251], v[90:91], v[56:57], v[250:251] op_sel:[0,1,0] op_sel_hi:[1,1,1]
v_pk_mul_f32 v[248:249], v[248:249], v[72:73]
v_pk_mul_f32 v[250:251], v[250:251], v[74:75]
v_cvt_pk_bf16_f32 v126, v248, v249
v_cvt_pk_bf16_f32 v127, v250, v251
v_pk_fma_f32 v[188:189], v[148:149], v[92:93], v[188:189] op_sel:[0,1,0] op_sel_hi:[1,1,1]
v_pk_fma_f32 v[190:191], v[150:151], v[92:93], v[190:191] op_sel:[0,1,0] op_sel_hi:[1,1,1]
v_pk_fma_f32 v[192:193], v[152:153], v[92:93], v[192:193] op_sel:[0,1,0] op_sel_hi:[1,1,1]
v_pk_fma_f32 v[194:195], v[154:155], v[92:93], v[194:195] op_sel:[0,1,0] op_sel_hi:[1,1,1]
v_cvt_pk_bf16_f32 v188, v188, v189
v_cvt_pk_bf16_f32 v189, v190, v191
v_cvt_pk_bf16_f32 v190, v192, v193
v_cvt_pk_bf16_f32 v191, v194, v195
v_pk_fma_f32 v[196:197], v[148:149], v[94:95], v[196:197] op_sel:[0,1,0] op_sel_hi:[1,1,1]
v_pk_fma_f32 v[198:199], v[150:151], v[94:95], v[198:199] op_sel:[0,1,0] op_sel_hi:[1,1,1]
v_pk_fma_f32 v[200:201], v[152:153], v[94:95], v[200:201] op_sel:[0,1,0] op_sel_hi:[1,1,1]
v_pk_fma_f32 v[202:203], v[154:155], v[94:95], v[202:203] op_sel:[0,1,0] op_sel_hi:[1,1,1]
v_cvt_pk_bf16_f32 v196, v196, v197
v_mfma_f32_16x16x32_bf16 v[60:63], v[10:13], v[188:191], 0
v_cvt_pk_bf16_f32 v197, v198, v199
v_cvt_pk_bf16_f32 v198, v200, v201
v_mfma_f32_16x16x32_bf16 v[64:67], v[14:17], v[188:191], 0
v_cvt_pk_bf16_f32 v199, v202, v203
v_pk_fma_f32 v[204:205], v[148:149], v[96:97], v[204:205] op_sel:[0,1,0] op_sel_hi:[1,1,1]
v_pk_fma_f32 v[206:207], v[150:151], v[96:97], v[206:207] op_sel:[0,1,0] op_sel_hi:[1,1,1]
v_pk_fma_f32 v[208:209], v[152:153], v[96:97], v[208:209] op_sel:[0,1,0] op_sel_hi:[1,1,1]
v_pk_fma_f32 v[210:211], v[154:155], v[96:97], v[210:211] op_sel:[0,1,0] op_sel_hi:[1,1,1]
v_cvt_pk_bf16_f32 v204, v204, v205
v_mfma_f32_16x16x32_bf16 v[68:71], v[10:13], v[196:199], 0
v_cvt_pk_bf16_f32 v205, v206, v207
v_cvt_pk_bf16_f32 v206, v208, v209
v_mfma_f32_16x16x32_bf16 v[72:75], v[14:17], v[196:199], 0
v_cvt_pk_bf16_f32 v207, v210, v211
v_pk_fma_f32 v[212:213], v[148:149], v[98:99], v[212:213] op_sel:[0,1,0] op_sel_hi:[1,1,1]
v_pk_fma_f32 v[214:215], v[150:151], v[98:99], v[214:215] op_sel:[0,1,0] op_sel_hi:[1,1,1]
v_pk_fma_f32 v[216:217], v[152:153], v[98:99], v[216:217] op_sel:[0,1,0] op_sel_hi:[1,1,1]
v_pk_fma_f32 v[218:219], v[154:155], v[98:99], v[218:219] op_sel:[0,1,0] op_sel_hi:[1,1,1]
v_cvt_pk_bf16_f32 v212, v212, v213
v_mfma_f32_16x16x32_bf16 v[76:79], v[10:13], v[204:207], 0
v_cvt_pk_bf16_f32 v213, v214, v215
v_cvt_pk_bf16_f32 v214, v216, v217
v_mfma_f32_16x16x32_bf16 v[80:83], v[14:17], v[204:207], 0
v_cvt_pk_bf16_f32 v215, v218, v219
s_nop 1
v_mfma_f32_16x16x32_bf16 v[84:87], v[10:13], v[212:215], 0
v_mfma_f32_16x16x32_bf16 v[88:91], v[14:17], v[212:215], 0
v_max3_f32 v100, v60, v61, v62
v_min3_f32 v104, v60, v61, v62
v_max3_f32 v100, v100, v63, v64
v_min3_f32 v104, v104, v63, v64
v_max3_f32 v100, v100, v65, v66
v_min3_f32 v104, v104, v65, v66
v_max_f32 v100, v100, v67
v_min_f32 v104, v104, v67
v_max3_f32 v101, v68, v69, v70
v_min3_f32 v105, v68, v69, v70
v_max3_f32 v101, v101, v71, v72
v_min3_f32 v105, v105, v71, v72
v_max3_f32 v101, v101, v73, v74
v_min3_f32 v105, v105, v73, v74
v_max_f32 v101, v101, v75
v_min_f32 v105, v105, v75
v_max3_f32 v102, v76, v77, v78
v_min3_f32 v106, v76, v77, v78
v_max3_f32 v102, v102, v79, v80
v_min3_f32 v106, v106, v79, v80
v_max3_f32 v102, v102, v81, v82
v_min3_f32 v106, v106, v81, v82
v_max_f32 v102, v102, v83
v_min_f32 v106, v106, v83
v_max3_f32 v103, v84, v85, v86
v_min3_f32 v107, v84, v85, v86
v_max3_f32 v103, v103, v87, v88
v_min3_f32 v107, v107, v87, v88
v_max3_f32 v103, v103, v89, v90
v_min3_f32 v107, v107, v89, v90
v_max_f32 v103, v103, v91
v_min_f32 v107, v107, v91
s_nop 1
v_permlane32_swap_b32 v100, v101
v_permlane32_swap_b32 v102, v103
v_permlane32_swap_b32 v104, v105
v_permlane32_swap_b32 v106, v107
v_max_f32 v100, v100, v101
v_max_f32 v102, v102, v103
v_min_f32 v104, v104, v105
v_min_f32 v106, v106, v107
v_permlane16_swap_b32 v100, v102
s_nop 0
v_permlane16_swap_b32 v104, v106
v_max_f32 v100, v100, v102
v_min_f32 v104, v104, v106
v_mov_b32 v102, v100
v_mov_b32 v106, v104
s_nop 0
v_permlane16_swap_b32 v100, v102
v_permlane16_swap_b32 v104, v106
v_mov_b32 v101, v100
v_mov_b32 v103, v102
v_mov_b32 v105, v104
v_mov_b32 v107, v106
v_permlane32_swap_b32 v100, v101
v_permlane32_swap_b32 v102, v103
v_permlane32_swap_b32 v104, v105
v_permlane32_swap_b32 v106, v107
v_pk_mul_f32 v[100:101], v[100:101], v[128:129]
v_pk_mul_f32 v[102:103], v[102:103], v[130:131]
v_pk_mul_f32 v[104:105], v[104:105], v[128:129]
v_pk_mul_f32 v[106:107], v[106:107], v[130:131]
v_pk_fma_f32 v[220:221], v[60:61], v[128:129], v[104:105] op_sel:[0,0,0] op_sel_hi:[1,0,0] neg_lo:[1,0,0] neg_hi:[1,0,0]
v_pk_fma_f32 v[60:61], v[60:61], v[128:129], v[100:101] op_sel:[0,0,0] op_sel_hi:[1,0,0] neg_lo:[0,0,1] neg_hi:[0,0,1]
v_exp_f32 v220, v220
v_exp_f32 v60, v60
v_exp_f32 v221, v221
v_exp_f32 v61, v61
v_pk_fma_f32 v[222:223], v[62:63], v[128:129], v[104:105] op_sel:[0,0,0] op_sel_hi:[1,0,0] neg_lo:[1,0,0] neg_hi:[1,0,0]
v_pk_fma_f32 v[62:63], v[62:63], v[128:129], v[100:101] op_sel:[0,0,0] op_sel_hi:[1,0,0] neg_lo:[0,0,1] neg_hi:[0,0,1]
v_exp_f32 v222, v222
v_exp_f32 v62, v62
v_exp_f32 v223, v223
v_exp_f32 v63, v63
v_pk_fma_f32 v[224:225], v[64:65], v[128:129], v[104:105] op_sel:[0,0,0] op_sel_hi:[1,0,0] neg_lo:[1,0,0] neg_hi:[1,0,0]
v_pk_fma_f32 v[64:65], v[64:65], v[128:129], v[100:101] op_sel:[0,0,0] op_sel_hi:[1,0,0] neg_lo:[0,0,1] neg_hi:[0,0,1]
v_exp_f32 v224, v224
v_exp_f32 v64, v64
v_exp_f32 v225, v225
v_exp_f32 v65, v65
v_pk_fma_f32 v[226:227], v[66:67], v[128:129], v[104:105] op_sel:[0,0,0] op_sel_hi:[1,0,0] neg_lo:[1,0,0] neg_hi:[1,0,0]
v_pk_fma_f32 v[66:67], v[66:67], v[128:129], v[100:101] op_sel:[0,0,0] op_sel_hi:[1,0,0] neg_lo:[0,0,1] neg_hi:[0,0,1]
v_exp_f32 v226, v226
v_exp_f32 v66, v66
v_exp_f32 v227, v227
v_exp_f32 v67, v67
v_pk_fma_f32 v[228:229], v[68:69], v[128:129], v[104:105] op_sel:[0,1,1] op_sel_hi:[1,1,1] neg_lo:[1,0,0] neg_hi:[1,0,0]
v_pk_fma_f32 v[68:69], v[68:69], v[128:129], v[100:101] op_sel:[0,1,1] op_sel_hi:[1,1,1] neg_lo:[0,0,1] neg_hi:[0,0,1]
v_exp_f32 v228, v228
v_exp_f32 v68, v68
v_exp_f32 v229, v229
v_exp_f32 v69, v69
v_pk_fma_f32 v[230:231], v[70:71], v[128:129], v[104:105] op_sel:[0,1,1] op_sel_hi:[1,1,1] neg_lo:[1,0,0] neg_hi:[1,0,0]
v_pk_fma_f32 v[70:71], v[70:71], v[128:129], v[100:101] op_sel:[0,1,1] op_sel_hi:[1,1,1] neg_lo:[0,0,1] neg_hi:[0,0,1]
v_exp_f32 v230, v230
v_exp_f32 v70, v70
v_exp_f32 v231, v231
v_exp_f32 v71, v71
v_pk_fma_f32 v[232:233], v[72:73], v[128:129], v[104:105] op_sel:[0,1,1] op_sel_hi:[1,1,1] neg_lo:[1,0,0] neg_hi:[1,0,0]
v_pk_fma_f32 v[72:73], v[72:73], v[128:129], v[100:101] op_sel:[0,1,1] op_sel_hi:[1,1,1] neg_lo:[0,0,1] neg_hi:[0,0,1]
v_exp_f32 v232, v232
v_exp_f32 v72, v72
v_exp_f32 v233, v233
v_exp_f32 v73, v73
v_pk_fma_f32 v[234:235], v[74:75], v[128:129], v[104:105] op_sel:[0,1,1] op_sel_hi:[1,1,1] neg_lo:[1,0,0] neg_hi:[1,0,0]
v_pk_fma_f32 v[74:75], v[74:75], v[128:129], v[100:101] op_sel:[0,1,1] op_sel_hi:[1,1,1] neg_lo:[0,0,1] neg_hi:[0,0,1]
v_exp_f32 v234, v234
v_exp_f32 v74, v74
v_exp_f32 v235, v235
v_exp_f32 v75, v75
v_pk_fma_f32 v[236:237], v[76:77], v[130:131], v[106:107] op_sel:[0,0,0] op_sel_hi:[1,0,0] neg_lo:[1,0,0] neg_hi:[1,0,0]
v_pk_fma_f32 v[76:77], v[76:77], v[130:131], v[102:103] op_sel:[0,0,0] op_sel_hi:[1,0,0] neg_lo:[0,0,1] neg_hi:[0,0,1]
v_exp_f32 v236, v236
v_exp_f32 v76, v76
v_exp_f32 v237, v237
v_exp_f32 v77, v77
v_pk_fma_f32 v[238:239], v[78:79], v[130:131], v[106:107] op_sel:[0,0,0] op_sel_hi:[1,0,0] neg_lo:[1,0,0] neg_hi:[1,0,0]
v_pk_fma_f32 v[78:79], v[78:79], v[130:131], v[102:103] op_sel:[0,0,0] op_sel_hi:[1,0,0] neg_lo:[0,0,1] neg_hi:[0,0,1]
v_exp_f32 v238, v238
v_exp_f32 v78, v78
v_exp_f32 v239, v239
v_exp_f32 v79, v79
v_pk_fma_f32 v[240:241], v[80:81], v[130:131], v[106:107] op_sel:[0,0,0] op_sel_hi:[1,0,0] neg_lo:[1,0,0] neg_hi:[1,0,0]
v_pk_fma_f32 v[80:81], v[80:81], v[130:131], v[102:103] op_sel:[0,0,0] op_sel_hi:[1,0,0] neg_lo:[0,0,1] neg_hi:[0,0,1]
v_exp_f32 v240, v240
v_exp_f32 v80, v80
v_exp_f32 v241, v241
v_exp_f32 v81, v81
v_pk_fma_f32 v[242:243], v[82:83], v[130:131], v[106:107] op_sel:[0,0,0] op_sel_hi:[1,0,0] neg_lo:[1,0,0] neg_hi:[1,0,0]
v_pk_fma_f32 v[82:83], v[82:83], v[130:131], v[102:103] op_sel:[0,0,0] op_sel_hi:[1,0,0] neg_lo:[0,0,1] neg_hi:[0,0,1]
v_exp_f32 v242, v242
v_exp_f32 v82, v82
v_exp_f32 v243, v243
v_exp_f32 v83, v83
v_pk_fma_f32 v[244:245], v[84:85], v[130:131], v[106:107] op_sel:[0,1,1] op_sel_hi:[1,1,1] neg_lo:[1,0,0] neg_hi:[1,0,0]
v_pk_fma_f32 v[84:85], v[84:85], v[130:131], v[102:103] op_sel:[0,1,1] op_sel_hi:[1,1,1] neg_lo:[0,0,1] neg_hi:[0,0,1]
v_exp_f32 v244, v244
v_exp_f32 v84, v84
v_exp_f32 v245, v245
v_exp_f32 v85, v85
v_pk_fma_f32 v[246:247], v[86:87], v[130:131], v[106:107] op_sel:[0,1,1] op_sel_hi:[1,1,1] neg_lo:[1,0,0] neg_hi:[1,0,0]
v_pk_fma_f32 v[86:87], v[86:87], v[130:131], v[102:103] op_sel:[0,1,1] op_sel_hi:[1,1,1] neg_lo:[0,0,1] neg_hi:[0,0,1]
v_exp_f32 v246, v246
v_exp_f32 v86, v86
v_exp_f32 v247, v247
v_exp_f32 v87, v87
v_pk_fma_f32 v[248:249], v[88:89], v[130:131], v[106:107] op_sel:[0,1,1] op_sel_hi:[1,1,1] neg_lo:[1,0,0] neg_hi:[1,0,0]
v_pk_fma_f32 v[88:89], v[88:89], v[130:131], v[102:103] op_sel:[0,1,1] op_sel_hi:[1,1,1] neg_lo:[0,0,1] neg_hi:[0,0,1]
v_exp_f32 v248, v248
v_exp_f32 v88, v88
v_exp_f32 v249, v249
v_exp_f32 v89, v89
v_pk_fma_f32 v[250:251], v[90:91], v[130:131], v[106:107] op_sel:[0,1,1] op_sel_hi:[1,1,1] neg_lo:[1,0,0] neg_hi:[1,0,0]
v_pk_fma_f32 v[90:91], v[90:91], v[130:131], v[102:103] op_sel:[0,1,1] op_sel_hi:[1,1,1] neg_lo:[0,0,1] neg_hi:[0,0,1]
v_exp_f32 v250, v250
v_exp_f32 v90, v90
v_exp_f32 v251, v251
v_exp_f32 v91, v91
v_pk_add_f32 v[108:109], v[60:61], v[62:63]
v_pk_add_f32 v[110:111], v[220:221], v[222:223]
v_pk_add_f32 v[108:109], v[108:109], v[64:65]
v_pk_add_f32 v[110:111], v[110:111], v[224:225]
v_pk_add_f32 v[108:109], v[108:109], v[66:67]
v_pk_add_f32 v[110:111], v[110:111], v[226:227]
v_add_f32 v100, v108, v109
v_add_f32 v104, v110, v111
v_pk_add_f32 v[108:109], v[68:69], v[70:71]
v_pk_add_f32 v[110:111], v[228:229], v[230:231]
v_pk_add_f32 v[108:109], v[108:109], v[72:73]
v_pk_add_f32 v[110:111], v[110:111], v[232:233]
v_pk_add_f32 v[108:109], v[108:109], v[74:75]
v_pk_add_f32 v[110:111], v[110:111], v[234:235]
v_add_f32 v101, v108, v109
v_add_f32 v105, v110, v111
v_pk_add_f32 v[108:109], v[76:77], v[78:79]
v_pk_add_f32 v[110:111], v[236:237], v[238:239]
v_pk_add_f32 v[108:109], v[108:109], v[80:81]
v_pk_add_f32 v[110:111], v[110:111], v[240:241]
v_pk_add_f32 v[108:109], v[108:109], v[82:83]
v_pk_add_f32 v[110:111], v[110:111], v[242:243]
v_add_f32 v102, v108, v109
v_add_f32 v106, v110, v111
v_pk_add_f32 v[108:109], v[84:85], v[86:87]
v_pk_add_f32 v[110:111], v[244:245], v[246:247]
v_pk_add_f32 v[108:109], v[108:109], v[88:89]
v_pk_add_f32 v[110:111], v[110:111], v[248:249]
v_pk_add_f32 v[108:109], v[108:109], v[90:91]
v_pk_add_f32 v[110:111], v[110:111], v[250:251]
v_add_f32 v103, v108, v109
v_add_f32 v107, v110, v111
s_nop 1
v_permlane32_swap_b32 v100, v101
v_permlane32_swap_b32 v102, v103
v_permlane32_swap_b32 v104, v105
v_permlane32_swap_b32 v106, v107
v_add_f32 v100, v100, v101
v_add_f32 v102, v102, v103
v_add_f32 v104, v104, v105
v_add_f32 v106, v106, v107
v_permlane16_swap_b32 v100, v102
s_nop 0
v_permlane16_swap_b32 v104, v106
v_add_f32 v100, v100, v102
v_add_f32 v104, v104, v106
v_rcp_f32 v100, v100
v_rcp_f32 v104, v104
s_nop 0
v_mov_b32 v102, v100
v_mov_b32 v106, v104
s_nop 0
v_permlane16_swap_b32 v100, v102
v_permlane16_swap_b32 v104, v106
v_mov_b32 v101, v100
v_mov_b32 v103, v102
v_mov_b32 v105, v104
v_mov_b32 v107, v106
v_permlane32_swap_b32 v100, v101
v_permlane32_swap_b32 v102, v103
v_permlane32_swap_b32 v104, v105
v_permlane32_swap_b32 v106, v107
.p2align 3
v_pk_mul_f32 v[60:61], v[60:61], v[100:101] op_sel:[0,0] op_sel_hi:[1,0]
v_pk_mul_f32 v[62:63], v[62:63], v[100:101] op_sel:[0,0] op_sel_hi:[1,0]
v_pk_mul_f32 v[64:65], v[64:65], v[100:101] op_sel:[0,0] op_sel_hi:[1,0]
v_pk_mul_f32 v[66:67], v[66:67], v[100:101] op_sel:[0,0] op_sel_hi:[1,0]
v_pk_mul_f32 v[220:221], v[220:221], v[104:105] op_sel:[0,0] op_sel_hi:[1,0]
v_pk_mul_f32 v[222:223], v[222:223], v[104:105] op_sel:[0,0] op_sel_hi:[1,0]
v_pk_mul_f32 v[224:225], v[224:225], v[104:105] op_sel:[0,0] op_sel_hi:[1,0]
v_pk_mul_f32 v[226:227], v[226:227], v[104:105] op_sel:[0,0] op_sel_hi:[1,0]
v_cvt_pk_bf16_f32 v60, v60, v61
v_cvt_pk_bf16_f32 v61, v62, v63
v_cvt_pk_bf16_f32 v62, v64, v65
v_cvt_pk_bf16_f32 v63, v66, v67
v_cvt_pk_bf16_f32 v220, v220, v221
v_cvt_pk_bf16_f32 v221, v222, v223
v_cvt_pk_bf16_f32 v222, v224, v225
v_cvt_pk_bf16_f32 v223, v226, v227
v_pk_mul_f32 v[68:69], v[68:69], v[100:101] op_sel:[0,1] op_sel_hi:[1,1]
v_pk_mul_f32 v[70:71], v[70:71], v[100:101] op_sel:[0,1] op_sel_hi:[1,1]
v_pk_mul_f32 v[72:73], v[72:73], v[100:101] op_sel:[0,1] op_sel_hi:[1,1]
v_pk_mul_f32 v[74:75], v[74:75], v[100:101] op_sel:[0,1] op_sel_hi:[1,1]
v_pk_mul_f32 v[228:229], v[228:229], v[104:105] op_sel:[0,1] op_sel_hi:[1,1]
v_pk_mul_f32 v[230:231], v[230:231], v[104:105] op_sel:[0,1] op_sel_hi:[1,1]
v_pk_mul_f32 v[232:233], v[232:233], v[104:105] op_sel:[0,1] op_sel_hi:[1,1]
v_pk_mul_f32 v[234:235], v[234:235], v[104:105] op_sel:[0,1] op_sel_hi:[1,1]
v_cvt_pk_bf16_f32 v68, v68, v69
v_mfma_f32_16x16x32_bf16 v[204:207], v[60:63], v[38:41], 0
v_cvt_pk_bf16_f32 v69, v70, v71
v_cvt_pk_bf16_f32 v70, v72, v73
v_mfma_f32_16x16x32_bf16 v[208:211], v[60:63], v[36:39], 0
v_cvt_pk_bf16_f32 v71, v74, v75
v_cvt_pk_bf16_f32 v228, v228, v229
v_mfma_f32_16x16x32_bf16 v[212:215], v[220:223], v[38:41], 0
v_cvt_pk_bf16_f32 v229, v230, v231
v_cvt_pk_bf16_f32 v230, v232, v233
v_mfma_f32_16x16x32_bf16 v[216:219], v[220:223], v[36:39], 0
v_cvt_pk_bf16_f32 v231, v234, v235
v_pk_mul_f32 v[76:77], v[76:77], v[102:103] op_sel:[0,0] op_sel_hi:[1,0]
v_pk_mul_f32 v[78:79], v[78:79], v[102:103] op_sel:[0,0] op_sel_hi:[1,0]
v_pk_mul_f32 v[80:81], v[80:81], v[102:103] op_sel:[0,0] op_sel_hi:[1,0]
v_pk_mul_f32 v[82:83], v[82:83], v[102:103] op_sel:[0,0] op_sel_hi:[1,0]
v_pk_mul_f32 v[236:237], v[236:237], v[106:107] op_sel:[0,0] op_sel_hi:[1,0]
v_pk_mul_f32 v[238:239], v[238:239], v[106:107] op_sel:[0,0] op_sel_hi:[1,0]
v_pk_mul_f32 v[240:241], v[240:241], v[106:107] op_sel:[0,0] op_sel_hi:[1,0]
v_pk_mul_f32 v[242:243], v[242:243], v[106:107] op_sel:[0,0] op_sel_hi:[1,0]
v_cvt_pk_bf16_f32 v76, v76, v77
v_mfma_f32_16x16x32_bf16 v[188:191], v[68:71], v[38:41], 0
v_mfma_f32_16x16x32_bf16 v[192:195], v[68:71], v[36:39], 0
v_cvt_pk_bf16_f32 v77, v78, v79
v_mfma_f32_16x16x32_bf16 v[196:199], v[228:231], v[38:41], 0
v_cvt_pk_bf16_f32 v78, v80, v81
v_mfma_f32_16x16x32_bf16 v[200:203], v[228:231], v[36:39], 0
v_cvt_pk_bf16_f32 v64, v204, v205
v_cvt_pk_bf16_f32 v79, v82, v83
v_cvt_pk_bf16_f32 v65, v206, v207
v_cvt_pk_bf16_f32 v236, v236, v237
v_cvt_pk_bf16_f32 v72, v208, v209
v_cvt_pk_bf16_f32 v73, v210, v211
v_cvt_pk_bf16_f32 v237, v238, v239
v_cvt_pk_bf16_f32 v224, v212, v213
v_cvt_pk_bf16_f32 v238, v240, v241
v_cvt_pk_bf16_f32 v225, v214, v215
v_cvt_pk_bf16_f32 v232, v216, v217
v_cvt_pk_bf16_f32 v239, v242, v243
v_cvt_pk_bf16_f32 v233, v218, v219
v_pk_mul_f32 v[84:85], v[84:85], v[102:103] op_sel:[0,1] op_sel_hi:[1,1]
v_pk_mul_f32 v[86:87], v[86:87], v[102:103] op_sel:[0,1] op_sel_hi:[1,1]
v_pk_mul_f32 v[88:89], v[88:89], v[102:103] op_sel:[0,1] op_sel_hi:[1,1]
v_pk_mul_f32 v[90:91], v[90:91], v[102:103] op_sel:[0,1] op_sel_hi:[1,1]
v_pk_mul_f32 v[244:245], v[244:245], v[106:107] op_sel:[0,1] op_sel_hi:[1,1]
v_pk_mul_f32 v[246:247], v[246:247], v[106:107] op_sel:[0,1] op_sel_hi:[1,1]
v_pk_mul_f32 v[248:249], v[248:249], v[106:107] op_sel:[0,1] op_sel_hi:[1,1]
v_pk_mul_f32 v[250:251], v[250:251], v[106:107] op_sel:[0,1] op_sel_hi:[1,1]
v_cvt_pk_bf16_f32 v84, v84, v85
v_mfma_f32_16x16x32_bf16 v[204:207], v[76:79], v[38:41], 0
v_mfma_f32_16x16x32_bf16 v[208:211], v[76:79], v[36:39], 0
v_cvt_pk_bf16_f32 v85, v86, v87
v_mfma_f32_16x16x32_bf16 v[212:215], v[236:239], v[38:41], 0
v_cvt_pk_bf16_f32 v86, v88, v89
v_mfma_f32_16x16x32_bf16 v[216:219], v[236:239], v[36:39], 0
v_cvt_pk_bf16_f32 v66, v188, v189
v_cvt_pk_bf16_f32 v87, v90, v91
v_cvt_pk_bf16_f32 v67, v190, v191
v_cvt_pk_bf16_f32 v244, v244, v245
v_cvt_pk_bf16_f32 v74, v192, v193
v_cvt_pk_bf16_f32 v75, v194, v195
v_cvt_pk_bf16_f32 v245, v246, v247
v_cvt_pk_bf16_f32 v226, v196, v197
v_cvt_pk_bf16_f32 v246, v248, v249
v_cvt_pk_bf16_f32 v227, v198, v199
v_cvt_pk_bf16_f32 v234, v200, v201
v_cvt_pk_bf16_f32 v247, v250, v251
v_cvt_pk_bf16_f32 v235, v202, v203
v_mov_b32 v5, 2
v_cmp_eq_u32 s[50:51], s41, v2
v_mfma_f32_16x16x32_bf16 v[188:191], v[84:87], v[38:41], 0
v_mfma_f32_16x16x32_bf16 v[192:195], v[84:87], v[36:39], 0
v_mfma_f32_16x16x32_bf16 v[196:199], v[244:247], v[38:41], 0
v_mfma_f32_16x16x32_bf16 v[200:203], v[244:247], v[36:39], 0
v_mfma_f32_16x16x32_bf16 v[152:155], v[224:227], v[112:115], 0
v_cvt_pk_bf16_f32 v80, v204, v205
v_cvt_pk_bf16_f32 v81, v206, v207
v_mfma_f32_16x16x32_bf16 v[60:63], v[232:235], v[112:115], 0
v_cvt_pk_bf16_f32 v88, v208, v209
v_mfma_f32_16x16x32_bf16 v[68:71], v[224:227], v[120:123], 0
v_cvt_pk_bf16_f32 v89, v210, v211
v_mfma_f32_16x16x32_bf16 v[220:223], v[232:235], v[120:123], 0
v_cvt_pk_bf16_f32 v240, v212, v213
v_cvt_pk_bf16_f32 v241, v214, v215
v_mfma_f32_16x16x32_bf16 v[228:231], v[224:227], v[48:51], 0
v_cvt_pk_bf16_f32 v248, v216, v217
v_mfma_f32_16x16x32_bf16 v[76:79], v[232:235], v[48:51], 0
v_cvt_pk_bf16_f32 v249, v218, v219
v_mfma_f32_16x16x32_bf16 v[100:103], v[64:67], v[112:115], 0
v_cvt_pk_bf16_f32 v82, v188, v189
v_cvt_pk_bf16_f32 v83, v190, v191
v_mfma_f32_16x16x32_bf16 v[104:107], v[72:75], v[112:115], 0
v_cvt_pk_bf16_f32 v90, v192, v193
v_mfma_f32_16x16x32_bf16 v[108:111], v[64:67], v[120:123], 0
v_cvt_pk_bf16_f32 v91, v194, v195
v_mfma_f32_16x16x32_bf16 v[132:135], v[72:75], v[120:123], 0
v_cvt_pk_bf16_f32 v242, v196, v197
v_cvt_pk_bf16_f32 v243, v198, v199
v_mfma_f32_16x16x32_bf16 v[136:139], v[64:67], v[48:51], 0
v_cvt_pk_bf16_f32 v250, v200, v201
v_mfma_f32_16x16x32_bf16 v[148:151], v[72:75], v[48:51], 0
v_cvt_pk_bf16_f32 v251, v202, v203
s_nop 1
v_mfma_f32_16x16x32_bf16 v[152:155], v[240:243], v[116:119], v[152:155]
v_mfma_f32_16x16x32_bf16 v[60:63], v[248:251], v[116:119], v[60:63]
v_mfma_f32_16x16x32_bf16 v[68:71], v[240:243], v[124:127], v[68:71]
v_mfma_f32_16x16x32_bf16 v[220:223], v[248:251], v[124:127], v[220:223]
v_mfma_f32_16x16x32_bf16 v[228:231], v[240:243], v[48:51], v[228:231]
v_mfma_f32_16x16x32_bf16 v[76:79], v[248:251], v[48:51], v[76:79]
v_mfma_f32_16x16x32_bf16 v[100:103], v[80:83], v[116:119], v[100:103]
v_mfma_f32_16x16x32_bf16 v[104:107], v[88:91], v[116:119], v[104:107]
v_mfma_f32_16x16x32_bf16 v[108:111], v[80:83], v[124:127], v[108:111]
v_mfma_f32_16x16x32_bf16 v[132:135], v[88:91], v[124:127], v[132:135]
v_cvt_pk_bf16_f32 v152, v152, v153
v_cvt_pk_bf16_f32 v153, v154, v155
v_mfma_f32_16x16x32_bf16 v[136:139], v[80:83], v[48:51], v[136:139]
v_cvt_pk_bf16_f32 v154, v60, v61
v_cvt_pk_bf16_f32 v155, v62, v63
v_mfma_f32_16x16x32_bf16 v[148:151], v[88:91], v[48:51], v[148:151]
ds_write_b128 v42, v[152:155] offset:0
v_cvt_pk_bf16_f32 v68, v68, v69
v_cvt_pk_bf16_f32 v69, v70, v71
v_cvt_pk_bf16_f32 v70, v220, v221
v_cvt_pk_bf16_f32 v71, v222, v223
ds_write_b128 v42, v[68:71] offset:1024
v_cvt_pk_bf16_f32 v228, v228, v229
v_cvt_pk_bf16_f32 v229, v230, v231
v_cvt_pk_bf16_f32 v230, v76, v77
v_cvt_pk_bf16_f32 v231, v78, v79
ds_write_b128 v42, v[228:231] offset:2048
ds_write_b32 v52, v5
s_mov_b32 s63, 0
px_64:
ds_read_b32 v4, v19
ds_read_b128 v[188:191], v43 offset:0
ds_read_b128 v[192:195], v43 offset:1024
ds_read_b128 v[196:199], v43 offset:2048
s_add_u32 s63, s63, 1
s_cmp_lt_u32 s63, 0x400000
s_waitcnt lgkmcnt(0)
v_cmp_ne_u32 vcc, 2, v4
s_cbranch_vccz pxd_65
s_cbranch_scc1 px_64
pxd_65:
v_mfma_f32_16x16x32_bf16 v[100:103], v[38:41], v[188:191], v[100:103]
v_mfma_f32_16x16x32_bf16 v[104:107], v[36:39], v[188:191], v[104:107]
v_mfma_f32_16x16x32_bf16 v[108:111], v[38:41], v[192:195], v[108:111]
v_mfma_f32_16x16x32_bf16 v[132:135], v[36:39], v[192:195], v[132:135]
v_mfma_f32_16x16x32_bf16 v[136:139], v[38:41], v[196:199], v[136:139]
v_mfma_f32_16x16x32_bf16 v[148:151], v[36:39], v[196:199], v[148:151]
s_nop 2
v_cvt_pk_bf16_f32 v100, v100, v101
v_cvt_pk_bf16_f32 v101, v102, v103
v_cvt_pk_bf16_f32 v102, v104, v105
v_cvt_pk_bf16_f32 v103, v106, v107
buffer_store_dwordx4 v[100:103], v55, s[32:35], s53 offen sc1
v_cvt_pk_bf16_f32 v108, v108, v109
v_cvt_pk_bf16_f32 v109, v110, v111
v_cvt_pk_bf16_f32 v110, v132, v133
v_cvt_pk_bf16_f32 v111, v134, v135
buffer_store_dwordx4 v[108:111], v55, s[32:35], s54 offen sc1
v_cvt_pk_bf16_f32 v136, v136, v137
v_cvt_pk_bf16_f32 v137, v138, v139
v_cvt_pk_bf16_f32 v138, v148, v149
v_cvt_pk_bf16_f32 v139, v150, v151
s_mov_b64 exec, s[50:51]
buffer_store_dwordx4 v[136:139], v58, s[32:35], s56 offen sc1
s_mov_b64 exec, -1
.p2align 3
v_pk_fma_f32 v[156:157], v[140:141], v[92:93], v[156:157] op_sel:[0,1,0] op_sel_hi:[1,1,1]
v_pk_fma_f32 v[158:159], v[142:143], v[92:93], v[158:159] op_sel:[0,1,0] op_sel_hi:[1,1,1]
v_pk_fma_f32 v[160:161], v[144:145], v[92:93], v[160:161] op_sel:[0,1,0] op_sel_hi:[1,1,1]
v_pk_fma_f32 v[162:163], v[146:147], v[92:93], v[162:163] op_sel:[0,1,0] op_sel_hi:[1,1,1]
v_cvt_pk_bf16_f32 v156, v156, v157
v_cvt_pk_bf16_f32 v157, v158, v159
v_cvt_pk_bf16_f32 v158, v160, v161
v_cvt_pk_bf16_f32 v159, v162, v163
v_pk_fma_f32 v[164:165], v[140:141], v[94:95], v[164:165] op_sel:[0,1,0] op_sel_hi:[1,1,1]
v_pk_fma_f32 v[166:167], v[142:143], v[94:95], v[166:167] op_sel:[0,1,0] op_sel_hi:[1,1,1]
v_pk_fma_f32 v[168:169], v[144:145], v[94:95], v[168:169] op_sel:[0,1,0] op_sel_hi:[1,1,1]
v_pk_fma_f32 v[170:171], v[146:147], v[94:95], v[170:171] op_sel:[0,1,0] op_sel_hi:[1,1,1]
v_cvt_pk_bf16_f32 v164, v164, v165
v_mfma_f32_16x16x32_bf16 v[60:63], v[10:13], v[156:159], 0
v_cvt_pk_bf16_f32 v165, v166, v167
v_cvt_pk_bf16_f32 v166, v168, v169
v_mfma_f32_16x16x32_bf16 v[64:67], v[14:17], v[156:159], 0
v_cvt_pk_bf16_f32 v167, v170, v171
v_pk_fma_f32 v[172:173], v[140:141], v[96:97], v[172:173] op_sel:[0,1,0] op_sel_hi:[1,1,1]
v_pk_fma_f32 v[174:175], v[142:143], v[96:97], v[174:175] op_sel:[0,1,0] op_sel_hi:[1,1,1]
v_pk_fma_f32 v[176:177], v[144:145], v[96:97], v[176:177] op_sel:[0,1,0] op_sel_hi:[1,1,1]
v_pk_fma_f32 v[178:179], v[146:147], v[96:97], v[178:179] op_sel:[0,1,0] op_sel_hi:[1,1,1]
v_cvt_pk_bf16_f32 v172, v172, v173
v_mfma_f32_16x16x32_bf16 v[68:71], v[10:13], v[164:167], 0
v_cvt_pk_bf16_f32 v173, v174, v175
v_cvt_pk_bf16_f32 v174, v176, v177
v_mfma_f32_16x16x32_bf16 v[72:75], v[14:17], v[164:167], 0
v_cvt_pk_bf16_f32 v175, v178, v179
v_pk_fma_f32 v[180:181], v[140:141], v[98:99], v[180:181] op_sel:[0,1,0] op_sel_hi:[1,1,1]
v_pk_fma_f32 v[182:183], v[142:143], v[98:99], v[182:183] op_sel:[0,1,0] op_sel_hi:[1,1,1]
v_pk_fma_f32 v[184:185], v[144:145], v[98:99], v[184:185] op_sel:[0,1,0] op_sel_hi:[1,1,1]
v_pk_fma_f32 v[186:187], v[146:147], v[98:99], v[186:187] op_sel:[0,1,0] op_sel_hi:[1,1,1]
v_cvt_pk_bf16_f32 v180, v180, v181
v_mfma_f32_16x16x32_bf16 v[76:79], v[10:13], v[172:175], 0
v_cvt_pk_bf16_f32 v181, v182, v183
v_cvt_pk_bf16_f32 v182, v184, v185
v_mfma_f32_16x16x32_bf16 v[80:83], v[14:17], v[172:175], 0
v_cvt_pk_bf16_f32 v183, v186, v187
s_nop 1
v_mfma_f32_16x16x32_bf16 v[84:87], v[10:13], v[180:183], 0
v_mfma_f32_16x16x32_bf16 v[88:91], v[14:17], v[180:183], 0
v_max3_f32 v100, v60, v61, v62
v_min3_f32 v104, v60, v61, v62
v_max3_f32 v100, v100, v63, v64
v_min3_f32 v104, v104, v63, v64
v_max3_f32 v100, v100, v65, v66
v_min3_f32 v104, v104, v65, v66
v_max_f32 v100, v100, v67
v_min_f32 v104, v104, v67
v_max3_f32 v101, v68, v69, v70
v_min3_f32 v105, v68, v69, v70
v_max3_f32 v101, v101, v71, v72
v_min3_f32 v105, v105, v71, v72
v_max3_f32 v101, v101, v73, v74
v_min3_f32 v105, v105, v73, v74
v_max_f32 v101, v101, v75
v_min_f32 v105, v105, v75
v_max3_f32 v102, v76, v77, v78
v_min3_f32 v106, v76, v77, v78
v_max3_f32 v102, v102, v79, v80
v_min3_f32 v106, v106, v79, v80
v_max3_f32 v102, v102, v81, v82
v_min3_f32 v106, v106, v81, v82
v_max_f32 v102, v102, v83
v_min_f32 v106, v106, v83
v_max3_f32 v103, v84, v85, v86
v_min3_f32 v107, v84, v85, v86
v_max3_f32 v103, v103, v87, v88
v_min3_f32 v107, v107, v87, v88
v_max3_f32 v103, v103, v89, v90
v_min3_f32 v107, v107, v89, v90
v_max_f32 v103, v103, v91
v_min_f32 v107, v107, v91
s_nop 1
v_permlane32_swap_b32 v100, v101
v_permlane32_swap_b32 v102, v103
v_permlane32_swap_b32 v104, v105
v_permlane32_swap_b32 v106, v107
v_max_f32 v100, v100, v101
v_max_f32 v102, v102, v103
v_min_f32 v104, v104, v105
v_min_f32 v106, v106, v107
v_permlane16_swap_b32 v100, v102
s_nop 0
v_permlane16_swap_b32 v104, v106
v_max_f32 v100, v100, v102
v_min_f32 v104, v104, v106
v_mov_b32 v102, v100
v_mov_b32 v106, v104
s_nop 0
v_permlane16_swap_b32 v100, v102
v_permlane16_swap_b32 v104, v106
v_mov_b32 v101, v100
v_mov_b32 v103, v102
v_mov_b32 v105, v104
v_mov_b32 v107, v106
v_permlane32_swap_b32 v100, v101
v_permlane32_swap_b32 v102, v103
v_permlane32_swap_b32 v104, v105
v_permlane32_swap_b32 v106, v107
v_pk_mul_f32 v[100:101], v[100:101], v[128:129]
v_pk_mul_f32 v[102:103], v[102:103], v[130:131]
v_pk_mul_f32 v[104:105], v[104:105], v[128:129]
v_pk_mul_f32 v[106:107], v[106:107], v[130:131]
v_pk_fma_f32 v[220:221], v[60:61], v[128:129], v[104:105] op_sel:[0,0,0] op_sel_hi:[1,0,0] neg_lo:[1,0,0] neg_hi:[1,0,0]
v_pk_fma_f32 v[60:61], v[60:61], v[128:129], v[100:101] op_sel:[0,0,0] op_sel_hi:[1,0,0] neg_lo:[0,0,1] neg_hi:[0,0,1]
v_exp_f32 v220, v220
v_exp_f32 v60, v60
v_exp_f32 v221, v221
v_exp_f32 v61, v61
v_pk_fma_f32 v[222:223], v[62:63], v[128:129], v[104:105] op_sel:[0,0,0] op_sel_hi:[1,0,0] neg_lo:[1,0,0] neg_hi:[1,0,0]
v_pk_fma_f32 v[62:63], v[62:63], v[128:129], v[100:101] op_sel:[0,0,0] op_sel_hi:[1,0,0] neg_lo:[0,0,1] neg_hi:[0,0,1]
v_exp_f32 v222, v222
v_exp_f32 v62, v62
v_exp_f32 v223, v223
v_exp_f32 v63, v63
v_pk_fma_f32 v[224:225], v[64:65], v[128:129], v[104:105] op_sel:[0,0,0] op_sel_hi:[1,0,0] neg_lo:[1,0,0] neg_hi:[1,0,0]
v_pk_fma_f32 v[64:65], v[64:65], v[128:129], v[100:101] op_sel:[0,0,0] op_sel_hi:[1,0,0] neg_lo:[0,0,1] neg_hi:[0,0,1]
v_exp_f32 v224, v224
v_exp_f32 v64, v64
v_exp_f32 v225, v225
v_exp_f32 v65, v65
v_pk_fma_f32 v[226:227], v[66:67], v[128:129], v[104:105] op_sel:[0,0,0] op_sel_hi:[1,0,0] neg_lo:[1,0,0] neg_hi:[1,0,0]
v_pk_fma_f32 v[66:67], v[66:67], v[128:129], v[100:101] op_sel:[0,0,0] op_sel_hi:[1,0,0] neg_lo:[0,0,1] neg_hi:[0,0,1]
v_exp_f32 v226, v226
v_exp_f32 v66, v66
v_exp_f32 v227, v227
v_exp_f32 v67, v67
v_pk_fma_f32 v[228:229], v[68:69], v[128:129], v[104:105] op_sel:[0,1,1] op_sel_hi:[1,1,1] neg_lo:[1,0,0] neg_hi:[1,0,0]
v_pk_fma_f32 v[68:69], v[68:69], v[128:129], v[100:101] op_sel:[0,1,1] op_sel_hi:[1,1,1] neg_lo:[0,0,1] neg_hi:[0,0,1]
v_exp_f32 v228, v228
v_exp_f32 v68, v68
v_exp_f32 v229, v229
v_exp_f32 v69, v69
v_pk_fma_f32 v[230:231], v[70:71], v[128:129], v[104:105] op_sel:[0,1,1] op_sel_hi:[1,1,1] neg_lo:[1,0,0] neg_hi:[1,0,0]
v_pk_fma_f32 v[70:71], v[70:71], v[128:129], v[100:101] op_sel:[0,1,1] op_sel_hi:[1,1,1] neg_lo:[0,0,1] neg_hi:[0,0,1]
v_exp_f32 v230, v230
v_exp_f32 v70, v70
v_exp_f32 v231, v231
v_exp_f32 v71, v71
v_pk_fma_f32 v[232:233], v[72:73], v[128:129], v[104:105] op_sel:[0,1,1] op_sel_hi:[1,1,1] neg_lo:[1,0,0] neg_hi:[1,0,0]
v_pk_fma_f32 v[72:73], v[72:73], v[128:129], v[100:101] op_sel:[0,1,1] op_sel_hi:[1,1,1] neg_lo:[0,0,1] neg_hi:[0,0,1]
v_exp_f32 v232, v232
v_exp_f32 v72, v72
v_exp_f32 v233, v233
v_exp_f32 v73, v73
v_pk_fma_f32 v[234:235], v[74:75], v[128:129], v[104:105] op_sel:[0,1,1] op_sel_hi:[1,1,1] neg_lo:[1,0,0] neg_hi:[1,0,0]
v_pk_fma_f32 v[74:75], v[74:75], v[128:129], v[100:101] op_sel:[0,1,1] op_sel_hi:[1,1,1] neg_lo:[0,0,1] neg_hi:[0,0,1]
v_exp_f32 v234, v234
v_exp_f32 v74, v74
v_exp_f32 v235, v235
v_exp_f32 v75, v75
buffer_load_dwordx4 v[188:191], v18, s[32:35], s55 offen offset:0 sc1
buffer_load_dwordx4 v[192:195], v18, s[32:35], s55 offen offset:1024 sc1
buffer_load_dwordx4 v[204:207], v58, s[32:35], s56 offen sc1
buffer_load_dwordx4 v[208:211], v58, s[32:35], s57 offen sc1
v_pk_fma_f32 v[236:237], v[76:77], v[130:131], v[106:107] op_sel:[0,0,0] op_sel_hi:[1,0,0] neg_lo:[1,0,0] neg_hi:[1,0,0]
v_pk_fma_f32 v[76:77], v[76:77], v[130:131], v[102:103] op_sel:[0,0,0] op_sel_hi:[1,0,0] neg_lo:[0,0,1] neg_hi:[0,0,1]
v_exp_f32 v236, v236
v_exp_f32 v76, v76
v_exp_f32 v237, v237
v_exp_f32 v77, v77
v_pk_fma_f32 v[238:239], v[78:79], v[130:131], v[106:107] op_sel:[0,0,0] op_sel_hi:[1,0,0] neg_lo:[1,0,0] neg_hi:[1,0,0]
v_pk_fma_f32 v[78:79], v[78:79], v[130:131], v[102:103] op_sel:[0,0,0] op_sel_hi:[1,0,0] neg_lo:[0,0,1] neg_hi:[0,0,1]
v_exp_f32 v238, v238
v_exp_f32 v78, v78
v_exp_f32 v239, v239
v_exp_f32 v79, v79
v_pk_fma_f32 v[240:241], v[80:81], v[130:131], v[106:107] op_sel:[0,0,0] op_sel_hi:[1,0,0] neg_lo:[1,0,0] neg_hi:[1,0,0]
v_pk_fma_f32 v[80:81], v[80:81], v[130:131], v[102:103] op_sel:[0,0,0] op_sel_hi:[1,0,0] neg_lo:[0,0,1] neg_hi:[0,0,1]
v_exp_f32 v240, v240
v_exp_f32 v80, v80
v_exp_f32 v241, v241
v_exp_f32 v81, v81
v_pk_fma_f32 v[242:243], v[82:83], v[130:131], v[106:107] op_sel:[0,0,0] op_sel_hi:[1,0,0] neg_lo:[1,0,0] neg_hi:[1,0,0]
v_pk_fma_f32 v[82:83], v[82:83], v[130:131], v[102:103] op_sel:[0,0,0] op_sel_hi:[1,0,0] neg_lo:[0,0,1] neg_hi:[0,0,1]
v_exp_f32 v242, v242
v_exp_f32 v82, v82
v_exp_f32 v243, v243
v_exp_f32 v83, v83
v_pk_fma_f32 v[244:245], v[84:85], v[130:131], v[106:107] op_sel:[0,1,1] op_sel_hi:[1,1,1] neg_lo:[1,0,0] neg_hi:[1,0,0]
v_pk_fma_f32 v[84:85], v[84:85], v[130:131], v[102:103] op_sel:[0,1,1] op_sel_hi:[1,1,1] neg_lo:[0,0,1] neg_hi:[0,0,1]
v_exp_f32 v244, v244
v_exp_f32 v84, v84
v_exp_f32 v245, v245
v_exp_f32 v85, v85
v_pk_fma_f32 v[246:247], v[86:87], v[130:131], v[106:107] op_sel:[0,1,1] op_sel_hi:[1,1,1] neg_lo:[1,0,0] neg_hi:[1,0,0]
v_pk_fma_f32 v[86:87], v[86:87], v[130:131], v[102:103] op_sel:[0,1,1] op_sel_hi:[1,1,1] neg_lo:[0,0,1] neg_hi:[0,0,1]
v_exp_f32 v246, v246
v_exp_f32 v86, v86
v_exp_f32 v247, v247
v_exp_f32 v87, v87
v_pk_fma_f32 v[248:249], v[88:89], v[130:131], v[106:107] op_sel:[0,1,1] op_sel_hi:[1,1,1] neg_lo:[1,0,0] neg_hi:[1,0,0]
v_pk_fma_f32 v[88:89], v[88:89], v[130:131], v[102:103] op_sel:[0,1,1] op_sel_hi:[1,1,1] neg_lo:[0,0,1] neg_hi:[0,0,1]
v_exp_f32 v248, v248
v_exp_f32 v88, v88
v_exp_f32 v249, v249
v_exp_f32 v89, v89
v_pk_fma_f32 v[250:251], v[90:91], v[130:131], v[106:107] op_sel:[0,1,1] op_sel_hi:[1,1,1] neg_lo:[1,0,0] neg_hi:[1,0,0]
v_pk_fma_f32 v[90:91], v[90:91], v[130:131], v[102:103] op_sel:[0,1,1] op_sel_hi:[1,1,1] neg_lo:[0,0,1] neg_hi:[0,0,1]
v_exp_f32 v250, v250
v_exp_f32 v90, v90
v_exp_f32 v251, v251
v_exp_f32 v91, v91
v_pk_add_f32 v[108:109], v[60:61], v[62:63]
v_pk_add_f32 v[110:111], v[220:221], v[222:223]
v_pk_add_f32 v[108:109], v[108:109], v[64:65]
v_pk_add_f32 v[110:111], v[110:111], v[224:225]
v_pk_add_f32 v[108:109], v[108:109], v[66:67]
v_pk_add_f32 v[110:111], v[110:111], v[226:227]
v_add_f32 v100, v108, v109
v_add_f32 v104, v110, v111
v_pk_add_f32 v[108:109], v[68:69], v[70:71]
v_pk_add_f32 v[110:111], v[228:229], v[230:231]
v_pk_add_f32 v[108:109], v[108:109], v[72:73]
v_pk_add_f32 v[110:111], v[110:111], v[232:233]
v_pk_add_f32 v[108:109], v[108:109], v[74:75]
v_pk_add_f32 v[110:111], v[110:111], v[234:235]
v_add_f32 v101, v108, v109
v_add_f32 v105, v110, v111
v_pk_add_f32 v[108:109], v[76:77], v[78:79]
v_pk_add_f32 v[110:111], v[236:237], v[238:239]
v_pk_add_f32 v[108:109], v[108:109], v[80:81]
v_pk_add_f32 v[110:111], v[110:111], v[240:241]
v_pk_add_f32 v[108:109], v[108:109], v[82:83]
v_pk_add_f32 v[110:111], v[110:111], v[242:243]
v_add_f32 v102, v108, v109
v_add_f32 v106, v110, v111
v_pk_add_f32 v[108:109], v[84:85], v[86:87]
v_pk_add_f32 v[110:111], v[244:245], v[246:247]
v_pk_add_f32 v[108:109], v[108:109], v[88:89]
v_pk_add_f32 v[110:111], v[110:111], v[248:249]
v_pk_add_f32 v[108:109], v[108:109], v[90:91]
v_pk_add_f32 v[110:111], v[110:111], v[250:251]
v_add_f32 v103, v108, v109
v_add_f32 v107, v110, v111
s_mov_b32 s63, 0
sent_66:
s_waitcnt vmcnt(0)
v_max_u32 v4, v188, v189
v_max3_u32 v4, v4, v190, v191
v_max3_u32 v4, v4, v192, v193
v_max3_u32 v4, v4, v194, v195
v_max3_u32 v4, v4, v204, v205
v_max3_u32 v4, v4, v206, v207
v_max3_u32 v4, v4, v208, v209
v_max3_u32 v4, v4, v210, v211
v_cmp_eq_u32 vcc, -1, v4
s_cbranch_vccz sentd_67
buffer_load_dwordx4 v[188:191], v18, s[32:35], s55 offen offset:0 sc1
buffer_load_dwordx4 v[192:195], v18, s[32:35], s55 offen offset:1024 sc1
buffer_load_dwordx4 v[204:207], v58, s[32:35], s56 offen sc1
buffer_load_dwordx4 v[208:211], v58, s[32:35], s57 offen sc1
s_add_u32 s63, s63, 1
s_cmp_lt_u32 s63, 0x80000
s_cbranch_scc1 sent_66
s_waitcnt vmcnt(0)
sentd_67:
v_mfma_f32_16x16x32_bf16 v[132:135], v[44:47], v[188:191], 0
v_mfma_f32_16x16x32_bf16 v[132:135], v[44:47], v[192:195], v[132:135]
s_nop 7
v_add_f32_dpp v132, v132, v132 row_ror:8 row_mask:0xf bank_mask:0xf
v_add_f32_dpp v133, v133, v133 row_ror:8 row_mask:0xf bank_mask:0xf
v_add_f32_dpp v134, v134, v134 row_ror:8 row_mask:0xf bank_mask:0xf
v_add_f32_dpp v135, v135, v135 row_ror:8 row_mask:0xf bank_mask:0xf
v_cvt_pk_bf16_f32 v132, v132, v133
v_cvt_pk_bf16_f32 v133, v134, v135
s_mov_b64 exec, 0x00ff00ff
buffer_store_dwordx2 v[132:133], v59, s[32:35], s79 offen sc1
s_mov_b64 exec, -1
s_nop 1
v_permlane32_swap_b32 v100, v101
v_permlane32_swap_b32 v102, v103
v_permlane32_swap_b32 v104, v105
v_permlane32_swap_b32 v106, v107
v_add_f32 v100, v100, v101
v_add_f32 v102, v102, v103
v_add_f32 v104, v104, v105
v_add_f32 v106, v106, v107
v_permlane16_swap_b32 v100, v102
s_nop 0
v_permlane16_swap_b32 v104, v106
v_add_f32 v100, v100, v102
v_add_f32 v104, v104, v106
v_rcp_f32 v100, v100
v_rcp_f32 v104, v104
s_nop 0
v_mov_b32 v102, v100
v_mov_b32 v106, v104
s_nop 0
v_permlane16_swap_b32 v100, v102
v_permlane16_swap_b32 v104, v106
v_mov_b32 v101, v100
v_mov_b32 v103, v102
v_mov_b32 v105, v104
v_mov_b32 v107, v106
v_permlane32_swap_b32 v100, v101
v_permlane32_swap_b32 v102, v103
v_permlane32_swap_b32 v104, v105
v_permlane32_swap_b32 v106, v107
.p2align 3
v_pk_mul_f32 v[60:61], v[60:61], v[100:101] op_sel:[0,0] op_sel_hi:[1,0]
v_pk_mul_f32 v[62:63], v[62:63], v[100:101] op_sel:[0,0] op_sel_hi:[1,0]
v_pk_mul_f32 v[64:65], v[64:65], v[100:101] op_sel:[0,0] op_sel_hi:[1,0]
v_pk_mul_f32 v[66:67], v[66:67], v[100:101] op_sel:[0,0] op_sel_hi:[1,0]
v_pk_mul_f32 v[220:221], v[220:221], v[104:105] op_sel:[0,0] op_sel_hi:[1,0]
v_pk_mul_f32 v[222:223], v[222:223], v[104:105] op_sel:[0,0] op_sel_hi:[1,0]
v_pk_mul_f32 v[224:225], v[224:225], v[104:105] op_sel:[0,0] op_sel_hi:[1,0]
v_pk_mul_f32 v[226:227], v[226:227], v[104:105] op_sel:[0,0] op_sel_hi:[1,0]
v_cvt_pk_bf16_f32 v60, v60, v61
v_cvt_pk_bf16_f32 v61, v62, v63
v_cvt_pk_bf16_f32 v62, v64, v65
v_cvt_pk_bf16_f32 v63, v66, v67
v_cvt_pk_bf16_f32 v220, v220, v221
v_cvt_pk_bf16_f32 v221, v222, v223
v_cvt_pk_bf16_f32 v222, v224, v225
v_cvt_pk_bf16_f32 v223, v226, v227
v_pk_mul_f32 v[68:69], v[68:69], v[100:101] op_sel:[0,1] op_sel_hi:[1,1]
v_pk_mul_f32 v[70:71], v[70:71], v[100:101] op_sel:[0,1] op_sel_hi:[1,1]
v_pk_mul_f32 v[72:73], v[72:73], v[100:101] op_sel:[0,1] op_sel_hi:[1,1]
v_pk_mul_f32 v[74:75], v[74:75], v[100:101] op_sel:[0,1] op_sel_hi:[1,1]
v_pk_mul_f32 v[228:229], v[228:229], v[104:105] op_sel:[0,1] op_sel_hi:[1,1]
v_pk_mul_f32 v[230:231], v[230:231], v[104:105] op_sel:[0,1] op_sel_hi:[1,1]
v_pk_mul_f32 v[232:233], v[232:233], v[104:105] op_sel:[0,1] op_sel_hi:[1,1]
v_pk_mul_f32 v[234:235], v[234:235], v[104:105] op_sel:[0,1] op_sel_hi:[1,1]
v_cvt_pk_bf16_f32 v68, v68, v69
v_mfma_f32_16x16x32_bf16 v[112:115], v[204:207], v[60:63], 0
v_cvt_pk_bf16_f32 v69, v70, v71
v_cvt_pk_bf16_f32 v70, v72, v73
v_cvt_pk_bf16_f32 v71, v74, v75
v_cvt_pk_bf16_f32 v228, v228, v229
v_mfma_f32_16x16x32_bf16 v[112:115], v[208:211], v[220:223], v[112:115]
v_cvt_pk_bf16_f32 v229, v230, v231
v_cvt_pk_bf16_f32 v230, v232, v233
v_cvt_pk_bf16_f32 v231, v234, v235
v_pk_mul_f32 v[76:77], v[76:77], v[102:103] op_sel:[0,0] op_sel_hi:[1,0]
v_pk_mul_f32 v[78:79], v[78:79], v[102:103] op_sel:[0,0] op_sel_hi:[1,0]
v_pk_mul_f32 v[80:81], v[80:81], v[102:103] op_sel:[0,0] op_sel_hi:[1,0]
v_pk_mul_f32 v[82:83], v[82:83], v[102:103] op_sel:[0,0] op_sel_hi:[1,0]
v_pk_mul_f32 v[236:237], v[236:237], v[106:107] op_sel:[0,0] op_sel_hi:[1,0]
v_pk_mul_f32 v[238:239], v[238:239], v[106:107] op_sel:[0,0] op_sel_hi:[1,0]
v_pk_mul_f32 v[240:241], v[240:241], v[106:107] op_sel:[0,0] op_sel_hi:[1,0]
v_pk_mul_f32 v[242:243], v[242:243], v[106:107] op_sel:[0,0] op_sel_hi:[1,0]
v_cvt_pk_bf16_f32 v76, v76, v77
v_mfma_f32_16x16x32_bf16 v[116:119], v[204:207], v[68:71], 0
v_cvt_pk_bf16_f32 v77, v78, v79
v_cvt_pk_bf16_f32 v78, v80, v81
v_cvt_pk_bf16_f32 v79, v82, v83
v_cvt_pk_bf16_f32 v236, v236, v237
v_mfma_f32_16x16x32_bf16 v[116:119], v[208:211], v[228:231], v[116:119]
v_cvt_pk_bf16_f32 v237, v238, v239
v_cvt_pk_bf16_f32 v238, v240, v241
v_cvt_pk_bf16_f32 v239, v242, v243
v_pk_mul_f32 v[84:85], v[84:85], v[102:103] op_sel:[0,1] op_sel_hi:[1,1]
v_pk_mul_f32 v[86:87], v[86:87], v[102:103] op_sel:[0,1] op_sel_hi:[1,1]
v_pk_mul_f32 v[88:89], v[88:89], v[102:103] op_sel:[0,1] op_sel_hi:[1,1]
v_pk_mul_f32 v[90:91], v[90:91], v[102:103] op_sel:[0,1] op_sel_hi:[1,1]
v_pk_mul_f32 v[244:245], v[244:245], v[106:107] op_sel:[0,1] op_sel_hi:[1,1]
v_pk_mul_f32 v[246:247], v[246:247], v[106:107] op_sel:[0,1] op_sel_hi:[1,1]
v_pk_mul_f32 v[248:249], v[248:249], v[106:107] op_sel:[0,1] op_sel_hi:[1,1]
v_pk_mul_f32 v[250:251], v[250:251], v[106:107] op_sel:[0,1] op_sel_hi:[1,1]
v_cvt_pk_bf16_f32 v84, v84, v85
v_mfma_f32_16x16x32_bf16 v[120:123], v[204:207], v[76:79], 0
v_cvt_pk_bf16_f32 v85, v86, v87
v_cvt_pk_bf16_f32 v86, v88, v89
v_cvt_pk_bf16_f32 v87, v90, v91
v_cvt_pk_bf16_f32 v244, v244, v245
v_mfma_f32_16x16x32_bf16 v[120:123], v[208:211], v[236:239], v[120:123]
v_cvt_pk_bf16_f32 v245, v246, v247
v_cvt_pk_bf16_f32 v246, v248, v249
v_cvt_pk_bf16_f32 v247, v250, v251
buffer_load_dwordx4 v[188:191], v18, s[32:35], s58 offen offset:0 sc1
buffer_load_dwordx4 v[192:195], v18, s[32:35], s58 offen offset:1024 sc1
v_mfma_f32_16x16x32_bf16 v[124:127], v[204:207], v[84:87], 0
v_mfma_f32_16x16x32_bf16 v[124:127], v[208:211], v[244:247], v[124:127]
buffer_load_dwordx4 v[196:199], v18, s[32:35], s59 offen offset:0 sc1
buffer_load_dwordx4 v[200:203], v18, s[32:35], s59 offen offset:1024 sc1
v_add_f32 v100, v112, v113
v_add_f32 v114, v114, v115
v_add_f32 v100, v100, v114
v_add_f32 v101, v116, v117
v_add_f32 v118, v118, v119
v_add_f32 v101, v101, v118
v_add_f32 v102, v120, v121
v_add_f32 v122, v122, v123
v_add_f32 v102, v102, v122
v_add_f32 v103, v124, v125
v_add_f32 v126, v126, v127
v_add_f32 v103, v103, v126
s_nop 1
v_permlane32_swap_b32 v100, v101
v_permlane32_swap_b32 v102, v103
v_add_f32 v100, v100, v101
v_add_f32 v102, v102, v103
s_nop 1
v_permlane16_swap_b32 v100, v102
s_nop 0
v_add_f32 v100, v100, v102
v_add_f32 v100, 0x358637bd, v100
v_rcp_f32 v100, v100
s_nop 0
v_mov_b32 v102, v100
s_nop 1
v_permlane16_swap_b32 v100, v102
s_nop 0
v_mov_b32 v101, v100
v_mov_b32 v103, v102
s_nop 0
v_permlane32_swap_b32 v100, v101
v_permlane32_swap_b32 v102, v103
s_mov_b32 s63, 0
sent_68:
s_waitcnt vmcnt(0)
v_max_u32 v4, v188, v189
v_max3_u32 v4, v4, v190, v191
v_max3_u32 v4, v4, v192, v193
v_max3_u32 v4, v4, v194, v195
v_max3_u32 v4, v4, v196, v197
v_max3_u32 v4, v4, v198, v199
v_max3_u32 v4, v4, v200, v201
v_max3_u32 v4, v4, v202, v203
v_cmp_eq_u32 vcc, -1, v4
s_cbranch_vccz sentd_69
buffer_load_dwordx4 v[188:191], v18, s[32:35], s58 offen offset:0 sc1
buffer_load_dwordx4 v[192:195], v18, s[32:35], s58 offen offset:1024 sc1
buffer_load_dwordx4 v[196:199], v18, s[32:35], s59 offen offset:0 sc1
buffer_load_dwordx4 v[200:203], v18, s[32:35], s59 offen offset:1024 sc1
s_add_u32 s63, s63, 1
s_cmp_lt_u32 s63, 0x80000
s_cbranch_scc1 sent_68
s_waitcnt vmcnt(0)
sentd_69:
v_mfma_f32_16x16x32_bf16 v[156:159], v[188:191], v[60:63], 0
v_mfma_f32_16x16x32_bf16 v[160:163], v[192:195], v[60:63], 0
v_mfma_f32_16x16x32_bf16 v[156:159], v[196:199], v[220:223], v[156:159]
v_mfma_f32_16x16x32_bf16 v[160:163], v[200:203], v[220:223], v[160:163]
v_mfma_f32_16x16x32_bf16 v[164:167], v[188:191], v[68:71], 0
v_mfma_f32_16x16x32_bf16 v[168:171], v[192:195], v[68:71], 0
v_mfma_f32_16x16x32_bf16 v[164:167], v[196:199], v[228:231], v[164:167]
v_mfma_f32_16x16x32_bf16 v[168:171], v[200:203], v[228:231], v[168:171]
v_mfma_f32_16x16x32_bf16 v[172:175], v[188:191], v[76:79], 0
v_mfma_f32_16x16x32_bf16 v[176:179], v[192:195], v[76:79], 0
v_mfma_f32_16x16x32_bf16 v[172:175], v[196:199], v[236:239], v[172:175]
v_mfma_f32_16x16x32_bf16 v[176:179], v[200:203], v[236:239], v[176:179]
v_mfma_f32_16x16x32_bf16 v[180:183], v[188:191], v[84:87], 0
v_mfma_f32_16x16x32_bf16 v[184:187], v[192:195], v[84:87], 0
v_mfma_f32_16x16x32_bf16 v[180:183], v[196:199], v[244:247], v[180:183]
v_mfma_f32_16x16x32_bf16 v[184:187], v[200:203], v[244:247], v[184:187]
s_cmp_eq_u32 s46, 0
s_cbranch_scc1 slow_70
.p2align 3
v_pk_mul_f32 v[156:157], v[156:157], v[100:101] op_sel:[0,0] op_sel_hi:[1,0]
v_pk_mul_f32 v[158:159], v[158:159], v[100:101] op_sel:[0,0] op_sel_hi:[1,0]
v_pk_mul_f32 v[160:161], v[160:161], v[100:101] op_sel:[0,0] op_sel_hi:[1,0]
v_pk_mul_f32 v[162:163], v[162:163], v[100:101] op_sel:[0,0] op_sel_hi:[1,0]
v_cvt_pk_bf16_f32 v156, v156, v157
v_cvt_pk_bf16_f32 v157, v158, v159
v_cvt_pk_bf16_f32 v158, v160, v161
v_cvt_pk_bf16_f32 v159, v162, v163
buffer_store_dwordx4 v[156:159], v18, s[32:35], s80 offen
v_pk_mul_f32 v[164:165], v[164:165], v[100:101] op_sel:[0,1] op_sel_hi:[1,1]
v_pk_mul_f32 v[166:167], v[166:167], v[100:101] op_sel:[0,1] op_sel_hi:[1,1]
v_pk_mul_f32 v[168:169], v[168:169], v[100:101] op_sel:[0,1] op_sel_hi:[1,1]
v_pk_mul_f32 v[170:171], v[170:171], v[100:101] op_sel:[0,1] op_sel_hi:[1,1]
v_cvt_pk_bf16_f32 v164, v164, v165
v_cvt_pk_bf16_f32 v165, v166, v167
v_cvt_pk_bf16_f32 v166, v168, v169
v_cvt_pk_bf16_f32 v167, v170, v171
buffer_store_dwordx4 v[164:167], v18, s[32:35], s81 offen
v_pk_mul_f32 v[172:173], v[172:173], v[102:103] op_sel:[0,0] op_sel_hi:[1,0]
v_pk_mul_f32 v[174:175], v[174:175], v[102:103] op_sel:[0,0] op_sel_hi:[1,0]
v_pk_mul_f32 v[176:177], v[176:177], v[102:103] op_sel:[0,0] op_sel_hi:[1,0]
v_pk_mul_f32 v[178:179], v[178:179], v[102:103] op_sel:[0,0] op_sel_hi:[1,0]
v_cvt_pk_bf16_f32 v172, v172, v173
v_cvt_pk_bf16_f32 v173, v174, v175
v_cvt_pk_bf16_f32 v174, v176, v177
v_cvt_pk_bf16_f32 v175, v178, v179
buffer_store_dwordx4 v[172:175], v18, s[32:35], s82 offen
v_pk_mul_f32 v[180:181], v[180:181], v[102:103] op_sel:[0,1] op_sel_hi:[1,1]
v_pk_mul_f32 v[182:183], v[182:183], v[102:103] op_sel:[0,1] op_sel_hi:[1,1]
v_pk_mul_f32 v[184:185], v[184:185], v[102:103] op_sel:[0,1] op_sel_hi:[1,1]
v_pk_mul_f32 v[186:187], v[186:187], v[102:103] op_sel:[0,1] op_sel_hi:[1,1]
v_cvt_pk_bf16_f32 v180, v180, v181
v_cvt_pk_bf16_f32 v181, v182, v183
v_cvt_pk_bf16_f32 v182, v184, v185
v_cvt_pk_bf16_f32 v183, v186, v187
buffer_store_dwordx4 v[180:183], v18, s[32:35], s83 offen
s_barrier
s_lshl_b32 s62, s45, 2
v_mov_b32 v4, s62
v_mov_b32 v5, 2
s_mov_b64 exec, 1
s_waitcnt vmcnt(0)
buffer_store_dword v5, v4, s[32:35], s84 offen
s_mov_b64 exec, -1
back_71:
v_and_b32 v36, 31, v0
v_lshlrev_b32 v36, 2, v36
buffer_load_dword v37, v36, s[32:35], s84 offen sc1
v_lshrrev_b32 v4, 2, v2
v_and_b32 v5, 3, v0
v_lshl_add_u32 v6, v3, 3, v4
v_lshlrev_b32 v6, 7, v6
v_lshl_add_u32 v6, v5, 3, v6
v_lshrrev_b32 v7, 1, v4
v_and_b32 v8, 1, v3
v_lshl_add_u32 v7, v8, 1, v7
v_lshl_add_u32 v10, v7, 5, v6
v_xor_b32 v11, 32, v10
v_xor_b32 v12, 64, v10
v_xor_b32 v13, 96, v10
v_add_u32 v14, 0x10000, v10
v_add_u32 v15, 0x10000, v11
v_add_u32 v16, 0x10000, v12
v_add_u32 v17, 0x10000, v13
ds_read_b64_tr_b16 v[220:221], v10 offset:0
ds_read_b64_tr_b16 v[222:223], v10 offset:512
ds_read_b64_tr_b16 v[224:225], v11 offset:0
ds_read_b64_tr_b16 v[226:227], v11 offset:512
ds_read_b64_tr_b16 v[228:229], v12 offset:0
ds_read_b64_tr_b16 v[230:231], v12 offset:512
ds_read_b64_tr_b16 v[232:233], v13 offset:0
ds_read_b64_tr_b16 v[234:235], v13 offset:512
ds_read_b64_tr_b16 v[236:237], v10 offset:4096
ds_read_b64_tr_b16 v[238:239], v10 offset:4608
ds_read_b64_tr_b16 v[240:241], v11 offset:4096
ds_read_b64_tr_b16 v[242:243], v11 offset:4608
ds_read_b64_tr_b16 v[244:245], v12 offset:4096
ds_read_b64_tr_b16 v[246:247], v12 offset:4608
ds_read_b64_tr_b16 v[248:249], v13 offset:4096
ds_read_b64_tr_b16 v[250:251], v13 offset:4608
s_lshl_b32 s48, s41, 3
s_lshl_b32 s49, s40, 1
s_add_u32 s48, s48, s49
s_lshl_b32 s48, s48, 15
s_add_u32 s48, s48, 4194304
v_add_u32 v38, s48, v18
v_add_u32 v39, 32768, v38
s_lshl_b32 s57, s47, 11
s_mov_b32 s63, 0
s_waitcnt vmcnt(0)
poll_72:
v_cmp_gt_u32 vcc, 2, v37
s_cbranch_vccz polled_73
buffer_load_dword v37, v36, s[32:35], s84 offen sc1
s_add_u32 s63, s63, 1
s_cmp_lt_u32 s63, 0x80000
s_waitcnt vmcnt(0)
s_cbranch_scc1 poll_72
polled_73:
buffer_load_dwordx4 v[156:159], v38, s[32:35], s57 offen sc1
buffer_load_dwordx4 v[160:163], v39, s[32:35], s57 offen sc1
buffer_load_dwordx4 v[164:167], v38, s[32:35], s57 offen offset:1024 sc1
buffer_load_dwordx4 v[168:171], v39, s[32:35], s57 offen offset:1024 sc1
s_add_u32 s57, s57, 2048
s_and_b32 s57, s57, 0x7fff
buffer_load_dwordx4 v[172:175], v38, s[32:35], s57 offen sc1
buffer_load_dwordx4 v[176:179], v39, s[32:35], s57 offen sc1
buffer_load_dwordx4 v[180:183], v38, s[32:35], s57 offen offset:1024 sc1
buffer_load_dwordx4 v[184:187], v39, s[32:35], s57 offen offset:1024 sc1
s_add_u32 s57, s57, 2048
s_and_b32 s57, s57, 0x7fff
v_lshlrev_b32 v60, 16, v20
v_and_b32 v61, 0xffff0000, v20
v_lshlrev_b32 v62, 16, v21
v_and_b32 v63, 0xffff0000, v21
v_lshlrev_b32 v64, 16, v22
v_and_b32 v65, 0xffff0000, v22
v_lshlrev_b32 v66, 16, v23
v_and_b32 v67, 0xffff0000, v23
v_lshlrev_b32 v68, 16, v24
v_and_b32 v69, 0xffff0000, v24
v_lshlrev_b32 v70, 16, v25
v_and_b32 v71, 0xffff0000, v25
v_lshlrev_b32 v72, 16, v26
v_and_b32 v73, 0xffff0000, v26
v_lshlrev_b32 v74, 16, v27
v_and_b32 v75, 0xffff0000, v27
v_lshlrev_b32 v76, 16, v28
v_and_b32 v77, 0xffff0000, v28
v_lshlrev_b32 v78, 16, v29
v_and_b32 v79, 0xffff0000, v29
v_lshlrev_b32 v80, 16, v30
v_and_b32 v81, 0xffff0000, v30
v_lshlrev_b32 v82, 16, v31
v_and_b32 v83, 0xffff0000, v31
v_lshlrev_b32 v84, 16, v32
v_and_b32 v85, 0xffff0000, v32
v_lshlrev_b32 v86, 16, v33
v_and_b32 v87, 0xffff0000, v33
v_lshlrev_b32 v88, 16, v34
v_and_b32 v89, 0xffff0000, v34
v_lshlrev_b32 v90, 16, v35
v_and_b32 v91, 0xffff0000, v35
v_mov_b32 v6, 0
v_mov_b32 v7, 0
v_mov_b32 v8, 0
v_mov_b32 v9, 0
s_lshl_b32 s62, s42, 2
v_mov_b32 v4, s62
v_mov_b32 v5, 2
buffer_load_dwordx4 v[188:191], v38, s[32:35], s57 offen sc1
buffer_load_dwordx4 v[192:195], v39, s[32:35], s57 offen sc1
buffer_load_dwordx4 v[196:199], v38, s[32:35], s57 offen offset:1024 sc1
buffer_load_dwordx4 v[200:203], v39, s[32:35], s57 offen offset:1024 sc1
s_add_u32 s57, s57, 2048
s_and_b32 s57, s57, 0x7fff
s_waitcnt vmcnt(10) lgkmcnt(8)
v_mfma_f32_16x16x32_bf16 v[60:63], v[220:223], v[156:159], v[60:63]
ds_read_b64_tr_b16 v[100:101], v10 offset:8192
ds_read_b64_tr_b16 v[102:103], v10 offset:8704
v_mfma_f32_16x16x32_bf16 v[76:79], v[220:223], v[160:163], v[76:79]
buffer_load_dwordx4 v[204:207], v38, s[32:35], s57 offen sc1
v_mfma_f32_16x16x32_bf16 v[64:67], v[224:227], v[156:159], v[64:67]
ds_read_b64_tr_b16 v[104:105], v11 offset:8192
v_mfma_f32_16x16x32_bf16 v[80:83], v[224:227], v[160:163], v[80:83]
ds_read_b64_tr_b16 v[106:107], v11 offset:8704
v_mfma_f32_16x16x32_bf16 v[68:71], v[228:231], v[156:159], v[68:71]
ds_read_b64_tr_b16 v[108:109], v12 offset:8192
buffer_load_dwordx4 v[208:211], v39, s[32:35], s57 offen sc1
v_mfma_f32_16x16x32_bf16 v[84:87], v[228:231], v[160:163], v[84:87]
ds_read_b64_tr_b16 v[110:111], v12 offset:8704
v_mfma_f32_16x16x32_bf16 v[72:75], v[232:235], v[156:159], v[72:75]
ds_read_b64_tr_b16 v[112:113], v13 offset:8192
v_mfma_f32_16x16x32_bf16 v[88:91], v[232:235], v[160:163], v[88:91]
ds_read_b64_tr_b16 v[114:115], v13 offset:8704
s_waitcnt vmcnt(10) lgkmcnt(8)
v_mfma_f32_16x16x32_bf16 v[60:63], v[236:239], v[164:167], v[60:63]
ds_read_b64_tr_b16 v[220:221], v10 offset:12288
ds_read_b64_tr_b16 v[222:223], v10 offset:12800
v_mfma_f32_16x16x32_bf16 v[76:79], v[236:239], v[168:171], v[76:79]
buffer_load_dwordx4 v[212:215], v38, s[32:35], s57 offen offset:1024 sc1
v_mfma_f32_16x16x32_bf16 v[64:67], v[240:243], v[164:167], v[64:67]
ds_read_b64_tr_b16 v[224:225], v11 offset:12288
v_mfma_f32_16x16x32_bf16 v[80:83], v[240:243], v[168:171], v[80:83]
ds_read_b64_tr_b16 v[226:227], v11 offset:12800
v_mfma_f32_16x16x32_bf16 v[68:71], v[244:247], v[164:167], v[68:71]
ds_read_b64_tr_b16 v[228:229], v12 offset:12288
buffer_load_dwordx4 v[216:219], v39, s[32:35], s57 offen offset:1024 sc1
s_add_u32 s57, s57, 2048
s_and_b32 s57, s57, 0x7fff
v_mfma_f32_16x16x32_bf16 v[84:87], v[244:247], v[168:171], v[84:87]
ds_read_b64_tr_b16 v[230:231], v12 offset:12800
v_mfma_f32_16x16x32_bf16 v[72:75], v[248:251], v[164:167], v[72:75]
ds_read_b64_tr_b16 v[232:233], v13 offset:12288
v_mfma_f32_16x16x32_bf16 v[88:91], v[248:251], v[168:171], v[88:91]
ds_read_b64_tr_b16 v[234:235], v13 offset:12800
s_waitcnt vmcnt(10) lgkmcnt(8)
v_mfma_f32_16x16x32_bf16 v[60:63], v[100:103], v[172:175], v[60:63]
ds_read_b64_tr_b16 v[236:237], v10 offset:16384
ds_read_b64_tr_b16 v[238:239], v10 offset:16896
v_mfma_f32_16x16x32_bf16 v[76:79], v[100:103], v[176:179], v[76:79]
buffer_load_dwordx4 v[156:159], v38, s[32:35], s57 offen sc1
v_mfma_f32_16x16x32_bf16 v[64:67], v[104:107], v[172:175], v[64:67]
ds_read_b64_tr_b16 v[240:241], v11 offset:16384
v_mfma_f32_16x16x32_bf16 v[80:83], v[104:107], v[176:179], v[80:83]
ds_read_b64_tr_b16 v[242:243], v11 offset:16896
v_mfma_f32_16x16x32_bf16 v[68:71], v[108:111], v[172:175], v[68:71]
ds_read_b64_tr_b16 v[244:245], v12 offset:16384
buffer_load_dwordx4 v[160:163], v39, s[32:35], s57 offen sc1
v_mfma_f32_16x16x32_bf16 v[84:87], v[108:111], v[176:179], v[84:87]
ds_read_b64_tr_b16 v[246:247], v12 offset:16896
v_mfma_f32_16x16x32_bf16 v[72:75], v[112:115], v[172:175], v[72:75]
ds_read_b64_tr_b16 v[248:249], v13 offset:16384
v_mfma_f32_16x16x32_bf16 v[88:91], v[112:115], v[176:179], v[88:91]
ds_read_b64_tr_b16 v[250:251], v13 offset:16896
s_waitcnt vmcnt(10) lgkmcnt(8)
v_mfma_f32_16x16x32_bf16 v[60:63], v[220:223], v[180:183], v[60:63]
ds_read_b64_tr_b16 v[100:101], v10 offset:20480
ds_read_b64_tr_b16 v[102:103], v10 offset:20992
v_mfma_f32_16x16x32_bf16 v[76:79], v[220:223], v[184:187], v[76:79]
buffer_load_dwordx4 v[164:167], v38, s[32:35], s57 offen offset:1024 sc1
v_mfma_f32_16x16x32_bf16 v[64:67], v[224:227], v[180:183], v[64:67]
ds_read_b64_tr_b16 v[104:105], v11 offset:20480
v_mfma_f32_16x16x32_bf16 v[80:83], v[224:227], v[184:187], v[80:83]
ds_read_b64_tr_b16 v[106:107], v11 offset:20992
v_mfma_f32_16x16x32_bf16 v[68:71], v[228:231], v[180:183], v[68:71]
ds_read_b64_tr_b16 v[108:109], v12 offset:20480
buffer_load_dwordx4 v[168:171], v39, s[32:35], s57 offen offset:1024 sc1
s_add_u32 s57, s57, 2048
s_and_b32 s57, s57, 0x7fff
v_mfma_f32_16x16x32_bf16 v[84:87], v[228:231], v[184:187], v[84:87]
ds_read_b64_tr_b16 v[110:111], v12 offset:20992
v_mfma_f32_16x16x32_bf16 v[72:75], v[232:235], v[180:183], v[72:75]
ds_read_b64_tr_b16 v[112:113], v13 offset:20480
v_mfma_f32_16x16x32_bf16 v[88:91], v[232:235], v[184:187], v[88:91]
ds_read_b64_tr_b16 v[114:115], v13 offset:20992
s_waitcnt vmcnt(10) lgkmcnt(8)
v_mfma_f32_16x16x32_bf16 v[60:63], v[236:239], v[188:191], v[60:63]
ds_read_b64_tr_b16 v[220:221], v10 offset:24576
ds_read_b64_tr_b16 v[222:223], v10 offset:25088
v_mfma_f32_16x16x32_bf16 v[76:79], v[236:239], v[192:195], v[76:79]
buffer_load_dwordx4 v[172:175], v38, s[32:35], s57 offen sc1
v_mfma_f32_16x16x32_bf16 v[64:67], v[240:243], v[188:191], v[64:67]
ds_read_b64_tr_b16 v[224:225], v11 offset:24576
v_mfma_f32_16x16x32_bf16 v[80:83], v[240:243], v[192:195], v[80:83]
ds_read_b64_tr_b16 v[226:227], v11 offset:25088
v_mfma_f32_16x16x32_bf16 v[68:71], v[244:247], v[188:191], v[68:71]
ds_read_b64_tr_b16 v[228:229], v12 offset:24576
buffer_load_dwordx4 v[176:179], v39, s[32:35], s57 offen sc1
v_mfma_f32_16x16x32_bf16 v[84:87], v[244:247], v[192:195], v[84:87]
ds_read_b64_tr_b16 v[230:231], v12 offset:25088
v_mfma_f32_16x16x32_bf16 v[72:75], v[248:251], v[188:191], v[72:75]
ds_read_b64_tr_b16 v[232:233], v13 offset:24576
v_mfma_f32_16x16x32_bf16 v[88:91], v[248:251], v[192:195], v[88:91]
ds_read_b64_tr_b16 v[234:235], v13 offset:25088
s_waitcnt vmcnt(10) lgkmcnt(8)
v_mfma_f32_16x16x32_bf16 v[60:63], v[100:103], v[196:199], v[60:63]
ds_read_b64_tr_b16 v[236:237], v10 offset:28672
ds_read_b64_tr_b16 v[238:239], v10 offset:29184
v_mfma_f32_16x16x32_bf16 v[76:79], v[100:103], v[200:203], v[76:79]
buffer_load_dwordx4 v[180:183], v38, s[32:35], s57 offen offset:1024 sc1
v_mfma_f32_16x16x32_bf16 v[64:67], v[104:107], v[196:199], v[64:67]
ds_read_b64_tr_b16 v[240:241], v11 offset:28672
v_mfma_f32_16x16x32_bf16 v[80:83], v[104:107], v[200:203], v[80:83]
ds_read_b64_tr_b16 v[242:243], v11 offset:29184
v_mfma_f32_16x16x32_bf16 v[68:71], v[108:111], v[196:199], v[68:71]
ds_read_b64_tr_b16 v[244:245], v12 offset:28672
buffer_load_dwordx4 v[184:187], v39, s[32:35], s57 offen offset:1024 sc1
s_add_u32 s57, s57, 2048
s_and_b32 s57, s57, 0x7fff
v_mfma_f32_16x16x32_bf16 v[84:87], v[108:111], v[200:203], v[84:87]
ds_read_b64_tr_b16 v[246:247], v12 offset:29184
v_mfma_f32_16x16x32_bf16 v[72:75], v[112:115], v[196:199], v[72:75]
ds_read_b64_tr_b16 v[248:249], v13 offset:28672
v_mfma_f32_16x16x32_bf16 v[88:91], v[112:115], v[200:203], v[88:91]
ds_read_b64_tr_b16 v[250:251], v13 offset:29184
s_waitcnt vmcnt(10) lgkmcnt(8)
v_mfma_f32_16x16x32_bf16 v[60:63], v[220:223], v[204:207], v[60:63]
ds_read_b64_tr_b16 v[100:101], v10 offset:32768
ds_read_b64_tr_b16 v[102:103], v10 offset:33280
v_mfma_f32_16x16x32_bf16 v[76:79], v[220:223], v[208:211], v[76:79]
buffer_load_dwordx4 v[188:191], v38, s[32:35], s57 offen sc1
v_mfma_f32_16x16x32_bf16 v[64:67], v[224:227], v[204:207], v[64:67]
ds_read_b64_tr_b16 v[104:105], v11 offset:32768
v_mfma_f32_16x16x32_bf16 v[80:83], v[224:227], v[208:211], v[80:83]
ds_read_b64_tr_b16 v[106:107], v11 offset:33280
v_mfma_f32_16x16x32_bf16 v[68:71], v[228:231], v[204:207], v[68:71]
ds_read_b64_tr_b16 v[108:109], v12 offset:32768
buffer_load_dwordx4 v[192:195], v39, s[32:35], s57 offen sc1
v_mfma_f32_16x16x32_bf16 v[84:87], v[228:231], v[208:211], v[84:87]
ds_read_b64_tr_b16 v[110:111], v12 offset:33280
v_mfma_f32_16x16x32_bf16 v[72:75], v[232:235], v[204:207], v[72:75]
ds_read_b64_tr_b16 v[112:113], v13 offset:32768
v_mfma_f32_16x16x32_bf16 v[88:91], v[232:235], v[208:211], v[88:91]
ds_read_b64_tr_b16 v[114:115], v13 offset:33280
s_waitcnt vmcnt(10) lgkmcnt(8)
v_mfma_f32_16x16x32_bf16 v[60:63], v[236:239], v[212:215], v[60:63]
ds_read_b64_tr_b16 v[220:221], v10 offset:36864
ds_read_b64_tr_b16 v[222:223], v10 offset:37376
v_mfma_f32_16x16x32_bf16 v[76:79], v[236:239], v[216:219], v[76:79]
buffer_load_dwordx4 v[196:199], v38, s[32:35], s57 offen offset:1024 sc1
v_mfma_f32_16x16x32_bf16 v[64:67], v[240:243], v[212:215], v[64:67]
ds_read_b64_tr_b16 v[224:225], v11 offset:36864
v_mfma_f32_16x16x32_bf16 v[80:83], v[240:243], v[216:219], v[80:83]
ds_read_b64_tr_b16 v[226:227], v11 offset:37376
v_mfma_f32_16x16x32_bf16 v[68:71], v[244:247], v[212:215], v[68:71]
ds_read_b64_tr_b16 v[228:229], v12 offset:36864
buffer_load_dwordx4 v[200:203], v39, s[32:35], s57 offen offset:1024 sc1
s_add_u32 s57, s57, 2048
s_and_b32 s57, s57, 0x7fff
v_mfma_f32_16x16x32_bf16 v[84:87], v[244:247], v[216:219], v[84:87]
ds_read_b64_tr_b16 v[230:231], v12 offset:37376
v_mfma_f32_16x16x32_bf16 v[72:75], v[248:251], v[212:215], v[72:75]
ds_read_b64_tr_b16 v[232:233], v13 offset:36864
v_mfma_f32_16x16x32_bf16 v[88:91], v[248:251], v[216:219], v[88:91]
ds_read_b64_tr_b16 v[234:235], v13 offset:37376
s_waitcnt vmcnt(10) lgkmcnt(8)
v_mfma_f32_16x16x32_bf16 v[60:63], v[100:103], v[156:159], v[60:63]
ds_read_b64_tr_b16 v[236:237], v10 offset:40960
ds_read_b64_tr_b16 v[238:239], v10 offset:41472
v_mfma_f32_16x16x32_bf16 v[76:79], v[100:103], v[160:163], v[76:79]
buffer_load_dwordx4 v[204:207], v38, s[32:35], s57 offen sc1
v_mfma_f32_16x16x32_bf16 v[64:67], v[104:107], v[156:159], v[64:67]
ds_read_b64_tr_b16 v[240:241], v11 offset:40960
v_mfma_f32_16x16x32_bf16 v[80:83], v[104:107], v[160:163], v[80:83]
ds_read_b64_tr_b16 v[242:243], v11 offset:41472
v_mfma_f32_16x16x32_bf16 v[68:71], v[108:111], v[156:159], v[68:71]
ds_read_b64_tr_b16 v[244:245], v12 offset:40960
buffer_load_dwordx4 v[208:211], v39, s[32:35], s57 offen sc1
v_mfma_f32_16x16x32_bf16 v[84:87], v[108:111], v[160:163], v[84:87]
ds_read_b64_tr_b16 v[246:247], v12 offset:41472
v_mfma_f32_16x16x32_bf16 v[72:75], v[112:115], v[156:159], v[72:75]
ds_read_b64_tr_b16 v[248:249], v13 offset:40960
v_mfma_f32_16x16x32_bf16 v[88:91], v[112:115], v[160:163], v[88:91]
ds_read_b64_tr_b16 v[250:251], v13 offset:41472
s_waitcnt vmcnt(10) lgkmcnt(8)
v_mfma_f32_16x16x32_bf16 v[60:63], v[220:223], v[164:167], v[60:63]
ds_read_b64_tr_b16 v[100:101], v10 offset:45056
ds_read_b64_tr_b16 v[102:103], v10 offset:45568
v_mfma_f32_16x16x32_bf16 v[76:79], v[220:223], v[168:171], v[76:79]
buffer_load_dwordx4 v[212:215], v38, s[32:35], s57 offen offset:1024 sc1
v_mfma_f32_16x16x32_bf16 v[64:67], v[224:227], v[164:167], v[64:67]
ds_read_b64_tr_b16 v[104:105], v11 offset:45056
v_mfma_f32_16x16x32_bf16 v[80:83], v[224:227], v[168:171], v[80:83]
ds_read_b64_tr_b16 v[106:107], v11 offset:45568
v_mfma_f32_16x16x32_bf16 v[68:71], v[228:231], v[164:167], v[68:71]
ds_read_b64_tr_b16 v[108:109], v12 offset:45056
buffer_load_dwordx4 v[216:219], v39, s[32:35], s57 offen offset:1024 sc1
s_add_u32 s57, s57, 2048
s_and_b32 s57, s57, 0x7fff
v_mfma_f32_16x16x32_bf16 v[84:87], v[228:231], v[168:171], v[84:87]
ds_read_b64_tr_b16 v[110:111], v12 offset:45568
v_mfma_f32_16x16x32_bf16 v[72:75], v[232:235], v[164:167], v[72:75]
ds_read_b64_tr_b16 v[112:113], v13 offset:45056
v_mfma_f32_16x16x32_bf16 v[88:91], v[232:235], v[168:171], v[88:91]
ds_read_b64_tr_b16 v[114:115], v13 offset:45568
s_waitcnt vmcnt(10) lgkmcnt(8)
v_mfma_f32_16x16x32_bf16 v[60:63], v[236:239], v[172:175], v[60:63]
ds_read_b64_tr_b16 v[220:221], v10 offset:49152
ds_read_b64_tr_b16 v[222:223], v10 offset:49664
v_mfma_f32_16x16x32_bf16 v[76:79], v[236:239], v[176:179], v[76:79]
buffer_load_dwordx4 v[156:159], v38, s[32:35], s57 offen sc1
v_mfma_f32_16x16x32_bf16 v[64:67], v[240:243], v[172:175], v[64:67]
ds_read_b64_tr_b16 v[224:225], v11 offset:49152
v_mfma_f32_16x16x32_bf16 v[80:83], v[240:243], v[176:179], v[80:83]
ds_read_b64_tr_b16 v[226:227], v11 offset:49664
v_mfma_f32_16x16x32_bf16 v[68:71], v[244:247], v[172:175], v[68:71]
ds_read_b64_tr_b16 v[228:229], v12 offset:49152
buffer_load_dwordx4 v[160:163], v39, s[32:35], s57 offen sc1
v_mfma_f32_16x16x32_bf16 v[84:87], v[244:247], v[176:179], v[84:87]
ds_read_b64_tr_b16 v[230:231], v12 offset:49664
v_mfma_f32_16x16x32_bf16 v[72:75], v[248:251], v[172:175], v[72:75]
ds_read_b64_tr_b16 v[232:233], v13 offset:49152
v_mfma_f32_16x16x32_bf16 v[88:91], v[248:251], v[176:179], v[88:91]
ds_read_b64_tr_b16 v[234:235], v13 offset:49664
s_waitcnt vmcnt(10) lgkmcnt(8)
v_mfma_f32_16x16x32_bf16 v[60:63], v[100:103], v[180:183], v[60:63]
ds_read_b64_tr_b16 v[236:237], v10 offset:53248
ds_read_b64_tr_b16 v[238:239], v10 offset:53760
v_mfma_f32_16x16x32_bf16 v[76:79], v[100:103], v[184:187], v[76:79]
buffer_load_dwordx4 v[164:167], v38, s[32:35], s57 offen offset:1024 sc1
v_mfma_f32_16x16x32_bf16 v[64:67], v[104:107], v[180:183], v[64:67]
ds_read_b64_tr_b16 v[240:241], v11 offset:53248
v_mfma_f32_16x16x32_bf16 v[80:83], v[104:107], v[184:187], v[80:83]
ds_read_b64_tr_b16 v[242:243], v11 offset:53760
v_mfma_f32_16x16x32_bf16 v[68:71], v[108:111], v[180:183], v[68:71]
ds_read_b64_tr_b16 v[244:245], v12 offset:53248
buffer_load_dwordx4 v[168:171], v39, s[32:35], s57 offen offset:1024 sc1
s_add_u32 s57, s57, 2048
s_and_b32 s57, s57, 0x7fff
v_mfma_f32_16x16x32_bf16 v[84:87], v[108:111], v[184:187], v[84:87]
ds_read_b64_tr_b16 v[246:247], v12 offset:53760
v_mfma_f32_16x16x32_bf16 v[72:75], v[112:115], v[180:183], v[72:75]
ds_read_b64_tr_b16 v[248:249], v13 offset:53248
v_mfma_f32_16x16x32_bf16 v[88:91], v[112:115], v[184:187], v[88:91]
ds_read_b64_tr_b16 v[250:251], v13 offset:53760
s_waitcnt vmcnt(10) lgkmcnt(8)
v_mfma_f32_16x16x32_bf16 v[60:63], v[220:223], v[188:191], v[60:63]
ds_read_b64_tr_b16 v[100:101], v10 offset:57344
ds_read_b64_tr_b16 v[102:103], v10 offset:57856
v_mfma_f32_16x16x32_bf16 v[76:79], v[220:223], v[192:195], v[76:79]
buffer_load_dwordx4 v[172:175], v38, s[32:35], s57 offen sc1
v_mfma_f32_16x16x32_bf16 v[64:67], v[224:227], v[188:191], v[64:67]
ds_read_b64_tr_b16 v[104:105], v11 offset:57344
v_mfma_f32_16x16x32_bf16 v[80:83], v[224:227], v[192:195], v[80:83]
ds_read_b64_tr_b16 v[106:107], v11 offset:57856
v_mfma_f32_16x16x32_bf16 v[68:71], v[228:231], v[188:191], v[68:71]
ds_read_b64_tr_b16 v[108:109], v12 offset:57344
buffer_load_dwordx4 v[176:179], v39, s[32:35], s57 offen sc1
v_mfma_f32_16x16x32_bf16 v[84:87], v[228:231], v[192:195], v[84:87]
ds_read_b64_tr_b16 v[110:111], v12 offset:57856
v_mfma_f32_16x16x32_bf16 v[72:75], v[232:235], v[188:191], v[72:75]
ds_read_b64_tr_b16 v[112:113], v13 offset:57344
v_mfma_f32_16x16x32_bf16 v[88:91], v[232:235], v[192:195], v[88:91]
ds_read_b64_tr_b16 v[114:115], v13 offset:57856
s_waitcnt vmcnt(10) lgkmcnt(8)
v_mfma_f32_16x16x32_bf16 v[60:63], v[236:239], v[196:199], v[60:63]
ds_read_b64_tr_b16 v[220:221], v10 offset:61440
ds_read_b64_tr_b16 v[222:223], v10 offset:61952
v_mfma_f32_16x16x32_bf16 v[76:79], v[236:239], v[200:203], v[76:79]
buffer_load_dwordx4 v[180:183], v38, s[32:35], s57 offen offset:1024 sc1
v_mfma_f32_16x16x32_bf16 v[64:67], v[240:243], v[196:199], v[64:67]
ds_read_b64_tr_b16 v[224:225], v11 offset:61440
v_mfma_f32_16x16x32_bf16 v[80:83], v[240:243], v[200:203], v[80:83]
ds_read_b64_tr_b16 v[226:227], v11 offset:61952
v_mfma_f32_16x16x32_bf16 v[68:71], v[244:247], v[196:199], v[68:71]
ds_read_b64_tr_b16 v[228:229], v12 offset:61440
buffer_load_dwordx4 v[184:187], v39, s[32:35], s57 offen offset:1024 sc1
s_add_u32 s57, s57, 2048
s_and_b32 s57, s57, 0x7fff
v_mfma_f32_16x16x32_bf16 v[84:87], v[244:247], v[200:203], v[84:87]
ds_read_b64_tr_b16 v[230:231], v12 offset:61952
v_mfma_f32_16x16x32_bf16 v[72:75], v[248:251], v[196:199], v[72:75]
ds_read_b64_tr_b16 v[232:233], v13 offset:61440
v_mfma_f32_16x16x32_bf16 v[88:91], v[248:251], v[200:203], v[88:91]
ds_read_b64_tr_b16 v[234:235], v13 offset:61952
s_waitcnt vmcnt(10) lgkmcnt(8)
v_mfma_f32_16x16x32_bf16 v[60:63], v[100:103], v[204:207], v[60:63]
ds_read_b64_tr_b16 v[236:237], v14 offset:0
ds_read_b64_tr_b16 v[238:239], v14 offset:512
v_mfma_f32_16x16x32_bf16 v[76:79], v[100:103], v[208:211], v[76:79]
buffer_load_dwordx4 v[188:191], v38, s[32:35], s57 offen sc1
v_mfma_f32_16x16x32_bf16 v[64:67], v[104:107], v[204:207], v[64:67]
ds_read_b64_tr_b16 v[240:241], v15 offset:0
v_mfma_f32_16x16x32_bf16 v[80:83], v[104:107], v[208:211], v[80:83]
ds_read_b64_tr_b16 v[242:243], v15 offset:512
v_mfma_f32_16x16x32_bf16 v[68:71], v[108:111], v[204:207], v[68:71]
ds_read_b64_tr_b16 v[244:245], v16 offset:0
buffer_load_dwordx4 v[192:195], v39, s[32:35], s57 offen sc1
v_mfma_f32_16x16x32_bf16 v[84:87], v[108:111], v[208:211], v[84:87]
ds_read_b64_tr_b16 v[246:247], v16 offset:512
v_mfma_f32_16x16x32_bf16 v[72:75], v[112:115], v[204:207], v[72:75]
ds_read_b64_tr_b16 v[248:249], v17 offset:0
v_mfma_f32_16x16x32_bf16 v[88:91], v[112:115], v[208:211], v[88:91]
ds_read_b64_tr_b16 v[250:251], v17 offset:512
s_waitcnt vmcnt(10) lgkmcnt(8)
v_mfma_f32_16x16x32_bf16 v[60:63], v[220:223], v[212:215], v[60:63]
ds_read_b64_tr_b16 v[100:101], v14 offset:4096
ds_read_b64_tr_b16 v[102:103], v14 offset:4608
v_mfma_f32_16x16x32_bf16 v[76:79], v[220:223], v[216:219], v[76:79]
buffer_load_dwordx4 v[196:199], v38, s[32:35], s57 offen offset:1024 sc1
v_mfma_f32_16x16x32_bf16 v[64:67], v[224:227], v[212:215], v[64:67]
ds_read_b64_tr_b16 v[104:105], v15 offset:4096
v_mfma_f32_16x16x32_bf16 v[80:83], v[224:227], v[216:219], v[80:83]
ds_read_b64_tr_b16 v[106:107], v15 offset:4608
v_mfma_f32_16x16x32_bf16 v[68:71], v[228:231], v[212:215], v[68:71]
ds_read_b64_tr_b16 v[108:109], v16 offset:4096
buffer_load_dwordx4 v[200:203], v39, s[32:35], s57 offen offset:1024 sc1
s_add_u32 s57, s57, 2048
s_and_b32 s57, s57, 0x7fff
v_mfma_f32_16x16x32_bf16 v[84:87], v[228:231], v[216:219], v[84:87]
ds_read_b64_tr_b16 v[110:111], v16 offset:4608
v_mfma_f32_16x16x32_bf16 v[72:75], v[232:235], v[212:215], v[72:75]
ds_read_b64_tr_b16 v[112:113], v17 offset:4096
v_mfma_f32_16x16x32_bf16 v[88:91], v[232:235], v[216:219], v[88:91]
ds_read_b64_tr_b16 v[114:115], v17 offset:4608
s_waitcnt vmcnt(10) lgkmcnt(8)
v_mfma_f32_16x16x32_bf16 v[60:63], v[236:239], v[156:159], v[60:63]
ds_read_b64_tr_b16 v[220:221], v14 offset:8192
ds_read_b64_tr_b16 v[222:223], v14 offset:8704
v_mfma_f32_16x16x32_bf16 v[76:79], v[236:239], v[160:163], v[76:79]
buffer_load_dwordx4 v[204:207], v38, s[32:35], s57 offen sc1
v_mfma_f32_16x16x32_bf16 v[64:67], v[240:243], v[156:159], v[64:67]
ds_read_b64_tr_b16 v[224:225], v15 offset:8192
v_mfma_f32_16x16x32_bf16 v[80:83], v[240:243], v[160:163], v[80:83]
ds_read_b64_tr_b16 v[226:227], v15 offset:8704
v_mfma_f32_16x16x32_bf16 v[68:71], v[244:247], v[156:159], v[68:71]
ds_read_b64_tr_b16 v[228:229], v16 offset:8192
buffer_load_dwordx4 v[208:211], v39, s[32:35], s57 offen sc1
v_mfma_f32_16x16x32_bf16 v[84:87], v[244:247], v[160:163], v[84:87]
ds_read_b64_tr_b16 v[230:231], v16 offset:8704
v_mfma_f32_16x16x32_bf16 v[72:75], v[248:251], v[156:159], v[72:75]
ds_read_b64_tr_b16 v[232:233], v17 offset:8192
v_mfma_f32_16x16x32_bf16 v[88:91], v[248:251], v[160:163], v[88:91]
ds_read_b64_tr_b16 v[234:235], v17 offset:8704
s_waitcnt vmcnt(10) lgkmcnt(8)
v_mfma_f32_16x16x32_bf16 v[60:63], v[100:103], v[164:167], v[60:63]
ds_read_b64_tr_b16 v[236:237], v14 offset:12288
ds_read_b64_tr_b16 v[238:239], v14 offset:12800
v_mfma_f32_16x16x32_bf16 v[76:79], v[100:103], v[168:171], v[76:79]
buffer_load_dwordx4 v[212:215], v38, s[32:35], s57 offen offset:1024 sc1
v_mfma_f32_16x16x32_bf16 v[64:67], v[104:107], v[164:167], v[64:67]
ds_read_b64_tr_b16 v[240:241], v15 offset:12288
v_mfma_f32_16x16x32_bf16 v[80:83], v[104:107], v[168:171], v[80:83]
ds_read_b64_tr_b16 v[242:243], v15 offset:12800
v_mfma_f32_16x16x32_bf16 v[68:71], v[108:111], v[164:167], v[68:71]
ds_read_b64_tr_b16 v[244:245], v16 offset:12288
buffer_load_dwordx4 v[216:219], v39, s[32:35], s57 offen offset:1024 sc1
s_add_u32 s57, s57, 2048
s_and_b32 s57, s57, 0x7fff
v_mfma_f32_16x16x32_bf16 v[84:87], v[108:111], v[168:171], v[84:87]
ds_read_b64_tr_b16 v[246:247], v16 offset:12800
v_mfma_f32_16x16x32_bf16 v[72:75], v[112:115], v[164:167], v[72:75]
ds_read_b64_tr_b16 v[248:249], v17 offset:12288
v_mfma_f32_16x16x32_bf16 v[88:91], v[112:115], v[168:171], v[88:91]
ds_read_b64_tr_b16 v[250:251], v17 offset:12800
s_waitcnt vmcnt(10) lgkmcnt(8)
v_mfma_f32_16x16x32_bf16 v[60:63], v[220:223], v[172:175], v[60:63]
ds_read_b64_tr_b16 v[100:101], v14 offset:16384
ds_read_b64_tr_b16 v[102:103], v14 offset:16896
v_mfma_f32_16x16x32_bf16 v[76:79], v[220:223], v[176:179], v[76:79]
buffer_load_dwordx4 v[156:159], v38, s[32:35], s57 offen sc1
v_mfma_f32_16x16x32_bf16 v[64:67], v[224:227], v[172:175], v[64:67]
ds_read_b64_tr_b16 v[104:105], v15 offset:16384
v_mfma_f32_16x16x32_bf16 v[80:83], v[224:227], v[176:179], v[80:83]
ds_read_b64_tr_b16 v[106:107], v15 offset:16896
v_mfma_f32_16x16x32_bf16 v[68:71], v[228:231], v[172:175], v[68:71]
ds_read_b64_tr_b16 v[108:109], v16 offset:16384
buffer_load_dwordx4 v[160:163], v39, s[32:35], s57 offen sc1
v_mfma_f32_16x16x32_bf16 v[84:87], v[228:231], v[176:179], v[84:87]
ds_read_b64_tr_b16 v[110:111], v16 offset:16896
v_mfma_f32_16x16x32_bf16 v[72:75], v[232:235], v[172:175], v[72:75]
ds_read_b64_tr_b16 v[112:113], v17 offset:16384
v_mfma_f32_16x16x32_bf16 v[88:91], v[232:235], v[176:179], v[88:91]
ds_read_b64_tr_b16 v[114:115], v17 offset:16896
s_waitcnt vmcnt(10) lgkmcnt(8)
v_mfma_f32_16x16x32_bf16 v[60:63], v[236:239], v[180:183], v[60:63]
ds_read_b64_tr_b16 v[220:221], v14 offset:20480
ds_read_b64_tr_b16 v[222:223], v14 offset:20992
v_mfma_f32_16x16x32_bf16 v[76:79], v[236:239], v[184:187], v[76:79]
buffer_load_dwordx4 v[164:167], v38, s[32:35], s57 offen offset:1024 sc1
v_mfma_f32_16x16x32_bf16 v[64:67], v[240:243], v[180:183], v[64:67]
ds_read_b64_tr_b16 v[224:225], v15 offset:20480
v_mfma_f32_16x16x32_bf16 v[80:83], v[240:243], v[184:187], v[80:83]
ds_read_b64_tr_b16 v[226:227], v15 offset:20992
v_mfma_f32_16x16x32_bf16 v[68:71], v[244:247], v[180:183], v[68:71]
ds_read_b64_tr_b16 v[228:229], v16 offset:20480
buffer_load_dwordx4 v[168:171], v39, s[32:35], s57 offen offset:1024 sc1
s_add_u32 s57, s57, 2048
s_and_b32 s57, s57, 0x7fff
v_mfma_f32_16x16x32_bf16 v[84:87], v[244:247], v[184:187], v[84:87]
ds_read_b64_tr_b16 v[230:231], v16 offset:20992
v_mfma_f32_16x16x32_bf16 v[72:75], v[248:251], v[180:183], v[72:75]
ds_read_b64_tr_b16 v[232:233], v17 offset:20480
v_mfma_f32_16x16x32_bf16 v[88:91], v[248:251], v[184:187], v[88:91]
ds_read_b64_tr_b16 v[234:235], v17 offset:20992
s_waitcnt vmcnt(10) lgkmcnt(8)
v_mfma_f32_16x16x32_bf16 v[60:63], v[100:103], v[188:191], v[60:63]
ds_read_b64_tr_b16 v[236:237], v14 offset:24576
ds_read_b64_tr_b16 v[238:239], v14 offset:25088
v_mfma_f32_16x16x32_bf16 v[76:79], v[100:103], v[192:195], v[76:79]
buffer_load_dwordx4 v[172:175], v38, s[32:35], s57 offen sc1
v_mfma_f32_16x16x32_bf16 v[64:67], v[104:107], v[188:191], v[64:67]
ds_read_b64_tr_b16 v[240:241], v15 offset:24576
v_mfma_f32_16x16x32_bf16 v[80:83], v[104:107], v[192:195], v[80:83]
ds_read_b64_tr_b16 v[242:243], v15 offset:25088
v_mfma_f32_16x16x32_bf16 v[68:71], v[108:111], v[188:191], v[68:71]
ds_read_b64_tr_b16 v[244:245], v16 offset:24576
buffer_load_dwordx4 v[176:179], v39, s[32:35], s57 offen sc1
v_mfma_f32_16x16x32_bf16 v[84:87], v[108:111], v[192:195], v[84:87]
ds_read_b64_tr_b16 v[246:247], v16 offset:25088
v_mfma_f32_16x16x32_bf16 v[72:75], v[112:115], v[188:191], v[72:75]
ds_read_b64_tr_b16 v[248:249], v17 offset:24576
v_mfma_f32_16x16x32_bf16 v[88:91], v[112:115], v[192:195], v[88:91]
ds_read_b64_tr_b16 v[250:251], v17 offset:25088
s_waitcnt vmcnt(10) lgkmcnt(8)
v_mfma_f32_16x16x32_bf16 v[60:63], v[220:223], v[196:199], v[60:63]
ds_read_b64_tr_b16 v[100:101], v14 offset:28672
ds_read_b64_tr_b16 v[102:103], v14 offset:29184
v_mfma_f32_16x16x32_bf16 v[76:79], v[220:223], v[200:203], v[76:79]
buffer_load_dwordx4 v[180:183], v38, s[32:35], s57 offen offset:1024 sc1
v_mfma_f32_16x16x32_bf16 v[64:67], v[224:227], v[196:199], v[64:67]
ds_read_b64_tr_b16 v[104:105], v15 offset:28672
v_mfma_f32_16x16x32_bf16 v[80:83], v[224:227], v[200:203], v[80:83]
ds_read_b64_tr_b16 v[106:107], v15 offset:29184
v_mfma_f32_16x16x32_bf16 v[68:71], v[228:231], v[196:199], v[68:71]
ds_read_b64_tr_b16 v[108:109], v16 offset:28672
buffer_load_dwordx4 v[184:187], v39, s[32:35], s57 offen offset:1024 sc1
s_add_u32 s57, s57, 2048
s_and_b32 s57, s57, 0x7fff
v_mfma_f32_16x16x32_bf16 v[84:87], v[228:231], v[200:203], v[84:87]
ds_read_b64_tr_b16 v[110:111], v16 offset:29184
v_mfma_f32_16x16x32_bf16 v[72:75], v[232:235], v[196:199], v[72:75]
ds_read_b64_tr_b16 v[112:113], v17 offset:28672
v_mfma_f32_16x16x32_bf16 v[88:91], v[232:235], v[200:203], v[88:91]
ds_read_b64_tr_b16 v[114:115], v17 offset:29184
s_waitcnt vmcnt(10) lgkmcnt(8)
v_mfma_f32_16x16x32_bf16 v[60:63], v[236:239], v[204:207], v[60:63]
ds_read_b64_tr_b16 v[220:221], v14 offset:32768
ds_read_b64_tr_b16 v[222:223], v14 offset:33280
v_mfma_f32_16x16x32_bf16 v[76:79], v[236:239], v[208:211], v[76:79]
buffer_load_dwordx4 v[188:191], v38, s[32:35], s57 offen sc1
v_mfma_f32_16x16x32_bf16 v[64:67], v[240:243], v[204:207], v[64:67]
ds_read_b64_tr_b16 v[224:225], v15 offset:32768
v_mfma_f32_16x16x32_bf16 v[80:83], v[240:243], v[208:211], v[80:83]
ds_read_b64_tr_b16 v[226:227], v15 offset:33280
v_mfma_f32_16x16x32_bf16 v[68:71], v[244:247], v[204:207], v[68:71]
ds_read_b64_tr_b16 v[228:229], v16 offset:32768
buffer_load_dwordx4 v[192:195], v39, s[32:35], s57 offen sc1
v_mfma_f32_16x16x32_bf16 v[84:87], v[244:247], v[208:211], v[84:87]
ds_read_b64_tr_b16 v[230:231], v16 offset:33280
v_mfma_f32_16x16x32_bf16 v[72:75], v[248:251], v[204:207], v[72:75]
ds_read_b64_tr_b16 v[232:233], v17 offset:32768
v_mfma_f32_16x16x32_bf16 v[88:91], v[248:251], v[208:211], v[88:91]
ds_read_b64_tr_b16 v[234:235], v17 offset:33280
s_waitcnt vmcnt(10) lgkmcnt(8)
v_mfma_f32_16x16x32_bf16 v[60:63], v[100:103], v[212:215], v[60:63]
ds_read_b64_tr_b16 v[236:237], v14 offset:36864
ds_read_b64_tr_b16 v[238:239], v14 offset:37376
v_mfma_f32_16x16x32_bf16 v[76:79], v[100:103], v[216:219], v[76:79]
buffer_load_dwordx4 v[196:199], v38, s[32:35], s57 offen offset:1024 sc1
v_mfma_f32_16x16x32_bf16 v[64:67], v[104:107], v[212:215], v[64:67]
ds_read_b64_tr_b16 v[240:241], v15 offset:36864
v_mfma_f32_16x16x32_bf16 v[80:83], v[104:107], v[216:219], v[80:83]
ds_read_b64_tr_b16 v[242:243], v15 offset:37376
v_mfma_f32_16x16x32_bf16 v[68:71], v[108:111], v[212:215], v[68:71]
ds_read_b64_tr_b16 v[244:245], v16 offset:36864
buffer_load_dwordx4 v[200:203], v39, s[32:35], s57 offen offset:1024 sc1
s_add_u32 s57, s57, 2048
s_and_b32 s57, s57, 0x7fff
v_mfma_f32_16x16x32_bf16 v[84:87], v[108:111], v[216:219], v[84:87]
ds_read_b64_tr_b16 v[246:247], v16 offset:37376
v_mfma_f32_16x16x32_bf16 v[72:75], v[112:115], v[212:215], v[72:75]
ds_read_b64_tr_b16 v[248:249], v17 offset:36864
v_mfma_f32_16x16x32_bf16 v[88:91], v[112:115], v[216:219], v[88:91]
ds_read_b64_tr_b16 v[250:251], v17 offset:37376
s_waitcnt vmcnt(10) lgkmcnt(8)
v_mfma_f32_16x16x32_bf16 v[60:63], v[220:223], v[156:159], v[60:63]
ds_read_b64_tr_b16 v[100:101], v14 offset:40960
ds_read_b64_tr_b16 v[102:103], v14 offset:41472
v_mfma_f32_16x16x32_bf16 v[76:79], v[220:223], v[160:163], v[76:79]
buffer_load_dwordx4 v[204:207], v38, s[32:35], s57 offen sc1
v_mfma_f32_16x16x32_bf16 v[64:67], v[224:227], v[156:159], v[64:67]
ds_read_b64_tr_b16 v[104:105], v15 offset:40960
v_mfma_f32_16x16x32_bf16 v[80:83], v[224:227], v[160:163], v[80:83]
ds_read_b64_tr_b16 v[106:107], v15 offset:41472
v_mfma_f32_16x16x32_bf16 v[68:71], v[228:231], v[156:159], v[68:71]
ds_read_b64_tr_b16 v[108:109], v16 offset:40960
buffer_load_dwordx4 v[208:211], v39, s[32:35], s57 offen sc1
v_mfma_f32_16x16x32_bf16 v[84:87], v[228:231], v[160:163], v[84:87]
ds_read_b64_tr_b16 v[110:111], v16 offset:41472
v_mfma_f32_16x16x32_bf16 v[72:75], v[232:235], v[156:159], v[72:75]
ds_read_b64_tr_b16 v[112:113], v17 offset:40960
v_mfma_f32_16x16x32_bf16 v[88:91], v[232:235], v[160:163], v[88:91]
ds_read_b64_tr_b16 v[114:115], v17 offset:41472
s_waitcnt vmcnt(10) lgkmcnt(8)
v_mfma_f32_16x16x32_bf16 v[60:63], v[236:239], v[164:167], v[60:63]
ds_read_b64_tr_b16 v[220:221], v14 offset:45056
ds_read_b64_tr_b16 v[222:223], v14 offset:45568
v_mfma_f32_16x16x32_bf16 v[76:79], v[236:239], v[168:171], v[76:79]
buffer_load_dwordx4 v[212:215], v38, s[32:35], s57 offen offset:1024 sc1
v_mfma_f32_16x16x32_bf16 v[64:67], v[240:243], v[164:167], v[64:67]
ds_read_b64_tr_b16 v[224:225], v15 offset:45056
v_mfma_f32_16x16x32_bf16 v[80:83], v[240:243], v[168:171], v[80:83]
ds_read_b64_tr_b16 v[226:227], v15 offset:45568
v_mfma_f32_16x16x32_bf16 v[68:71], v[244:247], v[164:167], v[68:71]
ds_read_b64_tr_b16 v[228:229], v16 offset:45056
buffer_load_dwordx4 v[216:219], v39, s[32:35], s57 offen offset:1024 sc1
s_add_u32 s57, s57, 2048
s_and_b32 s57, s57, 0x7fff
v_mfma_f32_16x16x32_bf16 v[84:87], v[244:247], v[168:171], v[84:87]
ds_read_b64_tr_b16 v[230:231], v16 offset:45568
v_mfma_f32_16x16x32_bf16 v[72:75], v[248:251], v[164:167], v[72:75]
ds_read_b64_tr_b16 v[232:233], v17 offset:45056
v_mfma_f32_16x16x32_bf16 v[88:91], v[248:251], v[168:171], v[88:91]
ds_read_b64_tr_b16 v[234:235], v17 offset:45568
s_waitcnt vmcnt(10) lgkmcnt(8)
v_mfma_f32_16x16x32_bf16 v[60:63], v[100:103], v[172:175], v[60:63]
ds_read_b64_tr_b16 v[236:237], v14 offset:49152
v_mfma_f32_16x16x32_bf16 v[76:79], v[100:103], v[176:179], v[76:79]
ds_read_b64_tr_b16 v[238:239], v14 offset:49664
v_mfma_f32_16x16x32_bf16 v[64:67], v[104:107], v[172:175], v[64:67]
ds_read_b64_tr_b16 v[240:241], v15 offset:49152
v_mfma_f32_16x16x32_bf16 v[80:83], v[104:107], v[176:179], v[80:83]
ds_read_b64_tr_b16 v[242:243], v15 offset:49664
v_mfma_f32_16x16x32_bf16 v[68:71], v[108:111], v[172:175], v[68:71]
ds_read_b64_tr_b16 v[244:245], v16 offset:49152
v_mfma_f32_16x16x32_bf16 v[84:87], v[108:111], v[176:179], v[84:87]
ds_read_b64_tr_b16 v[246:247], v16 offset:49664
v_mfma_f32_16x16x32_bf16 v[72:75], v[112:115], v[172:175], v[72:75]
ds_read_b64_tr_b16 v[248:249], v17 offset:49152
v_mfma_f32_16x16x32_bf16 v[88:91], v[112:115], v[176:179], v[88:91]
ds_read_b64_tr_b16 v[250:251], v17 offset:49664
s_waitcnt vmcnt(8) lgkmcnt(8)
v_mfma_f32_16x16x32_bf16 v[60:63], v[220:223], v[180:183], v[60:63]
ds_read_b64_tr_b16 v[100:101], v14 offset:53248
v_mfma_f32_16x16x32_bf16 v[76:79], v[220:223], v[184:187], v[76:79]
ds_read_b64_tr_b16 v[102:103], v14 offset:53760
v_mfma_f32_16x16x32_bf16 v[64:67], v[224:227], v[180:183], v[64:67]
ds_read_b64_tr_b16 v[104:105], v15 offset:53248
v_mfma_f32_16x16x32_bf16 v[80:83], v[224:227], v[184:187], v[80:83]
ds_read_b64_tr_b16 v[106:107], v15 offset:53760
v_mfma_f32_16x16x32_bf16 v[68:71], v[228:231], v[180:183], v[68:71]
ds_read_b64_tr_b16 v[108:109], v16 offset:53248
v_mfma_f32_16x16x32_bf16 v[84:87], v[228:231], v[184:187], v[84:87]
ds_read_b64_tr_b16 v[110:111], v16 offset:53760
v_mfma_f32_16x16x32_bf16 v[72:75], v[232:235], v[180:183], v[72:75]
ds_read_b64_tr_b16 v[112:113], v17 offset:53248
v_mfma_f32_16x16x32_bf16 v[88:91], v[232:235], v[184:187], v[88:91]
ds_read_b64_tr_b16 v[114:115], v17 offset:53760
s_waitcnt vmcnt(6) lgkmcnt(8)
v_mfma_f32_16x16x32_bf16 v[60:63], v[236:239], v[188:191], v[60:63]
ds_read_b64_tr_b16 v[220:221], v14 offset:57344
v_mfma_f32_16x16x32_bf16 v[76:79], v[236:239], v[192:195], v[76:79]
ds_read_b64_tr_b16 v[222:223], v14 offset:57856
v_mfma_f32_16x16x32_bf16 v[64:67], v[240:243], v[188:191], v[64:67]
ds_read_b64_tr_b16 v[224:225], v15 offset:57344
v_mfma_f32_16x16x32_bf16 v[80:83], v[240:243], v[192:195], v[80:83]
ds_read_b64_tr_b16 v[226:227], v15 offset:57856
v_mfma_f32_16x16x32_bf16 v[68:71], v[244:247], v[188:191], v[68:71]
ds_read_b64_tr_b16 v[228:229], v16 offset:57344
v_mfma_f32_16x16x32_bf16 v[84:87], v[244:247], v[192:195], v[84:87]
ds_read_b64_tr_b16 v[230:231], v16 offset:57856
v_mfma_f32_16x16x32_bf16 v[72:75], v[248:251], v[188:191], v[72:75]
ds_read_b64_tr_b16 v[232:233], v17 offset:57344
v_mfma_f32_16x16x32_bf16 v[88:91], v[248:251], v[192:195], v[88:91]
ds_read_b64_tr_b16 v[234:235], v17 offset:57856
s_waitcnt vmcnt(4) lgkmcnt(8)
v_mfma_f32_16x16x32_bf16 v[60:63], v[100:103], v[196:199], v[60:63]
ds_read_b64_tr_b16 v[236:237], v14 offset:61440
v_mfma_f32_16x16x32_bf16 v[76:79], v[100:103], v[200:203], v[76:79]
ds_read_b64_tr_b16 v[238:239], v14 offset:61952
v_mfma_f32_16x16x32_bf16 v[64:67], v[104:107], v[196:199], v[64:67]
ds_read_b64_tr_b16 v[240:241], v15 offset:61440
v_mfma_f32_16x16x32_bf16 v[80:83], v[104:107], v[200:203], v[80:83]
ds_read_b64_tr_b16 v[242:243], v15 offset:61952
v_mfma_f32_16x16x32_bf16 v[68:71], v[108:111], v[196:199], v[68:71]
ds_read_b64_tr_b16 v[244:245], v16 offset:61440
v_mfma_f32_16x16x32_bf16 v[84:87], v[108:111], v[200:203], v[84:87]
ds_read_b64_tr_b16 v[246:247], v16 offset:61952
v_mfma_f32_16x16x32_bf16 v[72:75], v[112:115], v[196:199], v[72:75]
ds_read_b64_tr_b16 v[248:249], v17 offset:61440
v_mfma_f32_16x16x32_bf16 v[88:91], v[112:115], v[200:203], v[88:91]
ds_read_b64_tr_b16 v[250:251], v17 offset:61952
s_waitcnt vmcnt(2) lgkmcnt(8)
v_mfma_f32_16x16x32_bf16 v[60:63], v[220:223], v[204:207], v[60:63]
v_mfma_f32_16x16x32_bf16 v[76:79], v[220:223], v[208:211], v[76:79]
v_mfma_f32_16x16x32_bf16 v[64:67], v[224:227], v[204:207], v[64:67]
v_mfma_f32_16x16x32_bf16 v[80:83], v[224:227], v[208:211], v[80:83]
v_mfma_f32_16x16x32_bf16 v[68:71], v[228:231], v[204:207], v[68:71]
v_mfma_f32_16x16x32_bf16 v[84:87], v[228:231], v[208:211], v[84:87]
v_mfma_f32_16x16x32_bf16 v[72:75], v[232:235], v[204:207], v[72:75]
v_mfma_f32_16x16x32_bf16 v[88:91], v[232:235], v[208:211], v[88:91]
s_waitcnt vmcnt(0) lgkmcnt(0)
v_mfma_f32_16x16x32_bf16 v[60:63], v[236:239], v[212:215], v[60:63]
v_mfma_f32_16x16x32_bf16 v[64:67], v[240:243], v[212:215], v[64:67]
v_mfma_f32_16x16x32_bf16 v[68:71], v[244:247], v[212:215], v[68:71]
v_mfma_f32_16x16x32_bf16 v[72:75], v[248:251], v[212:215], v[72:75]
v_mfma_f32_16x16x32_bf16 v[76:79], v[236:239], v[216:219], v[76:79]
v_mfma_f32_16x16x32_bf16 v[80:83], v[240:243], v[216:219], v[80:83]
v_mfma_f32_16x16x32_bf16 v[84:87], v[244:247], v[216:219], v[84:87]
v_mfma_f32_16x16x32_bf16 v[88:91], v[248:251], v[216:219], v[88:91]
s_cmp_eq_u32 s46, 0
s_cbranch_scc1 slow_74
s_nop 0
v_cvt_pk_bf16_f32 v20, v60, v61
v_cvt_pk_bf16_f32 v21, v62, v63
v_cvt_pk_bf16_f32 v22, v64, v65
v_cvt_pk_bf16_f32 v23, v66, v67
buffer_store_dwordx4 v[20:23], v18, s[32:35], s85 offen offset:0
v_cvt_pk_bf16_f32 v24, v68, v69
v_cvt_pk_bf16_f32 v25, v70, v71
v_cvt_pk_bf16_f32 v26, v72, v73
v_cvt_pk_bf16_f32 v27, v74, v75
buffer_store_dwordx4 v[24:27], v18, s[32:35], s85 offen offset:1024
v_cvt_pk_bf16_f32 v28, v76, v77
v_cvt_pk_bf16_f32 v29, v78, v79
v_cvt_pk_bf16_f32 v30, v80, v81
v_cvt_pk_bf16_f32 v31, v82, v83
buffer_store_dwordx4 v[28:31], v18, s[32:35], s86 offen offset:0
v_cvt_pk_bf16_f32 v32, v84, v85
v_cvt_pk_bf16_f32 v33, v86, v87
v_cvt_pk_bf16_f32 v34, v88, v89
v_cvt_pk_bf16_f32 v35, v90, v91
buffer_store_dwordx4 v[32:35], v18, s[32:35], s86 offen offset:1024
s_barrier
v_dot2c_f32_bf16 v6, v20, v48
v_dot2c_f32_bf16 v8, v20, v20
v_dot2c_f32_bf16 v7, v28, v48
v_dot2c_f32_bf16 v9, v28, v28
v_dot2c_f32_bf16 v6, v21, v48
v_dot2c_f32_bf16 v8, v21, v21
v_dot2c_f32_bf16 v7, v29, v48
v_dot2c_f32_bf16 v9, v29, v29
v_dot2c_f32_bf16 v6, v22, v48
v_dot2c_f32_bf16 v8, v22, v22
v_dot2c_f32_bf16 v7, v30, v48
v_dot2c_f32_bf16 v9, v30, v30
v_dot2c_f32_bf16 v6, v23, v48
v_dot2c_f32_bf16 v8, v23, v23
v_dot2c_f32_bf16 v7, v31, v48
v_dot2c_f32_bf16 v9, v31, v31
v_dot2c_f32_bf16 v6, v24, v48
v_dot2c_f32_bf16 v8, v24, v24
v_dot2c_f32_bf16 v7, v32, v48
v_dot2c_f32_bf16 v9, v32, v32
v_dot2c_f32_bf16 v6, v25, v48
v_dot2c_f32_bf16 v8, v25, v25
v_dot2c_f32_bf16 v7, v33, v48
v_dot2c_f32_bf16 v9, v33, v33
v_dot2c_f32_bf16 v6, v26, v48
v_dot2c_f32_bf16 v8, v26, v26
v_dot2c_f32_bf16 v7, v34, v48
v_dot2c_f32_bf16 v9, v34, v34
v_dot2c_f32_bf16 v6, v27, v48
v_dot2c_f32_bf16 v8, v27, v27
v_dot2c_f32_bf16 v7, v35, v48
v_dot2c_f32_bf16 v9, v35, v35
s_mov_b64 exec, 1
s_waitcnt vmcnt(0)
buffer_store_dword v5, v4, s[32:35], s88 offen
s_mov_b64 exec, -1
s_nop 1
v_permlane32_swap_b32 v6, v7
v_permlane32_swap_b32 v8, v9
v_add_f32 v6, v6, v7
v_add_f32 v8, v8, v9
s_nop 1
v_permlane16_swap_b32 v6, v8
s_nop 0
v_add_f32 v6, v6, v8
buffer_store_dword v6, v1, s[32:35], s87 offen
back_75:
s_lshl_b32 s49, s44, 13
v_add_u32 v10, s49, v18
v_add_u32 v11, 1024, v10
s_lshl_b32 s48, s43, 1
v_lshrrev_b32 v4, 2, v2
v_and_b32 v5, 3, v0
v_lshl_add_u32 v6, v3, 3, v4
v_lshlrev_b32 v6, 7, v6
v_lshl_add_u32 v6, v5, 3, v6
v_lshrrev_b32 v7, 1, v4
v_and_b32 v8, 1, v3
v_lshl_add_u32 v7, v8, 1, v7
v_xor_b32 v7, s48, v7
v_lshl_add_u32 v12, v7, 5, v6
v_add_u32 v12, 16384, v12
v_xor_b32 v13, 32, v12
v_mov_b32 v14, v10
v_mov_b32 v15, v11
v_add_u32 v16, 122880, v12
v_add_u32 v17, 122880, v13
v_mov_b32 v156, 0
v_mov_b32 v157, 0
v_mov_b32 v158, 0
v_mov_b32 v159, 0
v_mov_b32 v160, 0
v_mov_b32 v161, 0
v_mov_b32 v162, 0
v_mov_b32 v163, 0
v_mov_b32 v164, 0
v_mov_b32 v165, 0
v_mov_b32 v166, 0
v_mov_b32 v167, 0
v_mov_b32 v168, 0
v_mov_b32 v169, 0
v_mov_b32 v170, 0
v_mov_b32 v171, 0
v_mov_b32 v172, 0
v_mov_b32 v173, 0
v_mov_b32 v174, 0
v_mov_b32 v175, 0
v_mov_b32 v176, 0
v_mov_b32 v177, 0
v_mov_b32 v178, 0
v_mov_b32 v179, 0
v_mov_b32 v180, 0
v_mov_b32 v181, 0
v_mov_b32 v182, 0
v_mov_b32 v183, 0
v_mov_b32 v184, 0
v_mov_b32 v185, 0
v_mov_b32 v186, 0
v_mov_b32 v187, 0
v_mov_b32 v188, 0
v_mov_b32 v189, 0
v_mov_b32 v190, 0
v_mov_b32 v191, 0
v_mov_b32 v192, 0
v_mov_b32 v193, 0
v_mov_b32 v194, 0
v_mov_b32 v195, 0
v_mov_b32 v196, 0
v_mov_b32 v197, 0
v_mov_b32 v198, 0
v_mov_b32 v199, 0
v_mov_b32 v200, 0
v_mov_b32 v201, 0
v_mov_b32 v202, 0
v_mov_b32 v203, 0
v_mov_b32 v204, 0
v_mov_b32 v205, 0
v_mov_b32 v206, 0
v_mov_b32 v207, 0
v_mov_b32 v208, 0
v_mov_b32 v209, 0
v_mov_b32 v210, 0
v_mov_b32 v211, 0
v_mov_b32 v212, 0
v_mov_b32 v213, 0
v_mov_b32 v214, 0
v_mov_b32 v215, 0
v_mov_b32 v216, 0
v_mov_b32 v217, 0
v_mov_b32 v218, 0
v_mov_b32 v219, 0
v_mov_b32 v220, 0
v_mov_b32 v221, 0
v_mov_b32 v222, 0
v_mov_b32 v223, 0
v_mov_b32 v224, 0
v_mov_b32 v225, 0
v_mov_b32 v226, 0
v_mov_b32 v227, 0
v_mov_b32 v228, 0
v_mov_b32 v229, 0
v_mov_b32 v230, 0
v_mov_b32 v231, 0
v_mov_b32 v232, 0
v_mov_b32 v233, 0
v_mov_b32 v234, 0
v_mov_b32 v235, 0
v_mov_b32 v236, 0
v_mov_b32 v237, 0
v_mov_b32 v238, 0
v_mov_b32 v239, 0
v_mov_b32 v240, 0
v_mov_b32 v241, 0
v_mov_b32 v242, 0
v_mov_b32 v243, 0
v_mov_b32 v244, 0
v_mov_b32 v245, 0
v_mov_b32 v246, 0
v_mov_b32 v247, 0
v_mov_b32 v248, 0
v_mov_b32 v249, 0
v_mov_b32 v250, 0
v_mov_b32 v251, 0
s_mov_b32 s48, 0xf149f2ca
v_mov_b32 v9, s48
v_lshlrev_b32 v4, 2, v3
v_sub_u32 v4, v2, v4
v_subrev_u32 v5, 0, v4
v_and_b32 v6, 0x80000001, v5
v_cmp_eq_u32 vcc, 0, v6
v_add_u32 v5, 1, v5
v_and_b32 v6, 0x80000001, v5
v_cndmask_b32 v40, v9, 0, vcc
v_cmp_eq_u32 vcc, 0x80000001, v6
s_nop 1
v_cndmask_b32 v36, v9, 0, vcc
v_subrev_u32 v5, 1, v4
v_and_b32 v6, 0x80000001, v5
v_cmp_eq_u32 vcc, 0, v6
v_add_u32 v5, 1, v5
v_and_b32 v6, 0x80000001, v5
v_cndmask_b32 v41, v9, 0, vcc
v_cmp_eq_u32 vcc, 0x80000001, v6
s_nop 1
v_cndmask_b32 v37, v9, 0, vcc
v_subrev_u32 v5, 2, v4
v_and_b32 v6, 0x80000001, v5
v_cmp_eq_u32 vcc, 0, v6
v_add_u32 v5, 1, v5
v_and_b32 v6, 0x80000001, v5
v_cndmask_b32 v42, v9, 0, vcc
v_cmp_eq_u32 vcc, 0x80000001, v6
s_nop 1
v_cndmask_b32 v38, v9, 0, vcc
v_subrev_u32 v5, 3, v4
v_and_b32 v6, 0x80000001, v5
v_cmp_eq_u32 vcc, 0, v6
v_add_u32 v5, 1, v5
v_and_b32 v6, 0x80000001, v5
v_cndmask_b32 v43, v9, 0, vcc
v_cmp_eq_u32 vcc, 0x80000001, v6
s_nop 1
v_cndmask_b32 v39, v9, 0, vcc
s_or_b32 s48, s41, s44
s_cmp_eq_u32 s48, 0
s_cselect_b64 vcc, -1, 0
v_cndmask_b32 v44, v36, v9, vcc
v_cndmask_b32 v45, v37, v9, vcc
v_cndmask_b32 v46, v38, v9, vcc
v_cndmask_b32 v47, v39, v9, vcc
v_and_b32 v4, 1, v2
v_lshlrev_b32 v4, 4, v4
v_mov_b32 v5, 0xffff
v_lshlrev_b32 v52, v4, v5
s_lshl_b32 s48, s43, 11
s_add_u32 s48, s48, 135168
v_add_u32 v53, s48, v18
v_lshl_add_u32 v55, v0, 3, s48
s_add_u32 s48, s41, s44
s_sub_u32 s48, s48, 1
s_lshl_b32 s49, s48, 5
s_add_u32 s49, s49, s45
s_lshl_b32 s49, s49, 11
s_add_u32 s49, s49, 9437184
s_cmp_lt_i32 s48, 0
s_cselect_b32 s49, 0xf0000000, s49
v_add_u32 v58, s49, v18
v_lshl_add_u32 v59, v0, 3, s49
s_lshl_b32 s48, s43, 2
s_add_u32 s48, s48, 134672
v_mov_b32 v19, s48
s_lshl_b32 s48, s43, 7
s_add_u32 s48, s48, 133120
v_lshl_add_u32 v7, v3, 4, s48
v_lshl_add_u32 v54, v2, 2, s48
s_lshl_b32 s49, s44, 6
v_add_u32 v8, s49, v2
v_lshlrev_b32 v8, 3, v8
v_add_u32 v8, 131072, v8
v_lshl_add_u32 v9, v3, 2, s49
v_lshlrev_b32 v9, 2, v9
v_add_u32 v9, 132096, v9
s_mov_b32 s64, 0
s_mov_b32 s65, 0
s_mov_b32 s66, 0x3e8293ee
s_waitcnt vmcnt(0)
s_cmp_eq_u32 s46, 0
s_cbranch_scc1 slow_76
s_lshl_b32 s62, s42, 2
v_mov_b32 v4, s62
v_mov_b32 v5, 2
s_mov_b64 exec, 1
buffer_store_dword v5, v4, s[32:35], s89 offen
s_mov_b64 exec, -1
back_77:
s_barrier
ds_read_b128 v[60:63], v14 offset:0
ds_read_b128 v[64:67], v14 offset:2048
ds_read_b128 v[68:71], v14 offset:4096
ds_read_b128 v[72:75], v14 offset:6144
ds_read_b64_tr_b16 v[84:85], v16 offset:8192
ds_read_b64_tr_b16 v[86:87], v16 offset:8704
ds_read_b64_tr_b16 v[88:89], v17 offset:8192
ds_read_b64_tr_b16 v[90:91], v17 offset:8704
ds_read_b64_tr_b16 v[92:93], v16 offset:16384
ds_read_b64_tr_b16 v[94:95], v16 offset:16896
ds_read_b64_tr_b16 v[96:97], v17 offset:16384
ds_read_b64_tr_b16 v[98:99], v17 offset:16896
ds_read_b64_tr_b16 v[76:77], v16 offset:0
ds_read_b64_tr_b16 v[78:79], v16 offset:512
ds_read_b64_tr_b16 v[80:81], v17 offset:0
ds_read_b64_tr_b16 v[82:83], v17 offset:512
s_waitcnt lgkmcnt(0)
c2_loop:
v_mfma_f32_16x16x32_bf16 v[212:215], v[84:87], v[72:75], v[212:215]
ds_read_b128 v[100:103], v15 offset:0
v_mfma_f32_16x16x32_bf16 v[204:207], v[84:87], v[68:71], v[204:207]
ds_read_b128 v[104:107], v15 offset:2048
v_mfma_f32_16x16x32_bf16 v[196:199], v[84:87], v[64:67], v[196:199]
ds_read_b128 v[108:111], v15 offset:4096
v_mfma_f32_16x16x32_bf16 v[188:191], v[84:87], v[60:63], v[188:191]
ds_read_b128 v[112:115], v15 offset:6144
v_mfma_f32_16x16x32_bf16 v[192:195], v[88:91], v[60:63], v[192:195]
ds_read_b64_tr_b16 v[124:125], v16 offset:12288
v_mfma_f32_16x16x32_bf16 v[200:203], v[88:91], v[64:67], v[200:203]
ds_read_b64_tr_b16 v[126:127], v16 offset:12800
v_mfma_f32_16x16x32_bf16 v[208:211], v[88:91], v[68:71], v[208:211]
ds_read_b64_tr_b16 v[128:129], v17 offset:12288
v_mfma_f32_16x16x32_bf16 v[216:219], v[88:91], v[72:75], v[216:219]
ds_read_b64_tr_b16 v[130:131], v17 offset:12800
v_mfma_f32_16x16x32_bf16 v[244:247], v[72:75], v[92:95], v[244:247]
ds_read_b64_tr_b16 v[132:133], v16 offset:20480
v_mfma_f32_16x16x32_bf16 v[236:239], v[68:71], v[92:95], v[236:239]
ds_read_b64_tr_b16 v[134:135], v16 offset:20992
v_mfma_f32_16x16x32_bf16 v[228:231], v[64:67], v[92:95], v[228:231]
ds_read_b64_tr_b16 v[136:137], v17 offset:20480
v_mfma_f32_16x16x32_bf16 v[220:223], v[60:63], v[92:95], v[220:223]
ds_read_b64_tr_b16 v[138:139], v17 offset:20992
v_mfma_f32_16x16x32_bf16 v[224:227], v[60:63], v[96:99], v[224:227]
ds_read_b64_tr_b16 v[116:117], v16 offset:4096
v_mfma_f32_16x16x32_bf16 v[232:235], v[64:67], v[96:99], v[232:235]
ds_read_b64_tr_b16 v[118:119], v16 offset:4608
v_mfma_f32_16x16x32_bf16 v[240:243], v[68:71], v[96:99], v[240:243]
ds_read_b64_tr_b16 v[120:121], v17 offset:4096
v_mfma_f32_16x16x32_bf16 v[248:251], v[72:75], v[96:99], v[248:251]
ds_read_b64_tr_b16 v[122:123], v17 offset:4608
v_mfma_f32_16x16x32_bf16 v[180:183], v[76:79], v[72:75], v[180:183]
s_add_u32 s65, s65, 40960
s_cmp_eq_u32 s65, 122880
v_mfma_f32_16x16x32_bf16 v[172:175], v[76:79], v[68:71], v[172:175]
s_cselect_b32 s65, 0, s65
s_add_u32 s64, s64, 1
v_mfma_f32_16x16x32_bf16 v[164:167], v[76:79], v[64:67], v[164:167]
v_add_u32 v14, s65, v10
v_add_u32 v15, s65, v11
v_mfma_f32_16x16x32_bf16 v[156:159], v[76:79], v[60:63], v[156:159]
v_add_u32 v16, s65, v12
v_add_u32 v17, s65, v13
v_mfma_f32_16x16x32_bf16 v[160:163], v[80:83], v[60:63], v[160:163]
v_mfma_f32_16x16x32_bf16 v[168:171], v[80:83], v[64:67], v[168:171]
s_cmp_eq_u32 s64, 16
s_cbranch_scc1 c2_last
v_mfma_f32_16x16x32_bf16 v[176:179], v[80:83], v[68:71], v[176:179]
s_waitcnt lgkmcnt(0)
v_mfma_f32_16x16x32_bf16 v[184:187], v[80:83], v[72:75], v[184:187]
s_barrier
v_mfma_f32_16x16x32_bf16 v[212:215], v[124:127], v[112:115], v[212:215]
ds_read_b128 v[60:63], v14 offset:0
v_mfma_f32_16x16x32_bf16 v[204:207], v[124:127], v[108:111], v[204:207]
ds_read_b128 v[64:67], v14 offset:2048
v_mfma_f32_16x16x32_bf16 v[196:199], v[124:127], v[104:107], v[196:199]
ds_read_b128 v[68:71], v14 offset:4096
v_mfma_f32_16x16x32_bf16 v[188:191], v[124:127], v[100:103], v[188:191]
ds_read_b128 v[72:75], v14 offset:6144
v_mfma_f32_16x16x32_bf16 v[192:195], v[128:131], v[100:103], v[192:195]
ds_read_b64_tr_b16 v[84:85], v16 offset:8192
v_mfma_f32_16x16x32_bf16 v[200:203], v[128:131], v[104:107], v[200:203]
ds_read_b64_tr_b16 v[86:87], v16 offset:8704
v_mfma_f32_16x16x32_bf16 v[208:211], v[128:131], v[108:111], v[208:211]
ds_read_b64_tr_b16 v[88:89], v17 offset:8192
v_mfma_f32_16x16x32_bf16 v[216:219], v[128:131], v[112:115], v[216:219]
ds_read_b64_tr_b16 v[90:91], v17 offset:8704
v_mfma_f32_16x16x32_bf16 v[244:247], v[112:115], v[132:135], v[244:247]
ds_read_b64_tr_b16 v[92:93], v16 offset:16384
v_mfma_f32_16x16x32_bf16 v[236:239], v[108:111], v[132:135], v[236:239]
ds_read_b64_tr_b16 v[94:95], v16 offset:16896
v_mfma_f32_16x16x32_bf16 v[228:231], v[104:107], v[132:135], v[228:231]
ds_read_b64_tr_b16 v[96:97], v17 offset:16384
v_mfma_f32_16x16x32_bf16 v[220:223], v[100:103], v[132:135], v[220:223]
ds_read_b64_tr_b16 v[98:99], v17 offset:16896
v_mfma_f32_16x16x32_bf16 v[224:227], v[100:103], v[136:139], v[224:227]
ds_read_b64_tr_b16 v[76:77], v16 offset:0
v_mfma_f32_16x16x32_bf16 v[232:235], v[104:107], v[136:139], v[232:235]
ds_read_b64_tr_b16 v[78:79], v16 offset:512
v_mfma_f32_16x16x32_bf16 v[240:243], v[108:111], v[136:139], v[240:243]
ds_read_b64_tr_b16 v[80:81], v17 offset:0
v_mfma_f32_16x16x32_bf16 v[248:251], v[112:115], v[136:139], v[248:251]
ds_read_b64_tr_b16 v[82:83], v17 offset:512
v_mfma_f32_16x16x32_bf16 v[180:183], v[116:119], v[112:115], v[180:183]
v_mfma_f32_16x16x32_bf16 v[172:175], v[116:119], v[108:111], v[172:175]
v_mfma_f32_16x16x32_bf16 v[164:167], v[116:119], v[104:107], v[164:167]
v_mfma_f32_16x16x32_bf16 v[156:159], v[116:119], v[100:103], v[156:159]
v_mfma_f32_16x16x32_bf16 v[160:163], v[120:123], v[100:103], v[160:163]
v_mfma_f32_16x16x32_bf16 v[168:171], v[120:123], v[104:107], v[168:171]
v_mfma_f32_16x16x32_bf16 v[176:179], v[120:123], v[108:111], v[176:179]
s_waitcnt lgkmcnt(0)
v_mfma_f32_16x16x32_bf16 v[184:187], v[120:123], v[112:115], v[184:187]
s_branch c2_loop
c2_last:
v_mfma_f32_16x16x32_bf16 v[176:179], v[80:83], v[68:71], v[176:179]
s_waitcnt lgkmcnt(0)
v_mfma_f32_16x16x32_bf16 v[184:187], v[80:83], v[72:75], v[184:187]
s_barrier
v_mfma_f32_16x16x32_bf16 v[212:215], v[124:127], v[112:115], v[212:215]
ds_read_b128 v[140:143], v7 offset:0
v_mfma_f32_16x16x32_bf16 v[204:207], v[124:127], v[108:111], v[204:207]
ds_read_b128 v[144:147], v7 offset:64
v_mfma_f32_16x16x32_bf16 v[196:199], v[124:127], v[104:107], v[196:199]
ds_read_b128 v[148:151], v7 offset:256
v_mfma_f32_16x16x32_bf16 v[188:191], v[124:127], v[100:103], v[188:191]
ds_read_b128 v[152:155], v7 offset:320
v_mfma_f32_16x16x32_bf16 v[192:195], v[128:131], v[100:103], v[192:195]
ds_read_b64 v[92:93], v8 offset:0
v_mfma_f32_16x16x32_bf16 v[200:203], v[128:131], v[104:107], v[200:203]
ds_read_b64 v[94:95], v8 offset:128
v_mfma_f32_16x16x32_bf16 v[208:211], v[128:131], v[108:111], v[208:211]
ds_read_b64 v[96:97], v8 offset:256
v_mfma_f32_16x16x32_bf16 v[216:219], v[128:131], v[112:115], v[216:219]
ds_read_b64 v[98:99], v8 offset:384
v_mfma_f32_16x16x32_bf16 v[244:247], v[112:115], v[132:135], v[244:247]
ds_read2_b32 v[56:57], v54 offset0:128 offset1:144
v_mfma_f32_16x16x32_bf16 v[236:239], v[108:111], v[132:135], v[236:239]
ds_read_b128 v[60:63], v9 offset:0
v_mfma_f32_16x16x32_bf16 v[228:231], v[104:107], v[132:135], v[228:231]
ds_read_b128 v[64:67], v9 offset:64
v_mfma_f32_16x16x32_bf16 v[220:223], v[100:103], v[132:135], v[220:223]
ds_read_b128 v[68:71], v9 offset:128
v_mfma_f32_16x16x32_bf16 v[224:227], v[100:103], v[136:139], v[224:227]
ds_read_b128 v[72:75], v9 offset:192
v_mfma_f32_16x16x32_bf16 v[232:235], v[104:107], v[136:139], v[232:235]
ds_read_b128 v[76:79], v9 offset:512
v_mfma_f32_16x16x32_bf16 v[240:243], v[108:111], v[136:139], v[240:243]
ds_read_b128 v[80:83], v9 offset:576
v_mfma_f32_16x16x32_bf16 v[248:251], v[112:115], v[136:139], v[248:251]
ds_read_b128 v[84:87], v9 offset:640
v_mfma_f32_16x16x32_bf16 v[180:183], v[116:119], v[112:115], v[180:183]
ds_read_b128 v[88:91], v9 offset:704
v_mfma_f32_16x16x32_bf16 v[172:175], v[116:119], v[108:111], v[172:175]
v_mfma_f32_16x16x32_bf16 v[164:167], v[116:119], v[104:107], v[164:167]
v_mfma_f32_16x16x32_bf16 v[156:159], v[116:119], v[100:103], v[156:159]
v_mfma_f32_16x16x32_bf16 v[160:163], v[120:123], v[100:103], v[160:163]
v_mfma_f32_16x16x32_bf16 v[168:171], v[120:123], v[104:107], v[168:171]
v_mfma_f32_16x16x32_bf16 v[176:179], v[120:123], v[108:111], v[176:179]
v_mfma_f32_16x16x32_bf16 v[184:187], v[120:123], v[112:115], v[184:187]
c2_epi:
s_waitcnt lgkmcnt(0)
.p2align 3
v_pk_fma_f32 v[212:213], v[148:149], v[98:99], v[212:213] op_sel:[0,1,0] op_sel_hi:[1,1,1]
v_pk_fma_f32 v[214:215], v[150:151], v[98:99], v[214:215] op_sel:[0,1,0] op_sel_hi:[1,1,1]
v_pk_fma_f32 v[216:217], v[152:153], v[98:99], v[216:217] op_sel:[0,1,0] op_sel_hi:[1,1,1]
v_pk_fma_f32 v[218:219], v[154:155], v[98:99], v[218:219] op_sel:[0,1,0] op_sel_hi:[1,1,1]
v_pk_mul_f32 v[212:213], v[212:213], v[98:99] op_sel:[0,0] op_sel_hi:[1,0]
v_pk_mul_f32 v[214:215], v[214:215], v[98:99] op_sel:[0,0] op_sel_hi:[1,0]
v_pk_mul_f32 v[216:217], v[216:217], v[98:99] op_sel:[0,0] op_sel_hi:[1,0]
v_pk_mul_f32 v[218:219], v[218:219], v[98:99] op_sel:[0,0] op_sel_hi:[1,0]
v_cvt_pk_bf16_f32 v212, v212, v213
v_cvt_pk_bf16_f32 v213, v214, v215
v_cvt_pk_bf16_f32 v214, v216, v217
v_cvt_pk_bf16_f32 v215, v218, v219
v_pk_fma_f32 v[244:245], v[88:89], v[56:57], v[244:245] op_sel:[0,0,0] op_sel_hi:[1,0,1]
v_pk_fma_f32 v[246:247], v[90:91], v[56:57], v[246:247] op_sel:[0,0,0] op_sel_hi:[1,0,1]
v_pk_mul_f32 v[244:245], v[244:245], v[72:73]
v_pk_mul_f32 v[246:247], v[246:247], v[74:75]
v_cvt_pk_bf16_f32 v108, v244, v245
v_cvt_pk_bf16_f32 v109, v246, v247
v_pk_fma_f32 v[248:249], v[88:89], v[56:57], v[248:249] op_sel:[0,1,0] op_sel_hi:[1,1,1]
v_pk_fma_f32 v[250:251], v[90:91], v[56:57], v[250:251] op_sel:[0,1,0] op_sel_hi:[1,1,1]
v_pk_mul_f32 v[248:249], v[248:249], v[72:73]
v_pk_mul_f32 v[250:251], v[250:251], v[74:75]
v_cvt_pk_bf16_f32 v118, v248, v249
v_cvt_pk_bf16_f32 v119, v250, v251
s_cmp_lg_u32 s44, 1
s_cbranch_scc1 else_78
buffer_store_dwordx4 v[212:215], v58, s[32:35], 0 offen sc1
buffer_store_dwordx2 v[108:109], v59, s[32:35], 0 offen offset:1024 sc1
buffer_store_dwordx2 v[118:119], v59, s[32:35], 0 offen offset:1536 sc1
s_branch fi_79
else_78:
ds_write_b128 v53, v[212:215]
ds_write_b64 v55, v[108:109] offset:1024
ds_write_b64 v55, v[118:119] offset:1536
v_mov_b32 v4, 3
ds_write_b32 v19, v4
fi_79:
v_mul_f32 v124, s66, v92
v_mul_f32 v125, s66, v94
v_mul_f32 v126, s66, v96
v_mul_f32 v127, s66, v98
.p2align 3
v_pk_fma_f32 v[156:157], v[140:141], v[92:93], v[156:157] op_sel:[0,1,0] op_sel_hi:[1,1,1]
v_pk_fma_f32 v[158:159], v[142:143], v[92:93], v[158:159] op_sel:[0,1,0] op_sel_hi:[1,1,1]
v_pk_fma_f32 v[160:161], v[144:145], v[92:93], v[160:161] op_sel:[0,1,0] op_sel_hi:[1,1,1]
v_pk_fma_f32 v[162:163], v[146:147], v[92:93], v[162:163] op_sel:[0,1,0] op_sel_hi:[1,1,1]
v_cvt_pk_bf16_f32 v156, v156, v157
v_cvt_pk_bf16_f32 v157, v158, v159
v_cvt_pk_bf16_f32 v158, v160, v161
v_cvt_pk_bf16_f32 v159, v162, v163
v_pk_fma_f32 v[164:165], v[140:141], v[94:95], v[164:165] op_sel:[0,1,0] op_sel_hi:[1,1,1]
v_pk_fma_f32 v[166:167], v[142:143], v[94:95], v[166:167] op_sel:[0,1,0] op_sel_hi:[1,1,1]
v_pk_fma_f32 v[168:169], v[144:145], v[94:95], v[168:169] op_sel:[0,1,0] op_sel_hi:[1,1,1]
v_pk_fma_f32 v[170:171], v[146:147], v[94:95], v[170:171] op_sel:[0,1,0] op_sel_hi:[1,1,1]
v_cvt_pk_bf16_f32 v164, v164, v165
v_cvt_pk_bf16_f32 v165, v166, v167
v_cvt_pk_bf16_f32 v166, v168, v169
v_cvt_pk_bf16_f32 v167, v170, v171
v_pk_fma_f32 v[172:173], v[140:141], v[96:97], v[172:173] op_sel:[0,1,0] op_sel_hi:[1,1,1]
v_pk_fma_f32 v[174:175], v[142:143], v[96:97], v[174:175] op_sel:[0,1,0] op_sel_hi:[1,1,1]
v_pk_fma_f32 v[176:177], v[144:145], v[96:97], v[176:177] op_sel:[0,1,0] op_sel_hi:[1,1,1]
v_pk_fma_f32 v[178:179], v[146:147], v[96:97], v[178:179] op_sel:[0,1,0] op_sel_hi:[1,1,1]
v_cvt_pk_bf16_f32 v172, v172, v173
v_cvt_pk_bf16_f32 v173, v174, v175
v_cvt_pk_bf16_f32 v174, v176, v177
v_cvt_pk_bf16_f32 v175, v178, v179
v_pk_fma_f32 v[180:181], v[140:141], v[98:99], v[180:181] op_sel:[0,1,0] op_sel_hi:[1,1,1]
v_pk_fma_f32 v[182:183], v[142:143], v[98:99], v[182:183] op_sel:[0,1,0] op_sel_hi:[1,1,1]
v_pk_fma_f32 v[184:185], v[144:145], v[98:99], v[184:185] op_sel:[0,1,0] op_sel_hi:[1,1,1]
v_pk_fma_f32 v[186:187], v[146:147], v[98:99], v[186:187] op_sel:[0,1,0] op_sel_hi:[1,1,1]
v_cvt_pk_bf16_f32 v180, v180, v181
v_cvt_pk_bf16_f32 v181, v182, v183
v_cvt_pk_bf16_f32 v182, v184, v185
v_cvt_pk_bf16_f32 v183, v186, v187
v_pk_fma_f32 v[188:189], v[148:149], v[92:93], v[188:189] op_sel:[0,1,0] op_sel_hi:[1,1,1]
v_pk_fma_f32 v[190:191], v[150:151], v[92:93], v[190:191] op_sel:[0,1,0] op_sel_hi:[1,1,1]
v_pk_fma_f32 v[192:193], v[152:153], v[92:93], v[192:193] op_sel:[0,1,0] op_sel_hi:[1,1,1]
v_pk_fma_f32 v[194:195], v[154:155], v[92:93], v[194:195] op_sel:[0,1,0] op_sel_hi:[1,1,1]
v_pk_mul_f32 v[188:189], v[188:189], v[92:93] op_sel:[0,0] op_sel_hi:[1,0]
v_pk_mul_f32 v[190:191], v[190:191], v[92:93] op_sel:[0,0] op_sel_hi:[1,0]
v_pk_mul_f32 v[192:193], v[192:193], v[92:93] op_sel:[0,0] op_sel_hi:[1,0]
v_pk_mul_f32 v[194:195], v[194:195], v[92:93] op_sel:[0,0] op_sel_hi:[1,0]
v_cvt_pk_bf16_f32 v188, v188, v189
v_cvt_pk_bf16_f32 v189, v190, v191
v_cvt_pk_bf16_f32 v190, v192, v193
v_cvt_pk_bf16_f32 v191, v194, v195
v_pk_fma_f32 v[196:197], v[148:149], v[94:95], v[196:197] op_sel:[0,1,0] op_sel_hi:[1,1,1]
v_pk_fma_f32 v[198:199], v[150:151], v[94:95], v[198:199] op_sel:[0,1,0] op_sel_hi:[1,1,1]
v_pk_fma_f32 v[200:201], v[152:153], v[94:95], v[200:201] op_sel:[0,1,0] op_sel_hi:[1,1,1]
v_pk_fma_f32 v[202:203], v[154:155], v[94:95], v[202:203] op_sel:[0,1,0] op_sel_hi:[1,1,1]
v_pk_mul_f32 v[196:197], v[196:197], v[94:95] op_sel:[0,0] op_sel_hi:[1,0]
v_pk_mul_f32 v[198:199], v[198:199], v[94:95] op_sel:[0,0] op_sel_hi:[1,0]
v_pk_mul_f32 v[200:201], v[200:201], v[94:95] op_sel:[0,0] op_sel_hi:[1,0]
v_pk_mul_f32 v[202:203], v[202:203], v[94:95] op_sel:[0,0] op_sel_hi:[1,0]
v_cvt_pk_bf16_f32 v196, v196, v197
v_cvt_pk_bf16_f32 v197, v198, v199
v_cvt_pk_bf16_f32 v198, v200, v201
v_cvt_pk_bf16_f32 v199, v202, v203
v_pk_fma_f32 v[204:205], v[148:149], v[96:97], v[204:205] op_sel:[0,1,0] op_sel_hi:[1,1,1]
v_pk_fma_f32 v[206:207], v[150:151], v[96:97], v[206:207] op_sel:[0,1,0] op_sel_hi:[1,1,1]
v_pk_fma_f32 v[208:209], v[152:153], v[96:97], v[208:209] op_sel:[0,1,0] op_sel_hi:[1,1,1]
v_pk_fma_f32 v[210:211], v[154:155], v[96:97], v[210:211] op_sel:[0,1,0] op_sel_hi:[1,1,1]
v_pk_mul_f32 v[204:205], v[204:205], v[96:97] op_sel:[0,0] op_sel_hi:[1,0]
v_pk_mul_f32 v[206:207], v[206:207], v[96:97] op_sel:[0,0] op_sel_hi:[1,0]
v_pk_mul_f32 v[208:209], v[208:209], v[96:97] op_sel:[0,0] op_sel_hi:[1,0]
v_pk_mul_f32 v[210:211], v[210:211], v[96:97] op_sel:[0,0] op_sel_hi:[1,0]
v_cvt_pk_bf16_f32 v204, v204, v205
v_cvt_pk_bf16_f32 v205, v206, v207
v_cvt_pk_bf16_f32 v206, v208, v209
v_cvt_pk_bf16_f32 v207, v210, v211
s_cmp_lg_u32 s44, 0
s_cbranch_scc1 else_80
buffer_load_dwordx4 v[120:123], v58, s[32:35], 0 offen sc1
buffer_load_dwordx2 v[100:101], v59, s[32:35], 0 offen offset:1024 sc1
buffer_load_dwordx2 v[110:111], v59, s[32:35], 0 offen offset:1536 sc1
else_80:
.p2align 3
v_mfma_f32_16x16x32_bf16 v[216:219], v[212:215], v[180:183], v[40:43]
v_pk_fma_f32 v[220:221], v[76:77], v[56:57], v[220:221] op_sel:[0,0,0] op_sel_hi:[1,0,1]
v_pk_fma_f32 v[222:223], v[78:79], v[56:57], v[222:223] op_sel:[0,0,0] op_sel_hi:[1,0,1]
v_pk_mul_f32 v[220:221], v[220:221], v[60:61]
v_pk_mul_f32 v[222:223], v[222:223], v[62:63]
v_cvt_pk_bf16_f32 v102, v220, v221
v_mfma_f32_16x16x32_bf16 v[192:195], v[188:191], v[156:159], v[40:43]
v_cvt_pk_bf16_f32 v103, v222, v223
v_pk_fma_f32 v[224:225], v[76:77], v[56:57], v[224:225] op_sel:[0,1,0] op_sel_hi:[1,1,1]
v_pk_fma_f32 v[226:227], v[78:79], v[56:57], v[226:227] op_sel:[0,1,0] op_sel_hi:[1,1,1]
v_pk_mul_f32 v[224:225], v[224:225], v[60:61]
v_pk_mul_f32 v[226:227], v[226:227], v[62:63]
v_cvt_pk_bf16_f32 v112, v224, v225
v_mfma_f32_16x16x32_bf16 v[168:171], v[188:191], v[164:167], v[36:39]
v_cvt_pk_bf16_f32 v113, v226, v227
v_pk_fma_f32 v[228:229], v[80:81], v[56:57], v[228:229] op_sel:[0,0,0] op_sel_hi:[1,0,1]
v_pk_fma_f32 v[230:231], v[82:83], v[56:57], v[230:231] op_sel:[0,0,0] op_sel_hi:[1,0,1]
v_pk_mul_f32 v[228:229], v[228:229], v[64:65]
v_pk_mul_f32 v[230:231], v[230:231], v[66:67]
v_cvt_pk_bf16_f32 v104, v228, v229
v_mfma_f32_16x16x32_bf16 v[200:203], v[196:199], v[164:167], v[40:43]
v_cvt_pk_bf16_f32 v105, v230, v231
v_pk_fma_f32 v[232:233], v[80:81], v[56:57], v[232:233] op_sel:[0,1,0] op_sel_hi:[1,1,1]
v_pk_fma_f32 v[234:235], v[82:83], v[56:57], v[234:235] op_sel:[0,1,0] op_sel_hi:[1,1,1]
v_pk_mul_f32 v[232:233], v[232:233], v[64:65]
v_pk_mul_f32 v[234:235], v[234:235], v[66:67]
v_cvt_pk_bf16_f32 v114, v232, v233
v_mfma_f32_16x16x32_bf16 v[176:179], v[196:199], v[172:175], v[36:39]
v_cvt_pk_bf16_f32 v115, v234, v235
v_pk_fma_f32 v[236:237], v[84:85], v[56:57], v[236:237] op_sel:[0,0,0] op_sel_hi:[1,0,1]
v_pk_fma_f32 v[238:239], v[86:87], v[56:57], v[238:239] op_sel:[0,0,0] op_sel_hi:[1,0,1]
v_pk_mul_f32 v[236:237], v[236:237], v[68:69]
v_pk_mul_f32 v[238:239], v[238:239], v[70:71]
v_cvt_pk_bf16_f32 v106, v236, v237
v_mfma_f32_16x16x32_bf16 v[208:211], v[204:207], v[172:175], v[40:43]
v_cvt_pk_bf16_f32 v107, v238, v239
v_pk_fma_f32 v[240:241], v[84:85], v[56:57], v[240:241] op_sel:[0,1,0] op_sel_hi:[1,1,1]
v_pk_fma_f32 v[242:243], v[86:87], v[56:57], v[242:243] op_sel:[0,1,0] op_sel_hi:[1,1,1]
v_pk_mul_f32 v[240:241], v[240:241], v[68:69]
v_pk_mul_f32 v[242:243], v[242:243], v[70:71]
v_cvt_pk_bf16_f32 v116, v240, v241
v_mfma_f32_16x16x32_bf16 v[184:187], v[204:207], v[180:183], v[36:39]
v_cvt_pk_bf16_f32 v117, v242, v243
v_max_f32 v166, v200, v201
v_max_f32 v167, v202, v203
v_max_f32 v164, v168, v169
v_max_f32 v165, v170, v171
v_max3_f32 v129, v164, v165, v166
v_max_f32 v129, v129, v167
s_cmp_lg_u32 s44, 0
s_cbranch_scc1 else_82
s_mov_b32 s63, 0
sent_84:
s_waitcnt vmcnt(0)
v_max_u32 v4, v120, v121
v_max3_u32 v4, v4, v122, v123
v_max3_u32 v4, v4, v100, v101
v_max3_u32 v4, v4, v110, v111
v_cmp_eq_u32 vcc, -1, v4
s_cbranch_vccz sentd_85
buffer_load_dwordx4 v[120:123], v58, s[32:35], 0 offen sc1
buffer_load_dwordx2 v[100:101], v59, s[32:35], 0 offen offset:1024 sc1
buffer_load_dwordx2 v[110:111], v59, s[32:35], 0 offen offset:1536 sc1
s_add_u32 s63, s63, 1
s_cmp_lt_u32 s63, 0x80000
s_cbranch_scc1 sent_84
s_waitcnt vmcnt(0)
sentd_85:
s_branch fi_83
else_82:
s_mov_b32 s63, 0
px_86:
ds_read_b32 v4, v19
ds_read_b128 v[120:123], v53
ds_read_b64 v[100:101], v55 offset:1024
ds_read_b64 v[110:111], v55 offset:1536
s_add_u32 s63, s63, 1
s_cmp_lt_u32 s63, 0x400000
s_waitcnt lgkmcnt(0)
v_cmp_ne_u32 vcc, 3, v4
s_cbranch_vccz pxd_87
s_cbranch_scc1 px_86
pxd_87:
fi_83:
v_mfma_f32_16x16x32_bf16 v[160:163], v[120:123], v[156:159], v[44:47]
v_max_f32 v174, v208, v209
v_max_f32 v175, v210, v211
v_max_f32 v172, v176, v177
v_max_f32 v173, v178, v179
v_max3_f32 v130, v172, v173, v174
v_max_f32 v130, v130, v175
v_max_f32 v182, v216, v217
v_max_f32 v183, v218, v219
v_max_f32 v180, v184, v185
v_max_f32 v181, v186, v187
v_max3_f32 v131, v180, v181, v182
v_max_f32 v131, v131, v183
v_max_f32 v158, v192, v193
v_max_f32 v159, v194, v195
v_max_f32 v156, v160, v161
v_max_f32 v157, v162, v163
v_max3_f32 v128, v156, v157, v158
v_max_f32 v128, v128, v159
s_nop 1
v_permlane32_swap_b32 v128, v129
v_permlane32_swap_b32 v130, v131
v_max_f32 v128, v128, v129
v_max_f32 v130, v130, v131
s_nop 1
v_permlane16_swap_b32 v128, v130
s_nop 0
v_max_f32 v128, v128, v130
v_mov_b32 v130, v128
s_nop 1
v_permlane16_swap_b32 v128, v130
s_nop 0
v_mov_b32 v129, v128
v_mov_b32 v131, v130
s_nop 0
v_permlane32_swap_b32 v128, v129
v_permlane32_swap_b32 v130, v131
v_pk_mul_f32 v[128:129], v[128:129], v[124:125]
v_pk_mul_f32 v[130:131], v[130:131], v[126:127]
v_pk_fma_f32 v[156:157], v[156:157], v[124:125], v[128:129] op_sel:[0,0,0] op_sel_hi:[1,0,0] neg_lo:[0,0,1] neg_hi:[0,0,1]
v_pk_fma_f32 v[158:159], v[158:159], v[124:125], v[128:129] op_sel:[0,0,0] op_sel_hi:[1,0,0] neg_lo:[0,0,1] neg_hi:[0,0,1]
v_exp_f32 v156, v156
v_exp_f32 v157, v157
v_exp_f32 v158, v158
v_exp_f32 v159, v159
v_cvt_pk_bf16_f32 v156, v156, v156
v_cvt_pk_bf16_f32 v157, v157, v157
v_cvt_pk_bf16_f32 v158, v158, v158
v_cvt_pk_bf16_f32 v159, v159, v159
v_and_b32 v156, v52, v156
v_and_b32 v157, v52, v157
v_and_b32 v158, v52, v158
v_and_b32 v159, v52, v159
v_pk_fma_f32 v[164:165], v[164:165], v[124:125], v[128:129] op_sel:[0,1,1] op_sel_hi:[1,1,1] neg_lo:[0,0,1] neg_hi:[0,0,1]
v_pk_fma_f32 v[166:167], v[166:167], v[124:125], v[128:129] op_sel:[0,1,1] op_sel_hi:[1,1,1] neg_lo:[0,0,1] neg_hi:[0,0,1]
v_exp_f32 v164, v164
v_mfma_f32_16x16x32_bf16 v[160:163], v[48:51], v[156:159], 0
v_exp_f32 v165, v165
v_exp_f32 v166, v166
v_exp_f32 v167, v167
v_cvt_pk_bf16_f32 v164, v164, v164
v_mfma_f32_16x16x32_bf16 v[220:223], v[100:103], v[156:159], 0
v_cvt_pk_bf16_f32 v165, v165, v165
v_cvt_pk_bf16_f32 v166, v166, v166
v_cvt_pk_bf16_f32 v167, v167, v167
v_and_b32 v164, v52, v164
v_mfma_f32_16x16x32_bf16 v[224:227], v[110:113], v[156:159], 0
v_and_b32 v165, v52, v165
v_and_b32 v166, v52, v166
v_and_b32 v167, v52, v167
v_pk_fma_f32 v[172:173], v[172:173], v[126:127], v[130:131] op_sel:[0,0,0] op_sel_hi:[1,0,0] neg_lo:[0,0,1] neg_hi:[0,0,1]
v_pk_fma_f32 v[174:175], v[174:175], v[126:127], v[130:131] op_sel:[0,0,0] op_sel_hi:[1,0,0] neg_lo:[0,0,1] neg_hi:[0,0,1]
v_exp_f32 v172, v172
v_mfma_f32_16x16x32_bf16 v[168:171], v[48:51], v[164:167], 0
v_exp_f32 v173, v173
v_exp_f32 v174, v174
v_exp_f32 v175, v175
v_cvt_pk_bf16_f32 v172, v172, v172
v_mfma_f32_16x16x32_bf16 v[228:231], v[102:105], v[164:167], 0
v_cvt_pk_bf16_f32 v173, v173, v173
v_cvt_pk_bf16_f32 v174, v174, v174
v_cvt_pk_bf16_f32 v175, v175, v175
v_and_b32 v172, v52, v172
v_mfma_f32_16x16x32_bf16 v[232:235], v[112:115], v[164:167], 0
v_and_b32 v173, v52, v173
v_and_b32 v174, v52, v174
v_and_b32 v175, v52, v175
v_pk_fma_f32 v[180:181], v[180:181], v[126:127], v[130:131] op_sel:[0,1,1] op_sel_hi:[1,1,1] neg_lo:[0,0,1] neg_hi:[0,0,1]
v_pk_fma_f32 v[182:183], v[182:183], v[126:127], v[130:131] op_sel:[0,1,1] op_sel_hi:[1,1,1] neg_lo:[0,0,1] neg_hi:[0,0,1]
v_exp_f32 v180, v180
v_mfma_f32_16x16x32_bf16 v[176:179], v[48:51], v[172:175], 0
v_exp_f32 v181, v181
v_exp_f32 v182, v182
v_exp_f32 v183, v183
v_cvt_pk_bf16_f32 v180, v180, v180
v_mfma_f32_16x16x32_bf16 v[236:239], v[104:107], v[172:175], 0
v_cvt_pk_bf16_f32 v181, v181, v181
v_cvt_pk_bf16_f32 v182, v182, v182
v_cvt_pk_bf16_f32 v183, v183, v183
v_and_b32 v180, v52, v180
v_mfma_f32_16x16x32_bf16 v[240:243], v[114:117], v[172:175], 0
v_and_b32 v181, v52, v181
v_and_b32 v182, v52, v182
v_and_b32 v183, v52, v183
v_rcp_f32 v160, v160
v_rcp_f32 v168, v168
v_mfma_f32_16x16x32_bf16 v[184:187], v[48:51], v[180:183], 0
v_mfma_f32_16x16x32_bf16 v[244:247], v[106:109], v[180:183], 0
v_mfma_f32_16x16x32_bf16 v[248:251], v[116:119], v[180:183], 0
v_rcp_f32 v176, v176
s_nop 4
v_rcp_f32 v184, v184
s_cmp_eq_u32 s46, 0
s_cbranch_scc1 slow_88
.p2align 3
v_pk_mul_f32 v[220:221], v[220:221], v[160:161] op_sel:[0,0] op_sel_hi:[1,0]
v_pk_mul_f32 v[222:223], v[222:223], v[160:161] op_sel:[0,0] op_sel_hi:[1,0]
v_pk_mul_f32 v[224:225], v[224:225], v[160:161] op_sel:[0,0] op_sel_hi:[1,0]
v_pk_mul_f32 v[226:227], v[226:227], v[160:161] op_sel:[0,0] op_sel_hi:[1,0]
v_cvt_pk_bf16_f32 v220, v220, v221
v_cvt_pk_bf16_f32 v221, v222, v223
v_cvt_pk_bf16_f32 v222, v224, v225
v_cvt_pk_bf16_f32 v223, v226, v227
buffer_store_dwordx4 v[220:223], v18, s[32:35], s80 offen
v_pk_mul_f32 v[228:229], v[228:229], v[168:169] op_sel:[0,0] op_sel_hi:[1,0]
v_pk_mul_f32 v[230:231], v[230:231], v[168:169] op_sel:[0,0] op_sel_hi:[1,0]
v_pk_mul_f32 v[232:233], v[232:233], v[168:169] op_sel:[0,0] op_sel_hi:[1,0]
v_pk_mul_f32 v[234:235], v[234:235], v[168:169] op_sel:[0,0] op_sel_hi:[1,0]
v_cvt_pk_bf16_f32 v228, v228, v229
v_cvt_pk_bf16_f32 v229, v230, v231
v_cvt_pk_bf16_f32 v230, v232, v233
v_cvt_pk_bf16_f32 v231, v234, v235
buffer_store_dwordx4 v[228:231], v18, s[32:35], s81 offen
v_pk_mul_f32 v[236:237], v[236:237], v[176:177] op_sel:[0,0] op_sel_hi:[1,0]
v_pk_mul_f32 v[238:239], v[238:239], v[176:177] op_sel:[0,0] op_sel_hi:[1,0]
v_pk_mul_f32 v[240:241], v[240:241], v[176:177] op_sel:[0,0] op_sel_hi:[1,0]
v_pk_mul_f32 v[242:243], v[242:243], v[176:177] op_sel:[0,0] op_sel_hi:[1,0]
v_cvt_pk_bf16_f32 v236, v236, v237
v_cvt_pk_bf16_f32 v237, v238, v239
v_cvt_pk_bf16_f32 v238, v240, v241
v_cvt_pk_bf16_f32 v239, v242, v243
buffer_store_dwordx4 v[236:239], v18, s[32:35], s82 offen
v_pk_mul_f32 v[244:245], v[244:245], v[184:185] op_sel:[0,0] op_sel_hi:[1,0]
v_pk_mul_f32 v[246:247], v[246:247], v[184:185] op_sel:[0,0] op_sel_hi:[1,0]
v_pk_mul_f32 v[248:249], v[248:249], v[184:185] op_sel:[0,0] op_sel_hi:[1,0]
v_pk_mul_f32 v[250:251], v[250:251], v[184:185] op_sel:[0,0] op_sel_hi:[1,0]
v_cvt_pk_bf16_f32 v244, v244, v245
v_cvt_pk_bf16_f32 v245, v246, v247
v_cvt_pk_bf16_f32 v246, v248, v249
v_cvt_pk_bf16_f32 v247, v250, v251
buffer_store_dwordx4 v[244:247], v18, s[32:35], s83 offen
s_barrier
s_lshl_b32 s62, s45, 2
v_mov_b32 v4, s62
v_mov_b32 v5, 3
s_mov_b64 exec, 1
s_waitcnt vmcnt(0)
buffer_store_dword v5, v4, s[32:35], s84 offen
s_mov_b64 exec, -1
back_89:
v_and_b32 v36, 31, v0
v_lshlrev_b32 v36, 2, v36
buffer_load_dword v37, v36, s[32:35], s84 offen sc1
v_lshrrev_b32 v4, 2, v2
v_and_b32 v5, 3, v0
v_lshl_add_u32 v6, v3, 3, v4
v_lshlrev_b32 v6, 7, v6
v_lshl_add_u32 v6, v5, 3, v6
v_lshrrev_b32 v7, 1, v4
v_and_b32 v8, 1, v3
v_lshl_add_u32 v7, v8, 1, v7
v_lshl_add_u32 v10, v7, 5, v6
v_xor_b32 v11, 32, v10
v_xor_b32 v12, 64, v10
v_xor_b32 v13, 96, v10
v_add_u32 v14, 0x10000, v10
v_add_u32 v15, 0x10000, v11
v_add_u32 v16, 0x10000, v12
v_add_u32 v17, 0x10000, v13
ds_read_b64_tr_b16 v[220:221], v10 offset:0
ds_read_b64_tr_b16 v[222:223], v10 offset:512
ds_read_b64_tr_b16 v[224:225], v11 offset:0
ds_read_b64_tr_b16 v[226:227], v11 offset:512
ds_read_b64_tr_b16 v[228:229], v12 offset:0
ds_read_b64_tr_b16 v[230:231], v12 offset:512
ds_read_b64_tr_b16 v[232:233], v13 offset:0
ds_read_b64_tr_b16 v[234:235], v13 offset:512
ds_read_b64_tr_b16 v[236:237], v10 offset:4096
ds_read_b64_tr_b16 v[238:239], v10 offset:4608
ds_read_b64_tr_b16 v[240:241], v11 offset:4096
ds_read_b64_tr_b16 v[242:243], v11 offset:4608
ds_read_b64_tr_b16 v[244:245], v12 offset:4096
ds_read_b64_tr_b16 v[246:247], v12 offset:4608
ds_read_b64_tr_b16 v[248:249], v13 offset:4096
ds_read_b64_tr_b16 v[250:251], v13 offset:4608
s_lshl_b32 s48, s41, 3
s_lshl_b32 s49, s40, 1
s_add_u32 s48, s48, s49
s_lshl_b32 s48, s48, 15
s_add_u32 s48, s48, 4194304
v_add_u32 v38, s48, v18
v_add_u32 v39, 32768, v38
s_lshl_b32 s57, s47, 11
s_mov_b32 s63, 0
s_waitcnt vmcnt(0)
poll_90:
v_cmp_gt_u32 vcc, 3, v37
s_cbranch_vccz polled_91
buffer_load_dword v37, v36, s[32:35], s84 offen sc1
s_add_u32 s63, s63, 1
s_cmp_lt_u32 s63, 0x80000
s_waitcnt vmcnt(0)
s_cbranch_scc1 poll_90
polled_91:
buffer_load_dwordx4 v[156:159], v38, s[32:35], s57 offen sc1
buffer_load_dwordx4 v[160:163], v39, s[32:35], s57 offen sc1
buffer_load_dwordx4 v[164:167], v38, s[32:35], s57 offen offset:1024 sc1
buffer_load_dwordx4 v[168:171], v39, s[32:35], s57 offen offset:1024 sc1
s_add_u32 s57, s57, 2048
s_and_b32 s57, s57, 0x7fff
buffer_load_dwordx4 v[172:175], v38, s[32:35], s57 offen sc1
buffer_load_dwordx4 v[176:179], v39, s[32:35], s57 offen sc1
buffer_load_dwordx4 v[180:183], v38, s[32:35], s57 offen offset:1024 sc1
buffer_load_dwordx4 v[184:187], v39, s[32:35], s57 offen offset:1024 sc1
s_add_u32 s57, s57, 2048
s_and_b32 s57, s57, 0x7fff
v_lshlrev_b32 v60, 16, v20
v_and_b32 v61, 0xffff0000, v20
v_lshlrev_b32 v62, 16, v21
v_and_b32 v63, 0xffff0000, v21
v_lshlrev_b32 v64, 16, v22
v_and_b32 v65, 0xffff0000, v22
v_lshlrev_b32 v66, 16, v23
v_and_b32 v67, 0xffff0000, v23
v_lshlrev_b32 v68, 16, v24
v_and_b32 v69, 0xffff0000, v24
v_lshlrev_b32 v70, 16, v25
v_and_b32 v71, 0xffff0000, v25
v_lshlrev_b32 v72, 16, v26
v_and_b32 v73, 0xffff0000, v26
v_lshlrev_b32 v74, 16, v27
v_and_b32 v75, 0xffff0000, v27
v_lshlrev_b32 v76, 16, v28
v_and_b32 v77, 0xffff0000, v28
v_lshlrev_b32 v78, 16, v29
v_and_b32 v79, 0xffff0000, v29
v_lshlrev_b32 v80, 16, v30
v_and_b32 v81, 0xffff0000, v30
v_lshlrev_b32 v82, 16, v31
v_and_b32 v83, 0xffff0000, v31
v_lshlrev_b32 v84, 16, v32
v_and_b32 v85, 0xffff0000, v32
v_lshlrev_b32 v86, 16, v33
v_and_b32 v87, 0xffff0000, v33
v_lshlrev_b32 v88, 16, v34
v_and_b32 v89, 0xffff0000, v34
v_lshlrev_b32 v90, 16, v35
v_and_b32 v91, 0xffff0000, v35
v_mov_b32 v6, 0
v_mov_b32 v7, 0
v_mov_b32 v8, 0
v_mov_b32 v9, 0
s_lshl_b32 s62, s42, 2
v_mov_b32 v4, s62
v_mov_b32 v5, 3
buffer_load_dwordx4 v[188:191], v38, s[32:35], s57 offen sc1
buffer_load_dwordx4 v[192:195], v39, s[32:35], s57 offen sc1
buffer_load_dwordx4 v[196:199], v38, s[32:35], s57 offen offset:1024 sc1
buffer_load_dwordx4 v[200:203], v39, s[32:35], s57 offen offset:1024 sc1
s_add_u32 s57, s57, 2048
s_and_b32 s57, s57, 0x7fff
s_waitcnt vmcnt(10) lgkmcnt(8)
v_mfma_f32_16x16x32_bf16 v[60:63], v[220:223], v[156:159], v[60:63]
ds_read_b64_tr_b16 v[100:101], v10 offset:8192
ds_read_b64_tr_b16 v[102:103], v10 offset:8704
v_mfma_f32_16x16x32_bf16 v[76:79], v[220:223], v[160:163], v[76:79]
buffer_load_dwordx4 v[204:207], v38, s[32:35], s57 offen sc1
v_mfma_f32_16x16x32_bf16 v[64:67], v[224:227], v[156:159], v[64:67]
ds_read_b64_tr_b16 v[104:105], v11 offset:8192
v_mfma_f32_16x16x32_bf16 v[80:83], v[224:227], v[160:163], v[80:83]
ds_read_b64_tr_b16 v[106:107], v11 offset:8704
v_mfma_f32_16x16x32_bf16 v[68:71], v[228:231], v[156:159], v[68:71]
ds_read_b64_tr_b16 v[108:109], v12 offset:8192
buffer_load_dwordx4 v[208:211], v39, s[32:35], s57 offen sc1
v_mfma_f32_16x16x32_bf16 v[84:87], v[228:231], v[160:163], v[84:87]
ds_read_b64_tr_b16 v[110:111], v12 offset:8704
v_mfma_f32_16x16x32_bf16 v[72:75], v[232:235], v[156:159], v[72:75]
ds_read_b64_tr_b16 v[112:113], v13 offset:8192
v_mfma_f32_16x16x32_bf16 v[88:91], v[232:235], v[160:163], v[88:91]
ds_read_b64_tr_b16 v[114:115], v13 offset:8704
s_waitcnt vmcnt(10) lgkmcnt(8)
v_mfma_f32_16x16x32_bf16 v[60:63], v[236:239], v[164:167], v[60:63]
ds_read_b64_tr_b16 v[220:221], v10 offset:12288
ds_read_b64_tr_b16 v[222:223], v10 offset:12800
v_mfma_f32_16x16x32_bf16 v[76:79], v[236:239], v[168:171], v[76:79]
buffer_load_dwordx4 v[212:215], v38, s[32:35], s57 offen offset:1024 sc1
v_mfma_f32_16x16x32_bf16 v[64:67], v[240:243], v[164:167], v[64:67]
ds_read_b64_tr_b16 v[224:225], v11 offset:12288
v_mfma_f32_16x16x32_bf16 v[80:83], v[240:243], v[168:171], v[80:83]
ds_read_b64_tr_b16 v[226:227], v11 offset:12800
v_mfma_f32_16x16x32_bf16 v[68:71], v[244:247], v[164:167], v[68:71]
ds_read_b64_tr_b16 v[228:229], v12 offset:12288
buffer_load_dwordx4 v[216:219], v39, s[32:35], s57 offen offset:1024 sc1
s_add_u32 s57, s57, 2048
s_and_b32 s57, s57, 0x7fff
v_mfma_f32_16x16x32_bf16 v[84:87], v[244:247], v[168:171], v[84:87]
ds_read_b64_tr_b16 v[230:231], v12 offset:12800
v_mfma_f32_16x16x32_bf16 v[72:75], v[248:251], v[164:167], v[72:75]
ds_read_b64_tr_b16 v[232:233], v13 offset:12288
v_mfma_f32_16x16x32_bf16 v[88:91], v[248:251], v[168:171], v[88:91]
ds_read_b64_tr_b16 v[234:235], v13 offset:12800
s_waitcnt vmcnt(10) lgkmcnt(8)
v_mfma_f32_16x16x32_bf16 v[60:63], v[100:103], v[172:175], v[60:63]
ds_read_b64_tr_b16 v[236:237], v10 offset:16384
ds_read_b64_tr_b16 v[238:239], v10 offset:16896
v_mfma_f32_16x16x32_bf16 v[76:79], v[100:103], v[176:179], v[76:79]
buffer_load_dwordx4 v[156:159], v38, s[32:35], s57 offen sc1
v_mfma_f32_16x16x32_bf16 v[64:67], v[104:107], v[172:175], v[64:67]
ds_read_b64_tr_b16 v[240:241], v11 offset:16384
v_mfma_f32_16x16x32_bf16 v[80:83], v[104:107], v[176:179], v[80:83]
ds_read_b64_tr_b16 v[242:243], v11 offset:16896
v_mfma_f32_16x16x32_bf16 v[68:71], v[108:111], v[172:175], v[68:71]
ds_read_b64_tr_b16 v[244:245], v12 offset:16384
buffer_load_dwordx4 v[160:163], v39, s[32:35], s57 offen sc1
v_mfma_f32_16x16x32_bf16 v[84:87], v[108:111], v[176:179], v[84:87]
ds_read_b64_tr_b16 v[246:247], v12 offset:16896
v_mfma_f32_16x16x32_bf16 v[72:75], v[112:115], v[172:175], v[72:75]
ds_read_b64_tr_b16 v[248:249], v13 offset:16384
v_mfma_f32_16x16x32_bf16 v[88:91], v[112:115], v[176:179], v[88:91]
ds_read_b64_tr_b16 v[250:251], v13 offset:16896
s_waitcnt vmcnt(10) lgkmcnt(8)
v_mfma_f32_16x16x32_bf16 v[60:63], v[220:223], v[180:183], v[60:63]
ds_read_b64_tr_b16 v[100:101], v10 offset:20480
ds_read_b64_tr_b16 v[102:103], v10 offset:20992
v_mfma_f32_16x16x32_bf16 v[76:79], v[220:223], v[184:187], v[76:79]
buffer_load_dwordx4 v[164:167], v38, s[32:35], s57 offen offset:1024 sc1
v_mfma_f32_16x16x32_bf16 v[64:67], v[224:227], v[180:183], v[64:67]
ds_read_b64_tr_b16 v[104:105], v11 offset:20480
v_mfma_f32_16x16x32_bf16 v[80:83], v[224:227], v[184:187], v[80:83]
ds_read_b64_tr_b16 v[106:107], v11 offset:20992
v_mfma_f32_16x16x32_bf16 v[68:71], v[228:231], v[180:183], v[68:71]
ds_read_b64_tr_b16 v[108:109], v12 offset:20480
buffer_load_dwordx4 v[168:171], v39, s[32:35], s57 offen offset:1024 sc1
s_add_u32 s57, s57, 2048
s_and_b32 s57, s57, 0x7fff
v_mfma_f32_16x16x32_bf16 v[84:87], v[228:231], v[184:187], v[84:87]
ds_read_b64_tr_b16 v[110:111], v12 offset:20992
v_mfma_f32_16x16x32_bf16 v[72:75], v[232:235], v[180:183], v[72:75]
ds_read_b64_tr_b16 v[112:113], v13 offset:20480
v_mfma_f32_16x16x32_bf16 v[88:91], v[232:235], v[184:187], v[88:91]
ds_read_b64_tr_b16 v[114:115], v13 offset:20992
s_waitcnt vmcnt(10) lgkmcnt(8)
v_mfma_f32_16x16x32_bf16 v[60:63], v[236:239], v[188:191], v[60:63]
ds_read_b64_tr_b16 v[220:221], v10 offset:24576
ds_read_b64_tr_b16 v[222:223], v10 offset:25088
v_mfma_f32_16x16x32_bf16 v[76:79], v[236:239], v[192:195], v[76:79]
buffer_load_dwordx4 v[172:175], v38, s[32:35], s57 offen sc1
v_mfma_f32_16x16x32_bf16 v[64:67], v[240:243], v[188:191], v[64:67]
ds_read_b64_tr_b16 v[224:225], v11 offset:24576
v_mfma_f32_16x16x32_bf16 v[80:83], v[240:243], v[192:195], v[80:83]
ds_read_b64_tr_b16 v[226:227], v11 offset:25088
v_mfma_f32_16x16x32_bf16 v[68:71], v[244:247], v[188:191], v[68:71]
ds_read_b64_tr_b16 v[228:229], v12 offset:24576
buffer_load_dwordx4 v[176:179], v39, s[32:35], s57 offen sc1
v_mfma_f32_16x16x32_bf16 v[84:87], v[244:247], v[192:195], v[84:87]
ds_read_b64_tr_b16 v[230:231], v12 offset:25088
v_mfma_f32_16x16x32_bf16 v[72:75], v[248:251], v[188:191], v[72:75]
ds_read_b64_tr_b16 v[232:233], v13 offset:24576
v_mfma_f32_16x16x32_bf16 v[88:91], v[248:251], v[192:195], v[88:91]
ds_read_b64_tr_b16 v[234:235], v13 offset:25088
s_waitcnt vmcnt(10) lgkmcnt(8)
v_mfma_f32_16x16x32_bf16 v[60:63], v[100:103], v[196:199], v[60:63]
ds_read_b64_tr_b16 v[236:237], v10 offset:28672
ds_read_b64_tr_b16 v[238:239], v10 offset:29184
v_mfma_f32_16x16x32_bf16 v[76:79], v[100:103], v[200:203], v[76:79]
buffer_load_dwordx4 v[180:183], v38, s[32:35], s57 offen offset:1024 sc1
v_mfma_f32_16x16x32_bf16 v[64:67], v[104:107], v[196:199], v[64:67]
ds_read_b64_tr_b16 v[240:241], v11 offset:28672
v_mfma_f32_16x16x32_bf16 v[80:83], v[104:107], v[200:203], v[80:83]
ds_read_b64_tr_b16 v[242:243], v11 offset:29184
v_mfma_f32_16x16x32_bf16 v[68:71], v[108:111], v[196:199], v[68:71]
ds_read_b64_tr_b16 v[244:245], v12 offset:28672
buffer_load_dwordx4 v[184:187], v39, s[32:35], s57 offen offset:1024 sc1
s_add_u32 s57, s57, 2048
s_and_b32 s57, s57, 0x7fff
v_mfma_f32_16x16x32_bf16 v[84:87], v[108:111], v[200:203], v[84:87]
ds_read_b64_tr_b16 v[246:247], v12 offset:29184
v_mfma_f32_16x16x32_bf16 v[72:75], v[112:115], v[196:199], v[72:75]
ds_read_b64_tr_b16 v[248:249], v13 offset:28672
v_mfma_f32_16x16x32_bf16 v[88:91], v[112:115], v[200:203], v[88:91]
ds_read_b64_tr_b16 v[250:251], v13 offset:29184
s_waitcnt vmcnt(10) lgkmcnt(8)
v_mfma_f32_16x16x32_bf16 v[60:63], v[220:223], v[204:207], v[60:63]
ds_read_b64_tr_b16 v[100:101], v10 offset:32768
ds_read_b64_tr_b16 v[102:103], v10 offset:33280
v_mfma_f32_16x16x32_bf16 v[76:79], v[220:223], v[208:211], v[76:79]
buffer_load_dwordx4 v[188:191], v38, s[32:35], s57 offen sc1
v_mfma_f32_16x16x32_bf16 v[64:67], v[224:227], v[204:207], v[64:67]
ds_read_b64_tr_b16 v[104:105], v11 offset:32768
v_mfma_f32_16x16x32_bf16 v[80:83], v[224:227], v[208:211], v[80:83]
ds_read_b64_tr_b16 v[106:107], v11 offset:33280
v_mfma_f32_16x16x32_bf16 v[68:71], v[228:231], v[204:207], v[68:71]
ds_read_b64_tr_b16 v[108:109], v12 offset:32768
buffer_load_dwordx4 v[192:195], v39, s[32:35], s57 offen sc1
v_mfma_f32_16x16x32_bf16 v[84:87], v[228:231], v[208:211], v[84:87]
ds_read_b64_tr_b16 v[110:111], v12 offset:33280
v_mfma_f32_16x16x32_bf16 v[72:75], v[232:235], v[204:207], v[72:75]
ds_read_b64_tr_b16 v[112:113], v13 offset:32768
v_mfma_f32_16x16x32_bf16 v[88:91], v[232:235], v[208:211], v[88:91]
ds_read_b64_tr_b16 v[114:115], v13 offset:33280
s_waitcnt vmcnt(10) lgkmcnt(8)
v_mfma_f32_16x16x32_bf16 v[60:63], v[236:239], v[212:215], v[60:63]
ds_read_b64_tr_b16 v[220:221], v10 offset:36864
ds_read_b64_tr_b16 v[222:223], v10 offset:37376
v_mfma_f32_16x16x32_bf16 v[76:79], v[236:239], v[216:219], v[76:79]
buffer_load_dwordx4 v[196:199], v38, s[32:35], s57 offen offset:1024 sc1
v_mfma_f32_16x16x32_bf16 v[64:67], v[240:243], v[212:215], v[64:67]
ds_read_b64_tr_b16 v[224:225], v11 offset:36864
v_mfma_f32_16x16x32_bf16 v[80:83], v[240:243], v[216:219], v[80:83]
ds_read_b64_tr_b16 v[226:227], v11 offset:37376
v_mfma_f32_16x16x32_bf16 v[68:71], v[244:247], v[212:215], v[68:71]
ds_read_b64_tr_b16 v[228:229], v12 offset:36864
buffer_load_dwordx4 v[200:203], v39, s[32:35], s57 offen offset:1024 sc1
s_add_u32 s57, s57, 2048
s_and_b32 s57, s57, 0x7fff
v_mfma_f32_16x16x32_bf16 v[84:87], v[244:247], v[216:219], v[84:87]
ds_read_b64_tr_b16 v[230:231], v12 offset:37376
v_mfma_f32_16x16x32_bf16 v[72:75], v[248:251], v[212:215], v[72:75]
ds_read_b64_tr_b16 v[232:233], v13 offset:36864
v_mfma_f32_16x16x32_bf16 v[88:91], v[248:251], v[216:219], v[88:91]
ds_read_b64_tr_b16 v[234:235], v13 offset:37376
s_waitcnt vmcnt(10) lgkmcnt(8)
v_mfma_f32_16x16x32_bf16 v[60:63], v[100:103], v[156:159], v[60:63]
ds_read_b64_tr_b16 v[236:237], v10 offset:40960
ds_read_b64_tr_b16 v[238:239], v10 offset:41472
v_mfma_f32_16x16x32_bf16 v[76:79], v[100:103], v[160:163], v[76:79]
buffer_load_dwordx4 v[204:207], v38, s[32:35], s57 offen sc1
v_mfma_f32_16x16x32_bf16 v[64:67], v[104:107], v[156:159], v[64:67]
ds_read_b64_tr_b16 v[240:241], v11 offset:40960
v_mfma_f32_16x16x32_bf16 v[80:83], v[104:107], v[160:163], v[80:83]
ds_read_b64_tr_b16 v[242:243], v11 offset:41472
v_mfma_f32_16x16x32_bf16 v[68:71], v[108:111], v[156:159], v[68:71]
ds_read_b64_tr_b16 v[244:245], v12 offset:40960
buffer_load_dwordx4 v[208:211], v39, s[32:35], s57 offen sc1
v_mfma_f32_16x16x32_bf16 v[84:87], v[108:111], v[160:163], v[84:87]
ds_read_b64_tr_b16 v[246:247], v12 offset:41472
v_mfma_f32_16x16x32_bf16 v[72:75], v[112:115], v[156:159], v[72:75]
ds_read_b64_tr_b16 v[248:249], v13 offset:40960
v_mfma_f32_16x16x32_bf16 v[88:91], v[112:115], v[160:163], v[88:91]
ds_read_b64_tr_b16 v[250:251], v13 offset:41472
s_waitcnt vmcnt(10) lgkmcnt(8)
v_mfma_f32_16x16x32_bf16 v[60:63], v[220:223], v[164:167], v[60:63]
ds_read_b64_tr_b16 v[100:101], v10 offset:45056
ds_read_b64_tr_b16 v[102:103], v10 offset:45568
v_mfma_f32_16x16x32_bf16 v[76:79], v[220:223], v[168:171], v[76:79]
buffer_load_dwordx4 v[212:215], v38, s[32:35], s57 offen offset:1024 sc1
v_mfma_f32_16x16x32_bf16 v[64:67], v[224:227], v[164:167], v[64:67]
ds_read_b64_tr_b16 v[104:105], v11 offset:45056
v_mfma_f32_16x16x32_bf16 v[80:83], v[224:227], v[168:171], v[80:83]
ds_read_b64_tr_b16 v[106:107], v11 offset:45568
v_mfma_f32_16x16x32_bf16 v[68:71], v[228:231], v[164:167], v[68:71]
ds_read_b64_tr_b16 v[108:109], v12 offset:45056
buffer_load_dwordx4 v[216:219], v39, s[32:35], s57 offen offset:1024 sc1
s_add_u32 s57, s57, 2048
s_and_b32 s57, s57, 0x7fff
v_mfma_f32_16x16x32_bf16 v[84:87], v[228:231], v[168:171], v[84:87]
ds_read_b64_tr_b16 v[110:111], v12 offset:45568
v_mfma_f32_16x16x32_bf16 v[72:75], v[232:235], v[164:167], v[72:75]
ds_read_b64_tr_b16 v[112:113], v13 offset:45056
v_mfma_f32_16x16x32_bf16 v[88:91], v[232:235], v[168:171], v[88:91]
ds_read_b64_tr_b16 v[114:115], v13 offset:45568
s_waitcnt vmcnt(10) lgkmcnt(8)
v_mfma_f32_16x16x32_bf16 v[60:63], v[236:239], v[172:175], v[60:63]
ds_read_b64_tr_b16 v[220:221], v10 offset:49152
ds_read_b64_tr_b16 v[222:223], v10 offset:49664
v_mfma_f32_16x16x32_bf16 v[76:79], v[236:239], v[176:179], v[76:79]
buffer_load_dwordx4 v[156:159], v38, s[32:35], s57 offen sc1
v_mfma_f32_16x16x32_bf16 v[64:67], v[240:243], v[172:175], v[64:67]
ds_read_b64_tr_b16 v[224:225], v11 offset:49152
v_mfma_f32_16x16x32_bf16 v[80:83], v[240:243], v[176:179], v[80:83]
ds_read_b64_tr_b16 v[226:227], v11 offset:49664
v_mfma_f32_16x16x32_bf16 v[68:71], v[244:247], v[172:175], v[68:71]
ds_read_b64_tr_b16 v[228:229], v12 offset:49152
buffer_load_dwordx4 v[160:163], v39, s[32:35], s57 offen sc1
v_mfma_f32_16x16x32_bf16 v[84:87], v[244:247], v[176:179], v[84:87]
ds_read_b64_tr_b16 v[230:231], v12 offset:49664
v_mfma_f32_16x16x32_bf16 v[72:75], v[248:251], v[172:175], v[72:75]
ds_read_b64_tr_b16 v[232:233], v13 offset:49152
v_mfma_f32_16x16x32_bf16 v[88:91], v[248:251], v[176:179], v[88:91]
ds_read_b64_tr_b16 v[234:235], v13 offset:49664
s_waitcnt vmcnt(10) lgkmcnt(8)
v_mfma_f32_16x16x32_bf16 v[60:63], v[100:103], v[180:183], v[60:63]
ds_read_b64_tr_b16 v[236:237], v10 offset:53248
ds_read_b64_tr_b16 v[238:239], v10 offset:53760
v_mfma_f32_16x16x32_bf16 v[76:79], v[100:103], v[184:187], v[76:79]
buffer_load_dwordx4 v[164:167], v38, s[32:35], s57 offen offset:1024 sc1
v_mfma_f32_16x16x32_bf16 v[64:67], v[104:107], v[180:183], v[64:67]
ds_read_b64_tr_b16 v[240:241], v11 offset:53248
v_mfma_f32_16x16x32_bf16 v[80:83], v[104:107], v[184:187], v[80:83]
ds_read_b64_tr_b16 v[242:243], v11 offset:53760
v_mfma_f32_16x16x32_bf16 v[68:71], v[108:111], v[180:183], v[68:71]
ds_read_b64_tr_b16 v[244:245], v12 offset:53248
buffer_load_dwordx4 v[168:171], v39, s[32:35], s57 offen offset:1024 sc1
s_add_u32 s57, s57, 2048
s_and_b32 s57, s57, 0x7fff
v_mfma_f32_16x16x32_bf16 v[84:87], v[108:111], v[184:187], v[84:87]
ds_read_b64_tr_b16 v[246:247], v12 offset:53760
v_mfma_f32_16x16x32_bf16 v[72:75], v[112:115], v[180:183], v[72:75]
ds_read_b64_tr_b16 v[248:249], v13 offset:53248
v_mfma_f32_16x16x32_bf16 v[88:91], v[112:115], v[184:187], v[88:91]
ds_read_b64_tr_b16 v[250:251], v13 offset:53760
s_waitcnt vmcnt(10) lgkmcnt(8)
v_mfma_f32_16x16x32_bf16 v[60:63], v[220:223], v[188:191], v[60:63]
ds_read_b64_tr_b16 v[100:101], v10 offset:57344
ds_read_b64_tr_b16 v[102:103], v10 offset:57856
v_mfma_f32_16x16x32_bf16 v[76:79], v[220:223], v[192:195], v[76:79]
buffer_load_dwordx4 v[172:175], v38, s[32:35], s57 offen sc1
v_mfma_f32_16x16x32_bf16 v[64:67], v[224:227], v[188:191], v[64:67]
ds_read_b64_tr_b16 v[104:105], v11 offset:57344
v_mfma_f32_16x16x32_bf16 v[80:83], v[224:227], v[192:195], v[80:83]
ds_read_b64_tr_b16 v[106:107], v11 offset:57856
v_mfma_f32_16x16x32_bf16 v[68:71], v[228:231], v[188:191], v[68:71]
ds_read_b64_tr_b16 v[108:109], v12 offset:57344
buffer_load_dwordx4 v[176:179], v39, s[32:35], s57 offen sc1
v_mfma_f32_16x16x32_bf16 v[84:87], v[228:231], v[192:195], v[84:87]
ds_read_b64_tr_b16 v[110:111], v12 offset:57856
v_mfma_f32_16x16x32_bf16 v[72:75], v[232:235], v[188:191], v[72:75]
ds_read_b64_tr_b16 v[112:113], v13 offset:57344
v_mfma_f32_16x16x32_bf16 v[88:91], v[232:235], v[192:195], v[88:91]
ds_read_b64_tr_b16 v[114:115], v13 offset:57856
s_waitcnt vmcnt(10) lgkmcnt(8)
v_mfma_f32_16x16x32_bf16 v[60:63], v[236:239], v[196:199], v[60:63]
ds_read_b64_tr_b16 v[220:221], v10 offset:61440
ds_read_b64_tr_b16 v[222:223], v10 offset:61952
v_mfma_f32_16x16x32_bf16 v[76:79], v[236:239], v[200:203], v[76:79]
buffer_load_dwordx4 v[180:183], v38, s[32:35], s57 offen offset:1024 sc1
v_mfma_f32_16x16x32_bf16 v[64:67], v[240:243], v[196:199], v[64:67]
ds_read_b64_tr_b16 v[224:225], v11 offset:61440
v_mfma_f32_16x16x32_bf16 v[80:83], v[240:243], v[200:203], v[80:83]
ds_read_b64_tr_b16 v[226:227], v11 offset:61952
v_mfma_f32_16x16x32_bf16 v[68:71], v[244:247], v[196:199], v[68:71]
ds_read_b64_tr_b16 v[228:229], v12 offset:61440
buffer_load_dwordx4 v[184:187], v39, s[32:35], s57 offen offset:1024 sc1
s_add_u32 s57, s57, 2048
s_and_b32 s57, s57, 0x7fff
v_mfma_f32_16x16x32_bf16 v[84:87], v[244:247], v[200:203], v[84:87]
ds_read_b64_tr_b16 v[230:231], v12 offset:61952
v_mfma_f32_16x16x32_bf16 v[72:75], v[248:251], v[196:199], v[72:75]
ds_read_b64_tr_b16 v[232:233], v13 offset:61440
v_mfma_f32_16x16x32_bf16 v[88:91], v[248:251], v[200:203], v[88:91]
ds_read_b64_tr_b16 v[234:235], v13 offset:61952
s_waitcnt vmcnt(10) lgkmcnt(8)
v_mfma_f32_16x16x32_bf16 v[60:63], v[100:103], v[204:207], v[60:63]
ds_read_b64_tr_b16 v[236:237], v14 offset:0
ds_read_b64_tr_b16 v[238:239], v14 offset:512
v_mfma_f32_16x16x32_bf16 v[76:79], v[100:103], v[208:211], v[76:79]
buffer_load_dwordx4 v[188:191], v38, s[32:35], s57 offen sc1
v_mfma_f32_16x16x32_bf16 v[64:67], v[104:107], v[204:207], v[64:67]
ds_read_b64_tr_b16 v[240:241], v15 offset:0
v_mfma_f32_16x16x32_bf16 v[80:83], v[104:107], v[208:211], v[80:83]
ds_read_b64_tr_b16 v[242:243], v15 offset:512
v_mfma_f32_16x16x32_bf16 v[68:71], v[108:111], v[204:207], v[68:71]
ds_read_b64_tr_b16 v[244:245], v16 offset:0
buffer_load_dwordx4 v[192:195], v39, s[32:35], s57 offen sc1
v_mfma_f32_16x16x32_bf16 v[84:87], v[108:111], v[208:211], v[84:87]
ds_read_b64_tr_b16 v[246:247], v16 offset:512
v_mfma_f32_16x16x32_bf16 v[72:75], v[112:115], v[204:207], v[72:75]
ds_read_b64_tr_b16 v[248:249], v17 offset:0
v_mfma_f32_16x16x32_bf16 v[88:91], v[112:115], v[208:211], v[88:91]
ds_read_b64_tr_b16 v[250:251], v17 offset:512
s_waitcnt vmcnt(10) lgkmcnt(8)
v_mfma_f32_16x16x32_bf16 v[60:63], v[220:223], v[212:215], v[60:63]
ds_read_b64_tr_b16 v[100:101], v14 offset:4096
ds_read_b64_tr_b16 v[102:103], v14 offset:4608
v_mfma_f32_16x16x32_bf16 v[76:79], v[220:223], v[216:219], v[76:79]
buffer_load_dwordx4 v[196:199], v38, s[32:35], s57 offen offset:1024 sc1
v_mfma_f32_16x16x32_bf16 v[64:67], v[224:227], v[212:215], v[64:67]
ds_read_b64_tr_b16 v[104:105], v15 offset:4096
v_mfma_f32_16x16x32_bf16 v[80:83], v[224:227], v[216:219], v[80:83]
ds_read_b64_tr_b16 v[106:107], v15 offset:4608
v_mfma_f32_16x16x32_bf16 v[68:71], v[228:231], v[212:215], v[68:71]
ds_read_b64_tr_b16 v[108:109], v16 offset:4096
buffer_load_dwordx4 v[200:203], v39, s[32:35], s57 offen offset:1024 sc1
s_add_u32 s57, s57, 2048
s_and_b32 s57, s57, 0x7fff
v_mfma_f32_16x16x32_bf16 v[84:87], v[228:231], v[216:219], v[84:87]
ds_read_b64_tr_b16 v[110:111], v16 offset:4608
v_mfma_f32_16x16x32_bf16 v[72:75], v[232:235], v[212:215], v[72:75]
ds_read_b64_tr_b16 v[112:113], v17 offset:4096
v_mfma_f32_16x16x32_bf16 v[88:91], v[232:235], v[216:219], v[88:91]
ds_read_b64_tr_b16 v[114:115], v17 offset:4608
s_waitcnt vmcnt(10) lgkmcnt(8)
v_mfma_f32_16x16x32_bf16 v[60:63], v[236:239], v[156:159], v[60:63]
ds_read_b64_tr_b16 v[220:221], v14 offset:8192
ds_read_b64_tr_b16 v[222:223], v14 offset:8704
v_mfma_f32_16x16x32_bf16 v[76:79], v[236:239], v[160:163], v[76:79]
buffer_load_dwordx4 v[204:207], v38, s[32:35], s57 offen sc1
v_mfma_f32_16x16x32_bf16 v[64:67], v[240:243], v[156:159], v[64:67]
ds_read_b64_tr_b16 v[224:225], v15 offset:8192
v_mfma_f32_16x16x32_bf16 v[80:83], v[240:243], v[160:163], v[80:83]
ds_read_b64_tr_b16 v[226:227], v15 offset:8704
v_mfma_f32_16x16x32_bf16 v[68:71], v[244:247], v[156:159], v[68:71]
ds_read_b64_tr_b16 v[228:229], v16 offset:8192
buffer_load_dwordx4 v[208:211], v39, s[32:35], s57 offen sc1
v_mfma_f32_16x16x32_bf16 v[84:87], v[244:247], v[160:163], v[84:87]
ds_read_b64_tr_b16 v[230:231], v16 offset:8704
v_mfma_f32_16x16x32_bf16 v[72:75], v[248:251], v[156:159], v[72:75]
ds_read_b64_tr_b16 v[232:233], v17 offset:8192
v_mfma_f32_16x16x32_bf16 v[88:91], v[248:251], v[160:163], v[88:91]
ds_read_b64_tr_b16 v[234:235], v17 offset:8704
s_waitcnt vmcnt(10) lgkmcnt(8)
v_mfma_f32_16x16x32_bf16 v[60:63], v[100:103], v[164:167], v[60:63]
ds_read_b64_tr_b16 v[236:237], v14 offset:12288
ds_read_b64_tr_b16 v[238:239], v14 offset:12800
v_mfma_f32_16x16x32_bf16 v[76:79], v[100:103], v[168:171], v[76:79]
buffer_load_dwordx4 v[212:215], v38, s[32:35], s57 offen offset:1024 sc1
v_mfma_f32_16x16x32_bf16 v[64:67], v[104:107], v[164:167], v[64:67]
ds_read_b64_tr_b16 v[240:241], v15 offset:12288
v_mfma_f32_16x16x32_bf16 v[80:83], v[104:107], v[168:171], v[80:83]
ds_read_b64_tr_b16 v[242:243], v15 offset:12800
v_mfma_f32_16x16x32_bf16 v[68:71], v[108:111], v[164:167], v[68:71]
ds_read_b64_tr_b16 v[244:245], v16 offset:12288
buffer_load_dwordx4 v[216:219], v39, s[32:35], s57 offen offset:1024 sc1
s_add_u32 s57, s57, 2048
s_and_b32 s57, s57, 0x7fff
v_mfma_f32_16x16x32_bf16 v[84:87], v[108:111], v[168:171], v[84:87]
ds_read_b64_tr_b16 v[246:247], v16 offset:12800
v_mfma_f32_16x16x32_bf16 v[72:75], v[112:115], v[164:167], v[72:75]
ds_read_b64_tr_b16 v[248:249], v17 offset:12288
v_mfma_f32_16x16x32_bf16 v[88:91], v[112:115], v[168:171], v[88:91]
ds_read_b64_tr_b16 v[250:251], v17 offset:12800
s_waitcnt vmcnt(10) lgkmcnt(8)
v_mfma_f32_16x16x32_bf16 v[60:63], v[220:223], v[172:175], v[60:63]
ds_read_b64_tr_b16 v[100:101], v14 offset:16384
ds_read_b64_tr_b16 v[102:103], v14 offset:16896
v_mfma_f32_16x16x32_bf16 v[76:79], v[220:223], v[176:179], v[76:79]
buffer_load_dwordx4 v[156:159], v38, s[32:35], s57 offen sc1
v_mfma_f32_16x16x32_bf16 v[64:67], v[224:227], v[172:175], v[64:67]
ds_read_b64_tr_b16 v[104:105], v15 offset:16384
v_mfma_f32_16x16x32_bf16 v[80:83], v[224:227], v[176:179], v[80:83]
ds_read_b64_tr_b16 v[106:107], v15 offset:16896
v_mfma_f32_16x16x32_bf16 v[68:71], v[228:231], v[172:175], v[68:71]
ds_read_b64_tr_b16 v[108:109], v16 offset:16384
buffer_load_dwordx4 v[160:163], v39, s[32:35], s57 offen sc1
v_mfma_f32_16x16x32_bf16 v[84:87], v[228:231], v[176:179], v[84:87]
ds_read_b64_tr_b16 v[110:111], v16 offset:16896
v_mfma_f32_16x16x32_bf16 v[72:75], v[232:235], v[172:175], v[72:75]
ds_read_b64_tr_b16 v[112:113], v17 offset:16384
v_mfma_f32_16x16x32_bf16 v[88:91], v[232:235], v[176:179], v[88:91]
ds_read_b64_tr_b16 v[114:115], v17 offset:16896
s_waitcnt vmcnt(10) lgkmcnt(8)
v_mfma_f32_16x16x32_bf16 v[60:63], v[236:239], v[180:183], v[60:63]
ds_read_b64_tr_b16 v[220:221], v14 offset:20480
ds_read_b64_tr_b16 v[222:223], v14 offset:20992
v_mfma_f32_16x16x32_bf16 v[76:79], v[236:239], v[184:187], v[76:79]
buffer_load_dwordx4 v[164:167], v38, s[32:35], s57 offen offset:1024 sc1
v_mfma_f32_16x16x32_bf16 v[64:67], v[240:243], v[180:183], v[64:67]
ds_read_b64_tr_b16 v[224:225], v15 offset:20480
v_mfma_f32_16x16x32_bf16 v[80:83], v[240:243], v[184:187], v[80:83]
ds_read_b64_tr_b16 v[226:227], v15 offset:20992
v_mfma_f32_16x16x32_bf16 v[68:71], v[244:247], v[180:183], v[68:71]
ds_read_b64_tr_b16 v[228:229], v16 offset:20480
buffer_load_dwordx4 v[168:171], v39, s[32:35], s57 offen offset:1024 sc1
s_add_u32 s57, s57, 2048
s_and_b32 s57, s57, 0x7fff
v_mfma_f32_16x16x32_bf16 v[84:87], v[244:247], v[184:187], v[84:87]
ds_read_b64_tr_b16 v[230:231], v16 offset:20992
v_mfma_f32_16x16x32_bf16 v[72:75], v[248:251], v[180:183], v[72:75]
ds_read_b64_tr_b16 v[232:233], v17 offset:20480
v_mfma_f32_16x16x32_bf16 v[88:91], v[248:251], v[184:187], v[88:91]
ds_read_b64_tr_b16 v[234:235], v17 offset:20992
s_waitcnt vmcnt(10) lgkmcnt(8)
v_mfma_f32_16x16x32_bf16 v[60:63], v[100:103], v[188:191], v[60:63]
ds_read_b64_tr_b16 v[236:237], v14 offset:24576
ds_read_b64_tr_b16 v[238:239], v14 offset:25088
v_mfma_f32_16x16x32_bf16 v[76:79], v[100:103], v[192:195], v[76:79]
buffer_load_dwordx4 v[172:175], v38, s[32:35], s57 offen sc1
v_mfma_f32_16x16x32_bf16 v[64:67], v[104:107], v[188:191], v[64:67]
ds_read_b64_tr_b16 v[240:241], v15 offset:24576
v_mfma_f32_16x16x32_bf16 v[80:83], v[104:107], v[192:195], v[80:83]
ds_read_b64_tr_b16 v[242:243], v15 offset:25088
v_mfma_f32_16x16x32_bf16 v[68:71], v[108:111], v[188:191], v[68:71]
ds_read_b64_tr_b16 v[244:245], v16 offset:24576
buffer_load_dwordx4 v[176:179], v39, s[32:35], s57 offen sc1
v_mfma_f32_16x16x32_bf16 v[84:87], v[108:111], v[192:195], v[84:87]
ds_read_b64_tr_b16 v[246:247], v16 offset:25088
v_mfma_f32_16x16x32_bf16 v[72:75], v[112:115], v[188:191], v[72:75]
ds_read_b64_tr_b16 v[248:249], v17 offset:24576
v_mfma_f32_16x16x32_bf16 v[88:91], v[112:115], v[192:195], v[88:91]
ds_read_b64_tr_b16 v[250:251], v17 offset:25088
s_waitcnt vmcnt(10) lgkmcnt(8)
v_mfma_f32_16x16x32_bf16 v[60:63], v[220:223], v[196:199], v[60:63]
ds_read_b64_tr_b16 v[100:101], v14 offset:28672
ds_read_b64_tr_b16 v[102:103], v14 offset:29184
v_mfma_f32_16x16x32_bf16 v[76:79], v[220:223], v[200:203], v[76:79]
buffer_load_dwordx4 v[180:183], v38, s[32:35], s57 offen offset:1024 sc1
v_mfma_f32_16x16x32_bf16 v[64:67], v[224:227], v[196:199], v[64:67]
ds_read_b64_tr_b16 v[104:105], v15 offset:28672
v_mfma_f32_16x16x32_bf16 v[80:83], v[224:227], v[200:203], v[80:83]
ds_read_b64_tr_b16 v[106:107], v15 offset:29184
v_mfma_f32_16x16x32_bf16 v[68:71], v[228:231], v[196:199], v[68:71]
ds_read_b64_tr_b16 v[108:109], v16 offset:28672
buffer_load_dwordx4 v[184:187], v39, s[32:35], s57 offen offset:1024 sc1
s_add_u32 s57, s57, 2048
s_and_b32 s57, s57, 0x7fff
v_mfma_f32_16x16x32_bf16 v[84:87], v[228:231], v[200:203], v[84:87]
ds_read_b64_tr_b16 v[110:111], v16 offset:29184
v_mfma_f32_16x16x32_bf16 v[72:75], v[232:235], v[196:199], v[72:75]
ds_read_b64_tr_b16 v[112:113], v17 offset:28672
v_mfma_f32_16x16x32_bf16 v[88:91], v[232:235], v[200:203], v[88:91]
ds_read_b64_tr_b16 v[114:115], v17 offset:29184
s_waitcnt vmcnt(10) lgkmcnt(8)
v_mfma_f32_16x16x32_bf16 v[60:63], v[236:239], v[204:207], v[60:63]
ds_read_b64_tr_b16 v[220:221], v14 offset:32768
ds_read_b64_tr_b16 v[222:223], v14 offset:33280
v_mfma_f32_16x16x32_bf16 v[76:79], v[236:239], v[208:211], v[76:79]
buffer_load_dwordx4 v[188:191], v38, s[32:35], s57 offen sc1
v_mfma_f32_16x16x32_bf16 v[64:67], v[240:243], v[204:207], v[64:67]
ds_read_b64_tr_b16 v[224:225], v15 offset:32768
v_mfma_f32_16x16x32_bf16 v[80:83], v[240:243], v[208:211], v[80:83]
ds_read_b64_tr_b16 v[226:227], v15 offset:33280
v_mfma_f32_16x16x32_bf16 v[68:71], v[244:247], v[204:207], v[68:71]
ds_read_b64_tr_b16 v[228:229], v16 offset:32768
buffer_load_dwordx4 v[192:195], v39, s[32:35], s57 offen sc1
v_mfma_f32_16x16x32_bf16 v[84:87], v[244:247], v[208:211], v[84:87]
ds_read_b64_tr_b16 v[230:231], v16 offset:33280
v_mfma_f32_16x16x32_bf16 v[72:75], v[248:251], v[204:207], v[72:75]
ds_read_b64_tr_b16 v[232:233], v17 offset:32768
v_mfma_f32_16x16x32_bf16 v[88:91], v[248:251], v[208:211], v[88:91]
ds_read_b64_tr_b16 v[234:235], v17 offset:33280
s_waitcnt vmcnt(10) lgkmcnt(8)
v_mfma_f32_16x16x32_bf16 v[60:63], v[100:103], v[212:215], v[60:63]
ds_read_b64_tr_b16 v[236:237], v14 offset:36864
ds_read_b64_tr_b16 v[238:239], v14 offset:37376
v_mfma_f32_16x16x32_bf16 v[76:79], v[100:103], v[216:219], v[76:79]
buffer_load_dwordx4 v[196:199], v38, s[32:35], s57 offen offset:1024 sc1
v_mfma_f32_16x16x32_bf16 v[64:67], v[104:107], v[212:215], v[64:67]
ds_read_b64_tr_b16 v[240:241], v15 offset:36864
v_mfma_f32_16x16x32_bf16 v[80:83], v[104:107], v[216:219], v[80:83]
ds_read_b64_tr_b16 v[242:243], v15 offset:37376
v_mfma_f32_16x16x32_bf16 v[68:71], v[108:111], v[212:215], v[68:71]
ds_read_b64_tr_b16 v[244:245], v16 offset:36864
buffer_load_dwordx4 v[200:203], v39, s[32:35], s57 offen offset:1024 sc1
s_add_u32 s57, s57, 2048
s_and_b32 s57, s57, 0x7fff
v_mfma_f32_16x16x32_bf16 v[84:87], v[108:111], v[216:219], v[84:87]
ds_read_b64_tr_b16 v[246:247], v16 offset:37376
v_mfma_f32_16x16x32_bf16 v[72:75], v[112:115], v[212:215], v[72:75]
ds_read_b64_tr_b16 v[248:249], v17 offset:36864
v_mfma_f32_16x16x32_bf16 v[88:91], v[112:115], v[216:219], v[88:91]
ds_read_b64_tr_b16 v[250:251], v17 offset:37376
s_waitcnt vmcnt(10) lgkmcnt(8)
v_mfma_f32_16x16x32_bf16 v[60:63], v[220:223], v[156:159], v[60:63]
ds_read_b64_tr_b16 v[100:101], v14 offset:40960
ds_read_b64_tr_b16 v[102:103], v14 offset:41472
v_mfma_f32_16x16x32_bf16 v[76:79], v[220:223], v[160:163], v[76:79]
buffer_load_dwordx4 v[204:207], v38, s[32:35], s57 offen sc1
v_mfma_f32_16x16x32_bf16 v[64:67], v[224:227], v[156:159], v[64:67]
ds_read_b64_tr_b16 v[104:105], v15 offset:40960
v_mfma_f32_16x16x32_bf16 v[80:83], v[224:227], v[160:163], v[80:83]
ds_read_b64_tr_b16 v[106:107], v15 offset:41472
v_mfma_f32_16x16x32_bf16 v[68:71], v[228:231], v[156:159], v[68:71]
ds_read_b64_tr_b16 v[108:109], v16 offset:40960
buffer_load_dwordx4 v[208:211], v39, s[32:35], s57 offen sc1
v_mfma_f32_16x16x32_bf16 v[84:87], v[228:231], v[160:163], v[84:87]
ds_read_b64_tr_b16 v[110:111], v16 offset:41472
v_mfma_f32_16x16x32_bf16 v[72:75], v[232:235], v[156:159], v[72:75]
ds_read_b64_tr_b16 v[112:113], v17 offset:40960
v_mfma_f32_16x16x32_bf16 v[88:91], v[232:235], v[160:163], v[88:91]
ds_read_b64_tr_b16 v[114:115], v17 offset:41472
s_waitcnt vmcnt(10) lgkmcnt(8)
v_mfma_f32_16x16x32_bf16 v[60:63], v[236:239], v[164:167], v[60:63]
ds_read_b64_tr_b16 v[220:221], v14 offset:45056
ds_read_b64_tr_b16 v[222:223], v14 offset:45568
v_mfma_f32_16x16x32_bf16 v[76:79], v[236:239], v[168:171], v[76:79]
buffer_load_dwordx4 v[212:215], v38, s[32:35], s57 offen offset:1024 sc1
v_mfma_f32_16x16x32_bf16 v[64:67], v[240:243], v[164:167], v[64:67]
ds_read_b64_tr_b16 v[224:225], v15 offset:45056
v_mfma_f32_16x16x32_bf16 v[80:83], v[240:243], v[168:171], v[80:83]
ds_read_b64_tr_b16 v[226:227], v15 offset:45568
v_mfma_f32_16x16x32_bf16 v[68:71], v[244:247], v[164:167], v[68:71]
ds_read_b64_tr_b16 v[228:229], v16 offset:45056
buffer_load_dwordx4 v[216:219], v39, s[32:35], s57 offen offset:1024 sc1
s_add_u32 s57, s57, 2048
s_and_b32 s57, s57, 0x7fff
v_mfma_f32_16x16x32_bf16 v[84:87], v[244:247], v[168:171], v[84:87]
ds_read_b64_tr_b16 v[230:231], v16 offset:45568
v_mfma_f32_16x16x32_bf16 v[72:75], v[248:251], v[164:167], v[72:75]
ds_read_b64_tr_b16 v[232:233], v17 offset:45056
v_mfma_f32_16x16x32_bf16 v[88:91], v[248:251], v[168:171], v[88:91]
ds_read_b64_tr_b16 v[234:235], v17 offset:45568
s_waitcnt vmcnt(10) lgkmcnt(8)
v_mfma_f32_16x16x32_bf16 v[60:63], v[100:103], v[172:175], v[60:63]
ds_read_b64_tr_b16 v[236:237], v14 offset:49152
v_mfma_f32_16x16x32_bf16 v[76:79], v[100:103], v[176:179], v[76:79]
ds_read_b64_tr_b16 v[238:239], v14 offset:49664
v_mfma_f32_16x16x32_bf16 v[64:67], v[104:107], v[172:175], v[64:67]
ds_read_b64_tr_b16 v[240:241], v15 offset:49152
v_mfma_f32_16x16x32_bf16 v[80:83], v[104:107], v[176:179], v[80:83]
ds_read_b64_tr_b16 v[242:243], v15 offset:49664
v_mfma_f32_16x16x32_bf16 v[68:71], v[108:111], v[172:175], v[68:71]
ds_read_b64_tr_b16 v[244:245], v16 offset:49152
v_mfma_f32_16x16x32_bf16 v[84:87], v[108:111], v[176:179], v[84:87]
ds_read_b64_tr_b16 v[246:247], v16 offset:49664
v_mfma_f32_16x16x32_bf16 v[72:75], v[112:115], v[172:175], v[72:75]
ds_read_b64_tr_b16 v[248:249], v17 offset:49152
v_mfma_f32_16x16x32_bf16 v[88:91], v[112:115], v[176:179], v[88:91]
ds_read_b64_tr_b16 v[250:251], v17 offset:49664
s_waitcnt vmcnt(8) lgkmcnt(8)
v_mfma_f32_16x16x32_bf16 v[60:63], v[220:223], v[180:183], v[60:63]
ds_read_b64_tr_b16 v[100:101], v14 offset:53248
v_mfma_f32_16x16x32_bf16 v[76:79], v[220:223], v[184:187], v[76:79]
ds_read_b64_tr_b16 v[102:103], v14 offset:53760
v_mfma_f32_16x16x32_bf16 v[64:67], v[224:227], v[180:183], v[64:67]
ds_read_b64_tr_b16 v[104:105], v15 offset:53248
v_mfma_f32_16x16x32_bf16 v[80:83], v[224:227], v[184:187], v[80:83]
ds_read_b64_tr_b16 v[106:107], v15 offset:53760
v_mfma_f32_16x16x32_bf16 v[68:71], v[228:231], v[180:183], v[68:71]
ds_read_b64_tr_b16 v[108:109], v16 offset:53248
v_mfma_f32_16x16x32_bf16 v[84:87], v[228:231], v[184:187], v[84:87]
ds_read_b64_tr_b16 v[110:111], v16 offset:53760
v_mfma_f32_16x16x32_bf16 v[72:75], v[232:235], v[180:183], v[72:75]
ds_read_b64_tr_b16 v[112:113], v17 offset:53248
v_mfma_f32_16x16x32_bf16 v[88:91], v[232:235], v[184:187], v[88:91]
ds_read_b64_tr_b16 v[114:115], v17 offset:53760
s_waitcnt vmcnt(6) lgkmcnt(8)
v_mfma_f32_16x16x32_bf16 v[60:63], v[236:239], v[188:191], v[60:63]
ds_read_b64_tr_b16 v[220:221], v14 offset:57344
v_mfma_f32_16x16x32_bf16 v[76:79], v[236:239], v[192:195], v[76:79]
ds_read_b64_tr_b16 v[222:223], v14 offset:57856
v_mfma_f32_16x16x32_bf16 v[64:67], v[240:243], v[188:191], v[64:67]
ds_read_b64_tr_b16 v[224:225], v15 offset:57344
v_mfma_f32_16x16x32_bf16 v[80:83], v[240:243], v[192:195], v[80:83]
ds_read_b64_tr_b16 v[226:227], v15 offset:57856
v_mfma_f32_16x16x32_bf16 v[68:71], v[244:247], v[188:191], v[68:71]
ds_read_b64_tr_b16 v[228:229], v16 offset:57344
v_mfma_f32_16x16x32_bf16 v[84:87], v[244:247], v[192:195], v[84:87]
ds_read_b64_tr_b16 v[230:231], v16 offset:57856
v_mfma_f32_16x16x32_bf16 v[72:75], v[248:251], v[188:191], v[72:75]
ds_read_b64_tr_b16 v[232:233], v17 offset:57344
v_mfma_f32_16x16x32_bf16 v[88:91], v[248:251], v[192:195], v[88:91]
ds_read_b64_tr_b16 v[234:235], v17 offset:57856
s_waitcnt vmcnt(4) lgkmcnt(8)
v_mfma_f32_16x16x32_bf16 v[60:63], v[100:103], v[196:199], v[60:63]
ds_read_b64_tr_b16 v[236:237], v14 offset:61440
v_mfma_f32_16x16x32_bf16 v[76:79], v[100:103], v[200:203], v[76:79]
ds_read_b64_tr_b16 v[238:239], v14 offset:61952
v_mfma_f32_16x16x32_bf16 v[64:67], v[104:107], v[196:199], v[64:67]
ds_read_b64_tr_b16 v[240:241], v15 offset:61440
v_mfma_f32_16x16x32_bf16 v[80:83], v[104:107], v[200:203], v[80:83]
ds_read_b64_tr_b16 v[242:243], v15 offset:61952
v_mfma_f32_16x16x32_bf16 v[68:71], v[108:111], v[196:199], v[68:71]
ds_read_b64_tr_b16 v[244:245], v16 offset:61440
v_mfma_f32_16x16x32_bf16 v[84:87], v[108:111], v[200:203], v[84:87]
ds_read_b64_tr_b16 v[246:247], v16 offset:61952
v_mfma_f32_16x16x32_bf16 v[72:75], v[112:115], v[196:199], v[72:75]
ds_read_b64_tr_b16 v[248:249], v17 offset:61440
v_mfma_f32_16x16x32_bf16 v[88:91], v[112:115], v[200:203], v[88:91]
ds_read_b64_tr_b16 v[250:251], v17 offset:61952
s_waitcnt vmcnt(2) lgkmcnt(8)
v_mfma_f32_16x16x32_bf16 v[60:63], v[220:223], v[204:207], v[60:63]
v_mfma_f32_16x16x32_bf16 v[76:79], v[220:223], v[208:211], v[76:79]
v_mfma_f32_16x16x32_bf16 v[64:67], v[224:227], v[204:207], v[64:67]
v_mfma_f32_16x16x32_bf16 v[80:83], v[224:227], v[208:211], v[80:83]
v_mfma_f32_16x16x32_bf16 v[68:71], v[228:231], v[204:207], v[68:71]
v_mfma_f32_16x16x32_bf16 v[84:87], v[228:231], v[208:211], v[84:87]
v_mfma_f32_16x16x32_bf16 v[72:75], v[232:235], v[204:207], v[72:75]
v_mfma_f32_16x16x32_bf16 v[88:91], v[232:235], v[208:211], v[88:91]
s_waitcnt vmcnt(0) lgkmcnt(0)
v_mfma_f32_16x16x32_bf16 v[60:63], v[236:239], v[212:215], v[60:63]
v_mfma_f32_16x16x32_bf16 v[64:67], v[240:243], v[212:215], v[64:67]
v_mfma_f32_16x16x32_bf16 v[68:71], v[244:247], v[212:215], v[68:71]
v_mfma_f32_16x16x32_bf16 v[72:75], v[248:251], v[212:215], v[72:75]
v_mfma_f32_16x16x32_bf16 v[76:79], v[236:239], v[216:219], v[76:79]
v_mfma_f32_16x16x32_bf16 v[80:83], v[240:243], v[216:219], v[80:83]
v_mfma_f32_16x16x32_bf16 v[84:87], v[244:247], v[216:219], v[84:87]
v_mfma_f32_16x16x32_bf16 v[88:91], v[248:251], v[216:219], v[88:91]
s_cmp_eq_u32 s46, 0
s_cbranch_scc1 slow_92
s_nop 0
v_cvt_pk_bf16_f32 v20, v60, v61
v_cvt_pk_bf16_f32 v21, v62, v63
v_cvt_pk_bf16_f32 v22, v64, v65
v_cvt_pk_bf16_f32 v23, v66, v67
buffer_store_dwordx4 v[20:23], v18, s[32:35], s85 offen offset:0
v_cvt_pk_bf16_f32 v24, v68, v69
v_cvt_pk_bf16_f32 v25, v70, v71
v_cvt_pk_bf16_f32 v26, v72, v73
v_cvt_pk_bf16_f32 v27, v74, v75
buffer_store_dwordx4 v[24:27], v18, s[32:35], s85 offen offset:1024
v_cvt_pk_bf16_f32 v28, v76, v77
v_cvt_pk_bf16_f32 v29, v78, v79
v_cvt_pk_bf16_f32 v30, v80, v81
v_cvt_pk_bf16_f32 v31, v82, v83
buffer_store_dwordx4 v[28:31], v18, s[32:35], s86 offen offset:0
v_cvt_pk_bf16_f32 v32, v84, v85
v_cvt_pk_bf16_f32 v33, v86, v87
v_cvt_pk_bf16_f32 v34, v88, v89
v_cvt_pk_bf16_f32 v35, v90, v91
buffer_store_dwordx4 v[32:35], v18, s[32:35], s86 offen offset:1024
s_barrier
v_dot2c_f32_bf16 v6, v20, v48
v_dot2c_f32_bf16 v8, v20, v20
v_dot2c_f32_bf16 v7, v28, v48
v_dot2c_f32_bf16 v9, v28, v28
v_dot2c_f32_bf16 v6, v21, v48
v_dot2c_f32_bf16 v8, v21, v21
v_dot2c_f32_bf16 v7, v29, v48
v_dot2c_f32_bf16 v9, v29, v29
v_dot2c_f32_bf16 v6, v22, v48
v_dot2c_f32_bf16 v8, v22, v22
v_dot2c_f32_bf16 v7, v30, v48
v_dot2c_f32_bf16 v9, v30, v30
v_dot2c_f32_bf16 v6, v23, v48
v_dot2c_f32_bf16 v8, v23, v23
v_dot2c_f32_bf16 v7, v31, v48
v_dot2c_f32_bf16 v9, v31, v31
v_dot2c_f32_bf16 v6, v24, v48
v_dot2c_f32_bf16 v8, v24, v24
v_dot2c_f32_bf16 v7, v32, v48
v_dot2c_f32_bf16 v9, v32, v32
v_dot2c_f32_bf16 v6, v25, v48
v_dot2c_f32_bf16 v8, v25, v25
v_dot2c_f32_bf16 v7, v33, v48
v_dot2c_f32_bf16 v9, v33, v33
v_dot2c_f32_bf16 v6, v26, v48
v_dot2c_f32_bf16 v8, v26, v26
v_dot2c_f32_bf16 v7, v34, v48
v_dot2c_f32_bf16 v9, v34, v34
v_dot2c_f32_bf16 v6, v27, v48
v_dot2c_f32_bf16 v8, v27, v27
v_dot2c_f32_bf16 v7, v35, v48
v_dot2c_f32_bf16 v9, v35, v35
s_mov_b64 exec, 1
s_waitcnt vmcnt(0)
buffer_store_dword v5, v4, s[32:35], s88 offen
s_mov_b64 exec, -1
s_nop 1
v_permlane32_swap_b32 v6, v7
v_permlane32_swap_b32 v8, v9
v_add_f32 v6, v6, v7
v_add_f32 v8, v8, v9
s_nop 1
v_permlane16_swap_b32 v6, v8
s_nop 0
v_add_f32 v6, v6, v8
buffer_store_dword v6, v1, s[32:35], s87 offen
back_93:
s_lshl_b32 s49, s44, 13
v_add_u32 v10, s49, v18
v_add_u32 v11, 1024, v10
s_lshl_b32 s48, s43, 1
v_lshrrev_b32 v4, 2, v2
v_and_b32 v5, 3, v0
v_lshl_add_u32 v6, v3, 3, v4
v_lshlrev_b32 v6, 7, v6
v_lshl_add_u32 v6, v5, 3, v6
v_lshrrev_b32 v7, 1, v4
v_and_b32 v8, 1, v3
v_lshl_add_u32 v7, v8, 1, v7
v_xor_b32 v7, s48, v7
v_lshl_add_u32 v12, v7, 5, v6
v_add_u32 v12, 16384, v12
v_xor_b32 v13, 32, v12
v_mov_b32 v14, v10
v_mov_b32 v15, v11
v_add_u32 v16, 122880, v12
v_add_u32 v17, 122880, v13
v_mov_b32 v156, 0
v_mov_b32 v157, 0
v_mov_b32 v158, 0
v_mov_b32 v159, 0
v_mov_b32 v160, 0
v_mov_b32 v161, 0
v_mov_b32 v162, 0
v_mov_b32 v163, 0
v_mov_b32 v164, 0
v_mov_b32 v165, 0
v_mov_b32 v166, 0
v_mov_b32 v167, 0
v_mov_b32 v168, 0
v_mov_b32 v169, 0
v_mov_b32 v170, 0
v_mov_b32 v171, 0
v_mov_b32 v172, 0
v_mov_b32 v173, 0
v_mov_b32 v174, 0
v_mov_b32 v175, 0
v_mov_b32 v176, 0
v_mov_b32 v177, 0
v_mov_b32 v178, 0
v_mov_b32 v179, 0
v_mov_b32 v180, 0
v_mov_b32 v181, 0
v_mov_b32 v182, 0
v_mov_b32 v183, 0
v_mov_b32 v184, 0
v_mov_b32 v185, 0
v_mov_b32 v186, 0
v_mov_b32 v187, 0
v_mov_b32 v188, 0
v_mov_b32 v189, 0
v_mov_b32 v190, 0
v_mov_b32 v191, 0
v_mov_b32 v192, 0
v_mov_b32 v193, 0
v_mov_b32 v194, 0
v_mov_b32 v195, 0
v_mov_b32 v196, 0
v_mov_b32 v197, 0
v_mov_b32 v198, 0
v_mov_b32 v199, 0
v_mov_b32 v200, 0
v_mov_b32 v201, 0
v_mov_b32 v202, 0
v_mov_b32 v203, 0
v_mov_b32 v204, 0
v_mov_b32 v205, 0
v_mov_b32 v206, 0
v_mov_b32 v207, 0
v_mov_b32 v208, 0
v_mov_b32 v209, 0
v_mov_b32 v210, 0
v_mov_b32 v211, 0
v_mov_b32 v212, 0
v_mov_b32 v213, 0
v_mov_b32 v214, 0
v_mov_b32 v215, 0
v_mov_b32 v216, 0
v_mov_b32 v217, 0
v_mov_b32 v218, 0
v_mov_b32 v219, 0
v_mov_b32 v220, 0
v_mov_b32 v221, 0
v_mov_b32 v222, 0
v_mov_b32 v223, 0
v_mov_b32 v224, 0
v_mov_b32 v225, 0
v_mov_b32 v226, 0
v_mov_b32 v227, 0
v_mov_b32 v228, 0
v_mov_b32 v229, 0
v_mov_b32 v230, 0
v_mov_b32 v231, 0
v_mov_b32 v232, 0
v_mov_b32 v233, 0
v_mov_b32 v234, 0
v_mov_b32 v235, 0
v_mov_b32 v236, 0
v_mov_b32 v237, 0
v_mov_b32 v238, 0
v_mov_b32 v239, 0
v_mov_b32 v240, 0
v_mov_b32 v241, 0
v_mov_b32 v242, 0
v_mov_b32 v243, 0
v_mov_b32 v244, 0
v_mov_b32 v245, 0
v_mov_b32 v246, 0
v_mov_b32 v247, 0
v_mov_b32 v248, 0
v_mov_b32 v249, 0
v_mov_b32 v250, 0
v_mov_b32 v251, 0
v_lshrrev_b32 v6, 2, v2
v_cmp_eq_u32 vcc, v6, v3
v_and_b32 v7, 1, v0
v_lshlrev_b32 v7, 4, v7
v_mov_b32 v8, 0x3f80
v_lshlrev_b32 v9, v7, v8
v_cndmask_b32 v7, 0, v9, vcc
v_and_b32 v6, 2, v0
v_cmp_eq_u32 vcc, 0, v6
v_mov_b32 v36, 0
v_mov_b32 v37, 0
v_mov_b32 v40, 0
v_mov_b32 v41, 0
v_cndmask_b32 v38, 0, v7, vcc
v_cndmask_b32 v39, v7, 0, vcc
v_lshrrev_b32 v8, 1, v2
v_cmp_eq_u32 vcc, 0, v8
s_nop 1
v_cndmask_b32 v44, 0, v9, vcc
v_cmp_eq_u32 vcc, 1, v8
s_nop 1
v_cndmask_b32 v45, 0, v9, vcc
v_cmp_eq_u32 vcc, 2, v8
s_nop 1
v_cndmask_b32 v46, 0, v9, vcc
v_cmp_eq_u32 vcc, 3, v8
s_nop 1
v_cndmask_b32 v47, 0, v9, vcc
v_lshrrev_b32 v4, 2, v2
v_lshl_add_u32 v4, v3, 2, v4
v_lshlrev_b32 v4, 6, v4
v_and_b32 v5, 3, v0
v_lshl_add_u32 v4, v5, 3, v4
s_lshl_b32 s48, s43, 11
s_add_u32 s48, s48, 135168
v_add_u32 v53, s48, v4
s_mul_i32 s48, s40, 3072
s_add_u32 s48, s48, 139264
v_add_u32 v42, s48, v18
s_xor_b32 s49, s40, 2
s_mul_i32 s48, s49, 3072
s_add_u32 s48, s48, 139264
v_add_u32 v43, s48, v18
s_lshl_b32 s49, s49, 2
s_add_u32 s49, s49, 134672
v_mov_b32 v19, s49
v_xor_b32 v52, 8, v19
v_lshrrev_b32 v4, 3, v0
v_and_b32 v5, 7, v0
v_lshlrev_b32 v4, 11, v4
v_lshl_add_u32 v55, v5, 4, v4
v_lshlrev_b32 v4, 6, v2
v_lshl_add_u32 v58, v3, 4, v4
v_lshlrev_b32 v4, 4, v2
v_lshl_add_u32 v59, v3, 3, v4
s_lshl_b32 s48, s45, 16
s_lshl_b32 s49, s44, 15
s_add_u32 s48, s48, s49
s_add_u32 s48, s48, 12582912
s_lshl_b32 s49, s41, 7
s_add_u32 s53, s48, s49
s_add_u32 s54, s53, 16384
s_lshl_b32 s50, s41, 11
s_add_u32 s55, s48, s50
s_lshl_b32 s56, s45, 11
s_lshl_b32 s50, s44, 10
s_add_u32 s56, s56, s50
s_lshl_b32 s58, s56, 1
s_add_u32 s56, s56, 14745600
s_xor_b32 s57, s56, 1024
s_add_u32 s58, s58, 14942208
s_xor_b32 s59, s58, 2048
s_add_u32 s79, s58, s49
s_lshl_b32 s48, s43, 7
s_add_u32 s48, s48, 133888
v_lshl_add_u32 v7, v3, 4, s48
v_lshl_add_u32 v54, v2, 2, s48
s_lshl_b32 s49, s44, 6
v_add_u32 v8, s49, v2
v_lshlrev_b32 v8, 3, v8
v_add_u32 v8, 131072, v8
v_lshl_add_u32 v9, v3, 2, s49
v_lshlrev_b32 v9, 2, v9
v_add_u32 v9, 132096, v9
s_mov_b32 s64, 0
s_mov_b32 s65, 0
s_mov_b32 s66, 0x3fb8aa3b
s_waitcnt vmcnt(0)
s_cmp_eq_u32 s46, 0
s_cbranch_scc1 slow_94
s_lshl_b32 s62, s42, 2
v_mov_b32 v4, s62
v_mov_b32 v5, 3
s_mov_b64 exec, 1
buffer_store_dword v5, v4, s[32:35], s89 offen
s_mov_b64 exec, -1
back_95:
s_barrier
ds_read_b128 v[60:63], v14 offset:0
ds_read_b128 v[64:67], v14 offset:2048
ds_read_b128 v[68:71], v14 offset:4096
ds_read_b128 v[72:75], v14 offset:6144
ds_read_b64_tr_b16 v[84:85], v16 offset:8192
ds_read_b64_tr_b16 v[86:87], v16 offset:8704
ds_read_b64_tr_b16 v[88:89], v17 offset:8192
ds_read_b64_tr_b16 v[90:91], v17 offset:8704
ds_read_b64_tr_b16 v[92:93], v16 offset:16384
ds_read_b64_tr_b16 v[94:95], v16 offset:16896
ds_read_b64_tr_b16 v[96:97], v17 offset:16384
ds_read_b64_tr_b16 v[98:99], v17 offset:16896
ds_read_b64_tr_b16 v[76:77], v16 offset:0
ds_read_b64_tr_b16 v[78:79], v16 offset:512
ds_read_b64_tr_b16 v[80:81], v17 offset:0
ds_read_b64_tr_b16 v[82:83], v17 offset:512
s_waitcnt lgkmcnt(0)
c3_loop:
v_mfma_f32_16x16x32_bf16 v[212:215], v[84:87], v[72:75], v[212:215]
ds_read_b128 v[100:103], v15 offset:0
v_mfma_f32_16x16x32_bf16 v[204:207], v[84:87], v[68:71], v[204:207]
ds_read_b128 v[104:107], v15 offset:2048
v_mfma_f32_16x16x32_bf16 v[196:199], v[84:87], v[64:67], v[196:199]
ds_read_b128 v[108:111], v15 offset:4096
v_mfma_f32_16x16x32_bf16 v[188:191], v[84:87], v[60:63], v[188:191]
ds_read_b128 v[112:115], v15 offset:6144
v_mfma_f32_16x16x32_bf16 v[192:195], v[88:91], v[60:63], v[192:195]
ds_read_b64_tr_b16 v[124:125], v16 offset:12288
v_mfma_f32_16x16x32_bf16 v[200:203], v[88:91], v[64:67], v[200:203]
ds_read_b64_tr_b16 v[126:127], v16 offset:12800
v_mfma_f32_16x16x32_bf16 v[208:211], v[88:91], v[68:71], v[208:211]
ds_read_b64_tr_b16 v[128:129], v17 offset:12288
v_mfma_f32_16x16x32_bf16 v[216:219], v[88:91], v[72:75], v[216:219]
ds_read_b64_tr_b16 v[130:131], v17 offset:12800
v_mfma_f32_16x16x32_bf16 v[244:247], v[72:75], v[92:95], v[244:247]
ds_read_b64_tr_b16 v[132:133], v16 offset:20480
v_mfma_f32_16x16x32_bf16 v[236:239], v[68:71], v[92:95], v[236:239]
ds_read_b64_tr_b16 v[134:135], v16 offset:20992
v_mfma_f32_16x16x32_bf16 v[228:231], v[64:67], v[92:95], v[228:231]
ds_read_b64_tr_b16 v[136:137], v17 offset:20480
v_mfma_f32_16x16x32_bf16 v[220:223], v[60:63], v[92:95], v[220:223]
ds_read_b64_tr_b16 v[138:139], v17 offset:20992
v_mfma_f32_16x16x32_bf16 v[224:227], v[60:63], v[96:99], v[224:227]
ds_read_b64_tr_b16 v[116:117], v16 offset:4096
v_mfma_f32_16x16x32_bf16 v[232:235], v[64:67], v[96:99], v[232:235]
ds_read_b64_tr_b16 v[118:119], v16 offset:4608
v_mfma_f32_16x16x32_bf16 v[240:243], v[68:71], v[96:99], v[240:243]
ds_read_b64_tr_b16 v[120:121], v17 offset:4096
v_mfma_f32_16x16x32_bf16 v[248:251], v[72:75], v[96:99], v[248:251]
ds_read_b64_tr_b16 v[122:123], v17 offset:4608
v_mfma_f32_16x16x32_bf16 v[180:183], v[76:79], v[72:75], v[180:183]
s_add_u32 s65, s65, 40960
s_cmp_eq_u32 s65, 122880
v_mfma_f32_16x16x32_bf16 v[172:175], v[76:79], v[68:71], v[172:175]
s_cselect_b32 s65, 0, s65
s_add_u32 s64, s64, 1
v_mfma_f32_16x16x32_bf16 v[164:167], v[76:79], v[64:67], v[164:167]
v_add_u32 v14, s65, v10
v_add_u32 v15, s65, v11
v_mfma_f32_16x16x32_bf16 v[156:159], v[76:79], v[60:63], v[156:159]
v_add_u32 v16, s65, v12
v_add_u32 v17, s65, v13
v_mfma_f32_16x16x32_bf16 v[160:163], v[80:83], v[60:63], v[160:163]
v_mfma_f32_16x16x32_bf16 v[168:171], v[80:83], v[64:67], v[168:171]
s_cmp_eq_u32 s64, 16
s_cbranch_scc1 c3_last
v_mfma_f32_16x16x32_bf16 v[176:179], v[80:83], v[68:71], v[176:179]
s_waitcnt lgkmcnt(0)
v_mfma_f32_16x16x32_bf16 v[184:187], v[80:83], v[72:75], v[184:187]
s_barrier
v_mfma_f32_16x16x32_bf16 v[212:215], v[124:127], v[112:115], v[212:215]
ds_read_b128 v[60:63], v14 offset:0
v_mfma_f32_16x16x32_bf16 v[204:207], v[124:127], v[108:111], v[204:207]
ds_read_b128 v[64:67], v14 offset:2048
v_mfma_f32_16x16x32_bf16 v[196:199], v[124:127], v[104:107], v[196:199]
ds_read_b128 v[68:71], v14 offset:4096
v_mfma_f32_16x16x32_bf16 v[188:191], v[124:127], v[100:103], v[188:191]
ds_read_b128 v[72:75], v14 offset:6144
v_mfma_f32_16x16x32_bf16 v[192:195], v[128:131], v[100:103], v[192:195]
ds_read_b64_tr_b16 v[84:85], v16 offset:8192
v_mfma_f32_16x16x32_bf16 v[200:203], v[128:131], v[104:107], v[200:203]
ds_read_b64_tr_b16 v[86:87], v16 offset:8704
v_mfma_f32_16x16x32_bf16 v[208:211], v[128:131], v[108:111], v[208:211]
ds_read_b64_tr_b16 v[88:89], v17 offset:8192
v_mfma_f32_16x16x32_bf16 v[216:219], v[128:131], v[112:115], v[216:219]
ds_read_b64_tr_b16 v[90:91], v17 offset:8704
v_mfma_f32_16x16x32_bf16 v[244:247], v[112:115], v[132:135], v[244:247]
ds_read_b64_tr_b16 v[92:93], v16 offset:16384
v_mfma_f32_16x16x32_bf16 v[236:239], v[108:111], v[132:135], v[236:239]
ds_read_b64_tr_b16 v[94:95], v16 offset:16896
v_mfma_f32_16x16x32_bf16 v[228:231], v[104:107], v[132:135], v[228:231]
ds_read_b64_tr_b16 v[96:97], v17 offset:16384
v_mfma_f32_16x16x32_bf16 v[220:223], v[100:103], v[132:135], v[220:223]
ds_read_b64_tr_b16 v[98:99], v17 offset:16896
v_mfma_f32_16x16x32_bf16 v[224:227], v[100:103], v[136:139], v[224:227]
ds_read_b64_tr_b16 v[76:77], v16 offset:0
v_mfma_f32_16x16x32_bf16 v[232:235], v[104:107], v[136:139], v[232:235]
ds_read_b64_tr_b16 v[78:79], v16 offset:512
v_mfma_f32_16x16x32_bf16 v[240:243], v[108:111], v[136:139], v[240:243]
ds_read_b64_tr_b16 v[80:81], v17 offset:0
v_mfma_f32_16x16x32_bf16 v[248:251], v[112:115], v[136:139], v[248:251]
ds_read_b64_tr_b16 v[82:83], v17 offset:512
v_mfma_f32_16x16x32_bf16 v[180:183], v[116:119], v[112:115], v[180:183]
v_mfma_f32_16x16x32_bf16 v[172:175], v[116:119], v[108:111], v[172:175]
v_mfma_f32_16x16x32_bf16 v[164:167], v[116:119], v[104:107], v[164:167]
v_mfma_f32_16x16x32_bf16 v[156:159], v[116:119], v[100:103], v[156:159]
v_mfma_f32_16x16x32_bf16 v[160:163], v[120:123], v[100:103], v[160:163]
v_mfma_f32_16x16x32_bf16 v[168:171], v[120:123], v[104:107], v[168:171]
v_mfma_f32_16x16x32_bf16 v[176:179], v[120:123], v[108:111], v[176:179]
s_waitcnt lgkmcnt(0)
v_mfma_f32_16x16x32_bf16 v[184:187], v[120:123], v[112:115], v[184:187]
s_branch c3_loop
c3_last:
v_mfma_f32_16x16x32_bf16 v[176:179], v[80:83], v[68:71], v[176:179]
s_waitcnt lgkmcnt(0)
v_mfma_f32_16x16x32_bf16 v[184:187], v[80:83], v[72:75], v[184:187]
s_barrier
v_mfma_f32_16x16x32_bf16 v[212:215], v[124:127], v[112:115], v[212:215]
ds_read_b128 v[140:143], v7 offset:0
v_mfma_f32_16x16x32_bf16 v[204:207], v[124:127], v[108:111], v[204:207]
ds_read_b128 v[144:147], v7 offset:64
v_mfma_f32_16x16x32_bf16 v[196:199], v[124:127], v[104:107], v[196:199]
ds_read_b128 v[148:151], v7 offset:256
v_mfma_f32_16x16x32_bf16 v[188:191], v[124:127], v[100:103], v[188:191]
ds_read_b128 v[152:155], v7 offset:320
v_mfma_f32_16x16x32_bf16 v[192:195], v[128:131], v[100:103], v[192:195]
ds_read_b64 v[92:93], v8 offset:0
v_mfma_f32_16x16x32_bf16 v[200:203], v[128:131], v[104:107], v[200:203]
ds_read_b64 v[94:95], v8 offset:128
v_mfma_f32_16x16x32_bf16 v[208:211], v[128:131], v[108:111], v[208:211]
ds_read_b64 v[96:97], v8 offset:256
v_mfma_f32_16x16x32_bf16 v[216:219], v[128:131], v[112:115], v[216:219]
ds_read_b64 v[98:99], v8 offset:384
v_mfma_f32_16x16x32_bf16 v[244:247], v[112:115], v[132:135], v[244:247]
ds_read2_b32 v[56:57], v54 offset0:128 offset1:144
v_mfma_f32_16x16x32_bf16 v[236:239], v[108:111], v[132:135], v[236:239]
ds_read_b128 v[60:63], v9 offset:0
v_mfma_f32_16x16x32_bf16 v[228:231], v[104:107], v[132:135], v[228:231]
ds_read_b128 v[64:67], v9 offset:64
v_mfma_f32_16x16x32_bf16 v[220:223], v[100:103], v[132:135], v[220:223]
ds_read_b128 v[68:71], v9 offset:128
v_mfma_f32_16x16x32_bf16 v[224:227], v[100:103], v[136:139], v[224:227]
ds_read_b128 v[72:75], v9 offset:192
v_mfma_f32_16x16x32_bf16 v[232:235], v[104:107], v[136:139], v[232:235]
ds_read_b128 v[76:79], v9 offset:512
v_mfma_f32_16x16x32_bf16 v[240:243], v[108:111], v[136:139], v[240:243]
ds_read_b128 v[80:83], v9 offset:576
v_mfma_f32_16x16x32_bf16 v[248:251], v[112:115], v[136:139], v[248:251]
ds_read_b128 v[84:87], v9 offset:640
v_mfma_f32_16x16x32_bf16 v[180:183], v[116:119], v[112:115], v[180:183]
ds_read_b128 v[88:91], v9 offset:704
v_mfma_f32_16x16x32_bf16 v[172:175], v[116:119], v[108:111], v[172:175]
ds_read_b64_tr_b16 v[10:11], v53 offset:0
v_mfma_f32_16x16x32_bf16 v[164:167], v[116:119], v[104:107], v[164:167]
ds_read_b64_tr_b16 v[12:13], v53 offset:1024
v_mfma_f32_16x16x32_bf16 v[156:159], v[116:119], v[100:103], v[156:159]
ds_read_b64_tr_b16 v[14:15], v53 offset:32
v_mfma_f32_16x16x32_bf16 v[160:163], v[120:123], v[100:103], v[160:163]
ds_read_b64_tr_b16 v[16:17], v53 offset:1056
v_mfma_f32_16x16x32_bf16 v[168:171], v[120:123], v[104:107], v[168:171]
v_mfma_f32_16x16x32_bf16 v[176:179], v[120:123], v[108:111], v[176:179]
v_mfma_f32_16x16x32_bf16 v[184:187], v[120:123], v[112:115], v[184:187]
c3_epi:
s_waitcnt lgkmcnt(0)
s_mul_i32 s48, s44, 0x80008000
v_xor_b32 v10, s48, v10
v_xor_b32 v11, s48, v11
v_xor_b32 v12, s48, v12
v_xor_b32 v13, s48, v13
v_xor_b32 v14, s48, v14
v_xor_b32 v15, s48, v15
v_xor_b32 v16, s48, v16
v_xor_b32 v17, s48, v17
v_mul_f32 v128, s66, v92
v_mul_f32 v129, s66, v94
v_mul_f32 v130, s66, v96
v_mul_f32 v131, s66, v98
.p2align 3
v_pk_fma_f32 v[220:221], v[76:77], v[56:57], v[220:221] op_sel:[0,0,0] op_sel_hi:[1,0,1]
v_pk_fma_f32 v[222:223], v[78:79], v[56:57], v[222:223] op_sel:[0,0,0] op_sel_hi:[1,0,1]
v_pk_mul_f32 v[220:221], v[220:221], v[60:61]
v_pk_mul_f32 v[222:223], v[222:223], v[62:63]
v_cvt_pk_bf16_f32 v112, v220, v221
v_cvt_pk_bf16_f32 v113, v222, v223
v_pk_fma_f32 v[228:229], v[80:81], v[56:57], v[228:229] op_sel:[0,0,0] op_sel_hi:[1,0,1]
v_pk_fma_f32 v[230:231], v[82:83], v[56:57], v[230:231] op_sel:[0,0,0] op_sel_hi:[1,0,1]
v_pk_mul_f32 v[228:229], v[228:229], v[64:65]
v_pk_mul_f32 v[230:231], v[230:231], v[66:67]
v_cvt_pk_bf16_f32 v114, v228, v229
v_cvt_pk_bf16_f32 v115, v230, v231
v_pk_fma_f32 v[236:237], v[84:85], v[56:57], v[236:237] op_sel:[0,0,0] op_sel_hi:[1,0,1]
v_pk_fma_f32 v[238:239], v[86:87], v[56:57], v[238:239] op_sel:[0,0,0] op_sel_hi:[1,0,1]
v_pk_mul_f32 v[236:237], v[236:237], v[68:69]
v_pk_mul_f32 v[238:239], v[238:239], v[70:71]
v_cvt_pk_bf16_f32 v116, v236, v237
v_cvt_pk_bf16_f32 v117, v238, v239
v_pk_fma_f32 v[244:245], v[88:89], v[56:57], v[244:245] op_sel:[0,0,0] op_sel_hi:[1,0,1]
v_pk_fma_f32 v[246:247], v[90:91], v[56:57], v[246:247] op_sel:[0,0,0] op_sel_hi:[1,0,1]
v_pk_mul_f32 v[244:245], v[244:245], v[72:73]
v_pk_mul_f32 v[246:247], v[246:247], v[74:75]
v_cvt_pk_bf16_f32 v118, v244, v245
v_cvt_pk_bf16_f32 v119, v246, v247
v_pk_fma_f32 v[224:225], v[76:77], v[56:57], v[224:225] op_sel:[0,1,0] op_sel_hi:[1,1,1]
v_pk_fma_f32 v[226:227], v[78:79], v[56:57], v[226:227] op_sel:[0,1,0] op_sel_hi:[1,1,1]
v_pk_mul_f32 v[224:225], v[224:225], v[60:61]
v_pk_mul_f32 v[226:227], v[226:227], v[62:63]
v_cvt_pk_bf16_f32 v120, v224, v225
v_cvt_pk_bf16_f32 v121, v226, v227
v_pk_fma_f32 v[232:233], v[80:81], v[56:57], v[232:233] op_sel:[0,1,0] op_sel_hi:[1,1,1]
v_pk_fma_f32 v[234:235], v[82:83], v[56:57], v[234:235] op_sel:[0,1,0] op_sel_hi:[1,1,1]
v_pk_mul_f32 v[232:233], v[232:233], v[64:65]
v_pk_mul_f32 v[234:235], v[234:235], v[66:67]
v_cvt_pk_bf16_f32 v122, v232, v233
v_cvt_pk_bf16_f32 v123, v234, v235
v_pk_fma_f32 v[240:241], v[84:85], v[56:57], v[240:241] op_sel:[0,1,0] op_sel_hi:[1,1,1]
v_pk_fma_f32 v[242:243], v[86:87], v[56:57], v[242:243] op_sel:[0,1,0] op_sel_hi:[1,1,1]
v_pk_mul_f32 v[240:241], v[240:241], v[68:69]
v_pk_mul_f32 v[242:243], v[242:243], v[70:71]
v_cvt_pk_bf16_f32 v124, v240, v241
v_cvt_pk_bf16_f32 v125, v242, v243
v_pk_fma_f32 v[248:249], v[88:89], v[56:57], v[248:249] op_sel:[0,1,0] op_sel_hi:[1,1,1]
v_pk_fma_f32 v[250:251], v[90:91], v[56:57], v[250:251] op_sel:[0,1,0] op_sel_hi:[1,1,1]
v_pk_mul_f32 v[248:249], v[248:249], v[72:73]
v_pk_mul_f32 v[250:251], v[250:251], v[74:75]
v_cvt_pk_bf16_f32 v126, v248, v249
v_cvt_pk_bf16_f32 v127, v250, v251
v_pk_fma_f32 v[188:189], v[148:149], v[92:93], v[188:189] op_sel:[0,1,0] op_sel_hi:[1,1,1]
v_pk_fma_f32 v[190:191], v[150:151], v[92:93], v[190:191] op_sel:[0,1,0] op_sel_hi:[1,1,1]
v_pk_fma_f32 v[192:193], v[152:153], v[92:93], v[192:193] op_sel:[0,1,0] op_sel_hi:[1,1,1]
v_pk_fma_f32 v[194:195], v[154:155], v[92:93], v[194:195] op_sel:[0,1,0] op_sel_hi:[1,1,1]
v_cvt_pk_bf16_f32 v188, v188, v189
v_cvt_pk_bf16_f32 v189, v190, v191
v_cvt_pk_bf16_f32 v190, v192, v193
v_cvt_pk_bf16_f32 v191, v194, v195
v_pk_fma_f32 v[196:197], v[148:149], v[94:95], v[196:197] op_sel:[0,1,0] op_sel_hi:[1,1,1]
v_pk_fma_f32 v[198:199], v[150:151], v[94:95], v[198:199] op_sel:[0,1,0] op_sel_hi:[1,1,1]
v_pk_fma_f32 v[200:201], v[152:153], v[94:95], v[200:201] op_sel:[0,1,0] op_sel_hi:[1,1,1]
v_pk_fma_f32 v[202:203], v[154:155], v[94:95], v[202:203] op_sel:[0,1,0] op_sel_hi:[1,1,1]
v_cvt_pk_bf16_f32 v196, v196, v197
v_mfma_f32_16x16x32_bf16 v[60:63], v[10:13], v[188:191], 0
v_cvt_pk_bf16_f32 v197, v198, v199
v_cvt_pk_bf16_f32 v198, v200, v201
v_mfma_f32_16x16x32_bf16 v[64:67], v[14:17], v[188:191], 0
v_cvt_pk_bf16_f32 v199, v202, v203
v_pk_fma_f32 v[204:205], v[148:149], v[96:97], v[204:205] op_sel:[0,1,0] op_sel_hi:[1,1,1]
v_pk_fma_f32 v[206:207], v[150:151], v[96:97], v[206:207] op_sel:[0,1,0] op_sel_hi:[1,1,1]
v_pk_fma_f32 v[208:209], v[152:153], v[96:97], v[208:209] op_sel:[0,1,0] op_sel_hi:[1,1,1]
v_pk_fma_f32 v[210:211], v[154:155], v[96:97], v[210:211] op_sel:[0,1,0] op_sel_hi:[1,1,1]
v_cvt_pk_bf16_f32 v204, v204, v205
v_mfma_f32_16x16x32_bf16 v[68:71], v[10:13], v[196:199], 0
v_cvt_pk_bf16_f32 v205, v206, v207
v_cvt_pk_bf16_f32 v206, v208, v209
v_mfma_f32_16x16x32_bf16 v[72:75], v[14:17], v[196:199], 0
v_cvt_pk_bf16_f32 v207, v210, v211
v_pk_fma_f32 v[212:213], v[148:149], v[98:99], v[212:213] op_sel:[0,1,0] op_sel_hi:[1,1,1]
v_pk_fma_f32 v[214:215], v[150:151], v[98:99], v[214:215] op_sel:[0,1,0] op_sel_hi:[1,1,1]
v_pk_fma_f32 v[216:217], v[152:153], v[98:99], v[216:217] op_sel:[0,1,0] op_sel_hi:[1,1,1]
v_pk_fma_f32 v[218:219], v[154:155], v[98:99], v[218:219] op_sel:[0,1,0] op_sel_hi:[1,1,1]
v_cvt_pk_bf16_f32 v212, v212, v213
v_mfma_f32_16x16x32_bf16 v[76:79], v[10:13], v[204:207], 0
v_cvt_pk_bf16_f32 v213, v214, v215
v_cvt_pk_bf16_f32 v214, v216, v217
v_mfma_f32_16x16x32_bf16 v[80:83], v[14:17], v[204:207], 0
v_cvt_pk_bf16_f32 v215, v218, v219
s_nop 1
v_mfma_f32_16x16x32_bf16 v[84:87], v[10:13], v[212:215], 0
v_mfma_f32_16x16x32_bf16 v[88:91], v[14:17], v[212:215], 0
v_max3_f32 v100, v60, v61, v62
v_min3_f32 v104, v60, v61, v62
v_max3_f32 v100, v100, v63, v64
v_min3_f32 v104, v104, v63, v64
v_max3_f32 v100, v100, v65, v66
v_min3_f32 v104, v104, v65, v66
v_max_f32 v100, v100, v67
v_min_f32 v104, v104, v67
v_max3_f32 v101, v68, v69, v70
v_min3_f32 v105, v68, v69, v70
v_max3_f32 v101, v101, v71, v72
v_min3_f32 v105, v105, v71, v72
v_max3_f32 v101, v101, v73, v74
v_min3_f32 v105, v105, v73, v74
v_max_f32 v101, v101, v75
v_min_f32 v105, v105, v75
v_max3_f32 v102, v76, v77, v78
v_min3_f32 v106, v76, v77, v78
v_max3_f32 v102, v102, v79, v80
v_min3_f32 v106, v106, v79, v80
v_max3_f32 v102, v102, v81, v82
v_min3_f32 v106, v106, v81, v82
v_max_f32 v102, v102, v83
v_min_f32 v106, v106, v83
v_max3_f32 v103, v84, v85, v86
v_min3_f32 v107, v84, v85, v86
v_max3_f32 v103, v103, v87, v88
v_min3_f32 v107, v107, v87, v88
v_max3_f32 v103, v103, v89, v90
v_min3_f32 v107, v107, v89, v90
v_max_f32 v103, v103, v91
v_min_f32 v107, v107, v91
s_nop 1
v_permlane32_swap_b32 v100, v101
v_permlane32_swap_b32 v102, v103
v_permlane32_swap_b32 v104, v105
v_permlane32_swap_b32 v106, v107
v_max_f32 v100, v100, v101
v_max_f32 v102, v102, v103
v_min_f32 v104, v104, v105
v_min_f32 v106, v106, v107
v_permlane16_swap_b32 v100, v102
s_nop 0
v_permlane16_swap_b32 v104, v106
v_max_f32 v100, v100, v102
v_min_f32 v104, v104, v106
v_mov_b32 v102, v100
v_mov_b32 v106, v104
s_nop 0
v_permlane16_swap_b32 v100, v102
v_permlane16_swap_b32 v104, v106
v_mov_b32 v101, v100
v_mov_b32 v103, v102
v_mov_b32 v105, v104
v_mov_b32 v107, v106
v_permlane32_swap_b32 v100, v101
v_permlane32_swap_b32 v102, v103
v_permlane32_swap_b32 v104, v105
v_permlane32_swap_b32 v106, v107
v_pk_mul_f32 v[100:101], v[100:101], v[128:129]
v_pk_mul_f32 v[102:103], v[102:103], v[130:131]
v_pk_mul_f32 v[104:105], v[104:105], v[128:129]
v_pk_mul_f32 v[106:107], v[106:107], v[130:131]
v_pk_fma_f32 v[220:221], v[60:61], v[128:129], v[104:105] op_sel:[0,0,0] op_sel_hi:[1,0,0] neg_lo:[1,0,0] neg_hi:[1,0,0]
v_pk_fma_f32 v[60:61], v[60:61], v[128:129], v[100:101] op_sel:[0,0,0] op_sel_hi:[1,0,0] neg_lo:[0,0,1] neg_hi:[0,0,1]
v_exp_f32 v220, v220
v_exp_f32 v60, v60
v_exp_f32 v221, v221
v_exp_f32 v61, v61
v_pk_fma_f32 v[222:223], v[62:63], v[128:129], v[104:105] op_sel:[0,0,0] op_sel_hi:[1,0,0] neg_lo:[1,0,0] neg_hi:[1,0,0]
v_pk_fma_f32 v[62:63], v[62:63], v[128:129], v[100:101] op_sel:[0,0,0] op_sel_hi:[1,0,0] neg_lo:[0,0,1] neg_hi:[0,0,1]
v_exp_f32 v222, v222
v_exp_f32 v62, v62
v_exp_f32 v223, v223
v_exp_f32 v63, v63
v_pk_fma_f32 v[224:225], v[64:65], v[128:129], v[104:105] op_sel:[0,0,0] op_sel_hi:[1,0,0] neg_lo:[1,0,0] neg_hi:[1,0,0]
v_pk_fma_f32 v[64:65], v[64:65], v[128:129], v[100:101] op_sel:[0,0,0] op_sel_hi:[1,0,0] neg_lo:[0,0,1] neg_hi:[0,0,1]
v_exp_f32 v224, v224
v_exp_f32 v64, v64
v_exp_f32 v225, v225
v_exp_f32 v65, v65
v_pk_fma_f32 v[226:227], v[66:67], v[128:129], v[104:105] op_sel:[0,0,0] op_sel_hi:[1,0,0] neg_lo:[1,0,0] neg_hi:[1,0,0]
v_pk_fma_f32 v[66:67], v[66:67], v[128:129], v[100:101] op_sel:[0,0,0] op_sel_hi:[1,0,0] neg_lo:[0,0,1] neg_hi:[0,0,1]
v_exp_f32 v226, v226
v_exp_f32 v66, v66
v_exp_f32 v227, v227
v_exp_f32 v67, v67
v_pk_fma_f32 v[228:229], v[68:69], v[128:129], v[104:105] op_sel:[0,1,1] op_sel_hi:[1,1,1] neg_lo:[1,0,0] neg_hi:[1,0,0]
v_pk_fma_f32 v[68:69], v[68:69], v[128:129], v[100:101] op_sel:[0,1,1] op_sel_hi:[1,1,1] neg_lo:[0,0,1] neg_hi:[0,0,1]
v_exp_f32 v228, v228
v_exp_f32 v68, v68
v_exp_f32 v229, v229
v_exp_f32 v69, v69
v_pk_fma_f32 v[230:231], v[70:71], v[128:129], v[104:105] op_sel:[0,1,1] op_sel_hi:[1,1,1] neg_lo:[1,0,0] neg_hi:[1,0,0]
v_pk_fma_f32 v[70:71], v[70:71], v[128:129], v[100:101] op_sel:[0,1,1] op_sel_hi:[1,1,1] neg_lo:[0,0,1] neg_hi:[0,0,1]
v_exp_f32 v230, v230
v_exp_f32 v70, v70
v_exp_f32 v231, v231
v_exp_f32 v71, v71
v_pk_fma_f32 v[232:233], v[72:73], v[128:129], v[104:105] op_sel:[0,1,1] op_sel_hi:[1,1,1] neg_lo:[1,0,0] neg_hi:[1,0,0]
v_pk_fma_f32 v[72:73], v[72:73], v[128:129], v[100:101] op_sel:[0,1,1] op_sel_hi:[1,1,1] neg_lo:[0,0,1] neg_hi:[0,0,1]
v_exp_f32 v232, v232
v_exp_f32 v72, v72
v_exp_f32 v233, v233
v_exp_f32 v73, v73
v_pk_fma_f32 v[234:235], v[74:75], v[128:129], v[104:105] op_sel:[0,1,1] op_sel_hi:[1,1,1] neg_lo:[1,0,0] neg_hi:[1,0,0]
v_pk_fma_f32 v[74:75], v[74:75], v[128:129], v[100:101] op_sel:[0,1,1] op_sel_hi:[1,1,1] neg_lo:[0,0,1] neg_hi:[0,0,1]
v_exp_f32 v234, v234
v_exp_f32 v74, v74
v_exp_f32 v235, v235
v_exp_f32 v75, v75
v_pk_fma_f32 v[236:237], v[76:77], v[130:131], v[106:107] op_sel:[0,0,0] op_sel_hi:[1,0,0] neg_lo:[1,0,0] neg_hi:[1,0,0]
v_pk_fma_f32 v[76:77], v[76:77], v[130:131], v[102:103] op_sel:[0,0,0] op_sel_hi:[1,0,0] neg_lo:[0,0,1] neg_hi:[0,0,1]
v_exp_f32 v236, v236
v_exp_f32 v76, v76
v_exp_f32 v237, v237
v_exp_f32 v77, v77
v_pk_fma_f32 v[238:239], v[78:79], v[130:131], v[106:107] op_sel:[0,0,0] op_sel_hi:[1,0,0] neg_lo:[1,0,0] neg_hi:[1,0,0]
v_pk_fma_f32 v[78:79], v[78:79], v[130:131], v[102:103] op_sel:[0,0,0] op_sel_hi:[1,0,0] neg_lo:[0,0,1] neg_hi:[0,0,1]
v_exp_f32 v238, v238
v_exp_f32 v78, v78
v_exp_f32 v239, v239
v_exp_f32 v79, v79
v_pk_fma_f32 v[240:241], v[80:81], v[130:131], v[106:107] op_sel:[0,0,0] op_sel_hi:[1,0,0] neg_lo:[1,0,0] neg_hi:[1,0,0]
v_pk_fma_f32 v[80:81], v[80:81], v[130:131], v[102:103] op_sel:[0,0,0] op_sel_hi:[1,0,0] neg_lo:[0,0,1] neg_hi:[0,0,1]
v_exp_f32 v240, v240
v_exp_f32 v80, v80
v_exp_f32 v241, v241
v_exp_f32 v81, v81
v_pk_fma_f32 v[242:243], v[82:83], v[130:131], v[106:107] op_sel:[0,0,0] op_sel_hi:[1,0,0] neg_lo:[1,0,0] neg_hi:[1,0,0]
v_pk_fma_f32 v[82:83], v[82:83], v[130:131], v[102:103] op_sel:[0,0,0] op_sel_hi:[1,0,0] neg_lo:[0,0,1] neg_hi:[0,0,1]
v_exp_f32 v242, v242
v_exp_f32 v82, v82
v_exp_f32 v243, v243
v_exp_f32 v83, v83
v_pk_fma_f32 v[244:245], v[84:85], v[130:131], v[106:107] op_sel:[0,1,1] op_sel_hi:[1,1,1] neg_lo:[1,0,0] neg_hi:[1,0,0]
v_pk_fma_f32 v[84:85], v[84:85], v[130:131], v[102:103] op_sel:[0,1,1] op_sel_hi:[1,1,1] neg_lo:[0,0,1] neg_hi:[0,0,1]
v_exp_f32 v244, v244
v_exp_f32 v84, v84
v_exp_f32 v245, v245
v_exp_f32 v85, v85
v_pk_fma_f32 v[246:247], v[86:87], v[130:131], v[106:107] op_sel:[0,1,1] op_sel_hi:[1,1,1] neg_lo:[1,0,0] neg_hi:[1,0,0]
v_pk_fma_f32 v[86:87], v[86:87], v[130:131], v[102:103] op_sel:[0,1,1] op_sel_hi:[1,1,1] neg_lo:[0,0,1] neg_hi:[0,0,1]
v_exp_f32 v246, v246
v_exp_f32 v86, v86
v_exp_f32 v247, v247
v_exp_f32 v87, v87
v_pk_fma_f32 v[248:249], v[88:89], v[130:131], v[106:107] op_sel:[0,1,1] op_sel_hi:[1,1,1] neg_lo:[1,0,0] neg_hi:[1,0,0]
v_pk_fma_f32 v[88:89], v[88:89], v[130:131], v[102:103] op_sel:[0,1,1] op_sel_hi:[1,1,1] neg_lo:[0,0,1] neg_hi:[0,0,1]
v_exp_f32 v248, v248
v_exp_f32 v88, v88
v_exp_f32 v249, v249
v_exp_f32 v89, v89
v_pk_fma_f32 v[250:251], v[90:91], v[130:131], v[106:107] op_sel:[0,1,1] op_sel_hi:[1,1,1] neg_lo:[1,0,0] neg_hi:[1,0,0]
v_pk_fma_f32 v[90:91], v[90:91], v[130:131], v[102:103] op_sel:[0,1,1] op_sel_hi:[1,1,1] neg_lo:[0,0,1] neg_hi:[0,0,1]
v_exp_f32 v250, v250
v_exp_f32 v90, v90
v_exp_f32 v251, v251
v_exp_f32 v91, v91
v_pk_add_f32 v[108:109], v[60:61], v[62:63]
v_pk_add_f32 v[110:111], v[220:221], v[222:223]
v_pk_add_f32 v[108:109], v[108:109], v[64:65]
v_pk_add_f32 v[110:111], v[110:111], v[224:225]
v_pk_add_f32 v[108:109], v[108:109], v[66:67]
v_pk_add_f32 v[110:111], v[110:111], v[226:227]
v_add_f32 v100, v108, v109
v_add_f32 v104, v110, v111
v_pk_add_f32 v[108:109], v[68:69], v[70:71]
v_pk_add_f32 v[110:111], v[228:229], v[230:231]
v_pk_add_f32 v[108:109], v[108:109], v[72:73]
v_pk_add_f32 v[110:111], v[110:111], v[232:233]
v_pk_add_f32 v[108:109], v[108:109], v[74:75]
v_pk_add_f32 v[110:111], v[110:111], v[234:235]
v_add_f32 v101, v108, v109
v_add_f32 v105, v110, v111
v_pk_add_f32 v[108:109], v[76:77], v[78:79]
v_pk_add_f32 v[110:111], v[236:237], v[238:239]
v_pk_add_f32 v[108:109], v[108:109], v[80:81]
v_pk_add_f32 v[110:111], v[110:111], v[240:241]
v_pk_add_f32 v[108:109], v[108:109], v[82:83]
v_pk_add_f32 v[110:111], v[110:111], v[242:243]
v_add_f32 v102, v108, v109
v_add_f32 v106, v110, v111
v_pk_add_f32 v[108:109], v[84:85], v[86:87]
v_pk_add_f32 v[110:111], v[244:245], v[246:247]
v_pk_add_f32 v[108:109], v[108:109], v[88:89]
v_pk_add_f32 v[110:111], v[110:111], v[248:249]
v_pk_add_f32 v[108:109], v[108:109], v[90:91]
v_pk_add_f32 v[110:111], v[110:111], v[250:251]
v_add_f32 v103, v108, v109
v_add_f32 v107, v110, v111
s_nop 1
v_permlane32_swap_b32 v100, v101
v_permlane32_swap_b32 v102, v103
v_permlane32_swap_b32 v104, v105
v_permlane32_swap_b32 v106, v107
v_add_f32 v100, v100, v101
v_add_f32 v102, v102, v103
v_add_f32 v104, v104, v105
v_add_f32 v106, v106, v107
v_permlane16_swap_b32 v100, v102
s_nop 0
v_permlane16_swap_b32 v104, v106
v_add_f32 v100, v100, v102
v_add_f32 v104, v104, v106
v_rcp_f32 v100, v100
v_rcp_f32 v104, v104
s_nop 0
v_mov_b32 v102, v100
v_mov_b32 v106, v104
s_nop 0
v_permlane16_swap_b32 v100, v102
v_permlane16_swap_b32 v104, v106
v_mov_b32 v101, v100
v_mov_b32 v103, v102
v_mov_b32 v105, v104
v_mov_b32 v107, v106
v_permlane32_swap_b32 v100, v101
v_permlane32_swap_b32 v102, v103
v_permlane32_swap_b32 v104, v105
v_permlane32_swap_b32 v106, v107
.p2align 3
v_pk_mul_f32 v[60:61], v[60:61], v[100:101] op_sel:[0,0] op_sel_hi:[1,0]
v_pk_mul_f32 v[62:63], v[62:63], v[100:101] op_sel:[0,0] op_sel_hi:[1,0]
v_pk_mul_f32 v[64:65], v[64:65], v[100:101] op_sel:[0,0] op_sel_hi:[1,0]
v_pk_mul_f32 v[66:67], v[66:67], v[100:101] op_sel:[0,0] op_sel_hi:[1,0]
v_pk_mul_f32 v[220:221], v[220:221], v[104:105] op_sel:[0,0] op_sel_hi:[1,0]
v_pk_mul_f32 v[222:223], v[222:223], v[104:105] op_sel:[0,0] op_sel_hi:[1,0]
v_pk_mul_f32 v[224:225], v[224:225], v[104:105] op_sel:[0,0] op_sel_hi:[1,0]
v_pk_mul_f32 v[226:227], v[226:227], v[104:105] op_sel:[0,0] op_sel_hi:[1,0]
v_cvt_pk_bf16_f32 v60, v60, v61
v_cvt_pk_bf16_f32 v61, v62, v63
v_cvt_pk_bf16_f32 v62, v64, v65
v_cvt_pk_bf16_f32 v63, v66, v67
v_cvt_pk_bf16_f32 v220, v220, v221
v_cvt_pk_bf16_f32 v221, v222, v223
v_cvt_pk_bf16_f32 v222, v224, v225
v_cvt_pk_bf16_f32 v223, v226, v227
v_pk_mul_f32 v[68:69], v[68:69], v[100:101] op_sel:[0,1] op_sel_hi:[1,1]
v_pk_mul_f32 v[70:71], v[70:71], v[100:101] op_sel:[0,1] op_sel_hi:[1,1]
v_pk_mul_f32 v[72:73], v[72:73], v[100:101] op_sel:[0,1] op_sel_hi:[1,1]
v_pk_mul_f32 v[74:75], v[74:75], v[100:101] op_sel:[0,1] op_sel_hi:[1,1]
v_pk_mul_f32 v[228:229], v[228:229], v[104:105] op_sel:[0,1] op_sel_hi:[1,1]
v_pk_mul_f32 v[230:231], v[230:231], v[104:105] op_sel:[0,1] op_sel_hi:[1,1]
v_pk_mul_f32 v[232:233], v[232:233], v[104:105] op_sel:[0,1] op_sel_hi:[1,1]
v_pk_mul_f32 v[234:235], v[234:235], v[104:105] op_sel:[0,1] op_sel_hi:[1,1]
v_cvt_pk_bf16_f32 v68, v68, v69
v_mfma_f32_16x16x32_bf16 v[204:207], v[60:63], v[38:41], 0
v_cvt_pk_bf16_f32 v69, v70, v71
v_cvt_pk_bf16_f32 v70, v72, v73
v_mfma_f32_16x16x32_bf16 v[208:211], v[60:63], v[36:39], 0
v_cvt_pk_bf16_f32 v71, v74, v75
v_cvt_pk_bf16_f32 v228, v228, v229
v_mfma_f32_16x16x32_bf16 v[212:215], v[220:223], v[38:41], 0
v_cvt_pk_bf16_f32 v229, v230, v231
v_cvt_pk_bf16_f32 v230, v232, v233
v_mfma_f32_16x16x32_bf16 v[216:219], v[220:223], v[36:39], 0
v_cvt_pk_bf16_f32 v231, v234, v235
v_pk_mul_f32 v[76:77], v[76:77], v[102:103] op_sel:[0,0] op_sel_hi:[1,0]
v_pk_mul_f32 v[78:79], v[78:79], v[102:103] op_sel:[0,0] op_sel_hi:[1,0]
v_pk_mul_f32 v[80:81], v[80:81], v[102:103] op_sel:[0,0] op_sel_hi:[1,0]
v_pk_mul_f32 v[82:83], v[82:83], v[102:103] op_sel:[0,0] op_sel_hi:[1,0]
v_pk_mul_f32 v[236:237], v[236:237], v[106:107] op_sel:[0,0] op_sel_hi:[1,0]
v_pk_mul_f32 v[238:239], v[238:239], v[106:107] op_sel:[0,0] op_sel_hi:[1,0]
v_pk_mul_f32 v[240:241], v[240:241], v[106:107] op_sel:[0,0] op_sel_hi:[1,0]
v_pk_mul_f32 v[242:243], v[242:243], v[106:107] op_sel:[0,0] op_sel_hi:[1,0]
v_cvt_pk_bf16_f32 v76, v76, v77
v_mfma_f32_16x16x32_bf16 v[188:191], v[68:71], v[38:41], 0
v_mfma_f32_16x16x32_bf16 v[192:195], v[68:71], v[36:39], 0
v_cvt_pk_bf16_f32 v77, v78, v79
v_mfma_f32_16x16x32_bf16 v[196:199], v[228:231], v[38:41], 0
v_cvt_pk_bf16_f32 v78, v80, v81
v_mfma_f32_16x16x32_bf16 v[200:203], v[228:231], v[36:39], 0
v_cvt_pk_bf16_f32 v64, v204, v205
v_cvt_pk_bf16_f32 v79, v82, v83
v_cvt_pk_bf16_f32 v65, v206, v207
v_cvt_pk_bf16_f32 v236, v236, v237
v_cvt_pk_bf16_f32 v72, v208, v209
v_cvt_pk_bf16_f32 v73, v210, v211
v_cvt_pk_bf16_f32 v237, v238, v239
v_cvt_pk_bf16_f32 v224, v212, v213
v_cvt_pk_bf16_f32 v238, v240, v241
v_cvt_pk_bf16_f32 v225, v214, v215
v_cvt_pk_bf16_f32 v232, v216, v217
v_cvt_pk_bf16_f32 v239, v242, v243
v_cvt_pk_bf16_f32 v233, v218, v219
v_pk_mul_f32 v[84:85], v[84:85], v[102:103] op_sel:[0,1] op_sel_hi:[1,1]
v_pk_mul_f32 v[86:87], v[86:87], v[102:103] op_sel:[0,1] op_sel_hi:[1,1]
v_pk_mul_f32 v[88:89], v[88:89], v[102:103] op_sel:[0,1] op_sel_hi:[1,1]
v_pk_mul_f32 v[90:91], v[90:91], v[102:103] op_sel:[0,1] op_sel_hi:[1,1]
v_pk_mul_f32 v[244:245], v[244:245], v[106:107] op_sel:[0,1] op_sel_hi:[1,1]
v_pk_mul_f32 v[246:247], v[246:247], v[106:107] op_sel:[0,1] op_sel_hi:[1,1]
v_pk_mul_f32 v[248:249], v[248:249], v[106:107] op_sel:[0,1] op_sel_hi:[1,1]
v_pk_mul_f32 v[250:251], v[250:251], v[106:107] op_sel:[0,1] op_sel_hi:[1,1]
v_cvt_pk_bf16_f32 v84, v84, v85
v_mfma_f32_16x16x32_bf16 v[204:207], v[76:79], v[38:41], 0
v_mfma_f32_16x16x32_bf16 v[208:211], v[76:79], v[36:39], 0
v_cvt_pk_bf16_f32 v85, v86, v87
v_mfma_f32_16x16x32_bf16 v[212:215], v[236:239], v[38:41], 0
v_cvt_pk_bf16_f32 v86, v88, v89
v_mfma_f32_16x16x32_bf16 v[216:219], v[236:239], v[36:39], 0
v_cvt_pk_bf16_f32 v66, v188, v189
v_cvt_pk_bf16_f32 v87, v90, v91
v_cvt_pk_bf16_f32 v67, v190, v191
v_cvt_pk_bf16_f32 v244, v244, v245
v_cvt_pk_bf16_f32 v74, v192, v193
v_cvt_pk_bf16_f32 v75, v194, v195
v_cvt_pk_bf16_f32 v245, v246, v247
v_cvt_pk_bf16_f32 v226, v196, v197
v_cvt_pk_bf16_f32 v246, v248, v249
v_cvt_pk_bf16_f32 v227, v198, v199
v_cvt_pk_bf16_f32 v234, v200, v201
v_cvt_pk_bf16_f32 v247, v250, v251
v_cvt_pk_bf16_f32 v235, v202, v203
v_mov_b32 v5, 4
v_cmp_eq_u32 s[50:51], s41, v2
v_mfma_f32_16x16x32_bf16 v[188:191], v[84:87], v[38:41], 0
v_mfma_f32_16x16x32_bf16 v[192:195], v[84:87], v[36:39], 0
v_mfma_f32_16x16x32_bf16 v[196:199], v[244:247], v[38:41], 0
v_mfma_f32_16x16x32_bf16 v[200:203], v[244:247], v[36:39], 0
v_mfma_f32_16x16x32_bf16 v[152:155], v[224:227], v[112:115], 0
v_cvt_pk_bf16_f32 v80, v204, v205
v_cvt_pk_bf16_f32 v81, v206, v207
v_mfma_f32_16x16x32_bf16 v[60:63], v[232:235], v[112:115], 0
v_cvt_pk_bf16_f32 v88, v208, v209
v_mfma_f32_16x16x32_bf16 v[68:71], v[224:227], v[120:123], 0
v_cvt_pk_bf16_f32 v89, v210, v211
v_mfma_f32_16x16x32_bf16 v[220:223], v[232:235], v[120:123], 0
v_cvt_pk_bf16_f32 v240, v212, v213
v_cvt_pk_bf16_f32 v241, v214, v215
v_mfma_f32_16x16x32_bf16 v[228:231], v[224:227], v[48:51], 0
v_cvt_pk_bf16_f32 v248, v216, v217
v_mfma_f32_16x16x32_bf16 v[76:79], v[232:235], v[48:51], 0
v_cvt_pk_bf16_f32 v249, v218, v219
v_mfma_f32_16x16x32_bf16 v[100:103], v[64:67], v[112:115], 0
v_cvt_pk_bf16_f32 v82, v188, v189
v_cvt_pk_bf16_f32 v83, v190, v191
v_mfma_f32_16x16x32_bf16 v[104:107], v[72:75], v[112:115], 0
v_cvt_pk_bf16_f32 v90, v192, v193
v_mfma_f32_16x16x32_bf16 v[108:111], v[64:67], v[120:123], 0
v_cvt_pk_bf16_f32 v91, v194, v195
v_mfma_f32_16x16x32_bf16 v[132:135], v[72:75], v[120:123], 0
v_cvt_pk_bf16_f32 v242, v196, v197
v_cvt_pk_bf16_f32 v243, v198, v199
v_mfma_f32_16x16x32_bf16 v[136:139], v[64:67], v[48:51], 0
v_cvt_pk_bf16_f32 v250, v200, v201
v_mfma_f32_16x16x32_bf16 v[148:151], v[72:75], v[48:51], 0
v_cvt_pk_bf16_f32 v251, v202, v203
s_nop 1
v_mfma_f32_16x16x32_bf16 v[152:155], v[240:243], v[116:119], v[152:155]
v_mfma_f32_16x16x32_bf16 v[60:63], v[248:251], v[116:119], v[60:63]
v_mfma_f32_16x16x32_bf16 v[68:71], v[240:243], v[124:127], v[68:71]
v_mfma_f32_16x16x32_bf16 v[220:223], v[248:251], v[124:127], v[220:223]
v_mfma_f32_16x16x32_bf16 v[228:231], v[240:243], v[48:51], v[228:231]
v_mfma_f32_16x16x32_bf16 v[76:79], v[248:251], v[48:51], v[76:79]
v_mfma_f32_16x16x32_bf16 v[100:103], v[80:83], v[116:119], v[100:103]
v_mfma_f32_16x16x32_bf16 v[104:107], v[88:91], v[116:119], v[104:107]
v_mfma_f32_16x16x32_bf16 v[108:111], v[80:83], v[124:127], v[108:111]
v_mfma_f32_16x16x32_bf16 v[132:135], v[88:91], v[124:127], v[132:135]
v_cvt_pk_bf16_f32 v152, v152, v153
v_cvt_pk_bf16_f32 v153, v154, v155
v_mfma_f32_16x16x32_bf16 v[136:139], v[80:83], v[48:51], v[136:139]
v_cvt_pk_bf16_f32 v154, v60, v61
v_cvt_pk_bf16_f32 v155, v62, v63
v_mfma_f32_16x16x32_bf16 v[148:151], v[88:91], v[48:51], v[148:151]
ds_write_b128 v42, v[152:155] offset:0
v_cvt_pk_bf16_f32 v68, v68, v69
v_cvt_pk_bf16_f32 v69, v70, v71
v_cvt_pk_bf16_f32 v70, v220, v221
v_cvt_pk_bf16_f32 v71, v222, v223
ds_write_b128 v42, v[68:71] offset:1024
v_cvt_pk_bf16_f32 v228, v228, v229
v_cvt_pk_bf16_f32 v229, v230, v231
v_cvt_pk_bf16_f32 v230, v76, v77
v_cvt_pk_bf16_f32 v231, v78, v79
ds_write_b128 v42, v[228:231] offset:2048
ds_write_b32 v52, v5
s_mov_b32 s63, 0
px_96:
ds_read_b32 v4, v19
ds_read_b128 v[188:191], v43 offset:0
ds_read_b128 v[192:195], v43 offset:1024
ds_read_b128 v[196:199], v43 offset:2048
s_add_u32 s63, s63, 1
s_cmp_lt_u32 s63, 0x400000
s_waitcnt lgkmcnt(0)
v_cmp_ne_u32 vcc, 4, v4
s_cbranch_vccz pxd_97
s_cbranch_scc1 px_96
pxd_97:
v_mfma_f32_16x16x32_bf16 v[100:103], v[38:41], v[188:191], v[100:103]
v_mfma_f32_16x16x32_bf16 v[104:107], v[36:39], v[188:191], v[104:107]
v_mfma_f32_16x16x32_bf16 v[108:111], v[38:41], v[192:195], v[108:111]
v_mfma_f32_16x16x32_bf16 v[132:135], v[36:39], v[192:195], v[132:135]
v_mfma_f32_16x16x32_bf16 v[136:139], v[38:41], v[196:199], v[136:139]
v_mfma_f32_16x16x32_bf16 v[148:151], v[36:39], v[196:199], v[148:151]
s_nop 2
v_cvt_pk_bf16_f32 v100, v100, v101
v_cvt_pk_bf16_f32 v101, v102, v103
v_cvt_pk_bf16_f32 v102, v104, v105
v_cvt_pk_bf16_f32 v103, v106, v107
buffer_store_dwordx4 v[100:103], v55, s[32:35], s53 offen sc1
v_cvt_pk_bf16_f32 v108, v108, v109
v_cvt_pk_bf16_f32 v109, v110, v111
v_cvt_pk_bf16_f32 v110, v132, v133
v_cvt_pk_bf16_f32 v111, v134, v135
buffer_store_dwordx4 v[108:111], v55, s[32:35], s54 offen sc1
v_cvt_pk_bf16_f32 v136, v136, v137
v_cvt_pk_bf16_f32 v137, v138, v139
v_cvt_pk_bf16_f32 v138, v148, v149
v_cvt_pk_bf16_f32 v139, v150, v151
s_mov_b64 exec, s[50:51]
buffer_store_dwordx4 v[136:139], v58, s[32:35], s56 offen sc1
s_mov_b64 exec, -1
.p2align 3
v_pk_fma_f32 v[156:157], v[140:141], v[92:93], v[156:157] op_sel:[0,1,0] op_sel_hi:[1,1,1]
v_pk_fma_f32 v[158:159], v[142:143], v[92:93], v[158:159] op_sel:[0,1,0] op_sel_hi:[1,1,1]
v_pk_fma_f32 v[160:161], v[144:145], v[92:93], v[160:161] op_sel:[0,1,0] op_sel_hi:[1,1,1]
v_pk_fma_f32 v[162:163], v[146:147], v[92:93], v[162:163] op_sel:[0,1,0] op_sel_hi:[1,1,1]
v_cvt_pk_bf16_f32 v156, v156, v157
v_cvt_pk_bf16_f32 v157, v158, v159
v_cvt_pk_bf16_f32 v158, v160, v161
v_cvt_pk_bf16_f32 v159, v162, v163
v_pk_fma_f32 v[164:165], v[140:141], v[94:95], v[164:165] op_sel:[0,1,0] op_sel_hi:[1,1,1]
v_pk_fma_f32 v[166:167], v[142:143], v[94:95], v[166:167] op_sel:[0,1,0] op_sel_hi:[1,1,1]
v_pk_fma_f32 v[168:169], v[144:145], v[94:95], v[168:169] op_sel:[0,1,0] op_sel_hi:[1,1,1]
v_pk_fma_f32 v[170:171], v[146:147], v[94:95], v[170:171] op_sel:[0,1,0] op_sel_hi:[1,1,1]
v_cvt_pk_bf16_f32 v164, v164, v165
v_mfma_f32_16x16x32_bf16 v[60:63], v[10:13], v[156:159], 0
v_cvt_pk_bf16_f32 v165, v166, v167
v_cvt_pk_bf16_f32 v166, v168, v169
v_mfma_f32_16x16x32_bf16 v[64:67], v[14:17], v[156:159], 0
v_cvt_pk_bf16_f32 v167, v170, v171
v_pk_fma_f32 v[172:173], v[140:141], v[96:97], v[172:173] op_sel:[0,1,0] op_sel_hi:[1,1,1]
v_pk_fma_f32 v[174:175], v[142:143], v[96:97], v[174:175] op_sel:[0,1,0] op_sel_hi:[1,1,1]
v_pk_fma_f32 v[176:177], v[144:145], v[96:97], v[176:177] op_sel:[0,1,0] op_sel_hi:[1,1,1]
v_pk_fma_f32 v[178:179], v[146:147], v[96:97], v[178:179] op_sel:[0,1,0] op_sel_hi:[1,1,1]
v_cvt_pk_bf16_f32 v172, v172, v173
v_mfma_f32_16x16x32_bf16 v[68:71], v[10:13], v[164:167], 0
v_cvt_pk_bf16_f32 v173, v174, v175
v_cvt_pk_bf16_f32 v174, v176, v177
v_mfma_f32_16x16x32_bf16 v[72:75], v[14:17], v[164:167], 0
v_cvt_pk_bf16_f32 v175, v178, v179
v_pk_fma_f32 v[180:181], v[140:141], v[98:99], v[180:181] op_sel:[0,1,0] op_sel_hi:[1,1,1]
v_pk_fma_f32 v[182:183], v[142:143], v[98:99], v[182:183] op_sel:[0,1,0] op_sel_hi:[1,1,1]
v_pk_fma_f32 v[184:185], v[144:145], v[98:99], v[184:185] op_sel:[0,1,0] op_sel_hi:[1,1,1]
v_pk_fma_f32 v[186:187], v[146:147], v[98:99], v[186:187] op_sel:[0,1,0] op_sel_hi:[1,1,1]
v_cvt_pk_bf16_f32 v180, v180, v181
v_mfma_f32_16x16x32_bf16 v[76:79], v[10:13], v[172:175], 0
v_cvt_pk_bf16_f32 v181, v182, v183
v_cvt_pk_bf16_f32 v182, v184, v185
v_mfma_f32_16x16x32_bf16 v[80:83], v[14:17], v[172:175], 0
v_cvt_pk_bf16_f32 v183, v186, v187
s_nop 1
v_mfma_f32_16x16x32_bf16 v[84:87], v[10:13], v[180:183], 0
v_mfma_f32_16x16x32_bf16 v[88:91], v[14:17], v[180:183], 0
v_max3_f32 v100, v60, v61, v62
v_min3_f32 v104, v60, v61, v62
v_max3_f32 v100, v100, v63, v64
v_min3_f32 v104, v104, v63, v64
v_max3_f32 v100, v100, v65, v66
v_min3_f32 v104, v104, v65, v66
v_max_f32 v100, v100, v67
v_min_f32 v104, v104, v67
v_max3_f32 v101, v68, v69, v70
v_min3_f32 v105, v68, v69, v70
v_max3_f32 v101, v101, v71, v72
v_min3_f32 v105, v105, v71, v72
v_max3_f32 v101, v101, v73, v74
v_min3_f32 v105, v105, v73, v74
v_max_f32 v101, v101, v75
v_min_f32 v105, v105, v75
v_max3_f32 v102, v76, v77, v78
v_min3_f32 v106, v76, v77, v78
v_max3_f32 v102, v102, v79, v80
v_min3_f32 v106, v106, v79, v80
v_max3_f32 v102, v102, v81, v82
v_min3_f32 v106, v106, v81, v82
v_max_f32 v102, v102, v83
v_min_f32 v106, v106, v83
v_max3_f32 v103, v84, v85, v86
v_min3_f32 v107, v84, v85, v86
v_max3_f32 v103, v103, v87, v88
v_min3_f32 v107, v107, v87, v88
v_max3_f32 v103, v103, v89, v90
v_min3_f32 v107, v107, v89, v90
v_max_f32 v103, v103, v91
v_min_f32 v107, v107, v91
s_nop 1
v_permlane32_swap_b32 v100, v101
v_permlane32_swap_b32 v102, v103
v_permlane32_swap_b32 v104, v105
v_permlane32_swap_b32 v106, v107
v_max_f32 v100, v100, v101
v_max_f32 v102, v102, v103
v_min_f32 v104, v104, v105
v_min_f32 v106, v106, v107
v_permlane16_swap_b32 v100, v102
s_nop 0
v_permlane16_swap_b32 v104, v106
v_max_f32 v100, v100, v102
v_min_f32 v104, v104, v106
v_mov_b32 v102, v100
v_mov_b32 v106, v104
s_nop 0
v_permlane16_swap_b32 v100, v102
v_permlane16_swap_b32 v104, v106
v_mov_b32 v101, v100
v_mov_b32 v103, v102
v_mov_b32 v105, v104
v_mov_b32 v107, v106
v_permlane32_swap_b32 v100, v101
v_permlane32_swap_b32 v102, v103
v_permlane32_swap_b32 v104, v105
v_permlane32_swap_b32 v106, v107
v_pk_mul_f32 v[100:101], v[100:101], v[128:129]
v_pk_mul_f32 v[102:103], v[102:103], v[130:131]
v_pk_mul_f32 v[104:105], v[104:105], v[128:129]
v_pk_mul_f32 v[106:107], v[106:107], v[130:131]
v_pk_fma_f32 v[220:221], v[60:61], v[128:129], v[104:105] op_sel:[0,0,0] op_sel_hi:[1,0,0] neg_lo:[1,0,0] neg_hi:[1,0,0]
v_pk_fma_f32 v[60:61], v[60:61], v[128:129], v[100:101] op_sel:[0,0,0] op_sel_hi:[1,0,0] neg_lo:[0,0,1] neg_hi:[0,0,1]
v_exp_f32 v220, v220
v_exp_f32 v60, v60
v_exp_f32 v221, v221
v_exp_f32 v61, v61
v_pk_fma_f32 v[222:223], v[62:63], v[128:129], v[104:105] op_sel:[0,0,0] op_sel_hi:[1,0,0] neg_lo:[1,0,0] neg_hi:[1,0,0]
v_pk_fma_f32 v[62:63], v[62:63], v[128:129], v[100:101] op_sel:[0,0,0] op_sel_hi:[1,0,0] neg_lo:[0,0,1] neg_hi:[0,0,1]
v_exp_f32 v222, v222
v_exp_f32 v62, v62
v_exp_f32 v223, v223
v_exp_f32 v63, v63
v_pk_fma_f32 v[224:225], v[64:65], v[128:129], v[104:105] op_sel:[0,0,0] op_sel_hi:[1,0,0] neg_lo:[1,0,0] neg_hi:[1,0,0]
v_pk_fma_f32 v[64:65], v[64:65], v[128:129], v[100:101] op_sel:[0,0,0] op_sel_hi:[1,0,0] neg_lo:[0,0,1] neg_hi:[0,0,1]
v_exp_f32 v224, v224
v_exp_f32 v64, v64
v_exp_f32 v225, v225
v_exp_f32 v65, v65
v_pk_fma_f32 v[226:227], v[66:67], v[128:129], v[104:105] op_sel:[0,0,0] op_sel_hi:[1,0,0] neg_lo:[1,0,0] neg_hi:[1,0,0]
v_pk_fma_f32 v[66:67], v[66:67], v[128:129], v[100:101] op_sel:[0,0,0] op_sel_hi:[1,0,0] neg_lo:[0,0,1] neg_hi:[0,0,1]
v_exp_f32 v226, v226
v_exp_f32 v66, v66
v_exp_f32 v227, v227
v_exp_f32 v67, v67
v_pk_fma_f32 v[228:229], v[68:69], v[128:129], v[104:105] op_sel:[0,1,1] op_sel_hi:[1,1,1] neg_lo:[1,0,0] neg_hi:[1,0,0]
v_pk_fma_f32 v[68:69], v[68:69], v[128:129], v[100:101] op_sel:[0,1,1] op_sel_hi:[1,1,1] neg_lo:[0,0,1] neg_hi:[0,0,1]
v_exp_f32 v228, v228
v_exp_f32 v68, v68
v_exp_f32 v229, v229
v_exp_f32 v69, v69
v_pk_fma_f32 v[230:231], v[70:71], v[128:129], v[104:105] op_sel:[0,1,1] op_sel_hi:[1,1,1] neg_lo:[1,0,0] neg_hi:[1,0,0]
v_pk_fma_f32 v[70:71], v[70:71], v[128:129], v[100:101] op_sel:[0,1,1] op_sel_hi:[1,1,1] neg_lo:[0,0,1] neg_hi:[0,0,1]
v_exp_f32 v230, v230
v_exp_f32 v70, v70
v_exp_f32 v231, v231
v_exp_f32 v71, v71
v_pk_fma_f32 v[232:233], v[72:73], v[128:129], v[104:105] op_sel:[0,1,1] op_sel_hi:[1,1,1] neg_lo:[1,0,0] neg_hi:[1,0,0]
v_pk_fma_f32 v[72:73], v[72:73], v[128:129], v[100:101] op_sel:[0,1,1] op_sel_hi:[1,1,1] neg_lo:[0,0,1] neg_hi:[0,0,1]
v_exp_f32 v232, v232
v_exp_f32 v72, v72
v_exp_f32 v233, v233
v_exp_f32 v73, v73
v_pk_fma_f32 v[234:235], v[74:75], v[128:129], v[104:105] op_sel:[0,1,1] op_sel_hi:[1,1,1] neg_lo:[1,0,0] neg_hi:[1,0,0]
v_pk_fma_f32 v[74:75], v[74:75], v[128:129], v[100:101] op_sel:[0,1,1] op_sel_hi:[1,1,1] neg_lo:[0,0,1] neg_hi:[0,0,1]
v_exp_f32 v234, v234
v_exp_f32 v74, v74
v_exp_f32 v235, v235
v_exp_f32 v75, v75
buffer_load_dwordx4 v[188:191], v18, s[32:35], s55 offen offset:0 sc1
buffer_load_dwordx4 v[192:195], v18, s[32:35], s55 offen offset:1024 sc1
buffer_load_dwordx4 v[204:207], v58, s[32:35], s56 offen sc1
buffer_load_dwordx4 v[208:211], v58, s[32:35], s57 offen sc1
v_pk_fma_f32 v[236:237], v[76:77], v[130:131], v[106:107] op_sel:[0,0,0] op_sel_hi:[1,0,0] neg_lo:[1,0,0] neg_hi:[1,0,0]
v_pk_fma_f32 v[76:77], v[76:77], v[130:131], v[102:103] op_sel:[0,0,0] op_sel_hi:[1,0,0] neg_lo:[0,0,1] neg_hi:[0,0,1]
v_exp_f32 v236, v236
v_exp_f32 v76, v76
v_exp_f32 v237, v237
v_exp_f32 v77, v77
v_pk_fma_f32 v[238:239], v[78:79], v[130:131], v[106:107] op_sel:[0,0,0] op_sel_hi:[1,0,0] neg_lo:[1,0,0] neg_hi:[1,0,0]
v_pk_fma_f32 v[78:79], v[78:79], v[130:131], v[102:103] op_sel:[0,0,0] op_sel_hi:[1,0,0] neg_lo:[0,0,1] neg_hi:[0,0,1]
v_exp_f32 v238, v238
v_exp_f32 v78, v78
v_exp_f32 v239, v239
v_exp_f32 v79, v79
v_pk_fma_f32 v[240:241], v[80:81], v[130:131], v[106:107] op_sel:[0,0,0] op_sel_hi:[1,0,0] neg_lo:[1,0,0] neg_hi:[1,0,0]
v_pk_fma_f32 v[80:81], v[80:81], v[130:131], v[102:103] op_sel:[0,0,0] op_sel_hi:[1,0,0] neg_lo:[0,0,1] neg_hi:[0,0,1]
v_exp_f32 v240, v240
v_exp_f32 v80, v80
v_exp_f32 v241, v241
v_exp_f32 v81, v81
v_pk_fma_f32 v[242:243], v[82:83], v[130:131], v[106:107] op_sel:[0,0,0] op_sel_hi:[1,0,0] neg_lo:[1,0,0] neg_hi:[1,0,0]
v_pk_fma_f32 v[82:83], v[82:83], v[130:131], v[102:103] op_sel:[0,0,0] op_sel_hi:[1,0,0] neg_lo:[0,0,1] neg_hi:[0,0,1]
v_exp_f32 v242, v242
v_exp_f32 v82, v82
v_exp_f32 v243, v243
v_exp_f32 v83, v83
v_pk_fma_f32 v[244:245], v[84:85], v[130:131], v[106:107] op_sel:[0,1,1] op_sel_hi:[1,1,1] neg_lo:[1,0,0] neg_hi:[1,0,0]
v_pk_fma_f32 v[84:85], v[84:85], v[130:131], v[102:103] op_sel:[0,1,1] op_sel_hi:[1,1,1] neg_lo:[0,0,1] neg_hi:[0,0,1]
v_exp_f32 v244, v244
v_exp_f32 v84, v84
v_exp_f32 v245, v245
v_exp_f32 v85, v85
v_pk_fma_f32 v[246:247], v[86:87], v[130:131], v[106:107] op_sel:[0,1,1] op_sel_hi:[1,1,1] neg_lo:[1,0,0] neg_hi:[1,0,0]
v_pk_fma_f32 v[86:87], v[86:87], v[130:131], v[102:103] op_sel:[0,1,1] op_sel_hi:[1,1,1] neg_lo:[0,0,1] neg_hi:[0,0,1]
v_exp_f32 v246, v246
v_exp_f32 v86, v86
v_exp_f32 v247, v247
v_exp_f32 v87, v87
v_pk_fma_f32 v[248:249], v[88:89], v[130:131], v[106:107] op_sel:[0,1,1] op_sel_hi:[1,1,1] neg_lo:[1,0,0] neg_hi:[1,0,0]
v_pk_fma_f32 v[88:89], v[88:89], v[130:131], v[102:103] op_sel:[0,1,1] op_sel_hi:[1,1,1] neg_lo:[0,0,1] neg_hi:[0,0,1]
v_exp_f32 v248, v248
v_exp_f32 v88, v88
v_exp_f32 v249, v249
v_exp_f32 v89, v89
v_pk_fma_f32 v[250:251], v[90:91], v[130:131], v[106:107] op_sel:[0,1,1] op_sel_hi:[1,1,1] neg_lo:[1,0,0] neg_hi:[1,0,0]
v_pk_fma_f32 v[90:91], v[90:91], v[130:131], v[102:103] op_sel:[0,1,1] op_sel_hi:[1,1,1] neg_lo:[0,0,1] neg_hi:[0,0,1]
v_exp_f32 v250, v250
v_exp_f32 v90, v90
v_exp_f32 v251, v251
v_exp_f32 v91, v91
v_pk_add_f32 v[108:109], v[60:61], v[62:63]
v_pk_add_f32 v[110:111], v[220:221], v[222:223]
v_pk_add_f32 v[108:109], v[108:109], v[64:65]
v_pk_add_f32 v[110:111], v[110:111], v[224:225]
v_pk_add_f32 v[108:109], v[108:109], v[66:67]
v_pk_add_f32 v[110:111], v[110:111], v[226:227]
v_add_f32 v100, v108, v109
v_add_f32 v104, v110, v111
v_pk_add_f32 v[108:109], v[68:69], v[70:71]
v_pk_add_f32 v[110:111], v[228:229], v[230:231]
v_pk_add_f32 v[108:109], v[108:109], v[72:73]
v_pk_add_f32 v[110:111], v[110:111], v[232:233]
v_pk_add_f32 v[108:109], v[108:109], v[74:75]
v_pk_add_f32 v[110:111], v[110:111], v[234:235]
v_add_f32 v101, v108, v109
v_add_f32 v105, v110, v111
v_pk_add_f32 v[108:109], v[76:77], v[78:79]
v_pk_add_f32 v[110:111], v[236:237], v[238:239]
v_pk_add_f32 v[108:109], v[108:109], v[80:81]
v_pk_add_f32 v[110:111], v[110:111], v[240:241]
v_pk_add_f32 v[108:109], v[108:109], v[82:83]
v_pk_add_f32 v[110:111], v[110:111], v[242:243]
v_add_f32 v102, v108, v109
v_add_f32 v106, v110, v111
v_pk_add_f32 v[108:109], v[84:85], v[86:87]
v_pk_add_f32 v[110:111], v[244:245], v[246:247]
v_pk_add_f32 v[108:109], v[108:109], v[88:89]
v_pk_add_f32 v[110:111], v[110:111], v[248:249]
v_pk_add_f32 v[108:109], v[108:109], v[90:91]
v_pk_add_f32 v[110:111], v[110:111], v[250:251]
v_add_f32 v103, v108, v109
v_add_f32 v107, v110, v111
s_mov_b32 s63, 0
sent_98:
s_waitcnt vmcnt(0)
v_max_u32 v4, v188, v189
v_max3_u32 v4, v4, v190, v191
v_max3_u32 v4, v4, v192, v193
v_max3_u32 v4, v4, v194, v195
v_max3_u32 v4, v4, v204, v205
v_max3_u32 v4, v4, v206, v207
v_max3_u32 v4, v4, v208, v209
v_max3_u32 v4, v4, v210, v211
v_cmp_eq_u32 vcc, -1, v4
s_cbranch_vccz sentd_99
buffer_load_dwordx4 v[188:191], v18, s[32:35], s55 offen offset:0 sc1
buffer_load_dwordx4 v[192:195], v18, s[32:35], s55 offen offset:1024 sc1
buffer_load_dwordx4 v[204:207], v58, s[32:35], s56 offen sc1
buffer_load_dwordx4 v[208:211], v58, s[32:35], s57 offen sc1
s_add_u32 s63, s63, 1
s_cmp_lt_u32 s63, 0x80000
s_cbranch_scc1 sent_98
s_waitcnt vmcnt(0)
sentd_99:
v_mfma_f32_16x16x32_bf16 v[132:135], v[44:47], v[188:191], 0
v_mfma_f32_16x16x32_bf16 v[132:135], v[44:47], v[192:195], v[132:135]
s_nop 7
v_add_f32_dpp v132, v132, v132 row_ror:8 row_mask:0xf bank_mask:0xf
v_add_f32_dpp v133, v133, v133 row_ror:8 row_mask:0xf bank_mask:0xf
v_add_f32_dpp v134, v134, v134 row_ror:8 row_mask:0xf bank_mask:0xf
v_add_f32_dpp v135, v135, v135 row_ror:8 row_mask:0xf bank_mask:0xf
v_cvt_pk_bf16_f32 v132, v132, v133
v_cvt_pk_bf16_f32 v133, v134, v135
s_mov_b64 exec, 0x00ff00ff
buffer_store_dwordx2 v[132:133], v59, s[32:35], s79 offen sc1
s_mov_b64 exec, -1
s_nop 1
v_permlane32_swap_b32 v100, v101
v_permlane32_swap_b32 v102, v103
v_permlane32_swap_b32 v104, v105
v_permlane32_swap_b32 v106, v107
v_add_f32 v100, v100, v101
v_add_f32 v102, v102, v103
v_add_f32 v104, v104, v105
v_add_f32 v106, v106, v107
v_permlane16_swap_b32 v100, v102
s_nop 0
v_permlane16_swap_b32 v104, v106
v_add_f32 v100, v100, v102
v_add_f32 v104, v104, v106
v_rcp_f32 v100, v100
v_rcp_f32 v104, v104
s_nop 0
v_mov_b32 v102, v100
v_mov_b32 v106, v104
s_nop 0
v_permlane16_swap_b32 v100, v102
v_permlane16_swap_b32 v104, v106
v_mov_b32 v101, v100
v_mov_b32 v103, v102
v_mov_b32 v105, v104
v_mov_b32 v107, v106
v_permlane32_swap_b32 v100, v101
v_permlane32_swap_b32 v102, v103
v_permlane32_swap_b32 v104, v105
v_permlane32_swap_b32 v106, v107
.p2align 3
v_pk_mul_f32 v[60:61], v[60:61], v[100:101] op_sel:[0,0] op_sel_hi:[1,0]
v_pk_mul_f32 v[62:63], v[62:63], v[100:101] op_sel:[0,0] op_sel_hi:[1,0]
v_pk_mul_f32 v[64:65], v[64:65], v[100:101] op_sel:[0,0] op_sel_hi:[1,0]
v_pk_mul_f32 v[66:67], v[66:67], v[100:101] op_sel:[0,0] op_sel_hi:[1,0]
v_pk_mul_f32 v[220:221], v[220:221], v[104:105] op_sel:[0,0] op_sel_hi:[1,0]
v_pk_mul_f32 v[222:223], v[222:223], v[104:105] op_sel:[0,0] op_sel_hi:[1,0]
v_pk_mul_f32 v[224:225], v[224:225], v[104:105] op_sel:[0,0] op_sel_hi:[1,0]
v_pk_mul_f32 v[226:227], v[226:227], v[104:105] op_sel:[0,0] op_sel_hi:[1,0]
v_cvt_pk_bf16_f32 v60, v60, v61
v_cvt_pk_bf16_f32 v61, v62, v63
v_cvt_pk_bf16_f32 v62, v64, v65
v_cvt_pk_bf16_f32 v63, v66, v67
v_cvt_pk_bf16_f32 v220, v220, v221
v_cvt_pk_bf16_f32 v221, v222, v223
v_cvt_pk_bf16_f32 v222, v224, v225
v_cvt_pk_bf16_f32 v223, v226, v227
v_pk_mul_f32 v[68:69], v[68:69], v[100:101] op_sel:[0,1] op_sel_hi:[1,1]
v_pk_mul_f32 v[70:71], v[70:71], v[100:101] op_sel:[0,1] op_sel_hi:[1,1]
v_pk_mul_f32 v[72:73], v[72:73], v[100:101] op_sel:[0,1] op_sel_hi:[1,1]
v_pk_mul_f32 v[74:75], v[74:75], v[100:101] op_sel:[0,1] op_sel_hi:[1,1]
v_pk_mul_f32 v[228:229], v[228:229], v[104:105] op_sel:[0,1] op_sel_hi:[1,1]
v_pk_mul_f32 v[230:231], v[230:231], v[104:105] op_sel:[0,1] op_sel_hi:[1,1]
v_pk_mul_f32 v[232:233], v[232:233], v[104:105] op_sel:[0,1] op_sel_hi:[1,1]
v_pk_mul_f32 v[234:235], v[234:235], v[104:105] op_sel:[0,1] op_sel_hi:[1,1]
v_cvt_pk_bf16_f32 v68, v68, v69
v_mfma_f32_16x16x32_bf16 v[112:115], v[204:207], v[60:63], 0
v_cvt_pk_bf16_f32 v69, v70, v71
v_cvt_pk_bf16_f32 v70, v72, v73
v_cvt_pk_bf16_f32 v71, v74, v75
v_cvt_pk_bf16_f32 v228, v228, v229
v_mfma_f32_16x16x32_bf16 v[112:115], v[208:211], v[220:223], v[112:115]
v_cvt_pk_bf16_f32 v229, v230, v231
v_cvt_pk_bf16_f32 v230, v232, v233
v_cvt_pk_bf16_f32 v231, v234, v235
v_pk_mul_f32 v[76:77], v[76:77], v[102:103] op_sel:[0,0] op_sel_hi:[1,0]
v_pk_mul_f32 v[78:79], v[78:79], v[102:103] op_sel:[0,0] op_sel_hi:[1,0]
v_pk_mul_f32 v[80:81], v[80:81], v[102:103] op_sel:[0,0] op_sel_hi:[1,0]
v_pk_mul_f32 v[82:83], v[82:83], v[102:103] op_sel:[0,0] op_sel_hi:[1,0]
v_pk_mul_f32 v[236:237], v[236:237], v[106:107] op_sel:[0,0] op_sel_hi:[1,0]
v_pk_mul_f32 v[238:239], v[238:239], v[106:107] op_sel:[0,0] op_sel_hi:[1,0]
v_pk_mul_f32 v[240:241], v[240:241], v[106:107] op_sel:[0,0] op_sel_hi:[1,0]
v_pk_mul_f32 v[242:243], v[242:243], v[106:107] op_sel:[0,0] op_sel_hi:[1,0]
v_cvt_pk_bf16_f32 v76, v76, v77
v_mfma_f32_16x16x32_bf16 v[116:119], v[204:207], v[68:71], 0
v_cvt_pk_bf16_f32 v77, v78, v79
v_cvt_pk_bf16_f32 v78, v80, v81
v_cvt_pk_bf16_f32 v79, v82, v83
v_cvt_pk_bf16_f32 v236, v236, v237
v_mfma_f32_16x16x32_bf16 v[116:119], v[208:211], v[228:231], v[116:119]
v_cvt_pk_bf16_f32 v237, v238, v239
v_cvt_pk_bf16_f32 v238, v240, v241
v_cvt_pk_bf16_f32 v239, v242, v243
v_pk_mul_f32 v[84:85], v[84:85], v[102:103] op_sel:[0,1] op_sel_hi:[1,1]
v_pk_mul_f32 v[86:87], v[86:87], v[102:103] op_sel:[0,1] op_sel_hi:[1,1]
v_pk_mul_f32 v[88:89], v[88:89], v[102:103] op_sel:[0,1] op_sel_hi:[1,1]
v_pk_mul_f32 v[90:91], v[90:91], v[102:103] op_sel:[0,1] op_sel_hi:[1,1]
v_pk_mul_f32 v[244:245], v[244:245], v[106:107] op_sel:[0,1] op_sel_hi:[1,1]
v_pk_mul_f32 v[246:247], v[246:247], v[106:107] op_sel:[0,1] op_sel_hi:[1,1]
v_pk_mul_f32 v[248:249], v[248:249], v[106:107] op_sel:[0,1] op_sel_hi:[1,1]
v_pk_mul_f32 v[250:251], v[250:251], v[106:107] op_sel:[0,1] op_sel_hi:[1,1]
v_cvt_pk_bf16_f32 v84, v84, v85
v_mfma_f32_16x16x32_bf16 v[120:123], v[204:207], v[76:79], 0
v_cvt_pk_bf16_f32 v85, v86, v87
v_cvt_pk_bf16_f32 v86, v88, v89
v_cvt_pk_bf16_f32 v87, v90, v91
v_cvt_pk_bf16_f32 v244, v244, v245
v_mfma_f32_16x16x32_bf16 v[120:123], v[208:211], v[236:239], v[120:123]
v_cvt_pk_bf16_f32 v245, v246, v247
v_cvt_pk_bf16_f32 v246, v248, v249
v_cvt_pk_bf16_f32 v247, v250, v251
buffer_load_dwordx4 v[188:191], v18, s[32:35], s58 offen offset:0 sc1
buffer_load_dwordx4 v[192:195], v18, s[32:35], s58 offen offset:1024 sc1
v_mfma_f32_16x16x32_bf16 v[124:127], v[204:207], v[84:87], 0
v_mfma_f32_16x16x32_bf16 v[124:127], v[208:211], v[244:247], v[124:127]
buffer_load_dwordx4 v[196:199], v18, s[32:35], s59 offen offset:0 sc1
buffer_load_dwordx4 v[200:203], v18, s[32:35], s59 offen offset:1024 sc1
v_add_f32 v100, v112, v113
v_add_f32 v114, v114, v115
v_add_f32 v100, v100, v114
v_add_f32 v101, v116, v117
v_add_f32 v118, v118, v119
v_add_f32 v101, v101, v118
v_add_f32 v102, v120, v121
v_add_f32 v122, v122, v123
v_add_f32 v102, v102, v122
v_add_f32 v103, v124, v125
v_add_f32 v126, v126, v127
v_add_f32 v103, v103, v126
s_nop 1
v_permlane32_swap_b32 v100, v101
v_permlane32_swap_b32 v102, v103
v_add_f32 v100, v100, v101
v_add_f32 v102, v102, v103
s_nop 1
v_permlane16_swap_b32 v100, v102
s_nop 0
v_add_f32 v100, v100, v102
v_add_f32 v100, 0x358637bd, v100
v_rcp_f32 v100, v100
s_nop 0
v_mov_b32 v102, v100
s_nop 1
v_permlane16_swap_b32 v100, v102
s_nop 0
v_mov_b32 v101, v100
v_mov_b32 v103, v102
s_nop 0
v_permlane32_swap_b32 v100, v101
v_permlane32_swap_b32 v102, v103
s_mov_b32 s63, 0
sent_100:
s_waitcnt vmcnt(0)
v_max_u32 v4, v188, v189
v_max3_u32 v4, v4, v190, v191
v_max3_u32 v4, v4, v192, v193
v_max3_u32 v4, v4, v194, v195
v_max3_u32 v4, v4, v196, v197
v_max3_u32 v4, v4, v198, v199
v_max3_u32 v4, v4, v200, v201
v_max3_u32 v4, v4, v202, v203
v_cmp_eq_u32 vcc, -1, v4
s_cbranch_vccz sentd_101
buffer_load_dwordx4 v[188:191], v18, s[32:35], s58 offen offset:0 sc1
buffer_load_dwordx4 v[192:195], v18, s[32:35], s58 offen offset:1024 sc1
buffer_load_dwordx4 v[196:199], v18, s[32:35], s59 offen offset:0 sc1
buffer_load_dwordx4 v[200:203], v18, s[32:35], s59 offen offset:1024 sc1
s_add_u32 s63, s63, 1
s_cmp_lt_u32 s63, 0x80000
s_cbranch_scc1 sent_100
s_waitcnt vmcnt(0)
sentd_101:
v_mfma_f32_16x16x32_bf16 v[156:159], v[188:191], v[60:63], 0
v_mfma_f32_16x16x32_bf16 v[160:163], v[192:195], v[60:63], 0
v_mfma_f32_16x16x32_bf16 v[156:159], v[196:199], v[220:223], v[156:159]
v_mfma_f32_16x16x32_bf16 v[160:163], v[200:203], v[220:223], v[160:163]
v_mfma_f32_16x16x32_bf16 v[164:167], v[188:191], v[68:71], 0
v_mfma_f32_16x16x32_bf16 v[168:171], v[192:195], v[68:71], 0
v_mfma_f32_16x16x32_bf16 v[164:167], v[196:199], v[228:231], v[164:167]
v_mfma_f32_16x16x32_bf16 v[168:171], v[200:203], v[228:231], v[168:171]
v_mfma_f32_16x16x32_bf16 v[172:175], v[188:191], v[76:79], 0
v_mfma_f32_16x16x32_bf16 v[176:179], v[192:195], v[76:79], 0
v_mfma_f32_16x16x32_bf16 v[172:175], v[196:199], v[236:239], v[172:175]
v_mfma_f32_16x16x32_bf16 v[176:179], v[200:203], v[236:239], v[176:179]
v_mfma_f32_16x16x32_bf16 v[180:183], v[188:191], v[84:87], 0
v_mfma_f32_16x16x32_bf16 v[184:187], v[192:195], v[84:87], 0
v_mfma_f32_16x16x32_bf16 v[180:183], v[196:199], v[244:247], v[180:183]
v_mfma_f32_16x16x32_bf16 v[184:187], v[200:203], v[244:247], v[184:187]
s_cmp_eq_u32 s46, 0
s_cbranch_scc1 slow_102
.p2align 3
v_pk_mul_f32 v[156:157], v[156:157], v[100:101] op_sel:[0,0] op_sel_hi:[1,0]
v_pk_mul_f32 v[158:159], v[158:159], v[100:101] op_sel:[0,0] op_sel_hi:[1,0]
v_pk_mul_f32 v[160:161], v[160:161], v[100:101] op_sel:[0,0] op_sel_hi:[1,0]
v_pk_mul_f32 v[162:163], v[162:163], v[100:101] op_sel:[0,0] op_sel_hi:[1,0]
v_cvt_pk_bf16_f32 v156, v156, v157
v_cvt_pk_bf16_f32 v157, v158, v159
v_cvt_pk_bf16_f32 v158, v160, v161
v_cvt_pk_bf16_f32 v159, v162, v163
buffer_store_dwordx4 v[156:159], v18, s[32:35], s80 offen
v_pk_mul_f32 v[164:165], v[164:165], v[100:101] op_sel:[0,1] op_sel_hi:[1,1]
v_pk_mul_f32 v[166:167], v[166:167], v[100:101] op_sel:[0,1] op_sel_hi:[1,1]
v_pk_mul_f32 v[168:169], v[168:169], v[100:101] op_sel:[0,1] op_sel_hi:[1,1]
v_pk_mul_f32 v[170:171], v[170:171], v[100:101] op_sel:[0,1] op_sel_hi:[1,1]
v_cvt_pk_bf16_f32 v164, v164, v165
v_cvt_pk_bf16_f32 v165, v166, v167
v_cvt_pk_bf16_f32 v166, v168, v169
v_cvt_pk_bf16_f32 v167, v170, v171
buffer_store_dwordx4 v[164:167], v18, s[32:35], s81 offen
v_pk_mul_f32 v[172:173], v[172:173], v[102:103] op_sel:[0,0] op_sel_hi:[1,0]
v_pk_mul_f32 v[174:175], v[174:175], v[102:103] op_sel:[0,0] op_sel_hi:[1,0]
v_pk_mul_f32 v[176:177], v[176:177], v[102:103] op_sel:[0,0] op_sel_hi:[1,0]
v_pk_mul_f32 v[178:179], v[178:179], v[102:103] op_sel:[0,0] op_sel_hi:[1,0]
v_cvt_pk_bf16_f32 v172, v172, v173
v_cvt_pk_bf16_f32 v173, v174, v175
v_cvt_pk_bf16_f32 v174, v176, v177
v_cvt_pk_bf16_f32 v175, v178, v179
buffer_store_dwordx4 v[172:175], v18, s[32:35], s82 offen
v_pk_mul_f32 v[180:181], v[180:181], v[102:103] op_sel:[0,1] op_sel_hi:[1,1]
v_pk_mul_f32 v[182:183], v[182:183], v[102:103] op_sel:[0,1] op_sel_hi:[1,1]
v_pk_mul_f32 v[184:185], v[184:185], v[102:103] op_sel:[0,1] op_sel_hi:[1,1]
v_pk_mul_f32 v[186:187], v[186:187], v[102:103] op_sel:[0,1] op_sel_hi:[1,1]
v_cvt_pk_bf16_f32 v180, v180, v181
v_cvt_pk_bf16_f32 v181, v182, v183
v_cvt_pk_bf16_f32 v182, v184, v185
v_cvt_pk_bf16_f32 v183, v186, v187
buffer_store_dwordx4 v[180:183], v18, s[32:35], s83 offen
s_barrier
s_lshl_b32 s62, s45, 2
v_mov_b32 v4, s62
v_mov_b32 v5, 4
s_mov_b64 exec, 1
s_waitcnt vmcnt(0)
buffer_store_dword v5, v4, s[32:35], s84 offen
s_mov_b64 exec, -1
back_103:
v_and_b32 v36, 31, v0
v_lshlrev_b32 v36, 2, v36
buffer_load_dword v37, v36, s[32:35], s84 offen sc1
v_lshrrev_b32 v4, 2, v2
v_and_b32 v5, 3, v0
v_lshl_add_u32 v6, v3, 3, v4
v_lshlrev_b32 v6, 7, v6
v_lshl_add_u32 v6, v5, 3, v6
v_lshrrev_b32 v7, 1, v4
v_and_b32 v8, 1, v3
v_lshl_add_u32 v7, v8, 1, v7
v_lshl_add_u32 v10, v7, 5, v6
v_xor_b32 v11, 32, v10
v_xor_b32 v12, 64, v10
v_xor_b32 v13, 96, v10
v_add_u32 v14, 0x10000, v10
v_add_u32 v15, 0x10000, v11
v_add_u32 v16, 0x10000, v12
v_add_u32 v17, 0x10000, v13
ds_read_b64_tr_b16 v[220:221], v10 offset:0
ds_read_b64_tr_b16 v[222:223], v10 offset:512
ds_read_b64_tr_b16 v[224:225], v11 offset:0
ds_read_b64_tr_b16 v[226:227], v11 offset:512
ds_read_b64_tr_b16 v[228:229], v12 offset:0
ds_read_b64_tr_b16 v[230:231], v12 offset:512
ds_read_b64_tr_b16 v[232:233], v13 offset:0
ds_read_b64_tr_b16 v[234:235], v13 offset:512
ds_read_b64_tr_b16 v[236:237], v10 offset:4096
ds_read_b64_tr_b16 v[238:239], v10 offset:4608
ds_read_b64_tr_b16 v[240:241], v11 offset:4096
ds_read_b64_tr_b16 v[242:243], v11 offset:4608
ds_read_b64_tr_b16 v[244:245], v12 offset:4096
ds_read_b64_tr_b16 v[246:247], v12 offset:4608
ds_read_b64_tr_b16 v[248:249], v13 offset:4096
ds_read_b64_tr_b16 v[250:251], v13 offset:4608
s_lshl_b32 s48, s41, 3
s_lshl_b32 s49, s40, 1
s_add_u32 s48, s48, s49
s_lshl_b32 s48, s48, 15
s_add_u32 s48, s48, 4194304
v_add_u32 v38, s48, v18
v_add_u32 v39, 32768, v38
s_lshl_b32 s57, s47, 11
s_mov_b32 s63, 0
s_waitcnt vmcnt(0)
poll_104:
v_cmp_gt_u32 vcc, 4, v37
s_cbranch_vccz polled_105
buffer_load_dword v37, v36, s[32:35], s84 offen sc1
s_add_u32 s63, s63, 1
s_cmp_lt_u32 s63, 0x80000
s_waitcnt vmcnt(0)
s_cbranch_scc1 poll_104
polled_105:
buffer_load_dwordx4 v[156:159], v38, s[32:35], s57 offen sc1
buffer_load_dwordx4 v[160:163], v39, s[32:35], s57 offen sc1
buffer_load_dwordx4 v[164:167], v38, s[32:35], s57 offen offset:1024 sc1
buffer_load_dwordx4 v[168:171], v39, s[32:35], s57 offen offset:1024 sc1
s_add_u32 s57, s57, 2048
s_and_b32 s57, s57, 0x7fff
buffer_load_dwordx4 v[172:175], v38, s[32:35], s57 offen sc1
buffer_load_dwordx4 v[176:179], v39, s[32:35], s57 offen sc1
buffer_load_dwordx4 v[180:183], v38, s[32:35], s57 offen offset:1024 sc1
buffer_load_dwordx4 v[184:187], v39, s[32:35], s57 offen offset:1024 sc1
s_add_u32 s57, s57, 2048
s_and_b32 s57, s57, 0x7fff
v_lshlrev_b32 v60, 16, v20
v_and_b32 v61, 0xffff0000, v20
v_lshlrev_b32 v62, 16, v21
v_and_b32 v63, 0xffff0000, v21
v_lshlrev_b32 v64, 16, v22
v_and_b32 v65, 0xffff0000, v22
v_lshlrev_b32 v66, 16, v23
v_and_b32 v67, 0xffff0000, v23
v_lshlrev_b32 v68, 16, v24
v_and_b32 v69, 0xffff0000, v24
v_lshlrev_b32 v70, 16, v25
v_and_b32 v71, 0xffff0000, v25
v_lshlrev_b32 v72, 16, v26
v_and_b32 v73, 0xffff0000, v26
v_lshlrev_b32 v74, 16, v27
v_and_b32 v75, 0xffff0000, v27
v_lshlrev_b32 v76, 16, v28
v_and_b32 v77, 0xffff0000, v28
v_lshlrev_b32 v78, 16, v29
v_and_b32 v79, 0xffff0000, v29
v_lshlrev_b32 v80, 16, v30
v_and_b32 v81, 0xffff0000, v30
v_lshlrev_b32 v82, 16, v31
v_and_b32 v83, 0xffff0000, v31
v_lshlrev_b32 v84, 16, v32
v_and_b32 v85, 0xffff0000, v32
v_lshlrev_b32 v86, 16, v33
v_and_b32 v87, 0xffff0000, v33
v_lshlrev_b32 v88, 16, v34
v_and_b32 v89, 0xffff0000, v34
v_lshlrev_b32 v90, 16, v35
v_and_b32 v91, 0xffff0000, v35
s_mov_b32 s24, s18
s_and_b32 s25, s19, 0xffff
s_mov_b32 s26, 4194304
s_mov_b32 s27, 0x00020000
s_lshl_b32 s48, s41, 7
s_lshl_b32 s49, s40, 5
s_add_u32 s48, s48, s49
v_add_u32 v4, s48, v2
v_lshlrev_b32 v4, 11, v4
v_and_b32 v5, 1, v3
v_lshl_add_u32 v4, v5, 5, v4
v_lshrrev_b32 v5, 1, v3
v_lshl_add_u32 v4, v5, 4, v4
s_lshl_b32 s49, s42, 7
v_add_u32 v40, s49, v4
v_add_u32 v41, 32768, v40
buffer_load_dwordx4 v[188:191], v38, s[32:35], s57 offen sc1
buffer_load_dwordx4 v[192:195], v39, s[32:35], s57 offen sc1
buffer_load_dwordx4 v[196:199], v38, s[32:35], s57 offen offset:1024 sc1
buffer_load_dwordx4 v[200:203], v39, s[32:35], s57 offen offset:1024 sc1
s_add_u32 s57, s57, 2048
s_and_b32 s57, s57, 0x7fff
s_waitcnt vmcnt(10) lgkmcnt(8)
v_mfma_f32_16x16x32_bf16 v[60:63], v[220:223], v[156:159], v[60:63]
ds_read_b64_tr_b16 v[100:101], v10 offset:8192
ds_read_b64_tr_b16 v[102:103], v10 offset:8704
v_mfma_f32_16x16x32_bf16 v[76:79], v[220:223], v[160:163], v[76:79]
buffer_load_dwordx4 v[204:207], v38, s[32:35], s57 offen sc1
v_mfma_f32_16x16x32_bf16 v[64:67], v[224:227], v[156:159], v[64:67]
ds_read_b64_tr_b16 v[104:105], v11 offset:8192
v_mfma_f32_16x16x32_bf16 v[80:83], v[224:227], v[160:163], v[80:83]
ds_read_b64_tr_b16 v[106:107], v11 offset:8704
v_mfma_f32_16x16x32_bf16 v[68:71], v[228:231], v[156:159], v[68:71]
ds_read_b64_tr_b16 v[108:109], v12 offset:8192
buffer_load_dwordx4 v[208:211], v39, s[32:35], s57 offen sc1
v_mfma_f32_16x16x32_bf16 v[84:87], v[228:231], v[160:163], v[84:87]
ds_read_b64_tr_b16 v[110:111], v12 offset:8704
v_mfma_f32_16x16x32_bf16 v[72:75], v[232:235], v[156:159], v[72:75]
ds_read_b64_tr_b16 v[112:113], v13 offset:8192
v_mfma_f32_16x16x32_bf16 v[88:91], v[232:235], v[160:163], v[88:91]
ds_read_b64_tr_b16 v[114:115], v13 offset:8704
s_waitcnt vmcnt(10) lgkmcnt(8)
v_mfma_f32_16x16x32_bf16 v[60:63], v[236:239], v[164:167], v[60:63]
ds_read_b64_tr_b16 v[220:221], v10 offset:12288
ds_read_b64_tr_b16 v[222:223], v10 offset:12800
v_mfma_f32_16x16x32_bf16 v[76:79], v[236:239], v[168:171], v[76:79]
buffer_load_dwordx4 v[212:215], v38, s[32:35], s57 offen offset:1024 sc1
v_mfma_f32_16x16x32_bf16 v[64:67], v[240:243], v[164:167], v[64:67]
ds_read_b64_tr_b16 v[224:225], v11 offset:12288
v_mfma_f32_16x16x32_bf16 v[80:83], v[240:243], v[168:171], v[80:83]
ds_read_b64_tr_b16 v[226:227], v11 offset:12800
v_mfma_f32_16x16x32_bf16 v[68:71], v[244:247], v[164:167], v[68:71]
ds_read_b64_tr_b16 v[228:229], v12 offset:12288
buffer_load_dwordx4 v[216:219], v39, s[32:35], s57 offen offset:1024 sc1
s_add_u32 s57, s57, 2048
s_and_b32 s57, s57, 0x7fff
v_mfma_f32_16x16x32_bf16 v[84:87], v[244:247], v[168:171], v[84:87]
ds_read_b64_tr_b16 v[230:231], v12 offset:12800
v_mfma_f32_16x16x32_bf16 v[72:75], v[248:251], v[164:167], v[72:75]
ds_read_b64_tr_b16 v[232:233], v13 offset:12288
v_mfma_f32_16x16x32_bf16 v[88:91], v[248:251], v[168:171], v[88:91]
ds_read_b64_tr_b16 v[234:235], v13 offset:12800
s_waitcnt vmcnt(10) lgkmcnt(8)
v_mfma_f32_16x16x32_bf16 v[60:63], v[100:103], v[172:175], v[60:63]
ds_read_b64_tr_b16 v[236:237], v10 offset:16384
ds_read_b64_tr_b16 v[238:239], v10 offset:16896
v_mfma_f32_16x16x32_bf16 v[76:79], v[100:103], v[176:179], v[76:79]
buffer_load_dwordx4 v[156:159], v38, s[32:35], s57 offen sc1
v_mfma_f32_16x16x32_bf16 v[64:67], v[104:107], v[172:175], v[64:67]
ds_read_b64_tr_b16 v[240:241], v11 offset:16384
v_mfma_f32_16x16x32_bf16 v[80:83], v[104:107], v[176:179], v[80:83]
ds_read_b64_tr_b16 v[242:243], v11 offset:16896
v_mfma_f32_16x16x32_bf16 v[68:71], v[108:111], v[172:175], v[68:71]
ds_read_b64_tr_b16 v[244:245], v12 offset:16384
buffer_load_dwordx4 v[160:163], v39, s[32:35], s57 offen sc1
v_mfma_f32_16x16x32_bf16 v[84:87], v[108:111], v[176:179], v[84:87]
ds_read_b64_tr_b16 v[246:247], v12 offset:16896
v_mfma_f32_16x16x32_bf16 v[72:75], v[112:115], v[172:175], v[72:75]
ds_read_b64_tr_b16 v[248:249], v13 offset:16384
v_mfma_f32_16x16x32_bf16 v[88:91], v[112:115], v[176:179], v[88:91]
ds_read_b64_tr_b16 v[250:251], v13 offset:16896
s_waitcnt vmcnt(10) lgkmcnt(8)
v_mfma_f32_16x16x32_bf16 v[60:63], v[220:223], v[180:183], v[60:63]
ds_read_b64_tr_b16 v[100:101], v10 offset:20480
ds_read_b64_tr_b16 v[102:103], v10 offset:20992
v_mfma_f32_16x16x32_bf16 v[76:79], v[220:223], v[184:187], v[76:79]
buffer_load_dwordx4 v[164:167], v38, s[32:35], s57 offen offset:1024 sc1
v_mfma_f32_16x16x32_bf16 v[64:67], v[224:227], v[180:183], v[64:67]
ds_read_b64_tr_b16 v[104:105], v11 offset:20480
v_mfma_f32_16x16x32_bf16 v[80:83], v[224:227], v[184:187], v[80:83]
ds_read_b64_tr_b16 v[106:107], v11 offset:20992
v_mfma_f32_16x16x32_bf16 v[68:71], v[228:231], v[180:183], v[68:71]
ds_read_b64_tr_b16 v[108:109], v12 offset:20480
buffer_load_dwordx4 v[168:171], v39, s[32:35], s57 offen offset:1024 sc1
s_add_u32 s57, s57, 2048
s_and_b32 s57, s57, 0x7fff
v_mfma_f32_16x16x32_bf16 v[84:87], v[228:231], v[184:187], v[84:87]
ds_read_b64_tr_b16 v[110:111], v12 offset:20992
v_mfma_f32_16x16x32_bf16 v[72:75], v[232:235], v[180:183], v[72:75]
ds_read_b64_tr_b16 v[112:113], v13 offset:20480
v_mfma_f32_16x16x32_bf16 v[88:91], v[232:235], v[184:187], v[88:91]
ds_read_b64_tr_b16 v[114:115], v13 offset:20992
s_waitcnt vmcnt(10) lgkmcnt(8)
v_mfma_f32_16x16x32_bf16 v[60:63], v[236:239], v[188:191], v[60:63]
ds_read_b64_tr_b16 v[220:221], v10 offset:24576
ds_read_b64_tr_b16 v[222:223], v10 offset:25088
v_mfma_f32_16x16x32_bf16 v[76:79], v[236:239], v[192:195], v[76:79]
buffer_load_dwordx4 v[172:175], v38, s[32:35], s57 offen sc1
v_mfma_f32_16x16x32_bf16 v[64:67], v[240:243], v[188:191], v[64:67]
ds_read_b64_tr_b16 v[224:225], v11 offset:24576
v_mfma_f32_16x16x32_bf16 v[80:83], v[240:243], v[192:195], v[80:83]
ds_read_b64_tr_b16 v[226:227], v11 offset:25088
v_mfma_f32_16x16x32_bf16 v[68:71], v[244:247], v[188:191], v[68:71]
ds_read_b64_tr_b16 v[228:229], v12 offset:24576
buffer_load_dwordx4 v[176:179], v39, s[32:35], s57 offen sc1
v_mfma_f32_16x16x32_bf16 v[84:87], v[244:247], v[192:195], v[84:87]
ds_read_b64_tr_b16 v[230:231], v12 offset:25088
v_mfma_f32_16x16x32_bf16 v[72:75], v[248:251], v[188:191], v[72:75]
ds_read_b64_tr_b16 v[232:233], v13 offset:24576
v_mfma_f32_16x16x32_bf16 v[88:91], v[248:251], v[192:195], v[88:91]
ds_read_b64_tr_b16 v[234:235], v13 offset:25088
s_waitcnt vmcnt(10) lgkmcnt(8)
v_mfma_f32_16x16x32_bf16 v[60:63], v[100:103], v[196:199], v[60:63]
ds_read_b64_tr_b16 v[236:237], v10 offset:28672
ds_read_b64_tr_b16 v[238:239], v10 offset:29184
v_mfma_f32_16x16x32_bf16 v[76:79], v[100:103], v[200:203], v[76:79]
buffer_load_dwordx4 v[180:183], v38, s[32:35], s57 offen offset:1024 sc1
v_mfma_f32_16x16x32_bf16 v[64:67], v[104:107], v[196:199], v[64:67]
ds_read_b64_tr_b16 v[240:241], v11 offset:28672
v_mfma_f32_16x16x32_bf16 v[80:83], v[104:107], v[200:203], v[80:83]
ds_read_b64_tr_b16 v[242:243], v11 offset:29184
v_mfma_f32_16x16x32_bf16 v[68:71], v[108:111], v[196:199], v[68:71]
ds_read_b64_tr_b16 v[244:245], v12 offset:28672
buffer_load_dwordx4 v[184:187], v39, s[32:35], s57 offen offset:1024 sc1
s_add_u32 s57, s57, 2048
s_and_b32 s57, s57, 0x7fff
v_mfma_f32_16x16x32_bf16 v[84:87], v[108:111], v[200:203], v[84:87]
ds_read_b64_tr_b16 v[246:247], v12 offset:29184
v_mfma_f32_16x16x32_bf16 v[72:75], v[112:115], v[196:199], v[72:75]
ds_read_b64_tr_b16 v[248:249], v13 offset:28672
v_mfma_f32_16x16x32_bf16 v[88:91], v[112:115], v[200:203], v[88:91]
ds_read_b64_tr_b16 v[250:251], v13 offset:29184
s_waitcnt vmcnt(10) lgkmcnt(8)
v_mfma_f32_16x16x32_bf16 v[60:63], v[220:223], v[204:207], v[60:63]
ds_read_b64_tr_b16 v[100:101], v10 offset:32768
ds_read_b64_tr_b16 v[102:103], v10 offset:33280
v_mfma_f32_16x16x32_bf16 v[76:79], v[220:223], v[208:211], v[76:79]
buffer_load_dwordx4 v[188:191], v38, s[32:35], s57 offen sc1
v_mfma_f32_16x16x32_bf16 v[64:67], v[224:227], v[204:207], v[64:67]
ds_read_b64_tr_b16 v[104:105], v11 offset:32768
v_mfma_f32_16x16x32_bf16 v[80:83], v[224:227], v[208:211], v[80:83]
ds_read_b64_tr_b16 v[106:107], v11 offset:33280
v_mfma_f32_16x16x32_bf16 v[68:71], v[228:231], v[204:207], v[68:71]
ds_read_b64_tr_b16 v[108:109], v12 offset:32768
buffer_load_dwordx4 v[192:195], v39, s[32:35], s57 offen sc1
v_mfma_f32_16x16x32_bf16 v[84:87], v[228:231], v[208:211], v[84:87]
ds_read_b64_tr_b16 v[110:111], v12 offset:33280
v_mfma_f32_16x16x32_bf16 v[72:75], v[232:235], v[204:207], v[72:75]
ds_read_b64_tr_b16 v[112:113], v13 offset:32768
v_mfma_f32_16x16x32_bf16 v[88:91], v[232:235], v[208:211], v[88:91]
ds_read_b64_tr_b16 v[114:115], v13 offset:33280
s_waitcnt vmcnt(10) lgkmcnt(8)
v_mfma_f32_16x16x32_bf16 v[60:63], v[236:239], v[212:215], v[60:63]
ds_read_b64_tr_b16 v[220:221], v10 offset:36864
ds_read_b64_tr_b16 v[222:223], v10 offset:37376
v_mfma_f32_16x16x32_bf16 v[76:79], v[236:239], v[216:219], v[76:79]
buffer_load_dwordx4 v[196:199], v38, s[32:35], s57 offen offset:1024 sc1
v_mfma_f32_16x16x32_bf16 v[64:67], v[240:243], v[212:215], v[64:67]
ds_read_b64_tr_b16 v[224:225], v11 offset:36864
v_mfma_f32_16x16x32_bf16 v[80:83], v[240:243], v[216:219], v[80:83]
ds_read_b64_tr_b16 v[226:227], v11 offset:37376
v_mfma_f32_16x16x32_bf16 v[68:71], v[244:247], v[212:215], v[68:71]
ds_read_b64_tr_b16 v[228:229], v12 offset:36864
buffer_load_dwordx4 v[200:203], v39, s[32:35], s57 offen offset:1024 sc1
s_add_u32 s57, s57, 2048
s_and_b32 s57, s57, 0x7fff
v_mfma_f32_16x16x32_bf16 v[84:87], v[244:247], v[216:219], v[84:87]
ds_read_b64_tr_b16 v[230:231], v12 offset:37376
v_mfma_f32_16x16x32_bf16 v[72:75], v[248:251], v[212:215], v[72:75]
ds_read_b64_tr_b16 v[232:233], v13 offset:36864
v_mfma_f32_16x16x32_bf16 v[88:91], v[248:251], v[216:219], v[88:91]
ds_read_b64_tr_b16 v[234:235], v13 offset:37376
s_waitcnt vmcnt(10) lgkmcnt(8)
v_mfma_f32_16x16x32_bf16 v[60:63], v[100:103], v[156:159], v[60:63]
ds_read_b64_tr_b16 v[236:237], v10 offset:40960
ds_read_b64_tr_b16 v[238:239], v10 offset:41472
v_mfma_f32_16x16x32_bf16 v[76:79], v[100:103], v[160:163], v[76:79]
buffer_load_dwordx4 v[204:207], v38, s[32:35], s57 offen sc1
v_mfma_f32_16x16x32_bf16 v[64:67], v[104:107], v[156:159], v[64:67]
ds_read_b64_tr_b16 v[240:241], v11 offset:40960
v_mfma_f32_16x16x32_bf16 v[80:83], v[104:107], v[160:163], v[80:83]
ds_read_b64_tr_b16 v[242:243], v11 offset:41472
v_mfma_f32_16x16x32_bf16 v[68:71], v[108:111], v[156:159], v[68:71]
ds_read_b64_tr_b16 v[244:245], v12 offset:40960
buffer_load_dwordx4 v[208:211], v39, s[32:35], s57 offen sc1
v_mfma_f32_16x16x32_bf16 v[84:87], v[108:111], v[160:163], v[84:87]
ds_read_b64_tr_b16 v[246:247], v12 offset:41472
v_mfma_f32_16x16x32_bf16 v[72:75], v[112:115], v[156:159], v[72:75]
ds_read_b64_tr_b16 v[248:249], v13 offset:40960
v_mfma_f32_16x16x32_bf16 v[88:91], v[112:115], v[160:163], v[88:91]
ds_read_b64_tr_b16 v[250:251], v13 offset:41472
s_waitcnt vmcnt(10) lgkmcnt(8)
v_mfma_f32_16x16x32_bf16 v[60:63], v[220:223], v[164:167], v[60:63]
ds_read_b64_tr_b16 v[100:101], v10 offset:45056
ds_read_b64_tr_b16 v[102:103], v10 offset:45568
v_mfma_f32_16x16x32_bf16 v[76:79], v[220:223], v[168:171], v[76:79]
buffer_load_dwordx4 v[212:215], v38, s[32:35], s57 offen offset:1024 sc1
v_mfma_f32_16x16x32_bf16 v[64:67], v[224:227], v[164:167], v[64:67]
ds_read_b64_tr_b16 v[104:105], v11 offset:45056
v_mfma_f32_16x16x32_bf16 v[80:83], v[224:227], v[168:171], v[80:83]
ds_read_b64_tr_b16 v[106:107], v11 offset:45568
v_mfma_f32_16x16x32_bf16 v[68:71], v[228:231], v[164:167], v[68:71]
ds_read_b64_tr_b16 v[108:109], v12 offset:45056
buffer_load_dwordx4 v[216:219], v39, s[32:35], s57 offen offset:1024 sc1
s_add_u32 s57, s57, 2048
s_and_b32 s57, s57, 0x7fff
v_mfma_f32_16x16x32_bf16 v[84:87], v[228:231], v[168:171], v[84:87]
ds_read_b64_tr_b16 v[110:111], v12 offset:45568
v_mfma_f32_16x16x32_bf16 v[72:75], v[232:235], v[164:167], v[72:75]
ds_read_b64_tr_b16 v[112:113], v13 offset:45056
v_mfma_f32_16x16x32_bf16 v[88:91], v[232:235], v[168:171], v[88:91]
ds_read_b64_tr_b16 v[114:115], v13 offset:45568
s_waitcnt vmcnt(10) lgkmcnt(8)
v_mfma_f32_16x16x32_bf16 v[60:63], v[236:239], v[172:175], v[60:63]
ds_read_b64_tr_b16 v[220:221], v10 offset:49152
ds_read_b64_tr_b16 v[222:223], v10 offset:49664
v_mfma_f32_16x16x32_bf16 v[76:79], v[236:239], v[176:179], v[76:79]
buffer_load_dwordx4 v[156:159], v38, s[32:35], s57 offen sc1
v_mfma_f32_16x16x32_bf16 v[64:67], v[240:243], v[172:175], v[64:67]
ds_read_b64_tr_b16 v[224:225], v11 offset:49152
v_mfma_f32_16x16x32_bf16 v[80:83], v[240:243], v[176:179], v[80:83]
ds_read_b64_tr_b16 v[226:227], v11 offset:49664
v_mfma_f32_16x16x32_bf16 v[68:71], v[244:247], v[172:175], v[68:71]
ds_read_b64_tr_b16 v[228:229], v12 offset:49152
buffer_load_dwordx4 v[160:163], v39, s[32:35], s57 offen sc1
v_mfma_f32_16x16x32_bf16 v[84:87], v[244:247], v[176:179], v[84:87]
ds_read_b64_tr_b16 v[230:231], v12 offset:49664
v_mfma_f32_16x16x32_bf16 v[72:75], v[248:251], v[172:175], v[72:75]
ds_read_b64_tr_b16 v[232:233], v13 offset:49152
v_mfma_f32_16x16x32_bf16 v[88:91], v[248:251], v[176:179], v[88:91]
ds_read_b64_tr_b16 v[234:235], v13 offset:49664
s_waitcnt vmcnt(10) lgkmcnt(8)
v_mfma_f32_16x16x32_bf16 v[60:63], v[100:103], v[180:183], v[60:63]
ds_read_b64_tr_b16 v[236:237], v10 offset:53248
ds_read_b64_tr_b16 v[238:239], v10 offset:53760
v_mfma_f32_16x16x32_bf16 v[76:79], v[100:103], v[184:187], v[76:79]
buffer_load_dwordx4 v[164:167], v38, s[32:35], s57 offen offset:1024 sc1
v_mfma_f32_16x16x32_bf16 v[64:67], v[104:107], v[180:183], v[64:67]
ds_read_b64_tr_b16 v[240:241], v11 offset:53248
v_mfma_f32_16x16x32_bf16 v[80:83], v[104:107], v[184:187], v[80:83]
ds_read_b64_tr_b16 v[242:243], v11 offset:53760
v_mfma_f32_16x16x32_bf16 v[68:71], v[108:111], v[180:183], v[68:71]
ds_read_b64_tr_b16 v[244:245], v12 offset:53248
buffer_load_dwordx4 v[168:171], v39, s[32:35], s57 offen offset:1024 sc1
s_add_u32 s57, s57, 2048
s_and_b32 s57, s57, 0x7fff
v_mfma_f32_16x16x32_bf16 v[84:87], v[108:111], v[184:187], v[84:87]
ds_read_b64_tr_b16 v[246:247], v12 offset:53760
v_mfma_f32_16x16x32_bf16 v[72:75], v[112:115], v[180:183], v[72:75]
ds_read_b64_tr_b16 v[248:249], v13 offset:53248
v_mfma_f32_16x16x32_bf16 v[88:91], v[112:115], v[184:187], v[88:91]
ds_read_b64_tr_b16 v[250:251], v13 offset:53760
s_waitcnt vmcnt(10) lgkmcnt(8)
v_mfma_f32_16x16x32_bf16 v[60:63], v[220:223], v[188:191], v[60:63]
ds_read_b64_tr_b16 v[100:101], v10 offset:57344
ds_read_b64_tr_b16 v[102:103], v10 offset:57856
v_mfma_f32_16x16x32_bf16 v[76:79], v[220:223], v[192:195], v[76:79]
buffer_load_dwordx4 v[172:175], v38, s[32:35], s57 offen sc1
v_mfma_f32_16x16x32_bf16 v[64:67], v[224:227], v[188:191], v[64:67]
ds_read_b64_tr_b16 v[104:105], v11 offset:57344
v_mfma_f32_16x16x32_bf16 v[80:83], v[224:227], v[192:195], v[80:83]
ds_read_b64_tr_b16 v[106:107], v11 offset:57856
v_mfma_f32_16x16x32_bf16 v[68:71], v[228:231], v[188:191], v[68:71]
ds_read_b64_tr_b16 v[108:109], v12 offset:57344
buffer_load_dwordx4 v[176:179], v39, s[32:35], s57 offen sc1
v_mfma_f32_16x16x32_bf16 v[84:87], v[228:231], v[192:195], v[84:87]
ds_read_b64_tr_b16 v[110:111], v12 offset:57856
v_mfma_f32_16x16x32_bf16 v[72:75], v[232:235], v[188:191], v[72:75]
ds_read_b64_tr_b16 v[112:113], v13 offset:57344
v_mfma_f32_16x16x32_bf16 v[88:91], v[232:235], v[192:195], v[88:91]
ds_read_b64_tr_b16 v[114:115], v13 offset:57856
s_waitcnt vmcnt(10) lgkmcnt(8)
v_mfma_f32_16x16x32_bf16 v[60:63], v[236:239], v[196:199], v[60:63]
ds_read_b64_tr_b16 v[220:221], v10 offset:61440
ds_read_b64_tr_b16 v[222:223], v10 offset:61952
v_mfma_f32_16x16x32_bf16 v[76:79], v[236:239], v[200:203], v[76:79]
buffer_load_dwordx4 v[180:183], v38, s[32:35], s57 offen offset:1024 sc1
v_mfma_f32_16x16x32_bf16 v[64:67], v[240:243], v[196:199], v[64:67]
ds_read_b64_tr_b16 v[224:225], v11 offset:61440
v_mfma_f32_16x16x32_bf16 v[80:83], v[240:243], v[200:203], v[80:83]
ds_read_b64_tr_b16 v[226:227], v11 offset:61952
v_mfma_f32_16x16x32_bf16 v[68:71], v[244:247], v[196:199], v[68:71]
ds_read_b64_tr_b16 v[228:229], v12 offset:61440
buffer_load_dwordx4 v[184:187], v39, s[32:35], s57 offen offset:1024 sc1
s_add_u32 s57, s57, 2048
s_and_b32 s57, s57, 0x7fff
v_mfma_f32_16x16x32_bf16 v[84:87], v[244:247], v[200:203], v[84:87]
ds_read_b64_tr_b16 v[230:231], v12 offset:61952
v_mfma_f32_16x16x32_bf16 v[72:75], v[248:251], v[196:199], v[72:75]
ds_read_b64_tr_b16 v[232:233], v13 offset:61440
v_mfma_f32_16x16x32_bf16 v[88:91], v[248:251], v[200:203], v[88:91]
ds_read_b64_tr_b16 v[234:235], v13 offset:61952
s_waitcnt vmcnt(10) lgkmcnt(8)
v_mfma_f32_16x16x32_bf16 v[60:63], v[100:103], v[204:207], v[60:63]
ds_read_b64_tr_b16 v[236:237], v14 offset:0
ds_read_b64_tr_b16 v[238:239], v14 offset:512
v_mfma_f32_16x16x32_bf16 v[76:79], v[100:103], v[208:211], v[76:79]
buffer_load_dwordx4 v[188:191], v38, s[32:35], s57 offen sc1
v_mfma_f32_16x16x32_bf16 v[64:67], v[104:107], v[204:207], v[64:67]
ds_read_b64_tr_b16 v[240:241], v15 offset:0
v_mfma_f32_16x16x32_bf16 v[80:83], v[104:107], v[208:211], v[80:83]
ds_read_b64_tr_b16 v[242:243], v15 offset:512
v_mfma_f32_16x16x32_bf16 v[68:71], v[108:111], v[204:207], v[68:71]
ds_read_b64_tr_b16 v[244:245], v16 offset:0
buffer_load_dwordx4 v[192:195], v39, s[32:35], s57 offen sc1
v_mfma_f32_16x16x32_bf16 v[84:87], v[108:111], v[208:211], v[84:87]
ds_read_b64_tr_b16 v[246:247], v16 offset:512
v_mfma_f32_16x16x32_bf16 v[72:75], v[112:115], v[204:207], v[72:75]
ds_read_b64_tr_b16 v[248:249], v17 offset:0
v_mfma_f32_16x16x32_bf16 v[88:91], v[112:115], v[208:211], v[88:91]
ds_read_b64_tr_b16 v[250:251], v17 offset:512
s_waitcnt vmcnt(10) lgkmcnt(8)
v_mfma_f32_16x16x32_bf16 v[60:63], v[220:223], v[212:215], v[60:63]
ds_read_b64_tr_b16 v[100:101], v14 offset:4096
ds_read_b64_tr_b16 v[102:103], v14 offset:4608
v_mfma_f32_16x16x32_bf16 v[76:79], v[220:223], v[216:219], v[76:79]
buffer_load_dwordx4 v[196:199], v38, s[32:35], s57 offen offset:1024 sc1
v_mfma_f32_16x16x32_bf16 v[64:67], v[224:227], v[212:215], v[64:67]
ds_read_b64_tr_b16 v[104:105], v15 offset:4096
v_mfma_f32_16x16x32_bf16 v[80:83], v[224:227], v[216:219], v[80:83]
ds_read_b64_tr_b16 v[106:107], v15 offset:4608
v_mfma_f32_16x16x32_bf16 v[68:71], v[228:231], v[212:215], v[68:71]
ds_read_b64_tr_b16 v[108:109], v16 offset:4096
buffer_load_dwordx4 v[200:203], v39, s[32:35], s57 offen offset:1024 sc1
s_add_u32 s57, s57, 2048
s_and_b32 s57, s57, 0x7fff
v_mfma_f32_16x16x32_bf16 v[84:87], v[228:231], v[216:219], v[84:87]
ds_read_b64_tr_b16 v[110:111], v16 offset:4608
v_mfma_f32_16x16x32_bf16 v[72:75], v[232:235], v[212:215], v[72:75]
ds_read_b64_tr_b16 v[112:113], v17 offset:4096
v_mfma_f32_16x16x32_bf16 v[88:91], v[232:235], v[216:219], v[88:91]
ds_read_b64_tr_b16 v[114:115], v17 offset:4608
s_waitcnt vmcnt(10) lgkmcnt(8)
v_mfma_f32_16x16x32_bf16 v[60:63], v[236:239], v[156:159], v[60:63]
ds_read_b64_tr_b16 v[220:221], v14 offset:8192
ds_read_b64_tr_b16 v[222:223], v14 offset:8704
v_mfma_f32_16x16x32_bf16 v[76:79], v[236:239], v[160:163], v[76:79]
buffer_load_dwordx4 v[204:207], v38, s[32:35], s57 offen sc1
v_mfma_f32_16x16x32_bf16 v[64:67], v[240:243], v[156:159], v[64:67]
ds_read_b64_tr_b16 v[224:225], v15 offset:8192
v_mfma_f32_16x16x32_bf16 v[80:83], v[240:243], v[160:163], v[80:83]
ds_read_b64_tr_b16 v[226:227], v15 offset:8704
v_mfma_f32_16x16x32_bf16 v[68:71], v[244:247], v[156:159], v[68:71]
ds_read_b64_tr_b16 v[228:229], v16 offset:8192
buffer_load_dwordx4 v[208:211], v39, s[32:35], s57 offen sc1
v_mfma_f32_16x16x32_bf16 v[84:87], v[244:247], v[160:163], v[84:87]
ds_read_b64_tr_b16 v[230:231], v16 offset:8704
v_mfma_f32_16x16x32_bf16 v[72:75], v[248:251], v[156:159], v[72:75]
ds_read_b64_tr_b16 v[232:233], v17 offset:8192
v_mfma_f32_16x16x32_bf16 v[88:91], v[248:251], v[160:163], v[88:91]
ds_read_b64_tr_b16 v[234:235], v17 offset:8704
s_waitcnt vmcnt(10) lgkmcnt(8)
v_mfma_f32_16x16x32_bf16 v[60:63], v[100:103], v[164:167], v[60:63]
ds_read_b64_tr_b16 v[236:237], v14 offset:12288
ds_read_b64_tr_b16 v[238:239], v14 offset:12800
v_mfma_f32_16x16x32_bf16 v[76:79], v[100:103], v[168:171], v[76:79]
buffer_load_dwordx4 v[212:215], v38, s[32:35], s57 offen offset:1024 sc1
v_mfma_f32_16x16x32_bf16 v[64:67], v[104:107], v[164:167], v[64:67]
ds_read_b64_tr_b16 v[240:241], v15 offset:12288
v_mfma_f32_16x16x32_bf16 v[80:83], v[104:107], v[168:171], v[80:83]
ds_read_b64_tr_b16 v[242:243], v15 offset:12800
v_mfma_f32_16x16x32_bf16 v[68:71], v[108:111], v[164:167], v[68:71]
ds_read_b64_tr_b16 v[244:245], v16 offset:12288
buffer_load_dwordx4 v[216:219], v39, s[32:35], s57 offen offset:1024 sc1
s_add_u32 s57, s57, 2048
s_and_b32 s57, s57, 0x7fff
v_mfma_f32_16x16x32_bf16 v[84:87], v[108:111], v[168:171], v[84:87]
ds_read_b64_tr_b16 v[246:247], v16 offset:12800
v_mfma_f32_16x16x32_bf16 v[72:75], v[112:115], v[164:167], v[72:75]
ds_read_b64_tr_b16 v[248:249], v17 offset:12288
v_mfma_f32_16x16x32_bf16 v[88:91], v[112:115], v[168:171], v[88:91]
ds_read_b64_tr_b16 v[250:251], v17 offset:12800
s_waitcnt vmcnt(10) lgkmcnt(8)
v_mfma_f32_16x16x32_bf16 v[60:63], v[220:223], v[172:175], v[60:63]
ds_read_b64_tr_b16 v[100:101], v14 offset:16384
ds_read_b64_tr_b16 v[102:103], v14 offset:16896
v_mfma_f32_16x16x32_bf16 v[76:79], v[220:223], v[176:179], v[76:79]
buffer_load_dwordx4 v[156:159], v38, s[32:35], s57 offen sc1
v_mfma_f32_16x16x32_bf16 v[64:67], v[224:227], v[172:175], v[64:67]
ds_read_b64_tr_b16 v[104:105], v15 offset:16384
v_mfma_f32_16x16x32_bf16 v[80:83], v[224:227], v[176:179], v[80:83]
ds_read_b64_tr_b16 v[106:107], v15 offset:16896
v_mfma_f32_16x16x32_bf16 v[68:71], v[228:231], v[172:175], v[68:71]
ds_read_b64_tr_b16 v[108:109], v16 offset:16384
buffer_load_dwordx4 v[160:163], v39, s[32:35], s57 offen sc1
v_mfma_f32_16x16x32_bf16 v[84:87], v[228:231], v[176:179], v[84:87]
ds_read_b64_tr_b16 v[110:111], v16 offset:16896
v_mfma_f32_16x16x32_bf16 v[72:75], v[232:235], v[172:175], v[72:75]
ds_read_b64_tr_b16 v[112:113], v17 offset:16384
v_mfma_f32_16x16x32_bf16 v[88:91], v[232:235], v[176:179], v[88:91]
ds_read_b64_tr_b16 v[114:115], v17 offset:16896
s_waitcnt vmcnt(10) lgkmcnt(8)
v_mfma_f32_16x16x32_bf16 v[60:63], v[236:239], v[180:183], v[60:63]
ds_read_b64_tr_b16 v[220:221], v14 offset:20480
ds_read_b64_tr_b16 v[222:223], v14 offset:20992
v_mfma_f32_16x16x32_bf16 v[76:79], v[236:239], v[184:187], v[76:79]
buffer_load_dwordx4 v[164:167], v38, s[32:35], s57 offen offset:1024 sc1
v_mfma_f32_16x16x32_bf16 v[64:67], v[240:243], v[180:183], v[64:67]
ds_read_b64_tr_b16 v[224:225], v15 offset:20480
v_mfma_f32_16x16x32_bf16 v[80:83], v[240:243], v[184:187], v[80:83]
ds_read_b64_tr_b16 v[226:227], v15 offset:20992
v_mfma_f32_16x16x32_bf16 v[68:71], v[244:247], v[180:183], v[68:71]
ds_read_b64_tr_b16 v[228:229], v16 offset:20480
buffer_load_dwordx4 v[168:171], v39, s[32:35], s57 offen offset:1024 sc1
s_add_u32 s57, s57, 2048
s_and_b32 s57, s57, 0x7fff
v_mfma_f32_16x16x32_bf16 v[84:87], v[244:247], v[184:187], v[84:87]
ds_read_b64_tr_b16 v[230:231], v16 offset:20992
v_mfma_f32_16x16x32_bf16 v[72:75], v[248:251], v[180:183], v[72:75]
ds_read_b64_tr_b16 v[232:233], v17 offset:20480
v_mfma_f32_16x16x32_bf16 v[88:91], v[248:251], v[184:187], v[88:91]
ds_read_b64_tr_b16 v[234:235], v17 offset:20992
s_waitcnt vmcnt(10) lgkmcnt(8)
v_mfma_f32_16x16x32_bf16 v[60:63], v[100:103], v[188:191], v[60:63]
ds_read_b64_tr_b16 v[236:237], v14 offset:24576
ds_read_b64_tr_b16 v[238:239], v14 offset:25088
v_mfma_f32_16x16x32_bf16 v[76:79], v[100:103], v[192:195], v[76:79]
buffer_load_dwordx4 v[172:175], v38, s[32:35], s57 offen sc1
v_mfma_f32_16x16x32_bf16 v[64:67], v[104:107], v[188:191], v[64:67]
ds_read_b64_tr_b16 v[240:241], v15 offset:24576
v_mfma_f32_16x16x32_bf16 v[80:83], v[104:107], v[192:195], v[80:83]
ds_read_b64_tr_b16 v[242:243], v15 offset:25088
v_mfma_f32_16x16x32_bf16 v[68:71], v[108:111], v[188:191], v[68:71]
ds_read_b64_tr_b16 v[244:245], v16 offset:24576
buffer_load_dwordx4 v[176:179], v39, s[32:35], s57 offen sc1
v_mfma_f32_16x16x32_bf16 v[84:87], v[108:111], v[192:195], v[84:87]
ds_read_b64_tr_b16 v[246:247], v16 offset:25088
v_mfma_f32_16x16x32_bf16 v[72:75], v[112:115], v[188:191], v[72:75]
ds_read_b64_tr_b16 v[248:249], v17 offset:24576
v_mfma_f32_16x16x32_bf16 v[88:91], v[112:115], v[192:195], v[88:91]
ds_read_b64_tr_b16 v[250:251], v17 offset:25088
s_waitcnt vmcnt(10) lgkmcnt(8)
v_mfma_f32_16x16x32_bf16 v[60:63], v[220:223], v[196:199], v[60:63]
ds_read_b64_tr_b16 v[100:101], v14 offset:28672
ds_read_b64_tr_b16 v[102:103], v14 offset:29184
v_mfma_f32_16x16x32_bf16 v[76:79], v[220:223], v[200:203], v[76:79]
buffer_load_dwordx4 v[180:183], v38, s[32:35], s57 offen offset:1024 sc1
v_mfma_f32_16x16x32_bf16 v[64:67], v[224:227], v[196:199], v[64:67]
ds_read_b64_tr_b16 v[104:105], v15 offset:28672
v_mfma_f32_16x16x32_bf16 v[80:83], v[224:227], v[200:203], v[80:83]
ds_read_b64_tr_b16 v[106:107], v15 offset:29184
v_mfma_f32_16x16x32_bf16 v[68:71], v[228:231], v[196:199], v[68:71]
ds_read_b64_tr_b16 v[108:109], v16 offset:28672
buffer_load_dwordx4 v[184:187], v39, s[32:35], s57 offen offset:1024 sc1
s_add_u32 s57, s57, 2048
s_and_b32 s57, s57, 0x7fff
v_mfma_f32_16x16x32_bf16 v[84:87], v[228:231], v[200:203], v[84:87]
ds_read_b64_tr_b16 v[110:111], v16 offset:29184
v_mfma_f32_16x16x32_bf16 v[72:75], v[232:235], v[196:199], v[72:75]
ds_read_b64_tr_b16 v[112:113], v17 offset:28672
v_mfma_f32_16x16x32_bf16 v[88:91], v[232:235], v[200:203], v[88:91]
ds_read_b64_tr_b16 v[114:115], v17 offset:29184
s_waitcnt vmcnt(10) lgkmcnt(8)
v_mfma_f32_16x16x32_bf16 v[60:63], v[236:239], v[204:207], v[60:63]
ds_read_b64_tr_b16 v[220:221], v14 offset:32768
ds_read_b64_tr_b16 v[222:223], v14 offset:33280
v_mfma_f32_16x16x32_bf16 v[76:79], v[236:239], v[208:211], v[76:79]
buffer_load_dwordx4 v[188:191], v38, s[32:35], s57 offen sc1
v_mfma_f32_16x16x32_bf16 v[64:67], v[240:243], v[204:207], v[64:67]
ds_read_b64_tr_b16 v[224:225], v15 offset:32768
v_mfma_f32_16x16x32_bf16 v[80:83], v[240:243], v[208:211], v[80:83]
ds_read_b64_tr_b16 v[226:227], v15 offset:33280
v_mfma_f32_16x16x32_bf16 v[68:71], v[244:247], v[204:207], v[68:71]
ds_read_b64_tr_b16 v[228:229], v16 offset:32768
buffer_load_dwordx4 v[192:195], v39, s[32:35], s57 offen sc1
v_mfma_f32_16x16x32_bf16 v[84:87], v[244:247], v[208:211], v[84:87]
ds_read_b64_tr_b16 v[230:231], v16 offset:33280
v_mfma_f32_16x16x32_bf16 v[72:75], v[248:251], v[204:207], v[72:75]
ds_read_b64_tr_b16 v[232:233], v17 offset:32768
v_mfma_f32_16x16x32_bf16 v[88:91], v[248:251], v[208:211], v[88:91]
ds_read_b64_tr_b16 v[234:235], v17 offset:33280
s_waitcnt vmcnt(10) lgkmcnt(8)
v_mfma_f32_16x16x32_bf16 v[60:63], v[100:103], v[212:215], v[60:63]
ds_read_b64_tr_b16 v[236:237], v14 offset:36864
ds_read_b64_tr_b16 v[238:239], v14 offset:37376
v_mfma_f32_16x16x32_bf16 v[76:79], v[100:103], v[216:219], v[76:79]
buffer_load_dwordx4 v[196:199], v38, s[32:35], s57 offen offset:1024 sc1
v_mfma_f32_16x16x32_bf16 v[64:67], v[104:107], v[212:215], v[64:67]
ds_read_b64_tr_b16 v[240:241], v15 offset:36864
v_mfma_f32_16x16x32_bf16 v[80:83], v[104:107], v[216:219], v[80:83]
ds_read_b64_tr_b16 v[242:243], v15 offset:37376
v_mfma_f32_16x16x32_bf16 v[68:71], v[108:111], v[212:215], v[68:71]
ds_read_b64_tr_b16 v[244:245], v16 offset:36864
buffer_load_dwordx4 v[200:203], v39, s[32:35], s57 offen offset:1024 sc1
s_add_u32 s57, s57, 2048
s_and_b32 s57, s57, 0x7fff
v_mfma_f32_16x16x32_bf16 v[84:87], v[108:111], v[216:219], v[84:87]
ds_read_b64_tr_b16 v[246:247], v16 offset:37376
v_mfma_f32_16x16x32_bf16 v[72:75], v[112:115], v[212:215], v[72:75]
ds_read_b64_tr_b16 v[248:249], v17 offset:36864
v_mfma_f32_16x16x32_bf16 v[88:91], v[112:115], v[216:219], v[88:91]
ds_read_b64_tr_b16 v[250:251], v17 offset:37376
s_waitcnt vmcnt(10) lgkmcnt(8)
v_mfma_f32_16x16x32_bf16 v[60:63], v[220:223], v[156:159], v[60:63]
ds_read_b64_tr_b16 v[100:101], v14 offset:40960
ds_read_b64_tr_b16 v[102:103], v14 offset:41472
v_mfma_f32_16x16x32_bf16 v[76:79], v[220:223], v[160:163], v[76:79]
buffer_load_dwordx4 v[204:207], v38, s[32:35], s57 offen sc1
v_mfma_f32_16x16x32_bf16 v[64:67], v[224:227], v[156:159], v[64:67]
ds_read_b64_tr_b16 v[104:105], v15 offset:40960
v_mfma_f32_16x16x32_bf16 v[80:83], v[224:227], v[160:163], v[80:83]
ds_read_b64_tr_b16 v[106:107], v15 offset:41472
v_mfma_f32_16x16x32_bf16 v[68:71], v[228:231], v[156:159], v[68:71]
ds_read_b64_tr_b16 v[108:109], v16 offset:40960
buffer_load_dwordx4 v[208:211], v39, s[32:35], s57 offen sc1
v_mfma_f32_16x16x32_bf16 v[84:87], v[228:231], v[160:163], v[84:87]
ds_read_b64_tr_b16 v[110:111], v16 offset:41472
v_mfma_f32_16x16x32_bf16 v[72:75], v[232:235], v[156:159], v[72:75]
ds_read_b64_tr_b16 v[112:113], v17 offset:40960
v_mfma_f32_16x16x32_bf16 v[88:91], v[232:235], v[160:163], v[88:91]
ds_read_b64_tr_b16 v[114:115], v17 offset:41472
s_waitcnt vmcnt(10) lgkmcnt(8)
v_mfma_f32_16x16x32_bf16 v[60:63], v[236:239], v[164:167], v[60:63]
ds_read_b64_tr_b16 v[220:221], v14 offset:45056
ds_read_b64_tr_b16 v[222:223], v14 offset:45568
v_mfma_f32_16x16x32_bf16 v[76:79], v[236:239], v[168:171], v[76:79]
buffer_load_dwordx4 v[212:215], v38, s[32:35], s57 offen offset:1024 sc1
v_mfma_f32_16x16x32_bf16 v[64:67], v[240:243], v[164:167], v[64:67]
ds_read_b64_tr_b16 v[224:225], v15 offset:45056
v_mfma_f32_16x16x32_bf16 v[80:83], v[240:243], v[168:171], v[80:83]
ds_read_b64_tr_b16 v[226:227], v15 offset:45568
v_mfma_f32_16x16x32_bf16 v[68:71], v[244:247], v[164:167], v[68:71]
ds_read_b64_tr_b16 v[228:229], v16 offset:45056
buffer_load_dwordx4 v[216:219], v39, s[32:35], s57 offen offset:1024 sc1
s_add_u32 s57, s57, 2048
s_and_b32 s57, s57, 0x7fff
v_mfma_f32_16x16x32_bf16 v[84:87], v[244:247], v[168:171], v[84:87]
ds_read_b64_tr_b16 v[230:231], v16 offset:45568
v_mfma_f32_16x16x32_bf16 v[72:75], v[248:251], v[164:167], v[72:75]
ds_read_b64_tr_b16 v[232:233], v17 offset:45056
v_mfma_f32_16x16x32_bf16 v[88:91], v[248:251], v[168:171], v[88:91]
ds_read_b64_tr_b16 v[234:235], v17 offset:45568
s_waitcnt vmcnt(10) lgkmcnt(8)
v_mfma_f32_16x16x32_bf16 v[60:63], v[100:103], v[172:175], v[60:63]
ds_read_b64_tr_b16 v[236:237], v14 offset:49152
v_mfma_f32_16x16x32_bf16 v[76:79], v[100:103], v[176:179], v[76:79]
ds_read_b64_tr_b16 v[238:239], v14 offset:49664
v_mfma_f32_16x16x32_bf16 v[64:67], v[104:107], v[172:175], v[64:67]
ds_read_b64_tr_b16 v[240:241], v15 offset:49152
v_mfma_f32_16x16x32_bf16 v[80:83], v[104:107], v[176:179], v[80:83]
ds_read_b64_tr_b16 v[242:243], v15 offset:49664
v_mfma_f32_16x16x32_bf16 v[68:71], v[108:111], v[172:175], v[68:71]
ds_read_b64_tr_b16 v[244:245], v16 offset:49152
v_mfma_f32_16x16x32_bf16 v[84:87], v[108:111], v[176:179], v[84:87]
ds_read_b64_tr_b16 v[246:247], v16 offset:49664
v_mfma_f32_16x16x32_bf16 v[72:75], v[112:115], v[172:175], v[72:75]
ds_read_b64_tr_b16 v[248:249], v17 offset:49152
v_mfma_f32_16x16x32_bf16 v[88:91], v[112:115], v[176:179], v[88:91]
ds_read_b64_tr_b16 v[250:251], v17 offset:49664
s_waitcnt vmcnt(8) lgkmcnt(8)
v_mfma_f32_16x16x32_bf16 v[60:63], v[220:223], v[180:183], v[60:63]
ds_read_b64_tr_b16 v[100:101], v14 offset:53248
v_mfma_f32_16x16x32_bf16 v[76:79], v[220:223], v[184:187], v[76:79]
ds_read_b64_tr_b16 v[102:103], v14 offset:53760
v_mfma_f32_16x16x32_bf16 v[64:67], v[224:227], v[180:183], v[64:67]
ds_read_b64_tr_b16 v[104:105], v15 offset:53248
v_mfma_f32_16x16x32_bf16 v[80:83], v[224:227], v[184:187], v[80:83]
ds_read_b64_tr_b16 v[106:107], v15 offset:53760
v_mfma_f32_16x16x32_bf16 v[68:71], v[228:231], v[180:183], v[68:71]
ds_read_b64_tr_b16 v[108:109], v16 offset:53248
v_mfma_f32_16x16x32_bf16 v[84:87], v[228:231], v[184:187], v[84:87]
ds_read_b64_tr_b16 v[110:111], v16 offset:53760
v_mfma_f32_16x16x32_bf16 v[72:75], v[232:235], v[180:183], v[72:75]
ds_read_b64_tr_b16 v[112:113], v17 offset:53248
v_mfma_f32_16x16x32_bf16 v[88:91], v[232:235], v[184:187], v[88:91]
ds_read_b64_tr_b16 v[114:115], v17 offset:53760
s_waitcnt vmcnt(6) lgkmcnt(8)
v_mfma_f32_16x16x32_bf16 v[60:63], v[236:239], v[188:191], v[60:63]
ds_read_b64_tr_b16 v[220:221], v14 offset:57344
v_mfma_f32_16x16x32_bf16 v[76:79], v[236:239], v[192:195], v[76:79]
ds_read_b64_tr_b16 v[222:223], v14 offset:57856
v_mfma_f32_16x16x32_bf16 v[64:67], v[240:243], v[188:191], v[64:67]
ds_read_b64_tr_b16 v[224:225], v15 offset:57344
v_mfma_f32_16x16x32_bf16 v[80:83], v[240:243], v[192:195], v[80:83]
ds_read_b64_tr_b16 v[226:227], v15 offset:57856
v_mfma_f32_16x16x32_bf16 v[68:71], v[244:247], v[188:191], v[68:71]
ds_read_b64_tr_b16 v[228:229], v16 offset:57344
v_mfma_f32_16x16x32_bf16 v[84:87], v[244:247], v[192:195], v[84:87]
ds_read_b64_tr_b16 v[230:231], v16 offset:57856
v_mfma_f32_16x16x32_bf16 v[72:75], v[248:251], v[188:191], v[72:75]
ds_read_b64_tr_b16 v[232:233], v17 offset:57344
v_mfma_f32_16x16x32_bf16 v[88:91], v[248:251], v[192:195], v[88:91]
ds_read_b64_tr_b16 v[234:235], v17 offset:57856
s_waitcnt vmcnt(4) lgkmcnt(8)
v_mfma_f32_16x16x32_bf16 v[60:63], v[100:103], v[196:199], v[60:63]
ds_read_b64_tr_b16 v[236:237], v14 offset:61440
v_mfma_f32_16x16x32_bf16 v[76:79], v[100:103], v[200:203], v[76:79]
ds_read_b64_tr_b16 v[238:239], v14 offset:61952
v_mfma_f32_16x16x32_bf16 v[64:67], v[104:107], v[196:199], v[64:67]
ds_read_b64_tr_b16 v[240:241], v15 offset:61440
v_mfma_f32_16x16x32_bf16 v[80:83], v[104:107], v[200:203], v[80:83]
ds_read_b64_tr_b16 v[242:243], v15 offset:61952
v_mfma_f32_16x16x32_bf16 v[68:71], v[108:111], v[196:199], v[68:71]
ds_read_b64_tr_b16 v[244:245], v16 offset:61440
v_mfma_f32_16x16x32_bf16 v[84:87], v[108:111], v[200:203], v[84:87]
ds_read_b64_tr_b16 v[246:247], v16 offset:61952
v_mfma_f32_16x16x32_bf16 v[72:75], v[112:115], v[196:199], v[72:75]
ds_read_b64_tr_b16 v[248:249], v17 offset:61440
v_mfma_f32_16x16x32_bf16 v[88:91], v[112:115], v[200:203], v[88:91]
ds_read_b64_tr_b16 v[250:251], v17 offset:61952
s_waitcnt vmcnt(2) lgkmcnt(8)
v_mfma_f32_16x16x32_bf16 v[60:63], v[220:223], v[204:207], v[60:63]
v_mfma_f32_16x16x32_bf16 v[76:79], v[220:223], v[208:211], v[76:79]
v_mfma_f32_16x16x32_bf16 v[64:67], v[224:227], v[204:207], v[64:67]
v_mfma_f32_16x16x32_bf16 v[80:83], v[224:227], v[208:211], v[80:83]
v_mfma_f32_16x16x32_bf16 v[68:71], v[228:231], v[204:207], v[68:71]
v_mfma_f32_16x16x32_bf16 v[84:87], v[228:231], v[208:211], v[84:87]
v_mfma_f32_16x16x32_bf16 v[72:75], v[232:235], v[204:207], v[72:75]
v_mfma_f32_16x16x32_bf16 v[88:91], v[232:235], v[208:211], v[88:91]
s_waitcnt vmcnt(0) lgkmcnt(0)
v_mfma_f32_16x16x32_bf16 v[60:63], v[236:239], v[212:215], v[60:63]
v_mfma_f32_16x16x32_bf16 v[64:67], v[240:243], v[212:215], v[64:67]
v_mfma_f32_16x16x32_bf16 v[68:71], v[244:247], v[212:215], v[68:71]
v_mfma_f32_16x16x32_bf16 v[72:75], v[248:251], v[212:215], v[72:75]
v_mfma_f32_16x16x32_bf16 v[76:79], v[236:239], v[216:219], v[76:79]
v_mfma_f32_16x16x32_bf16 v[80:83], v[240:243], v[216:219], v[80:83]
v_mfma_f32_16x16x32_bf16 v[84:87], v[244:247], v[216:219], v[84:87]
v_mfma_f32_16x16x32_bf16 v[88:91], v[248:251], v[216:219], v[88:91]
s_nop 0
v_cvt_pk_bf16_f32 v20, v60, v61
v_cvt_pk_bf16_f32 v21, v62, v63
v_cvt_pk_bf16_f32 v22, v64, v65
v_cvt_pk_bf16_f32 v23, v66, v67
s_nop 1
v_permlane16_swap_b32 v20, v22
v_permlane16_swap_b32 v21, v23
buffer_store_dwordx4 v[20:23], v40, s[24:27], 0 offen offset:0
v_cvt_pk_bf16_f32 v24, v68, v69
v_cvt_pk_bf16_f32 v25, v70, v71
v_cvt_pk_bf16_f32 v26, v72, v73
v_cvt_pk_bf16_f32 v27, v74, v75
s_nop 1
v_permlane16_swap_b32 v24, v26
v_permlane16_swap_b32 v25, v27
buffer_store_dwordx4 v[24:27], v40, s[24:27], 0 offen offset:64
v_cvt_pk_bf16_f32 v28, v76, v77
v_cvt_pk_bf16_f32 v29, v78, v79
v_cvt_pk_bf16_f32 v30, v80, v81
v_cvt_pk_bf16_f32 v31, v82, v83
s_nop 1
v_permlane16_swap_b32 v28, v30
v_permlane16_swap_b32 v29, v31
buffer_store_dwordx4 v[28:31], v41, s[24:27], 0 offen offset:0
v_cvt_pk_bf16_f32 v32, v84, v85
v_cvt_pk_bf16_f32 v33, v86, v87
v_cvt_pk_bf16_f32 v34, v88, v89
v_cvt_pk_bf16_f32 v35, v90, v91
s_nop 1
v_permlane16_swap_b32 v32, v34
v_permlane16_swap_b32 v33, v35
buffer_store_dwordx4 v[32:35], v41, s[24:27], 0 offen offset:64
s_endpgm
L_code_end:
slow_50:
.p2align 3
v_pk_mul_f32 v[220:221], v[220:221], v[160:161] op_sel:[0,0] op_sel_hi:[1,0]
v_pk_mul_f32 v[222:223], v[222:223], v[160:161] op_sel:[0,0] op_sel_hi:[1,0]
v_pk_mul_f32 v[224:225], v[224:225], v[160:161] op_sel:[0,0] op_sel_hi:[1,0]
v_pk_mul_f32 v[226:227], v[226:227], v[160:161] op_sel:[0,0] op_sel_hi:[1,0]
v_cvt_pk_bf16_f32 v220, v220, v221
v_cvt_pk_bf16_f32 v221, v222, v223
v_cvt_pk_bf16_f32 v222, v224, v225
v_cvt_pk_bf16_f32 v223, v226, v227
buffer_store_dwordx4 v[220:223], v18, s[32:35], s80 offen sc1
v_pk_mul_f32 v[228:229], v[228:229], v[168:169] op_sel:[0,0] op_sel_hi:[1,0]
v_pk_mul_f32 v[230:231], v[230:231], v[168:169] op_sel:[0,0] op_sel_hi:[1,0]
v_pk_mul_f32 v[232:233], v[232:233], v[168:169] op_sel:[0,0] op_sel_hi:[1,0]
v_pk_mul_f32 v[234:235], v[234:235], v[168:169] op_sel:[0,0] op_sel_hi:[1,0]
v_cvt_pk_bf16_f32 v228, v228, v229
v_cvt_pk_bf16_f32 v229, v230, v231
v_cvt_pk_bf16_f32 v230, v232, v233
v_cvt_pk_bf16_f32 v231, v234, v235
buffer_store_dwordx4 v[228:231], v18, s[32:35], s81 offen sc1
v_pk_mul_f32 v[236:237], v[236:237], v[176:177] op_sel:[0,0] op_sel_hi:[1,0]
v_pk_mul_f32 v[238:239], v[238:239], v[176:177] op_sel:[0,0] op_sel_hi:[1,0]
v_pk_mul_f32 v[240:241], v[240:241], v[176:177] op_sel:[0,0] op_sel_hi:[1,0]
v_pk_mul_f32 v[242:243], v[242:243], v[176:177] op_sel:[0,0] op_sel_hi:[1,0]
v_cvt_pk_bf16_f32 v236, v236, v237
v_cvt_pk_bf16_f32 v237, v238, v239
v_cvt_pk_bf16_f32 v238, v240, v241
v_cvt_pk_bf16_f32 v239, v242, v243
buffer_store_dwordx4 v[236:239], v18, s[32:35], s82 offen sc1
v_pk_mul_f32 v[244:245], v[244:245], v[184:185] op_sel:[0,0] op_sel_hi:[1,0]
v_pk_mul_f32 v[246:247], v[246:247], v[184:185] op_sel:[0,0] op_sel_hi:[1,0]
v_pk_mul_f32 v[248:249], v[248:249], v[184:185] op_sel:[0,0] op_sel_hi:[1,0]
v_pk_mul_f32 v[250:251], v[250:251], v[184:185] op_sel:[0,0] op_sel_hi:[1,0]
v_cvt_pk_bf16_f32 v244, v244, v245
v_cvt_pk_bf16_f32 v245, v246, v247
v_cvt_pk_bf16_f32 v246, v248, v249
v_cvt_pk_bf16_f32 v247, v250, v251
buffer_store_dwordx4 v[244:247], v18, s[32:35], s83 offen sc1
s_barrier
s_lshl_b32 s62, s45, 2
v_mov_b32 v4, s62
v_mov_b32 v5, 1
s_mov_b64 exec, 1
s_waitcnt vmcnt(0)
buffer_store_dword v5, v4, s[32:35], s84 offen sc1
s_mov_b64 exec, -1
s_branch back_51
slow_54:
s_nop 0
v_cvt_pk_bf16_f32 v20, v60, v61
v_cvt_pk_bf16_f32 v21, v62, v63
v_cvt_pk_bf16_f32 v22, v64, v65
v_cvt_pk_bf16_f32 v23, v66, v67
buffer_store_dwordx4 v[20:23], v18, s[32:35], s85 offen offset:0 sc1
v_cvt_pk_bf16_f32 v24, v68, v69
v_cvt_pk_bf16_f32 v25, v70, v71
v_cvt_pk_bf16_f32 v26, v72, v73
v_cvt_pk_bf16_f32 v27, v74, v75
buffer_store_dwordx4 v[24:27], v18, s[32:35], s85 offen offset:1024 sc1
v_cvt_pk_bf16_f32 v28, v76, v77
v_cvt_pk_bf16_f32 v29, v78, v79
v_cvt_pk_bf16_f32 v30, v80, v81
v_cvt_pk_bf16_f32 v31, v82, v83
buffer_store_dwordx4 v[28:31], v18, s[32:35], s86 offen offset:0 sc1
v_cvt_pk_bf16_f32 v32, v84, v85
v_cvt_pk_bf16_f32 v33, v86, v87
v_cvt_pk_bf16_f32 v34, v88, v89
v_cvt_pk_bf16_f32 v35, v90, v91
buffer_store_dwordx4 v[32:35], v18, s[32:35], s86 offen offset:1024 sc1
s_barrier
v_dot2c_f32_bf16 v6, v20, v48
v_dot2c_f32_bf16 v8, v20, v20
v_dot2c_f32_bf16 v7, v28, v48
v_dot2c_f32_bf16 v9, v28, v28
v_dot2c_f32_bf16 v6, v21, v48
v_dot2c_f32_bf16 v8, v21, v21
v_dot2c_f32_bf16 v7, v29, v48
v_dot2c_f32_bf16 v9, v29, v29
v_dot2c_f32_bf16 v6, v22, v48
v_dot2c_f32_bf16 v8, v22, v22
v_dot2c_f32_bf16 v7, v30, v48
v_dot2c_f32_bf16 v9, v30, v30
v_dot2c_f32_bf16 v6, v23, v48
v_dot2c_f32_bf16 v8, v23, v23
v_dot2c_f32_bf16 v7, v31, v48
v_dot2c_f32_bf16 v9, v31, v31
v_dot2c_f32_bf16 v6, v24, v48
v_dot2c_f32_bf16 v8, v24, v24
v_dot2c_f32_bf16 v7, v32, v48
v_dot2c_f32_bf16 v9, v32, v32
v_dot2c_f32_bf16 v6, v25, v48
v_dot2c_f32_bf16 v8, v25, v25
v_dot2c_f32_bf16 v7, v33, v48
v_dot2c_f32_bf16 v9, v33, v33
v_dot2c_f32_bf16 v6, v26, v48
v_dot2c_f32_bf16 v8, v26, v26
v_dot2c_f32_bf16 v7, v34, v48
v_dot2c_f32_bf16 v9, v34, v34
v_dot2c_f32_bf16 v6, v27, v48
v_dot2c_f32_bf16 v8, v27, v27
v_dot2c_f32_bf16 v7, v35, v48
v_dot2c_f32_bf16 v9, v35, v35
s_mov_b64 exec, 1
s_waitcnt vmcnt(0)
buffer_store_dword v5, v4, s[32:35], s88 offen sc1
s_mov_b64 exec, -1
s_nop 1
v_permlane32_swap_b32 v6, v7
v_permlane32_swap_b32 v8, v9
v_add_f32 v6, v6, v7
v_add_f32 v8, v8, v9
s_nop 1
v_permlane16_swap_b32 v6, v8
s_nop 0
v_add_f32 v6, v6, v8
buffer_store_dword v6, v1, s[32:35], s87 offen sc1
s_branch back_55
slow_56:
s_lshl_b32 s62, s42, 2
v_mov_b32 v4, s62
v_mov_b32 v5, 1
s_mov_b64 exec, 1
buffer_store_dword v5, v4, s[32:35], s89 offen sc1
s_mov_b64 exec, -1
s_branch back_57
slow_70:
.p2align 3
v_pk_mul_f32 v[156:157], v[156:157], v[100:101] op_sel:[0,0] op_sel_hi:[1,0]
v_pk_mul_f32 v[158:159], v[158:159], v[100:101] op_sel:[0,0] op_sel_hi:[1,0]
v_pk_mul_f32 v[160:161], v[160:161], v[100:101] op_sel:[0,0] op_sel_hi:[1,0]
v_pk_mul_f32 v[162:163], v[162:163], v[100:101] op_sel:[0,0] op_sel_hi:[1,0]
v_cvt_pk_bf16_f32 v156, v156, v157
v_cvt_pk_bf16_f32 v157, v158, v159
v_cvt_pk_bf16_f32 v158, v160, v161
v_cvt_pk_bf16_f32 v159, v162, v163
buffer_store_dwordx4 v[156:159], v18, s[32:35], s80 offen sc1
v_pk_mul_f32 v[164:165], v[164:165], v[100:101] op_sel:[0,1] op_sel_hi:[1,1]
v_pk_mul_f32 v[166:167], v[166:167], v[100:101] op_sel:[0,1] op_sel_hi:[1,1]
v_pk_mul_f32 v[168:169], v[168:169], v[100:101] op_sel:[0,1] op_sel_hi:[1,1]
v_pk_mul_f32 v[170:171], v[170:171], v[100:101] op_sel:[0,1] op_sel_hi:[1,1]
v_cvt_pk_bf16_f32 v164, v164, v165
v_cvt_pk_bf16_f32 v165, v166, v167
v_cvt_pk_bf16_f32 v166, v168, v169
v_cvt_pk_bf16_f32 v167, v170, v171
buffer_store_dwordx4 v[164:167], v18, s[32:35], s81 offen sc1
v_pk_mul_f32 v[172:173], v[172:173], v[102:103] op_sel:[0,0] op_sel_hi:[1,0]
v_pk_mul_f32 v[174:175], v[174:175], v[102:103] op_sel:[0,0] op_sel_hi:[1,0]
v_pk_mul_f32 v[176:177], v[176:177], v[102:103] op_sel:[0,0] op_sel_hi:[1,0]
v_pk_mul_f32 v[178:179], v[178:179], v[102:103] op_sel:[0,0] op_sel_hi:[1,0]
v_cvt_pk_bf16_f32 v172, v172, v173
v_cvt_pk_bf16_f32 v173, v174, v175
v_cvt_pk_bf16_f32 v174, v176, v177
v_cvt_pk_bf16_f32 v175, v178, v179
buffer_store_dwordx4 v[172:175], v18, s[32:35], s82 offen sc1
v_pk_mul_f32 v[180:181], v[180:181], v[102:103] op_sel:[0,1] op_sel_hi:[1,1]
v_pk_mul_f32 v[182:183], v[182:183], v[102:103] op_sel:[0,1] op_sel_hi:[1,1]
v_pk_mul_f32 v[184:185], v[184:185], v[102:103] op_sel:[0,1] op_sel_hi:[1,1]
v_pk_mul_f32 v[186:187], v[186:187], v[102:103] op_sel:[0,1] op_sel_hi:[1,1]
v_cvt_pk_bf16_f32 v180, v180, v181
v_cvt_pk_bf16_f32 v181, v182, v183
v_cvt_pk_bf16_f32 v182, v184, v185
v_cvt_pk_bf16_f32 v183, v186, v187
buffer_store_dwordx4 v[180:183], v18, s[32:35], s83 offen sc1
s_barrier
s_lshl_b32 s62, s45, 2
v_mov_b32 v4, s62
v_mov_b32 v5, 2
s_mov_b64 exec, 1
s_waitcnt vmcnt(0)
buffer_store_dword v5, v4, s[32:35], s84 offen sc1
s_mov_b64 exec, -1
s_branch back_71
slow_74:
s_nop 0
v_cvt_pk_bf16_f32 v20, v60, v61
v_cvt_pk_bf16_f32 v21, v62, v63
v_cvt_pk_bf16_f32 v22, v64, v65
v_cvt_pk_bf16_f32 v23, v66, v67
buffer_store_dwordx4 v[20:23], v18, s[32:35], s85 offen offset:0 sc1
v_cvt_pk_bf16_f32 v24, v68, v69
v_cvt_pk_bf16_f32 v25, v70, v71
v_cvt_pk_bf16_f32 v26, v72, v73
v_cvt_pk_bf16_f32 v27, v74, v75
buffer_store_dwordx4 v[24:27], v18, s[32:35], s85 offen offset:1024 sc1
v_cvt_pk_bf16_f32 v28, v76, v77
v_cvt_pk_bf16_f32 v29, v78, v79
v_cvt_pk_bf16_f32 v30, v80, v81
v_cvt_pk_bf16_f32 v31, v82, v83
buffer_store_dwordx4 v[28:31], v18, s[32:35], s86 offen offset:0 sc1
v_cvt_pk_bf16_f32 v32, v84, v85
v_cvt_pk_bf16_f32 v33, v86, v87
v_cvt_pk_bf16_f32 v34, v88, v89
v_cvt_pk_bf16_f32 v35, v90, v91
buffer_store_dwordx4 v[32:35], v18, s[32:35], s86 offen offset:1024 sc1
s_barrier
v_dot2c_f32_bf16 v6, v20, v48
v_dot2c_f32_bf16 v8, v20, v20
v_dot2c_f32_bf16 v7, v28, v48
v_dot2c_f32_bf16 v9, v28, v28
v_dot2c_f32_bf16 v6, v21, v48
v_dot2c_f32_bf16 v8, v21, v21
v_dot2c_f32_bf16 v7, v29, v48
v_dot2c_f32_bf16 v9, v29, v29
v_dot2c_f32_bf16 v6, v22, v48
v_dot2c_f32_bf16 v8, v22, v22
v_dot2c_f32_bf16 v7, v30, v48
v_dot2c_f32_bf16 v9, v30, v30
v_dot2c_f32_bf16 v6, v23, v48
v_dot2c_f32_bf16 v8, v23, v23
v_dot2c_f32_bf16 v7, v31, v48
v_dot2c_f32_bf16 v9, v31, v31
v_dot2c_f32_bf16 v6, v24, v48
v_dot2c_f32_bf16 v8, v24, v24
v_dot2c_f32_bf16 v7, v32, v48
v_dot2c_f32_bf16 v9, v32, v32
v_dot2c_f32_bf16 v6, v25, v48
v_dot2c_f32_bf16 v8, v25, v25
v_dot2c_f32_bf16 v7, v33, v48
v_dot2c_f32_bf16 v9, v33, v33
v_dot2c_f32_bf16 v6, v26, v48
v_dot2c_f32_bf16 v8, v26, v26
v_dot2c_f32_bf16 v7, v34, v48
v_dot2c_f32_bf16 v9, v34, v34
v_dot2c_f32_bf16 v6, v27, v48
v_dot2c_f32_bf16 v8, v27, v27
v_dot2c_f32_bf16 v7, v35, v48
v_dot2c_f32_bf16 v9, v35, v35
s_mov_b64 exec, 1
s_waitcnt vmcnt(0)
buffer_store_dword v5, v4, s[32:35], s88 offen sc1
s_mov_b64 exec, -1
s_nop 1
v_permlane32_swap_b32 v6, v7
v_permlane32_swap_b32 v8, v9
v_add_f32 v6, v6, v7
v_add_f32 v8, v8, v9
s_nop 1
v_permlane16_swap_b32 v6, v8
s_nop 0
v_add_f32 v6, v6, v8
buffer_store_dword v6, v1, s[32:35], s87 offen sc1
s_branch back_75
slow_76:
s_lshl_b32 s62, s42, 2
v_mov_b32 v4, s62
v_mov_b32 v5, 2
s_mov_b64 exec, 1
buffer_store_dword v5, v4, s[32:35], s89 offen sc1
s_mov_b64 exec, -1
s_branch back_77
slow_88:
.p2align 3
v_pk_mul_f32 v[220:221], v[220:221], v[160:161] op_sel:[0,0] op_sel_hi:[1,0]
v_pk_mul_f32 v[222:223], v[222:223], v[160:161] op_sel:[0,0] op_sel_hi:[1,0]
v_pk_mul_f32 v[224:225], v[224:225], v[160:161] op_sel:[0,0] op_sel_hi:[1,0]
v_pk_mul_f32 v[226:227], v[226:227], v[160:161] op_sel:[0,0] op_sel_hi:[1,0]
v_cvt_pk_bf16_f32 v220, v220, v221
v_cvt_pk_bf16_f32 v221, v222, v223
v_cvt_pk_bf16_f32 v222, v224, v225
v_cvt_pk_bf16_f32 v223, v226, v227
buffer_store_dwordx4 v[220:223], v18, s[32:35], s80 offen sc1
v_pk_mul_f32 v[228:229], v[228:229], v[168:169] op_sel:[0,0] op_sel_hi:[1,0]
v_pk_mul_f32 v[230:231], v[230:231], v[168:169] op_sel:[0,0] op_sel_hi:[1,0]
v_pk_mul_f32 v[232:233], v[232:233], v[168:169] op_sel:[0,0] op_sel_hi:[1,0]
v_pk_mul_f32 v[234:235], v[234:235], v[168:169] op_sel:[0,0] op_sel_hi:[1,0]
v_cvt_pk_bf16_f32 v228, v228, v229
v_cvt_pk_bf16_f32 v229, v230, v231
v_cvt_pk_bf16_f32 v230, v232, v233
v_cvt_pk_bf16_f32 v231, v234, v235
buffer_store_dwordx4 v[228:231], v18, s[32:35], s81 offen sc1
v_pk_mul_f32 v[236:237], v[236:237], v[176:177] op_sel:[0,0] op_sel_hi:[1,0]
v_pk_mul_f32 v[238:239], v[238:239], v[176:177] op_sel:[0,0] op_sel_hi:[1,0]
v_pk_mul_f32 v[240:241], v[240:241], v[176:177] op_sel:[0,0] op_sel_hi:[1,0]
v_pk_mul_f32 v[242:243], v[242:243], v[176:177] op_sel:[0,0] op_sel_hi:[1,0]
v_cvt_pk_bf16_f32 v236, v236, v237
v_cvt_pk_bf16_f32 v237, v238, v239
v_cvt_pk_bf16_f32 v238, v240, v241
v_cvt_pk_bf16_f32 v239, v242, v243
buffer_store_dwordx4 v[236:239], v18, s[32:35], s82 offen sc1
v_pk_mul_f32 v[244:245], v[244:245], v[184:185] op_sel:[0,0] op_sel_hi:[1,0]
v_pk_mul_f32 v[246:247], v[246:247], v[184:185] op_sel:[0,0] op_sel_hi:[1,0]
v_pk_mul_f32 v[248:249], v[248:249], v[184:185] op_sel:[0,0] op_sel_hi:[1,0]
v_pk_mul_f32 v[250:251], v[250:251], v[184:185] op_sel:[0,0] op_sel_hi:[1,0]
v_cvt_pk_bf16_f32 v244, v244, v245
v_cvt_pk_bf16_f32 v245, v246, v247
v_cvt_pk_bf16_f32 v246, v248, v249
v_cvt_pk_bf16_f32 v247, v250, v251
buffer_store_dwordx4 v[244:247], v18, s[32:35], s83 offen sc1
s_barrier
s_lshl_b32 s62, s45, 2
v_mov_b32 v4, s62
v_mov_b32 v5, 3
s_mov_b64 exec, 1
s_waitcnt vmcnt(0)
buffer_store_dword v5, v4, s[32:35], s84 offen sc1
s_mov_b64 exec, -1
s_branch back_89
slow_92:
s_nop 0
v_cvt_pk_bf16_f32 v20, v60, v61
v_cvt_pk_bf16_f32 v21, v62, v63
v_cvt_pk_bf16_f32 v22, v64, v65
v_cvt_pk_bf16_f32 v23, v66, v67
buffer_store_dwordx4 v[20:23], v18, s[32:35], s85 offen offset:0 sc1
v_cvt_pk_bf16_f32 v24, v68, v69
v_cvt_pk_bf16_f32 v25, v70, v71
v_cvt_pk_bf16_f32 v26, v72, v73
v_cvt_pk_bf16_f32 v27, v74, v75
buffer_store_dwordx4 v[24:27], v18, s[32:35], s85 offen offset:1024 sc1
v_cvt_pk_bf16_f32 v28, v76, v77
v_cvt_pk_bf16_f32 v29, v78, v79
v_cvt_pk_bf16_f32 v30, v80, v81
v_cvt_pk_bf16_f32 v31, v82, v83
buffer_store_dwordx4 v[28:31], v18, s[32:35], s86 offen offset:0 sc1
v_cvt_pk_bf16_f32 v32, v84, v85
v_cvt_pk_bf16_f32 v33, v86, v87
v_cvt_pk_bf16_f32 v34, v88, v89
v_cvt_pk_bf16_f32 v35, v90, v91
buffer_store_dwordx4 v[32:35], v18, s[32:35], s86 offen offset:1024 sc1
s_barrier
v_dot2c_f32_bf16 v6, v20, v48
v_dot2c_f32_bf16 v8, v20, v20
v_dot2c_f32_bf16 v7, v28, v48
v_dot2c_f32_bf16 v9, v28, v28
v_dot2c_f32_bf16 v6, v21, v48
v_dot2c_f32_bf16 v8, v21, v21
v_dot2c_f32_bf16 v7, v29, v48
v_dot2c_f32_bf16 v9, v29, v29
v_dot2c_f32_bf16 v6, v22, v48
v_dot2c_f32_bf16 v8, v22, v22
v_dot2c_f32_bf16 v7, v30, v48
v_dot2c_f32_bf16 v9, v30, v30
v_dot2c_f32_bf16 v6, v23, v48
v_dot2c_f32_bf16 v8, v23, v23
v_dot2c_f32_bf16 v7, v31, v48
v_dot2c_f32_bf16 v9, v31, v31
v_dot2c_f32_bf16 v6, v24, v48
v_dot2c_f32_bf16 v8, v24, v24
v_dot2c_f32_bf16 v7, v32, v48
v_dot2c_f32_bf16 v9, v32, v32
v_dot2c_f32_bf16 v6, v25, v48
v_dot2c_f32_bf16 v8, v25, v25
v_dot2c_f32_bf16 v7, v33, v48
v_dot2c_f32_bf16 v9, v33, v33
v_dot2c_f32_bf16 v6, v26, v48
v_dot2c_f32_bf16 v8, v26, v26
v_dot2c_f32_bf16 v7, v34, v48
v_dot2c_f32_bf16 v9, v34, v34
v_dot2c_f32_bf16 v6, v27, v48
v_dot2c_f32_bf16 v8, v27, v27
v_dot2c_f32_bf16 v7, v35, v48
v_dot2c_f32_bf16 v9, v35, v35
s_mov_b64 exec, 1
s_waitcnt vmcnt(0)
buffer_store_dword v5, v4, s[32:35], s88 offen sc1
s_mov_b64 exec, -1
s_nop 1
v_permlane32_swap_b32 v6, v7
v_permlane32_swap_b32 v8, v9
v_add_f32 v6, v6, v7
v_add_f32 v8, v8, v9
s_nop 1
v_permlane16_swap_b32 v6, v8
s_nop 0
v_add_f32 v6, v6, v8
buffer_store_dword v6, v1, s[32:35], s87 offen sc1
s_branch back_93
slow_94:
s_lshl_b32 s62, s42, 2
v_mov_b32 v4, s62
v_mov_b32 v5, 3
s_mov_b64 exec, 1
buffer_store_dword v5, v4, s[32:35], s89 offen sc1
s_mov_b64 exec, -1
s_branch back_95
slow_102:
.p2align 3
v_pk_mul_f32 v[156:157], v[156:157], v[100:101] op_sel:[0,0] op_sel_hi:[1,0]
v_pk_mul_f32 v[158:159], v[158:159], v[100:101] op_sel:[0,0] op_sel_hi:[1,0]
v_pk_mul_f32 v[160:161], v[160:161], v[100:101] op_sel:[0,0] op_sel_hi:[1,0]
v_pk_mul_f32 v[162:163], v[162:163], v[100:101] op_sel:[0,0] op_sel_hi:[1,0]
v_cvt_pk_bf16_f32 v156, v156, v157
v_cvt_pk_bf16_f32 v157, v158, v159
v_cvt_pk_bf16_f32 v158, v160, v161
v_cvt_pk_bf16_f32 v159, v162, v163
buffer_store_dwordx4 v[156:159], v18, s[32:35], s80 offen sc1
v_pk_mul_f32 v[164:165], v[164:165], v[100:101] op_sel:[0,1] op_sel_hi:[1,1]
v_pk_mul_f32 v[166:167], v[166:167], v[100:101] op_sel:[0,1] op_sel_hi:[1,1]
v_pk_mul_f32 v[168:169], v[168:169], v[100:101] op_sel:[0,1] op_sel_hi:[1,1]
v_pk_mul_f32 v[170:171], v[170:171], v[100:101] op_sel:[0,1] op_sel_hi:[1,1]
v_cvt_pk_bf16_f32 v164, v164, v165
v_cvt_pk_bf16_f32 v165, v166, v167
v_cvt_pk_bf16_f32 v166, v168, v169
v_cvt_pk_bf16_f32 v167, v170, v171
buffer_store_dwordx4 v[164:167], v18, s[32:35], s81 offen sc1
v_pk_mul_f32 v[172:173], v[172:173], v[102:103] op_sel:[0,0] op_sel_hi:[1,0]
v_pk_mul_f32 v[174:175], v[174:175], v[102:103] op_sel:[0,0] op_sel_hi:[1,0]
v_pk_mul_f32 v[176:177], v[176:177], v[102:103] op_sel:[0,0] op_sel_hi:[1,0]
v_pk_mul_f32 v[178:179], v[178:179], v[102:103] op_sel:[0,0] op_sel_hi:[1,0]
v_cvt_pk_bf16_f32 v172, v172, v173
v_cvt_pk_bf16_f32 v173, v174, v175
v_cvt_pk_bf16_f32 v174, v176, v177
v_cvt_pk_bf16_f32 v175, v178, v179
buffer_store_dwordx4 v[172:175], v18, s[32:35], s82 offen sc1
v_pk_mul_f32 v[180:181], v[180:181], v[102:103] op_sel:[0,1] op_sel_hi:[1,1]
v_pk_mul_f32 v[182:183], v[182:183], v[102:103] op_sel:[0,1] op_sel_hi:[1,1]
v_pk_mul_f32 v[184:185], v[184:185], v[102:103] op_sel:[0,1] op_sel_hi:[1,1]
v_pk_mul_f32 v[186:187], v[186:187], v[102:103] op_sel:[0,1] op_sel_hi:[1,1]
v_cvt_pk_bf16_f32 v180, v180, v181
v_cvt_pk_bf16_f32 v181, v182, v183
v_cvt_pk_bf16_f32 v182, v184, v185
v_cvt_pk_bf16_f32 v183, v186, v187
buffer_store_dwordx4 v[180:183], v18, s[32:35], s83 offen sc1
s_barrier
s_lshl_b32 s62, s45, 2
v_mov_b32 v4, s62
v_mov_b32 v5, 4
s_mov_b64 exec, 1
s_waitcnt vmcnt(0)
buffer_store_dword v5, v4, s[32:35], s84 offen sc1
s_mov_b64 exec, -1
s_branch back_103
s_endpgm
.section .rodata,"a"
.p2align 6
.amdhsa_kernel interleave_layers__sliding_local_dilated__linear_kernel_hedgehog__prompt_kernel
  .amdhsa_next_free_vgpr 256
  .amdhsa_next_free_sgpr 102
  .amdhsa_accum_offset 256
  .amdhsa_group_segment_fixed_size 0
  .amdhsa_kernarg_size 80
  .amdhsa_user_sgpr_count 2
  .amdhsa_user_sgpr_kernarg_segment_ptr 1
  .amdhsa_system_sgpr_workgroup_id_x 1
.end_amdhsa_kernel
```

```asm
; @launch grid=(256,1,1) block=(512,1,1) lds=163840
.amdgcn_target "amdgcn-amd-amdhsa--gfx950"
.text
.globl interleave_layers__sliding_local_dilated__linear_kernel_hedgehog__prompt_kernel
.p2align 8
.type interleave_layers__sliding_local_dilated__linear_kernel_hedgehog__prompt_kernel,@function
interleave_layers__sliding_local_dilated__linear_kernel_hedgehog__prompt_kernel:
s_cmp_ge_u32 s2, 256
s_cbranch_scc1 L_end
s_load_dwordx16 s[4:19], s[0:1], 0
s_load_dwordx4 s[20:23], s[0:1], 64
v_lshrrev_b32 v1, 6, v0
v_and_b32 v0, 63, v0
v_readfirstlane_b32 s40, v1
v_and_b32 v2, 15, v0
v_lshrrev_b32 v3, 4, v0
v_lshlrev_b32 v18, 4, v0
s_and_b32 s48, s2, 7
s_lshr_b32 s49, s2, 3
s_and_b32 s74, s49, 1
s_lshl_b32 s41, s48, 1
s_add_u32 s41, s41, s74
s_lshr_b32 s42, s49, 1
s_and_b32 s48, s2, 7
s_add_u32 s47, s42, s48
s_and_b32 s47, s47, 3
s_mul_i32 s47, s47, 4
s_lshr_b32 s48, s2, 2
s_and_b32 s48, s48, 1
s_lshl_b32 s48, s48, 1
s_add_u32 s48, s48, s74
s_lshr_b32 s49, s42, 2
s_xor_b32 s77, s48, s49
s_add_u32 s77, s77, 4
s_add_u32 s78, s47, s77
s_and_b32 s78, s78, 15
s_and_b32 s48, s2, 7
s_add_u32 s75, s78, s48
s_and_b32 s75, s75, 7
s_mul_i32 s75, s75, 2
s_mov_b32 s46, 0
s_and_b32 s43, s40, 3
s_lshl_b32 s70, s43, 12
s_lshl_b32 s71, s43, 11
s_add_u32 s71, s71, 16384
s_cmp_lt_u32 s40, 4
s_cbranch_scc1 L_compute
v_lshrrev_b32 v4, 3, v0
v_and_b32 v5, 7, v0
s_lshl_b32 s48, s43, 4
v_add_u32 v6, s48, v4
v_mul_u32_u24 v6, 6144, v6
v_and_b32 v7, 2, v4
v_xor_b32 v7, v7, v5
s_lshl_b32 s48, s42, 7
v_lshl_add_u32 v26, v7, 4, v6
v_add_u32 v26, s48, v26
v_xor_b32 v27, 64, v26
v_add_u32 v27, 48128, v27
s_lshl_b32 s48, s41, 7
s_lshl_b32 s49, s43, 5
s_add_u32 s48, s48, s49
v_add_u32 v6, s48, v4
v_lshlrev_b32 v6, 11, v6
v_lshrrev_b32 v7, 1, v4
v_xor_b32 v7, v7, v5
v_lshl_add_u32 v20, v7, 4, v6
v_xor_b32 v21, 64, v20
v_add_u32 v21, 15360, v21
v_add_u32 v22, 30720, v20
v_add_u32 v23, 30720, v21
s_add_u32 s69, s47, 0
s_and_b32 s69, s69, 15
s_mul_i32 s67, s69, 128
s_mul_i32 s68, s69, 393216
v_mov_b32 v56, -1
v_mov_b32 v57, -1
v_mov_b32 v58, -1
v_mov_b32 v59, -1
v_lshlrev_b32 v8, 12, v3
v_lshl_add_u32 v8, v2, 4, v8
v_lshlrev_b32 v9, 2, v0
v_mov_b32 v10, 0
s_lshl_b32 s52, s41, 6
s_add_u32 s52, s52, s42
s_lshl_b32 s52, s52, 8
s_add_u32 s52, s52, 16777216
s_lshl_b32 s53, s42, 6
s_add_u32 s53, s53, s41
s_lshl_b32 s53, s53, 8
s_add_u32 s53, s53, 17825792
s_add_u32 s54, s53, 262144
s_lshl_b32 s55, s2, 12
s_add_u32 s55, s55, 8388608
s_and_b32 s56, s2, 63
s_lshl_b32 s56, s56, 8
s_add_u32 s56, s56, 18350080
s_getreg_b32 s50, hwreg(HW_REG_XCC_ID)
s_and_b32 s50, s50, 7
s_lshl_b32 s50, s50, 3
s_lshl_b64 s[94:95], 1, s50
s_and_b32 s96, s2, 7
s_lshl_b32 s96, s96, 5
s_waitcnt lgkmcnt(0)
s_mov_b32 s24, s4
s_and_b32 s25, s5, 0xffff
s_mov_b32 s26, 4194304
s_mov_b32 s27, 0x00020000
s_mov_b32 s28, s6
s_and_b32 s29, s7, 0xffff
s_mov_b32 s30, 6291456
s_mov_b32 s31, 0x00020000
s_mov_b32 s32, s22
s_and_b32 s33, s23, 0xffff
s_mov_b32 s34, 268435456
s_mov_b32 s35, 0x00020000
s_cmp_lg_u32 s43, 3
s_cbranch_scc1 else_1
buffer_store_dwordx4 v[56:59], v8, s[32:35], s52 offen sc1
buffer_store_dwordx4 v[56:59], v8, s[32:35], s53 offen sc1
buffer_store_dwordx4 v[56:59], v8, s[32:35], s54 offen sc1
buffer_store_dwordx4 v[56:59], v18, s[32:35], s55 offen offset:0 sc1
buffer_store_dwordx4 v[56:59], v18, s[32:35], s55 offen offset:1024 sc1
buffer_store_dwordx4 v[56:59], v18, s[32:35], s55 offen offset:2048 sc1
buffer_store_dwordx4 v[56:59], v18, s[32:35], s55 offen offset:3072 sc1
s_cmp_ge_u32 s2, 64
s_cbranch_scc1 nofl_3
buffer_store_dword v10, v9, s[32:35], s56 offen sc1
nofl_3:
else_1:
s_add_u32 m0, s70, 0
s_nop 0
buffer_load_dwordx4 v20, s[24:27], s67 offen offset:0  lds
buffer_load_dwordx4 v21, s[24:27], s67 offen offset:1024  lds
buffer_load_dwordx4 v22, s[24:27], s67 offen offset:2048  lds
buffer_load_dwordx4 v23, s[24:27], s67 offen offset:3072  lds
s_add_u32 s60, s71, 0
s_add_u32 m0, s60, 0
s_add_u32 s61, s68, 0
buffer_load_dwordx4 v26, s[28:31], s61 offen lds
buffer_load_dwordx4 v27, s[28:31], s61 offen offset:1024 lds
s_add_u32 m0, s60, 8192
s_add_u32 s61, s68, 2048
buffer_load_dwordx4 v26, s[28:31], s61 offen lds
buffer_load_dwordx4 v27, s[28:31], s61 offen offset:1024 lds
s_add_u32 m0, s60, 16384
s_add_u32 s61, s68, 4096
buffer_load_dwordx4 v26, s[28:31], s61 offen lds
buffer_load_dwordx4 v27, s[28:31], s61 offen offset:1024 lds
s_cmp_lg_u32 s43, 3
s_cbranch_scc1 else_4
s_waitcnt vmcnt(10)
s_atomic_add_x2 s[94:95], s[20:21], s96
else_4:
s_and_b32 s51, s42, 7
s_cmp_gt_u32 s51, 3
s_cselect_b32 s49, 1, 0
s_sub_u32 s49, s51, s49
s_lshl_b32 s49, s49, 1
s_add_u32 s49, s49, s74
s_lshl_b32 s49, s49, 2
s_add_u32 s49, s49, s43
s_lshr_b32 s50, s49, 4
s_lshl_b32 s50, s50, 11
s_and_b32 s49, s49, 15
s_mul_i32 s49, s49, 24576
s_add_u32 s49, s49, s50
s_and_b32 s50, s42, 8
s_or_b32 s50, s50, 3
s_and_b32 s48, s2, 7
s_add_u32 s76, s50, s48
s_and_b32 s76, s76, 3
s_mul_i32 s76, s76, 4
s_lshl_b32 s50, s50, 7
s_add_u32 s49, s49, s50
s_and_b32 s51, s51, 3
s_cmp_eq_u32 s51, 3
s_cselect_b32 s49, 0x70000000, s49
v_mul_u32_u24 v4, 6144, v4
v_lshl_add_u32 v4, v5, 4, v4
v_lshrrev_b32 v5, 5, v0
v_lshlrev_b32 v5, 30, v5
v_add3_u32 v36, v4, v5, s49
v_lshrrev_b32 v4, 3, v0
v_and_b32 v5, 7, v0
s_lshr_b32 s48, s43, 1
s_lshl_b32 s48, s48, 5
s_and_b32 s49, s43, 1
s_lshl_b32 s49, s49, 3
s_add_u32 s48, s48, s49
v_lshrrev_b32 v6, 2, v4
v_lshlrev_b32 v6, 4, v6
v_and_b32 v7, 3, v4
v_add3_u32 v6, v6, v7, s48
v_mul_u32_u24 v6, 2048, v6
v_and_b32 v7, 2, v4
v_xor_b32 v7, v7, v5
s_lshl_b32 s48, s78, 7
v_lshl_add_u32 v28, v7, 4, v6
v_add_u32 v28, s48, v28
v_xor_b32 v29, 64, v28
v_add_u32 v29, 7168, v29
v_lshlrev_b32 v30, 2, v2
v_and_b32 v32, 7, v0
v_lshlrev_b32 v32, 5, v32
s_lshl_b32 s50, s41, 2
s_add_u32 s50, s50, s43
s_lshl_b32 s50, s50, 12
s_add_u32 s50, s50, 16777216
v_add_u32 v37, s50, v18
v_lshrrev_b32 v4, 5, v0
v_lshl_add_u32 v4, v4, 4, v2
s_lshl_b32 s48, s43, 5
v_add_u32 v4, s48, v4
v_lshlrev_b32 v49, 3, v4
v_add_u32 v49, 131072, v49
v_lshlrev_b32 v50, 2, v4
v_add_u32 v50, 132096, v50
s_lshl_b32 s79, s41, 2
s_add_u32 s79, s79, s43
s_lshl_b32 s79, s79, 7
s_add_u32 s79, s79, 18358272
s_lshl_b32 s48, s41, 3
s_lshl_b32 s49, s43, 1
s_add_u32 s48, s48, s49
s_lshl_b32 s80, s48, 15
s_lshl_b32 s49, s42, 11
s_add_u32 s81, s80, s49
s_add_u32 s81, s81, 4194304
s_add_u32 s82, s81, 32768
s_lshl_b32 s48, s43, 11
v_add_u32 v51, s48, v18
v_add_u32 v52, 0x10000, v51
s_mul_i32 s48, s42, 393216
s_lshl_b32 s49, s41, 2
s_add_u32 s49, s49, s43
s_mul_i32 s49, s49, 6144
s_add_u32 s48, s48, s49
s_add_u32 s86, s48, 9437184
s_lshl_b32 s50, s43, 12
s_add_u32 s50, s50, s52
s_add_u32 s50, s50, 262144
v_min_u32 v8, 2, v3
v_lshlrev_b32 v8, 18, v8
v_lshl_add_u32 v8, v2, 4, v8
v_add_u32 v55, s50, v8
s_lshl_b32 s50, s42, 2
s_add_u32 s50, s50, s43
s_lshl_b32 s50, s50, 12
s_add_u32 s50, s50, 17825792
v_add_u32 v38, s50, v18
v_min_u32 v4, 2, v3
v_lshlrev_b32 v4, 8, v4
v_lshl_add_u32 v4, v2, 2, v4
s_and_b32 s48, s43, 1
s_lshl_b32 s48, s48, 7
s_lshr_b32 s49, s43, 1
s_lshl_b32 s49, s49, 6
s_add_u32 s48, s48, s49
s_add_u32 s48, s48, 133120
v_add_u32 v53, s48, v4
s_getpc_b64 s[98:99]
pc_6:
s_add_u32 s98, s98, c0_last - pc_6
s_addc_u32 s99, s99, 0
s_lshr_b32 s50, s2, 3
s_lshl_b32 s50, s50, 2
s_add_u32 s50, s50, s43
s_lshl_b32 s50, s50, 7
v_and_b32 v4, 1, v0
v_lshl_add_u32 v4, v4, 6, s50
v_min_u32 v54, L_code_end - c0_last, v4
s_add_u32 s69, s47, 1
s_and_b32 s69, s69, 15
s_mul_i32 s67, s69, 128
s_mul_i32 s68, s69, 393216
s_add_u32 m0, s70, 40960
s_nop 0
buffer_load_dwordx4 v20, s[24:27], s67 offen offset:0  lds
buffer_load_dwordx4 v21, s[24:27], s67 offen offset:1024  lds
buffer_load_dwordx4 v22, s[24:27], s67 offen offset:2048  lds
buffer_load_dwordx4 v23, s[24:27], s67 offen offset:3072  lds
s_add_u32 s60, s71, 40960
s_add_u32 m0, s60, 0
s_add_u32 s61, s68, 0
buffer_load_dwordx4 v26, s[28:31], s61 offen lds
buffer_load_dwordx4 v27, s[28:31], s61 offen offset:1024 lds
s_add_u32 m0, s60, 8192
s_add_u32 s61, s68, 2048
buffer_load_dwordx4 v26, s[28:31], s61 offen lds
buffer_load_dwordx4 v27, s[28:31], s61 offen offset:1024 lds
s_add_u32 m0, s60, 16384
s_add_u32 s61, s68, 4096
buffer_load_dwordx4 v26, s[28:31], s61 offen lds
buffer_load_dwordx4 v27, s[28:31], s61 offen offset:1024 lds
s_waitcnt vmcnt(10)
s_barrier
s_add_u32 s49, s76, 2
s_and_b32 s49, s49, 15
s_mul_i32 s49, s49, 393216
buffer_load_dwordx4 v[40:43], v36, s[28:31], s49 offen
s_add_u32 s49, s76, 3
s_and_b32 s49, s49, 15
s_mul_i32 s49, s49, 393216
buffer_load_dwordx4 v[40:43], v36, s[28:31], s49 offen
s_add_u32 s69, s47, 2
s_and_b32 s69, s69, 15
s_mul_i32 s67, s69, 128
s_mul_i32 s68, s69, 393216
s_add_u32 m0, s70, 81920
s_nop 0
buffer_load_dwordx4 v20, s[24:27], s67 offen offset:0  lds
buffer_load_dwordx4 v21, s[24:27], s67 offen offset:1024  lds
buffer_load_dwordx4 v22, s[24:27], s67 offen offset:2048  lds
buffer_load_dwordx4 v23, s[24:27], s67 offen offset:3072  lds
s_add_u32 s60, s71, 81920
s_add_u32 m0, s60, 0
s_add_u32 s61, s68, 0
buffer_load_dwordx4 v26, s[28:31], s61 offen lds
buffer_load_dwordx4 v27, s[28:31], s61 offen offset:1024 lds
s_add_u32 m0, s60, 8192
s_add_u32 s61, s68, 2048
buffer_load_dwordx4 v26, s[28:31], s61 offen lds
buffer_load_dwordx4 v27, s[28:31], s61 offen offset:1024 lds
s_add_u32 m0, s60, 16384
s_add_u32 s61, s68, 4096
buffer_load_dwordx4 v26, s[28:31], s61 offen lds
buffer_load_dwordx4 v27, s[28:31], s61 offen offset:1024 lds
s_add_u32 s49, s76, 4
s_and_b32 s49, s49, 15
s_mul_i32 s49, s49, 393216
buffer_load_dwordx4 v[40:43], v36, s[28:31], s49 offen
s_mov_b32 s64, 0
s_mov_b32 s65, 0
h0_loop:
s_waitcnt vmcnt(11)
s_barrier
s_sub_u32 s48, s64, 2
s_cmp_ge_u32 s48, 6
s_cbranch_scc1 nofill_7
buffer_store_dwordx4 v[56:59], v18, s[32:35], s86 offen offset:0 sc1
s_add_u32 s86, s86, 1024
nofill_7:
s_add_u32 s69, s69, 1
s_and_b32 s69, s69, 15
s_mul_i32 s67, s69, 128
s_mul_i32 s68, s69, 393216
s_add_u32 m0, s70, s65
s_nop 0
buffer_load_dwordx4 v20, s[24:27], s67 offen offset:0  lds
buffer_load_dwordx4 v21, s[24:27], s67 offen offset:1024  lds
buffer_load_dwordx4 v22, s[24:27], s67 offen offset:2048  lds
buffer_load_dwordx4 v23, s[24:27], s67 offen offset:3072  lds
s_add_u32 s60, s71, s65
s_add_u32 m0, s60, 0
s_add_u32 s61, s68, 0
buffer_load_dwordx4 v26, s[28:31], s61 offen lds
buffer_load_dwordx4 v27, s[28:31], s61 offen offset:1024 lds
s_add_u32 m0, s60, 8192
s_add_u32 s61, s68, 2048
buffer_load_dwordx4 v26, s[28:31], s61 offen lds
buffer_load_dwordx4 v27, s[28:31], s61 offen offset:1024 lds
s_add_u32 m0, s60, 16384
s_add_u32 s61, s68, 4096
buffer_load_dwordx4 v26, s[28:31], s61 offen lds
buffer_load_dwordx4 v27, s[28:31], s61 offen offset:1024 lds
s_add_u32 s48, s64, 5
s_min_u32 s48, s48, 15
s_add_u32 s49, s48, s76
s_and_b32 s49, s49, 15
s_mul_i32 s49, s49, 393216
buffer_load_dwordx4 v[40:43], v36, s[28:31], s49 offen
s_add_u32 s65, s65, 40960
s_cmp_eq_u32 s65, 122880
s_cselect_b32 s65, 0, s65
s_add_u32 s64, s64, 1
s_cmp_lt_u32 s64, 11
s_cbranch_scc1 h0_loop
s_waitcnt vmcnt(11)
s_barrier
global_load_dwordx2 v[34:35], v32, s[20:21] sc1
buffer_store_dwordx4 v[56:59], v55, s[32:35], 0 offen sc1
s_add_u32 s69, s69, 1
s_and_b32 s69, s69, 15
s_mul_i32 s67, s69, 128
s_mul_i32 s68, s69, 393216
s_add_u32 m0, s70, s65
s_nop 0
buffer_load_dwordx4 v20, s[24:27], s67 offen offset:0  lds
buffer_load_dwordx4 v21, s[24:27], s67 offen offset:1024  lds
buffer_load_dwordx4 v22, s[24:27], s67 offen offset:2048  lds
buffer_load_dwordx4 v23, s[24:27], s67 offen offset:3072  lds
s_add_u32 s60, s71, s65
s_add_u32 m0, s60, 0
s_add_u32 s61, s68, 0
buffer_load_dwordx4 v26, s[28:31], s61 offen lds
buffer_load_dwordx4 v27, s[28:31], s61 offen offset:1024 lds
s_add_u32 m0, s60, 8192
s_add_u32 s61, s68, 2048
buffer_load_dwordx4 v26, s[28:31], s61 offen lds
buffer_load_dwordx4 v27, s[28:31], s61 offen offset:1024 lds
s_add_u32 m0, s60, 16384
s_add_u32 s61, s68, 4096
buffer_load_dwordx4 v26, s[28:31], s61 offen lds
buffer_load_dwordx4 v27, s[28:31], s61 offen offset:1024 lds
s_add_u32 s65, s65, 40960
s_cmp_eq_u32 s65, 122880
s_cselect_b32 s65, 0, s65
s_add_u32 s64, s64, 1
s_mov_b32 s36, s8
s_and_b32 s37, s9, 0xffff
s_mov_b32 s38, 2097152
s_mov_b32 s39, 0x00020000
s_waitcnt vmcnt(10)
s_barrier
s_mov_b32 s63, 0
ipoll_8:
v_sad_u8 v4, v34, 0, 0
v_sad_u8 v4, v35, 0, v4
v_cmp_gt_u32 vcc, 32, v4
s_cbranch_vccz ipolled_9
global_load_dwordx2 v[34:35], v32, s[20:21] sc1
s_add_u32 s63, s63, 1
s_cmp_lt_u32 s63, 0x80000
s_waitcnt vmcnt(0)
s_cbranch_scc1 ipoll_8
ipolled_9:
buffer_load_dwordx4 v[80:83], v37, s[32:35], 0 offen offset:0 sc1
buffer_load_dwordx4 v[84:87], v37, s[32:35], 0 offen offset:1024 sc1
buffer_load_dwordx4 v[88:91], v37, s[32:35], 0 offen offset:2048 sc1
buffer_load_dwordx4 v[92:95], v37, s[32:35], 0 offen offset:3072 sc1
s_add_u32 s69, s47, 15
s_and_b32 s69, s69, 15
s_mul_i32 s67, s69, 128
s_mul_i32 s68, s69, 393216
s_add_u32 m0, s70, 0
s_nop 0
buffer_load_dwordx4 v20, s[24:27], s67 offen offset:0  lds
buffer_load_dwordx4 v21, s[24:27], s67 offen offset:1024  lds
buffer_load_dwordx4 v22, s[24:27], s67 offen offset:2048  lds
buffer_load_dwordx4 v23, s[24:27], s67 offen offset:3072  lds
s_add_u32 s60, s71, 0
s_add_u32 m0, s60, 0
s_add_u32 s61, s68, 0
buffer_load_dwordx4 v26, s[28:31], s61 offen lds
buffer_load_dwordx4 v27, s[28:31], s61 offen offset:1024 lds
s_waitcnt vmcnt(10)
s_barrier
s_setprio 2
s_add_u32 m0, s60, 8192
s_add_u32 s61, s68, 2048
buffer_load_dwordx4 v26, s[28:31], s61 offen lds
buffer_load_dwordx4 v27, s[28:31], s61 offen offset:1024 lds
s_waitcnt vmcnt(8)
s_add_u32 m0, s60, 16384
s_add_u32 s61, s68, 4096
buffer_load_dwordx4 v26, s[28:31], s61 offen lds
v_add_f32 v80, v80, v88
v_add_f32 v81, v81, v89
v_add_f32 v82, v82, v90
v_add_f32 v83, v83, v91
v_add_f32 v84, v84, v92
buffer_load_dwordx4 v27, s[28:31], s61 offen offset:1024 lds
v_add_f32 v85, v85, v93
v_add_f32 v86, v86, v94
v_add_f32 v87, v87, v95
v_add_f32 v80, v80, v84
global_load_dword v48, v54, s[98:99]
v_add_f32 v81, v81, v85
v_add_f32 v82, v82, v86
v_add_f32 v83, v83, v87
s_nop 1
buffer_load_dwordx4 v[64:67], v38, s[32:35], 0 offen offset:0 sc1
v_permlane32_swap_b32 v80, v81
v_permlane32_swap_b32 v82, v83
v_add_f32 v80, v80, v81
v_add_f32 v82, v82, v83
buffer_load_dwordx4 v[68:71], v38, s[32:35], 0 offen offset:1024 sc1
s_nop 1
v_permlane16_swap_b32 v80, v82
s_nop 0
v_add_f32 v80, v80, v82
buffer_load_dwordx4 v[72:75], v38, s[32:35], 0 offen offset:2048 sc1
v_cmp_u_f32 vcc, v80, v80
s_cbranch_vccnz again_10
summed_11:
v_mul_f32 v44, 0x3a800000, v80
buffer_load_dwordx4 v[76:79], v38, s[32:35], 0 offen offset:3072 sc1
v_mov_b32 v45, v44
s_nop 1
v_permlane16_swap_b32 v44, v45
s_nop 0
s_add_u32 s48, s75, 15
s_and_b32 s48, s48, 15
s_lshl_b32 s48, s48, 17
s_add_u32 m0, s71, 106496
s_nop 0
buffer_load_dwordx4 v28, s[36:39], s48 offen lds
v_fma_f32 v45, -v44, v44, v45
v_max_f32 v45, 0, v45
v_add_f32 v45, 0x3727c5ac, v45
v_rsq_f32 v46, v45
buffer_load_dwordx4 v29, s[36:39], s48 offen offset:1024 lds
v_sub_f32 v47, 0, v44
ds_write_b32 v50, v47 offset:512
ds_write_b64 v49, v[46:47]
ds_write_b32 v50, v46
s_waitcnt vmcnt(7)
s_barrier
s_add_u32 s48, s75, 5
s_and_b32 s48, s48, 15
s_lshl_b32 s48, s48, 17
s_add_u32 m0, s71, 24576
s_nop 0
buffer_load_dwordx4 v28, s[36:39], s48 offen lds
buffer_load_dwordx4 v29, s[36:39], s48 offen offset:1024 lds
s_waitcnt vmcnt(4)
s_add_u32 s48, s75, 6
s_and_b32 s48, s48, 15
s_lshl_b32 s48, s48, 17
s_add_u32 m0, s71, 32768
s_nop 0
buffer_load_dwordx4 v28, s[36:39], s48 offen lds
v_add_f32 v64, v64, v72
v_add_f32 v65, v65, v73
v_add_f32 v66, v66, v74
v_add_f32 v67, v67, v75
v_add_f32 v68, v68, v76
buffer_load_dwordx4 v29, s[36:39], s48 offen offset:1024 lds
v_add_f32 v69, v69, v77
v_add_f32 v70, v70, v78
v_add_f32 v71, v71, v79
v_add_f32 v64, v64, v68
s_add_u32 s48, s75, 7
s_and_b32 s48, s48, 15
s_lshl_b32 s48, s48, 17
s_add_u32 m0, s71, 40960
s_nop 0
buffer_load_dwordx4 v28, s[36:39], s48 offen lds
v_add_f32 v65, v65, v69
v_add_f32 v66, v66, v70
v_add_f32 v67, v67, v71
s_nop 1
buffer_load_dwordx4 v29, s[36:39], s48 offen offset:1024 lds
v_permlane32_swap_b32 v64, v65
v_permlane32_swap_b32 v66, v67
v_add_f32 v64, v64, v65
v_add_f32 v66, v66, v67
s_add_u32 s48, s75, 8
s_and_b32 s48, s48, 15
s_lshl_b32 s48, s48, 17
s_add_u32 m0, s71, 49152
s_nop 0
buffer_load_dwordx4 v28, s[36:39], s48 offen lds
s_nop 1
v_permlane16_swap_b32 v64, v66
s_nop 0
v_add_f32 v64, v64, v66
buffer_load_dwordx4 v29, s[36:39], s48 offen offset:1024 lds
v_cmp_u_f32 vcc, v64, v64
s_cbranch_vccnz again_13
summed_14:
ds_write_b32 v53, v64
s_cmp_lg_u32 s43, 2
s_cbranch_scc1 else_16
s_and_b32 s50, s2, 7
v_readlane_b32 s58, v34, s50
v_readlane_b32 s59, v35, s50
s_lshl_b64 s[48:49], s[94:95], 5
v_mov_b32 v4, 134656
s_nop 1
s_cmp_eq_u64 s[48:49], s[58:59]
s_cselect_b32 s48, 1, 0
v_mov_b32 v5, s48
ds_write_b32 v4, v5
else_16:
s_setprio 0
s_waitcnt lgkmcnt(0)
s_waitcnt vmcnt(63)
s_barrier
s_add_u32 s48, s75, 9
s_and_b32 s48, s48, 15
s_lshl_b32 s48, s48, 17
s_add_u32 m0, s71, 57344
s_waitcnt vmcnt(4)
buffer_load_dwordx4 v28, s[36:39], s48 offen lds
buffer_load_dwordx4 v29, s[36:39], s48 offen offset:1024 lds
s_add_u32 s48, s75, 10
s_and_b32 s48, s48, 15
s_lshl_b32 s48, s48, 17
s_add_u32 m0, s71, 65536
s_waitcnt vmcnt(4)
buffer_load_dwordx4 v28, s[36:39], s48 offen lds
buffer_load_dwordx4 v29, s[36:39], s48 offen offset:1024 lds
s_add_u32 s48, s75, 11
s_and_b32 s48, s48, 15
s_lshl_b32 s48, s48, 17
s_add_u32 m0, s71, 73728
s_waitcnt vmcnt(4)
buffer_load_dwordx4 v28, s[36:39], s48 offen lds
buffer_load_dwordx4 v29, s[36:39], s48 offen offset:1024 lds
s_add_u32 s48, s75, 12
s_and_b32 s48, s48, 15
s_lshl_b32 s48, s48, 17
s_add_u32 m0, s71, 81920
s_waitcnt vmcnt(4)
buffer_load_dwordx4 v28, s[36:39], s48 offen lds
buffer_load_dwordx4 v29, s[36:39], s48 offen offset:1024 lds
s_add_u32 s48, s75, 13
s_and_b32 s48, s48, 15
s_lshl_b32 s48, s48, 17
s_add_u32 m0, s71, 90112
s_waitcnt vmcnt(4)
buffer_load_dwordx4 v28, s[36:39], s48 offen lds
buffer_load_dwordx4 v29, s[36:39], s48 offen offset:1024 lds
s_add_u32 s48, s75, 14
s_and_b32 s48, s48, 15
s_lshl_b32 s48, s48, 17
s_add_u32 m0, s71, 98304
s_waitcnt vmcnt(4)
buffer_load_dwordx4 v28, s[36:39], s48 offen lds
buffer_load_dwordx4 v29, s[36:39], s48 offen offset:1024 lds
s_add_u32 s48, s75, 0
s_and_b32 s48, s48, 15
s_lshl_b32 s48, s48, 17
s_add_u32 m0, s71, 4294950912
s_waitcnt vmcnt(4)
buffer_load_dwordx4 v28, s[36:39], s48 offen lds
buffer_load_dwordx4 v29, s[36:39], s48 offen offset:1024 lds
s_add_u32 s48, s75, 1
s_and_b32 s48, s48, 15
s_lshl_b32 s48, s48, 17
s_add_u32 m0, s71, 4294959104
s_waitcnt vmcnt(4)
buffer_load_dwordx4 v28, s[36:39], s48 offen lds
buffer_load_dwordx4 v29, s[36:39], s48 offen offset:1024 lds
s_add_u32 s48, s75, 2
s_and_b32 s48, s48, 15
s_lshl_b32 s48, s48, 17
s_add_u32 m0, s71, 0
s_waitcnt vmcnt(4)
buffer_load_dwordx4 v28, s[36:39], s48 offen lds
buffer_load_dwordx4 v29, s[36:39], s48 offen offset:1024 lds
s_add_u32 s48, s75, 3
s_and_b32 s48, s48, 15
s_lshl_b32 s48, s48, 17
s_add_u32 m0, s71, 8192
s_waitcnt vmcnt(4)
buffer_load_dwordx4 v28, s[36:39], s48 offen lds
buffer_load_dwordx4 v29, s[36:39], s48 offen offset:1024 lds
s_add_u32 s48, s75, 4
s_and_b32 s48, s48, 15
s_lshl_b32 s48, s48, 17
s_add_u32 m0, s71, 16384
s_waitcnt vmcnt(4)
buffer_load_dwordx4 v28, s[36:39], s48 offen lds
buffer_load_dwordx4 v29, s[36:39], s48 offen offset:1024 lds
s_mov_b32 s28, s12
s_and_b32 s29, s13, 0xffff
s_mov_b32 s30, 6291456
s_mov_b32 s31, 0x00020000
v_lshrrev_b32 v4, 3, v0
v_and_b32 v5, 7, v0
s_lshr_b32 s48, s43, 1
s_lshl_b32 s48, s48, 5
s_and_b32 s49, s43, 1
s_lshl_b32 s49, s49, 3
s_add_u32 s48, s48, s49
v_lshrrev_b32 v6, 2, v4
v_lshlrev_b32 v6, 4, v6
v_and_b32 v7, 3, v4
v_add3_u32 v6, v6, v7, s48
v_mul_u32_u24 v6, 6144, v6
v_and_b32 v7, 2, v4
v_xor_b32 v7, v7, v5
s_lshl_b32 s48, s42, 7
v_lshl_add_u32 v26, v7, 4, v6
v_add_u32 v26, s48, v26
v_xor_b32 v27, 64, v26
v_add_u32 v27, 23552, v27
s_lshl_b32 s83, s41, 2
s_add_u32 s83, s83, 0
s_lshl_b32 s83, s83, 7
s_add_u32 s83, s83, 18350080
s_and_b32 s48, s2, 7
s_lshl_b32 s48, s48, 1
s_add_u32 s47, s42, s48
s_and_b32 s47, s47, 15
s_and_b32 s50, s42, 8
s_or_b32 s50, s50, 3
s_and_b32 s48, s2, 7
s_lshl_b32 s48, s48, 1
s_add_u32 s76, s50, s48
s_and_b32 s76, s76, 15
s_add_u32 s69, s47, 0
s_and_b32 s69, s69, 15
s_mul_i32 s67, s69, 128
s_mul_i32 s68, s69, 393216
s_waitcnt vmcnt(0) lgkmcnt(0)
s_barrier
s_add_u32 s60, s71, 122880
s_add_u32 m0, s60, 0
s_add_u32 s61, s68, 0
buffer_load_dwordx4 v26, s[28:31], s61 offen lds
buffer_load_dwordx4 v27, s[28:31], s61 offen offset:1024 lds
s_add_u32 m0, s60, 8192
s_add_u32 s61, s68, 2048
buffer_load_dwordx4 v26, s[28:31], s61 offen lds
buffer_load_dwordx4 v27, s[28:31], s61 offen offset:1024 lds
s_add_u32 m0, s60, 16384
s_add_u32 s61, s68, 4096
buffer_load_dwordx4 v26, s[28:31], s61 offen lds
buffer_load_dwordx4 v27, s[28:31], s61 offen offset:1024 lds
s_mov_b32 s36, s14
s_and_b32 s37, s15, 0xffff
s_mov_b32 s38, 65536
s_mov_b32 s39, 0x00020000
s_lshl_b32 s48, s42, 12
s_lshl_b32 s49, s43, 10
s_add_u32 s48, s48, s49
s_add_u32 m0, s49, 135168
s_nop 0
buffer_load_dwordx4 v18, s[36:39], s48 offen lds
ds_read_b128 v[112:115], v51 offset:0
ds_read_b128 v[116:119], v51 offset:1024
ds_read_b128 v[120:123], v51 offset:8192
ds_read_b128 v[124:127], v51 offset:9216
ds_read_b128 v[128:131], v51 offset:16384
ds_read_b128 v[132:135], v51 offset:17408
ds_read_b128 v[136:139], v51 offset:24576
ds_read_b128 v[140:143], v51 offset:25600
ds_read_b128 v[144:147], v51 offset:32768
ds_read_b128 v[148:151], v51 offset:33792
ds_read_b128 v[152:155], v51 offset:40960
ds_read_b128 v[156:159], v51 offset:41984
ds_read_b128 v[160:163], v51 offset:49152
ds_read_b128 v[164:167], v51 offset:50176
ds_read_b128 v[168:171], v51 offset:57344
ds_read_b128 v[172:175], v51 offset:58368
ds_read_b128 v[176:179], v52 offset:0
ds_read_b128 v[180:183], v52 offset:1024
ds_read_b128 v[184:187], v52 offset:8192
ds_read_b128 v[188:191], v52 offset:9216
ds_read_b128 v[192:195], v52 offset:16384
ds_read_b128 v[196:199], v52 offset:17408
ds_read_b128 v[200:203], v52 offset:24576
ds_read_b128 v[204:207], v52 offset:25600
ds_read_b128 v[208:211], v52 offset:32768
ds_read_b128 v[212:215], v52 offset:33792
ds_read_b128 v[216:219], v52 offset:40960
ds_read_b128 v[220:223], v52 offset:41984
ds_read_b128 v[224:227], v52 offset:49152
ds_read_b128 v[228:231], v52 offset:50176
ds_read_b128 v[232:235], v52 offset:57344
ds_read_b128 v[236:239], v52 offset:58368
s_add_u32 s48, s80, 0
v_add_u32 v20, s48, v18
v_mov_b32 v21, v20
v_add_u32 v22, 30720, v20
v_mov_b32 v23, v22
v_add_u32 v37, 262144, v37
s_lshl_b32 s50, s42, 2
s_add_u32 s50, s50, s43
s_lshl_b32 s50, s50, 12
s_add_u32 s50, s50, 18087936
v_add_u32 v38, s50, v18
v_min_u32 v4, 2, v3
v_lshlrev_b32 v4, 8, v4
v_lshl_add_u32 v4, v2, 2, v4
s_and_b32 s48, s43, 1
s_lshl_b32 s48, s48, 7
s_lshr_b32 s49, s43, 1
s_lshl_b32 s49, s49, 6
s_add_u32 s48, s48, s49
s_add_u32 s48, s48, 133888
v_add_u32 v53, s48, v4
s_getpc_b64 s[98:99]
pc_18:
s_add_u32 s98, s98, c1_last - pc_18
s_addc_u32 s99, s99, 0
s_lshr_b32 s50, s2, 3
s_lshl_b32 s50, s50, 2
s_add_u32 s50, s50, s43
s_lshl_b32 s50, s50, 7
v_and_b32 v4, 1, v0
v_lshl_add_u32 v4, v4, 6, s50
v_min_u32 v54, L_code_end - c1_last, v4
s_waitcnt vmcnt(0) lgkmcnt(0)
s_add_u32 s69, s47, 1
s_and_b32 s69, s69, 15
s_mul_i32 s67, s69, 2048
s_mul_i32 s68, s69, 393216
s_barrier
s_add_u32 s60, s71, 40960
s_add_u32 m0, s60, 0
s_add_u32 s61, s68, 0
buffer_load_dwordx4 v26, s[28:31], s61 offen lds
buffer_load_dwordx4 v27, s[28:31], s61 offen offset:1024 lds
s_add_u32 m0, s60, 8192
s_add_u32 s61, s68, 2048
buffer_load_dwordx4 v26, s[28:31], s61 offen lds
buffer_load_dwordx4 v27, s[28:31], s61 offen offset:1024 lds
s_add_u32 m0, s60, 16384
s_add_u32 s61, s68, 4096
buffer_load_dwordx4 v26, s[28:31], s61 offen lds
buffer_load_dwordx4 v27, s[28:31], s61 offen offset:1024 lds
s_add_u32 s49, s76, 2
s_and_b32 s49, s49, 15
s_mul_i32 s49, s49, 393216
buffer_load_dwordx4 v[40:43], v36, s[28:31], s49 offen
s_add_u32 s49, s76, 3
s_and_b32 s49, s49, 15
s_mul_i32 s49, s49, 393216
buffer_load_dwordx4 v[40:43], v36, s[28:31], s49 offen
buffer_load_dword v5, v30, s[32:35], s79 offen sc1
s_mov_b32 s63, 0
s_waitcnt vmcnt(0)
poll_19:
v_cmp_gt_u32 vcc, 1, v5
s_cbranch_vccz polled_20
buffer_load_dword v5, v30, s[32:35], s79 offen sc1
s_add_u32 s63, s63, 1
s_cmp_lt_u32 s63, 0x80000
s_waitcnt vmcnt(0)
s_cbranch_scc1 poll_19
polled_20:
s_add_u32 s69, s47, 0
s_and_b32 s69, s69, 15
s_mul_i32 s67, s69, 2048
s_mul_i32 s68, s69, 393216
s_add_u32 m0, s70, 0
s_nop 0
buffer_load_dwordx4 v20, s[32:35], s67 offen offset:0 sc1 lds
buffer_load_dwordx4 v21, s[32:35], s67 offen offset:1024 sc1 lds
buffer_load_dwordx4 v22, s[32:35], s67 offen offset:2048 sc1 lds
buffer_load_dwordx4 v23, s[32:35], s67 offen offset:3072 sc1 lds
s_add_u32 s69, s47, 1
s_and_b32 s69, s69, 15
s_mul_i32 s67, s69, 2048
s_mul_i32 s68, s69, 393216
s_add_u32 m0, s70, 40960
s_nop 0
buffer_load_dwordx4 v20, s[32:35], s67 offen offset:0 sc1 lds
buffer_load_dwordx4 v21, s[32:35], s67 offen offset:1024 sc1 lds
buffer_load_dwordx4 v22, s[32:35], s67 offen offset:2048 sc1 lds
buffer_load_dwordx4 v23, s[32:35], s67 offen offset:3072 sc1 lds
s_waitcnt vmcnt(4)
s_barrier
s_add_u32 s69, s47, 2
s_and_b32 s69, s69, 15
s_mul_i32 s67, s69, 2048
s_mul_i32 s68, s69, 393216
s_add_u32 m0, s70, 81920
s_nop 0
buffer_load_dwordx4 v20, s[32:35], s67 offen offset:0 sc1 lds
buffer_load_dwordx4 v21, s[32:35], s67 offen offset:1024 sc1 lds
buffer_load_dwordx4 v22, s[32:35], s67 offen offset:2048 sc1 lds
buffer_load_dwordx4 v23, s[32:35], s67 offen offset:3072 sc1 lds
s_add_u32 s60, s71, 81920
s_add_u32 m0, s60, 0
s_add_u32 s61, s68, 0
buffer_load_dwordx4 v26, s[28:31], s61 offen lds
buffer_load_dwordx4 v27, s[28:31], s61 offen offset:1024 lds
s_add_u32 m0, s60, 8192
s_add_u32 s61, s68, 2048
buffer_load_dwordx4 v26, s[28:31], s61 offen lds
buffer_load_dwordx4 v27, s[28:31], s61 offen offset:1024 lds
s_add_u32 m0, s60, 16384
s_add_u32 s61, s68, 4096
buffer_load_dwordx4 v26, s[28:31], s61 offen lds
buffer_load_dwordx4 v27, s[28:31], s61 offen offset:1024 lds
s_add_u32 s49, s76, 4
s_and_b32 s49, s49, 15
s_mul_i32 s49, s49, 393216
buffer_load_dwordx4 v[40:43], v36, s[28:31], s49 offen
s_mov_b32 s64, 0
s_mov_b32 s65, 0
h1_loop:
s_waitcnt vmcnt(11)
s_barrier
s_add_u32 s69, s69, 1
s_and_b32 s69, s69, 15
s_mul_i32 s67, s69, 2048
s_mul_i32 s68, s69, 393216
s_add_u32 m0, s70, s65
s_nop 0
buffer_load_dwordx4 v20, s[32:35], s67 offen offset:0 sc1 lds
buffer_load_dwordx4 v21, s[32:35], s67 offen offset:1024 sc1 lds
buffer_load_dwordx4 v22, s[32:35], s67 offen offset:2048 sc1 lds
buffer_load_dwordx4 v23, s[32:35], s67 offen offset:3072 sc1 lds
s_add_u32 s60, s71, s65
s_add_u32 m0, s60, 0
s_add_u32 s61, s68, 0
buffer_load_dwordx4 v26, s[28:31], s61 offen lds
buffer_load_dwordx4 v27, s[28:31], s61 offen offset:1024 lds
s_add_u32 m0, s60, 8192
s_add_u32 s61, s68, 2048
buffer_load_dwordx4 v26, s[28:31], s61 offen lds
buffer_load_dwordx4 v27, s[28:31], s61 offen offset:1024 lds
s_add_u32 m0, s60, 16384
s_add_u32 s61, s68, 4096
buffer_load_dwordx4 v26, s[28:31], s61 offen lds
buffer_load_dwordx4 v27, s[28:31], s61 offen offset:1024 lds
s_add_u32 s48, s64, 5
s_min_u32 s48, s48, 15
s_add_u32 s49, s48, s76
s_and_b32 s49, s49, 15
s_mul_i32 s49, s49, 393216
buffer_load_dwordx4 v[40:43], v36, s[28:31], s49 offen
s_add_u32 s65, s65, 40960
s_cmp_eq_u32 s65, 122880
s_cselect_b32 s65, 0, s65
s_add_u32 s64, s64, 1
s_cmp_lt_u32 s64, 11
s_cbranch_scc1 h1_loop
s_waitcnt vmcnt(11)
s_barrier
s_add_u32 s69, s69, 1
s_and_b32 s69, s69, 15
s_mul_i32 s67, s69, 2048
s_mul_i32 s68, s69, 393216
s_add_u32 m0, s70, s65
s_nop 0
buffer_load_dwordx4 v20, s[32:35], s67 offen offset:0 sc1 lds
buffer_load_dwordx4 v21, s[32:35], s67 offen offset:1024 sc1 lds
buffer_load_dwordx4 v22, s[32:35], s67 offen offset:2048 sc1 lds
buffer_load_dwordx4 v23, s[32:35], s67 offen offset:3072 sc1 lds
s_add_u32 s60, s71, s65
s_add_u32 m0, s60, 0
s_add_u32 s61, s68, 0
buffer_load_dwordx4 v26, s[28:31], s61 offen lds
buffer_load_dwordx4 v27, s[28:31], s61 offen offset:1024 lds
s_add_u32 m0, s60, 8192
s_add_u32 s61, s68, 2048
buffer_load_dwordx4 v26, s[28:31], s61 offen lds
buffer_load_dwordx4 v27, s[28:31], s61 offen offset:1024 lds
s_add_u32 m0, s60, 16384
s_add_u32 s61, s68, 4096
buffer_load_dwordx4 v26, s[28:31], s61 offen lds
buffer_load_dwordx4 v27, s[28:31], s61 offen offset:1024 lds
s_add_u32 s65, s65, 40960
s_cmp_eq_u32 s65, 122880
s_cselect_b32 s65, 0, s65
s_add_u32 s64, s64, 1
s_mov_b32 s36, s16
s_and_b32 s37, s17, 0xffff
s_mov_b32 s38, 2097152
s_mov_b32 s39, 0x00020000
s_waitcnt vmcnt(10)
s_barrier
buffer_load_dwordx4 v[80:83], v37, s[32:35], 0 offen offset:0 sc1
buffer_load_dwordx4 v[84:87], v37, s[32:35], 0 offen offset:1024 sc1
buffer_load_dwordx4 v[88:91], v37, s[32:35], 0 offen offset:2048 sc1
buffer_load_dwordx4 v[92:95], v37, s[32:35], 0 offen offset:3072 sc1
s_add_u32 s69, s47, 15
s_and_b32 s69, s69, 15
s_mul_i32 s67, s69, 2048
s_mul_i32 s68, s69, 393216
s_add_u32 m0, s70, 0
s_nop 0
buffer_load_dwordx4 v20, s[32:35], s67 offen offset:0 sc1 lds
buffer_load_dwordx4 v21, s[32:35], s67 offen offset:1024 sc1 lds
buffer_load_dwordx4 v22, s[32:35], s67 offen offset:2048 sc1 lds
buffer_load_dwordx4 v23, s[32:35], s67 offen offset:3072 sc1 lds
s_add_u32 s60, s71, 0
s_add_u32 m0, s60, 0
s_add_u32 s61, s68, 0
buffer_load_dwordx4 v26, s[28:31], s61 offen lds
buffer_load_dwordx4 v27, s[28:31], s61 offen offset:1024 lds
s_waitcnt vmcnt(10)
s_barrier
s_setprio 2
s_add_u32 m0, s60, 8192
s_add_u32 s61, s68, 2048
buffer_load_dwordx4 v26, s[28:31], s61 offen lds
buffer_load_dwordx4 v27, s[28:31], s61 offen offset:1024 lds
s_waitcnt vmcnt(8)
s_add_u32 m0, s60, 16384
s_add_u32 s61, s68, 4096
buffer_load_dwordx4 v26, s[28:31], s61 offen lds
v_add_f32 v80, v80, v88
v_add_f32 v81, v81, v89
v_add_f32 v82, v82, v90
v_add_f32 v83, v83, v91
v_add_f32 v84, v84, v92
buffer_load_dwordx4 v27, s[28:31], s61 offen offset:1024 lds
v_add_f32 v85, v85, v93
v_add_f32 v86, v86, v94
v_add_f32 v87, v87, v95
v_add_f32 v80, v80, v84
global_load_dword v48, v54, s[98:99]
v_add_f32 v81, v81, v85
v_add_f32 v82, v82, v86
v_add_f32 v83, v83, v87
s_nop 1
buffer_load_dwordx4 v[64:67], v38, s[32:35], 0 offen offset:0 sc1
v_permlane32_swap_b32 v80, v81
v_permlane32_swap_b32 v82, v83
v_add_f32 v80, v80, v81
v_add_f32 v82, v82, v83
buffer_load_dwordx4 v[68:71], v38, s[32:35], 0 offen offset:1024 sc1
s_nop 1
v_permlane16_swap_b32 v80, v82
s_nop 0
v_add_f32 v80, v80, v82
buffer_load_dwordx4 v[72:75], v38, s[32:35], 0 offen offset:2048 sc1
v_cmp_u_f32 vcc, v80, v80
s_cbranch_vccnz again_21
summed_22:
v_mul_f32 v44, 0x3a800000, v80
buffer_load_dwordx4 v[76:79], v38, s[32:35], 0 offen offset:3072 sc1
v_mov_b32 v45, v44
s_nop 1
v_permlane16_swap_b32 v44, v45
s_nop 0
s_add_u32 s48, s75, 15
s_and_b32 s48, s48, 15
s_lshl_b32 s48, s48, 17
s_add_u32 m0, s71, 106496
s_nop 0
buffer_load_dwordx4 v28, s[36:39], s48 offen lds
v_fma_f32 v45, -v44, v44, v45
v_max_f32 v45, 0, v45
v_add_f32 v45, 0x3727c5ac, v45
v_rsq_f32 v46, v45
buffer_load_dwordx4 v29, s[36:39], s48 offen offset:1024 lds
v_sub_f32 v47, 0, v44
ds_write_b32 v50, v47 offset:512
ds_write_b64 v49, v[46:47]
ds_write_b32 v50, v46
s_waitcnt vmcnt(7)
s_barrier
s_add_u32 s48, s75, 5
s_and_b32 s48, s48, 15
s_lshl_b32 s48, s48, 17
s_add_u32 m0, s71, 24576
s_nop 0
buffer_load_dwordx4 v28, s[36:39], s48 offen lds
buffer_load_dwordx4 v29, s[36:39], s48 offen offset:1024 lds
s_waitcnt vmcnt(4)
s_add_u32 s48, s75, 6
s_and_b32 s48, s48, 15
s_lshl_b32 s48, s48, 17
s_add_u32 m0, s71, 32768
s_nop 0
buffer_load_dwordx4 v28, s[36:39], s48 offen lds
v_add_f32 v64, v64, v72
v_add_f32 v65, v65, v73
v_add_f32 v66, v66, v74
v_add_f32 v67, v67, v75
v_add_f32 v68, v68, v76
buffer_load_dwordx4 v29, s[36:39], s48 offen offset:1024 lds
v_add_f32 v69, v69, v77
v_add_f32 v70, v70, v78
v_add_f32 v71, v71, v79
v_add_f32 v64, v64, v68
s_add_u32 s48, s75, 7
s_and_b32 s48, s48, 15
s_lshl_b32 s48, s48, 17
s_add_u32 m0, s71, 40960
s_nop 0
buffer_load_dwordx4 v28, s[36:39], s48 offen lds
v_add_f32 v65, v65, v69
v_add_f32 v66, v66, v70
v_add_f32 v67, v67, v71
s_nop 1
buffer_load_dwordx4 v29, s[36:39], s48 offen offset:1024 lds
v_permlane32_swap_b32 v64, v65
v_permlane32_swap_b32 v66, v67
v_add_f32 v64, v64, v65
v_add_f32 v66, v66, v67
s_add_u32 s48, s75, 8
s_and_b32 s48, s48, 15
s_lshl_b32 s48, s48, 17
s_add_u32 m0, s71, 49152
s_nop 0
buffer_load_dwordx4 v28, s[36:39], s48 offen lds
s_nop 1
v_permlane16_swap_b32 v64, v66
s_nop 0
v_add_f32 v64, v64, v66
buffer_load_dwordx4 v29, s[36:39], s48 offen offset:1024 lds
v_cmp_u_f32 vcc, v64, v64
s_cbranch_vccnz again_24
summed_25:
ds_write_b32 v53, v64
s_setprio 0
s_waitcnt lgkmcnt(0)
s_waitcnt vmcnt(63)
s_barrier
s_add_u32 s48, s75, 9
s_and_b32 s48, s48, 15
s_lshl_b32 s48, s48, 17
s_add_u32 m0, s71, 57344
s_waitcnt vmcnt(4)
buffer_load_dwordx4 v28, s[36:39], s48 offen lds
buffer_load_dwordx4 v29, s[36:39], s48 offen offset:1024 lds
s_add_u32 s48, s75, 10
s_and_b32 s48, s48, 15
s_lshl_b32 s48, s48, 17
s_add_u32 m0, s71, 65536
s_waitcnt vmcnt(4)
buffer_load_dwordx4 v28, s[36:39], s48 offen lds
buffer_load_dwordx4 v29, s[36:39], s48 offen offset:1024 lds
s_add_u32 s48, s75, 11
s_and_b32 s48, s48, 15
s_lshl_b32 s48, s48, 17
s_add_u32 m0, s71, 73728
s_waitcnt vmcnt(4)
buffer_load_dwordx4 v28, s[36:39], s48 offen lds
buffer_load_dwordx4 v29, s[36:39], s48 offen offset:1024 lds
s_add_u32 s48, s75, 12
s_and_b32 s48, s48, 15
s_lshl_b32 s48, s48, 17
s_add_u32 m0, s71, 81920
s_waitcnt vmcnt(4)
buffer_load_dwordx4 v28, s[36:39], s48 offen lds
buffer_load_dwordx4 v29, s[36:39], s48 offen offset:1024 lds
s_add_u32 s48, s75, 13
s_and_b32 s48, s48, 15
s_lshl_b32 s48, s48, 17
s_add_u32 m0, s71, 90112
s_waitcnt vmcnt(4)
buffer_load_dwordx4 v28, s[36:39], s48 offen lds
buffer_load_dwordx4 v29, s[36:39], s48 offen offset:1024 lds
s_add_u32 s48, s75, 14
s_and_b32 s48, s48, 15
s_lshl_b32 s48, s48, 17
s_add_u32 m0, s71, 98304
s_waitcnt vmcnt(4)
buffer_load_dwordx4 v28, s[36:39], s48 offen lds
buffer_load_dwordx4 v29, s[36:39], s48 offen offset:1024 lds
s_add_u32 s48, s75, 0
s_and_b32 s48, s48, 15
s_lshl_b32 s48, s48, 17
s_add_u32 m0, s71, 4294950912
s_waitcnt vmcnt(4)
buffer_load_dwordx4 v28, s[36:39], s48 offen lds
buffer_load_dwordx4 v29, s[36:39], s48 offen offset:1024 lds
s_add_u32 s48, s75, 1
s_and_b32 s48, s48, 15
s_lshl_b32 s48, s48, 17
s_add_u32 m0, s71, 4294959104
s_waitcnt vmcnt(4)
buffer_load_dwordx4 v28, s[36:39], s48 offen lds
buffer_load_dwordx4 v29, s[36:39], s48 offen offset:1024 lds
s_add_u32 s48, s75, 2
s_and_b32 s48, s48, 15
s_lshl_b32 s48, s48, 17
s_add_u32 m0, s71, 0
s_waitcnt vmcnt(4)
buffer_load_dwordx4 v28, s[36:39], s48 offen lds
buffer_load_dwordx4 v29, s[36:39], s48 offen offset:1024 lds
s_add_u32 s48, s75, 3
s_and_b32 s48, s48, 15
s_lshl_b32 s48, s48, 17
s_add_u32 m0, s71, 8192
s_waitcnt vmcnt(4)
buffer_load_dwordx4 v28, s[36:39], s48 offen lds
buffer_load_dwordx4 v29, s[36:39], s48 offen offset:1024 lds
s_add_u32 s48, s75, 4
s_and_b32 s48, s48, 15
s_lshl_b32 s48, s48, 17
s_add_u32 m0, s71, 16384
s_waitcnt vmcnt(4)
buffer_load_dwordx4 v28, s[36:39], s48 offen lds
buffer_load_dwordx4 v29, s[36:39], s48 offen offset:1024 lds
buffer_load_dwordx4 v[96:99], v18, s[32:35], s81 offen offset:0 sc1
buffer_load_dwordx4 v[100:103], v18, s[32:35], s81 offen offset:1024 sc1
buffer_load_dwordx4 v[104:107], v18, s[32:35], s82 offen offset:0 sc1
buffer_load_dwordx4 v[108:111], v18, s[32:35], s82 offen offset:1024 sc1
s_mov_b32 s28, s6
s_and_b32 s29, s7, 0xffff
s_mov_b32 s30, 6291456
s_mov_b32 s31, 0x00020000
s_add_u32 s69, s47, 0
s_and_b32 s69, s69, 15
s_mul_i32 s67, s69, 2048
s_mul_i32 s68, s69, 393216
s_waitcnt vmcnt(0) lgkmcnt(0)
s_barrier
s_add_u32 s60, s71, 122880
s_add_u32 m0, s60, 0
s_add_u32 s61, s68, 0
buffer_load_dwordx4 v26, s[28:31], s61 offen lds
buffer_load_dwordx4 v27, s[28:31], s61 offen offset:1024 lds
s_add_u32 m0, s60, 8192
s_add_u32 s61, s68, 2048
buffer_load_dwordx4 v26, s[28:31], s61 offen lds
buffer_load_dwordx4 v27, s[28:31], s61 offen offset:1024 lds
s_add_u32 m0, s60, 16384
s_add_u32 s61, s68, 4096
buffer_load_dwordx4 v26, s[28:31], s61 offen lds
buffer_load_dwordx4 v27, s[28:31], s61 offen offset:1024 lds
v_add_u32 v37, 262144, v37
s_getpc_b64 s[98:99]
pc_27:
s_add_u32 s98, s98, c2_last - pc_27
s_addc_u32 s99, s99, 0
s_lshr_b32 s50, s2, 3
s_lshl_b32 s50, s50, 2
s_add_u32 s50, s50, s43
s_lshl_b32 s50, s50, 7
v_and_b32 v4, 1, v0
v_lshl_add_u32 v4, v4, 6, s50
v_min_u32 v54, L_code_end - c2_last, v4
s_waitcnt vmcnt(0) lgkmcnt(0)
s_add_u32 s69, s47, 1
s_and_b32 s69, s69, 15
s_mul_i32 s67, s69, 2048
s_mul_i32 s68, s69, 393216
s_barrier
s_add_u32 s60, s71, 40960
s_add_u32 m0, s60, 0
s_add_u32 s61, s68, 0
buffer_load_dwordx4 v26, s[28:31], s61 offen lds
buffer_load_dwordx4 v27, s[28:31], s61 offen offset:1024 lds
s_add_u32 m0, s60, 8192
s_add_u32 s61, s68, 2048
buffer_load_dwordx4 v26, s[28:31], s61 offen lds
buffer_load_dwordx4 v27, s[28:31], s61 offen offset:1024 lds
s_add_u32 m0, s60, 16384
s_add_u32 s61, s68, 4096
buffer_load_dwordx4 v26, s[28:31], s61 offen lds
buffer_load_dwordx4 v27, s[28:31], s61 offen offset:1024 lds
s_add_u32 s49, s76, 2
s_and_b32 s49, s49, 15
s_mul_i32 s49, s49, 393216
buffer_load_dwordx4 v[40:43], v36, s[28:31], s49 offen
s_add_u32 s49, s76, 3
s_and_b32 s49, s49, 15
s_mul_i32 s49, s49, 393216
buffer_load_dwordx4 v[40:43], v36, s[28:31], s49 offen
buffer_load_dword v5, v30, s[32:35], s79 offen sc1
s_mov_b32 s63, 0
s_waitcnt vmcnt(0)
poll_28:
v_cmp_gt_u32 vcc, 2, v5
s_cbranch_vccz polled_29
buffer_load_dword v5, v30, s[32:35], s79 offen sc1
s_add_u32 s63, s63, 1
s_cmp_lt_u32 s63, 0x80000
s_waitcnt vmcnt(0)
s_cbranch_scc1 poll_28
polled_29:
s_add_u32 s69, s47, 0
s_and_b32 s69, s69, 15
s_mul_i32 s67, s69, 2048
s_mul_i32 s68, s69, 393216
s_add_u32 m0, s70, 0
s_nop 0
buffer_load_dwordx4 v20, s[32:35], s67 offen offset:0 sc1 lds
buffer_load_dwordx4 v21, s[32:35], s67 offen offset:1024 sc1 lds
buffer_load_dwordx4 v22, s[32:35], s67 offen offset:2048 sc1 lds
buffer_load_dwordx4 v23, s[32:35], s67 offen offset:3072 sc1 lds
s_add_u32 s69, s47, 1
s_and_b32 s69, s69, 15
s_mul_i32 s67, s69, 2048
s_mul_i32 s68, s69, 393216
s_add_u32 m0, s70, 40960
s_nop 0
buffer_load_dwordx4 v20, s[32:35], s67 offen offset:0 sc1 lds
buffer_load_dwordx4 v21, s[32:35], s67 offen offset:1024 sc1 lds
buffer_load_dwordx4 v22, s[32:35], s67 offen offset:2048 sc1 lds
buffer_load_dwordx4 v23, s[32:35], s67 offen offset:3072 sc1 lds
s_waitcnt vmcnt(4)
s_barrier
s_add_u32 s69, s47, 2
s_and_b32 s69, s69, 15
s_mul_i32 s67, s69, 2048
s_mul_i32 s68, s69, 393216
s_add_u32 m0, s70, 81920
s_nop 0
buffer_load_dwordx4 v20, s[32:35], s67 offen offset:0 sc1 lds
buffer_load_dwordx4 v21, s[32:35], s67 offen offset:1024 sc1 lds
buffer_load_dwordx4 v22, s[32:35], s67 offen offset:2048 sc1 lds
buffer_load_dwordx4 v23, s[32:35], s67 offen offset:3072 sc1 lds
s_add_u32 s60, s71, 81920
s_add_u32 m0, s60, 0
s_add_u32 s61, s68, 0
buffer_load_dwordx4 v26, s[28:31], s61 offen lds
buffer_load_dwordx4 v27, s[28:31], s61 offen offset:1024 lds
s_add_u32 m0, s60, 8192
s_add_u32 s61, s68, 2048
buffer_load_dwordx4 v26, s[28:31], s61 offen lds
buffer_load_dwordx4 v27, s[28:31], s61 offen offset:1024 lds
s_add_u32 m0, s60, 16384
s_add_u32 s61, s68, 4096
buffer_load_dwordx4 v26, s[28:31], s61 offen lds
buffer_load_dwordx4 v27, s[28:31], s61 offen offset:1024 lds
s_add_u32 s49, s76, 4
s_and_b32 s49, s49, 15
s_mul_i32 s49, s49, 393216
buffer_load_dwordx4 v[40:43], v36, s[28:31], s49 offen
s_mov_b32 s64, 0
s_mov_b32 s65, 0
h2_loop:
s_waitcnt vmcnt(11)
s_barrier
s_add_u32 s69, s69, 1
s_and_b32 s69, s69, 15
s_mul_i32 s67, s69, 2048
s_mul_i32 s68, s69, 393216
s_add_u32 m0, s70, s65
s_nop 0
buffer_load_dwordx4 v20, s[32:35], s67 offen offset:0 sc1 lds
buffer_load_dwordx4 v21, s[32:35], s67 offen offset:1024 sc1 lds
buffer_load_dwordx4 v22, s[32:35], s67 offen offset:2048 sc1 lds
buffer_load_dwordx4 v23, s[32:35], s67 offen offset:3072 sc1 lds
s_add_u32 s60, s71, s65
s_add_u32 m0, s60, 0
s_add_u32 s61, s68, 0
buffer_load_dwordx4 v26, s[28:31], s61 offen lds
buffer_load_dwordx4 v27, s[28:31], s61 offen offset:1024 lds
s_add_u32 m0, s60, 8192
s_add_u32 s61, s68, 2048
buffer_load_dwordx4 v26, s[28:31], s61 offen lds
buffer_load_dwordx4 v27, s[28:31], s61 offen offset:1024 lds
s_add_u32 m0, s60, 16384
s_add_u32 s61, s68, 4096
buffer_load_dwordx4 v26, s[28:31], s61 offen lds
buffer_load_dwordx4 v27, s[28:31], s61 offen offset:1024 lds
s_add_u32 s48, s64, 5
s_min_u32 s48, s48, 15
s_add_u32 s49, s48, s76
s_and_b32 s49, s49, 15
s_mul_i32 s49, s49, 393216
buffer_load_dwordx4 v[40:43], v36, s[28:31], s49 offen
s_add_u32 s65, s65, 40960
s_cmp_eq_u32 s65, 122880
s_cselect_b32 s65, 0, s65
s_add_u32 s64, s64, 1
s_cmp_lt_u32 s64, 11
s_cbranch_scc1 h2_loop
s_waitcnt vmcnt(11)
s_barrier
s_add_u32 s69, s69, 1
s_and_b32 s69, s69, 15
s_mul_i32 s67, s69, 2048
s_mul_i32 s68, s69, 393216
s_add_u32 m0, s70, s65
s_nop 0
buffer_load_dwordx4 v20, s[32:35], s67 offen offset:0 sc1 lds
buffer_load_dwordx4 v21, s[32:35], s67 offen offset:1024 sc1 lds
buffer_load_dwordx4 v22, s[32:35], s67 offen offset:2048 sc1 lds
buffer_load_dwordx4 v23, s[32:35], s67 offen offset:3072 sc1 lds
s_add_u32 s60, s71, s65
s_add_u32 m0, s60, 0
s_add_u32 s61, s68, 0
buffer_load_dwordx4 v26, s[28:31], s61 offen lds
buffer_load_dwordx4 v27, s[28:31], s61 offen offset:1024 lds
s_add_u32 m0, s60, 8192
s_add_u32 s61, s68, 2048
buffer_load_dwordx4 v26, s[28:31], s61 offen lds
buffer_load_dwordx4 v27, s[28:31], s61 offen offset:1024 lds
s_add_u32 m0, s60, 16384
s_add_u32 s61, s68, 4096
buffer_load_dwordx4 v26, s[28:31], s61 offen lds
buffer_load_dwordx4 v27, s[28:31], s61 offen offset:1024 lds
s_add_u32 s65, s65, 40960
s_cmp_eq_u32 s65, 122880
s_cselect_b32 s65, 0, s65
s_add_u32 s64, s64, 1
s_mov_b32 s36, s12
s_and_b32 s37, s13, 0xffff
s_mov_b32 s38, 6291456
s_mov_b32 s39, 0x00020000
s_waitcnt vmcnt(10)
s_barrier
buffer_load_dwordx4 v[80:83], v37, s[32:35], 0 offen offset:0 sc1
buffer_load_dwordx4 v[84:87], v37, s[32:35], 0 offen offset:1024 sc1
buffer_load_dwordx4 v[88:91], v37, s[32:35], 0 offen offset:2048 sc1
buffer_load_dwordx4 v[92:95], v37, s[32:35], 0 offen offset:3072 sc1
s_add_u32 s69, s47, 15
s_and_b32 s69, s69, 15
s_mul_i32 s67, s69, 2048
s_mul_i32 s68, s69, 393216
s_add_u32 m0, s70, 0
s_nop 0
buffer_load_dwordx4 v20, s[32:35], s67 offen offset:0 sc1 lds
buffer_load_dwordx4 v21, s[32:35], s67 offen offset:1024 sc1 lds
buffer_load_dwordx4 v22, s[32:35], s67 offen offset:2048 sc1 lds
buffer_load_dwordx4 v23, s[32:35], s67 offen offset:3072 sc1 lds
s_add_u32 s60, s71, 0
s_add_u32 m0, s60, 0
s_add_u32 s61, s68, 0
buffer_load_dwordx4 v26, s[28:31], s61 offen lds
buffer_load_dwordx4 v27, s[28:31], s61 offen offset:1024 lds
s_waitcnt vmcnt(10)
s_barrier
s_setprio 2
s_add_u32 m0, s60, 8192
s_add_u32 s61, s68, 2048
buffer_load_dwordx4 v26, s[28:31], s61 offen lds
buffer_load_dwordx4 v27, s[28:31], s61 offen offset:1024 lds
s_waitcnt vmcnt(8)
s_add_u32 m0, s60, 16384
s_add_u32 s61, s68, 4096
buffer_load_dwordx4 v26, s[28:31], s61 offen lds
v_add_f32 v80, v80, v88
v_add_f32 v81, v81, v89
buffer_load_dwordx4 v27, s[28:31], s61 offen offset:1024 lds
v_add_f32 v82, v82, v90
v_add_f32 v83, v83, v91
global_load_dword v48, v54, s[98:99]
v_add_f32 v84, v84, v92
s_add_u32 s69, s47, 0
s_and_b32 s69, s69, 15
s_mul_i32 s67, s69, 2048
s_mul_i32 s68, s69, 393216
s_add_u32 s60, s71, 122880
s_add_u32 m0, s60, 0
s_add_u32 s61, s68, 0
buffer_load_dwordx4 v26, s[36:39], s61 offen lds
v_add_f32 v85, v85, v93
v_add_f32 v86, v86, v94
buffer_load_dwordx4 v27, s[36:39], s61 offen offset:1024 lds
v_add_f32 v87, v87, v95
s_add_u32 m0, s60, 8192
s_add_u32 s61, s68, 2048
buffer_load_dwordx4 v26, s[36:39], s61 offen lds
v_add_f32 v80, v80, v84
v_add_f32 v81, v81, v85
buffer_load_dwordx4 v27, s[36:39], s61 offen offset:1024 lds
v_add_f32 v82, v82, v86
s_add_u32 m0, s60, 16384
s_add_u32 s61, s68, 4096
buffer_load_dwordx4 v26, s[36:39], s61 offen lds
v_add_f32 v83, v83, v87
s_nop 1
buffer_load_dwordx4 v27, s[36:39], s61 offen offset:1024 lds
v_permlane32_swap_b32 v80, v81
s_waitcnt vmcnt(7)
s_barrier
buffer_load_dwordx4 v[96:99], v18, s[32:35], s81 offen offset:0 sc1
v_permlane32_swap_b32 v82, v83
v_add_f32 v80, v80, v81
v_add_f32 v82, v82, v83
s_nop 1
v_permlane16_swap_b32 v80, v82
s_nop 0
buffer_load_dwordx4 v[100:103], v18, s[32:35], s81 offen offset:1024 sc1
v_add_f32 v80, v80, v82
v_cmp_u_f32 vcc, v80, v80
s_cbranch_vccnz again_30
summed_31:
v_mul_f32 v44, 0x3a800000, v80
v_mov_b32 v45, v44
buffer_load_dwordx4 v[104:107], v18, s[32:35], s82 offen offset:0 sc1
s_nop 1
v_permlane16_swap_b32 v44, v45
s_nop 0
v_fma_f32 v45, -v44, v44, v45
v_max_f32 v45, 0, v45
v_add_f32 v45, 0x3727c5ac, v45
buffer_load_dwordx4 v[108:111], v18, s[32:35], s82 offen offset:1024 sc1
v_rsq_f32 v46, v45
v_sub_f32 v47, 0, v44
ds_write_b32 v50, v47 offset:512
ds_write_b64 v49, v[46:47]
ds_write_b32 v50, v46
s_setprio 0
s_waitcnt lgkmcnt(0)
s_waitcnt vmcnt(63)
s_barrier
ds_write_b128 v51, v[112:115] offset:0
ds_write_b128 v51, v[116:119] offset:1024
ds_write_b128 v51, v[120:123] offset:8192
ds_write_b128 v51, v[124:127] offset:9216
ds_write_b128 v51, v[128:131] offset:16384
ds_write_b128 v51, v[132:135] offset:17408
ds_write_b128 v51, v[136:139] offset:24576
ds_write_b128 v51, v[140:143] offset:25600
ds_write_b128 v51, v[144:147] offset:32768
ds_write_b128 v51, v[148:151] offset:33792
ds_write_b128 v51, v[152:155] offset:40960
ds_write_b128 v51, v[156:159] offset:41984
ds_write_b128 v51, v[160:163] offset:49152
ds_write_b128 v51, v[164:167] offset:50176
ds_write_b128 v51, v[168:171] offset:57344
ds_write_b128 v51, v[172:175] offset:58368
ds_write_b128 v52, v[176:179] offset:0
ds_write_b128 v52, v[180:183] offset:1024
ds_write_b128 v52, v[184:187] offset:8192
ds_write_b128 v52, v[188:191] offset:9216
ds_write_b128 v52, v[192:195] offset:16384
ds_write_b128 v52, v[196:199] offset:17408
ds_write_b128 v52, v[200:203] offset:24576
ds_write_b128 v52, v[204:207] offset:25600
ds_write_b128 v52, v[208:211] offset:32768
ds_write_b128 v52, v[212:215] offset:33792
ds_write_b128 v52, v[216:219] offset:40960
ds_write_b128 v52, v[220:223] offset:41984
ds_write_b128 v52, v[224:227] offset:49152
ds_write_b128 v52, v[228:231] offset:50176
ds_write_b128 v52, v[232:235] offset:57344
ds_write_b128 v52, v[236:239] offset:58368
s_mov_b32 s28, s12
s_and_b32 s29, s13, 0xffff
s_mov_b32 s30, 6291456
s_mov_b32 s31, 0x00020000
s_add_u32 s69, s47, 0
s_and_b32 s69, s69, 15
s_mul_i32 s67, s69, 2048
s_mul_i32 s68, s69, 393216
s_waitcnt vmcnt(0) lgkmcnt(0)
s_barrier
s_mov_b32 s36, s14
s_and_b32 s37, s15, 0xffff
s_mov_b32 s38, 65536
s_mov_b32 s39, 0x00020000
s_lshl_b32 s48, s42, 12
s_lshl_b32 s49, s43, 10
s_add_u32 s48, s48, s49
s_add_u32 m0, s49, 135168
s_nop 0
buffer_load_dwordx4 v18, s[36:39], s48 offen lds
v_add_u32 v37, 262144, v37
s_getpc_b64 s[98:99]
pc_33:
s_add_u32 s98, s98, c3_last - pc_33
s_addc_u32 s99, s99, 0
s_lshr_b32 s50, s2, 3
s_lshl_b32 s50, s50, 2
s_add_u32 s50, s50, s43
s_lshl_b32 s50, s50, 7
v_and_b32 v4, 1, v0
v_lshl_add_u32 v4, v4, 6, s50
v_min_u32 v54, L_code_end - c3_last, v4
s_waitcnt vmcnt(0) lgkmcnt(0)
s_add_u32 s69, s47, 1
s_and_b32 s69, s69, 15
s_mul_i32 s67, s69, 2048
s_mul_i32 s68, s69, 393216
s_barrier
s_add_u32 s60, s71, 40960
s_add_u32 m0, s60, 0
s_add_u32 s61, s68, 0
buffer_load_dwordx4 v26, s[28:31], s61 offen lds
buffer_load_dwordx4 v27, s[28:31], s61 offen offset:1024 lds
s_add_u32 m0, s60, 8192
s_add_u32 s61, s68, 2048
buffer_load_dwordx4 v26, s[28:31], s61 offen lds
buffer_load_dwordx4 v27, s[28:31], s61 offen offset:1024 lds
s_add_u32 m0, s60, 16384
s_add_u32 s61, s68, 4096
buffer_load_dwordx4 v26, s[28:31], s61 offen lds
buffer_load_dwordx4 v27, s[28:31], s61 offen offset:1024 lds
s_add_u32 s49, s76, 2
s_and_b32 s49, s49, 15
s_mul_i32 s49, s49, 393216
buffer_load_dwordx4 v[40:43], v36, s[28:31], s49 offen
s_add_u32 s49, s76, 3
s_and_b32 s49, s49, 15
s_mul_i32 s49, s49, 393216
buffer_load_dwordx4 v[40:43], v36, s[28:31], s49 offen
buffer_load_dword v5, v30, s[32:35], s79 offen sc1
s_mov_b32 s63, 0
s_waitcnt vmcnt(0)
poll_34:
v_cmp_gt_u32 vcc, 3, v5
s_cbranch_vccz polled_35
buffer_load_dword v5, v30, s[32:35], s79 offen sc1
s_add_u32 s63, s63, 1
s_cmp_lt_u32 s63, 0x80000
s_waitcnt vmcnt(0)
s_cbranch_scc1 poll_34
polled_35:
s_add_u32 s69, s47, 0
s_and_b32 s69, s69, 15
s_mul_i32 s67, s69, 2048
s_mul_i32 s68, s69, 393216
s_add_u32 m0, s70, 0
s_nop 0
buffer_load_dwordx4 v20, s[32:35], s67 offen offset:0 sc1 lds
buffer_load_dwordx4 v21, s[32:35], s67 offen offset:1024 sc1 lds
buffer_load_dwordx4 v22, s[32:35], s67 offen offset:2048 sc1 lds
buffer_load_dwordx4 v23, s[32:35], s67 offen offset:3072 sc1 lds
s_add_u32 s69, s47, 1
s_and_b32 s69, s69, 15
s_mul_i32 s67, s69, 2048
s_mul_i32 s68, s69, 393216
s_add_u32 m0, s70, 40960
s_nop 0
buffer_load_dwordx4 v20, s[32:35], s67 offen offset:0 sc1 lds
buffer_load_dwordx4 v21, s[32:35], s67 offen offset:1024 sc1 lds
buffer_load_dwordx4 v22, s[32:35], s67 offen offset:2048 sc1 lds
buffer_load_dwordx4 v23, s[32:35], s67 offen offset:3072 sc1 lds
s_waitcnt vmcnt(4)
s_barrier
s_add_u32 s69, s47, 2
s_and_b32 s69, s69, 15
s_mul_i32 s67, s69, 2048
s_mul_i32 s68, s69, 393216
s_add_u32 m0, s70, 81920
s_nop 0
buffer_load_dwordx4 v20, s[32:35], s67 offen offset:0 sc1 lds
buffer_load_dwordx4 v21, s[32:35], s67 offen offset:1024 sc1 lds
buffer_load_dwordx4 v22, s[32:35], s67 offen offset:2048 sc1 lds
buffer_load_dwordx4 v23, s[32:35], s67 offen offset:3072 sc1 lds
s_add_u32 s60, s71, 81920
s_add_u32 m0, s60, 0
s_add_u32 s61, s68, 0
buffer_load_dwordx4 v26, s[28:31], s61 offen lds
buffer_load_dwordx4 v27, s[28:31], s61 offen offset:1024 lds
s_add_u32 m0, s60, 8192
s_add_u32 s61, s68, 2048
buffer_load_dwordx4 v26, s[28:31], s61 offen lds
buffer_load_dwordx4 v27, s[28:31], s61 offen offset:1024 lds
s_add_u32 m0, s60, 16384
s_add_u32 s61, s68, 4096
buffer_load_dwordx4 v26, s[28:31], s61 offen lds
buffer_load_dwordx4 v27, s[28:31], s61 offen offset:1024 lds
s_add_u32 s49, s76, 4
s_and_b32 s49, s49, 15
s_mul_i32 s49, s49, 393216
buffer_load_dwordx4 v[40:43], v36, s[28:31], s49 offen
s_mov_b32 s64, 0
s_mov_b32 s65, 0
h3_loop:
s_waitcnt vmcnt(11)
s_barrier
s_add_u32 s69, s69, 1
s_and_b32 s69, s69, 15
s_mul_i32 s67, s69, 2048
s_mul_i32 s68, s69, 393216
s_add_u32 m0, s70, s65
s_nop 0
buffer_load_dwordx4 v20, s[32:35], s67 offen offset:0 sc1 lds
buffer_load_dwordx4 v21, s[32:35], s67 offen offset:1024 sc1 lds
buffer_load_dwordx4 v22, s[32:35], s67 offen offset:2048 sc1 lds
buffer_load_dwordx4 v23, s[32:35], s67 offen offset:3072 sc1 lds
s_add_u32 s60, s71, s65
s_add_u32 m0, s60, 0
s_add_u32 s61, s68, 0
buffer_load_dwordx4 v26, s[28:31], s61 offen lds
buffer_load_dwordx4 v27, s[28:31], s61 offen offset:1024 lds
s_add_u32 m0, s60, 8192
s_add_u32 s61, s68, 2048
buffer_load_dwordx4 v26, s[28:31], s61 offen lds
buffer_load_dwordx4 v27, s[28:31], s61 offen offset:1024 lds
s_add_u32 m0, s60, 16384
s_add_u32 s61, s68, 4096
buffer_load_dwordx4 v26, s[28:31], s61 offen lds
buffer_load_dwordx4 v27, s[28:31], s61 offen offset:1024 lds
s_add_u32 s48, s64, 5
s_min_u32 s48, s48, 15
s_add_u32 s49, s48, s76
s_and_b32 s49, s49, 15
s_mul_i32 s49, s49, 393216
buffer_load_dwordx4 v[40:43], v36, s[28:31], s49 offen
s_add_u32 s65, s65, 40960
s_cmp_eq_u32 s65, 122880
s_cselect_b32 s65, 0, s65
s_add_u32 s64, s64, 1
s_cmp_lt_u32 s64, 11
s_cbranch_scc1 h3_loop
s_waitcnt vmcnt(11)
s_barrier
s_add_u32 s69, s69, 1
s_and_b32 s69, s69, 15
s_mul_i32 s67, s69, 2048
s_mul_i32 s68, s69, 393216
s_add_u32 m0, s70, s65
s_nop 0
buffer_load_dwordx4 v20, s[32:35], s67 offen offset:0 sc1 lds
buffer_load_dwordx4 v21, s[32:35], s67 offen offset:1024 sc1 lds
buffer_load_dwordx4 v22, s[32:35], s67 offen offset:2048 sc1 lds
buffer_load_dwordx4 v23, s[32:35], s67 offen offset:3072 sc1 lds
s_add_u32 s60, s71, s65
s_add_u32 m0, s60, 0
s_add_u32 s61, s68, 0
buffer_load_dwordx4 v26, s[28:31], s61 offen lds
buffer_load_dwordx4 v27, s[28:31], s61 offen offset:1024 lds
s_add_u32 m0, s60, 8192
s_add_u32 s61, s68, 2048
buffer_load_dwordx4 v26, s[28:31], s61 offen lds
buffer_load_dwordx4 v27, s[28:31], s61 offen offset:1024 lds
s_add_u32 m0, s60, 16384
s_add_u32 s61, s68, 4096
buffer_load_dwordx4 v26, s[28:31], s61 offen lds
buffer_load_dwordx4 v27, s[28:31], s61 offen offset:1024 lds
s_add_u32 s65, s65, 40960
s_cmp_eq_u32 s65, 122880
s_cselect_b32 s65, 0, s65
s_add_u32 s64, s64, 1
s_mov_b32 s36, s16
s_and_b32 s37, s17, 0xffff
s_mov_b32 s38, 2097152
s_mov_b32 s39, 0x00020000
s_waitcnt vmcnt(10)
s_barrier
buffer_load_dwordx4 v[80:83], v37, s[32:35], 0 offen offset:0 sc1
buffer_load_dwordx4 v[84:87], v37, s[32:35], 0 offen offset:1024 sc1
buffer_load_dwordx4 v[88:91], v37, s[32:35], 0 offen offset:2048 sc1
buffer_load_dwordx4 v[92:95], v37, s[32:35], 0 offen offset:3072 sc1
s_add_u32 s69, s47, 15
s_and_b32 s69, s69, 15
s_mul_i32 s67, s69, 2048
s_mul_i32 s68, s69, 393216
s_add_u32 m0, s70, 0
s_nop 0
buffer_load_dwordx4 v20, s[32:35], s67 offen offset:0 sc1 lds
buffer_load_dwordx4 v21, s[32:35], s67 offen offset:1024 sc1 lds
buffer_load_dwordx4 v22, s[32:35], s67 offen offset:2048 sc1 lds
buffer_load_dwordx4 v23, s[32:35], s67 offen offset:3072 sc1 lds
s_add_u32 s60, s71, 0
s_add_u32 m0, s60, 0
s_add_u32 s61, s68, 0
buffer_load_dwordx4 v26, s[28:31], s61 offen lds
buffer_load_dwordx4 v27, s[28:31], s61 offen offset:1024 lds
s_waitcnt vmcnt(10)
s_barrier
s_setprio 2
s_add_u32 m0, s60, 8192
s_add_u32 s61, s68, 2048
buffer_load_dwordx4 v26, s[28:31], s61 offen lds
buffer_load_dwordx4 v27, s[28:31], s61 offen offset:1024 lds
s_waitcnt vmcnt(8)
s_add_u32 m0, s60, 16384
s_add_u32 s61, s68, 4096
buffer_load_dwordx4 v26, s[28:31], s61 offen lds
v_add_f32 v80, v80, v88
v_add_f32 v81, v81, v89
buffer_load_dwordx4 v27, s[28:31], s61 offen offset:1024 lds
v_add_f32 v82, v82, v90
v_add_f32 v83, v83, v91
global_load_dword v48, v54, s[98:99]
v_add_f32 v84, v84, v92
s_add_u32 s48, s75, 15
s_and_b32 s48, s48, 15
s_lshl_b32 s48, s48, 17
s_add_u32 m0, s71, 106496
s_nop 0
buffer_load_dwordx4 v28, s[36:39], s48 offen lds
v_add_f32 v85, v85, v93
v_add_f32 v86, v86, v94
buffer_load_dwordx4 v29, s[36:39], s48 offen offset:1024 lds
v_add_f32 v87, v87, v95
s_add_u32 s48, s75, 5
s_and_b32 s48, s48, 15
s_lshl_b32 s48, s48, 17
s_add_u32 m0, s71, 24576
s_nop 0
buffer_load_dwordx4 v28, s[36:39], s48 offen lds
v_add_f32 v80, v80, v84
v_add_f32 v81, v81, v85
buffer_load_dwordx4 v29, s[36:39], s48 offen offset:1024 lds
v_add_f32 v82, v82, v86
s_add_u32 s48, s75, 6
s_and_b32 s48, s48, 15
s_lshl_b32 s48, s48, 17
s_add_u32 m0, s71, 32768
s_nop 0
buffer_load_dwordx4 v28, s[36:39], s48 offen lds
v_add_f32 v83, v83, v87
s_nop 1
buffer_load_dwordx4 v29, s[36:39], s48 offen offset:1024 lds
v_permlane32_swap_b32 v80, v81
s_waitcnt vmcnt(7)
s_barrier
s_add_u32 s48, s75, 7
s_and_b32 s48, s48, 15
s_lshl_b32 s48, s48, 17
s_add_u32 m0, s71, 40960
s_nop 0
buffer_load_dwordx4 v28, s[36:39], s48 offen lds
v_permlane32_swap_b32 v82, v83
v_add_f32 v80, v80, v81
v_add_f32 v82, v82, v83
buffer_load_dwordx4 v29, s[36:39], s48 offen offset:1024 lds
s_nop 1
v_permlane16_swap_b32 v80, v82
s_nop 0
s_add_u32 s48, s75, 8
s_and_b32 s48, s48, 15
s_lshl_b32 s48, s48, 17
s_add_u32 m0, s71, 49152
s_nop 0
buffer_load_dwordx4 v28, s[36:39], s48 offen lds
v_add_f32 v80, v80, v82
v_cmp_u_f32 vcc, v80, v80
s_cbranch_vccnz again_36
summed_37:
buffer_load_dwordx4 v29, s[36:39], s48 offen offset:1024 lds
v_mul_f32 v44, 0x3a800000, v80
v_mov_b32 v45, v44
s_add_u32 s48, s75, 9
s_and_b32 s48, s48, 15
s_lshl_b32 s48, s48, 17
s_add_u32 m0, s71, 57344
s_nop 0
buffer_load_dwordx4 v28, s[36:39], s48 offen lds
s_nop 1
v_permlane16_swap_b32 v44, v45
s_nop 0
buffer_load_dwordx4 v29, s[36:39], s48 offen offset:1024 lds
v_fma_f32 v45, -v44, v44, v45
v_max_f32 v45, 0, v45
v_add_f32 v45, 0x3727c5ac, v45
s_add_u32 s48, s75, 10
s_and_b32 s48, s48, 15
s_lshl_b32 s48, s48, 17
s_add_u32 m0, s71, 65536
s_nop 0
buffer_load_dwordx4 v28, s[36:39], s48 offen lds
v_rsq_f32 v46, v45
v_sub_f32 v47, 0, v44
ds_write_b32 v50, v47 offset:512
buffer_load_dwordx4 v29, s[36:39], s48 offen offset:1024 lds
ds_write_b64 v49, v[46:47]
ds_write_b32 v50, v46
s_setprio 0
s_waitcnt lgkmcnt(0)
s_waitcnt vmcnt(63)
s_barrier
s_add_u32 s48, s75, 11
s_and_b32 s48, s48, 15
s_lshl_b32 s48, s48, 17
s_add_u32 m0, s71, 73728
s_waitcnt vmcnt(4)
buffer_load_dwordx4 v28, s[36:39], s48 offen lds
buffer_load_dwordx4 v29, s[36:39], s48 offen offset:1024 lds
s_add_u32 s48, s75, 12
s_and_b32 s48, s48, 15
s_lshl_b32 s48, s48, 17
s_add_u32 m0, s71, 81920
s_waitcnt vmcnt(4)
buffer_load_dwordx4 v28, s[36:39], s48 offen lds
buffer_load_dwordx4 v29, s[36:39], s48 offen offset:1024 lds
s_add_u32 s48, s75, 13
s_and_b32 s48, s48, 15
s_lshl_b32 s48, s48, 17
s_add_u32 m0, s71, 90112
s_waitcnt vmcnt(4)
buffer_load_dwordx4 v28, s[36:39], s48 offen lds
buffer_load_dwordx4 v29, s[36:39], s48 offen offset:1024 lds
s_add_u32 s48, s75, 14
s_and_b32 s48, s48, 15
s_lshl_b32 s48, s48, 17
s_add_u32 m0, s71, 98304
s_waitcnt vmcnt(4)
buffer_load_dwordx4 v28, s[36:39], s48 offen lds
buffer_load_dwordx4 v29, s[36:39], s48 offen offset:1024 lds
s_add_u32 s48, s75, 0
s_and_b32 s48, s48, 15
s_lshl_b32 s48, s48, 17
s_add_u32 m0, s71, 4294950912
s_waitcnt vmcnt(4)
buffer_load_dwordx4 v28, s[36:39], s48 offen lds
buffer_load_dwordx4 v29, s[36:39], s48 offen offset:1024 lds
s_add_u32 s48, s75, 1
s_and_b32 s48, s48, 15
s_lshl_b32 s48, s48, 17
s_add_u32 m0, s71, 4294959104
s_waitcnt vmcnt(4)
buffer_load_dwordx4 v28, s[36:39], s48 offen lds
buffer_load_dwordx4 v29, s[36:39], s48 offen offset:1024 lds
s_add_u32 s48, s75, 2
s_and_b32 s48, s48, 15
s_lshl_b32 s48, s48, 17
s_add_u32 m0, s71, 0
s_waitcnt vmcnt(4)
buffer_load_dwordx4 v28, s[36:39], s48 offen lds
buffer_load_dwordx4 v29, s[36:39], s48 offen offset:1024 lds
s_add_u32 s48, s75, 3
s_and_b32 s48, s48, 15
s_lshl_b32 s48, s48, 17
s_add_u32 m0, s71, 8192
s_waitcnt vmcnt(4)
buffer_load_dwordx4 v28, s[36:39], s48 offen lds
buffer_load_dwordx4 v29, s[36:39], s48 offen offset:1024 lds
s_add_u32 s48, s75, 4
s_and_b32 s48, s48, 15
s_lshl_b32 s48, s48, 17
s_add_u32 m0, s71, 16384
s_waitcnt vmcnt(4)
buffer_load_dwordx4 v28, s[36:39], s48 offen lds
buffer_load_dwordx4 v29, s[36:39], s48 offen offset:1024 lds
buffer_load_dwordx4 v[96:99], v18, s[32:35], s81 offen offset:0 sc1
buffer_load_dwordx4 v[100:103], v18, s[32:35], s81 offen offset:1024 sc1
buffer_load_dwordx4 v[104:107], v18, s[32:35], s82 offen offset:0 sc1
buffer_load_dwordx4 v[108:111], v18, s[32:35], s82 offen offset:1024 sc1
s_waitcnt vmcnt(0) lgkmcnt(0)
s_barrier
L_end:
s_endpgm
L_compute:
s_waitcnt lgkmcnt(0)
s_mov_b32 s32, s22
s_and_b32 s33, s23, 0xffff
s_mov_b32 s34, 268435456
s_mov_b32 s35, 0x00020000
s_setprio 1
s_and_b32 s43, s40, 1
s_lshr_b32 s44, s40, 1
s_lshl_b32 s45, s42, 1
s_add_u32 s45, s45, s43
s_cmp_lg_u32 s40, 1
s_cbranch_scc1 else_39
s_getpc_b64 s[48:49]
L_pc:
s_sub_u32 s48, s48, L_pc - interleave_layers__sliding_local_dilated__linear_kernel_hedgehog__prompt_kernel
s_subb_u32 s49, s49, 0
s_lshr_b32 s50, s2, 3
s_lshl_b32 s50, s50, 12
v_lshl_add_u32 v8, v0, 6, s50
v_cmp_gt_u32 vcc, L_code_end - interleave_layers__sliding_local_dilated__linear_kernel_hedgehog__prompt_kernel, v8
s_and_saveexec_b64 s[50:51], vcc
s_cbranch_execz nopf_41
global_load_dword v254, v8, s[48:49]
nopf_41:
s_mov_b64 exec, -1
else_39:
s_lshl_b32 s48, s41, 3
s_lshl_b32 s49, s44, 2
s_add_u32 s48, s48, s49
s_lshl_b32 s48, s48, 5
s_add_u32 s48, s48, s45
s_lshl_b32 s48, s48, 10
s_add_u32 s80, s48, 4194304
s_add_u32 s81, s80, 32768
s_add_u32 s82, s80, 65536
s_add_u32 s83, s80, 98304
s_lshl_b32 s84, s41, 2
s_add_u32 s84, s84, s44
s_lshl_b32 s84, s84, 7
s_add_u32 s84, s84, 18350080
s_lshl_b32 s48, s41, 3
s_lshl_b32 s49, s40, 1
s_add_u32 s48, s48, s49
s_lshl_b32 s48, s48, 15
s_lshl_b32 s49, s78, 11
s_add_u32 s85, s48, s49
s_add_u32 s86, s85, 32768
s_lshl_b32 s50, s41, 2
s_add_u32 s50, s50, s40
s_lshl_b32 s50, s50, 4
s_add_u32 s50, s50, s42
s_lshl_b32 s50, s50, 8
s_add_u32 s87, s50, 16777216
s_lshl_b32 s88, s41, 2
s_add_u32 s88, s88, s40
s_lshl_b32 s88, s88, 7
s_add_u32 s88, s88, 18358272
v_lshrrev_b32 v4, 1, v3
v_lshl_add_u32 v4, v2, 2, v4
v_and_b32 v5, 1, v3
v_lshl_add_u32 v4, v5, 1, v4
v_lshlrev_b32 v1, 2, v4
s_lshl_b32 s48, s40, 2
s_add_u32 s48, s48, 134672
v_mov_b32 v10, s48
v_mov_b32 v11, 0
ds_write_b32 v10, v11
s_lshl_b32 s49, s44, 13
v_lshrrev_b32 v4, 1, v2
v_xor_b32 v4, v4, v3
v_lshlrev_b32 v4, 4, v4
v_lshl_add_u32 v10, v2, 7, v4
v_add_u32 v10, s49, v10
v_xor_b32 v11, 64, v10
s_lshl_b32 s48, s43, 1
v_lshrrev_b32 v4, 2, v2
v_and_b32 v5, 3, v0
v_lshl_add_u32 v6, v3, 3, v4
v_lshlrev_b32 v6, 7, v6
v_lshl_add_u32 v6, v5, 3, v6
v_lshrrev_b32 v7, 1, v4
v_and_b32 v8, 1, v3
v_lshl_add_u32 v7, v8, 1, v7
v_xor_b32 v7, s48, v7
v_lshl_add_u32 v12, v7, 5, v6
v_add_u32 v12, 16384, v12
v_xor_b32 v13, 32, v12
v_mov_b32 v14, v10
v_mov_b32 v15, v11
v_add_u32 v16, 0, v12
v_add_u32 v17, 0, v13
v_mov_b32 v156, 0
v_mov_b32 v157, 0
v_mov_b32 v158, 0
v_mov_b32 v159, 0
v_mov_b32 v160, 0
v_mov_b32 v161, 0
v_mov_b32 v162, 0
v_mov_b32 v163, 0
v_mov_b32 v164, 0
v_mov_b32 v165, 0
v_mov_b32 v166, 0
v_mov_b32 v167, 0
v_mov_b32 v168, 0
v_mov_b32 v169, 0
v_mov_b32 v170, 0
v_mov_b32 v171, 0
v_mov_b32 v172, 0
v_mov_b32 v173, 0
v_mov_b32 v174, 0
v_mov_b32 v175, 0
v_mov_b32 v176, 0
v_mov_b32 v177, 0
v_mov_b32 v178, 0
v_mov_b32 v179, 0
v_mov_b32 v180, 0
v_mov_b32 v181, 0
v_mov_b32 v182, 0
v_mov_b32 v183, 0
v_mov_b32 v184, 0
v_mov_b32 v185, 0
v_mov_b32 v186, 0
v_mov_b32 v187, 0
v_mov_b32 v188, 0
v_mov_b32 v189, 0
v_mov_b32 v190, 0
v_mov_b32 v191, 0
v_mov_b32 v192, 0
v_mov_b32 v193, 0
v_mov_b32 v194, 0
v_mov_b32 v195, 0
v_mov_b32 v196, 0
v_mov_b32 v197, 0
v_mov_b32 v198, 0
v_mov_b32 v199, 0
v_mov_b32 v200, 0
v_mov_b32 v201, 0
v_mov_b32 v202, 0
v_mov_b32 v203, 0
v_mov_b32 v204, 0
v_mov_b32 v205, 0
v_mov_b32 v206, 0
v_mov_b32 v207, 0
v_mov_b32 v208, 0
v_mov_b32 v209, 0
v_mov_b32 v210, 0
v_mov_b32 v211, 0
v_mov_b32 v212, 0
v_mov_b32 v213, 0
v_mov_b32 v214, 0
v_mov_b32 v215, 0
v_mov_b32 v216, 0
v_mov_b32 v217, 0
v_mov_b32 v218, 0
v_mov_b32 v219, 0
v_mov_b32 v220, 0
v_mov_b32 v221, 0
v_mov_b32 v222, 0
v_mov_b32 v223, 0
v_mov_b32 v224, 0
v_mov_b32 v225, 0
v_mov_b32 v226, 0
v_mov_b32 v227, 0
v_mov_b32 v228, 0
v_mov_b32 v229, 0
v_mov_b32 v230, 0
v_mov_b32 v231, 0
v_mov_b32 v232, 0
v_mov_b32 v233, 0
v_mov_b32 v234, 0
v_mov_b32 v235, 0
v_mov_b32 v236, 0
v_mov_b32 v237, 0
v_mov_b32 v238, 0
v_mov_b32 v239, 0
v_mov_b32 v240, 0
v_mov_b32 v241, 0
v_mov_b32 v242, 0
v_mov_b32 v243, 0
v_mov_b32 v244, 0
v_mov_b32 v245, 0
v_mov_b32 v246, 0
v_mov_b32 v247, 0
v_mov_b32 v248, 0
v_mov_b32 v249, 0
v_mov_b32 v250, 0
v_mov_b32 v251, 0
v_mov_b32 v48, 0x3f803f80
v_mov_b32 v49, 0x3f803f80
v_mov_b32 v50, 0x3f803f80
v_mov_b32 v51, 0x3f803f80
s_mov_b32 s48, 0xf149f2ca
v_mov_b32 v9, s48
v_lshlrev_b32 v4, 2, v3
v_sub_u32 v4, v2, v4
v_subrev_u32 v5, 0, v4
v_and_b32 v6, 0x80000001, v5
v_cmp_eq_u32 vcc, 0, v6
v_add_u32 v5, 1, v5
v_and_b32 v6, 0x80000001, v5
v_cndmask_b32 v40, v9, 0, vcc
v_cmp_eq_u32 vcc, 0x80000001, v6
s_nop 1
v_cndmask_b32 v36, v9, 0, vcc
v_subrev_u32 v5, 1, v4
v_and_b32 v6, 0x80000001, v5
v_cmp_eq_u32 vcc, 0, v6
v_add_u32 v5, 1, v5
v_and_b32 v6, 0x80000001, v5
v_cndmask_b32 v41, v9, 0, vcc
v_cmp_eq_u32 vcc, 0x80000001, v6
s_nop 1
v_cndmask_b32 v37, v9, 0, vcc
v_subrev_u32 v5, 2, v4
v_and_b32 v6, 0x80000001, v5
v_cmp_eq_u32 vcc, 0, v6
v_add_u32 v5, 1, v5
v_and_b32 v6, 0x80000001, v5
v_cndmask_b32 v42, v9, 0, vcc
v_cmp_eq_u32 vcc, 0x80000001, v6
s_nop 1
v_cndmask_b32 v38, v9, 0, vcc
v_subrev_u32 v5, 3, v4
v_and_b32 v6, 0x80000001, v5
v_cmp_eq_u32 vcc, 0, v6
v_add_u32 v5, 1, v5
v_and_b32 v6, 0x80000001, v5
v_cndmask_b32 v43, v9, 0, vcc
v_cmp_eq_u32 vcc, 0x80000001, v6
s_nop 1
v_cndmask_b32 v39, v9, 0, vcc
s_or_b32 s48, s41, s44
s_cmp_eq_u32 s48, 0
s_cselect_b64 vcc, -1, 0
v_cndmask_b32 v44, v36, v9, vcc
v_cndmask_b32 v45, v37, v9, vcc
v_cndmask_b32 v46, v38, v9, vcc
v_cndmask_b32 v47, v39, v9, vcc
v_and_b32 v4, 1, v2
v_lshlrev_b32 v4, 4, v4
v_mov_b32 v5, 0xffff
v_lshlrev_b32 v52, v4, v5
s_lshl_b32 s48, s43, 11
s_add_u32 s48, s48, 135168
v_add_u32 v53, s48, v18
v_lshl_add_u32 v55, v0, 3, s48
s_add_u32 s48, s41, s44
s_sub_u32 s48, s48, 1
s_lshl_b32 s49, s48, 1
s_add_u32 s49, s49, s43
s_lshl_b32 s49, s49, 11
s_mul_i32 s50, s42, 65536
s_add_u32 s49, s49, s50
s_add_u32 s49, s49, 8388608
s_cmp_lt_i32 s48, 0
s_cselect_b32 s49, 0xf0000000, s49
v_add_u32 v58, s49, v18
v_lshl_add_u32 v59, v0, 3, s49
s_lshl_b32 s48, s43, 2
s_add_u32 s48, s48, 134672
v_mov_b32 v19, s48
s_lshl_b32 s48, s43, 7
s_add_u32 s48, s48, 133120
v_lshl_add_u32 v7, v3, 4, s48
v_lshl_add_u32 v54, v2, 2, s48
s_lshl_b32 s49, s44, 6
v_add_u32 v8, s49, v2
v_lshlrev_b32 v8, 3, v8
v_add_u32 v8, 131072, v8
v_lshl_add_u32 v9, v3, 2, s49
v_lshlrev_b32 v9, 2, v9
v_add_u32 v9, 132096, v9
s_mov_b32 s64, 0
s_mov_b32 s65, 0
s_mov_b32 s66, 0x3e8293ee
s_lshl_b32 s50, s42, 2
s_add_u32 s50, s50, s40
s_lshl_b32 s50, s50, 4
s_add_u32 s50, s50, s41
s_lshl_b32 s50, s50, 8
s_add_u32 s52, s50, 17825792
v_lshrrev_b32 v4, 1, v2
v_lshrrev_b32 v5, 1, v3
v_xor_b32 v4, v4, v5
v_lshlrev_b32 v4, 4, v4
v_and_b32 v5, 1, v3
v_lshl_add_u32 v4, v5, 3, v4
v_lshl_add_u32 v4, v2, 7, v4
s_lshl_b32 s48, s40, 12
v_add_u32 v155, s48, v4
v_mov_b32 v152, 0
v_mov_b32 v153, 0
v_mov_b32 v56, 0
v_mov_b32 v57, 0
s_barrier
ds_read_b128 v[60:63], v14 offset:0
ds_read_b128 v[64:67], v14 offset:2048
ds_read_b128 v[68:71], v14 offset:4096
ds_read_b128 v[72:75], v14 offset:6144
ds_read_b64_tr_b16 v[84:85], v16 offset:8192
ds_read_b64_tr_b16 v[86:87], v16 offset:8704
ds_read_b64_tr_b16 v[88:89], v17 offset:8192
ds_read_b64_tr_b16 v[90:91], v17 offset:8704
ds_read_b64_tr_b16 v[92:93], v16 offset:16384
ds_read_b64_tr_b16 v[94:95], v16 offset:16896
ds_read_b64_tr_b16 v[96:97], v17 offset:16384
ds_read_b64_tr_b16 v[98:99], v17 offset:16896
ds_read_b64_tr_b16 v[76:77], v16 offset:0
ds_read_b64_tr_b16 v[78:79], v16 offset:512
ds_read_b64_tr_b16 v[80:81], v17 offset:0
ds_read_b64_tr_b16 v[82:83], v17 offset:512
s_waitcnt lgkmcnt(0)
c0_loop:
v_mfma_f32_16x16x32_bf16 v[212:215], v[84:87], v[72:75], v[212:215]
ds_read_b128 v[100:103], v15 offset:0
v_mfma_f32_16x16x32_bf16 v[204:207], v[84:87], v[68:71], v[204:207]
ds_read_b128 v[104:107], v15 offset:2048
v_mfma_f32_16x16x32_bf16 v[196:199], v[84:87], v[64:67], v[196:199]
ds_read_b128 v[108:111], v15 offset:4096
v_mfma_f32_16x16x32_bf16 v[188:191], v[84:87], v[60:63], v[188:191]
ds_read_b128 v[112:115], v15 offset:6144
v_mfma_f32_16x16x32_bf16 v[192:195], v[88:91], v[60:63], v[192:195]
ds_read_b64_tr_b16 v[124:125], v16 offset:12288
v_mfma_f32_16x16x32_bf16 v[200:203], v[88:91], v[64:67], v[200:203]
ds_read_b64_tr_b16 v[126:127], v16 offset:12800
v_mfma_f32_16x16x32_bf16 v[208:211], v[88:91], v[68:71], v[208:211]
ds_read_b64_tr_b16 v[128:129], v17 offset:12288
v_mfma_f32_16x16x32_bf16 v[216:219], v[88:91], v[72:75], v[216:219]
ds_read_b64_tr_b16 v[130:131], v17 offset:12800
v_mfma_f32_16x16x32_bf16 v[244:247], v[72:75], v[92:95], v[244:247]
ds_read_b64_tr_b16 v[132:133], v16 offset:20480
v_mfma_f32_16x16x32_bf16 v[236:239], v[68:71], v[92:95], v[236:239]
ds_read_b64_tr_b16 v[134:135], v16 offset:20992
v_mfma_f32_16x16x32_bf16 v[228:231], v[64:67], v[92:95], v[228:231]
ds_read_b64_tr_b16 v[136:137], v17 offset:20480
v_mfma_f32_16x16x32_bf16 v[220:223], v[60:63], v[92:95], v[220:223]
ds_read_b64_tr_b16 v[138:139], v17 offset:20992
v_mfma_f32_16x16x32_bf16 v[224:227], v[60:63], v[96:99], v[224:227]
ds_read_b64_tr_b16 v[116:117], v16 offset:4096
v_mfma_f32_16x16x32_bf16 v[232:235], v[64:67], v[96:99], v[232:235]
ds_read_b64_tr_b16 v[118:119], v16 offset:4608
v_mfma_f32_16x16x32_bf16 v[240:243], v[68:71], v[96:99], v[240:243]
ds_read_b64_tr_b16 v[120:121], v17 offset:4096
v_mfma_f32_16x16x32_bf16 v[248:251], v[72:75], v[96:99], v[248:251]
ds_read_b64_tr_b16 v[122:123], v17 offset:4608
v_mfma_f32_16x16x32_bf16 v[180:183], v[76:79], v[72:75], v[180:183]
s_cmp_eq_u32 s77, s64
s_cbranch_scc1 c0_hook
c0_hook_ret:
v_mfma_f32_16x16x32_bf16 v[172:175], v[76:79], v[68:71], v[172:175]
s_add_u32 s65, s65, 40960
s_cmp_eq_u32 s65, 122880
v_mfma_f32_16x16x32_bf16 v[164:167], v[76:79], v[64:67], v[164:167]
s_cselect_b32 s65, 0, s65
s_add_u32 s64, s64, 1
v_mfma_f32_16x16x32_bf16 v[156:159], v[76:79], v[60:63], v[156:159]
v_add_u32 v14, s65, v10
v_add_u32 v15, s65, v11
v_mfma_f32_16x16x32_bf16 v[160:163], v[80:83], v[60:63], v[160:163]
v_add_u32 v16, s65, v12
v_add_u32 v17, s65, v13
v_mfma_f32_16x16x32_bf16 v[168:171], v[80:83], v[64:67], v[168:171]
s_cmp_eq_u32 s64, 16
s_cbranch_scc1 c0_last
v_mfma_f32_16x16x32_bf16 v[176:179], v[80:83], v[68:71], v[176:179]
s_waitcnt lgkmcnt(0)
v_mfma_f32_16x16x32_bf16 v[184:187], v[80:83], v[72:75], v[184:187]
s_barrier
v_mfma_f32_16x16x32_bf16 v[212:215], v[124:127], v[112:115], v[212:215]
ds_read_b128 v[60:63], v14 offset:0
v_mfma_f32_16x16x32_bf16 v[204:207], v[124:127], v[108:111], v[204:207]
ds_read_b128 v[64:67], v14 offset:2048
v_mfma_f32_16x16x32_bf16 v[196:199], v[124:127], v[104:107], v[196:199]
ds_read_b128 v[68:71], v14 offset:4096
v_mfma_f32_16x16x32_bf16 v[188:191], v[124:127], v[100:103], v[188:191]
ds_read_b128 v[72:75], v14 offset:6144
v_mfma_f32_16x16x32_bf16 v[192:195], v[128:131], v[100:103], v[192:195]
ds_read_b64_tr_b16 v[84:85], v16 offset:8192
v_mfma_f32_16x16x32_bf16 v[200:203], v[128:131], v[104:107], v[200:203]
ds_read_b64_tr_b16 v[86:87], v16 offset:8704
v_mfma_f32_16x16x32_bf16 v[208:211], v[128:131], v[108:111], v[208:211]
ds_read_b64_tr_b16 v[88:89], v17 offset:8192
v_mfma_f32_16x16x32_bf16 v[216:219], v[128:131], v[112:115], v[216:219]
ds_read_b64_tr_b16 v[90:91], v17 offset:8704
v_mfma_f32_16x16x32_bf16 v[244:247], v[112:115], v[132:135], v[244:247]
ds_read_b64_tr_b16 v[92:93], v16 offset:16384
v_mfma_f32_16x16x32_bf16 v[236:239], v[108:111], v[132:135], v[236:239]
ds_read_b64_tr_b16 v[94:95], v16 offset:16896
v_mfma_f32_16x16x32_bf16 v[228:231], v[104:107], v[132:135], v[228:231]
ds_read_b64_tr_b16 v[96:97], v17 offset:16384
v_mfma_f32_16x16x32_bf16 v[220:223], v[100:103], v[132:135], v[220:223]
ds_read_b64_tr_b16 v[98:99], v17 offset:16896
v_mfma_f32_16x16x32_bf16 v[224:227], v[100:103], v[136:139], v[224:227]
ds_read_b64_tr_b16 v[76:77], v16 offset:0
v_mfma_f32_16x16x32_bf16 v[232:235], v[104:107], v[136:139], v[232:235]
ds_read_b64_tr_b16 v[78:79], v16 offset:512
v_mfma_f32_16x16x32_bf16 v[240:243], v[108:111], v[136:139], v[240:243]
ds_read_b64_tr_b16 v[80:81], v17 offset:0
v_mfma_f32_16x16x32_bf16 v[248:251], v[112:115], v[136:139], v[248:251]
ds_read_b64_tr_b16 v[82:83], v17 offset:512
v_mfma_f32_16x16x32_bf16 v[180:183], v[116:119], v[112:115], v[180:183]
v_mfma_f32_16x16x32_bf16 v[172:175], v[116:119], v[108:111], v[172:175]
v_mfma_f32_16x16x32_bf16 v[164:167], v[116:119], v[104:107], v[164:167]
v_mfma_f32_16x16x32_bf16 v[156:159], v[116:119], v[100:103], v[156:159]
v_mfma_f32_16x16x32_bf16 v[160:163], v[120:123], v[100:103], v[160:163]
v_mfma_f32_16x16x32_bf16 v[168:171], v[120:123], v[104:107], v[168:171]
v_mfma_f32_16x16x32_bf16 v[176:179], v[120:123], v[108:111], v[176:179]
s_waitcnt lgkmcnt(0)
v_mfma_f32_16x16x32_bf16 v[184:187], v[120:123], v[112:115], v[184:187]
s_branch c0_loop
c0_hook:
v_add_u32 v4, s65, v155
ds_read_b64 v[20:21], v4 offset:0
ds_read_b64 v[28:29], v4 offset:2048
v_xor_b32 v5, 32, v4
ds_read_b64 v[22:23], v5 offset:0
ds_read_b64 v[30:31], v5 offset:2048
v_xor_b32 v5, 64, v4
ds_read_b64 v[24:25], v5 offset:0
ds_read_b64 v[32:33], v5 offset:2048
v_xor_b32 v5, 96, v4
ds_read_b64 v[26:27], v5 offset:0
ds_read_b64 v[34:35], v5 offset:2048
s_waitcnt lgkmcnt(8)
s_cmp_lg_u32 s44, 0
s_cbranch_scc1 else_42
v_mfma_f32_16x16x32_bf16 v[140:143], v[48:51], v[76:79], 0
v_mfma_f32_16x16x32_bf16 v[144:147], v[48:51], v[84:87], 0
v_mfma_f32_16x16x32_bf16 v[148:151], v[48:51], v[92:95], 0
v_mfma_f32_16x16x32_bf16 v[140:143], v[48:51], v[116:119], v[140:143]
v_mfma_f32_16x16x32_bf16 v[144:147], v[48:51], v[124:127], v[144:147]
v_mfma_f32_16x16x32_bf16 v[148:151], v[48:51], v[132:135], v[148:151]
s_branch fi_43
else_42:
v_mfma_f32_16x16x32_bf16 v[140:143], v[48:51], v[80:83], 0
v_mfma_f32_16x16x32_bf16 v[144:147], v[48:51], v[88:91], 0
v_mfma_f32_16x16x32_bf16 v[148:151], v[48:51], v[96:99], 0
v_mfma_f32_16x16x32_bf16 v[140:143], v[48:51], v[120:123], v[140:143]
v_mfma_f32_16x16x32_bf16 v[144:147], v[48:51], v[128:131], v[144:147]
v_mfma_f32_16x16x32_bf16 v[148:151], v[48:51], v[136:139], v[148:151]
fi_43:
s_waitcnt lgkmcnt(0)
v_dot2c_f32_bf16 v152, v20, v48
v_dot2c_f32_bf16 v56, v20, v20
v_dot2c_f32_bf16 v153, v28, v48
v_dot2c_f32_bf16 v57, v28, v28
v_dot2c_f32_bf16 v152, v21, v48
v_dot2c_f32_bf16 v56, v21, v21
v_dot2c_f32_bf16 v153, v29, v48
v_dot2c_f32_bf16 v57, v29, v29
v_dot2c_f32_bf16 v152, v22, v48
v_dot2c_f32_bf16 v56, v22, v22
v_dot2c_f32_bf16 v153, v30, v48
v_dot2c_f32_bf16 v57, v30, v30
v_dot2c_f32_bf16 v152, v23, v48
v_dot2c_f32_bf16 v56, v23, v23
v_dot2c_f32_bf16 v153, v31, v48
v_dot2c_f32_bf16 v57, v31, v31
v_dot2c_f32_bf16 v152, v24, v48
v_dot2c_f32_bf16 v56, v24, v24
v_dot2c_f32_bf16 v153, v32, v48
v_dot2c_f32_bf16 v57, v32, v32
v_dot2c_f32_bf16 v152, v25, v48
v_dot2c_f32_bf16 v56, v25, v25
v_dot2c_f32_bf16 v153, v33, v48
v_dot2c_f32_bf16 v57, v33, v33
v_dot2c_f32_bf16 v152, v26, v48
v_dot2c_f32_bf16 v56, v26, v26
v_dot2c_f32_bf16 v153, v34, v48
v_dot2c_f32_bf16 v57, v34, v34
v_dot2c_f32_bf16 v152, v27, v48
v_dot2c_f32_bf16 v56, v27, v27
v_dot2c_f32_bf16 v153, v35, v48
v_dot2c_f32_bf16 v57, v35, v35
v_cmp_eq_u32 vcc, 0, v3
v_cmp_eq_u32 s[48:49], 1, v3
s_nop 1
v_cndmask_b32 v4, v148, v144, s[48:49]
v_cndmask_b32 v4, v4, v140, vcc
buffer_store_dword v4, v1, s[32:35], s52 offen sc1
s_nop 1
v_permlane32_swap_b32 v152, v153
v_permlane32_swap_b32 v56, v57
v_add_f32 v152, v152, v153
v_add_f32 v56, v56, v57
s_nop 1
v_permlane16_swap_b32 v152, v56
s_nop 0
v_add_f32 v152, v152, v56
buffer_store_dword v152, v1, s[32:35], s87 offen sc1
s_branch c0_hook_ret
c0_last:
v_mfma_f32_16x16x32_bf16 v[176:179], v[80:83], v[68:71], v[176:179]
s_waitcnt lgkmcnt(0)
v_mfma_f32_16x16x32_bf16 v[184:187], v[80:83], v[72:75], v[184:187]
s_barrier
v_mfma_f32_16x16x32_bf16 v[212:215], v[124:127], v[112:115], v[212:215]
ds_read_b128 v[140:143], v7 offset:0
v_mfma_f32_16x16x32_bf16 v[204:207], v[124:127], v[108:111], v[204:207]
ds_read_b128 v[144:147], v7 offset:64
v_mfma_f32_16x16x32_bf16 v[196:199], v[124:127], v[104:107], v[196:199]
ds_read_b128 v[148:151], v7 offset:256
v_mfma_f32_16x16x32_bf16 v[188:191], v[124:127], v[100:103], v[188:191]
ds_read_b128 v[152:155], v7 offset:320
v_mfma_f32_16x16x32_bf16 v[192:195], v[128:131], v[100:103], v[192:195]
ds_read_b64 v[92:93], v8 offset:0
v_mfma_f32_16x16x32_bf16 v[200:203], v[128:131], v[104:107], v[200:203]
ds_read_b64 v[94:95], v8 offset:128
v_mfma_f32_16x16x32_bf16 v[208:211], v[128:131], v[108:111], v[208:211]
ds_read_b64 v[96:97], v8 offset:256
v_mfma_f32_16x16x32_bf16 v[216:219], v[128:131], v[112:115], v[216:219]
ds_read_b64 v[98:99], v8 offset:384
v_mfma_f32_16x16x32_bf16 v[244:247], v[112:115], v[132:135], v[244:247]
ds_read2_b32 v[56:57], v54 offset0:128 offset1:144
v_mfma_f32_16x16x32_bf16 v[236:239], v[108:111], v[132:135], v[236:239]
ds_read_b128 v[60:63], v9 offset:0
v_mfma_f32_16x16x32_bf16 v[228:231], v[104:107], v[132:135], v[228:231]
ds_read_b128 v[64:67], v9 offset:64
v_mfma_f32_16x16x32_bf16 v[220:223], v[100:103], v[132:135], v[220:223]
ds_read_b128 v[68:71], v9 offset:128
v_mfma_f32_16x16x32_bf16 v[224:227], v[100:103], v[136:139], v[224:227]
ds_read_b128 v[72:75], v9 offset:192
v_mfma_f32_16x16x32_bf16 v[232:235], v[104:107], v[136:139], v[232:235]
ds_read_b128 v[76:79], v9 offset:512
v_mfma_f32_16x16x32_bf16 v[240:243], v[108:111], v[136:139], v[240:243]
ds_read_b128 v[80:83], v9 offset:576
v_mfma_f32_16x16x32_bf16 v[248:251], v[112:115], v[136:139], v[248:251]
ds_read_b128 v[84:87], v9 offset:640
v_mfma_f32_16x16x32_bf16 v[180:183], v[116:119], v[112:115], v[180:183]
ds_read_b128 v[88:91], v9 offset:704
v_mfma_f32_16x16x32_bf16 v[172:175], v[116:119], v[108:111], v[172:175]
v_mov_b32 v6, 134656
ds_read_b32 v6, v6
v_mfma_f32_16x16x32_bf16 v[164:167], v[116:119], v[104:107], v[164:167]
v_mfma_f32_16x16x32_bf16 v[156:159], v[116:119], v[100:103], v[156:159]
v_mfma_f32_16x16x32_bf16 v[160:163], v[120:123], v[100:103], v[160:163]
v_mfma_f32_16x16x32_bf16 v[168:171], v[120:123], v[104:107], v[168:171]
v_mfma_f32_16x16x32_bf16 v[176:179], v[120:123], v[108:111], v[176:179]
v_mfma_f32_16x16x32_bf16 v[184:187], v[120:123], v[112:115], v[184:187]
c0_epi:
s_waitcnt lgkmcnt(0)
v_readfirstlane_b32 s46, v6
.p2align 3
v_pk_fma_f32 v[212:213], v[148:149], v[98:99], v[212:213] op_sel:[0,1,0] op_sel_hi:[1,1,1]
v_pk_fma_f32 v[214:215], v[150:151], v[98:99], v[214:215] op_sel:[0,1,0] op_sel_hi:[1,1,1]
v_pk_fma_f32 v[216:217], v[152:153], v[98:99], v[216:217] op_sel:[0,1,0] op_sel_hi:[1,1,1]
v_pk_fma_f32 v[218:219], v[154:155], v[98:99], v[218:219] op_sel:[0,1,0] op_sel_hi:[1,1,1]
v_pk_mul_f32 v[212:213], v[212:213], v[98:99] op_sel:[0,0] op_sel_hi:[1,0]
v_pk_mul_f32 v[214:215], v[214:215], v[98:99] op_sel:[0,0] op_sel_hi:[1,0]
v_pk_mul_f32 v[216:217], v[216:217], v[98:99] op_sel:[0,0] op_sel_hi:[1,0]
v_pk_mul_f32 v[218:219], v[218:219], v[98:99] op_sel:[0,0] op_sel_hi:[1,0]
v_cvt_pk_bf16_f32 v212, v212, v213
v_cvt_pk_bf16_f32 v213, v214, v215
v_cvt_pk_bf16_f32 v214, v216, v217
v_cvt_pk_bf16_f32 v215, v218, v219
v_pk_fma_f32 v[244:245], v[88:89], v[56:57], v[244:245] op_sel:[0,0,0] op_sel_hi:[1,0,1]
v_pk_fma_f32 v[246:247], v[90:91], v[56:57], v[246:247] op_sel:[0,0,0] op_sel_hi:[1,0,1]
v_pk_mul_f32 v[244:245], v[244:245], v[72:73]
v_pk_mul_f32 v[246:247], v[246:247], v[74:75]
v_cvt_pk_bf16_f32 v108, v244, v245
v_cvt_pk_bf16_f32 v109, v246, v247
v_pk_fma_f32 v[248:249], v[88:89], v[56:57], v[248:249] op_sel:[0,1,0] op_sel_hi:[1,1,1]
v_pk_fma_f32 v[250:251], v[90:91], v[56:57], v[250:251] op_sel:[0,1,0] op_sel_hi:[1,1,1]
v_pk_mul_f32 v[248:249], v[248:249], v[72:73]
v_pk_mul_f32 v[250:251], v[250:251], v[74:75]
v_cvt_pk_bf16_f32 v118, v248, v249
v_cvt_pk_bf16_f32 v119, v250, v251
s_cmp_lg_u32 s44, 1
s_cbranch_scc1 else_44
buffer_store_dwordx4 v[212:215], v58, s[32:35], 0 offen sc1
buffer_store_dwordx2 v[108:109], v59, s[32:35], 0 offen offset:1024 sc1
buffer_store_dwordx2 v[118:119], v59, s[32:35], 0 offen offset:1536 sc1
s_branch fi_45
else_44:
ds_write_b128 v53, v[212:215]
ds_write_b64 v55, v[108:109] offset:1024
ds_write_b64 v55, v[118:119] offset:1536
v_mov_b32 v4, 1
ds_write_b32 v19, v4
fi_45:
v_mul_f32 v124, s66, v92
v_mul_f32 v125, s66, v94
v_mul_f32 v126, s66, v96
v_mul_f32 v127, s66, v98
.p2align 3
v_pk_fma_f32 v[156:157], v[140:141], v[92:93], v[156:157] op_sel:[0,1,0] op_sel_hi:[1,1,1]
v_pk_fma_f32 v[158:159], v[142:143], v[92:93], v[158:159] op_sel:[0,1,0] op_sel_hi:[1,1,1]
v_pk_fma_f32 v[160:161], v[144:145], v[92:93], v[160:161] op_sel:[0,1,0] op_sel_hi:[1,1,1]
v_pk_fma_f32 v[162:163], v[146:147], v[92:93], v[162:163] op_sel:[0,1,0] op_sel_hi:[1,1,1]
v_cvt_pk_bf16_f32 v156, v156, v157
v_cvt_pk_bf16_f32 v157, v158, v159
v_cvt_pk_bf16_f32 v158, v160, v161
v_cvt_pk_bf16_f32 v159, v162, v163
v_pk_fma_f32 v[164:165], v[140:141], v[94:95], v[164:165] op_sel:[0,1,0] op_sel_hi:[1,1,1]
v_pk_fma_f32 v[166:167], v[142:143], v[94:95], v[166:167] op_sel:[0,1,0] op_sel_hi:[1,1,1]
v_pk_fma_f32 v[168:169], v[144:145], v[94:95], v[168:169] op_sel:[0,1,0] op_sel_hi:[1,1,1]
v_pk_fma_f32 v[170:171], v[146:147], v[94:95], v[170:171] op_sel:[0,1,0] op_sel_hi:[1,1,1]
v_cvt_pk_bf16_f32 v164, v164, v165
v_cvt_pk_bf16_f32 v165, v166, v167
v_cvt_pk_bf16_f32 v166, v168, v169
v_cvt_pk_bf16_f32 v167, v170, v171
v_pk_fma_f32 v[172:173], v[140:141], v[96:97], v[172:173] op_sel:[0,1,0] op_sel_hi:[1,1,1]
v_pk_fma_f32 v[174:175], v[142:143], v[96:97], v[174:175] op_sel:[0,1,0] op_sel_hi:[1,1,1]
v_pk_fma_f32 v[176:177], v[144:145], v[96:97], v[176:177] op_sel:[0,1,0] op_sel_hi:[1,1,1]
v_pk_fma_f32 v[178:179], v[146:147], v[96:97], v[178:179] op_sel:[0,1,0] op_sel_hi:[1,1,1]
v_cvt_pk_bf16_f32 v172, v172, v173
v_cvt_pk_bf16_f32 v173, v174, v175
v_cvt_pk_bf16_f32 v174, v176, v177
v_cvt_pk_bf16_f32 v175, v178, v179
v_pk_fma_f32 v[180:181], v[140:141], v[98:99], v[180:181] op_sel:[0,1,0] op_sel_hi:[1,1,1]
v_pk_fma_f32 v[182:183], v[142:143], v[98:99], v[182:183] op_sel:[0,1,0] op_sel_hi:[1,1,1]
v_pk_fma_f32 v[184:185], v[144:145], v[98:99], v[184:185] op_sel:[0,1,0] op_sel_hi:[1,1,1]
v_pk_fma_f32 v[186:187], v[146:147], v[98:99], v[186:187] op_sel:[0,1,0] op_sel_hi:[1,1,1]
v_cvt_pk_bf16_f32 v180, v180, v181
v_cvt_pk_bf16_f32 v181, v182, v183
v_cvt_pk_bf16_f32 v182, v184, v185
v_cvt_pk_bf16_f32 v183, v186, v187
v_pk_fma_f32 v[188:189], v[148:149], v[92:93], v[188:189] op_sel:[0,1,0] op_sel_hi:[1,1,1]
v_pk_fma_f32 v[190:191], v[150:151], v[92:93], v[190:191] op_sel:[0,1,0] op_sel_hi:[1,1,1]
v_pk_fma_f32 v[192:193], v[152:153], v[92:93], v[192:193] op_sel:[0,1,0] op_sel_hi:[1,1,1]
v_pk_fma_f32 v[194:195], v[154:155], v[92:93], v[194:195] op_sel:[0,1,0] op_sel_hi:[1,1,1]
v_pk_mul_f32 v[188:189], v[188:189], v[92:93] op_sel:[0,0] op_sel_hi:[1,0]
v_pk_mul_f32 v[190:191], v[190:191], v[92:93] op_sel:[0,0] op_sel_hi:[1,0]
v_pk_mul_f32 v[192:193], v[192:193], v[92:93] op_sel:[0,0] op_sel_hi:[1,0]
v_pk_mul_f32 v[194:195], v[194:195], v[92:93] op_sel:[0,0] op_sel_hi:[1,0]
v_cvt_pk_bf16_f32 v188, v188, v189
v_cvt_pk_bf16_f32 v189, v190, v191
v_cvt_pk_bf16_f32 v190, v192, v193
v_cvt_pk_bf16_f32 v191, v194, v195
v_pk_fma_f32 v[196:197], v[148:149], v[94:95], v[196:197] op_sel:[0,1,0] op_sel_hi:[1,1,1]
v_pk_fma_f32 v[198:199], v[150:151], v[94:95], v[198:199] op_sel:[0,1,0] op_sel_hi:[1,1,1]
v_pk_fma_f32 v[200:201], v[152:153], v[94:95], v[200:201] op_sel:[0,1,0] op_sel_hi:[1,1,1]
v_pk_fma_f32 v[202:203], v[154:155], v[94:95], v[202:203] op_sel:[0,1,0] op_sel_hi:[1,1,1]
v_pk_mul_f32 v[196:197], v[196:197], v[94:95] op_sel:[0,0] op_sel_hi:[1,0]
v_pk_mul_f32 v[198:199], v[198:199], v[94:95] op_sel:[0,0] op_sel_hi:[1,0]
v_pk_mul_f32 v[200:201], v[200:201], v[94:95] op_sel:[0,0] op_sel_hi:[1,0]
v_pk_mul_f32 v[202:203], v[202:203], v[94:95] op_sel:[0,0] op_sel_hi:[1,0]
v_cvt_pk_bf16_f32 v196, v196, v197
v_cvt_pk_bf16_f32 v197, v198, v199
v_cvt_pk_bf16_f32 v198, v200, v201
v_cvt_pk_bf16_f32 v199, v202, v203
v_pk_fma_f32 v[204:205], v[148:149], v[96:97], v[204:205] op_sel:[0,1,0] op_sel_hi:[1,1,1]
v_pk_fma_f32 v[206:207], v[150:151], v[96:97], v[206:207] op_sel:[0,1,0] op_sel_hi:[1,1,1]
v_pk_fma_f32 v[208:209], v[152:153], v[96:97], v[208:209] op_sel:[0,1,0] op_sel_hi:[1,1,1]
v_pk_fma_f32 v[210:211], v[154:155], v[96:97], v[210:211] op_sel:[0,1,0] op_sel_hi:[1,1,1]
v_pk_mul_f32 v[204:205], v[204:205], v[96:97] op_sel:[0,0] op_sel_hi:[1,0]
v_pk_mul_f32 v[206:207], v[206:207], v[96:97] op_sel:[0,0] op_sel_hi:[1,0]
v_pk_mul_f32 v[208:209], v[208:209], v[96:97] op_sel:[0,0] op_sel_hi:[1,0]
v_pk_mul_f32 v[210:211], v[210:211], v[96:97] op_sel:[0,0] op_sel_hi:[1,0]
v_cvt_pk_bf16_f32 v204, v204, v205
v_cvt_pk_bf16_f32 v205, v206, v207
v_cvt_pk_bf16_f32 v206, v208, v209
v_cvt_pk_bf16_f32 v207, v210, v211
s_cmp_lg_u32 s44, 0
s_cbranch_scc1 else_46
buffer_load_dwordx4 v[120:123], v58, s[32:35], 0 offen sc1
buffer_load_dwordx2 v[100:101], v59, s[32:35], 0 offen offset:1024 sc1
buffer_load_dwordx2 v[110:111], v59, s[32:35], 0 offen offset:1536 sc1
else_46:
.p2align 3
v_mfma_f32_16x16x32_bf16 v[216:219], v[212:215], v[180:183], v[40:43]
v_pk_fma_f32 v[220:221], v[76:77], v[56:57], v[220:221] op_sel:[0,0,0] op_sel_hi:[1,0,1]
v_pk_fma_f32 v[222:223], v[78:79], v[56:57], v[222:223] op_sel:[0,0,0] op_sel_hi:[1,0,1]
v_pk_mul_f32 v[220:221], v[220:221], v[60:61]
v_pk_mul_f32 v[222:223], v[222:223], v[62:63]
v_cvt_pk_bf16_f32 v102, v220, v221
v_mfma_f32_16x16x32_bf16 v[192:195], v[188:191], v[156:159], v[40:43]
v_cvt_pk_bf16_f32 v103, v222, v223
v_pk_fma_f32 v[224:225], v[76:77], v[56:57], v[224:225] op_sel:[0,1,0] op_sel_hi:[1,1,1]
v_pk_fma_f32 v[226:227], v[78:79], v[56:57], v[226:227] op_sel:[0,1,0] op_sel_hi:[1,1,1]
v_pk_mul_f32 v[224:225], v[224:225], v[60:61]
v_pk_mul_f32 v[226:227], v[226:227], v[62:63]
v_cvt_pk_bf16_f32 v112, v224, v225
v_mfma_f32_16x16x32_bf16 v[168:171], v[188:191], v[164:167], v[36:39]
v_cvt_pk_bf16_f32 v113, v226, v227
v_pk_fma_f32 v[228:229], v[80:81], v[56:57], v[228:229] op_sel:[0,0,0] op_sel_hi:[1,0,1]
v_pk_fma_f32 v[230:231], v[82:83], v[56:57], v[230:231] op_sel:[0,0,0] op_sel_hi:[1,0,1]
v_pk_mul_f32 v[228:229], v[228:229], v[64:65]
v_pk_mul_f32 v[230:231], v[230:231], v[66:67]
v_cvt_pk_bf16_f32 v104, v228, v229
v_mfma_f32_16x16x32_bf16 v[200:203], v[196:199], v[164:167], v[40:43]
v_cvt_pk_bf16_f32 v105, v230, v231
v_pk_fma_f32 v[232:233], v[80:81], v[56:57], v[232:233] op_sel:[0,1,0] op_sel_hi:[1,1,1]
v_pk_fma_f32 v[234:235], v[82:83], v[56:57], v[234:235] op_sel:[0,1,0] op_sel_hi:[1,1,1]
v_pk_mul_f32 v[232:233], v[232:233], v[64:65]
v_pk_mul_f32 v[234:235], v[234:235], v[66:67]
v_cvt_pk_bf16_f32 v114, v232, v233
v_mfma_f32_16x16x32_bf16 v[176:179], v[196:199], v[172:175], v[36:39]
v_cvt_pk_bf16_f32 v115, v234, v235
v_pk_fma_f32 v[236:237], v[84:85], v[56:57], v[236:237] op_sel:[0,0,0] op_sel_hi:[1,0,1]
v_pk_fma_f32 v[238:239], v[86:87], v[56:57], v[238:239] op_sel:[0,0,0] op_sel_hi:[1,0,1]
v_pk_mul_f32 v[236:237], v[236:237], v[68:69]
v_pk_mul_f32 v[238:239], v[238:239], v[70:71]
v_cvt_pk_bf16_f32 v106, v236, v237
v_mfma_f32_16x16x32_bf16 v[208:211], v[204:207], v[172:175], v[40:43]
v_cvt_pk_bf16_f32 v107, v238, v239
v_pk_fma_f32 v[240:241], v[84:85], v[56:57], v[240:241] op_sel:[0,1,0] op_sel_hi:[1,1,1]
v_pk_fma_f32 v[242:243], v[86:87], v[56:57], v[242:243] op_sel:[0,1,0] op_sel_hi:[1,1,1]
v_pk_mul_f32 v[240:241], v[240:241], v[68:69]
v_pk_mul_f32 v[242:243], v[242:243], v[70:71]
v_cvt_pk_bf16_f32 v116, v240, v241
v_mfma_f32_16x16x32_bf16 v[184:187], v[204:207], v[180:183], v[36:39]
v_cvt_pk_bf16_f32 v117, v242, v243
v_max_f32 v166, v200, v201
v_max_f32 v167, v202, v203
v_max_f32 v164, v168, v169
v_max_f32 v165, v170, v171
v_max3_f32 v129, v164, v165, v166
v_max_f32 v129, v129, v167
s_cmp_lg_u32 s44, 0
s_cbranch_scc1 else_48
s_mov_b32 s63, 0
sent_50:
s_waitcnt vmcnt(0)
v_max_u32 v4, v120, v121
v_max3_u32 v4, v4, v122, v123
v_max3_u32 v4, v4, v100, v101
v_max3_u32 v4, v4, v110, v111
v_cmp_eq_u32 vcc, -1, v4
s_cbranch_vccz sentd_51
buffer_load_dwordx4 v[120:123], v58, s[32:35], 0 offen sc1
buffer_load_dwordx2 v[100:101], v59, s[32:35], 0 offen offset:1024 sc1
buffer_load_dwordx2 v[110:111], v59, s[32:35], 0 offen offset:1536 sc1
s_add_u32 s63, s63, 1
s_cmp_lt_u32 s63, 0x80000
s_cbranch_scc1 sent_50
s_waitcnt vmcnt(0)
sentd_51:
s_branch fi_49
else_48:
s_mov_b32 s63, 0
px_52:
ds_read_b32 v4, v19
ds_read_b128 v[120:123], v53
ds_read_b64 v[100:101], v55 offset:1024
ds_read_b64 v[110:111], v55 offset:1536
s_add_u32 s63, s63, 1
s_cmp_lt_u32 s63, 0x400000
s_waitcnt lgkmcnt(0)
v_cmp_ne_u32 vcc, 1, v4
s_cbranch_vccz pxd_53
s_cbranch_scc1 px_52
pxd_53:
fi_49:
v_mfma_f32_16x16x32_bf16 v[160:163], v[120:123], v[156:159], v[44:47]
v_max_f32 v174, v208, v209
v_max_f32 v175, v210, v211
v_max_f32 v172, v176, v177
v_max_f32 v173, v178, v179
v_max3_f32 v130, v172, v173, v174
v_max_f32 v130, v130, v175
v_max_f32 v182, v216, v217
v_max_f32 v183, v218, v219
v_max_f32 v180, v184, v185
v_max_f32 v181, v186, v187
v_max3_f32 v131, v180, v181, v182
v_max_f32 v131, v131, v183
v_max_f32 v158, v192, v193
v_max_f32 v159, v194, v195
v_max_f32 v156, v160, v161
v_max_f32 v157, v162, v163
v_max3_f32 v128, v156, v157, v158
v_max_f32 v128, v128, v159
s_nop 1
v_permlane32_swap_b32 v128, v129
v_permlane32_swap_b32 v130, v131
v_max_f32 v128, v128, v129
v_max_f32 v130, v130, v131
s_nop 1
v_permlane16_swap_b32 v128, v130
s_nop 0
v_max_f32 v128, v128, v130
v_mov_b32 v130, v128
s_nop 1
v_permlane16_swap_b32 v128, v130
s_nop 0
v_mov_b32 v129, v128
v_mov_b32 v131, v130
s_nop 0
v_permlane32_swap_b32 v128, v129
v_permlane32_swap_b32 v130, v131
v_pk_mul_f32 v[128:129], v[128:129], v[124:125]
v_pk_mul_f32 v[130:131], v[130:131], v[126:127]
v_pk_fma_f32 v[156:157], v[156:157], v[124:125], v[128:129] op_sel:[0,0,0] op_sel_hi:[1,0,0] neg_lo:[0,0,1] neg_hi:[0,0,1]
v_pk_fma_f32 v[158:159], v[158:159], v[124:125], v[128:129] op_sel:[0,0,0] op_sel_hi:[1,0,0] neg_lo:[0,0,1] neg_hi:[0,0,1]
v_exp_f32 v156, v156
v_exp_f32 v157, v157
v_exp_f32 v158, v158
v_exp_f32 v159, v159
v_cvt_pk_bf16_f32 v156, v156, v156
v_cvt_pk_bf16_f32 v157, v157, v157
v_cvt_pk_bf16_f32 v158, v158, v158
v_cvt_pk_bf16_f32 v159, v159, v159
v_and_b32 v156, v52, v156
v_and_b32 v157, v52, v157
v_and_b32 v158, v52, v158
v_and_b32 v159, v52, v159
v_pk_fma_f32 v[164:165], v[164:165], v[124:125], v[128:129] op_sel:[0,1,1] op_sel_hi:[1,1,1] neg_lo:[0,0,1] neg_hi:[0,0,1]
v_pk_fma_f32 v[166:167], v[166:167], v[124:125], v[128:129] op_sel:[0,1,1] op_sel_hi:[1,1,1] neg_lo:[0,0,1] neg_hi:[0,0,1]
v_exp_f32 v164, v164
v_mfma_f32_16x16x32_bf16 v[160:163], v[48:51], v[156:159], 0
v_exp_f32 v165, v165
v_exp_f32 v166, v166
v_exp_f32 v167, v167
v_cvt_pk_bf16_f32 v164, v164, v164
v_mfma_f32_16x16x32_bf16 v[220:223], v[100:103], v[156:159], 0
v_cvt_pk_bf16_f32 v165, v165, v165
v_cvt_pk_bf16_f32 v166, v166, v166
v_cvt_pk_bf16_f32 v167, v167, v167
v_and_b32 v164, v52, v164
v_mfma_f32_16x16x32_bf16 v[224:227], v[110:113], v[156:159], 0
v_and_b32 v165, v52, v165
v_and_b32 v166, v52, v166
v_and_b32 v167, v52, v167
v_pk_fma_f32 v[172:173], v[172:173], v[126:127], v[130:131] op_sel:[0,0,0] op_sel_hi:[1,0,0] neg_lo:[0,0,1] neg_hi:[0,0,1]
v_pk_fma_f32 v[174:175], v[174:175], v[126:127], v[130:131] op_sel:[0,0,0] op_sel_hi:[1,0,0] neg_lo:[0,0,1] neg_hi:[0,0,1]
v_exp_f32 v172, v172
v_mfma_f32_16x16x32_bf16 v[168:171], v[48:51], v[164:167], 0
v_exp_f32 v173, v173
v_exp_f32 v174, v174
v_exp_f32 v175, v175
v_cvt_pk_bf16_f32 v172, v172, v172
v_mfma_f32_16x16x32_bf16 v[228:231], v[102:105], v[164:167], 0
v_cvt_pk_bf16_f32 v173, v173, v173
v_cvt_pk_bf16_f32 v174, v174, v174
v_cvt_pk_bf16_f32 v175, v175, v175
v_and_b32 v172, v52, v172
v_mfma_f32_16x16x32_bf16 v[232:235], v[112:115], v[164:167], 0
v_and_b32 v173, v52, v173
v_and_b32 v174, v52, v174
v_and_b32 v175, v52, v175
v_pk_fma_f32 v[180:181], v[180:181], v[126:127], v[130:131] op_sel:[0,1,1] op_sel_hi:[1,1,1] neg_lo:[0,0,1] neg_hi:[0,0,1]
v_pk_fma_f32 v[182:183], v[182:183], v[126:127], v[130:131] op_sel:[0,1,1] op_sel_hi:[1,1,1] neg_lo:[0,0,1] neg_hi:[0,0,1]
v_exp_f32 v180, v180
v_mfma_f32_16x16x32_bf16 v[176:179], v[48:51], v[172:175], 0
v_exp_f32 v181, v181
v_exp_f32 v182, v182
v_exp_f32 v183, v183
v_cvt_pk_bf16_f32 v180, v180, v180
v_mfma_f32_16x16x32_bf16 v[236:239], v[104:107], v[172:175], 0
v_cvt_pk_bf16_f32 v181, v181, v181
v_cvt_pk_bf16_f32 v182, v182, v182
v_cvt_pk_bf16_f32 v183, v183, v183
v_and_b32 v180, v52, v180
v_mfma_f32_16x16x32_bf16 v[240:243], v[114:117], v[172:175], 0
v_and_b32 v181, v52, v181
v_and_b32 v182, v52, v182
v_and_b32 v183, v52, v183
v_rcp_f32 v160, v160
v_rcp_f32 v168, v168
v_mfma_f32_16x16x32_bf16 v[184:187], v[48:51], v[180:183], 0
v_mfma_f32_16x16x32_bf16 v[244:247], v[106:109], v[180:183], 0
v_mfma_f32_16x16x32_bf16 v[248:251], v[116:119], v[180:183], 0
v_rcp_f32 v176, v176
s_nop 4
v_rcp_f32 v184, v184
s_cmp_eq_u32 s46, 0
s_cbranch_scc1 slow_54
.p2align 3
v_pk_mul_f32 v[220:221], v[220:221], v[160:161] op_sel:[0,0] op_sel_hi:[1,0]
v_pk_mul_f32 v[222:223], v[222:223], v[160:161] op_sel:[0,0] op_sel_hi:[1,0]
v_pk_mul_f32 v[224:225], v[224:225], v[160:161] op_sel:[0,0] op_sel_hi:[1,0]
v_pk_mul_f32 v[226:227], v[226:227], v[160:161] op_sel:[0,0] op_sel_hi:[1,0]
v_cvt_pk_bf16_f32 v220, v220, v221
v_cvt_pk_bf16_f32 v221, v222, v223
v_cvt_pk_bf16_f32 v222, v224, v225
v_cvt_pk_bf16_f32 v223, v226, v227
buffer_store_dwordx4 v[220:223], v18, s[32:35], s80 offen sc1
v_pk_mul_f32 v[228:229], v[228:229], v[168:169] op_sel:[0,0] op_sel_hi:[1,0]
v_pk_mul_f32 v[230:231], v[230:231], v[168:169] op_sel:[0,0] op_sel_hi:[1,0]
v_pk_mul_f32 v[232:233], v[232:233], v[168:169] op_sel:[0,0] op_sel_hi:[1,0]
v_pk_mul_f32 v[234:235], v[234:235], v[168:169] op_sel:[0,0] op_sel_hi:[1,0]
v_cvt_pk_bf16_f32 v228, v228, v229
v_cvt_pk_bf16_f32 v229, v230, v231
v_cvt_pk_bf16_f32 v230, v232, v233
v_cvt_pk_bf16_f32 v231, v234, v235
buffer_store_dwordx4 v[228:231], v18, s[32:35], s81 offen sc1
v_pk_mul_f32 v[236:237], v[236:237], v[176:177] op_sel:[0,0] op_sel_hi:[1,0]
v_pk_mul_f32 v[238:239], v[238:239], v[176:177] op_sel:[0,0] op_sel_hi:[1,0]
v_pk_mul_f32 v[240:241], v[240:241], v[176:177] op_sel:[0,0] op_sel_hi:[1,0]
v_pk_mul_f32 v[242:243], v[242:243], v[176:177] op_sel:[0,0] op_sel_hi:[1,0]
v_cvt_pk_bf16_f32 v236, v236, v237
v_cvt_pk_bf16_f32 v237, v238, v239
v_cvt_pk_bf16_f32 v238, v240, v241
v_cvt_pk_bf16_f32 v239, v242, v243
buffer_store_dwordx4 v[236:239], v18, s[32:35], s82 offen sc1
v_pk_mul_f32 v[244:245], v[244:245], v[184:185] op_sel:[0,0] op_sel_hi:[1,0]
v_pk_mul_f32 v[246:247], v[246:247], v[184:185] op_sel:[0,0] op_sel_hi:[1,0]
v_pk_mul_f32 v[248:249], v[248:249], v[184:185] op_sel:[0,0] op_sel_hi:[1,0]
v_pk_mul_f32 v[250:251], v[250:251], v[184:185] op_sel:[0,0] op_sel_hi:[1,0]
v_cvt_pk_bf16_f32 v244, v244, v245
v_cvt_pk_bf16_f32 v245, v246, v247
v_cvt_pk_bf16_f32 v246, v248, v249
v_cvt_pk_bf16_f32 v247, v250, v251
buffer_store_dwordx4 v[244:247], v18, s[32:35], s83 offen sc1
s_barrier
s_lshl_b32 s62, s45, 2
v_mov_b32 v4, s62
v_mov_b32 v5, 1
s_mov_b64 exec, 1
s_waitcnt vmcnt(0)
buffer_store_dword v5, v4, s[32:35], s84 offen
s_mov_b64 exec, -1
back_55:
v_and_b32 v36, 31, v0
v_lshlrev_b32 v36, 2, v36
buffer_load_dword v37, v36, s[32:35], s84 offen sc1
v_lshrrev_b32 v4, 2, v2
v_and_b32 v5, 3, v0
v_lshl_add_u32 v6, v3, 3, v4
v_lshlrev_b32 v6, 7, v6
v_lshl_add_u32 v6, v5, 3, v6
v_lshrrev_b32 v7, 1, v4
v_and_b32 v8, 1, v3
v_lshl_add_u32 v7, v8, 1, v7
v_lshl_add_u32 v10, v7, 5, v6
v_xor_b32 v11, 32, v10
v_xor_b32 v12, 64, v10
v_xor_b32 v13, 96, v10
v_add_u32 v14, 0x10000, v10
v_add_u32 v15, 0x10000, v11
v_add_u32 v16, 0x10000, v12
v_add_u32 v17, 0x10000, v13
ds_read_b64_tr_b16 v[220:221], v10 offset:0
ds_read_b64_tr_b16 v[222:223], v10 offset:512
ds_read_b64_tr_b16 v[224:225], v11 offset:0
ds_read_b64_tr_b16 v[226:227], v11 offset:512
ds_read_b64_tr_b16 v[228:229], v12 offset:0
ds_read_b64_tr_b16 v[230:231], v12 offset:512
ds_read_b64_tr_b16 v[232:233], v13 offset:0
ds_read_b64_tr_b16 v[234:235], v13 offset:512
ds_read_b64_tr_b16 v[236:237], v10 offset:4096
ds_read_b64_tr_b16 v[238:239], v10 offset:4608
ds_read_b64_tr_b16 v[240:241], v11 offset:4096
ds_read_b64_tr_b16 v[242:243], v11 offset:4608
ds_read_b64_tr_b16 v[244:245], v12 offset:4096
ds_read_b64_tr_b16 v[246:247], v12 offset:4608
ds_read_b64_tr_b16 v[248:249], v13 offset:4096
ds_read_b64_tr_b16 v[250:251], v13 offset:4608
s_lshl_b32 s48, s41, 3
s_lshl_b32 s49, s40, 1
s_add_u32 s48, s48, s49
s_lshl_b32 s48, s48, 15
s_add_u32 s48, s48, 4194304
v_add_u32 v38, s48, v18
v_add_u32 v39, 32768, v38
s_lshl_b32 s57, s75, 11
s_add_u32 s87, s87, 262144
v_lshlrev_b32 v60, 16, v20
v_and_b32 v61, 0xffff0000, v20
v_lshlrev_b32 v62, 16, v21
v_and_b32 v63, 0xffff0000, v21
v_lshlrev_b32 v64, 16, v22
v_and_b32 v65, 0xffff0000, v22
v_lshlrev_b32 v66, 16, v23
v_and_b32 v67, 0xffff0000, v23
v_lshlrev_b32 v68, 16, v24
v_and_b32 v69, 0xffff0000, v24
v_lshlrev_b32 v70, 16, v25
v_and_b32 v71, 0xffff0000, v25
v_lshlrev_b32 v72, 16, v26
v_and_b32 v73, 0xffff0000, v26
v_lshlrev_b32 v74, 16, v27
v_and_b32 v75, 0xffff0000, v27
v_lshlrev_b32 v76, 16, v28
v_and_b32 v77, 0xffff0000, v28
v_lshlrev_b32 v78, 16, v29
v_and_b32 v79, 0xffff0000, v29
v_lshlrev_b32 v80, 16, v30
v_and_b32 v81, 0xffff0000, v30
v_lshlrev_b32 v82, 16, v31
v_and_b32 v83, 0xffff0000, v31
v_lshlrev_b32 v84, 16, v32
v_and_b32 v85, 0xffff0000, v32
v_lshlrev_b32 v86, 16, v33
v_and_b32 v87, 0xffff0000, v33
v_lshlrev_b32 v88, 16, v34
v_and_b32 v89, 0xffff0000, v34
v_lshlrev_b32 v90, 16, v35
v_and_b32 v91, 0xffff0000, v35
v_mov_b32 v6, 0
v_mov_b32 v7, 0
v_mov_b32 v8, 0
v_mov_b32 v9, 0
s_lshl_b32 s62, s42, 2
v_mov_b32 v4, s62
v_mov_b32 v5, 1
s_mov_b32 s63, 0
s_waitcnt vmcnt(0)
poll_56:
v_cmp_gt_u32 vcc, 1, v37
s_cbranch_vccz polled_57
buffer_load_dword v37, v36, s[32:35], s84 offen sc1
s_add_u32 s63, s63, 1
s_cmp_lt_u32 s63, 0x80000
s_waitcnt vmcnt(0)
s_cbranch_scc1 poll_56
polled_57:
buffer_load_dwordx4 v[156:159], v38, s[32:35], s57 offen sc1
buffer_load_dwordx4 v[160:163], v39, s[32:35], s57 offen sc1
buffer_load_dwordx4 v[164:167], v38, s[32:35], s57 offen offset:1024 sc1
buffer_load_dwordx4 v[168:171], v39, s[32:35], s57 offen offset:1024 sc1
s_add_u32 s57, s57, 2048
s_and_b32 s57, s57, 0x7fff
buffer_load_dwordx4 v[172:175], v38, s[32:35], s57 offen sc1
buffer_load_dwordx4 v[176:179], v39, s[32:35], s57 offen sc1
buffer_load_dwordx4 v[180:183], v38, s[32:35], s57 offen offset:1024 sc1
buffer_load_dwordx4 v[184:187], v39, s[32:35], s57 offen offset:1024 sc1
s_add_u32 s57, s57, 2048
s_and_b32 s57, s57, 0x7fff
s_waitcnt vmcnt(6) lgkmcnt(8)
v_mfma_f32_16x16x32_bf16 v[60:63], v[220:223], v[156:159], v[60:63]
buffer_load_dwordx4 v[188:191], v38, s[32:35], s57 offen sc1
v_mfma_f32_16x16x32_bf16 v[76:79], v[220:223], v[160:163], v[76:79]
ds_read_b64_tr_b16 v[100:101], v10 offset:8192
ds_read_b64_tr_b16 v[102:103], v10 offset:8704
v_mfma_f32_16x16x32_bf16 v[64:67], v[224:227], v[156:159], v[64:67]
ds_read_b64_tr_b16 v[104:105], v11 offset:8192
ds_read_b64_tr_b16 v[106:107], v11 offset:8704
v_mfma_f32_16x16x32_bf16 v[80:83], v[224:227], v[160:163], v[80:83]
buffer_load_dwordx4 v[192:195], v39, s[32:35], s57 offen sc1
v_mfma_f32_16x16x32_bf16 v[68:71], v[228:231], v[156:159], v[68:71]
ds_read_b64_tr_b16 v[108:109], v12 offset:8192
ds_read_b64_tr_b16 v[110:111], v12 offset:8704
v_mfma_f32_16x16x32_bf16 v[84:87], v[228:231], v[160:163], v[84:87]
ds_read_b64_tr_b16 v[112:113], v13 offset:8192
ds_read_b64_tr_b16 v[114:115], v13 offset:8704
v_mfma_f32_16x16x32_bf16 v[72:75], v[232:235], v[156:159], v[72:75]
v_mfma_f32_16x16x32_bf16 v[88:91], v[232:235], v[160:163], v[88:91]
s_waitcnt vmcnt(6) lgkmcnt(8)
v_mfma_f32_16x16x32_bf16 v[60:63], v[236:239], v[164:167], v[60:63]
buffer_load_dwordx4 v[196:199], v38, s[32:35], s57 offen offset:1024 sc1
v_mfma_f32_16x16x32_bf16 v[76:79], v[236:239], v[168:171], v[76:79]
ds_read_b64_tr_b16 v[220:221], v10 offset:12288
ds_read_b64_tr_b16 v[222:223], v10 offset:12800
v_mfma_f32_16x16x32_bf16 v[64:67], v[240:243], v[164:167], v[64:67]
ds_read_b64_tr_b16 v[224:225], v11 offset:12288
ds_read_b64_tr_b16 v[226:227], v11 offset:12800
v_mfma_f32_16x16x32_bf16 v[80:83], v[240:243], v[168:171], v[80:83]
buffer_load_dwordx4 v[200:203], v39, s[32:35], s57 offen offset:1024 sc1
v_mfma_f32_16x16x32_bf16 v[68:71], v[244:247], v[164:167], v[68:71]
ds_read_b64_tr_b16 v[228:229], v12 offset:12288
ds_read_b64_tr_b16 v[230:231], v12 offset:12800
v_mfma_f32_16x16x32_bf16 v[84:87], v[244:247], v[168:171], v[84:87]
ds_read_b64_tr_b16 v[232:233], v13 offset:12288
ds_read_b64_tr_b16 v[234:235], v13 offset:12800
v_mfma_f32_16x16x32_bf16 v[72:75], v[248:251], v[164:167], v[72:75]
s_add_u32 s57, s57, 2048
s_and_b32 s57, s57, 0x7fff
v_mfma_f32_16x16x32_bf16 v[88:91], v[248:251], v[168:171], v[88:91]
s_waitcnt vmcnt(6) lgkmcnt(8)
v_mfma_f32_16x16x32_bf16 v[60:63], v[100:103], v[172:175], v[60:63]
buffer_load_dwordx4 v[204:207], v38, s[32:35], s57 offen sc1
v_mfma_f32_16x16x32_bf16 v[76:79], v[100:103], v[176:179], v[76:79]
ds_read_b64_tr_b16 v[236:237], v10 offset:16384
ds_read_b64_tr_b16 v[238:239], v10 offset:16896
v_mfma_f32_16x16x32_bf16 v[64:67], v[104:107], v[172:175], v[64:67]
ds_read_b64_tr_b16 v[240:241], v11 offset:16384
ds_read_b64_tr_b16 v[242:243], v11 offset:16896
v_mfma_f32_16x16x32_bf16 v[80:83], v[104:107], v[176:179], v[80:83]
buffer_load_dwordx4 v[208:211], v39, s[32:35], s57 offen sc1
v_mfma_f32_16x16x32_bf16 v[68:71], v[108:111], v[172:175], v[68:71]
ds_read_b64_tr_b16 v[244:245], v12 offset:16384
ds_read_b64_tr_b16 v[246:247], v12 offset:16896
v_mfma_f32_16x16x32_bf16 v[84:87], v[108:111], v[176:179], v[84:87]
ds_read_b64_tr_b16 v[248:249], v13 offset:16384
ds_read_b64_tr_b16 v[250:251], v13 offset:16896
v_mfma_f32_16x16x32_bf16 v[72:75], v[112:115], v[172:175], v[72:75]
v_mfma_f32_16x16x32_bf16 v[88:91], v[112:115], v[176:179], v[88:91]
s_waitcnt vmcnt(6) lgkmcnt(8)
v_mfma_f32_16x16x32_bf16 v[60:63], v[220:223], v[180:183], v[60:63]
buffer_load_dwordx4 v[212:215], v38, s[32:35], s57 offen offset:1024 sc1
v_mfma_f32_16x16x32_bf16 v[76:79], v[220:223], v[184:187], v[76:79]
ds_read_b64_tr_b16 v[100:101], v10 offset:20480
ds_read_b64_tr_b16 v[102:103], v10 offset:20992
v_mfma_f32_16x16x32_bf16 v[64:67], v[224:227], v[180:183], v[64:67]
ds_read_b64_tr_b16 v[104:105], v11 offset:20480
ds_read_b64_tr_b16 v[106:107], v11 offset:20992
v_mfma_f32_16x16x32_bf16 v[80:83], v[224:227], v[184:187], v[80:83]
buffer_load_dwordx4 v[216:219], v39, s[32:35], s57 offen offset:1024 sc1
v_mfma_f32_16x16x32_bf16 v[68:71], v[228:231], v[180:183], v[68:71]
ds_read_b64_tr_b16 v[108:109], v12 offset:20480
ds_read_b64_tr_b16 v[110:111], v12 offset:20992
v_mfma_f32_16x16x32_bf16 v[84:87], v[228:231], v[184:187], v[84:87]
ds_read_b64_tr_b16 v[112:113], v13 offset:20480
ds_read_b64_tr_b16 v[114:115], v13 offset:20992
v_mfma_f32_16x16x32_bf16 v[72:75], v[232:235], v[180:183], v[72:75]
s_add_u32 s57, s57, 2048
s_and_b32 s57, s57, 0x7fff
v_mfma_f32_16x16x32_bf16 v[88:91], v[232:235], v[184:187], v[88:91]
s_waitcnt vmcnt(6) lgkmcnt(8)
v_mfma_f32_16x16x32_bf16 v[60:63], v[236:239], v[188:191], v[60:63]
buffer_load_dwordx4 v[156:159], v38, s[32:35], s57 offen sc1
v_mfma_f32_16x16x32_bf16 v[76:79], v[236:239], v[192:195], v[76:79]
ds_read_b64_tr_b16 v[220:221], v10 offset:24576
ds_read_b64_tr_b16 v[222:223], v10 offset:25088
v_mfma_f32_16x16x32_bf16 v[64:67], v[240:243], v[188:191], v[64:67]
ds_read_b64_tr_b16 v[224:225], v11 offset:24576
ds_read_b64_tr_b16 v[226:227], v11 offset:25088
v_mfma_f32_16x16x32_bf16 v[80:83], v[240:243], v[192:195], v[80:83]
buffer_load_dwordx4 v[160:163], v39, s[32:35], s57 offen sc1
v_mfma_f32_16x16x32_bf16 v[68:71], v[244:247], v[188:191], v[68:71]
ds_read_b64_tr_b16 v[228:229], v12 offset:24576
ds_read_b64_tr_b16 v[230:231], v12 offset:25088
v_mfma_f32_16x16x32_bf16 v[84:87], v[244:247], v[192:195], v[84:87]
ds_read_b64_tr_b16 v[232:233], v13 offset:24576
ds_read_b64_tr_b16 v[234:235], v13 offset:25088
v_mfma_f32_16x16x32_bf16 v[72:75], v[248:251], v[188:191], v[72:75]
v_mfma_f32_16x16x32_bf16 v[88:91], v[248:251], v[192:195], v[88:91]
s_waitcnt vmcnt(6) lgkmcnt(8)
v_mfma_f32_16x16x32_bf16 v[60:63], v[100:103], v[196:199], v[60:63]
buffer_load_dwordx4 v[164:167], v38, s[32:35], s57 offen offset:1024 sc1
v_mfma_f32_16x16x32_bf16 v[76:79], v[100:103], v[200:203], v[76:79]
ds_read_b64_tr_b16 v[236:237], v10 offset:28672
ds_read_b64_tr_b16 v[238:239], v10 offset:29184
v_mfma_f32_16x16x32_bf16 v[64:67], v[104:107], v[196:199], v[64:67]
ds_read_b64_tr_b16 v[240:241], v11 offset:28672
ds_read_b64_tr_b16 v[242:243], v11 offset:29184
v_mfma_f32_16x16x32_bf16 v[80:83], v[104:107], v[200:203], v[80:83]
buffer_load_dwordx4 v[168:171], v39, s[32:35], s57 offen offset:1024 sc1
v_mfma_f32_16x16x32_bf16 v[68:71], v[108:111], v[196:199], v[68:71]
ds_read_b64_tr_b16 v[244:245], v12 offset:28672
ds_read_b64_tr_b16 v[246:247], v12 offset:29184
v_mfma_f32_16x16x32_bf16 v[84:87], v[108:111], v[200:203], v[84:87]
ds_read_b64_tr_b16 v[248:249], v13 offset:28672
ds_read_b64_tr_b16 v[250:251], v13 offset:29184
v_mfma_f32_16x16x32_bf16 v[72:75], v[112:115], v[196:199], v[72:75]
s_add_u32 s57, s57, 2048
s_and_b32 s57, s57, 0x7fff
v_mfma_f32_16x16x32_bf16 v[88:91], v[112:115], v[200:203], v[88:91]
s_waitcnt vmcnt(6) lgkmcnt(8)
v_mfma_f32_16x16x32_bf16 v[60:63], v[220:223], v[204:207], v[60:63]
buffer_load_dwordx4 v[172:175], v38, s[32:35], s57 offen sc1
v_mfma_f32_16x16x32_bf16 v[76:79], v[220:223], v[208:211], v[76:79]
ds_read_b64_tr_b16 v[100:101], v10 offset:32768
ds_read_b64_tr_b16 v[102:103], v10 offset:33280
v_mfma_f32_16x16x32_bf16 v[64:67], v[224:227], v[204:207], v[64:67]
ds_read_b64_tr_b16 v[104:105], v11 offset:32768
ds_read_b64_tr_b16 v[106:107], v11 offset:33280
v_mfma_f32_16x16x32_bf16 v[80:83], v[224:227], v[208:211], v[80:83]
buffer_load_dwordx4 v[176:179], v39, s[32:35], s57 offen sc1
v_mfma_f32_16x16x32_bf16 v[68:71], v[228:231], v[204:207], v[68:71]
ds_read_b64_tr_b16 v[108:109], v12 offset:32768
ds_read_b64_tr_b16 v[110:111], v12 offset:33280
v_mfma_f32_16x16x32_bf16 v[84:87], v[228:231], v[208:211], v[84:87]
ds_read_b64_tr_b16 v[112:113], v13 offset:32768
ds_read_b64_tr_b16 v[114:115], v13 offset:33280
v_mfma_f32_16x16x32_bf16 v[72:75], v[232:235], v[204:207], v[72:75]
v_mfma_f32_16x16x32_bf16 v[88:91], v[232:235], v[208:211], v[88:91]
s_waitcnt vmcnt(6) lgkmcnt(8)
v_mfma_f32_16x16x32_bf16 v[60:63], v[236:239], v[212:215], v[60:63]
buffer_load_dwordx4 v[180:183], v38, s[32:35], s57 offen offset:1024 sc1
v_mfma_f32_16x16x32_bf16 v[76:79], v[236:239], v[216:219], v[76:79]
ds_read_b64_tr_b16 v[220:221], v10 offset:36864
ds_read_b64_tr_b16 v[222:223], v10 offset:37376
v_mfma_f32_16x16x32_bf16 v[64:67], v[240:243], v[212:215], v[64:67]
ds_read_b64_tr_b16 v[224:225], v11 offset:36864
ds_read_b64_tr_b16 v[226:227], v11 offset:37376
v_mfma_f32_16x16x32_bf16 v[80:83], v[240:243], v[216:219], v[80:83]
buffer_load_dwordx4 v[184:187], v39, s[32:35], s57 offen offset:1024 sc1
v_mfma_f32_16x16x32_bf16 v[68:71], v[244:247], v[212:215], v[68:71]
ds_read_b64_tr_b16 v[228:229], v12 offset:36864
ds_read_b64_tr_b16 v[230:231], v12 offset:37376
v_mfma_f32_16x16x32_bf16 v[84:87], v[244:247], v[216:219], v[84:87]
ds_read_b64_tr_b16 v[232:233], v13 offset:36864
ds_read_b64_tr_b16 v[234:235], v13 offset:37376
v_mfma_f32_16x16x32_bf16 v[72:75], v[248:251], v[212:215], v[72:75]
s_add_u32 s57, s57, 2048
s_and_b32 s57, s57, 0x7fff
v_mfma_f32_16x16x32_bf16 v[88:91], v[248:251], v[216:219], v[88:91]
s_waitcnt vmcnt(6) lgkmcnt(8)
v_mfma_f32_16x16x32_bf16 v[60:63], v[100:103], v[156:159], v[60:63]
buffer_load_dwordx4 v[188:191], v38, s[32:35], s57 offen sc1
v_mfma_f32_16x16x32_bf16 v[76:79], v[100:103], v[160:163], v[76:79]
ds_read_b64_tr_b16 v[236:237], v10 offset:40960
ds_read_b64_tr_b16 v[238:239], v10 offset:41472
v_mfma_f32_16x16x32_bf16 v[64:67], v[104:107], v[156:159], v[64:67]
ds_read_b64_tr_b16 v[240:241], v11 offset:40960
ds_read_b64_tr_b16 v[242:243], v11 offset:41472
v_mfma_f32_16x16x32_bf16 v[80:83], v[104:107], v[160:163], v[80:83]
buffer_load_dwordx4 v[192:195], v39, s[32:35], s57 offen sc1
v_mfma_f32_16x16x32_bf16 v[68:71], v[108:111], v[156:159], v[68:71]
ds_read_b64_tr_b16 v[244:245], v12 offset:40960
ds_read_b64_tr_b16 v[246:247], v12 offset:41472
v_mfma_f32_16x16x32_bf16 v[84:87], v[108:111], v[160:163], v[84:87]
ds_read_b64_tr_b16 v[248:249], v13 offset:40960
ds_read_b64_tr_b16 v[250:251], v13 offset:41472
v_mfma_f32_16x16x32_bf16 v[72:75], v[112:115], v[156:159], v[72:75]
v_mfma_f32_16x16x32_bf16 v[88:91], v[112:115], v[160:163], v[88:91]
s_waitcnt vmcnt(6) lgkmcnt(8)
v_mfma_f32_16x16x32_bf16 v[60:63], v[220:223], v[164:167], v[60:63]
buffer_load_dwordx4 v[196:199], v38, s[32:35], s57 offen offset:1024 sc1
v_mfma_f32_16x16x32_bf16 v[76:79], v[220:223], v[168:171], v[76:79]
ds_read_b64_tr_b16 v[100:101], v10 offset:45056
ds_read_b64_tr_b16 v[102:103], v10 offset:45568
v_mfma_f32_16x16x32_bf16 v[64:67], v[224:227], v[164:167], v[64:67]
ds_read_b64_tr_b16 v[104:105], v11 offset:45056
ds_read_b64_tr_b16 v[106:107], v11 offset:45568
v_mfma_f32_16x16x32_bf16 v[80:83], v[224:227], v[168:171], v[80:83]
buffer_load_dwordx4 v[200:203], v39, s[32:35], s57 offen offset:1024 sc1
v_mfma_f32_16x16x32_bf16 v[68:71], v[228:231], v[164:167], v[68:71]
ds_read_b64_tr_b16 v[108:109], v12 offset:45056
ds_read_b64_tr_b16 v[110:111], v12 offset:45568
v_mfma_f32_16x16x32_bf16 v[84:87], v[228:231], v[168:171], v[84:87]
ds_read_b64_tr_b16 v[112:113], v13 offset:45056
ds_read_b64_tr_b16 v[114:115], v13 offset:45568
v_mfma_f32_16x16x32_bf16 v[72:75], v[232:235], v[164:167], v[72:75]
s_add_u32 s57, s57, 2048
s_and_b32 s57, s57, 0x7fff
v_mfma_f32_16x16x32_bf16 v[88:91], v[232:235], v[168:171], v[88:91]
s_waitcnt vmcnt(6) lgkmcnt(8)
v_mfma_f32_16x16x32_bf16 v[60:63], v[236:239], v[172:175], v[60:63]
buffer_load_dwordx4 v[204:207], v38, s[32:35], s57 offen sc1
v_mfma_f32_16x16x32_bf16 v[76:79], v[236:239], v[176:179], v[76:79]
ds_read_b64_tr_b16 v[220:221], v10 offset:49152
ds_read_b64_tr_b16 v[222:223], v10 offset:49664
v_mfma_f32_16x16x32_bf16 v[64:67], v[240:243], v[172:175], v[64:67]
ds_read_b64_tr_b16 v[224:225], v11 offset:49152
ds_read_b64_tr_b16 v[226:227], v11 offset:49664
v_mfma_f32_16x16x32_bf16 v[80:83], v[240:243], v[176:179], v[80:83]
buffer_load_dwordx4 v[208:211], v39, s[32:35], s57 offen sc1
v_mfma_f32_16x16x32_bf16 v[68:71], v[244:247], v[172:175], v[68:71]
ds_read_b64_tr_b16 v[228:229], v12 offset:49152
ds_read_b64_tr_b16 v[230:231], v12 offset:49664
v_mfma_f32_16x16x32_bf16 v[84:87], v[244:247], v[176:179], v[84:87]
ds_read_b64_tr_b16 v[232:233], v13 offset:49152
ds_read_b64_tr_b16 v[234:235], v13 offset:49664
v_mfma_f32_16x16x32_bf16 v[72:75], v[248:251], v[172:175], v[72:75]
v_mfma_f32_16x16x32_bf16 v[88:91], v[248:251], v[176:179], v[88:91]
s_waitcnt vmcnt(6) lgkmcnt(8)
v_mfma_f32_16x16x32_bf16 v[60:63], v[100:103], v[180:183], v[60:63]
buffer_load_dwordx4 v[212:215], v38, s[32:35], s57 offen offset:1024 sc1
v_mfma_f32_16x16x32_bf16 v[76:79], v[100:103], v[184:187], v[76:79]
ds_read_b64_tr_b16 v[236:237], v10 offset:53248
ds_read_b64_tr_b16 v[238:239], v10 offset:53760
v_mfma_f32_16x16x32_bf16 v[64:67], v[104:107], v[180:183], v[64:67]
ds_read_b64_tr_b16 v[240:241], v11 offset:53248
ds_read_b64_tr_b16 v[242:243], v11 offset:53760
v_mfma_f32_16x16x32_bf16 v[80:83], v[104:107], v[184:187], v[80:83]
buffer_load_dwordx4 v[216:219], v39, s[32:35], s57 offen offset:1024 sc1
v_mfma_f32_16x16x32_bf16 v[68:71], v[108:111], v[180:183], v[68:71]
ds_read_b64_tr_b16 v[244:245], v12 offset:53248
ds_read_b64_tr_b16 v[246:247], v12 offset:53760
v_mfma_f32_16x16x32_bf16 v[84:87], v[108:111], v[184:187], v[84:87]
ds_read_b64_tr_b16 v[248:249], v13 offset:53248
ds_read_b64_tr_b16 v[250:251], v13 offset:53760
v_mfma_f32_16x16x32_bf16 v[72:75], v[112:115], v[180:183], v[72:75]
s_add_u32 s57, s57, 2048
s_and_b32 s57, s57, 0x7fff
v_mfma_f32_16x16x32_bf16 v[88:91], v[112:115], v[184:187], v[88:91]
s_waitcnt vmcnt(6) lgkmcnt(8)
v_mfma_f32_16x16x32_bf16 v[60:63], v[220:223], v[188:191], v[60:63]
buffer_load_dwordx4 v[156:159], v38, s[32:35], s57 offen sc1
v_mfma_f32_16x16x32_bf16 v[76:79], v[220:223], v[192:195], v[76:79]
ds_read_b64_tr_b16 v[100:101], v10 offset:57344
ds_read_b64_tr_b16 v[102:103], v10 offset:57856
v_mfma_f32_16x16x32_bf16 v[64:67], v[224:227], v[188:191], v[64:67]
ds_read_b64_tr_b16 v[104:105], v11 offset:57344
ds_read_b64_tr_b16 v[106:107], v11 offset:57856
v_mfma_f32_16x16x32_bf16 v[80:83], v[224:227], v[192:195], v[80:83]
buffer_load_dwordx4 v[160:163], v39, s[32:35], s57 offen sc1
v_mfma_f32_16x16x32_bf16 v[68:71], v[228:231], v[188:191], v[68:71]
ds_read_b64_tr_b16 v[108:109], v12 offset:57344
ds_read_b64_tr_b16 v[110:111], v12 offset:57856
v_mfma_f32_16x16x32_bf16 v[84:87], v[228:231], v[192:195], v[84:87]
ds_read_b64_tr_b16 v[112:113], v13 offset:57344
ds_read_b64_tr_b16 v[114:115], v13 offset:57856
v_mfma_f32_16x16x32_bf16 v[72:75], v[232:235], v[188:191], v[72:75]
v_mfma_f32_16x16x32_bf16 v[88:91], v[232:235], v[192:195], v[88:91]
s_waitcnt vmcnt(6) lgkmcnt(8)
v_mfma_f32_16x16x32_bf16 v[60:63], v[236:239], v[196:199], v[60:63]
buffer_load_dwordx4 v[164:167], v38, s[32:35], s57 offen offset:1024 sc1
v_mfma_f32_16x16x32_bf16 v[76:79], v[236:239], v[200:203], v[76:79]
ds_read_b64_tr_b16 v[220:221], v10 offset:61440
ds_read_b64_tr_b16 v[222:223], v10 offset:61952
v_mfma_f32_16x16x32_bf16 v[64:67], v[240:243], v[196:199], v[64:67]
ds_read_b64_tr_b16 v[224:225], v11 offset:61440
ds_read_b64_tr_b16 v[226:227], v11 offset:61952
v_mfma_f32_16x16x32_bf16 v[80:83], v[240:243], v[200:203], v[80:83]
buffer_load_dwordx4 v[168:171], v39, s[32:35], s57 offen offset:1024 sc1
v_mfma_f32_16x16x32_bf16 v[68:71], v[244:247], v[196:199], v[68:71]
ds_read_b64_tr_b16 v[228:229], v12 offset:61440
ds_read_b64_tr_b16 v[230:231], v12 offset:61952
v_mfma_f32_16x16x32_bf16 v[84:87], v[244:247], v[200:203], v[84:87]
ds_read_b64_tr_b16 v[232:233], v13 offset:61440
ds_read_b64_tr_b16 v[234:235], v13 offset:61952
v_mfma_f32_16x16x32_bf16 v[72:75], v[248:251], v[196:199], v[72:75]
s_add_u32 s57, s57, 2048
s_and_b32 s57, s57, 0x7fff
v_mfma_f32_16x16x32_bf16 v[88:91], v[248:251], v[200:203], v[88:91]
s_waitcnt vmcnt(6) lgkmcnt(8)
v_mfma_f32_16x16x32_bf16 v[60:63], v[100:103], v[204:207], v[60:63]
buffer_load_dwordx4 v[172:175], v38, s[32:35], s57 offen sc1
v_mfma_f32_16x16x32_bf16 v[76:79], v[100:103], v[208:211], v[76:79]
ds_read_b64_tr_b16 v[236:237], v14 offset:0
ds_read_b64_tr_b16 v[238:239], v14 offset:512
v_mfma_f32_16x16x32_bf16 v[64:67], v[104:107], v[204:207], v[64:67]
ds_read_b64_tr_b16 v[240:241], v15 offset:0
ds_read_b64_tr_b16 v[242:243], v15 offset:512
v_mfma_f32_16x16x32_bf16 v[80:83], v[104:107], v[208:211], v[80:83]
buffer_load_dwordx4 v[176:179], v39, s[32:35], s57 offen sc1
v_mfma_f32_16x16x32_bf16 v[68:71], v[108:111], v[204:207], v[68:71]
ds_read_b64_tr_b16 v[244:245], v16 offset:0
ds_read_b64_tr_b16 v[246:247], v16 offset:512
v_mfma_f32_16x16x32_bf16 v[84:87], v[108:111], v[208:211], v[84:87]
ds_read_b64_tr_b16 v[248:249], v17 offset:0
ds_read_b64_tr_b16 v[250:251], v17 offset:512
v_mfma_f32_16x16x32_bf16 v[72:75], v[112:115], v[204:207], v[72:75]
v_mfma_f32_16x16x32_bf16 v[88:91], v[112:115], v[208:211], v[88:91]
s_waitcnt vmcnt(6) lgkmcnt(8)
v_mfma_f32_16x16x32_bf16 v[60:63], v[220:223], v[212:215], v[60:63]
buffer_load_dwordx4 v[180:183], v38, s[32:35], s57 offen offset:1024 sc1
v_mfma_f32_16x16x32_bf16 v[76:79], v[220:223], v[216:219], v[76:79]
ds_read_b64_tr_b16 v[100:101], v14 offset:4096
ds_read_b64_tr_b16 v[102:103], v14 offset:4608
v_mfma_f32_16x16x32_bf16 v[64:67], v[224:227], v[212:215], v[64:67]
ds_read_b64_tr_b16 v[104:105], v15 offset:4096
ds_read_b64_tr_b16 v[106:107], v15 offset:4608
v_mfma_f32_16x16x32_bf16 v[80:83], v[224:227], v[216:219], v[80:83]
buffer_load_dwordx4 v[184:187], v39, s[32:35], s57 offen offset:1024 sc1
v_mfma_f32_16x16x32_bf16 v[68:71], v[228:231], v[212:215], v[68:71]
ds_read_b64_tr_b16 v[108:109], v16 offset:4096
ds_read_b64_tr_b16 v[110:111], v16 offset:4608
v_mfma_f32_16x16x32_bf16 v[84:87], v[228:231], v[216:219], v[84:87]
ds_read_b64_tr_b16 v[112:113], v17 offset:4096
ds_read_b64_tr_b16 v[114:115], v17 offset:4608
v_mfma_f32_16x16x32_bf16 v[72:75], v[232:235], v[212:215], v[72:75]
s_add_u32 s57, s57, 2048
s_and_b32 s57, s57, 0x7fff
v_mfma_f32_16x16x32_bf16 v[88:91], v[232:235], v[216:219], v[88:91]
s_waitcnt vmcnt(6) lgkmcnt(8)
v_mfma_f32_16x16x32_bf16 v[60:63], v[236:239], v[156:159], v[60:63]
buffer_load_dwordx4 v[188:191], v38, s[32:35], s57 offen sc1
v_mfma_f32_16x16x32_bf16 v[76:79], v[236:239], v[160:163], v[76:79]
ds_read_b64_tr_b16 v[220:221], v14 offset:8192
ds_read_b64_tr_b16 v[222:223], v14 offset:8704
v_mfma_f32_16x16x32_bf16 v[64:67], v[240:243], v[156:159], v[64:67]
ds_read_b64_tr_b16 v[224:225], v15 offset:8192
ds_read_b64_tr_b16 v[226:227], v15 offset:8704
v_mfma_f32_16x16x32_bf16 v[80:83], v[240:243], v[160:163], v[80:83]
buffer_load_dwordx4 v[192:195], v39, s[32:35], s57 offen sc1
v_mfma_f32_16x16x32_bf16 v[68:71], v[244:247], v[156:159], v[68:71]
ds_read_b64_tr_b16 v[228:229], v16 offset:8192
ds_read_b64_tr_b16 v[230:231], v16 offset:8704
v_mfma_f32_16x16x32_bf16 v[84:87], v[244:247], v[160:163], v[84:87]
ds_read_b64_tr_b16 v[232:233], v17 offset:8192
ds_read_b64_tr_b16 v[234:235], v17 offset:8704
v_mfma_f32_16x16x32_bf16 v[72:75], v[248:251], v[156:159], v[72:75]
v_mfma_f32_16x16x32_bf16 v[88:91], v[248:251], v[160:163], v[88:91]
s_waitcnt vmcnt(6) lgkmcnt(8)
v_mfma_f32_16x16x32_bf16 v[60:63], v[100:103], v[164:167], v[60:63]
buffer_load_dwordx4 v[196:199], v38, s[32:35], s57 offen offset:1024 sc1
v_mfma_f32_16x16x32_bf16 v[76:79], v[100:103], v[168:171], v[76:79]
ds_read_b64_tr_b16 v[236:237], v14 offset:12288
ds_read_b64_tr_b16 v[238:239], v14 offset:12800
v_mfma_f32_16x16x32_bf16 v[64:67], v[104:107], v[164:167], v[64:67]
ds_read_b64_tr_b16 v[240:241], v15 offset:12288
ds_read_b64_tr_b16 v[242:243], v15 offset:12800
v_mfma_f32_16x16x32_bf16 v[80:83], v[104:107], v[168:171], v[80:83]
buffer_load_dwordx4 v[200:203], v39, s[32:35], s57 offen offset:1024 sc1
v_mfma_f32_16x16x32_bf16 v[68:71], v[108:111], v[164:167], v[68:71]
ds_read_b64_tr_b16 v[244:245], v16 offset:12288
ds_read_b64_tr_b16 v[246:247], v16 offset:12800
v_mfma_f32_16x16x32_bf16 v[84:87], v[108:111], v[168:171], v[84:87]
ds_read_b64_tr_b16 v[248:249], v17 offset:12288
ds_read_b64_tr_b16 v[250:251], v17 offset:12800
v_mfma_f32_16x16x32_bf16 v[72:75], v[112:115], v[164:167], v[72:75]
s_add_u32 s57, s57, 2048
s_and_b32 s57, s57, 0x7fff
v_mfma_f32_16x16x32_bf16 v[88:91], v[112:115], v[168:171], v[88:91]
s_waitcnt vmcnt(6) lgkmcnt(8)
v_mfma_f32_16x16x32_bf16 v[60:63], v[220:223], v[172:175], v[60:63]
buffer_load_dwordx4 v[204:207], v38, s[32:35], s57 offen sc1
v_mfma_f32_16x16x32_bf16 v[76:79], v[220:223], v[176:179], v[76:79]
ds_read_b64_tr_b16 v[100:101], v14 offset:16384
ds_read_b64_tr_b16 v[102:103], v14 offset:16896
v_mfma_f32_16x16x32_bf16 v[64:67], v[224:227], v[172:175], v[64:67]
ds_read_b64_tr_b16 v[104:105], v15 offset:16384
ds_read_b64_tr_b16 v[106:107], v15 offset:16896
v_mfma_f32_16x16x32_bf16 v[80:83], v[224:227], v[176:179], v[80:83]
buffer_load_dwordx4 v[208:211], v39, s[32:35], s57 offen sc1
v_mfma_f32_16x16x32_bf16 v[68:71], v[228:231], v[172:175], v[68:71]
ds_read_b64_tr_b16 v[108:109], v16 offset:16384
ds_read_b64_tr_b16 v[110:111], v16 offset:16896
v_mfma_f32_16x16x32_bf16 v[84:87], v[228:231], v[176:179], v[84:87]
ds_read_b64_tr_b16 v[112:113], v17 offset:16384
ds_read_b64_tr_b16 v[114:115], v17 offset:16896
v_mfma_f32_16x16x32_bf16 v[72:75], v[232:235], v[172:175], v[72:75]
v_mfma_f32_16x16x32_bf16 v[88:91], v[232:235], v[176:179], v[88:91]
s_waitcnt vmcnt(6) lgkmcnt(8)
v_mfma_f32_16x16x32_bf16 v[60:63], v[236:239], v[180:183], v[60:63]
buffer_load_dwordx4 v[212:215], v38, s[32:35], s57 offen offset:1024 sc1
v_mfma_f32_16x16x32_bf16 v[76:79], v[236:239], v[184:187], v[76:79]
ds_read_b64_tr_b16 v[220:221], v14 offset:20480
ds_read_b64_tr_b16 v[222:223], v14 offset:20992
v_mfma_f32_16x16x32_bf16 v[64:67], v[240:243], v[180:183], v[64:67]
ds_read_b64_tr_b16 v[224:225], v15 offset:20480
ds_read_b64_tr_b16 v[226:227], v15 offset:20992
v_mfma_f32_16x16x32_bf16 v[80:83], v[240:243], v[184:187], v[80:83]
buffer_load_dwordx4 v[216:219], v39, s[32:35], s57 offen offset:1024 sc1
v_mfma_f32_16x16x32_bf16 v[68:71], v[244:247], v[180:183], v[68:71]
ds_read_b64_tr_b16 v[228:229], v16 offset:20480
ds_read_b64_tr_b16 v[230:231], v16 offset:20992
v_mfma_f32_16x16x32_bf16 v[84:87], v[244:247], v[184:187], v[84:87]
ds_read_b64_tr_b16 v[232:233], v17 offset:20480
ds_read_b64_tr_b16 v[234:235], v17 offset:20992
v_mfma_f32_16x16x32_bf16 v[72:75], v[248:251], v[180:183], v[72:75]
s_add_u32 s57, s57, 2048
s_and_b32 s57, s57, 0x7fff
v_mfma_f32_16x16x32_bf16 v[88:91], v[248:251], v[184:187], v[88:91]
s_waitcnt vmcnt(6) lgkmcnt(8)
v_mfma_f32_16x16x32_bf16 v[60:63], v[100:103], v[188:191], v[60:63]
buffer_load_dwordx4 v[156:159], v38, s[32:35], s57 offen sc1
v_mfma_f32_16x16x32_bf16 v[76:79], v[100:103], v[192:195], v[76:79]
ds_read_b64_tr_b16 v[236:237], v14 offset:24576
ds_read_b64_tr_b16 v[238:239], v14 offset:25088
v_mfma_f32_16x16x32_bf16 v[64:67], v[104:107], v[188:191], v[64:67]
ds_read_b64_tr_b16 v[240:241], v15 offset:24576
ds_read_b64_tr_b16 v[242:243], v15 offset:25088
v_mfma_f32_16x16x32_bf16 v[80:83], v[104:107], v[192:195], v[80:83]
buffer_load_dwordx4 v[160:163], v39, s[32:35], s57 offen sc1
v_mfma_f32_16x16x32_bf16 v[68:71], v[108:111], v[188:191], v[68:71]
ds_read_b64_tr_b16 v[244:245], v16 offset:24576
ds_read_b64_tr_b16 v[246:247], v16 offset:25088
v_mfma_f32_16x16x32_bf16 v[84:87], v[108:111], v[192:195], v[84:87]
ds_read_b64_tr_b16 v[248:249], v17 offset:24576
ds_read_b64_tr_b16 v[250:251], v17 offset:25088
v_mfma_f32_16x16x32_bf16 v[72:75], v[112:115], v[188:191], v[72:75]
v_mfma_f32_16x16x32_bf16 v[88:91], v[112:115], v[192:195], v[88:91]
s_waitcnt vmcnt(6) lgkmcnt(8)
v_mfma_f32_16x16x32_bf16 v[60:63], v[220:223], v[196:199], v[60:63]
buffer_load_dwordx4 v[164:167], v38, s[32:35], s57 offen offset:1024 sc1
v_mfma_f32_16x16x32_bf16 v[76:79], v[220:223], v[200:203], v[76:79]
ds_read_b64_tr_b16 v[100:101], v14 offset:28672
ds_read_b64_tr_b16 v[102:103], v14 offset:29184
v_mfma_f32_16x16x32_bf16 v[64:67], v[224:227], v[196:199], v[64:67]
ds_read_b64_tr_b16 v[104:105], v15 offset:28672
ds_read_b64_tr_b16 v[106:107], v15 offset:29184
v_mfma_f32_16x16x32_bf16 v[80:83], v[224:227], v[200:203], v[80:83]
buffer_load_dwordx4 v[168:171], v39, s[32:35], s57 offen offset:1024 sc1
v_mfma_f32_16x16x32_bf16 v[68:71], v[228:231], v[196:199], v[68:71]
ds_read_b64_tr_b16 v[108:109], v16 offset:28672
ds_read_b64_tr_b16 v[110:111], v16 offset:29184
v_mfma_f32_16x16x32_bf16 v[84:87], v[228:231], v[200:203], v[84:87]
ds_read_b64_tr_b16 v[112:113], v17 offset:28672
ds_read_b64_tr_b16 v[114:115], v17 offset:29184
v_mfma_f32_16x16x32_bf16 v[72:75], v[232:235], v[196:199], v[72:75]
s_add_u32 s57, s57, 2048
s_and_b32 s57, s57, 0x7fff
v_mfma_f32_16x16x32_bf16 v[88:91], v[232:235], v[200:203], v[88:91]
s_waitcnt vmcnt(6) lgkmcnt(8)
v_mfma_f32_16x16x32_bf16 v[60:63], v[236:239], v[204:207], v[60:63]
buffer_load_dwordx4 v[172:175], v38, s[32:35], s57 offen sc1
v_mfma_f32_16x16x32_bf16 v[76:79], v[236:239], v[208:211], v[76:79]
ds_read_b64_tr_b16 v[220:221], v14 offset:32768
ds_read_b64_tr_b16 v[222:223], v14 offset:33280
v_mfma_f32_16x16x32_bf16 v[64:67], v[240:243], v[204:207], v[64:67]
ds_read_b64_tr_b16 v[224:225], v15 offset:32768
ds_read_b64_tr_b16 v[226:227], v15 offset:33280
v_mfma_f32_16x16x32_bf16 v[80:83], v[240:243], v[208:211], v[80:83]
buffer_load_dwordx4 v[176:179], v39, s[32:35], s57 offen sc1
v_mfma_f32_16x16x32_bf16 v[68:71], v[244:247], v[204:207], v[68:71]
ds_read_b64_tr_b16 v[228:229], v16 offset:32768
ds_read_b64_tr_b16 v[230:231], v16 offset:33280
v_mfma_f32_16x16x32_bf16 v[84:87], v[244:247], v[208:211], v[84:87]
ds_read_b64_tr_b16 v[232:233], v17 offset:32768
ds_read_b64_tr_b16 v[234:235], v17 offset:33280
v_mfma_f32_16x16x32_bf16 v[72:75], v[248:251], v[204:207], v[72:75]
v_mfma_f32_16x16x32_bf16 v[88:91], v[248:251], v[208:211], v[88:91]
s_waitcnt vmcnt(6) lgkmcnt(8)
v_mfma_f32_16x16x32_bf16 v[60:63], v[100:103], v[212:215], v[60:63]
buffer_load_dwordx4 v[180:183], v38, s[32:35], s57 offen offset:1024 sc1
v_mfma_f32_16x16x32_bf16 v[76:79], v[100:103], v[216:219], v[76:79]
ds_read_b64_tr_b16 v[236:237], v14 offset:36864
ds_read_b64_tr_b16 v[238:239], v14 offset:37376
v_mfma_f32_16x16x32_bf16 v[64:67], v[104:107], v[212:215], v[64:67]
ds_read_b64_tr_b16 v[240:241], v15 offset:36864
ds_read_b64_tr_b16 v[242:243], v15 offset:37376
v_mfma_f32_16x16x32_bf16 v[80:83], v[104:107], v[216:219], v[80:83]
buffer_load_dwordx4 v[184:187], v39, s[32:35], s57 offen offset:1024 sc1
v_mfma_f32_16x16x32_bf16 v[68:71], v[108:111], v[212:215], v[68:71]
ds_read_b64_tr_b16 v[244:245], v16 offset:36864
ds_read_b64_tr_b16 v[246:247], v16 offset:37376
v_mfma_f32_16x16x32_bf16 v[84:87], v[108:111], v[216:219], v[84:87]
ds_read_b64_tr_b16 v[248:249], v17 offset:36864
ds_read_b64_tr_b16 v[250:251], v17 offset:37376
v_mfma_f32_16x16x32_bf16 v[72:75], v[112:115], v[212:215], v[72:75]
s_add_u32 s57, s57, 2048
s_and_b32 s57, s57, 0x7fff
v_mfma_f32_16x16x32_bf16 v[88:91], v[112:115], v[216:219], v[88:91]
s_waitcnt vmcnt(6) lgkmcnt(8)
v_mfma_f32_16x16x32_bf16 v[60:63], v[220:223], v[156:159], v[60:63]
buffer_load_dwordx4 v[188:191], v38, s[32:35], s57 offen sc1
v_mfma_f32_16x16x32_bf16 v[76:79], v[220:223], v[160:163], v[76:79]
ds_read_b64_tr_b16 v[100:101], v14 offset:40960
ds_read_b64_tr_b16 v[102:103], v14 offset:41472
v_mfma_f32_16x16x32_bf16 v[64:67], v[224:227], v[156:159], v[64:67]
ds_read_b64_tr_b16 v[104:105], v15 offset:40960
ds_read_b64_tr_b16 v[106:107], v15 offset:41472
v_mfma_f32_16x16x32_bf16 v[80:83], v[224:227], v[160:163], v[80:83]
buffer_load_dwordx4 v[192:195], v39, s[32:35], s57 offen sc1
v_mfma_f32_16x16x32_bf16 v[68:71], v[228:231], v[156:159], v[68:71]
ds_read_b64_tr_b16 v[108:109], v16 offset:40960
ds_read_b64_tr_b16 v[110:111], v16 offset:41472
v_mfma_f32_16x16x32_bf16 v[84:87], v[228:231], v[160:163], v[84:87]
ds_read_b64_tr_b16 v[112:113], v17 offset:40960
ds_read_b64_tr_b16 v[114:115], v17 offset:41472
v_mfma_f32_16x16x32_bf16 v[72:75], v[232:235], v[156:159], v[72:75]
v_mfma_f32_16x16x32_bf16 v[88:91], v[232:235], v[160:163], v[88:91]
s_waitcnt vmcnt(6) lgkmcnt(8)
v_mfma_f32_16x16x32_bf16 v[60:63], v[236:239], v[164:167], v[60:63]
buffer_load_dwordx4 v[196:199], v38, s[32:35], s57 offen offset:1024 sc1
v_mfma_f32_16x16x32_bf16 v[76:79], v[236:239], v[168:171], v[76:79]
ds_read_b64_tr_b16 v[220:221], v14 offset:45056
ds_read_b64_tr_b16 v[222:223], v14 offset:45568
v_mfma_f32_16x16x32_bf16 v[64:67], v[240:243], v[164:167], v[64:67]
ds_read_b64_tr_b16 v[224:225], v15 offset:45056
ds_read_b64_tr_b16 v[226:227], v15 offset:45568
v_mfma_f32_16x16x32_bf16 v[80:83], v[240:243], v[168:171], v[80:83]
buffer_load_dwordx4 v[200:203], v39, s[32:35], s57 offen offset:1024 sc1
v_mfma_f32_16x16x32_bf16 v[68:71], v[244:247], v[164:167], v[68:71]
ds_read_b64_tr_b16 v[228:229], v16 offset:45056
ds_read_b64_tr_b16 v[230:231], v16 offset:45568
v_mfma_f32_16x16x32_bf16 v[84:87], v[244:247], v[168:171], v[84:87]
ds_read_b64_tr_b16 v[232:233], v17 offset:45056
ds_read_b64_tr_b16 v[234:235], v17 offset:45568
v_mfma_f32_16x16x32_bf16 v[72:75], v[248:251], v[164:167], v[72:75]
s_add_u32 s57, s57, 2048
s_and_b32 s57, s57, 0x7fff
v_mfma_f32_16x16x32_bf16 v[88:91], v[248:251], v[168:171], v[88:91]
s_waitcnt vmcnt(6) lgkmcnt(8)
v_mfma_f32_16x16x32_bf16 v[60:63], v[100:103], v[172:175], v[60:63]
buffer_load_dwordx4 v[204:207], v38, s[32:35], s57 offen sc1
v_mfma_f32_16x16x32_bf16 v[76:79], v[100:103], v[176:179], v[76:79]
ds_read_b64_tr_b16 v[236:237], v14 offset:49152
ds_read_b64_tr_b16 v[238:239], v14 offset:49664
v_mfma_f32_16x16x32_bf16 v[64:67], v[104:107], v[172:175], v[64:67]
ds_read_b64_tr_b16 v[240:241], v15 offset:49152
ds_read_b64_tr_b16 v[242:243], v15 offset:49664
v_mfma_f32_16x16x32_bf16 v[80:83], v[104:107], v[176:179], v[80:83]
buffer_load_dwordx4 v[208:211], v39, s[32:35], s57 offen sc1
v_mfma_f32_16x16x32_bf16 v[68:71], v[108:111], v[172:175], v[68:71]
ds_read_b64_tr_b16 v[244:245], v16 offset:49152
ds_read_b64_tr_b16 v[246:247], v16 offset:49664
v_mfma_f32_16x16x32_bf16 v[84:87], v[108:111], v[176:179], v[84:87]
ds_read_b64_tr_b16 v[248:249], v17 offset:49152
ds_read_b64_tr_b16 v[250:251], v17 offset:49664
v_mfma_f32_16x16x32_bf16 v[72:75], v[112:115], v[172:175], v[72:75]
v_mfma_f32_16x16x32_bf16 v[88:91], v[112:115], v[176:179], v[88:91]
s_waitcnt vmcnt(6) lgkmcnt(8)
v_mfma_f32_16x16x32_bf16 v[60:63], v[220:223], v[180:183], v[60:63]
buffer_load_dwordx4 v[212:215], v38, s[32:35], s57 offen offset:1024 sc1
v_mfma_f32_16x16x32_bf16 v[76:79], v[220:223], v[184:187], v[76:79]
ds_read_b64_tr_b16 v[100:101], v14 offset:53248
ds_read_b64_tr_b16 v[102:103], v14 offset:53760
v_mfma_f32_16x16x32_bf16 v[64:67], v[224:227], v[180:183], v[64:67]
ds_read_b64_tr_b16 v[104:105], v15 offset:53248
ds_read_b64_tr_b16 v[106:107], v15 offset:53760
v_mfma_f32_16x16x32_bf16 v[80:83], v[224:227], v[184:187], v[80:83]
buffer_load_dwordx4 v[216:219], v39, s[32:35], s57 offen offset:1024 sc1
v_mfma_f32_16x16x32_bf16 v[68:71], v[228:231], v[180:183], v[68:71]
ds_read_b64_tr_b16 v[108:109], v16 offset:53248
ds_read_b64_tr_b16 v[110:111], v16 offset:53760
v_mfma_f32_16x16x32_bf16 v[84:87], v[228:231], v[184:187], v[84:87]
ds_read_b64_tr_b16 v[112:113], v17 offset:53248
ds_read_b64_tr_b16 v[114:115], v17 offset:53760
v_mfma_f32_16x16x32_bf16 v[72:75], v[232:235], v[180:183], v[72:75]
v_mfma_f32_16x16x32_bf16 v[88:91], v[232:235], v[184:187], v[88:91]
s_waitcnt vmcnt(6) lgkmcnt(8)
v_mfma_f32_16x16x32_bf16 v[60:63], v[236:239], v[188:191], v[60:63]
v_mfma_f32_16x16x32_bf16 v[76:79], v[236:239], v[192:195], v[76:79]
ds_read_b64_tr_b16 v[220:221], v14 offset:57344
ds_read_b64_tr_b16 v[222:223], v14 offset:57856
v_mfma_f32_16x16x32_bf16 v[64:67], v[240:243], v[188:191], v[64:67]
ds_read_b64_tr_b16 v[224:225], v15 offset:57344
ds_read_b64_tr_b16 v[226:227], v15 offset:57856
v_mfma_f32_16x16x32_bf16 v[80:83], v[240:243], v[192:195], v[80:83]
v_mfma_f32_16x16x32_bf16 v[68:71], v[244:247], v[188:191], v[68:71]
ds_read_b64_tr_b16 v[228:229], v16 offset:57344
ds_read_b64_tr_b16 v[230:231], v16 offset:57856
v_mfma_f32_16x16x32_bf16 v[84:87], v[244:247], v[192:195], v[84:87]
ds_read_b64_tr_b16 v[232:233], v17 offset:57344
ds_read_b64_tr_b16 v[234:235], v17 offset:57856
v_mfma_f32_16x16x32_bf16 v[72:75], v[248:251], v[188:191], v[72:75]
v_mfma_f32_16x16x32_bf16 v[88:91], v[248:251], v[192:195], v[88:91]
s_waitcnt vmcnt(4) lgkmcnt(8)
v_mfma_f32_16x16x32_bf16 v[60:63], v[100:103], v[196:199], v[60:63]
v_mfma_f32_16x16x32_bf16 v[76:79], v[100:103], v[200:203], v[76:79]
ds_read_b64_tr_b16 v[236:237], v14 offset:61440
ds_read_b64_tr_b16 v[238:239], v14 offset:61952
v_mfma_f32_16x16x32_bf16 v[64:67], v[104:107], v[196:199], v[64:67]
ds_read_b64_tr_b16 v[240:241], v15 offset:61440
ds_read_b64_tr_b16 v[242:243], v15 offset:61952
v_mfma_f32_16x16x32_bf16 v[80:83], v[104:107], v[200:203], v[80:83]
v_mfma_f32_16x16x32_bf16 v[68:71], v[108:111], v[196:199], v[68:71]
ds_read_b64_tr_b16 v[244:245], v16 offset:61440
ds_read_b64_tr_b16 v[246:247], v16 offset:61952
v_mfma_f32_16x16x32_bf16 v[84:87], v[108:111], v[200:203], v[84:87]
ds_read_b64_tr_b16 v[248:249], v17 offset:61440
ds_read_b64_tr_b16 v[250:251], v17 offset:61952
v_mfma_f32_16x16x32_bf16 v[72:75], v[112:115], v[196:199], v[72:75]
v_mfma_f32_16x16x32_bf16 v[88:91], v[112:115], v[200:203], v[88:91]
s_waitcnt vmcnt(2) lgkmcnt(8)
v_mfma_f32_16x16x32_bf16 v[60:63], v[220:223], v[204:207], v[60:63]
v_mfma_f32_16x16x32_bf16 v[76:79], v[220:223], v[208:211], v[76:79]
v_mfma_f32_16x16x32_bf16 v[64:67], v[224:227], v[204:207], v[64:67]
v_mfma_f32_16x16x32_bf16 v[80:83], v[224:227], v[208:211], v[80:83]
v_mfma_f32_16x16x32_bf16 v[68:71], v[228:231], v[204:207], v[68:71]
v_mfma_f32_16x16x32_bf16 v[84:87], v[228:231], v[208:211], v[84:87]
v_mfma_f32_16x16x32_bf16 v[72:75], v[232:235], v[204:207], v[72:75]
v_mfma_f32_16x16x32_bf16 v[88:91], v[232:235], v[208:211], v[88:91]
s_waitcnt vmcnt(0) lgkmcnt(0)
v_mfma_f32_16x16x32_bf16 v[60:63], v[236:239], v[212:215], v[60:63]
v_mfma_f32_16x16x32_bf16 v[64:67], v[240:243], v[212:215], v[64:67]
v_mfma_f32_16x16x32_bf16 v[68:71], v[244:247], v[212:215], v[68:71]
v_mfma_f32_16x16x32_bf16 v[72:75], v[248:251], v[212:215], v[72:75]
v_mfma_f32_16x16x32_bf16 v[76:79], v[236:239], v[216:219], v[76:79]
v_mfma_f32_16x16x32_bf16 v[80:83], v[240:243], v[216:219], v[80:83]
v_mfma_f32_16x16x32_bf16 v[84:87], v[244:247], v[216:219], v[84:87]
v_mfma_f32_16x16x32_bf16 v[88:91], v[248:251], v[216:219], v[88:91]
s_cmp_eq_u32 s46, 0
s_cbranch_scc1 slow_58
s_nop 0
v_cvt_pk_bf16_f32 v20, v60, v61
v_cvt_pk_bf16_f32 v21, v62, v63
v_cvt_pk_bf16_f32 v22, v64, v65
v_cvt_pk_bf16_f32 v23, v66, v67
buffer_store_dwordx4 v[20:23], v18, s[32:35], s85 offen offset:0 sc1
v_cvt_pk_bf16_f32 v24, v68, v69
v_cvt_pk_bf16_f32 v25, v70, v71
v_cvt_pk_bf16_f32 v26, v72, v73
v_cvt_pk_bf16_f32 v27, v74, v75
buffer_store_dwordx4 v[24:27], v18, s[32:35], s85 offen offset:1024 sc1
v_cvt_pk_bf16_f32 v28, v76, v77
v_cvt_pk_bf16_f32 v29, v78, v79
v_cvt_pk_bf16_f32 v30, v80, v81
v_cvt_pk_bf16_f32 v31, v82, v83
buffer_store_dwordx4 v[28:31], v18, s[32:35], s86 offen offset:0 sc1
v_cvt_pk_bf16_f32 v32, v84, v85
v_cvt_pk_bf16_f32 v33, v86, v87
v_cvt_pk_bf16_f32 v34, v88, v89
v_cvt_pk_bf16_f32 v35, v90, v91
buffer_store_dwordx4 v[32:35], v18, s[32:35], s86 offen offset:1024 sc1
s_barrier
v_dot2c_f32_bf16 v6, v20, v48
v_dot2c_f32_bf16 v8, v20, v20
v_dot2c_f32_bf16 v7, v28, v48
v_dot2c_f32_bf16 v9, v28, v28
v_dot2c_f32_bf16 v6, v21, v48
v_dot2c_f32_bf16 v8, v21, v21
v_dot2c_f32_bf16 v7, v29, v48
v_dot2c_f32_bf16 v9, v29, v29
v_dot2c_f32_bf16 v6, v22, v48
v_dot2c_f32_bf16 v8, v22, v22
v_dot2c_f32_bf16 v7, v30, v48
v_dot2c_f32_bf16 v9, v30, v30
v_dot2c_f32_bf16 v6, v23, v48
v_dot2c_f32_bf16 v8, v23, v23
v_dot2c_f32_bf16 v7, v31, v48
v_dot2c_f32_bf16 v9, v31, v31
v_dot2c_f32_bf16 v6, v24, v48
v_dot2c_f32_bf16 v8, v24, v24
v_dot2c_f32_bf16 v7, v32, v48
v_dot2c_f32_bf16 v9, v32, v32
v_dot2c_f32_bf16 v6, v25, v48
v_dot2c_f32_bf16 v8, v25, v25
v_dot2c_f32_bf16 v7, v33, v48
v_dot2c_f32_bf16 v9, v33, v33
v_dot2c_f32_bf16 v6, v26, v48
v_dot2c_f32_bf16 v8, v26, v26
v_dot2c_f32_bf16 v7, v34, v48
v_dot2c_f32_bf16 v9, v34, v34
v_dot2c_f32_bf16 v6, v27, v48
v_dot2c_f32_bf16 v8, v27, v27
v_dot2c_f32_bf16 v7, v35, v48
v_dot2c_f32_bf16 v9, v35, v35
s_mov_b64 exec, 1
s_waitcnt vmcnt(0)
buffer_store_dword v5, v4, s[32:35], s88 offen
s_mov_b64 exec, -1
s_nop 1
v_permlane32_swap_b32 v6, v7
v_permlane32_swap_b32 v8, v9
v_add_f32 v6, v6, v7
v_add_f32 v8, v8, v9
s_nop 1
v_permlane16_swap_b32 v6, v8
s_nop 0
v_add_f32 v6, v6, v8
buffer_store_dword v6, v1, s[32:35], s87 offen
back_59:
s_lshl_b32 s49, s44, 13
v_add_u32 v10, s49, v18
v_add_u32 v11, 1024, v10
s_lshl_b32 s48, s43, 1
v_lshrrev_b32 v4, 2, v2
v_and_b32 v5, 3, v0
v_lshl_add_u32 v6, v3, 3, v4
v_lshlrev_b32 v6, 7, v6
v_lshl_add_u32 v6, v5, 3, v6
v_lshrrev_b32 v7, 1, v4
v_and_b32 v8, 1, v3
v_lshl_add_u32 v7, v8, 1, v7
v_xor_b32 v7, s48, v7
v_lshl_add_u32 v12, v7, 5, v6
v_add_u32 v12, 16384, v12
v_xor_b32 v13, 32, v12
v_mov_b32 v14, v10
v_mov_b32 v15, v11
v_add_u32 v16, 122880, v12
v_add_u32 v17, 122880, v13
v_mov_b32 v156, 0
v_mov_b32 v157, 0
v_mov_b32 v158, 0
v_mov_b32 v159, 0
v_mov_b32 v160, 0
v_mov_b32 v161, 0
v_mov_b32 v162, 0
v_mov_b32 v163, 0
v_mov_b32 v164, 0
v_mov_b32 v165, 0
v_mov_b32 v166, 0
v_mov_b32 v167, 0
v_mov_b32 v168, 0
v_mov_b32 v169, 0
v_mov_b32 v170, 0
v_mov_b32 v171, 0
v_mov_b32 v172, 0
v_mov_b32 v173, 0
v_mov_b32 v174, 0
v_mov_b32 v175, 0
v_mov_b32 v176, 0
v_mov_b32 v177, 0
v_mov_b32 v178, 0
v_mov_b32 v179, 0
v_mov_b32 v180, 0
v_mov_b32 v181, 0
v_mov_b32 v182, 0
v_mov_b32 v183, 0
v_mov_b32 v184, 0
v_mov_b32 v185, 0
v_mov_b32 v186, 0
v_mov_b32 v187, 0
v_mov_b32 v188, 0
v_mov_b32 v189, 0
v_mov_b32 v190, 0
v_mov_b32 v191, 0
v_mov_b32 v192, 0
v_mov_b32 v193, 0
v_mov_b32 v194, 0
v_mov_b32 v195, 0
v_mov_b32 v196, 0
v_mov_b32 v197, 0
v_mov_b32 v198, 0
v_mov_b32 v199, 0
v_mov_b32 v200, 0
v_mov_b32 v201, 0
v_mov_b32 v202, 0
v_mov_b32 v203, 0
v_mov_b32 v204, 0
v_mov_b32 v205, 0
v_mov_b32 v206, 0
v_mov_b32 v207, 0
v_mov_b32 v208, 0
v_mov_b32 v209, 0
v_mov_b32 v210, 0
v_mov_b32 v211, 0
v_mov_b32 v212, 0
v_mov_b32 v213, 0
v_mov_b32 v214, 0
v_mov_b32 v215, 0
v_mov_b32 v216, 0
v_mov_b32 v217, 0
v_mov_b32 v218, 0
v_mov_b32 v219, 0
v_mov_b32 v220, 0
v_mov_b32 v221, 0
v_mov_b32 v222, 0
v_mov_b32 v223, 0
v_mov_b32 v224, 0
v_mov_b32 v225, 0
v_mov_b32 v226, 0
v_mov_b32 v227, 0
v_mov_b32 v228, 0
v_mov_b32 v229, 0
v_mov_b32 v230, 0
v_mov_b32 v231, 0
v_mov_b32 v232, 0
v_mov_b32 v233, 0
v_mov_b32 v234, 0
v_mov_b32 v235, 0
v_mov_b32 v236, 0
v_mov_b32 v237, 0
v_mov_b32 v238, 0
v_mov_b32 v239, 0
v_mov_b32 v240, 0
v_mov_b32 v241, 0
v_mov_b32 v242, 0
v_mov_b32 v243, 0
v_mov_b32 v244, 0
v_mov_b32 v245, 0
v_mov_b32 v246, 0
v_mov_b32 v247, 0
v_mov_b32 v248, 0
v_mov_b32 v249, 0
v_mov_b32 v250, 0
v_mov_b32 v251, 0
v_lshrrev_b32 v6, 2, v2
v_cmp_eq_u32 vcc, v6, v3
v_and_b32 v7, 1, v0
v_lshlrev_b32 v7, 4, v7
v_mov_b32 v8, 0x3f80
v_lshlrev_b32 v9, v7, v8
v_cndmask_b32 v7, 0, v9, vcc
v_and_b32 v6, 2, v0
v_cmp_eq_u32 vcc, 0, v6
v_mov_b32 v36, 0
v_mov_b32 v37, 0
v_mov_b32 v40, 0
v_mov_b32 v41, 0
v_cndmask_b32 v38, 0, v7, vcc
v_cndmask_b32 v39, v7, 0, vcc
v_lshrrev_b32 v8, 1, v2
v_cmp_eq_u32 vcc, 0, v8
s_nop 1
v_cndmask_b32 v44, 0, v9, vcc
v_cmp_eq_u32 vcc, 1, v8
s_nop 1
v_cndmask_b32 v45, 0, v9, vcc
v_cmp_eq_u32 vcc, 2, v8
s_nop 1
v_cndmask_b32 v46, 0, v9, vcc
v_cmp_eq_u32 vcc, 3, v8
s_nop 1
v_cndmask_b32 v47, 0, v9, vcc
v_lshrrev_b32 v4, 2, v2
v_lshl_add_u32 v4, v3, 2, v4
v_lshlrev_b32 v4, 6, v4
v_and_b32 v5, 3, v0
v_lshl_add_u32 v4, v5, 3, v4
s_lshl_b32 s48, s43, 11
s_add_u32 s48, s48, 135168
v_add_u32 v53, s48, v4
s_mul_i32 s48, s40, 3072
s_add_u32 s48, s48, 139264
v_add_u32 v42, s48, v18
s_xor_b32 s49, s40, 2
s_mul_i32 s48, s49, 3072
s_add_u32 s48, s48, 139264
v_add_u32 v43, s48, v18
s_lshl_b32 s49, s49, 2
s_add_u32 s49, s49, 134672
v_mov_b32 v19, s49
v_xor_b32 v52, 8, v19
v_lshrrev_b32 v4, 3, v0
v_and_b32 v5, 7, v0
v_lshlrev_b32 v4, 11, v4
v_lshl_add_u32 v55, v5, 4, v4
v_lshlrev_b32 v4, 6, v2
v_lshl_add_u32 v58, v3, 4, v4
v_lshlrev_b32 v4, 4, v2
v_lshl_add_u32 v59, v3, 3, v4
s_mul_i32 s51, s42, 393216
s_add_u32 s51, s51, 9437184
s_lshl_b32 s50, s43, 1
s_add_u32 s50, s50, s44
s_lshl_b32 s48, s50, 15
s_add_u32 s48, s48, s51
s_add_u32 s48, s48, 0
s_lshl_b32 s49, s41, 7
s_add_u32 s53, s48, s49
s_add_u32 s54, s53, 16384
s_lshl_b32 s56, s50, 10
s_add_u32 s56, s56, s51
s_add_u32 s56, s56, 344064
s_xor_b32 s57, s56, 1024
s_lshl_b32 s58, s50, 11
s_add_u32 s58, s58, s51
s_add_u32 s58, s58, 327680
s_xor_b32 s59, s58, 2048
s_add_u32 s79, s58, s49
s_lshl_b32 s50, s41, 11
s_add_u32 s55, s48, s50
s_lshl_b32 s48, s43, 7
s_add_u32 s48, s48, 133888
v_lshl_add_u32 v7, v3, 4, s48
v_lshl_add_u32 v54, v2, 2, s48
s_lshl_b32 s49, s44, 6
v_add_u32 v8, s49, v2
v_lshlrev_b32 v8, 3, v8
v_add_u32 v8, 131072, v8
v_lshl_add_u32 v9, v3, 2, s49
v_lshlrev_b32 v9, 2, v9
v_add_u32 v9, 132096, v9
s_mov_b32 s64, 0
s_mov_b32 s65, 0
s_mov_b32 s66, 0x3fb8aa3b
s_mov_b32 s77, s74
s_add_u32 s77, s77, 4
s_lshl_b32 s50, s42, 2
s_add_u32 s50, s50, s40
s_lshl_b32 s50, s50, 4
s_add_u32 s50, s50, s41
s_lshl_b32 s50, s50, 8
s_add_u32 s52, s50, 18087936
s_barrier
ds_read_b128 v[60:63], v14 offset:0
ds_read_b128 v[64:67], v14 offset:2048
ds_read_b128 v[68:71], v14 offset:4096
ds_read_b128 v[72:75], v14 offset:6144
ds_read_b64_tr_b16 v[84:85], v16 offset:8192
ds_read_b64_tr_b16 v[86:87], v16 offset:8704
ds_read_b64_tr_b16 v[88:89], v17 offset:8192
ds_read_b64_tr_b16 v[90:91], v17 offset:8704
ds_read_b64_tr_b16 v[92:93], v16 offset:16384
ds_read_b64_tr_b16 v[94:95], v16 offset:16896
ds_read_b64_tr_b16 v[96:97], v17 offset:16384
ds_read_b64_tr_b16 v[98:99], v17 offset:16896
ds_read_b64_tr_b16 v[76:77], v16 offset:0
ds_read_b64_tr_b16 v[78:79], v16 offset:512
ds_read_b64_tr_b16 v[80:81], v17 offset:0
ds_read_b64_tr_b16 v[82:83], v17 offset:512
s_waitcnt lgkmcnt(0)
c1_loop:
v_mfma_f32_16x16x32_bf16 v[212:215], v[84:87], v[72:75], v[212:215]
ds_read_b128 v[100:103], v15 offset:0
v_mfma_f32_16x16x32_bf16 v[204:207], v[84:87], v[68:71], v[204:207]
ds_read_b128 v[104:107], v15 offset:2048
v_mfma_f32_16x16x32_bf16 v[196:199], v[84:87], v[64:67], v[196:199]
ds_read_b128 v[108:111], v15 offset:4096
v_mfma_f32_16x16x32_bf16 v[188:191], v[84:87], v[60:63], v[188:191]
ds_read_b128 v[112:115], v15 offset:6144
v_mfma_f32_16x16x32_bf16 v[192:195], v[88:91], v[60:63], v[192:195]
ds_read_b64_tr_b16 v[124:125], v16 offset:12288
v_mfma_f32_16x16x32_bf16 v[200:203], v[88:91], v[64:67], v[200:203]
ds_read_b64_tr_b16 v[126:127], v16 offset:12800
v_mfma_f32_16x16x32_bf16 v[208:211], v[88:91], v[68:71], v[208:211]
ds_read_b64_tr_b16 v[128:129], v17 offset:12288
v_mfma_f32_16x16x32_bf16 v[216:219], v[88:91], v[72:75], v[216:219]
ds_read_b64_tr_b16 v[130:131], v17 offset:12800
v_mfma_f32_16x16x32_bf16 v[244:247], v[72:75], v[92:95], v[244:247]
ds_read_b64_tr_b16 v[132:133], v16 offset:20480
v_mfma_f32_16x16x32_bf16 v[236:239], v[68:71], v[92:95], v[236:239]
ds_read_b64_tr_b16 v[134:135], v16 offset:20992
v_mfma_f32_16x16x32_bf16 v[228:231], v[64:67], v[92:95], v[228:231]
ds_read_b64_tr_b16 v[136:137], v17 offset:20480
v_mfma_f32_16x16x32_bf16 v[220:223], v[60:63], v[92:95], v[220:223]
ds_read_b64_tr_b16 v[138:139], v17 offset:20992
v_mfma_f32_16x16x32_bf16 v[224:227], v[60:63], v[96:99], v[224:227]
ds_read_b64_tr_b16 v[116:117], v16 offset:4096
v_mfma_f32_16x16x32_bf16 v[232:235], v[64:67], v[96:99], v[232:235]
ds_read_b64_tr_b16 v[118:119], v16 offset:4608
v_mfma_f32_16x16x32_bf16 v[240:243], v[68:71], v[96:99], v[240:243]
ds_read_b64_tr_b16 v[120:121], v17 offset:4096
v_mfma_f32_16x16x32_bf16 v[248:251], v[72:75], v[96:99], v[248:251]
ds_read_b64_tr_b16 v[122:123], v17 offset:4608
v_mfma_f32_16x16x32_bf16 v[180:183], v[76:79], v[72:75], v[180:183]
s_cmp_eq_u32 s77, s64
s_cbranch_scc1 c1_hook
c1_hook_ret:
v_mfma_f32_16x16x32_bf16 v[172:175], v[76:79], v[68:71], v[172:175]
s_add_u32 s65, s65, 40960
s_cmp_eq_u32 s65, 122880
v_mfma_f32_16x16x32_bf16 v[164:167], v[76:79], v[64:67], v[164:167]
s_cselect_b32 s65, 0, s65
s_add_u32 s64, s64, 1
v_mfma_f32_16x16x32_bf16 v[156:159], v[76:79], v[60:63], v[156:159]
v_add_u32 v14, s65, v10
v_add_u32 v15, s65, v11
v_mfma_f32_16x16x32_bf16 v[160:163], v[80:83], v[60:63], v[160:163]
v_add_u32 v16, s65, v12
v_add_u32 v17, s65, v13
v_mfma_f32_16x16x32_bf16 v[168:171], v[80:83], v[64:67], v[168:171]
s_cmp_eq_u32 s64, 16
s_cbranch_scc1 c1_last
v_mfma_f32_16x16x32_bf16 v[176:179], v[80:83], v[68:71], v[176:179]
s_waitcnt lgkmcnt(0)
v_mfma_f32_16x16x32_bf16 v[184:187], v[80:83], v[72:75], v[184:187]
s_barrier
v_mfma_f32_16x16x32_bf16 v[212:215], v[124:127], v[112:115], v[212:215]
ds_read_b128 v[60:63], v14 offset:0
v_mfma_f32_16x16x32_bf16 v[204:207], v[124:127], v[108:111], v[204:207]
ds_read_b128 v[64:67], v14 offset:2048
v_mfma_f32_16x16x32_bf16 v[196:199], v[124:127], v[104:107], v[196:199]
ds_read_b128 v[68:71], v14 offset:4096
v_mfma_f32_16x16x32_bf16 v[188:191], v[124:127], v[100:103], v[188:191]
ds_read_b128 v[72:75], v14 offset:6144
v_mfma_f32_16x16x32_bf16 v[192:195], v[128:131], v[100:103], v[192:195]
ds_read_b64_tr_b16 v[84:85], v16 offset:8192
v_mfma_f32_16x16x32_bf16 v[200:203], v[128:131], v[104:107], v[200:203]
ds_read_b64_tr_b16 v[86:87], v16 offset:8704
v_mfma_f32_16x16x32_bf16 v[208:211], v[128:131], v[108:111], v[208:211]
ds_read_b64_tr_b16 v[88:89], v17 offset:8192
v_mfma_f32_16x16x32_bf16 v[216:219], v[128:131], v[112:115], v[216:219]
ds_read_b64_tr_b16 v[90:91], v17 offset:8704
v_mfma_f32_16x16x32_bf16 v[244:247], v[112:115], v[132:135], v[244:247]
ds_read_b64_tr_b16 v[92:93], v16 offset:16384
v_mfma_f32_16x16x32_bf16 v[236:239], v[108:111], v[132:135], v[236:239]
ds_read_b64_tr_b16 v[94:95], v16 offset:16896
v_mfma_f32_16x16x32_bf16 v[228:231], v[104:107], v[132:135], v[228:231]
ds_read_b64_tr_b16 v[96:97], v17 offset:16384
v_mfma_f32_16x16x32_bf16 v[220:223], v[100:103], v[132:135], v[220:223]
ds_read_b64_tr_b16 v[98:99], v17 offset:16896
v_mfma_f32_16x16x32_bf16 v[224:227], v[100:103], v[136:139], v[224:227]
ds_read_b64_tr_b16 v[76:77], v16 offset:0
v_mfma_f32_16x16x32_bf16 v[232:235], v[104:107], v[136:139], v[232:235]
ds_read_b64_tr_b16 v[78:79], v16 offset:512
v_mfma_f32_16x16x32_bf16 v[240:243], v[108:111], v[136:139], v[240:243]
ds_read_b64_tr_b16 v[80:81], v17 offset:0
v_mfma_f32_16x16x32_bf16 v[248:251], v[112:115], v[136:139], v[248:251]
ds_read_b64_tr_b16 v[82:83], v17 offset:512
v_mfma_f32_16x16x32_bf16 v[180:183], v[116:119], v[112:115], v[180:183]
v_mfma_f32_16x16x32_bf16 v[172:175], v[116:119], v[108:111], v[172:175]
v_mfma_f32_16x16x32_bf16 v[164:167], v[116:119], v[104:107], v[164:167]
v_mfma_f32_16x16x32_bf16 v[156:159], v[116:119], v[100:103], v[156:159]
v_mfma_f32_16x16x32_bf16 v[160:163], v[120:123], v[100:103], v[160:163]
v_mfma_f32_16x16x32_bf16 v[168:171], v[120:123], v[104:107], v[168:171]
v_mfma_f32_16x16x32_bf16 v[176:179], v[120:123], v[108:111], v[176:179]
s_waitcnt lgkmcnt(0)
v_mfma_f32_16x16x32_bf16 v[184:187], v[120:123], v[112:115], v[184:187]
s_branch c1_loop
c1_hook:
s_waitcnt lgkmcnt(0)
s_cmp_lg_u32 s44, 0
s_cbranch_scc1 else_60
v_mfma_f32_16x16x32_bf16 v[140:143], v[48:51], v[76:79], 0
v_mfma_f32_16x16x32_bf16 v[144:147], v[48:51], v[84:87], 0
v_mfma_f32_16x16x32_bf16 v[148:151], v[48:51], v[92:95], 0
v_mfma_f32_16x16x32_bf16 v[140:143], v[48:51], v[116:119], v[140:143]
v_mfma_f32_16x16x32_bf16 v[144:147], v[48:51], v[124:127], v[144:147]
v_mfma_f32_16x16x32_bf16 v[148:151], v[48:51], v[132:135], v[148:151]
s_branch fi_61
else_60:
v_mfma_f32_16x16x32_bf16 v[140:143], v[48:51], v[80:83], 0
v_mfma_f32_16x16x32_bf16 v[144:147], v[48:51], v[88:91], 0
v_mfma_f32_16x16x32_bf16 v[148:151], v[48:51], v[96:99], 0
v_mfma_f32_16x16x32_bf16 v[140:143], v[48:51], v[120:123], v[140:143]
v_mfma_f32_16x16x32_bf16 v[144:147], v[48:51], v[128:131], v[144:147]
v_mfma_f32_16x16x32_bf16 v[148:151], v[48:51], v[136:139], v[148:151]
fi_61:
s_nop 4
v_cmp_eq_u32 vcc, 0, v3
v_cmp_eq_u32 s[48:49], 1, v3
s_nop 1
v_cndmask_b32 v4, v148, v144, s[48:49]
v_cndmask_b32 v4, v4, v140, vcc
buffer_store_dword v4, v1, s[32:35], s52 offen sc1
s_branch c1_hook_ret
c1_last:
v_mfma_f32_16x16x32_bf16 v[176:179], v[80:83], v[68:71], v[176:179]
s_waitcnt lgkmcnt(0)
v_mfma_f32_16x16x32_bf16 v[184:187], v[80:83], v[72:75], v[184:187]
s_barrier
v_mfma_f32_16x16x32_bf16 v[212:215], v[124:127], v[112:115], v[212:215]
ds_read_b128 v[140:143], v7 offset:0
v_mfma_f32_16x16x32_bf16 v[204:207], v[124:127], v[108:111], v[204:207]
ds_read_b128 v[144:147], v7 offset:64
v_mfma_f32_16x16x32_bf16 v[196:199], v[124:127], v[104:107], v[196:199]
ds_read_b128 v[148:151], v7 offset:256
v_mfma_f32_16x16x32_bf16 v[188:191], v[124:127], v[100:103], v[188:191]
ds_read_b128 v[152:155], v7 offset:320
v_mfma_f32_16x16x32_bf16 v[192:195], v[128:131], v[100:103], v[192:195]
ds_read_b64 v[92:93], v8 offset:0
v_mfma_f32_16x16x32_bf16 v[200:203], v[128:131], v[104:107], v[200:203]
ds_read_b64 v[94:95], v8 offset:128
v_mfma_f32_16x16x32_bf16 v[208:211], v[128:131], v[108:111], v[208:211]
ds_read_b64 v[96:97], v8 offset:256
v_mfma_f32_16x16x32_bf16 v[216:219], v[128:131], v[112:115], v[216:219]
ds_read_b64 v[98:99], v8 offset:384
v_mfma_f32_16x16x32_bf16 v[244:247], v[112:115], v[132:135], v[244:247]
ds_read2_b32 v[56:57], v54 offset0:128 offset1:144
v_mfma_f32_16x16x32_bf16 v[236:239], v[108:111], v[132:135], v[236:239]
ds_read_b128 v[60:63], v9 offset:0
v_mfma_f32_16x16x32_bf16 v[228:231], v[104:107], v[132:135], v[228:231]
ds_read_b128 v[64:67], v9 offset:64
v_mfma_f32_16x16x32_bf16 v[220:223], v[100:103], v[132:135], v[220:223]
ds_read_b128 v[68:71], v9 offset:128
v_mfma_f32_16x16x32_bf16 v[224:227], v[100:103], v[136:139], v[224:227]
ds_read_b128 v[72:75], v9 offset:192
v_mfma_f32_16x16x32_bf16 v[232:235], v[104:107], v[136:139], v[232:235]
ds_read_b128 v[76:79], v9 offset:512
v_mfma_f32_16x16x32_bf16 v[240:243], v[108:111], v[136:139], v[240:243]
ds_read_b128 v[80:83], v9 offset:576
v_mfma_f32_16x16x32_bf16 v[248:251], v[112:115], v[136:139], v[248:251]
ds_read_b128 v[84:87], v9 offset:640
v_mfma_f32_16x16x32_bf16 v[180:183], v[116:119], v[112:115], v[180:183]
ds_read_b128 v[88:91], v9 offset:704
v_mfma_f32_16x16x32_bf16 v[172:175], v[116:119], v[108:111], v[172:175]
ds_read_b64_tr_b16 v[10:11], v53 offset:0
v_mfma_f32_16x16x32_bf16 v[164:167], v[116:119], v[104:107], v[164:167]
ds_read_b64_tr_b16 v[12:13], v53 offset:1024
v_mfma_f32_16x16x32_bf16 v[156:159], v[116:119], v[100:103], v[156:159]
ds_read_b64_tr_b16 v[14:15], v53 offset:32
v_mfma_f32_16x16x32_bf16 v[160:163], v[120:123], v[100:103], v[160:163]
ds_read_b64_tr_b16 v[16:17], v53 offset:1056
v_mfma_f32_16x16x32_bf16 v[168:171], v[120:123], v[104:107], v[168:171]
v_mfma_f32_16x16x32_bf16 v[176:179], v[120:123], v[108:111], v[176:179]
v_mfma_f32_16x16x32_bf16 v[184:187], v[120:123], v[112:115], v[184:187]
c1_epi:
s_waitcnt lgkmcnt(0)
s_mul_i32 s48, s44, 0x80008000
v_xor_b32 v10, s48, v10
v_xor_b32 v11, s48, v11
v_xor_b32 v12, s48, v12
v_xor_b32 v13, s48, v13
v_xor_b32 v14, s48, v14
v_xor_b32 v15, s48, v15
v_xor_b32 v16, s48, v16
v_xor_b32 v17, s48, v17
v_mul_f32 v128, s66, v92
v_mul_f32 v129, s66, v94
v_mul_f32 v130, s66, v96
v_mul_f32 v131, s66, v98
.p2align 3
v_pk_fma_f32 v[220:221], v[76:77], v[56:57], v[220:221] op_sel:[0,0,0] op_sel_hi:[1,0,1]
v_pk_fma_f32 v[222:223], v[78:79], v[56:57], v[222:223] op_sel:[0,0,0] op_sel_hi:[1,0,1]
v_pk_mul_f32 v[220:221], v[220:221], v[60:61]
v_pk_mul_f32 v[222:223], v[222:223], v[62:63]
v_cvt_pk_bf16_f32 v112, v220, v221
v_cvt_pk_bf16_f32 v113, v222, v223
v_pk_fma_f32 v[228:229], v[80:81], v[56:57], v[228:229] op_sel:[0,0,0] op_sel_hi:[1,0,1]
v_pk_fma_f32 v[230:231], v[82:83], v[56:57], v[230:231] op_sel:[0,0,0] op_sel_hi:[1,0,1]
v_pk_mul_f32 v[228:229], v[228:229], v[64:65]
v_pk_mul_f32 v[230:231], v[230:231], v[66:67]
v_cvt_pk_bf16_f32 v114, v228, v229
v_cvt_pk_bf16_f32 v115, v230, v231
v_pk_fma_f32 v[236:237], v[84:85], v[56:57], v[236:237] op_sel:[0,0,0] op_sel_hi:[1,0,1]
v_pk_fma_f32 v[238:239], v[86:87], v[56:57], v[238:239] op_sel:[0,0,0] op_sel_hi:[1,0,1]
v_pk_mul_f32 v[236:237], v[236:237], v[68:69]
v_pk_mul_f32 v[238:239], v[238:239], v[70:71]
v_cvt_pk_bf16_f32 v116, v236, v237
v_cvt_pk_bf16_f32 v117, v238, v239
v_pk_fma_f32 v[244:245], v[88:89], v[56:57], v[244:245] op_sel:[0,0,0] op_sel_hi:[1,0,1]
v_pk_fma_f32 v[246:247], v[90:91], v[56:57], v[246:247] op_sel:[0,0,0] op_sel_hi:[1,0,1]
v_pk_mul_f32 v[244:245], v[244:245], v[72:73]
v_pk_mul_f32 v[246:247], v[246:247], v[74:75]
v_cvt_pk_bf16_f32 v118, v244, v245
v_cvt_pk_bf16_f32 v119, v246, v247
v_pk_fma_f32 v[224:225], v[76:77], v[56:57], v[224:225] op_sel:[0,1,0] op_sel_hi:[1,1,1]
v_pk_fma_f32 v[226:227], v[78:79], v[56:57], v[226:227] op_sel:[0,1,0] op_sel_hi:[1,1,1]
v_pk_mul_f32 v[224:225], v[224:225], v[60:61]
v_pk_mul_f32 v[226:227], v[226:227], v[62:63]
v_cvt_pk_bf16_f32 v120, v224, v225
v_cvt_pk_bf16_f32 v121, v226, v227
v_pk_fma_f32 v[232:233], v[80:81], v[56:57], v[232:233] op_sel:[0,1,0] op_sel_hi:[1,1,1]
v_pk_fma_f32 v[234:235], v[82:83], v[56:57], v[234:235] op_sel:[0,1,0] op_sel_hi:[1,1,1]
v_pk_mul_f32 v[232:233], v[232:233], v[64:65]
v_pk_mul_f32 v[234:235], v[234:235], v[66:67]
v_cvt_pk_bf16_f32 v122, v232, v233
v_cvt_pk_bf16_f32 v123, v234, v235
v_pk_fma_f32 v[240:241], v[84:85], v[56:57], v[240:241] op_sel:[0,1,0] op_sel_hi:[1,1,1]
v_pk_fma_f32 v[242:243], v[86:87], v[56:57], v[242:243] op_sel:[0,1,0] op_sel_hi:[1,1,1]
v_pk_mul_f32 v[240:241], v[240:241], v[68:69]
v_pk_mul_f32 v[242:243], v[242:243], v[70:71]
v_cvt_pk_bf16_f32 v124, v240, v241
v_cvt_pk_bf16_f32 v125, v242, v243
v_pk_fma_f32 v[248:249], v[88:89], v[56:57], v[248:249] op_sel:[0,1,0] op_sel_hi:[1,1,1]
v_pk_fma_f32 v[250:251], v[90:91], v[56:57], v[250:251] op_sel:[0,1,0] op_sel_hi:[1,1,1]
v_pk_mul_f32 v[248:249], v[248:249], v[72:73]
v_pk_mul_f32 v[250:251], v[250:251], v[74:75]
v_cvt_pk_bf16_f32 v126, v248, v249
v_cvt_pk_bf16_f32 v127, v250, v251
v_pk_fma_f32 v[188:189], v[148:149], v[92:93], v[188:189] op_sel:[0,1,0] op_sel_hi:[1,1,1]
v_pk_fma_f32 v[190:191], v[150:151], v[92:93], v[190:191] op_sel:[0,1,0] op_sel_hi:[1,1,1]
v_pk_fma_f32 v[192:193], v[152:153], v[92:93], v[192:193] op_sel:[0,1,0] op_sel_hi:[1,1,1]
v_pk_fma_f32 v[194:195], v[154:155], v[92:93], v[194:195] op_sel:[0,1,0] op_sel_hi:[1,1,1]
v_cvt_pk_bf16_f32 v188, v188, v189
v_cvt_pk_bf16_f32 v189, v190, v191
v_cvt_pk_bf16_f32 v190, v192, v193
v_cvt_pk_bf16_f32 v191, v194, v195
v_pk_fma_f32 v[196:197], v[148:149], v[94:95], v[196:197] op_sel:[0,1,0] op_sel_hi:[1,1,1]
v_pk_fma_f32 v[198:199], v[150:151], v[94:95], v[198:199] op_sel:[0,1,0] op_sel_hi:[1,1,1]
v_pk_fma_f32 v[200:201], v[152:153], v[94:95], v[200:201] op_sel:[0,1,0] op_sel_hi:[1,1,1]
v_pk_fma_f32 v[202:203], v[154:155], v[94:95], v[202:203] op_sel:[0,1,0] op_sel_hi:[1,1,1]
v_cvt_pk_bf16_f32 v196, v196, v197
v_mfma_f32_16x16x32_bf16 v[60:63], v[10:13], v[188:191], 0
v_cvt_pk_bf16_f32 v197, v198, v199
v_cvt_pk_bf16_f32 v198, v200, v201
v_mfma_f32_16x16x32_bf16 v[64:67], v[14:17], v[188:191], 0
v_cvt_pk_bf16_f32 v199, v202, v203
v_pk_fma_f32 v[204:205], v[148:149], v[96:97], v[204:205] op_sel:[0,1,0] op_sel_hi:[1,1,1]
v_pk_fma_f32 v[206:207], v[150:151], v[96:97], v[206:207] op_sel:[0,1,0] op_sel_hi:[1,1,1]
v_pk_fma_f32 v[208:209], v[152:153], v[96:97], v[208:209] op_sel:[0,1,0] op_sel_hi:[1,1,1]
v_pk_fma_f32 v[210:211], v[154:155], v[96:97], v[210:211] op_sel:[0,1,0] op_sel_hi:[1,1,1]
v_cvt_pk_bf16_f32 v204, v204, v205
v_mfma_f32_16x16x32_bf16 v[68:71], v[10:13], v[196:199], 0
v_cvt_pk_bf16_f32 v205, v206, v207
v_cvt_pk_bf16_f32 v206, v208, v209
v_mfma_f32_16x16x32_bf16 v[72:75], v[14:17], v[196:199], 0
v_cvt_pk_bf16_f32 v207, v210, v211
v_pk_fma_f32 v[212:213], v[148:149], v[98:99], v[212:213] op_sel:[0,1,0] op_sel_hi:[1,1,1]
v_pk_fma_f32 v[214:215], v[150:151], v[98:99], v[214:215] op_sel:[0,1,0] op_sel_hi:[1,1,1]
v_pk_fma_f32 v[216:217], v[152:153], v[98:99], v[216:217] op_sel:[0,1,0] op_sel_hi:[1,1,1]
v_pk_fma_f32 v[218:219], v[154:155], v[98:99], v[218:219] op_sel:[0,1,0] op_sel_hi:[1,1,1]
v_cvt_pk_bf16_f32 v212, v212, v213
v_mfma_f32_16x16x32_bf16 v[76:79], v[10:13], v[204:207], 0
v_cvt_pk_bf16_f32 v213, v214, v215
v_cvt_pk_bf16_f32 v214, v216, v217
v_mfma_f32_16x16x32_bf16 v[80:83], v[14:17], v[204:207], 0
v_cvt_pk_bf16_f32 v215, v218, v219
s_nop 1
v_mfma_f32_16x16x32_bf16 v[84:87], v[10:13], v[212:215], 0
v_mfma_f32_16x16x32_bf16 v[88:91], v[14:17], v[212:215], 0
v_max3_f32 v100, v60, v61, v62
v_min3_f32 v104, v60, v61, v62
v_max3_f32 v100, v100, v63, v64
v_min3_f32 v104, v104, v63, v64
v_max3_f32 v100, v100, v65, v66
v_min3_f32 v104, v104, v65, v66
v_max_f32 v100, v100, v67
v_min_f32 v104, v104, v67
v_max3_f32 v101, v68, v69, v70
v_min3_f32 v105, v68, v69, v70
v_max3_f32 v101, v101, v71, v72
v_min3_f32 v105, v105, v71, v72
v_max3_f32 v101, v101, v73, v74
v_min3_f32 v105, v105, v73, v74
v_max_f32 v101, v101, v75
v_min_f32 v105, v105, v75
v_max3_f32 v102, v76, v77, v78
v_min3_f32 v106, v76, v77, v78
v_max3_f32 v102, v102, v79, v80
v_min3_f32 v106, v106, v79, v80
v_max3_f32 v102, v102, v81, v82
v_min3_f32 v106, v106, v81, v82
v_max_f32 v102, v102, v83
v_min_f32 v106, v106, v83
v_max3_f32 v103, v84, v85, v86
v_min3_f32 v107, v84, v85, v86
v_max3_f32 v103, v103, v87, v88
v_min3_f32 v107, v107, v87, v88
v_max3_f32 v103, v103, v89, v90
v_min3_f32 v107, v107, v89, v90
v_max_f32 v103, v103, v91
v_min_f32 v107, v107, v91
s_nop 1
v_permlane32_swap_b32 v100, v101
v_permlane32_swap_b32 v102, v103
v_permlane32_swap_b32 v104, v105
v_permlane32_swap_b32 v106, v107
v_max_f32 v100, v100, v101
v_max_f32 v102, v102, v103
v_min_f32 v104, v104, v105
v_min_f32 v106, v106, v107
v_permlane16_swap_b32 v100, v102
s_nop 0
v_permlane16_swap_b32 v104, v106
v_max_f32 v100, v100, v102
v_min_f32 v104, v104, v106
v_mov_b32 v102, v100
v_mov_b32 v106, v104
s_nop 0
v_permlane16_swap_b32 v100, v102
v_permlane16_swap_b32 v104, v106
v_mov_b32 v101, v100
v_mov_b32 v103, v102
v_mov_b32 v105, v104
v_mov_b32 v107, v106
v_permlane32_swap_b32 v100, v101
v_permlane32_swap_b32 v102, v103
v_permlane32_swap_b32 v104, v105
v_permlane32_swap_b32 v106, v107
v_pk_mul_f32 v[100:101], v[100:101], v[128:129]
v_pk_mul_f32 v[102:103], v[102:103], v[130:131]
v_pk_mul_f32 v[104:105], v[104:105], v[128:129]
v_pk_mul_f32 v[106:107], v[106:107], v[130:131]
v_pk_fma_f32 v[220:221], v[60:61], v[128:129], v[104:105] op_sel:[0,0,0] op_sel_hi:[1,0,0] neg_lo:[1,0,0] neg_hi:[1,0,0]
v_pk_fma_f32 v[60:61], v[60:61], v[128:129], v[100:101] op_sel:[0,0,0] op_sel_hi:[1,0,0] neg_lo:[0,0,1] neg_hi:[0,0,1]
v_exp_f32 v220, v220
v_exp_f32 v60, v60
v_exp_f32 v221, v221
v_exp_f32 v61, v61
v_pk_fma_f32 v[222:223], v[62:63], v[128:129], v[104:105] op_sel:[0,0,0] op_sel_hi:[1,0,0] neg_lo:[1,0,0] neg_hi:[1,0,0]
v_pk_fma_f32 v[62:63], v[62:63], v[128:129], v[100:101] op_sel:[0,0,0] op_sel_hi:[1,0,0] neg_lo:[0,0,1] neg_hi:[0,0,1]
v_exp_f32 v222, v222
v_exp_f32 v62, v62
v_exp_f32 v223, v223
v_exp_f32 v63, v63
v_pk_fma_f32 v[224:225], v[64:65], v[128:129], v[104:105] op_sel:[0,0,0] op_sel_hi:[1,0,0] neg_lo:[1,0,0] neg_hi:[1,0,0]
v_pk_fma_f32 v[64:65], v[64:65], v[128:129], v[100:101] op_sel:[0,0,0] op_sel_hi:[1,0,0] neg_lo:[0,0,1] neg_hi:[0,0,1]
v_exp_f32 v224, v224
v_exp_f32 v64, v64
v_exp_f32 v225, v225
v_exp_f32 v65, v65
v_pk_fma_f32 v[226:227], v[66:67], v[128:129], v[104:105] op_sel:[0,0,0] op_sel_hi:[1,0,0] neg_lo:[1,0,0] neg_hi:[1,0,0]
v_pk_fma_f32 v[66:67], v[66:67], v[128:129], v[100:101] op_sel:[0,0,0] op_sel_hi:[1,0,0] neg_lo:[0,0,1] neg_hi:[0,0,1]
v_exp_f32 v226, v226
v_exp_f32 v66, v66
v_exp_f32 v227, v227
v_exp_f32 v67, v67
v_pk_fma_f32 v[228:229], v[68:69], v[128:129], v[104:105] op_sel:[0,1,1] op_sel_hi:[1,1,1] neg_lo:[1,0,0] neg_hi:[1,0,0]
v_pk_fma_f32 v[68:69], v[68:69], v[128:129], v[100:101] op_sel:[0,1,1] op_sel_hi:[1,1,1] neg_lo:[0,0,1] neg_hi:[0,0,1]
v_exp_f32 v228, v228
v_exp_f32 v68, v68
v_exp_f32 v229, v229
v_exp_f32 v69, v69
v_pk_fma_f32 v[230:231], v[70:71], v[128:129], v[104:105] op_sel:[0,1,1] op_sel_hi:[1,1,1] neg_lo:[1,0,0] neg_hi:[1,0,0]
v_pk_fma_f32 v[70:71], v[70:71], v[128:129], v[100:101] op_sel:[0,1,1] op_sel_hi:[1,1,1] neg_lo:[0,0,1] neg_hi:[0,0,1]
v_exp_f32 v230, v230
v_exp_f32 v70, v70
v_exp_f32 v231, v231
v_exp_f32 v71, v71
v_pk_fma_f32 v[232:233], v[72:73], v[128:129], v[104:105] op_sel:[0,1,1] op_sel_hi:[1,1,1] neg_lo:[1,0,0] neg_hi:[1,0,0]
v_pk_fma_f32 v[72:73], v[72:73], v[128:129], v[100:101] op_sel:[0,1,1] op_sel_hi:[1,1,1] neg_lo:[0,0,1] neg_hi:[0,0,1]
v_exp_f32 v232, v232
v_exp_f32 v72, v72
v_exp_f32 v233, v233
v_exp_f32 v73, v73
v_pk_fma_f32 v[234:235], v[74:75], v[128:129], v[104:105] op_sel:[0,1,1] op_sel_hi:[1,1,1] neg_lo:[1,0,0] neg_hi:[1,0,0]
v_pk_fma_f32 v[74:75], v[74:75], v[128:129], v[100:101] op_sel:[0,1,1] op_sel_hi:[1,1,1] neg_lo:[0,0,1] neg_hi:[0,0,1]
v_exp_f32 v234, v234
v_exp_f32 v74, v74
v_exp_f32 v235, v235
v_exp_f32 v75, v75
v_pk_fma_f32 v[236:237], v[76:77], v[130:131], v[106:107] op_sel:[0,0,0] op_sel_hi:[1,0,0] neg_lo:[1,0,0] neg_hi:[1,0,0]
v_pk_fma_f32 v[76:77], v[76:77], v[130:131], v[102:103] op_sel:[0,0,0] op_sel_hi:[1,0,0] neg_lo:[0,0,1] neg_hi:[0,0,1]
v_exp_f32 v236, v236
v_exp_f32 v76, v76
v_exp_f32 v237, v237
v_exp_f32 v77, v77
v_pk_fma_f32 v[238:239], v[78:79], v[130:131], v[106:107] op_sel:[0,0,0] op_sel_hi:[1,0,0] neg_lo:[1,0,0] neg_hi:[1,0,0]
v_pk_fma_f32 v[78:79], v[78:79], v[130:131], v[102:103] op_sel:[0,0,0] op_sel_hi:[1,0,0] neg_lo:[0,0,1] neg_hi:[0,0,1]
v_exp_f32 v238, v238
v_exp_f32 v78, v78
v_exp_f32 v239, v239
v_exp_f32 v79, v79
v_pk_fma_f32 v[240:241], v[80:81], v[130:131], v[106:107] op_sel:[0,0,0] op_sel_hi:[1,0,0] neg_lo:[1,0,0] neg_hi:[1,0,0]
v_pk_fma_f32 v[80:81], v[80:81], v[130:131], v[102:103] op_sel:[0,0,0] op_sel_hi:[1,0,0] neg_lo:[0,0,1] neg_hi:[0,0,1]
v_exp_f32 v240, v240
v_exp_f32 v80, v80
v_exp_f32 v241, v241
v_exp_f32 v81, v81
v_pk_fma_f32 v[242:243], v[82:83], v[130:131], v[106:107] op_sel:[0,0,0] op_sel_hi:[1,0,0] neg_lo:[1,0,0] neg_hi:[1,0,0]
v_pk_fma_f32 v[82:83], v[82:83], v[130:131], v[102:103] op_sel:[0,0,0] op_sel_hi:[1,0,0] neg_lo:[0,0,1] neg_hi:[0,0,1]
v_exp_f32 v242, v242
v_exp_f32 v82, v82
v_exp_f32 v243, v243
v_exp_f32 v83, v83
v_pk_fma_f32 v[244:245], v[84:85], v[130:131], v[106:107] op_sel:[0,1,1] op_sel_hi:[1,1,1] neg_lo:[1,0,0] neg_hi:[1,0,0]
v_pk_fma_f32 v[84:85], v[84:85], v[130:131], v[102:103] op_sel:[0,1,1] op_sel_hi:[1,1,1] neg_lo:[0,0,1] neg_hi:[0,0,1]
v_exp_f32 v244, v244
v_exp_f32 v84, v84
v_exp_f32 v245, v245
v_exp_f32 v85, v85
v_pk_fma_f32 v[246:247], v[86:87], v[130:131], v[106:107] op_sel:[0,1,1] op_sel_hi:[1,1,1] neg_lo:[1,0,0] neg_hi:[1,0,0]
v_pk_fma_f32 v[86:87], v[86:87], v[130:131], v[102:103] op_sel:[0,1,1] op_sel_hi:[1,1,1] neg_lo:[0,0,1] neg_hi:[0,0,1]
v_exp_f32 v246, v246
v_exp_f32 v86, v86
v_exp_f32 v247, v247
v_exp_f32 v87, v87
v_pk_fma_f32 v[248:249], v[88:89], v[130:131], v[106:107] op_sel:[0,1,1] op_sel_hi:[1,1,1] neg_lo:[1,0,0] neg_hi:[1,0,0]
v_pk_fma_f32 v[88:89], v[88:89], v[130:131], v[102:103] op_sel:[0,1,1] op_sel_hi:[1,1,1] neg_lo:[0,0,1] neg_hi:[0,0,1]
v_exp_f32 v248, v248
v_exp_f32 v88, v88
v_exp_f32 v249, v249
v_exp_f32 v89, v89
v_pk_fma_f32 v[250:251], v[90:91], v[130:131], v[106:107] op_sel:[0,1,1] op_sel_hi:[1,1,1] neg_lo:[1,0,0] neg_hi:[1,0,0]
v_pk_fma_f32 v[90:91], v[90:91], v[130:131], v[102:103] op_sel:[0,1,1] op_sel_hi:[1,1,1] neg_lo:[0,0,1] neg_hi:[0,0,1]
v_exp_f32 v250, v250
v_exp_f32 v90, v90
v_exp_f32 v251, v251
v_exp_f32 v91, v91
v_pk_add_f32 v[108:109], v[60:61], v[62:63]
v_pk_add_f32 v[110:111], v[220:221], v[222:223]
v_pk_add_f32 v[108:109], v[108:109], v[64:65]
v_pk_add_f32 v[110:111], v[110:111], v[224:225]
v_pk_add_f32 v[108:109], v[108:109], v[66:67]
v_pk_add_f32 v[110:111], v[110:111], v[226:227]
v_add_f32 v100, v108, v109
v_add_f32 v104, v110, v111
v_pk_add_f32 v[108:109], v[68:69], v[70:71]
v_pk_add_f32 v[110:111], v[228:229], v[230:231]
v_pk_add_f32 v[108:109], v[108:109], v[72:73]
v_pk_add_f32 v[110:111], v[110:111], v[232:233]
v_pk_add_f32 v[108:109], v[108:109], v[74:75]
v_pk_add_f32 v[110:111], v[110:111], v[234:235]
v_add_f32 v101, v108, v109
v_add_f32 v105, v110, v111
v_pk_add_f32 v[108:109], v[76:77], v[78:79]
v_pk_add_f32 v[110:111], v[236:237], v[238:239]
v_pk_add_f32 v[108:109], v[108:109], v[80:81]
v_pk_add_f32 v[110:111], v[110:111], v[240:241]
v_pk_add_f32 v[108:109], v[108:109], v[82:83]
v_pk_add_f32 v[110:111], v[110:111], v[242:243]
v_add_f32 v102, v108, v109
v_add_f32 v106, v110, v111
v_pk_add_f32 v[108:109], v[84:85], v[86:87]
v_pk_add_f32 v[110:111], v[244:245], v[246:247]
v_pk_add_f32 v[108:109], v[108:109], v[88:89]
v_pk_add_f32 v[110:111], v[110:111], v[248:249]
v_pk_add_f32 v[108:109], v[108:109], v[90:91]
v_pk_add_f32 v[110:111], v[110:111], v[250:251]
v_add_f32 v103, v108, v109
v_add_f32 v107, v110, v111
s_nop 1
v_permlane32_swap_b32 v100, v101
v_permlane32_swap_b32 v102, v103
v_permlane32_swap_b32 v104, v105
v_permlane32_swap_b32 v106, v107
v_add_f32 v100, v100, v101
v_add_f32 v102, v102, v103
v_add_f32 v104, v104, v105
v_add_f32 v106, v106, v107
v_permlane16_swap_b32 v100, v102
s_nop 0
v_permlane16_swap_b32 v104, v106
v_add_f32 v100, v100, v102
v_add_f32 v104, v104, v106
v_rcp_f32 v100, v100
v_rcp_f32 v104, v104
s_nop 0
v_mov_b32 v102, v100
v_mov_b32 v106, v104
s_nop 0
v_permlane16_swap_b32 v100, v102
v_permlane16_swap_b32 v104, v106
v_mov_b32 v101, v100
v_mov_b32 v103, v102
v_mov_b32 v105, v104
v_mov_b32 v107, v106
v_permlane32_swap_b32 v100, v101
v_permlane32_swap_b32 v102, v103
v_permlane32_swap_b32 v104, v105
v_permlane32_swap_b32 v106, v107
.p2align 3
v_pk_mul_f32 v[60:61], v[60:61], v[100:101] op_sel:[0,0] op_sel_hi:[1,0]
v_pk_mul_f32 v[62:63], v[62:63], v[100:101] op_sel:[0,0] op_sel_hi:[1,0]
v_pk_mul_f32 v[64:65], v[64:65], v[100:101] op_sel:[0,0] op_sel_hi:[1,0]
v_pk_mul_f32 v[66:67], v[66:67], v[100:101] op_sel:[0,0] op_sel_hi:[1,0]
v_pk_mul_f32 v[220:221], v[220:221], v[104:105] op_sel:[0,0] op_sel_hi:[1,0]
v_pk_mul_f32 v[222:223], v[222:223], v[104:105] op_sel:[0,0] op_sel_hi:[1,0]
v_pk_mul_f32 v[224:225], v[224:225], v[104:105] op_sel:[0,0] op_sel_hi:[1,0]
v_pk_mul_f32 v[226:227], v[226:227], v[104:105] op_sel:[0,0] op_sel_hi:[1,0]
v_cvt_pk_bf16_f32 v60, v60, v61
v_cvt_pk_bf16_f32 v61, v62, v63
v_cvt_pk_bf16_f32 v62, v64, v65
v_cvt_pk_bf16_f32 v63, v66, v67
v_cvt_pk_bf16_f32 v220, v220, v221
v_cvt_pk_bf16_f32 v221, v222, v223
v_cvt_pk_bf16_f32 v222, v224, v225
v_cvt_pk_bf16_f32 v223, v226, v227
v_pk_mul_f32 v[68:69], v[68:69], v[100:101] op_sel:[0,1] op_sel_hi:[1,1]
v_pk_mul_f32 v[70:71], v[70:71], v[100:101] op_sel:[0,1] op_sel_hi:[1,1]
v_pk_mul_f32 v[72:73], v[72:73], v[100:101] op_sel:[0,1] op_sel_hi:[1,1]
v_pk_mul_f32 v[74:75], v[74:75], v[100:101] op_sel:[0,1] op_sel_hi:[1,1]
v_pk_mul_f32 v[228:229], v[228:229], v[104:105] op_sel:[0,1] op_sel_hi:[1,1]
v_pk_mul_f32 v[230:231], v[230:231], v[104:105] op_sel:[0,1] op_sel_hi:[1,1]
v_pk_mul_f32 v[232:233], v[232:233], v[104:105] op_sel:[0,1] op_sel_hi:[1,1]
v_pk_mul_f32 v[234:235], v[234:235], v[104:105] op_sel:[0,1] op_sel_hi:[1,1]
v_cvt_pk_bf16_f32 v68, v68, v69
v_mfma_f32_16x16x32_bf16 v[204:207], v[60:63], v[38:41], 0
v_cvt_pk_bf16_f32 v69, v70, v71
v_cvt_pk_bf16_f32 v70, v72, v73
v_mfma_f32_16x16x32_bf16 v[208:211], v[60:63], v[36:39], 0
v_cvt_pk_bf16_f32 v71, v74, v75
v_cvt_pk_bf16_f32 v228, v228, v229
v_mfma_f32_16x16x32_bf16 v[212:215], v[220:223], v[38:41], 0
v_cvt_pk_bf16_f32 v229, v230, v231
v_cvt_pk_bf16_f32 v230, v232, v233
v_mfma_f32_16x16x32_bf16 v[216:219], v[220:223], v[36:39], 0
v_cvt_pk_bf16_f32 v231, v234, v235
v_pk_mul_f32 v[76:77], v[76:77], v[102:103] op_sel:[0,0] op_sel_hi:[1,0]
v_pk_mul_f32 v[78:79], v[78:79], v[102:103] op_sel:[0,0] op_sel_hi:[1,0]
v_pk_mul_f32 v[80:81], v[80:81], v[102:103] op_sel:[0,0] op_sel_hi:[1,0]
v_pk_mul_f32 v[82:83], v[82:83], v[102:103] op_sel:[0,0] op_sel_hi:[1,0]
v_pk_mul_f32 v[236:237], v[236:237], v[106:107] op_sel:[0,0] op_sel_hi:[1,0]
v_pk_mul_f32 v[238:239], v[238:239], v[106:107] op_sel:[0,0] op_sel_hi:[1,0]
v_pk_mul_f32 v[240:241], v[240:241], v[106:107] op_sel:[0,0] op_sel_hi:[1,0]
v_pk_mul_f32 v[242:243], v[242:243], v[106:107] op_sel:[0,0] op_sel_hi:[1,0]
v_cvt_pk_bf16_f32 v76, v76, v77
v_mfma_f32_16x16x32_bf16 v[188:191], v[68:71], v[38:41], 0
v_mfma_f32_16x16x32_bf16 v[192:195], v[68:71], v[36:39], 0
v_cvt_pk_bf16_f32 v77, v78, v79
v_mfma_f32_16x16x32_bf16 v[196:199], v[228:231], v[38:41], 0
v_cvt_pk_bf16_f32 v78, v80, v81
v_mfma_f32_16x16x32_bf16 v[200:203], v[228:231], v[36:39], 0
v_cvt_pk_bf16_f32 v64, v204, v205
v_cvt_pk_bf16_f32 v79, v82, v83
v_cvt_pk_bf16_f32 v65, v206, v207
v_cvt_pk_bf16_f32 v236, v236, v237
v_cvt_pk_bf16_f32 v72, v208, v209
v_cvt_pk_bf16_f32 v73, v210, v211
v_cvt_pk_bf16_f32 v237, v238, v239
v_cvt_pk_bf16_f32 v224, v212, v213
v_cvt_pk_bf16_f32 v238, v240, v241
v_cvt_pk_bf16_f32 v225, v214, v215
v_cvt_pk_bf16_f32 v232, v216, v217
v_cvt_pk_bf16_f32 v239, v242, v243
v_cvt_pk_bf16_f32 v233, v218, v219
v_pk_mul_f32 v[84:85], v[84:85], v[102:103] op_sel:[0,1] op_sel_hi:[1,1]
v_pk_mul_f32 v[86:87], v[86:87], v[102:103] op_sel:[0,1] op_sel_hi:[1,1]
v_pk_mul_f32 v[88:89], v[88:89], v[102:103] op_sel:[0,1] op_sel_hi:[1,1]
v_pk_mul_f32 v[90:91], v[90:91], v[102:103] op_sel:[0,1] op_sel_hi:[1,1]
v_pk_mul_f32 v[244:245], v[244:245], v[106:107] op_sel:[0,1] op_sel_hi:[1,1]
v_pk_mul_f32 v[246:247], v[246:247], v[106:107] op_sel:[0,1] op_sel_hi:[1,1]
v_pk_mul_f32 v[248:249], v[248:249], v[106:107] op_sel:[0,1] op_sel_hi:[1,1]
v_pk_mul_f32 v[250:251], v[250:251], v[106:107] op_sel:[0,1] op_sel_hi:[1,1]
v_cvt_pk_bf16_f32 v84, v84, v85
v_mfma_f32_16x16x32_bf16 v[204:207], v[76:79], v[38:41], 0
v_mfma_f32_16x16x32_bf16 v[208:211], v[76:79], v[36:39], 0
v_cvt_pk_bf16_f32 v85, v86, v87
v_mfma_f32_16x16x32_bf16 v[212:215], v[236:239], v[38:41], 0
v_cvt_pk_bf16_f32 v86, v88, v89
v_mfma_f32_16x16x32_bf16 v[216:219], v[236:239], v[36:39], 0
v_cvt_pk_bf16_f32 v66, v188, v189
v_cvt_pk_bf16_f32 v87, v90, v91
v_cvt_pk_bf16_f32 v67, v190, v191
v_cvt_pk_bf16_f32 v244, v244, v245
v_cvt_pk_bf16_f32 v74, v192, v193
v_cvt_pk_bf16_f32 v75, v194, v195
v_cvt_pk_bf16_f32 v245, v246, v247
v_cvt_pk_bf16_f32 v226, v196, v197
v_cvt_pk_bf16_f32 v246, v248, v249
v_cvt_pk_bf16_f32 v227, v198, v199
v_cvt_pk_bf16_f32 v234, v200, v201
v_cvt_pk_bf16_f32 v247, v250, v251
v_cvt_pk_bf16_f32 v235, v202, v203
v_mov_b32 v5, 2
v_cmp_eq_u32 s[50:51], s41, v2
v_mfma_f32_16x16x32_bf16 v[188:191], v[84:87], v[38:41], 0
v_mfma_f32_16x16x32_bf16 v[192:195], v[84:87], v[36:39], 0
v_mfma_f32_16x16x32_bf16 v[196:199], v[244:247], v[38:41], 0
v_mfma_f32_16x16x32_bf16 v[200:203], v[244:247], v[36:39], 0
v_mfma_f32_16x16x32_bf16 v[152:155], v[224:227], v[112:115], 0
v_cvt_pk_bf16_f32 v80, v204, v205
v_cvt_pk_bf16_f32 v81, v206, v207
v_mfma_f32_16x16x32_bf16 v[60:63], v[232:235], v[112:115], 0
v_cvt_pk_bf16_f32 v88, v208, v209
v_mfma_f32_16x16x32_bf16 v[68:71], v[224:227], v[120:123], 0
v_cvt_pk_bf16_f32 v89, v210, v211
v_mfma_f32_16x16x32_bf16 v[220:223], v[232:235], v[120:123], 0
v_cvt_pk_bf16_f32 v240, v212, v213
v_cvt_pk_bf16_f32 v241, v214, v215
v_mfma_f32_16x16x32_bf16 v[228:231], v[224:227], v[48:51], 0
v_cvt_pk_bf16_f32 v248, v216, v217
v_mfma_f32_16x16x32_bf16 v[76:79], v[232:235], v[48:51], 0
v_cvt_pk_bf16_f32 v249, v218, v219
v_mfma_f32_16x16x32_bf16 v[100:103], v[64:67], v[112:115], 0
v_cvt_pk_bf16_f32 v82, v188, v189
v_cvt_pk_bf16_f32 v83, v190, v191
v_mfma_f32_16x16x32_bf16 v[104:107], v[72:75], v[112:115], 0
v_cvt_pk_bf16_f32 v90, v192, v193
v_mfma_f32_16x16x32_bf16 v[108:111], v[64:67], v[120:123], 0
v_cvt_pk_bf16_f32 v91, v194, v195
v_mfma_f32_16x16x32_bf16 v[132:135], v[72:75], v[120:123], 0
v_cvt_pk_bf16_f32 v242, v196, v197
v_cvt_pk_bf16_f32 v243, v198, v199
v_mfma_f32_16x16x32_bf16 v[136:139], v[64:67], v[48:51], 0
v_cvt_pk_bf16_f32 v250, v200, v201
v_mfma_f32_16x16x32_bf16 v[148:151], v[72:75], v[48:51], 0
v_cvt_pk_bf16_f32 v251, v202, v203
s_nop 1
v_mfma_f32_16x16x32_bf16 v[152:155], v[240:243], v[116:119], v[152:155]
v_mfma_f32_16x16x32_bf16 v[60:63], v[248:251], v[116:119], v[60:63]
v_mfma_f32_16x16x32_bf16 v[68:71], v[240:243], v[124:127], v[68:71]
v_mfma_f32_16x16x32_bf16 v[220:223], v[248:251], v[124:127], v[220:223]
v_mfma_f32_16x16x32_bf16 v[228:231], v[240:243], v[48:51], v[228:231]
v_mfma_f32_16x16x32_bf16 v[76:79], v[248:251], v[48:51], v[76:79]
v_mfma_f32_16x16x32_bf16 v[100:103], v[80:83], v[116:119], v[100:103]
v_mfma_f32_16x16x32_bf16 v[104:107], v[88:91], v[116:119], v[104:107]
v_mfma_f32_16x16x32_bf16 v[108:111], v[80:83], v[124:127], v[108:111]
v_mfma_f32_16x16x32_bf16 v[132:135], v[88:91], v[124:127], v[132:135]
v_cvt_pk_bf16_f32 v152, v152, v153
v_cvt_pk_bf16_f32 v153, v154, v155
v_mfma_f32_16x16x32_bf16 v[136:139], v[80:83], v[48:51], v[136:139]
v_cvt_pk_bf16_f32 v154, v60, v61
v_cvt_pk_bf16_f32 v155, v62, v63
v_mfma_f32_16x16x32_bf16 v[148:151], v[88:91], v[48:51], v[148:151]
ds_write_b128 v42, v[152:155] offset:0
v_cvt_pk_bf16_f32 v68, v68, v69
v_cvt_pk_bf16_f32 v69, v70, v71
v_cvt_pk_bf16_f32 v70, v220, v221
v_cvt_pk_bf16_f32 v71, v222, v223
ds_write_b128 v42, v[68:71] offset:1024
v_cvt_pk_bf16_f32 v228, v228, v229
v_cvt_pk_bf16_f32 v229, v230, v231
v_cvt_pk_bf16_f32 v230, v76, v77
v_cvt_pk_bf16_f32 v231, v78, v79
ds_write_b128 v42, v[228:231] offset:2048
ds_write_b32 v52, v5
s_mov_b32 s63, 0
px_62:
ds_read_b32 v4, v19
ds_read_b128 v[188:191], v43 offset:0
ds_read_b128 v[192:195], v43 offset:1024
ds_read_b128 v[196:199], v43 offset:2048
s_add_u32 s63, s63, 1
s_cmp_lt_u32 s63, 0x400000
s_waitcnt lgkmcnt(0)
v_cmp_ne_u32 vcc, 2, v4
s_cbranch_vccz pxd_63
s_cbranch_scc1 px_62
pxd_63:
v_mfma_f32_16x16x32_bf16 v[100:103], v[38:41], v[188:191], v[100:103]
v_mfma_f32_16x16x32_bf16 v[104:107], v[36:39], v[188:191], v[104:107]
v_mfma_f32_16x16x32_bf16 v[108:111], v[38:41], v[192:195], v[108:111]
v_mfma_f32_16x16x32_bf16 v[132:135], v[36:39], v[192:195], v[132:135]
v_mfma_f32_16x16x32_bf16 v[136:139], v[38:41], v[196:199], v[136:139]
v_mfma_f32_16x16x32_bf16 v[148:151], v[36:39], v[196:199], v[148:151]
s_nop 2
v_cvt_pk_bf16_f32 v100, v100, v101
v_cvt_pk_bf16_f32 v101, v102, v103
v_cvt_pk_bf16_f32 v102, v104, v105
v_cvt_pk_bf16_f32 v103, v106, v107
buffer_store_dwordx4 v[100:103], v55, s[32:35], s53 offen sc1
v_cvt_pk_bf16_f32 v108, v108, v109
v_cvt_pk_bf16_f32 v109, v110, v111
v_cvt_pk_bf16_f32 v110, v132, v133
v_cvt_pk_bf16_f32 v111, v134, v135
buffer_store_dwordx4 v[108:111], v55, s[32:35], s54 offen sc1
v_cvt_pk_bf16_f32 v136, v136, v137
v_cvt_pk_bf16_f32 v137, v138, v139
v_cvt_pk_bf16_f32 v138, v148, v149
v_cvt_pk_bf16_f32 v139, v150, v151
s_mov_b64 exec, s[50:51]
buffer_store_dwordx4 v[136:139], v58, s[32:35], s56 offen sc1
s_mov_b64 exec, -1
.p2align 3
v_pk_fma_f32 v[156:157], v[140:141], v[92:93], v[156:157] op_sel:[0,1,0] op_sel_hi:[1,1,1]
v_pk_fma_f32 v[158:159], v[142:143], v[92:93], v[158:159] op_sel:[0,1,0] op_sel_hi:[1,1,1]
v_pk_fma_f32 v[160:161], v[144:145], v[92:93], v[160:161] op_sel:[0,1,0] op_sel_hi:[1,1,1]
v_pk_fma_f32 v[162:163], v[146:147], v[92:93], v[162:163] op_sel:[0,1,0] op_sel_hi:[1,1,1]
v_cvt_pk_bf16_f32 v156, v156, v157
v_cvt_pk_bf16_f32 v157, v158, v159
v_cvt_pk_bf16_f32 v158, v160, v161
v_cvt_pk_bf16_f32 v159, v162, v163
v_pk_fma_f32 v[164:165], v[140:141], v[94:95], v[164:165] op_sel:[0,1,0] op_sel_hi:[1,1,1]
v_pk_fma_f32 v[166:167], v[142:143], v[94:95], v[166:167] op_sel:[0,1,0] op_sel_hi:[1,1,1]
v_pk_fma_f32 v[168:169], v[144:145], v[94:95], v[168:169] op_sel:[0,1,0] op_sel_hi:[1,1,1]
v_pk_fma_f32 v[170:171], v[146:147], v[94:95], v[170:171] op_sel:[0,1,0] op_sel_hi:[1,1,1]
v_cvt_pk_bf16_f32 v164, v164, v165
v_mfma_f32_16x16x32_bf16 v[60:63], v[10:13], v[156:159], 0
v_cvt_pk_bf16_f32 v165, v166, v167
v_cvt_pk_bf16_f32 v166, v168, v169
v_mfma_f32_16x16x32_bf16 v[64:67], v[14:17], v[156:159], 0
v_cvt_pk_bf16_f32 v167, v170, v171
v_pk_fma_f32 v[172:173], v[140:141], v[96:97], v[172:173] op_sel:[0,1,0] op_sel_hi:[1,1,1]
v_pk_fma_f32 v[174:175], v[142:143], v[96:97], v[174:175] op_sel:[0,1,0] op_sel_hi:[1,1,1]
v_pk_fma_f32 v[176:177], v[144:145], v[96:97], v[176:177] op_sel:[0,1,0] op_sel_hi:[1,1,1]
v_pk_fma_f32 v[178:179], v[146:147], v[96:97], v[178:179] op_sel:[0,1,0] op_sel_hi:[1,1,1]
v_cvt_pk_bf16_f32 v172, v172, v173
v_mfma_f32_16x16x32_bf16 v[68:71], v[10:13], v[164:167], 0
v_cvt_pk_bf16_f32 v173, v174, v175
v_cvt_pk_bf16_f32 v174, v176, v177
v_mfma_f32_16x16x32_bf16 v[72:75], v[14:17], v[164:167], 0
v_cvt_pk_bf16_f32 v175, v178, v179
v_pk_fma_f32 v[180:181], v[140:141], v[98:99], v[180:181] op_sel:[0,1,0] op_sel_hi:[1,1,1]
v_pk_fma_f32 v[182:183], v[142:143], v[98:99], v[182:183] op_sel:[0,1,0] op_sel_hi:[1,1,1]
v_pk_fma_f32 v[184:185], v[144:145], v[98:99], v[184:185] op_sel:[0,1,0] op_sel_hi:[1,1,1]
v_pk_fma_f32 v[186:187], v[146:147], v[98:99], v[186:187] op_sel:[0,1,0] op_sel_hi:[1,1,1]
v_cvt_pk_bf16_f32 v180, v180, v181
v_mfma_f32_16x16x32_bf16 v[76:79], v[10:13], v[172:175], 0
v_cvt_pk_bf16_f32 v181, v182, v183
v_cvt_pk_bf16_f32 v182, v184, v185
v_mfma_f32_16x16x32_bf16 v[80:83], v[14:17], v[172:175], 0
v_cvt_pk_bf16_f32 v183, v186, v187
s_nop 1
v_mfma_f32_16x16x32_bf16 v[84:87], v[10:13], v[180:183], 0
v_mfma_f32_16x16x32_bf16 v[88:91], v[14:17], v[180:183], 0
v_max3_f32 v100, v60, v61, v62
v_min3_f32 v104, v60, v61, v62
v_max3_f32 v100, v100, v63, v64
v_min3_f32 v104, v104, v63, v64
v_max3_f32 v100, v100, v65, v66
v_min3_f32 v104, v104, v65, v66
v_max_f32 v100, v100, v67
v_min_f32 v104, v104, v67
v_max3_f32 v101, v68, v69, v70
v_min3_f32 v105, v68, v69, v70
v_max3_f32 v101, v101, v71, v72
v_min3_f32 v105, v105, v71, v72
v_max3_f32 v101, v101, v73, v74
v_min3_f32 v105, v105, v73, v74
v_max_f32 v101, v101, v75
v_min_f32 v105, v105, v75
v_max3_f32 v102, v76, v77, v78
v_min3_f32 v106, v76, v77, v78
v_max3_f32 v102, v102, v79, v80
v_min3_f32 v106, v106, v79, v80
v_max3_f32 v102, v102, v81, v82
v_min3_f32 v106, v106, v81, v82
v_max_f32 v102, v102, v83
v_min_f32 v106, v106, v83
v_max3_f32 v103, v84, v85, v86
v_min3_f32 v107, v84, v85, v86
v_max3_f32 v103, v103, v87, v88
v_min3_f32 v107, v107, v87, v88
v_max3_f32 v103, v103, v89, v90
v_min3_f32 v107, v107, v89, v90
v_max_f32 v103, v103, v91
v_min_f32 v107, v107, v91
s_nop 1
v_permlane32_swap_b32 v100, v101
v_permlane32_swap_b32 v102, v103
v_permlane32_swap_b32 v104, v105
v_permlane32_swap_b32 v106, v107
v_max_f32 v100, v100, v101
v_max_f32 v102, v102, v103
v_min_f32 v104, v104, v105
v_min_f32 v106, v106, v107
v_permlane16_swap_b32 v100, v102
s_nop 0
v_permlane16_swap_b32 v104, v106
v_max_f32 v100, v100, v102
v_min_f32 v104, v104, v106
v_mov_b32 v102, v100
v_mov_b32 v106, v104
s_nop 0
v_permlane16_swap_b32 v100, v102
v_permlane16_swap_b32 v104, v106
v_mov_b32 v101, v100
v_mov_b32 v103, v102
v_mov_b32 v105, v104
v_mov_b32 v107, v106
v_permlane32_swap_b32 v100, v101
v_permlane32_swap_b32 v102, v103
v_permlane32_swap_b32 v104, v105
v_permlane32_swap_b32 v106, v107
v_pk_mul_f32 v[100:101], v[100:101], v[128:129]
v_pk_mul_f32 v[102:103], v[102:103], v[130:131]
v_pk_mul_f32 v[104:105], v[104:105], v[128:129]
v_pk_mul_f32 v[106:107], v[106:107], v[130:131]
v_pk_fma_f32 v[220:221], v[60:61], v[128:129], v[104:105] op_sel:[0,0,0] op_sel_hi:[1,0,0] neg_lo:[1,0,0] neg_hi:[1,0,0]
v_pk_fma_f32 v[60:61], v[60:61], v[128:129], v[100:101] op_sel:[0,0,0] op_sel_hi:[1,0,0] neg_lo:[0,0,1] neg_hi:[0,0,1]
v_exp_f32 v220, v220
v_exp_f32 v60, v60
v_exp_f32 v221, v221
v_exp_f32 v61, v61
v_pk_fma_f32 v[222:223], v[62:63], v[128:129], v[104:105] op_sel:[0,0,0] op_sel_hi:[1,0,0] neg_lo:[1,0,0] neg_hi:[1,0,0]
v_pk_fma_f32 v[62:63], v[62:63], v[128:129], v[100:101] op_sel:[0,0,0] op_sel_hi:[1,0,0] neg_lo:[0,0,1] neg_hi:[0,0,1]
v_exp_f32 v222, v222
v_exp_f32 v62, v62
v_exp_f32 v223, v223
v_exp_f32 v63, v63
v_pk_fma_f32 v[224:225], v[64:65], v[128:129], v[104:105] op_sel:[0,0,0] op_sel_hi:[1,0,0] neg_lo:[1,0,0] neg_hi:[1,0,0]
v_pk_fma_f32 v[64:65], v[64:65], v[128:129], v[100:101] op_sel:[0,0,0] op_sel_hi:[1,0,0] neg_lo:[0,0,1] neg_hi:[0,0,1]
v_exp_f32 v224, v224
v_exp_f32 v64, v64
v_exp_f32 v225, v225
v_exp_f32 v65, v65
v_pk_fma_f32 v[226:227], v[66:67], v[128:129], v[104:105] op_sel:[0,0,0] op_sel_hi:[1,0,0] neg_lo:[1,0,0] neg_hi:[1,0,0]
v_pk_fma_f32 v[66:67], v[66:67], v[128:129], v[100:101] op_sel:[0,0,0] op_sel_hi:[1,0,0] neg_lo:[0,0,1] neg_hi:[0,0,1]
v_exp_f32 v226, v226
v_exp_f32 v66, v66
v_exp_f32 v227, v227
v_exp_f32 v67, v67
v_pk_fma_f32 v[228:229], v[68:69], v[128:129], v[104:105] op_sel:[0,1,1] op_sel_hi:[1,1,1] neg_lo:[1,0,0] neg_hi:[1,0,0]
v_pk_fma_f32 v[68:69], v[68:69], v[128:129], v[100:101] op_sel:[0,1,1] op_sel_hi:[1,1,1] neg_lo:[0,0,1] neg_hi:[0,0,1]
v_exp_f32 v228, v228
v_exp_f32 v68, v68
v_exp_f32 v229, v229
v_exp_f32 v69, v69
v_pk_fma_f32 v[230:231], v[70:71], v[128:129], v[104:105] op_sel:[0,1,1] op_sel_hi:[1,1,1] neg_lo:[1,0,0] neg_hi:[1,0,0]
v_pk_fma_f32 v[70:71], v[70:71], v[128:129], v[100:101] op_sel:[0,1,1] op_sel_hi:[1,1,1] neg_lo:[0,0,1] neg_hi:[0,0,1]
v_exp_f32 v230, v230
v_exp_f32 v70, v70
v_exp_f32 v231, v231
v_exp_f32 v71, v71
v_pk_fma_f32 v[232:233], v[72:73], v[128:129], v[104:105] op_sel:[0,1,1] op_sel_hi:[1,1,1] neg_lo:[1,0,0] neg_hi:[1,0,0]
v_pk_fma_f32 v[72:73], v[72:73], v[128:129], v[100:101] op_sel:[0,1,1] op_sel_hi:[1,1,1] neg_lo:[0,0,1] neg_hi:[0,0,1]
v_exp_f32 v232, v232
v_exp_f32 v72, v72
v_exp_f32 v233, v233
v_exp_f32 v73, v73
v_pk_fma_f32 v[234:235], v[74:75], v[128:129], v[104:105] op_sel:[0,1,1] op_sel_hi:[1,1,1] neg_lo:[1,0,0] neg_hi:[1,0,0]
v_pk_fma_f32 v[74:75], v[74:75], v[128:129], v[100:101] op_sel:[0,1,1] op_sel_hi:[1,1,1] neg_lo:[0,0,1] neg_hi:[0,0,1]
v_exp_f32 v234, v234
v_exp_f32 v74, v74
v_exp_f32 v235, v235
v_exp_f32 v75, v75
buffer_load_dwordx4 v[188:191], v18, s[32:35], s55 offen offset:0 sc1
buffer_load_dwordx4 v[192:195], v18, s[32:35], s55 offen offset:1024 sc1
buffer_load_dwordx4 v[204:207], v58, s[32:35], s56 offen sc1
buffer_load_dwordx4 v[208:211], v58, s[32:35], s57 offen sc1
v_pk_fma_f32 v[236:237], v[76:77], v[130:131], v[106:107] op_sel:[0,0,0] op_sel_hi:[1,0,0] neg_lo:[1,0,0] neg_hi:[1,0,0]
v_pk_fma_f32 v[76:77], v[76:77], v[130:131], v[102:103] op_sel:[0,0,0] op_sel_hi:[1,0,0] neg_lo:[0,0,1] neg_hi:[0,0,1]
v_exp_f32 v236, v236
v_exp_f32 v76, v76
v_exp_f32 v237, v237
v_exp_f32 v77, v77
v_pk_fma_f32 v[238:239], v[78:79], v[130:131], v[106:107] op_sel:[0,0,0] op_sel_hi:[1,0,0] neg_lo:[1,0,0] neg_hi:[1,0,0]
v_pk_fma_f32 v[78:79], v[78:79], v[130:131], v[102:103] op_sel:[0,0,0] op_sel_hi:[1,0,0] neg_lo:[0,0,1] neg_hi:[0,0,1]
v_exp_f32 v238, v238
v_exp_f32 v78, v78
v_exp_f32 v239, v239
v_exp_f32 v79, v79
v_pk_fma_f32 v[240:241], v[80:81], v[130:131], v[106:107] op_sel:[0,0,0] op_sel_hi:[1,0,0] neg_lo:[1,0,0] neg_hi:[1,0,0]
v_pk_fma_f32 v[80:81], v[80:81], v[130:131], v[102:103] op_sel:[0,0,0] op_sel_hi:[1,0,0] neg_lo:[0,0,1] neg_hi:[0,0,1]
v_exp_f32 v240, v240
v_exp_f32 v80, v80
v_exp_f32 v241, v241
v_exp_f32 v81, v81
v_pk_fma_f32 v[242:243], v[82:83], v[130:131], v[106:107] op_sel:[0,0,0] op_sel_hi:[1,0,0] neg_lo:[1,0,0] neg_hi:[1,0,0]
v_pk_fma_f32 v[82:83], v[82:83], v[130:131], v[102:103] op_sel:[0,0,0] op_sel_hi:[1,0,0] neg_lo:[0,0,1] neg_hi:[0,0,1]
v_exp_f32 v242, v242
v_exp_f32 v82, v82
v_exp_f32 v243, v243
v_exp_f32 v83, v83
v_pk_fma_f32 v[244:245], v[84:85], v[130:131], v[106:107] op_sel:[0,1,1] op_sel_hi:[1,1,1] neg_lo:[1,0,0] neg_hi:[1,0,0]
v_pk_fma_f32 v[84:85], v[84:85], v[130:131], v[102:103] op_sel:[0,1,1] op_sel_hi:[1,1,1] neg_lo:[0,0,1] neg_hi:[0,0,1]
v_exp_f32 v244, v244
v_exp_f32 v84, v84
v_exp_f32 v245, v245
v_exp_f32 v85, v85
v_pk_fma_f32 v[246:247], v[86:87], v[130:131], v[106:107] op_sel:[0,1,1] op_sel_hi:[1,1,1] neg_lo:[1,0,0] neg_hi:[1,0,0]
v_pk_fma_f32 v[86:87], v[86:87], v[130:131], v[102:103] op_sel:[0,1,1] op_sel_hi:[1,1,1] neg_lo:[0,0,1] neg_hi:[0,0,1]
v_exp_f32 v246, v246
v_exp_f32 v86, v86
v_exp_f32 v247, v247
v_exp_f32 v87, v87
v_pk_fma_f32 v[248:249], v[88:89], v[130:131], v[106:107] op_sel:[0,1,1] op_sel_hi:[1,1,1] neg_lo:[1,0,0] neg_hi:[1,0,0]
v_pk_fma_f32 v[88:89], v[88:89], v[130:131], v[102:103] op_sel:[0,1,1] op_sel_hi:[1,1,1] neg_lo:[0,0,1] neg_hi:[0,0,1]
v_exp_f32 v248, v248
v_exp_f32 v88, v88
v_exp_f32 v249, v249
v_exp_f32 v89, v89
v_pk_fma_f32 v[250:251], v[90:91], v[130:131], v[106:107] op_sel:[0,1,1] op_sel_hi:[1,1,1] neg_lo:[1,0,0] neg_hi:[1,0,0]
v_pk_fma_f32 v[90:91], v[90:91], v[130:131], v[102:103] op_sel:[0,1,1] op_sel_hi:[1,1,1] neg_lo:[0,0,1] neg_hi:[0,0,1]
v_exp_f32 v250, v250
v_exp_f32 v90, v90
v_exp_f32 v251, v251
v_exp_f32 v91, v91
v_pk_add_f32 v[108:109], v[60:61], v[62:63]
v_pk_add_f32 v[110:111], v[220:221], v[222:223]
v_pk_add_f32 v[108:109], v[108:109], v[64:65]
v_pk_add_f32 v[110:111], v[110:111], v[224:225]
v_pk_add_f32 v[108:109], v[108:109], v[66:67]
v_pk_add_f32 v[110:111], v[110:111], v[226:227]
v_add_f32 v100, v108, v109
v_add_f32 v104, v110, v111
v_pk_add_f32 v[108:109], v[68:69], v[70:71]
v_pk_add_f32 v[110:111], v[228:229], v[230:231]
v_pk_add_f32 v[108:109], v[108:109], v[72:73]
v_pk_add_f32 v[110:111], v[110:111], v[232:233]
v_pk_add_f32 v[108:109], v[108:109], v[74:75]
v_pk_add_f32 v[110:111], v[110:111], v[234:235]
v_add_f32 v101, v108, v109
v_add_f32 v105, v110, v111
v_pk_add_f32 v[108:109], v[76:77], v[78:79]
v_pk_add_f32 v[110:111], v[236:237], v[238:239]
v_pk_add_f32 v[108:109], v[108:109], v[80:81]
v_pk_add_f32 v[110:111], v[110:111], v[240:241]
v_pk_add_f32 v[108:109], v[108:109], v[82:83]
v_pk_add_f32 v[110:111], v[110:111], v[242:243]
v_add_f32 v102, v108, v109
v_add_f32 v106, v110, v111
v_pk_add_f32 v[108:109], v[84:85], v[86:87]
v_pk_add_f32 v[110:111], v[244:245], v[246:247]
v_pk_add_f32 v[108:109], v[108:109], v[88:89]
v_pk_add_f32 v[110:111], v[110:111], v[248:249]
v_pk_add_f32 v[108:109], v[108:109], v[90:91]
v_pk_add_f32 v[110:111], v[110:111], v[250:251]
v_add_f32 v103, v108, v109
v_add_f32 v107, v110, v111
s_mov_b32 s63, 0
sent_64:
s_waitcnt vmcnt(0)
v_max_u32 v4, v188, v189
v_max3_u32 v4, v4, v190, v191
v_max3_u32 v4, v4, v192, v193
v_max3_u32 v4, v4, v194, v195
v_max3_u32 v4, v4, v204, v205
v_max3_u32 v4, v4, v206, v207
v_max3_u32 v4, v4, v208, v209
v_max3_u32 v4, v4, v210, v211
v_cmp_eq_u32 vcc, -1, v4
s_cbranch_vccz sentd_65
buffer_load_dwordx4 v[188:191], v18, s[32:35], s55 offen offset:0 sc1
buffer_load_dwordx4 v[192:195], v18, s[32:35], s55 offen offset:1024 sc1
buffer_load_dwordx4 v[204:207], v58, s[32:35], s56 offen sc1
buffer_load_dwordx4 v[208:211], v58, s[32:35], s57 offen sc1
s_add_u32 s63, s63, 1
s_cmp_lt_u32 s63, 0x80000
s_cbranch_scc1 sent_64
s_waitcnt vmcnt(0)
sentd_65:
v_mfma_f32_16x16x32_bf16 v[132:135], v[44:47], v[188:191], 0
v_mfma_f32_16x16x32_bf16 v[132:135], v[44:47], v[192:195], v[132:135]
s_nop 7
v_add_f32_dpp v132, v132, v132 row_ror:8 row_mask:0xf bank_mask:0xf
v_add_f32_dpp v133, v133, v133 row_ror:8 row_mask:0xf bank_mask:0xf
v_add_f32_dpp v134, v134, v134 row_ror:8 row_mask:0xf bank_mask:0xf
v_add_f32_dpp v135, v135, v135 row_ror:8 row_mask:0xf bank_mask:0xf
v_cvt_pk_bf16_f32 v132, v132, v133
v_cvt_pk_bf16_f32 v133, v134, v135
s_mov_b64 exec, 0x00ff00ff
buffer_store_dwordx2 v[132:133], v59, s[32:35], s79 offen sc1
s_mov_b64 exec, -1
s_nop 1
v_permlane32_swap_b32 v100, v101
v_permlane32_swap_b32 v102, v103
v_permlane32_swap_b32 v104, v105
v_permlane32_swap_b32 v106, v107
v_add_f32 v100, v100, v101
v_add_f32 v102, v102, v103
v_add_f32 v104, v104, v105
v_add_f32 v106, v106, v107
v_permlane16_swap_b32 v100, v102
s_nop 0
v_permlane16_swap_b32 v104, v106
v_add_f32 v100, v100, v102
v_add_f32 v104, v104, v106
v_rcp_f32 v100, v100
v_rcp_f32 v104, v104
s_nop 0
v_mov_b32 v102, v100
v_mov_b32 v106, v104
s_nop 0
v_permlane16_swap_b32 v100, v102
v_permlane16_swap_b32 v104, v106
v_mov_b32 v101, v100
v_mov_b32 v103, v102
v_mov_b32 v105, v104
v_mov_b32 v107, v106
v_permlane32_swap_b32 v100, v101
v_permlane32_swap_b32 v102, v103
v_permlane32_swap_b32 v104, v105
v_permlane32_swap_b32 v106, v107
.p2align 3
v_pk_mul_f32 v[60:61], v[60:61], v[100:101] op_sel:[0,0] op_sel_hi:[1,0]
v_pk_mul_f32 v[62:63], v[62:63], v[100:101] op_sel:[0,0] op_sel_hi:[1,0]
v_pk_mul_f32 v[64:65], v[64:65], v[100:101] op_sel:[0,0] op_sel_hi:[1,0]
v_pk_mul_f32 v[66:67], v[66:67], v[100:101] op_sel:[0,0] op_sel_hi:[1,0]
v_pk_mul_f32 v[220:221], v[220:221], v[104:105] op_sel:[0,0] op_sel_hi:[1,0]
v_pk_mul_f32 v[222:223], v[222:223], v[104:105] op_sel:[0,0] op_sel_hi:[1,0]
v_pk_mul_f32 v[224:225], v[224:225], v[104:105] op_sel:[0,0] op_sel_hi:[1,0]
v_pk_mul_f32 v[226:227], v[226:227], v[104:105] op_sel:[0,0] op_sel_hi:[1,0]
v_cvt_pk_bf16_f32 v60, v60, v61
v_cvt_pk_bf16_f32 v61, v62, v63
v_cvt_pk_bf16_f32 v62, v64, v65
v_cvt_pk_bf16_f32 v63, v66, v67
v_cvt_pk_bf16_f32 v220, v220, v221
v_cvt_pk_bf16_f32 v221, v222, v223
v_cvt_pk_bf16_f32 v222, v224, v225
v_cvt_pk_bf16_f32 v223, v226, v227
v_pk_mul_f32 v[68:69], v[68:69], v[100:101] op_sel:[0,1] op_sel_hi:[1,1]
v_pk_mul_f32 v[70:71], v[70:71], v[100:101] op_sel:[0,1] op_sel_hi:[1,1]
v_pk_mul_f32 v[72:73], v[72:73], v[100:101] op_sel:[0,1] op_sel_hi:[1,1]
v_pk_mul_f32 v[74:75], v[74:75], v[100:101] op_sel:[0,1] op_sel_hi:[1,1]
v_pk_mul_f32 v[228:229], v[228:229], v[104:105] op_sel:[0,1] op_sel_hi:[1,1]
v_pk_mul_f32 v[230:231], v[230:231], v[104:105] op_sel:[0,1] op_sel_hi:[1,1]
v_pk_mul_f32 v[232:233], v[232:233], v[104:105] op_sel:[0,1] op_sel_hi:[1,1]
v_pk_mul_f32 v[234:235], v[234:235], v[104:105] op_sel:[0,1] op_sel_hi:[1,1]
v_cvt_pk_bf16_f32 v68, v68, v69
v_mfma_f32_16x16x32_bf16 v[112:115], v[204:207], v[60:63], 0
v_cvt_pk_bf16_f32 v69, v70, v71
v_cvt_pk_bf16_f32 v70, v72, v73
v_cvt_pk_bf16_f32 v71, v74, v75
v_cvt_pk_bf16_f32 v228, v228, v229
v_mfma_f32_16x16x32_bf16 v[112:115], v[208:211], v[220:223], v[112:115]
v_cvt_pk_bf16_f32 v229, v230, v231
v_cvt_pk_bf16_f32 v230, v232, v233
v_cvt_pk_bf16_f32 v231, v234, v235
v_pk_mul_f32 v[76:77], v[76:77], v[102:103] op_sel:[0,0] op_sel_hi:[1,0]
v_pk_mul_f32 v[78:79], v[78:79], v[102:103] op_sel:[0,0] op_sel_hi:[1,0]
v_pk_mul_f32 v[80:81], v[80:81], v[102:103] op_sel:[0,0] op_sel_hi:[1,0]
v_pk_mul_f32 v[82:83], v[82:83], v[102:103] op_sel:[0,0] op_sel_hi:[1,0]
v_pk_mul_f32 v[236:237], v[236:237], v[106:107] op_sel:[0,0] op_sel_hi:[1,0]
v_pk_mul_f32 v[238:239], v[238:239], v[106:107] op_sel:[0,0] op_sel_hi:[1,0]
v_pk_mul_f32 v[240:241], v[240:241], v[106:107] op_sel:[0,0] op_sel_hi:[1,0]
v_pk_mul_f32 v[242:243], v[242:243], v[106:107] op_sel:[0,0] op_sel_hi:[1,0]
v_cvt_pk_bf16_f32 v76, v76, v77
v_mfma_f32_16x16x32_bf16 v[116:119], v[204:207], v[68:71], 0
v_cvt_pk_bf16_f32 v77, v78, v79
v_cvt_pk_bf16_f32 v78, v80, v81
v_cvt_pk_bf16_f32 v79, v82, v83
v_cvt_pk_bf16_f32 v236, v236, v237
v_mfma_f32_16x16x32_bf16 v[116:119], v[208:211], v[228:231], v[116:119]
v_cvt_pk_bf16_f32 v237, v238, v239
v_cvt_pk_bf16_f32 v238, v240, v241
v_cvt_pk_bf16_f32 v239, v242, v243
v_pk_mul_f32 v[84:85], v[84:85], v[102:103] op_sel:[0,1] op_sel_hi:[1,1]
v_pk_mul_f32 v[86:87], v[86:87], v[102:103] op_sel:[0,1] op_sel_hi:[1,1]
v_pk_mul_f32 v[88:89], v[88:89], v[102:103] op_sel:[0,1] op_sel_hi:[1,1]
v_pk_mul_f32 v[90:91], v[90:91], v[102:103] op_sel:[0,1] op_sel_hi:[1,1]
v_pk_mul_f32 v[244:245], v[244:245], v[106:107] op_sel:[0,1] op_sel_hi:[1,1]
v_pk_mul_f32 v[246:247], v[246:247], v[106:107] op_sel:[0,1] op_sel_hi:[1,1]
v_pk_mul_f32 v[248:249], v[248:249], v[106:107] op_sel:[0,1] op_sel_hi:[1,1]
v_pk_mul_f32 v[250:251], v[250:251], v[106:107] op_sel:[0,1] op_sel_hi:[1,1]
v_cvt_pk_bf16_f32 v84, v84, v85
v_mfma_f32_16x16x32_bf16 v[120:123], v[204:207], v[76:79], 0
v_cvt_pk_bf16_f32 v85, v86, v87
v_cvt_pk_bf16_f32 v86, v88, v89
v_cvt_pk_bf16_f32 v87, v90, v91
v_cvt_pk_bf16_f32 v244, v244, v245
v_mfma_f32_16x16x32_bf16 v[120:123], v[208:211], v[236:239], v[120:123]
v_cvt_pk_bf16_f32 v245, v246, v247
v_cvt_pk_bf16_f32 v246, v248, v249
v_cvt_pk_bf16_f32 v247, v250, v251
buffer_load_dwordx4 v[188:191], v18, s[32:35], s58 offen offset:0 sc1
buffer_load_dwordx4 v[192:195], v18, s[32:35], s58 offen offset:1024 sc1
v_mfma_f32_16x16x32_bf16 v[124:127], v[204:207], v[84:87], 0
v_mfma_f32_16x16x32_bf16 v[124:127], v[208:211], v[244:247], v[124:127]
buffer_load_dwordx4 v[196:199], v18, s[32:35], s59 offen offset:0 sc1
buffer_load_dwordx4 v[200:203], v18, s[32:35], s59 offen offset:1024 sc1
v_add_f32 v100, v112, v113
v_add_f32 v114, v114, v115
v_add_f32 v100, v100, v114
v_add_f32 v101, v116, v117
v_add_f32 v118, v118, v119
v_add_f32 v101, v101, v118
v_add_f32 v102, v120, v121
v_add_f32 v122, v122, v123
v_add_f32 v102, v102, v122
v_add_f32 v103, v124, v125
v_add_f32 v126, v126, v127
v_add_f32 v103, v103, v126
s_nop 1
v_permlane32_swap_b32 v100, v101
v_permlane32_swap_b32 v102, v103
v_add_f32 v100, v100, v101
v_add_f32 v102, v102, v103
s_nop 1
v_permlane16_swap_b32 v100, v102
s_nop 0
v_add_f32 v100, v100, v102
v_add_f32 v100, 0x358637bd, v100
v_rcp_f32 v100, v100
s_nop 0
v_mov_b32 v102, v100
s_nop 1
v_permlane16_swap_b32 v100, v102
s_nop 0
v_mov_b32 v101, v100
v_mov_b32 v103, v102
s_nop 0
v_permlane32_swap_b32 v100, v101
v_permlane32_swap_b32 v102, v103
s_mov_b32 s63, 0
sent_66:
s_waitcnt vmcnt(0)
v_max_u32 v4, v188, v189
v_max3_u32 v4, v4, v190, v191
v_max3_u32 v4, v4, v192, v193
v_max3_u32 v4, v4, v194, v195
v_max3_u32 v4, v4, v196, v197
v_max3_u32 v4, v4, v198, v199
v_max3_u32 v4, v4, v200, v201
v_max3_u32 v4, v4, v202, v203
v_cmp_eq_u32 vcc, -1, v4
s_cbranch_vccz sentd_67
buffer_load_dwordx4 v[188:191], v18, s[32:35], s58 offen offset:0 sc1
buffer_load_dwordx4 v[192:195], v18, s[32:35], s58 offen offset:1024 sc1
buffer_load_dwordx4 v[196:199], v18, s[32:35], s59 offen offset:0 sc1
buffer_load_dwordx4 v[200:203], v18, s[32:35], s59 offen offset:1024 sc1
s_add_u32 s63, s63, 1
s_cmp_lt_u32 s63, 0x80000
s_cbranch_scc1 sent_66
s_waitcnt vmcnt(0)
sentd_67:
v_mfma_f32_16x16x32_bf16 v[156:159], v[188:191], v[60:63], 0
v_mfma_f32_16x16x32_bf16 v[160:163], v[192:195], v[60:63], 0
v_mfma_f32_16x16x32_bf16 v[156:159], v[196:199], v[220:223], v[156:159]
v_mfma_f32_16x16x32_bf16 v[160:163], v[200:203], v[220:223], v[160:163]
v_mfma_f32_16x16x32_bf16 v[164:167], v[188:191], v[68:71], 0
v_mfma_f32_16x16x32_bf16 v[168:171], v[192:195], v[68:71], 0
v_mfma_f32_16x16x32_bf16 v[164:167], v[196:199], v[228:231], v[164:167]
v_mfma_f32_16x16x32_bf16 v[168:171], v[200:203], v[228:231], v[168:171]
v_mfma_f32_16x16x32_bf16 v[172:175], v[188:191], v[76:79], 0
v_mfma_f32_16x16x32_bf16 v[176:179], v[192:195], v[76:79], 0
v_mfma_f32_16x16x32_bf16 v[172:175], v[196:199], v[236:239], v[172:175]
v_mfma_f32_16x16x32_bf16 v[176:179], v[200:203], v[236:239], v[176:179]
v_mfma_f32_16x16x32_bf16 v[180:183], v[188:191], v[84:87], 0
v_mfma_f32_16x16x32_bf16 v[184:187], v[192:195], v[84:87], 0
v_mfma_f32_16x16x32_bf16 v[180:183], v[196:199], v[244:247], v[180:183]
v_mfma_f32_16x16x32_bf16 v[184:187], v[200:203], v[244:247], v[184:187]
s_cmp_eq_u32 s46, 0
s_cbranch_scc1 slow_68
.p2align 3
v_pk_mul_f32 v[156:157], v[156:157], v[100:101] op_sel:[0,0] op_sel_hi:[1,0]
v_pk_mul_f32 v[158:159], v[158:159], v[100:101] op_sel:[0,0] op_sel_hi:[1,0]
v_pk_mul_f32 v[160:161], v[160:161], v[100:101] op_sel:[0,0] op_sel_hi:[1,0]
v_pk_mul_f32 v[162:163], v[162:163], v[100:101] op_sel:[0,0] op_sel_hi:[1,0]
v_cvt_pk_bf16_f32 v156, v156, v157
v_cvt_pk_bf16_f32 v157, v158, v159
v_cvt_pk_bf16_f32 v158, v160, v161
v_cvt_pk_bf16_f32 v159, v162, v163
buffer_store_dwordx4 v[156:159], v18, s[32:35], s80 offen
v_pk_mul_f32 v[164:165], v[164:165], v[100:101] op_sel:[0,1] op_sel_hi:[1,1]
v_pk_mul_f32 v[166:167], v[166:167], v[100:101] op_sel:[0,1] op_sel_hi:[1,1]
v_pk_mul_f32 v[168:169], v[168:169], v[100:101] op_sel:[0,1] op_sel_hi:[1,1]
v_pk_mul_f32 v[170:171], v[170:171], v[100:101] op_sel:[0,1] op_sel_hi:[1,1]
v_cvt_pk_bf16_f32 v164, v164, v165
v_cvt_pk_bf16_f32 v165, v166, v167
v_cvt_pk_bf16_f32 v166, v168, v169
v_cvt_pk_bf16_f32 v167, v170, v171
buffer_store_dwordx4 v[164:167], v18, s[32:35], s81 offen
v_pk_mul_f32 v[172:173], v[172:173], v[102:103] op_sel:[0,0] op_sel_hi:[1,0]
v_pk_mul_f32 v[174:175], v[174:175], v[102:103] op_sel:[0,0] op_sel_hi:[1,0]
v_pk_mul_f32 v[176:177], v[176:177], v[102:103] op_sel:[0,0] op_sel_hi:[1,0]
v_pk_mul_f32 v[178:179], v[178:179], v[102:103] op_sel:[0,0] op_sel_hi:[1,0]
v_cvt_pk_bf16_f32 v172, v172, v173
v_cvt_pk_bf16_f32 v173, v174, v175
v_cvt_pk_bf16_f32 v174, v176, v177
v_cvt_pk_bf16_f32 v175, v178, v179
buffer_store_dwordx4 v[172:175], v18, s[32:35], s82 offen
v_pk_mul_f32 v[180:181], v[180:181], v[102:103] op_sel:[0,1] op_sel_hi:[1,1]
v_pk_mul_f32 v[182:183], v[182:183], v[102:103] op_sel:[0,1] op_sel_hi:[1,1]
v_pk_mul_f32 v[184:185], v[184:185], v[102:103] op_sel:[0,1] op_sel_hi:[1,1]
v_pk_mul_f32 v[186:187], v[186:187], v[102:103] op_sel:[0,1] op_sel_hi:[1,1]
v_cvt_pk_bf16_f32 v180, v180, v181
v_cvt_pk_bf16_f32 v181, v182, v183
v_cvt_pk_bf16_f32 v182, v184, v185
v_cvt_pk_bf16_f32 v183, v186, v187
buffer_store_dwordx4 v[180:183], v18, s[32:35], s83 offen
s_barrier
s_lshl_b32 s62, s45, 2
v_mov_b32 v4, s62
v_mov_b32 v5, 2
s_mov_b64 exec, 1
s_waitcnt vmcnt(0)
buffer_store_dword v5, v4, s[32:35], s84 offen
s_mov_b64 exec, -1
back_69:
v_and_b32 v36, 31, v0
v_lshlrev_b32 v36, 2, v36
buffer_load_dword v37, v36, s[32:35], s84 offen sc1
v_lshrrev_b32 v4, 2, v2
v_and_b32 v5, 3, v0
v_lshl_add_u32 v6, v3, 3, v4
v_lshlrev_b32 v6, 7, v6
v_lshl_add_u32 v6, v5, 3, v6
v_lshrrev_b32 v7, 1, v4
v_and_b32 v8, 1, v3
v_lshl_add_u32 v7, v8, 1, v7
v_lshl_add_u32 v10, v7, 5, v6
v_xor_b32 v11, 32, v10
v_xor_b32 v12, 64, v10
v_xor_b32 v13, 96, v10
v_add_u32 v14, 0x10000, v10
v_add_u32 v15, 0x10000, v11
v_add_u32 v16, 0x10000, v12
v_add_u32 v17, 0x10000, v13
ds_read_b64_tr_b16 v[220:221], v10 offset:0
ds_read_b64_tr_b16 v[222:223], v10 offset:512
ds_read_b64_tr_b16 v[224:225], v11 offset:0
ds_read_b64_tr_b16 v[226:227], v11 offset:512
ds_read_b64_tr_b16 v[228:229], v12 offset:0
ds_read_b64_tr_b16 v[230:231], v12 offset:512
ds_read_b64_tr_b16 v[232:233], v13 offset:0
ds_read_b64_tr_b16 v[234:235], v13 offset:512
ds_read_b64_tr_b16 v[236:237], v10 offset:4096
ds_read_b64_tr_b16 v[238:239], v10 offset:4608
ds_read_b64_tr_b16 v[240:241], v11 offset:4096
ds_read_b64_tr_b16 v[242:243], v11 offset:4608
ds_read_b64_tr_b16 v[244:245], v12 offset:4096
ds_read_b64_tr_b16 v[246:247], v12 offset:4608
ds_read_b64_tr_b16 v[248:249], v13 offset:4096
ds_read_b64_tr_b16 v[250:251], v13 offset:4608
s_lshl_b32 s48, s41, 3
s_lshl_b32 s49, s40, 1
s_add_u32 s48, s48, s49
s_lshl_b32 s48, s48, 15
s_add_u32 s48, s48, 4194304
v_add_u32 v38, s48, v18
v_add_u32 v39, 32768, v38
s_lshl_b32 s57, s75, 11
s_add_u32 s87, s87, 262144
v_lshlrev_b32 v60, 16, v20
v_and_b32 v61, 0xffff0000, v20
v_lshlrev_b32 v62, 16, v21
v_and_b32 v63, 0xffff0000, v21
v_lshlrev_b32 v64, 16, v22
v_and_b32 v65, 0xffff0000, v22
v_lshlrev_b32 v66, 16, v23
v_and_b32 v67, 0xffff0000, v23
v_lshlrev_b32 v68, 16, v24
v_and_b32 v69, 0xffff0000, v24
v_lshlrev_b32 v70, 16, v25
v_and_b32 v71, 0xffff0000, v25
v_lshlrev_b32 v72, 16, v26
v_and_b32 v73, 0xffff0000, v26
v_lshlrev_b32 v74, 16, v27
v_and_b32 v75, 0xffff0000, v27
v_lshlrev_b32 v76, 16, v28
v_and_b32 v77, 0xffff0000, v28
v_lshlrev_b32 v78, 16, v29
v_and_b32 v79, 0xffff0000, v29
v_lshlrev_b32 v80, 16, v30
v_and_b32 v81, 0xffff0000, v30
v_lshlrev_b32 v82, 16, v31
v_and_b32 v83, 0xffff0000, v31
v_lshlrev_b32 v84, 16, v32
v_and_b32 v85, 0xffff0000, v32
v_lshlrev_b32 v86, 16, v33
v_and_b32 v87, 0xffff0000, v33
v_lshlrev_b32 v88, 16, v34
v_and_b32 v89, 0xffff0000, v34
v_lshlrev_b32 v90, 16, v35
v_and_b32 v91, 0xffff0000, v35
v_mov_b32 v6, 0
v_mov_b32 v7, 0
v_mov_b32 v8, 0
v_mov_b32 v9, 0
s_lshl_b32 s62, s42, 2
v_mov_b32 v4, s62
v_mov_b32 v5, 2
s_mov_b32 s63, 0
s_waitcnt vmcnt(0)
poll_70:
v_cmp_gt_u32 vcc, 2, v37
s_cbranch_vccz polled_71
buffer_load_dword v37, v36, s[32:35], s84 offen sc1
s_add_u32 s63, s63, 1
s_cmp_lt_u32 s63, 0x80000
s_waitcnt vmcnt(0)
s_cbranch_scc1 poll_70
polled_71:
buffer_load_dwordx4 v[156:159], v38, s[32:35], s57 offen sc1
buffer_load_dwordx4 v[160:163], v39, s[32:35], s57 offen sc1
buffer_load_dwordx4 v[164:167], v38, s[32:35], s57 offen offset:1024 sc1
buffer_load_dwordx4 v[168:171], v39, s[32:35], s57 offen offset:1024 sc1
s_add_u32 s57, s57, 2048
s_and_b32 s57, s57, 0x7fff
buffer_load_dwordx4 v[172:175], v38, s[32:35], s57 offen sc1
buffer_load_dwordx4 v[176:179], v39, s[32:35], s57 offen sc1
buffer_load_dwordx4 v[180:183], v38, s[32:35], s57 offen offset:1024 sc1
buffer_load_dwordx4 v[184:187], v39, s[32:35], s57 offen offset:1024 sc1
s_add_u32 s57, s57, 2048
s_and_b32 s57, s57, 0x7fff
s_waitcnt vmcnt(6) lgkmcnt(8)
v_mfma_f32_16x16x32_bf16 v[60:63], v[220:223], v[156:159], v[60:63]
buffer_load_dwordx4 v[188:191], v38, s[32:35], s57 offen sc1
v_mfma_f32_16x16x32_bf16 v[76:79], v[220:223], v[160:163], v[76:79]
ds_read_b64_tr_b16 v[100:101], v10 offset:8192
ds_read_b64_tr_b16 v[102:103], v10 offset:8704
v_mfma_f32_16x16x32_bf16 v[64:67], v[224:227], v[156:159], v[64:67]
ds_read_b64_tr_b16 v[104:105], v11 offset:8192
ds_read_b64_tr_b16 v[106:107], v11 offset:8704
v_mfma_f32_16x16x32_bf16 v[80:83], v[224:227], v[160:163], v[80:83]
buffer_load_dwordx4 v[192:195], v39, s[32:35], s57 offen sc1
v_mfma_f32_16x16x32_bf16 v[68:71], v[228:231], v[156:159], v[68:71]
ds_read_b64_tr_b16 v[108:109], v12 offset:8192
ds_read_b64_tr_b16 v[110:111], v12 offset:8704
v_mfma_f32_16x16x32_bf16 v[84:87], v[228:231], v[160:163], v[84:87]
ds_read_b64_tr_b16 v[112:113], v13 offset:8192
ds_read_b64_tr_b16 v[114:115], v13 offset:8704
v_mfma_f32_16x16x32_bf16 v[72:75], v[232:235], v[156:159], v[72:75]
v_mfma_f32_16x16x32_bf16 v[88:91], v[232:235], v[160:163], v[88:91]
s_waitcnt vmcnt(6) lgkmcnt(8)
v_mfma_f32_16x16x32_bf16 v[60:63], v[236:239], v[164:167], v[60:63]
buffer_load_dwordx4 v[196:199], v38, s[32:35], s57 offen offset:1024 sc1
v_mfma_f32_16x16x32_bf16 v[76:79], v[236:239], v[168:171], v[76:79]
ds_read_b64_tr_b16 v[220:221], v10 offset:12288
ds_read_b64_tr_b16 v[222:223], v10 offset:12800
v_mfma_f32_16x16x32_bf16 v[64:67], v[240:243], v[164:167], v[64:67]
ds_read_b64_tr_b16 v[224:225], v11 offset:12288
ds_read_b64_tr_b16 v[226:227], v11 offset:12800
v_mfma_f32_16x16x32_bf16 v[80:83], v[240:243], v[168:171], v[80:83]
buffer_load_dwordx4 v[200:203], v39, s[32:35], s57 offen offset:1024 sc1
v_mfma_f32_16x16x32_bf16 v[68:71], v[244:247], v[164:167], v[68:71]
ds_read_b64_tr_b16 v[228:229], v12 offset:12288
ds_read_b64_tr_b16 v[230:231], v12 offset:12800
v_mfma_f32_16x16x32_bf16 v[84:87], v[244:247], v[168:171], v[84:87]
ds_read_b64_tr_b16 v[232:233], v13 offset:12288
ds_read_b64_tr_b16 v[234:235], v13 offset:12800
v_mfma_f32_16x16x32_bf16 v[72:75], v[248:251], v[164:167], v[72:75]
s_add_u32 s57, s57, 2048
s_and_b32 s57, s57, 0x7fff
v_mfma_f32_16x16x32_bf16 v[88:91], v[248:251], v[168:171], v[88:91]
s_waitcnt vmcnt(6) lgkmcnt(8)
v_mfma_f32_16x16x32_bf16 v[60:63], v[100:103], v[172:175], v[60:63]
buffer_load_dwordx4 v[204:207], v38, s[32:35], s57 offen sc1
v_mfma_f32_16x16x32_bf16 v[76:79], v[100:103], v[176:179], v[76:79]
ds_read_b64_tr_b16 v[236:237], v10 offset:16384
ds_read_b64_tr_b16 v[238:239], v10 offset:16896
v_mfma_f32_16x16x32_bf16 v[64:67], v[104:107], v[172:175], v[64:67]
ds_read_b64_tr_b16 v[240:241], v11 offset:16384
ds_read_b64_tr_b16 v[242:243], v11 offset:16896
v_mfma_f32_16x16x32_bf16 v[80:83], v[104:107], v[176:179], v[80:83]
buffer_load_dwordx4 v[208:211], v39, s[32:35], s57 offen sc1
v_mfma_f32_16x16x32_bf16 v[68:71], v[108:111], v[172:175], v[68:71]
ds_read_b64_tr_b16 v[244:245], v12 offset:16384
ds_read_b64_tr_b16 v[246:247], v12 offset:16896
v_mfma_f32_16x16x32_bf16 v[84:87], v[108:111], v[176:179], v[84:87]
ds_read_b64_tr_b16 v[248:249], v13 offset:16384
ds_read_b64_tr_b16 v[250:251], v13 offset:16896
v_mfma_f32_16x16x32_bf16 v[72:75], v[112:115], v[172:175], v[72:75]
v_mfma_f32_16x16x32_bf16 v[88:91], v[112:115], v[176:179], v[88:91]
s_waitcnt vmcnt(6) lgkmcnt(8)
v_mfma_f32_16x16x32_bf16 v[60:63], v[220:223], v[180:183], v[60:63]
buffer_load_dwordx4 v[212:215], v38, s[32:35], s57 offen offset:1024 sc1
v_mfma_f32_16x16x32_bf16 v[76:79], v[220:223], v[184:187], v[76:79]
ds_read_b64_tr_b16 v[100:101], v10 offset:20480
ds_read_b64_tr_b16 v[102:103], v10 offset:20992
v_mfma_f32_16x16x32_bf16 v[64:67], v[224:227], v[180:183], v[64:67]
ds_read_b64_tr_b16 v[104:105], v11 offset:20480
ds_read_b64_tr_b16 v[106:107], v11 offset:20992
v_mfma_f32_16x16x32_bf16 v[80:83], v[224:227], v[184:187], v[80:83]
buffer_load_dwordx4 v[216:219], v39, s[32:35], s57 offen offset:1024 sc1
v_mfma_f32_16x16x32_bf16 v[68:71], v[228:231], v[180:183], v[68:71]
ds_read_b64_tr_b16 v[108:109], v12 offset:20480
ds_read_b64_tr_b16 v[110:111], v12 offset:20992
v_mfma_f32_16x16x32_bf16 v[84:87], v[228:231], v[184:187], v[84:87]
ds_read_b64_tr_b16 v[112:113], v13 offset:20480
ds_read_b64_tr_b16 v[114:115], v13 offset:20992
v_mfma_f32_16x16x32_bf16 v[72:75], v[232:235], v[180:183], v[72:75]
s_add_u32 s57, s57, 2048
s_and_b32 s57, s57, 0x7fff
v_mfma_f32_16x16x32_bf16 v[88:91], v[232:235], v[184:187], v[88:91]
s_waitcnt vmcnt(6) lgkmcnt(8)
v_mfma_f32_16x16x32_bf16 v[60:63], v[236:239], v[188:191], v[60:63]
buffer_load_dwordx4 v[156:159], v38, s[32:35], s57 offen sc1
v_mfma_f32_16x16x32_bf16 v[76:79], v[236:239], v[192:195], v[76:79]
ds_read_b64_tr_b16 v[220:221], v10 offset:24576
ds_read_b64_tr_b16 v[222:223], v10 offset:25088
v_mfma_f32_16x16x32_bf16 v[64:67], v[240:243], v[188:191], v[64:67]
ds_read_b64_tr_b16 v[224:225], v11 offset:24576
ds_read_b64_tr_b16 v[226:227], v11 offset:25088
v_mfma_f32_16x16x32_bf16 v[80:83], v[240:243], v[192:195], v[80:83]
buffer_load_dwordx4 v[160:163], v39, s[32:35], s57 offen sc1
v_mfma_f32_16x16x32_bf16 v[68:71], v[244:247], v[188:191], v[68:71]
ds_read_b64_tr_b16 v[228:229], v12 offset:24576
ds_read_b64_tr_b16 v[230:231], v12 offset:25088
v_mfma_f32_16x16x32_bf16 v[84:87], v[244:247], v[192:195], v[84:87]
ds_read_b64_tr_b16 v[232:233], v13 offset:24576
ds_read_b64_tr_b16 v[234:235], v13 offset:25088
v_mfma_f32_16x16x32_bf16 v[72:75], v[248:251], v[188:191], v[72:75]
v_mfma_f32_16x16x32_bf16 v[88:91], v[248:251], v[192:195], v[88:91]
s_waitcnt vmcnt(6) lgkmcnt(8)
v_mfma_f32_16x16x32_bf16 v[60:63], v[100:103], v[196:199], v[60:63]
buffer_load_dwordx4 v[164:167], v38, s[32:35], s57 offen offset:1024 sc1
v_mfma_f32_16x16x32_bf16 v[76:79], v[100:103], v[200:203], v[76:79]
ds_read_b64_tr_b16 v[236:237], v10 offset:28672
ds_read_b64_tr_b16 v[238:239], v10 offset:29184
v_mfma_f32_16x16x32_bf16 v[64:67], v[104:107], v[196:199], v[64:67]
ds_read_b64_tr_b16 v[240:241], v11 offset:28672
ds_read_b64_tr_b16 v[242:243], v11 offset:29184
v_mfma_f32_16x16x32_bf16 v[80:83], v[104:107], v[200:203], v[80:83]
buffer_load_dwordx4 v[168:171], v39, s[32:35], s57 offen offset:1024 sc1
v_mfma_f32_16x16x32_bf16 v[68:71], v[108:111], v[196:199], v[68:71]
ds_read_b64_tr_b16 v[244:245], v12 offset:28672
ds_read_b64_tr_b16 v[246:247], v12 offset:29184
v_mfma_f32_16x16x32_bf16 v[84:87], v[108:111], v[200:203], v[84:87]
ds_read_b64_tr_b16 v[248:249], v13 offset:28672
ds_read_b64_tr_b16 v[250:251], v13 offset:29184
v_mfma_f32_16x16x32_bf16 v[72:75], v[112:115], v[196:199], v[72:75]
s_add_u32 s57, s57, 2048
s_and_b32 s57, s57, 0x7fff
v_mfma_f32_16x16x32_bf16 v[88:91], v[112:115], v[200:203], v[88:91]
s_waitcnt vmcnt(6) lgkmcnt(8)
v_mfma_f32_16x16x32_bf16 v[60:63], v[220:223], v[204:207], v[60:63]
buffer_load_dwordx4 v[172:175], v38, s[32:35], s57 offen sc1
v_mfma_f32_16x16x32_bf16 v[76:79], v[220:223], v[208:211], v[76:79]
ds_read_b64_tr_b16 v[100:101], v10 offset:32768
ds_read_b64_tr_b16 v[102:103], v10 offset:33280
v_mfma_f32_16x16x32_bf16 v[64:67], v[224:227], v[204:207], v[64:67]
ds_read_b64_tr_b16 v[104:105], v11 offset:32768
ds_read_b64_tr_b16 v[106:107], v11 offset:33280
v_mfma_f32_16x16x32_bf16 v[80:83], v[224:227], v[208:211], v[80:83]
buffer_load_dwordx4 v[176:179], v39, s[32:35], s57 offen sc1
v_mfma_f32_16x16x32_bf16 v[68:71], v[228:231], v[204:207], v[68:71]
ds_read_b64_tr_b16 v[108:109], v12 offset:32768
ds_read_b64_tr_b16 v[110:111], v12 offset:33280
v_mfma_f32_16x16x32_bf16 v[84:87], v[228:231], v[208:211], v[84:87]
ds_read_b64_tr_b16 v[112:113], v13 offset:32768
ds_read_b64_tr_b16 v[114:115], v13 offset:33280
v_mfma_f32_16x16x32_bf16 v[72:75], v[232:235], v[204:207], v[72:75]
v_mfma_f32_16x16x32_bf16 v[88:91], v[232:235], v[208:211], v[88:91]
s_waitcnt vmcnt(6) lgkmcnt(8)
v_mfma_f32_16x16x32_bf16 v[60:63], v[236:239], v[212:215], v[60:63]
buffer_load_dwordx4 v[180:183], v38, s[32:35], s57 offen offset:1024 sc1
v_mfma_f32_16x16x32_bf16 v[76:79], v[236:239], v[216:219], v[76:79]
ds_read_b64_tr_b16 v[220:221], v10 offset:36864
ds_read_b64_tr_b16 v[222:223], v10 offset:37376
v_mfma_f32_16x16x32_bf16 v[64:67], v[240:243], v[212:215], v[64:67]
ds_read_b64_tr_b16 v[224:225], v11 offset:36864
ds_read_b64_tr_b16 v[226:227], v11 offset:37376
v_mfma_f32_16x16x32_bf16 v[80:83], v[240:243], v[216:219], v[80:83]
buffer_load_dwordx4 v[184:187], v39, s[32:35], s57 offen offset:1024 sc1
v_mfma_f32_16x16x32_bf16 v[68:71], v[244:247], v[212:215], v[68:71]
ds_read_b64_tr_b16 v[228:229], v12 offset:36864
ds_read_b64_tr_b16 v[230:231], v12 offset:37376
v_mfma_f32_16x16x32_bf16 v[84:87], v[244:247], v[216:219], v[84:87]
ds_read_b64_tr_b16 v[232:233], v13 offset:36864
ds_read_b64_tr_b16 v[234:235], v13 offset:37376
v_mfma_f32_16x16x32_bf16 v[72:75], v[248:251], v[212:215], v[72:75]
s_add_u32 s57, s57, 2048
s_and_b32 s57, s57, 0x7fff
v_mfma_f32_16x16x32_bf16 v[88:91], v[248:251], v[216:219], v[88:91]
s_waitcnt vmcnt(6) lgkmcnt(8)
v_mfma_f32_16x16x32_bf16 v[60:63], v[100:103], v[156:159], v[60:63]
buffer_load_dwordx4 v[188:191], v38, s[32:35], s57 offen sc1
v_mfma_f32_16x16x32_bf16 v[76:79], v[100:103], v[160:163], v[76:79]
ds_read_b64_tr_b16 v[236:237], v10 offset:40960
ds_read_b64_tr_b16 v[238:239], v10 offset:41472
v_mfma_f32_16x16x32_bf16 v[64:67], v[104:107], v[156:159], v[64:67]
ds_read_b64_tr_b16 v[240:241], v11 offset:40960
ds_read_b64_tr_b16 v[242:243], v11 offset:41472
v_mfma_f32_16x16x32_bf16 v[80:83], v[104:107], v[160:163], v[80:83]
buffer_load_dwordx4 v[192:195], v39, s[32:35], s57 offen sc1
v_mfma_f32_16x16x32_bf16 v[68:71], v[108:111], v[156:159], v[68:71]
ds_read_b64_tr_b16 v[244:245], v12 offset:40960
ds_read_b64_tr_b16 v[246:247], v12 offset:41472
v_mfma_f32_16x16x32_bf16 v[84:87], v[108:111], v[160:163], v[84:87]
ds_read_b64_tr_b16 v[248:249], v13 offset:40960
ds_read_b64_tr_b16 v[250:251], v13 offset:41472
v_mfma_f32_16x16x32_bf16 v[72:75], v[112:115], v[156:159], v[72:75]
v_mfma_f32_16x16x32_bf16 v[88:91], v[112:115], v[160:163], v[88:91]
s_waitcnt vmcnt(6) lgkmcnt(8)
v_mfma_f32_16x16x32_bf16 v[60:63], v[220:223], v[164:167], v[60:63]
buffer_load_dwordx4 v[196:199], v38, s[32:35], s57 offen offset:1024 sc1
v_mfma_f32_16x16x32_bf16 v[76:79], v[220:223], v[168:171], v[76:79]
ds_read_b64_tr_b16 v[100:101], v10 offset:45056
ds_read_b64_tr_b16 v[102:103], v10 offset:45568
v_mfma_f32_16x16x32_bf16 v[64:67], v[224:227], v[164:167], v[64:67]
ds_read_b64_tr_b16 v[104:105], v11 offset:45056
ds_read_b64_tr_b16 v[106:107], v11 offset:45568
v_mfma_f32_16x16x32_bf16 v[80:83], v[224:227], v[168:171], v[80:83]
buffer_load_dwordx4 v[200:203], v39, s[32:35], s57 offen offset:1024 sc1
v_mfma_f32_16x16x32_bf16 v[68:71], v[228:231], v[164:167], v[68:71]
ds_read_b64_tr_b16 v[108:109], v12 offset:45056
ds_read_b64_tr_b16 v[110:111], v12 offset:45568
v_mfma_f32_16x16x32_bf16 v[84:87], v[228:231], v[168:171], v[84:87]
ds_read_b64_tr_b16 v[112:113], v13 offset:45056
ds_read_b64_tr_b16 v[114:115], v13 offset:45568
v_mfma_f32_16x16x32_bf16 v[72:75], v[232:235], v[164:167], v[72:75]
s_add_u32 s57, s57, 2048
s_and_b32 s57, s57, 0x7fff
v_mfma_f32_16x16x32_bf16 v[88:91], v[232:235], v[168:171], v[88:91]
s_waitcnt vmcnt(6) lgkmcnt(8)
v_mfma_f32_16x16x32_bf16 v[60:63], v[236:239], v[172:175], v[60:63]
buffer_load_dwordx4 v[204:207], v38, s[32:35], s57 offen sc1
v_mfma_f32_16x16x32_bf16 v[76:79], v[236:239], v[176:179], v[76:79]
ds_read_b64_tr_b16 v[220:221], v10 offset:49152
ds_read_b64_tr_b16 v[222:223], v10 offset:49664
v_mfma_f32_16x16x32_bf16 v[64:67], v[240:243], v[172:175], v[64:67]
ds_read_b64_tr_b16 v[224:225], v11 offset:49152
ds_read_b64_tr_b16 v[226:227], v11 offset:49664
v_mfma_f32_16x16x32_bf16 v[80:83], v[240:243], v[176:179], v[80:83]
buffer_load_dwordx4 v[208:211], v39, s[32:35], s57 offen sc1
v_mfma_f32_16x16x32_bf16 v[68:71], v[244:247], v[172:175], v[68:71]
ds_read_b64_tr_b16 v[228:229], v12 offset:49152
ds_read_b64_tr_b16 v[230:231], v12 offset:49664
v_mfma_f32_16x16x32_bf16 v[84:87], v[244:247], v[176:179], v[84:87]
ds_read_b64_tr_b16 v[232:233], v13 offset:49152
ds_read_b64_tr_b16 v[234:235], v13 offset:49664
v_mfma_f32_16x16x32_bf16 v[72:75], v[248:251], v[172:175], v[72:75]
v_mfma_f32_16x16x32_bf16 v[88:91], v[248:251], v[176:179], v[88:91]
s_waitcnt vmcnt(6) lgkmcnt(8)
v_mfma_f32_16x16x32_bf16 v[60:63], v[100:103], v[180:183], v[60:63]
buffer_load_dwordx4 v[212:215], v38, s[32:35], s57 offen offset:1024 sc1
v_mfma_f32_16x16x32_bf16 v[76:79], v[100:103], v[184:187], v[76:79]
ds_read_b64_tr_b16 v[236:237], v10 offset:53248
ds_read_b64_tr_b16 v[238:239], v10 offset:53760
v_mfma_f32_16x16x32_bf16 v[64:67], v[104:107], v[180:183], v[64:67]
ds_read_b64_tr_b16 v[240:241], v11 offset:53248
ds_read_b64_tr_b16 v[242:243], v11 offset:53760
v_mfma_f32_16x16x32_bf16 v[80:83], v[104:107], v[184:187], v[80:83]
buffer_load_dwordx4 v[216:219], v39, s[32:35], s57 offen offset:1024 sc1
v_mfma_f32_16x16x32_bf16 v[68:71], v[108:111], v[180:183], v[68:71]
ds_read_b64_tr_b16 v[244:245], v12 offset:53248
ds_read_b64_tr_b16 v[246:247], v12 offset:53760
v_mfma_f32_16x16x32_bf16 v[84:87], v[108:111], v[184:187], v[84:87]
ds_read_b64_tr_b16 v[248:249], v13 offset:53248
ds_read_b64_tr_b16 v[250:251], v13 offset:53760
v_mfma_f32_16x16x32_bf16 v[72:75], v[112:115], v[180:183], v[72:75]
s_add_u32 s57, s57, 2048
s_and_b32 s57, s57, 0x7fff
v_mfma_f32_16x16x32_bf16 v[88:91], v[112:115], v[184:187], v[88:91]
s_waitcnt vmcnt(6) lgkmcnt(8)
v_mfma_f32_16x16x32_bf16 v[60:63], v[220:223], v[188:191], v[60:63]
buffer_load_dwordx4 v[156:159], v38, s[32:35], s57 offen sc1
v_mfma_f32_16x16x32_bf16 v[76:79], v[220:223], v[192:195], v[76:79]
ds_read_b64_tr_b16 v[100:101], v10 offset:57344
ds_read_b64_tr_b16 v[102:103], v10 offset:57856
v_mfma_f32_16x16x32_bf16 v[64:67], v[224:227], v[188:191], v[64:67]
ds_read_b64_tr_b16 v[104:105], v11 offset:57344
ds_read_b64_tr_b16 v[106:107], v11 offset:57856
v_mfma_f32_16x16x32_bf16 v[80:83], v[224:227], v[192:195], v[80:83]
buffer_load_dwordx4 v[160:163], v39, s[32:35], s57 offen sc1
v_mfma_f32_16x16x32_bf16 v[68:71], v[228:231], v[188:191], v[68:71]
ds_read_b64_tr_b16 v[108:109], v12 offset:57344
ds_read_b64_tr_b16 v[110:111], v12 offset:57856
v_mfma_f32_16x16x32_bf16 v[84:87], v[228:231], v[192:195], v[84:87]
ds_read_b64_tr_b16 v[112:113], v13 offset:57344
ds_read_b64_tr_b16 v[114:115], v13 offset:57856
v_mfma_f32_16x16x32_bf16 v[72:75], v[232:235], v[188:191], v[72:75]
v_mfma_f32_16x16x32_bf16 v[88:91], v[232:235], v[192:195], v[88:91]
s_waitcnt vmcnt(6) lgkmcnt(8)
v_mfma_f32_16x16x32_bf16 v[60:63], v[236:239], v[196:199], v[60:63]
buffer_load_dwordx4 v[164:167], v38, s[32:35], s57 offen offset:1024 sc1
v_mfma_f32_16x16x32_bf16 v[76:79], v[236:239], v[200:203], v[76:79]
ds_read_b64_tr_b16 v[220:221], v10 offset:61440
ds_read_b64_tr_b16 v[222:223], v10 offset:61952
v_mfma_f32_16x16x32_bf16 v[64:67], v[240:243], v[196:199], v[64:67]
ds_read_b64_tr_b16 v[224:225], v11 offset:61440
ds_read_b64_tr_b16 v[226:227], v11 offset:61952
v_mfma_f32_16x16x32_bf16 v[80:83], v[240:243], v[200:203], v[80:83]
buffer_load_dwordx4 v[168:171], v39, s[32:35], s57 offen offset:1024 sc1
v_mfma_f32_16x16x32_bf16 v[68:71], v[244:247], v[196:199], v[68:71]
ds_read_b64_tr_b16 v[228:229], v12 offset:61440
ds_read_b64_tr_b16 v[230:231], v12 offset:61952
v_mfma_f32_16x16x32_bf16 v[84:87], v[244:247], v[200:203], v[84:87]
ds_read_b64_tr_b16 v[232:233], v13 offset:61440
ds_read_b64_tr_b16 v[234:235], v13 offset:61952
v_mfma_f32_16x16x32_bf16 v[72:75], v[248:251], v[196:199], v[72:75]
s_add_u32 s57, s57, 2048
s_and_b32 s57, s57, 0x7fff
v_mfma_f32_16x16x32_bf16 v[88:91], v[248:251], v[200:203], v[88:91]
s_waitcnt vmcnt(6) lgkmcnt(8)
v_mfma_f32_16x16x32_bf16 v[60:63], v[100:103], v[204:207], v[60:63]
buffer_load_dwordx4 v[172:175], v38, s[32:35], s57 offen sc1
v_mfma_f32_16x16x32_bf16 v[76:79], v[100:103], v[208:211], v[76:79]
ds_read_b64_tr_b16 v[236:237], v14 offset:0
ds_read_b64_tr_b16 v[238:239], v14 offset:512
v_mfma_f32_16x16x32_bf16 v[64:67], v[104:107], v[204:207], v[64:67]
ds_read_b64_tr_b16 v[240:241], v15 offset:0
ds_read_b64_tr_b16 v[242:243], v15 offset:512
v_mfma_f32_16x16x32_bf16 v[80:83], v[104:107], v[208:211], v[80:83]
buffer_load_dwordx4 v[176:179], v39, s[32:35], s57 offen sc1
v_mfma_f32_16x16x32_bf16 v[68:71], v[108:111], v[204:207], v[68:71]
ds_read_b64_tr_b16 v[244:245], v16 offset:0
ds_read_b64_tr_b16 v[246:247], v16 offset:512
v_mfma_f32_16x16x32_bf16 v[84:87], v[108:111], v[208:211], v[84:87]
ds_read_b64_tr_b16 v[248:249], v17 offset:0
ds_read_b64_tr_b16 v[250:251], v17 offset:512
v_mfma_f32_16x16x32_bf16 v[72:75], v[112:115], v[204:207], v[72:75]
v_mfma_f32_16x16x32_bf16 v[88:91], v[112:115], v[208:211], v[88:91]
s_waitcnt vmcnt(6) lgkmcnt(8)
v_mfma_f32_16x16x32_bf16 v[60:63], v[220:223], v[212:215], v[60:63]
buffer_load_dwordx4 v[180:183], v38, s[32:35], s57 offen offset:1024 sc1
v_mfma_f32_16x16x32_bf16 v[76:79], v[220:223], v[216:219], v[76:79]
ds_read_b64_tr_b16 v[100:101], v14 offset:4096
ds_read_b64_tr_b16 v[102:103], v14 offset:4608
v_mfma_f32_16x16x32_bf16 v[64:67], v[224:227], v[212:215], v[64:67]
ds_read_b64_tr_b16 v[104:105], v15 offset:4096
ds_read_b64_tr_b16 v[106:107], v15 offset:4608
v_mfma_f32_16x16x32_bf16 v[80:83], v[224:227], v[216:219], v[80:83]
buffer_load_dwordx4 v[184:187], v39, s[32:35], s57 offen offset:1024 sc1
v_mfma_f32_16x16x32_bf16 v[68:71], v[228:231], v[212:215], v[68:71]
ds_read_b64_tr_b16 v[108:109], v16 offset:4096
ds_read_b64_tr_b16 v[110:111], v16 offset:4608
v_mfma_f32_16x16x32_bf16 v[84:87], v[228:231], v[216:219], v[84:87]
ds_read_b64_tr_b16 v[112:113], v17 offset:4096
ds_read_b64_tr_b16 v[114:115], v17 offset:4608
v_mfma_f32_16x16x32_bf16 v[72:75], v[232:235], v[212:215], v[72:75]
s_add_u32 s57, s57, 2048
s_and_b32 s57, s57, 0x7fff
v_mfma_f32_16x16x32_bf16 v[88:91], v[232:235], v[216:219], v[88:91]
s_waitcnt vmcnt(6) lgkmcnt(8)
v_mfma_f32_16x16x32_bf16 v[60:63], v[236:239], v[156:159], v[60:63]
buffer_load_dwordx4 v[188:191], v38, s[32:35], s57 offen sc1
v_mfma_f32_16x16x32_bf16 v[76:79], v[236:239], v[160:163], v[76:79]
ds_read_b64_tr_b16 v[220:221], v14 offset:8192
ds_read_b64_tr_b16 v[222:223], v14 offset:8704
v_mfma_f32_16x16x32_bf16 v[64:67], v[240:243], v[156:159], v[64:67]
ds_read_b64_tr_b16 v[224:225], v15 offset:8192
ds_read_b64_tr_b16 v[226:227], v15 offset:8704
v_mfma_f32_16x16x32_bf16 v[80:83], v[240:243], v[160:163], v[80:83]
buffer_load_dwordx4 v[192:195], v39, s[32:35], s57 offen sc1
v_mfma_f32_16x16x32_bf16 v[68:71], v[244:247], v[156:159], v[68:71]
ds_read_b64_tr_b16 v[228:229], v16 offset:8192
ds_read_b64_tr_b16 v[230:231], v16 offset:8704
v_mfma_f32_16x16x32_bf16 v[84:87], v[244:247], v[160:163], v[84:87]
ds_read_b64_tr_b16 v[232:233], v17 offset:8192
ds_read_b64_tr_b16 v[234:235], v17 offset:8704
v_mfma_f32_16x16x32_bf16 v[72:75], v[248:251], v[156:159], v[72:75]
v_mfma_f32_16x16x32_bf16 v[88:91], v[248:251], v[160:163], v[88:91]
s_waitcnt vmcnt(6) lgkmcnt(8)
v_mfma_f32_16x16x32_bf16 v[60:63], v[100:103], v[164:167], v[60:63]
buffer_load_dwordx4 v[196:199], v38, s[32:35], s57 offen offset:1024 sc1
v_mfma_f32_16x16x32_bf16 v[76:79], v[100:103], v[168:171], v[76:79]
ds_read_b64_tr_b16 v[236:237], v14 offset:12288
ds_read_b64_tr_b16 v[238:239], v14 offset:12800
v_mfma_f32_16x16x32_bf16 v[64:67], v[104:107], v[164:167], v[64:67]
ds_read_b64_tr_b16 v[240:241], v15 offset:12288
ds_read_b64_tr_b16 v[242:243], v15 offset:12800
v_mfma_f32_16x16x32_bf16 v[80:83], v[104:107], v[168:171], v[80:83]
buffer_load_dwordx4 v[200:203], v39, s[32:35], s57 offen offset:1024 sc1
v_mfma_f32_16x16x32_bf16 v[68:71], v[108:111], v[164:167], v[68:71]
ds_read_b64_tr_b16 v[244:245], v16 offset:12288
ds_read_b64_tr_b16 v[246:247], v16 offset:12800
v_mfma_f32_16x16x32_bf16 v[84:87], v[108:111], v[168:171], v[84:87]
ds_read_b64_tr_b16 v[248:249], v17 offset:12288
ds_read_b64_tr_b16 v[250:251], v17 offset:12800
v_mfma_f32_16x16x32_bf16 v[72:75], v[112:115], v[164:167], v[72:75]
s_add_u32 s57, s57, 2048
s_and_b32 s57, s57, 0x7fff
v_mfma_f32_16x16x32_bf16 v[88:91], v[112:115], v[168:171], v[88:91]
s_waitcnt vmcnt(6) lgkmcnt(8)
v_mfma_f32_16x16x32_bf16 v[60:63], v[220:223], v[172:175], v[60:63]
buffer_load_dwordx4 v[204:207], v38, s[32:35], s57 offen sc1
v_mfma_f32_16x16x32_bf16 v[76:79], v[220:223], v[176:179], v[76:79]
ds_read_b64_tr_b16 v[100:101], v14 offset:16384
ds_read_b64_tr_b16 v[102:103], v14 offset:16896
v_mfma_f32_16x16x32_bf16 v[64:67], v[224:227], v[172:175], v[64:67]
ds_read_b64_tr_b16 v[104:105], v15 offset:16384
ds_read_b64_tr_b16 v[106:107], v15 offset:16896
v_mfma_f32_16x16x32_bf16 v[80:83], v[224:227], v[176:179], v[80:83]
buffer_load_dwordx4 v[208:211], v39, s[32:35], s57 offen sc1
v_mfma_f32_16x16x32_bf16 v[68:71], v[228:231], v[172:175], v[68:71]
ds_read_b64_tr_b16 v[108:109], v16 offset:16384
ds_read_b64_tr_b16 v[110:111], v16 offset:16896
v_mfma_f32_16x16x32_bf16 v[84:87], v[228:231], v[176:179], v[84:87]
ds_read_b64_tr_b16 v[112:113], v17 offset:16384
ds_read_b64_tr_b16 v[114:115], v17 offset:16896
v_mfma_f32_16x16x32_bf16 v[72:75], v[232:235], v[172:175], v[72:75]
v_mfma_f32_16x16x32_bf16 v[88:91], v[232:235], v[176:179], v[88:91]
s_waitcnt vmcnt(6) lgkmcnt(8)
v_mfma_f32_16x16x32_bf16 v[60:63], v[236:239], v[180:183], v[60:63]
buffer_load_dwordx4 v[212:215], v38, s[32:35], s57 offen offset:1024 sc1
v_mfma_f32_16x16x32_bf16 v[76:79], v[236:239], v[184:187], v[76:79]
ds_read_b64_tr_b16 v[220:221], v14 offset:20480
ds_read_b64_tr_b16 v[222:223], v14 offset:20992
v_mfma_f32_16x16x32_bf16 v[64:67], v[240:243], v[180:183], v[64:67]
ds_read_b64_tr_b16 v[224:225], v15 offset:20480
ds_read_b64_tr_b16 v[226:227], v15 offset:20992
v_mfma_f32_16x16x32_bf16 v[80:83], v[240:243], v[184:187], v[80:83]
buffer_load_dwordx4 v[216:219], v39, s[32:35], s57 offen offset:1024 sc1
v_mfma_f32_16x16x32_bf16 v[68:71], v[244:247], v[180:183], v[68:71]
ds_read_b64_tr_b16 v[228:229], v16 offset:20480
ds_read_b64_tr_b16 v[230:231], v16 offset:20992
v_mfma_f32_16x16x32_bf16 v[84:87], v[244:247], v[184:187], v[84:87]
ds_read_b64_tr_b16 v[232:233], v17 offset:20480
ds_read_b64_tr_b16 v[234:235], v17 offset:20992
v_mfma_f32_16x16x32_bf16 v[72:75], v[248:251], v[180:183], v[72:75]
s_add_u32 s57, s57, 2048
s_and_b32 s57, s57, 0x7fff
v_mfma_f32_16x16x32_bf16 v[88:91], v[248:251], v[184:187], v[88:91]
s_waitcnt vmcnt(6) lgkmcnt(8)
v_mfma_f32_16x16x32_bf16 v[60:63], v[100:103], v[188:191], v[60:63]
buffer_load_dwordx4 v[156:159], v38, s[32:35], s57 offen sc1
v_mfma_f32_16x16x32_bf16 v[76:79], v[100:103], v[192:195], v[76:79]
ds_read_b64_tr_b16 v[236:237], v14 offset:24576
ds_read_b64_tr_b16 v[238:239], v14 offset:25088
v_mfma_f32_16x16x32_bf16 v[64:67], v[104:107], v[188:191], v[64:67]
ds_read_b64_tr_b16 v[240:241], v15 offset:24576
ds_read_b64_tr_b16 v[242:243], v15 offset:25088
v_mfma_f32_16x16x32_bf16 v[80:83], v[104:107], v[192:195], v[80:83]
buffer_load_dwordx4 v[160:163], v39, s[32:35], s57 offen sc1
v_mfma_f32_16x16x32_bf16 v[68:71], v[108:111], v[188:191], v[68:71]
ds_read_b64_tr_b16 v[244:245], v16 offset:24576
ds_read_b64_tr_b16 v[246:247], v16 offset:25088
v_mfma_f32_16x16x32_bf16 v[84:87], v[108:111], v[192:195], v[84:87]
ds_read_b64_tr_b16 v[248:249], v17 offset:24576
ds_read_b64_tr_b16 v[250:251], v17 offset:25088
v_mfma_f32_16x16x32_bf16 v[72:75], v[112:115], v[188:191], v[72:75]
v_mfma_f32_16x16x32_bf16 v[88:91], v[112:115], v[192:195], v[88:91]
s_waitcnt vmcnt(6) lgkmcnt(8)
v_mfma_f32_16x16x32_bf16 v[60:63], v[220:223], v[196:199], v[60:63]
buffer_load_dwordx4 v[164:167], v38, s[32:35], s57 offen offset:1024 sc1
v_mfma_f32_16x16x32_bf16 v[76:79], v[220:223], v[200:203], v[76:79]
ds_read_b64_tr_b16 v[100:101], v14 offset:28672
ds_read_b64_tr_b16 v[102:103], v14 offset:29184
v_mfma_f32_16x16x32_bf16 v[64:67], v[224:227], v[196:199], v[64:67]
ds_read_b64_tr_b16 v[104:105], v15 offset:28672
ds_read_b64_tr_b16 v[106:107], v15 offset:29184
v_mfma_f32_16x16x32_bf16 v[80:83], v[224:227], v[200:203], v[80:83]
buffer_load_dwordx4 v[168:171], v39, s[32:35], s57 offen offset:1024 sc1
v_mfma_f32_16x16x32_bf16 v[68:71], v[228:231], v[196:199], v[68:71]
ds_read_b64_tr_b16 v[108:109], v16 offset:28672
ds_read_b64_tr_b16 v[110:111], v16 offset:29184
v_mfma_f32_16x16x32_bf16 v[84:87], v[228:231], v[200:203], v[84:87]
ds_read_b64_tr_b16 v[112:113], v17 offset:28672
ds_read_b64_tr_b16 v[114:115], v17 offset:29184
v_mfma_f32_16x16x32_bf16 v[72:75], v[232:235], v[196:199], v[72:75]
s_add_u32 s57, s57, 2048
s_and_b32 s57, s57, 0x7fff
v_mfma_f32_16x16x32_bf16 v[88:91], v[232:235], v[200:203], v[88:91]
s_waitcnt vmcnt(6) lgkmcnt(8)
v_mfma_f32_16x16x32_bf16 v[60:63], v[236:239], v[204:207], v[60:63]
buffer_load_dwordx4 v[172:175], v38, s[32:35], s57 offen sc1
v_mfma_f32_16x16x32_bf16 v[76:79], v[236:239], v[208:211], v[76:79]
ds_read_b64_tr_b16 v[220:221], v14 offset:32768
ds_read_b64_tr_b16 v[222:223], v14 offset:33280
v_mfma_f32_16x16x32_bf16 v[64:67], v[240:243], v[204:207], v[64:67]
ds_read_b64_tr_b16 v[224:225], v15 offset:32768
ds_read_b64_tr_b16 v[226:227], v15 offset:33280
v_mfma_f32_16x16x32_bf16 v[80:83], v[240:243], v[208:211], v[80:83]
buffer_load_dwordx4 v[176:179], v39, s[32:35], s57 offen sc1
v_mfma_f32_16x16x32_bf16 v[68:71], v[244:247], v[204:207], v[68:71]
ds_read_b64_tr_b16 v[228:229], v16 offset:32768
ds_read_b64_tr_b16 v[230:231], v16 offset:33280
v_mfma_f32_16x16x32_bf16 v[84:87], v[244:247], v[208:211], v[84:87]
ds_read_b64_tr_b16 v[232:233], v17 offset:32768
ds_read_b64_tr_b16 v[234:235], v17 offset:33280
v_mfma_f32_16x16x32_bf16 v[72:75], v[248:251], v[204:207], v[72:75]
v_mfma_f32_16x16x32_bf16 v[88:91], v[248:251], v[208:211], v[88:91]
s_waitcnt vmcnt(6) lgkmcnt(8)
v_mfma_f32_16x16x32_bf16 v[60:63], v[100:103], v[212:215], v[60:63]
buffer_load_dwordx4 v[180:183], v38, s[32:35], s57 offen offset:1024 sc1
v_mfma_f32_16x16x32_bf16 v[76:79], v[100:103], v[216:219], v[76:79]
ds_read_b64_tr_b16 v[236:237], v14 offset:36864
ds_read_b64_tr_b16 v[238:239], v14 offset:37376
v_mfma_f32_16x16x32_bf16 v[64:67], v[104:107], v[212:215], v[64:67]
ds_read_b64_tr_b16 v[240:241], v15 offset:36864
ds_read_b64_tr_b16 v[242:243], v15 offset:37376
v_mfma_f32_16x16x32_bf16 v[80:83], v[104:107], v[216:219], v[80:83]
buffer_load_dwordx4 v[184:187], v39, s[32:35], s57 offen offset:1024 sc1
v_mfma_f32_16x16x32_bf16 v[68:71], v[108:111], v[212:215], v[68:71]
ds_read_b64_tr_b16 v[244:245], v16 offset:36864
ds_read_b64_tr_b16 v[246:247], v16 offset:37376
v_mfma_f32_16x16x32_bf16 v[84:87], v[108:111], v[216:219], v[84:87]
ds_read_b64_tr_b16 v[248:249], v17 offset:36864
ds_read_b64_tr_b16 v[250:251], v17 offset:37376
v_mfma_f32_16x16x32_bf16 v[72:75], v[112:115], v[212:215], v[72:75]
s_add_u32 s57, s57, 2048
s_and_b32 s57, s57, 0x7fff
v_mfma_f32_16x16x32_bf16 v[88:91], v[112:115], v[216:219], v[88:91]
s_waitcnt vmcnt(6) lgkmcnt(8)
v_mfma_f32_16x16x32_bf16 v[60:63], v[220:223], v[156:159], v[60:63]
buffer_load_dwordx4 v[188:191], v38, s[32:35], s57 offen sc1
v_mfma_f32_16x16x32_bf16 v[76:79], v[220:223], v[160:163], v[76:79]
ds_read_b64_tr_b16 v[100:101], v14 offset:40960
ds_read_b64_tr_b16 v[102:103], v14 offset:41472
v_mfma_f32_16x16x32_bf16 v[64:67], v[224:227], v[156:159], v[64:67]
ds_read_b64_tr_b16 v[104:105], v15 offset:40960
ds_read_b64_tr_b16 v[106:107], v15 offset:41472
v_mfma_f32_16x16x32_bf16 v[80:83], v[224:227], v[160:163], v[80:83]
buffer_load_dwordx4 v[192:195], v39, s[32:35], s57 offen sc1
v_mfma_f32_16x16x32_bf16 v[68:71], v[228:231], v[156:159], v[68:71]
ds_read_b64_tr_b16 v[108:109], v16 offset:40960
ds_read_b64_tr_b16 v[110:111], v16 offset:41472
v_mfma_f32_16x16x32_bf16 v[84:87], v[228:231], v[160:163], v[84:87]
ds_read_b64_tr_b16 v[112:113], v17 offset:40960
ds_read_b64_tr_b16 v[114:115], v17 offset:41472
v_mfma_f32_16x16x32_bf16 v[72:75], v[232:235], v[156:159], v[72:75]
v_mfma_f32_16x16x32_bf16 v[88:91], v[232:235], v[160:163], v[88:91]
s_waitcnt vmcnt(6) lgkmcnt(8)
v_mfma_f32_16x16x32_bf16 v[60:63], v[236:239], v[164:167], v[60:63]
buffer_load_dwordx4 v[196:199], v38, s[32:35], s57 offen offset:1024 sc1
v_mfma_f32_16x16x32_bf16 v[76:79], v[236:239], v[168:171], v[76:79]
ds_read_b64_tr_b16 v[220:221], v14 offset:45056
ds_read_b64_tr_b16 v[222:223], v14 offset:45568
v_mfma_f32_16x16x32_bf16 v[64:67], v[240:243], v[164:167], v[64:67]
ds_read_b64_tr_b16 v[224:225], v15 offset:45056
ds_read_b64_tr_b16 v[226:227], v15 offset:45568
v_mfma_f32_16x16x32_bf16 v[80:83], v[240:243], v[168:171], v[80:83]
buffer_load_dwordx4 v[200:203], v39, s[32:35], s57 offen offset:1024 sc1
v_mfma_f32_16x16x32_bf16 v[68:71], v[244:247], v[164:167], v[68:71]
ds_read_b64_tr_b16 v[228:229], v16 offset:45056
ds_read_b64_tr_b16 v[230:231], v16 offset:45568
v_mfma_f32_16x16x32_bf16 v[84:87], v[244:247], v[168:171], v[84:87]
ds_read_b64_tr_b16 v[232:233], v17 offset:45056
ds_read_b64_tr_b16 v[234:235], v17 offset:45568
v_mfma_f32_16x16x32_bf16 v[72:75], v[248:251], v[164:167], v[72:75]
s_add_u32 s57, s57, 2048
s_and_b32 s57, s57, 0x7fff
v_mfma_f32_16x16x32_bf16 v[88:91], v[248:251], v[168:171], v[88:91]
s_waitcnt vmcnt(6) lgkmcnt(8)
v_mfma_f32_16x16x32_bf16 v[60:63], v[100:103], v[172:175], v[60:63]
buffer_load_dwordx4 v[204:207], v38, s[32:35], s57 offen sc1
v_mfma_f32_16x16x32_bf16 v[76:79], v[100:103], v[176:179], v[76:79]
ds_read_b64_tr_b16 v[236:237], v14 offset:49152
ds_read_b64_tr_b16 v[238:239], v14 offset:49664
v_mfma_f32_16x16x32_bf16 v[64:67], v[104:107], v[172:175], v[64:67]
ds_read_b64_tr_b16 v[240:241], v15 offset:49152
ds_read_b64_tr_b16 v[242:243], v15 offset:49664
v_mfma_f32_16x16x32_bf16 v[80:83], v[104:107], v[176:179], v[80:83]
buffer_load_dwordx4 v[208:211], v39, s[32:35], s57 offen sc1
v_mfma_f32_16x16x32_bf16 v[68:71], v[108:111], v[172:175], v[68:71]
ds_read_b64_tr_b16 v[244:245], v16 offset:49152
ds_read_b64_tr_b16 v[246:247], v16 offset:49664
v_mfma_f32_16x16x32_bf16 v[84:87], v[108:111], v[176:179], v[84:87]
ds_read_b64_tr_b16 v[248:249], v17 offset:49152
ds_read_b64_tr_b16 v[250:251], v17 offset:49664
v_mfma_f32_16x16x32_bf16 v[72:75], v[112:115], v[172:175], v[72:75]
v_mfma_f32_16x16x32_bf16 v[88:91], v[112:115], v[176:179], v[88:91]
s_waitcnt vmcnt(6) lgkmcnt(8)
v_mfma_f32_16x16x32_bf16 v[60:63], v[220:223], v[180:183], v[60:63]
buffer_load_dwordx4 v[212:215], v38, s[32:35], s57 offen offset:1024 sc1
v_mfma_f32_16x16x32_bf16 v[76:79], v[220:223], v[184:187], v[76:79]
ds_read_b64_tr_b16 v[100:101], v14 offset:53248
ds_read_b64_tr_b16 v[102:103], v14 offset:53760
v_mfma_f32_16x16x32_bf16 v[64:67], v[224:227], v[180:183], v[64:67]
ds_read_b64_tr_b16 v[104:105], v15 offset:53248
ds_read_b64_tr_b16 v[106:107], v15 offset:53760
v_mfma_f32_16x16x32_bf16 v[80:83], v[224:227], v[184:187], v[80:83]
buffer_load_dwordx4 v[216:219], v39, s[32:35], s57 offen offset:1024 sc1
v_mfma_f32_16x16x32_bf16 v[68:71], v[228:231], v[180:183], v[68:71]
ds_read_b64_tr_b16 v[108:109], v16 offset:53248
ds_read_b64_tr_b16 v[110:111], v16 offset:53760
v_mfma_f32_16x16x32_bf16 v[84:87], v[228:231], v[184:187], v[84:87]
ds_read_b64_tr_b16 v[112:113], v17 offset:53248
ds_read_b64_tr_b16 v[114:115], v17 offset:53760
v_mfma_f32_16x16x32_bf16 v[72:75], v[232:235], v[180:183], v[72:75]
v_mfma_f32_16x16x32_bf16 v[88:91], v[232:235], v[184:187], v[88:91]
s_waitcnt vmcnt(6) lgkmcnt(8)
v_mfma_f32_16x16x32_bf16 v[60:63], v[236:239], v[188:191], v[60:63]
v_mfma_f32_16x16x32_bf16 v[76:79], v[236:239], v[192:195], v[76:79]
ds_read_b64_tr_b16 v[220:221], v14 offset:57344
ds_read_b64_tr_b16 v[222:223], v14 offset:57856
v_mfma_f32_16x16x32_bf16 v[64:67], v[240:243], v[188:191], v[64:67]
ds_read_b64_tr_b16 v[224:225], v15 offset:57344
ds_read_b64_tr_b16 v[226:227], v15 offset:57856
v_mfma_f32_16x16x32_bf16 v[80:83], v[240:243], v[192:195], v[80:83]
v_mfma_f32_16x16x32_bf16 v[68:71], v[244:247], v[188:191], v[68:71]
ds_read_b64_tr_b16 v[228:229], v16 offset:57344
ds_read_b64_tr_b16 v[230:231], v16 offset:57856
v_mfma_f32_16x16x32_bf16 v[84:87], v[244:247], v[192:195], v[84:87]
ds_read_b64_tr_b16 v[232:233], v17 offset:57344
ds_read_b64_tr_b16 v[234:235], v17 offset:57856
v_mfma_f32_16x16x32_bf16 v[72:75], v[248:251], v[188:191], v[72:75]
v_mfma_f32_16x16x32_bf16 v[88:91], v[248:251], v[192:195], v[88:91]
s_waitcnt vmcnt(4) lgkmcnt(8)
v_mfma_f32_16x16x32_bf16 v[60:63], v[100:103], v[196:199], v[60:63]
v_mfma_f32_16x16x32_bf16 v[76:79], v[100:103], v[200:203], v[76:79]
ds_read_b64_tr_b16 v[236:237], v14 offset:61440
ds_read_b64_tr_b16 v[238:239], v14 offset:61952
v_mfma_f32_16x16x32_bf16 v[64:67], v[104:107], v[196:199], v[64:67]
ds_read_b64_tr_b16 v[240:241], v15 offset:61440
ds_read_b64_tr_b16 v[242:243], v15 offset:61952
v_mfma_f32_16x16x32_bf16 v[80:83], v[104:107], v[200:203], v[80:83]
v_mfma_f32_16x16x32_bf16 v[68:71], v[108:111], v[196:199], v[68:71]
ds_read_b64_tr_b16 v[244:245], v16 offset:61440
ds_read_b64_tr_b16 v[246:247], v16 offset:61952
v_mfma_f32_16x16x32_bf16 v[84:87], v[108:111], v[200:203], v[84:87]
ds_read_b64_tr_b16 v[248:249], v17 offset:61440
ds_read_b64_tr_b16 v[250:251], v17 offset:61952
v_mfma_f32_16x16x32_bf16 v[72:75], v[112:115], v[196:199], v[72:75]
v_mfma_f32_16x16x32_bf16 v[88:91], v[112:115], v[200:203], v[88:91]
s_waitcnt vmcnt(2) lgkmcnt(8)
v_mfma_f32_16x16x32_bf16 v[60:63], v[220:223], v[204:207], v[60:63]
v_mfma_f32_16x16x32_bf16 v[76:79], v[220:223], v[208:211], v[76:79]
v_mfma_f32_16x16x32_bf16 v[64:67], v[224:227], v[204:207], v[64:67]
v_mfma_f32_16x16x32_bf16 v[80:83], v[224:227], v[208:211], v[80:83]
v_mfma_f32_16x16x32_bf16 v[68:71], v[228:231], v[204:207], v[68:71]
v_mfma_f32_16x16x32_bf16 v[84:87], v[228:231], v[208:211], v[84:87]
v_mfma_f32_16x16x32_bf16 v[72:75], v[232:235], v[204:207], v[72:75]
v_mfma_f32_16x16x32_bf16 v[88:91], v[232:235], v[208:211], v[88:91]
s_waitcnt vmcnt(0) lgkmcnt(0)
v_mfma_f32_16x16x32_bf16 v[60:63], v[236:239], v[212:215], v[60:63]
v_mfma_f32_16x16x32_bf16 v[64:67], v[240:243], v[212:215], v[64:67]
v_mfma_f32_16x16x32_bf16 v[68:71], v[244:247], v[212:215], v[68:71]
v_mfma_f32_16x16x32_bf16 v[72:75], v[248:251], v[212:215], v[72:75]
v_mfma_f32_16x16x32_bf16 v[76:79], v[236:239], v[216:219], v[76:79]
v_mfma_f32_16x16x32_bf16 v[80:83], v[240:243], v[216:219], v[80:83]
v_mfma_f32_16x16x32_bf16 v[84:87], v[244:247], v[216:219], v[84:87]
v_mfma_f32_16x16x32_bf16 v[88:91], v[248:251], v[216:219], v[88:91]
s_cmp_eq_u32 s46, 0
s_cbranch_scc1 slow_72
s_nop 0
v_cvt_pk_bf16_f32 v20, v60, v61
v_cvt_pk_bf16_f32 v21, v62, v63
v_cvt_pk_bf16_f32 v22, v64, v65
v_cvt_pk_bf16_f32 v23, v66, v67
buffer_store_dwordx4 v[20:23], v18, s[32:35], s85 offen offset:0
v_cvt_pk_bf16_f32 v24, v68, v69
v_cvt_pk_bf16_f32 v25, v70, v71
v_cvt_pk_bf16_f32 v26, v72, v73
v_cvt_pk_bf16_f32 v27, v74, v75
buffer_store_dwordx4 v[24:27], v18, s[32:35], s85 offen offset:1024
v_cvt_pk_bf16_f32 v28, v76, v77
v_cvt_pk_bf16_f32 v29, v78, v79
v_cvt_pk_bf16_f32 v30, v80, v81
v_cvt_pk_bf16_f32 v31, v82, v83
buffer_store_dwordx4 v[28:31], v18, s[32:35], s86 offen offset:0
v_cvt_pk_bf16_f32 v32, v84, v85
v_cvt_pk_bf16_f32 v33, v86, v87
v_cvt_pk_bf16_f32 v34, v88, v89
v_cvt_pk_bf16_f32 v35, v90, v91
buffer_store_dwordx4 v[32:35], v18, s[32:35], s86 offen offset:1024
s_barrier
v_dot2c_f32_bf16 v6, v20, v48
v_dot2c_f32_bf16 v8, v20, v20
v_dot2c_f32_bf16 v7, v28, v48
v_dot2c_f32_bf16 v9, v28, v28
v_dot2c_f32_bf16 v6, v21, v48
v_dot2c_f32_bf16 v8, v21, v21
v_dot2c_f32_bf16 v7, v29, v48
v_dot2c_f32_bf16 v9, v29, v29
v_dot2c_f32_bf16 v6, v22, v48
v_dot2c_f32_bf16 v8, v22, v22
v_dot2c_f32_bf16 v7, v30, v48
v_dot2c_f32_bf16 v9, v30, v30
v_dot2c_f32_bf16 v6, v23, v48
v_dot2c_f32_bf16 v8, v23, v23
v_dot2c_f32_bf16 v7, v31, v48
v_dot2c_f32_bf16 v9, v31, v31
v_dot2c_f32_bf16 v6, v24, v48
v_dot2c_f32_bf16 v8, v24, v24
v_dot2c_f32_bf16 v7, v32, v48
v_dot2c_f32_bf16 v9, v32, v32
v_dot2c_f32_bf16 v6, v25, v48
v_dot2c_f32_bf16 v8, v25, v25
v_dot2c_f32_bf16 v7, v33, v48
v_dot2c_f32_bf16 v9, v33, v33
v_dot2c_f32_bf16 v6, v26, v48
v_dot2c_f32_bf16 v8, v26, v26
v_dot2c_f32_bf16 v7, v34, v48
v_dot2c_f32_bf16 v9, v34, v34
v_dot2c_f32_bf16 v6, v27, v48
v_dot2c_f32_bf16 v8, v27, v27
v_dot2c_f32_bf16 v7, v35, v48
v_dot2c_f32_bf16 v9, v35, v35
s_mov_b64 exec, 1
s_waitcnt vmcnt(0)
buffer_store_dword v5, v4, s[32:35], s88 offen
s_mov_b64 exec, -1
s_nop 1
v_permlane32_swap_b32 v6, v7
v_permlane32_swap_b32 v8, v9
v_add_f32 v6, v6, v7
v_add_f32 v8, v8, v9
s_nop 1
v_permlane16_swap_b32 v6, v8
s_nop 0
v_add_f32 v6, v6, v8
buffer_store_dword v6, v1, s[32:35], s87 offen
back_73:
s_lshl_b32 s49, s44, 13
v_add_u32 v10, s49, v18
v_add_u32 v11, 1024, v10
s_lshl_b32 s48, s43, 1
v_lshrrev_b32 v4, 2, v2
v_and_b32 v5, 3, v0
v_lshl_add_u32 v6, v3, 3, v4
v_lshlrev_b32 v6, 7, v6
v_lshl_add_u32 v6, v5, 3, v6
v_lshrrev_b32 v7, 1, v4
v_and_b32 v8, 1, v3
v_lshl_add_u32 v7, v8, 1, v7
v_xor_b32 v7, s48, v7
v_lshl_add_u32 v12, v7, 5, v6
v_add_u32 v12, 16384, v12
v_xor_b32 v13, 32, v12
v_mov_b32 v14, v10
v_mov_b32 v15, v11
v_add_u32 v16, 122880, v12
v_add_u32 v17, 122880, v13
v_mov_b32 v156, 0
v_mov_b32 v157, 0
v_mov_b32 v158, 0
v_mov_b32 v159, 0
v_mov_b32 v160, 0
v_mov_b32 v161, 0
v_mov_b32 v162, 0
v_mov_b32 v163, 0
v_mov_b32 v164, 0
v_mov_b32 v165, 0
v_mov_b32 v166, 0
v_mov_b32 v167, 0
v_mov_b32 v168, 0
v_mov_b32 v169, 0
v_mov_b32 v170, 0
v_mov_b32 v171, 0
v_mov_b32 v172, 0
v_mov_b32 v173, 0
v_mov_b32 v174, 0
v_mov_b32 v175, 0
v_mov_b32 v176, 0
v_mov_b32 v177, 0
v_mov_b32 v178, 0
v_mov_b32 v179, 0
v_mov_b32 v180, 0
v_mov_b32 v181, 0
v_mov_b32 v182, 0
v_mov_b32 v183, 0
v_mov_b32 v184, 0
v_mov_b32 v185, 0
v_mov_b32 v186, 0
v_mov_b32 v187, 0
v_mov_b32 v188, 0
v_mov_b32 v189, 0
v_mov_b32 v190, 0
v_mov_b32 v191, 0
v_mov_b32 v192, 0
v_mov_b32 v193, 0
v_mov_b32 v194, 0
v_mov_b32 v195, 0
v_mov_b32 v196, 0
v_mov_b32 v197, 0
v_mov_b32 v198, 0
v_mov_b32 v199, 0
v_mov_b32 v200, 0
v_mov_b32 v201, 0
v_mov_b32 v202, 0
v_mov_b32 v203, 0
v_mov_b32 v204, 0
v_mov_b32 v205, 0
v_mov_b32 v206, 0
v_mov_b32 v207, 0
v_mov_b32 v208, 0
v_mov_b32 v209, 0
v_mov_b32 v210, 0
v_mov_b32 v211, 0
v_mov_b32 v212, 0
v_mov_b32 v213, 0
v_mov_b32 v214, 0
v_mov_b32 v215, 0
v_mov_b32 v216, 0
v_mov_b32 v217, 0
v_mov_b32 v218, 0
v_mov_b32 v219, 0
v_mov_b32 v220, 0
v_mov_b32 v221, 0
v_mov_b32 v222, 0
v_mov_b32 v223, 0
v_mov_b32 v224, 0
v_mov_b32 v225, 0
v_mov_b32 v226, 0
v_mov_b32 v227, 0
v_mov_b32 v228, 0
v_mov_b32 v229, 0
v_mov_b32 v230, 0
v_mov_b32 v231, 0
v_mov_b32 v232, 0
v_mov_b32 v233, 0
v_mov_b32 v234, 0
v_mov_b32 v235, 0
v_mov_b32 v236, 0
v_mov_b32 v237, 0
v_mov_b32 v238, 0
v_mov_b32 v239, 0
v_mov_b32 v240, 0
v_mov_b32 v241, 0
v_mov_b32 v242, 0
v_mov_b32 v243, 0
v_mov_b32 v244, 0
v_mov_b32 v245, 0
v_mov_b32 v246, 0
v_mov_b32 v247, 0
v_mov_b32 v248, 0
v_mov_b32 v249, 0
v_mov_b32 v250, 0
v_mov_b32 v251, 0
s_mov_b32 s48, 0xf149f2ca
v_mov_b32 v9, s48
v_lshlrev_b32 v4, 2, v3
v_sub_u32 v4, v2, v4
v_subrev_u32 v5, 0, v4
v_and_b32 v6, 0x80000001, v5
v_cmp_eq_u32 vcc, 0, v6
v_add_u32 v5, 1, v5
v_and_b32 v6, 0x80000001, v5
v_cndmask_b32 v40, v9, 0, vcc
v_cmp_eq_u32 vcc, 0x80000001, v6
s_nop 1
v_cndmask_b32 v36, v9, 0, vcc
v_subrev_u32 v5, 1, v4
v_and_b32 v6, 0x80000001, v5
v_cmp_eq_u32 vcc, 0, v6
v_add_u32 v5, 1, v5
v_and_b32 v6, 0x80000001, v5
v_cndmask_b32 v41, v9, 0, vcc
v_cmp_eq_u32 vcc, 0x80000001, v6
s_nop 1
v_cndmask_b32 v37, v9, 0, vcc
v_subrev_u32 v5, 2, v4
v_and_b32 v6, 0x80000001, v5
v_cmp_eq_u32 vcc, 0, v6
v_add_u32 v5, 1, v5
v_and_b32 v6, 0x80000001, v5
v_cndmask_b32 v42, v9, 0, vcc
v_cmp_eq_u32 vcc, 0x80000001, v6
s_nop 1
v_cndmask_b32 v38, v9, 0, vcc
v_subrev_u32 v5, 3, v4
v_and_b32 v6, 0x80000001, v5
v_cmp_eq_u32 vcc, 0, v6
v_add_u32 v5, 1, v5
v_and_b32 v6, 0x80000001, v5
v_cndmask_b32 v43, v9, 0, vcc
v_cmp_eq_u32 vcc, 0x80000001, v6
s_nop 1
v_cndmask_b32 v39, v9, 0, vcc
s_or_b32 s48, s41, s44
s_cmp_eq_u32 s48, 0
s_cselect_b64 vcc, -1, 0
v_cndmask_b32 v44, v36, v9, vcc
v_cndmask_b32 v45, v37, v9, vcc
v_cndmask_b32 v46, v38, v9, vcc
v_cndmask_b32 v47, v39, v9, vcc
v_and_b32 v4, 1, v2
v_lshlrev_b32 v4, 4, v4
v_mov_b32 v5, 0xffff
v_lshlrev_b32 v52, v4, v5
s_lshl_b32 s48, s43, 11
s_add_u32 s48, s48, 135168
v_add_u32 v53, s48, v18
v_lshl_add_u32 v55, v0, 3, s48
s_add_u32 s48, s41, s44
s_sub_u32 s48, s48, 1
s_lshl_b32 s49, s48, 1
s_add_u32 s49, s49, s43
s_lshl_b32 s49, s49, 11
s_mul_i32 s50, s42, 393216
s_add_u32 s49, s49, s50
s_add_u32 s49, s49, 9699328
s_cmp_lt_i32 s48, 0
s_cselect_b32 s49, 0xf0000000, s49
v_add_u32 v58, s49, v18
v_lshl_add_u32 v59, v0, 3, s49
s_lshl_b32 s48, s43, 2
s_add_u32 s48, s48, 134672
v_mov_b32 v19, s48
s_lshl_b32 s48, s43, 7
s_add_u32 s48, s48, 133120
v_lshl_add_u32 v7, v3, 4, s48
v_lshl_add_u32 v54, v2, 2, s48
s_lshl_b32 s49, s44, 6
v_add_u32 v8, s49, v2
v_lshlrev_b32 v8, 3, v8
v_add_u32 v8, 131072, v8
v_lshl_add_u32 v9, v3, 2, s49
v_lshlrev_b32 v9, 2, v9
v_add_u32 v9, 132096, v9
s_mov_b32 s64, 0
s_mov_b32 s65, 0
s_mov_b32 s66, 0x3e8293ee
s_barrier
ds_read_b128 v[60:63], v14 offset:0
ds_read_b128 v[64:67], v14 offset:2048
ds_read_b128 v[68:71], v14 offset:4096
ds_read_b128 v[72:75], v14 offset:6144
ds_read_b64_tr_b16 v[84:85], v16 offset:8192
ds_read_b64_tr_b16 v[86:87], v16 offset:8704
ds_read_b64_tr_b16 v[88:89], v17 offset:8192
ds_read_b64_tr_b16 v[90:91], v17 offset:8704
ds_read_b64_tr_b16 v[92:93], v16 offset:16384
ds_read_b64_tr_b16 v[94:95], v16 offset:16896
ds_read_b64_tr_b16 v[96:97], v17 offset:16384
ds_read_b64_tr_b16 v[98:99], v17 offset:16896
ds_read_b64_tr_b16 v[76:77], v16 offset:0
ds_read_b64_tr_b16 v[78:79], v16 offset:512
ds_read_b64_tr_b16 v[80:81], v17 offset:0
ds_read_b64_tr_b16 v[82:83], v17 offset:512
s_waitcnt lgkmcnt(0)
c2_loop:
v_mfma_f32_16x16x32_bf16 v[212:215], v[84:87], v[72:75], v[212:215]
ds_read_b128 v[100:103], v15 offset:0
v_mfma_f32_16x16x32_bf16 v[204:207], v[84:87], v[68:71], v[204:207]
ds_read_b128 v[104:107], v15 offset:2048
v_mfma_f32_16x16x32_bf16 v[196:199], v[84:87], v[64:67], v[196:199]
ds_read_b128 v[108:111], v15 offset:4096
v_mfma_f32_16x16x32_bf16 v[188:191], v[84:87], v[60:63], v[188:191]
ds_read_b128 v[112:115], v15 offset:6144
v_mfma_f32_16x16x32_bf16 v[192:195], v[88:91], v[60:63], v[192:195]
ds_read_b64_tr_b16 v[124:125], v16 offset:12288
v_mfma_f32_16x16x32_bf16 v[200:203], v[88:91], v[64:67], v[200:203]
ds_read_b64_tr_b16 v[126:127], v16 offset:12800
v_mfma_f32_16x16x32_bf16 v[208:211], v[88:91], v[68:71], v[208:211]
ds_read_b64_tr_b16 v[128:129], v17 offset:12288
v_mfma_f32_16x16x32_bf16 v[216:219], v[88:91], v[72:75], v[216:219]
ds_read_b64_tr_b16 v[130:131], v17 offset:12800
v_mfma_f32_16x16x32_bf16 v[244:247], v[72:75], v[92:95], v[244:247]
ds_read_b64_tr_b16 v[132:133], v16 offset:20480
v_mfma_f32_16x16x32_bf16 v[236:239], v[68:71], v[92:95], v[236:239]
ds_read_b64_tr_b16 v[134:135], v16 offset:20992
v_mfma_f32_16x16x32_bf16 v[228:231], v[64:67], v[92:95], v[228:231]
ds_read_b64_tr_b16 v[136:137], v17 offset:20480
v_mfma_f32_16x16x32_bf16 v[220:223], v[60:63], v[92:95], v[220:223]
ds_read_b64_tr_b16 v[138:139], v17 offset:20992
v_mfma_f32_16x16x32_bf16 v[224:227], v[60:63], v[96:99], v[224:227]
ds_read_b64_tr_b16 v[116:117], v16 offset:4096
v_mfma_f32_16x16x32_bf16 v[232:235], v[64:67], v[96:99], v[232:235]
ds_read_b64_tr_b16 v[118:119], v16 offset:4608
v_mfma_f32_16x16x32_bf16 v[240:243], v[68:71], v[96:99], v[240:243]
ds_read_b64_tr_b16 v[120:121], v17 offset:4096
v_mfma_f32_16x16x32_bf16 v[248:251], v[72:75], v[96:99], v[248:251]
ds_read_b64_tr_b16 v[122:123], v17 offset:4608
v_mfma_f32_16x16x32_bf16 v[180:183], v[76:79], v[72:75], v[180:183]
s_add_u32 s65, s65, 40960
s_cmp_eq_u32 s65, 122880
v_mfma_f32_16x16x32_bf16 v[172:175], v[76:79], v[68:71], v[172:175]
s_cselect_b32 s65, 0, s65
s_add_u32 s64, s64, 1
v_mfma_f32_16x16x32_bf16 v[164:167], v[76:79], v[64:67], v[164:167]
v_add_u32 v14, s65, v10
v_add_u32 v15, s65, v11
v_mfma_f32_16x16x32_bf16 v[156:159], v[76:79], v[60:63], v[156:159]
v_add_u32 v16, s65, v12
v_add_u32 v17, s65, v13
v_mfma_f32_16x16x32_bf16 v[160:163], v[80:83], v[60:63], v[160:163]
v_mfma_f32_16x16x32_bf16 v[168:171], v[80:83], v[64:67], v[168:171]
s_cmp_eq_u32 s64, 16
s_cbranch_scc1 c2_last
v_mfma_f32_16x16x32_bf16 v[176:179], v[80:83], v[68:71], v[176:179]
s_waitcnt lgkmcnt(0)
v_mfma_f32_16x16x32_bf16 v[184:187], v[80:83], v[72:75], v[184:187]
s_barrier
v_mfma_f32_16x16x32_bf16 v[212:215], v[124:127], v[112:115], v[212:215]
ds_read_b128 v[60:63], v14 offset:0
v_mfma_f32_16x16x32_bf16 v[204:207], v[124:127], v[108:111], v[204:207]
ds_read_b128 v[64:67], v14 offset:2048
v_mfma_f32_16x16x32_bf16 v[196:199], v[124:127], v[104:107], v[196:199]
ds_read_b128 v[68:71], v14 offset:4096
v_mfma_f32_16x16x32_bf16 v[188:191], v[124:127], v[100:103], v[188:191]
ds_read_b128 v[72:75], v14 offset:6144
v_mfma_f32_16x16x32_bf16 v[192:195], v[128:131], v[100:103], v[192:195]
ds_read_b64_tr_b16 v[84:85], v16 offset:8192
v_mfma_f32_16x16x32_bf16 v[200:203], v[128:131], v[104:107], v[200:203]
ds_read_b64_tr_b16 v[86:87], v16 offset:8704
v_mfma_f32_16x16x32_bf16 v[208:211], v[128:131], v[108:111], v[208:211]
ds_read_b64_tr_b16 v[88:89], v17 offset:8192
v_mfma_f32_16x16x32_bf16 v[216:219], v[128:131], v[112:115], v[216:219]
ds_read_b64_tr_b16 v[90:91], v17 offset:8704
v_mfma_f32_16x16x32_bf16 v[244:247], v[112:115], v[132:135], v[244:247]
ds_read_b64_tr_b16 v[92:93], v16 offset:16384
v_mfma_f32_16x16x32_bf16 v[236:239], v[108:111], v[132:135], v[236:239]
ds_read_b64_tr_b16 v[94:95], v16 offset:16896
v_mfma_f32_16x16x32_bf16 v[228:231], v[104:107], v[132:135], v[228:231]
ds_read_b64_tr_b16 v[96:97], v17 offset:16384
v_mfma_f32_16x16x32_bf16 v[220:223], v[100:103], v[132:135], v[220:223]
ds_read_b64_tr_b16 v[98:99], v17 offset:16896
v_mfma_f32_16x16x32_bf16 v[224:227], v[100:103], v[136:139], v[224:227]
ds_read_b64_tr_b16 v[76:77], v16 offset:0
v_mfma_f32_16x16x32_bf16 v[232:235], v[104:107], v[136:139], v[232:235]
ds_read_b64_tr_b16 v[78:79], v16 offset:512
v_mfma_f32_16x16x32_bf16 v[240:243], v[108:111], v[136:139], v[240:243]
ds_read_b64_tr_b16 v[80:81], v17 offset:0
v_mfma_f32_16x16x32_bf16 v[248:251], v[112:115], v[136:139], v[248:251]
ds_read_b64_tr_b16 v[82:83], v17 offset:512
v_mfma_f32_16x16x32_bf16 v[180:183], v[116:119], v[112:115], v[180:183]
v_mfma_f32_16x16x32_bf16 v[172:175], v[116:119], v[108:111], v[172:175]
v_mfma_f32_16x16x32_bf16 v[164:167], v[116:119], v[104:107], v[164:167]
v_mfma_f32_16x16x32_bf16 v[156:159], v[116:119], v[100:103], v[156:159]
v_mfma_f32_16x16x32_bf16 v[160:163], v[120:123], v[100:103], v[160:163]
v_mfma_f32_16x16x32_bf16 v[168:171], v[120:123], v[104:107], v[168:171]
v_mfma_f32_16x16x32_bf16 v[176:179], v[120:123], v[108:111], v[176:179]
s_waitcnt lgkmcnt(0)
v_mfma_f32_16x16x32_bf16 v[184:187], v[120:123], v[112:115], v[184:187]
s_branch c2_loop
c2_last:
v_mfma_f32_16x16x32_bf16 v[176:179], v[80:83], v[68:71], v[176:179]
s_waitcnt lgkmcnt(0)
v_mfma_f32_16x16x32_bf16 v[184:187], v[80:83], v[72:75], v[184:187]
s_barrier
v_mfma_f32_16x16x32_bf16 v[212:215], v[124:127], v[112:115], v[212:215]
ds_read_b128 v[140:143], v7 offset:0
v_mfma_f32_16x16x32_bf16 v[204:207], v[124:127], v[108:111], v[204:207]
ds_read_b128 v[144:147], v7 offset:64
v_mfma_f32_16x16x32_bf16 v[196:199], v[124:127], v[104:107], v[196:199]
ds_read_b128 v[148:151], v7 offset:256
v_mfma_f32_16x16x32_bf16 v[188:191], v[124:127], v[100:103], v[188:191]
ds_read_b128 v[152:155], v7 offset:320
v_mfma_f32_16x16x32_bf16 v[192:195], v[128:131], v[100:103], v[192:195]
ds_read_b64 v[92:93], v8 offset:0
v_mfma_f32_16x16x32_bf16 v[200:203], v[128:131], v[104:107], v[200:203]
ds_read_b64 v[94:95], v8 offset:128
v_mfma_f32_16x16x32_bf16 v[208:211], v[128:131], v[108:111], v[208:211]
ds_read_b64 v[96:97], v8 offset:256
v_mfma_f32_16x16x32_bf16 v[216:219], v[128:131], v[112:115], v[216:219]
ds_read_b64 v[98:99], v8 offset:384
v_mfma_f32_16x16x32_bf16 v[244:247], v[112:115], v[132:135], v[244:247]
ds_read2_b32 v[56:57], v54 offset0:128 offset1:144
v_mfma_f32_16x16x32_bf16 v[236:239], v[108:111], v[132:135], v[236:239]
ds_read_b128 v[60:63], v9 offset:0
v_mfma_f32_16x16x32_bf16 v[228:231], v[104:107], v[132:135], v[228:231]
ds_read_b128 v[64:67], v9 offset:64
v_mfma_f32_16x16x32_bf16 v[220:223], v[100:103], v[132:135], v[220:223]
ds_read_b128 v[68:71], v9 offset:128
v_mfma_f32_16x16x32_bf16 v[224:227], v[100:103], v[136:139], v[224:227]
ds_read_b128 v[72:75], v9 offset:192
v_mfma_f32_16x16x32_bf16 v[232:235], v[104:107], v[136:139], v[232:235]
ds_read_b128 v[76:79], v9 offset:512
v_mfma_f32_16x16x32_bf16 v[240:243], v[108:111], v[136:139], v[240:243]
ds_read_b128 v[80:83], v9 offset:576
v_mfma_f32_16x16x32_bf16 v[248:251], v[112:115], v[136:139], v[248:251]
ds_read_b128 v[84:87], v9 offset:640
v_mfma_f32_16x16x32_bf16 v[180:183], v[116:119], v[112:115], v[180:183]
ds_read_b128 v[88:91], v9 offset:704
v_mfma_f32_16x16x32_bf16 v[172:175], v[116:119], v[108:111], v[172:175]
v_mfma_f32_16x16x32_bf16 v[164:167], v[116:119], v[104:107], v[164:167]
v_mfma_f32_16x16x32_bf16 v[156:159], v[116:119], v[100:103], v[156:159]
v_mfma_f32_16x16x32_bf16 v[160:163], v[120:123], v[100:103], v[160:163]
v_mfma_f32_16x16x32_bf16 v[168:171], v[120:123], v[104:107], v[168:171]
v_mfma_f32_16x16x32_bf16 v[176:179], v[120:123], v[108:111], v[176:179]
v_mfma_f32_16x16x32_bf16 v[184:187], v[120:123], v[112:115], v[184:187]
c2_epi:
s_waitcnt lgkmcnt(0)
.p2align 3
v_pk_fma_f32 v[212:213], v[148:149], v[98:99], v[212:213] op_sel:[0,1,0] op_sel_hi:[1,1,1]
v_pk_fma_f32 v[214:215], v[150:151], v[98:99], v[214:215] op_sel:[0,1,0] op_sel_hi:[1,1,1]
v_pk_fma_f32 v[216:217], v[152:153], v[98:99], v[216:217] op_sel:[0,1,0] op_sel_hi:[1,1,1]
v_pk_fma_f32 v[218:219], v[154:155], v[98:99], v[218:219] op_sel:[0,1,0] op_sel_hi:[1,1,1]
v_pk_mul_f32 v[212:213], v[212:213], v[98:99] op_sel:[0,0] op_sel_hi:[1,0]
v_pk_mul_f32 v[214:215], v[214:215], v[98:99] op_sel:[0,0] op_sel_hi:[1,0]
v_pk_mul_f32 v[216:217], v[216:217], v[98:99] op_sel:[0,0] op_sel_hi:[1,0]
v_pk_mul_f32 v[218:219], v[218:219], v[98:99] op_sel:[0,0] op_sel_hi:[1,0]
v_cvt_pk_bf16_f32 v212, v212, v213
v_cvt_pk_bf16_f32 v213, v214, v215
v_cvt_pk_bf16_f32 v214, v216, v217
v_cvt_pk_bf16_f32 v215, v218, v219
v_pk_fma_f32 v[244:245], v[88:89], v[56:57], v[244:245] op_sel:[0,0,0] op_sel_hi:[1,0,1]
v_pk_fma_f32 v[246:247], v[90:91], v[56:57], v[246:247] op_sel:[0,0,0] op_sel_hi:[1,0,1]
v_pk_mul_f32 v[244:245], v[244:245], v[72:73]
v_pk_mul_f32 v[246:247], v[246:247], v[74:75]
v_cvt_pk_bf16_f32 v108, v244, v245
v_cvt_pk_bf16_f32 v109, v246, v247
v_pk_fma_f32 v[248:249], v[88:89], v[56:57], v[248:249] op_sel:[0,1,0] op_sel_hi:[1,1,1]
v_pk_fma_f32 v[250:251], v[90:91], v[56:57], v[250:251] op_sel:[0,1,0] op_sel_hi:[1,1,1]
v_pk_mul_f32 v[248:249], v[248:249], v[72:73]
v_pk_mul_f32 v[250:251], v[250:251], v[74:75]
v_cvt_pk_bf16_f32 v118, v248, v249
v_cvt_pk_bf16_f32 v119, v250, v251
s_cmp_lg_u32 s44, 1
s_cbranch_scc1 else_74
buffer_store_dwordx4 v[212:215], v58, s[32:35], 0 offen sc1
buffer_store_dwordx2 v[108:109], v59, s[32:35], 0 offen offset:1024 sc1
buffer_store_dwordx2 v[118:119], v59, s[32:35], 0 offen offset:1536 sc1
s_branch fi_75
else_74:
ds_write_b128 v53, v[212:215]
ds_write_b64 v55, v[108:109] offset:1024
ds_write_b64 v55, v[118:119] offset:1536
v_mov_b32 v4, 3
ds_write_b32 v19, v4
fi_75:
v_mul_f32 v124, s66, v92
v_mul_f32 v125, s66, v94
v_mul_f32 v126, s66, v96
v_mul_f32 v127, s66, v98
.p2align 3
v_pk_fma_f32 v[156:157], v[140:141], v[92:93], v[156:157] op_sel:[0,1,0] op_sel_hi:[1,1,1]
v_pk_fma_f32 v[158:159], v[142:143], v[92:93], v[158:159] op_sel:[0,1,0] op_sel_hi:[1,1,1]
v_pk_fma_f32 v[160:161], v[144:145], v[92:93], v[160:161] op_sel:[0,1,0] op_sel_hi:[1,1,1]
v_pk_fma_f32 v[162:163], v[146:147], v[92:93], v[162:163] op_sel:[0,1,0] op_sel_hi:[1,1,1]
v_cvt_pk_bf16_f32 v156, v156, v157
v_cvt_pk_bf16_f32 v157, v158, v159
v_cvt_pk_bf16_f32 v158, v160, v161
v_cvt_pk_bf16_f32 v159, v162, v163
v_pk_fma_f32 v[164:165], v[140:141], v[94:95], v[164:165] op_sel:[0,1,0] op_sel_hi:[1,1,1]
v_pk_fma_f32 v[166:167], v[142:143], v[94:95], v[166:167] op_sel:[0,1,0] op_sel_hi:[1,1,1]
v_pk_fma_f32 v[168:169], v[144:145], v[94:95], v[168:169] op_sel:[0,1,0] op_sel_hi:[1,1,1]
v_pk_fma_f32 v[170:171], v[146:147], v[94:95], v[170:171] op_sel:[0,1,0] op_sel_hi:[1,1,1]
v_cvt_pk_bf16_f32 v164, v164, v165
v_cvt_pk_bf16_f32 v165, v166, v167
v_cvt_pk_bf16_f32 v166, v168, v169
v_cvt_pk_bf16_f32 v167, v170, v171
v_pk_fma_f32 v[172:173], v[140:141], v[96:97], v[172:173] op_sel:[0,1,0] op_sel_hi:[1,1,1]
v_pk_fma_f32 v[174:175], v[142:143], v[96:97], v[174:175] op_sel:[0,1,0] op_sel_hi:[1,1,1]
v_pk_fma_f32 v[176:177], v[144:145], v[96:97], v[176:177] op_sel:[0,1,0] op_sel_hi:[1,1,1]
v_pk_fma_f32 v[178:179], v[146:147], v[96:97], v[178:179] op_sel:[0,1,0] op_sel_hi:[1,1,1]
v_cvt_pk_bf16_f32 v172, v172, v173
v_cvt_pk_bf16_f32 v173, v174, v175
v_cvt_pk_bf16_f32 v174, v176, v177
v_cvt_pk_bf16_f32 v175, v178, v179
v_pk_fma_f32 v[180:181], v[140:141], v[98:99], v[180:181] op_sel:[0,1,0] op_sel_hi:[1,1,1]
v_pk_fma_f32 v[182:183], v[142:143], v[98:99], v[182:183] op_sel:[0,1,0] op_sel_hi:[1,1,1]
v_pk_fma_f32 v[184:185], v[144:145], v[98:99], v[184:185] op_sel:[0,1,0] op_sel_hi:[1,1,1]
v_pk_fma_f32 v[186:187], v[146:147], v[98:99], v[186:187] op_sel:[0,1,0] op_sel_hi:[1,1,1]
v_cvt_pk_bf16_f32 v180, v180, v181
v_cvt_pk_bf16_f32 v181, v182, v183
v_cvt_pk_bf16_f32 v182, v184, v185
v_cvt_pk_bf16_f32 v183, v186, v187
v_pk_fma_f32 v[188:189], v[148:149], v[92:93], v[188:189] op_sel:[0,1,0] op_sel_hi:[1,1,1]
v_pk_fma_f32 v[190:191], v[150:151], v[92:93], v[190:191] op_sel:[0,1,0] op_sel_hi:[1,1,1]
v_pk_fma_f32 v[192:193], v[152:153], v[92:93], v[192:193] op_sel:[0,1,0] op_sel_hi:[1,1,1]
v_pk_fma_f32 v[194:195], v[154:155], v[92:93], v[194:195] op_sel:[0,1,0] op_sel_hi:[1,1,1]
v_pk_mul_f32 v[188:189], v[188:189], v[92:93] op_sel:[0,0] op_sel_hi:[1,0]
v_pk_mul_f32 v[190:191], v[190:191], v[92:93] op_sel:[0,0] op_sel_hi:[1,0]
v_pk_mul_f32 v[192:193], v[192:193], v[92:93] op_sel:[0,0] op_sel_hi:[1,0]
v_pk_mul_f32 v[194:195], v[194:195], v[92:93] op_sel:[0,0] op_sel_hi:[1,0]
v_cvt_pk_bf16_f32 v188, v188, v189
v_cvt_pk_bf16_f32 v189, v190, v191
v_cvt_pk_bf16_f32 v190, v192, v193
v_cvt_pk_bf16_f32 v191, v194, v195
v_pk_fma_f32 v[196:197], v[148:149], v[94:95], v[196:197] op_sel:[0,1,0] op_sel_hi:[1,1,1]
v_pk_fma_f32 v[198:199], v[150:151], v[94:95], v[198:199] op_sel:[0,1,0] op_sel_hi:[1,1,1]
v_pk_fma_f32 v[200:201], v[152:153], v[94:95], v[200:201] op_sel:[0,1,0] op_sel_hi:[1,1,1]
v_pk_fma_f32 v[202:203], v[154:155], v[94:95], v[202:203] op_sel:[0,1,0] op_sel_hi:[1,1,1]
v_pk_mul_f32 v[196:197], v[196:197], v[94:95] op_sel:[0,0] op_sel_hi:[1,0]
v_pk_mul_f32 v[198:199], v[198:199], v[94:95] op_sel:[0,0] op_sel_hi:[1,0]
v_pk_mul_f32 v[200:201], v[200:201], v[94:95] op_sel:[0,0] op_sel_hi:[1,0]
v_pk_mul_f32 v[202:203], v[202:203], v[94:95] op_sel:[0,0] op_sel_hi:[1,0]
v_cvt_pk_bf16_f32 v196, v196, v197
v_cvt_pk_bf16_f32 v197, v198, v199
v_cvt_pk_bf16_f32 v198, v200, v201
v_cvt_pk_bf16_f32 v199, v202, v203
v_pk_fma_f32 v[204:205], v[148:149], v[96:97], v[204:205] op_sel:[0,1,0] op_sel_hi:[1,1,1]
v_pk_fma_f32 v[206:207], v[150:151], v[96:97], v[206:207] op_sel:[0,1,0] op_sel_hi:[1,1,1]
v_pk_fma_f32 v[208:209], v[152:153], v[96:97], v[208:209] op_sel:[0,1,0] op_sel_hi:[1,1,1]
v_pk_fma_f32 v[210:211], v[154:155], v[96:97], v[210:211] op_sel:[0,1,0] op_sel_hi:[1,1,1]
v_pk_mul_f32 v[204:205], v[204:205], v[96:97] op_sel:[0,0] op_sel_hi:[1,0]
v_pk_mul_f32 v[206:207], v[206:207], v[96:97] op_sel:[0,0] op_sel_hi:[1,0]
v_pk_mul_f32 v[208:209], v[208:209], v[96:97] op_sel:[0,0] op_sel_hi:[1,0]
v_pk_mul_f32 v[210:211], v[210:211], v[96:97] op_sel:[0,0] op_sel_hi:[1,0]
v_cvt_pk_bf16_f32 v204, v204, v205
v_cvt_pk_bf16_f32 v205, v206, v207
v_cvt_pk_bf16_f32 v206, v208, v209
v_cvt_pk_bf16_f32 v207, v210, v211
s_cmp_lg_u32 s44, 0
s_cbranch_scc1 else_76
buffer_load_dwordx4 v[120:123], v58, s[32:35], 0 offen sc1
buffer_load_dwordx2 v[100:101], v59, s[32:35], 0 offen offset:1024 sc1
buffer_load_dwordx2 v[110:111], v59, s[32:35], 0 offen offset:1536 sc1
else_76:
.p2align 3
v_mfma_f32_16x16x32_bf16 v[216:219], v[212:215], v[180:183], v[40:43]
v_pk_fma_f32 v[220:221], v[76:77], v[56:57], v[220:221] op_sel:[0,0,0] op_sel_hi:[1,0,1]
v_pk_fma_f32 v[222:223], v[78:79], v[56:57], v[222:223] op_sel:[0,0,0] op_sel_hi:[1,0,1]
v_pk_mul_f32 v[220:221], v[220:221], v[60:61]
v_pk_mul_f32 v[222:223], v[222:223], v[62:63]
v_cvt_pk_bf16_f32 v102, v220, v221
v_mfma_f32_16x16x32_bf16 v[192:195], v[188:191], v[156:159], v[40:43]
v_cvt_pk_bf16_f32 v103, v222, v223
v_pk_fma_f32 v[224:225], v[76:77], v[56:57], v[224:225] op_sel:[0,1,0] op_sel_hi:[1,1,1]
v_pk_fma_f32 v[226:227], v[78:79], v[56:57], v[226:227] op_sel:[0,1,0] op_sel_hi:[1,1,1]
v_pk_mul_f32 v[224:225], v[224:225], v[60:61]
v_pk_mul_f32 v[226:227], v[226:227], v[62:63]
v_cvt_pk_bf16_f32 v112, v224, v225
v_mfma_f32_16x16x32_bf16 v[168:171], v[188:191], v[164:167], v[36:39]
v_cvt_pk_bf16_f32 v113, v226, v227
v_pk_fma_f32 v[228:229], v[80:81], v[56:57], v[228:229] op_sel:[0,0,0] op_sel_hi:[1,0,1]
v_pk_fma_f32 v[230:231], v[82:83], v[56:57], v[230:231] op_sel:[0,0,0] op_sel_hi:[1,0,1]
v_pk_mul_f32 v[228:229], v[228:229], v[64:65]
v_pk_mul_f32 v[230:231], v[230:231], v[66:67]
v_cvt_pk_bf16_f32 v104, v228, v229
v_mfma_f32_16x16x32_bf16 v[200:203], v[196:199], v[164:167], v[40:43]
v_cvt_pk_bf16_f32 v105, v230, v231
v_pk_fma_f32 v[232:233], v[80:81], v[56:57], v[232:233] op_sel:[0,1,0] op_sel_hi:[1,1,1]
v_pk_fma_f32 v[234:235], v[82:83], v[56:57], v[234:235] op_sel:[0,1,0] op_sel_hi:[1,1,1]
v_pk_mul_f32 v[232:233], v[232:233], v[64:65]
v_pk_mul_f32 v[234:235], v[234:235], v[66:67]
v_cvt_pk_bf16_f32 v114, v232, v233
v_mfma_f32_16x16x32_bf16 v[176:179], v[196:199], v[172:175], v[36:39]
v_cvt_pk_bf16_f32 v115, v234, v235
v_pk_fma_f32 v[236:237], v[84:85], v[56:57], v[236:237] op_sel:[0,0,0] op_sel_hi:[1,0,1]
v_pk_fma_f32 v[238:239], v[86:87], v[56:57], v[238:239] op_sel:[0,0,0] op_sel_hi:[1,0,1]
v_pk_mul_f32 v[236:237], v[236:237], v[68:69]
v_pk_mul_f32 v[238:239], v[238:239], v[70:71]
v_cvt_pk_bf16_f32 v106, v236, v237
v_mfma_f32_16x16x32_bf16 v[208:211], v[204:207], v[172:175], v[40:43]
v_cvt_pk_bf16_f32 v107, v238, v239
v_pk_fma_f32 v[240:241], v[84:85], v[56:57], v[240:241] op_sel:[0,1,0] op_sel_hi:[1,1,1]
v_pk_fma_f32 v[242:243], v[86:87], v[56:57], v[242:243] op_sel:[0,1,0] op_sel_hi:[1,1,1]
v_pk_mul_f32 v[240:241], v[240:241], v[68:69]
v_pk_mul_f32 v[242:243], v[242:243], v[70:71]
v_cvt_pk_bf16_f32 v116, v240, v241
v_mfma_f32_16x16x32_bf16 v[184:187], v[204:207], v[180:183], v[36:39]
v_cvt_pk_bf16_f32 v117, v242, v243
v_max_f32 v166, v200, v201
v_max_f32 v167, v202, v203
v_max_f32 v164, v168, v169
v_max_f32 v165, v170, v171
v_max3_f32 v129, v164, v165, v166
v_max_f32 v129, v129, v167
s_cmp_lg_u32 s44, 0
s_cbranch_scc1 else_78
s_mov_b32 s63, 0
sent_80:
s_waitcnt vmcnt(0)
v_max_u32 v4, v120, v121
v_max3_u32 v4, v4, v122, v123
v_max3_u32 v4, v4, v100, v101
v_max3_u32 v4, v4, v110, v111
v_cmp_eq_u32 vcc, -1, v4
s_cbranch_vccz sentd_81
buffer_load_dwordx4 v[120:123], v58, s[32:35], 0 offen sc1
buffer_load_dwordx2 v[100:101], v59, s[32:35], 0 offen offset:1024 sc1
buffer_load_dwordx2 v[110:111], v59, s[32:35], 0 offen offset:1536 sc1
s_add_u32 s63, s63, 1
s_cmp_lt_u32 s63, 0x80000
s_cbranch_scc1 sent_80
s_waitcnt vmcnt(0)
sentd_81:
s_branch fi_79
else_78:
s_mov_b32 s63, 0
px_82:
ds_read_b32 v4, v19
ds_read_b128 v[120:123], v53
ds_read_b64 v[100:101], v55 offset:1024
ds_read_b64 v[110:111], v55 offset:1536
s_add_u32 s63, s63, 1
s_cmp_lt_u32 s63, 0x400000
s_waitcnt lgkmcnt(0)
v_cmp_ne_u32 vcc, 3, v4
s_cbranch_vccz pxd_83
s_cbranch_scc1 px_82
pxd_83:
fi_79:
v_mfma_f32_16x16x32_bf16 v[160:163], v[120:123], v[156:159], v[44:47]
v_max_f32 v174, v208, v209
v_max_f32 v175, v210, v211
v_max_f32 v172, v176, v177
v_max_f32 v173, v178, v179
v_max3_f32 v130, v172, v173, v174
v_max_f32 v130, v130, v175
v_max_f32 v182, v216, v217
v_max_f32 v183, v218, v219
v_max_f32 v180, v184, v185
v_max_f32 v181, v186, v187
v_max3_f32 v131, v180, v181, v182
v_max_f32 v131, v131, v183
v_max_f32 v158, v192, v193
v_max_f32 v159, v194, v195
v_max_f32 v156, v160, v161
v_max_f32 v157, v162, v163
v_max3_f32 v128, v156, v157, v158
v_max_f32 v128, v128, v159
s_nop 1
v_permlane32_swap_b32 v128, v129
v_permlane32_swap_b32 v130, v131
v_max_f32 v128, v128, v129
v_max_f32 v130, v130, v131
s_nop 1
v_permlane16_swap_b32 v128, v130
s_nop 0
v_max_f32 v128, v128, v130
v_mov_b32 v130, v128
s_nop 1
v_permlane16_swap_b32 v128, v130
s_nop 0
v_mov_b32 v129, v128
v_mov_b32 v131, v130
s_nop 0
v_permlane32_swap_b32 v128, v129
v_permlane32_swap_b32 v130, v131
v_pk_mul_f32 v[128:129], v[128:129], v[124:125]
v_pk_mul_f32 v[130:131], v[130:131], v[126:127]
v_pk_fma_f32 v[156:157], v[156:157], v[124:125], v[128:129] op_sel:[0,0,0] op_sel_hi:[1,0,0] neg_lo:[0,0,1] neg_hi:[0,0,1]
v_pk_fma_f32 v[158:159], v[158:159], v[124:125], v[128:129] op_sel:[0,0,0] op_sel_hi:[1,0,0] neg_lo:[0,0,1] neg_hi:[0,0,1]
v_exp_f32 v156, v156
v_exp_f32 v157, v157
v_exp_f32 v158, v158
v_exp_f32 v159, v159
v_cvt_pk_bf16_f32 v156, v156, v156
v_cvt_pk_bf16_f32 v157, v157, v157
v_cvt_pk_bf16_f32 v158, v158, v158
v_cvt_pk_bf16_f32 v159, v159, v159
v_and_b32 v156, v52, v156
v_and_b32 v157, v52, v157
v_and_b32 v158, v52, v158
v_and_b32 v159, v52, v159
v_pk_fma_f32 v[164:165], v[164:165], v[124:125], v[128:129] op_sel:[0,1,1] op_sel_hi:[1,1,1] neg_lo:[0,0,1] neg_hi:[0,0,1]
v_pk_fma_f32 v[166:167], v[166:167], v[124:125], v[128:129] op_sel:[0,1,1] op_sel_hi:[1,1,1] neg_lo:[0,0,1] neg_hi:[0,0,1]
v_exp_f32 v164, v164
v_mfma_f32_16x16x32_bf16 v[160:163], v[48:51], v[156:159], 0
v_exp_f32 v165, v165
v_exp_f32 v166, v166
v_exp_f32 v167, v167
v_cvt_pk_bf16_f32 v164, v164, v164
v_mfma_f32_16x16x32_bf16 v[220:223], v[100:103], v[156:159], 0
v_cvt_pk_bf16_f32 v165, v165, v165
v_cvt_pk_bf16_f32 v166, v166, v166
v_cvt_pk_bf16_f32 v167, v167, v167
v_and_b32 v164, v52, v164
v_mfma_f32_16x16x32_bf16 v[224:227], v[110:113], v[156:159], 0
v_and_b32 v165, v52, v165
v_and_b32 v166, v52, v166
v_and_b32 v167, v52, v167
v_pk_fma_f32 v[172:173], v[172:173], v[126:127], v[130:131] op_sel:[0,0,0] op_sel_hi:[1,0,0] neg_lo:[0,0,1] neg_hi:[0,0,1]
v_pk_fma_f32 v[174:175], v[174:175], v[126:127], v[130:131] op_sel:[0,0,0] op_sel_hi:[1,0,0] neg_lo:[0,0,1] neg_hi:[0,0,1]
v_exp_f32 v172, v172
v_mfma_f32_16x16x32_bf16 v[168:171], v[48:51], v[164:167], 0
v_exp_f32 v173, v173
v_exp_f32 v174, v174
v_exp_f32 v175, v175
v_cvt_pk_bf16_f32 v172, v172, v172
v_mfma_f32_16x16x32_bf16 v[228:231], v[102:105], v[164:167], 0
v_cvt_pk_bf16_f32 v173, v173, v173
v_cvt_pk_bf16_f32 v174, v174, v174
v_cvt_pk_bf16_f32 v175, v175, v175
v_and_b32 v172, v52, v172
v_mfma_f32_16x16x32_bf16 v[232:235], v[112:115], v[164:167], 0
v_and_b32 v173, v52, v173
v_and_b32 v174, v52, v174
v_and_b32 v175, v52, v175
v_pk_fma_f32 v[180:181], v[180:181], v[126:127], v[130:131] op_sel:[0,1,1] op_sel_hi:[1,1,1] neg_lo:[0,0,1] neg_hi:[0,0,1]
v_pk_fma_f32 v[182:183], v[182:183], v[126:127], v[130:131] op_sel:[0,1,1] op_sel_hi:[1,1,1] neg_lo:[0,0,1] neg_hi:[0,0,1]
v_exp_f32 v180, v180
v_mfma_f32_16x16x32_bf16 v[176:179], v[48:51], v[172:175], 0
v_exp_f32 v181, v181
v_exp_f32 v182, v182
v_exp_f32 v183, v183
v_cvt_pk_bf16_f32 v180, v180, v180
v_mfma_f32_16x16x32_bf16 v[236:239], v[104:107], v[172:175], 0
v_cvt_pk_bf16_f32 v181, v181, v181
v_cvt_pk_bf16_f32 v182, v182, v182
v_cvt_pk_bf16_f32 v183, v183, v183
v_and_b32 v180, v52, v180
v_mfma_f32_16x16x32_bf16 v[240:243], v[114:117], v[172:175], 0
v_and_b32 v181, v52, v181
v_and_b32 v182, v52, v182
v_and_b32 v183, v52, v183
v_rcp_f32 v160, v160
v_rcp_f32 v168, v168
v_mfma_f32_16x16x32_bf16 v[184:187], v[48:51], v[180:183], 0
v_mfma_f32_16x16x32_bf16 v[244:247], v[106:109], v[180:183], 0
v_mfma_f32_16x16x32_bf16 v[248:251], v[116:119], v[180:183], 0
v_rcp_f32 v176, v176
s_nop 4
v_rcp_f32 v184, v184
s_cmp_eq_u32 s46, 0
s_cbranch_scc1 slow_84
.p2align 3
v_pk_mul_f32 v[220:221], v[220:221], v[160:161] op_sel:[0,0] op_sel_hi:[1,0]
v_pk_mul_f32 v[222:223], v[222:223], v[160:161] op_sel:[0,0] op_sel_hi:[1,0]
v_pk_mul_f32 v[224:225], v[224:225], v[160:161] op_sel:[0,0] op_sel_hi:[1,0]
v_pk_mul_f32 v[226:227], v[226:227], v[160:161] op_sel:[0,0] op_sel_hi:[1,0]
v_cvt_pk_bf16_f32 v220, v220, v221
v_cvt_pk_bf16_f32 v221, v222, v223
v_cvt_pk_bf16_f32 v222, v224, v225
v_cvt_pk_bf16_f32 v223, v226, v227
buffer_store_dwordx4 v[220:223], v18, s[32:35], s80 offen
v_pk_mul_f32 v[228:229], v[228:229], v[168:169] op_sel:[0,0] op_sel_hi:[1,0]
v_pk_mul_f32 v[230:231], v[230:231], v[168:169] op_sel:[0,0] op_sel_hi:[1,0]
v_pk_mul_f32 v[232:233], v[232:233], v[168:169] op_sel:[0,0] op_sel_hi:[1,0]
v_pk_mul_f32 v[234:235], v[234:235], v[168:169] op_sel:[0,0] op_sel_hi:[1,0]
v_cvt_pk_bf16_f32 v228, v228, v229
v_cvt_pk_bf16_f32 v229, v230, v231
v_cvt_pk_bf16_f32 v230, v232, v233
v_cvt_pk_bf16_f32 v231, v234, v235
buffer_store_dwordx4 v[228:231], v18, s[32:35], s81 offen
v_pk_mul_f32 v[236:237], v[236:237], v[176:177] op_sel:[0,0] op_sel_hi:[1,0]
v_pk_mul_f32 v[238:239], v[238:239], v[176:177] op_sel:[0,0] op_sel_hi:[1,0]
v_pk_mul_f32 v[240:241], v[240:241], v[176:177] op_sel:[0,0] op_sel_hi:[1,0]
v_pk_mul_f32 v[242:243], v[242:243], v[176:177] op_sel:[0,0] op_sel_hi:[1,0]
v_cvt_pk_bf16_f32 v236, v236, v237
v_cvt_pk_bf16_f32 v237, v238, v239
v_cvt_pk_bf16_f32 v238, v240, v241
v_cvt_pk_bf16_f32 v239, v242, v243
buffer_store_dwordx4 v[236:239], v18, s[32:35], s82 offen
v_pk_mul_f32 v[244:245], v[244:245], v[184:185] op_sel:[0,0] op_sel_hi:[1,0]
v_pk_mul_f32 v[246:247], v[246:247], v[184:185] op_sel:[0,0] op_sel_hi:[1,0]
v_pk_mul_f32 v[248:249], v[248:249], v[184:185] op_sel:[0,0] op_sel_hi:[1,0]
v_pk_mul_f32 v[250:251], v[250:251], v[184:185] op_sel:[0,0] op_sel_hi:[1,0]
v_cvt_pk_bf16_f32 v244, v244, v245
v_cvt_pk_bf16_f32 v245, v246, v247
v_cvt_pk_bf16_f32 v246, v248, v249
v_cvt_pk_bf16_f32 v247, v250, v251
buffer_store_dwordx4 v[244:247], v18, s[32:35], s83 offen
s_barrier
s_lshl_b32 s62, s45, 2
v_mov_b32 v4, s62
v_mov_b32 v5, 3
s_mov_b64 exec, 1
s_waitcnt vmcnt(0)
buffer_store_dword v5, v4, s[32:35], s84 offen
s_mov_b64 exec, -1
back_85:
v_and_b32 v36, 31, v0
v_lshlrev_b32 v36, 2, v36
buffer_load_dword v37, v36, s[32:35], s84 offen sc1
v_lshrrev_b32 v4, 2, v2
v_and_b32 v5, 3, v0
v_lshl_add_u32 v6, v3, 3, v4
v_lshlrev_b32 v6, 7, v6
v_lshl_add_u32 v6, v5, 3, v6
v_lshrrev_b32 v7, 1, v4
v_and_b32 v8, 1, v3
v_lshl_add_u32 v7, v8, 1, v7
v_lshl_add_u32 v10, v7, 5, v6
v_xor_b32 v11, 32, v10
v_xor_b32 v12, 64, v10
v_xor_b32 v13, 96, v10
v_add_u32 v14, 0x10000, v10
v_add_u32 v15, 0x10000, v11
v_add_u32 v16, 0x10000, v12
v_add_u32 v17, 0x10000, v13
ds_read_b64_tr_b16 v[220:221], v10 offset:0
ds_read_b64_tr_b16 v[222:223], v10 offset:512
ds_read_b64_tr_b16 v[224:225], v11 offset:0
ds_read_b64_tr_b16 v[226:227], v11 offset:512
ds_read_b64_tr_b16 v[228:229], v12 offset:0
ds_read_b64_tr_b16 v[230:231], v12 offset:512
ds_read_b64_tr_b16 v[232:233], v13 offset:0
ds_read_b64_tr_b16 v[234:235], v13 offset:512
ds_read_b64_tr_b16 v[236:237], v10 offset:4096
ds_read_b64_tr_b16 v[238:239], v10 offset:4608
ds_read_b64_tr_b16 v[240:241], v11 offset:4096
ds_read_b64_tr_b16 v[242:243], v11 offset:4608
ds_read_b64_tr_b16 v[244:245], v12 offset:4096
ds_read_b64_tr_b16 v[246:247], v12 offset:4608
ds_read_b64_tr_b16 v[248:249], v13 offset:4096
ds_read_b64_tr_b16 v[250:251], v13 offset:4608
s_lshl_b32 s48, s41, 3
s_lshl_b32 s49, s40, 1
s_add_u32 s48, s48, s49
s_lshl_b32 s48, s48, 15
s_add_u32 s48, s48, 4194304
v_add_u32 v38, s48, v18
v_add_u32 v39, 32768, v38
s_lshl_b32 s57, s75, 11
s_add_u32 s87, s87, 262144
v_lshlrev_b32 v60, 16, v20
v_and_b32 v61, 0xffff0000, v20
v_lshlrev_b32 v62, 16, v21
v_and_b32 v63, 0xffff0000, v21
v_lshlrev_b32 v64, 16, v22
v_and_b32 v65, 0xffff0000, v22
v_lshlrev_b32 v66, 16, v23
v_and_b32 v67, 0xffff0000, v23
v_lshlrev_b32 v68, 16, v24
v_and_b32 v69, 0xffff0000, v24
v_lshlrev_b32 v70, 16, v25
v_and_b32 v71, 0xffff0000, v25
v_lshlrev_b32 v72, 16, v26
v_and_b32 v73, 0xffff0000, v26
v_lshlrev_b32 v74, 16, v27
v_and_b32 v75, 0xffff0000, v27
v_lshlrev_b32 v76, 16, v28
v_and_b32 v77, 0xffff0000, v28
v_lshlrev_b32 v78, 16, v29
v_and_b32 v79, 0xffff0000, v29
v_lshlrev_b32 v80, 16, v30
v_and_b32 v81, 0xffff0000, v30
v_lshlrev_b32 v82, 16, v31
v_and_b32 v83, 0xffff0000, v31
v_lshlrev_b32 v84, 16, v32
v_and_b32 v85, 0xffff0000, v32
v_lshlrev_b32 v86, 16, v33
v_and_b32 v87, 0xffff0000, v33
v_lshlrev_b32 v88, 16, v34
v_and_b32 v89, 0xffff0000, v34
v_lshlrev_b32 v90, 16, v35
v_and_b32 v91, 0xffff0000, v35
v_mov_b32 v6, 0
v_mov_b32 v7, 0
v_mov_b32 v8, 0
v_mov_b32 v9, 0
s_lshl_b32 s62, s42, 2
v_mov_b32 v4, s62
v_mov_b32 v5, 3
s_mov_b32 s63, 0
s_waitcnt vmcnt(0)
poll_86:
v_cmp_gt_u32 vcc, 3, v37
s_cbranch_vccz polled_87
buffer_load_dword v37, v36, s[32:35], s84 offen sc1
s_add_u32 s63, s63, 1
s_cmp_lt_u32 s63, 0x80000
s_waitcnt vmcnt(0)
s_cbranch_scc1 poll_86
polled_87:
buffer_load_dwordx4 v[156:159], v38, s[32:35], s57 offen sc1
buffer_load_dwordx4 v[160:163], v39, s[32:35], s57 offen sc1
buffer_load_dwordx4 v[164:167], v38, s[32:35], s57 offen offset:1024 sc1
buffer_load_dwordx4 v[168:171], v39, s[32:35], s57 offen offset:1024 sc1
s_add_u32 s57, s57, 2048
s_and_b32 s57, s57, 0x7fff
buffer_load_dwordx4 v[172:175], v38, s[32:35], s57 offen sc1
buffer_load_dwordx4 v[176:179], v39, s[32:35], s57 offen sc1
buffer_load_dwordx4 v[180:183], v38, s[32:35], s57 offen offset:1024 sc1
buffer_load_dwordx4 v[184:187], v39, s[32:35], s57 offen offset:1024 sc1
s_add_u32 s57, s57, 2048
s_and_b32 s57, s57, 0x7fff
s_waitcnt vmcnt(6) lgkmcnt(8)
v_mfma_f32_16x16x32_bf16 v[60:63], v[220:223], v[156:159], v[60:63]
buffer_load_dwordx4 v[188:191], v38, s[32:35], s57 offen sc1
v_mfma_f32_16x16x32_bf16 v[76:79], v[220:223], v[160:163], v[76:79]
ds_read_b64_tr_b16 v[100:101], v10 offset:8192
ds_read_b64_tr_b16 v[102:103], v10 offset:8704
v_mfma_f32_16x16x32_bf16 v[64:67], v[224:227], v[156:159], v[64:67]
ds_read_b64_tr_b16 v[104:105], v11 offset:8192
ds_read_b64_tr_b16 v[106:107], v11 offset:8704
v_mfma_f32_16x16x32_bf16 v[80:83], v[224:227], v[160:163], v[80:83]
buffer_load_dwordx4 v[192:195], v39, s[32:35], s57 offen sc1
v_mfma_f32_16x16x32_bf16 v[68:71], v[228:231], v[156:159], v[68:71]
ds_read_b64_tr_b16 v[108:109], v12 offset:8192
ds_read_b64_tr_b16 v[110:111], v12 offset:8704
v_mfma_f32_16x16x32_bf16 v[84:87], v[228:231], v[160:163], v[84:87]
ds_read_b64_tr_b16 v[112:113], v13 offset:8192
ds_read_b64_tr_b16 v[114:115], v13 offset:8704
v_mfma_f32_16x16x32_bf16 v[72:75], v[232:235], v[156:159], v[72:75]
v_mfma_f32_16x16x32_bf16 v[88:91], v[232:235], v[160:163], v[88:91]
s_waitcnt vmcnt(6) lgkmcnt(8)
v_mfma_f32_16x16x32_bf16 v[60:63], v[236:239], v[164:167], v[60:63]
buffer_load_dwordx4 v[196:199], v38, s[32:35], s57 offen offset:1024 sc1
v_mfma_f32_16x16x32_bf16 v[76:79], v[236:239], v[168:171], v[76:79]
ds_read_b64_tr_b16 v[220:221], v10 offset:12288
ds_read_b64_tr_b16 v[222:223], v10 offset:12800
v_mfma_f32_16x16x32_bf16 v[64:67], v[240:243], v[164:167], v[64:67]
ds_read_b64_tr_b16 v[224:225], v11 offset:12288
ds_read_b64_tr_b16 v[226:227], v11 offset:12800
v_mfma_f32_16x16x32_bf16 v[80:83], v[240:243], v[168:171], v[80:83]
buffer_load_dwordx4 v[200:203], v39, s[32:35], s57 offen offset:1024 sc1
v_mfma_f32_16x16x32_bf16 v[68:71], v[244:247], v[164:167], v[68:71]
ds_read_b64_tr_b16 v[228:229], v12 offset:12288
ds_read_b64_tr_b16 v[230:231], v12 offset:12800
v_mfma_f32_16x16x32_bf16 v[84:87], v[244:247], v[168:171], v[84:87]
ds_read_b64_tr_b16 v[232:233], v13 offset:12288
ds_read_b64_tr_b16 v[234:235], v13 offset:12800
v_mfma_f32_16x16x32_bf16 v[72:75], v[248:251], v[164:167], v[72:75]
s_add_u32 s57, s57, 2048
s_and_b32 s57, s57, 0x7fff
v_mfma_f32_16x16x32_bf16 v[88:91], v[248:251], v[168:171], v[88:91]
s_waitcnt vmcnt(6) lgkmcnt(8)
v_mfma_f32_16x16x32_bf16 v[60:63], v[100:103], v[172:175], v[60:63]
buffer_load_dwordx4 v[204:207], v38, s[32:35], s57 offen sc1
v_mfma_f32_16x16x32_bf16 v[76:79], v[100:103], v[176:179], v[76:79]
ds_read_b64_tr_b16 v[236:237], v10 offset:16384
ds_read_b64_tr_b16 v[238:239], v10 offset:16896
v_mfma_f32_16x16x32_bf16 v[64:67], v[104:107], v[172:175], v[64:67]
ds_read_b64_tr_b16 v[240:241], v11 offset:16384
ds_read_b64_tr_b16 v[242:243], v11 offset:16896
v_mfma_f32_16x16x32_bf16 v[80:83], v[104:107], v[176:179], v[80:83]
buffer_load_dwordx4 v[208:211], v39, s[32:35], s57 offen sc1
v_mfma_f32_16x16x32_bf16 v[68:71], v[108:111], v[172:175], v[68:71]
ds_read_b64_tr_b16 v[244:245], v12 offset:16384
ds_read_b64_tr_b16 v[246:247], v12 offset:16896
v_mfma_f32_16x16x32_bf16 v[84:87], v[108:111], v[176:179], v[84:87]
ds_read_b64_tr_b16 v[248:249], v13 offset:16384
ds_read_b64_tr_b16 v[250:251], v13 offset:16896
v_mfma_f32_16x16x32_bf16 v[72:75], v[112:115], v[172:175], v[72:75]
v_mfma_f32_16x16x32_bf16 v[88:91], v[112:115], v[176:179], v[88:91]
s_waitcnt vmcnt(6) lgkmcnt(8)
v_mfma_f32_16x16x32_bf16 v[60:63], v[220:223], v[180:183], v[60:63]
buffer_load_dwordx4 v[212:215], v38, s[32:35], s57 offen offset:1024 sc1
v_mfma_f32_16x16x32_bf16 v[76:79], v[220:223], v[184:187], v[76:79]
ds_read_b64_tr_b16 v[100:101], v10 offset:20480
ds_read_b64_tr_b16 v[102:103], v10 offset:20992
v_mfma_f32_16x16x32_bf16 v[64:67], v[224:227], v[180:183], v[64:67]
ds_read_b64_tr_b16 v[104:105], v11 offset:20480
ds_read_b64_tr_b16 v[106:107], v11 offset:20992
v_mfma_f32_16x16x32_bf16 v[80:83], v[224:227], v[184:187], v[80:83]
buffer_load_dwordx4 v[216:219], v39, s[32:35], s57 offen offset:1024 sc1
v_mfma_f32_16x16x32_bf16 v[68:71], v[228:231], v[180:183], v[68:71]
ds_read_b64_tr_b16 v[108:109], v12 offset:20480
ds_read_b64_tr_b16 v[110:111], v12 offset:20992
v_mfma_f32_16x16x32_bf16 v[84:87], v[228:231], v[184:187], v[84:87]
ds_read_b64_tr_b16 v[112:113], v13 offset:20480
ds_read_b64_tr_b16 v[114:115], v13 offset:20992
v_mfma_f32_16x16x32_bf16 v[72:75], v[232:235], v[180:183], v[72:75]
s_add_u32 s57, s57, 2048
s_and_b32 s57, s57, 0x7fff
v_mfma_f32_16x16x32_bf16 v[88:91], v[232:235], v[184:187], v[88:91]
s_waitcnt vmcnt(6) lgkmcnt(8)
v_mfma_f32_16x16x32_bf16 v[60:63], v[236:239], v[188:191], v[60:63]
buffer_load_dwordx4 v[156:159], v38, s[32:35], s57 offen sc1
v_mfma_f32_16x16x32_bf16 v[76:79], v[236:239], v[192:195], v[76:79]
ds_read_b64_tr_b16 v[220:221], v10 offset:24576
ds_read_b64_tr_b16 v[222:223], v10 offset:25088
v_mfma_f32_16x16x32_bf16 v[64:67], v[240:243], v[188:191], v[64:67]
ds_read_b64_tr_b16 v[224:225], v11 offset:24576
ds_read_b64_tr_b16 v[226:227], v11 offset:25088
v_mfma_f32_16x16x32_bf16 v[80:83], v[240:243], v[192:195], v[80:83]
buffer_load_dwordx4 v[160:163], v39, s[32:35], s57 offen sc1
v_mfma_f32_16x16x32_bf16 v[68:71], v[244:247], v[188:191], v[68:71]
ds_read_b64_tr_b16 v[228:229], v12 offset:24576
ds_read_b64_tr_b16 v[230:231], v12 offset:25088
v_mfma_f32_16x16x32_bf16 v[84:87], v[244:247], v[192:195], v[84:87]
ds_read_b64_tr_b16 v[232:233], v13 offset:24576
ds_read_b64_tr_b16 v[234:235], v13 offset:25088
v_mfma_f32_16x16x32_bf16 v[72:75], v[248:251], v[188:191], v[72:75]
v_mfma_f32_16x16x32_bf16 v[88:91], v[248:251], v[192:195], v[88:91]
s_waitcnt vmcnt(6) lgkmcnt(8)
v_mfma_f32_16x16x32_bf16 v[60:63], v[100:103], v[196:199], v[60:63]
buffer_load_dwordx4 v[164:167], v38, s[32:35], s57 offen offset:1024 sc1
v_mfma_f32_16x16x32_bf16 v[76:79], v[100:103], v[200:203], v[76:79]
ds_read_b64_tr_b16 v[236:237], v10 offset:28672
ds_read_b64_tr_b16 v[238:239], v10 offset:29184
v_mfma_f32_16x16x32_bf16 v[64:67], v[104:107], v[196:199], v[64:67]
ds_read_b64_tr_b16 v[240:241], v11 offset:28672
ds_read_b64_tr_b16 v[242:243], v11 offset:29184
v_mfma_f32_16x16x32_bf16 v[80:83], v[104:107], v[200:203], v[80:83]
buffer_load_dwordx4 v[168:171], v39, s[32:35], s57 offen offset:1024 sc1
v_mfma_f32_16x16x32_bf16 v[68:71], v[108:111], v[196:199], v[68:71]
ds_read_b64_tr_b16 v[244:245], v12 offset:28672
ds_read_b64_tr_b16 v[246:247], v12 offset:29184
v_mfma_f32_16x16x32_bf16 v[84:87], v[108:111], v[200:203], v[84:87]
ds_read_b64_tr_b16 v[248:249], v13 offset:28672
ds_read_b64_tr_b16 v[250:251], v13 offset:29184
v_mfma_f32_16x16x32_bf16 v[72:75], v[112:115], v[196:199], v[72:75]
s_add_u32 s57, s57, 2048
s_and_b32 s57, s57, 0x7fff
v_mfma_f32_16x16x32_bf16 v[88:91], v[112:115], v[200:203], v[88:91]
s_waitcnt vmcnt(6) lgkmcnt(8)
v_mfma_f32_16x16x32_bf16 v[60:63], v[220:223], v[204:207], v[60:63]
buffer_load_dwordx4 v[172:175], v38, s[32:35], s57 offen sc1
v_mfma_f32_16x16x32_bf16 v[76:79], v[220:223], v[208:211], v[76:79]
ds_read_b64_tr_b16 v[100:101], v10 offset:32768
ds_read_b64_tr_b16 v[102:103], v10 offset:33280
v_mfma_f32_16x16x32_bf16 v[64:67], v[224:227], v[204:207], v[64:67]
ds_read_b64_tr_b16 v[104:105], v11 offset:32768
ds_read_b64_tr_b16 v[106:107], v11 offset:33280
v_mfma_f32_16x16x32_bf16 v[80:83], v[224:227], v[208:211], v[80:83]
buffer_load_dwordx4 v[176:179], v39, s[32:35], s57 offen sc1
v_mfma_f32_16x16x32_bf16 v[68:71], v[228:231], v[204:207], v[68:71]
ds_read_b64_tr_b16 v[108:109], v12 offset:32768
ds_read_b64_tr_b16 v[110:111], v12 offset:33280
v_mfma_f32_16x16x32_bf16 v[84:87], v[228:231], v[208:211], v[84:87]
ds_read_b64_tr_b16 v[112:113], v13 offset:32768
ds_read_b64_tr_b16 v[114:115], v13 offset:33280
v_mfma_f32_16x16x32_bf16 v[72:75], v[232:235], v[204:207], v[72:75]
v_mfma_f32_16x16x32_bf16 v[88:91], v[232:235], v[208:211], v[88:91]
s_waitcnt vmcnt(6) lgkmcnt(8)
v_mfma_f32_16x16x32_bf16 v[60:63], v[236:239], v[212:215], v[60:63]
buffer_load_dwordx4 v[180:183], v38, s[32:35], s57 offen offset:1024 sc1
v_mfma_f32_16x16x32_bf16 v[76:79], v[236:239], v[216:219], v[76:79]
ds_read_b64_tr_b16 v[220:221], v10 offset:36864
ds_read_b64_tr_b16 v[222:223], v10 offset:37376
v_mfma_f32_16x16x32_bf16 v[64:67], v[240:243], v[212:215], v[64:67]
ds_read_b64_tr_b16 v[224:225], v11 offset:36864
ds_read_b64_tr_b16 v[226:227], v11 offset:37376
v_mfma_f32_16x16x32_bf16 v[80:83], v[240:243], v[216:219], v[80:83]
buffer_load_dwordx4 v[184:187], v39, s[32:35], s57 offen offset:1024 sc1
v_mfma_f32_16x16x32_bf16 v[68:71], v[244:247], v[212:215], v[68:71]
ds_read_b64_tr_b16 v[228:229], v12 offset:36864
ds_read_b64_tr_b16 v[230:231], v12 offset:37376
v_mfma_f32_16x16x32_bf16 v[84:87], v[244:247], v[216:219], v[84:87]
ds_read_b64_tr_b16 v[232:233], v13 offset:36864
ds_read_b64_tr_b16 v[234:235], v13 offset:37376
v_mfma_f32_16x16x32_bf16 v[72:75], v[248:251], v[212:215], v[72:75]
s_add_u32 s57, s57, 2048
s_and_b32 s57, s57, 0x7fff
v_mfma_f32_16x16x32_bf16 v[88:91], v[248:251], v[216:219], v[88:91]
s_waitcnt vmcnt(6) lgkmcnt(8)
v_mfma_f32_16x16x32_bf16 v[60:63], v[100:103], v[156:159], v[60:63]
buffer_load_dwordx4 v[188:191], v38, s[32:35], s57 offen sc1
v_mfma_f32_16x16x32_bf16 v[76:79], v[100:103], v[160:163], v[76:79]
ds_read_b64_tr_b16 v[236:237], v10 offset:40960
ds_read_b64_tr_b16 v[238:239], v10 offset:41472
v_mfma_f32_16x16x32_bf16 v[64:67], v[104:107], v[156:159], v[64:67]
ds_read_b64_tr_b16 v[240:241], v11 offset:40960
ds_read_b64_tr_b16 v[242:243], v11 offset:41472
v_mfma_f32_16x16x32_bf16 v[80:83], v[104:107], v[160:163], v[80:83]
buffer_load_dwordx4 v[192:195], v39, s[32:35], s57 offen sc1
v_mfma_f32_16x16x32_bf16 v[68:71], v[108:111], v[156:159], v[68:71]
ds_read_b64_tr_b16 v[244:245], v12 offset:40960
ds_read_b64_tr_b16 v[246:247], v12 offset:41472
v_mfma_f32_16x16x32_bf16 v[84:87], v[108:111], v[160:163], v[84:87]
ds_read_b64_tr_b16 v[248:249], v13 offset:40960
ds_read_b64_tr_b16 v[250:251], v13 offset:41472
v_mfma_f32_16x16x32_bf16 v[72:75], v[112:115], v[156:159], v[72:75]
v_mfma_f32_16x16x32_bf16 v[88:91], v[112:115], v[160:163], v[88:91]
s_waitcnt vmcnt(6) lgkmcnt(8)
v_mfma_f32_16x16x32_bf16 v[60:63], v[220:223], v[164:167], v[60:63]
buffer_load_dwordx4 v[196:199], v38, s[32:35], s57 offen offset:1024 sc1
v_mfma_f32_16x16x32_bf16 v[76:79], v[220:223], v[168:171], v[76:79]
ds_read_b64_tr_b16 v[100:101], v10 offset:45056
ds_read_b64_tr_b16 v[102:103], v10 offset:45568
v_mfma_f32_16x16x32_bf16 v[64:67], v[224:227], v[164:167], v[64:67]
ds_read_b64_tr_b16 v[104:105], v11 offset:45056
ds_read_b64_tr_b16 v[106:107], v11 offset:45568
v_mfma_f32_16x16x32_bf16 v[80:83], v[224:227], v[168:171], v[80:83]
buffer_load_dwordx4 v[200:203], v39, s[32:35], s57 offen offset:1024 sc1
v_mfma_f32_16x16x32_bf16 v[68:71], v[228:231], v[164:167], v[68:71]
ds_read_b64_tr_b16 v[108:109], v12 offset:45056
ds_read_b64_tr_b16 v[110:111], v12 offset:45568
v_mfma_f32_16x16x32_bf16 v[84:87], v[228:231], v[168:171], v[84:87]
ds_read_b64_tr_b16 v[112:113], v13 offset:45056
ds_read_b64_tr_b16 v[114:115], v13 offset:45568
v_mfma_f32_16x16x32_bf16 v[72:75], v[232:235], v[164:167], v[72:75]
s_add_u32 s57, s57, 2048
s_and_b32 s57, s57, 0x7fff
v_mfma_f32_16x16x32_bf16 v[88:91], v[232:235], v[168:171], v[88:91]
s_waitcnt vmcnt(6) lgkmcnt(8)
v_mfma_f32_16x16x32_bf16 v[60:63], v[236:239], v[172:175], v[60:63]
buffer_load_dwordx4 v[204:207], v38, s[32:35], s57 offen sc1
v_mfma_f32_16x16x32_bf16 v[76:79], v[236:239], v[176:179], v[76:79]
ds_read_b64_tr_b16 v[220:221], v10 offset:49152
ds_read_b64_tr_b16 v[222:223], v10 offset:49664
v_mfma_f32_16x16x32_bf16 v[64:67], v[240:243], v[172:175], v[64:67]
ds_read_b64_tr_b16 v[224:225], v11 offset:49152
ds_read_b64_tr_b16 v[226:227], v11 offset:49664
v_mfma_f32_16x16x32_bf16 v[80:83], v[240:243], v[176:179], v[80:83]
buffer_load_dwordx4 v[208:211], v39, s[32:35], s57 offen sc1
v_mfma_f32_16x16x32_bf16 v[68:71], v[244:247], v[172:175], v[68:71]
ds_read_b64_tr_b16 v[228:229], v12 offset:49152
ds_read_b64_tr_b16 v[230:231], v12 offset:49664
v_mfma_f32_16x16x32_bf16 v[84:87], v[244:247], v[176:179], v[84:87]
ds_read_b64_tr_b16 v[232:233], v13 offset:49152
ds_read_b64_tr_b16 v[234:235], v13 offset:49664
v_mfma_f32_16x16x32_bf16 v[72:75], v[248:251], v[172:175], v[72:75]
v_mfma_f32_16x16x32_bf16 v[88:91], v[248:251], v[176:179], v[88:91]
s_waitcnt vmcnt(6) lgkmcnt(8)
v_mfma_f32_16x16x32_bf16 v[60:63], v[100:103], v[180:183], v[60:63]
buffer_load_dwordx4 v[212:215], v38, s[32:35], s57 offen offset:1024 sc1
v_mfma_f32_16x16x32_bf16 v[76:79], v[100:103], v[184:187], v[76:79]
ds_read_b64_tr_b16 v[236:237], v10 offset:53248
ds_read_b64_tr_b16 v[238:239], v10 offset:53760
v_mfma_f32_16x16x32_bf16 v[64:67], v[104:107], v[180:183], v[64:67]
ds_read_b64_tr_b16 v[240:241], v11 offset:53248
ds_read_b64_tr_b16 v[242:243], v11 offset:53760
v_mfma_f32_16x16x32_bf16 v[80:83], v[104:107], v[184:187], v[80:83]
buffer_load_dwordx4 v[216:219], v39, s[32:35], s57 offen offset:1024 sc1
v_mfma_f32_16x16x32_bf16 v[68:71], v[108:111], v[180:183], v[68:71]
ds_read_b64_tr_b16 v[244:245], v12 offset:53248
ds_read_b64_tr_b16 v[246:247], v12 offset:53760
v_mfma_f32_16x16x32_bf16 v[84:87], v[108:111], v[184:187], v[84:87]
ds_read_b64_tr_b16 v[248:249], v13 offset:53248
ds_read_b64_tr_b16 v[250:251], v13 offset:53760
v_mfma_f32_16x16x32_bf16 v[72:75], v[112:115], v[180:183], v[72:75]
s_add_u32 s57, s57, 2048
s_and_b32 s57, s57, 0x7fff
v_mfma_f32_16x16x32_bf16 v[88:91], v[112:115], v[184:187], v[88:91]
s_waitcnt vmcnt(6) lgkmcnt(8)
v_mfma_f32_16x16x32_bf16 v[60:63], v[220:223], v[188:191], v[60:63]
buffer_load_dwordx4 v[156:159], v38, s[32:35], s57 offen sc1
v_mfma_f32_16x16x32_bf16 v[76:79], v[220:223], v[192:195], v[76:79]
ds_read_b64_tr_b16 v[100:101], v10 offset:57344
ds_read_b64_tr_b16 v[102:103], v10 offset:57856
v_mfma_f32_16x16x32_bf16 v[64:67], v[224:227], v[188:191], v[64:67]
ds_read_b64_tr_b16 v[104:105], v11 offset:57344
ds_read_b64_tr_b16 v[106:107], v11 offset:57856
v_mfma_f32_16x16x32_bf16 v[80:83], v[224:227], v[192:195], v[80:83]
buffer_load_dwordx4 v[160:163], v39, s[32:35], s57 offen sc1
v_mfma_f32_16x16x32_bf16 v[68:71], v[228:231], v[188:191], v[68:71]
ds_read_b64_tr_b16 v[108:109], v12 offset:57344
ds_read_b64_tr_b16 v[110:111], v12 offset:57856
v_mfma_f32_16x16x32_bf16 v[84:87], v[228:231], v[192:195], v[84:87]
ds_read_b64_tr_b16 v[112:113], v13 offset:57344
ds_read_b64_tr_b16 v[114:115], v13 offset:57856
v_mfma_f32_16x16x32_bf16 v[72:75], v[232:235], v[188:191], v[72:75]
v_mfma_f32_16x16x32_bf16 v[88:91], v[232:235], v[192:195], v[88:91]
s_waitcnt vmcnt(6) lgkmcnt(8)
v_mfma_f32_16x16x32_bf16 v[60:63], v[236:239], v[196:199], v[60:63]
buffer_load_dwordx4 v[164:167], v38, s[32:35], s57 offen offset:1024 sc1
v_mfma_f32_16x16x32_bf16 v[76:79], v[236:239], v[200:203], v[76:79]
ds_read_b64_tr_b16 v[220:221], v10 offset:61440
ds_read_b64_tr_b16 v[222:223], v10 offset:61952
v_mfma_f32_16x16x32_bf16 v[64:67], v[240:243], v[196:199], v[64:67]
ds_read_b64_tr_b16 v[224:225], v11 offset:61440
ds_read_b64_tr_b16 v[226:227], v11 offset:61952
v_mfma_f32_16x16x32_bf16 v[80:83], v[240:243], v[200:203], v[80:83]
buffer_load_dwordx4 v[168:171], v39, s[32:35], s57 offen offset:1024 sc1
v_mfma_f32_16x16x32_bf16 v[68:71], v[244:247], v[196:199], v[68:71]
ds_read_b64_tr_b16 v[228:229], v12 offset:61440
ds_read_b64_tr_b16 v[230:231], v12 offset:61952
v_mfma_f32_16x16x32_bf16 v[84:87], v[244:247], v[200:203], v[84:87]
ds_read_b64_tr_b16 v[232:233], v13 offset:61440
ds_read_b64_tr_b16 v[234:235], v13 offset:61952
v_mfma_f32_16x16x32_bf16 v[72:75], v[248:251], v[196:199], v[72:75]
s_add_u32 s57, s57, 2048
s_and_b32 s57, s57, 0x7fff
v_mfma_f32_16x16x32_bf16 v[88:91], v[248:251], v[200:203], v[88:91]
s_waitcnt vmcnt(6) lgkmcnt(8)
v_mfma_f32_16x16x32_bf16 v[60:63], v[100:103], v[204:207], v[60:63]
buffer_load_dwordx4 v[172:175], v38, s[32:35], s57 offen sc1
v_mfma_f32_16x16x32_bf16 v[76:79], v[100:103], v[208:211], v[76:79]
ds_read_b64_tr_b16 v[236:237], v14 offset:0
ds_read_b64_tr_b16 v[238:239], v14 offset:512
v_mfma_f32_16x16x32_bf16 v[64:67], v[104:107], v[204:207], v[64:67]
ds_read_b64_tr_b16 v[240:241], v15 offset:0
ds_read_b64_tr_b16 v[242:243], v15 offset:512
v_mfma_f32_16x16x32_bf16 v[80:83], v[104:107], v[208:211], v[80:83]
buffer_load_dwordx4 v[176:179], v39, s[32:35], s57 offen sc1
v_mfma_f32_16x16x32_bf16 v[68:71], v[108:111], v[204:207], v[68:71]
ds_read_b64_tr_b16 v[244:245], v16 offset:0
ds_read_b64_tr_b16 v[246:247], v16 offset:512
v_mfma_f32_16x16x32_bf16 v[84:87], v[108:111], v[208:211], v[84:87]
ds_read_b64_tr_b16 v[248:249], v17 offset:0
ds_read_b64_tr_b16 v[250:251], v17 offset:512
v_mfma_f32_16x16x32_bf16 v[72:75], v[112:115], v[204:207], v[72:75]
v_mfma_f32_16x16x32_bf16 v[88:91], v[112:115], v[208:211], v[88:91]
s_waitcnt vmcnt(6) lgkmcnt(8)
v_mfma_f32_16x16x32_bf16 v[60:63], v[220:223], v[212:215], v[60:63]
buffer_load_dwordx4 v[180:183], v38, s[32:35], s57 offen offset:1024 sc1
v_mfma_f32_16x16x32_bf16 v[76:79], v[220:223], v[216:219], v[76:79]
ds_read_b64_tr_b16 v[100:101], v14 offset:4096
ds_read_b64_tr_b16 v[102:103], v14 offset:4608
v_mfma_f32_16x16x32_bf16 v[64:67], v[224:227], v[212:215], v[64:67]
ds_read_b64_tr_b16 v[104:105], v15 offset:4096
ds_read_b64_tr_b16 v[106:107], v15 offset:4608
v_mfma_f32_16x16x32_bf16 v[80:83], v[224:227], v[216:219], v[80:83]
buffer_load_dwordx4 v[184:187], v39, s[32:35], s57 offen offset:1024 sc1
v_mfma_f32_16x16x32_bf16 v[68:71], v[228:231], v[212:215], v[68:71]
ds_read_b64_tr_b16 v[108:109], v16 offset:4096
ds_read_b64_tr_b16 v[110:111], v16 offset:4608
v_mfma_f32_16x16x32_bf16 v[84:87], v[228:231], v[216:219], v[84:87]
ds_read_b64_tr_b16 v[112:113], v17 offset:4096
ds_read_b64_tr_b16 v[114:115], v17 offset:4608
v_mfma_f32_16x16x32_bf16 v[72:75], v[232:235], v[212:215], v[72:75]
s_add_u32 s57, s57, 2048
s_and_b32 s57, s57, 0x7fff
v_mfma_f32_16x16x32_bf16 v[88:91], v[232:235], v[216:219], v[88:91]
s_waitcnt vmcnt(6) lgkmcnt(8)
v_mfma_f32_16x16x32_bf16 v[60:63], v[236:239], v[156:159], v[60:63]
buffer_load_dwordx4 v[188:191], v38, s[32:35], s57 offen sc1
v_mfma_f32_16x16x32_bf16 v[76:79], v[236:239], v[160:163], v[76:79]
ds_read_b64_tr_b16 v[220:221], v14 offset:8192
ds_read_b64_tr_b16 v[222:223], v14 offset:8704
v_mfma_f32_16x16x32_bf16 v[64:67], v[240:243], v[156:159], v[64:67]
ds_read_b64_tr_b16 v[224:225], v15 offset:8192
ds_read_b64_tr_b16 v[226:227], v15 offset:8704
v_mfma_f32_16x16x32_bf16 v[80:83], v[240:243], v[160:163], v[80:83]
buffer_load_dwordx4 v[192:195], v39, s[32:35], s57 offen sc1
v_mfma_f32_16x16x32_bf16 v[68:71], v[244:247], v[156:159], v[68:71]
ds_read_b64_tr_b16 v[228:229], v16 offset:8192
ds_read_b64_tr_b16 v[230:231], v16 offset:8704
v_mfma_f32_16x16x32_bf16 v[84:87], v[244:247], v[160:163], v[84:87]
ds_read_b64_tr_b16 v[232:233], v17 offset:8192
ds_read_b64_tr_b16 v[234:235], v17 offset:8704
v_mfma_f32_16x16x32_bf16 v[72:75], v[248:251], v[156:159], v[72:75]
v_mfma_f32_16x16x32_bf16 v[88:91], v[248:251], v[160:163], v[88:91]
s_waitcnt vmcnt(6) lgkmcnt(8)
v_mfma_f32_16x16x32_bf16 v[60:63], v[100:103], v[164:167], v[60:63]
buffer_load_dwordx4 v[196:199], v38, s[32:35], s57 offen offset:1024 sc1
v_mfma_f32_16x16x32_bf16 v[76:79], v[100:103], v[168:171], v[76:79]
ds_read_b64_tr_b16 v[236:237], v14 offset:12288
ds_read_b64_tr_b16 v[238:239], v14 offset:12800
v_mfma_f32_16x16x32_bf16 v[64:67], v[104:107], v[164:167], v[64:67]
ds_read_b64_tr_b16 v[240:241], v15 offset:12288
ds_read_b64_tr_b16 v[242:243], v15 offset:12800
v_mfma_f32_16x16x32_bf16 v[80:83], v[104:107], v[168:171], v[80:83]
buffer_load_dwordx4 v[200:203], v39, s[32:35], s57 offen offset:1024 sc1
v_mfma_f32_16x16x32_bf16 v[68:71], v[108:111], v[164:167], v[68:71]
ds_read_b64_tr_b16 v[244:245], v16 offset:12288
ds_read_b64_tr_b16 v[246:247], v16 offset:12800
v_mfma_f32_16x16x32_bf16 v[84:87], v[108:111], v[168:171], v[84:87]
ds_read_b64_tr_b16 v[248:249], v17 offset:12288
ds_read_b64_tr_b16 v[250:251], v17 offset:12800
v_mfma_f32_16x16x32_bf16 v[72:75], v[112:115], v[164:167], v[72:75]
s_add_u32 s57, s57, 2048
s_and_b32 s57, s57, 0x7fff
v_mfma_f32_16x16x32_bf16 v[88:91], v[112:115], v[168:171], v[88:91]
s_waitcnt vmcnt(6) lgkmcnt(8)
v_mfma_f32_16x16x32_bf16 v[60:63], v[220:223], v[172:175], v[60:63]
buffer_load_dwordx4 v[204:207], v38, s[32:35], s57 offen sc1
v_mfma_f32_16x16x32_bf16 v[76:79], v[220:223], v[176:179], v[76:79]
ds_read_b64_tr_b16 v[100:101], v14 offset:16384
ds_read_b64_tr_b16 v[102:103], v14 offset:16896
v_mfma_f32_16x16x32_bf16 v[64:67], v[224:227], v[172:175], v[64:67]
ds_read_b64_tr_b16 v[104:105], v15 offset:16384
ds_read_b64_tr_b16 v[106:107], v15 offset:16896
v_mfma_f32_16x16x32_bf16 v[80:83], v[224:227], v[176:179], v[80:83]
buffer_load_dwordx4 v[208:211], v39, s[32:35], s57 offen sc1
v_mfma_f32_16x16x32_bf16 v[68:71], v[228:231], v[172:175], v[68:71]
ds_read_b64_tr_b16 v[108:109], v16 offset:16384
ds_read_b64_tr_b16 v[110:111], v16 offset:16896
v_mfma_f32_16x16x32_bf16 v[84:87], v[228:231], v[176:179], v[84:87]
ds_read_b64_tr_b16 v[112:113], v17 offset:16384
ds_read_b64_tr_b16 v[114:115], v17 offset:16896
v_mfma_f32_16x16x32_bf16 v[72:75], v[232:235], v[172:175], v[72:75]
v_mfma_f32_16x16x32_bf16 v[88:91], v[232:235], v[176:179], v[88:91]
s_waitcnt vmcnt(6) lgkmcnt(8)
v_mfma_f32_16x16x32_bf16 v[60:63], v[236:239], v[180:183], v[60:63]
buffer_load_dwordx4 v[212:215], v38, s[32:35], s57 offen offset:1024 sc1
v_mfma_f32_16x16x32_bf16 v[76:79], v[236:239], v[184:187], v[76:79]
ds_read_b64_tr_b16 v[220:221], v14 offset:20480
ds_read_b64_tr_b16 v[222:223], v14 offset:20992
v_mfma_f32_16x16x32_bf16 v[64:67], v[240:243], v[180:183], v[64:67]
ds_read_b64_tr_b16 v[224:225], v15 offset:20480
ds_read_b64_tr_b16 v[226:227], v15 offset:20992
v_mfma_f32_16x16x32_bf16 v[80:83], v[240:243], v[184:187], v[80:83]
buffer_load_dwordx4 v[216:219], v39, s[32:35], s57 offen offset:1024 sc1
v_mfma_f32_16x16x32_bf16 v[68:71], v[244:247], v[180:183], v[68:71]
ds_read_b64_tr_b16 v[228:229], v16 offset:20480
ds_read_b64_tr_b16 v[230:231], v16 offset:20992
v_mfma_f32_16x16x32_bf16 v[84:87], v[244:247], v[184:187], v[84:87]
ds_read_b64_tr_b16 v[232:233], v17 offset:20480
ds_read_b64_tr_b16 v[234:235], v17 offset:20992
v_mfma_f32_16x16x32_bf16 v[72:75], v[248:251], v[180:183], v[72:75]
s_add_u32 s57, s57, 2048
s_and_b32 s57, s57, 0x7fff
v_mfma_f32_16x16x32_bf16 v[88:91], v[248:251], v[184:187], v[88:91]
s_waitcnt vmcnt(6) lgkmcnt(8)
v_mfma_f32_16x16x32_bf16 v[60:63], v[100:103], v[188:191], v[60:63]
buffer_load_dwordx4 v[156:159], v38, s[32:35], s57 offen sc1
v_mfma_f32_16x16x32_bf16 v[76:79], v[100:103], v[192:195], v[76:79]
ds_read_b64_tr_b16 v[236:237], v14 offset:24576
ds_read_b64_tr_b16 v[238:239], v14 offset:25088
v_mfma_f32_16x16x32_bf16 v[64:67], v[104:107], v[188:191], v[64:67]
ds_read_b64_tr_b16 v[240:241], v15 offset:24576
ds_read_b64_tr_b16 v[242:243], v15 offset:25088
v_mfma_f32_16x16x32_bf16 v[80:83], v[104:107], v[192:195], v[80:83]
buffer_load_dwordx4 v[160:163], v39, s[32:35], s57 offen sc1
v_mfma_f32_16x16x32_bf16 v[68:71], v[108:111], v[188:191], v[68:71]
ds_read_b64_tr_b16 v[244:245], v16 offset:24576
ds_read_b64_tr_b16 v[246:247], v16 offset:25088
v_mfma_f32_16x16x32_bf16 v[84:87], v[108:111], v[192:195], v[84:87]
ds_read_b64_tr_b16 v[248:249], v17 offset:24576
ds_read_b64_tr_b16 v[250:251], v17 offset:25088
v_mfma_f32_16x16x32_bf16 v[72:75], v[112:115], v[188:191], v[72:75]
v_mfma_f32_16x16x32_bf16 v[88:91], v[112:115], v[192:195], v[88:91]
s_waitcnt vmcnt(6) lgkmcnt(8)
v_mfma_f32_16x16x32_bf16 v[60:63], v[220:223], v[196:199], v[60:63]
buffer_load_dwordx4 v[164:167], v38, s[32:35], s57 offen offset:1024 sc1
v_mfma_f32_16x16x32_bf16 v[76:79], v[220:223], v[200:203], v[76:79]
ds_read_b64_tr_b16 v[100:101], v14 offset:28672
ds_read_b64_tr_b16 v[102:103], v14 offset:29184
v_mfma_f32_16x16x32_bf16 v[64:67], v[224:227], v[196:199], v[64:67]
ds_read_b64_tr_b16 v[104:105], v15 offset:28672
ds_read_b64_tr_b16 v[106:107], v15 offset:29184
v_mfma_f32_16x16x32_bf16 v[80:83], v[224:227], v[200:203], v[80:83]
buffer_load_dwordx4 v[168:171], v39, s[32:35], s57 offen offset:1024 sc1
v_mfma_f32_16x16x32_bf16 v[68:71], v[228:231], v[196:199], v[68:71]
ds_read_b64_tr_b16 v[108:109], v16 offset:28672
ds_read_b64_tr_b16 v[110:111], v16 offset:29184
v_mfma_f32_16x16x32_bf16 v[84:87], v[228:231], v[200:203], v[84:87]
ds_read_b64_tr_b16 v[112:113], v17 offset:28672
ds_read_b64_tr_b16 v[114:115], v17 offset:29184
v_mfma_f32_16x16x32_bf16 v[72:75], v[232:235], v[196:199], v[72:75]
s_add_u32 s57, s57, 2048
s_and_b32 s57, s57, 0x7fff
v_mfma_f32_16x16x32_bf16 v[88:91], v[232:235], v[200:203], v[88:91]
s_waitcnt vmcnt(6) lgkmcnt(8)
v_mfma_f32_16x16x32_bf16 v[60:63], v[236:239], v[204:207], v[60:63]
buffer_load_dwordx4 v[172:175], v38, s[32:35], s57 offen sc1
v_mfma_f32_16x16x32_bf16 v[76:79], v[236:239], v[208:211], v[76:79]
ds_read_b64_tr_b16 v[220:221], v14 offset:32768
ds_read_b64_tr_b16 v[222:223], v14 offset:33280
v_mfma_f32_16x16x32_bf16 v[64:67], v[240:243], v[204:207], v[64:67]
ds_read_b64_tr_b16 v[224:225], v15 offset:32768
ds_read_b64_tr_b16 v[226:227], v15 offset:33280
v_mfma_f32_16x16x32_bf16 v[80:83], v[240:243], v[208:211], v[80:83]
buffer_load_dwordx4 v[176:179], v39, s[32:35], s57 offen sc1
v_mfma_f32_16x16x32_bf16 v[68:71], v[244:247], v[204:207], v[68:71]
ds_read_b64_tr_b16 v[228:229], v16 offset:32768
ds_read_b64_tr_b16 v[230:231], v16 offset:33280
v_mfma_f32_16x16x32_bf16 v[84:87], v[244:247], v[208:211], v[84:87]
ds_read_b64_tr_b16 v[232:233], v17 offset:32768
ds_read_b64_tr_b16 v[234:235], v17 offset:33280
v_mfma_f32_16x16x32_bf16 v[72:75], v[248:251], v[204:207], v[72:75]
v_mfma_f32_16x16x32_bf16 v[88:91], v[248:251], v[208:211], v[88:91]
s_waitcnt vmcnt(6) lgkmcnt(8)
v_mfma_f32_16x16x32_bf16 v[60:63], v[100:103], v[212:215], v[60:63]
buffer_load_dwordx4 v[180:183], v38, s[32:35], s57 offen offset:1024 sc1
v_mfma_f32_16x16x32_bf16 v[76:79], v[100:103], v[216:219], v[76:79]
ds_read_b64_tr_b16 v[236:237], v14 offset:36864
ds_read_b64_tr_b16 v[238:239], v14 offset:37376
v_mfma_f32_16x16x32_bf16 v[64:67], v[104:107], v[212:215], v[64:67]
ds_read_b64_tr_b16 v[240:241], v15 offset:36864
ds_read_b64_tr_b16 v[242:243], v15 offset:37376
v_mfma_f32_16x16x32_bf16 v[80:83], v[104:107], v[216:219], v[80:83]
buffer_load_dwordx4 v[184:187], v39, s[32:35], s57 offen offset:1024 sc1
v_mfma_f32_16x16x32_bf16 v[68:71], v[108:111], v[212:215], v[68:71]
ds_read_b64_tr_b16 v[244:245], v16 offset:36864
ds_read_b64_tr_b16 v[246:247], v16 offset:37376
v_mfma_f32_16x16x32_bf16 v[84:87], v[108:111], v[216:219], v[84:87]
ds_read_b64_tr_b16 v[248:249], v17 offset:36864
ds_read_b64_tr_b16 v[250:251], v17 offset:37376
v_mfma_f32_16x16x32_bf16 v[72:75], v[112:115], v[212:215], v[72:75]
s_add_u32 s57, s57, 2048
s_and_b32 s57, s57, 0x7fff
v_mfma_f32_16x16x32_bf16 v[88:91], v[112:115], v[216:219], v[88:91]
s_waitcnt vmcnt(6) lgkmcnt(8)
v_mfma_f32_16x16x32_bf16 v[60:63], v[220:223], v[156:159], v[60:63]
buffer_load_dwordx4 v[188:191], v38, s[32:35], s57 offen sc1
v_mfma_f32_16x16x32_bf16 v[76:79], v[220:223], v[160:163], v[76:79]
ds_read_b64_tr_b16 v[100:101], v14 offset:40960
ds_read_b64_tr_b16 v[102:103], v14 offset:41472
v_mfma_f32_16x16x32_bf16 v[64:67], v[224:227], v[156:159], v[64:67]
ds_read_b64_tr_b16 v[104:105], v15 offset:40960
ds_read_b64_tr_b16 v[106:107], v15 offset:41472
v_mfma_f32_16x16x32_bf16 v[80:83], v[224:227], v[160:163], v[80:83]
buffer_load_dwordx4 v[192:195], v39, s[32:35], s57 offen sc1
v_mfma_f32_16x16x32_bf16 v[68:71], v[228:231], v[156:159], v[68:71]
ds_read_b64_tr_b16 v[108:109], v16 offset:40960
ds_read_b64_tr_b16 v[110:111], v16 offset:41472
v_mfma_f32_16x16x32_bf16 v[84:87], v[228:231], v[160:163], v[84:87]
ds_read_b64_tr_b16 v[112:113], v17 offset:40960
ds_read_b64_tr_b16 v[114:115], v17 offset:41472
v_mfma_f32_16x16x32_bf16 v[72:75], v[232:235], v[156:159], v[72:75]
v_mfma_f32_16x16x32_bf16 v[88:91], v[232:235], v[160:163], v[88:91]
s_waitcnt vmcnt(6) lgkmcnt(8)
v_mfma_f32_16x16x32_bf16 v[60:63], v[236:239], v[164:167], v[60:63]
buffer_load_dwordx4 v[196:199], v38, s[32:35], s57 offen offset:1024 sc1
v_mfma_f32_16x16x32_bf16 v[76:79], v[236:239], v[168:171], v[76:79]
ds_read_b64_tr_b16 v[220:221], v14 offset:45056
ds_read_b64_tr_b16 v[222:223], v14 offset:45568
v_mfma_f32_16x16x32_bf16 v[64:67], v[240:243], v[164:167], v[64:67]
ds_read_b64_tr_b16 v[224:225], v15 offset:45056
ds_read_b64_tr_b16 v[226:227], v15 offset:45568
v_mfma_f32_16x16x32_bf16 v[80:83], v[240:243], v[168:171], v[80:83]
buffer_load_dwordx4 v[200:203], v39, s[32:35], s57 offen offset:1024 sc1
v_mfma_f32_16x16x32_bf16 v[68:71], v[244:247], v[164:167], v[68:71]
ds_read_b64_tr_b16 v[228:229], v16 offset:45056
ds_read_b64_tr_b16 v[230:231], v16 offset:45568
v_mfma_f32_16x16x32_bf16 v[84:87], v[244:247], v[168:171], v[84:87]
ds_read_b64_tr_b16 v[232:233], v17 offset:45056
ds_read_b64_tr_b16 v[234:235], v17 offset:45568
v_mfma_f32_16x16x32_bf16 v[72:75], v[248:251], v[164:167], v[72:75]
s_add_u32 s57, s57, 2048
s_and_b32 s57, s57, 0x7fff
v_mfma_f32_16x16x32_bf16 v[88:91], v[248:251], v[168:171], v[88:91]
s_waitcnt vmcnt(6) lgkmcnt(8)
v_mfma_f32_16x16x32_bf16 v[60:63], v[100:103], v[172:175], v[60:63]
buffer_load_dwordx4 v[204:207], v38, s[32:35], s57 offen sc1
v_mfma_f32_16x16x32_bf16 v[76:79], v[100:103], v[176:179], v[76:79]
ds_read_b64_tr_b16 v[236:237], v14 offset:49152
ds_read_b64_tr_b16 v[238:239], v14 offset:49664
v_mfma_f32_16x16x32_bf16 v[64:67], v[104:107], v[172:175], v[64:67]
ds_read_b64_tr_b16 v[240:241], v15 offset:49152
ds_read_b64_tr_b16 v[242:243], v15 offset:49664
v_mfma_f32_16x16x32_bf16 v[80:83], v[104:107], v[176:179], v[80:83]
buffer_load_dwordx4 v[208:211], v39, s[32:35], s57 offen sc1
v_mfma_f32_16x16x32_bf16 v[68:71], v[108:111], v[172:175], v[68:71]
ds_read_b64_tr_b16 v[244:245], v16 offset:49152
ds_read_b64_tr_b16 v[246:247], v16 offset:49664
v_mfma_f32_16x16x32_bf16 v[84:87], v[108:111], v[176:179], v[84:87]
ds_read_b64_tr_b16 v[248:249], v17 offset:49152
ds_read_b64_tr_b16 v[250:251], v17 offset:49664
v_mfma_f32_16x16x32_bf16 v[72:75], v[112:115], v[172:175], v[72:75]
v_mfma_f32_16x16x32_bf16 v[88:91], v[112:115], v[176:179], v[88:91]
s_waitcnt vmcnt(6) lgkmcnt(8)
v_mfma_f32_16x16x32_bf16 v[60:63], v[220:223], v[180:183], v[60:63]
buffer_load_dwordx4 v[212:215], v38, s[32:35], s57 offen offset:1024 sc1
v_mfma_f32_16x16x32_bf16 v[76:79], v[220:223], v[184:187], v[76:79]
ds_read_b64_tr_b16 v[100:101], v14 offset:53248
ds_read_b64_tr_b16 v[102:103], v14 offset:53760
v_mfma_f32_16x16x32_bf16 v[64:67], v[224:227], v[180:183], v[64:67]
ds_read_b64_tr_b16 v[104:105], v15 offset:53248
ds_read_b64_tr_b16 v[106:107], v15 offset:53760
v_mfma_f32_16x16x32_bf16 v[80:83], v[224:227], v[184:187], v[80:83]
buffer_load_dwordx4 v[216:219], v39, s[32:35], s57 offen offset:1024 sc1
v_mfma_f32_16x16x32_bf16 v[68:71], v[228:231], v[180:183], v[68:71]
ds_read_b64_tr_b16 v[108:109], v16 offset:53248
ds_read_b64_tr_b16 v[110:111], v16 offset:53760
v_mfma_f32_16x16x32_bf16 v[84:87], v[228:231], v[184:187], v[84:87]
ds_read_b64_tr_b16 v[112:113], v17 offset:53248
ds_read_b64_tr_b16 v[114:115], v17 offset:53760
v_mfma_f32_16x16x32_bf16 v[72:75], v[232:235], v[180:183], v[72:75]
v_mfma_f32_16x16x32_bf16 v[88:91], v[232:235], v[184:187], v[88:91]
s_waitcnt vmcnt(6) lgkmcnt(8)
v_mfma_f32_16x16x32_bf16 v[60:63], v[236:239], v[188:191], v[60:63]
v_mfma_f32_16x16x32_bf16 v[76:79], v[236:239], v[192:195], v[76:79]
ds_read_b64_tr_b16 v[220:221], v14 offset:57344
ds_read_b64_tr_b16 v[222:223], v14 offset:57856
v_mfma_f32_16x16x32_bf16 v[64:67], v[240:243], v[188:191], v[64:67]
ds_read_b64_tr_b16 v[224:225], v15 offset:57344
ds_read_b64_tr_b16 v[226:227], v15 offset:57856
v_mfma_f32_16x16x32_bf16 v[80:83], v[240:243], v[192:195], v[80:83]
v_mfma_f32_16x16x32_bf16 v[68:71], v[244:247], v[188:191], v[68:71]
ds_read_b64_tr_b16 v[228:229], v16 offset:57344
ds_read_b64_tr_b16 v[230:231], v16 offset:57856
v_mfma_f32_16x16x32_bf16 v[84:87], v[244:247], v[192:195], v[84:87]
ds_read_b64_tr_b16 v[232:233], v17 offset:57344
ds_read_b64_tr_b16 v[234:235], v17 offset:57856
v_mfma_f32_16x16x32_bf16 v[72:75], v[248:251], v[188:191], v[72:75]
v_mfma_f32_16x16x32_bf16 v[88:91], v[248:251], v[192:195], v[88:91]
s_waitcnt vmcnt(4) lgkmcnt(8)
v_mfma_f32_16x16x32_bf16 v[60:63], v[100:103], v[196:199], v[60:63]
v_mfma_f32_16x16x32_bf16 v[76:79], v[100:103], v[200:203], v[76:79]
ds_read_b64_tr_b16 v[236:237], v14 offset:61440
ds_read_b64_tr_b16 v[238:239], v14 offset:61952
v_mfma_f32_16x16x32_bf16 v[64:67], v[104:107], v[196:199], v[64:67]
ds_read_b64_tr_b16 v[240:241], v15 offset:61440
ds_read_b64_tr_b16 v[242:243], v15 offset:61952
v_mfma_f32_16x16x32_bf16 v[80:83], v[104:107], v[200:203], v[80:83]
v_mfma_f32_16x16x32_bf16 v[68:71], v[108:111], v[196:199], v[68:71]
ds_read_b64_tr_b16 v[244:245], v16 offset:61440
ds_read_b64_tr_b16 v[246:247], v16 offset:61952
v_mfma_f32_16x16x32_bf16 v[84:87], v[108:111], v[200:203], v[84:87]
ds_read_b64_tr_b16 v[248:249], v17 offset:61440
ds_read_b64_tr_b16 v[250:251], v17 offset:61952
v_mfma_f32_16x16x32_bf16 v[72:75], v[112:115], v[196:199], v[72:75]
v_mfma_f32_16x16x32_bf16 v[88:91], v[112:115], v[200:203], v[88:91]
s_waitcnt vmcnt(2) lgkmcnt(8)
v_mfma_f32_16x16x32_bf16 v[60:63], v[220:223], v[204:207], v[60:63]
v_mfma_f32_16x16x32_bf16 v[76:79], v[220:223], v[208:211], v[76:79]
v_mfma_f32_16x16x32_bf16 v[64:67], v[224:227], v[204:207], v[64:67]
v_mfma_f32_16x16x32_bf16 v[80:83], v[224:227], v[208:211], v[80:83]
v_mfma_f32_16x16x32_bf16 v[68:71], v[228:231], v[204:207], v[68:71]
v_mfma_f32_16x16x32_bf16 v[84:87], v[228:231], v[208:211], v[84:87]
v_mfma_f32_16x16x32_bf16 v[72:75], v[232:235], v[204:207], v[72:75]
v_mfma_f32_16x16x32_bf16 v[88:91], v[232:235], v[208:211], v[88:91]
s_waitcnt vmcnt(0) lgkmcnt(0)
v_mfma_f32_16x16x32_bf16 v[60:63], v[236:239], v[212:215], v[60:63]
v_mfma_f32_16x16x32_bf16 v[64:67], v[240:243], v[212:215], v[64:67]
v_mfma_f32_16x16x32_bf16 v[68:71], v[244:247], v[212:215], v[68:71]
v_mfma_f32_16x16x32_bf16 v[72:75], v[248:251], v[212:215], v[72:75]
v_mfma_f32_16x16x32_bf16 v[76:79], v[236:239], v[216:219], v[76:79]
v_mfma_f32_16x16x32_bf16 v[80:83], v[240:243], v[216:219], v[80:83]
v_mfma_f32_16x16x32_bf16 v[84:87], v[244:247], v[216:219], v[84:87]
v_mfma_f32_16x16x32_bf16 v[88:91], v[248:251], v[216:219], v[88:91]
s_cmp_eq_u32 s46, 0
s_cbranch_scc1 slow_88
s_nop 0
v_cvt_pk_bf16_f32 v20, v60, v61
v_cvt_pk_bf16_f32 v21, v62, v63
v_cvt_pk_bf16_f32 v22, v64, v65
v_cvt_pk_bf16_f32 v23, v66, v67
buffer_store_dwordx4 v[20:23], v18, s[32:35], s85 offen offset:0
v_cvt_pk_bf16_f32 v24, v68, v69
v_cvt_pk_bf16_f32 v25, v70, v71
v_cvt_pk_bf16_f32 v26, v72, v73
v_cvt_pk_bf16_f32 v27, v74, v75
buffer_store_dwordx4 v[24:27], v18, s[32:35], s85 offen offset:1024
v_cvt_pk_bf16_f32 v28, v76, v77
v_cvt_pk_bf16_f32 v29, v78, v79
v_cvt_pk_bf16_f32 v30, v80, v81
v_cvt_pk_bf16_f32 v31, v82, v83
buffer_store_dwordx4 v[28:31], v18, s[32:35], s86 offen offset:0
v_cvt_pk_bf16_f32 v32, v84, v85
v_cvt_pk_bf16_f32 v33, v86, v87
v_cvt_pk_bf16_f32 v34, v88, v89
v_cvt_pk_bf16_f32 v35, v90, v91
buffer_store_dwordx4 v[32:35], v18, s[32:35], s86 offen offset:1024
s_barrier
v_dot2c_f32_bf16 v6, v20, v48
v_dot2c_f32_bf16 v8, v20, v20
v_dot2c_f32_bf16 v7, v28, v48
v_dot2c_f32_bf16 v9, v28, v28
v_dot2c_f32_bf16 v6, v21, v48
v_dot2c_f32_bf16 v8, v21, v21
v_dot2c_f32_bf16 v7, v29, v48
v_dot2c_f32_bf16 v9, v29, v29
v_dot2c_f32_bf16 v6, v22, v48
v_dot2c_f32_bf16 v8, v22, v22
v_dot2c_f32_bf16 v7, v30, v48
v_dot2c_f32_bf16 v9, v30, v30
v_dot2c_f32_bf16 v6, v23, v48
v_dot2c_f32_bf16 v8, v23, v23
v_dot2c_f32_bf16 v7, v31, v48
v_dot2c_f32_bf16 v9, v31, v31
v_dot2c_f32_bf16 v6, v24, v48
v_dot2c_f32_bf16 v8, v24, v24
v_dot2c_f32_bf16 v7, v32, v48
v_dot2c_f32_bf16 v9, v32, v32
v_dot2c_f32_bf16 v6, v25, v48
v_dot2c_f32_bf16 v8, v25, v25
v_dot2c_f32_bf16 v7, v33, v48
v_dot2c_f32_bf16 v9, v33, v33
v_dot2c_f32_bf16 v6, v26, v48
v_dot2c_f32_bf16 v8, v26, v26
v_dot2c_f32_bf16 v7, v34, v48
v_dot2c_f32_bf16 v9, v34, v34
v_dot2c_f32_bf16 v6, v27, v48
v_dot2c_f32_bf16 v8, v27, v27
v_dot2c_f32_bf16 v7, v35, v48
v_dot2c_f32_bf16 v9, v35, v35
s_mov_b64 exec, 1
s_waitcnt vmcnt(0)
buffer_store_dword v5, v4, s[32:35], s88 offen
s_mov_b64 exec, -1
s_nop 1
v_permlane32_swap_b32 v6, v7
v_permlane32_swap_b32 v8, v9
v_add_f32 v6, v6, v7
v_add_f32 v8, v8, v9
s_nop 1
v_permlane16_swap_b32 v6, v8
s_nop 0
v_add_f32 v6, v6, v8
buffer_store_dword v6, v1, s[32:35], s87 offen
back_89:
s_lshl_b32 s49, s44, 13
v_add_u32 v10, s49, v18
v_add_u32 v11, 1024, v10
s_lshl_b32 s48, s43, 1
v_lshrrev_b32 v4, 2, v2
v_and_b32 v5, 3, v0
v_lshl_add_u32 v6, v3, 3, v4
v_lshlrev_b32 v6, 7, v6
v_lshl_add_u32 v6, v5, 3, v6
v_lshrrev_b32 v7, 1, v4
v_and_b32 v8, 1, v3
v_lshl_add_u32 v7, v8, 1, v7
v_xor_b32 v7, s48, v7
v_lshl_add_u32 v12, v7, 5, v6
v_add_u32 v12, 16384, v12
v_xor_b32 v13, 32, v12
v_mov_b32 v14, v10
v_mov_b32 v15, v11
v_add_u32 v16, 122880, v12
v_add_u32 v17, 122880, v13
v_mov_b32 v156, 0
v_mov_b32 v157, 0
v_mov_b32 v158, 0
v_mov_b32 v159, 0
v_mov_b32 v160, 0
v_mov_b32 v161, 0
v_mov_b32 v162, 0
v_mov_b32 v163, 0
v_mov_b32 v164, 0
v_mov_b32 v165, 0
v_mov_b32 v166, 0
v_mov_b32 v167, 0
v_mov_b32 v168, 0
v_mov_b32 v169, 0
v_mov_b32 v170, 0
v_mov_b32 v171, 0
v_mov_b32 v172, 0
v_mov_b32 v173, 0
v_mov_b32 v174, 0
v_mov_b32 v175, 0
v_mov_b32 v176, 0
v_mov_b32 v177, 0
v_mov_b32 v178, 0
v_mov_b32 v179, 0
v_mov_b32 v180, 0
v_mov_b32 v181, 0
v_mov_b32 v182, 0
v_mov_b32 v183, 0
v_mov_b32 v184, 0
v_mov_b32 v185, 0
v_mov_b32 v186, 0
v_mov_b32 v187, 0
v_mov_b32 v188, 0
v_mov_b32 v189, 0
v_mov_b32 v190, 0
v_mov_b32 v191, 0
v_mov_b32 v192, 0
v_mov_b32 v193, 0
v_mov_b32 v194, 0
v_mov_b32 v195, 0
v_mov_b32 v196, 0
v_mov_b32 v197, 0
v_mov_b32 v198, 0
v_mov_b32 v199, 0
v_mov_b32 v200, 0
v_mov_b32 v201, 0
v_mov_b32 v202, 0
v_mov_b32 v203, 0
v_mov_b32 v204, 0
v_mov_b32 v205, 0
v_mov_b32 v206, 0
v_mov_b32 v207, 0
v_mov_b32 v208, 0
v_mov_b32 v209, 0
v_mov_b32 v210, 0
v_mov_b32 v211, 0
v_mov_b32 v212, 0
v_mov_b32 v213, 0
v_mov_b32 v214, 0
v_mov_b32 v215, 0
v_mov_b32 v216, 0
v_mov_b32 v217, 0
v_mov_b32 v218, 0
v_mov_b32 v219, 0
v_mov_b32 v220, 0
v_mov_b32 v221, 0
v_mov_b32 v222, 0
v_mov_b32 v223, 0
v_mov_b32 v224, 0
v_mov_b32 v225, 0
v_mov_b32 v226, 0
v_mov_b32 v227, 0
v_mov_b32 v228, 0
v_mov_b32 v229, 0
v_mov_b32 v230, 0
v_mov_b32 v231, 0
v_mov_b32 v232, 0
v_mov_b32 v233, 0
v_mov_b32 v234, 0
v_mov_b32 v235, 0
v_mov_b32 v236, 0
v_mov_b32 v237, 0
v_mov_b32 v238, 0
v_mov_b32 v239, 0
v_mov_b32 v240, 0
v_mov_b32 v241, 0
v_mov_b32 v242, 0
v_mov_b32 v243, 0
v_mov_b32 v244, 0
v_mov_b32 v245, 0
v_mov_b32 v246, 0
v_mov_b32 v247, 0
v_mov_b32 v248, 0
v_mov_b32 v249, 0
v_mov_b32 v250, 0
v_mov_b32 v251, 0
v_lshrrev_b32 v6, 2, v2
v_cmp_eq_u32 vcc, v6, v3
v_and_b32 v7, 1, v0
v_lshlrev_b32 v7, 4, v7
v_mov_b32 v8, 0x3f80
v_lshlrev_b32 v9, v7, v8
v_cndmask_b32 v7, 0, v9, vcc
v_and_b32 v6, 2, v0
v_cmp_eq_u32 vcc, 0, v6
v_mov_b32 v36, 0
v_mov_b32 v37, 0
v_mov_b32 v40, 0
v_mov_b32 v41, 0
v_cndmask_b32 v38, 0, v7, vcc
v_cndmask_b32 v39, v7, 0, vcc
v_lshrrev_b32 v8, 1, v2
v_cmp_eq_u32 vcc, 0, v8
s_nop 1
v_cndmask_b32 v44, 0, v9, vcc
v_cmp_eq_u32 vcc, 1, v8
s_nop 1
v_cndmask_b32 v45, 0, v9, vcc
v_cmp_eq_u32 vcc, 2, v8
s_nop 1
v_cndmask_b32 v46, 0, v9, vcc
v_cmp_eq_u32 vcc, 3, v8
s_nop 1
v_cndmask_b32 v47, 0, v9, vcc
v_lshrrev_b32 v4, 2, v2
v_lshl_add_u32 v4, v3, 2, v4
v_lshlrev_b32 v4, 6, v4
v_and_b32 v5, 3, v0
v_lshl_add_u32 v4, v5, 3, v4
s_lshl_b32 s48, s43, 11
s_add_u32 s48, s48, 135168
v_add_u32 v53, s48, v4
s_mul_i32 s48, s40, 3072
s_add_u32 s48, s48, 139264
v_add_u32 v42, s48, v18
s_xor_b32 s49, s40, 2
s_mul_i32 s48, s49, 3072
s_add_u32 s48, s48, 139264
v_add_u32 v43, s48, v18
s_lshl_b32 s49, s49, 2
s_add_u32 s49, s49, 134672
v_mov_b32 v19, s49
v_xor_b32 v52, 8, v19
v_lshrrev_b32 v4, 3, v0
v_and_b32 v5, 7, v0
v_lshlrev_b32 v4, 11, v4
v_lshl_add_u32 v55, v5, 4, v4
v_lshlrev_b32 v4, 6, v2
v_lshl_add_u32 v58, v3, 4, v4
v_lshlrev_b32 v4, 4, v2
v_lshl_add_u32 v59, v3, 3, v4
s_mul_i32 s51, s42, 393216
s_add_u32 s51, s51, 9437184
s_lshl_b32 s50, s43, 1
s_add_u32 s50, s50, s44
s_lshl_b32 s48, s50, 15
s_add_u32 s48, s48, s51
s_add_u32 s48, s48, 131072
s_lshl_b32 s49, s41, 7
s_add_u32 s53, s48, s49
s_add_u32 s54, s53, 16384
s_lshl_b32 s56, s50, 10
s_add_u32 s56, s56, s51
s_add_u32 s56, s56, 348160
s_xor_b32 s57, s56, 1024
s_lshl_b32 s58, s50, 11
s_add_u32 s58, s58, s51
s_add_u32 s58, s58, 335872
s_xor_b32 s59, s58, 2048
s_add_u32 s79, s58, s49
s_lshl_b32 s50, s41, 11
s_add_u32 s55, s48, s50
s_lshl_b32 s48, s43, 7
s_add_u32 s48, s48, 133888
v_lshl_add_u32 v7, v3, 4, s48
v_lshl_add_u32 v54, v2, 2, s48
s_lshl_b32 s49, s44, 6
v_add_u32 v8, s49, v2
v_lshlrev_b32 v8, 3, v8
v_add_u32 v8, 131072, v8
v_lshl_add_u32 v9, v3, 2, s49
v_lshlrev_b32 v9, 2, v9
v_add_u32 v9, 132096, v9
s_mov_b32 s64, 0
s_mov_b32 s65, 0
s_mov_b32 s66, 0x3fb8aa3b
s_barrier
ds_read_b128 v[60:63], v14 offset:0
ds_read_b128 v[64:67], v14 offset:2048
ds_read_b128 v[68:71], v14 offset:4096
ds_read_b128 v[72:75], v14 offset:6144
ds_read_b64_tr_b16 v[84:85], v16 offset:8192
ds_read_b64_tr_b16 v[86:87], v16 offset:8704
ds_read_b64_tr_b16 v[88:89], v17 offset:8192
ds_read_b64_tr_b16 v[90:91], v17 offset:8704
ds_read_b64_tr_b16 v[92:93], v16 offset:16384
ds_read_b64_tr_b16 v[94:95], v16 offset:16896
ds_read_b64_tr_b16 v[96:97], v17 offset:16384
ds_read_b64_tr_b16 v[98:99], v17 offset:16896
ds_read_b64_tr_b16 v[76:77], v16 offset:0
ds_read_b64_tr_b16 v[78:79], v16 offset:512
ds_read_b64_tr_b16 v[80:81], v17 offset:0
ds_read_b64_tr_b16 v[82:83], v17 offset:512
s_waitcnt lgkmcnt(0)
c3_loop:
v_mfma_f32_16x16x32_bf16 v[212:215], v[84:87], v[72:75], v[212:215]
ds_read_b128 v[100:103], v15 offset:0
v_mfma_f32_16x16x32_bf16 v[204:207], v[84:87], v[68:71], v[204:207]
ds_read_b128 v[104:107], v15 offset:2048
v_mfma_f32_16x16x32_bf16 v[196:199], v[84:87], v[64:67], v[196:199]
ds_read_b128 v[108:111], v15 offset:4096
v_mfma_f32_16x16x32_bf16 v[188:191], v[84:87], v[60:63], v[188:191]
ds_read_b128 v[112:115], v15 offset:6144
v_mfma_f32_16x16x32_bf16 v[192:195], v[88:91], v[60:63], v[192:195]
ds_read_b64_tr_b16 v[124:125], v16 offset:12288
v_mfma_f32_16x16x32_bf16 v[200:203], v[88:91], v[64:67], v[200:203]
ds_read_b64_tr_b16 v[126:127], v16 offset:12800
v_mfma_f32_16x16x32_bf16 v[208:211], v[88:91], v[68:71], v[208:211]
ds_read_b64_tr_b16 v[128:129], v17 offset:12288
v_mfma_f32_16x16x32_bf16 v[216:219], v[88:91], v[72:75], v[216:219]
ds_read_b64_tr_b16 v[130:131], v17 offset:12800
v_mfma_f32_16x16x32_bf16 v[244:247], v[72:75], v[92:95], v[244:247]
ds_read_b64_tr_b16 v[132:133], v16 offset:20480
v_mfma_f32_16x16x32_bf16 v[236:239], v[68:71], v[92:95], v[236:239]
ds_read_b64_tr_b16 v[134:135], v16 offset:20992
v_mfma_f32_16x16x32_bf16 v[228:231], v[64:67], v[92:95], v[228:231]
ds_read_b64_tr_b16 v[136:137], v17 offset:20480
v_mfma_f32_16x16x32_bf16 v[220:223], v[60:63], v[92:95], v[220:223]
ds_read_b64_tr_b16 v[138:139], v17 offset:20992
v_mfma_f32_16x16x32_bf16 v[224:227], v[60:63], v[96:99], v[224:227]
ds_read_b64_tr_b16 v[116:117], v16 offset:4096
v_mfma_f32_16x16x32_bf16 v[232:235], v[64:67], v[96:99], v[232:235]
ds_read_b64_tr_b16 v[118:119], v16 offset:4608
v_mfma_f32_16x16x32_bf16 v[240:243], v[68:71], v[96:99], v[240:243]
ds_read_b64_tr_b16 v[120:121], v17 offset:4096
v_mfma_f32_16x16x32_bf16 v[248:251], v[72:75], v[96:99], v[248:251]
ds_read_b64_tr_b16 v[122:123], v17 offset:4608
v_mfma_f32_16x16x32_bf16 v[180:183], v[76:79], v[72:75], v[180:183]
s_add_u32 s65, s65, 40960
s_cmp_eq_u32 s65, 122880
v_mfma_f32_16x16x32_bf16 v[172:175], v[76:79], v[68:71], v[172:175]
s_cselect_b32 s65, 0, s65
s_add_u32 s64, s64, 1
v_mfma_f32_16x16x32_bf16 v[164:167], v[76:79], v[64:67], v[164:167]
v_add_u32 v14, s65, v10
v_add_u32 v15, s65, v11
v_mfma_f32_16x16x32_bf16 v[156:159], v[76:79], v[60:63], v[156:159]
v_add_u32 v16, s65, v12
v_add_u32 v17, s65, v13
v_mfma_f32_16x16x32_bf16 v[160:163], v[80:83], v[60:63], v[160:163]
v_mfma_f32_16x16x32_bf16 v[168:171], v[80:83], v[64:67], v[168:171]
s_cmp_eq_u32 s64, 16
s_cbranch_scc1 c3_last
v_mfma_f32_16x16x32_bf16 v[176:179], v[80:83], v[68:71], v[176:179]
s_waitcnt lgkmcnt(0)
v_mfma_f32_16x16x32_bf16 v[184:187], v[80:83], v[72:75], v[184:187]
s_barrier
v_mfma_f32_16x16x32_bf16 v[212:215], v[124:127], v[112:115], v[212:215]
ds_read_b128 v[60:63], v14 offset:0
v_mfma_f32_16x16x32_bf16 v[204:207], v[124:127], v[108:111], v[204:207]
ds_read_b128 v[64:67], v14 offset:2048
v_mfma_f32_16x16x32_bf16 v[196:199], v[124:127], v[104:107], v[196:199]
ds_read_b128 v[68:71], v14 offset:4096
v_mfma_f32_16x16x32_bf16 v[188:191], v[124:127], v[100:103], v[188:191]
ds_read_b128 v[72:75], v14 offset:6144
v_mfma_f32_16x16x32_bf16 v[192:195], v[128:131], v[100:103], v[192:195]
ds_read_b64_tr_b16 v[84:85], v16 offset:8192
v_mfma_f32_16x16x32_bf16 v[200:203], v[128:131], v[104:107], v[200:203]
ds_read_b64_tr_b16 v[86:87], v16 offset:8704
v_mfma_f32_16x16x32_bf16 v[208:211], v[128:131], v[108:111], v[208:211]
ds_read_b64_tr_b16 v[88:89], v17 offset:8192
v_mfma_f32_16x16x32_bf16 v[216:219], v[128:131], v[112:115], v[216:219]
ds_read_b64_tr_b16 v[90:91], v17 offset:8704
v_mfma_f32_16x16x32_bf16 v[244:247], v[112:115], v[132:135], v[244:247]
ds_read_b64_tr_b16 v[92:93], v16 offset:16384
v_mfma_f32_16x16x32_bf16 v[236:239], v[108:111], v[132:135], v[236:239]
ds_read_b64_tr_b16 v[94:95], v16 offset:16896
v_mfma_f32_16x16x32_bf16 v[228:231], v[104:107], v[132:135], v[228:231]
ds_read_b64_tr_b16 v[96:97], v17 offset:16384
v_mfma_f32_16x16x32_bf16 v[220:223], v[100:103], v[132:135], v[220:223]
ds_read_b64_tr_b16 v[98:99], v17 offset:16896
v_mfma_f32_16x16x32_bf16 v[224:227], v[100:103], v[136:139], v[224:227]
ds_read_b64_tr_b16 v[76:77], v16 offset:0
v_mfma_f32_16x16x32_bf16 v[232:235], v[104:107], v[136:139], v[232:235]
ds_read_b64_tr_b16 v[78:79], v16 offset:512
v_mfma_f32_16x16x32_bf16 v[240:243], v[108:111], v[136:139], v[240:243]
ds_read_b64_tr_b16 v[80:81], v17 offset:0
v_mfma_f32_16x16x32_bf16 v[248:251], v[112:115], v[136:139], v[248:251]
ds_read_b64_tr_b16 v[82:83], v17 offset:512
v_mfma_f32_16x16x32_bf16 v[180:183], v[116:119], v[112:115], v[180:183]
v_mfma_f32_16x16x32_bf16 v[172:175], v[116:119], v[108:111], v[172:175]
v_mfma_f32_16x16x32_bf16 v[164:167], v[116:119], v[104:107], v[164:167]
v_mfma_f32_16x16x32_bf16 v[156:159], v[116:119], v[100:103], v[156:159]
v_mfma_f32_16x16x32_bf16 v[160:163], v[120:123], v[100:103], v[160:163]
v_mfma_f32_16x16x32_bf16 v[168:171], v[120:123], v[104:107], v[168:171]
v_mfma_f32_16x16x32_bf16 v[176:179], v[120:123], v[108:111], v[176:179]
s_waitcnt lgkmcnt(0)
v_mfma_f32_16x16x32_bf16 v[184:187], v[120:123], v[112:115], v[184:187]
s_branch c3_loop
c3_last:
v_mfma_f32_16x16x32_bf16 v[176:179], v[80:83], v[68:71], v[176:179]
s_waitcnt lgkmcnt(0)
v_mfma_f32_16x16x32_bf16 v[184:187], v[80:83], v[72:75], v[184:187]
s_barrier
v_mfma_f32_16x16x32_bf16 v[212:215], v[124:127], v[112:115], v[212:215]
ds_read_b128 v[140:143], v7 offset:0
v_mfma_f32_16x16x32_bf16 v[204:207], v[124:127], v[108:111], v[204:207]
ds_read_b128 v[144:147], v7 offset:64
v_mfma_f32_16x16x32_bf16 v[196:199], v[124:127], v[104:107], v[196:199]
ds_read_b128 v[148:151], v7 offset:256
v_mfma_f32_16x16x32_bf16 v[188:191], v[124:127], v[100:103], v[188:191]
ds_read_b128 v[152:155], v7 offset:320
v_mfma_f32_16x16x32_bf16 v[192:195], v[128:131], v[100:103], v[192:195]
ds_read_b64 v[92:93], v8 offset:0
v_mfma_f32_16x16x32_bf16 v[200:203], v[128:131], v[104:107], v[200:203]
ds_read_b64 v[94:95], v8 offset:128
v_mfma_f32_16x16x32_bf16 v[208:211], v[128:131], v[108:111], v[208:211]
ds_read_b64 v[96:97], v8 offset:256
v_mfma_f32_16x16x32_bf16 v[216:219], v[128:131], v[112:115], v[216:219]
ds_read_b64 v[98:99], v8 offset:384
v_mfma_f32_16x16x32_bf16 v[244:247], v[112:115], v[132:135], v[244:247]
ds_read2_b32 v[56:57], v54 offset0:128 offset1:144
v_mfma_f32_16x16x32_bf16 v[236:239], v[108:111], v[132:135], v[236:239]
ds_read_b128 v[60:63], v9 offset:0
v_mfma_f32_16x16x32_bf16 v[228:231], v[104:107], v[132:135], v[228:231]
ds_read_b128 v[64:67], v9 offset:64
v_mfma_f32_16x16x32_bf16 v[220:223], v[100:103], v[132:135], v[220:223]
ds_read_b128 v[68:71], v9 offset:128
v_mfma_f32_16x16x32_bf16 v[224:227], v[100:103], v[136:139], v[224:227]
ds_read_b128 v[72:75], v9 offset:192
v_mfma_f32_16x16x32_bf16 v[232:235], v[104:107], v[136:139], v[232:235]
ds_read_b128 v[76:79], v9 offset:512
v_mfma_f32_16x16x32_bf16 v[240:243], v[108:111], v[136:139], v[240:243]
ds_read_b128 v[80:83], v9 offset:576
v_mfma_f32_16x16x32_bf16 v[248:251], v[112:115], v[136:139], v[248:251]
ds_read_b128 v[84:87], v9 offset:640
v_mfma_f32_16x16x32_bf16 v[180:183], v[116:119], v[112:115], v[180:183]
ds_read_b128 v[88:91], v9 offset:704
v_mfma_f32_16x16x32_bf16 v[172:175], v[116:119], v[108:111], v[172:175]
ds_read_b64_tr_b16 v[10:11], v53 offset:0
v_mfma_f32_16x16x32_bf16 v[164:167], v[116:119], v[104:107], v[164:167]
ds_read_b64_tr_b16 v[12:13], v53 offset:1024
v_mfma_f32_16x16x32_bf16 v[156:159], v[116:119], v[100:103], v[156:159]
ds_read_b64_tr_b16 v[14:15], v53 offset:32
v_mfma_f32_16x16x32_bf16 v[160:163], v[120:123], v[100:103], v[160:163]
ds_read_b64_tr_b16 v[16:17], v53 offset:1056
v_mfma_f32_16x16x32_bf16 v[168:171], v[120:123], v[104:107], v[168:171]
v_mfma_f32_16x16x32_bf16 v[176:179], v[120:123], v[108:111], v[176:179]
v_mfma_f32_16x16x32_bf16 v[184:187], v[120:123], v[112:115], v[184:187]
c3_epi:
s_waitcnt lgkmcnt(0)
s_mul_i32 s48, s44, 0x80008000
v_xor_b32 v10, s48, v10
v_xor_b32 v11, s48, v11
v_xor_b32 v12, s48, v12
v_xor_b32 v13, s48, v13
v_xor_b32 v14, s48, v14
v_xor_b32 v15, s48, v15
v_xor_b32 v16, s48, v16
v_xor_b32 v17, s48, v17
v_mul_f32 v128, s66, v92
v_mul_f32 v129, s66, v94
v_mul_f32 v130, s66, v96
v_mul_f32 v131, s66, v98
.p2align 3
v_pk_fma_f32 v[220:221], v[76:77], v[56:57], v[220:221] op_sel:[0,0,0] op_sel_hi:[1,0,1]
v_pk_fma_f32 v[222:223], v[78:79], v[56:57], v[222:223] op_sel:[0,0,0] op_sel_hi:[1,0,1]
v_pk_mul_f32 v[220:221], v[220:221], v[60:61]
v_pk_mul_f32 v[222:223], v[222:223], v[62:63]
v_cvt_pk_bf16_f32 v112, v220, v221
v_cvt_pk_bf16_f32 v113, v222, v223
v_pk_fma_f32 v[228:229], v[80:81], v[56:57], v[228:229] op_sel:[0,0,0] op_sel_hi:[1,0,1]
v_pk_fma_f32 v[230:231], v[82:83], v[56:57], v[230:231] op_sel:[0,0,0] op_sel_hi:[1,0,1]
v_pk_mul_f32 v[228:229], v[228:229], v[64:65]
v_pk_mul_f32 v[230:231], v[230:231], v[66:67]
v_cvt_pk_bf16_f32 v114, v228, v229
v_cvt_pk_bf16_f32 v115, v230, v231
v_pk_fma_f32 v[236:237], v[84:85], v[56:57], v[236:237] op_sel:[0,0,0] op_sel_hi:[1,0,1]
v_pk_fma_f32 v[238:239], v[86:87], v[56:57], v[238:239] op_sel:[0,0,0] op_sel_hi:[1,0,1]
v_pk_mul_f32 v[236:237], v[236:237], v[68:69]
v_pk_mul_f32 v[238:239], v[238:239], v[70:71]
v_cvt_pk_bf16_f32 v116, v236, v237
v_cvt_pk_bf16_f32 v117, v238, v239
v_pk_fma_f32 v[244:245], v[88:89], v[56:57], v[244:245] op_sel:[0,0,0] op_sel_hi:[1,0,1]
v_pk_fma_f32 v[246:247], v[90:91], v[56:57], v[246:247] op_sel:[0,0,0] op_sel_hi:[1,0,1]
v_pk_mul_f32 v[244:245], v[244:245], v[72:73]
v_pk_mul_f32 v[246:247], v[246:247], v[74:75]
v_cvt_pk_bf16_f32 v118, v244, v245
v_cvt_pk_bf16_f32 v119, v246, v247
v_pk_fma_f32 v[224:225], v[76:77], v[56:57], v[224:225] op_sel:[0,1,0] op_sel_hi:[1,1,1]
v_pk_fma_f32 v[226:227], v[78:79], v[56:57], v[226:227] op_sel:[0,1,0] op_sel_hi:[1,1,1]
v_pk_mul_f32 v[224:225], v[224:225], v[60:61]
v_pk_mul_f32 v[226:227], v[226:227], v[62:63]
v_cvt_pk_bf16_f32 v120, v224, v225
v_cvt_pk_bf16_f32 v121, v226, v227
v_pk_fma_f32 v[232:233], v[80:81], v[56:57], v[232:233] op_sel:[0,1,0] op_sel_hi:[1,1,1]
v_pk_fma_f32 v[234:235], v[82:83], v[56:57], v[234:235] op_sel:[0,1,0] op_sel_hi:[1,1,1]
v_pk_mul_f32 v[232:233], v[232:233], v[64:65]
v_pk_mul_f32 v[234:235], v[234:235], v[66:67]
v_cvt_pk_bf16_f32 v122, v232, v233
v_cvt_pk_bf16_f32 v123, v234, v235
v_pk_fma_f32 v[240:241], v[84:85], v[56:57], v[240:241] op_sel:[0,1,0] op_sel_hi:[1,1,1]
v_pk_fma_f32 v[242:243], v[86:87], v[56:57], v[242:243] op_sel:[0,1,0] op_sel_hi:[1,1,1]
v_pk_mul_f32 v[240:241], v[240:241], v[68:69]
v_pk_mul_f32 v[242:243], v[242:243], v[70:71]
v_cvt_pk_bf16_f32 v124, v240, v241
v_cvt_pk_bf16_f32 v125, v242, v243
v_pk_fma_f32 v[248:249], v[88:89], v[56:57], v[248:249] op_sel:[0,1,0] op_sel_hi:[1,1,1]
v_pk_fma_f32 v[250:251], v[90:91], v[56:57], v[250:251] op_sel:[0,1,0] op_sel_hi:[1,1,1]
v_pk_mul_f32 v[248:249], v[248:249], v[72:73]
v_pk_mul_f32 v[250:251], v[250:251], v[74:75]
v_cvt_pk_bf16_f32 v126, v248, v249
v_cvt_pk_bf16_f32 v127, v250, v251
v_pk_fma_f32 v[188:189], v[148:149], v[92:93], v[188:189] op_sel:[0,1,0] op_sel_hi:[1,1,1]
v_pk_fma_f32 v[190:191], v[150:151], v[92:93], v[190:191] op_sel:[0,1,0] op_sel_hi:[1,1,1]
v_pk_fma_f32 v[192:193], v[152:153], v[92:93], v[192:193] op_sel:[0,1,0] op_sel_hi:[1,1,1]
v_pk_fma_f32 v[194:195], v[154:155], v[92:93], v[194:195] op_sel:[0,1,0] op_sel_hi:[1,1,1]
v_cvt_pk_bf16_f32 v188, v188, v189
v_cvt_pk_bf16_f32 v189, v190, v191
v_cvt_pk_bf16_f32 v190, v192, v193
v_cvt_pk_bf16_f32 v191, v194, v195
v_pk_fma_f32 v[196:197], v[148:149], v[94:95], v[196:197] op_sel:[0,1,0] op_sel_hi:[1,1,1]
v_pk_fma_f32 v[198:199], v[150:151], v[94:95], v[198:199] op_sel:[0,1,0] op_sel_hi:[1,1,1]
v_pk_fma_f32 v[200:201], v[152:153], v[94:95], v[200:201] op_sel:[0,1,0] op_sel_hi:[1,1,1]
v_pk_fma_f32 v[202:203], v[154:155], v[94:95], v[202:203] op_sel:[0,1,0] op_sel_hi:[1,1,1]
v_cvt_pk_bf16_f32 v196, v196, v197
v_mfma_f32_16x16x32_bf16 v[60:63], v[10:13], v[188:191], 0
v_cvt_pk_bf16_f32 v197, v198, v199
v_cvt_pk_bf16_f32 v198, v200, v201
v_mfma_f32_16x16x32_bf16 v[64:67], v[14:17], v[188:191], 0
v_cvt_pk_bf16_f32 v199, v202, v203
v_pk_fma_f32 v[204:205], v[148:149], v[96:97], v[204:205] op_sel:[0,1,0] op_sel_hi:[1,1,1]
v_pk_fma_f32 v[206:207], v[150:151], v[96:97], v[206:207] op_sel:[0,1,0] op_sel_hi:[1,1,1]
v_pk_fma_f32 v[208:209], v[152:153], v[96:97], v[208:209] op_sel:[0,1,0] op_sel_hi:[1,1,1]
v_pk_fma_f32 v[210:211], v[154:155], v[96:97], v[210:211] op_sel:[0,1,0] op_sel_hi:[1,1,1]
v_cvt_pk_bf16_f32 v204, v204, v205
v_mfma_f32_16x16x32_bf16 v[68:71], v[10:13], v[196:199], 0
v_cvt_pk_bf16_f32 v205, v206, v207
v_cvt_pk_bf16_f32 v206, v208, v209
v_mfma_f32_16x16x32_bf16 v[72:75], v[14:17], v[196:199], 0
v_cvt_pk_bf16_f32 v207, v210, v211
v_pk_fma_f32 v[212:213], v[148:149], v[98:99], v[212:213] op_sel:[0,1,0] op_sel_hi:[1,1,1]
v_pk_fma_f32 v[214:215], v[150:151], v[98:99], v[214:215] op_sel:[0,1,0] op_sel_hi:[1,1,1]
v_pk_fma_f32 v[216:217], v[152:153], v[98:99], v[216:217] op_sel:[0,1,0] op_sel_hi:[1,1,1]
v_pk_fma_f32 v[218:219], v[154:155], v[98:99], v[218:219] op_sel:[0,1,0] op_sel_hi:[1,1,1]
v_cvt_pk_bf16_f32 v212, v212, v213
v_mfma_f32_16x16x32_bf16 v[76:79], v[10:13], v[204:207], 0
v_cvt_pk_bf16_f32 v213, v214, v215
v_cvt_pk_bf16_f32 v214, v216, v217
v_mfma_f32_16x16x32_bf16 v[80:83], v[14:17], v[204:207], 0
v_cvt_pk_bf16_f32 v215, v218, v219
s_nop 1
v_mfma_f32_16x16x32_bf16 v[84:87], v[10:13], v[212:215], 0
v_mfma_f32_16x16x32_bf16 v[88:91], v[14:17], v[212:215], 0
v_max3_f32 v100, v60, v61, v62
v_min3_f32 v104, v60, v61, v62
v_max3_f32 v100, v100, v63, v64
v_min3_f32 v104, v104, v63, v64
v_max3_f32 v100, v100, v65, v66
v_min3_f32 v104, v104, v65, v66
v_max_f32 v100, v100, v67
v_min_f32 v104, v104, v67
v_max3_f32 v101, v68, v69, v70
v_min3_f32 v105, v68, v69, v70
v_max3_f32 v101, v101, v71, v72
v_min3_f32 v105, v105, v71, v72
v_max3_f32 v101, v101, v73, v74
v_min3_f32 v105, v105, v73, v74
v_max_f32 v101, v101, v75
v_min_f32 v105, v105, v75
v_max3_f32 v102, v76, v77, v78
v_min3_f32 v106, v76, v77, v78
v_max3_f32 v102, v102, v79, v80
v_min3_f32 v106, v106, v79, v80
v_max3_f32 v102, v102, v81, v82
v_min3_f32 v106, v106, v81, v82
v_max_f32 v102, v102, v83
v_min_f32 v106, v106, v83
v_max3_f32 v103, v84, v85, v86
v_min3_f32 v107, v84, v85, v86
v_max3_f32 v103, v103, v87, v88
v_min3_f32 v107, v107, v87, v88
v_max3_f32 v103, v103, v89, v90
v_min3_f32 v107, v107, v89, v90
v_max_f32 v103, v103, v91
v_min_f32 v107, v107, v91
s_nop 1
v_permlane32_swap_b32 v100, v101
v_permlane32_swap_b32 v102, v103
v_permlane32_swap_b32 v104, v105
v_permlane32_swap_b32 v106, v107
v_max_f32 v100, v100, v101
v_max_f32 v102, v102, v103
v_min_f32 v104, v104, v105
v_min_f32 v106, v106, v107
v_permlane16_swap_b32 v100, v102
s_nop 0
v_permlane16_swap_b32 v104, v106
v_max_f32 v100, v100, v102
v_min_f32 v104, v104, v106
v_mov_b32 v102, v100
v_mov_b32 v106, v104
s_nop 0
v_permlane16_swap_b32 v100, v102
v_permlane16_swap_b32 v104, v106
v_mov_b32 v101, v100
v_mov_b32 v103, v102
v_mov_b32 v105, v104
v_mov_b32 v107, v106
v_permlane32_swap_b32 v100, v101
v_permlane32_swap_b32 v102, v103
v_permlane32_swap_b32 v104, v105
v_permlane32_swap_b32 v106, v107
v_pk_mul_f32 v[100:101], v[100:101], v[128:129]
v_pk_mul_f32 v[102:103], v[102:103], v[130:131]
v_pk_mul_f32 v[104:105], v[104:105], v[128:129]
v_pk_mul_f32 v[106:107], v[106:107], v[130:131]
v_pk_fma_f32 v[220:221], v[60:61], v[128:129], v[104:105] op_sel:[0,0,0] op_sel_hi:[1,0,0] neg_lo:[1,0,0] neg_hi:[1,0,0]
v_pk_fma_f32 v[60:61], v[60:61], v[128:129], v[100:101] op_sel:[0,0,0] op_sel_hi:[1,0,0] neg_lo:[0,0,1] neg_hi:[0,0,1]
v_exp_f32 v220, v220
v_exp_f32 v60, v60
v_exp_f32 v221, v221
v_exp_f32 v61, v61
v_pk_fma_f32 v[222:223], v[62:63], v[128:129], v[104:105] op_sel:[0,0,0] op_sel_hi:[1,0,0] neg_lo:[1,0,0] neg_hi:[1,0,0]
v_pk_fma_f32 v[62:63], v[62:63], v[128:129], v[100:101] op_sel:[0,0,0] op_sel_hi:[1,0,0] neg_lo:[0,0,1] neg_hi:[0,0,1]
v_exp_f32 v222, v222
v_exp_f32 v62, v62
v_exp_f32 v223, v223
v_exp_f32 v63, v63
v_pk_fma_f32 v[224:225], v[64:65], v[128:129], v[104:105] op_sel:[0,0,0] op_sel_hi:[1,0,0] neg_lo:[1,0,0] neg_hi:[1,0,0]
v_pk_fma_f32 v[64:65], v[64:65], v[128:129], v[100:101] op_sel:[0,0,0] op_sel_hi:[1,0,0] neg_lo:[0,0,1] neg_hi:[0,0,1]
v_exp_f32 v224, v224
v_exp_f32 v64, v64
v_exp_f32 v225, v225
v_exp_f32 v65, v65
v_pk_fma_f32 v[226:227], v[66:67], v[128:129], v[104:105] op_sel:[0,0,0] op_sel_hi:[1,0,0] neg_lo:[1,0,0] neg_hi:[1,0,0]
v_pk_fma_f32 v[66:67], v[66:67], v[128:129], v[100:101] op_sel:[0,0,0] op_sel_hi:[1,0,0] neg_lo:[0,0,1] neg_hi:[0,0,1]
v_exp_f32 v226, v226
v_exp_f32 v66, v66
v_exp_f32 v227, v227
v_exp_f32 v67, v67
v_pk_fma_f32 v[228:229], v[68:69], v[128:129], v[104:105] op_sel:[0,1,1] op_sel_hi:[1,1,1] neg_lo:[1,0,0] neg_hi:[1,0,0]
v_pk_fma_f32 v[68:69], v[68:69], v[128:129], v[100:101] op_sel:[0,1,1] op_sel_hi:[1,1,1] neg_lo:[0,0,1] neg_hi:[0,0,1]
v_exp_f32 v228, v228
v_exp_f32 v68, v68
v_exp_f32 v229, v229
v_exp_f32 v69, v69
v_pk_fma_f32 v[230:231], v[70:71], v[128:129], v[104:105] op_sel:[0,1,1] op_sel_hi:[1,1,1] neg_lo:[1,0,0] neg_hi:[1,0,0]
v_pk_fma_f32 v[70:71], v[70:71], v[128:129], v[100:101] op_sel:[0,1,1] op_sel_hi:[1,1,1] neg_lo:[0,0,1] neg_hi:[0,0,1]
v_exp_f32 v230, v230
v_exp_f32 v70, v70
v_exp_f32 v231, v231
v_exp_f32 v71, v71
v_pk_fma_f32 v[232:233], v[72:73], v[128:129], v[104:105] op_sel:[0,1,1] op_sel_hi:[1,1,1] neg_lo:[1,0,0] neg_hi:[1,0,0]
v_pk_fma_f32 v[72:73], v[72:73], v[128:129], v[100:101] op_sel:[0,1,1] op_sel_hi:[1,1,1] neg_lo:[0,0,1] neg_hi:[0,0,1]
v_exp_f32 v232, v232
v_exp_f32 v72, v72
v_exp_f32 v233, v233
v_exp_f32 v73, v73
v_pk_fma_f32 v[234:235], v[74:75], v[128:129], v[104:105] op_sel:[0,1,1] op_sel_hi:[1,1,1] neg_lo:[1,0,0] neg_hi:[1,0,0]
v_pk_fma_f32 v[74:75], v[74:75], v[128:129], v[100:101] op_sel:[0,1,1] op_sel_hi:[1,1,1] neg_lo:[0,0,1] neg_hi:[0,0,1]
v_exp_f32 v234, v234
v_exp_f32 v74, v74
v_exp_f32 v235, v235
v_exp_f32 v75, v75
v_pk_fma_f32 v[236:237], v[76:77], v[130:131], v[106:107] op_sel:[0,0,0] op_sel_hi:[1,0,0] neg_lo:[1,0,0] neg_hi:[1,0,0]
v_pk_fma_f32 v[76:77], v[76:77], v[130:131], v[102:103] op_sel:[0,0,0] op_sel_hi:[1,0,0] neg_lo:[0,0,1] neg_hi:[0,0,1]
v_exp_f32 v236, v236
v_exp_f32 v76, v76
v_exp_f32 v237, v237
v_exp_f32 v77, v77
v_pk_fma_f32 v[238:239], v[78:79], v[130:131], v[106:107] op_sel:[0,0,0] op_sel_hi:[1,0,0] neg_lo:[1,0,0] neg_hi:[1,0,0]
v_pk_fma_f32 v[78:79], v[78:79], v[130:131], v[102:103] op_sel:[0,0,0] op_sel_hi:[1,0,0] neg_lo:[0,0,1] neg_hi:[0,0,1]
v_exp_f32 v238, v238
v_exp_f32 v78, v78
v_exp_f32 v239, v239
v_exp_f32 v79, v79
v_pk_fma_f32 v[240:241], v[80:81], v[130:131], v[106:107] op_sel:[0,0,0] op_sel_hi:[1,0,0] neg_lo:[1,0,0] neg_hi:[1,0,0]
v_pk_fma_f32 v[80:81], v[80:81], v[130:131], v[102:103] op_sel:[0,0,0] op_sel_hi:[1,0,0] neg_lo:[0,0,1] neg_hi:[0,0,1]
v_exp_f32 v240, v240
v_exp_f32 v80, v80
v_exp_f32 v241, v241
v_exp_f32 v81, v81
v_pk_fma_f32 v[242:243], v[82:83], v[130:131], v[106:107] op_sel:[0,0,0] op_sel_hi:[1,0,0] neg_lo:[1,0,0] neg_hi:[1,0,0]
v_pk_fma_f32 v[82:83], v[82:83], v[130:131], v[102:103] op_sel:[0,0,0] op_sel_hi:[1,0,0] neg_lo:[0,0,1] neg_hi:[0,0,1]
v_exp_f32 v242, v242
v_exp_f32 v82, v82
v_exp_f32 v243, v243
v_exp_f32 v83, v83
v_pk_fma_f32 v[244:245], v[84:85], v[130:131], v[106:107] op_sel:[0,1,1] op_sel_hi:[1,1,1] neg_lo:[1,0,0] neg_hi:[1,0,0]
v_pk_fma_f32 v[84:85], v[84:85], v[130:131], v[102:103] op_sel:[0,1,1] op_sel_hi:[1,1,1] neg_lo:[0,0,1] neg_hi:[0,0,1]
v_exp_f32 v244, v244
v_exp_f32 v84, v84
v_exp_f32 v245, v245
v_exp_f32 v85, v85
v_pk_fma_f32 v[246:247], v[86:87], v[130:131], v[106:107] op_sel:[0,1,1] op_sel_hi:[1,1,1] neg_lo:[1,0,0] neg_hi:[1,0,0]
v_pk_fma_f32 v[86:87], v[86:87], v[130:131], v[102:103] op_sel:[0,1,1] op_sel_hi:[1,1,1] neg_lo:[0,0,1] neg_hi:[0,0,1]
v_exp_f32 v246, v246
v_exp_f32 v86, v86
v_exp_f32 v247, v247
v_exp_f32 v87, v87
v_pk_fma_f32 v[248:249], v[88:89], v[130:131], v[106:107] op_sel:[0,1,1] op_sel_hi:[1,1,1] neg_lo:[1,0,0] neg_hi:[1,0,0]
v_pk_fma_f32 v[88:89], v[88:89], v[130:131], v[102:103] op_sel:[0,1,1] op_sel_hi:[1,1,1] neg_lo:[0,0,1] neg_hi:[0,0,1]
v_exp_f32 v248, v248
v_exp_f32 v88, v88
v_exp_f32 v249, v249
v_exp_f32 v89, v89
v_pk_fma_f32 v[250:251], v[90:91], v[130:131], v[106:107] op_sel:[0,1,1] op_sel_hi:[1,1,1] neg_lo:[1,0,0] neg_hi:[1,0,0]
v_pk_fma_f32 v[90:91], v[90:91], v[130:131], v[102:103] op_sel:[0,1,1] op_sel_hi:[1,1,1] neg_lo:[0,0,1] neg_hi:[0,0,1]
v_exp_f32 v250, v250
v_exp_f32 v90, v90
v_exp_f32 v251, v251
v_exp_f32 v91, v91
v_pk_add_f32 v[108:109], v[60:61], v[62:63]
v_pk_add_f32 v[110:111], v[220:221], v[222:223]
v_pk_add_f32 v[108:109], v[108:109], v[64:65]
v_pk_add_f32 v[110:111], v[110:111], v[224:225]
v_pk_add_f32 v[108:109], v[108:109], v[66:67]
v_pk_add_f32 v[110:111], v[110:111], v[226:227]
v_add_f32 v100, v108, v109
v_add_f32 v104, v110, v111
v_pk_add_f32 v[108:109], v[68:69], v[70:71]
v_pk_add_f32 v[110:111], v[228:229], v[230:231]
v_pk_add_f32 v[108:109], v[108:109], v[72:73]
v_pk_add_f32 v[110:111], v[110:111], v[232:233]
v_pk_add_f32 v[108:109], v[108:109], v[74:75]
v_pk_add_f32 v[110:111], v[110:111], v[234:235]
v_add_f32 v101, v108, v109
v_add_f32 v105, v110, v111
v_pk_add_f32 v[108:109], v[76:77], v[78:79]
v_pk_add_f32 v[110:111], v[236:237], v[238:239]
v_pk_add_f32 v[108:109], v[108:109], v[80:81]
v_pk_add_f32 v[110:111], v[110:111], v[240:241]
v_pk_add_f32 v[108:109], v[108:109], v[82:83]
v_pk_add_f32 v[110:111], v[110:111], v[242:243]
v_add_f32 v102, v108, v109
v_add_f32 v106, v110, v111
v_pk_add_f32 v[108:109], v[84:85], v[86:87]
v_pk_add_f32 v[110:111], v[244:245], v[246:247]
v_pk_add_f32 v[108:109], v[108:109], v[88:89]
v_pk_add_f32 v[110:111], v[110:111], v[248:249]
v_pk_add_f32 v[108:109], v[108:109], v[90:91]
v_pk_add_f32 v[110:111], v[110:111], v[250:251]
v_add_f32 v103, v108, v109
v_add_f32 v107, v110, v111
s_nop 1
v_permlane32_swap_b32 v100, v101
v_permlane32_swap_b32 v102, v103
v_permlane32_swap_b32 v104, v105
v_permlane32_swap_b32 v106, v107
v_add_f32 v100, v100, v101
v_add_f32 v102, v102, v103
v_add_f32 v104, v104, v105
v_add_f32 v106, v106, v107
v_permlane16_swap_b32 v100, v102
s_nop 0
v_permlane16_swap_b32 v104, v106
v_add_f32 v100, v100, v102
v_add_f32 v104, v104, v106
v_rcp_f32 v100, v100
v_rcp_f32 v104, v104
s_nop 0
v_mov_b32 v102, v100
v_mov_b32 v106, v104
s_nop 0
v_permlane16_swap_b32 v100, v102
v_permlane16_swap_b32 v104, v106
v_mov_b32 v101, v100
v_mov_b32 v103, v102
v_mov_b32 v105, v104
v_mov_b32 v107, v106
v_permlane32_swap_b32 v100, v101
v_permlane32_swap_b32 v102, v103
v_permlane32_swap_b32 v104, v105
v_permlane32_swap_b32 v106, v107
.p2align 3
v_pk_mul_f32 v[60:61], v[60:61], v[100:101] op_sel:[0,0] op_sel_hi:[1,0]
v_pk_mul_f32 v[62:63], v[62:63], v[100:101] op_sel:[0,0] op_sel_hi:[1,0]
v_pk_mul_f32 v[64:65], v[64:65], v[100:101] op_sel:[0,0] op_sel_hi:[1,0]
v_pk_mul_f32 v[66:67], v[66:67], v[100:101] op_sel:[0,0] op_sel_hi:[1,0]
v_pk_mul_f32 v[220:221], v[220:221], v[104:105] op_sel:[0,0] op_sel_hi:[1,0]
v_pk_mul_f32 v[222:223], v[222:223], v[104:105] op_sel:[0,0] op_sel_hi:[1,0]
v_pk_mul_f32 v[224:225], v[224:225], v[104:105] op_sel:[0,0] op_sel_hi:[1,0]
v_pk_mul_f32 v[226:227], v[226:227], v[104:105] op_sel:[0,0] op_sel_hi:[1,0]
v_cvt_pk_bf16_f32 v60, v60, v61
v_cvt_pk_bf16_f32 v61, v62, v63
v_cvt_pk_bf16_f32 v62, v64, v65
v_cvt_pk_bf16_f32 v63, v66, v67
v_cvt_pk_bf16_f32 v220, v220, v221
v_cvt_pk_bf16_f32 v221, v222, v223
v_cvt_pk_bf16_f32 v222, v224, v225
v_cvt_pk_bf16_f32 v223, v226, v227
v_pk_mul_f32 v[68:69], v[68:69], v[100:101] op_sel:[0,1] op_sel_hi:[1,1]
v_pk_mul_f32 v[70:71], v[70:71], v[100:101] op_sel:[0,1] op_sel_hi:[1,1]
v_pk_mul_f32 v[72:73], v[72:73], v[100:101] op_sel:[0,1] op_sel_hi:[1,1]
v_pk_mul_f32 v[74:75], v[74:75], v[100:101] op_sel:[0,1] op_sel_hi:[1,1]
v_pk_mul_f32 v[228:229], v[228:229], v[104:105] op_sel:[0,1] op_sel_hi:[1,1]
v_pk_mul_f32 v[230:231], v[230:231], v[104:105] op_sel:[0,1] op_sel_hi:[1,1]
v_pk_mul_f32 v[232:233], v[232:233], v[104:105] op_sel:[0,1] op_sel_hi:[1,1]
v_pk_mul_f32 v[234:235], v[234:235], v[104:105] op_sel:[0,1] op_sel_hi:[1,1]
v_cvt_pk_bf16_f32 v68, v68, v69
v_mfma_f32_16x16x32_bf16 v[204:207], v[60:63], v[38:41], 0
v_cvt_pk_bf16_f32 v69, v70, v71
v_cvt_pk_bf16_f32 v70, v72, v73
v_mfma_f32_16x16x32_bf16 v[208:211], v[60:63], v[36:39], 0
v_cvt_pk_bf16_f32 v71, v74, v75
v_cvt_pk_bf16_f32 v228, v228, v229
v_mfma_f32_16x16x32_bf16 v[212:215], v[220:223], v[38:41], 0
v_cvt_pk_bf16_f32 v229, v230, v231
v_cvt_pk_bf16_f32 v230, v232, v233
v_mfma_f32_16x16x32_bf16 v[216:219], v[220:223], v[36:39], 0
v_cvt_pk_bf16_f32 v231, v234, v235
v_pk_mul_f32 v[76:77], v[76:77], v[102:103] op_sel:[0,0] op_sel_hi:[1,0]
v_pk_mul_f32 v[78:79], v[78:79], v[102:103] op_sel:[0,0] op_sel_hi:[1,0]
v_pk_mul_f32 v[80:81], v[80:81], v[102:103] op_sel:[0,0] op_sel_hi:[1,0]
v_pk_mul_f32 v[82:83], v[82:83], v[102:103] op_sel:[0,0] op_sel_hi:[1,0]
v_pk_mul_f32 v[236:237], v[236:237], v[106:107] op_sel:[0,0] op_sel_hi:[1,0]
v_pk_mul_f32 v[238:239], v[238:239], v[106:107] op_sel:[0,0] op_sel_hi:[1,0]
v_pk_mul_f32 v[240:241], v[240:241], v[106:107] op_sel:[0,0] op_sel_hi:[1,0]
v_pk_mul_f32 v[242:243], v[242:243], v[106:107] op_sel:[0,0] op_sel_hi:[1,0]
v_cvt_pk_bf16_f32 v76, v76, v77
v_mfma_f32_16x16x32_bf16 v[188:191], v[68:71], v[38:41], 0
v_mfma_f32_16x16x32_bf16 v[192:195], v[68:71], v[36:39], 0
v_cvt_pk_bf16_f32 v77, v78, v79
v_mfma_f32_16x16x32_bf16 v[196:199], v[228:231], v[38:41], 0
v_cvt_pk_bf16_f32 v78, v80, v81
v_mfma_f32_16x16x32_bf16 v[200:203], v[228:231], v[36:39], 0
v_cvt_pk_bf16_f32 v64, v204, v205
v_cvt_pk_bf16_f32 v79, v82, v83
v_cvt_pk_bf16_f32 v65, v206, v207
v_cvt_pk_bf16_f32 v236, v236, v237
v_cvt_pk_bf16_f32 v72, v208, v209
v_cvt_pk_bf16_f32 v73, v210, v211
v_cvt_pk_bf16_f32 v237, v238, v239
v_cvt_pk_bf16_f32 v224, v212, v213
v_cvt_pk_bf16_f32 v238, v240, v241
v_cvt_pk_bf16_f32 v225, v214, v215
v_cvt_pk_bf16_f32 v232, v216, v217
v_cvt_pk_bf16_f32 v239, v242, v243
v_cvt_pk_bf16_f32 v233, v218, v219
v_pk_mul_f32 v[84:85], v[84:85], v[102:103] op_sel:[0,1] op_sel_hi:[1,1]
v_pk_mul_f32 v[86:87], v[86:87], v[102:103] op_sel:[0,1] op_sel_hi:[1,1]
v_pk_mul_f32 v[88:89], v[88:89], v[102:103] op_sel:[0,1] op_sel_hi:[1,1]
v_pk_mul_f32 v[90:91], v[90:91], v[102:103] op_sel:[0,1] op_sel_hi:[1,1]
v_pk_mul_f32 v[244:245], v[244:245], v[106:107] op_sel:[0,1] op_sel_hi:[1,1]
v_pk_mul_f32 v[246:247], v[246:247], v[106:107] op_sel:[0,1] op_sel_hi:[1,1]
v_pk_mul_f32 v[248:249], v[248:249], v[106:107] op_sel:[0,1] op_sel_hi:[1,1]
v_pk_mul_f32 v[250:251], v[250:251], v[106:107] op_sel:[0,1] op_sel_hi:[1,1]
v_cvt_pk_bf16_f32 v84, v84, v85
v_mfma_f32_16x16x32_bf16 v[204:207], v[76:79], v[38:41], 0
v_mfma_f32_16x16x32_bf16 v[208:211], v[76:79], v[36:39], 0
v_cvt_pk_bf16_f32 v85, v86, v87
v_mfma_f32_16x16x32_bf16 v[212:215], v[236:239], v[38:41], 0
v_cvt_pk_bf16_f32 v86, v88, v89
v_mfma_f32_16x16x32_bf16 v[216:219], v[236:239], v[36:39], 0
v_cvt_pk_bf16_f32 v66, v188, v189
v_cvt_pk_bf16_f32 v87, v90, v91
v_cvt_pk_bf16_f32 v67, v190, v191
v_cvt_pk_bf16_f32 v244, v244, v245
v_cvt_pk_bf16_f32 v74, v192, v193
v_cvt_pk_bf16_f32 v75, v194, v195
v_cvt_pk_bf16_f32 v245, v246, v247
v_cvt_pk_bf16_f32 v226, v196, v197
v_cvt_pk_bf16_f32 v246, v248, v249
v_cvt_pk_bf16_f32 v227, v198, v199
v_cvt_pk_bf16_f32 v234, v200, v201
v_cvt_pk_bf16_f32 v247, v250, v251
v_cvt_pk_bf16_f32 v235, v202, v203
v_mov_b32 v5, 4
v_cmp_eq_u32 s[50:51], s41, v2
v_mfma_f32_16x16x32_bf16 v[188:191], v[84:87], v[38:41], 0
v_mfma_f32_16x16x32_bf16 v[192:195], v[84:87], v[36:39], 0
v_mfma_f32_16x16x32_bf16 v[196:199], v[244:247], v[38:41], 0
v_mfma_f32_16x16x32_bf16 v[200:203], v[244:247], v[36:39], 0
v_mfma_f32_16x16x32_bf16 v[152:155], v[224:227], v[112:115], 0
v_cvt_pk_bf16_f32 v80, v204, v205
v_cvt_pk_bf16_f32 v81, v206, v207
v_mfma_f32_16x16x32_bf16 v[60:63], v[232:235], v[112:115], 0
v_cvt_pk_bf16_f32 v88, v208, v209
v_mfma_f32_16x16x32_bf16 v[68:71], v[224:227], v[120:123], 0
v_cvt_pk_bf16_f32 v89, v210, v211
v_mfma_f32_16x16x32_bf16 v[220:223], v[232:235], v[120:123], 0
v_cvt_pk_bf16_f32 v240, v212, v213
v_cvt_pk_bf16_f32 v241, v214, v215
v_mfma_f32_16x16x32_bf16 v[228:231], v[224:227], v[48:51], 0
v_cvt_pk_bf16_f32 v248, v216, v217
v_mfma_f32_16x16x32_bf16 v[76:79], v[232:235], v[48:51], 0
v_cvt_pk_bf16_f32 v249, v218, v219
v_mfma_f32_16x16x32_bf16 v[100:103], v[64:67], v[112:115], 0
v_cvt_pk_bf16_f32 v82, v188, v189
v_cvt_pk_bf16_f32 v83, v190, v191
v_mfma_f32_16x16x32_bf16 v[104:107], v[72:75], v[112:115], 0
v_cvt_pk_bf16_f32 v90, v192, v193
v_mfma_f32_16x16x32_bf16 v[108:111], v[64:67], v[120:123], 0
v_cvt_pk_bf16_f32 v91, v194, v195
v_mfma_f32_16x16x32_bf16 v[132:135], v[72:75], v[120:123], 0
v_cvt_pk_bf16_f32 v242, v196, v197
v_cvt_pk_bf16_f32 v243, v198, v199
v_mfma_f32_16x16x32_bf16 v[136:139], v[64:67], v[48:51], 0
v_cvt_pk_bf16_f32 v250, v200, v201
v_mfma_f32_16x16x32_bf16 v[148:151], v[72:75], v[48:51], 0
v_cvt_pk_bf16_f32 v251, v202, v203
s_nop 1
v_mfma_f32_16x16x32_bf16 v[152:155], v[240:243], v[116:119], v[152:155]
v_mfma_f32_16x16x32_bf16 v[60:63], v[248:251], v[116:119], v[60:63]
v_mfma_f32_16x16x32_bf16 v[68:71], v[240:243], v[124:127], v[68:71]
v_mfma_f32_16x16x32_bf16 v[220:223], v[248:251], v[124:127], v[220:223]
v_mfma_f32_16x16x32_bf16 v[228:231], v[240:243], v[48:51], v[228:231]
v_mfma_f32_16x16x32_bf16 v[76:79], v[248:251], v[48:51], v[76:79]
v_mfma_f32_16x16x32_bf16 v[100:103], v[80:83], v[116:119], v[100:103]
v_mfma_f32_16x16x32_bf16 v[104:107], v[88:91], v[116:119], v[104:107]
v_mfma_f32_16x16x32_bf16 v[108:111], v[80:83], v[124:127], v[108:111]
v_mfma_f32_16x16x32_bf16 v[132:135], v[88:91], v[124:127], v[132:135]
v_cvt_pk_bf16_f32 v152, v152, v153
v_cvt_pk_bf16_f32 v153, v154, v155
v_mfma_f32_16x16x32_bf16 v[136:139], v[80:83], v[48:51], v[136:139]
v_cvt_pk_bf16_f32 v154, v60, v61
v_cvt_pk_bf16_f32 v155, v62, v63
v_mfma_f32_16x16x32_bf16 v[148:151], v[88:91], v[48:51], v[148:151]
ds_write_b128 v42, v[152:155] offset:0
v_cvt_pk_bf16_f32 v68, v68, v69
v_cvt_pk_bf16_f32 v69, v70, v71
v_cvt_pk_bf16_f32 v70, v220, v221
v_cvt_pk_bf16_f32 v71, v222, v223
ds_write_b128 v42, v[68:71] offset:1024
v_cvt_pk_bf16_f32 v228, v228, v229
v_cvt_pk_bf16_f32 v229, v230, v231
v_cvt_pk_bf16_f32 v230, v76, v77
v_cvt_pk_bf16_f32 v231, v78, v79
ds_write_b128 v42, v[228:231] offset:2048
ds_write_b32 v52, v5
s_mov_b32 s63, 0
px_90:
ds_read_b32 v4, v19
ds_read_b128 v[188:191], v43 offset:0
ds_read_b128 v[192:195], v43 offset:1024
ds_read_b128 v[196:199], v43 offset:2048
s_add_u32 s63, s63, 1
s_cmp_lt_u32 s63, 0x400000
s_waitcnt lgkmcnt(0)
v_cmp_ne_u32 vcc, 4, v4
s_cbranch_vccz pxd_91
s_cbranch_scc1 px_90
pxd_91:
v_mfma_f32_16x16x32_bf16 v[100:103], v[38:41], v[188:191], v[100:103]
v_mfma_f32_16x16x32_bf16 v[104:107], v[36:39], v[188:191], v[104:107]
v_mfma_f32_16x16x32_bf16 v[108:111], v[38:41], v[192:195], v[108:111]
v_mfma_f32_16x16x32_bf16 v[132:135], v[36:39], v[192:195], v[132:135]
v_mfma_f32_16x16x32_bf16 v[136:139], v[38:41], v[196:199], v[136:139]
v_mfma_f32_16x16x32_bf16 v[148:151], v[36:39], v[196:199], v[148:151]
s_nop 2
v_cvt_pk_bf16_f32 v100, v100, v101
v_cvt_pk_bf16_f32 v101, v102, v103
v_cvt_pk_bf16_f32 v102, v104, v105
v_cvt_pk_bf16_f32 v103, v106, v107
buffer_store_dwordx4 v[100:103], v55, s[32:35], s53 offen sc1
v_cvt_pk_bf16_f32 v108, v108, v109
v_cvt_pk_bf16_f32 v109, v110, v111
v_cvt_pk_bf16_f32 v110, v132, v133
v_cvt_pk_bf16_f32 v111, v134, v135
buffer_store_dwordx4 v[108:111], v55, s[32:35], s54 offen sc1
v_cvt_pk_bf16_f32 v136, v136, v137
v_cvt_pk_bf16_f32 v137, v138, v139
v_cvt_pk_bf16_f32 v138, v148, v149
v_cvt_pk_bf16_f32 v139, v150, v151
s_mov_b64 exec, s[50:51]
buffer_store_dwordx4 v[136:139], v58, s[32:35], s56 offen sc1
s_mov_b64 exec, -1
.p2align 3
v_pk_fma_f32 v[156:157], v[140:141], v[92:93], v[156:157] op_sel:[0,1,0] op_sel_hi:[1,1,1]
v_pk_fma_f32 v[158:159], v[142:143], v[92:93], v[158:159] op_sel:[0,1,0] op_sel_hi:[1,1,1]
v_pk_fma_f32 v[160:161], v[144:145], v[92:93], v[160:161] op_sel:[0,1,0] op_sel_hi:[1,1,1]
v_pk_fma_f32 v[162:163], v[146:147], v[92:93], v[162:163] op_sel:[0,1,0] op_sel_hi:[1,1,1]
v_cvt_pk_bf16_f32 v156, v156, v157
v_cvt_pk_bf16_f32 v157, v158, v159
v_cvt_pk_bf16_f32 v158, v160, v161
v_cvt_pk_bf16_f32 v159, v162, v163
v_pk_fma_f32 v[164:165], v[140:141], v[94:95], v[164:165] op_sel:[0,1,0] op_sel_hi:[1,1,1]
v_pk_fma_f32 v[166:167], v[142:143], v[94:95], v[166:167] op_sel:[0,1,0] op_sel_hi:[1,1,1]
v_pk_fma_f32 v[168:169], v[144:145], v[94:95], v[168:169] op_sel:[0,1,0] op_sel_hi:[1,1,1]
v_pk_fma_f32 v[170:171], v[146:147], v[94:95], v[170:171] op_sel:[0,1,0] op_sel_hi:[1,1,1]
v_cvt_pk_bf16_f32 v164, v164, v165
v_mfma_f32_16x16x32_bf16 v[60:63], v[10:13], v[156:159], 0
v_cvt_pk_bf16_f32 v165, v166, v167
v_cvt_pk_bf16_f32 v166, v168, v169
v_mfma_f32_16x16x32_bf16 v[64:67], v[14:17], v[156:159], 0
v_cvt_pk_bf16_f32 v167, v170, v171
v_pk_fma_f32 v[172:173], v[140:141], v[96:97], v[172:173] op_sel:[0,1,0] op_sel_hi:[1,1,1]
v_pk_fma_f32 v[174:175], v[142:143], v[96:97], v[174:175] op_sel:[0,1,0] op_sel_hi:[1,1,1]
v_pk_fma_f32 v[176:177], v[144:145], v[96:97], v[176:177] op_sel:[0,1,0] op_sel_hi:[1,1,1]
v_pk_fma_f32 v[178:179], v[146:147], v[96:97], v[178:179] op_sel:[0,1,0] op_sel_hi:[1,1,1]
v_cvt_pk_bf16_f32 v172, v172, v173
v_mfma_f32_16x16x32_bf16 v[68:71], v[10:13], v[164:167], 0
v_cvt_pk_bf16_f32 v173, v174, v175
v_cvt_pk_bf16_f32 v174, v176, v177
v_mfma_f32_16x16x32_bf16 v[72:75], v[14:17], v[164:167], 0
v_cvt_pk_bf16_f32 v175, v178, v179
v_pk_fma_f32 v[180:181], v[140:141], v[98:99], v[180:181] op_sel:[0,1,0] op_sel_hi:[1,1,1]
v_pk_fma_f32 v[182:183], v[142:143], v[98:99], v[182:183] op_sel:[0,1,0] op_sel_hi:[1,1,1]
v_pk_fma_f32 v[184:185], v[144:145], v[98:99], v[184:185] op_sel:[0,1,0] op_sel_hi:[1,1,1]
v_pk_fma_f32 v[186:187], v[146:147], v[98:99], v[186:187] op_sel:[0,1,0] op_sel_hi:[1,1,1]
v_cvt_pk_bf16_f32 v180, v180, v181
v_mfma_f32_16x16x32_bf16 v[76:79], v[10:13], v[172:175], 0
v_cvt_pk_bf16_f32 v181, v182, v183
v_cvt_pk_bf16_f32 v182, v184, v185
v_mfma_f32_16x16x32_bf16 v[80:83], v[14:17], v[172:175], 0
v_cvt_pk_bf16_f32 v183, v186, v187
s_nop 1
v_mfma_f32_16x16x32_bf16 v[84:87], v[10:13], v[180:183], 0
v_mfma_f32_16x16x32_bf16 v[88:91], v[14:17], v[180:183], 0
v_max3_f32 v100, v60, v61, v62
v_min3_f32 v104, v60, v61, v62
v_max3_f32 v100, v100, v63, v64
v_min3_f32 v104, v104, v63, v64
v_max3_f32 v100, v100, v65, v66
v_min3_f32 v104, v104, v65, v66
v_max_f32 v100, v100, v67
v_min_f32 v104, v104, v67
v_max3_f32 v101, v68, v69, v70
v_min3_f32 v105, v68, v69, v70
v_max3_f32 v101, v101, v71, v72
v_min3_f32 v105, v105, v71, v72
v_max3_f32 v101, v101, v73, v74
v_min3_f32 v105, v105, v73, v74
v_max_f32 v101, v101, v75
v_min_f32 v105, v105, v75
v_max3_f32 v102, v76, v77, v78
v_min3_f32 v106, v76, v77, v78
v_max3_f32 v102, v102, v79, v80
v_min3_f32 v106, v106, v79, v80
v_max3_f32 v102, v102, v81, v82
v_min3_f32 v106, v106, v81, v82
v_max_f32 v102, v102, v83
v_min_f32 v106, v106, v83
v_max3_f32 v103, v84, v85, v86
v_min3_f32 v107, v84, v85, v86
v_max3_f32 v103, v103, v87, v88
v_min3_f32 v107, v107, v87, v88
v_max3_f32 v103, v103, v89, v90
v_min3_f32 v107, v107, v89, v90
v_max_f32 v103, v103, v91
v_min_f32 v107, v107, v91
s_nop 1
v_permlane32_swap_b32 v100, v101
v_permlane32_swap_b32 v102, v103
v_permlane32_swap_b32 v104, v105
v_permlane32_swap_b32 v106, v107
v_max_f32 v100, v100, v101
v_max_f32 v102, v102, v103
v_min_f32 v104, v104, v105
v_min_f32 v106, v106, v107
v_permlane16_swap_b32 v100, v102
s_nop 0
v_permlane16_swap_b32 v104, v106
v_max_f32 v100, v100, v102
v_min_f32 v104, v104, v106
v_mov_b32 v102, v100
v_mov_b32 v106, v104
s_nop 0
v_permlane16_swap_b32 v100, v102
v_permlane16_swap_b32 v104, v106
v_mov_b32 v101, v100
v_mov_b32 v103, v102
v_mov_b32 v105, v104
v_mov_b32 v107, v106
v_permlane32_swap_b32 v100, v101
v_permlane32_swap_b32 v102, v103
v_permlane32_swap_b32 v104, v105
v_permlane32_swap_b32 v106, v107
v_pk_mul_f32 v[100:101], v[100:101], v[128:129]
v_pk_mul_f32 v[102:103], v[102:103], v[130:131]
v_pk_mul_f32 v[104:105], v[104:105], v[128:129]
v_pk_mul_f32 v[106:107], v[106:107], v[130:131]
v_pk_fma_f32 v[220:221], v[60:61], v[128:129], v[104:105] op_sel:[0,0,0] op_sel_hi:[1,0,0] neg_lo:[1,0,0] neg_hi:[1,0,0]
v_pk_fma_f32 v[60:61], v[60:61], v[128:129], v[100:101] op_sel:[0,0,0] op_sel_hi:[1,0,0] neg_lo:[0,0,1] neg_hi:[0,0,1]
v_exp_f32 v220, v220
v_exp_f32 v60, v60
v_exp_f32 v221, v221
v_exp_f32 v61, v61
v_pk_fma_f32 v[222:223], v[62:63], v[128:129], v[104:105] op_sel:[0,0,0] op_sel_hi:[1,0,0] neg_lo:[1,0,0] neg_hi:[1,0,0]
v_pk_fma_f32 v[62:63], v[62:63], v[128:129], v[100:101] op_sel:[0,0,0] op_sel_hi:[1,0,0] neg_lo:[0,0,1] neg_hi:[0,0,1]
v_exp_f32 v222, v222
v_exp_f32 v62, v62
v_exp_f32 v223, v223
v_exp_f32 v63, v63
v_pk_fma_f32 v[224:225], v[64:65], v[128:129], v[104:105] op_sel:[0,0,0] op_sel_hi:[1,0,0] neg_lo:[1,0,0] neg_hi:[1,0,0]
v_pk_fma_f32 v[64:65], v[64:65], v[128:129], v[100:101] op_sel:[0,0,0] op_sel_hi:[1,0,0] neg_lo:[0,0,1] neg_hi:[0,0,1]
v_exp_f32 v224, v224
v_exp_f32 v64, v64
v_exp_f32 v225, v225
v_exp_f32 v65, v65
v_pk_fma_f32 v[226:227], v[66:67], v[128:129], v[104:105] op_sel:[0,0,0] op_sel_hi:[1,0,0] neg_lo:[1,0,0] neg_hi:[1,0,0]
v_pk_fma_f32 v[66:67], v[66:67], v[128:129], v[100:101] op_sel:[0,0,0] op_sel_hi:[1,0,0] neg_lo:[0,0,1] neg_hi:[0,0,1]
v_exp_f32 v226, v226
v_exp_f32 v66, v66
v_exp_f32 v227, v227
v_exp_f32 v67, v67
v_pk_fma_f32 v[228:229], v[68:69], v[128:129], v[104:105] op_sel:[0,1,1] op_sel_hi:[1,1,1] neg_lo:[1,0,0] neg_hi:[1,0,0]
v_pk_fma_f32 v[68:69], v[68:69], v[128:129], v[100:101] op_sel:[0,1,1] op_sel_hi:[1,1,1] neg_lo:[0,0,1] neg_hi:[0,0,1]
v_exp_f32 v228, v228
v_exp_f32 v68, v68
v_exp_f32 v229, v229
v_exp_f32 v69, v69
v_pk_fma_f32 v[230:231], v[70:71], v[128:129], v[104:105] op_sel:[0,1,1] op_sel_hi:[1,1,1] neg_lo:[1,0,0] neg_hi:[1,0,0]
v_pk_fma_f32 v[70:71], v[70:71], v[128:129], v[100:101] op_sel:[0,1,1] op_sel_hi:[1,1,1] neg_lo:[0,0,1] neg_hi:[0,0,1]
v_exp_f32 v230, v230
v_exp_f32 v70, v70
v_exp_f32 v231, v231
v_exp_f32 v71, v71
v_pk_fma_f32 v[232:233], v[72:73], v[128:129], v[104:105] op_sel:[0,1,1] op_sel_hi:[1,1,1] neg_lo:[1,0,0] neg_hi:[1,0,0]
v_pk_fma_f32 v[72:73], v[72:73], v[128:129], v[100:101] op_sel:[0,1,1] op_sel_hi:[1,1,1] neg_lo:[0,0,1] neg_hi:[0,0,1]
v_exp_f32 v232, v232
v_exp_f32 v72, v72
v_exp_f32 v233, v233
v_exp_f32 v73, v73
v_pk_fma_f32 v[234:235], v[74:75], v[128:129], v[104:105] op_sel:[0,1,1] op_sel_hi:[1,1,1] neg_lo:[1,0,0] neg_hi:[1,0,0]
v_pk_fma_f32 v[74:75], v[74:75], v[128:129], v[100:101] op_sel:[0,1,1] op_sel_hi:[1,1,1] neg_lo:[0,0,1] neg_hi:[0,0,1]
v_exp_f32 v234, v234
v_exp_f32 v74, v74
v_exp_f32 v235, v235
v_exp_f32 v75, v75
buffer_load_dwordx4 v[188:191], v18, s[32:35], s55 offen offset:0 sc1
buffer_load_dwordx4 v[192:195], v18, s[32:35], s55 offen offset:1024 sc1
buffer_load_dwordx4 v[204:207], v58, s[32:35], s56 offen sc1
buffer_load_dwordx4 v[208:211], v58, s[32:35], s57 offen sc1
v_pk_fma_f32 v[236:237], v[76:77], v[130:131], v[106:107] op_sel:[0,0,0] op_sel_hi:[1,0,0] neg_lo:[1,0,0] neg_hi:[1,0,0]
v_pk_fma_f32 v[76:77], v[76:77], v[130:131], v[102:103] op_sel:[0,0,0] op_sel_hi:[1,0,0] neg_lo:[0,0,1] neg_hi:[0,0,1]
v_exp_f32 v236, v236
v_exp_f32 v76, v76
v_exp_f32 v237, v237
v_exp_f32 v77, v77
v_pk_fma_f32 v[238:239], v[78:79], v[130:131], v[106:107] op_sel:[0,0,0] op_sel_hi:[1,0,0] neg_lo:[1,0,0] neg_hi:[1,0,0]
v_pk_fma_f32 v[78:79], v[78:79], v[130:131], v[102:103] op_sel:[0,0,0] op_sel_hi:[1,0,0] neg_lo:[0,0,1] neg_hi:[0,0,1]
v_exp_f32 v238, v238
v_exp_f32 v78, v78
v_exp_f32 v239, v239
v_exp_f32 v79, v79
v_pk_fma_f32 v[240:241], v[80:81], v[130:131], v[106:107] op_sel:[0,0,0] op_sel_hi:[1,0,0] neg_lo:[1,0,0] neg_hi:[1,0,0]
v_pk_fma_f32 v[80:81], v[80:81], v[130:131], v[102:103] op_sel:[0,0,0] op_sel_hi:[1,0,0] neg_lo:[0,0,1] neg_hi:[0,0,1]
v_exp_f32 v240, v240
v_exp_f32 v80, v80
v_exp_f32 v241, v241
v_exp_f32 v81, v81
v_pk_fma_f32 v[242:243], v[82:83], v[130:131], v[106:107] op_sel:[0,0,0] op_sel_hi:[1,0,0] neg_lo:[1,0,0] neg_hi:[1,0,0]
v_pk_fma_f32 v[82:83], v[82:83], v[130:131], v[102:103] op_sel:[0,0,0] op_sel_hi:[1,0,0] neg_lo:[0,0,1] neg_hi:[0,0,1]
v_exp_f32 v242, v242
v_exp_f32 v82, v82
v_exp_f32 v243, v243
v_exp_f32 v83, v83
v_pk_fma_f32 v[244:245], v[84:85], v[130:131], v[106:107] op_sel:[0,1,1] op_sel_hi:[1,1,1] neg_lo:[1,0,0] neg_hi:[1,0,0]
v_pk_fma_f32 v[84:85], v[84:85], v[130:131], v[102:103] op_sel:[0,1,1] op_sel_hi:[1,1,1] neg_lo:[0,0,1] neg_hi:[0,0,1]
v_exp_f32 v244, v244
v_exp_f32 v84, v84
v_exp_f32 v245, v245
v_exp_f32 v85, v85
v_pk_fma_f32 v[246:247], v[86:87], v[130:131], v[106:107] op_sel:[0,1,1] op_sel_hi:[1,1,1] neg_lo:[1,0,0] neg_hi:[1,0,0]
v_pk_fma_f32 v[86:87], v[86:87], v[130:131], v[102:103] op_sel:[0,1,1] op_sel_hi:[1,1,1] neg_lo:[0,0,1] neg_hi:[0,0,1]
v_exp_f32 v246, v246
v_exp_f32 v86, v86
v_exp_f32 v247, v247
v_exp_f32 v87, v87
v_pk_fma_f32 v[248:249], v[88:89], v[130:131], v[106:107] op_sel:[0,1,1] op_sel_hi:[1,1,1] neg_lo:[1,0,0] neg_hi:[1,0,0]
v_pk_fma_f32 v[88:89], v[88:89], v[130:131], v[102:103] op_sel:[0,1,1] op_sel_hi:[1,1,1] neg_lo:[0,0,1] neg_hi:[0,0,1]
v_exp_f32 v248, v248
v_exp_f32 v88, v88
v_exp_f32 v249, v249
v_exp_f32 v89, v89
v_pk_fma_f32 v[250:251], v[90:91], v[130:131], v[106:107] op_sel:[0,1,1] op_sel_hi:[1,1,1] neg_lo:[1,0,0] neg_hi:[1,0,0]
v_pk_fma_f32 v[90:91], v[90:91], v[130:131], v[102:103] op_sel:[0,1,1] op_sel_hi:[1,1,1] neg_lo:[0,0,1] neg_hi:[0,0,1]
v_exp_f32 v250, v250
v_exp_f32 v90, v90
v_exp_f32 v251, v251
v_exp_f32 v91, v91
v_pk_add_f32 v[108:109], v[60:61], v[62:63]
v_pk_add_f32 v[110:111], v[220:221], v[222:223]
v_pk_add_f32 v[108:109], v[108:109], v[64:65]
v_pk_add_f32 v[110:111], v[110:111], v[224:225]
v_pk_add_f32 v[108:109], v[108:109], v[66:67]
v_pk_add_f32 v[110:111], v[110:111], v[226:227]
v_add_f32 v100, v108, v109
v_add_f32 v104, v110, v111
v_pk_add_f32 v[108:109], v[68:69], v[70:71]
v_pk_add_f32 v[110:111], v[228:229], v[230:231]
v_pk_add_f32 v[108:109], v[108:109], v[72:73]
v_pk_add_f32 v[110:111], v[110:111], v[232:233]
v_pk_add_f32 v[108:109], v[108:109], v[74:75]
v_pk_add_f32 v[110:111], v[110:111], v[234:235]
v_add_f32 v101, v108, v109
v_add_f32 v105, v110, v111
v_pk_add_f32 v[108:109], v[76:77], v[78:79]
v_pk_add_f32 v[110:111], v[236:237], v[238:239]
v_pk_add_f32 v[108:109], v[108:109], v[80:81]
v_pk_add_f32 v[110:111], v[110:111], v[240:241]
v_pk_add_f32 v[108:109], v[108:109], v[82:83]
v_pk_add_f32 v[110:111], v[110:111], v[242:243]
v_add_f32 v102, v108, v109
v_add_f32 v106, v110, v111
v_pk_add_f32 v[108:109], v[84:85], v[86:87]
v_pk_add_f32 v[110:111], v[244:245], v[246:247]
v_pk_add_f32 v[108:109], v[108:109], v[88:89]
v_pk_add_f32 v[110:111], v[110:111], v[248:249]
v_pk_add_f32 v[108:109], v[108:109], v[90:91]
v_pk_add_f32 v[110:111], v[110:111], v[250:251]
v_add_f32 v103, v108, v109
v_add_f32 v107, v110, v111
s_mov_b32 s63, 0
sent_92:
s_waitcnt vmcnt(0)
v_max_u32 v4, v188, v189
v_max3_u32 v4, v4, v190, v191
v_max3_u32 v4, v4, v192, v193
v_max3_u32 v4, v4, v194, v195
v_max3_u32 v4, v4, v204, v205
v_max3_u32 v4, v4, v206, v207
v_max3_u32 v4, v4, v208, v209
v_max3_u32 v4, v4, v210, v211
v_cmp_eq_u32 vcc, -1, v4
s_cbranch_vccz sentd_93
buffer_load_dwordx4 v[188:191], v18, s[32:35], s55 offen offset:0 sc1
buffer_load_dwordx4 v[192:195], v18, s[32:35], s55 offen offset:1024 sc1
buffer_load_dwordx4 v[204:207], v58, s[32:35], s56 offen sc1
buffer_load_dwordx4 v[208:211], v58, s[32:35], s57 offen sc1
s_add_u32 s63, s63, 1
s_cmp_lt_u32 s63, 0x80000
s_cbranch_scc1 sent_92
s_waitcnt vmcnt(0)
sentd_93:
v_mfma_f32_16x16x32_bf16 v[132:135], v[44:47], v[188:191], 0
v_mfma_f32_16x16x32_bf16 v[132:135], v[44:47], v[192:195], v[132:135]
s_nop 7
v_add_f32_dpp v132, v132, v132 row_ror:8 row_mask:0xf bank_mask:0xf
v_add_f32_dpp v133, v133, v133 row_ror:8 row_mask:0xf bank_mask:0xf
v_add_f32_dpp v134, v134, v134 row_ror:8 row_mask:0xf bank_mask:0xf
v_add_f32_dpp v135, v135, v135 row_ror:8 row_mask:0xf bank_mask:0xf
v_cvt_pk_bf16_f32 v132, v132, v133
v_cvt_pk_bf16_f32 v133, v134, v135
s_mov_b64 exec, 0x00ff00ff
buffer_store_dwordx2 v[132:133], v59, s[32:35], s79 offen sc1
s_mov_b64 exec, -1
s_nop 1
v_permlane32_swap_b32 v100, v101
v_permlane32_swap_b32 v102, v103
v_permlane32_swap_b32 v104, v105
v_permlane32_swap_b32 v106, v107
v_add_f32 v100, v100, v101
v_add_f32 v102, v102, v103
v_add_f32 v104, v104, v105
v_add_f32 v106, v106, v107
v_permlane16_swap_b32 v100, v102
s_nop 0
v_permlane16_swap_b32 v104, v106
v_add_f32 v100, v100, v102
v_add_f32 v104, v104, v106
v_rcp_f32 v100, v100
v_rcp_f32 v104, v104
s_nop 0
v_mov_b32 v102, v100
v_mov_b32 v106, v104
s_nop 0
v_permlane16_swap_b32 v100, v102
v_permlane16_swap_b32 v104, v106
v_mov_b32 v101, v100
v_mov_b32 v103, v102
v_mov_b32 v105, v104
v_mov_b32 v107, v106
v_permlane32_swap_b32 v100, v101
v_permlane32_swap_b32 v102, v103
v_permlane32_swap_b32 v104, v105
v_permlane32_swap_b32 v106, v107
.p2align 3
v_pk_mul_f32 v[60:61], v[60:61], v[100:101] op_sel:[0,0] op_sel_hi:[1,0]
v_pk_mul_f32 v[62:63], v[62:63], v[100:101] op_sel:[0,0] op_sel_hi:[1,0]
v_pk_mul_f32 v[64:65], v[64:65], v[100:101] op_sel:[0,0] op_sel_hi:[1,0]
v_pk_mul_f32 v[66:67], v[66:67], v[100:101] op_sel:[0,0] op_sel_hi:[1,0]
v_pk_mul_f32 v[220:221], v[220:221], v[104:105] op_sel:[0,0] op_sel_hi:[1,0]
v_pk_mul_f32 v[222:223], v[222:223], v[104:105] op_sel:[0,0] op_sel_hi:[1,0]
v_pk_mul_f32 v[224:225], v[224:225], v[104:105] op_sel:[0,0] op_sel_hi:[1,0]
v_pk_mul_f32 v[226:227], v[226:227], v[104:105] op_sel:[0,0] op_sel_hi:[1,0]
v_cvt_pk_bf16_f32 v60, v60, v61
v_cvt_pk_bf16_f32 v61, v62, v63
v_cvt_pk_bf16_f32 v62, v64, v65
v_cvt_pk_bf16_f32 v63, v66, v67
v_cvt_pk_bf16_f32 v220, v220, v221
v_cvt_pk_bf16_f32 v221, v222, v223
v_cvt_pk_bf16_f32 v222, v224, v225
v_cvt_pk_bf16_f32 v223, v226, v227
v_pk_mul_f32 v[68:69], v[68:69], v[100:101] op_sel:[0,1] op_sel_hi:[1,1]
v_pk_mul_f32 v[70:71], v[70:71], v[100:101] op_sel:[0,1] op_sel_hi:[1,1]
v_pk_mul_f32 v[72:73], v[72:73], v[100:101] op_sel:[0,1] op_sel_hi:[1,1]
v_pk_mul_f32 v[74:75], v[74:75], v[100:101] op_sel:[0,1] op_sel_hi:[1,1]
v_pk_mul_f32 v[228:229], v[228:229], v[104:105] op_sel:[0,1] op_sel_hi:[1,1]
v_pk_mul_f32 v[230:231], v[230:231], v[104:105] op_sel:[0,1] op_sel_hi:[1,1]
v_pk_mul_f32 v[232:233], v[232:233], v[104:105] op_sel:[0,1] op_sel_hi:[1,1]
v_pk_mul_f32 v[234:235], v[234:235], v[104:105] op_sel:[0,1] op_sel_hi:[1,1]
v_cvt_pk_bf16_f32 v68, v68, v69
v_mfma_f32_16x16x32_bf16 v[112:115], v[204:207], v[60:63], 0
v_cvt_pk_bf16_f32 v69, v70, v71
v_cvt_pk_bf16_f32 v70, v72, v73
v_cvt_pk_bf16_f32 v71, v74, v75
v_cvt_pk_bf16_f32 v228, v228, v229
v_mfma_f32_16x16x32_bf16 v[112:115], v[208:211], v[220:223], v[112:115]
v_cvt_pk_bf16_f32 v229, v230, v231
v_cvt_pk_bf16_f32 v230, v232, v233
v_cvt_pk_bf16_f32 v231, v234, v235
v_pk_mul_f32 v[76:77], v[76:77], v[102:103] op_sel:[0,0] op_sel_hi:[1,0]
v_pk_mul_f32 v[78:79], v[78:79], v[102:103] op_sel:[0,0] op_sel_hi:[1,0]
v_pk_mul_f32 v[80:81], v[80:81], v[102:103] op_sel:[0,0] op_sel_hi:[1,0]
v_pk_mul_f32 v[82:83], v[82:83], v[102:103] op_sel:[0,0] op_sel_hi:[1,0]
v_pk_mul_f32 v[236:237], v[236:237], v[106:107] op_sel:[0,0] op_sel_hi:[1,0]
v_pk_mul_f32 v[238:239], v[238:239], v[106:107] op_sel:[0,0] op_sel_hi:[1,0]
v_pk_mul_f32 v[240:241], v[240:241], v[106:107] op_sel:[0,0] op_sel_hi:[1,0]
v_pk_mul_f32 v[242:243], v[242:243], v[106:107] op_sel:[0,0] op_sel_hi:[1,0]
v_cvt_pk_bf16_f32 v76, v76, v77
v_mfma_f32_16x16x32_bf16 v[116:119], v[204:207], v[68:71], 0
v_cvt_pk_bf16_f32 v77, v78, v79
v_cvt_pk_bf16_f32 v78, v80, v81
v_cvt_pk_bf16_f32 v79, v82, v83
v_cvt_pk_bf16_f32 v236, v236, v237
v_mfma_f32_16x16x32_bf16 v[116:119], v[208:211], v[228:231], v[116:119]
v_cvt_pk_bf16_f32 v237, v238, v239
v_cvt_pk_bf16_f32 v238, v240, v241
v_cvt_pk_bf16_f32 v239, v242, v243
v_pk_mul_f32 v[84:85], v[84:85], v[102:103] op_sel:[0,1] op_sel_hi:[1,1]
v_pk_mul_f32 v[86:87], v[86:87], v[102:103] op_sel:[0,1] op_sel_hi:[1,1]
v_pk_mul_f32 v[88:89], v[88:89], v[102:103] op_sel:[0,1] op_sel_hi:[1,1]
v_pk_mul_f32 v[90:91], v[90:91], v[102:103] op_sel:[0,1] op_sel_hi:[1,1]
v_pk_mul_f32 v[244:245], v[244:245], v[106:107] op_sel:[0,1] op_sel_hi:[1,1]
v_pk_mul_f32 v[246:247], v[246:247], v[106:107] op_sel:[0,1] op_sel_hi:[1,1]
v_pk_mul_f32 v[248:249], v[248:249], v[106:107] op_sel:[0,1] op_sel_hi:[1,1]
v_pk_mul_f32 v[250:251], v[250:251], v[106:107] op_sel:[0,1] op_sel_hi:[1,1]
v_cvt_pk_bf16_f32 v84, v84, v85
v_mfma_f32_16x16x32_bf16 v[120:123], v[204:207], v[76:79], 0
v_cvt_pk_bf16_f32 v85, v86, v87
v_cvt_pk_bf16_f32 v86, v88, v89
v_cvt_pk_bf16_f32 v87, v90, v91
v_cvt_pk_bf16_f32 v244, v244, v245
v_mfma_f32_16x16x32_bf16 v[120:123], v[208:211], v[236:239], v[120:123]
v_cvt_pk_bf16_f32 v245, v246, v247
v_cvt_pk_bf16_f32 v246, v248, v249
v_cvt_pk_bf16_f32 v247, v250, v251
buffer_load_dwordx4 v[188:191], v18, s[32:35], s58 offen offset:0 sc1
buffer_load_dwordx4 v[192:195], v18, s[32:35], s58 offen offset:1024 sc1
v_mfma_f32_16x16x32_bf16 v[124:127], v[204:207], v[84:87], 0
v_mfma_f32_16x16x32_bf16 v[124:127], v[208:211], v[244:247], v[124:127]
buffer_load_dwordx4 v[196:199], v18, s[32:35], s59 offen offset:0 sc1
buffer_load_dwordx4 v[200:203], v18, s[32:35], s59 offen offset:1024 sc1
v_add_f32 v100, v112, v113
v_add_f32 v114, v114, v115
v_add_f32 v100, v100, v114
v_add_f32 v101, v116, v117
v_add_f32 v118, v118, v119
v_add_f32 v101, v101, v118
v_add_f32 v102, v120, v121
v_add_f32 v122, v122, v123
v_add_f32 v102, v102, v122
v_add_f32 v103, v124, v125
v_add_f32 v126, v126, v127
v_add_f32 v103, v103, v126
s_nop 1
v_permlane32_swap_b32 v100, v101
v_permlane32_swap_b32 v102, v103
v_add_f32 v100, v100, v101
v_add_f32 v102, v102, v103
s_nop 1
v_permlane16_swap_b32 v100, v102
s_nop 0
v_add_f32 v100, v100, v102
v_add_f32 v100, 0x358637bd, v100
v_rcp_f32 v100, v100
s_nop 0
v_mov_b32 v102, v100
s_nop 1
v_permlane16_swap_b32 v100, v102
s_nop 0
v_mov_b32 v101, v100
v_mov_b32 v103, v102
s_nop 0
v_permlane32_swap_b32 v100, v101
v_permlane32_swap_b32 v102, v103
s_mov_b32 s63, 0
sent_94:
s_waitcnt vmcnt(0)
v_max_u32 v4, v188, v189
v_max3_u32 v4, v4, v190, v191
v_max3_u32 v4, v4, v192, v193
v_max3_u32 v4, v4, v194, v195
v_max3_u32 v4, v4, v196, v197
v_max3_u32 v4, v4, v198, v199
v_max3_u32 v4, v4, v200, v201
v_max3_u32 v4, v4, v202, v203
v_cmp_eq_u32 vcc, -1, v4
s_cbranch_vccz sentd_95
buffer_load_dwordx4 v[188:191], v18, s[32:35], s58 offen offset:0 sc1
buffer_load_dwordx4 v[192:195], v18, s[32:35], s58 offen offset:1024 sc1
buffer_load_dwordx4 v[196:199], v18, s[32:35], s59 offen offset:0 sc1
buffer_load_dwordx4 v[200:203], v18, s[32:35], s59 offen offset:1024 sc1
s_add_u32 s63, s63, 1
s_cmp_lt_u32 s63, 0x80000
s_cbranch_scc1 sent_94
s_waitcnt vmcnt(0)
sentd_95:
v_mfma_f32_16x16x32_bf16 v[156:159], v[188:191], v[60:63], 0
v_mfma_f32_16x16x32_bf16 v[160:163], v[192:195], v[60:63], 0
v_mfma_f32_16x16x32_bf16 v[156:159], v[196:199], v[220:223], v[156:159]
v_mfma_f32_16x16x32_bf16 v[160:163], v[200:203], v[220:223], v[160:163]
v_mfma_f32_16x16x32_bf16 v[164:167], v[188:191], v[68:71], 0
v_mfma_f32_16x16x32_bf16 v[168:171], v[192:195], v[68:71], 0
v_mfma_f32_16x16x32_bf16 v[164:167], v[196:199], v[228:231], v[164:167]
v_mfma_f32_16x16x32_bf16 v[168:171], v[200:203], v[228:231], v[168:171]
v_mfma_f32_16x16x32_bf16 v[172:175], v[188:191], v[76:79], 0
v_mfma_f32_16x16x32_bf16 v[176:179], v[192:195], v[76:79], 0
v_mfma_f32_16x16x32_bf16 v[172:175], v[196:199], v[236:239], v[172:175]
v_mfma_f32_16x16x32_bf16 v[176:179], v[200:203], v[236:239], v[176:179]
v_mfma_f32_16x16x32_bf16 v[180:183], v[188:191], v[84:87], 0
v_mfma_f32_16x16x32_bf16 v[184:187], v[192:195], v[84:87], 0
v_mfma_f32_16x16x32_bf16 v[180:183], v[196:199], v[244:247], v[180:183]
v_mfma_f32_16x16x32_bf16 v[184:187], v[200:203], v[244:247], v[184:187]
s_cmp_eq_u32 s46, 0
s_cbranch_scc1 slow_96
.p2align 3
v_pk_mul_f32 v[156:157], v[156:157], v[100:101] op_sel:[0,0] op_sel_hi:[1,0]
v_pk_mul_f32 v[158:159], v[158:159], v[100:101] op_sel:[0,0] op_sel_hi:[1,0]
v_pk_mul_f32 v[160:161], v[160:161], v[100:101] op_sel:[0,0] op_sel_hi:[1,0]
v_pk_mul_f32 v[162:163], v[162:163], v[100:101] op_sel:[0,0] op_sel_hi:[1,0]
v_cvt_pk_bf16_f32 v156, v156, v157
v_cvt_pk_bf16_f32 v157, v158, v159
v_cvt_pk_bf16_f32 v158, v160, v161
v_cvt_pk_bf16_f32 v159, v162, v163
buffer_store_dwordx4 v[156:159], v18, s[32:35], s80 offen
v_pk_mul_f32 v[164:165], v[164:165], v[100:101] op_sel:[0,1] op_sel_hi:[1,1]
v_pk_mul_f32 v[166:167], v[166:167], v[100:101] op_sel:[0,1] op_sel_hi:[1,1]
v_pk_mul_f32 v[168:169], v[168:169], v[100:101] op_sel:[0,1] op_sel_hi:[1,1]
v_pk_mul_f32 v[170:171], v[170:171], v[100:101] op_sel:[0,1] op_sel_hi:[1,1]
v_cvt_pk_bf16_f32 v164, v164, v165
v_cvt_pk_bf16_f32 v165, v166, v167
v_cvt_pk_bf16_f32 v166, v168, v169
v_cvt_pk_bf16_f32 v167, v170, v171
buffer_store_dwordx4 v[164:167], v18, s[32:35], s81 offen
v_pk_mul_f32 v[172:173], v[172:173], v[102:103] op_sel:[0,0] op_sel_hi:[1,0]
v_pk_mul_f32 v[174:175], v[174:175], v[102:103] op_sel:[0,0] op_sel_hi:[1,0]
v_pk_mul_f32 v[176:177], v[176:177], v[102:103] op_sel:[0,0] op_sel_hi:[1,0]
v_pk_mul_f32 v[178:179], v[178:179], v[102:103] op_sel:[0,0] op_sel_hi:[1,0]
v_cvt_pk_bf16_f32 v172, v172, v173
v_cvt_pk_bf16_f32 v173, v174, v175
v_cvt_pk_bf16_f32 v174, v176, v177
v_cvt_pk_bf16_f32 v175, v178, v179
buffer_store_dwordx4 v[172:175], v18, s[32:35], s82 offen
v_pk_mul_f32 v[180:181], v[180:181], v[102:103] op_sel:[0,1] op_sel_hi:[1,1]
v_pk_mul_f32 v[182:183], v[182:183], v[102:103] op_sel:[0,1] op_sel_hi:[1,1]
v_pk_mul_f32 v[184:185], v[184:185], v[102:103] op_sel:[0,1] op_sel_hi:[1,1]
v_pk_mul_f32 v[186:187], v[186:187], v[102:103] op_sel:[0,1] op_sel_hi:[1,1]
v_cvt_pk_bf16_f32 v180, v180, v181
v_cvt_pk_bf16_f32 v181, v182, v183
v_cvt_pk_bf16_f32 v182, v184, v185
v_cvt_pk_bf16_f32 v183, v186, v187
buffer_store_dwordx4 v[180:183], v18, s[32:35], s83 offen
s_barrier
s_lshl_b32 s62, s45, 2
v_mov_b32 v4, s62
v_mov_b32 v5, 4
s_mov_b64 exec, 1
s_waitcnt vmcnt(0)
buffer_store_dword v5, v4, s[32:35], s84 offen
s_mov_b64 exec, -1
back_97:
v_and_b32 v36, 31, v0
v_lshlrev_b32 v36, 2, v36
buffer_load_dword v37, v36, s[32:35], s84 offen sc1
v_lshrrev_b32 v4, 2, v2
v_and_b32 v5, 3, v0
v_lshl_add_u32 v6, v3, 3, v4
v_lshlrev_b32 v6, 7, v6
v_lshl_add_u32 v6, v5, 3, v6
v_lshrrev_b32 v7, 1, v4
v_and_b32 v8, 1, v3
v_lshl_add_u32 v7, v8, 1, v7
v_lshl_add_u32 v10, v7, 5, v6
v_xor_b32 v11, 32, v10
v_xor_b32 v12, 64, v10
v_xor_b32 v13, 96, v10
v_add_u32 v14, 0x10000, v10
v_add_u32 v15, 0x10000, v11
v_add_u32 v16, 0x10000, v12
v_add_u32 v17, 0x10000, v13
ds_read_b64_tr_b16 v[220:221], v10 offset:0
ds_read_b64_tr_b16 v[222:223], v10 offset:512
ds_read_b64_tr_b16 v[224:225], v11 offset:0
ds_read_b64_tr_b16 v[226:227], v11 offset:512
ds_read_b64_tr_b16 v[228:229], v12 offset:0
ds_read_b64_tr_b16 v[230:231], v12 offset:512
ds_read_b64_tr_b16 v[232:233], v13 offset:0
ds_read_b64_tr_b16 v[234:235], v13 offset:512
ds_read_b64_tr_b16 v[236:237], v10 offset:4096
ds_read_b64_tr_b16 v[238:239], v10 offset:4608
ds_read_b64_tr_b16 v[240:241], v11 offset:4096
ds_read_b64_tr_b16 v[242:243], v11 offset:4608
ds_read_b64_tr_b16 v[244:245], v12 offset:4096
ds_read_b64_tr_b16 v[246:247], v12 offset:4608
ds_read_b64_tr_b16 v[248:249], v13 offset:4096
ds_read_b64_tr_b16 v[250:251], v13 offset:4608
s_lshl_b32 s48, s41, 3
s_lshl_b32 s49, s40, 1
s_add_u32 s48, s48, s49
s_lshl_b32 s48, s48, 15
s_add_u32 s48, s48, 4194304
v_add_u32 v38, s48, v18
v_add_u32 v39, 32768, v38
s_lshl_b32 s57, s75, 11
s_add_u32 s87, s87, 262144
v_lshlrev_b32 v60, 16, v20
v_and_b32 v61, 0xffff0000, v20
v_lshlrev_b32 v62, 16, v21
v_and_b32 v63, 0xffff0000, v21
v_lshlrev_b32 v64, 16, v22
v_and_b32 v65, 0xffff0000, v22
v_lshlrev_b32 v66, 16, v23
v_and_b32 v67, 0xffff0000, v23
v_lshlrev_b32 v68, 16, v24
v_and_b32 v69, 0xffff0000, v24
v_lshlrev_b32 v70, 16, v25
v_and_b32 v71, 0xffff0000, v25
v_lshlrev_b32 v72, 16, v26
v_and_b32 v73, 0xffff0000, v26
v_lshlrev_b32 v74, 16, v27
v_and_b32 v75, 0xffff0000, v27
v_lshlrev_b32 v76, 16, v28
v_and_b32 v77, 0xffff0000, v28
v_lshlrev_b32 v78, 16, v29
v_and_b32 v79, 0xffff0000, v29
v_lshlrev_b32 v80, 16, v30
v_and_b32 v81, 0xffff0000, v30
v_lshlrev_b32 v82, 16, v31
v_and_b32 v83, 0xffff0000, v31
v_lshlrev_b32 v84, 16, v32
v_and_b32 v85, 0xffff0000, v32
v_lshlrev_b32 v86, 16, v33
v_and_b32 v87, 0xffff0000, v33
v_lshlrev_b32 v88, 16, v34
v_and_b32 v89, 0xffff0000, v34
v_lshlrev_b32 v90, 16, v35
v_and_b32 v91, 0xffff0000, v35
s_mov_b32 s24, s18
s_and_b32 s25, s19, 0xffff
s_mov_b32 s26, 4194304
s_mov_b32 s27, 0x00020000
s_lshl_b32 s48, s41, 7
s_lshl_b32 s49, s40, 5
s_add_u32 s48, s48, s49
v_add_u32 v4, s48, v2
v_lshlrev_b32 v4, 11, v4
v_and_b32 v5, 1, v3
v_lshl_add_u32 v4, v5, 5, v4
v_lshrrev_b32 v5, 1, v3
v_lshl_add_u32 v4, v5, 4, v4
s_lshl_b32 s49, s78, 7
v_add_u32 v40, s49, v4
v_add_u32 v41, 32768, v40
s_mov_b32 s63, 0
s_waitcnt vmcnt(0)
poll_98:
v_cmp_gt_u32 vcc, 4, v37
s_cbranch_vccz polled_99
buffer_load_dword v37, v36, s[32:35], s84 offen sc1
s_add_u32 s63, s63, 1
s_cmp_lt_u32 s63, 0x80000
s_waitcnt vmcnt(0)
s_cbranch_scc1 poll_98
polled_99:
buffer_load_dwordx4 v[156:159], v38, s[32:35], s57 offen sc1
buffer_load_dwordx4 v[160:163], v39, s[32:35], s57 offen sc1
buffer_load_dwordx4 v[164:167], v38, s[32:35], s57 offen offset:1024 sc1
buffer_load_dwordx4 v[168:171], v39, s[32:35], s57 offen offset:1024 sc1
s_add_u32 s57, s57, 2048
s_and_b32 s57, s57, 0x7fff
buffer_load_dwordx4 v[172:175], v38, s[32:35], s57 offen sc1
buffer_load_dwordx4 v[176:179], v39, s[32:35], s57 offen sc1
buffer_load_dwordx4 v[180:183], v38, s[32:35], s57 offen offset:1024 sc1
buffer_load_dwordx4 v[184:187], v39, s[32:35], s57 offen offset:1024 sc1
s_add_u32 s57, s57, 2048
s_and_b32 s57, s57, 0x7fff
s_waitcnt vmcnt(6) lgkmcnt(8)
v_mfma_f32_16x16x32_bf16 v[60:63], v[220:223], v[156:159], v[60:63]
buffer_load_dwordx4 v[188:191], v38, s[32:35], s57 offen sc1
v_mfma_f32_16x16x32_bf16 v[76:79], v[220:223], v[160:163], v[76:79]
ds_read_b64_tr_b16 v[100:101], v10 offset:8192
ds_read_b64_tr_b16 v[102:103], v10 offset:8704
v_mfma_f32_16x16x32_bf16 v[64:67], v[224:227], v[156:159], v[64:67]
ds_read_b64_tr_b16 v[104:105], v11 offset:8192
ds_read_b64_tr_b16 v[106:107], v11 offset:8704
v_mfma_f32_16x16x32_bf16 v[80:83], v[224:227], v[160:163], v[80:83]
buffer_load_dwordx4 v[192:195], v39, s[32:35], s57 offen sc1
v_mfma_f32_16x16x32_bf16 v[68:71], v[228:231], v[156:159], v[68:71]
ds_read_b64_tr_b16 v[108:109], v12 offset:8192
ds_read_b64_tr_b16 v[110:111], v12 offset:8704
v_mfma_f32_16x16x32_bf16 v[84:87], v[228:231], v[160:163], v[84:87]
ds_read_b64_tr_b16 v[112:113], v13 offset:8192
ds_read_b64_tr_b16 v[114:115], v13 offset:8704
v_mfma_f32_16x16x32_bf16 v[72:75], v[232:235], v[156:159], v[72:75]
v_mfma_f32_16x16x32_bf16 v[88:91], v[232:235], v[160:163], v[88:91]
s_waitcnt vmcnt(6) lgkmcnt(8)
v_mfma_f32_16x16x32_bf16 v[60:63], v[236:239], v[164:167], v[60:63]
buffer_load_dwordx4 v[196:199], v38, s[32:35], s57 offen offset:1024 sc1
v_mfma_f32_16x16x32_bf16 v[76:79], v[236:239], v[168:171], v[76:79]
ds_read_b64_tr_b16 v[220:221], v10 offset:12288
ds_read_b64_tr_b16 v[222:223], v10 offset:12800
v_mfma_f32_16x16x32_bf16 v[64:67], v[240:243], v[164:167], v[64:67]
ds_read_b64_tr_b16 v[224:225], v11 offset:12288
ds_read_b64_tr_b16 v[226:227], v11 offset:12800
v_mfma_f32_16x16x32_bf16 v[80:83], v[240:243], v[168:171], v[80:83]
buffer_load_dwordx4 v[200:203], v39, s[32:35], s57 offen offset:1024 sc1
v_mfma_f32_16x16x32_bf16 v[68:71], v[244:247], v[164:167], v[68:71]
ds_read_b64_tr_b16 v[228:229], v12 offset:12288
ds_read_b64_tr_b16 v[230:231], v12 offset:12800
v_mfma_f32_16x16x32_bf16 v[84:87], v[244:247], v[168:171], v[84:87]
ds_read_b64_tr_b16 v[232:233], v13 offset:12288
ds_read_b64_tr_b16 v[234:235], v13 offset:12800
v_mfma_f32_16x16x32_bf16 v[72:75], v[248:251], v[164:167], v[72:75]
s_add_u32 s57, s57, 2048
s_and_b32 s57, s57, 0x7fff
v_mfma_f32_16x16x32_bf16 v[88:91], v[248:251], v[168:171], v[88:91]
s_waitcnt vmcnt(6) lgkmcnt(8)
v_mfma_f32_16x16x32_bf16 v[60:63], v[100:103], v[172:175], v[60:63]
buffer_load_dwordx4 v[204:207], v38, s[32:35], s57 offen sc1
v_mfma_f32_16x16x32_bf16 v[76:79], v[100:103], v[176:179], v[76:79]
ds_read_b64_tr_b16 v[236:237], v10 offset:16384
ds_read_b64_tr_b16 v[238:239], v10 offset:16896
v_mfma_f32_16x16x32_bf16 v[64:67], v[104:107], v[172:175], v[64:67]
ds_read_b64_tr_b16 v[240:241], v11 offset:16384
ds_read_b64_tr_b16 v[242:243], v11 offset:16896
v_mfma_f32_16x16x32_bf16 v[80:83], v[104:107], v[176:179], v[80:83]
buffer_load_dwordx4 v[208:211], v39, s[32:35], s57 offen sc1
v_mfma_f32_16x16x32_bf16 v[68:71], v[108:111], v[172:175], v[68:71]
ds_read_b64_tr_b16 v[244:245], v12 offset:16384
ds_read_b64_tr_b16 v[246:247], v12 offset:16896
v_mfma_f32_16x16x32_bf16 v[84:87], v[108:111], v[176:179], v[84:87]
ds_read_b64_tr_b16 v[248:249], v13 offset:16384
ds_read_b64_tr_b16 v[250:251], v13 offset:16896
v_mfma_f32_16x16x32_bf16 v[72:75], v[112:115], v[172:175], v[72:75]
v_mfma_f32_16x16x32_bf16 v[88:91], v[112:115], v[176:179], v[88:91]
s_waitcnt vmcnt(6) lgkmcnt(8)
v_mfma_f32_16x16x32_bf16 v[60:63], v[220:223], v[180:183], v[60:63]
buffer_load_dwordx4 v[212:215], v38, s[32:35], s57 offen offset:1024 sc1
v_mfma_f32_16x16x32_bf16 v[76:79], v[220:223], v[184:187], v[76:79]
ds_read_b64_tr_b16 v[100:101], v10 offset:20480
ds_read_b64_tr_b16 v[102:103], v10 offset:20992
v_mfma_f32_16x16x32_bf16 v[64:67], v[224:227], v[180:183], v[64:67]
ds_read_b64_tr_b16 v[104:105], v11 offset:20480
ds_read_b64_tr_b16 v[106:107], v11 offset:20992
v_mfma_f32_16x16x32_bf16 v[80:83], v[224:227], v[184:187], v[80:83]
buffer_load_dwordx4 v[216:219], v39, s[32:35], s57 offen offset:1024 sc1
v_mfma_f32_16x16x32_bf16 v[68:71], v[228:231], v[180:183], v[68:71]
ds_read_b64_tr_b16 v[108:109], v12 offset:20480
ds_read_b64_tr_b16 v[110:111], v12 offset:20992
v_mfma_f32_16x16x32_bf16 v[84:87], v[228:231], v[184:187], v[84:87]
ds_read_b64_tr_b16 v[112:113], v13 offset:20480
ds_read_b64_tr_b16 v[114:115], v13 offset:20992
v_mfma_f32_16x16x32_bf16 v[72:75], v[232:235], v[180:183], v[72:75]
s_add_u32 s57, s57, 2048
s_and_b32 s57, s57, 0x7fff
v_mfma_f32_16x16x32_bf16 v[88:91], v[232:235], v[184:187], v[88:91]
s_waitcnt vmcnt(6) lgkmcnt(8)
v_mfma_f32_16x16x32_bf16 v[60:63], v[236:239], v[188:191], v[60:63]
buffer_load_dwordx4 v[156:159], v38, s[32:35], s57 offen sc1
v_mfma_f32_16x16x32_bf16 v[76:79], v[236:239], v[192:195], v[76:79]
ds_read_b64_tr_b16 v[220:221], v10 offset:24576
ds_read_b64_tr_b16 v[222:223], v10 offset:25088
v_mfma_f32_16x16x32_bf16 v[64:67], v[240:243], v[188:191], v[64:67]
ds_read_b64_tr_b16 v[224:225], v11 offset:24576
ds_read_b64_tr_b16 v[226:227], v11 offset:25088
v_mfma_f32_16x16x32_bf16 v[80:83], v[240:243], v[192:195], v[80:83]
buffer_load_dwordx4 v[160:163], v39, s[32:35], s57 offen sc1
v_mfma_f32_16x16x32_bf16 v[68:71], v[244:247], v[188:191], v[68:71]
ds_read_b64_tr_b16 v[228:229], v12 offset:24576
ds_read_b64_tr_b16 v[230:231], v12 offset:25088
v_mfma_f32_16x16x32_bf16 v[84:87], v[244:247], v[192:195], v[84:87]
ds_read_b64_tr_b16 v[232:233], v13 offset:24576
ds_read_b64_tr_b16 v[234:235], v13 offset:25088
v_mfma_f32_16x16x32_bf16 v[72:75], v[248:251], v[188:191], v[72:75]
v_mfma_f32_16x16x32_bf16 v[88:91], v[248:251], v[192:195], v[88:91]
s_waitcnt vmcnt(6) lgkmcnt(8)
v_mfma_f32_16x16x32_bf16 v[60:63], v[100:103], v[196:199], v[60:63]
buffer_load_dwordx4 v[164:167], v38, s[32:35], s57 offen offset:1024 sc1
v_mfma_f32_16x16x32_bf16 v[76:79], v[100:103], v[200:203], v[76:79]
ds_read_b64_tr_b16 v[236:237], v10 offset:28672
ds_read_b64_tr_b16 v[238:239], v10 offset:29184
v_mfma_f32_16x16x32_bf16 v[64:67], v[104:107], v[196:199], v[64:67]
ds_read_b64_tr_b16 v[240:241], v11 offset:28672
ds_read_b64_tr_b16 v[242:243], v11 offset:29184
v_mfma_f32_16x16x32_bf16 v[80:83], v[104:107], v[200:203], v[80:83]
buffer_load_dwordx4 v[168:171], v39, s[32:35], s57 offen offset:1024 sc1
v_mfma_f32_16x16x32_bf16 v[68:71], v[108:111], v[196:199], v[68:71]
ds_read_b64_tr_b16 v[244:245], v12 offset:28672
ds_read_b64_tr_b16 v[246:247], v12 offset:29184
v_mfma_f32_16x16x32_bf16 v[84:87], v[108:111], v[200:203], v[84:87]
ds_read_b64_tr_b16 v[248:249], v13 offset:28672
ds_read_b64_tr_b16 v[250:251], v13 offset:29184
v_mfma_f32_16x16x32_bf16 v[72:75], v[112:115], v[196:199], v[72:75]
s_add_u32 s57, s57, 2048
s_and_b32 s57, s57, 0x7fff
v_mfma_f32_16x16x32_bf16 v[88:91], v[112:115], v[200:203], v[88:91]
s_waitcnt vmcnt(6) lgkmcnt(8)
v_mfma_f32_16x16x32_bf16 v[60:63], v[220:223], v[204:207], v[60:63]
buffer_load_dwordx4 v[172:175], v38, s[32:35], s57 offen sc1
v_mfma_f32_16x16x32_bf16 v[76:79], v[220:223], v[208:211], v[76:79]
ds_read_b64_tr_b16 v[100:101], v10 offset:32768
ds_read_b64_tr_b16 v[102:103], v10 offset:33280
v_mfma_f32_16x16x32_bf16 v[64:67], v[224:227], v[204:207], v[64:67]
ds_read_b64_tr_b16 v[104:105], v11 offset:32768
ds_read_b64_tr_b16 v[106:107], v11 offset:33280
v_mfma_f32_16x16x32_bf16 v[80:83], v[224:227], v[208:211], v[80:83]
buffer_load_dwordx4 v[176:179], v39, s[32:35], s57 offen sc1
v_mfma_f32_16x16x32_bf16 v[68:71], v[228:231], v[204:207], v[68:71]
ds_read_b64_tr_b16 v[108:109], v12 offset:32768
ds_read_b64_tr_b16 v[110:111], v12 offset:33280
v_mfma_f32_16x16x32_bf16 v[84:87], v[228:231], v[208:211], v[84:87]
ds_read_b64_tr_b16 v[112:113], v13 offset:32768
ds_read_b64_tr_b16 v[114:115], v13 offset:33280
v_mfma_f32_16x16x32_bf16 v[72:75], v[232:235], v[204:207], v[72:75]
v_mfma_f32_16x16x32_bf16 v[88:91], v[232:235], v[208:211], v[88:91]
s_waitcnt vmcnt(6) lgkmcnt(8)
v_mfma_f32_16x16x32_bf16 v[60:63], v[236:239], v[212:215], v[60:63]
buffer_load_dwordx4 v[180:183], v38, s[32:35], s57 offen offset:1024 sc1
v_mfma_f32_16x16x32_bf16 v[76:79], v[236:239], v[216:219], v[76:79]
ds_read_b64_tr_b16 v[220:221], v10 offset:36864
ds_read_b64_tr_b16 v[222:223], v10 offset:37376
v_mfma_f32_16x16x32_bf16 v[64:67], v[240:243], v[212:215], v[64:67]
ds_read_b64_tr_b16 v[224:225], v11 offset:36864
ds_read_b64_tr_b16 v[226:227], v11 offset:37376
v_mfma_f32_16x16x32_bf16 v[80:83], v[240:243], v[216:219], v[80:83]
buffer_load_dwordx4 v[184:187], v39, s[32:35], s57 offen offset:1024 sc1
v_mfma_f32_16x16x32_bf16 v[68:71], v[244:247], v[212:215], v[68:71]
ds_read_b64_tr_b16 v[228:229], v12 offset:36864
ds_read_b64_tr_b16 v[230:231], v12 offset:37376
v_mfma_f32_16x16x32_bf16 v[84:87], v[244:247], v[216:219], v[84:87]
ds_read_b64_tr_b16 v[232:233], v13 offset:36864
ds_read_b64_tr_b16 v[234:235], v13 offset:37376
v_mfma_f32_16x16x32_bf16 v[72:75], v[248:251], v[212:215], v[72:75]
s_add_u32 s57, s57, 2048
s_and_b32 s57, s57, 0x7fff
v_mfma_f32_16x16x32_bf16 v[88:91], v[248:251], v[216:219], v[88:91]
s_waitcnt vmcnt(6) lgkmcnt(8)
v_mfma_f32_16x16x32_bf16 v[60:63], v[100:103], v[156:159], v[60:63]
buffer_load_dwordx4 v[188:191], v38, s[32:35], s57 offen sc1
v_mfma_f32_16x16x32_bf16 v[76:79], v[100:103], v[160:163], v[76:79]
ds_read_b64_tr_b16 v[236:237], v10 offset:40960
ds_read_b64_tr_b16 v[238:239], v10 offset:41472
v_mfma_f32_16x16x32_bf16 v[64:67], v[104:107], v[156:159], v[64:67]
ds_read_b64_tr_b16 v[240:241], v11 offset:40960
ds_read_b64_tr_b16 v[242:243], v11 offset:41472
v_mfma_f32_16x16x32_bf16 v[80:83], v[104:107], v[160:163], v[80:83]
buffer_load_dwordx4 v[192:195], v39, s[32:35], s57 offen sc1
v_mfma_f32_16x16x32_bf16 v[68:71], v[108:111], v[156:159], v[68:71]
ds_read_b64_tr_b16 v[244:245], v12 offset:40960
ds_read_b64_tr_b16 v[246:247], v12 offset:41472
v_mfma_f32_16x16x32_bf16 v[84:87], v[108:111], v[160:163], v[84:87]
ds_read_b64_tr_b16 v[248:249], v13 offset:40960
ds_read_b64_tr_b16 v[250:251], v13 offset:41472
v_mfma_f32_16x16x32_bf16 v[72:75], v[112:115], v[156:159], v[72:75]
v_mfma_f32_16x16x32_bf16 v[88:91], v[112:115], v[160:163], v[88:91]
s_waitcnt vmcnt(6) lgkmcnt(8)
v_mfma_f32_16x16x32_bf16 v[60:63], v[220:223], v[164:167], v[60:63]
buffer_load_dwordx4 v[196:199], v38, s[32:35], s57 offen offset:1024 sc1
v_mfma_f32_16x16x32_bf16 v[76:79], v[220:223], v[168:171], v[76:79]
ds_read_b64_tr_b16 v[100:101], v10 offset:45056
ds_read_b64_tr_b16 v[102:103], v10 offset:45568
v_mfma_f32_16x16x32_bf16 v[64:67], v[224:227], v[164:167], v[64:67]
ds_read_b64_tr_b16 v[104:105], v11 offset:45056
ds_read_b64_tr_b16 v[106:107], v11 offset:45568
v_mfma_f32_16x16x32_bf16 v[80:83], v[224:227], v[168:171], v[80:83]
buffer_load_dwordx4 v[200:203], v39, s[32:35], s57 offen offset:1024 sc1
v_mfma_f32_16x16x32_bf16 v[68:71], v[228:231], v[164:167], v[68:71]
ds_read_b64_tr_b16 v[108:109], v12 offset:45056
ds_read_b64_tr_b16 v[110:111], v12 offset:45568
v_mfma_f32_16x16x32_bf16 v[84:87], v[228:231], v[168:171], v[84:87]
ds_read_b64_tr_b16 v[112:113], v13 offset:45056
ds_read_b64_tr_b16 v[114:115], v13 offset:45568
v_mfma_f32_16x16x32_bf16 v[72:75], v[232:235], v[164:167], v[72:75]
s_add_u32 s57, s57, 2048
s_and_b32 s57, s57, 0x7fff
v_mfma_f32_16x16x32_bf16 v[88:91], v[232:235], v[168:171], v[88:91]
s_waitcnt vmcnt(6) lgkmcnt(8)
v_mfma_f32_16x16x32_bf16 v[60:63], v[236:239], v[172:175], v[60:63]
buffer_load_dwordx4 v[204:207], v38, s[32:35], s57 offen sc1
v_mfma_f32_16x16x32_bf16 v[76:79], v[236:239], v[176:179], v[76:79]
ds_read_b64_tr_b16 v[220:221], v10 offset:49152
ds_read_b64_tr_b16 v[222:223], v10 offset:49664
v_mfma_f32_16x16x32_bf16 v[64:67], v[240:243], v[172:175], v[64:67]
ds_read_b64_tr_b16 v[224:225], v11 offset:49152
ds_read_b64_tr_b16 v[226:227], v11 offset:49664
v_mfma_f32_16x16x32_bf16 v[80:83], v[240:243], v[176:179], v[80:83]
buffer_load_dwordx4 v[208:211], v39, s[32:35], s57 offen sc1
v_mfma_f32_16x16x32_bf16 v[68:71], v[244:247], v[172:175], v[68:71]
ds_read_b64_tr_b16 v[228:229], v12 offset:49152
ds_read_b64_tr_b16 v[230:231], v12 offset:49664
v_mfma_f32_16x16x32_bf16 v[84:87], v[244:247], v[176:179], v[84:87]
ds_read_b64_tr_b16 v[232:233], v13 offset:49152
ds_read_b64_tr_b16 v[234:235], v13 offset:49664
v_mfma_f32_16x16x32_bf16 v[72:75], v[248:251], v[172:175], v[72:75]
v_mfma_f32_16x16x32_bf16 v[88:91], v[248:251], v[176:179], v[88:91]
s_waitcnt vmcnt(6) lgkmcnt(8)
v_mfma_f32_16x16x32_bf16 v[60:63], v[100:103], v[180:183], v[60:63]
buffer_load_dwordx4 v[212:215], v38, s[32:35], s57 offen offset:1024 sc1
v_mfma_f32_16x16x32_bf16 v[76:79], v[100:103], v[184:187], v[76:79]
ds_read_b64_tr_b16 v[236:237], v10 offset:53248
ds_read_b64_tr_b16 v[238:239], v10 offset:53760
v_mfma_f32_16x16x32_bf16 v[64:67], v[104:107], v[180:183], v[64:67]
ds_read_b64_tr_b16 v[240:241], v11 offset:53248
ds_read_b64_tr_b16 v[242:243], v11 offset:53760
v_mfma_f32_16x16x32_bf16 v[80:83], v[104:107], v[184:187], v[80:83]
buffer_load_dwordx4 v[216:219], v39, s[32:35], s57 offen offset:1024 sc1
v_mfma_f32_16x16x32_bf16 v[68:71], v[108:111], v[180:183], v[68:71]
ds_read_b64_tr_b16 v[244:245], v12 offset:53248
ds_read_b64_tr_b16 v[246:247], v12 offset:53760
v_mfma_f32_16x16x32_bf16 v[84:87], v[108:111], v[184:187], v[84:87]
ds_read_b64_tr_b16 v[248:249], v13 offset:53248
ds_read_b64_tr_b16 v[250:251], v13 offset:53760
v_mfma_f32_16x16x32_bf16 v[72:75], v[112:115], v[180:183], v[72:75]
s_add_u32 s57, s57, 2048
s_and_b32 s57, s57, 0x7fff
v_mfma_f32_16x16x32_bf16 v[88:91], v[112:115], v[184:187], v[88:91]
s_waitcnt vmcnt(6) lgkmcnt(8)
v_mfma_f32_16x16x32_bf16 v[60:63], v[220:223], v[188:191], v[60:63]
buffer_load_dwordx4 v[156:159], v38, s[32:35], s57 offen sc1
v_mfma_f32_16x16x32_bf16 v[76:79], v[220:223], v[192:195], v[76:79]
ds_read_b64_tr_b16 v[100:101], v10 offset:57344
ds_read_b64_tr_b16 v[102:103], v10 offset:57856
v_mfma_f32_16x16x32_bf16 v[64:67], v[224:227], v[188:191], v[64:67]
ds_read_b64_tr_b16 v[104:105], v11 offset:57344
ds_read_b64_tr_b16 v[106:107], v11 offset:57856
v_mfma_f32_16x16x32_bf16 v[80:83], v[224:227], v[192:195], v[80:83]
buffer_load_dwordx4 v[160:163], v39, s[32:35], s57 offen sc1
v_mfma_f32_16x16x32_bf16 v[68:71], v[228:231], v[188:191], v[68:71]
ds_read_b64_tr_b16 v[108:109], v12 offset:57344
ds_read_b64_tr_b16 v[110:111], v12 offset:57856
v_mfma_f32_16x16x32_bf16 v[84:87], v[228:231], v[192:195], v[84:87]
ds_read_b64_tr_b16 v[112:113], v13 offset:57344
ds_read_b64_tr_b16 v[114:115], v13 offset:57856
v_mfma_f32_16x16x32_bf16 v[72:75], v[232:235], v[188:191], v[72:75]
v_mfma_f32_16x16x32_bf16 v[88:91], v[232:235], v[192:195], v[88:91]
s_waitcnt vmcnt(6) lgkmcnt(8)
v_mfma_f32_16x16x32_bf16 v[60:63], v[236:239], v[196:199], v[60:63]
buffer_load_dwordx4 v[164:167], v38, s[32:35], s57 offen offset:1024 sc1
v_mfma_f32_16x16x32_bf16 v[76:79], v[236:239], v[200:203], v[76:79]
ds_read_b64_tr_b16 v[220:221], v10 offset:61440
ds_read_b64_tr_b16 v[222:223], v10 offset:61952
v_mfma_f32_16x16x32_bf16 v[64:67], v[240:243], v[196:199], v[64:67]
ds_read_b64_tr_b16 v[224:225], v11 offset:61440
ds_read_b64_tr_b16 v[226:227], v11 offset:61952
v_mfma_f32_16x16x32_bf16 v[80:83], v[240:243], v[200:203], v[80:83]
buffer_load_dwordx4 v[168:171], v39, s[32:35], s57 offen offset:1024 sc1
v_mfma_f32_16x16x32_bf16 v[68:71], v[244:247], v[196:199], v[68:71]
ds_read_b64_tr_b16 v[228:229], v12 offset:61440
ds_read_b64_tr_b16 v[230:231], v12 offset:61952
v_mfma_f32_16x16x32_bf16 v[84:87], v[244:247], v[200:203], v[84:87]
ds_read_b64_tr_b16 v[232:233], v13 offset:61440
ds_read_b64_tr_b16 v[234:235], v13 offset:61952
v_mfma_f32_16x16x32_bf16 v[72:75], v[248:251], v[196:199], v[72:75]
s_add_u32 s57, s57, 2048
s_and_b32 s57, s57, 0x7fff
v_mfma_f32_16x16x32_bf16 v[88:91], v[248:251], v[200:203], v[88:91]
s_waitcnt vmcnt(6) lgkmcnt(8)
v_mfma_f32_16x16x32_bf16 v[60:63], v[100:103], v[204:207], v[60:63]
buffer_load_dwordx4 v[172:175], v38, s[32:35], s57 offen sc1
v_mfma_f32_16x16x32_bf16 v[76:79], v[100:103], v[208:211], v[76:79]
ds_read_b64_tr_b16 v[236:237], v14 offset:0
ds_read_b64_tr_b16 v[238:239], v14 offset:512
v_mfma_f32_16x16x32_bf16 v[64:67], v[104:107], v[204:207], v[64:67]
ds_read_b64_tr_b16 v[240:241], v15 offset:0
ds_read_b64_tr_b16 v[242:243], v15 offset:512
v_mfma_f32_16x16x32_bf16 v[80:83], v[104:107], v[208:211], v[80:83]
buffer_load_dwordx4 v[176:179], v39, s[32:35], s57 offen sc1
v_mfma_f32_16x16x32_bf16 v[68:71], v[108:111], v[204:207], v[68:71]
ds_read_b64_tr_b16 v[244:245], v16 offset:0
ds_read_b64_tr_b16 v[246:247], v16 offset:512
v_mfma_f32_16x16x32_bf16 v[84:87], v[108:111], v[208:211], v[84:87]
ds_read_b64_tr_b16 v[248:249], v17 offset:0
ds_read_b64_tr_b16 v[250:251], v17 offset:512
v_mfma_f32_16x16x32_bf16 v[72:75], v[112:115], v[204:207], v[72:75]
v_mfma_f32_16x16x32_bf16 v[88:91], v[112:115], v[208:211], v[88:91]
s_waitcnt vmcnt(6) lgkmcnt(8)
v_mfma_f32_16x16x32_bf16 v[60:63], v[220:223], v[212:215], v[60:63]
buffer_load_dwordx4 v[180:183], v38, s[32:35], s57 offen offset:1024 sc1
v_mfma_f32_16x16x32_bf16 v[76:79], v[220:223], v[216:219], v[76:79]
ds_read_b64_tr_b16 v[100:101], v14 offset:4096
ds_read_b64_tr_b16 v[102:103], v14 offset:4608
v_mfma_f32_16x16x32_bf16 v[64:67], v[224:227], v[212:215], v[64:67]
ds_read_b64_tr_b16 v[104:105], v15 offset:4096
ds_read_b64_tr_b16 v[106:107], v15 offset:4608
v_mfma_f32_16x16x32_bf16 v[80:83], v[224:227], v[216:219], v[80:83]
buffer_load_dwordx4 v[184:187], v39, s[32:35], s57 offen offset:1024 sc1
v_mfma_f32_16x16x32_bf16 v[68:71], v[228:231], v[212:215], v[68:71]
ds_read_b64_tr_b16 v[108:109], v16 offset:4096
ds_read_b64_tr_b16 v[110:111], v16 offset:4608
v_mfma_f32_16x16x32_bf16 v[84:87], v[228:231], v[216:219], v[84:87]
ds_read_b64_tr_b16 v[112:113], v17 offset:4096
ds_read_b64_tr_b16 v[114:115], v17 offset:4608
v_mfma_f32_16x16x32_bf16 v[72:75], v[232:235], v[212:215], v[72:75]
s_add_u32 s57, s57, 2048
s_and_b32 s57, s57, 0x7fff
v_mfma_f32_16x16x32_bf16 v[88:91], v[232:235], v[216:219], v[88:91]
s_waitcnt vmcnt(6) lgkmcnt(8)
v_mfma_f32_16x16x32_bf16 v[60:63], v[236:239], v[156:159], v[60:63]
buffer_load_dwordx4 v[188:191], v38, s[32:35], s57 offen sc1
v_mfma_f32_16x16x32_bf16 v[76:79], v[236:239], v[160:163], v[76:79]
ds_read_b64_tr_b16 v[220:221], v14 offset:8192
ds_read_b64_tr_b16 v[222:223], v14 offset:8704
v_mfma_f32_16x16x32_bf16 v[64:67], v[240:243], v[156:159], v[64:67]
ds_read_b64_tr_b16 v[224:225], v15 offset:8192
ds_read_b64_tr_b16 v[226:227], v15 offset:8704
v_mfma_f32_16x16x32_bf16 v[80:83], v[240:243], v[160:163], v[80:83]
buffer_load_dwordx4 v[192:195], v39, s[32:35], s57 offen sc1
v_mfma_f32_16x16x32_bf16 v[68:71], v[244:247], v[156:159], v[68:71]
ds_read_b64_tr_b16 v[228:229], v16 offset:8192
ds_read_b64_tr_b16 v[230:231], v16 offset:8704
v_mfma_f32_16x16x32_bf16 v[84:87], v[244:247], v[160:163], v[84:87]
ds_read_b64_tr_b16 v[232:233], v17 offset:8192
ds_read_b64_tr_b16 v[234:235], v17 offset:8704
v_mfma_f32_16x16x32_bf16 v[72:75], v[248:251], v[156:159], v[72:75]
v_mfma_f32_16x16x32_bf16 v[88:91], v[248:251], v[160:163], v[88:91]
s_waitcnt vmcnt(6) lgkmcnt(8)
v_mfma_f32_16x16x32_bf16 v[60:63], v[100:103], v[164:167], v[60:63]
buffer_load_dwordx4 v[196:199], v38, s[32:35], s57 offen offset:1024 sc1
v_mfma_f32_16x16x32_bf16 v[76:79], v[100:103], v[168:171], v[76:79]
ds_read_b64_tr_b16 v[236:237], v14 offset:12288
ds_read_b64_tr_b16 v[238:239], v14 offset:12800
v_mfma_f32_16x16x32_bf16 v[64:67], v[104:107], v[164:167], v[64:67]
ds_read_b64_tr_b16 v[240:241], v15 offset:12288
ds_read_b64_tr_b16 v[242:243], v15 offset:12800
v_mfma_f32_16x16x32_bf16 v[80:83], v[104:107], v[168:171], v[80:83]
buffer_load_dwordx4 v[200:203], v39, s[32:35], s57 offen offset:1024 sc1
v_mfma_f32_16x16x32_bf16 v[68:71], v[108:111], v[164:167], v[68:71]
ds_read_b64_tr_b16 v[244:245], v16 offset:12288
ds_read_b64_tr_b16 v[246:247], v16 offset:12800
v_mfma_f32_16x16x32_bf16 v[84:87], v[108:111], v[168:171], v[84:87]
ds_read_b64_tr_b16 v[248:249], v17 offset:12288
ds_read_b64_tr_b16 v[250:251], v17 offset:12800
v_mfma_f32_16x16x32_bf16 v[72:75], v[112:115], v[164:167], v[72:75]
s_add_u32 s57, s57, 2048
s_and_b32 s57, s57, 0x7fff
v_mfma_f32_16x16x32_bf16 v[88:91], v[112:115], v[168:171], v[88:91]
s_waitcnt vmcnt(6) lgkmcnt(8)
v_mfma_f32_16x16x32_bf16 v[60:63], v[220:223], v[172:175], v[60:63]
buffer_load_dwordx4 v[204:207], v38, s[32:35], s57 offen sc1
v_mfma_f32_16x16x32_bf16 v[76:79], v[220:223], v[176:179], v[76:79]
ds_read_b64_tr_b16 v[100:101], v14 offset:16384
ds_read_b64_tr_b16 v[102:103], v14 offset:16896
v_mfma_f32_16x16x32_bf16 v[64:67], v[224:227], v[172:175], v[64:67]
ds_read_b64_tr_b16 v[104:105], v15 offset:16384
ds_read_b64_tr_b16 v[106:107], v15 offset:16896
v_mfma_f32_16x16x32_bf16 v[80:83], v[224:227], v[176:179], v[80:83]
buffer_load_dwordx4 v[208:211], v39, s[32:35], s57 offen sc1
v_mfma_f32_16x16x32_bf16 v[68:71], v[228:231], v[172:175], v[68:71]
ds_read_b64_tr_b16 v[108:109], v16 offset:16384
ds_read_b64_tr_b16 v[110:111], v16 offset:16896
v_mfma_f32_16x16x32_bf16 v[84:87], v[228:231], v[176:179], v[84:87]
ds_read_b64_tr_b16 v[112:113], v17 offset:16384
ds_read_b64_tr_b16 v[114:115], v17 offset:16896
v_mfma_f32_16x16x32_bf16 v[72:75], v[232:235], v[172:175], v[72:75]
v_mfma_f32_16x16x32_bf16 v[88:91], v[232:235], v[176:179], v[88:91]
s_waitcnt vmcnt(6) lgkmcnt(8)
v_mfma_f32_16x16x32_bf16 v[60:63], v[236:239], v[180:183], v[60:63]
buffer_load_dwordx4 v[212:215], v38, s[32:35], s57 offen offset:1024 sc1
v_mfma_f32_16x16x32_bf16 v[76:79], v[236:239], v[184:187], v[76:79]
ds_read_b64_tr_b16 v[220:221], v14 offset:20480
ds_read_b64_tr_b16 v[222:223], v14 offset:20992
v_mfma_f32_16x16x32_bf16 v[64:67], v[240:243], v[180:183], v[64:67]
ds_read_b64_tr_b16 v[224:225], v15 offset:20480
ds_read_b64_tr_b16 v[226:227], v15 offset:20992
v_mfma_f32_16x16x32_bf16 v[80:83], v[240:243], v[184:187], v[80:83]
buffer_load_dwordx4 v[216:219], v39, s[32:35], s57 offen offset:1024 sc1
v_mfma_f32_16x16x32_bf16 v[68:71], v[244:247], v[180:183], v[68:71]
ds_read_b64_tr_b16 v[228:229], v16 offset:20480
ds_read_b64_tr_b16 v[230:231], v16 offset:20992
v_mfma_f32_16x16x32_bf16 v[84:87], v[244:247], v[184:187], v[84:87]
ds_read_b64_tr_b16 v[232:233], v17 offset:20480
ds_read_b64_tr_b16 v[234:235], v17 offset:20992
v_mfma_f32_16x16x32_bf16 v[72:75], v[248:251], v[180:183], v[72:75]
s_add_u32 s57, s57, 2048
s_and_b32 s57, s57, 0x7fff
v_mfma_f32_16x16x32_bf16 v[88:91], v[248:251], v[184:187], v[88:91]
s_waitcnt vmcnt(6) lgkmcnt(8)
v_mfma_f32_16x16x32_bf16 v[60:63], v[100:103], v[188:191], v[60:63]
buffer_load_dwordx4 v[156:159], v38, s[32:35], s57 offen sc1
v_mfma_f32_16x16x32_bf16 v[76:79], v[100:103], v[192:195], v[76:79]
ds_read_b64_tr_b16 v[236:237], v14 offset:24576
ds_read_b64_tr_b16 v[238:239], v14 offset:25088
v_mfma_f32_16x16x32_bf16 v[64:67], v[104:107], v[188:191], v[64:67]
ds_read_b64_tr_b16 v[240:241], v15 offset:24576
ds_read_b64_tr_b16 v[242:243], v15 offset:25088
v_mfma_f32_16x16x32_bf16 v[80:83], v[104:107], v[192:195], v[80:83]
buffer_load_dwordx4 v[160:163], v39, s[32:35], s57 offen sc1
v_mfma_f32_16x16x32_bf16 v[68:71], v[108:111], v[188:191], v[68:71]
ds_read_b64_tr_b16 v[244:245], v16 offset:24576
ds_read_b64_tr_b16 v[246:247], v16 offset:25088
v_mfma_f32_16x16x32_bf16 v[84:87], v[108:111], v[192:195], v[84:87]
ds_read_b64_tr_b16 v[248:249], v17 offset:24576
ds_read_b64_tr_b16 v[250:251], v17 offset:25088
v_mfma_f32_16x16x32_bf16 v[72:75], v[112:115], v[188:191], v[72:75]
v_mfma_f32_16x16x32_bf16 v[88:91], v[112:115], v[192:195], v[88:91]
s_waitcnt vmcnt(6) lgkmcnt(8)
v_mfma_f32_16x16x32_bf16 v[60:63], v[220:223], v[196:199], v[60:63]
buffer_load_dwordx4 v[164:167], v38, s[32:35], s57 offen offset:1024 sc1
v_mfma_f32_16x16x32_bf16 v[76:79], v[220:223], v[200:203], v[76:79]
ds_read_b64_tr_b16 v[100:101], v14 offset:28672
ds_read_b64_tr_b16 v[102:103], v14 offset:29184
v_mfma_f32_16x16x32_bf16 v[64:67], v[224:227], v[196:199], v[64:67]
ds_read_b64_tr_b16 v[104:105], v15 offset:28672
ds_read_b64_tr_b16 v[106:107], v15 offset:29184
v_mfma_f32_16x16x32_bf16 v[80:83], v[224:227], v[200:203], v[80:83]
buffer_load_dwordx4 v[168:171], v39, s[32:35], s57 offen offset:1024 sc1
v_mfma_f32_16x16x32_bf16 v[68:71], v[228:231], v[196:199], v[68:71]
ds_read_b64_tr_b16 v[108:109], v16 offset:28672
ds_read_b64_tr_b16 v[110:111], v16 offset:29184
v_mfma_f32_16x16x32_bf16 v[84:87], v[228:231], v[200:203], v[84:87]
ds_read_b64_tr_b16 v[112:113], v17 offset:28672
ds_read_b64_tr_b16 v[114:115], v17 offset:29184
v_mfma_f32_16x16x32_bf16 v[72:75], v[232:235], v[196:199], v[72:75]
s_add_u32 s57, s57, 2048
s_and_b32 s57, s57, 0x7fff
v_mfma_f32_16x16x32_bf16 v[88:91], v[232:235], v[200:203], v[88:91]
s_waitcnt vmcnt(6) lgkmcnt(8)
v_mfma_f32_16x16x32_bf16 v[60:63], v[236:239], v[204:207], v[60:63]
buffer_load_dwordx4 v[172:175], v38, s[32:35], s57 offen sc1
v_mfma_f32_16x16x32_bf16 v[76:79], v[236:239], v[208:211], v[76:79]
ds_read_b64_tr_b16 v[220:221], v14 offset:32768
ds_read_b64_tr_b16 v[222:223], v14 offset:33280
v_mfma_f32_16x16x32_bf16 v[64:67], v[240:243], v[204:207], v[64:67]
ds_read_b64_tr_b16 v[224:225], v15 offset:32768
ds_read_b64_tr_b16 v[226:227], v15 offset:33280
v_mfma_f32_16x16x32_bf16 v[80:83], v[240:243], v[208:211], v[80:83]
buffer_load_dwordx4 v[176:179], v39, s[32:35], s57 offen sc1
v_mfma_f32_16x16x32_bf16 v[68:71], v[244:247], v[204:207], v[68:71]
ds_read_b64_tr_b16 v[228:229], v16 offset:32768
ds_read_b64_tr_b16 v[230:231], v16 offset:33280
v_mfma_f32_16x16x32_bf16 v[84:87], v[244:247], v[208:211], v[84:87]
ds_read_b64_tr_b16 v[232:233], v17 offset:32768
ds_read_b64_tr_b16 v[234:235], v17 offset:33280
v_mfma_f32_16x16x32_bf16 v[72:75], v[248:251], v[204:207], v[72:75]
v_mfma_f32_16x16x32_bf16 v[88:91], v[248:251], v[208:211], v[88:91]
s_waitcnt vmcnt(6) lgkmcnt(8)
v_mfma_f32_16x16x32_bf16 v[60:63], v[100:103], v[212:215], v[60:63]
buffer_load_dwordx4 v[180:183], v38, s[32:35], s57 offen offset:1024 sc1
v_mfma_f32_16x16x32_bf16 v[76:79], v[100:103], v[216:219], v[76:79]
ds_read_b64_tr_b16 v[236:237], v14 offset:36864
ds_read_b64_tr_b16 v[238:239], v14 offset:37376
v_mfma_f32_16x16x32_bf16 v[64:67], v[104:107], v[212:215], v[64:67]
ds_read_b64_tr_b16 v[240:241], v15 offset:36864
ds_read_b64_tr_b16 v[242:243], v15 offset:37376
v_mfma_f32_16x16x32_bf16 v[80:83], v[104:107], v[216:219], v[80:83]
buffer_load_dwordx4 v[184:187], v39, s[32:35], s57 offen offset:1024 sc1
v_mfma_f32_16x16x32_bf16 v[68:71], v[108:111], v[212:215], v[68:71]
ds_read_b64_tr_b16 v[244:245], v16 offset:36864
ds_read_b64_tr_b16 v[246:247], v16 offset:37376
v_mfma_f32_16x16x32_bf16 v[84:87], v[108:111], v[216:219], v[84:87]
ds_read_b64_tr_b16 v[248:249], v17 offset:36864
ds_read_b64_tr_b16 v[250:251], v17 offset:37376
v_mfma_f32_16x16x32_bf16 v[72:75], v[112:115], v[212:215], v[72:75]
s_add_u32 s57, s57, 2048
s_and_b32 s57, s57, 0x7fff
v_mfma_f32_16x16x32_bf16 v[88:91], v[112:115], v[216:219], v[88:91]
s_waitcnt vmcnt(6) lgkmcnt(8)
v_mfma_f32_16x16x32_bf16 v[60:63], v[220:223], v[156:159], v[60:63]
buffer_load_dwordx4 v[188:191], v38, s[32:35], s57 offen sc1
v_mfma_f32_16x16x32_bf16 v[76:79], v[220:223], v[160:163], v[76:79]
ds_read_b64_tr_b16 v[100:101], v14 offset:40960
ds_read_b64_tr_b16 v[102:103], v14 offset:41472
v_mfma_f32_16x16x32_bf16 v[64:67], v[224:227], v[156:159], v[64:67]
ds_read_b64_tr_b16 v[104:105], v15 offset:40960
ds_read_b64_tr_b16 v[106:107], v15 offset:41472
v_mfma_f32_16x16x32_bf16 v[80:83], v[224:227], v[160:163], v[80:83]
buffer_load_dwordx4 v[192:195], v39, s[32:35], s57 offen sc1
v_mfma_f32_16x16x32_bf16 v[68:71], v[228:231], v[156:159], v[68:71]
ds_read_b64_tr_b16 v[108:109], v16 offset:40960
ds_read_b64_tr_b16 v[110:111], v16 offset:41472
v_mfma_f32_16x16x32_bf16 v[84:87], v[228:231], v[160:163], v[84:87]
ds_read_b64_tr_b16 v[112:113], v17 offset:40960
ds_read_b64_tr_b16 v[114:115], v17 offset:41472
v_mfma_f32_16x16x32_bf16 v[72:75], v[232:235], v[156:159], v[72:75]
v_mfma_f32_16x16x32_bf16 v[88:91], v[232:235], v[160:163], v[88:91]
s_waitcnt vmcnt(6) lgkmcnt(8)
v_mfma_f32_16x16x32_bf16 v[60:63], v[236:239], v[164:167], v[60:63]
buffer_load_dwordx4 v[196:199], v38, s[32:35], s57 offen offset:1024 sc1
v_mfma_f32_16x16x32_bf16 v[76:79], v[236:239], v[168:171], v[76:79]
ds_read_b64_tr_b16 v[220:221], v14 offset:45056
ds_read_b64_tr_b16 v[222:223], v14 offset:45568
v_mfma_f32_16x16x32_bf16 v[64:67], v[240:243], v[164:167], v[64:67]
ds_read_b64_tr_b16 v[224:225], v15 offset:45056
ds_read_b64_tr_b16 v[226:227], v15 offset:45568
v_mfma_f32_16x16x32_bf16 v[80:83], v[240:243], v[168:171], v[80:83]
buffer_load_dwordx4 v[200:203], v39, s[32:35], s57 offen offset:1024 sc1
v_mfma_f32_16x16x32_bf16 v[68:71], v[244:247], v[164:167], v[68:71]
ds_read_b64_tr_b16 v[228:229], v16 offset:45056
ds_read_b64_tr_b16 v[230:231], v16 offset:45568
v_mfma_f32_16x16x32_bf16 v[84:87], v[244:247], v[168:171], v[84:87]
ds_read_b64_tr_b16 v[232:233], v17 offset:45056
ds_read_b64_tr_b16 v[234:235], v17 offset:45568
v_mfma_f32_16x16x32_bf16 v[72:75], v[248:251], v[164:167], v[72:75]
s_add_u32 s57, s57, 2048
s_and_b32 s57, s57, 0x7fff
v_mfma_f32_16x16x32_bf16 v[88:91], v[248:251], v[168:171], v[88:91]
s_waitcnt vmcnt(6) lgkmcnt(8)
v_mfma_f32_16x16x32_bf16 v[60:63], v[100:103], v[172:175], v[60:63]
buffer_load_dwordx4 v[204:207], v38, s[32:35], s57 offen sc1
v_mfma_f32_16x16x32_bf16 v[76:79], v[100:103], v[176:179], v[76:79]
ds_read_b64_tr_b16 v[236:237], v14 offset:49152
ds_read_b64_tr_b16 v[238:239], v14 offset:49664
v_mfma_f32_16x16x32_bf16 v[64:67], v[104:107], v[172:175], v[64:67]
ds_read_b64_tr_b16 v[240:241], v15 offset:49152
ds_read_b64_tr_b16 v[242:243], v15 offset:49664
v_mfma_f32_16x16x32_bf16 v[80:83], v[104:107], v[176:179], v[80:83]
buffer_load_dwordx4 v[208:211], v39, s[32:35], s57 offen sc1
v_mfma_f32_16x16x32_bf16 v[68:71], v[108:111], v[172:175], v[68:71]
ds_read_b64_tr_b16 v[244:245], v16 offset:49152
ds_read_b64_tr_b16 v[246:247], v16 offset:49664
v_mfma_f32_16x16x32_bf16 v[84:87], v[108:111], v[176:179], v[84:87]
ds_read_b64_tr_b16 v[248:249], v17 offset:49152
ds_read_b64_tr_b16 v[250:251], v17 offset:49664
v_mfma_f32_16x16x32_bf16 v[72:75], v[112:115], v[172:175], v[72:75]
v_mfma_f32_16x16x32_bf16 v[88:91], v[112:115], v[176:179], v[88:91]
s_waitcnt vmcnt(6) lgkmcnt(8)
v_mfma_f32_16x16x32_bf16 v[60:63], v[220:223], v[180:183], v[60:63]
buffer_load_dwordx4 v[212:215], v38, s[32:35], s57 offen offset:1024 sc1
v_mfma_f32_16x16x32_bf16 v[76:79], v[220:223], v[184:187], v[76:79]
ds_read_b64_tr_b16 v[100:101], v14 offset:53248
ds_read_b64_tr_b16 v[102:103], v14 offset:53760
v_mfma_f32_16x16x32_bf16 v[64:67], v[224:227], v[180:183], v[64:67]
ds_read_b64_tr_b16 v[104:105], v15 offset:53248
ds_read_b64_tr_b16 v[106:107], v15 offset:53760
v_mfma_f32_16x16x32_bf16 v[80:83], v[224:227], v[184:187], v[80:83]
buffer_load_dwordx4 v[216:219], v39, s[32:35], s57 offen offset:1024 sc1
v_mfma_f32_16x16x32_bf16 v[68:71], v[228:231], v[180:183], v[68:71]
ds_read_b64_tr_b16 v[108:109], v16 offset:53248
ds_read_b64_tr_b16 v[110:111], v16 offset:53760
v_mfma_f32_16x16x32_bf16 v[84:87], v[228:231], v[184:187], v[84:87]
ds_read_b64_tr_b16 v[112:113], v17 offset:53248
ds_read_b64_tr_b16 v[114:115], v17 offset:53760
v_mfma_f32_16x16x32_bf16 v[72:75], v[232:235], v[180:183], v[72:75]
v_mfma_f32_16x16x32_bf16 v[88:91], v[232:235], v[184:187], v[88:91]
s_waitcnt vmcnt(6) lgkmcnt(8)
v_mfma_f32_16x16x32_bf16 v[60:63], v[236:239], v[188:191], v[60:63]
v_mfma_f32_16x16x32_bf16 v[76:79], v[236:239], v[192:195], v[76:79]
ds_read_b64_tr_b16 v[220:221], v14 offset:57344
ds_read_b64_tr_b16 v[222:223], v14 offset:57856
v_mfma_f32_16x16x32_bf16 v[64:67], v[240:243], v[188:191], v[64:67]
ds_read_b64_tr_b16 v[224:225], v15 offset:57344
ds_read_b64_tr_b16 v[226:227], v15 offset:57856
v_mfma_f32_16x16x32_bf16 v[80:83], v[240:243], v[192:195], v[80:83]
v_mfma_f32_16x16x32_bf16 v[68:71], v[244:247], v[188:191], v[68:71]
ds_read_b64_tr_b16 v[228:229], v16 offset:57344
ds_read_b64_tr_b16 v[230:231], v16 offset:57856
v_mfma_f32_16x16x32_bf16 v[84:87], v[244:247], v[192:195], v[84:87]
ds_read_b64_tr_b16 v[232:233], v17 offset:57344
ds_read_b64_tr_b16 v[234:235], v17 offset:57856
v_mfma_f32_16x16x32_bf16 v[72:75], v[248:251], v[188:191], v[72:75]
v_mfma_f32_16x16x32_bf16 v[88:91], v[248:251], v[192:195], v[88:91]
s_waitcnt vmcnt(4) lgkmcnt(8)
v_mfma_f32_16x16x32_bf16 v[60:63], v[100:103], v[196:199], v[60:63]
v_mfma_f32_16x16x32_bf16 v[76:79], v[100:103], v[200:203], v[76:79]
ds_read_b64_tr_b16 v[236:237], v14 offset:61440
ds_read_b64_tr_b16 v[238:239], v14 offset:61952
v_mfma_f32_16x16x32_bf16 v[64:67], v[104:107], v[196:199], v[64:67]
ds_read_b64_tr_b16 v[240:241], v15 offset:61440
ds_read_b64_tr_b16 v[242:243], v15 offset:61952
v_mfma_f32_16x16x32_bf16 v[80:83], v[104:107], v[200:203], v[80:83]
v_mfma_f32_16x16x32_bf16 v[68:71], v[108:111], v[196:199], v[68:71]
ds_read_b64_tr_b16 v[244:245], v16 offset:61440
ds_read_b64_tr_b16 v[246:247], v16 offset:61952
v_mfma_f32_16x16x32_bf16 v[84:87], v[108:111], v[200:203], v[84:87]
ds_read_b64_tr_b16 v[248:249], v17 offset:61440
ds_read_b64_tr_b16 v[250:251], v17 offset:61952
v_mfma_f32_16x16x32_bf16 v[72:75], v[112:115], v[196:199], v[72:75]
v_mfma_f32_16x16x32_bf16 v[88:91], v[112:115], v[200:203], v[88:91]
s_waitcnt vmcnt(2) lgkmcnt(8)
v_mfma_f32_16x16x32_bf16 v[60:63], v[220:223], v[204:207], v[60:63]
v_mfma_f32_16x16x32_bf16 v[76:79], v[220:223], v[208:211], v[76:79]
v_mfma_f32_16x16x32_bf16 v[64:67], v[224:227], v[204:207], v[64:67]
v_mfma_f32_16x16x32_bf16 v[80:83], v[224:227], v[208:211], v[80:83]
v_mfma_f32_16x16x32_bf16 v[68:71], v[228:231], v[204:207], v[68:71]
v_mfma_f32_16x16x32_bf16 v[84:87], v[228:231], v[208:211], v[84:87]
v_mfma_f32_16x16x32_bf16 v[72:75], v[232:235], v[204:207], v[72:75]
v_mfma_f32_16x16x32_bf16 v[88:91], v[232:235], v[208:211], v[88:91]
s_waitcnt vmcnt(0) lgkmcnt(0)
v_mfma_f32_16x16x32_bf16 v[60:63], v[236:239], v[212:215], v[60:63]
v_mfma_f32_16x16x32_bf16 v[64:67], v[240:243], v[212:215], v[64:67]
v_mfma_f32_16x16x32_bf16 v[68:71], v[244:247], v[212:215], v[68:71]
v_mfma_f32_16x16x32_bf16 v[72:75], v[248:251], v[212:215], v[72:75]
v_mfma_f32_16x16x32_bf16 v[76:79], v[236:239], v[216:219], v[76:79]
v_mfma_f32_16x16x32_bf16 v[80:83], v[240:243], v[216:219], v[80:83]
v_mfma_f32_16x16x32_bf16 v[84:87], v[244:247], v[216:219], v[84:87]
v_mfma_f32_16x16x32_bf16 v[88:91], v[248:251], v[216:219], v[88:91]
s_nop 0
v_cvt_pk_bf16_f32 v20, v60, v61
v_cvt_pk_bf16_f32 v21, v62, v63
v_cvt_pk_bf16_f32 v22, v64, v65
v_cvt_pk_bf16_f32 v23, v66, v67
s_nop 1
v_permlane16_swap_b32 v20, v22
v_permlane16_swap_b32 v21, v23
buffer_store_dwordx4 v[20:23], v40, s[24:27], 0 offen offset:0 sc1
v_cvt_pk_bf16_f32 v24, v68, v69
v_cvt_pk_bf16_f32 v25, v70, v71
v_cvt_pk_bf16_f32 v26, v72, v73
v_cvt_pk_bf16_f32 v27, v74, v75
s_nop 1
v_permlane16_swap_b32 v24, v26
v_permlane16_swap_b32 v25, v27
buffer_store_dwordx4 v[24:27], v40, s[24:27], 0 offen offset:64 sc1
v_cvt_pk_bf16_f32 v28, v76, v77
v_cvt_pk_bf16_f32 v29, v78, v79
v_cvt_pk_bf16_f32 v30, v80, v81
v_cvt_pk_bf16_f32 v31, v82, v83
s_nop 1
v_permlane16_swap_b32 v28, v30
v_permlane16_swap_b32 v29, v31
buffer_store_dwordx4 v[28:31], v41, s[24:27], 0 offen offset:0 sc1
v_cvt_pk_bf16_f32 v32, v84, v85
v_cvt_pk_bf16_f32 v33, v86, v87
v_cvt_pk_bf16_f32 v34, v88, v89
v_cvt_pk_bf16_f32 v35, v90, v91
s_nop 1
v_permlane16_swap_b32 v32, v34
v_permlane16_swap_b32 v33, v35
buffer_store_dwordx4 v[32:35], v41, s[24:27], 0 offen offset:64 sc1
s_endpgm
L_code_end:
again_10:
s_mov_b32 s63, 0
retry_12:
buffer_load_dwordx4 v[80:83], v37, s[32:35], 0 offen offset:0 sc1
buffer_load_dwordx4 v[84:87], v37, s[32:35], 0 offen offset:1024 sc1
buffer_load_dwordx4 v[88:91], v37, s[32:35], 0 offen offset:2048 sc1
buffer_load_dwordx4 v[92:95], v37, s[32:35], 0 offen offset:3072 sc1
s_waitcnt vmcnt(0)
v_add_f32 v80, v80, v88
v_add_f32 v81, v81, v89
v_add_f32 v82, v82, v90
v_add_f32 v83, v83, v91
v_add_f32 v84, v84, v92
v_add_f32 v85, v85, v93
v_add_f32 v86, v86, v94
v_add_f32 v87, v87, v95
v_add_f32 v80, v80, v84
v_add_f32 v81, v81, v85
v_add_f32 v82, v82, v86
v_add_f32 v83, v83, v87
s_nop 1
v_permlane32_swap_b32 v80, v81
v_permlane32_swap_b32 v82, v83
v_add_f32 v80, v80, v81
v_add_f32 v82, v82, v83
s_nop 1
v_permlane16_swap_b32 v80, v82
s_nop 0
v_add_f32 v80, v80, v82
v_cmp_u_f32 vcc, v80, v80
s_cbranch_vccz summed_11
s_add_u32 s63, s63, 1
s_cmp_lt_u32 s63, 0x10000
s_cbranch_scc1 retry_12
s_branch summed_11
again_13:
s_mov_b32 s63, 0
retry_15:
buffer_load_dwordx4 v[64:67], v38, s[32:35], 0 offen offset:0 sc1
buffer_load_dwordx4 v[68:71], v38, s[32:35], 0 offen offset:1024 sc1
buffer_load_dwordx4 v[72:75], v38, s[32:35], 0 offen offset:2048 sc1
buffer_load_dwordx4 v[76:79], v38, s[32:35], 0 offen offset:3072 sc1
s_waitcnt vmcnt(0)
v_add_f32 v64, v64, v72
v_add_f32 v65, v65, v73
v_add_f32 v66, v66, v74
v_add_f32 v67, v67, v75
v_add_f32 v68, v68, v76
v_add_f32 v69, v69, v77
v_add_f32 v70, v70, v78
v_add_f32 v71, v71, v79
v_add_f32 v64, v64, v68
v_add_f32 v65, v65, v69
v_add_f32 v66, v66, v70
v_add_f32 v67, v67, v71
s_nop 1
v_permlane32_swap_b32 v64, v65
v_permlane32_swap_b32 v66, v67
v_add_f32 v64, v64, v65
v_add_f32 v66, v66, v67
s_nop 1
v_permlane16_swap_b32 v64, v66
s_nop 0
v_add_f32 v64, v64, v66
v_cmp_u_f32 vcc, v64, v64
s_cbranch_vccz summed_14
s_add_u32 s63, s63, 1
s_cmp_lt_u32 s63, 0x10000
s_cbranch_scc1 retry_15
s_branch summed_14
again_21:
s_mov_b32 s63, 0
retry_23:
buffer_load_dwordx4 v[80:83], v37, s[32:35], 0 offen offset:0 sc1
buffer_load_dwordx4 v[84:87], v37, s[32:35], 0 offen offset:1024 sc1
buffer_load_dwordx4 v[88:91], v37, s[32:35], 0 offen offset:2048 sc1
buffer_load_dwordx4 v[92:95], v37, s[32:35], 0 offen offset:3072 sc1
s_waitcnt vmcnt(0)
v_add_f32 v80, v80, v88
v_add_f32 v81, v81, v89
v_add_f32 v82, v82, v90
v_add_f32 v83, v83, v91
v_add_f32 v84, v84, v92
v_add_f32 v85, v85, v93
v_add_f32 v86, v86, v94
v_add_f32 v87, v87, v95
v_add_f32 v80, v80, v84
v_add_f32 v81, v81, v85
v_add_f32 v82, v82, v86
v_add_f32 v83, v83, v87
s_nop 1
v_permlane32_swap_b32 v80, v81
v_permlane32_swap_b32 v82, v83
v_add_f32 v80, v80, v81
v_add_f32 v82, v82, v83
s_nop 1
v_permlane16_swap_b32 v80, v82
s_nop 0
v_add_f32 v80, v80, v82
v_cmp_u_f32 vcc, v80, v80
s_cbranch_vccz summed_22
s_add_u32 s63, s63, 1
s_cmp_lt_u32 s63, 0x10000
s_cbranch_scc1 retry_23
s_branch summed_22
again_24:
s_mov_b32 s63, 0
retry_26:
buffer_load_dwordx4 v[64:67], v38, s[32:35], 0 offen offset:0 sc1
buffer_load_dwordx4 v[68:71], v38, s[32:35], 0 offen offset:1024 sc1
buffer_load_dwordx4 v[72:75], v38, s[32:35], 0 offen offset:2048 sc1
buffer_load_dwordx4 v[76:79], v38, s[32:35], 0 offen offset:3072 sc1
s_waitcnt vmcnt(0)
v_add_f32 v64, v64, v72
v_add_f32 v65, v65, v73
v_add_f32 v66, v66, v74
v_add_f32 v67, v67, v75
v_add_f32 v68, v68, v76
v_add_f32 v69, v69, v77
v_add_f32 v70, v70, v78
v_add_f32 v71, v71, v79
v_add_f32 v64, v64, v68
v_add_f32 v65, v65, v69
v_add_f32 v66, v66, v70
v_add_f32 v67, v67, v71
s_nop 1
v_permlane32_swap_b32 v64, v65
v_permlane32_swap_b32 v66, v67
v_add_f32 v64, v64, v65
v_add_f32 v66, v66, v67
s_nop 1
v_permlane16_swap_b32 v64, v66
s_nop 0
v_add_f32 v64, v64, v66
v_cmp_u_f32 vcc, v64, v64
s_cbranch_vccz summed_25
s_add_u32 s63, s63, 1
s_cmp_lt_u32 s63, 0x10000
s_cbranch_scc1 retry_26
s_branch summed_25
again_30:
s_mov_b32 s63, 0
retry_32:
buffer_load_dwordx4 v[80:83], v37, s[32:35], 0 offen offset:0 sc1
buffer_load_dwordx4 v[84:87], v37, s[32:35], 0 offen offset:1024 sc1
buffer_load_dwordx4 v[88:91], v37, s[32:35], 0 offen offset:2048 sc1
buffer_load_dwordx4 v[92:95], v37, s[32:35], 0 offen offset:3072 sc1
s_waitcnt vmcnt(0)
v_add_f32 v80, v80, v88
v_add_f32 v81, v81, v89
v_add_f32 v82, v82, v90
v_add_f32 v83, v83, v91
v_add_f32 v84, v84, v92
v_add_f32 v85, v85, v93
v_add_f32 v86, v86, v94
v_add_f32 v87, v87, v95
v_add_f32 v80, v80, v84
v_add_f32 v81, v81, v85
v_add_f32 v82, v82, v86
v_add_f32 v83, v83, v87
s_nop 1
v_permlane32_swap_b32 v80, v81
v_permlane32_swap_b32 v82, v83
v_add_f32 v80, v80, v81
v_add_f32 v82, v82, v83
s_nop 1
v_permlane16_swap_b32 v80, v82
s_nop 0
v_add_f32 v80, v80, v82
v_cmp_u_f32 vcc, v80, v80
s_cbranch_vccz summed_31
s_add_u32 s63, s63, 1
s_cmp_lt_u32 s63, 0x10000
s_cbranch_scc1 retry_32
s_branch summed_31
again_36:
s_mov_b32 s63, 0
retry_38:
buffer_load_dwordx4 v[80:83], v37, s[32:35], 0 offen offset:0 sc1
buffer_load_dwordx4 v[84:87], v37, s[32:35], 0 offen offset:1024 sc1
buffer_load_dwordx4 v[88:91], v37, s[32:35], 0 offen offset:2048 sc1
buffer_load_dwordx4 v[92:95], v37, s[32:35], 0 offen offset:3072 sc1
s_waitcnt vmcnt(0)
v_add_f32 v80, v80, v88
v_add_f32 v81, v81, v89
v_add_f32 v82, v82, v90
v_add_f32 v83, v83, v91
v_add_f32 v84, v84, v92
v_add_f32 v85, v85, v93
v_add_f32 v86, v86, v94
v_add_f32 v87, v87, v95
v_add_f32 v80, v80, v84
v_add_f32 v81, v81, v85
v_add_f32 v82, v82, v86
v_add_f32 v83, v83, v87
s_nop 1
v_permlane32_swap_b32 v80, v81
v_permlane32_swap_b32 v82, v83
v_add_f32 v80, v80, v81
v_add_f32 v82, v82, v83
s_nop 1
v_permlane16_swap_b32 v80, v82
s_nop 0
v_add_f32 v80, v80, v82
v_cmp_u_f32 vcc, v80, v80
s_cbranch_vccz summed_37
s_add_u32 s63, s63, 1
s_cmp_lt_u32 s63, 0x10000
s_cbranch_scc1 retry_38
s_branch summed_37
slow_54:
.p2align 3
v_pk_mul_f32 v[220:221], v[220:221], v[160:161] op_sel:[0,0] op_sel_hi:[1,0]
v_pk_mul_f32 v[222:223], v[222:223], v[160:161] op_sel:[0,0] op_sel_hi:[1,0]
v_pk_mul_f32 v[224:225], v[224:225], v[160:161] op_sel:[0,0] op_sel_hi:[1,0]
v_pk_mul_f32 v[226:227], v[226:227], v[160:161] op_sel:[0,0] op_sel_hi:[1,0]
v_cvt_pk_bf16_f32 v220, v220, v221
v_cvt_pk_bf16_f32 v221, v222, v223
v_cvt_pk_bf16_f32 v222, v224, v225
v_cvt_pk_bf16_f32 v223, v226, v227
buffer_store_dwordx4 v[220:223], v18, s[32:35], s80 offen sc1
v_pk_mul_f32 v[228:229], v[228:229], v[168:169] op_sel:[0,0] op_sel_hi:[1,0]
v_pk_mul_f32 v[230:231], v[230:231], v[168:169] op_sel:[0,0] op_sel_hi:[1,0]
v_pk_mul_f32 v[232:233], v[232:233], v[168:169] op_sel:[0,0] op_sel_hi:[1,0]
v_pk_mul_f32 v[234:235], v[234:235], v[168:169] op_sel:[0,0] op_sel_hi:[1,0]
v_cvt_pk_bf16_f32 v228, v228, v229
v_cvt_pk_bf16_f32 v229, v230, v231
v_cvt_pk_bf16_f32 v230, v232, v233
v_cvt_pk_bf16_f32 v231, v234, v235
buffer_store_dwordx4 v[228:231], v18, s[32:35], s81 offen sc1
v_pk_mul_f32 v[236:237], v[236:237], v[176:177] op_sel:[0,0] op_sel_hi:[1,0]
v_pk_mul_f32 v[238:239], v[238:239], v[176:177] op_sel:[0,0] op_sel_hi:[1,0]
v_pk_mul_f32 v[240:241], v[240:241], v[176:177] op_sel:[0,0] op_sel_hi:[1,0]
v_pk_mul_f32 v[242:243], v[242:243], v[176:177] op_sel:[0,0] op_sel_hi:[1,0]
v_cvt_pk_bf16_f32 v236, v236, v237
v_cvt_pk_bf16_f32 v237, v238, v239
v_cvt_pk_bf16_f32 v238, v240, v241
v_cvt_pk_bf16_f32 v239, v242, v243
buffer_store_dwordx4 v[236:239], v18, s[32:35], s82 offen sc1
v_pk_mul_f32 v[244:245], v[244:245], v[184:185] op_sel:[0,0] op_sel_hi:[1,0]
v_pk_mul_f32 v[246:247], v[246:247], v[184:185] op_sel:[0,0] op_sel_hi:[1,0]
v_pk_mul_f32 v[248:249], v[248:249], v[184:185] op_sel:[0,0] op_sel_hi:[1,0]
v_pk_mul_f32 v[250:251], v[250:251], v[184:185] op_sel:[0,0] op_sel_hi:[1,0]
v_cvt_pk_bf16_f32 v244, v244, v245
v_cvt_pk_bf16_f32 v245, v246, v247
v_cvt_pk_bf16_f32 v246, v248, v249
v_cvt_pk_bf16_f32 v247, v250, v251
buffer_store_dwordx4 v[244:247], v18, s[32:35], s83 offen sc1
s_barrier
s_lshl_b32 s62, s45, 2
v_mov_b32 v4, s62
v_mov_b32 v5, 1
s_mov_b64 exec, 1
s_waitcnt vmcnt(0)
buffer_store_dword v5, v4, s[32:35], s84 offen sc1
s_mov_b64 exec, -1
s_branch back_55
slow_58:
s_nop 0
v_cvt_pk_bf16_f32 v20, v60, v61
v_cvt_pk_bf16_f32 v21, v62, v63
v_cvt_pk_bf16_f32 v22, v64, v65
v_cvt_pk_bf16_f32 v23, v66, v67
buffer_store_dwordx4 v[20:23], v18, s[32:35], s85 offen offset:0 sc1
v_cvt_pk_bf16_f32 v24, v68, v69
v_cvt_pk_bf16_f32 v25, v70, v71
v_cvt_pk_bf16_f32 v26, v72, v73
v_cvt_pk_bf16_f32 v27, v74, v75
buffer_store_dwordx4 v[24:27], v18, s[32:35], s85 offen offset:1024 sc1
v_cvt_pk_bf16_f32 v28, v76, v77
v_cvt_pk_bf16_f32 v29, v78, v79
v_cvt_pk_bf16_f32 v30, v80, v81
v_cvt_pk_bf16_f32 v31, v82, v83
buffer_store_dwordx4 v[28:31], v18, s[32:35], s86 offen offset:0 sc1
v_cvt_pk_bf16_f32 v32, v84, v85
v_cvt_pk_bf16_f32 v33, v86, v87
v_cvt_pk_bf16_f32 v34, v88, v89
v_cvt_pk_bf16_f32 v35, v90, v91
buffer_store_dwordx4 v[32:35], v18, s[32:35], s86 offen offset:1024 sc1
s_barrier
v_dot2c_f32_bf16 v6, v20, v48
v_dot2c_f32_bf16 v8, v20, v20
v_dot2c_f32_bf16 v7, v28, v48
v_dot2c_f32_bf16 v9, v28, v28
v_dot2c_f32_bf16 v6, v21, v48
v_dot2c_f32_bf16 v8, v21, v21
v_dot2c_f32_bf16 v7, v29, v48
v_dot2c_f32_bf16 v9, v29, v29
v_dot2c_f32_bf16 v6, v22, v48
v_dot2c_f32_bf16 v8, v22, v22
v_dot2c_f32_bf16 v7, v30, v48
v_dot2c_f32_bf16 v9, v30, v30
v_dot2c_f32_bf16 v6, v23, v48
v_dot2c_f32_bf16 v8, v23, v23
v_dot2c_f32_bf16 v7, v31, v48
v_dot2c_f32_bf16 v9, v31, v31
v_dot2c_f32_bf16 v6, v24, v48
v_dot2c_f32_bf16 v8, v24, v24
v_dot2c_f32_bf16 v7, v32, v48
v_dot2c_f32_bf16 v9, v32, v32
v_dot2c_f32_bf16 v6, v25, v48
v_dot2c_f32_bf16 v8, v25, v25
v_dot2c_f32_bf16 v7, v33, v48
v_dot2c_f32_bf16 v9, v33, v33
v_dot2c_f32_bf16 v6, v26, v48
v_dot2c_f32_bf16 v8, v26, v26
v_dot2c_f32_bf16 v7, v34, v48
v_dot2c_f32_bf16 v9, v34, v34
v_dot2c_f32_bf16 v6, v27, v48
v_dot2c_f32_bf16 v8, v27, v27
v_dot2c_f32_bf16 v7, v35, v48
v_dot2c_f32_bf16 v9, v35, v35
s_mov_b64 exec, 1
s_waitcnt vmcnt(0)
buffer_store_dword v5, v4, s[32:35], s88 offen sc1
s_mov_b64 exec, -1
s_nop 1
v_permlane32_swap_b32 v6, v7
v_permlane32_swap_b32 v8, v9
v_add_f32 v6, v6, v7
v_add_f32 v8, v8, v9
s_nop 1
v_permlane16_swap_b32 v6, v8
s_nop 0
v_add_f32 v6, v6, v8
buffer_store_dword v6, v1, s[32:35], s87 offen sc1
s_branch back_59
slow_68:
.p2align 3
v_pk_mul_f32 v[156:157], v[156:157], v[100:101] op_sel:[0,0] op_sel_hi:[1,0]
v_pk_mul_f32 v[158:159], v[158:159], v[100:101] op_sel:[0,0] op_sel_hi:[1,0]
v_pk_mul_f32 v[160:161], v[160:161], v[100:101] op_sel:[0,0] op_sel_hi:[1,0]
v_pk_mul_f32 v[162:163], v[162:163], v[100:101] op_sel:[0,0] op_sel_hi:[1,0]
v_cvt_pk_bf16_f32 v156, v156, v157
v_cvt_pk_bf16_f32 v157, v158, v159
v_cvt_pk_bf16_f32 v158, v160, v161
v_cvt_pk_bf16_f32 v159, v162, v163
buffer_store_dwordx4 v[156:159], v18, s[32:35], s80 offen sc1
v_pk_mul_f32 v[164:165], v[164:165], v[100:101] op_sel:[0,1] op_sel_hi:[1,1]
v_pk_mul_f32 v[166:167], v[166:167], v[100:101] op_sel:[0,1] op_sel_hi:[1,1]
v_pk_mul_f32 v[168:169], v[168:169], v[100:101] op_sel:[0,1] op_sel_hi:[1,1]
v_pk_mul_f32 v[170:171], v[170:171], v[100:101] op_sel:[0,1] op_sel_hi:[1,1]
v_cvt_pk_bf16_f32 v164, v164, v165
v_cvt_pk_bf16_f32 v165, v166, v167
v_cvt_pk_bf16_f32 v166, v168, v169
v_cvt_pk_bf16_f32 v167, v170, v171
buffer_store_dwordx4 v[164:167], v18, s[32:35], s81 offen sc1
v_pk_mul_f32 v[172:173], v[172:173], v[102:103] op_sel:[0,0] op_sel_hi:[1,0]
v_pk_mul_f32 v[174:175], v[174:175], v[102:103] op_sel:[0,0] op_sel_hi:[1,0]
v_pk_mul_f32 v[176:177], v[176:177], v[102:103] op_sel:[0,0] op_sel_hi:[1,0]
v_pk_mul_f32 v[178:179], v[178:179], v[102:103] op_sel:[0,0] op_sel_hi:[1,0]
v_cvt_pk_bf16_f32 v172, v172, v173
v_cvt_pk_bf16_f32 v173, v174, v175
v_cvt_pk_bf16_f32 v174, v176, v177
v_cvt_pk_bf16_f32 v175, v178, v179
buffer_store_dwordx4 v[172:175], v18, s[32:35], s82 offen sc1
v_pk_mul_f32 v[180:181], v[180:181], v[102:103] op_sel:[0,1] op_sel_hi:[1,1]
v_pk_mul_f32 v[182:183], v[182:183], v[102:103] op_sel:[0,1] op_sel_hi:[1,1]
v_pk_mul_f32 v[184:185], v[184:185], v[102:103] op_sel:[0,1] op_sel_hi:[1,1]
v_pk_mul_f32 v[186:187], v[186:187], v[102:103] op_sel:[0,1] op_sel_hi:[1,1]
v_cvt_pk_bf16_f32 v180, v180, v181
v_cvt_pk_bf16_f32 v181, v182, v183
v_cvt_pk_bf16_f32 v182, v184, v185
v_cvt_pk_bf16_f32 v183, v186, v187
buffer_store_dwordx4 v[180:183], v18, s[32:35], s83 offen sc1
s_barrier
s_lshl_b32 s62, s45, 2
v_mov_b32 v4, s62
v_mov_b32 v5, 2
s_mov_b64 exec, 1
s_waitcnt vmcnt(0)
buffer_store_dword v5, v4, s[32:35], s84 offen sc1
s_mov_b64 exec, -1
s_branch back_69
slow_72:
s_nop 0
v_cvt_pk_bf16_f32 v20, v60, v61
v_cvt_pk_bf16_f32 v21, v62, v63
v_cvt_pk_bf16_f32 v22, v64, v65
v_cvt_pk_bf16_f32 v23, v66, v67
buffer_store_dwordx4 v[20:23], v18, s[32:35], s85 offen offset:0 sc1
v_cvt_pk_bf16_f32 v24, v68, v69
v_cvt_pk_bf16_f32 v25, v70, v71
v_cvt_pk_bf16_f32 v26, v72, v73
v_cvt_pk_bf16_f32 v27, v74, v75
buffer_store_dwordx4 v[24:27], v18, s[32:35], s85 offen offset:1024 sc1
v_cvt_pk_bf16_f32 v28, v76, v77
v_cvt_pk_bf16_f32 v29, v78, v79
v_cvt_pk_bf16_f32 v30, v80, v81
v_cvt_pk_bf16_f32 v31, v82, v83
buffer_store_dwordx4 v[28:31], v18, s[32:35], s86 offen offset:0 sc1
v_cvt_pk_bf16_f32 v32, v84, v85
v_cvt_pk_bf16_f32 v33, v86, v87
v_cvt_pk_bf16_f32 v34, v88, v89
v_cvt_pk_bf16_f32 v35, v90, v91
buffer_store_dwordx4 v[32:35], v18, s[32:35], s86 offen offset:1024 sc1
s_barrier
v_dot2c_f32_bf16 v6, v20, v48
v_dot2c_f32_bf16 v8, v20, v20
v_dot2c_f32_bf16 v7, v28, v48
v_dot2c_f32_bf16 v9, v28, v28
v_dot2c_f32_bf16 v6, v21, v48
v_dot2c_f32_bf16 v8, v21, v21
v_dot2c_f32_bf16 v7, v29, v48
v_dot2c_f32_bf16 v9, v29, v29
v_dot2c_f32_bf16 v6, v22, v48
v_dot2c_f32_bf16 v8, v22, v22
v_dot2c_f32_bf16 v7, v30, v48
v_dot2c_f32_bf16 v9, v30, v30
v_dot2c_f32_bf16 v6, v23, v48
v_dot2c_f32_bf16 v8, v23, v23
v_dot2c_f32_bf16 v7, v31, v48
v_dot2c_f32_bf16 v9, v31, v31
v_dot2c_f32_bf16 v6, v24, v48
v_dot2c_f32_bf16 v8, v24, v24
v_dot2c_f32_bf16 v7, v32, v48
v_dot2c_f32_bf16 v9, v32, v32
v_dot2c_f32_bf16 v6, v25, v48
v_dot2c_f32_bf16 v8, v25, v25
v_dot2c_f32_bf16 v7, v33, v48
v_dot2c_f32_bf16 v9, v33, v33
v_dot2c_f32_bf16 v6, v26, v48
v_dot2c_f32_bf16 v8, v26, v26
v_dot2c_f32_bf16 v7, v34, v48
v_dot2c_f32_bf16 v9, v34, v34
v_dot2c_f32_bf16 v6, v27, v48
v_dot2c_f32_bf16 v8, v27, v27
v_dot2c_f32_bf16 v7, v35, v48
v_dot2c_f32_bf16 v9, v35, v35
s_mov_b64 exec, 1
s_waitcnt vmcnt(0)
buffer_store_dword v5, v4, s[32:35], s88 offen sc1
s_mov_b64 exec, -1
s_nop 1
v_permlane32_swap_b32 v6, v7
v_permlane32_swap_b32 v8, v9
v_add_f32 v6, v6, v7
v_add_f32 v8, v8, v9
s_nop 1
v_permlane16_swap_b32 v6, v8
s_nop 0
v_add_f32 v6, v6, v8
buffer_store_dword v6, v1, s[32:35], s87 offen sc1
s_branch back_73
slow_84:
.p2align 3
v_pk_mul_f32 v[220:221], v[220:221], v[160:161] op_sel:[0,0] op_sel_hi:[1,0]
v_pk_mul_f32 v[222:223], v[222:223], v[160:161] op_sel:[0,0] op_sel_hi:[1,0]
v_pk_mul_f32 v[224:225], v[224:225], v[160:161] op_sel:[0,0] op_sel_hi:[1,0]
v_pk_mul_f32 v[226:227], v[226:227], v[160:161] op_sel:[0,0] op_sel_hi:[1,0]
v_cvt_pk_bf16_f32 v220, v220, v221
v_cvt_pk_bf16_f32 v221, v222, v223
v_cvt_pk_bf16_f32 v222, v224, v225
v_cvt_pk_bf16_f32 v223, v226, v227
buffer_store_dwordx4 v[220:223], v18, s[32:35], s80 offen sc1
v_pk_mul_f32 v[228:229], v[228:229], v[168:169] op_sel:[0,0] op_sel_hi:[1,0]
v_pk_mul_f32 v[230:231], v[230:231], v[168:169] op_sel:[0,0] op_sel_hi:[1,0]
v_pk_mul_f32 v[232:233], v[232:233], v[168:169] op_sel:[0,0] op_sel_hi:[1,0]
v_pk_mul_f32 v[234:235], v[234:235], v[168:169] op_sel:[0,0] op_sel_hi:[1,0]
v_cvt_pk_bf16_f32 v228, v228, v229
v_cvt_pk_bf16_f32 v229, v230, v231
v_cvt_pk_bf16_f32 v230, v232, v233
v_cvt_pk_bf16_f32 v231, v234, v235
buffer_store_dwordx4 v[228:231], v18, s[32:35], s81 offen sc1
v_pk_mul_f32 v[236:237], v[236:237], v[176:177] op_sel:[0,0] op_sel_hi:[1,0]
v_pk_mul_f32 v[238:239], v[238:239], v[176:177] op_sel:[0,0] op_sel_hi:[1,0]
v_pk_mul_f32 v[240:241], v[240:241], v[176:177] op_sel:[0,0] op_sel_hi:[1,0]
v_pk_mul_f32 v[242:243], v[242:243], v[176:177] op_sel:[0,0] op_sel_hi:[1,0]
v_cvt_pk_bf16_f32 v236, v236, v237
v_cvt_pk_bf16_f32 v237, v238, v239
v_cvt_pk_bf16_f32 v238, v240, v241
v_cvt_pk_bf16_f32 v239, v242, v243
buffer_store_dwordx4 v[236:239], v18, s[32:35], s82 offen sc1
v_pk_mul_f32 v[244:245], v[244:245], v[184:185] op_sel:[0,0] op_sel_hi:[1,0]
v_pk_mul_f32 v[246:247], v[246:247], v[184:185] op_sel:[0,0] op_sel_hi:[1,0]
v_pk_mul_f32 v[248:249], v[248:249], v[184:185] op_sel:[0,0] op_sel_hi:[1,0]
v_pk_mul_f32 v[250:251], v[250:251], v[184:185] op_sel:[0,0] op_sel_hi:[1,0]
v_cvt_pk_bf16_f32 v244, v244, v245
v_cvt_pk_bf16_f32 v245, v246, v247
v_cvt_pk_bf16_f32 v246, v248, v249
v_cvt_pk_bf16_f32 v247, v250, v251
buffer_store_dwordx4 v[244:247], v18, s[32:35], s83 offen sc1
s_barrier
s_lshl_b32 s62, s45, 2
v_mov_b32 v4, s62
v_mov_b32 v5, 3
s_mov_b64 exec, 1
s_waitcnt vmcnt(0)
buffer_store_dword v5, v4, s[32:35], s84 offen sc1
s_mov_b64 exec, -1
s_branch back_85
slow_88:
s_nop 0
v_cvt_pk_bf16_f32 v20, v60, v61
v_cvt_pk_bf16_f32 v21, v62, v63
v_cvt_pk_bf16_f32 v22, v64, v65
v_cvt_pk_bf16_f32 v23, v66, v67
buffer_store_dwordx4 v[20:23], v18, s[32:35], s85 offen offset:0 sc1
v_cvt_pk_bf16_f32 v24, v68, v69
v_cvt_pk_bf16_f32 v25, v70, v71
v_cvt_pk_bf16_f32 v26, v72, v73
v_cvt_pk_bf16_f32 v27, v74, v75
buffer_store_dwordx4 v[24:27], v18, s[32:35], s85 offen offset:1024 sc1
v_cvt_pk_bf16_f32 v28, v76, v77
v_cvt_pk_bf16_f32 v29, v78, v79
v_cvt_pk_bf16_f32 v30, v80, v81
v_cvt_pk_bf16_f32 v31, v82, v83
buffer_store_dwordx4 v[28:31], v18, s[32:35], s86 offen offset:0 sc1
v_cvt_pk_bf16_f32 v32, v84, v85
v_cvt_pk_bf16_f32 v33, v86, v87
v_cvt_pk_bf16_f32 v34, v88, v89
v_cvt_pk_bf16_f32 v35, v90, v91
buffer_store_dwordx4 v[32:35], v18, s[32:35], s86 offen offset:1024 sc1
s_barrier
v_dot2c_f32_bf16 v6, v20, v48
v_dot2c_f32_bf16 v8, v20, v20
v_dot2c_f32_bf16 v7, v28, v48
v_dot2c_f32_bf16 v9, v28, v28
v_dot2c_f32_bf16 v6, v21, v48
v_dot2c_f32_bf16 v8, v21, v21
v_dot2c_f32_bf16 v7, v29, v48
v_dot2c_f32_bf16 v9, v29, v29
v_dot2c_f32_bf16 v6, v22, v48
v_dot2c_f32_bf16 v8, v22, v22
v_dot2c_f32_bf16 v7, v30, v48
v_dot2c_f32_bf16 v9, v30, v30
v_dot2c_f32_bf16 v6, v23, v48
v_dot2c_f32_bf16 v8, v23, v23
v_dot2c_f32_bf16 v7, v31, v48
v_dot2c_f32_bf16 v9, v31, v31
v_dot2c_f32_bf16 v6, v24, v48
v_dot2c_f32_bf16 v8, v24, v24
v_dot2c_f32_bf16 v7, v32, v48
v_dot2c_f32_bf16 v9, v32, v32
v_dot2c_f32_bf16 v6, v25, v48
v_dot2c_f32_bf16 v8, v25, v25
v_dot2c_f32_bf16 v7, v33, v48
v_dot2c_f32_bf16 v9, v33, v33
v_dot2c_f32_bf16 v6, v26, v48
v_dot2c_f32_bf16 v8, v26, v26
v_dot2c_f32_bf16 v7, v34, v48
v_dot2c_f32_bf16 v9, v34, v34
v_dot2c_f32_bf16 v6, v27, v48
v_dot2c_f32_bf16 v8, v27, v27
v_dot2c_f32_bf16 v7, v35, v48
v_dot2c_f32_bf16 v9, v35, v35
s_mov_b64 exec, 1
s_waitcnt vmcnt(0)
buffer_store_dword v5, v4, s[32:35], s88 offen sc1
s_mov_b64 exec, -1
s_nop 1
v_permlane32_swap_b32 v6, v7
v_permlane32_swap_b32 v8, v9
v_add_f32 v6, v6, v7
v_add_f32 v8, v8, v9
s_nop 1
v_permlane16_swap_b32 v6, v8
s_nop 0
v_add_f32 v6, v6, v8
buffer_store_dword v6, v1, s[32:35], s87 offen sc1
s_branch back_89
slow_96:
.p2align 3
v_pk_mul_f32 v[156:157], v[156:157], v[100:101] op_sel:[0,0] op_sel_hi:[1,0]
v_pk_mul_f32 v[158:159], v[158:159], v[100:101] op_sel:[0,0] op_sel_hi:[1,0]
v_pk_mul_f32 v[160:161], v[160:161], v[100:101] op_sel:[0,0] op_sel_hi:[1,0]
v_pk_mul_f32 v[162:163], v[162:163], v[100:101] op_sel:[0,0] op_sel_hi:[1,0]
v_cvt_pk_bf16_f32 v156, v156, v157
v_cvt_pk_bf16_f32 v157, v158, v159
v_cvt_pk_bf16_f32 v158, v160, v161
v_cvt_pk_bf16_f32 v159, v162, v163
buffer_store_dwordx4 v[156:159], v18, s[32:35], s80 offen sc1
v_pk_mul_f32 v[164:165], v[164:165], v[100:101] op_sel:[0,1] op_sel_hi:[1,1]
v_pk_mul_f32 v[166:167], v[166:167], v[100:101] op_sel:[0,1] op_sel_hi:[1,1]
v_pk_mul_f32 v[168:169], v[168:169], v[100:101] op_sel:[0,1] op_sel_hi:[1,1]
v_pk_mul_f32 v[170:171], v[170:171], v[100:101] op_sel:[0,1] op_sel_hi:[1,1]
v_cvt_pk_bf16_f32 v164, v164, v165
v_cvt_pk_bf16_f32 v165, v166, v167
v_cvt_pk_bf16_f32 v166, v168, v169
v_cvt_pk_bf16_f32 v167, v170, v171
buffer_store_dwordx4 v[164:167], v18, s[32:35], s81 offen sc1
v_pk_mul_f32 v[172:173], v[172:173], v[102:103] op_sel:[0,0] op_sel_hi:[1,0]
v_pk_mul_f32 v[174:175], v[174:175], v[102:103] op_sel:[0,0] op_sel_hi:[1,0]
v_pk_mul_f32 v[176:177], v[176:177], v[102:103] op_sel:[0,0] op_sel_hi:[1,0]
v_pk_mul_f32 v[178:179], v[178:179], v[102:103] op_sel:[0,0] op_sel_hi:[1,0]
v_cvt_pk_bf16_f32 v172, v172, v173
v_cvt_pk_bf16_f32 v173, v174, v175
v_cvt_pk_bf16_f32 v174, v176, v177
v_cvt_pk_bf16_f32 v175, v178, v179
buffer_store_dwordx4 v[172:175], v18, s[32:35], s82 offen sc1
v_pk_mul_f32 v[180:181], v[180:181], v[102:103] op_sel:[0,1] op_sel_hi:[1,1]
v_pk_mul_f32 v[182:183], v[182:183], v[102:103] op_sel:[0,1] op_sel_hi:[1,1]
v_pk_mul_f32 v[184:185], v[184:185], v[102:103] op_sel:[0,1] op_sel_hi:[1,1]
v_pk_mul_f32 v[186:187], v[186:187], v[102:103] op_sel:[0,1] op_sel_hi:[1,1]
v_cvt_pk_bf16_f32 v180, v180, v181
v_cvt_pk_bf16_f32 v181, v182, v183
v_cvt_pk_bf16_f32 v182, v184, v185
v_cvt_pk_bf16_f32 v183, v186, v187
buffer_store_dwordx4 v[180:183], v18, s[32:35], s83 offen sc1
s_barrier
s_lshl_b32 s62, s45, 2
v_mov_b32 v4, s62
v_mov_b32 v5, 4
s_mov_b64 exec, 1
s_waitcnt vmcnt(0)
buffer_store_dword v5, v4, s[32:35], s84 offen sc1
s_mov_b64 exec, -1
s_branch back_97
s_endpgm
.section .rodata,"a"
.p2align 6
.amdhsa_kernel interleave_layers__sliding_local_dilated__linear_kernel_hedgehog__prompt_kernel
  .amdhsa_next_free_vgpr 256
  .amdhsa_next_free_sgpr 102
  .amdhsa_accum_offset 256
  .amdhsa_group_segment_fixed_size 0
  .amdhsa_kernarg_size 80
  .amdhsa_user_sgpr_count 2
  .amdhsa_user_sgpr_kernarg_segment_ptr 1
  .amdhsa_system_sgpr_workgroup_id_x 1
.end_amdhsa_kernel
```

```asm
; @launch grid=(256,1,1) block=(512,1,1) lds=163840
.amdgcn_target "amdgcn-amd-amdhsa--gfx950"
.text
.globl interleave_layers__sliding_local_dilated__linear_kernel_hedgehog__prompt_kernel
.p2align 8
.type interleave_layers__sliding_local_dilated__linear_kernel_hedgehog__prompt_kernel,@function
interleave_layers__sliding_local_dilated__linear_kernel_hedgehog__prompt_kernel:
s_cmp_ge_u32 s2, 256
s_cbranch_scc1 L_end
s_load_dwordx16 s[4:19], s[0:1], 0
s_load_dwordx4 s[20:23], s[0:1], 64
v_lshrrev_b32 v1, 6, v0
v_and_b32 v0, 63, v0
v_readfirstlane_b32 s40, v1
v_and_b32 v2, 15, v0
v_lshrrev_b32 v3, 4, v0
v_lshlrev_b32 v18, 4, v0
s_and_b32 s48, s2, 7
s_lshr_b32 s49, s2, 3
s_and_b32 s74, s49, 1
s_lshl_b32 s41, s48, 1
s_add_u32 s41, s41, s74
s_lshr_b32 s42, s49, 1
s_and_b32 s48, s2, 7
s_add_u32 s47, s42, s48
s_and_b32 s47, s47, 3
s_mul_i32 s47, s47, 4
s_lshr_b32 s48, s2, 2
s_and_b32 s48, s48, 1
s_lshl_b32 s48, s48, 1
s_add_u32 s48, s48, s74
s_lshr_b32 s49, s42, 2
s_xor_b32 s77, s48, s49
s_add_u32 s77, s77, 4
s_add_u32 s78, s47, s77
s_and_b32 s78, s78, 15
s_and_b32 s48, s2, 7
s_add_u32 s75, s78, s48
s_and_b32 s75, s75, 7
s_mul_i32 s75, s75, 2
s_mov_b32 s46, 0
s_and_b32 s43, s40, 3
s_lshl_b32 s70, s43, 12
s_lshl_b32 s71, s43, 11
s_add_u32 s71, s71, 16384
s_cmp_lt_u32 s40, 4
s_cbranch_scc1 L_compute
v_lshrrev_b32 v4, 3, v0
v_and_b32 v5, 7, v0
s_lshl_b32 s48, s43, 4
v_add_u32 v6, s48, v4
s_lshl_b32 s48, s42, 7
s_mov_b32 s49, 6144
v_mul_u32_u24 v6, s49, v6
v_and_b32 v7, 2, v4
v_xor_b32 v7, v7, v5
v_lshl_add_u32 v26, v7, 4, v6
v_add_u32 v26, s48, v26
s_mul_i32 s49, s49, 8
s_sub_u32 s49, s49, 1024
v_xor_b32 v27, 64, v26
v_add_u32 v27, s49, v27
s_mov_b32 s53, 2048
s_mov_b32 s54, 393216
s_mov_b32 s57, 131072
s_lshl_b32 s48, s41, 7
s_lshl_b32 s49, s43, 5
s_add_u32 s48, s48, s49
v_add_u32 v6, s48, v4
v_lshlrev_b32 v6, 11, v6
v_lshrrev_b32 v7, 1, v4
v_xor_b32 v7, v7, v5
v_lshl_add_u32 v20, v7, 4, v6
v_xor_b32 v21, 64, v20
v_add_u32 v21, 15360, v21
v_add_u32 v22, 30720, v20
v_add_u32 v23, 30720, v21
s_add_u32 s69, s47, 0
s_and_b32 s69, s69, 15
s_mul_i32 s67, s69, 128
s_mul_i32 s68, s69, s54
s_waitcnt lgkmcnt(0)
s_mov_b32 s24, s4
s_and_b32 s25, s5, 0xffff
s_mov_b32 s26, 4194304
s_mov_b32 s27, 0x00020000
s_mov_b32 s28, s6
s_and_b32 s29, s7, 0xffff
s_mov_b32 s30, 6291456
s_mov_b32 s31, 0x00020000
s_add_u32 m0, s70, 0
s_nop 0
buffer_load_dwordx4 v20, s[24:27], s67 offen offset:0  lds
buffer_load_dwordx4 v21, s[24:27], s67 offen offset:1024  lds
buffer_load_dwordx4 v22, s[24:27], s67 offen offset:2048  lds
buffer_load_dwordx4 v23, s[24:27], s67 offen offset:3072  lds
s_add_u32 s60, s71, 0
s_add_u32 m0, s60, 0
s_mov_b32 s61, s68
buffer_load_dwordx4 v26, s[28:31], s61 offen lds
buffer_load_dwordx4 v27, s[28:31], s61 offen offset:1024 lds
s_add_u32 m0, s60, 8192
s_add_u32 s61, s61, s53
buffer_load_dwordx4 v26, s[28:31], s61 offen lds
buffer_load_dwordx4 v27, s[28:31], s61 offen offset:1024 lds
s_add_u32 m0, s60, 16384
s_add_u32 s61, s61, s53
buffer_load_dwordx4 v26, s[28:31], s61 offen lds
buffer_load_dwordx4 v27, s[28:31], s61 offen offset:1024 lds
s_mov_b32 s32, s22
s_and_b32 s33, s23, 0xffff
s_mov_b32 s34, 268435456
s_mov_b32 s35, 0x00020000
s_mov_b32 s36, s8
s_and_b32 s37, s9, 0xffff
s_mov_b32 s38, 2097152
s_mov_b32 s39, 0x00020000
v_mov_b32 v56, -1
v_mov_b32 v57, -1
v_mov_b32 v58, -1
v_mov_b32 v59, -1
s_lshl_b32 s52, s41, 6
s_add_u32 s52, s52, s42
s_lshl_b32 s52, s52, 8
s_add_u32 s52, s52, 16777216
s_getreg_b32 s50, hwreg(HW_REG_XCC_ID)
s_and_b32 s50, s50, 7
s_lshl_b32 s50, s50, 3
s_lshl_b64 s[94:95], 1, s50
s_and_b32 s96, s2, 7
s_lshl_b32 s96, s96, 5
s_and_b32 s51, s42, 7
s_cmp_gt_u32 s51, 3
s_cselect_b32 s49, 1, 0
s_sub_u32 s49, s51, s49
s_lshl_b32 s49, s49, 1
s_add_u32 s49, s49, s74
s_lshl_b32 s49, s49, 2
s_add_u32 s49, s49, s43
s_lshr_b32 s50, s49, 4
s_lshl_b32 s50, s50, 11
s_and_b32 s49, s49, 15
s_mul_i32 s49, s49, 24576
s_add_u32 s49, s49, s50
s_and_b32 s50, s42, 8
s_or_b32 s50, s50, 3
s_and_b32 s48, s2, 7
s_add_u32 s76, s50, s48
s_and_b32 s76, s76, 3
s_mul_i32 s76, s76, 4
s_lshl_b32 s50, s50, 7
s_add_u32 s49, s49, s50
s_and_b32 s51, s51, 3
s_cmp_eq_u32 s51, 3
s_cselect_b32 s49, 0x70000000, s49
v_mul_u32_u24 v4, 6144, v4
v_lshl_add_u32 v4, v5, 4, v4
v_lshrrev_b32 v5, 5, v0
v_lshlrev_b32 v5, 30, v5
v_add3_u32 v36, v4, v5, s49
s_mov_b32 s55, -1
s_cmp_eq_u32 s42, 3
s_cselect_b32 s55, 0, s55
s_cmp_eq_u32 s42, 11
s_cselect_b32 s55, 1, s55
s_cmp_eq_u32 s42, 15
s_cselect_b32 s55, 2, s55
s_mov_b32 s56, -1
s_cmp_eq_u32 s78, 3
s_cselect_b32 s56, 0, s56
s_cmp_eq_u32 s78, 11
s_cselect_b32 s56, 1, s56
s_cmp_eq_u32 s78, 15
s_cselect_b32 s56, 2, s56
v_lshrrev_b32 v4, 3, v0
v_and_b32 v5, 7, v0
s_lshr_b32 s48, s43, 1
s_lshl_b32 s48, s48, 5
s_and_b32 s49, s43, 1
s_lshl_b32 s49, s49, 3
s_add_u32 s48, s48, s49
v_lshrrev_b32 v6, 2, v4
v_lshlrev_b32 v6, 4, v6
v_and_b32 v7, 3, v4
v_add3_u32 v6, v6, v7, s48
s_lshl_b32 s48, s78, 7
s_mov_b32 s49, 2048
v_mul_u32_u24 v6, s49, v6
v_and_b32 v7, 2, v4
v_xor_b32 v7, v7, v5
v_lshl_add_u32 v28, v7, 4, v6
v_add_u32 v28, s48, v28
s_mul_i32 s49, s49, 4
s_sub_u32 s49, s49, 1024
v_xor_b32 v29, 64, v28
v_add_u32 v29, s49, v29
v_lshrrev_b32 v4, 3, v0
v_and_b32 v5, 7, v0
s_lshr_b32 s48, s43, 1
s_lshl_b32 s48, s48, 5
s_and_b32 s49, s43, 1
s_lshl_b32 s49, s49, 3
s_add_u32 s48, s48, s49
v_lshrrev_b32 v6, 2, v4
v_lshlrev_b32 v6, 4, v6
v_and_b32 v7, 3, v4
v_add3_u32 v6, v6, v7, s48
s_lshl_b32 s48, s42, 7
s_mov_b32 s49, 6144
s_cmp_ge_i32 s55, 0
s_cselect_b32 s48, 1024, s48
s_cselect_b32 s49, 384, s49
v_mul_u32_u24 v6, s49, v6
v_and_b32 v7, 2, v4
v_xor_b32 v7, v7, v5
v_lshl_add_u32 v60, v7, 4, v6
v_add_u32 v60, s48, v60
s_mul_i32 s49, s49, 4
s_sub_u32 s49, s49, 1024
v_xor_b32 v61, 64, v60
v_add_u32 v61, s49, v61
v_lshrrev_b32 v4, 3, v0
v_and_b32 v5, 7, v0
s_lshr_b32 s48, s43, 1
s_lshl_b32 s48, s48, 5
s_and_b32 s49, s43, 1
s_lshl_b32 s49, s49, 3
s_add_u32 s48, s48, s49
v_lshrrev_b32 v6, 2, v4
v_lshlrev_b32 v6, 4, v6
v_and_b32 v7, 3, v4
v_add3_u32 v6, v6, v7, s48
s_lshl_b32 s48, s78, 7
s_mov_b32 s49, 2048
s_cmp_ge_i32 s56, 0
s_cselect_b32 s48, 1024, s48
s_cselect_b32 s49, 128, s49
v_mul_u32_u24 v6, s49, v6
v_and_b32 v7, 2, v4
v_xor_b32 v7, v7, v5
v_lshl_add_u32 v24, v7, 4, v6
v_add_u32 v24, s48, v24
s_mul_i32 s49, s49, 4
s_sub_u32 s49, s49, 1024
v_xor_b32 v25, 64, v24
v_add_u32 v25, s49, v25
v_lshlrev_b32 v30, 2, v2
v_and_b32 v32, 7, v0
v_lshlrev_b32 v32, 5, v32
s_lshl_b32 s50, s41, 2
s_add_u32 s50, s50, s43
s_lshl_b32 s50, s50, 12
s_add_u32 s50, s50, 16777216
v_add_u32 v37, s50, v18
v_lshrrev_b32 v4, 5, v0
v_lshl_add_u32 v4, v4, 4, v2
s_lshl_b32 s48, s43, 5
v_add_u32 v4, s48, v4
v_lshlrev_b32 v49, 3, v4
v_add_u32 v49, 131072, v49
v_lshlrev_b32 v50, 2, v4
v_add_u32 v50, 132096, v50
s_lshl_b32 s79, s41, 2
s_add_u32 s79, s79, s43
s_lshl_b32 s79, s79, 7
s_add_u32 s79, s79, 18358272
s_lshl_b32 s48, s41, 3
s_lshl_b32 s49, s43, 1
s_add_u32 s48, s48, s49
s_lshl_b32 s80, s48, 15
s_lshl_b32 s49, s42, 11
s_add_u32 s81, s80, s49
s_add_u32 s81, s81, 4194304
s_add_u32 s82, s81, 32768
s_lshl_b32 s48, s43, 11
v_add_u32 v51, s48, v18
v_add_u32 v52, 0x10000, v51
s_lshl_b32 s48, s2, 2
s_add_u32 s48, s48, s43
s_lshl_b32 s83, s48, 11
s_mul_i32 s87, s48, 6144
v_add_u32 v62, s83, v18
s_add_u32 s87, s87, 3072
v_add_u32 v63, s87, v18
v_lshrrev_b32 v4, 3, v0
v_and_b32 v5, 7, v0
s_lshl_b32 s48, s2, 2
s_add_u32 s48, s48, s43
s_add_u32 s48, s48, 0
s_lshr_b32 s49, s48, 7
s_and_b32 s48, s48, 127
s_lshl_b32 s48, s48, 3
v_add_u32 v6, s48, v4
s_mul_i32 s50, s49, 43
s_lshr_b32 s50, s50, 7
s_mul_i32 s51, s50, 3
s_sub_u32 s51, s49, s51
s_cmp_ge_u32 s50, 3
s_cselect_b32 s58, s6, s12
s_cselect_b32 s59, s7, s13
s_cselect_b32 s48, 3, 0
s_sub_u32 s48, s50, s48
s_mul_i32 s60, s50, 393216
s_lshl_b32 s61, s51, 7
s_add_u32 s60, s60, s61
s_lshl_b32 s61, s51, 11
s_cmp_eq_u32 s50, 6
s_cselect_b32 s58, s16, s58
s_cselect_b32 s59, s17, s59
s_cselect_b32 s48, s51, s48
s_cselect_b32 s61, 0, s61
s_cselect_b32 s63, 1, 3
s_mul_i32 s62, s63, 2048
s_mul_i32 s63, s63, 128
s_mul_i32 s49, s51, 130944
s_cselect_b32 s49, s49, 0
s_add_u32 s60, s60, s49
s_add_u32 s60, s60, 18874368
s_lshl_b32 s48, s48, 3
s_add_u32 s48, s48, 3
s_min_u32 s48, s48, 15
s_lshl_b32 s48, s48, 7
s_add_u32 s61, s61, s48
s_add_u32 s58, s58, s61
s_addc_u32 s59, s59, 0
v_mul_u32_u24 v7, s62, v6
v_lshl_add_u32 v7, v5, 4, v7
v_mov_b32 v8, s59
v_add_co_u32 v64, vcc, s58, v7
s_nop 1
v_addc_co_u32 v65, vcc, 0, v8, vcc
v_mul_u32_u24 v7, s63, v6
v_lshl_add_u32 v7, v5, 4, v7
v_add_u32 v70, s60, v7
s_lshl_b32 s48, s2, 2
s_add_u32 s48, s48, s43
s_add_u32 s48, s48, 1024
s_lshr_b32 s49, s48, 7
s_and_b32 s48, s48, 127
s_lshl_b32 s48, s48, 3
v_add_u32 v6, s48, v4
s_mul_i32 s50, s49, 43
s_lshr_b32 s50, s50, 7
s_mul_i32 s51, s50, 3
s_sub_u32 s51, s49, s51
s_cmp_ge_u32 s50, 3
s_cselect_b32 s58, s6, s12
s_cselect_b32 s59, s7, s13
s_cselect_b32 s48, 3, 0
s_sub_u32 s48, s50, s48
s_mul_i32 s60, s50, 393216
s_lshl_b32 s61, s51, 7
s_add_u32 s60, s60, s61
s_lshl_b32 s61, s51, 11
s_cmp_eq_u32 s50, 6
s_cselect_b32 s58, s16, s58
s_cselect_b32 s59, s17, s59
s_cselect_b32 s48, s51, s48
s_cselect_b32 s61, 0, s61
s_cselect_b32 s63, 1, 3
s_mul_i32 s62, s63, 2048
s_mul_i32 s63, s63, 128
s_mul_i32 s49, s51, 130944
s_cselect_b32 s49, s49, 0
s_add_u32 s60, s60, s49
s_add_u32 s60, s60, 18874368
s_lshl_b32 s48, s48, 3
s_add_u32 s48, s48, 3
s_min_u32 s48, s48, 15
s_lshl_b32 s48, s48, 7
s_add_u32 s61, s61, s48
s_add_u32 s58, s58, s61
s_addc_u32 s59, s59, 0
v_mul_u32_u24 v7, s62, v6
v_lshl_add_u32 v7, v5, 4, v7
v_mov_b32 v8, s59
v_add_co_u32 v66, vcc, s58, v7
s_nop 1
v_addc_co_u32 v67, vcc, 0, v8, vcc
v_mul_u32_u24 v7, s63, v6
v_lshl_add_u32 v7, v5, 4, v7
v_add_u32 v71, s60, v7
s_lshl_b32 s48, s2, 2
s_add_u32 s48, s48, s43
s_add_u32 s48, s48, 2048
s_cmp_gt_u32 s48, 2687
s_cselect_b32 s97, 0xe0000000, 0
s_cselect_b32 s49, 1024, 0
s_sub_u32 s48, s48, s49
s_lshr_b32 s49, s48, 7
s_and_b32 s48, s48, 127
s_lshl_b32 s48, s48, 3
v_add_u32 v6, s48, v4
s_mul_i32 s50, s49, 43
s_lshr_b32 s50, s50, 7
s_mul_i32 s51, s50, 3
s_sub_u32 s51, s49, s51
s_cmp_ge_u32 s50, 3
s_cselect_b32 s58, s6, s12
s_cselect_b32 s59, s7, s13
s_cselect_b32 s48, 3, 0
s_sub_u32 s48, s50, s48
s_mul_i32 s60, s50, 393216
s_lshl_b32 s61, s51, 7
s_add_u32 s60, s60, s61
s_lshl_b32 s61, s51, 11
s_cmp_eq_u32 s50, 6
s_cselect_b32 s58, s16, s58
s_cselect_b32 s59, s17, s59
s_cselect_b32 s48, s51, s48
s_cselect_b32 s61, 0, s61
s_cselect_b32 s63, 1, 3
s_mul_i32 s62, s63, 2048
s_mul_i32 s63, s63, 128
s_mul_i32 s49, s51, 130944
s_cselect_b32 s49, s49, 0
s_add_u32 s60, s60, s49
s_add_u32 s60, s60, 18874368
s_lshl_b32 s48, s48, 3
s_add_u32 s48, s48, 3
s_min_u32 s48, s48, 15
s_lshl_b32 s48, s48, 7
s_add_u32 s61, s61, s48
s_add_u32 s58, s58, s61
s_addc_u32 s59, s59, 0
v_mul_u32_u24 v7, s62, v6
v_lshl_add_u32 v7, v5, 4, v7
v_mov_b32 v8, s59
v_add_co_u32 v68, vcc, s58, v7
s_nop 1
v_addc_co_u32 v69, vcc, 0, v8, vcc
v_mul_u32_u24 v7, s63, v6
v_lshl_add_u32 v7, v5, 4, v7
v_add_u32 v72, s60, v7
v_add_u32 v72, s97, v72
s_mul_i32 s48, s42, 393216
s_lshl_b32 s49, s41, 2
s_add_u32 s49, s49, s43
s_mul_i32 s49, s49, 6144
s_add_u32 s48, s48, s49
s_add_u32 s86, s48, 9437184
s_lshl_b32 s50, s43, 12
s_add_u32 s50, s50, s52
s_add_u32 s50, s50, 262144
v_min_u32 v8, 2, v3
v_lshlrev_b32 v8, 18, v8
v_lshl_add_u32 v8, v2, 4, v8
v_add_u32 v55, s50, v8
s_lshl_b32 s50, s42, 2
s_add_u32 s50, s50, s43
s_lshl_b32 s50, s50, 12
s_add_u32 s50, s50, 17825792
v_add_u32 v38, s50, v18
v_min_u32 v4, 2, v3
v_lshlrev_b32 v4, 8, v4
v_lshl_add_u32 v4, v2, 2, v4
s_and_b32 s48, s43, 1
s_lshl_b32 s48, s48, 7
s_lshr_b32 s49, s43, 1
s_lshl_b32 s49, s49, 6
s_add_u32 s48, s48, s49
s_add_u32 s48, s48, 133120
v_add_u32 v53, s48, v4
s_getpc_b64 s[98:99]
pc_1:
s_add_u32 s98, s98, c0_last - pc_1
s_addc_u32 s99, s99, 0
s_lshr_b32 s50, s2, 3
s_lshl_b32 s50, s50, 2
s_add_u32 s50, s50, s43
s_lshl_b32 s50, s50, 7
v_and_b32 v4, 1, v0
v_lshl_add_u32 v4, v4, 6, s50
v_min_u32 v54, L_code_end - c0_last, v4
s_add_u32 s69, s47, 1
s_and_b32 s69, s69, 15
s_mul_i32 s67, s69, 128
s_mul_i32 s68, s69, s54
s_add_u32 m0, s70, 40960
s_nop 0
buffer_load_dwordx4 v20, s[24:27], s67 offen offset:0  lds
buffer_load_dwordx4 v21, s[24:27], s67 offen offset:1024  lds
buffer_load_dwordx4 v22, s[24:27], s67 offen offset:2048  lds
buffer_load_dwordx4 v23, s[24:27], s67 offen offset:3072  lds
s_add_u32 s60, s71, 40960
s_add_u32 m0, s60, 0
s_mov_b32 s61, s68
buffer_load_dwordx4 v26, s[28:31], s61 offen lds
buffer_load_dwordx4 v27, s[28:31], s61 offen offset:1024 lds
s_add_u32 m0, s60, 8192
s_add_u32 s61, s61, s53
buffer_load_dwordx4 v26, s[28:31], s61 offen lds
buffer_load_dwordx4 v27, s[28:31], s61 offen offset:1024 lds
s_add_u32 m0, s60, 16384
s_add_u32 s61, s61, s53
buffer_load_dwordx4 v26, s[28:31], s61 offen lds
buffer_load_dwordx4 v27, s[28:31], s61 offen offset:1024 lds
s_waitcnt vmcnt(10)
s_barrier
s_add_u32 s49, s76, 2
s_and_b32 s49, s49, 15
s_mul_i32 s49, s49, 393216
buffer_load_dwordx4 v[40:43], v36, s[28:31], s49 offen
s_add_u32 s49, s76, 3
s_and_b32 s49, s49, 15
s_mul_i32 s49, s49, 393216
buffer_load_dwordx4 v[40:43], v36, s[28:31], s49 offen
s_add_u32 s69, s47, 2
s_and_b32 s69, s69, 15
s_mul_i32 s67, s69, 128
s_mul_i32 s68, s69, s54
s_add_u32 m0, s70, 81920
s_nop 0
buffer_load_dwordx4 v20, s[24:27], s67 offen offset:0  lds
buffer_load_dwordx4 v21, s[24:27], s67 offen offset:1024  lds
buffer_load_dwordx4 v22, s[24:27], s67 offen offset:2048  lds
buffer_load_dwordx4 v23, s[24:27], s67 offen offset:3072  lds
s_add_u32 s60, s71, 81920
s_add_u32 m0, s60, 0
s_mov_b32 s61, s68
buffer_load_dwordx4 v26, s[28:31], s61 offen lds
buffer_load_dwordx4 v27, s[28:31], s61 offen offset:1024 lds
s_add_u32 m0, s60, 8192
s_add_u32 s61, s61, s53
buffer_load_dwordx4 v26, s[28:31], s61 offen lds
buffer_load_dwordx4 v27, s[28:31], s61 offen offset:1024 lds
s_add_u32 m0, s60, 16384
s_add_u32 s61, s61, s53
buffer_load_dwordx4 v26, s[28:31], s61 offen lds
buffer_load_dwordx4 v27, s[28:31], s61 offen offset:1024 lds
s_add_u32 s49, s76, 4
s_and_b32 s49, s49, 15
s_mul_i32 s49, s49, 393216
buffer_load_dwordx4 v[40:43], v36, s[28:31], s49 offen
s_mov_b32 s64, 0
s_mov_b32 s65, 0
s_waitcnt vmcnt(11)
s_barrier
s_add_u32 s69, s69, 1
s_and_b32 s69, s69, 15
s_mul_i32 s67, s69, 128
s_mul_i32 s68, s69, s54
s_add_u32 m0, s70, s65
s_nop 0
buffer_load_dwordx4 v20, s[24:27], s67 offen offset:0  lds
buffer_load_dwordx4 v21, s[24:27], s67 offen offset:1024  lds
buffer_load_dwordx4 v22, s[24:27], s67 offen offset:2048  lds
buffer_load_dwordx4 v23, s[24:27], s67 offen offset:3072  lds
s_add_u32 s60, s71, s65
s_add_u32 m0, s60, 0
s_mov_b32 s61, s68
buffer_load_dwordx4 v26, s[28:31], s61 offen lds
buffer_load_dwordx4 v27, s[28:31], s61 offen offset:1024 lds
s_add_u32 m0, s60, 8192
s_add_u32 s61, s61, s53
buffer_load_dwordx4 v26, s[28:31], s61 offen lds
buffer_load_dwordx4 v27, s[28:31], s61 offen offset:1024 lds
s_add_u32 m0, s60, 16384
s_add_u32 s61, s61, s53
buffer_load_dwordx4 v26, s[28:31], s61 offen lds
buffer_load_dwordx4 v27, s[28:31], s61 offen offset:1024 lds
s_add_u32 s48, s64, 5
s_min_u32 s48, s48, 15
s_add_u32 s49, s48, s76
s_and_b32 s49, s49, 15
s_mul_i32 s49, s49, 393216
buffer_load_dwordx4 v[40:43], v36, s[28:31], s49 offen
s_add_u32 s65, s65, 40960
s_cmp_eq_u32 s65, 122880
s_cselect_b32 s65, 0, s65
s_add_u32 s64, s64, 1
s_waitcnt vmcnt(11)
s_barrier
global_load_dwordx4 v[96:99], v[64:65], off
global_load_dwordx4 v[100:103], v[66:67], off
global_load_dwordx4 v[104:107], v[68:69], off
s_add_u32 s69, s69, 1
s_and_b32 s69, s69, 15
s_mul_i32 s67, s69, 128
s_mul_i32 s68, s69, s54
s_add_u32 m0, s70, s65
s_nop 0
buffer_load_dwordx4 v20, s[24:27], s67 offen offset:0  lds
buffer_load_dwordx4 v21, s[24:27], s67 offen offset:1024  lds
buffer_load_dwordx4 v22, s[24:27], s67 offen offset:2048  lds
buffer_load_dwordx4 v23, s[24:27], s67 offen offset:3072  lds
s_add_u32 s60, s71, s65
s_add_u32 m0, s60, 0
s_mov_b32 s61, s68
buffer_load_dwordx4 v26, s[28:31], s61 offen lds
buffer_load_dwordx4 v27, s[28:31], s61 offen offset:1024 lds
s_add_u32 m0, s60, 8192
s_add_u32 s61, s61, s53
buffer_load_dwordx4 v26, s[28:31], s61 offen lds
buffer_load_dwordx4 v27, s[28:31], s61 offen offset:1024 lds
s_add_u32 m0, s60, 16384
s_add_u32 s61, s61, s53
buffer_load_dwordx4 v26, s[28:31], s61 offen lds
buffer_load_dwordx4 v27, s[28:31], s61 offen offset:1024 lds
s_add_u32 s48, s64, 5
s_min_u32 s48, s48, 15
s_add_u32 s49, s48, s76
s_and_b32 s49, s49, 15
s_mul_i32 s49, s49, 393216
buffer_load_dwordx4 v[40:43], v36, s[28:31], s49 offen
s_add_u32 s65, s65, 40960
s_cmp_eq_u32 s65, 122880
s_cselect_b32 s65, 0, s65
s_add_u32 s64, s64, 1
s_waitcnt vmcnt(11)
s_barrier
buffer_store_dwordx4 v[96:99], v70, s[32:35], 0 offen sc1
buffer_store_dwordx4 v[100:103], v71, s[32:35], 0 offen sc1
buffer_store_dwordx4 v[104:107], v72, s[32:35], 0 offen sc1
buffer_store_dwordx4 v[56:59], v18, s[32:35], s86 offen sc1
s_add_u32 s86, s86, 1024
s_add_u32 s69, s69, 1
s_and_b32 s69, s69, 15
s_mul_i32 s67, s69, 128
s_mul_i32 s68, s69, s54
s_add_u32 m0, s70, s65
s_nop 0
buffer_load_dwordx4 v20, s[24:27], s67 offen offset:0  lds
buffer_load_dwordx4 v21, s[24:27], s67 offen offset:1024  lds
buffer_load_dwordx4 v22, s[24:27], s67 offen offset:2048  lds
buffer_load_dwordx4 v23, s[24:27], s67 offen offset:3072  lds
s_add_u32 s60, s71, s65
s_add_u32 m0, s60, 0
s_mov_b32 s61, s68
buffer_load_dwordx4 v26, s[28:31], s61 offen lds
buffer_load_dwordx4 v27, s[28:31], s61 offen offset:1024 lds
s_add_u32 m0, s60, 8192
s_add_u32 s61, s61, s53
buffer_load_dwordx4 v26, s[28:31], s61 offen lds
buffer_load_dwordx4 v27, s[28:31], s61 offen offset:1024 lds
s_add_u32 m0, s60, 16384
s_add_u32 s61, s61, s53
buffer_load_dwordx4 v26, s[28:31], s61 offen lds
buffer_load_dwordx4 v27, s[28:31], s61 offen offset:1024 lds
s_add_u32 s48, s64, 5
s_min_u32 s48, s48, 15
s_add_u32 s49, s48, s76
s_and_b32 s49, s49, 15
s_mul_i32 s49, s49, 393216
buffer_load_dwordx4 v[40:43], v36, s[28:31], s49 offen
s_add_u32 s65, s65, 40960
s_cmp_eq_u32 s65, 122880
s_cselect_b32 s65, 0, s65
s_add_u32 s64, s64, 1
s_waitcnt vmcnt(11)
s_barrier
s_cmp_lg_u32 s43, 3
s_cbranch_scc1 else_2
s_atomic_add_x2 s[94:95], s[20:21], s96
else_2:
buffer_store_dwordx4 v[56:59], v18, s[32:35], s86 offen sc1
s_add_u32 s86, s86, 1024
s_add_u32 s69, s69, 1
s_and_b32 s69, s69, 15
s_mul_i32 s67, s69, 128
s_mul_i32 s68, s69, s54
s_add_u32 m0, s70, s65
s_nop 0
buffer_load_dwordx4 v20, s[24:27], s67 offen offset:0  lds
buffer_load_dwordx4 v21, s[24:27], s67 offen offset:1024  lds
buffer_load_dwordx4 v22, s[24:27], s67 offen offset:2048  lds
buffer_load_dwordx4 v23, s[24:27], s67 offen offset:3072  lds
s_add_u32 s60, s71, s65
s_add_u32 m0, s60, 0
s_mov_b32 s61, s68
buffer_load_dwordx4 v26, s[28:31], s61 offen lds
buffer_load_dwordx4 v27, s[28:31], s61 offen offset:1024 lds
s_add_u32 m0, s60, 8192
s_add_u32 s61, s61, s53
buffer_load_dwordx4 v26, s[28:31], s61 offen lds
buffer_load_dwordx4 v27, s[28:31], s61 offen offset:1024 lds
s_add_u32 m0, s60, 16384
s_add_u32 s61, s61, s53
buffer_load_dwordx4 v26, s[28:31], s61 offen lds
buffer_load_dwordx4 v27, s[28:31], s61 offen offset:1024 lds
s_add_u32 s48, s64, 5
s_min_u32 s48, s48, 15
s_add_u32 s49, s48, s76
s_and_b32 s49, s49, 15
s_mul_i32 s49, s49, 393216
buffer_load_dwordx4 v[40:43], v36, s[28:31], s49 offen
s_add_u32 s65, s65, 40960
s_cmp_eq_u32 s65, 122880
s_cselect_b32 s65, 0, s65
s_add_u32 s64, s64, 1
s_waitcnt vmcnt(11)
s_barrier
buffer_store_dwordx4 v[56:59], v18, s[32:35], s86 offen sc1
s_add_u32 s86, s86, 1024
s_add_u32 s69, s69, 1
s_and_b32 s69, s69, 15
s_mul_i32 s67, s69, 128
s_mul_i32 s68, s69, s54
s_add_u32 m0, s70, s65
s_nop 0
buffer_load_dwordx4 v20, s[24:27], s67 offen offset:0  lds
buffer_load_dwordx4 v21, s[24:27], s67 offen offset:1024  lds
buffer_load_dwordx4 v22, s[24:27], s67 offen offset:2048  lds
buffer_load_dwordx4 v23, s[24:27], s67 offen offset:3072  lds
s_add_u32 s60, s71, s65
s_add_u32 m0, s60, 0
s_mov_b32 s61, s68
buffer_load_dwordx4 v26, s[28:31], s61 offen lds
buffer_load_dwordx4 v27, s[28:31], s61 offen offset:1024 lds
s_add_u32 m0, s60, 8192
s_add_u32 s61, s61, s53
buffer_load_dwordx4 v26, s[28:31], s61 offen lds
buffer_load_dwordx4 v27, s[28:31], s61 offen offset:1024 lds
s_add_u32 m0, s60, 16384
s_add_u32 s61, s61, s53
buffer_load_dwordx4 v26, s[28:31], s61 offen lds
buffer_load_dwordx4 v27, s[28:31], s61 offen offset:1024 lds
s_add_u32 s48, s64, 5
s_min_u32 s48, s48, 15
s_add_u32 s49, s48, s76
s_and_b32 s49, s49, 15
s_mul_i32 s49, s49, 393216
buffer_load_dwordx4 v[40:43], v36, s[28:31], s49 offen
s_add_u32 s65, s65, 40960
s_cmp_eq_u32 s65, 122880
s_cselect_b32 s65, 0, s65
s_add_u32 s64, s64, 1
s_waitcnt vmcnt(11)
s_barrier
buffer_store_dwordx4 v[56:59], v18, s[32:35], s86 offen sc1
s_add_u32 s86, s86, 1024
s_add_u32 s69, s69, 1
s_and_b32 s69, s69, 15
s_mul_i32 s67, s69, 128
s_mul_i32 s68, s69, s54
s_add_u32 m0, s70, s65
s_nop 0
buffer_load_dwordx4 v20, s[24:27], s67 offen offset:0  lds
buffer_load_dwordx4 v21, s[24:27], s67 offen offset:1024  lds
buffer_load_dwordx4 v22, s[24:27], s67 offen offset:2048  lds
buffer_load_dwordx4 v23, s[24:27], s67 offen offset:3072  lds
s_add_u32 s60, s71, s65
s_add_u32 m0, s60, 0
s_mov_b32 s61, s68
buffer_load_dwordx4 v26, s[28:31], s61 offen lds
buffer_load_dwordx4 v27, s[28:31], s61 offen offset:1024 lds
s_add_u32 m0, s60, 8192
s_add_u32 s61, s61, s53
buffer_load_dwordx4 v26, s[28:31], s61 offen lds
buffer_load_dwordx4 v27, s[28:31], s61 offen offset:1024 lds
s_add_u32 m0, s60, 16384
s_add_u32 s61, s61, s53
buffer_load_dwordx4 v26, s[28:31], s61 offen lds
buffer_load_dwordx4 v27, s[28:31], s61 offen offset:1024 lds
s_add_u32 s48, s64, 5
s_min_u32 s48, s48, 15
s_add_u32 s49, s48, s76
s_and_b32 s49, s49, 15
s_mul_i32 s49, s49, 393216
buffer_load_dwordx4 v[40:43], v36, s[28:31], s49 offen
s_add_u32 s65, s65, 40960
s_cmp_eq_u32 s65, 122880
s_cselect_b32 s65, 0, s65
s_add_u32 s64, s64, 1
s_waitcnt vmcnt(11)
s_barrier
buffer_store_dwordx4 v[56:59], v18, s[32:35], s86 offen sc1
s_add_u32 s86, s86, 1024
s_add_u32 s69, s69, 1
s_and_b32 s69, s69, 15
s_mul_i32 s67, s69, 128
s_mul_i32 s68, s69, s54
s_add_u32 m0, s70, s65
s_nop 0
buffer_load_dwordx4 v20, s[24:27], s67 offen offset:0  lds
buffer_load_dwordx4 v21, s[24:27], s67 offen offset:1024  lds
buffer_load_dwordx4 v22, s[24:27], s67 offen offset:2048  lds
buffer_load_dwordx4 v23, s[24:27], s67 offen offset:3072  lds
s_add_u32 s60, s71, s65
s_add_u32 m0, s60, 0
s_mov_b32 s61, s68
buffer_load_dwordx4 v26, s[28:31], s61 offen lds
buffer_load_dwordx4 v27, s[28:31], s61 offen offset:1024 lds
s_add_u32 m0, s60, 8192
s_add_u32 s61, s61, s53
buffer_load_dwordx4 v26, s[28:31], s61 offen lds
buffer_load_dwordx4 v27, s[28:31], s61 offen offset:1024 lds
s_add_u32 m0, s60, 16384
s_add_u32 s61, s61, s53
buffer_load_dwordx4 v26, s[28:31], s61 offen lds
buffer_load_dwordx4 v27, s[28:31], s61 offen offset:1024 lds
s_add_u32 s48, s64, 5
s_min_u32 s48, s48, 15
s_add_u32 s49, s48, s76
s_and_b32 s49, s49, 15
s_mul_i32 s49, s49, 393216
buffer_load_dwordx4 v[40:43], v36, s[28:31], s49 offen
s_add_u32 s65, s65, 40960
s_cmp_eq_u32 s65, 122880
s_cselect_b32 s65, 0, s65
s_add_u32 s64, s64, 1
s_waitcnt vmcnt(11)
s_barrier
buffer_store_dwordx4 v[56:59], v18, s[32:35], s86 offen sc1
s_add_u32 s86, s86, 1024
s_add_u32 s69, s69, 1
s_and_b32 s69, s69, 15
s_mul_i32 s67, s69, 128
s_mul_i32 s68, s69, s54
s_add_u32 m0, s70, s65
s_nop 0
buffer_load_dwordx4 v20, s[24:27], s67 offen offset:0  lds
buffer_load_dwordx4 v21, s[24:27], s67 offen offset:1024  lds
buffer_load_dwordx4 v22, s[24:27], s67 offen offset:2048  lds
buffer_load_dwordx4 v23, s[24:27], s67 offen offset:3072  lds
s_add_u32 s60, s71, s65
s_add_u32 m0, s60, 0
s_mov_b32 s61, s68
buffer_load_dwordx4 v26, s[28:31], s61 offen lds
buffer_load_dwordx4 v27, s[28:31], s61 offen offset:1024 lds
s_add_u32 m0, s60, 8192
s_add_u32 s61, s61, s53
buffer_load_dwordx4 v26, s[28:31], s61 offen lds
buffer_load_dwordx4 v27, s[28:31], s61 offen offset:1024 lds
s_add_u32 m0, s60, 16384
s_add_u32 s61, s61, s53
buffer_load_dwordx4 v26, s[28:31], s61 offen lds
buffer_load_dwordx4 v27, s[28:31], s61 offen offset:1024 lds
s_add_u32 s48, s64, 5
s_min_u32 s48, s48, 15
s_add_u32 s49, s48, s76
s_and_b32 s49, s49, 15
s_mul_i32 s49, s49, 393216
buffer_load_dwordx4 v[40:43], v36, s[28:31], s49 offen
s_add_u32 s65, s65, 40960
s_cmp_eq_u32 s65, 122880
s_cselect_b32 s65, 0, s65
s_add_u32 s64, s64, 1
s_waitcnt vmcnt(11)
s_barrier
s_add_u32 s69, s69, 1
s_and_b32 s69, s69, 15
s_mul_i32 s67, s69, 128
s_mul_i32 s68, s69, s54
s_add_u32 m0, s70, s65
s_nop 0
buffer_load_dwordx4 v20, s[24:27], s67 offen offset:0  lds
buffer_load_dwordx4 v21, s[24:27], s67 offen offset:1024  lds
buffer_load_dwordx4 v22, s[24:27], s67 offen offset:2048  lds
buffer_load_dwordx4 v23, s[24:27], s67 offen offset:3072  lds
s_add_u32 s60, s71, s65
s_add_u32 m0, s60, 0
s_mov_b32 s61, s68
buffer_load_dwordx4 v26, s[28:31], s61 offen lds
buffer_load_dwordx4 v27, s[28:31], s61 offen offset:1024 lds
s_add_u32 m0, s60, 8192
s_add_u32 s61, s61, s53
buffer_load_dwordx4 v26, s[28:31], s61 offen lds
buffer_load_dwordx4 v27, s[28:31], s61 offen offset:1024 lds
s_add_u32 m0, s60, 16384
s_add_u32 s61, s61, s53
buffer_load_dwordx4 v26, s[28:31], s61 offen lds
buffer_load_dwordx4 v27, s[28:31], s61 offen offset:1024 lds
s_add_u32 s48, s64, 5
s_min_u32 s48, s48, 15
s_add_u32 s49, s48, s76
s_and_b32 s49, s49, 15
s_mul_i32 s49, s49, 393216
buffer_load_dwordx4 v[40:43], v36, s[28:31], s49 offen
s_add_u32 s65, s65, 40960
s_cmp_eq_u32 s65, 122880
s_cselect_b32 s65, 0, s65
s_add_u32 s64, s64, 1
s_waitcnt vmcnt(11)
s_barrier
s_add_u32 s69, s69, 1
s_and_b32 s69, s69, 15
s_mul_i32 s67, s69, 128
s_mul_i32 s68, s69, s54
s_add_u32 m0, s70, s65
s_nop 0
buffer_load_dwordx4 v20, s[24:27], s67 offen offset:0  lds
buffer_load_dwordx4 v21, s[24:27], s67 offen offset:1024  lds
buffer_load_dwordx4 v22, s[24:27], s67 offen offset:2048  lds
buffer_load_dwordx4 v23, s[24:27], s67 offen offset:3072  lds
s_add_u32 s60, s71, s65
s_add_u32 m0, s60, 0
s_mov_b32 s61, s68
buffer_load_dwordx4 v26, s[28:31], s61 offen lds
buffer_load_dwordx4 v27, s[28:31], s61 offen offset:1024 lds
s_add_u32 m0, s60, 8192
s_add_u32 s61, s61, s53
buffer_load_dwordx4 v26, s[28:31], s61 offen lds
buffer_load_dwordx4 v27, s[28:31], s61 offen offset:1024 lds
s_add_u32 m0, s60, 16384
s_add_u32 s61, s61, s53
buffer_load_dwordx4 v26, s[28:31], s61 offen lds
buffer_load_dwordx4 v27, s[28:31], s61 offen offset:1024 lds
s_add_u32 s48, s64, 5
s_min_u32 s48, s48, 15
s_add_u32 s49, s48, s76
s_and_b32 s49, s49, 15
s_mul_i32 s49, s49, 393216
buffer_load_dwordx4 v[40:43], v36, s[28:31], s49 offen
s_add_u32 s65, s65, 40960
s_cmp_eq_u32 s65, 122880
s_cselect_b32 s65, 0, s65
s_add_u32 s64, s64, 1
s_waitcnt vmcnt(11)
s_barrier
s_add_u32 s69, s69, 1
s_and_b32 s69, s69, 15
s_mul_i32 s67, s69, 128
s_mul_i32 s68, s69, s54
s_add_u32 m0, s70, s65
s_nop 0
buffer_load_dwordx4 v20, s[24:27], s67 offen offset:0  lds
buffer_load_dwordx4 v21, s[24:27], s67 offen offset:1024  lds
buffer_load_dwordx4 v22, s[24:27], s67 offen offset:2048  lds
buffer_load_dwordx4 v23, s[24:27], s67 offen offset:3072  lds
s_add_u32 s60, s71, s65
s_add_u32 m0, s60, 0
s_mov_b32 s61, s68
buffer_load_dwordx4 v26, s[28:31], s61 offen lds
buffer_load_dwordx4 v27, s[28:31], s61 offen offset:1024 lds
s_add_u32 m0, s60, 8192
s_add_u32 s61, s61, s53
buffer_load_dwordx4 v26, s[28:31], s61 offen lds
buffer_load_dwordx4 v27, s[28:31], s61 offen offset:1024 lds
s_add_u32 m0, s60, 16384
s_add_u32 s61, s61, s53
buffer_load_dwordx4 v26, s[28:31], s61 offen lds
buffer_load_dwordx4 v27, s[28:31], s61 offen offset:1024 lds
s_add_u32 s48, s64, 5
s_min_u32 s48, s48, 15
s_add_u32 s49, s48, s76
s_and_b32 s49, s49, 15
s_mul_i32 s49, s49, 393216
buffer_load_dwordx4 v[40:43], v36, s[28:31], s49 offen
s_add_u32 s65, s65, 40960
s_cmp_eq_u32 s65, 122880
s_cselect_b32 s65, 0, s65
s_add_u32 s64, s64, 1
s_waitcnt vmcnt(11)
s_barrier
global_load_dwordx2 v[34:35], v32, s[20:21] sc1
s_add_u32 s69, s69, 1
s_and_b32 s69, s69, 15
s_mul_i32 s67, s69, 128
s_mul_i32 s68, s69, s54
s_add_u32 m0, s70, s65
s_nop 0
buffer_load_dwordx4 v20, s[24:27], s67 offen offset:0  lds
buffer_load_dwordx4 v21, s[24:27], s67 offen offset:1024  lds
buffer_load_dwordx4 v22, s[24:27], s67 offen offset:2048  lds
buffer_load_dwordx4 v23, s[24:27], s67 offen offset:3072  lds
s_add_u32 s60, s71, s65
s_add_u32 m0, s60, 0
s_mov_b32 s61, s68
buffer_load_dwordx4 v26, s[28:31], s61 offen lds
buffer_load_dwordx4 v27, s[28:31], s61 offen offset:1024 lds
s_add_u32 m0, s60, 8192
s_add_u32 s61, s61, s53
buffer_load_dwordx4 v26, s[28:31], s61 offen lds
buffer_load_dwordx4 v27, s[28:31], s61 offen offset:1024 lds
s_add_u32 m0, s60, 16384
s_add_u32 s61, s61, s53
buffer_load_dwordx4 v26, s[28:31], s61 offen lds
buffer_load_dwordx4 v27, s[28:31], s61 offen offset:1024 lds
s_add_u32 s65, s65, 40960
s_cmp_eq_u32 s65, 122880
s_cselect_b32 s65, 0, s65
s_add_u32 s64, s64, 1
s_waitcnt vmcnt(10)
s_barrier
s_mov_b32 s63, 0
ipoll_4:
v_sad_u8 v4, v34, 0, 0
v_sad_u8 v4, v35, 0, v4
v_cmp_gt_u32 vcc, 32, v4
s_cbranch_vccz ipolled_5
global_load_dwordx2 v[34:35], v32, s[20:21] sc1
s_add_u32 s63, s63, 1
s_cmp_lt_u32 s63, 0x80000
s_waitcnt vmcnt(0)
s_cbranch_scc1 ipoll_4
ipolled_5:
buffer_load_dwordx4 v[80:83], v37, s[32:35], 0 offen offset:0 sc1
buffer_load_dwordx4 v[84:87], v37, s[32:35], 0 offen offset:1024 sc1
buffer_load_dwordx4 v[88:91], v37, s[32:35], 0 offen offset:2048 sc1
buffer_load_dwordx4 v[92:95], v37, s[32:35], 0 offen offset:3072 sc1
s_add_u32 s69, s47, 15
s_and_b32 s69, s69, 15
s_mul_i32 s67, s69, 128
s_mul_i32 s68, s69, s54
s_add_u32 m0, s70, 0
s_nop 0
buffer_load_dwordx4 v20, s[24:27], s67 offen offset:0  lds
buffer_load_dwordx4 v21, s[24:27], s67 offen offset:1024  lds
buffer_load_dwordx4 v22, s[24:27], s67 offen offset:2048  lds
buffer_load_dwordx4 v23, s[24:27], s67 offen offset:3072  lds
s_add_u32 s60, s71, 0
s_add_u32 m0, s60, 0
s_mov_b32 s61, s68
buffer_load_dwordx4 v26, s[28:31], s61 offen lds
buffer_load_dwordx4 v27, s[28:31], s61 offen offset:1024 lds
s_waitcnt vmcnt(10)
s_barrier
s_setprio 0
s_add_u32 m0, s60, 8192
s_add_u32 s61, s61, s53
buffer_load_dwordx4 v26, s[28:31], s61 offen lds
buffer_load_dwordx4 v27, s[28:31], s61 offen offset:1024 lds
s_waitcnt vmcnt(8)
s_add_u32 m0, s60, 16384
s_add_u32 s61, s61, s53
buffer_load_dwordx4 v26, s[28:31], s61 offen lds
v_add_f32 v80, v80, v88
v_add_f32 v81, v81, v89
v_add_f32 v82, v82, v90
v_add_f32 v83, v83, v91
v_add_f32 v84, v84, v92
buffer_load_dwordx4 v27, s[28:31], s61 offen offset:1024 lds
v_add_f32 v85, v85, v93
v_add_f32 v86, v86, v94
v_add_f32 v87, v87, v95
v_add_f32 v80, v80, v84
global_load_dword v48, v54, s[98:99]
v_add_f32 v81, v81, v85
v_add_f32 v82, v82, v86
v_add_f32 v83, v83, v87
s_nop 1
buffer_load_dwordx4 v[64:67], v38, s[32:35], 0 offen offset:0 sc1
v_permlane32_swap_b32 v80, v81
v_permlane32_swap_b32 v82, v83
v_add_f32 v80, v80, v81
v_add_f32 v82, v82, v83
buffer_load_dwordx4 v[68:71], v38, s[32:35], 0 offen offset:1024 sc1
s_nop 1
v_permlane16_swap_b32 v80, v82
s_nop 0
v_add_f32 v80, v80, v82
buffer_load_dwordx4 v[72:75], v38, s[32:35], 0 offen offset:2048 sc1
v_cmp_u_f32 vcc, v80, v80
s_cbranch_vccnz again_6
summed_7:
v_mul_f32 v44, 0x3a800000, v80
buffer_load_dwordx4 v[76:79], v38, s[32:35], 0 offen offset:3072 sc1
v_mov_b32 v45, v44
s_nop 1
v_permlane16_swap_b32 v44, v45
s_nop 0
s_add_u32 s48, s75, 15
s_and_b32 s48, s48, 15
s_mul_i32 s48, s48, s57
s_add_u32 m0, s71, 106496
s_nop 0
buffer_load_dwordx4 v28, s[36:39], s48 offen lds
v_fma_f32 v45, -v44, v44, v45
v_max_f32 v45, 0, v45
v_add_f32 v45, 0x3727c5ac, v45
v_rsq_f32 v46, v45
buffer_load_dwordx4 v29, s[36:39], s48 offen offset:1024 lds
v_sub_f32 v47, 0, v44
ds_write_b32 v50, v47 offset:512
ds_write_b64 v49, v[46:47]
ds_write_b32 v50, v46
s_waitcnt vmcnt(7)
s_barrier
s_add_u32 s48, s75, 5
s_and_b32 s48, s48, 15
s_mul_i32 s48, s48, s57
s_add_u32 m0, s71, 24576
s_nop 0
buffer_load_dwordx4 v28, s[36:39], s48 offen lds
buffer_load_dwordx4 v29, s[36:39], s48 offen offset:1024 lds
s_waitcnt vmcnt(4)
s_add_u32 s48, s75, 6
s_and_b32 s48, s48, 15
s_mul_i32 s48, s48, s57
s_add_u32 m0, s71, 32768
s_nop 0
buffer_load_dwordx4 v28, s[36:39], s48 offen lds
v_add_f32 v64, v64, v72
v_add_f32 v65, v65, v73
v_add_f32 v66, v66, v74
v_add_f32 v67, v67, v75
v_add_f32 v68, v68, v76
buffer_load_dwordx4 v29, s[36:39], s48 offen offset:1024 lds
v_add_f32 v69, v69, v77
v_add_f32 v70, v70, v78
v_add_f32 v71, v71, v79
v_add_f32 v64, v64, v68
s_add_u32 s48, s75, 7
s_and_b32 s48, s48, 15
s_mul_i32 s48, s48, s57
s_add_u32 m0, s71, 40960
s_nop 0
buffer_load_dwordx4 v28, s[36:39], s48 offen lds
v_add_f32 v65, v65, v69
v_add_f32 v66, v66, v70
v_add_f32 v67, v67, v71
s_nop 1
buffer_load_dwordx4 v29, s[36:39], s48 offen offset:1024 lds
v_permlane32_swap_b32 v64, v65
v_permlane32_swap_b32 v66, v67
v_add_f32 v64, v64, v65
v_add_f32 v66, v66, v67
s_add_u32 s48, s75, 8
s_and_b32 s48, s48, 15
s_mul_i32 s48, s48, s57
s_add_u32 m0, s71, 49152
s_nop 0
buffer_load_dwordx4 v28, s[36:39], s48 offen lds
s_nop 1
v_permlane16_swap_b32 v64, v66
s_nop 0
v_add_f32 v64, v64, v66
buffer_load_dwordx4 v29, s[36:39], s48 offen offset:1024 lds
v_cmp_u_f32 vcc, v64, v64
s_cbranch_vccnz again_9
summed_10:
ds_write_b32 v53, v64
s_cmp_lg_u32 s43, 2
s_cbranch_scc1 else_12
s_and_b32 s50, s2, 7
v_readlane_b32 s58, v34, s50
v_readlane_b32 s59, v35, s50
s_lshl_b64 s[48:49], s[94:95], 5
v_mov_b32 v4, 134656
s_nop 1
s_cmp_eq_u64 s[48:49], s[58:59]
s_cselect_b32 s48, 1, 0
v_mov_b32 v5, s48
ds_write_b32 v4, v5
else_12:
s_setprio 0
s_waitcnt lgkmcnt(0)
s_waitcnt vmcnt(63)
s_barrier
s_waitcnt vmcnt(4)
s_add_u32 s48, s75, 9
s_and_b32 s48, s48, 15
s_mul_i32 s48, s48, s57
s_add_u32 m0, s71, 57344
s_nop 0
buffer_load_dwordx4 v28, s[36:39], s48 offen lds
buffer_load_dwordx4 v29, s[36:39], s48 offen offset:1024 lds
s_waitcnt vmcnt(4)
s_add_u32 s48, s75, 10
s_and_b32 s48, s48, 15
s_mul_i32 s48, s48, s57
s_add_u32 m0, s71, 65536
s_nop 0
buffer_load_dwordx4 v28, s[36:39], s48 offen lds
buffer_load_dwordx4 v29, s[36:39], s48 offen offset:1024 lds
s_waitcnt vmcnt(4)
s_add_u32 s48, s75, 11
s_and_b32 s48, s48, 15
s_mul_i32 s48, s48, s57
s_add_u32 m0, s71, 73728
s_nop 0
buffer_load_dwordx4 v28, s[36:39], s48 offen lds
buffer_load_dwordx4 v29, s[36:39], s48 offen offset:1024 lds
s_waitcnt vmcnt(4)
s_add_u32 s48, s75, 12
s_and_b32 s48, s48, 15
s_mul_i32 s48, s48, s57
s_add_u32 m0, s71, 81920
s_nop 0
buffer_load_dwordx4 v28, s[36:39], s48 offen lds
buffer_load_dwordx4 v29, s[36:39], s48 offen offset:1024 lds
s_waitcnt vmcnt(4)
s_add_u32 s48, s75, 13
s_and_b32 s48, s48, 15
s_mul_i32 s48, s48, s57
s_add_u32 m0, s71, 90112
s_nop 0
buffer_load_dwordx4 v28, s[36:39], s48 offen lds
buffer_load_dwordx4 v29, s[36:39], s48 offen offset:1024 lds
s_waitcnt vmcnt(4)
s_add_u32 s48, s75, 14
s_and_b32 s48, s48, 15
s_mul_i32 s48, s48, s57
s_add_u32 m0, s71, 98304
s_nop 0
buffer_load_dwordx4 v28, s[36:39], s48 offen lds
buffer_load_dwordx4 v29, s[36:39], s48 offen offset:1024 lds
s_waitcnt vmcnt(4)
s_add_u32 s48, s75, 0
s_and_b32 s48, s48, 15
s_mul_i32 s48, s48, s57
s_add_u32 m0, s71, 4294950912
s_nop 0
buffer_load_dwordx4 v28, s[36:39], s48 offen lds
buffer_load_dwordx4 v29, s[36:39], s48 offen offset:1024 lds
s_waitcnt vmcnt(4)
s_add_u32 s48, s75, 1
s_and_b32 s48, s48, 15
s_mul_i32 s48, s48, s57
s_add_u32 m0, s71, 4294959104
s_nop 0
buffer_load_dwordx4 v28, s[36:39], s48 offen lds
buffer_load_dwordx4 v29, s[36:39], s48 offen offset:1024 lds
s_waitcnt vmcnt(4)
s_add_u32 s48, s75, 2
s_and_b32 s48, s48, 15
s_mul_i32 s48, s48, s57
s_add_u32 m0, s71, 0
s_nop 0
buffer_load_dwordx4 v28, s[36:39], s48 offen lds
buffer_load_dwordx4 v29, s[36:39], s48 offen offset:1024 lds
s_waitcnt vmcnt(4)
s_add_u32 s48, s75, 3
s_and_b32 s48, s48, 15
s_mul_i32 s48, s48, s57
s_add_u32 m0, s71, 8192
s_nop 0
buffer_load_dwordx4 v28, s[36:39], s48 offen lds
buffer_load_dwordx4 v29, s[36:39], s48 offen offset:1024 lds
s_waitcnt vmcnt(4)
s_add_u32 s48, s75, 4
s_and_b32 s48, s48, 15
s_mul_i32 s48, s48, s57
s_add_u32 m0, s71, 16384
s_nop 0
buffer_load_dwordx4 v28, s[36:39], s48 offen lds
buffer_load_dwordx4 v29, s[36:39], s48 offen offset:1024 lds
s_waitcnt vmcnt(4)
buffer_store_dwordx4 v[56:59], v55, s[32:35], 0 offen sc1
s_mov_b32 s28, s12
s_and_b32 s29, s13, 0xffff
s_mov_b32 s30, 6291456
s_mov_b32 s31, 0x00020000
s_mul_i32 s48, s55, 393216
s_add_u32 s48, s48, 18873344
s_add_u32 s48, s22, s48
s_addc_u32 s49, s23, 0
s_and_b32 s49, s49, 0xffff
s_cmp_ge_i32 s55, 0
s_cselect_b32 s28, s48, s28
s_cselect_b32 s29, s49, s29
s_cselect_b32 s30, 394240, s30
v_mov_b32 v26, v60
v_mov_b32 v27, v61
v_mov_b32 v28, v24
v_mov_b32 v29, v25
s_cmp_ge_i32 s55, 0
s_cselect_b32 s53, 128, s53
s_cselect_b32 s54, 24576, s54
s_cmp_ge_i32 s56, 0
s_cselect_b32 s57, 8192, s57
s_and_b32 s48, s2, 7
s_lshl_b32 s48, s48, 1
s_add_u32 s47, s42, s48
s_and_b32 s47, s47, 15
s_and_b32 s50, s42, 8
s_or_b32 s50, s50, 3
s_and_b32 s48, s2, 7
s_lshl_b32 s48, s48, 1
s_add_u32 s76, s50, s48
s_and_b32 s76, s76, 15
s_add_u32 s69, s47, 0
s_and_b32 s69, s69, 15
s_mul_i32 s67, s69, 128
s_mul_i32 s68, s69, s54
s_waitcnt vmcnt(0) lgkmcnt(0)
s_barrier
s_add_u32 s60, s71, 122880
s_add_u32 m0, s60, 0
s_mov_b32 s61, s68
buffer_load_dwordx4 v26, s[28:31], s61 offen lds
buffer_load_dwordx4 v27, s[28:31], s61 offen offset:1024 lds
s_add_u32 m0, s60, 8192
s_add_u32 s61, s61, s53
buffer_load_dwordx4 v26, s[28:31], s61 offen lds
buffer_load_dwordx4 v27, s[28:31], s61 offen offset:1024 lds
s_add_u32 m0, s60, 16384
s_add_u32 s61, s61, s53
buffer_load_dwordx4 v26, s[28:31], s61 offen lds
buffer_load_dwordx4 v27, s[28:31], s61 offen offset:1024 lds
s_mov_b32 s36, s14
s_and_b32 s37, s15, 0xffff
s_mov_b32 s38, 65536
s_mov_b32 s39, 0x00020000
s_lshl_b32 s48, s42, 12
s_lshl_b32 s49, s43, 10
s_add_u32 s48, s48, s49
s_add_u32 m0, s49, 135168
s_nop 0
buffer_load_dwordx4 v18, s[36:39], s48 offen lds
ds_read_b128 v[232:235], v52 offset:57344
ds_read_b128 v[236:239], v52 offset:58368
ds_read_b128 v[152:155], v51 offset:40960
ds_read_b128 v[156:159], v51 offset:41984
ds_read_b128 v[160:163], v51 offset:49152
ds_read_b128 v[164:167], v51 offset:50176
ds_read_b128 v[168:171], v51 offset:57344
ds_read_b128 v[172:175], v51 offset:58368
ds_read_b128 v[176:179], v52 offset:0
ds_read_b128 v[180:183], v52 offset:1024
ds_read_b128 v[184:187], v52 offset:8192
ds_read_b128 v[188:191], v52 offset:9216
ds_read_b128 v[192:195], v52 offset:16384
ds_read_b128 v[196:199], v52 offset:17408
ds_read_b128 v[200:203], v52 offset:24576
ds_read_b128 v[204:207], v52 offset:25600
ds_read_b128 v[208:211], v52 offset:32768
ds_read_b128 v[212:215], v52 offset:33792
ds_read_b128 v[216:219], v52 offset:40960
ds_read_b128 v[220:223], v52 offset:41984
ds_read_b128 v[224:227], v52 offset:49152
ds_read_b128 v[228:231], v52 offset:50176
ds_read_b128 v[112:115], v51 offset:0
ds_read_b128 v[116:119], v51 offset:1024
ds_read_b128 v[120:123], v51 offset:8192
ds_read_b128 v[124:127], v51 offset:9216
ds_read_b128 v[128:131], v51 offset:16384
ds_read_b128 v[132:135], v51 offset:17408
ds_read_b128 v[136:139], v51 offset:24576
ds_read_b128 v[140:143], v51 offset:25600
ds_read_b128 v[144:147], v51 offset:32768
ds_read_b128 v[148:151], v51 offset:33792
s_add_u32 s48, s80, 0
v_add_u32 v20, s48, v18
v_mov_b32 v21, v20
v_add_u32 v22, 30720, v20
v_mov_b32 v23, v22
v_add_u32 v37, 262144, v37
s_lshl_b32 s50, s42, 2
s_add_u32 s50, s50, s43
s_lshl_b32 s50, s50, 12
s_add_u32 s50, s50, 18087936
v_add_u32 v38, s50, v18
v_min_u32 v4, 2, v3
v_lshlrev_b32 v4, 8, v4
v_lshl_add_u32 v4, v2, 2, v4
s_and_b32 s48, s43, 1
s_lshl_b32 s48, s48, 7
s_lshr_b32 s49, s43, 1
s_lshl_b32 s49, s49, 6
s_add_u32 s48, s48, s49
s_add_u32 s48, s48, 133888
v_add_u32 v53, s48, v4
s_getpc_b64 s[98:99]
pc_14:
s_add_u32 s98, s98, c1_last - pc_14
s_addc_u32 s99, s99, 0
s_lshr_b32 s50, s2, 3
s_lshl_b32 s50, s50, 2
s_add_u32 s50, s50, s43
s_lshl_b32 s50, s50, 7
v_and_b32 v4, 1, v0
v_lshl_add_u32 v4, v4, 6, s50
v_min_u32 v54, L_code_end - c1_last, v4
s_waitcnt vmcnt(0) lgkmcnt(0)
s_add_u32 s69, s47, 1
s_and_b32 s69, s69, 15
s_mul_i32 s67, s69, 2048
s_mul_i32 s68, s69, s54
s_barrier
s_add_u32 s60, s71, 40960
s_add_u32 m0, s60, 0
s_mov_b32 s61, s68
buffer_load_dwordx4 v26, s[28:31], s61 offen lds
buffer_load_dwordx4 v27, s[28:31], s61 offen offset:1024 lds
s_add_u32 m0, s60, 8192
s_add_u32 s61, s61, s53
buffer_load_dwordx4 v26, s[28:31], s61 offen lds
buffer_load_dwordx4 v27, s[28:31], s61 offen offset:1024 lds
s_add_u32 m0, s60, 16384
s_add_u32 s61, s61, s53
buffer_load_dwordx4 v26, s[28:31], s61 offen lds
buffer_load_dwordx4 v27, s[28:31], s61 offen offset:1024 lds
buffer_load_dword v5, v30, s[32:35], s79 offen sc1
s_mov_b32 s63, 0
s_waitcnt vmcnt(0)
poll_15:
v_cmp_gt_u32 vcc, 1, v5
s_cbranch_vccz polled_16
buffer_load_dword v5, v30, s[32:35], s79 offen sc1
s_add_u32 s63, s63, 1
s_cmp_lt_u32 s63, 0x80000
s_waitcnt vmcnt(0)
s_cbranch_scc1 poll_15
polled_16:
s_add_u32 s69, s47, 0
s_and_b32 s69, s69, 15
s_mul_i32 s67, s69, 2048
s_mul_i32 s68, s69, s54
s_add_u32 m0, s70, 0
s_nop 0
buffer_load_dwordx4 v20, s[32:35], s67 offen offset:0 sc1 lds
buffer_load_dwordx4 v21, s[32:35], s67 offen offset:1024 sc1 lds
buffer_load_dwordx4 v22, s[32:35], s67 offen offset:2048 sc1 lds
buffer_load_dwordx4 v23, s[32:35], s67 offen offset:3072 sc1 lds
s_add_u32 s69, s47, 1
s_and_b32 s69, s69, 15
s_mul_i32 s67, s69, 2048
s_mul_i32 s68, s69, s54
s_add_u32 m0, s70, 40960
s_nop 0
buffer_load_dwordx4 v20, s[32:35], s67 offen offset:0 sc1 lds
buffer_load_dwordx4 v21, s[32:35], s67 offen offset:1024 sc1 lds
buffer_load_dwordx4 v22, s[32:35], s67 offen offset:2048 sc1 lds
buffer_load_dwordx4 v23, s[32:35], s67 offen offset:3072 sc1 lds
s_waitcnt vmcnt(4)
s_barrier
s_add_u32 s69, s47, 2
s_and_b32 s69, s69, 15
s_mul_i32 s67, s69, 2048
s_mul_i32 s68, s69, s54
s_add_u32 m0, s70, 81920
s_nop 0
buffer_load_dwordx4 v20, s[32:35], s67 offen offset:0 sc1 lds
buffer_load_dwordx4 v21, s[32:35], s67 offen offset:1024 sc1 lds
buffer_load_dwordx4 v22, s[32:35], s67 offen offset:2048 sc1 lds
buffer_load_dwordx4 v23, s[32:35], s67 offen offset:3072 sc1 lds
s_add_u32 s60, s71, 81920
s_add_u32 m0, s60, 0
s_mov_b32 s61, s68
buffer_load_dwordx4 v26, s[28:31], s61 offen lds
buffer_load_dwordx4 v27, s[28:31], s61 offen offset:1024 lds
s_add_u32 m0, s60, 8192
s_add_u32 s61, s61, s53
buffer_load_dwordx4 v26, s[28:31], s61 offen lds
buffer_load_dwordx4 v27, s[28:31], s61 offen offset:1024 lds
s_add_u32 m0, s60, 16384
s_add_u32 s61, s61, s53
buffer_load_dwordx4 v26, s[28:31], s61 offen lds
buffer_load_dwordx4 v27, s[28:31], s61 offen offset:1024 lds
s_mov_b32 s64, 0
s_mov_b32 s65, 0
h1_loop:
s_waitcnt vmcnt(10)
s_barrier
s_add_u32 s69, s69, 1
s_and_b32 s69, s69, 15
s_mul_i32 s67, s69, 2048
s_mul_i32 s68, s69, s54
s_add_u32 m0, s70, s65
s_nop 0
buffer_load_dwordx4 v20, s[32:35], s67 offen offset:0 sc1 lds
buffer_load_dwordx4 v21, s[32:35], s67 offen offset:1024 sc1 lds
buffer_load_dwordx4 v22, s[32:35], s67 offen offset:2048 sc1 lds
buffer_load_dwordx4 v23, s[32:35], s67 offen offset:3072 sc1 lds
s_add_u32 s60, s71, s65
s_add_u32 m0, s60, 0
s_mov_b32 s61, s68
buffer_load_dwordx4 v26, s[28:31], s61 offen lds
buffer_load_dwordx4 v27, s[28:31], s61 offen offset:1024 lds
s_add_u32 m0, s60, 8192
s_add_u32 s61, s61, s53
buffer_load_dwordx4 v26, s[28:31], s61 offen lds
buffer_load_dwordx4 v27, s[28:31], s61 offen offset:1024 lds
s_add_u32 m0, s60, 16384
s_add_u32 s61, s61, s53
buffer_load_dwordx4 v26, s[28:31], s61 offen lds
buffer_load_dwordx4 v27, s[28:31], s61 offen offset:1024 lds
s_add_u32 s65, s65, 40960
s_cmp_eq_u32 s65, 122880
s_cselect_b32 s65, 0, s65
s_add_u32 s64, s64, 1
s_cmp_lt_u32 s64, 11
s_cbranch_scc1 h1_loop
s_waitcnt vmcnt(10)
s_barrier
s_add_u32 s69, s69, 1
s_and_b32 s69, s69, 15
s_mul_i32 s67, s69, 2048
s_mul_i32 s68, s69, s54
s_add_u32 m0, s70, s65
s_nop 0
buffer_load_dwordx4 v20, s[32:35], s67 offen offset:0 sc1 lds
buffer_load_dwordx4 v21, s[32:35], s67 offen offset:1024 sc1 lds
buffer_load_dwordx4 v22, s[32:35], s67 offen offset:2048 sc1 lds
buffer_load_dwordx4 v23, s[32:35], s67 offen offset:3072 sc1 lds
s_add_u32 s60, s71, s65
s_add_u32 m0, s60, 0
s_mov_b32 s61, s68
buffer_load_dwordx4 v26, s[28:31], s61 offen lds
buffer_load_dwordx4 v27, s[28:31], s61 offen offset:1024 lds
s_add_u32 m0, s60, 8192
s_add_u32 s61, s61, s53
buffer_load_dwordx4 v26, s[28:31], s61 offen lds
buffer_load_dwordx4 v27, s[28:31], s61 offen offset:1024 lds
s_add_u32 m0, s60, 16384
s_add_u32 s61, s61, s53
buffer_load_dwordx4 v26, s[28:31], s61 offen lds
buffer_load_dwordx4 v27, s[28:31], s61 offen offset:1024 lds
s_add_u32 s65, s65, 40960
s_cmp_eq_u32 s65, 122880
s_cselect_b32 s65, 0, s65
s_add_u32 s64, s64, 1
s_mov_b32 s36, s16
s_and_b32 s37, s17, 0xffff
s_mov_b32 s38, 2097152
s_mov_b32 s39, 0x00020000
s_mul_i32 s48, s56, 131072
s_add_u32 s48, s48, 21232640
s_add_u32 s48, s22, s48
s_addc_u32 s49, s23, 0
s_and_b32 s49, s49, 0xffff
s_cmp_ge_i32 s56, 0
s_cselect_b32 s36, s48, s36
s_cselect_b32 s37, s49, s37
s_cselect_b32 s38, 132096, s38
s_waitcnt vmcnt(10)
s_barrier
buffer_load_dwordx4 v[80:83], v37, s[32:35], 0 offen offset:0 sc1
buffer_load_dwordx4 v[84:87], v37, s[32:35], 0 offen offset:1024 sc1
buffer_load_dwordx4 v[88:91], v37, s[32:35], 0 offen offset:2048 sc1
buffer_load_dwordx4 v[92:95], v37, s[32:35], 0 offen offset:3072 sc1
s_add_u32 s69, s47, 15
s_and_b32 s69, s69, 15
s_mul_i32 s67, s69, 2048
s_mul_i32 s68, s69, s54
s_add_u32 m0, s70, 0
s_nop 0
buffer_load_dwordx4 v20, s[32:35], s67 offen offset:0 sc1 lds
buffer_load_dwordx4 v21, s[32:35], s67 offen offset:1024 sc1 lds
buffer_load_dwordx4 v22, s[32:35], s67 offen offset:2048 sc1 lds
buffer_load_dwordx4 v23, s[32:35], s67 offen offset:3072 sc1 lds
s_add_u32 s60, s71, 0
s_add_u32 m0, s60, 0
s_mov_b32 s61, s68
buffer_load_dwordx4 v26, s[28:31], s61 offen lds
buffer_load_dwordx4 v27, s[28:31], s61 offen offset:1024 lds
s_waitcnt vmcnt(10)
s_barrier
s_setprio 0
s_add_u32 m0, s60, 8192
s_add_u32 s61, s61, s53
buffer_load_dwordx4 v26, s[28:31], s61 offen lds
buffer_load_dwordx4 v27, s[28:31], s61 offen offset:1024 lds
s_waitcnt vmcnt(8)
s_add_u32 m0, s60, 16384
s_add_u32 s61, s61, s53
buffer_load_dwordx4 v26, s[28:31], s61 offen lds
v_add_f32 v80, v80, v88
v_add_f32 v81, v81, v89
v_add_f32 v82, v82, v90
v_add_f32 v83, v83, v91
v_add_f32 v84, v84, v92
buffer_load_dwordx4 v27, s[28:31], s61 offen offset:1024 lds
v_add_f32 v85, v85, v93
v_add_f32 v86, v86, v94
v_add_f32 v87, v87, v95
v_add_f32 v80, v80, v84
global_load_dword v48, v54, s[98:99]
v_add_f32 v81, v81, v85
v_add_f32 v82, v82, v86
v_add_f32 v83, v83, v87
s_nop 1
buffer_load_dwordx4 v[64:67], v38, s[32:35], 0 offen offset:0 sc1
v_permlane32_swap_b32 v80, v81
v_permlane32_swap_b32 v82, v83
v_add_f32 v80, v80, v81
v_add_f32 v82, v82, v83
buffer_load_dwordx4 v[68:71], v38, s[32:35], 0 offen offset:1024 sc1
s_nop 1
v_permlane16_swap_b32 v80, v82
s_nop 0
v_add_f32 v80, v80, v82
buffer_load_dwordx4 v[72:75], v38, s[32:35], 0 offen offset:2048 sc1
v_cmp_u_f32 vcc, v80, v80
s_cbranch_vccnz again_17
summed_18:
v_mul_f32 v44, 0x3a800000, v80
buffer_load_dwordx4 v[76:79], v38, s[32:35], 0 offen offset:3072 sc1
v_mov_b32 v45, v44
s_nop 1
v_permlane16_swap_b32 v44, v45
s_nop 0
s_add_u32 s48, s75, 15
s_and_b32 s48, s48, 15
s_mul_i32 s48, s48, s57
s_add_u32 m0, s71, 106496
s_nop 0
buffer_load_dwordx4 v28, s[36:39], s48 offen lds
v_fma_f32 v45, -v44, v44, v45
v_max_f32 v45, 0, v45
v_add_f32 v45, 0x3727c5ac, v45
v_rsq_f32 v46, v45
buffer_load_dwordx4 v29, s[36:39], s48 offen offset:1024 lds
v_sub_f32 v47, 0, v44
ds_write_b32 v50, v47 offset:512
ds_write_b64 v49, v[46:47]
ds_write_b32 v50, v46
s_waitcnt vmcnt(7)
s_barrier
s_add_u32 s48, s75, 5
s_and_b32 s48, s48, 15
s_mul_i32 s48, s48, s57
s_add_u32 m0, s71, 24576
s_nop 0
buffer_load_dwordx4 v28, s[36:39], s48 offen lds
buffer_load_dwordx4 v29, s[36:39], s48 offen offset:1024 lds
s_waitcnt vmcnt(4)
s_add_u32 s48, s75, 6
s_and_b32 s48, s48, 15
s_mul_i32 s48, s48, s57
s_add_u32 m0, s71, 32768
s_nop 0
buffer_load_dwordx4 v28, s[36:39], s48 offen lds
v_add_f32 v64, v64, v72
v_add_f32 v65, v65, v73
v_add_f32 v66, v66, v74
v_add_f32 v67, v67, v75
v_add_f32 v68, v68, v76
buffer_load_dwordx4 v29, s[36:39], s48 offen offset:1024 lds
v_add_f32 v69, v69, v77
v_add_f32 v70, v70, v78
v_add_f32 v71, v71, v79
v_add_f32 v64, v64, v68
s_add_u32 s48, s75, 7
s_and_b32 s48, s48, 15
s_mul_i32 s48, s48, s57
s_add_u32 m0, s71, 40960
s_nop 0
buffer_load_dwordx4 v28, s[36:39], s48 offen lds
v_add_f32 v65, v65, v69
v_add_f32 v66, v66, v70
v_add_f32 v67, v67, v71
s_nop 1
buffer_load_dwordx4 v29, s[36:39], s48 offen offset:1024 lds
v_permlane32_swap_b32 v64, v65
v_permlane32_swap_b32 v66, v67
v_add_f32 v64, v64, v65
v_add_f32 v66, v66, v67
s_add_u32 s48, s75, 8
s_and_b32 s48, s48, 15
s_mul_i32 s48, s48, s57
s_add_u32 m0, s71, 49152
s_nop 0
buffer_load_dwordx4 v28, s[36:39], s48 offen lds
s_nop 1
v_permlane16_swap_b32 v64, v66
s_nop 0
v_add_f32 v64, v64, v66
buffer_load_dwordx4 v29, s[36:39], s48 offen offset:1024 lds
v_cmp_u_f32 vcc, v64, v64
s_cbranch_vccnz again_20
summed_21:
ds_write_b32 v53, v64
s_setprio 0
s_waitcnt lgkmcnt(0)
s_waitcnt vmcnt(63)
s_barrier
s_waitcnt vmcnt(4)
s_add_u32 s48, s75, 9
s_and_b32 s48, s48, 15
s_mul_i32 s48, s48, s57
s_add_u32 m0, s71, 57344
s_nop 0
buffer_load_dwordx4 v28, s[36:39], s48 offen lds
buffer_load_dwordx4 v29, s[36:39], s48 offen offset:1024 lds
s_waitcnt vmcnt(4)
s_add_u32 s48, s75, 10
s_and_b32 s48, s48, 15
s_mul_i32 s48, s48, s57
s_add_u32 m0, s71, 65536
s_nop 0
buffer_load_dwordx4 v28, s[36:39], s48 offen lds
buffer_load_dwordx4 v29, s[36:39], s48 offen offset:1024 lds
s_waitcnt vmcnt(4)
s_add_u32 s48, s75, 11
s_and_b32 s48, s48, 15
s_mul_i32 s48, s48, s57
s_add_u32 m0, s71, 73728
s_nop 0
buffer_load_dwordx4 v28, s[36:39], s48 offen lds
buffer_load_dwordx4 v29, s[36:39], s48 offen offset:1024 lds
s_waitcnt vmcnt(4)
s_add_u32 s48, s75, 12
s_and_b32 s48, s48, 15
s_mul_i32 s48, s48, s57
s_add_u32 m0, s71, 81920
s_nop 0
buffer_load_dwordx4 v28, s[36:39], s48 offen lds
buffer_load_dwordx4 v29, s[36:39], s48 offen offset:1024 lds
s_waitcnt vmcnt(4)
s_add_u32 s48, s75, 13
s_and_b32 s48, s48, 15
s_mul_i32 s48, s48, s57
s_add_u32 m0, s71, 90112
s_nop 0
buffer_load_dwordx4 v28, s[36:39], s48 offen lds
buffer_load_dwordx4 v29, s[36:39], s48 offen offset:1024 lds
s_waitcnt vmcnt(4)
s_add_u32 s48, s75, 14
s_and_b32 s48, s48, 15
s_mul_i32 s48, s48, s57
s_add_u32 m0, s71, 98304
s_nop 0
buffer_load_dwordx4 v28, s[36:39], s48 offen lds
buffer_load_dwordx4 v29, s[36:39], s48 offen offset:1024 lds
s_waitcnt vmcnt(4)
s_add_u32 s48, s75, 0
s_and_b32 s48, s48, 15
s_mul_i32 s48, s48, s57
s_add_u32 m0, s71, 4294950912
s_nop 0
buffer_load_dwordx4 v28, s[36:39], s48 offen lds
buffer_load_dwordx4 v29, s[36:39], s48 offen offset:1024 lds
s_waitcnt vmcnt(4)
s_add_u32 s48, s75, 1
s_and_b32 s48, s48, 15
s_mul_i32 s48, s48, s57
s_add_u32 m0, s71, 4294959104
s_nop 0
buffer_load_dwordx4 v28, s[36:39], s48 offen lds
buffer_load_dwordx4 v29, s[36:39], s48 offen offset:1024 lds
s_waitcnt vmcnt(4)
s_add_u32 s48, s75, 2
s_and_b32 s48, s48, 15
s_mul_i32 s48, s48, s57
s_add_u32 m0, s71, 0
s_nop 0
buffer_load_dwordx4 v28, s[36:39], s48 offen lds
buffer_load_dwordx4 v29, s[36:39], s48 offen offset:1024 lds
s_waitcnt vmcnt(4)
s_add_u32 s48, s75, 3
s_and_b32 s48, s48, 15
s_mul_i32 s48, s48, s57
s_add_u32 m0, s71, 8192
s_nop 0
buffer_load_dwordx4 v28, s[36:39], s48 offen lds
buffer_load_dwordx4 v29, s[36:39], s48 offen offset:1024 lds
s_waitcnt vmcnt(4)
s_add_u32 s48, s75, 4
s_and_b32 s48, s48, 15
s_mul_i32 s48, s48, s57
s_add_u32 m0, s71, 16384
s_nop 0
buffer_load_dwordx4 v28, s[36:39], s48 offen lds
buffer_load_dwordx4 v29, s[36:39], s48 offen offset:1024 lds
s_waitcnt vmcnt(4)
buffer_load_dwordx4 v[96:99], v18, s[32:35], s81 offen offset:0 sc1
buffer_load_dwordx4 v[100:103], v18, s[32:35], s81 offen offset:1024 sc1
s_waitcnt vmcnt(4)
buffer_load_dwordx4 v[104:107], v18, s[32:35], s82 offen offset:0 sc1
buffer_load_dwordx4 v[108:111], v18, s[32:35], s82 offen offset:1024 sc1
s_mov_b32 s28, s6
s_and_b32 s29, s7, 0xffff
s_mov_b32 s30, 6291456
s_mov_b32 s31, 0x00020000
s_mul_i32 s48, s55, 393216
s_add_u32 s48, s48, 20052992
s_add_u32 s48, s22, s48
s_addc_u32 s49, s23, 0
s_and_b32 s49, s49, 0xffff
s_cmp_ge_i32 s55, 0
s_cselect_b32 s28, s48, s28
s_cselect_b32 s29, s49, s29
s_cselect_b32 s30, 394240, s30
s_add_u32 s69, s47, 0
s_and_b32 s69, s69, 15
s_mul_i32 s67, s69, 2048
s_mul_i32 s68, s69, s54
s_waitcnt vmcnt(0) lgkmcnt(0)
s_barrier
s_add_u32 s60, s71, 122880
s_add_u32 m0, s60, 0
s_mov_b32 s61, s68
buffer_load_dwordx4 v26, s[28:31], s61 offen lds
buffer_load_dwordx4 v27, s[28:31], s61 offen offset:1024 lds
s_add_u32 m0, s60, 8192
s_add_u32 s61, s61, s53
buffer_load_dwordx4 v26, s[28:31], s61 offen lds
buffer_load_dwordx4 v27, s[28:31], s61 offen offset:1024 lds
s_add_u32 m0, s60, 16384
s_add_u32 s61, s61, s53
buffer_load_dwordx4 v26, s[28:31], s61 offen lds
buffer_load_dwordx4 v27, s[28:31], s61 offen offset:1024 lds
v_add_u32 v37, 262144, v37
s_getpc_b64 s[98:99]
pc_23:
s_add_u32 s98, s98, c2_last - pc_23
s_addc_u32 s99, s99, 0
s_lshr_b32 s50, s2, 3
s_lshl_b32 s50, s50, 2
s_add_u32 s50, s50, s43
s_lshl_b32 s50, s50, 7
v_and_b32 v4, 1, v0
v_lshl_add_u32 v4, v4, 6, s50
v_min_u32 v54, L_code_end - c2_last, v4
s_waitcnt vmcnt(0) lgkmcnt(0)
s_add_u32 s69, s47, 1
s_and_b32 s69, s69, 15
s_mul_i32 s67, s69, 2048
s_mul_i32 s68, s69, s54
s_barrier
s_add_u32 s60, s71, 40960
s_add_u32 m0, s60, 0
s_mov_b32 s61, s68
buffer_load_dwordx4 v26, s[28:31], s61 offen lds
buffer_load_dwordx4 v27, s[28:31], s61 offen offset:1024 lds
s_add_u32 m0, s60, 8192
s_add_u32 s61, s61, s53
buffer_load_dwordx4 v26, s[28:31], s61 offen lds
buffer_load_dwordx4 v27, s[28:31], s61 offen offset:1024 lds
s_add_u32 m0, s60, 16384
s_add_u32 s61, s61, s53
buffer_load_dwordx4 v26, s[28:31], s61 offen lds
buffer_load_dwordx4 v27, s[28:31], s61 offen offset:1024 lds
buffer_load_dword v5, v30, s[32:35], s79 offen sc1
s_mov_b32 s63, 0
s_waitcnt vmcnt(0)
poll_24:
v_cmp_gt_u32 vcc, 2, v5
s_cbranch_vccz polled_25
buffer_load_dword v5, v30, s[32:35], s79 offen sc1
s_add_u32 s63, s63, 1
s_cmp_lt_u32 s63, 0x80000
s_waitcnt vmcnt(0)
s_cbranch_scc1 poll_24
polled_25:
s_add_u32 s69, s47, 0
s_and_b32 s69, s69, 15
s_mul_i32 s67, s69, 2048
s_mul_i32 s68, s69, s54
s_add_u32 m0, s70, 0
s_nop 0
buffer_load_dwordx4 v20, s[32:35], s67 offen offset:0 sc1 lds
buffer_load_dwordx4 v21, s[32:35], s67 offen offset:1024 sc1 lds
buffer_load_dwordx4 v22, s[32:35], s67 offen offset:2048 sc1 lds
buffer_load_dwordx4 v23, s[32:35], s67 offen offset:3072 sc1 lds
s_add_u32 s69, s47, 1
s_and_b32 s69, s69, 15
s_mul_i32 s67, s69, 2048
s_mul_i32 s68, s69, s54
s_add_u32 m0, s70, 40960
s_nop 0
buffer_load_dwordx4 v20, s[32:35], s67 offen offset:0 sc1 lds
buffer_load_dwordx4 v21, s[32:35], s67 offen offset:1024 sc1 lds
buffer_load_dwordx4 v22, s[32:35], s67 offen offset:2048 sc1 lds
buffer_load_dwordx4 v23, s[32:35], s67 offen offset:3072 sc1 lds
s_waitcnt vmcnt(4)
s_barrier
s_add_u32 s69, s47, 2
s_and_b32 s69, s69, 15
s_mul_i32 s67, s69, 2048
s_mul_i32 s68, s69, s54
s_add_u32 m0, s70, 81920
s_nop 0
buffer_load_dwordx4 v20, s[32:35], s67 offen offset:0 sc1 lds
buffer_load_dwordx4 v21, s[32:35], s67 offen offset:1024 sc1 lds
buffer_load_dwordx4 v22, s[32:35], s67 offen offset:2048 sc1 lds
buffer_load_dwordx4 v23, s[32:35], s67 offen offset:3072 sc1 lds
s_add_u32 s60, s71, 81920
s_add_u32 m0, s60, 0
s_mov_b32 s61, s68
buffer_load_dwordx4 v26, s[28:31], s61 offen lds
buffer_load_dwordx4 v27, s[28:31], s61 offen offset:1024 lds
s_add_u32 m0, s60, 8192
s_add_u32 s61, s61, s53
buffer_load_dwordx4 v26, s[28:31], s61 offen lds
buffer_load_dwordx4 v27, s[28:31], s61 offen offset:1024 lds
s_add_u32 m0, s60, 16384
s_add_u32 s61, s61, s53
buffer_load_dwordx4 v26, s[28:31], s61 offen lds
buffer_load_dwordx4 v27, s[28:31], s61 offen offset:1024 lds
s_mov_b32 s64, 0
s_mov_b32 s65, 0
h2_loop:
s_waitcnt vmcnt(10)
s_barrier
s_add_u32 s69, s69, 1
s_and_b32 s69, s69, 15
s_mul_i32 s67, s69, 2048
s_mul_i32 s68, s69, s54
s_add_u32 m0, s70, s65
s_nop 0
buffer_load_dwordx4 v20, s[32:35], s67 offen offset:0 sc1 lds
buffer_load_dwordx4 v21, s[32:35], s67 offen offset:1024 sc1 lds
buffer_load_dwordx4 v22, s[32:35], s67 offen offset:2048 sc1 lds
buffer_load_dwordx4 v23, s[32:35], s67 offen offset:3072 sc1 lds
s_add_u32 s60, s71, s65
s_add_u32 m0, s60, 0
s_mov_b32 s61, s68
buffer_load_dwordx4 v26, s[28:31], s61 offen lds
buffer_load_dwordx4 v27, s[28:31], s61 offen offset:1024 lds
s_add_u32 m0, s60, 8192
s_add_u32 s61, s61, s53
buffer_load_dwordx4 v26, s[28:31], s61 offen lds
buffer_load_dwordx4 v27, s[28:31], s61 offen offset:1024 lds
s_add_u32 m0, s60, 16384
s_add_u32 s61, s61, s53
buffer_load_dwordx4 v26, s[28:31], s61 offen lds
buffer_load_dwordx4 v27, s[28:31], s61 offen offset:1024 lds
s_add_u32 s65, s65, 40960
s_cmp_eq_u32 s65, 122880
s_cselect_b32 s65, 0, s65
s_add_u32 s64, s64, 1
s_cmp_lt_u32 s64, 11
s_cbranch_scc1 h2_loop
s_waitcnt vmcnt(10)
s_barrier
s_add_u32 s69, s69, 1
s_and_b32 s69, s69, 15
s_mul_i32 s67, s69, 2048
s_mul_i32 s68, s69, s54
s_add_u32 m0, s70, s65
s_nop 0
buffer_load_dwordx4 v20, s[32:35], s67 offen offset:0 sc1 lds
buffer_load_dwordx4 v21, s[32:35], s67 offen offset:1024 sc1 lds
buffer_load_dwordx4 v22, s[32:35], s67 offen offset:2048 sc1 lds
buffer_load_dwordx4 v23, s[32:35], s67 offen offset:3072 sc1 lds
s_add_u32 s60, s71, s65
s_add_u32 m0, s60, 0
s_mov_b32 s61, s68
buffer_load_dwordx4 v26, s[28:31], s61 offen lds
buffer_load_dwordx4 v27, s[28:31], s61 offen offset:1024 lds
s_add_u32 m0, s60, 8192
s_add_u32 s61, s61, s53
buffer_load_dwordx4 v26, s[28:31], s61 offen lds
buffer_load_dwordx4 v27, s[28:31], s61 offen offset:1024 lds
s_add_u32 m0, s60, 16384
s_add_u32 s61, s61, s53
buffer_load_dwordx4 v26, s[28:31], s61 offen lds
buffer_load_dwordx4 v27, s[28:31], s61 offen offset:1024 lds
s_add_u32 s65, s65, 40960
s_cmp_eq_u32 s65, 122880
s_cselect_b32 s65, 0, s65
s_add_u32 s64, s64, 1
s_mov_b32 s36, s12
s_and_b32 s37, s13, 0xffff
s_mov_b32 s38, 6291456
s_mov_b32 s39, 0x00020000
s_mul_i32 s48, s55, 393216
s_add_u32 s48, s48, 18873344
s_add_u32 s48, s22, s48
s_addc_u32 s49, s23, 0
s_and_b32 s49, s49, 0xffff
s_cmp_ge_i32 s55, 0
s_cselect_b32 s36, s48, s36
s_cselect_b32 s37, s49, s37
s_cselect_b32 s38, 394240, s38
s_waitcnt vmcnt(10)
s_barrier
s_add_u32 s69, s47, 15
s_and_b32 s69, s69, 15
s_mul_i32 s67, s69, 2048
s_mul_i32 s68, s69, s54
s_add_u32 m0, s70, 0
s_nop 0
buffer_load_dwordx4 v20, s[32:35], s67 offen offset:0 sc1 lds
buffer_load_dwordx4 v21, s[32:35], s67 offen offset:1024 sc1 lds
buffer_load_dwordx4 v22, s[32:35], s67 offen offset:2048 sc1 lds
buffer_load_dwordx4 v23, s[32:35], s67 offen offset:3072 sc1 lds
s_add_u32 s60, s71, 0
s_add_u32 m0, s60, 0
s_mov_b32 s61, s68
buffer_load_dwordx4 v26, s[28:31], s61 offen lds
buffer_load_dwordx4 v27, s[28:31], s61 offen offset:1024 lds
s_add_u32 m0, s60, 8192
s_add_u32 s61, s61, s53
buffer_load_dwordx4 v26, s[28:31], s61 offen lds
buffer_load_dwordx4 v27, s[28:31], s61 offen offset:1024 lds
s_add_u32 m0, s60, 16384
s_add_u32 s61, s61, s53
buffer_load_dwordx4 v26, s[28:31], s61 offen lds
buffer_load_dwordx4 v27, s[28:31], s61 offen offset:1024 lds
s_waitcnt vmcnt(10)
s_barrier
s_setprio 0
buffer_load_dwordx4 v[80:83], v37, s[32:35], 0 offen offset:0 sc1
buffer_load_dwordx4 v[84:87], v37, s[32:35], 0 offen offset:1024 sc1
buffer_load_dwordx4 v[88:91], v37, s[32:35], 0 offen offset:2048 sc1
buffer_load_dwordx4 v[92:95], v37, s[32:35], 0 offen offset:3072 sc1
global_load_dword v48, v54, s[98:99]
s_add_u32 s69, s47, 0
s_and_b32 s69, s69, 15
s_mul_i32 s67, s69, 2048
s_mul_i32 s68, s69, s54
s_add_u32 s60, s71, 122880
s_add_u32 m0, s60, 0
s_mov_b32 s61, s68
buffer_load_dwordx4 v26, s[36:39], s61 offen lds
buffer_load_dwordx4 v27, s[36:39], s61 offen offset:1024 lds
s_add_u32 m0, s60, 8192
s_add_u32 s61, s61, s53
buffer_load_dwordx4 v26, s[36:39], s61 offen lds
buffer_load_dwordx4 v27, s[36:39], s61 offen offset:1024 lds
s_add_u32 m0, s60, 16384
s_add_u32 s61, s61, s53
buffer_load_dwordx4 v26, s[36:39], s61 offen lds
buffer_load_dwordx4 v27, s[36:39], s61 offen offset:1024 lds
s_waitcnt vmcnt(11)
s_barrier
s_waitcnt vmcnt(7)
buffer_load_dwordx4 v[96:99], v18, s[32:35], s81 offen offset:0 sc1
v_add_f32 v80, v80, v88
v_add_f32 v81, v81, v89
v_add_f32 v82, v82, v90
v_add_f32 v83, v83, v91
v_add_f32 v84, v84, v92
v_add_f32 v85, v85, v93
v_add_f32 v86, v86, v94
v_add_f32 v87, v87, v95
v_add_f32 v80, v80, v84
v_add_f32 v81, v81, v85
buffer_load_dwordx4 v[100:103], v18, s[32:35], s81 offen offset:1024 sc1
v_add_f32 v82, v82, v86
v_add_f32 v83, v83, v87
s_nop 1
v_permlane32_swap_b32 v80, v81
v_permlane32_swap_b32 v82, v83
v_add_f32 v80, v80, v81
v_add_f32 v82, v82, v83
s_nop 1
v_permlane16_swap_b32 v80, v82
buffer_load_dwordx4 v[104:107], v18, s[32:35], s82 offen offset:0 sc1
s_nop 0
v_add_f32 v80, v80, v82
v_cmp_u_f32 vcc, v80, v80
s_cbranch_vccnz again_26
summed_27:
v_mul_f32 v44, 0x3a800000, v80
v_mov_b32 v45, v44
s_nop 1
v_permlane16_swap_b32 v44, v45
buffer_load_dwordx4 v[108:111], v18, s[32:35], s82 offen offset:1024 sc1
s_nop 0
v_fma_f32 v45, -v44, v44, v45
v_max_f32 v45, 0, v45
v_add_f32 v45, 0x3727c5ac, v45
v_rsq_f32 v46, v45
v_sub_f32 v47, 0, v44
ds_write_b32 v50, v47 offset:512
ds_write_b64 v49, v[46:47]
ds_write_b32 v50, v46
s_setprio 0
s_waitcnt lgkmcnt(0)
s_waitcnt vmcnt(63)
s_barrier
ds_write_b128 v52, v[232:235] offset:57344
ds_write_b128 v52, v[236:239] offset:58368
ds_write_b128 v51, v[152:155] offset:40960
ds_write_b128 v51, v[156:159] offset:41984
ds_write_b128 v51, v[160:163] offset:49152
ds_write_b128 v51, v[164:167] offset:50176
ds_write_b128 v51, v[168:171] offset:57344
ds_write_b128 v51, v[172:175] offset:58368
ds_write_b128 v52, v[176:179] offset:0
ds_write_b128 v52, v[180:183] offset:1024
ds_write_b128 v52, v[184:187] offset:8192
ds_write_b128 v52, v[188:191] offset:9216
ds_write_b128 v52, v[192:195] offset:16384
ds_write_b128 v52, v[196:199] offset:17408
ds_write_b128 v52, v[200:203] offset:24576
ds_write_b128 v52, v[204:207] offset:25600
ds_write_b128 v52, v[208:211] offset:32768
ds_write_b128 v52, v[212:215] offset:33792
ds_write_b128 v52, v[216:219] offset:40960
ds_write_b128 v52, v[220:223] offset:41984
ds_write_b128 v52, v[224:227] offset:49152
ds_write_b128 v52, v[228:231] offset:50176
ds_write_b128 v51, v[112:115] offset:0
ds_write_b128 v51, v[116:119] offset:1024
ds_write_b128 v51, v[120:123] offset:8192
ds_write_b128 v51, v[124:127] offset:9216
ds_write_b128 v51, v[128:131] offset:16384
ds_write_b128 v51, v[132:135] offset:17408
ds_write_b128 v51, v[136:139] offset:24576
ds_write_b128 v51, v[140:143] offset:25600
ds_write_b128 v51, v[144:147] offset:32768
ds_write_b128 v51, v[148:151] offset:33792
s_mov_b32 s28, s12
s_and_b32 s29, s13, 0xffff
s_mov_b32 s30, 6291456
s_mov_b32 s31, 0x00020000
s_mul_i32 s48, s55, 393216
s_add_u32 s48, s48, 18873344
s_add_u32 s48, s22, s48
s_addc_u32 s49, s23, 0
s_and_b32 s49, s49, 0xffff
s_cmp_ge_i32 s55, 0
s_cselect_b32 s28, s48, s28
s_cselect_b32 s29, s49, s29
s_cselect_b32 s30, 394240, s30
s_add_u32 s69, s47, 0
s_and_b32 s69, s69, 15
s_mul_i32 s67, s69, 2048
s_mul_i32 s68, s69, s54
s_waitcnt vmcnt(0) lgkmcnt(0)
s_barrier
s_mov_b32 s36, s14
s_and_b32 s37, s15, 0xffff
s_mov_b32 s38, 65536
s_mov_b32 s39, 0x00020000
s_lshl_b32 s48, s42, 12
s_lshl_b32 s49, s43, 10
s_add_u32 s48, s48, s49
s_add_u32 m0, s49, 135168
s_nop 0
buffer_load_dwordx4 v18, s[36:39], s48 offen lds
v_add_u32 v37, 262144, v37
s_getpc_b64 s[98:99]
pc_29:
s_add_u32 s98, s98, c3_last - pc_29
s_addc_u32 s99, s99, 0
s_lshr_b32 s50, s2, 3
s_lshl_b32 s50, s50, 2
s_add_u32 s50, s50, s43
s_lshl_b32 s50, s50, 7
v_and_b32 v4, 1, v0
v_lshl_add_u32 v4, v4, 6, s50
v_min_u32 v54, L_code_end - c3_last, v4
s_waitcnt vmcnt(0) lgkmcnt(0)
s_add_u32 s69, s47, 1
s_and_b32 s69, s69, 15
s_mul_i32 s67, s69, 2048
s_mul_i32 s68, s69, s54
s_barrier
s_add_u32 s60, s71, 40960
s_add_u32 m0, s60, 0
s_mov_b32 s61, s68
buffer_load_dwordx4 v26, s[28:31], s61 offen lds
buffer_load_dwordx4 v27, s[28:31], s61 offen offset:1024 lds
s_add_u32 m0, s60, 8192
s_add_u32 s61, s61, s53
buffer_load_dwordx4 v26, s[28:31], s61 offen lds
buffer_load_dwordx4 v27, s[28:31], s61 offen offset:1024 lds
s_add_u32 m0, s60, 16384
s_add_u32 s61, s61, s53
buffer_load_dwordx4 v26, s[28:31], s61 offen lds
buffer_load_dwordx4 v27, s[28:31], s61 offen offset:1024 lds
buffer_load_dword v5, v30, s[32:35], s79 offen sc1
s_mov_b32 s63, 0
s_waitcnt vmcnt(0)
poll_30:
v_cmp_gt_u32 vcc, 3, v5
s_cbranch_vccz polled_31
buffer_load_dword v5, v30, s[32:35], s79 offen sc1
s_add_u32 s63, s63, 1
s_cmp_lt_u32 s63, 0x80000
s_waitcnt vmcnt(0)
s_cbranch_scc1 poll_30
polled_31:
s_add_u32 s69, s47, 0
s_and_b32 s69, s69, 15
s_mul_i32 s67, s69, 2048
s_mul_i32 s68, s69, s54
s_add_u32 m0, s70, 0
s_nop 0
buffer_load_dwordx4 v20, s[32:35], s67 offen offset:0 sc1 lds
buffer_load_dwordx4 v21, s[32:35], s67 offen offset:1024 sc1 lds
buffer_load_dwordx4 v22, s[32:35], s67 offen offset:2048 sc1 lds
buffer_load_dwordx4 v23, s[32:35], s67 offen offset:3072 sc1 lds
s_add_u32 s69, s47, 1
s_and_b32 s69, s69, 15
s_mul_i32 s67, s69, 2048
s_mul_i32 s68, s69, s54
s_add_u32 m0, s70, 40960
s_nop 0
buffer_load_dwordx4 v20, s[32:35], s67 offen offset:0 sc1 lds
buffer_load_dwordx4 v21, s[32:35], s67 offen offset:1024 sc1 lds
buffer_load_dwordx4 v22, s[32:35], s67 offen offset:2048 sc1 lds
buffer_load_dwordx4 v23, s[32:35], s67 offen offset:3072 sc1 lds
s_waitcnt vmcnt(4)
s_barrier
s_add_u32 s69, s47, 2
s_and_b32 s69, s69, 15
s_mul_i32 s67, s69, 2048
s_mul_i32 s68, s69, s54
s_add_u32 m0, s70, 81920
s_nop 0
buffer_load_dwordx4 v20, s[32:35], s67 offen offset:0 sc1 lds
buffer_load_dwordx4 v21, s[32:35], s67 offen offset:1024 sc1 lds
buffer_load_dwordx4 v22, s[32:35], s67 offen offset:2048 sc1 lds
buffer_load_dwordx4 v23, s[32:35], s67 offen offset:3072 sc1 lds
s_add_u32 s60, s71, 81920
s_add_u32 m0, s60, 0
s_mov_b32 s61, s68
buffer_load_dwordx4 v26, s[28:31], s61 offen lds
buffer_load_dwordx4 v27, s[28:31], s61 offen offset:1024 lds
s_add_u32 m0, s60, 8192
s_add_u32 s61, s61, s53
buffer_load_dwordx4 v26, s[28:31], s61 offen lds
buffer_load_dwordx4 v27, s[28:31], s61 offen offset:1024 lds
s_add_u32 m0, s60, 16384
s_add_u32 s61, s61, s53
buffer_load_dwordx4 v26, s[28:31], s61 offen lds
buffer_load_dwordx4 v27, s[28:31], s61 offen offset:1024 lds
s_mov_b32 s64, 0
s_mov_b32 s65, 0
h3_loop:
s_waitcnt vmcnt(10)
s_barrier
s_add_u32 s69, s69, 1
s_and_b32 s69, s69, 15
s_mul_i32 s67, s69, 2048
s_mul_i32 s68, s69, s54
s_add_u32 m0, s70, s65
s_nop 0
buffer_load_dwordx4 v20, s[32:35], s67 offen offset:0 sc1 lds
buffer_load_dwordx4 v21, s[32:35], s67 offen offset:1024 sc1 lds
buffer_load_dwordx4 v22, s[32:35], s67 offen offset:2048 sc1 lds
buffer_load_dwordx4 v23, s[32:35], s67 offen offset:3072 sc1 lds
s_add_u32 s60, s71, s65
s_add_u32 m0, s60, 0
s_mov_b32 s61, s68
buffer_load_dwordx4 v26, s[28:31], s61 offen lds
buffer_load_dwordx4 v27, s[28:31], s61 offen offset:1024 lds
s_add_u32 m0, s60, 8192
s_add_u32 s61, s61, s53
buffer_load_dwordx4 v26, s[28:31], s61 offen lds
buffer_load_dwordx4 v27, s[28:31], s61 offen offset:1024 lds
s_add_u32 m0, s60, 16384
s_add_u32 s61, s61, s53
buffer_load_dwordx4 v26, s[28:31], s61 offen lds
buffer_load_dwordx4 v27, s[28:31], s61 offen offset:1024 lds
s_add_u32 s65, s65, 40960
s_cmp_eq_u32 s65, 122880
s_cselect_b32 s65, 0, s65
s_add_u32 s64, s64, 1
s_cmp_lt_u32 s64, 11
s_cbranch_scc1 h3_loop
s_waitcnt vmcnt(10)
s_barrier
s_add_u32 s69, s69, 1
s_and_b32 s69, s69, 15
s_mul_i32 s67, s69, 2048
s_mul_i32 s68, s69, s54
s_add_u32 m0, s70, s65
s_nop 0
buffer_load_dwordx4 v20, s[32:35], s67 offen offset:0 sc1 lds
buffer_load_dwordx4 v21, s[32:35], s67 offen offset:1024 sc1 lds
buffer_load_dwordx4 v22, s[32:35], s67 offen offset:2048 sc1 lds
buffer_load_dwordx4 v23, s[32:35], s67 offen offset:3072 sc1 lds
s_add_u32 s60, s71, s65
s_add_u32 m0, s60, 0
s_mov_b32 s61, s68
buffer_load_dwordx4 v26, s[28:31], s61 offen lds
buffer_load_dwordx4 v27, s[28:31], s61 offen offset:1024 lds
s_add_u32 m0, s60, 8192
s_add_u32 s61, s61, s53
buffer_load_dwordx4 v26, s[28:31], s61 offen lds
buffer_load_dwordx4 v27, s[28:31], s61 offen offset:1024 lds
s_add_u32 m0, s60, 16384
s_add_u32 s61, s61, s53
buffer_load_dwordx4 v26, s[28:31], s61 offen lds
buffer_load_dwordx4 v27, s[28:31], s61 offen offset:1024 lds
s_add_u32 s65, s65, 40960
s_cmp_eq_u32 s65, 122880
s_cselect_b32 s65, 0, s65
s_add_u32 s64, s64, 1
s_mov_b32 s36, s16
s_and_b32 s37, s17, 0xffff
s_mov_b32 s38, 2097152
s_mov_b32 s39, 0x00020000
s_mul_i32 s48, s56, 131072
s_add_u32 s48, s48, 21232640
s_add_u32 s48, s22, s48
s_addc_u32 s49, s23, 0
s_and_b32 s49, s49, 0xffff
s_cmp_ge_i32 s56, 0
s_cselect_b32 s36, s48, s36
s_cselect_b32 s37, s49, s37
s_cselect_b32 s38, 132096, s38
s_waitcnt vmcnt(10)
s_barrier
s_add_u32 s69, s47, 15
s_and_b32 s69, s69, 15
s_mul_i32 s67, s69, 2048
s_mul_i32 s68, s69, s54
s_add_u32 m0, s70, 0
s_nop 0
buffer_load_dwordx4 v20, s[32:35], s67 offen offset:0 sc1 lds
buffer_load_dwordx4 v21, s[32:35], s67 offen offset:1024 sc1 lds
buffer_load_dwordx4 v22, s[32:35], s67 offen offset:2048 sc1 lds
buffer_load_dwordx4 v23, s[32:35], s67 offen offset:3072 sc1 lds
s_add_u32 s60, s71, 0
s_add_u32 m0, s60, 0
s_mov_b32 s61, s68
buffer_load_dwordx4 v26, s[28:31], s61 offen lds
buffer_load_dwordx4 v27, s[28:31], s61 offen offset:1024 lds
s_add_u32 m0, s60, 8192
s_add_u32 s61, s61, s53
buffer_load_dwordx4 v26, s[28:31], s61 offen lds
buffer_load_dwordx4 v27, s[28:31], s61 offen offset:1024 lds
s_add_u32 m0, s60, 16384
s_add_u32 s61, s61, s53
buffer_load_dwordx4 v26, s[28:31], s61 offen lds
buffer_load_dwordx4 v27, s[28:31], s61 offen offset:1024 lds
s_waitcnt vmcnt(10)
s_barrier
s_setprio 0
buffer_load_dwordx4 v[80:83], v37, s[32:35], 0 offen offset:0 sc1
buffer_load_dwordx4 v[84:87], v37, s[32:35], 0 offen offset:1024 sc1
buffer_load_dwordx4 v[88:91], v37, s[32:35], 0 offen offset:2048 sc1
buffer_load_dwordx4 v[92:95], v37, s[32:35], 0 offen offset:3072 sc1
global_load_dword v48, v54, s[98:99]
s_add_u32 s48, s75, 15
s_and_b32 s48, s48, 15
s_mul_i32 s48, s48, s57
s_add_u32 m0, s71, 106496
s_nop 0
buffer_load_dwordx4 v28, s[36:39], s48 offen lds
buffer_load_dwordx4 v29, s[36:39], s48 offen offset:1024 lds
s_add_u32 s48, s75, 5
s_and_b32 s48, s48, 15
s_mul_i32 s48, s48, s57
s_add_u32 m0, s71, 24576
s_nop 0
buffer_load_dwordx4 v28, s[36:39], s48 offen lds
buffer_load_dwordx4 v29, s[36:39], s48 offen offset:1024 lds
s_add_u32 s48, s75, 6
s_and_b32 s48, s48, 15
s_mul_i32 s48, s48, s57
s_add_u32 m0, s71, 32768
s_nop 0
buffer_load_dwordx4 v28, s[36:39], s48 offen lds
buffer_load_dwordx4 v29, s[36:39], s48 offen offset:1024 lds
s_waitcnt vmcnt(11)
s_barrier
s_waitcnt vmcnt(7)
s_add_u32 s48, s75, 7
s_and_b32 s48, s48, 15
s_mul_i32 s48, s48, s57
s_add_u32 m0, s71, 40960
s_nop 0
buffer_load_dwordx4 v28, s[36:39], s48 offen lds
v_add_f32 v80, v80, v88
v_add_f32 v81, v81, v89
v_add_f32 v82, v82, v90
v_add_f32 v83, v83, v91
v_add_f32 v84, v84, v92
buffer_load_dwordx4 v29, s[36:39], s48 offen offset:1024 lds
v_add_f32 v85, v85, v93
v_add_f32 v86, v86, v94
v_add_f32 v87, v87, v95
v_add_f32 v80, v80, v84
v_add_f32 v81, v81, v85
s_add_u32 s48, s75, 8
s_and_b32 s48, s48, 15
s_mul_i32 s48, s48, s57
s_add_u32 m0, s71, 49152
s_nop 0
buffer_load_dwordx4 v28, s[36:39], s48 offen lds
v_add_f32 v82, v82, v86
v_add_f32 v83, v83, v87
s_nop 1
v_permlane32_swap_b32 v80, v81
buffer_load_dwordx4 v29, s[36:39], s48 offen offset:1024 lds
v_permlane32_swap_b32 v82, v83
v_add_f32 v80, v80, v81
v_add_f32 v82, v82, v83
s_nop 1
v_permlane16_swap_b32 v80, v82
s_add_u32 s48, s75, 9
s_and_b32 s48, s48, 15
s_mul_i32 s48, s48, s57
s_add_u32 m0, s71, 57344
s_nop 0
buffer_load_dwordx4 v28, s[36:39], s48 offen lds
s_nop 0
v_add_f32 v80, v80, v82
v_cmp_u_f32 vcc, v80, v80
s_cbranch_vccnz again_32
summed_33:
buffer_load_dwordx4 v29, s[36:39], s48 offen offset:1024 lds
v_mul_f32 v44, 0x3a800000, v80
v_mov_b32 v45, v44
s_nop 1
v_permlane16_swap_b32 v44, v45
s_add_u32 s48, s75, 10
s_and_b32 s48, s48, 15
s_mul_i32 s48, s48, s57
s_add_u32 m0, s71, 65536
s_nop 0
buffer_load_dwordx4 v28, s[36:39], s48 offen lds
s_nop 0
v_fma_f32 v45, -v44, v44, v45
v_max_f32 v45, 0, v45
v_add_f32 v45, 0x3727c5ac, v45
v_rsq_f32 v46, v45
buffer_load_dwordx4 v29, s[36:39], s48 offen offset:1024 lds
v_sub_f32 v47, 0, v44
ds_write_b32 v50, v47 offset:512
ds_write_b64 v49, v[46:47]
ds_write_b32 v50, v46
s_setprio 0
s_waitcnt lgkmcnt(0)
s_waitcnt vmcnt(63)
s_barrier
s_waitcnt vmcnt(4)
s_add_u32 s48, s75, 11
s_and_b32 s48, s48, 15
s_mul_i32 s48, s48, s57
s_add_u32 m0, s71, 73728
s_nop 0
buffer_load_dwordx4 v28, s[36:39], s48 offen lds
buffer_load_dwordx4 v29, s[36:39], s48 offen offset:1024 lds
s_waitcnt vmcnt(4)
s_add_u32 s48, s75, 12
s_and_b32 s48, s48, 15
s_mul_i32 s48, s48, s57
s_add_u32 m0, s71, 81920
s_nop 0
buffer_load_dwordx4 v28, s[36:39], s48 offen lds
buffer_load_dwordx4 v29, s[36:39], s48 offen offset:1024 lds
s_waitcnt vmcnt(4)
s_add_u32 s48, s75, 13
s_and_b32 s48, s48, 15
s_mul_i32 s48, s48, s57
s_add_u32 m0, s71, 90112
s_nop 0
buffer_load_dwordx4 v28, s[36:39], s48 offen lds
buffer_load_dwordx4 v29, s[36:39], s48 offen offset:1024 lds
s_waitcnt vmcnt(4)
s_add_u32 s48, s75, 14
s_and_b32 s48, s48, 15
s_mul_i32 s48, s48, s57
s_add_u32 m0, s71, 98304
s_nop 0
buffer_load_dwordx4 v28, s[36:39], s48 offen lds
buffer_load_dwordx4 v29, s[36:39], s48 offen offset:1024 lds
s_waitcnt vmcnt(4)
s_add_u32 s48, s75, 0
s_and_b32 s48, s48, 15
s_mul_i32 s48, s48, s57
s_add_u32 m0, s71, 4294950912
s_nop 0
buffer_load_dwordx4 v28, s[36:39], s48 offen lds
buffer_load_dwordx4 v29, s[36:39], s48 offen offset:1024 lds
s_waitcnt vmcnt(4)
s_add_u32 s48, s75, 1
s_and_b32 s48, s48, 15
s_mul_i32 s48, s48, s57
s_add_u32 m0, s71, 4294959104
s_nop 0
buffer_load_dwordx4 v28, s[36:39], s48 offen lds
buffer_load_dwordx4 v29, s[36:39], s48 offen offset:1024 lds
s_waitcnt vmcnt(4)
s_add_u32 s48, s75, 2
s_and_b32 s48, s48, 15
s_mul_i32 s48, s48, s57
s_add_u32 m0, s71, 0
s_nop 0
buffer_load_dwordx4 v28, s[36:39], s48 offen lds
buffer_load_dwordx4 v29, s[36:39], s48 offen offset:1024 lds
s_waitcnt vmcnt(4)
s_add_u32 s48, s75, 3
s_and_b32 s48, s48, 15
s_mul_i32 s48, s48, s57
s_add_u32 m0, s71, 8192
s_nop 0
buffer_load_dwordx4 v28, s[36:39], s48 offen lds
buffer_load_dwordx4 v29, s[36:39], s48 offen offset:1024 lds
s_waitcnt vmcnt(4)
s_add_u32 s48, s75, 4
s_and_b32 s48, s48, 15
s_mul_i32 s48, s48, s57
s_add_u32 m0, s71, 16384
s_nop 0
buffer_load_dwordx4 v28, s[36:39], s48 offen lds
buffer_load_dwordx4 v29, s[36:39], s48 offen offset:1024 lds
s_waitcnt vmcnt(4)
buffer_load_dwordx4 v[96:99], v18, s[32:35], s81 offen offset:0 sc1
buffer_load_dwordx4 v[100:103], v18, s[32:35], s81 offen offset:1024 sc1
s_waitcnt vmcnt(4)
buffer_load_dwordx4 v[104:107], v18, s[32:35], s82 offen offset:0 sc1
buffer_load_dwordx4 v[108:111], v18, s[32:35], s82 offen offset:1024 sc1
s_waitcnt vmcnt(0) lgkmcnt(0)
s_barrier
L_end:
s_endpgm
L_compute:
s_waitcnt lgkmcnt(0)
s_mov_b32 s32, s22
s_and_b32 s33, s23, 0xffff
s_mov_b32 s34, 268435456
s_mov_b32 s35, 0x00020000
s_setprio 1
s_and_b32 s43, s40, 1
s_lshr_b32 s44, s40, 1
s_lshl_b32 s45, s42, 1
s_add_u32 s45, s45, s43
s_cmp_lg_u32 s40, 1
s_cbranch_scc1 else_35
s_getpc_b64 s[48:49]
L_pc:
s_sub_u32 s48, s48, L_pc - interleave_layers__sliding_local_dilated__linear_kernel_hedgehog__prompt_kernel
s_subb_u32 s49, s49, 0
s_lshr_b32 s50, s2, 3
s_lshl_b32 s50, s50, 12
v_lshl_add_u32 v8, v0, 6, s50
v_cmp_gt_u32 vcc, L_code_end - interleave_layers__sliding_local_dilated__linear_kernel_hedgehog__prompt_kernel, v8
s_and_saveexec_b64 s[50:51], vcc
s_cbranch_execz nopf_37
global_load_dword v254, v8, s[48:49]
nopf_37:
s_mov_b64 exec, -1
else_35:
s_lshl_b32 s48, s41, 3
s_lshl_b32 s49, s44, 2
s_add_u32 s48, s48, s49
s_lshl_b32 s48, s48, 5
s_add_u32 s48, s48, s45
s_lshl_b32 s48, s48, 10
s_add_u32 s80, s48, 4194304
s_add_u32 s81, s80, 32768
s_add_u32 s82, s80, 65536
s_add_u32 s83, s80, 98304
s_lshl_b32 s84, s41, 2
s_add_u32 s84, s84, s44
s_lshl_b32 s84, s84, 7
s_add_u32 s84, s84, 18350080
s_lshl_b32 s48, s41, 3
s_lshl_b32 s49, s40, 1
s_add_u32 s48, s48, s49
s_lshl_b32 s48, s48, 15
s_lshl_b32 s49, s78, 11
s_add_u32 s85, s48, s49
s_add_u32 s86, s85, 32768
s_lshl_b32 s50, s41, 2
s_add_u32 s50, s50, s40
s_lshl_b32 s50, s50, 4
s_add_u32 s50, s50, s42
s_lshl_b32 s50, s50, 8
s_add_u32 s87, s50, 16777216
s_lshl_b32 s88, s41, 2
s_add_u32 s88, s88, s40
s_lshl_b32 s88, s88, 7
s_add_u32 s88, s88, 18358272
v_lshrrev_b32 v4, 1, v3
v_lshl_add_u32 v4, v2, 2, v4
v_and_b32 v5, 1, v3
v_lshl_add_u32 v4, v5, 1, v4
v_lshlrev_b32 v1, 2, v4
s_lshl_b32 s48, s40, 2
s_add_u32 s48, s48, 134672
v_mov_b32 v10, s48
v_mov_b32 v11, 0
ds_write_b32 v10, v11
v_mov_b32 v140, -1
v_mov_b32 v141, -1
v_mov_b32 v142, -1
v_mov_b32 v143, -1
s_lshl_b32 s50, s42, 2
s_add_u32 s50, s50, s40
s_lshl_b32 s50, s50, 4
s_add_u32 s50, s50, s41
s_lshl_b32 s50, s50, 8
s_add_u32 s50, s50, 17825792
v_mov_b32 v4, s87
v_mov_b32 v5, s50
v_cmp_eq_u32 vcc, 0, v3
v_lshrrev_b32 v6, 1, v3
v_mul_u32_u24 v6, 262144, v6
v_add_u32 v5, v5, v6
v_cndmask_b32 v4, v5, v4, vcc
v_lshl_add_u32 v4, v2, 4, v4
buffer_store_dwordx4 v[140:143], v4, s[32:35], 0 offen sc1
s_lshl_b32 s48, s2, 2
s_add_u32 s49, s48, s40
s_lshl_b32 s48, s49, 10
s_add_u32 s48, s48, 8388608
buffer_store_dwordx4 v[140:143], v18, s[32:35], s48 offen sc1
s_and_b32 s48, s49, 15
s_cmp_lg_u32 s48, 0
s_cbranch_scc1 nofl_38
s_lshl_b32 s48, s49, 4
s_add_u32 s48, s48, 18350080
v_lshlrev_b32 v6, 2, v0
buffer_store_dword v11, v6, s[32:35], s48 offen sc1
nofl_38:
s_lshl_b32 s49, s44, 13
v_lshrrev_b32 v4, 1, v2
v_xor_b32 v4, v4, v3
v_lshlrev_b32 v4, 4, v4
v_lshl_add_u32 v10, v2, 7, v4
v_add_u32 v10, s49, v10
v_xor_b32 v11, 64, v10
s_lshl_b32 s48, s43, 1
v_lshrrev_b32 v4, 2, v2
v_and_b32 v5, 3, v0
v_lshl_add_u32 v6, v3, 3, v4
v_lshlrev_b32 v6, 7, v6
v_lshl_add_u32 v6, v5, 3, v6
v_lshrrev_b32 v7, 1, v4
v_and_b32 v8, 1, v3
v_lshl_add_u32 v7, v8, 1, v7
v_xor_b32 v7, s48, v7
v_lshl_add_u32 v12, v7, 5, v6
v_add_u32 v12, 16384, v12
v_xor_b32 v13, 32, v12
v_mov_b32 v14, v10
v_mov_b32 v15, v11
v_add_u32 v16, 0, v12
v_add_u32 v17, 0, v13
v_mov_b32 v156, 0
v_mov_b32 v157, 0
v_mov_b32 v158, 0
v_mov_b32 v159, 0
v_mov_b32 v160, 0
v_mov_b32 v161, 0
v_mov_b32 v162, 0
v_mov_b32 v163, 0
v_mov_b32 v164, 0
v_mov_b32 v165, 0
v_mov_b32 v166, 0
v_mov_b32 v167, 0
v_mov_b32 v168, 0
v_mov_b32 v169, 0
v_mov_b32 v170, 0
v_mov_b32 v171, 0
v_mov_b32 v172, 0
v_mov_b32 v173, 0
v_mov_b32 v174, 0
v_mov_b32 v175, 0
v_mov_b32 v176, 0
v_mov_b32 v177, 0
v_mov_b32 v178, 0
v_mov_b32 v179, 0
v_mov_b32 v180, 0
v_mov_b32 v181, 0
v_mov_b32 v182, 0
v_mov_b32 v183, 0
v_mov_b32 v184, 0
v_mov_b32 v185, 0
v_mov_b32 v186, 0
v_mov_b32 v187, 0
v_mov_b32 v188, 0
v_mov_b32 v189, 0
v_mov_b32 v190, 0
v_mov_b32 v191, 0
v_mov_b32 v192, 0
v_mov_b32 v193, 0
v_mov_b32 v194, 0
v_mov_b32 v195, 0
v_mov_b32 v196, 0
v_mov_b32 v197, 0
v_mov_b32 v198, 0
v_mov_b32 v199, 0
v_mov_b32 v200, 0
v_mov_b32 v201, 0
v_mov_b32 v202, 0
v_mov_b32 v203, 0
v_mov_b32 v204, 0
v_mov_b32 v205, 0
v_mov_b32 v206, 0
v_mov_b32 v207, 0
v_mov_b32 v208, 0
v_mov_b32 v209, 0
v_mov_b32 v210, 0
v_mov_b32 v211, 0
v_mov_b32 v212, 0
v_mov_b32 v213, 0
v_mov_b32 v214, 0
v_mov_b32 v215, 0
v_mov_b32 v216, 0
v_mov_b32 v217, 0
v_mov_b32 v218, 0
v_mov_b32 v219, 0
v_mov_b32 v220, 0
v_mov_b32 v221, 0
v_mov_b32 v222, 0
v_mov_b32 v223, 0
v_mov_b32 v224, 0
v_mov_b32 v225, 0
v_mov_b32 v226, 0
v_mov_b32 v227, 0
v_mov_b32 v228, 0
v_mov_b32 v229, 0
v_mov_b32 v230, 0
v_mov_b32 v231, 0
v_mov_b32 v232, 0
v_mov_b32 v233, 0
v_mov_b32 v234, 0
v_mov_b32 v235, 0
v_mov_b32 v236, 0
v_mov_b32 v237, 0
v_mov_b32 v238, 0
v_mov_b32 v239, 0
v_mov_b32 v240, 0
v_mov_b32 v241, 0
v_mov_b32 v242, 0
v_mov_b32 v243, 0
v_mov_b32 v244, 0
v_mov_b32 v245, 0
v_mov_b32 v246, 0
v_mov_b32 v247, 0
v_mov_b32 v248, 0
v_mov_b32 v249, 0
v_mov_b32 v250, 0
v_mov_b32 v251, 0
v_mov_b32 v48, 0x3f803f80
v_mov_b32 v49, 0x3f803f80
v_mov_b32 v50, 0x3f803f80
v_mov_b32 v51, 0x3f803f80
s_mov_b32 s48, 0xf149f2ca
v_mov_b32 v9, s48
v_lshlrev_b32 v4, 2, v3
v_sub_u32 v4, v2, v4
v_subrev_u32 v5, 0, v4
v_and_b32 v6, 0x80000001, v5
v_cmp_eq_u32 vcc, 0, v6
v_add_u32 v5, 1, v5
v_and_b32 v6, 0x80000001, v5
v_cndmask_b32 v40, v9, 0, vcc
v_cmp_eq_u32 vcc, 0x80000001, v6
s_nop 1
v_cndmask_b32 v36, v9, 0, vcc
v_subrev_u32 v5, 1, v4
v_and_b32 v6, 0x80000001, v5
v_cmp_eq_u32 vcc, 0, v6
v_add_u32 v5, 1, v5
v_and_b32 v6, 0x80000001, v5
v_cndmask_b32 v41, v9, 0, vcc
v_cmp_eq_u32 vcc, 0x80000001, v6
s_nop 1
v_cndmask_b32 v37, v9, 0, vcc
v_subrev_u32 v5, 2, v4
v_and_b32 v6, 0x80000001, v5
v_cmp_eq_u32 vcc, 0, v6
v_add_u32 v5, 1, v5
v_and_b32 v6, 0x80000001, v5
v_cndmask_b32 v42, v9, 0, vcc
v_cmp_eq_u32 vcc, 0x80000001, v6
s_nop 1
v_cndmask_b32 v38, v9, 0, vcc
v_subrev_u32 v5, 3, v4
v_and_b32 v6, 0x80000001, v5
v_cmp_eq_u32 vcc, 0, v6
v_add_u32 v5, 1, v5
v_and_b32 v6, 0x80000001, v5
v_cndmask_b32 v43, v9, 0, vcc
v_cmp_eq_u32 vcc, 0x80000001, v6
s_nop 1
v_cndmask_b32 v39, v9, 0, vcc
s_or_b32 s48, s41, s44
s_cmp_eq_u32 s48, 0
s_cselect_b64 vcc, -1, 0
v_cndmask_b32 v44, v36, v9, vcc
v_cndmask_b32 v45, v37, v9, vcc
v_cndmask_b32 v46, v38, v9, vcc
v_cndmask_b32 v47, v39, v9, vcc
v_and_b32 v4, 1, v2
v_lshlrev_b32 v4, 4, v4
v_mov_b32 v5, 0xffff
v_lshlrev_b32 v52, v4, v5
s_lshl_b32 s48, s43, 11
s_add_u32 s48, s48, 135168
v_add_u32 v53, s48, v18
v_lshl_add_u32 v55, v0, 3, s48
s_add_u32 s48, s41, s44
s_sub_u32 s48, s48, 1
s_lshl_b32 s49, s48, 1
s_add_u32 s49, s49, s43
s_lshl_b32 s49, s49, 11
s_mul_i32 s50, s42, 65536
s_add_u32 s49, s49, s50
s_add_u32 s49, s49, 8388608
s_cmp_lt_i32 s48, 0
s_cselect_b32 s49, 0xf0000000, s49
v_add_u32 v58, s49, v18
v_lshl_add_u32 v59, v0, 3, s49
s_lshl_b32 s48, s43, 2
s_add_u32 s48, s48, 134672
v_mov_b32 v19, s48
s_lshl_b32 s48, s43, 7
s_add_u32 s48, s48, 133120
v_lshl_add_u32 v7, v3, 4, s48
v_lshl_add_u32 v54, v2, 2, s48
s_lshl_b32 s49, s44, 6
v_add_u32 v8, s49, v2
v_lshlrev_b32 v8, 3, v8
v_add_u32 v8, 131072, v8
v_lshl_add_u32 v9, v3, 2, s49
v_lshlrev_b32 v9, 2, v9
v_add_u32 v9, 132096, v9
s_mov_b32 s64, 0
s_mov_b32 s65, 0
s_mov_b32 s66, 0x3e8293ee
s_lshl_b32 s50, s42, 2
s_add_u32 s50, s50, s40
s_lshl_b32 s50, s50, 4
s_add_u32 s50, s50, s41
s_lshl_b32 s50, s50, 8
s_add_u32 s52, s50, 17825792
v_lshrrev_b32 v4, 1, v2
v_lshrrev_b32 v5, 1, v3
v_xor_b32 v4, v4, v5
v_lshlrev_b32 v4, 4, v4
v_and_b32 v5, 1, v3
v_lshl_add_u32 v4, v5, 3, v4
v_lshl_add_u32 v4, v2, 7, v4
s_lshl_b32 s48, s40, 12
v_add_u32 v155, s48, v4
v_mov_b32 v152, 0
v_mov_b32 v153, 0
v_mov_b32 v56, 0
v_mov_b32 v57, 0
s_waitcnt vmcnt(0)
s_barrier
ds_read_b128 v[60:63], v14 offset:0
ds_read_b128 v[64:67], v14 offset:2048
ds_read_b128 v[68:71], v14 offset:4096
ds_read_b128 v[72:75], v14 offset:6144
ds_read_b64_tr_b16 v[84:85], v16 offset:8192
ds_read_b64_tr_b16 v[86:87], v16 offset:8704
ds_read_b64_tr_b16 v[88:89], v17 offset:8192
ds_read_b64_tr_b16 v[90:91], v17 offset:8704
ds_read_b64_tr_b16 v[92:93], v16 offset:16384
ds_read_b64_tr_b16 v[94:95], v16 offset:16896
ds_read_b64_tr_b16 v[96:97], v17 offset:16384
ds_read_b64_tr_b16 v[98:99], v17 offset:16896
ds_read_b64_tr_b16 v[76:77], v16 offset:0
ds_read_b64_tr_b16 v[78:79], v16 offset:512
ds_read_b64_tr_b16 v[80:81], v17 offset:0
ds_read_b64_tr_b16 v[82:83], v17 offset:512
s_waitcnt lgkmcnt(0)
c0_loop:
v_mfma_f32_16x16x32_bf16 v[212:215], v[84:87], v[72:75], v[212:215]
ds_read_b128 v[100:103], v15 offset:0
v_mfma_f32_16x16x32_bf16 v[204:207], v[84:87], v[68:71], v[204:207]
ds_read_b128 v[104:107], v15 offset:2048
v_mfma_f32_16x16x32_bf16 v[196:199], v[84:87], v[64:67], v[196:199]
ds_read_b128 v[108:111], v15 offset:4096
v_mfma_f32_16x16x32_bf16 v[188:191], v[84:87], v[60:63], v[188:191]
ds_read_b128 v[112:115], v15 offset:6144
v_mfma_f32_16x16x32_bf16 v[192:195], v[88:91], v[60:63], v[192:195]
ds_read_b64_tr_b16 v[124:125], v16 offset:12288
v_mfma_f32_16x16x32_bf16 v[200:203], v[88:91], v[64:67], v[200:203]
ds_read_b64_tr_b16 v[126:127], v16 offset:12800
v_mfma_f32_16x16x32_bf16 v[208:211], v[88:91], v[68:71], v[208:211]
ds_read_b64_tr_b16 v[128:129], v17 offset:12288
v_mfma_f32_16x16x32_bf16 v[216:219], v[88:91], v[72:75], v[216:219]
ds_read_b64_tr_b16 v[130:131], v17 offset:12800
v_mfma_f32_16x16x32_bf16 v[244:247], v[72:75], v[92:95], v[244:247]
ds_read_b64_tr_b16 v[132:133], v16 offset:20480
v_mfma_f32_16x16x32_bf16 v[236:239], v[68:71], v[92:95], v[236:239]
ds_read_b64_tr_b16 v[134:135], v16 offset:20992
v_mfma_f32_16x16x32_bf16 v[228:231], v[64:67], v[92:95], v[228:231]
ds_read_b64_tr_b16 v[136:137], v17 offset:20480
v_mfma_f32_16x16x32_bf16 v[220:223], v[60:63], v[92:95], v[220:223]
ds_read_b64_tr_b16 v[138:139], v17 offset:20992
v_mfma_f32_16x16x32_bf16 v[224:227], v[60:63], v[96:99], v[224:227]
ds_read_b64_tr_b16 v[116:117], v16 offset:4096
v_mfma_f32_16x16x32_bf16 v[232:235], v[64:67], v[96:99], v[232:235]
ds_read_b64_tr_b16 v[118:119], v16 offset:4608
v_mfma_f32_16x16x32_bf16 v[240:243], v[68:71], v[96:99], v[240:243]
ds_read_b64_tr_b16 v[120:121], v17 offset:4096
v_mfma_f32_16x16x32_bf16 v[248:251], v[72:75], v[96:99], v[248:251]
ds_read_b64_tr_b16 v[122:123], v17 offset:4608
v_mfma_f32_16x16x32_bf16 v[180:183], v[76:79], v[72:75], v[180:183]
s_cmp_eq_u32 s77, s64
s_cbranch_scc1 c0_hook
c0_hook_ret:
v_mfma_f32_16x16x32_bf16 v[172:175], v[76:79], v[68:71], v[172:175]
s_add_u32 s65, s65, 40960
s_cmp_eq_u32 s65, 122880
v_mfma_f32_16x16x32_bf16 v[164:167], v[76:79], v[64:67], v[164:167]
s_cselect_b32 s65, 0, s65
s_add_u32 s64, s64, 1
v_mfma_f32_16x16x32_bf16 v[156:159], v[76:79], v[60:63], v[156:159]
v_add_u32 v14, s65, v10
v_add_u32 v15, s65, v11
v_mfma_f32_16x16x32_bf16 v[160:163], v[80:83], v[60:63], v[160:163]
v_add_u32 v16, s65, v12
v_add_u32 v17, s65, v13
v_mfma_f32_16x16x32_bf16 v[168:171], v[80:83], v[64:67], v[168:171]
s_cmp_eq_u32 s64, 16
s_cbranch_scc1 c0_last
v_mfma_f32_16x16x32_bf16 v[176:179], v[80:83], v[68:71], v[176:179]
s_waitcnt lgkmcnt(0)
v_mfma_f32_16x16x32_bf16 v[184:187], v[80:83], v[72:75], v[184:187]
s_barrier
v_mfma_f32_16x16x32_bf16 v[212:215], v[124:127], v[112:115], v[212:215]
ds_read_b128 v[60:63], v14 offset:0
v_mfma_f32_16x16x32_bf16 v[204:207], v[124:127], v[108:111], v[204:207]
ds_read_b128 v[64:67], v14 offset:2048
v_mfma_f32_16x16x32_bf16 v[196:199], v[124:127], v[104:107], v[196:199]
ds_read_b128 v[68:71], v14 offset:4096
v_mfma_f32_16x16x32_bf16 v[188:191], v[124:127], v[100:103], v[188:191]
ds_read_b128 v[72:75], v14 offset:6144
v_mfma_f32_16x16x32_bf16 v[192:195], v[128:131], v[100:103], v[192:195]
ds_read_b64_tr_b16 v[84:85], v16 offset:8192
v_mfma_f32_16x16x32_bf16 v[200:203], v[128:131], v[104:107], v[200:203]
ds_read_b64_tr_b16 v[86:87], v16 offset:8704
v_mfma_f32_16x16x32_bf16 v[208:211], v[128:131], v[108:111], v[208:211]
ds_read_b64_tr_b16 v[88:89], v17 offset:8192
v_mfma_f32_16x16x32_bf16 v[216:219], v[128:131], v[112:115], v[216:219]
ds_read_b64_tr_b16 v[90:91], v17 offset:8704
v_mfma_f32_16x16x32_bf16 v[244:247], v[112:115], v[132:135], v[244:247]
ds_read_b64_tr_b16 v[92:93], v16 offset:16384
v_mfma_f32_16x16x32_bf16 v[236:239], v[108:111], v[132:135], v[236:239]
ds_read_b64_tr_b16 v[94:95], v16 offset:16896
v_mfma_f32_16x16x32_bf16 v[228:231], v[104:107], v[132:135], v[228:231]
ds_read_b64_tr_b16 v[96:97], v17 offset:16384
v_mfma_f32_16x16x32_bf16 v[220:223], v[100:103], v[132:135], v[220:223]
ds_read_b64_tr_b16 v[98:99], v17 offset:16896
v_mfma_f32_16x16x32_bf16 v[224:227], v[100:103], v[136:139], v[224:227]
ds_read_b64_tr_b16 v[76:77], v16 offset:0
v_mfma_f32_16x16x32_bf16 v[232:235], v[104:107], v[136:139], v[232:235]
ds_read_b64_tr_b16 v[78:79], v16 offset:512
v_mfma_f32_16x16x32_bf16 v[240:243], v[108:111], v[136:139], v[240:243]
ds_read_b64_tr_b16 v[80:81], v17 offset:0
v_mfma_f32_16x16x32_bf16 v[248:251], v[112:115], v[136:139], v[248:251]
ds_read_b64_tr_b16 v[82:83], v17 offset:512
v_mfma_f32_16x16x32_bf16 v[180:183], v[116:119], v[112:115], v[180:183]
v_mfma_f32_16x16x32_bf16 v[172:175], v[116:119], v[108:111], v[172:175]
v_mfma_f32_16x16x32_bf16 v[164:167], v[116:119], v[104:107], v[164:167]
v_mfma_f32_16x16x32_bf16 v[156:159], v[116:119], v[100:103], v[156:159]
v_mfma_f32_16x16x32_bf16 v[160:163], v[120:123], v[100:103], v[160:163]
v_mfma_f32_16x16x32_bf16 v[168:171], v[120:123], v[104:107], v[168:171]
v_mfma_f32_16x16x32_bf16 v[176:179], v[120:123], v[108:111], v[176:179]
s_waitcnt lgkmcnt(0)
v_mfma_f32_16x16x32_bf16 v[184:187], v[120:123], v[112:115], v[184:187]
s_branch c0_loop
c0_hook:
v_add_u32 v4, s65, v155
ds_read_b64 v[20:21], v4 offset:0
ds_read_b64 v[28:29], v4 offset:2048
v_xor_b32 v5, 32, v4
ds_read_b64 v[22:23], v5 offset:0
ds_read_b64 v[30:31], v5 offset:2048
v_xor_b32 v5, 64, v4
ds_read_b64 v[24:25], v5 offset:0
ds_read_b64 v[32:33], v5 offset:2048
v_xor_b32 v5, 96, v4
ds_read_b64 v[26:27], v5 offset:0
ds_read_b64 v[34:35], v5 offset:2048
s_waitcnt lgkmcnt(8)
s_cmp_lg_u32 s44, 0
s_cbranch_scc1 else_39
v_mfma_f32_16x16x32_bf16 v[140:143], v[48:51], v[76:79], 0
v_mfma_f32_16x16x32_bf16 v[144:147], v[48:51], v[84:87], 0
v_mfma_f32_16x16x32_bf16 v[148:151], v[48:51], v[92:95], 0
v_mfma_f32_16x16x32_bf16 v[140:143], v[48:51], v[116:119], v[140:143]
v_mfma_f32_16x16x32_bf16 v[144:147], v[48:51], v[124:127], v[144:147]
v_mfma_f32_16x16x32_bf16 v[148:151], v[48:51], v[132:135], v[148:151]
s_branch fi_40
else_39:
v_mfma_f32_16x16x32_bf16 v[140:143], v[48:51], v[80:83], 0
v_mfma_f32_16x16x32_bf16 v[144:147], v[48:51], v[88:91], 0
v_mfma_f32_16x16x32_bf16 v[148:151], v[48:51], v[96:99], 0
v_mfma_f32_16x16x32_bf16 v[140:143], v[48:51], v[120:123], v[140:143]
v_mfma_f32_16x16x32_bf16 v[144:147], v[48:51], v[128:131], v[144:147]
v_mfma_f32_16x16x32_bf16 v[148:151], v[48:51], v[136:139], v[148:151]
fi_40:
s_waitcnt lgkmcnt(0)
v_dot2c_f32_bf16 v152, v20, v48
v_dot2c_f32_bf16 v56, v20, v20
v_dot2c_f32_bf16 v153, v28, v48
v_dot2c_f32_bf16 v57, v28, v28
v_dot2c_f32_bf16 v152, v21, v48
v_dot2c_f32_bf16 v56, v21, v21
v_dot2c_f32_bf16 v153, v29, v48
v_dot2c_f32_bf16 v57, v29, v29
v_dot2c_f32_bf16 v152, v22, v48
v_dot2c_f32_bf16 v56, v22, v22
v_dot2c_f32_bf16 v153, v30, v48
v_dot2c_f32_bf16 v57, v30, v30
v_dot2c_f32_bf16 v152, v23, v48
v_dot2c_f32_bf16 v56, v23, v23
v_dot2c_f32_bf16 v153, v31, v48
v_dot2c_f32_bf16 v57, v31, v31
v_dot2c_f32_bf16 v152, v24, v48
v_dot2c_f32_bf16 v56, v24, v24
v_dot2c_f32_bf16 v153, v32, v48
v_dot2c_f32_bf16 v57, v32, v32
v_dot2c_f32_bf16 v152, v25, v48
v_dot2c_f32_bf16 v56, v25, v25
v_dot2c_f32_bf16 v153, v33, v48
v_dot2c_f32_bf16 v57, v33, v33
v_dot2c_f32_bf16 v152, v26, v48
v_dot2c_f32_bf16 v56, v26, v26
v_dot2c_f32_bf16 v153, v34, v48
v_dot2c_f32_bf16 v57, v34, v34
v_dot2c_f32_bf16 v152, v27, v48
v_dot2c_f32_bf16 v56, v27, v27
v_dot2c_f32_bf16 v153, v35, v48
v_dot2c_f32_bf16 v57, v35, v35
v_cmp_eq_u32 vcc, 0, v3
v_cmp_eq_u32 s[48:49], 1, v3
s_nop 1
v_cndmask_b32 v4, v148, v144, s[48:49]
v_cndmask_b32 v4, v4, v140, vcc
buffer_store_dword v4, v1, s[32:35], s52 offen sc1
s_nop 1
v_permlane32_swap_b32 v152, v153
v_permlane32_swap_b32 v56, v57
v_add_f32 v152, v152, v153
v_add_f32 v56, v56, v57
s_nop 1
v_permlane16_swap_b32 v152, v56
s_nop 0
v_add_f32 v152, v152, v56
buffer_store_dword v152, v1, s[32:35], s87 offen sc1
s_branch c0_hook_ret
c0_last:
v_mfma_f32_16x16x32_bf16 v[176:179], v[80:83], v[68:71], v[176:179]
s_waitcnt lgkmcnt(0)
v_mfma_f32_16x16x32_bf16 v[184:187], v[80:83], v[72:75], v[184:187]
s_barrier
v_mfma_f32_16x16x32_bf16 v[212:215], v[124:127], v[112:115], v[212:215]
ds_read_b128 v[140:143], v7 offset:0
v_mfma_f32_16x16x32_bf16 v[204:207], v[124:127], v[108:111], v[204:207]
ds_read_b128 v[144:147], v7 offset:64
v_mfma_f32_16x16x32_bf16 v[196:199], v[124:127], v[104:107], v[196:199]
ds_read_b128 v[148:151], v7 offset:256
v_mfma_f32_16x16x32_bf16 v[188:191], v[124:127], v[100:103], v[188:191]
ds_read_b128 v[152:155], v7 offset:320
v_mfma_f32_16x16x32_bf16 v[192:195], v[128:131], v[100:103], v[192:195]
ds_read_b64 v[92:93], v8 offset:0
v_mfma_f32_16x16x32_bf16 v[200:203], v[128:131], v[104:107], v[200:203]
ds_read_b64 v[94:95], v8 offset:128
v_mfma_f32_16x16x32_bf16 v[208:211], v[128:131], v[108:111], v[208:211]
ds_read_b64 v[96:97], v8 offset:256
v_mfma_f32_16x16x32_bf16 v[216:219], v[128:131], v[112:115], v[216:219]
ds_read_b64 v[98:99], v8 offset:384
v_mfma_f32_16x16x32_bf16 v[244:247], v[112:115], v[132:135], v[244:247]
ds_read2_b32 v[56:57], v54 offset0:128 offset1:144
v_mfma_f32_16x16x32_bf16 v[236:239], v[108:111], v[132:135], v[236:239]
ds_read_b128 v[60:63], v9 offset:0
v_mfma_f32_16x16x32_bf16 v[228:231], v[104:107], v[132:135], v[228:231]
ds_read_b128 v[64:67], v9 offset:64
v_mfma_f32_16x16x32_bf16 v[220:223], v[100:103], v[132:135], v[220:223]
ds_read_b128 v[68:71], v9 offset:128
v_mfma_f32_16x16x32_bf16 v[224:227], v[100:103], v[136:139], v[224:227]
ds_read_b128 v[72:75], v9 offset:192
v_mfma_f32_16x16x32_bf16 v[232:235], v[104:107], v[136:139], v[232:235]
ds_read_b128 v[76:79], v9 offset:512
v_mfma_f32_16x16x32_bf16 v[240:243], v[108:111], v[136:139], v[240:243]
ds_read_b128 v[80:83], v9 offset:576
v_mfma_f32_16x16x32_bf16 v[248:251], v[112:115], v[136:139], v[248:251]
ds_read_b128 v[84:87], v9 offset:640
v_mfma_f32_16x16x32_bf16 v[180:183], v[116:119], v[112:115], v[180:183]
ds_read_b128 v[88:91], v9 offset:704
v_mfma_f32_16x16x32_bf16 v[172:175], v[116:119], v[108:111], v[172:175]
v_mov_b32 v6, 134656
ds_read_b32 v6, v6
v_mfma_f32_16x16x32_bf16 v[164:167], v[116:119], v[104:107], v[164:167]
v_mfma_f32_16x16x32_bf16 v[156:159], v[116:119], v[100:103], v[156:159]
v_mfma_f32_16x16x32_bf16 v[160:163], v[120:123], v[100:103], v[160:163]
v_mfma_f32_16x16x32_bf16 v[168:171], v[120:123], v[104:107], v[168:171]
v_mfma_f32_16x16x32_bf16 v[176:179], v[120:123], v[108:111], v[176:179]
v_mfma_f32_16x16x32_bf16 v[184:187], v[120:123], v[112:115], v[184:187]
c0_epi:
s_waitcnt lgkmcnt(0)
v_readfirstlane_b32 s46, v6
.p2align 3
v_pk_fma_f32 v[212:213], v[148:149], v[98:99], v[212:213] op_sel:[0,1,0] op_sel_hi:[1,1,1]
v_pk_fma_f32 v[214:215], v[150:151], v[98:99], v[214:215] op_sel:[0,1,0] op_sel_hi:[1,1,1]
v_pk_fma_f32 v[216:217], v[152:153], v[98:99], v[216:217] op_sel:[0,1,0] op_sel_hi:[1,1,1]
v_pk_fma_f32 v[218:219], v[154:155], v[98:99], v[218:219] op_sel:[0,1,0] op_sel_hi:[1,1,1]
v_pk_mul_f32 v[212:213], v[212:213], v[98:99] op_sel:[0,0] op_sel_hi:[1,0]
v_pk_mul_f32 v[214:215], v[214:215], v[98:99] op_sel:[0,0] op_sel_hi:[1,0]
v_pk_mul_f32 v[216:217], v[216:217], v[98:99] op_sel:[0,0] op_sel_hi:[1,0]
v_pk_mul_f32 v[218:219], v[218:219], v[98:99] op_sel:[0,0] op_sel_hi:[1,0]
v_cvt_pk_bf16_f32 v212, v212, v213
v_cvt_pk_bf16_f32 v213, v214, v215
v_cvt_pk_bf16_f32 v214, v216, v217
v_cvt_pk_bf16_f32 v215, v218, v219
v_pk_fma_f32 v[244:245], v[88:89], v[56:57], v[244:245] op_sel:[0,0,0] op_sel_hi:[1,0,1]
v_pk_fma_f32 v[246:247], v[90:91], v[56:57], v[246:247] op_sel:[0,0,0] op_sel_hi:[1,0,1]
v_pk_mul_f32 v[244:245], v[244:245], v[72:73]
v_pk_mul_f32 v[246:247], v[246:247], v[74:75]
v_cvt_pk_bf16_f32 v108, v244, v245
v_cvt_pk_bf16_f32 v109, v246, v247
v_pk_fma_f32 v[248:249], v[88:89], v[56:57], v[248:249] op_sel:[0,1,0] op_sel_hi:[1,1,1]
v_pk_fma_f32 v[250:251], v[90:91], v[56:57], v[250:251] op_sel:[0,1,0] op_sel_hi:[1,1,1]
v_pk_mul_f32 v[248:249], v[248:249], v[72:73]
v_pk_mul_f32 v[250:251], v[250:251], v[74:75]
v_cvt_pk_bf16_f32 v118, v248, v249
v_cvt_pk_bf16_f32 v119, v250, v251
s_cmp_lg_u32 s44, 1
s_cbranch_scc1 else_41
buffer_store_dwordx4 v[212:215], v58, s[32:35], 0 offen sc1
buffer_store_dwordx2 v[108:109], v59, s[32:35], 0 offen offset:1024 sc1
buffer_store_dwordx2 v[118:119], v59, s[32:35], 0 offen offset:1536 sc1
s_branch fi_42
else_41:
ds_write_b128 v53, v[212:215]
ds_write_b64 v55, v[108:109] offset:1024
ds_write_b64 v55, v[118:119] offset:1536
v_mov_b32 v4, 1
ds_write_b32 v19, v4
fi_42:
v_mul_f32 v124, s66, v92
v_mul_f32 v125, s66, v94
v_mul_f32 v126, s66, v96
v_mul_f32 v127, s66, v98
.p2align 3
v_pk_fma_f32 v[156:157], v[140:141], v[92:93], v[156:157] op_sel:[0,1,0] op_sel_hi:[1,1,1]
v_pk_fma_f32 v[158:159], v[142:143], v[92:93], v[158:159] op_sel:[0,1,0] op_sel_hi:[1,1,1]
v_pk_fma_f32 v[160:161], v[144:145], v[92:93], v[160:161] op_sel:[0,1,0] op_sel_hi:[1,1,1]
v_pk_fma_f32 v[162:163], v[146:147], v[92:93], v[162:163] op_sel:[0,1,0] op_sel_hi:[1,1,1]
v_cvt_pk_bf16_f32 v156, v156, v157
v_cvt_pk_bf16_f32 v157, v158, v159
v_cvt_pk_bf16_f32 v158, v160, v161
v_cvt_pk_bf16_f32 v159, v162, v163
v_pk_fma_f32 v[164:165], v[140:141], v[94:95], v[164:165] op_sel:[0,1,0] op_sel_hi:[1,1,1]
v_pk_fma_f32 v[166:167], v[142:143], v[94:95], v[166:167] op_sel:[0,1,0] op_sel_hi:[1,1,1]
v_pk_fma_f32 v[168:169], v[144:145], v[94:95], v[168:169] op_sel:[0,1,0] op_sel_hi:[1,1,1]
v_pk_fma_f32 v[170:171], v[146:147], v[94:95], v[170:171] op_sel:[0,1,0] op_sel_hi:[1,1,1]
v_cvt_pk_bf16_f32 v164, v164, v165
v_cvt_pk_bf16_f32 v165, v166, v167
v_cvt_pk_bf16_f32 v166, v168, v169
v_cvt_pk_bf16_f32 v167, v170, v171
v_pk_fma_f32 v[172:173], v[140:141], v[96:97], v[172:173] op_sel:[0,1,0] op_sel_hi:[1,1,1]
v_pk_fma_f32 v[174:175], v[142:143], v[96:97], v[174:175] op_sel:[0,1,0] op_sel_hi:[1,1,1]
v_pk_fma_f32 v[176:177], v[144:145], v[96:97], v[176:177] op_sel:[0,1,0] op_sel_hi:[1,1,1]
v_pk_fma_f32 v[178:179], v[146:147], v[96:97], v[178:179] op_sel:[0,1,0] op_sel_hi:[1,1,1]
v_cvt_pk_bf16_f32 v172, v172, v173
v_cvt_pk_bf16_f32 v173, v174, v175
v_cvt_pk_bf16_f32 v174, v176, v177
v_cvt_pk_bf16_f32 v175, v178, v179
v_pk_fma_f32 v[180:181], v[140:141], v[98:99], v[180:181] op_sel:[0,1,0] op_sel_hi:[1,1,1]
v_pk_fma_f32 v[182:183], v[142:143], v[98:99], v[182:183] op_sel:[0,1,0] op_sel_hi:[1,1,1]
v_pk_fma_f32 v[184:185], v[144:145], v[98:99], v[184:185] op_sel:[0,1,0] op_sel_hi:[1,1,1]
v_pk_fma_f32 v[186:187], v[146:147], v[98:99], v[186:187] op_sel:[0,1,0] op_sel_hi:[1,1,1]
v_cvt_pk_bf16_f32 v180, v180, v181
v_cvt_pk_bf16_f32 v181, v182, v183
v_cvt_pk_bf16_f32 v182, v184, v185
v_cvt_pk_bf16_f32 v183, v186, v187
v_pk_fma_f32 v[188:189], v[148:149], v[92:93], v[188:189] op_sel:[0,1,0] op_sel_hi:[1,1,1]
v_pk_fma_f32 v[190:191], v[150:151], v[92:93], v[190:191] op_sel:[0,1,0] op_sel_hi:[1,1,1]
v_pk_fma_f32 v[192:193], v[152:153], v[92:93], v[192:193] op_sel:[0,1,0] op_sel_hi:[1,1,1]
v_pk_fma_f32 v[194:195], v[154:155], v[92:93], v[194:195] op_sel:[0,1,0] op_sel_hi:[1,1,1]
v_pk_mul_f32 v[188:189], v[188:189], v[92:93] op_sel:[0,0] op_sel_hi:[1,0]
v_pk_mul_f32 v[190:191], v[190:191], v[92:93] op_sel:[0,0] op_sel_hi:[1,0]
v_pk_mul_f32 v[192:193], v[192:193], v[92:93] op_sel:[0,0] op_sel_hi:[1,0]
v_pk_mul_f32 v[194:195], v[194:195], v[92:93] op_sel:[0,0] op_sel_hi:[1,0]
v_cvt_pk_bf16_f32 v188, v188, v189
v_cvt_pk_bf16_f32 v189, v190, v191
v_cvt_pk_bf16_f32 v190, v192, v193
v_cvt_pk_bf16_f32 v191, v194, v195
v_pk_fma_f32 v[196:197], v[148:149], v[94:95], v[196:197] op_sel:[0,1,0] op_sel_hi:[1,1,1]
v_pk_fma_f32 v[198:199], v[150:151], v[94:95], v[198:199] op_sel:[0,1,0] op_sel_hi:[1,1,1]
v_pk_fma_f32 v[200:201], v[152:153], v[94:95], v[200:201] op_sel:[0,1,0] op_sel_hi:[1,1,1]
v_pk_fma_f32 v[202:203], v[154:155], v[94:95], v[202:203] op_sel:[0,1,0] op_sel_hi:[1,1,1]
v_pk_mul_f32 v[196:197], v[196:197], v[94:95] op_sel:[0,0] op_sel_hi:[1,0]
v_pk_mul_f32 v[198:199], v[198:199], v[94:95] op_sel:[0,0] op_sel_hi:[1,0]
v_pk_mul_f32 v[200:201], v[200:201], v[94:95] op_sel:[0,0] op_sel_hi:[1,0]
v_pk_mul_f32 v[202:203], v[202:203], v[94:95] op_sel:[0,0] op_sel_hi:[1,0]
v_cvt_pk_bf16_f32 v196, v196, v197
v_cvt_pk_bf16_f32 v197, v198, v199
v_cvt_pk_bf16_f32 v198, v200, v201
v_cvt_pk_bf16_f32 v199, v202, v203
v_pk_fma_f32 v[204:205], v[148:149], v[96:97], v[204:205] op_sel:[0,1,0] op_sel_hi:[1,1,1]
v_pk_fma_f32 v[206:207], v[150:151], v[96:97], v[206:207] op_sel:[0,1,0] op_sel_hi:[1,1,1]
v_pk_fma_f32 v[208:209], v[152:153], v[96:97], v[208:209] op_sel:[0,1,0] op_sel_hi:[1,1,1]
v_pk_fma_f32 v[210:211], v[154:155], v[96:97], v[210:211] op_sel:[0,1,0] op_sel_hi:[1,1,1]
v_pk_mul_f32 v[204:205], v[204:205], v[96:97] op_sel:[0,0] op_sel_hi:[1,0]
v_pk_mul_f32 v[206:207], v[206:207], v[96:97] op_sel:[0,0] op_sel_hi:[1,0]
v_pk_mul_f32 v[208:209], v[208:209], v[96:97] op_sel:[0,0] op_sel_hi:[1,0]
v_pk_mul_f32 v[210:211], v[210:211], v[96:97] op_sel:[0,0] op_sel_hi:[1,0]
v_cvt_pk_bf16_f32 v204, v204, v205
v_cvt_pk_bf16_f32 v205, v206, v207
v_cvt_pk_bf16_f32 v206, v208, v209
v_cvt_pk_bf16_f32 v207, v210, v211
s_cmp_lg_u32 s44, 0
s_cbranch_scc1 else_43
buffer_load_dwordx4 v[120:123], v58, s[32:35], 0 offen sc1
buffer_load_dwordx2 v[100:101], v59, s[32:35], 0 offen offset:1024 sc1
buffer_load_dwordx2 v[110:111], v59, s[32:35], 0 offen offset:1536 sc1
else_43:
.p2align 3
v_mfma_f32_16x16x32_bf16 v[216:219], v[212:215], v[180:183], v[40:43]
v_pk_fma_f32 v[220:221], v[76:77], v[56:57], v[220:221] op_sel:[0,0,0] op_sel_hi:[1,0,1]
v_pk_fma_f32 v[222:223], v[78:79], v[56:57], v[222:223] op_sel:[0,0,0] op_sel_hi:[1,0,1]
v_pk_mul_f32 v[220:221], v[220:221], v[60:61]
v_pk_mul_f32 v[222:223], v[222:223], v[62:63]
v_cvt_pk_bf16_f32 v102, v220, v221
v_mfma_f32_16x16x32_bf16 v[192:195], v[188:191], v[156:159], v[40:43]
v_cvt_pk_bf16_f32 v103, v222, v223
v_pk_fma_f32 v[224:225], v[76:77], v[56:57], v[224:225] op_sel:[0,1,0] op_sel_hi:[1,1,1]
v_pk_fma_f32 v[226:227], v[78:79], v[56:57], v[226:227] op_sel:[0,1,0] op_sel_hi:[1,1,1]
v_pk_mul_f32 v[224:225], v[224:225], v[60:61]
v_pk_mul_f32 v[226:227], v[226:227], v[62:63]
v_cvt_pk_bf16_f32 v112, v224, v225
v_mfma_f32_16x16x32_bf16 v[168:171], v[188:191], v[164:167], v[36:39]
v_cvt_pk_bf16_f32 v113, v226, v227
v_pk_fma_f32 v[228:229], v[80:81], v[56:57], v[228:229] op_sel:[0,0,0] op_sel_hi:[1,0,1]
v_pk_fma_f32 v[230:231], v[82:83], v[56:57], v[230:231] op_sel:[0,0,0] op_sel_hi:[1,0,1]
v_pk_mul_f32 v[228:229], v[228:229], v[64:65]
v_pk_mul_f32 v[230:231], v[230:231], v[66:67]
v_cvt_pk_bf16_f32 v104, v228, v229
v_mfma_f32_16x16x32_bf16 v[200:203], v[196:199], v[164:167], v[40:43]
v_cvt_pk_bf16_f32 v105, v230, v231
v_pk_fma_f32 v[232:233], v[80:81], v[56:57], v[232:233] op_sel:[0,1,0] op_sel_hi:[1,1,1]
v_pk_fma_f32 v[234:235], v[82:83], v[56:57], v[234:235] op_sel:[0,1,0] op_sel_hi:[1,1,1]
v_pk_mul_f32 v[232:233], v[232:233], v[64:65]
v_pk_mul_f32 v[234:235], v[234:235], v[66:67]
v_cvt_pk_bf16_f32 v114, v232, v233
v_mfma_f32_16x16x32_bf16 v[176:179], v[196:199], v[172:175], v[36:39]
v_cvt_pk_bf16_f32 v115, v234, v235
v_pk_fma_f32 v[236:237], v[84:85], v[56:57], v[236:237] op_sel:[0,0,0] op_sel_hi:[1,0,1]
v_pk_fma_f32 v[238:239], v[86:87], v[56:57], v[238:239] op_sel:[0,0,0] op_sel_hi:[1,0,1]
v_pk_mul_f32 v[236:237], v[236:237], v[68:69]
v_pk_mul_f32 v[238:239], v[238:239], v[70:71]
v_cvt_pk_bf16_f32 v106, v236, v237
v_mfma_f32_16x16x32_bf16 v[208:211], v[204:207], v[172:175], v[40:43]
v_cvt_pk_bf16_f32 v107, v238, v239
v_pk_fma_f32 v[240:241], v[84:85], v[56:57], v[240:241] op_sel:[0,1,0] op_sel_hi:[1,1,1]
v_pk_fma_f32 v[242:243], v[86:87], v[56:57], v[242:243] op_sel:[0,1,0] op_sel_hi:[1,1,1]
v_pk_mul_f32 v[240:241], v[240:241], v[68:69]
v_pk_mul_f32 v[242:243], v[242:243], v[70:71]
v_cvt_pk_bf16_f32 v116, v240, v241
v_mfma_f32_16x16x32_bf16 v[184:187], v[204:207], v[180:183], v[36:39]
v_cvt_pk_bf16_f32 v117, v242, v243
v_max_f32 v166, v200, v201
v_max_f32 v167, v202, v203
v_max_f32 v164, v168, v169
v_max_f32 v165, v170, v171
v_max3_f32 v129, v164, v165, v166
v_max_f32 v129, v129, v167
s_cmp_lg_u32 s44, 0
s_cbranch_scc1 else_45
s_mov_b32 s63, 0
sent_47:
s_waitcnt vmcnt(0)
v_max_u32 v4, v120, v121
v_max3_u32 v4, v4, v122, v123
v_max3_u32 v4, v4, v100, v101
v_max3_u32 v4, v4, v110, v111
v_cmp_eq_u32 vcc, -1, v4
s_cbranch_vccz sentd_48
buffer_load_dwordx4 v[120:123], v58, s[32:35], 0 offen sc1
buffer_load_dwordx2 v[100:101], v59, s[32:35], 0 offen offset:1024 sc1
buffer_load_dwordx2 v[110:111], v59, s[32:35], 0 offen offset:1536 sc1
s_add_u32 s63, s63, 1
s_cmp_lt_u32 s63, 0x80000
s_cbranch_scc1 sent_47
s_waitcnt vmcnt(0)
sentd_48:
s_branch fi_46
else_45:
s_mov_b32 s63, 0
px_49:
ds_read_b32 v4, v19
ds_read_b128 v[120:123], v53
ds_read_b64 v[100:101], v55 offset:1024
ds_read_b64 v[110:111], v55 offset:1536
s_add_u32 s63, s63, 1
s_cmp_lt_u32 s63, 0x400000
s_waitcnt lgkmcnt(0)
v_cmp_ne_u32 vcc, 1, v4
s_cbranch_vccz pxd_50
s_cbranch_scc1 px_49
pxd_50:
fi_46:
v_mfma_f32_16x16x32_bf16 v[160:163], v[120:123], v[156:159], v[44:47]
v_max_f32 v174, v208, v209
v_max_f32 v175, v210, v211
v_max_f32 v172, v176, v177
v_max_f32 v173, v178, v179
v_max3_f32 v130, v172, v173, v174
v_max_f32 v130, v130, v175
v_max_f32 v182, v216, v217
v_max_f32 v183, v218, v219
v_max_f32 v180, v184, v185
v_max_f32 v181, v186, v187
v_max3_f32 v131, v180, v181, v182
v_max_f32 v131, v131, v183
v_max_f32 v158, v192, v193
v_max_f32 v159, v194, v195
v_max_f32 v156, v160, v161
v_max_f32 v157, v162, v163
v_max3_f32 v128, v156, v157, v158
v_max_f32 v128, v128, v159
s_nop 1
v_permlane32_swap_b32 v128, v129
v_permlane32_swap_b32 v130, v131
v_max_f32 v128, v128, v129
v_max_f32 v130, v130, v131
s_nop 1
v_permlane16_swap_b32 v128, v130
s_nop 0
v_max_f32 v128, v128, v130
v_mov_b32 v130, v128
s_nop 1
v_permlane16_swap_b32 v128, v130
s_nop 0
v_mov_b32 v129, v128
v_mov_b32 v131, v130
s_nop 0
v_permlane32_swap_b32 v128, v129
v_permlane32_swap_b32 v130, v131
v_pk_mul_f32 v[128:129], v[128:129], v[124:125]
v_pk_mul_f32 v[130:131], v[130:131], v[126:127]
v_pk_fma_f32 v[156:157], v[156:157], v[124:125], v[128:129] op_sel:[0,0,0] op_sel_hi:[1,0,0] neg_lo:[0,0,1] neg_hi:[0,0,1]
v_pk_fma_f32 v[158:159], v[158:159], v[124:125], v[128:129] op_sel:[0,0,0] op_sel_hi:[1,0,0] neg_lo:[0,0,1] neg_hi:[0,0,1]
v_exp_f32 v156, v156
v_exp_f32 v157, v157
v_exp_f32 v158, v158
v_exp_f32 v159, v159
v_cvt_pk_bf16_f32 v156, v156, v156
v_cvt_pk_bf16_f32 v157, v157, v157
v_cvt_pk_bf16_f32 v158, v158, v158
v_cvt_pk_bf16_f32 v159, v159, v159
v_and_b32 v156, v52, v156
v_and_b32 v157, v52, v157
v_and_b32 v158, v52, v158
v_and_b32 v159, v52, v159
v_pk_fma_f32 v[164:165], v[164:165], v[124:125], v[128:129] op_sel:[0,1,1] op_sel_hi:[1,1,1] neg_lo:[0,0,1] neg_hi:[0,0,1]
v_pk_fma_f32 v[166:167], v[166:167], v[124:125], v[128:129] op_sel:[0,1,1] op_sel_hi:[1,1,1] neg_lo:[0,0,1] neg_hi:[0,0,1]
v_exp_f32 v164, v164
v_mfma_f32_16x16x32_bf16 v[160:163], v[48:51], v[156:159], 0
v_exp_f32 v165, v165
v_exp_f32 v166, v166
v_exp_f32 v167, v167
v_cvt_pk_bf16_f32 v164, v164, v164
v_mfma_f32_16x16x32_bf16 v[220:223], v[100:103], v[156:159], 0
v_cvt_pk_bf16_f32 v165, v165, v165
v_cvt_pk_bf16_f32 v166, v166, v166
v_cvt_pk_bf16_f32 v167, v167, v167
v_and_b32 v164, v52, v164
v_mfma_f32_16x16x32_bf16 v[224:227], v[110:113], v[156:159], 0
v_and_b32 v165, v52, v165
v_and_b32 v166, v52, v166
v_and_b32 v167, v52, v167
v_pk_fma_f32 v[172:173], v[172:173], v[126:127], v[130:131] op_sel:[0,0,0] op_sel_hi:[1,0,0] neg_lo:[0,0,1] neg_hi:[0,0,1]
v_pk_fma_f32 v[174:175], v[174:175], v[126:127], v[130:131] op_sel:[0,0,0] op_sel_hi:[1,0,0] neg_lo:[0,0,1] neg_hi:[0,0,1]
v_exp_f32 v172, v172
v_mfma_f32_16x16x32_bf16 v[168:171], v[48:51], v[164:167], 0
v_exp_f32 v173, v173
v_exp_f32 v174, v174
v_exp_f32 v175, v175
v_cvt_pk_bf16_f32 v172, v172, v172
v_mfma_f32_16x16x32_bf16 v[228:231], v[102:105], v[164:167], 0
v_cvt_pk_bf16_f32 v173, v173, v173
v_cvt_pk_bf16_f32 v174, v174, v174
v_cvt_pk_bf16_f32 v175, v175, v175
v_and_b32 v172, v52, v172
v_mfma_f32_16x16x32_bf16 v[232:235], v[112:115], v[164:167], 0
v_and_b32 v173, v52, v173
v_and_b32 v174, v52, v174
v_and_b32 v175, v52, v175
v_pk_fma_f32 v[180:181], v[180:181], v[126:127], v[130:131] op_sel:[0,1,1] op_sel_hi:[1,1,1] neg_lo:[0,0,1] neg_hi:[0,0,1]
v_pk_fma_f32 v[182:183], v[182:183], v[126:127], v[130:131] op_sel:[0,1,1] op_sel_hi:[1,1,1] neg_lo:[0,0,1] neg_hi:[0,0,1]
v_exp_f32 v180, v180
v_mfma_f32_16x16x32_bf16 v[176:179], v[48:51], v[172:175], 0
v_exp_f32 v181, v181
v_exp_f32 v182, v182
v_exp_f32 v183, v183
v_cvt_pk_bf16_f32 v180, v180, v180
v_mfma_f32_16x16x32_bf16 v[236:239], v[104:107], v[172:175], 0
v_cvt_pk_bf16_f32 v181, v181, v181
v_cvt_pk_bf16_f32 v182, v182, v182
v_cvt_pk_bf16_f32 v183, v183, v183
v_and_b32 v180, v52, v180
v_mfma_f32_16x16x32_bf16 v[240:243], v[114:117], v[172:175], 0
v_and_b32 v181, v52, v181
v_and_b32 v182, v52, v182
v_and_b32 v183, v52, v183
v_rcp_f32 v160, v160
v_rcp_f32 v168, v168
v_mfma_f32_16x16x32_bf16 v[184:187], v[48:51], v[180:183], 0
v_mfma_f32_16x16x32_bf16 v[244:247], v[106:109], v[180:183], 0
v_mfma_f32_16x16x32_bf16 v[248:251], v[116:119], v[180:183], 0
v_rcp_f32 v176, v176
s_nop 4
v_rcp_f32 v184, v184
s_cmp_eq_u32 s46, 0
s_cbranch_scc1 slow_51
.p2align 3
v_pk_mul_f32 v[220:221], v[220:221], v[160:161] op_sel:[0,0] op_sel_hi:[1,0]
v_pk_mul_f32 v[222:223], v[222:223], v[160:161] op_sel:[0,0] op_sel_hi:[1,0]
v_pk_mul_f32 v[224:225], v[224:225], v[160:161] op_sel:[0,0] op_sel_hi:[1,0]
v_pk_mul_f32 v[226:227], v[226:227], v[160:161] op_sel:[0,0] op_sel_hi:[1,0]
v_cvt_pk_bf16_f32 v220, v220, v221
v_cvt_pk_bf16_f32 v221, v222, v223
v_cvt_pk_bf16_f32 v222, v224, v225
v_cvt_pk_bf16_f32 v223, v226, v227
buffer_store_dwordx4 v[220:223], v18, s[32:35], s80 offen sc1
v_pk_mul_f32 v[228:229], v[228:229], v[168:169] op_sel:[0,0] op_sel_hi:[1,0]
v_pk_mul_f32 v[230:231], v[230:231], v[168:169] op_sel:[0,0] op_sel_hi:[1,0]
v_pk_mul_f32 v[232:233], v[232:233], v[168:169] op_sel:[0,0] op_sel_hi:[1,0]
v_pk_mul_f32 v[234:235], v[234:235], v[168:169] op_sel:[0,0] op_sel_hi:[1,0]
v_cvt_pk_bf16_f32 v228, v228, v229
v_cvt_pk_bf16_f32 v229, v230, v231
v_cvt_pk_bf16_f32 v230, v232, v233
v_cvt_pk_bf16_f32 v231, v234, v235
buffer_store_dwordx4 v[228:231], v18, s[32:35], s81 offen sc1
v_pk_mul_f32 v[236:237], v[236:237], v[176:177] op_sel:[0,0] op_sel_hi:[1,0]
v_pk_mul_f32 v[238:239], v[238:239], v[176:177] op_sel:[0,0] op_sel_hi:[1,0]
v_pk_mul_f32 v[240:241], v[240:241], v[176:177] op_sel:[0,0] op_sel_hi:[1,0]
v_pk_mul_f32 v[242:243], v[242:243], v[176:177] op_sel:[0,0] op_sel_hi:[1,0]
v_cvt_pk_bf16_f32 v236, v236, v237
v_cvt_pk_bf16_f32 v237, v238, v239
v_cvt_pk_bf16_f32 v238, v240, v241
v_cvt_pk_bf16_f32 v239, v242, v243
buffer_store_dwordx4 v[236:239], v18, s[32:35], s82 offen sc1
v_pk_mul_f32 v[244:245], v[244:245], v[184:185] op_sel:[0,0] op_sel_hi:[1,0]
v_pk_mul_f32 v[246:247], v[246:247], v[184:185] op_sel:[0,0] op_sel_hi:[1,0]
v_pk_mul_f32 v[248:249], v[248:249], v[184:185] op_sel:[0,0] op_sel_hi:[1,0]
v_pk_mul_f32 v[250:251], v[250:251], v[184:185] op_sel:[0,0] op_sel_hi:[1,0]
v_cvt_pk_bf16_f32 v244, v244, v245
v_cvt_pk_bf16_f32 v245, v246, v247
v_cvt_pk_bf16_f32 v246, v248, v249
v_cvt_pk_bf16_f32 v247, v250, v251
buffer_store_dwordx4 v[244:247], v18, s[32:35], s83 offen sc1
s_barrier
s_lshl_b32 s62, s45, 2
v_mov_b32 v4, s62
v_mov_b32 v5, 1
s_mov_b64 exec, 1
s_waitcnt vmcnt(0)
buffer_store_dword v5, v4, s[32:35], s84 offen
s_mov_b64 exec, -1
back_52:
v_and_b32 v36, 31, v0
v_lshlrev_b32 v36, 2, v36
buffer_load_dword v37, v36, s[32:35], s84 offen sc1
v_lshrrev_b32 v4, 2, v2
v_and_b32 v5, 3, v0
v_lshl_add_u32 v6, v3, 3, v4
v_lshlrev_b32 v6, 7, v6
v_lshl_add_u32 v6, v5, 3, v6
v_lshrrev_b32 v7, 1, v4
v_and_b32 v8, 1, v3
v_lshl_add_u32 v7, v8, 1, v7
v_lshl_add_u32 v10, v7, 5, v6
v_xor_b32 v11, 32, v10
v_xor_b32 v12, 64, v10
v_xor_b32 v13, 96, v10
v_add_u32 v14, 0x10000, v10
v_add_u32 v15, 0x10000, v11
v_add_u32 v16, 0x10000, v12
v_add_u32 v17, 0x10000, v13
ds_read_b64_tr_b16 v[220:221], v10 offset:0
ds_read_b64_tr_b16 v[222:223], v10 offset:512
ds_read_b64_tr_b16 v[224:225], v11 offset:0
ds_read_b64_tr_b16 v[226:227], v11 offset:512
ds_read_b64_tr_b16 v[228:229], v12 offset:0
ds_read_b64_tr_b16 v[230:231], v12 offset:512
ds_read_b64_tr_b16 v[232:233], v13 offset:0
ds_read_b64_tr_b16 v[234:235], v13 offset:512
ds_read_b64_tr_b16 v[236:237], v10 offset:4096
ds_read_b64_tr_b16 v[238:239], v10 offset:4608
ds_read_b64_tr_b16 v[240:241], v11 offset:4096
ds_read_b64_tr_b16 v[242:243], v11 offset:4608
ds_read_b64_tr_b16 v[244:245], v12 offset:4096
ds_read_b64_tr_b16 v[246:247], v12 offset:4608
ds_read_b64_tr_b16 v[248:249], v13 offset:4096
ds_read_b64_tr_b16 v[250:251], v13 offset:4608
s_lshl_b32 s48, s41, 3
s_lshl_b32 s49, s40, 1
s_add_u32 s48, s48, s49
s_lshl_b32 s48, s48, 15
s_add_u32 s48, s48, 4194304
v_add_u32 v38, s48, v18
v_add_u32 v39, 32768, v38
s_lshl_b32 s57, s75, 11
s_add_u32 s87, s87, 262144
v_lshlrev_b32 v60, 16, v20
v_and_b32 v61, 0xffff0000, v20
v_lshlrev_b32 v62, 16, v21
v_and_b32 v63, 0xffff0000, v21
v_lshlrev_b32 v64, 16, v22
v_and_b32 v65, 0xffff0000, v22
v_lshlrev_b32 v66, 16, v23
v_and_b32 v67, 0xffff0000, v23
v_lshlrev_b32 v68, 16, v24
v_and_b32 v69, 0xffff0000, v24
v_lshlrev_b32 v70, 16, v25
v_and_b32 v71, 0xffff0000, v25
v_lshlrev_b32 v72, 16, v26
v_and_b32 v73, 0xffff0000, v26
v_lshlrev_b32 v74, 16, v27
v_and_b32 v75, 0xffff0000, v27
v_lshlrev_b32 v76, 16, v28
v_and_b32 v77, 0xffff0000, v28
v_lshlrev_b32 v78, 16, v29
v_and_b32 v79, 0xffff0000, v29
v_lshlrev_b32 v80, 16, v30
v_and_b32 v81, 0xffff0000, v30
v_lshlrev_b32 v82, 16, v31
v_and_b32 v83, 0xffff0000, v31
v_lshlrev_b32 v84, 16, v32
v_and_b32 v85, 0xffff0000, v32
v_lshlrev_b32 v86, 16, v33
v_and_b32 v87, 0xffff0000, v33
v_lshlrev_b32 v88, 16, v34
v_and_b32 v89, 0xffff0000, v34
v_lshlrev_b32 v90, 16, v35
v_and_b32 v91, 0xffff0000, v35
v_mov_b32 v6, 0
v_mov_b32 v7, 0
v_mov_b32 v8, 0
v_mov_b32 v9, 0
s_lshl_b32 s62, s42, 2
v_mov_b32 v4, s62
v_mov_b32 v5, 1
s_mov_b32 s63, 0
s_waitcnt vmcnt(0)
poll_53:
v_cmp_gt_u32 vcc, 1, v37
s_cbranch_vccz polled_54
buffer_load_dword v37, v36, s[32:35], s84 offen sc1
s_add_u32 s63, s63, 1
s_cmp_lt_u32 s63, 0x80000
s_waitcnt vmcnt(0)
s_cbranch_scc1 poll_53
polled_54:
buffer_load_dwordx4 v[156:159], v38, s[32:35], s57 offen sc1
buffer_load_dwordx4 v[160:163], v39, s[32:35], s57 offen sc1
buffer_load_dwordx4 v[164:167], v38, s[32:35], s57 offen offset:1024 sc1
buffer_load_dwordx4 v[168:171], v39, s[32:35], s57 offen offset:1024 sc1
s_add_u32 s57, s57, 2048
s_and_b32 s57, s57, 0x7fff
buffer_load_dwordx4 v[172:175], v38, s[32:35], s57 offen sc1
buffer_load_dwordx4 v[176:179], v39, s[32:35], s57 offen sc1
buffer_load_dwordx4 v[180:183], v38, s[32:35], s57 offen offset:1024 sc1
buffer_load_dwordx4 v[184:187], v39, s[32:35], s57 offen offset:1024 sc1
s_add_u32 s57, s57, 2048
s_and_b32 s57, s57, 0x7fff
s_waitcnt vmcnt(6) lgkmcnt(8)
v_mfma_f32_16x16x32_bf16 v[60:63], v[220:223], v[156:159], v[60:63]
buffer_load_dwordx4 v[188:191], v38, s[32:35], s57 offen sc1
v_mfma_f32_16x16x32_bf16 v[76:79], v[220:223], v[160:163], v[76:79]
ds_read_b64_tr_b16 v[100:101], v10 offset:8192
ds_read_b64_tr_b16 v[102:103], v10 offset:8704
v_mfma_f32_16x16x32_bf16 v[64:67], v[224:227], v[156:159], v[64:67]
ds_read_b64_tr_b16 v[104:105], v11 offset:8192
ds_read_b64_tr_b16 v[106:107], v11 offset:8704
v_mfma_f32_16x16x32_bf16 v[80:83], v[224:227], v[160:163], v[80:83]
buffer_load_dwordx4 v[192:195], v39, s[32:35], s57 offen sc1
v_mfma_f32_16x16x32_bf16 v[68:71], v[228:231], v[156:159], v[68:71]
ds_read_b64_tr_b16 v[108:109], v12 offset:8192
ds_read_b64_tr_b16 v[110:111], v12 offset:8704
v_mfma_f32_16x16x32_bf16 v[84:87], v[228:231], v[160:163], v[84:87]
ds_read_b64_tr_b16 v[112:113], v13 offset:8192
ds_read_b64_tr_b16 v[114:115], v13 offset:8704
v_mfma_f32_16x16x32_bf16 v[72:75], v[232:235], v[156:159], v[72:75]
v_mfma_f32_16x16x32_bf16 v[88:91], v[232:235], v[160:163], v[88:91]
s_waitcnt vmcnt(6) lgkmcnt(8)
v_mfma_f32_16x16x32_bf16 v[60:63], v[236:239], v[164:167], v[60:63]
buffer_load_dwordx4 v[196:199], v38, s[32:35], s57 offen offset:1024 sc1
v_mfma_f32_16x16x32_bf16 v[76:79], v[236:239], v[168:171], v[76:79]
ds_read_b64_tr_b16 v[220:221], v10 offset:12288
ds_read_b64_tr_b16 v[222:223], v10 offset:12800
v_mfma_f32_16x16x32_bf16 v[64:67], v[240:243], v[164:167], v[64:67]
ds_read_b64_tr_b16 v[224:225], v11 offset:12288
ds_read_b64_tr_b16 v[226:227], v11 offset:12800
v_mfma_f32_16x16x32_bf16 v[80:83], v[240:243], v[168:171], v[80:83]
buffer_load_dwordx4 v[200:203], v39, s[32:35], s57 offen offset:1024 sc1
v_mfma_f32_16x16x32_bf16 v[68:71], v[244:247], v[164:167], v[68:71]
ds_read_b64_tr_b16 v[228:229], v12 offset:12288
ds_read_b64_tr_b16 v[230:231], v12 offset:12800
v_mfma_f32_16x16x32_bf16 v[84:87], v[244:247], v[168:171], v[84:87]
ds_read_b64_tr_b16 v[232:233], v13 offset:12288
ds_read_b64_tr_b16 v[234:235], v13 offset:12800
v_mfma_f32_16x16x32_bf16 v[72:75], v[248:251], v[164:167], v[72:75]
s_add_u32 s57, s57, 2048
s_and_b32 s57, s57, 0x7fff
v_mfma_f32_16x16x32_bf16 v[88:91], v[248:251], v[168:171], v[88:91]
s_waitcnt vmcnt(6) lgkmcnt(8)
v_mfma_f32_16x16x32_bf16 v[60:63], v[100:103], v[172:175], v[60:63]
buffer_load_dwordx4 v[204:207], v38, s[32:35], s57 offen sc1
v_mfma_f32_16x16x32_bf16 v[76:79], v[100:103], v[176:179], v[76:79]
ds_read_b64_tr_b16 v[236:237], v10 offset:16384
ds_read_b64_tr_b16 v[238:239], v10 offset:16896
v_mfma_f32_16x16x32_bf16 v[64:67], v[104:107], v[172:175], v[64:67]
ds_read_b64_tr_b16 v[240:241], v11 offset:16384
ds_read_b64_tr_b16 v[242:243], v11 offset:16896
v_mfma_f32_16x16x32_bf16 v[80:83], v[104:107], v[176:179], v[80:83]
buffer_load_dwordx4 v[208:211], v39, s[32:35], s57 offen sc1
v_mfma_f32_16x16x32_bf16 v[68:71], v[108:111], v[172:175], v[68:71]
ds_read_b64_tr_b16 v[244:245], v12 offset:16384
ds_read_b64_tr_b16 v[246:247], v12 offset:16896
v_mfma_f32_16x16x32_bf16 v[84:87], v[108:111], v[176:179], v[84:87]
ds_read_b64_tr_b16 v[248:249], v13 offset:16384
ds_read_b64_tr_b16 v[250:251], v13 offset:16896
v_mfma_f32_16x16x32_bf16 v[72:75], v[112:115], v[172:175], v[72:75]
v_mfma_f32_16x16x32_bf16 v[88:91], v[112:115], v[176:179], v[88:91]
s_waitcnt vmcnt(6) lgkmcnt(8)
v_mfma_f32_16x16x32_bf16 v[60:63], v[220:223], v[180:183], v[60:63]
buffer_load_dwordx4 v[212:215], v38, s[32:35], s57 offen offset:1024 sc1
v_mfma_f32_16x16x32_bf16 v[76:79], v[220:223], v[184:187], v[76:79]
ds_read_b64_tr_b16 v[100:101], v10 offset:20480
ds_read_b64_tr_b16 v[102:103], v10 offset:20992
v_mfma_f32_16x16x32_bf16 v[64:67], v[224:227], v[180:183], v[64:67]
ds_read_b64_tr_b16 v[104:105], v11 offset:20480
ds_read_b64_tr_b16 v[106:107], v11 offset:20992
v_mfma_f32_16x16x32_bf16 v[80:83], v[224:227], v[184:187], v[80:83]
buffer_load_dwordx4 v[216:219], v39, s[32:35], s57 offen offset:1024 sc1
v_mfma_f32_16x16x32_bf16 v[68:71], v[228:231], v[180:183], v[68:71]
ds_read_b64_tr_b16 v[108:109], v12 offset:20480
ds_read_b64_tr_b16 v[110:111], v12 offset:20992
v_mfma_f32_16x16x32_bf16 v[84:87], v[228:231], v[184:187], v[84:87]
ds_read_b64_tr_b16 v[112:113], v13 offset:20480
ds_read_b64_tr_b16 v[114:115], v13 offset:20992
v_mfma_f32_16x16x32_bf16 v[72:75], v[232:235], v[180:183], v[72:75]
s_add_u32 s57, s57, 2048
s_and_b32 s57, s57, 0x7fff
v_mfma_f32_16x16x32_bf16 v[88:91], v[232:235], v[184:187], v[88:91]
s_waitcnt vmcnt(6) lgkmcnt(8)
v_mfma_f32_16x16x32_bf16 v[60:63], v[236:239], v[188:191], v[60:63]
buffer_load_dwordx4 v[156:159], v38, s[32:35], s57 offen sc1
v_mfma_f32_16x16x32_bf16 v[76:79], v[236:239], v[192:195], v[76:79]
ds_read_b64_tr_b16 v[220:221], v10 offset:24576
ds_read_b64_tr_b16 v[222:223], v10 offset:25088
v_mfma_f32_16x16x32_bf16 v[64:67], v[240:243], v[188:191], v[64:67]
ds_read_b64_tr_b16 v[224:225], v11 offset:24576
ds_read_b64_tr_b16 v[226:227], v11 offset:25088
v_mfma_f32_16x16x32_bf16 v[80:83], v[240:243], v[192:195], v[80:83]
buffer_load_dwordx4 v[160:163], v39, s[32:35], s57 offen sc1
v_mfma_f32_16x16x32_bf16 v[68:71], v[244:247], v[188:191], v[68:71]
ds_read_b64_tr_b16 v[228:229], v12 offset:24576
ds_read_b64_tr_b16 v[230:231], v12 offset:25088
v_mfma_f32_16x16x32_bf16 v[84:87], v[244:247], v[192:195], v[84:87]
ds_read_b64_tr_b16 v[232:233], v13 offset:24576
ds_read_b64_tr_b16 v[234:235], v13 offset:25088
v_mfma_f32_16x16x32_bf16 v[72:75], v[248:251], v[188:191], v[72:75]
v_mfma_f32_16x16x32_bf16 v[88:91], v[248:251], v[192:195], v[88:91]
s_waitcnt vmcnt(6) lgkmcnt(8)
v_mfma_f32_16x16x32_bf16 v[60:63], v[100:103], v[196:199], v[60:63]
buffer_load_dwordx4 v[164:167], v38, s[32:35], s57 offen offset:1024 sc1
v_mfma_f32_16x16x32_bf16 v[76:79], v[100:103], v[200:203], v[76:79]
ds_read_b64_tr_b16 v[236:237], v10 offset:28672
ds_read_b64_tr_b16 v[238:239], v10 offset:29184
v_mfma_f32_16x16x32_bf16 v[64:67], v[104:107], v[196:199], v[64:67]
ds_read_b64_tr_b16 v[240:241], v11 offset:28672
ds_read_b64_tr_b16 v[242:243], v11 offset:29184
v_mfma_f32_16x16x32_bf16 v[80:83], v[104:107], v[200:203], v[80:83]
buffer_load_dwordx4 v[168:171], v39, s[32:35], s57 offen offset:1024 sc1
v_mfma_f32_16x16x32_bf16 v[68:71], v[108:111], v[196:199], v[68:71]
ds_read_b64_tr_b16 v[244:245], v12 offset:28672
ds_read_b64_tr_b16 v[246:247], v12 offset:29184
v_mfma_f32_16x16x32_bf16 v[84:87], v[108:111], v[200:203], v[84:87]
ds_read_b64_tr_b16 v[248:249], v13 offset:28672
ds_read_b64_tr_b16 v[250:251], v13 offset:29184
v_mfma_f32_16x16x32_bf16 v[72:75], v[112:115], v[196:199], v[72:75]
s_add_u32 s57, s57, 2048
s_and_b32 s57, s57, 0x7fff
v_mfma_f32_16x16x32_bf16 v[88:91], v[112:115], v[200:203], v[88:91]
s_waitcnt vmcnt(6) lgkmcnt(8)
v_mfma_f32_16x16x32_bf16 v[60:63], v[220:223], v[204:207], v[60:63]
buffer_load_dwordx4 v[172:175], v38, s[32:35], s57 offen sc1
v_mfma_f32_16x16x32_bf16 v[76:79], v[220:223], v[208:211], v[76:79]
ds_read_b64_tr_b16 v[100:101], v10 offset:32768
ds_read_b64_tr_b16 v[102:103], v10 offset:33280
v_mfma_f32_16x16x32_bf16 v[64:67], v[224:227], v[204:207], v[64:67]
ds_read_b64_tr_b16 v[104:105], v11 offset:32768
ds_read_b64_tr_b16 v[106:107], v11 offset:33280
v_mfma_f32_16x16x32_bf16 v[80:83], v[224:227], v[208:211], v[80:83]
buffer_load_dwordx4 v[176:179], v39, s[32:35], s57 offen sc1
v_mfma_f32_16x16x32_bf16 v[68:71], v[228:231], v[204:207], v[68:71]
ds_read_b64_tr_b16 v[108:109], v12 offset:32768
ds_read_b64_tr_b16 v[110:111], v12 offset:33280
v_mfma_f32_16x16x32_bf16 v[84:87], v[228:231], v[208:211], v[84:87]
ds_read_b64_tr_b16 v[112:113], v13 offset:32768
ds_read_b64_tr_b16 v[114:115], v13 offset:33280
v_mfma_f32_16x16x32_bf16 v[72:75], v[232:235], v[204:207], v[72:75]
v_mfma_f32_16x16x32_bf16 v[88:91], v[232:235], v[208:211], v[88:91]
s_waitcnt vmcnt(6) lgkmcnt(8)
v_mfma_f32_16x16x32_bf16 v[60:63], v[236:239], v[212:215], v[60:63]
buffer_load_dwordx4 v[180:183], v38, s[32:35], s57 offen offset:1024 sc1
v_mfma_f32_16x16x32_bf16 v[76:79], v[236:239], v[216:219], v[76:79]
ds_read_b64_tr_b16 v[220:221], v10 offset:36864
ds_read_b64_tr_b16 v[222:223], v10 offset:37376
v_mfma_f32_16x16x32_bf16 v[64:67], v[240:243], v[212:215], v[64:67]
ds_read_b64_tr_b16 v[224:225], v11 offset:36864
ds_read_b64_tr_b16 v[226:227], v11 offset:37376
v_mfma_f32_16x16x32_bf16 v[80:83], v[240:243], v[216:219], v[80:83]
buffer_load_dwordx4 v[184:187], v39, s[32:35], s57 offen offset:1024 sc1
v_mfma_f32_16x16x32_bf16 v[68:71], v[244:247], v[212:215], v[68:71]
ds_read_b64_tr_b16 v[228:229], v12 offset:36864
ds_read_b64_tr_b16 v[230:231], v12 offset:37376
v_mfma_f32_16x16x32_bf16 v[84:87], v[244:247], v[216:219], v[84:87]
ds_read_b64_tr_b16 v[232:233], v13 offset:36864
ds_read_b64_tr_b16 v[234:235], v13 offset:37376
v_mfma_f32_16x16x32_bf16 v[72:75], v[248:251], v[212:215], v[72:75]
s_add_u32 s57, s57, 2048
s_and_b32 s57, s57, 0x7fff
v_mfma_f32_16x16x32_bf16 v[88:91], v[248:251], v[216:219], v[88:91]
s_waitcnt vmcnt(6) lgkmcnt(8)
v_mfma_f32_16x16x32_bf16 v[60:63], v[100:103], v[156:159], v[60:63]
buffer_load_dwordx4 v[188:191], v38, s[32:35], s57 offen sc1
v_mfma_f32_16x16x32_bf16 v[76:79], v[100:103], v[160:163], v[76:79]
ds_read_b64_tr_b16 v[236:237], v10 offset:40960
ds_read_b64_tr_b16 v[238:239], v10 offset:41472
v_mfma_f32_16x16x32_bf16 v[64:67], v[104:107], v[156:159], v[64:67]
ds_read_b64_tr_b16 v[240:241], v11 offset:40960
ds_read_b64_tr_b16 v[242:243], v11 offset:41472
v_mfma_f32_16x16x32_bf16 v[80:83], v[104:107], v[160:163], v[80:83]
buffer_load_dwordx4 v[192:195], v39, s[32:35], s57 offen sc1
v_mfma_f32_16x16x32_bf16 v[68:71], v[108:111], v[156:159], v[68:71]
ds_read_b64_tr_b16 v[244:245], v12 offset:40960
ds_read_b64_tr_b16 v[246:247], v12 offset:41472
v_mfma_f32_16x16x32_bf16 v[84:87], v[108:111], v[160:163], v[84:87]
ds_read_b64_tr_b16 v[248:249], v13 offset:40960
ds_read_b64_tr_b16 v[250:251], v13 offset:41472
v_mfma_f32_16x16x32_bf16 v[72:75], v[112:115], v[156:159], v[72:75]
v_mfma_f32_16x16x32_bf16 v[88:91], v[112:115], v[160:163], v[88:91]
s_waitcnt vmcnt(6) lgkmcnt(8)
v_mfma_f32_16x16x32_bf16 v[60:63], v[220:223], v[164:167], v[60:63]
buffer_load_dwordx4 v[196:199], v38, s[32:35], s57 offen offset:1024 sc1
v_mfma_f32_16x16x32_bf16 v[76:79], v[220:223], v[168:171], v[76:79]
ds_read_b64_tr_b16 v[100:101], v10 offset:45056
ds_read_b64_tr_b16 v[102:103], v10 offset:45568
v_mfma_f32_16x16x32_bf16 v[64:67], v[224:227], v[164:167], v[64:67]
ds_read_b64_tr_b16 v[104:105], v11 offset:45056
ds_read_b64_tr_b16 v[106:107], v11 offset:45568
v_mfma_f32_16x16x32_bf16 v[80:83], v[224:227], v[168:171], v[80:83]
buffer_load_dwordx4 v[200:203], v39, s[32:35], s57 offen offset:1024 sc1
v_mfma_f32_16x16x32_bf16 v[68:71], v[228:231], v[164:167], v[68:71]
ds_read_b64_tr_b16 v[108:109], v12 offset:45056
ds_read_b64_tr_b16 v[110:111], v12 offset:45568
v_mfma_f32_16x16x32_bf16 v[84:87], v[228:231], v[168:171], v[84:87]
ds_read_b64_tr_b16 v[112:113], v13 offset:45056
ds_read_b64_tr_b16 v[114:115], v13 offset:45568
v_mfma_f32_16x16x32_bf16 v[72:75], v[232:235], v[164:167], v[72:75]
s_add_u32 s57, s57, 2048
s_and_b32 s57, s57, 0x7fff
v_mfma_f32_16x16x32_bf16 v[88:91], v[232:235], v[168:171], v[88:91]
s_waitcnt vmcnt(6) lgkmcnt(8)
v_mfma_f32_16x16x32_bf16 v[60:63], v[236:239], v[172:175], v[60:63]
buffer_load_dwordx4 v[204:207], v38, s[32:35], s57 offen sc1
v_mfma_f32_16x16x32_bf16 v[76:79], v[236:239], v[176:179], v[76:79]
ds_read_b64_tr_b16 v[220:221], v10 offset:49152
ds_read_b64_tr_b16 v[222:223], v10 offset:49664
v_mfma_f32_16x16x32_bf16 v[64:67], v[240:243], v[172:175], v[64:67]
ds_read_b64_tr_b16 v[224:225], v11 offset:49152
ds_read_b64_tr_b16 v[226:227], v11 offset:49664
v_mfma_f32_16x16x32_bf16 v[80:83], v[240:243], v[176:179], v[80:83]
buffer_load_dwordx4 v[208:211], v39, s[32:35], s57 offen sc1
v_mfma_f32_16x16x32_bf16 v[68:71], v[244:247], v[172:175], v[68:71]
ds_read_b64_tr_b16 v[228:229], v12 offset:49152
ds_read_b64_tr_b16 v[230:231], v12 offset:49664
v_mfma_f32_16x16x32_bf16 v[84:87], v[244:247], v[176:179], v[84:87]
ds_read_b64_tr_b16 v[232:233], v13 offset:49152
ds_read_b64_tr_b16 v[234:235], v13 offset:49664
v_mfma_f32_16x16x32_bf16 v[72:75], v[248:251], v[172:175], v[72:75]
v_mfma_f32_16x16x32_bf16 v[88:91], v[248:251], v[176:179], v[88:91]
s_waitcnt vmcnt(6) lgkmcnt(8)
v_mfma_f32_16x16x32_bf16 v[60:63], v[100:103], v[180:183], v[60:63]
buffer_load_dwordx4 v[212:215], v38, s[32:35], s57 offen offset:1024 sc1
v_mfma_f32_16x16x32_bf16 v[76:79], v[100:103], v[184:187], v[76:79]
ds_read_b64_tr_b16 v[236:237], v10 offset:53248
ds_read_b64_tr_b16 v[238:239], v10 offset:53760
v_mfma_f32_16x16x32_bf16 v[64:67], v[104:107], v[180:183], v[64:67]
ds_read_b64_tr_b16 v[240:241], v11 offset:53248
ds_read_b64_tr_b16 v[242:243], v11 offset:53760
v_mfma_f32_16x16x32_bf16 v[80:83], v[104:107], v[184:187], v[80:83]
buffer_load_dwordx4 v[216:219], v39, s[32:35], s57 offen offset:1024 sc1
v_mfma_f32_16x16x32_bf16 v[68:71], v[108:111], v[180:183], v[68:71]
ds_read_b64_tr_b16 v[244:245], v12 offset:53248
ds_read_b64_tr_b16 v[246:247], v12 offset:53760
v_mfma_f32_16x16x32_bf16 v[84:87], v[108:111], v[184:187], v[84:87]
ds_read_b64_tr_b16 v[248:249], v13 offset:53248
ds_read_b64_tr_b16 v[250:251], v13 offset:53760
v_mfma_f32_16x16x32_bf16 v[72:75], v[112:115], v[180:183], v[72:75]
s_add_u32 s57, s57, 2048
s_and_b32 s57, s57, 0x7fff
v_mfma_f32_16x16x32_bf16 v[88:91], v[112:115], v[184:187], v[88:91]
s_waitcnt vmcnt(6) lgkmcnt(8)
v_mfma_f32_16x16x32_bf16 v[60:63], v[220:223], v[188:191], v[60:63]
buffer_load_dwordx4 v[156:159], v38, s[32:35], s57 offen sc1
v_mfma_f32_16x16x32_bf16 v[76:79], v[220:223], v[192:195], v[76:79]
ds_read_b64_tr_b16 v[100:101], v10 offset:57344
ds_read_b64_tr_b16 v[102:103], v10 offset:57856
v_mfma_f32_16x16x32_bf16 v[64:67], v[224:227], v[188:191], v[64:67]
ds_read_b64_tr_b16 v[104:105], v11 offset:57344
ds_read_b64_tr_b16 v[106:107], v11 offset:57856
v_mfma_f32_16x16x32_bf16 v[80:83], v[224:227], v[192:195], v[80:83]
buffer_load_dwordx4 v[160:163], v39, s[32:35], s57 offen sc1
v_mfma_f32_16x16x32_bf16 v[68:71], v[228:231], v[188:191], v[68:71]
ds_read_b64_tr_b16 v[108:109], v12 offset:57344
ds_read_b64_tr_b16 v[110:111], v12 offset:57856
v_mfma_f32_16x16x32_bf16 v[84:87], v[228:231], v[192:195], v[84:87]
ds_read_b64_tr_b16 v[112:113], v13 offset:57344
ds_read_b64_tr_b16 v[114:115], v13 offset:57856
v_mfma_f32_16x16x32_bf16 v[72:75], v[232:235], v[188:191], v[72:75]
v_mfma_f32_16x16x32_bf16 v[88:91], v[232:235], v[192:195], v[88:91]
s_waitcnt vmcnt(6) lgkmcnt(8)
v_mfma_f32_16x16x32_bf16 v[60:63], v[236:239], v[196:199], v[60:63]
buffer_load_dwordx4 v[164:167], v38, s[32:35], s57 offen offset:1024 sc1
v_mfma_f32_16x16x32_bf16 v[76:79], v[236:239], v[200:203], v[76:79]
ds_read_b64_tr_b16 v[220:221], v10 offset:61440
ds_read_b64_tr_b16 v[222:223], v10 offset:61952
v_mfma_f32_16x16x32_bf16 v[64:67], v[240:243], v[196:199], v[64:67]
ds_read_b64_tr_b16 v[224:225], v11 offset:61440
ds_read_b64_tr_b16 v[226:227], v11 offset:61952
v_mfma_f32_16x16x32_bf16 v[80:83], v[240:243], v[200:203], v[80:83]
buffer_load_dwordx4 v[168:171], v39, s[32:35], s57 offen offset:1024 sc1
v_mfma_f32_16x16x32_bf16 v[68:71], v[244:247], v[196:199], v[68:71]
ds_read_b64_tr_b16 v[228:229], v12 offset:61440
ds_read_b64_tr_b16 v[230:231], v12 offset:61952
v_mfma_f32_16x16x32_bf16 v[84:87], v[244:247], v[200:203], v[84:87]
ds_read_b64_tr_b16 v[232:233], v13 offset:61440
ds_read_b64_tr_b16 v[234:235], v13 offset:61952
v_mfma_f32_16x16x32_bf16 v[72:75], v[248:251], v[196:199], v[72:75]
s_add_u32 s57, s57, 2048
s_and_b32 s57, s57, 0x7fff
v_mfma_f32_16x16x32_bf16 v[88:91], v[248:251], v[200:203], v[88:91]
s_waitcnt vmcnt(6) lgkmcnt(8)
v_mfma_f32_16x16x32_bf16 v[60:63], v[100:103], v[204:207], v[60:63]
buffer_load_dwordx4 v[172:175], v38, s[32:35], s57 offen sc1
v_mfma_f32_16x16x32_bf16 v[76:79], v[100:103], v[208:211], v[76:79]
ds_read_b64_tr_b16 v[236:237], v14 offset:0
ds_read_b64_tr_b16 v[238:239], v14 offset:512
v_mfma_f32_16x16x32_bf16 v[64:67], v[104:107], v[204:207], v[64:67]
ds_read_b64_tr_b16 v[240:241], v15 offset:0
ds_read_b64_tr_b16 v[242:243], v15 offset:512
v_mfma_f32_16x16x32_bf16 v[80:83], v[104:107], v[208:211], v[80:83]
buffer_load_dwordx4 v[176:179], v39, s[32:35], s57 offen sc1
v_mfma_f32_16x16x32_bf16 v[68:71], v[108:111], v[204:207], v[68:71]
ds_read_b64_tr_b16 v[244:245], v16 offset:0
ds_read_b64_tr_b16 v[246:247], v16 offset:512
v_mfma_f32_16x16x32_bf16 v[84:87], v[108:111], v[208:211], v[84:87]
ds_read_b64_tr_b16 v[248:249], v17 offset:0
ds_read_b64_tr_b16 v[250:251], v17 offset:512
v_mfma_f32_16x16x32_bf16 v[72:75], v[112:115], v[204:207], v[72:75]
v_mfma_f32_16x16x32_bf16 v[88:91], v[112:115], v[208:211], v[88:91]
s_waitcnt vmcnt(6) lgkmcnt(8)
v_mfma_f32_16x16x32_bf16 v[60:63], v[220:223], v[212:215], v[60:63]
buffer_load_dwordx4 v[180:183], v38, s[32:35], s57 offen offset:1024 sc1
v_mfma_f32_16x16x32_bf16 v[76:79], v[220:223], v[216:219], v[76:79]
ds_read_b64_tr_b16 v[100:101], v14 offset:4096
ds_read_b64_tr_b16 v[102:103], v14 offset:4608
v_mfma_f32_16x16x32_bf16 v[64:67], v[224:227], v[212:215], v[64:67]
ds_read_b64_tr_b16 v[104:105], v15 offset:4096
ds_read_b64_tr_b16 v[106:107], v15 offset:4608
v_mfma_f32_16x16x32_bf16 v[80:83], v[224:227], v[216:219], v[80:83]
buffer_load_dwordx4 v[184:187], v39, s[32:35], s57 offen offset:1024 sc1
v_mfma_f32_16x16x32_bf16 v[68:71], v[228:231], v[212:215], v[68:71]
ds_read_b64_tr_b16 v[108:109], v16 offset:4096
ds_read_b64_tr_b16 v[110:111], v16 offset:4608
v_mfma_f32_16x16x32_bf16 v[84:87], v[228:231], v[216:219], v[84:87]
ds_read_b64_tr_b16 v[112:113], v17 offset:4096
ds_read_b64_tr_b16 v[114:115], v17 offset:4608
v_mfma_f32_16x16x32_bf16 v[72:75], v[232:235], v[212:215], v[72:75]
s_add_u32 s57, s57, 2048
s_and_b32 s57, s57, 0x7fff
v_mfma_f32_16x16x32_bf16 v[88:91], v[232:235], v[216:219], v[88:91]
s_waitcnt vmcnt(6) lgkmcnt(8)
v_mfma_f32_16x16x32_bf16 v[60:63], v[236:239], v[156:159], v[60:63]
buffer_load_dwordx4 v[188:191], v38, s[32:35], s57 offen sc1
v_mfma_f32_16x16x32_bf16 v[76:79], v[236:239], v[160:163], v[76:79]
ds_read_b64_tr_b16 v[220:221], v14 offset:8192
ds_read_b64_tr_b16 v[222:223], v14 offset:8704
v_mfma_f32_16x16x32_bf16 v[64:67], v[240:243], v[156:159], v[64:67]
ds_read_b64_tr_b16 v[224:225], v15 offset:8192
ds_read_b64_tr_b16 v[226:227], v15 offset:8704
v_mfma_f32_16x16x32_bf16 v[80:83], v[240:243], v[160:163], v[80:83]
buffer_load_dwordx4 v[192:195], v39, s[32:35], s57 offen sc1
v_mfma_f32_16x16x32_bf16 v[68:71], v[244:247], v[156:159], v[68:71]
ds_read_b64_tr_b16 v[228:229], v16 offset:8192
ds_read_b64_tr_b16 v[230:231], v16 offset:8704
v_mfma_f32_16x16x32_bf16 v[84:87], v[244:247], v[160:163], v[84:87]
ds_read_b64_tr_b16 v[232:233], v17 offset:8192
ds_read_b64_tr_b16 v[234:235], v17 offset:8704
v_mfma_f32_16x16x32_bf16 v[72:75], v[248:251], v[156:159], v[72:75]
v_mfma_f32_16x16x32_bf16 v[88:91], v[248:251], v[160:163], v[88:91]
s_waitcnt vmcnt(6) lgkmcnt(8)
v_mfma_f32_16x16x32_bf16 v[60:63], v[100:103], v[164:167], v[60:63]
buffer_load_dwordx4 v[196:199], v38, s[32:35], s57 offen offset:1024 sc1
v_mfma_f32_16x16x32_bf16 v[76:79], v[100:103], v[168:171], v[76:79]
ds_read_b64_tr_b16 v[236:237], v14 offset:12288
ds_read_b64_tr_b16 v[238:239], v14 offset:12800
v_mfma_f32_16x16x32_bf16 v[64:67], v[104:107], v[164:167], v[64:67]
ds_read_b64_tr_b16 v[240:241], v15 offset:12288
ds_read_b64_tr_b16 v[242:243], v15 offset:12800
v_mfma_f32_16x16x32_bf16 v[80:83], v[104:107], v[168:171], v[80:83]
buffer_load_dwordx4 v[200:203], v39, s[32:35], s57 offen offset:1024 sc1
v_mfma_f32_16x16x32_bf16 v[68:71], v[108:111], v[164:167], v[68:71]
ds_read_b64_tr_b16 v[244:245], v16 offset:12288
ds_read_b64_tr_b16 v[246:247], v16 offset:12800
v_mfma_f32_16x16x32_bf16 v[84:87], v[108:111], v[168:171], v[84:87]
ds_read_b64_tr_b16 v[248:249], v17 offset:12288
ds_read_b64_tr_b16 v[250:251], v17 offset:12800
v_mfma_f32_16x16x32_bf16 v[72:75], v[112:115], v[164:167], v[72:75]
s_add_u32 s57, s57, 2048
s_and_b32 s57, s57, 0x7fff
v_mfma_f32_16x16x32_bf16 v[88:91], v[112:115], v[168:171], v[88:91]
s_waitcnt vmcnt(6) lgkmcnt(8)
v_mfma_f32_16x16x32_bf16 v[60:63], v[220:223], v[172:175], v[60:63]
buffer_load_dwordx4 v[204:207], v38, s[32:35], s57 offen sc1
v_mfma_f32_16x16x32_bf16 v[76:79], v[220:223], v[176:179], v[76:79]
ds_read_b64_tr_b16 v[100:101], v14 offset:16384
ds_read_b64_tr_b16 v[102:103], v14 offset:16896
v_mfma_f32_16x16x32_bf16 v[64:67], v[224:227], v[172:175], v[64:67]
ds_read_b64_tr_b16 v[104:105], v15 offset:16384
ds_read_b64_tr_b16 v[106:107], v15 offset:16896
v_mfma_f32_16x16x32_bf16 v[80:83], v[224:227], v[176:179], v[80:83]
buffer_load_dwordx4 v[208:211], v39, s[32:35], s57 offen sc1
v_mfma_f32_16x16x32_bf16 v[68:71], v[228:231], v[172:175], v[68:71]
ds_read_b64_tr_b16 v[108:109], v16 offset:16384
ds_read_b64_tr_b16 v[110:111], v16 offset:16896
v_mfma_f32_16x16x32_bf16 v[84:87], v[228:231], v[176:179], v[84:87]
ds_read_b64_tr_b16 v[112:113], v17 offset:16384
ds_read_b64_tr_b16 v[114:115], v17 offset:16896
v_mfma_f32_16x16x32_bf16 v[72:75], v[232:235], v[172:175], v[72:75]
v_mfma_f32_16x16x32_bf16 v[88:91], v[232:235], v[176:179], v[88:91]
s_waitcnt vmcnt(6) lgkmcnt(8)
v_mfma_f32_16x16x32_bf16 v[60:63], v[236:239], v[180:183], v[60:63]
buffer_load_dwordx4 v[212:215], v38, s[32:35], s57 offen offset:1024 sc1
v_mfma_f32_16x16x32_bf16 v[76:79], v[236:239], v[184:187], v[76:79]
ds_read_b64_tr_b16 v[220:221], v14 offset:20480
ds_read_b64_tr_b16 v[222:223], v14 offset:20992
v_mfma_f32_16x16x32_bf16 v[64:67], v[240:243], v[180:183], v[64:67]
ds_read_b64_tr_b16 v[224:225], v15 offset:20480
ds_read_b64_tr_b16 v[226:227], v15 offset:20992
v_mfma_f32_16x16x32_bf16 v[80:83], v[240:243], v[184:187], v[80:83]
buffer_load_dwordx4 v[216:219], v39, s[32:35], s57 offen offset:1024 sc1
v_mfma_f32_16x16x32_bf16 v[68:71], v[244:247], v[180:183], v[68:71]
ds_read_b64_tr_b16 v[228:229], v16 offset:20480
ds_read_b64_tr_b16 v[230:231], v16 offset:20992
v_mfma_f32_16x16x32_bf16 v[84:87], v[244:247], v[184:187], v[84:87]
ds_read_b64_tr_b16 v[232:233], v17 offset:20480
ds_read_b64_tr_b16 v[234:235], v17 offset:20992
v_mfma_f32_16x16x32_bf16 v[72:75], v[248:251], v[180:183], v[72:75]
s_add_u32 s57, s57, 2048
s_and_b32 s57, s57, 0x7fff
v_mfma_f32_16x16x32_bf16 v[88:91], v[248:251], v[184:187], v[88:91]
s_waitcnt vmcnt(6) lgkmcnt(8)
v_mfma_f32_16x16x32_bf16 v[60:63], v[100:103], v[188:191], v[60:63]
buffer_load_dwordx4 v[156:159], v38, s[32:35], s57 offen sc1
v_mfma_f32_16x16x32_bf16 v[76:79], v[100:103], v[192:195], v[76:79]
ds_read_b64_tr_b16 v[236:237], v14 offset:24576
ds_read_b64_tr_b16 v[238:239], v14 offset:25088
v_mfma_f32_16x16x32_bf16 v[64:67], v[104:107], v[188:191], v[64:67]
ds_read_b64_tr_b16 v[240:241], v15 offset:24576
ds_read_b64_tr_b16 v[242:243], v15 offset:25088
v_mfma_f32_16x16x32_bf16 v[80:83], v[104:107], v[192:195], v[80:83]
buffer_load_dwordx4 v[160:163], v39, s[32:35], s57 offen sc1
v_mfma_f32_16x16x32_bf16 v[68:71], v[108:111], v[188:191], v[68:71]
ds_read_b64_tr_b16 v[244:245], v16 offset:24576
ds_read_b64_tr_b16 v[246:247], v16 offset:25088
v_mfma_f32_16x16x32_bf16 v[84:87], v[108:111], v[192:195], v[84:87]
ds_read_b64_tr_b16 v[248:249], v17 offset:24576
ds_read_b64_tr_b16 v[250:251], v17 offset:25088
v_mfma_f32_16x16x32_bf16 v[72:75], v[112:115], v[188:191], v[72:75]
v_mfma_f32_16x16x32_bf16 v[88:91], v[112:115], v[192:195], v[88:91]
s_waitcnt vmcnt(6) lgkmcnt(8)
v_mfma_f32_16x16x32_bf16 v[60:63], v[220:223], v[196:199], v[60:63]
buffer_load_dwordx4 v[164:167], v38, s[32:35], s57 offen offset:1024 sc1
v_mfma_f32_16x16x32_bf16 v[76:79], v[220:223], v[200:203], v[76:79]
ds_read_b64_tr_b16 v[100:101], v14 offset:28672
ds_read_b64_tr_b16 v[102:103], v14 offset:29184
v_mfma_f32_16x16x32_bf16 v[64:67], v[224:227], v[196:199], v[64:67]
ds_read_b64_tr_b16 v[104:105], v15 offset:28672
ds_read_b64_tr_b16 v[106:107], v15 offset:29184
v_mfma_f32_16x16x32_bf16 v[80:83], v[224:227], v[200:203], v[80:83]
buffer_load_dwordx4 v[168:171], v39, s[32:35], s57 offen offset:1024 sc1
v_mfma_f32_16x16x32_bf16 v[68:71], v[228:231], v[196:199], v[68:71]
ds_read_b64_tr_b16 v[108:109], v16 offset:28672
ds_read_b64_tr_b16 v[110:111], v16 offset:29184
v_mfma_f32_16x16x32_bf16 v[84:87], v[228:231], v[200:203], v[84:87]
ds_read_b64_tr_b16 v[112:113], v17 offset:28672
ds_read_b64_tr_b16 v[114:115], v17 offset:29184
v_mfma_f32_16x16x32_bf16 v[72:75], v[232:235], v[196:199], v[72:75]
s_add_u32 s57, s57, 2048
s_and_b32 s57, s57, 0x7fff
v_mfma_f32_16x16x32_bf16 v[88:91], v[232:235], v[200:203], v[88:91]
s_waitcnt vmcnt(6) lgkmcnt(8)
v_mfma_f32_16x16x32_bf16 v[60:63], v[236:239], v[204:207], v[60:63]
buffer_load_dwordx4 v[172:175], v38, s[32:35], s57 offen sc1
v_mfma_f32_16x16x32_bf16 v[76:79], v[236:239], v[208:211], v[76:79]
ds_read_b64_tr_b16 v[220:221], v14 offset:32768
ds_read_b64_tr_b16 v[222:223], v14 offset:33280
v_mfma_f32_16x16x32_bf16 v[64:67], v[240:243], v[204:207], v[64:67]
ds_read_b64_tr_b16 v[224:225], v15 offset:32768
ds_read_b64_tr_b16 v[226:227], v15 offset:33280
v_mfma_f32_16x16x32_bf16 v[80:83], v[240:243], v[208:211], v[80:83]
buffer_load_dwordx4 v[176:179], v39, s[32:35], s57 offen sc1
v_mfma_f32_16x16x32_bf16 v[68:71], v[244:247], v[204:207], v[68:71]
ds_read_b64_tr_b16 v[228:229], v16 offset:32768
ds_read_b64_tr_b16 v[230:231], v16 offset:33280
v_mfma_f32_16x16x32_bf16 v[84:87], v[244:247], v[208:211], v[84:87]
ds_read_b64_tr_b16 v[232:233], v17 offset:32768
ds_read_b64_tr_b16 v[234:235], v17 offset:33280
v_mfma_f32_16x16x32_bf16 v[72:75], v[248:251], v[204:207], v[72:75]
v_mfma_f32_16x16x32_bf16 v[88:91], v[248:251], v[208:211], v[88:91]
s_waitcnt vmcnt(6) lgkmcnt(8)
v_mfma_f32_16x16x32_bf16 v[60:63], v[100:103], v[212:215], v[60:63]
buffer_load_dwordx4 v[180:183], v38, s[32:35], s57 offen offset:1024 sc1
v_mfma_f32_16x16x32_bf16 v[76:79], v[100:103], v[216:219], v[76:79]
ds_read_b64_tr_b16 v[236:237], v14 offset:36864
ds_read_b64_tr_b16 v[238:239], v14 offset:37376
v_mfma_f32_16x16x32_bf16 v[64:67], v[104:107], v[212:215], v[64:67]
ds_read_b64_tr_b16 v[240:241], v15 offset:36864
ds_read_b64_tr_b16 v[242:243], v15 offset:37376
v_mfma_f32_16x16x32_bf16 v[80:83], v[104:107], v[216:219], v[80:83]
buffer_load_dwordx4 v[184:187], v39, s[32:35], s57 offen offset:1024 sc1
v_mfma_f32_16x16x32_bf16 v[68:71], v[108:111], v[212:215], v[68:71]
ds_read_b64_tr_b16 v[244:245], v16 offset:36864
ds_read_b64_tr_b16 v[246:247], v16 offset:37376
v_mfma_f32_16x16x32_bf16 v[84:87], v[108:111], v[216:219], v[84:87]
ds_read_b64_tr_b16 v[248:249], v17 offset:36864
ds_read_b64_tr_b16 v[250:251], v17 offset:37376
v_mfma_f32_16x16x32_bf16 v[72:75], v[112:115], v[212:215], v[72:75]
s_add_u32 s57, s57, 2048
s_and_b32 s57, s57, 0x7fff
v_mfma_f32_16x16x32_bf16 v[88:91], v[112:115], v[216:219], v[88:91]
s_waitcnt vmcnt(6) lgkmcnt(8)
v_mfma_f32_16x16x32_bf16 v[60:63], v[220:223], v[156:159], v[60:63]
buffer_load_dwordx4 v[188:191], v38, s[32:35], s57 offen sc1
v_mfma_f32_16x16x32_bf16 v[76:79], v[220:223], v[160:163], v[76:79]
ds_read_b64_tr_b16 v[100:101], v14 offset:40960
ds_read_b64_tr_b16 v[102:103], v14 offset:41472
v_mfma_f32_16x16x32_bf16 v[64:67], v[224:227], v[156:159], v[64:67]
ds_read_b64_tr_b16 v[104:105], v15 offset:40960
ds_read_b64_tr_b16 v[106:107], v15 offset:41472
v_mfma_f32_16x16x32_bf16 v[80:83], v[224:227], v[160:163], v[80:83]
buffer_load_dwordx4 v[192:195], v39, s[32:35], s57 offen sc1
v_mfma_f32_16x16x32_bf16 v[68:71], v[228:231], v[156:159], v[68:71]
ds_read_b64_tr_b16 v[108:109], v16 offset:40960
ds_read_b64_tr_b16 v[110:111], v16 offset:41472
v_mfma_f32_16x16x32_bf16 v[84:87], v[228:231], v[160:163], v[84:87]
ds_read_b64_tr_b16 v[112:113], v17 offset:40960
ds_read_b64_tr_b16 v[114:115], v17 offset:41472
v_mfma_f32_16x16x32_bf16 v[72:75], v[232:235], v[156:159], v[72:75]
v_mfma_f32_16x16x32_bf16 v[88:91], v[232:235], v[160:163], v[88:91]
s_waitcnt vmcnt(6) lgkmcnt(8)
v_mfma_f32_16x16x32_bf16 v[60:63], v[236:239], v[164:167], v[60:63]
buffer_load_dwordx4 v[196:199], v38, s[32:35], s57 offen offset:1024 sc1
v_mfma_f32_16x16x32_bf16 v[76:79], v[236:239], v[168:171], v[76:79]
ds_read_b64_tr_b16 v[220:221], v14 offset:45056
ds_read_b64_tr_b16 v[222:223], v14 offset:45568
v_mfma_f32_16x16x32_bf16 v[64:67], v[240:243], v[164:167], v[64:67]
ds_read_b64_tr_b16 v[224:225], v15 offset:45056
ds_read_b64_tr_b16 v[226:227], v15 offset:45568
v_mfma_f32_16x16x32_bf16 v[80:83], v[240:243], v[168:171], v[80:83]
buffer_load_dwordx4 v[200:203], v39, s[32:35], s57 offen offset:1024 sc1
v_mfma_f32_16x16x32_bf16 v[68:71], v[244:247], v[164:167], v[68:71]
ds_read_b64_tr_b16 v[228:229], v16 offset:45056
ds_read_b64_tr_b16 v[230:231], v16 offset:45568
v_mfma_f32_16x16x32_bf16 v[84:87], v[244:247], v[168:171], v[84:87]
ds_read_b64_tr_b16 v[232:233], v17 offset:45056
ds_read_b64_tr_b16 v[234:235], v17 offset:45568
v_mfma_f32_16x16x32_bf16 v[72:75], v[248:251], v[164:167], v[72:75]
s_add_u32 s57, s57, 2048
s_and_b32 s57, s57, 0x7fff
v_mfma_f32_16x16x32_bf16 v[88:91], v[248:251], v[168:171], v[88:91]
s_waitcnt vmcnt(6) lgkmcnt(8)
v_mfma_f32_16x16x32_bf16 v[60:63], v[100:103], v[172:175], v[60:63]
buffer_load_dwordx4 v[204:207], v38, s[32:35], s57 offen sc1
v_mfma_f32_16x16x32_bf16 v[76:79], v[100:103], v[176:179], v[76:79]
ds_read_b64_tr_b16 v[236:237], v14 offset:49152
ds_read_b64_tr_b16 v[238:239], v14 offset:49664
v_mfma_f32_16x16x32_bf16 v[64:67], v[104:107], v[172:175], v[64:67]
ds_read_b64_tr_b16 v[240:241], v15 offset:49152
ds_read_b64_tr_b16 v[242:243], v15 offset:49664
v_mfma_f32_16x16x32_bf16 v[80:83], v[104:107], v[176:179], v[80:83]
buffer_load_dwordx4 v[208:211], v39, s[32:35], s57 offen sc1
v_mfma_f32_16x16x32_bf16 v[68:71], v[108:111], v[172:175], v[68:71]
ds_read_b64_tr_b16 v[244:245], v16 offset:49152
ds_read_b64_tr_b16 v[246:247], v16 offset:49664
v_mfma_f32_16x16x32_bf16 v[84:87], v[108:111], v[176:179], v[84:87]
ds_read_b64_tr_b16 v[248:249], v17 offset:49152
ds_read_b64_tr_b16 v[250:251], v17 offset:49664
v_mfma_f32_16x16x32_bf16 v[72:75], v[112:115], v[172:175], v[72:75]
v_mfma_f32_16x16x32_bf16 v[88:91], v[112:115], v[176:179], v[88:91]
s_waitcnt vmcnt(6) lgkmcnt(8)
v_mfma_f32_16x16x32_bf16 v[60:63], v[220:223], v[180:183], v[60:63]
buffer_load_dwordx4 v[212:215], v38, s[32:35], s57 offen offset:1024 sc1
v_mfma_f32_16x16x32_bf16 v[76:79], v[220:223], v[184:187], v[76:79]
ds_read_b64_tr_b16 v[100:101], v14 offset:53248
ds_read_b64_tr_b16 v[102:103], v14 offset:53760
v_mfma_f32_16x16x32_bf16 v[64:67], v[224:227], v[180:183], v[64:67]
ds_read_b64_tr_b16 v[104:105], v15 offset:53248
ds_read_b64_tr_b16 v[106:107], v15 offset:53760
v_mfma_f32_16x16x32_bf16 v[80:83], v[224:227], v[184:187], v[80:83]
buffer_load_dwordx4 v[216:219], v39, s[32:35], s57 offen offset:1024 sc1
v_mfma_f32_16x16x32_bf16 v[68:71], v[228:231], v[180:183], v[68:71]
ds_read_b64_tr_b16 v[108:109], v16 offset:53248
ds_read_b64_tr_b16 v[110:111], v16 offset:53760
v_mfma_f32_16x16x32_bf16 v[84:87], v[228:231], v[184:187], v[84:87]
ds_read_b64_tr_b16 v[112:113], v17 offset:53248
ds_read_b64_tr_b16 v[114:115], v17 offset:53760
v_mfma_f32_16x16x32_bf16 v[72:75], v[232:235], v[180:183], v[72:75]
v_mfma_f32_16x16x32_bf16 v[88:91], v[232:235], v[184:187], v[88:91]
s_waitcnt vmcnt(6) lgkmcnt(8)
v_mfma_f32_16x16x32_bf16 v[60:63], v[236:239], v[188:191], v[60:63]
v_mfma_f32_16x16x32_bf16 v[76:79], v[236:239], v[192:195], v[76:79]
ds_read_b64_tr_b16 v[220:221], v14 offset:57344
ds_read_b64_tr_b16 v[222:223], v14 offset:57856
v_mfma_f32_16x16x32_bf16 v[64:67], v[240:243], v[188:191], v[64:67]
ds_read_b64_tr_b16 v[224:225], v15 offset:57344
ds_read_b64_tr_b16 v[226:227], v15 offset:57856
v_mfma_f32_16x16x32_bf16 v[80:83], v[240:243], v[192:195], v[80:83]
v_mfma_f32_16x16x32_bf16 v[68:71], v[244:247], v[188:191], v[68:71]
ds_read_b64_tr_b16 v[228:229], v16 offset:57344
ds_read_b64_tr_b16 v[230:231], v16 offset:57856
v_mfma_f32_16x16x32_bf16 v[84:87], v[244:247], v[192:195], v[84:87]
ds_read_b64_tr_b16 v[232:233], v17 offset:57344
ds_read_b64_tr_b16 v[234:235], v17 offset:57856
v_mfma_f32_16x16x32_bf16 v[72:75], v[248:251], v[188:191], v[72:75]
v_mfma_f32_16x16x32_bf16 v[88:91], v[248:251], v[192:195], v[88:91]
s_waitcnt vmcnt(4) lgkmcnt(8)
v_mfma_f32_16x16x32_bf16 v[60:63], v[100:103], v[196:199], v[60:63]
v_mfma_f32_16x16x32_bf16 v[76:79], v[100:103], v[200:203], v[76:79]
ds_read_b64_tr_b16 v[236:237], v14 offset:61440
ds_read_b64_tr_b16 v[238:239], v14 offset:61952
v_mfma_f32_16x16x32_bf16 v[64:67], v[104:107], v[196:199], v[64:67]
ds_read_b64_tr_b16 v[240:241], v15 offset:61440
ds_read_b64_tr_b16 v[242:243], v15 offset:61952
v_mfma_f32_16x16x32_bf16 v[80:83], v[104:107], v[200:203], v[80:83]
v_mfma_f32_16x16x32_bf16 v[68:71], v[108:111], v[196:199], v[68:71]
ds_read_b64_tr_b16 v[244:245], v16 offset:61440
ds_read_b64_tr_b16 v[246:247], v16 offset:61952
v_mfma_f32_16x16x32_bf16 v[84:87], v[108:111], v[200:203], v[84:87]
ds_read_b64_tr_b16 v[248:249], v17 offset:61440
ds_read_b64_tr_b16 v[250:251], v17 offset:61952
v_mfma_f32_16x16x32_bf16 v[72:75], v[112:115], v[196:199], v[72:75]
v_mfma_f32_16x16x32_bf16 v[88:91], v[112:115], v[200:203], v[88:91]
s_waitcnt vmcnt(2) lgkmcnt(8)
v_mfma_f32_16x16x32_bf16 v[60:63], v[220:223], v[204:207], v[60:63]
v_mfma_f32_16x16x32_bf16 v[76:79], v[220:223], v[208:211], v[76:79]
v_mfma_f32_16x16x32_bf16 v[64:67], v[224:227], v[204:207], v[64:67]
v_mfma_f32_16x16x32_bf16 v[80:83], v[224:227], v[208:211], v[80:83]
v_mfma_f32_16x16x32_bf16 v[68:71], v[228:231], v[204:207], v[68:71]
v_mfma_f32_16x16x32_bf16 v[84:87], v[228:231], v[208:211], v[84:87]
v_mfma_f32_16x16x32_bf16 v[72:75], v[232:235], v[204:207], v[72:75]
v_mfma_f32_16x16x32_bf16 v[88:91], v[232:235], v[208:211], v[88:91]
s_waitcnt vmcnt(0) lgkmcnt(0)
v_mfma_f32_16x16x32_bf16 v[60:63], v[236:239], v[212:215], v[60:63]
v_mfma_f32_16x16x32_bf16 v[64:67], v[240:243], v[212:215], v[64:67]
v_mfma_f32_16x16x32_bf16 v[68:71], v[244:247], v[212:215], v[68:71]
v_mfma_f32_16x16x32_bf16 v[72:75], v[248:251], v[212:215], v[72:75]
v_mfma_f32_16x16x32_bf16 v[76:79], v[236:239], v[216:219], v[76:79]
v_mfma_f32_16x16x32_bf16 v[80:83], v[240:243], v[216:219], v[80:83]
v_mfma_f32_16x16x32_bf16 v[84:87], v[244:247], v[216:219], v[84:87]
v_mfma_f32_16x16x32_bf16 v[88:91], v[248:251], v[216:219], v[88:91]
s_cmp_eq_u32 s46, 0
s_cbranch_scc1 slow_55
s_nop 0
v_cvt_pk_bf16_f32 v20, v60, v61
v_cvt_pk_bf16_f32 v21, v62, v63
v_cvt_pk_bf16_f32 v22, v64, v65
v_cvt_pk_bf16_f32 v23, v66, v67
buffer_store_dwordx4 v[20:23], v18, s[32:35], s85 offen offset:0 sc1
v_cvt_pk_bf16_f32 v24, v68, v69
v_cvt_pk_bf16_f32 v25, v70, v71
v_cvt_pk_bf16_f32 v26, v72, v73
v_cvt_pk_bf16_f32 v27, v74, v75
buffer_store_dwordx4 v[24:27], v18, s[32:35], s85 offen offset:1024 sc1
v_cvt_pk_bf16_f32 v28, v76, v77
v_cvt_pk_bf16_f32 v29, v78, v79
v_cvt_pk_bf16_f32 v30, v80, v81
v_cvt_pk_bf16_f32 v31, v82, v83
buffer_store_dwordx4 v[28:31], v18, s[32:35], s86 offen offset:0 sc1
v_cvt_pk_bf16_f32 v32, v84, v85
v_cvt_pk_bf16_f32 v33, v86, v87
v_cvt_pk_bf16_f32 v34, v88, v89
v_cvt_pk_bf16_f32 v35, v90, v91
buffer_store_dwordx4 v[32:35], v18, s[32:35], s86 offen offset:1024 sc1
s_barrier
v_dot2c_f32_bf16 v6, v20, v48
v_dot2c_f32_bf16 v8, v20, v20
v_dot2c_f32_bf16 v7, v28, v48
v_dot2c_f32_bf16 v9, v28, v28
v_dot2c_f32_bf16 v6, v21, v48
v_dot2c_f32_bf16 v8, v21, v21
v_dot2c_f32_bf16 v7, v29, v48
v_dot2c_f32_bf16 v9, v29, v29
v_dot2c_f32_bf16 v6, v22, v48
v_dot2c_f32_bf16 v8, v22, v22
v_dot2c_f32_bf16 v7, v30, v48
v_dot2c_f32_bf16 v9, v30, v30
v_dot2c_f32_bf16 v6, v23, v48
v_dot2c_f32_bf16 v8, v23, v23
v_dot2c_f32_bf16 v7, v31, v48
v_dot2c_f32_bf16 v9, v31, v31
v_dot2c_f32_bf16 v6, v24, v48
v_dot2c_f32_bf16 v8, v24, v24
v_dot2c_f32_bf16 v7, v32, v48
v_dot2c_f32_bf16 v9, v32, v32
v_dot2c_f32_bf16 v6, v25, v48
v_dot2c_f32_bf16 v8, v25, v25
v_dot2c_f32_bf16 v7, v33, v48
v_dot2c_f32_bf16 v9, v33, v33
v_dot2c_f32_bf16 v6, v26, v48
v_dot2c_f32_bf16 v8, v26, v26
v_dot2c_f32_bf16 v7, v34, v48
v_dot2c_f32_bf16 v9, v34, v34
v_dot2c_f32_bf16 v6, v27, v48
v_dot2c_f32_bf16 v8, v27, v27
v_dot2c_f32_bf16 v7, v35, v48
v_dot2c_f32_bf16 v9, v35, v35
s_mov_b64 exec, 1
s_waitcnt vmcnt(0)
buffer_store_dword v5, v4, s[32:35], s88 offen
s_mov_b64 exec, -1
s_nop 1
v_permlane32_swap_b32 v6, v7
v_permlane32_swap_b32 v8, v9
v_add_f32 v6, v6, v7
v_add_f32 v8, v8, v9
s_nop 1
v_permlane16_swap_b32 v6, v8
s_nop 0
v_add_f32 v6, v6, v8
buffer_store_dword v6, v1, s[32:35], s87 offen
back_56:
s_lshl_b32 s49, s44, 13
v_add_u32 v10, s49, v18
v_add_u32 v11, 1024, v10
s_lshl_b32 s48, s43, 1
v_lshrrev_b32 v4, 2, v2
v_and_b32 v5, 3, v0
v_lshl_add_u32 v6, v3, 3, v4
v_lshlrev_b32 v6, 7, v6
v_lshl_add_u32 v6, v5, 3, v6
v_lshrrev_b32 v7, 1, v4
v_and_b32 v8, 1, v3
v_lshl_add_u32 v7, v8, 1, v7
v_xor_b32 v7, s48, v7
v_lshl_add_u32 v12, v7, 5, v6
v_add_u32 v12, 16384, v12
v_xor_b32 v13, 32, v12
v_mov_b32 v14, v10
v_mov_b32 v15, v11
v_add_u32 v16, 122880, v12
v_add_u32 v17, 122880, v13
v_mov_b32 v156, 0
v_mov_b32 v157, 0
v_mov_b32 v158, 0
v_mov_b32 v159, 0
v_mov_b32 v160, 0
v_mov_b32 v161, 0
v_mov_b32 v162, 0
v_mov_b32 v163, 0
v_mov_b32 v164, 0
v_mov_b32 v165, 0
v_mov_b32 v166, 0
v_mov_b32 v167, 0
v_mov_b32 v168, 0
v_mov_b32 v169, 0
v_mov_b32 v170, 0
v_mov_b32 v171, 0
v_mov_b32 v172, 0
v_mov_b32 v173, 0
v_mov_b32 v174, 0
v_mov_b32 v175, 0
v_mov_b32 v176, 0
v_mov_b32 v177, 0
v_mov_b32 v178, 0
v_mov_b32 v179, 0
v_mov_b32 v180, 0
v_mov_b32 v181, 0
v_mov_b32 v182, 0
v_mov_b32 v183, 0
v_mov_b32 v184, 0
v_mov_b32 v185, 0
v_mov_b32 v186, 0
v_mov_b32 v187, 0
v_mov_b32 v188, 0
v_mov_b32 v189, 0
v_mov_b32 v190, 0
v_mov_b32 v191, 0
v_mov_b32 v192, 0
v_mov_b32 v193, 0
v_mov_b32 v194, 0
v_mov_b32 v195, 0
v_mov_b32 v196, 0
v_mov_b32 v197, 0
v_mov_b32 v198, 0
v_mov_b32 v199, 0
v_mov_b32 v200, 0
v_mov_b32 v201, 0
v_mov_b32 v202, 0
v_mov_b32 v203, 0
v_mov_b32 v204, 0
v_mov_b32 v205, 0
v_mov_b32 v206, 0
v_mov_b32 v207, 0
v_mov_b32 v208, 0
v_mov_b32 v209, 0
v_mov_b32 v210, 0
v_mov_b32 v211, 0
v_mov_b32 v212, 0
v_mov_b32 v213, 0
v_mov_b32 v214, 0
v_mov_b32 v215, 0
v_mov_b32 v216, 0
v_mov_b32 v217, 0
v_mov_b32 v218, 0
v_mov_b32 v219, 0
v_mov_b32 v220, 0
v_mov_b32 v221, 0
v_mov_b32 v222, 0
v_mov_b32 v223, 0
v_mov_b32 v224, 0
v_mov_b32 v225, 0
v_mov_b32 v226, 0
v_mov_b32 v227, 0
v_mov_b32 v228, 0
v_mov_b32 v229, 0
v_mov_b32 v230, 0
v_mov_b32 v231, 0
v_mov_b32 v232, 0
v_mov_b32 v233, 0
v_mov_b32 v234, 0
v_mov_b32 v235, 0
v_mov_b32 v236, 0
v_mov_b32 v237, 0
v_mov_b32 v238, 0
v_mov_b32 v239, 0
v_mov_b32 v240, 0
v_mov_b32 v241, 0
v_mov_b32 v242, 0
v_mov_b32 v243, 0
v_mov_b32 v244, 0
v_mov_b32 v245, 0
v_mov_b32 v246, 0
v_mov_b32 v247, 0
v_mov_b32 v248, 0
v_mov_b32 v249, 0
v_mov_b32 v250, 0
v_mov_b32 v251, 0
v_lshrrev_b32 v6, 2, v2
v_cmp_eq_u32 vcc, v6, v3
v_and_b32 v7, 1, v0
v_lshlrev_b32 v7, 4, v7
v_mov_b32 v8, 0x3f80
v_lshlrev_b32 v9, v7, v8
v_cndmask_b32 v7, 0, v9, vcc
v_and_b32 v6, 2, v0
v_cmp_eq_u32 vcc, 0, v6
v_mov_b32 v36, 0
v_mov_b32 v37, 0
v_mov_b32 v40, 0
v_mov_b32 v41, 0
v_cndmask_b32 v38, 0, v7, vcc
v_cndmask_b32 v39, v7, 0, vcc
v_lshrrev_b32 v8, 1, v2
v_cmp_eq_u32 vcc, 0, v8
s_nop 1
v_cndmask_b32 v44, 0, v9, vcc
v_cmp_eq_u32 vcc, 1, v8
s_nop 1
v_cndmask_b32 v45, 0, v9, vcc
v_cmp_eq_u32 vcc, 2, v8
s_nop 1
v_cndmask_b32 v46, 0, v9, vcc
v_cmp_eq_u32 vcc, 3, v8
s_nop 1
v_cndmask_b32 v47, 0, v9, vcc
v_lshrrev_b32 v4, 2, v2
v_lshl_add_u32 v4, v3, 2, v4
v_lshlrev_b32 v4, 6, v4
v_and_b32 v5, 3, v0
v_lshl_add_u32 v4, v5, 3, v4
s_lshl_b32 s48, s43, 11
s_add_u32 s48, s48, 135168
v_add_u32 v53, s48, v4
s_mul_i32 s48, s40, 3072
s_add_u32 s48, s48, 139264
v_add_u32 v42, s48, v18
s_xor_b32 s49, s40, 2
s_mul_i32 s48, s49, 3072
s_add_u32 s48, s48, 139264
v_add_u32 v43, s48, v18
s_lshl_b32 s49, s49, 2
s_add_u32 s49, s49, 134672
v_mov_b32 v19, s49
v_xor_b32 v52, 8, v19
v_lshrrev_b32 v4, 3, v0
v_and_b32 v5, 7, v0
v_lshlrev_b32 v4, 11, v4
v_lshl_add_u32 v55, v5, 4, v4
v_lshlrev_b32 v4, 6, v2
v_lshl_add_u32 v58, v3, 4, v4
v_lshlrev_b32 v4, 4, v2
v_lshl_add_u32 v59, v3, 3, v4
s_mul_i32 s51, s42, 393216
s_add_u32 s51, s51, 9437184
s_lshl_b32 s50, s43, 1
s_add_u32 s50, s50, s44
s_lshl_b32 s48, s50, 15
s_add_u32 s48, s48, s51
s_add_u32 s48, s48, 0
s_lshl_b32 s49, s41, 7
s_add_u32 s53, s48, s49
s_add_u32 s54, s53, 16384
s_lshl_b32 s56, s50, 10
s_add_u32 s56, s56, s51
s_add_u32 s56, s56, 344064
s_xor_b32 s57, s56, 1024
s_lshl_b32 s58, s50, 11
s_add_u32 s58, s58, s51
s_add_u32 s58, s58, 327680
s_xor_b32 s59, s58, 2048
s_add_u32 s79, s58, s49
s_lshl_b32 s50, s41, 11
s_add_u32 s55, s48, s50
s_lshl_b32 s48, s43, 7
s_add_u32 s48, s48, 133888
v_lshl_add_u32 v7, v3, 4, s48
v_lshl_add_u32 v54, v2, 2, s48
s_lshl_b32 s49, s44, 6
v_add_u32 v8, s49, v2
v_lshlrev_b32 v8, 3, v8
v_add_u32 v8, 131072, v8
v_lshl_add_u32 v9, v3, 2, s49
v_lshlrev_b32 v9, 2, v9
v_add_u32 v9, 132096, v9
s_mov_b32 s64, 0
s_mov_b32 s65, 0
s_mov_b32 s66, 0x3fb8aa3b
s_mov_b32 s77, s74
s_add_u32 s77, s77, 4
s_lshl_b32 s50, s42, 2
s_add_u32 s50, s50, s40
s_lshl_b32 s50, s50, 4
s_add_u32 s50, s50, s41
s_lshl_b32 s50, s50, 8
s_add_u32 s52, s50, 18087936
s_barrier
ds_read_b128 v[60:63], v14 offset:0
ds_read_b128 v[64:67], v14 offset:2048
ds_read_b128 v[68:71], v14 offset:4096
ds_read_b128 v[72:75], v14 offset:6144
ds_read_b64_tr_b16 v[84:85], v16 offset:8192
ds_read_b64_tr_b16 v[86:87], v16 offset:8704
ds_read_b64_tr_b16 v[88:89], v17 offset:8192
ds_read_b64_tr_b16 v[90:91], v17 offset:8704
ds_read_b64_tr_b16 v[92:93], v16 offset:16384
ds_read_b64_tr_b16 v[94:95], v16 offset:16896
ds_read_b64_tr_b16 v[96:97], v17 offset:16384
ds_read_b64_tr_b16 v[98:99], v17 offset:16896
ds_read_b64_tr_b16 v[76:77], v16 offset:0
ds_read_b64_tr_b16 v[78:79], v16 offset:512
ds_read_b64_tr_b16 v[80:81], v17 offset:0
ds_read_b64_tr_b16 v[82:83], v17 offset:512
s_waitcnt lgkmcnt(0)
c1_loop:
v_mfma_f32_16x16x32_bf16 v[212:215], v[84:87], v[72:75], v[212:215]
ds_read_b128 v[100:103], v15 offset:0
v_mfma_f32_16x16x32_bf16 v[204:207], v[84:87], v[68:71], v[204:207]
ds_read_b128 v[104:107], v15 offset:2048
v_mfma_f32_16x16x32_bf16 v[196:199], v[84:87], v[64:67], v[196:199]
ds_read_b128 v[108:111], v15 offset:4096
v_mfma_f32_16x16x32_bf16 v[188:191], v[84:87], v[60:63], v[188:191]
ds_read_b128 v[112:115], v15 offset:6144
v_mfma_f32_16x16x32_bf16 v[192:195], v[88:91], v[60:63], v[192:195]
ds_read_b64_tr_b16 v[124:125], v16 offset:12288
v_mfma_f32_16x16x32_bf16 v[200:203], v[88:91], v[64:67], v[200:203]
ds_read_b64_tr_b16 v[126:127], v16 offset:12800
v_mfma_f32_16x16x32_bf16 v[208:211], v[88:91], v[68:71], v[208:211]
ds_read_b64_tr_b16 v[128:129], v17 offset:12288
v_mfma_f32_16x16x32_bf16 v[216:219], v[88:91], v[72:75], v[216:219]
ds_read_b64_tr_b16 v[130:131], v17 offset:12800
v_mfma_f32_16x16x32_bf16 v[244:247], v[72:75], v[92:95], v[244:247]
ds_read_b64_tr_b16 v[132:133], v16 offset:20480
v_mfma_f32_16x16x32_bf16 v[236:239], v[68:71], v[92:95], v[236:239]
ds_read_b64_tr_b16 v[134:135], v16 offset:20992
v_mfma_f32_16x16x32_bf16 v[228:231], v[64:67], v[92:95], v[228:231]
ds_read_b64_tr_b16 v[136:137], v17 offset:20480
v_mfma_f32_16x16x32_bf16 v[220:223], v[60:63], v[92:95], v[220:223]
ds_read_b64_tr_b16 v[138:139], v17 offset:20992
v_mfma_f32_16x16x32_bf16 v[224:227], v[60:63], v[96:99], v[224:227]
ds_read_b64_tr_b16 v[116:117], v16 offset:4096
v_mfma_f32_16x16x32_bf16 v[232:235], v[64:67], v[96:99], v[232:235]
ds_read_b64_tr_b16 v[118:119], v16 offset:4608
v_mfma_f32_16x16x32_bf16 v[240:243], v[68:71], v[96:99], v[240:243]
ds_read_b64_tr_b16 v[120:121], v17 offset:4096
v_mfma_f32_16x16x32_bf16 v[248:251], v[72:75], v[96:99], v[248:251]
ds_read_b64_tr_b16 v[122:123], v17 offset:4608
v_mfma_f32_16x16x32_bf16 v[180:183], v[76:79], v[72:75], v[180:183]
s_cmp_eq_u32 s77, s64
s_cbranch_scc1 c1_hook
c1_hook_ret:
v_mfma_f32_16x16x32_bf16 v[172:175], v[76:79], v[68:71], v[172:175]
s_add_u32 s65, s65, 40960
s_cmp_eq_u32 s65, 122880
v_mfma_f32_16x16x32_bf16 v[164:167], v[76:79], v[64:67], v[164:167]
s_cselect_b32 s65, 0, s65
s_add_u32 s64, s64, 1
v_mfma_f32_16x16x32_bf16 v[156:159], v[76:79], v[60:63], v[156:159]
v_add_u32 v14, s65, v10
v_add_u32 v15, s65, v11
v_mfma_f32_16x16x32_bf16 v[160:163], v[80:83], v[60:63], v[160:163]
v_add_u32 v16, s65, v12
v_add_u32 v17, s65, v13
v_mfma_f32_16x16x32_bf16 v[168:171], v[80:83], v[64:67], v[168:171]
s_cmp_eq_u32 s64, 16
s_cbranch_scc1 c1_last
v_mfma_f32_16x16x32_bf16 v[176:179], v[80:83], v[68:71], v[176:179]
s_waitcnt lgkmcnt(0)
v_mfma_f32_16x16x32_bf16 v[184:187], v[80:83], v[72:75], v[184:187]
s_barrier
v_mfma_f32_16x16x32_bf16 v[212:215], v[124:127], v[112:115], v[212:215]
ds_read_b128 v[60:63], v14 offset:0
v_mfma_f32_16x16x32_bf16 v[204:207], v[124:127], v[108:111], v[204:207]
ds_read_b128 v[64:67], v14 offset:2048
v_mfma_f32_16x16x32_bf16 v[196:199], v[124:127], v[104:107], v[196:199]
ds_read_b128 v[68:71], v14 offset:4096
v_mfma_f32_16x16x32_bf16 v[188:191], v[124:127], v[100:103], v[188:191]
ds_read_b128 v[72:75], v14 offset:6144
v_mfma_f32_16x16x32_bf16 v[192:195], v[128:131], v[100:103], v[192:195]
ds_read_b64_tr_b16 v[84:85], v16 offset:8192
v_mfma_f32_16x16x32_bf16 v[200:203], v[128:131], v[104:107], v[200:203]
ds_read_b64_tr_b16 v[86:87], v16 offset:8704
v_mfma_f32_16x16x32_bf16 v[208:211], v[128:131], v[108:111], v[208:211]
ds_read_b64_tr_b16 v[88:89], v17 offset:8192
v_mfma_f32_16x16x32_bf16 v[216:219], v[128:131], v[112:115], v[216:219]
ds_read_b64_tr_b16 v[90:91], v17 offset:8704
v_mfma_f32_16x16x32_bf16 v[244:247], v[112:115], v[132:135], v[244:247]
ds_read_b64_tr_b16 v[92:93], v16 offset:16384
v_mfma_f32_16x16x32_bf16 v[236:239], v[108:111], v[132:135], v[236:239]
ds_read_b64_tr_b16 v[94:95], v16 offset:16896
v_mfma_f32_16x16x32_bf16 v[228:231], v[104:107], v[132:135], v[228:231]
ds_read_b64_tr_b16 v[96:97], v17 offset:16384
v_mfma_f32_16x16x32_bf16 v[220:223], v[100:103], v[132:135], v[220:223]
ds_read_b64_tr_b16 v[98:99], v17 offset:16896
v_mfma_f32_16x16x32_bf16 v[224:227], v[100:103], v[136:139], v[224:227]
ds_read_b64_tr_b16 v[76:77], v16 offset:0
v_mfma_f32_16x16x32_bf16 v[232:235], v[104:107], v[136:139], v[232:235]
ds_read_b64_tr_b16 v[78:79], v16 offset:512
v_mfma_f32_16x16x32_bf16 v[240:243], v[108:111], v[136:139], v[240:243]
ds_read_b64_tr_b16 v[80:81], v17 offset:0
v_mfma_f32_16x16x32_bf16 v[248:251], v[112:115], v[136:139], v[248:251]
ds_read_b64_tr_b16 v[82:83], v17 offset:512
v_mfma_f32_16x16x32_bf16 v[180:183], v[116:119], v[112:115], v[180:183]
v_mfma_f32_16x16x32_bf16 v[172:175], v[116:119], v[108:111], v[172:175]
v_mfma_f32_16x16x32_bf16 v[164:167], v[116:119], v[104:107], v[164:167]
v_mfma_f32_16x16x32_bf16 v[156:159], v[116:119], v[100:103], v[156:159]
v_mfma_f32_16x16x32_bf16 v[160:163], v[120:123], v[100:103], v[160:163]
v_mfma_f32_16x16x32_bf16 v[168:171], v[120:123], v[104:107], v[168:171]
v_mfma_f32_16x16x32_bf16 v[176:179], v[120:123], v[108:111], v[176:179]
s_waitcnt lgkmcnt(0)
v_mfma_f32_16x16x32_bf16 v[184:187], v[120:123], v[112:115], v[184:187]
s_branch c1_loop
c1_hook:
s_waitcnt lgkmcnt(0)
s_cmp_lg_u32 s44, 0
s_cbranch_scc1 else_57
v_mfma_f32_16x16x32_bf16 v[140:143], v[48:51], v[76:79], 0
v_mfma_f32_16x16x32_bf16 v[144:147], v[48:51], v[84:87], 0
v_mfma_f32_16x16x32_bf16 v[148:151], v[48:51], v[92:95], 0
v_mfma_f32_16x16x32_bf16 v[140:143], v[48:51], v[116:119], v[140:143]
v_mfma_f32_16x16x32_bf16 v[144:147], v[48:51], v[124:127], v[144:147]
v_mfma_f32_16x16x32_bf16 v[148:151], v[48:51], v[132:135], v[148:151]
s_branch fi_58
else_57:
v_mfma_f32_16x16x32_bf16 v[140:143], v[48:51], v[80:83], 0
v_mfma_f32_16x16x32_bf16 v[144:147], v[48:51], v[88:91], 0
v_mfma_f32_16x16x32_bf16 v[148:151], v[48:51], v[96:99], 0
v_mfma_f32_16x16x32_bf16 v[140:143], v[48:51], v[120:123], v[140:143]
v_mfma_f32_16x16x32_bf16 v[144:147], v[48:51], v[128:131], v[144:147]
v_mfma_f32_16x16x32_bf16 v[148:151], v[48:51], v[136:139], v[148:151]
fi_58:
s_nop 4
v_cmp_eq_u32 vcc, 0, v3
v_cmp_eq_u32 s[48:49], 1, v3
s_nop 1
v_cndmask_b32 v4, v148, v144, s[48:49]
v_cndmask_b32 v4, v4, v140, vcc
buffer_store_dword v4, v1, s[32:35], s52 offen sc1
s_branch c1_hook_ret
c1_last:
v_mfma_f32_16x16x32_bf16 v[176:179], v[80:83], v[68:71], v[176:179]
s_waitcnt lgkmcnt(0)
v_mfma_f32_16x16x32_bf16 v[184:187], v[80:83], v[72:75], v[184:187]
s_barrier
v_mfma_f32_16x16x32_bf16 v[212:215], v[124:127], v[112:115], v[212:215]
ds_read_b128 v[140:143], v7 offset:0
v_mfma_f32_16x16x32_bf16 v[204:207], v[124:127], v[108:111], v[204:207]
ds_read_b128 v[144:147], v7 offset:64
v_mfma_f32_16x16x32_bf16 v[196:199], v[124:127], v[104:107], v[196:199]
ds_read_b128 v[148:151], v7 offset:256
v_mfma_f32_16x16x32_bf16 v[188:191], v[124:127], v[100:103], v[188:191]
ds_read_b128 v[152:155], v7 offset:320
v_mfma_f32_16x16x32_bf16 v[192:195], v[128:131], v[100:103], v[192:195]
ds_read_b64 v[92:93], v8 offset:0
v_mfma_f32_16x16x32_bf16 v[200:203], v[128:131], v[104:107], v[200:203]
ds_read_b64 v[94:95], v8 offset:128
v_mfma_f32_16x16x32_bf16 v[208:211], v[128:131], v[108:111], v[208:211]
ds_read_b64 v[96:97], v8 offset:256
v_mfma_f32_16x16x32_bf16 v[216:219], v[128:131], v[112:115], v[216:219]
ds_read_b64 v[98:99], v8 offset:384
v_mfma_f32_16x16x32_bf16 v[244:247], v[112:115], v[132:135], v[244:247]
ds_read2_b32 v[56:57], v54 offset0:128 offset1:144
v_mfma_f32_16x16x32_bf16 v[236:239], v[108:111], v[132:135], v[236:239]
ds_read_b128 v[60:63], v9 offset:0
v_mfma_f32_16x16x32_bf16 v[228:231], v[104:107], v[132:135], v[228:231]
ds_read_b128 v[64:67], v9 offset:64
v_mfma_f32_16x16x32_bf16 v[220:223], v[100:103], v[132:135], v[220:223]
ds_read_b128 v[68:71], v9 offset:128
v_mfma_f32_16x16x32_bf16 v[224:227], v[100:103], v[136:139], v[224:227]
ds_read_b128 v[72:75], v9 offset:192
v_mfma_f32_16x16x32_bf16 v[232:235], v[104:107], v[136:139], v[232:235]
ds_read_b128 v[76:79], v9 offset:512
v_mfma_f32_16x16x32_bf16 v[240:243], v[108:111], v[136:139], v[240:243]
ds_read_b128 v[80:83], v9 offset:576
v_mfma_f32_16x16x32_bf16 v[248:251], v[112:115], v[136:139], v[248:251]
ds_read_b128 v[84:87], v9 offset:640
v_mfma_f32_16x16x32_bf16 v[180:183], v[116:119], v[112:115], v[180:183]
ds_read_b128 v[88:91], v9 offset:704
v_mfma_f32_16x16x32_bf16 v[172:175], v[116:119], v[108:111], v[172:175]
ds_read_b64_tr_b16 v[10:11], v53 offset:0
v_mfma_f32_16x16x32_bf16 v[164:167], v[116:119], v[104:107], v[164:167]
ds_read_b64_tr_b16 v[12:13], v53 offset:1024
v_mfma_f32_16x16x32_bf16 v[156:159], v[116:119], v[100:103], v[156:159]
ds_read_b64_tr_b16 v[14:15], v53 offset:32
v_mfma_f32_16x16x32_bf16 v[160:163], v[120:123], v[100:103], v[160:163]
ds_read_b64_tr_b16 v[16:17], v53 offset:1056
v_mfma_f32_16x16x32_bf16 v[168:171], v[120:123], v[104:107], v[168:171]
v_mfma_f32_16x16x32_bf16 v[176:179], v[120:123], v[108:111], v[176:179]
v_mfma_f32_16x16x32_bf16 v[184:187], v[120:123], v[112:115], v[184:187]
c1_epi:
s_waitcnt lgkmcnt(0)
s_mul_i32 s48, s44, 0x80008000
v_xor_b32 v10, s48, v10
v_xor_b32 v11, s48, v11
v_xor_b32 v12, s48, v12
v_xor_b32 v13, s48, v13
v_xor_b32 v14, s48, v14
v_xor_b32 v15, s48, v15
v_xor_b32 v16, s48, v16
v_xor_b32 v17, s48, v17
v_mul_f32 v128, s66, v92
v_mul_f32 v129, s66, v94
v_mul_f32 v130, s66, v96
v_mul_f32 v131, s66, v98
.p2align 3
v_pk_fma_f32 v[220:221], v[76:77], v[56:57], v[220:221] op_sel:[0,0,0] op_sel_hi:[1,0,1]
v_pk_fma_f32 v[222:223], v[78:79], v[56:57], v[222:223] op_sel:[0,0,0] op_sel_hi:[1,0,1]
v_pk_mul_f32 v[220:221], v[220:221], v[60:61]
v_pk_mul_f32 v[222:223], v[222:223], v[62:63]
v_cvt_pk_bf16_f32 v112, v220, v221
v_cvt_pk_bf16_f32 v113, v222, v223
v_pk_fma_f32 v[228:229], v[80:81], v[56:57], v[228:229] op_sel:[0,0,0] op_sel_hi:[1,0,1]
v_pk_fma_f32 v[230:231], v[82:83], v[56:57], v[230:231] op_sel:[0,0,0] op_sel_hi:[1,0,1]
v_pk_mul_f32 v[228:229], v[228:229], v[64:65]
v_pk_mul_f32 v[230:231], v[230:231], v[66:67]
v_cvt_pk_bf16_f32 v114, v228, v229
v_cvt_pk_bf16_f32 v115, v230, v231
v_pk_fma_f32 v[236:237], v[84:85], v[56:57], v[236:237] op_sel:[0,0,0] op_sel_hi:[1,0,1]
v_pk_fma_f32 v[238:239], v[86:87], v[56:57], v[238:239] op_sel:[0,0,0] op_sel_hi:[1,0,1]
v_pk_mul_f32 v[236:237], v[236:237], v[68:69]
v_pk_mul_f32 v[238:239], v[238:239], v[70:71]
v_cvt_pk_bf16_f32 v116, v236, v237
v_cvt_pk_bf16_f32 v117, v238, v239
v_pk_fma_f32 v[244:245], v[88:89], v[56:57], v[244:245] op_sel:[0,0,0] op_sel_hi:[1,0,1]
v_pk_fma_f32 v[246:247], v[90:91], v[56:57], v[246:247] op_sel:[0,0,0] op_sel_hi:[1,0,1]
v_pk_mul_f32 v[244:245], v[244:245], v[72:73]
v_pk_mul_f32 v[246:247], v[246:247], v[74:75]
v_cvt_pk_bf16_f32 v118, v244, v245
v_cvt_pk_bf16_f32 v119, v246, v247
v_pk_fma_f32 v[224:225], v[76:77], v[56:57], v[224:225] op_sel:[0,1,0] op_sel_hi:[1,1,1]
v_pk_fma_f32 v[226:227], v[78:79], v[56:57], v[226:227] op_sel:[0,1,0] op_sel_hi:[1,1,1]
v_pk_mul_f32 v[224:225], v[224:225], v[60:61]
v_pk_mul_f32 v[226:227], v[226:227], v[62:63]
v_cvt_pk_bf16_f32 v120, v224, v225
v_cvt_pk_bf16_f32 v121, v226, v227
v_pk_fma_f32 v[232:233], v[80:81], v[56:57], v[232:233] op_sel:[0,1,0] op_sel_hi:[1,1,1]
v_pk_fma_f32 v[234:235], v[82:83], v[56:57], v[234:235] op_sel:[0,1,0] op_sel_hi:[1,1,1]
v_pk_mul_f32 v[232:233], v[232:233], v[64:65]
v_pk_mul_f32 v[234:235], v[234:235], v[66:67]
v_cvt_pk_bf16_f32 v122, v232, v233
v_cvt_pk_bf16_f32 v123, v234, v235
v_pk_fma_f32 v[240:241], v[84:85], v[56:57], v[240:241] op_sel:[0,1,0] op_sel_hi:[1,1,1]
v_pk_fma_f32 v[242:243], v[86:87], v[56:57], v[242:243] op_sel:[0,1,0] op_sel_hi:[1,1,1]
v_pk_mul_f32 v[240:241], v[240:241], v[68:69]
v_pk_mul_f32 v[242:243], v[242:243], v[70:71]
v_cvt_pk_bf16_f32 v124, v240, v241
v_cvt_pk_bf16_f32 v125, v242, v243
v_pk_fma_f32 v[248:249], v[88:89], v[56:57], v[248:249] op_sel:[0,1,0] op_sel_hi:[1,1,1]
v_pk_fma_f32 v[250:251], v[90:91], v[56:57], v[250:251] op_sel:[0,1,0] op_sel_hi:[1,1,1]
v_pk_mul_f32 v[248:249], v[248:249], v[72:73]
v_pk_mul_f32 v[250:251], v[250:251], v[74:75]
v_cvt_pk_bf16_f32 v126, v248, v249
v_cvt_pk_bf16_f32 v127, v250, v251
v_pk_fma_f32 v[188:189], v[148:149], v[92:93], v[188:189] op_sel:[0,1,0] op_sel_hi:[1,1,1]
v_pk_fma_f32 v[190:191], v[150:151], v[92:93], v[190:191] op_sel:[0,1,0] op_sel_hi:[1,1,1]
v_pk_fma_f32 v[192:193], v[152:153], v[92:93], v[192:193] op_sel:[0,1,0] op_sel_hi:[1,1,1]
v_pk_fma_f32 v[194:195], v[154:155], v[92:93], v[194:195] op_sel:[0,1,0] op_sel_hi:[1,1,1]
v_cvt_pk_bf16_f32 v188, v188, v189
v_cvt_pk_bf16_f32 v189, v190, v191
v_cvt_pk_bf16_f32 v190, v192, v193
v_cvt_pk_bf16_f32 v191, v194, v195
v_pk_fma_f32 v[196:197], v[148:149], v[94:95], v[196:197] op_sel:[0,1,0] op_sel_hi:[1,1,1]
v_pk_fma_f32 v[198:199], v[150:151], v[94:95], v[198:199] op_sel:[0,1,0] op_sel_hi:[1,1,1]
v_pk_fma_f32 v[200:201], v[152:153], v[94:95], v[200:201] op_sel:[0,1,0] op_sel_hi:[1,1,1]
v_pk_fma_f32 v[202:203], v[154:155], v[94:95], v[202:203] op_sel:[0,1,0] op_sel_hi:[1,1,1]
v_cvt_pk_bf16_f32 v196, v196, v197
v_mfma_f32_16x16x32_bf16 v[60:63], v[10:13], v[188:191], 0
v_cvt_pk_bf16_f32 v197, v198, v199
v_cvt_pk_bf16_f32 v198, v200, v201
v_mfma_f32_16x16x32_bf16 v[64:67], v[14:17], v[188:191], 0
v_cvt_pk_bf16_f32 v199, v202, v203
v_pk_fma_f32 v[204:205], v[148:149], v[96:97], v[204:205] op_sel:[0,1,0] op_sel_hi:[1,1,1]
v_pk_fma_f32 v[206:207], v[150:151], v[96:97], v[206:207] op_sel:[0,1,0] op_sel_hi:[1,1,1]
v_pk_fma_f32 v[208:209], v[152:153], v[96:97], v[208:209] op_sel:[0,1,0] op_sel_hi:[1,1,1]
v_pk_fma_f32 v[210:211], v[154:155], v[96:97], v[210:211] op_sel:[0,1,0] op_sel_hi:[1,1,1]
v_cvt_pk_bf16_f32 v204, v204, v205
v_mfma_f32_16x16x32_bf16 v[68:71], v[10:13], v[196:199], 0
v_cvt_pk_bf16_f32 v205, v206, v207
v_cvt_pk_bf16_f32 v206, v208, v209
v_mfma_f32_16x16x32_bf16 v[72:75], v[14:17], v[196:199], 0
v_cvt_pk_bf16_f32 v207, v210, v211
v_pk_fma_f32 v[212:213], v[148:149], v[98:99], v[212:213] op_sel:[0,1,0] op_sel_hi:[1,1,1]
v_pk_fma_f32 v[214:215], v[150:151], v[98:99], v[214:215] op_sel:[0,1,0] op_sel_hi:[1,1,1]
v_pk_fma_f32 v[216:217], v[152:153], v[98:99], v[216:217] op_sel:[0,1,0] op_sel_hi:[1,1,1]
v_pk_fma_f32 v[218:219], v[154:155], v[98:99], v[218:219] op_sel:[0,1,0] op_sel_hi:[1,1,1]
v_cvt_pk_bf16_f32 v212, v212, v213
v_mfma_f32_16x16x32_bf16 v[76:79], v[10:13], v[204:207], 0
v_cvt_pk_bf16_f32 v213, v214, v215
v_cvt_pk_bf16_f32 v214, v216, v217
v_mfma_f32_16x16x32_bf16 v[80:83], v[14:17], v[204:207], 0
v_cvt_pk_bf16_f32 v215, v218, v219
s_nop 1
v_mfma_f32_16x16x32_bf16 v[84:87], v[10:13], v[212:215], 0
v_mfma_f32_16x16x32_bf16 v[88:91], v[14:17], v[212:215], 0
v_max3_f32 v100, v60, v61, v62
v_min3_f32 v104, v60, v61, v62
v_max3_f32 v100, v100, v63, v64
v_min3_f32 v104, v104, v63, v64
v_max3_f32 v100, v100, v65, v66
v_min3_f32 v104, v104, v65, v66
v_max_f32 v100, v100, v67
v_min_f32 v104, v104, v67
v_max3_f32 v101, v68, v69, v70
v_min3_f32 v105, v68, v69, v70
v_max3_f32 v101, v101, v71, v72
v_min3_f32 v105, v105, v71, v72
v_max3_f32 v101, v101, v73, v74
v_min3_f32 v105, v105, v73, v74
v_max_f32 v101, v101, v75
v_min_f32 v105, v105, v75
v_max3_f32 v102, v76, v77, v78
v_min3_f32 v106, v76, v77, v78
v_max3_f32 v102, v102, v79, v80
v_min3_f32 v106, v106, v79, v80
v_max3_f32 v102, v102, v81, v82
v_min3_f32 v106, v106, v81, v82
v_max_f32 v102, v102, v83
v_min_f32 v106, v106, v83
v_max3_f32 v103, v84, v85, v86
v_min3_f32 v107, v84, v85, v86
v_max3_f32 v103, v103, v87, v88
v_min3_f32 v107, v107, v87, v88
v_max3_f32 v103, v103, v89, v90
v_min3_f32 v107, v107, v89, v90
v_max_f32 v103, v103, v91
v_min_f32 v107, v107, v91
s_nop 1
v_permlane32_swap_b32 v100, v101
v_permlane32_swap_b32 v102, v103
v_permlane32_swap_b32 v104, v105
v_permlane32_swap_b32 v106, v107
v_max_f32 v100, v100, v101
v_max_f32 v102, v102, v103
v_min_f32 v104, v104, v105
v_min_f32 v106, v106, v107
v_permlane16_swap_b32 v100, v102
s_nop 0
v_permlane16_swap_b32 v104, v106
v_max_f32 v100, v100, v102
v_min_f32 v104, v104, v106
v_mov_b32 v102, v100
v_mov_b32 v106, v104
s_nop 0
v_permlane16_swap_b32 v100, v102
v_permlane16_swap_b32 v104, v106
v_mov_b32 v101, v100
v_mov_b32 v103, v102
v_mov_b32 v105, v104
v_mov_b32 v107, v106
v_permlane32_swap_b32 v100, v101
v_permlane32_swap_b32 v102, v103
v_permlane32_swap_b32 v104, v105
v_permlane32_swap_b32 v106, v107
v_pk_mul_f32 v[100:101], v[100:101], v[128:129]
v_pk_mul_f32 v[102:103], v[102:103], v[130:131]
v_pk_mul_f32 v[104:105], v[104:105], v[128:129]
v_pk_mul_f32 v[106:107], v[106:107], v[130:131]
v_pk_fma_f32 v[220:221], v[60:61], v[128:129], v[104:105] op_sel:[0,0,0] op_sel_hi:[1,0,0] neg_lo:[1,0,0] neg_hi:[1,0,0]
v_pk_fma_f32 v[60:61], v[60:61], v[128:129], v[100:101] op_sel:[0,0,0] op_sel_hi:[1,0,0] neg_lo:[0,0,1] neg_hi:[0,0,1]
v_exp_f32 v220, v220
v_exp_f32 v60, v60
v_exp_f32 v221, v221
v_exp_f32 v61, v61
v_pk_fma_f32 v[222:223], v[62:63], v[128:129], v[104:105] op_sel:[0,0,0] op_sel_hi:[1,0,0] neg_lo:[1,0,0] neg_hi:[1,0,0]
v_pk_fma_f32 v[62:63], v[62:63], v[128:129], v[100:101] op_sel:[0,0,0] op_sel_hi:[1,0,0] neg_lo:[0,0,1] neg_hi:[0,0,1]
v_exp_f32 v222, v222
v_exp_f32 v62, v62
v_exp_f32 v223, v223
v_exp_f32 v63, v63
v_pk_fma_f32 v[224:225], v[64:65], v[128:129], v[104:105] op_sel:[0,0,0] op_sel_hi:[1,0,0] neg_lo:[1,0,0] neg_hi:[1,0,0]
v_pk_fma_f32 v[64:65], v[64:65], v[128:129], v[100:101] op_sel:[0,0,0] op_sel_hi:[1,0,0] neg_lo:[0,0,1] neg_hi:[0,0,1]
v_exp_f32 v224, v224
v_exp_f32 v64, v64
v_exp_f32 v225, v225
v_exp_f32 v65, v65
v_pk_fma_f32 v[226:227], v[66:67], v[128:129], v[104:105] op_sel:[0,0,0] op_sel_hi:[1,0,0] neg_lo:[1,0,0] neg_hi:[1,0,0]
v_pk_fma_f32 v[66:67], v[66:67], v[128:129], v[100:101] op_sel:[0,0,0] op_sel_hi:[1,0,0] neg_lo:[0,0,1] neg_hi:[0,0,1]
v_exp_f32 v226, v226
v_exp_f32 v66, v66
v_exp_f32 v227, v227
v_exp_f32 v67, v67
v_pk_fma_f32 v[228:229], v[68:69], v[128:129], v[104:105] op_sel:[0,1,1] op_sel_hi:[1,1,1] neg_lo:[1,0,0] neg_hi:[1,0,0]
v_pk_fma_f32 v[68:69], v[68:69], v[128:129], v[100:101] op_sel:[0,1,1] op_sel_hi:[1,1,1] neg_lo:[0,0,1] neg_hi:[0,0,1]
v_exp_f32 v228, v228
v_exp_f32 v68, v68
v_exp_f32 v229, v229
v_exp_f32 v69, v69
v_pk_fma_f32 v[230:231], v[70:71], v[128:129], v[104:105] op_sel:[0,1,1] op_sel_hi:[1,1,1] neg_lo:[1,0,0] neg_hi:[1,0,0]
v_pk_fma_f32 v[70:71], v[70:71], v[128:129], v[100:101] op_sel:[0,1,1] op_sel_hi:[1,1,1] neg_lo:[0,0,1] neg_hi:[0,0,1]
v_exp_f32 v230, v230
v_exp_f32 v70, v70
v_exp_f32 v231, v231
v_exp_f32 v71, v71
v_pk_fma_f32 v[232:233], v[72:73], v[128:129], v[104:105] op_sel:[0,1,1] op_sel_hi:[1,1,1] neg_lo:[1,0,0] neg_hi:[1,0,0]
v_pk_fma_f32 v[72:73], v[72:73], v[128:129], v[100:101] op_sel:[0,1,1] op_sel_hi:[1,1,1] neg_lo:[0,0,1] neg_hi:[0,0,1]
v_exp_f32 v232, v232
v_exp_f32 v72, v72
v_exp_f32 v233, v233
v_exp_f32 v73, v73
v_pk_fma_f32 v[234:235], v[74:75], v[128:129], v[104:105] op_sel:[0,1,1] op_sel_hi:[1,1,1] neg_lo:[1,0,0] neg_hi:[1,0,0]
v_pk_fma_f32 v[74:75], v[74:75], v[128:129], v[100:101] op_sel:[0,1,1] op_sel_hi:[1,1,1] neg_lo:[0,0,1] neg_hi:[0,0,1]
v_exp_f32 v234, v234
v_exp_f32 v74, v74
v_exp_f32 v235, v235
v_exp_f32 v75, v75
v_pk_fma_f32 v[236:237], v[76:77], v[130:131], v[106:107] op_sel:[0,0,0] op_sel_hi:[1,0,0] neg_lo:[1,0,0] neg_hi:[1,0,0]
v_pk_fma_f32 v[76:77], v[76:77], v[130:131], v[102:103] op_sel:[0,0,0] op_sel_hi:[1,0,0] neg_lo:[0,0,1] neg_hi:[0,0,1]
v_exp_f32 v236, v236
v_exp_f32 v76, v76
v_exp_f32 v237, v237
v_exp_f32 v77, v77
v_pk_fma_f32 v[238:239], v[78:79], v[130:131], v[106:107] op_sel:[0,0,0] op_sel_hi:[1,0,0] neg_lo:[1,0,0] neg_hi:[1,0,0]
v_pk_fma_f32 v[78:79], v[78:79], v[130:131], v[102:103] op_sel:[0,0,0] op_sel_hi:[1,0,0] neg_lo:[0,0,1] neg_hi:[0,0,1]
v_exp_f32 v238, v238
v_exp_f32 v78, v78
v_exp_f32 v239, v239
v_exp_f32 v79, v79
v_pk_fma_f32 v[240:241], v[80:81], v[130:131], v[106:107] op_sel:[0,0,0] op_sel_hi:[1,0,0] neg_lo:[1,0,0] neg_hi:[1,0,0]
v_pk_fma_f32 v[80:81], v[80:81], v[130:131], v[102:103] op_sel:[0,0,0] op_sel_hi:[1,0,0] neg_lo:[0,0,1] neg_hi:[0,0,1]
v_exp_f32 v240, v240
v_exp_f32 v80, v80
v_exp_f32 v241, v241
v_exp_f32 v81, v81
v_pk_fma_f32 v[242:243], v[82:83], v[130:131], v[106:107] op_sel:[0,0,0] op_sel_hi:[1,0,0] neg_lo:[1,0,0] neg_hi:[1,0,0]
v_pk_fma_f32 v[82:83], v[82:83], v[130:131], v[102:103] op_sel:[0,0,0] op_sel_hi:[1,0,0] neg_lo:[0,0,1] neg_hi:[0,0,1]
v_exp_f32 v242, v242
v_exp_f32 v82, v82
v_exp_f32 v243, v243
v_exp_f32 v83, v83
v_pk_fma_f32 v[244:245], v[84:85], v[130:131], v[106:107] op_sel:[0,1,1] op_sel_hi:[1,1,1] neg_lo:[1,0,0] neg_hi:[1,0,0]
v_pk_fma_f32 v[84:85], v[84:85], v[130:131], v[102:103] op_sel:[0,1,1] op_sel_hi:[1,1,1] neg_lo:[0,0,1] neg_hi:[0,0,1]
v_exp_f32 v244, v244
v_exp_f32 v84, v84
v_exp_f32 v245, v245
v_exp_f32 v85, v85
v_pk_fma_f32 v[246:247], v[86:87], v[130:131], v[106:107] op_sel:[0,1,1] op_sel_hi:[1,1,1] neg_lo:[1,0,0] neg_hi:[1,0,0]
v_pk_fma_f32 v[86:87], v[86:87], v[130:131], v[102:103] op_sel:[0,1,1] op_sel_hi:[1,1,1] neg_lo:[0,0,1] neg_hi:[0,0,1]
v_exp_f32 v246, v246
v_exp_f32 v86, v86
v_exp_f32 v247, v247
v_exp_f32 v87, v87
v_pk_fma_f32 v[248:249], v[88:89], v[130:131], v[106:107] op_sel:[0,1,1] op_sel_hi:[1,1,1] neg_lo:[1,0,0] neg_hi:[1,0,0]
v_pk_fma_f32 v[88:89], v[88:89], v[130:131], v[102:103] op_sel:[0,1,1] op_sel_hi:[1,1,1] neg_lo:[0,0,1] neg_hi:[0,0,1]
v_exp_f32 v248, v248
v_exp_f32 v88, v88
v_exp_f32 v249, v249
v_exp_f32 v89, v89
v_pk_fma_f32 v[250:251], v[90:91], v[130:131], v[106:107] op_sel:[0,1,1] op_sel_hi:[1,1,1] neg_lo:[1,0,0] neg_hi:[1,0,0]
v_pk_fma_f32 v[90:91], v[90:91], v[130:131], v[102:103] op_sel:[0,1,1] op_sel_hi:[1,1,1] neg_lo:[0,0,1] neg_hi:[0,0,1]
v_exp_f32 v250, v250
v_exp_f32 v90, v90
v_exp_f32 v251, v251
v_exp_f32 v91, v91
v_pk_add_f32 v[108:109], v[60:61], v[62:63]
v_pk_add_f32 v[110:111], v[220:221], v[222:223]
v_pk_add_f32 v[108:109], v[108:109], v[64:65]
v_pk_add_f32 v[110:111], v[110:111], v[224:225]
v_pk_add_f32 v[108:109], v[108:109], v[66:67]
v_pk_add_f32 v[110:111], v[110:111], v[226:227]
v_add_f32 v100, v108, v109
v_add_f32 v104, v110, v111
v_pk_add_f32 v[108:109], v[68:69], v[70:71]
v_pk_add_f32 v[110:111], v[228:229], v[230:231]
v_pk_add_f32 v[108:109], v[108:109], v[72:73]
v_pk_add_f32 v[110:111], v[110:111], v[232:233]
v_pk_add_f32 v[108:109], v[108:109], v[74:75]
v_pk_add_f32 v[110:111], v[110:111], v[234:235]
v_add_f32 v101, v108, v109
v_add_f32 v105, v110, v111
v_pk_add_f32 v[108:109], v[76:77], v[78:79]
v_pk_add_f32 v[110:111], v[236:237], v[238:239]
v_pk_add_f32 v[108:109], v[108:109], v[80:81]
v_pk_add_f32 v[110:111], v[110:111], v[240:241]
v_pk_add_f32 v[108:109], v[108:109], v[82:83]
v_pk_add_f32 v[110:111], v[110:111], v[242:243]
v_add_f32 v102, v108, v109
v_add_f32 v106, v110, v111
v_pk_add_f32 v[108:109], v[84:85], v[86:87]
v_pk_add_f32 v[110:111], v[244:245], v[246:247]
v_pk_add_f32 v[108:109], v[108:109], v[88:89]
v_pk_add_f32 v[110:111], v[110:111], v[248:249]
v_pk_add_f32 v[108:109], v[108:109], v[90:91]
v_pk_add_f32 v[110:111], v[110:111], v[250:251]
v_add_f32 v103, v108, v109
v_add_f32 v107, v110, v111
s_nop 1
v_permlane32_swap_b32 v100, v101
v_permlane32_swap_b32 v102, v103
v_permlane32_swap_b32 v104, v105
v_permlane32_swap_b32 v106, v107
v_add_f32 v100, v100, v101
v_add_f32 v102, v102, v103
v_add_f32 v104, v104, v105
v_add_f32 v106, v106, v107
v_permlane16_swap_b32 v100, v102
s_nop 0
v_permlane16_swap_b32 v104, v106
v_add_f32 v100, v100, v102
v_add_f32 v104, v104, v106
v_rcp_f32 v100, v100
v_rcp_f32 v104, v104
s_nop 0
v_mov_b32 v102, v100
v_mov_b32 v106, v104
s_nop 0
v_permlane16_swap_b32 v100, v102
v_permlane16_swap_b32 v104, v106
v_mov_b32 v101, v100
v_mov_b32 v103, v102
v_mov_b32 v105, v104
v_mov_b32 v107, v106
v_permlane32_swap_b32 v100, v101
v_permlane32_swap_b32 v102, v103
v_permlane32_swap_b32 v104, v105
v_permlane32_swap_b32 v106, v107
.p2align 3
v_pk_mul_f32 v[60:61], v[60:61], v[100:101] op_sel:[0,0] op_sel_hi:[1,0]
v_pk_mul_f32 v[62:63], v[62:63], v[100:101] op_sel:[0,0] op_sel_hi:[1,0]
v_pk_mul_f32 v[64:65], v[64:65], v[100:101] op_sel:[0,0] op_sel_hi:[1,0]
v_pk_mul_f32 v[66:67], v[66:67], v[100:101] op_sel:[0,0] op_sel_hi:[1,0]
v_pk_mul_f32 v[220:221], v[220:221], v[104:105] op_sel:[0,0] op_sel_hi:[1,0]
v_pk_mul_f32 v[222:223], v[222:223], v[104:105] op_sel:[0,0] op_sel_hi:[1,0]
v_pk_mul_f32 v[224:225], v[224:225], v[104:105] op_sel:[0,0] op_sel_hi:[1,0]
v_pk_mul_f32 v[226:227], v[226:227], v[104:105] op_sel:[0,0] op_sel_hi:[1,0]
v_cvt_pk_bf16_f32 v60, v60, v61
v_cvt_pk_bf16_f32 v61, v62, v63
v_cvt_pk_bf16_f32 v62, v64, v65
v_cvt_pk_bf16_f32 v63, v66, v67
v_cvt_pk_bf16_f32 v220, v220, v221
v_cvt_pk_bf16_f32 v221, v222, v223
v_cvt_pk_bf16_f32 v222, v224, v225
v_cvt_pk_bf16_f32 v223, v226, v227
v_pk_mul_f32 v[68:69], v[68:69], v[100:101] op_sel:[0,1] op_sel_hi:[1,1]
v_pk_mul_f32 v[70:71], v[70:71], v[100:101] op_sel:[0,1] op_sel_hi:[1,1]
v_pk_mul_f32 v[72:73], v[72:73], v[100:101] op_sel:[0,1] op_sel_hi:[1,1]
v_pk_mul_f32 v[74:75], v[74:75], v[100:101] op_sel:[0,1] op_sel_hi:[1,1]
v_pk_mul_f32 v[228:229], v[228:229], v[104:105] op_sel:[0,1] op_sel_hi:[1,1]
v_pk_mul_f32 v[230:231], v[230:231], v[104:105] op_sel:[0,1] op_sel_hi:[1,1]
v_pk_mul_f32 v[232:233], v[232:233], v[104:105] op_sel:[0,1] op_sel_hi:[1,1]
v_pk_mul_f32 v[234:235], v[234:235], v[104:105] op_sel:[0,1] op_sel_hi:[1,1]
v_cvt_pk_bf16_f32 v68, v68, v69
v_mfma_f32_16x16x32_bf16 v[204:207], v[60:63], v[38:41], 0
v_cvt_pk_bf16_f32 v69, v70, v71
v_cvt_pk_bf16_f32 v70, v72, v73
v_mfma_f32_16x16x32_bf16 v[208:211], v[60:63], v[36:39], 0
v_cvt_pk_bf16_f32 v71, v74, v75
v_cvt_pk_bf16_f32 v228, v228, v229
v_mfma_f32_16x16x32_bf16 v[212:215], v[220:223], v[38:41], 0
v_cvt_pk_bf16_f32 v229, v230, v231
v_cvt_pk_bf16_f32 v230, v232, v233
v_mfma_f32_16x16x32_bf16 v[216:219], v[220:223], v[36:39], 0
v_cvt_pk_bf16_f32 v231, v234, v235
v_pk_mul_f32 v[76:77], v[76:77], v[102:103] op_sel:[0,0] op_sel_hi:[1,0]
v_pk_mul_f32 v[78:79], v[78:79], v[102:103] op_sel:[0,0] op_sel_hi:[1,0]
v_pk_mul_f32 v[80:81], v[80:81], v[102:103] op_sel:[0,0] op_sel_hi:[1,0]
v_pk_mul_f32 v[82:83], v[82:83], v[102:103] op_sel:[0,0] op_sel_hi:[1,0]
v_pk_mul_f32 v[236:237], v[236:237], v[106:107] op_sel:[0,0] op_sel_hi:[1,0]
v_pk_mul_f32 v[238:239], v[238:239], v[106:107] op_sel:[0,0] op_sel_hi:[1,0]
v_pk_mul_f32 v[240:241], v[240:241], v[106:107] op_sel:[0,0] op_sel_hi:[1,0]
v_pk_mul_f32 v[242:243], v[242:243], v[106:107] op_sel:[0,0] op_sel_hi:[1,0]
v_cvt_pk_bf16_f32 v76, v76, v77
v_mfma_f32_16x16x32_bf16 v[188:191], v[68:71], v[38:41], 0
v_mfma_f32_16x16x32_bf16 v[192:195], v[68:71], v[36:39], 0
v_cvt_pk_bf16_f32 v77, v78, v79
v_mfma_f32_16x16x32_bf16 v[196:199], v[228:231], v[38:41], 0
v_cvt_pk_bf16_f32 v78, v80, v81
v_mfma_f32_16x16x32_bf16 v[200:203], v[228:231], v[36:39], 0
v_cvt_pk_bf16_f32 v64, v204, v205
v_cvt_pk_bf16_f32 v79, v82, v83
v_cvt_pk_bf16_f32 v65, v206, v207
v_cvt_pk_bf16_f32 v236, v236, v237
v_cvt_pk_bf16_f32 v72, v208, v209
v_cvt_pk_bf16_f32 v73, v210, v211
v_cvt_pk_bf16_f32 v237, v238, v239
v_cvt_pk_bf16_f32 v224, v212, v213
v_cvt_pk_bf16_f32 v238, v240, v241
v_cvt_pk_bf16_f32 v225, v214, v215
v_cvt_pk_bf16_f32 v232, v216, v217
v_cvt_pk_bf16_f32 v239, v242, v243
v_cvt_pk_bf16_f32 v233, v218, v219
v_pk_mul_f32 v[84:85], v[84:85], v[102:103] op_sel:[0,1] op_sel_hi:[1,1]
v_pk_mul_f32 v[86:87], v[86:87], v[102:103] op_sel:[0,1] op_sel_hi:[1,1]
v_pk_mul_f32 v[88:89], v[88:89], v[102:103] op_sel:[0,1] op_sel_hi:[1,1]
v_pk_mul_f32 v[90:91], v[90:91], v[102:103] op_sel:[0,1] op_sel_hi:[1,1]
v_pk_mul_f32 v[244:245], v[244:245], v[106:107] op_sel:[0,1] op_sel_hi:[1,1]
v_pk_mul_f32 v[246:247], v[246:247], v[106:107] op_sel:[0,1] op_sel_hi:[1,1]
v_pk_mul_f32 v[248:249], v[248:249], v[106:107] op_sel:[0,1] op_sel_hi:[1,1]
v_pk_mul_f32 v[250:251], v[250:251], v[106:107] op_sel:[0,1] op_sel_hi:[1,1]
v_cvt_pk_bf16_f32 v84, v84, v85
v_mfma_f32_16x16x32_bf16 v[204:207], v[76:79], v[38:41], 0
v_mfma_f32_16x16x32_bf16 v[208:211], v[76:79], v[36:39], 0
v_cvt_pk_bf16_f32 v85, v86, v87
v_mfma_f32_16x16x32_bf16 v[212:215], v[236:239], v[38:41], 0
v_cvt_pk_bf16_f32 v86, v88, v89
v_mfma_f32_16x16x32_bf16 v[216:219], v[236:239], v[36:39], 0
v_cvt_pk_bf16_f32 v66, v188, v189
v_cvt_pk_bf16_f32 v87, v90, v91
v_cvt_pk_bf16_f32 v67, v190, v191
v_cvt_pk_bf16_f32 v244, v244, v245
v_cvt_pk_bf16_f32 v74, v192, v193
v_cvt_pk_bf16_f32 v75, v194, v195
v_cvt_pk_bf16_f32 v245, v246, v247
v_cvt_pk_bf16_f32 v226, v196, v197
v_cvt_pk_bf16_f32 v246, v248, v249
v_cvt_pk_bf16_f32 v227, v198, v199
v_cvt_pk_bf16_f32 v234, v200, v201
v_cvt_pk_bf16_f32 v247, v250, v251
v_cvt_pk_bf16_f32 v235, v202, v203
v_mov_b32 v5, 2
v_cmp_eq_u32 s[50:51], s41, v2
v_mfma_f32_16x16x32_bf16 v[188:191], v[84:87], v[38:41], 0
v_mfma_f32_16x16x32_bf16 v[192:195], v[84:87], v[36:39], 0
v_mfma_f32_16x16x32_bf16 v[196:199], v[244:247], v[38:41], 0
v_mfma_f32_16x16x32_bf16 v[200:203], v[244:247], v[36:39], 0
v_mfma_f32_16x16x32_bf16 v[152:155], v[224:227], v[112:115], 0
v_cvt_pk_bf16_f32 v80, v204, v205
v_cvt_pk_bf16_f32 v81, v206, v207
v_mfma_f32_16x16x32_bf16 v[60:63], v[232:235], v[112:115], 0
v_cvt_pk_bf16_f32 v88, v208, v209
v_mfma_f32_16x16x32_bf16 v[68:71], v[224:227], v[120:123], 0
v_cvt_pk_bf16_f32 v89, v210, v211
v_mfma_f32_16x16x32_bf16 v[220:223], v[232:235], v[120:123], 0
v_cvt_pk_bf16_f32 v240, v212, v213
v_cvt_pk_bf16_f32 v241, v214, v215
v_mfma_f32_16x16x32_bf16 v[228:231], v[224:227], v[48:51], 0
v_cvt_pk_bf16_f32 v248, v216, v217
v_mfma_f32_16x16x32_bf16 v[76:79], v[232:235], v[48:51], 0
v_cvt_pk_bf16_f32 v249, v218, v219
v_mfma_f32_16x16x32_bf16 v[100:103], v[64:67], v[112:115], 0
v_cvt_pk_bf16_f32 v82, v188, v189
v_cvt_pk_bf16_f32 v83, v190, v191
v_mfma_f32_16x16x32_bf16 v[104:107], v[72:75], v[112:115], 0
v_cvt_pk_bf16_f32 v90, v192, v193
v_mfma_f32_16x16x32_bf16 v[108:111], v[64:67], v[120:123], 0
v_cvt_pk_bf16_f32 v91, v194, v195
v_mfma_f32_16x16x32_bf16 v[132:135], v[72:75], v[120:123], 0
v_cvt_pk_bf16_f32 v242, v196, v197
v_cvt_pk_bf16_f32 v243, v198, v199
v_mfma_f32_16x16x32_bf16 v[136:139], v[64:67], v[48:51], 0
v_cvt_pk_bf16_f32 v250, v200, v201
v_mfma_f32_16x16x32_bf16 v[148:151], v[72:75], v[48:51], 0
v_cvt_pk_bf16_f32 v251, v202, v203
s_nop 1
v_mfma_f32_16x16x32_bf16 v[152:155], v[240:243], v[116:119], v[152:155]
v_mfma_f32_16x16x32_bf16 v[60:63], v[248:251], v[116:119], v[60:63]
v_mfma_f32_16x16x32_bf16 v[68:71], v[240:243], v[124:127], v[68:71]
v_mfma_f32_16x16x32_bf16 v[220:223], v[248:251], v[124:127], v[220:223]
v_mfma_f32_16x16x32_bf16 v[228:231], v[240:243], v[48:51], v[228:231]
v_mfma_f32_16x16x32_bf16 v[76:79], v[248:251], v[48:51], v[76:79]
v_mfma_f32_16x16x32_bf16 v[100:103], v[80:83], v[116:119], v[100:103]
v_mfma_f32_16x16x32_bf16 v[104:107], v[88:91], v[116:119], v[104:107]
v_mfma_f32_16x16x32_bf16 v[108:111], v[80:83], v[124:127], v[108:111]
v_mfma_f32_16x16x32_bf16 v[132:135], v[88:91], v[124:127], v[132:135]
v_cvt_pk_bf16_f32 v152, v152, v153
v_cvt_pk_bf16_f32 v153, v154, v155
v_mfma_f32_16x16x32_bf16 v[136:139], v[80:83], v[48:51], v[136:139]
v_cvt_pk_bf16_f32 v154, v60, v61
v_cvt_pk_bf16_f32 v155, v62, v63
v_mfma_f32_16x16x32_bf16 v[148:151], v[88:91], v[48:51], v[148:151]
ds_write_b128 v42, v[152:155] offset:0
v_cvt_pk_bf16_f32 v68, v68, v69
v_cvt_pk_bf16_f32 v69, v70, v71
v_cvt_pk_bf16_f32 v70, v220, v221
v_cvt_pk_bf16_f32 v71, v222, v223
ds_write_b128 v42, v[68:71] offset:1024
v_cvt_pk_bf16_f32 v228, v228, v229
v_cvt_pk_bf16_f32 v229, v230, v231
v_cvt_pk_bf16_f32 v230, v76, v77
v_cvt_pk_bf16_f32 v231, v78, v79
ds_write_b128 v42, v[228:231] offset:2048
ds_write_b32 v52, v5
s_mov_b32 s63, 0
px_59:
ds_read_b32 v4, v19
ds_read_b128 v[188:191], v43 offset:0
ds_read_b128 v[192:195], v43 offset:1024
ds_read_b128 v[196:199], v43 offset:2048
s_add_u32 s63, s63, 1
s_cmp_lt_u32 s63, 0x400000
s_waitcnt lgkmcnt(0)
v_cmp_ne_u32 vcc, 2, v4
s_cbranch_vccz pxd_60
s_cbranch_scc1 px_59
pxd_60:
v_mfma_f32_16x16x32_bf16 v[100:103], v[38:41], v[188:191], v[100:103]
v_mfma_f32_16x16x32_bf16 v[104:107], v[36:39], v[188:191], v[104:107]
v_mfma_f32_16x16x32_bf16 v[108:111], v[38:41], v[192:195], v[108:111]
v_mfma_f32_16x16x32_bf16 v[132:135], v[36:39], v[192:195], v[132:135]
v_mfma_f32_16x16x32_bf16 v[136:139], v[38:41], v[196:199], v[136:139]
v_mfma_f32_16x16x32_bf16 v[148:151], v[36:39], v[196:199], v[148:151]
s_nop 2
v_cvt_pk_bf16_f32 v100, v100, v101
v_cvt_pk_bf16_f32 v101, v102, v103
v_cvt_pk_bf16_f32 v102, v104, v105
v_cvt_pk_bf16_f32 v103, v106, v107
buffer_store_dwordx4 v[100:103], v55, s[32:35], s53 offen sc1
v_cvt_pk_bf16_f32 v108, v108, v109
v_cvt_pk_bf16_f32 v109, v110, v111
v_cvt_pk_bf16_f32 v110, v132, v133
v_cvt_pk_bf16_f32 v111, v134, v135
buffer_store_dwordx4 v[108:111], v55, s[32:35], s54 offen sc1
v_cvt_pk_bf16_f32 v136, v136, v137
v_cvt_pk_bf16_f32 v137, v138, v139
v_cvt_pk_bf16_f32 v138, v148, v149
v_cvt_pk_bf16_f32 v139, v150, v151
s_mov_b64 exec, s[50:51]
buffer_store_dwordx4 v[136:139], v58, s[32:35], s56 offen sc1
s_mov_b64 exec, -1
s_mov_b32 s51, 0
.p2align 3
v_pk_fma_f32 v[156:157], v[140:141], v[92:93], v[156:157] op_sel:[0,1,0] op_sel_hi:[1,1,1]
v_pk_fma_f32 v[158:159], v[142:143], v[92:93], v[158:159] op_sel:[0,1,0] op_sel_hi:[1,1,1]
v_pk_fma_f32 v[160:161], v[144:145], v[92:93], v[160:161] op_sel:[0,1,0] op_sel_hi:[1,1,1]
v_pk_fma_f32 v[162:163], v[146:147], v[92:93], v[162:163] op_sel:[0,1,0] op_sel_hi:[1,1,1]
v_cvt_pk_bf16_f32 v156, v156, v157
v_cvt_pk_bf16_f32 v157, v158, v159
v_cvt_pk_bf16_f32 v158, v160, v161
v_cvt_pk_bf16_f32 v159, v162, v163
v_pk_fma_f32 v[164:165], v[140:141], v[94:95], v[164:165] op_sel:[0,1,0] op_sel_hi:[1,1,1]
v_pk_fma_f32 v[166:167], v[142:143], v[94:95], v[166:167] op_sel:[0,1,0] op_sel_hi:[1,1,1]
v_pk_fma_f32 v[168:169], v[144:145], v[94:95], v[168:169] op_sel:[0,1,0] op_sel_hi:[1,1,1]
v_pk_fma_f32 v[170:171], v[146:147], v[94:95], v[170:171] op_sel:[0,1,0] op_sel_hi:[1,1,1]
v_cvt_pk_bf16_f32 v164, v164, v165
v_mfma_f32_16x16x32_bf16 v[60:63], v[10:13], v[156:159], 0
v_cvt_pk_bf16_f32 v165, v166, v167
v_cvt_pk_bf16_f32 v166, v168, v169
v_mfma_f32_16x16x32_bf16 v[64:67], v[14:17], v[156:159], 0
v_cvt_pk_bf16_f32 v167, v170, v171
v_pk_fma_f32 v[172:173], v[140:141], v[96:97], v[172:173] op_sel:[0,1,0] op_sel_hi:[1,1,1]
v_pk_fma_f32 v[174:175], v[142:143], v[96:97], v[174:175] op_sel:[0,1,0] op_sel_hi:[1,1,1]
v_pk_fma_f32 v[176:177], v[144:145], v[96:97], v[176:177] op_sel:[0,1,0] op_sel_hi:[1,1,1]
v_pk_fma_f32 v[178:179], v[146:147], v[96:97], v[178:179] op_sel:[0,1,0] op_sel_hi:[1,1,1]
v_cvt_pk_bf16_f32 v172, v172, v173
v_mfma_f32_16x16x32_bf16 v[68:71], v[10:13], v[164:167], 0
v_cvt_pk_bf16_f32 v173, v174, v175
v_cvt_pk_bf16_f32 v174, v176, v177
v_mfma_f32_16x16x32_bf16 v[72:75], v[14:17], v[164:167], 0
v_cvt_pk_bf16_f32 v175, v178, v179
v_pk_fma_f32 v[180:181], v[140:141], v[98:99], v[180:181] op_sel:[0,1,0] op_sel_hi:[1,1,1]
v_pk_fma_f32 v[182:183], v[142:143], v[98:99], v[182:183] op_sel:[0,1,0] op_sel_hi:[1,1,1]
v_pk_fma_f32 v[184:185], v[144:145], v[98:99], v[184:185] op_sel:[0,1,0] op_sel_hi:[1,1,1]
v_pk_fma_f32 v[186:187], v[146:147], v[98:99], v[186:187] op_sel:[0,1,0] op_sel_hi:[1,1,1]
v_cvt_pk_bf16_f32 v180, v180, v181
v_mfma_f32_16x16x32_bf16 v[76:79], v[10:13], v[172:175], 0
v_cvt_pk_bf16_f32 v181, v182, v183
v_cvt_pk_bf16_f32 v182, v184, v185
v_mfma_f32_16x16x32_bf16 v[80:83], v[14:17], v[172:175], 0
v_cvt_pk_bf16_f32 v183, v186, v187
s_nop 1
v_mfma_f32_16x16x32_bf16 v[84:87], v[10:13], v[180:183], 0
v_mfma_f32_16x16x32_bf16 v[88:91], v[14:17], v[180:183], 0
v_max3_f32 v100, v60, v61, v62
v_min3_f32 v104, v60, v61, v62
v_max3_f32 v100, v100, v63, v64
v_min3_f32 v104, v104, v63, v64
v_max3_f32 v100, v100, v65, v66
v_min3_f32 v104, v104, v65, v66
v_max_f32 v100, v100, v67
v_min_f32 v104, v104, v67
v_max3_f32 v101, v68, v69, v70
v_min3_f32 v105, v68, v69, v70
v_max3_f32 v101, v101, v71, v72
v_min3_f32 v105, v105, v71, v72
v_max3_f32 v101, v101, v73, v74
v_min3_f32 v105, v105, v73, v74
v_max_f32 v101, v101, v75
v_min_f32 v105, v105, v75
v_max3_f32 v102, v76, v77, v78
v_min3_f32 v106, v76, v77, v78
v_max3_f32 v102, v102, v79, v80
v_min3_f32 v106, v106, v79, v80
v_max3_f32 v102, v102, v81, v82
v_min3_f32 v106, v106, v81, v82
v_max_f32 v102, v102, v83
v_min_f32 v106, v106, v83
v_max3_f32 v103, v84, v85, v86
v_min3_f32 v107, v84, v85, v86
v_max3_f32 v103, v103, v87, v88
v_min3_f32 v107, v107, v87, v88
v_max3_f32 v103, v103, v89, v90
v_min3_f32 v107, v107, v89, v90
v_max_f32 v103, v103, v91
v_min_f32 v107, v107, v91
s_nop 1
v_permlane32_swap_b32 v100, v101
v_permlane32_swap_b32 v102, v103
v_permlane32_swap_b32 v104, v105
v_permlane32_swap_b32 v106, v107
v_max_f32 v100, v100, v101
v_max_f32 v102, v102, v103
v_min_f32 v104, v104, v105
v_min_f32 v106, v106, v107
v_permlane16_swap_b32 v100, v102
s_nop 0
v_permlane16_swap_b32 v104, v106
v_max_f32 v100, v100, v102
v_min_f32 v104, v104, v106
v_mov_b32 v102, v100
v_mov_b32 v106, v104
s_nop 0
v_permlane16_swap_b32 v100, v102
v_permlane16_swap_b32 v104, v106
v_mov_b32 v101, v100
v_mov_b32 v103, v102
v_mov_b32 v105, v104
v_mov_b32 v107, v106
v_permlane32_swap_b32 v100, v101
v_permlane32_swap_b32 v102, v103
v_permlane32_swap_b32 v104, v105
v_permlane32_swap_b32 v106, v107
v_pk_mul_f32 v[100:101], v[100:101], v[128:129]
v_pk_mul_f32 v[102:103], v[102:103], v[130:131]
v_pk_mul_f32 v[104:105], v[104:105], v[128:129]
v_pk_mul_f32 v[106:107], v[106:107], v[130:131]
v_pk_fma_f32 v[220:221], v[60:61], v[128:129], v[104:105] op_sel:[0,0,0] op_sel_hi:[1,0,0] neg_lo:[1,0,0] neg_hi:[1,0,0]
v_pk_fma_f32 v[60:61], v[60:61], v[128:129], v[100:101] op_sel:[0,0,0] op_sel_hi:[1,0,0] neg_lo:[0,0,1] neg_hi:[0,0,1]
v_exp_f32 v220, v220
v_exp_f32 v60, v60
v_exp_f32 v221, v221
v_exp_f32 v61, v61
v_pk_fma_f32 v[222:223], v[62:63], v[128:129], v[104:105] op_sel:[0,0,0] op_sel_hi:[1,0,0] neg_lo:[1,0,0] neg_hi:[1,0,0]
v_pk_fma_f32 v[62:63], v[62:63], v[128:129], v[100:101] op_sel:[0,0,0] op_sel_hi:[1,0,0] neg_lo:[0,0,1] neg_hi:[0,0,1]
v_exp_f32 v222, v222
v_exp_f32 v62, v62
v_exp_f32 v223, v223
v_exp_f32 v63, v63
v_pk_fma_f32 v[224:225], v[64:65], v[128:129], v[104:105] op_sel:[0,0,0] op_sel_hi:[1,0,0] neg_lo:[1,0,0] neg_hi:[1,0,0]
v_pk_fma_f32 v[64:65], v[64:65], v[128:129], v[100:101] op_sel:[0,0,0] op_sel_hi:[1,0,0] neg_lo:[0,0,1] neg_hi:[0,0,1]
v_exp_f32 v224, v224
v_exp_f32 v64, v64
v_exp_f32 v225, v225
v_exp_f32 v65, v65
v_pk_fma_f32 v[226:227], v[66:67], v[128:129], v[104:105] op_sel:[0,0,0] op_sel_hi:[1,0,0] neg_lo:[1,0,0] neg_hi:[1,0,0]
v_pk_fma_f32 v[66:67], v[66:67], v[128:129], v[100:101] op_sel:[0,0,0] op_sel_hi:[1,0,0] neg_lo:[0,0,1] neg_hi:[0,0,1]
v_exp_f32 v226, v226
v_exp_f32 v66, v66
v_exp_f32 v227, v227
v_exp_f32 v67, v67
buffer_load_dwordx4 v[212:215], v18, s[32:35], s55 offen offset:0 sc1
buffer_load_dwordx4 v[216:219], v18, s[32:35], s55 offen offset:1024 sc1
v_pk_fma_f32 v[228:229], v[68:69], v[128:129], v[104:105] op_sel:[0,1,1] op_sel_hi:[1,1,1] neg_lo:[1,0,0] neg_hi:[1,0,0]
v_pk_fma_f32 v[68:69], v[68:69], v[128:129], v[100:101] op_sel:[0,1,1] op_sel_hi:[1,1,1] neg_lo:[0,0,1] neg_hi:[0,0,1]
v_exp_f32 v228, v228
v_exp_f32 v68, v68
v_exp_f32 v229, v229
v_exp_f32 v69, v69
v_pk_fma_f32 v[230:231], v[70:71], v[128:129], v[104:105] op_sel:[0,1,1] op_sel_hi:[1,1,1] neg_lo:[1,0,0] neg_hi:[1,0,0]
v_pk_fma_f32 v[70:71], v[70:71], v[128:129], v[100:101] op_sel:[0,1,1] op_sel_hi:[1,1,1] neg_lo:[0,0,1] neg_hi:[0,0,1]
v_exp_f32 v230, v230
v_exp_f32 v70, v70
v_exp_f32 v231, v231
v_exp_f32 v71, v71
v_pk_fma_f32 v[232:233], v[72:73], v[128:129], v[104:105] op_sel:[0,1,1] op_sel_hi:[1,1,1] neg_lo:[1,0,0] neg_hi:[1,0,0]
v_pk_fma_f32 v[72:73], v[72:73], v[128:129], v[100:101] op_sel:[0,1,1] op_sel_hi:[1,1,1] neg_lo:[0,0,1] neg_hi:[0,0,1]
v_exp_f32 v232, v232
v_exp_f32 v72, v72
v_exp_f32 v233, v233
v_exp_f32 v73, v73
v_pk_fma_f32 v[234:235], v[74:75], v[128:129], v[104:105] op_sel:[0,1,1] op_sel_hi:[1,1,1] neg_lo:[1,0,0] neg_hi:[1,0,0]
v_pk_fma_f32 v[74:75], v[74:75], v[128:129], v[100:101] op_sel:[0,1,1] op_sel_hi:[1,1,1] neg_lo:[0,0,1] neg_hi:[0,0,1]
v_exp_f32 v234, v234
v_exp_f32 v74, v74
v_exp_f32 v235, v235
v_exp_f32 v75, v75
v_pk_fma_f32 v[236:237], v[76:77], v[130:131], v[106:107] op_sel:[0,0,0] op_sel_hi:[1,0,0] neg_lo:[1,0,0] neg_hi:[1,0,0]
v_pk_fma_f32 v[76:77], v[76:77], v[130:131], v[102:103] op_sel:[0,0,0] op_sel_hi:[1,0,0] neg_lo:[0,0,1] neg_hi:[0,0,1]
v_exp_f32 v236, v236
v_exp_f32 v76, v76
v_exp_f32 v237, v237
v_exp_f32 v77, v77
v_pk_fma_f32 v[238:239], v[78:79], v[130:131], v[106:107] op_sel:[0,0,0] op_sel_hi:[1,0,0] neg_lo:[1,0,0] neg_hi:[1,0,0]
v_pk_fma_f32 v[78:79], v[78:79], v[130:131], v[102:103] op_sel:[0,0,0] op_sel_hi:[1,0,0] neg_lo:[0,0,1] neg_hi:[0,0,1]
v_exp_f32 v238, v238
v_exp_f32 v78, v78
v_exp_f32 v239, v239
v_exp_f32 v79, v79
v_pk_fma_f32 v[240:241], v[80:81], v[130:131], v[106:107] op_sel:[0,0,0] op_sel_hi:[1,0,0] neg_lo:[1,0,0] neg_hi:[1,0,0]
v_pk_fma_f32 v[80:81], v[80:81], v[130:131], v[102:103] op_sel:[0,0,0] op_sel_hi:[1,0,0] neg_lo:[0,0,1] neg_hi:[0,0,1]
v_exp_f32 v240, v240
v_exp_f32 v80, v80
v_exp_f32 v241, v241
v_exp_f32 v81, v81
v_pk_fma_f32 v[242:243], v[82:83], v[130:131], v[106:107] op_sel:[0,0,0] op_sel_hi:[1,0,0] neg_lo:[1,0,0] neg_hi:[1,0,0]
v_pk_fma_f32 v[82:83], v[82:83], v[130:131], v[102:103] op_sel:[0,0,0] op_sel_hi:[1,0,0] neg_lo:[0,0,1] neg_hi:[0,0,1]
v_exp_f32 v242, v242
v_exp_f32 v82, v82
v_exp_f32 v243, v243
v_exp_f32 v83, v83
v_pk_fma_f32 v[244:245], v[84:85], v[130:131], v[106:107] op_sel:[0,1,1] op_sel_hi:[1,1,1] neg_lo:[1,0,0] neg_hi:[1,0,0]
v_pk_fma_f32 v[84:85], v[84:85], v[130:131], v[102:103] op_sel:[0,1,1] op_sel_hi:[1,1,1] neg_lo:[0,0,1] neg_hi:[0,0,1]
v_exp_f32 v244, v244
v_exp_f32 v84, v84
v_exp_f32 v245, v245
v_exp_f32 v85, v85
v_pk_fma_f32 v[246:247], v[86:87], v[130:131], v[106:107] op_sel:[0,1,1] op_sel_hi:[1,1,1] neg_lo:[1,0,0] neg_hi:[1,0,0]
v_pk_fma_f32 v[86:87], v[86:87], v[130:131], v[102:103] op_sel:[0,1,1] op_sel_hi:[1,1,1] neg_lo:[0,0,1] neg_hi:[0,0,1]
v_exp_f32 v246, v246
v_exp_f32 v86, v86
v_exp_f32 v247, v247
v_exp_f32 v87, v87
v_pk_fma_f32 v[248:249], v[88:89], v[130:131], v[106:107] op_sel:[0,1,1] op_sel_hi:[1,1,1] neg_lo:[1,0,0] neg_hi:[1,0,0]
v_pk_fma_f32 v[88:89], v[88:89], v[130:131], v[102:103] op_sel:[0,1,1] op_sel_hi:[1,1,1] neg_lo:[0,0,1] neg_hi:[0,0,1]
v_exp_f32 v248, v248
v_exp_f32 v88, v88
v_exp_f32 v249, v249
v_exp_f32 v89, v89
v_pk_fma_f32 v[250:251], v[90:91], v[130:131], v[106:107] op_sel:[0,1,1] op_sel_hi:[1,1,1] neg_lo:[1,0,0] neg_hi:[1,0,0]
v_pk_fma_f32 v[90:91], v[90:91], v[130:131], v[102:103] op_sel:[0,1,1] op_sel_hi:[1,1,1] neg_lo:[0,0,1] neg_hi:[0,0,1]
v_exp_f32 v250, v250
v_exp_f32 v90, v90
v_exp_f32 v251, v251
v_exp_f32 v91, v91
s_cmp_eq_u32 s51, 1
s_cbranch_scc1 chk_61
s_waitcnt vmcnt(0)
v_max_u32 v4, v212, v213
v_max3_u32 v4, v4, v214, v215
v_max3_u32 v4, v4, v216, v217
v_max3_u32 v4, v4, v218, v219
v_cmp_eq_u32 vcc, -1, v4
s_cbranch_vccz red_62
buffer_load_dwordx4 v[212:215], v18, s[32:35], s55 offen offset:0 sc1
buffer_load_dwordx4 v[216:219], v18, s[32:35], s55 offen offset:1024 sc1
s_branch chk_61
red_62:
v_mfma_f32_16x16x32_bf16 v[132:135], v[44:47], v[212:215], 0
v_mfma_f32_16x16x32_bf16 v[132:135], v[44:47], v[216:219], v[132:135]
s_mov_b32 s51, 1
s_nop 6
v_add_f32_dpp v132, v132, v132 row_ror:8 row_mask:0xf bank_mask:0xf
v_add_f32_dpp v133, v133, v133 row_ror:8 row_mask:0xf bank_mask:0xf
v_add_f32_dpp v134, v134, v134 row_ror:8 row_mask:0xf bank_mask:0xf
v_add_f32_dpp v135, v135, v135 row_ror:8 row_mask:0xf bank_mask:0xf
v_cvt_pk_bf16_f32 v132, v132, v133
v_cvt_pk_bf16_f32 v133, v134, v135
s_mov_b64 exec, 0x00ff00ff
buffer_store_dwordx2 v[132:133], v59, s[32:35], s79 offen sc1
s_mov_b64 exec, -1
buffer_load_dwordx4 v[204:207], v58, s[32:35], s56 offen sc1
buffer_load_dwordx4 v[208:211], v58, s[32:35], s57 offen sc1
chk_61:
v_pk_add_f32 v[108:109], v[60:61], v[62:63]
v_pk_add_f32 v[110:111], v[220:221], v[222:223]
v_pk_add_f32 v[108:109], v[108:109], v[64:65]
v_pk_add_f32 v[110:111], v[110:111], v[224:225]
v_pk_add_f32 v[108:109], v[108:109], v[66:67]
v_pk_add_f32 v[110:111], v[110:111], v[226:227]
v_add_f32 v100, v108, v109
v_add_f32 v104, v110, v111
v_pk_add_f32 v[108:109], v[68:69], v[70:71]
v_pk_add_f32 v[110:111], v[228:229], v[230:231]
v_pk_add_f32 v[108:109], v[108:109], v[72:73]
v_pk_add_f32 v[110:111], v[110:111], v[232:233]
v_pk_add_f32 v[108:109], v[108:109], v[74:75]
v_pk_add_f32 v[110:111], v[110:111], v[234:235]
v_add_f32 v101, v108, v109
v_add_f32 v105, v110, v111
v_pk_add_f32 v[108:109], v[76:77], v[78:79]
v_pk_add_f32 v[110:111], v[236:237], v[238:239]
v_pk_add_f32 v[108:109], v[108:109], v[80:81]
v_pk_add_f32 v[110:111], v[110:111], v[240:241]
v_pk_add_f32 v[108:109], v[108:109], v[82:83]
v_pk_add_f32 v[110:111], v[110:111], v[242:243]
v_add_f32 v102, v108, v109
v_add_f32 v106, v110, v111
v_pk_add_f32 v[108:109], v[84:85], v[86:87]
v_pk_add_f32 v[110:111], v[244:245], v[246:247]
v_pk_add_f32 v[108:109], v[108:109], v[88:89]
v_pk_add_f32 v[110:111], v[110:111], v[248:249]
v_pk_add_f32 v[108:109], v[108:109], v[90:91]
v_pk_add_f32 v[110:111], v[110:111], v[250:251]
v_add_f32 v103, v108, v109
v_add_f32 v107, v110, v111
s_nop 1
v_permlane32_swap_b32 v100, v101
v_permlane32_swap_b32 v102, v103
v_permlane32_swap_b32 v104, v105
v_permlane32_swap_b32 v106, v107
v_add_f32 v100, v100, v101
v_add_f32 v102, v102, v103
v_add_f32 v104, v104, v105
v_add_f32 v106, v106, v107
v_permlane16_swap_b32 v100, v102
s_nop 0
v_permlane16_swap_b32 v104, v106
v_add_f32 v100, v100, v102
v_add_f32 v104, v104, v106
v_rcp_f32 v100, v100
v_rcp_f32 v104, v104
s_nop 0
v_mov_b32 v102, v100
v_mov_b32 v106, v104
s_nop 0
v_permlane16_swap_b32 v100, v102
v_permlane16_swap_b32 v104, v106
v_mov_b32 v101, v100
v_mov_b32 v103, v102
v_mov_b32 v105, v104
v_mov_b32 v107, v106
v_permlane32_swap_b32 v100, v101
v_permlane32_swap_b32 v102, v103
v_permlane32_swap_b32 v104, v105
v_permlane32_swap_b32 v106, v107
s_cmp_eq_u32 s51, 1
s_cbranch_scc1 chk_63
s_waitcnt vmcnt(0)
v_max_u32 v4, v212, v213
v_max3_u32 v4, v4, v214, v215
v_max3_u32 v4, v4, v216, v217
v_max3_u32 v4, v4, v218, v219
v_cmp_eq_u32 vcc, -1, v4
s_cbranch_vccz red_64
buffer_load_dwordx4 v[212:215], v18, s[32:35], s55 offen offset:0 sc1
buffer_load_dwordx4 v[216:219], v18, s[32:35], s55 offen offset:1024 sc1
s_branch chk_63
red_64:
v_mfma_f32_16x16x32_bf16 v[132:135], v[44:47], v[212:215], 0
v_mfma_f32_16x16x32_bf16 v[132:135], v[44:47], v[216:219], v[132:135]
s_mov_b32 s51, 1
s_nop 6
v_add_f32_dpp v132, v132, v132 row_ror:8 row_mask:0xf bank_mask:0xf
v_add_f32_dpp v133, v133, v133 row_ror:8 row_mask:0xf bank_mask:0xf
v_add_f32_dpp v134, v134, v134 row_ror:8 row_mask:0xf bank_mask:0xf
v_add_f32_dpp v135, v135, v135 row_ror:8 row_mask:0xf bank_mask:0xf
v_cvt_pk_bf16_f32 v132, v132, v133
v_cvt_pk_bf16_f32 v133, v134, v135
s_mov_b64 exec, 0x00ff00ff
buffer_store_dwordx2 v[132:133], v59, s[32:35], s79 offen sc1
s_mov_b64 exec, -1
buffer_load_dwordx4 v[204:207], v58, s[32:35], s56 offen sc1
buffer_load_dwordx4 v[208:211], v58, s[32:35], s57 offen sc1
chk_63:
.p2align 3
v_pk_mul_f32 v[60:61], v[60:61], v[100:101] op_sel:[0,0] op_sel_hi:[1,0]
v_pk_mul_f32 v[62:63], v[62:63], v[100:101] op_sel:[0,0] op_sel_hi:[1,0]
v_pk_mul_f32 v[64:65], v[64:65], v[100:101] op_sel:[0,0] op_sel_hi:[1,0]
v_pk_mul_f32 v[66:67], v[66:67], v[100:101] op_sel:[0,0] op_sel_hi:[1,0]
v_pk_mul_f32 v[220:221], v[220:221], v[104:105] op_sel:[0,0] op_sel_hi:[1,0]
v_pk_mul_f32 v[222:223], v[222:223], v[104:105] op_sel:[0,0] op_sel_hi:[1,0]
v_pk_mul_f32 v[224:225], v[224:225], v[104:105] op_sel:[0,0] op_sel_hi:[1,0]
v_pk_mul_f32 v[226:227], v[226:227], v[104:105] op_sel:[0,0] op_sel_hi:[1,0]
v_cvt_pk_bf16_f32 v60, v60, v61
v_cvt_pk_bf16_f32 v61, v62, v63
v_cvt_pk_bf16_f32 v62, v64, v65
v_cvt_pk_bf16_f32 v63, v66, v67
v_cvt_pk_bf16_f32 v220, v220, v221
v_cvt_pk_bf16_f32 v221, v222, v223
v_cvt_pk_bf16_f32 v222, v224, v225
v_cvt_pk_bf16_f32 v223, v226, v227
v_pk_mul_f32 v[68:69], v[68:69], v[100:101] op_sel:[0,1] op_sel_hi:[1,1]
v_pk_mul_f32 v[70:71], v[70:71], v[100:101] op_sel:[0,1] op_sel_hi:[1,1]
v_pk_mul_f32 v[72:73], v[72:73], v[100:101] op_sel:[0,1] op_sel_hi:[1,1]
v_pk_mul_f32 v[74:75], v[74:75], v[100:101] op_sel:[0,1] op_sel_hi:[1,1]
v_pk_mul_f32 v[228:229], v[228:229], v[104:105] op_sel:[0,1] op_sel_hi:[1,1]
v_pk_mul_f32 v[230:231], v[230:231], v[104:105] op_sel:[0,1] op_sel_hi:[1,1]
v_pk_mul_f32 v[232:233], v[232:233], v[104:105] op_sel:[0,1] op_sel_hi:[1,1]
v_pk_mul_f32 v[234:235], v[234:235], v[104:105] op_sel:[0,1] op_sel_hi:[1,1]
v_cvt_pk_bf16_f32 v68, v68, v69
v_cvt_pk_bf16_f32 v69, v70, v71
v_cvt_pk_bf16_f32 v70, v72, v73
v_cvt_pk_bf16_f32 v71, v74, v75
v_cvt_pk_bf16_f32 v228, v228, v229
v_cvt_pk_bf16_f32 v229, v230, v231
v_cvt_pk_bf16_f32 v230, v232, v233
v_cvt_pk_bf16_f32 v231, v234, v235
v_pk_mul_f32 v[76:77], v[76:77], v[102:103] op_sel:[0,0] op_sel_hi:[1,0]
v_pk_mul_f32 v[78:79], v[78:79], v[102:103] op_sel:[0,0] op_sel_hi:[1,0]
v_pk_mul_f32 v[80:81], v[80:81], v[102:103] op_sel:[0,0] op_sel_hi:[1,0]
v_pk_mul_f32 v[82:83], v[82:83], v[102:103] op_sel:[0,0] op_sel_hi:[1,0]
v_pk_mul_f32 v[236:237], v[236:237], v[106:107] op_sel:[0,0] op_sel_hi:[1,0]
v_pk_mul_f32 v[238:239], v[238:239], v[106:107] op_sel:[0,0] op_sel_hi:[1,0]
v_pk_mul_f32 v[240:241], v[240:241], v[106:107] op_sel:[0,0] op_sel_hi:[1,0]
v_pk_mul_f32 v[242:243], v[242:243], v[106:107] op_sel:[0,0] op_sel_hi:[1,0]
v_cvt_pk_bf16_f32 v76, v76, v77
v_cvt_pk_bf16_f32 v77, v78, v79
v_cvt_pk_bf16_f32 v78, v80, v81
v_cvt_pk_bf16_f32 v79, v82, v83
v_cvt_pk_bf16_f32 v236, v236, v237
v_cvt_pk_bf16_f32 v237, v238, v239
v_cvt_pk_bf16_f32 v238, v240, v241
v_cvt_pk_bf16_f32 v239, v242, v243
v_pk_mul_f32 v[84:85], v[84:85], v[102:103] op_sel:[0,1] op_sel_hi:[1,1]
v_pk_mul_f32 v[86:87], v[86:87], v[102:103] op_sel:[0,1] op_sel_hi:[1,1]
v_pk_mul_f32 v[88:89], v[88:89], v[102:103] op_sel:[0,1] op_sel_hi:[1,1]
v_pk_mul_f32 v[90:91], v[90:91], v[102:103] op_sel:[0,1] op_sel_hi:[1,1]
v_pk_mul_f32 v[244:245], v[244:245], v[106:107] op_sel:[0,1] op_sel_hi:[1,1]
v_pk_mul_f32 v[246:247], v[246:247], v[106:107] op_sel:[0,1] op_sel_hi:[1,1]
v_pk_mul_f32 v[248:249], v[248:249], v[106:107] op_sel:[0,1] op_sel_hi:[1,1]
v_pk_mul_f32 v[250:251], v[250:251], v[106:107] op_sel:[0,1] op_sel_hi:[1,1]
v_cvt_pk_bf16_f32 v84, v84, v85
v_cvt_pk_bf16_f32 v85, v86, v87
v_cvt_pk_bf16_f32 v86, v88, v89
v_cvt_pk_bf16_f32 v87, v90, v91
v_cvt_pk_bf16_f32 v244, v244, v245
v_cvt_pk_bf16_f32 v245, v246, v247
v_cvt_pk_bf16_f32 v246, v248, v249
v_cvt_pk_bf16_f32 v247, v250, v251
s_cmp_lg_u32 s51, 0
s_cbranch_scc1 else_65
s_mov_b32 s63, 0
sent_67:
s_waitcnt vmcnt(0)
v_max_u32 v4, v212, v213
v_max3_u32 v4, v4, v214, v215
v_max3_u32 v4, v4, v216, v217
v_max3_u32 v4, v4, v218, v219
v_cmp_eq_u32 vcc, -1, v4
s_cbranch_vccz sentd_68
buffer_load_dwordx4 v[212:215], v18, s[32:35], s55 offen offset:0 sc1
buffer_load_dwordx4 v[216:219], v18, s[32:35], s55 offen offset:1024 sc1
s_add_u32 s63, s63, 1
s_cmp_lt_u32 s63, 0x80000
s_cbranch_scc1 sent_67
s_waitcnt vmcnt(0)
sentd_68:
v_mfma_f32_16x16x32_bf16 v[132:135], v[44:47], v[212:215], 0
v_mfma_f32_16x16x32_bf16 v[132:135], v[44:47], v[216:219], v[132:135]
s_mov_b32 s51, 1
s_nop 6
v_add_f32_dpp v132, v132, v132 row_ror:8 row_mask:0xf bank_mask:0xf
v_add_f32_dpp v133, v133, v133 row_ror:8 row_mask:0xf bank_mask:0xf
v_add_f32_dpp v134, v134, v134 row_ror:8 row_mask:0xf bank_mask:0xf
v_add_f32_dpp v135, v135, v135 row_ror:8 row_mask:0xf bank_mask:0xf
v_cvt_pk_bf16_f32 v132, v132, v133
v_cvt_pk_bf16_f32 v133, v134, v135
s_mov_b64 exec, 0x00ff00ff
buffer_store_dwordx2 v[132:133], v59, s[32:35], s79 offen sc1
s_mov_b64 exec, -1
buffer_load_dwordx4 v[204:207], v58, s[32:35], s56 offen sc1
buffer_load_dwordx4 v[208:211], v58, s[32:35], s57 offen sc1
else_65:
s_mov_b32 s63, 0
sent_69:
s_waitcnt vmcnt(0)
v_max_u32 v4, v204, v205
v_max3_u32 v4, v4, v206, v207
v_max3_u32 v4, v4, v208, v209
v_max3_u32 v4, v4, v210, v211
v_cmp_eq_u32 vcc, -1, v4
s_cbranch_vccz sentd_70
buffer_load_dwordx4 v[204:207], v58, s[32:35], s56 offen sc1
buffer_load_dwordx4 v[208:211], v58, s[32:35], s57 offen sc1
s_add_u32 s63, s63, 1
s_cmp_lt_u32 s63, 0x80000
s_cbranch_scc1 sent_69
s_waitcnt vmcnt(0)
sentd_70:
buffer_load_dwordx4 v[188:191], v18, s[32:35], s58 offen offset:0 sc1
buffer_load_dwordx4 v[192:195], v18, s[32:35], s58 offen offset:1024 sc1
buffer_load_dwordx4 v[196:199], v18, s[32:35], s59 offen offset:0 sc1
buffer_load_dwordx4 v[200:203], v18, s[32:35], s59 offen offset:1024 sc1
v_mfma_f32_16x16x32_bf16 v[112:115], v[204:207], v[60:63], 0
v_mfma_f32_16x16x32_bf16 v[116:119], v[204:207], v[68:71], 0
v_mfma_f32_16x16x32_bf16 v[120:123], v[204:207], v[76:79], 0
v_mfma_f32_16x16x32_bf16 v[124:127], v[204:207], v[84:87], 0
v_mfma_f32_16x16x32_bf16 v[112:115], v[208:211], v[220:223], v[112:115]
v_mfma_f32_16x16x32_bf16 v[116:119], v[208:211], v[228:231], v[116:119]
v_mfma_f32_16x16x32_bf16 v[120:123], v[208:211], v[236:239], v[120:123]
v_mfma_f32_16x16x32_bf16 v[124:127], v[208:211], v[244:247], v[124:127]
s_nop 4
v_add_f32 v100, v112, v113
v_add_f32 v114, v114, v115
v_add_f32 v100, v100, v114
v_add_f32 v101, v116, v117
v_add_f32 v118, v118, v119
v_add_f32 v101, v101, v118
v_add_f32 v102, v120, v121
v_add_f32 v122, v122, v123
v_add_f32 v102, v102, v122
v_add_f32 v103, v124, v125
v_add_f32 v126, v126, v127
v_add_f32 v103, v103, v126
s_nop 1
v_permlane32_swap_b32 v100, v101
v_permlane32_swap_b32 v102, v103
v_add_f32 v100, v100, v101
v_add_f32 v102, v102, v103
s_nop 1
v_permlane16_swap_b32 v100, v102
s_nop 0
v_add_f32 v100, v100, v102
v_add_f32 v100, 0x358637bd, v100
v_rcp_f32 v100, v100
s_nop 0
v_mov_b32 v102, v100
s_nop 1
v_permlane16_swap_b32 v100, v102
s_nop 0
v_mov_b32 v101, v100
v_mov_b32 v103, v102
s_nop 0
v_permlane32_swap_b32 v100, v101
v_permlane32_swap_b32 v102, v103
s_mov_b32 s63, 0
sent_71:
s_waitcnt vmcnt(0)
v_max_u32 v4, v188, v189
v_max3_u32 v4, v4, v190, v191
v_max3_u32 v4, v4, v192, v193
v_max3_u32 v4, v4, v194, v195
v_max3_u32 v4, v4, v196, v197
v_max3_u32 v4, v4, v198, v199
v_max3_u32 v4, v4, v200, v201
v_max3_u32 v4, v4, v202, v203
v_cmp_eq_u32 vcc, -1, v4
s_cbranch_vccz sentd_72
buffer_load_dwordx4 v[188:191], v18, s[32:35], s58 offen offset:0 sc1
buffer_load_dwordx4 v[192:195], v18, s[32:35], s58 offen offset:1024 sc1
buffer_load_dwordx4 v[196:199], v18, s[32:35], s59 offen offset:0 sc1
buffer_load_dwordx4 v[200:203], v18, s[32:35], s59 offen offset:1024 sc1
s_add_u32 s63, s63, 1
s_cmp_lt_u32 s63, 0x80000
s_cbranch_scc1 sent_71
s_waitcnt vmcnt(0)
sentd_72:
v_mfma_f32_16x16x32_bf16 v[156:159], v[188:191], v[60:63], 0
v_mfma_f32_16x16x32_bf16 v[160:163], v[192:195], v[60:63], 0
v_mfma_f32_16x16x32_bf16 v[156:159], v[196:199], v[220:223], v[156:159]
v_mfma_f32_16x16x32_bf16 v[160:163], v[200:203], v[220:223], v[160:163]
v_mfma_f32_16x16x32_bf16 v[164:167], v[188:191], v[68:71], 0
v_mfma_f32_16x16x32_bf16 v[168:171], v[192:195], v[68:71], 0
v_mfma_f32_16x16x32_bf16 v[164:167], v[196:199], v[228:231], v[164:167]
v_mfma_f32_16x16x32_bf16 v[168:171], v[200:203], v[228:231], v[168:171]
v_mfma_f32_16x16x32_bf16 v[172:175], v[188:191], v[76:79], 0
v_mfma_f32_16x16x32_bf16 v[176:179], v[192:195], v[76:79], 0
v_mfma_f32_16x16x32_bf16 v[172:175], v[196:199], v[236:239], v[172:175]
v_mfma_f32_16x16x32_bf16 v[176:179], v[200:203], v[236:239], v[176:179]
v_mfma_f32_16x16x32_bf16 v[180:183], v[188:191], v[84:87], 0
v_mfma_f32_16x16x32_bf16 v[184:187], v[192:195], v[84:87], 0
v_mfma_f32_16x16x32_bf16 v[180:183], v[196:199], v[244:247], v[180:183]
v_mfma_f32_16x16x32_bf16 v[184:187], v[200:203], v[244:247], v[184:187]
s_cmp_eq_u32 s46, 0
s_cbranch_scc1 slow_73
.p2align 3
v_pk_mul_f32 v[156:157], v[156:157], v[100:101] op_sel:[0,0] op_sel_hi:[1,0]
v_pk_mul_f32 v[158:159], v[158:159], v[100:101] op_sel:[0,0] op_sel_hi:[1,0]
v_pk_mul_f32 v[160:161], v[160:161], v[100:101] op_sel:[0,0] op_sel_hi:[1,0]
v_pk_mul_f32 v[162:163], v[162:163], v[100:101] op_sel:[0,0] op_sel_hi:[1,0]
v_cvt_pk_bf16_f32 v156, v156, v157
v_cvt_pk_bf16_f32 v157, v158, v159
v_cvt_pk_bf16_f32 v158, v160, v161
v_cvt_pk_bf16_f32 v159, v162, v163
buffer_store_dwordx4 v[156:159], v18, s[32:35], s80 offen
v_pk_mul_f32 v[164:165], v[164:165], v[100:101] op_sel:[0,1] op_sel_hi:[1,1]
v_pk_mul_f32 v[166:167], v[166:167], v[100:101] op_sel:[0,1] op_sel_hi:[1,1]
v_pk_mul_f32 v[168:169], v[168:169], v[100:101] op_sel:[0,1] op_sel_hi:[1,1]
v_pk_mul_f32 v[170:171], v[170:171], v[100:101] op_sel:[0,1] op_sel_hi:[1,1]
v_cvt_pk_bf16_f32 v164, v164, v165
v_cvt_pk_bf16_f32 v165, v166, v167
v_cvt_pk_bf16_f32 v166, v168, v169
v_cvt_pk_bf16_f32 v167, v170, v171
buffer_store_dwordx4 v[164:167], v18, s[32:35], s81 offen
v_pk_mul_f32 v[172:173], v[172:173], v[102:103] op_sel:[0,0] op_sel_hi:[1,0]
v_pk_mul_f32 v[174:175], v[174:175], v[102:103] op_sel:[0,0] op_sel_hi:[1,0]
v_pk_mul_f32 v[176:177], v[176:177], v[102:103] op_sel:[0,0] op_sel_hi:[1,0]
v_pk_mul_f32 v[178:179], v[178:179], v[102:103] op_sel:[0,0] op_sel_hi:[1,0]
v_cvt_pk_bf16_f32 v172, v172, v173
v_cvt_pk_bf16_f32 v173, v174, v175
v_cvt_pk_bf16_f32 v174, v176, v177
v_cvt_pk_bf16_f32 v175, v178, v179
buffer_store_dwordx4 v[172:175], v18, s[32:35], s82 offen
v_pk_mul_f32 v[180:181], v[180:181], v[102:103] op_sel:[0,1] op_sel_hi:[1,1]
v_pk_mul_f32 v[182:183], v[182:183], v[102:103] op_sel:[0,1] op_sel_hi:[1,1]
v_pk_mul_f32 v[184:185], v[184:185], v[102:103] op_sel:[0,1] op_sel_hi:[1,1]
v_pk_mul_f32 v[186:187], v[186:187], v[102:103] op_sel:[0,1] op_sel_hi:[1,1]
v_cvt_pk_bf16_f32 v180, v180, v181
v_cvt_pk_bf16_f32 v181, v182, v183
v_cvt_pk_bf16_f32 v182, v184, v185
v_cvt_pk_bf16_f32 v183, v186, v187
buffer_store_dwordx4 v[180:183], v18, s[32:35], s83 offen
s_barrier
s_lshl_b32 s62, s45, 2
v_mov_b32 v4, s62
v_mov_b32 v5, 2
s_mov_b64 exec, 1
s_waitcnt vmcnt(0)
buffer_store_dword v5, v4, s[32:35], s84 offen
s_mov_b64 exec, -1
back_74:
v_and_b32 v36, 31, v0
v_lshlrev_b32 v36, 2, v36
buffer_load_dword v37, v36, s[32:35], s84 offen sc1
v_lshrrev_b32 v4, 2, v2
v_and_b32 v5, 3, v0
v_lshl_add_u32 v6, v3, 3, v4
v_lshlrev_b32 v6, 7, v6
v_lshl_add_u32 v6, v5, 3, v6
v_lshrrev_b32 v7, 1, v4
v_and_b32 v8, 1, v3
v_lshl_add_u32 v7, v8, 1, v7
v_lshl_add_u32 v10, v7, 5, v6
v_xor_b32 v11, 32, v10
v_xor_b32 v12, 64, v10
v_xor_b32 v13, 96, v10
v_add_u32 v14, 0x10000, v10
v_add_u32 v15, 0x10000, v11
v_add_u32 v16, 0x10000, v12
v_add_u32 v17, 0x10000, v13
ds_read_b64_tr_b16 v[220:221], v10 offset:0
ds_read_b64_tr_b16 v[222:223], v10 offset:512
ds_read_b64_tr_b16 v[224:225], v11 offset:0
ds_read_b64_tr_b16 v[226:227], v11 offset:512
ds_read_b64_tr_b16 v[228:229], v12 offset:0
ds_read_b64_tr_b16 v[230:231], v12 offset:512
ds_read_b64_tr_b16 v[232:233], v13 offset:0
ds_read_b64_tr_b16 v[234:235], v13 offset:512
ds_read_b64_tr_b16 v[236:237], v10 offset:4096
ds_read_b64_tr_b16 v[238:239], v10 offset:4608
ds_read_b64_tr_b16 v[240:241], v11 offset:4096
ds_read_b64_tr_b16 v[242:243], v11 offset:4608
ds_read_b64_tr_b16 v[244:245], v12 offset:4096
ds_read_b64_tr_b16 v[246:247], v12 offset:4608
ds_read_b64_tr_b16 v[248:249], v13 offset:4096
ds_read_b64_tr_b16 v[250:251], v13 offset:4608
s_lshl_b32 s48, s41, 3
s_lshl_b32 s49, s40, 1
s_add_u32 s48, s48, s49
s_lshl_b32 s48, s48, 15
s_add_u32 s48, s48, 4194304
v_add_u32 v38, s48, v18
v_add_u32 v39, 32768, v38
s_lshl_b32 s57, s75, 11
s_add_u32 s87, s87, 262144
v_lshlrev_b32 v60, 16, v20
v_and_b32 v61, 0xffff0000, v20
v_lshlrev_b32 v62, 16, v21
v_and_b32 v63, 0xffff0000, v21
v_lshlrev_b32 v64, 16, v22
v_and_b32 v65, 0xffff0000, v22
v_lshlrev_b32 v66, 16, v23
v_and_b32 v67, 0xffff0000, v23
v_lshlrev_b32 v68, 16, v24
v_and_b32 v69, 0xffff0000, v24
v_lshlrev_b32 v70, 16, v25
v_and_b32 v71, 0xffff0000, v25
v_lshlrev_b32 v72, 16, v26
v_and_b32 v73, 0xffff0000, v26
v_lshlrev_b32 v74, 16, v27
v_and_b32 v75, 0xffff0000, v27
v_lshlrev_b32 v76, 16, v28
v_and_b32 v77, 0xffff0000, v28
v_lshlrev_b32 v78, 16, v29
v_and_b32 v79, 0xffff0000, v29
v_lshlrev_b32 v80, 16, v30
v_and_b32 v81, 0xffff0000, v30
v_lshlrev_b32 v82, 16, v31
v_and_b32 v83, 0xffff0000, v31
v_lshlrev_b32 v84, 16, v32
v_and_b32 v85, 0xffff0000, v32
v_lshlrev_b32 v86, 16, v33
v_and_b32 v87, 0xffff0000, v33
v_lshlrev_b32 v88, 16, v34
v_and_b32 v89, 0xffff0000, v34
v_lshlrev_b32 v90, 16, v35
v_and_b32 v91, 0xffff0000, v35
v_mov_b32 v6, 0
v_mov_b32 v7, 0
v_mov_b32 v8, 0
v_mov_b32 v9, 0
s_lshl_b32 s62, s42, 2
v_mov_b32 v4, s62
v_mov_b32 v5, 2
s_mov_b32 s63, 0
s_waitcnt vmcnt(0)
poll_75:
v_cmp_gt_u32 vcc, 2, v37
s_cbranch_vccz polled_76
buffer_load_dword v37, v36, s[32:35], s84 offen sc1
s_add_u32 s63, s63, 1
s_cmp_lt_u32 s63, 0x80000
s_waitcnt vmcnt(0)
s_cbranch_scc1 poll_75
polled_76:
buffer_load_dwordx4 v[156:159], v38, s[32:35], s57 offen sc1
buffer_load_dwordx4 v[160:163], v39, s[32:35], s57 offen sc1
buffer_load_dwordx4 v[164:167], v38, s[32:35], s57 offen offset:1024 sc1
buffer_load_dwordx4 v[168:171], v39, s[32:35], s57 offen offset:1024 sc1
s_add_u32 s57, s57, 2048
s_and_b32 s57, s57, 0x7fff
buffer_load_dwordx4 v[172:175], v38, s[32:35], s57 offen sc1
buffer_load_dwordx4 v[176:179], v39, s[32:35], s57 offen sc1
buffer_load_dwordx4 v[180:183], v38, s[32:35], s57 offen offset:1024 sc1
buffer_load_dwordx4 v[184:187], v39, s[32:35], s57 offen offset:1024 sc1
s_add_u32 s57, s57, 2048
s_and_b32 s57, s57, 0x7fff
s_waitcnt vmcnt(6) lgkmcnt(8)
v_mfma_f32_16x16x32_bf16 v[60:63], v[220:223], v[156:159], v[60:63]
buffer_load_dwordx4 v[188:191], v38, s[32:35], s57 offen sc1
v_mfma_f32_16x16x32_bf16 v[76:79], v[220:223], v[160:163], v[76:79]
ds_read_b64_tr_b16 v[100:101], v10 offset:8192
ds_read_b64_tr_b16 v[102:103], v10 offset:8704
v_mfma_f32_16x16x32_bf16 v[64:67], v[224:227], v[156:159], v[64:67]
ds_read_b64_tr_b16 v[104:105], v11 offset:8192
ds_read_b64_tr_b16 v[106:107], v11 offset:8704
v_mfma_f32_16x16x32_bf16 v[80:83], v[224:227], v[160:163], v[80:83]
buffer_load_dwordx4 v[192:195], v39, s[32:35], s57 offen sc1
v_mfma_f32_16x16x32_bf16 v[68:71], v[228:231], v[156:159], v[68:71]
ds_read_b64_tr_b16 v[108:109], v12 offset:8192
ds_read_b64_tr_b16 v[110:111], v12 offset:8704
v_mfma_f32_16x16x32_bf16 v[84:87], v[228:231], v[160:163], v[84:87]
ds_read_b64_tr_b16 v[112:113], v13 offset:8192
ds_read_b64_tr_b16 v[114:115], v13 offset:8704
v_mfma_f32_16x16x32_bf16 v[72:75], v[232:235], v[156:159], v[72:75]
v_mfma_f32_16x16x32_bf16 v[88:91], v[232:235], v[160:163], v[88:91]
s_waitcnt vmcnt(6) lgkmcnt(8)
v_mfma_f32_16x16x32_bf16 v[60:63], v[236:239], v[164:167], v[60:63]
buffer_load_dwordx4 v[196:199], v38, s[32:35], s57 offen offset:1024 sc1
v_mfma_f32_16x16x32_bf16 v[76:79], v[236:239], v[168:171], v[76:79]
ds_read_b64_tr_b16 v[220:221], v10 offset:12288
ds_read_b64_tr_b16 v[222:223], v10 offset:12800
v_mfma_f32_16x16x32_bf16 v[64:67], v[240:243], v[164:167], v[64:67]
ds_read_b64_tr_b16 v[224:225], v11 offset:12288
ds_read_b64_tr_b16 v[226:227], v11 offset:12800
v_mfma_f32_16x16x32_bf16 v[80:83], v[240:243], v[168:171], v[80:83]
buffer_load_dwordx4 v[200:203], v39, s[32:35], s57 offen offset:1024 sc1
v_mfma_f32_16x16x32_bf16 v[68:71], v[244:247], v[164:167], v[68:71]
ds_read_b64_tr_b16 v[228:229], v12 offset:12288
ds_read_b64_tr_b16 v[230:231], v12 offset:12800
v_mfma_f32_16x16x32_bf16 v[84:87], v[244:247], v[168:171], v[84:87]
ds_read_b64_tr_b16 v[232:233], v13 offset:12288
ds_read_b64_tr_b16 v[234:235], v13 offset:12800
v_mfma_f32_16x16x32_bf16 v[72:75], v[248:251], v[164:167], v[72:75]
s_add_u32 s57, s57, 2048
s_and_b32 s57, s57, 0x7fff
v_mfma_f32_16x16x32_bf16 v[88:91], v[248:251], v[168:171], v[88:91]
s_waitcnt vmcnt(6) lgkmcnt(8)
v_mfma_f32_16x16x32_bf16 v[60:63], v[100:103], v[172:175], v[60:63]
buffer_load_dwordx4 v[204:207], v38, s[32:35], s57 offen sc1
v_mfma_f32_16x16x32_bf16 v[76:79], v[100:103], v[176:179], v[76:79]
ds_read_b64_tr_b16 v[236:237], v10 offset:16384
ds_read_b64_tr_b16 v[238:239], v10 offset:16896
v_mfma_f32_16x16x32_bf16 v[64:67], v[104:107], v[172:175], v[64:67]
ds_read_b64_tr_b16 v[240:241], v11 offset:16384
ds_read_b64_tr_b16 v[242:243], v11 offset:16896
v_mfma_f32_16x16x32_bf16 v[80:83], v[104:107], v[176:179], v[80:83]
buffer_load_dwordx4 v[208:211], v39, s[32:35], s57 offen sc1
v_mfma_f32_16x16x32_bf16 v[68:71], v[108:111], v[172:175], v[68:71]
ds_read_b64_tr_b16 v[244:245], v12 offset:16384
ds_read_b64_tr_b16 v[246:247], v12 offset:16896
v_mfma_f32_16x16x32_bf16 v[84:87], v[108:111], v[176:179], v[84:87]
ds_read_b64_tr_b16 v[248:249], v13 offset:16384
ds_read_b64_tr_b16 v[250:251], v13 offset:16896
v_mfma_f32_16x16x32_bf16 v[72:75], v[112:115], v[172:175], v[72:75]
v_mfma_f32_16x16x32_bf16 v[88:91], v[112:115], v[176:179], v[88:91]
s_waitcnt vmcnt(6) lgkmcnt(8)
v_mfma_f32_16x16x32_bf16 v[60:63], v[220:223], v[180:183], v[60:63]
buffer_load_dwordx4 v[212:215], v38, s[32:35], s57 offen offset:1024 sc1
v_mfma_f32_16x16x32_bf16 v[76:79], v[220:223], v[184:187], v[76:79]
ds_read_b64_tr_b16 v[100:101], v10 offset:20480
ds_read_b64_tr_b16 v[102:103], v10 offset:20992
v_mfma_f32_16x16x32_bf16 v[64:67], v[224:227], v[180:183], v[64:67]
ds_read_b64_tr_b16 v[104:105], v11 offset:20480
ds_read_b64_tr_b16 v[106:107], v11 offset:20992
v_mfma_f32_16x16x32_bf16 v[80:83], v[224:227], v[184:187], v[80:83]
buffer_load_dwordx4 v[216:219], v39, s[32:35], s57 offen offset:1024 sc1
v_mfma_f32_16x16x32_bf16 v[68:71], v[228:231], v[180:183], v[68:71]
ds_read_b64_tr_b16 v[108:109], v12 offset:20480
ds_read_b64_tr_b16 v[110:111], v12 offset:20992
v_mfma_f32_16x16x32_bf16 v[84:87], v[228:231], v[184:187], v[84:87]
ds_read_b64_tr_b16 v[112:113], v13 offset:20480
ds_read_b64_tr_b16 v[114:115], v13 offset:20992
v_mfma_f32_16x16x32_bf16 v[72:75], v[232:235], v[180:183], v[72:75]
s_add_u32 s57, s57, 2048
s_and_b32 s57, s57, 0x7fff
v_mfma_f32_16x16x32_bf16 v[88:91], v[232:235], v[184:187], v[88:91]
s_waitcnt vmcnt(6) lgkmcnt(8)
v_mfma_f32_16x16x32_bf16 v[60:63], v[236:239], v[188:191], v[60:63]
buffer_load_dwordx4 v[156:159], v38, s[32:35], s57 offen sc1
v_mfma_f32_16x16x32_bf16 v[76:79], v[236:239], v[192:195], v[76:79]
ds_read_b64_tr_b16 v[220:221], v10 offset:24576
ds_read_b64_tr_b16 v[222:223], v10 offset:25088
v_mfma_f32_16x16x32_bf16 v[64:67], v[240:243], v[188:191], v[64:67]
ds_read_b64_tr_b16 v[224:225], v11 offset:24576
ds_read_b64_tr_b16 v[226:227], v11 offset:25088
v_mfma_f32_16x16x32_bf16 v[80:83], v[240:243], v[192:195], v[80:83]
buffer_load_dwordx4 v[160:163], v39, s[32:35], s57 offen sc1
v_mfma_f32_16x16x32_bf16 v[68:71], v[244:247], v[188:191], v[68:71]
ds_read_b64_tr_b16 v[228:229], v12 offset:24576
ds_read_b64_tr_b16 v[230:231], v12 offset:25088
v_mfma_f32_16x16x32_bf16 v[84:87], v[244:247], v[192:195], v[84:87]
ds_read_b64_tr_b16 v[232:233], v13 offset:24576
ds_read_b64_tr_b16 v[234:235], v13 offset:25088
v_mfma_f32_16x16x32_bf16 v[72:75], v[248:251], v[188:191], v[72:75]
v_mfma_f32_16x16x32_bf16 v[88:91], v[248:251], v[192:195], v[88:91]
s_waitcnt vmcnt(6) lgkmcnt(8)
v_mfma_f32_16x16x32_bf16 v[60:63], v[100:103], v[196:199], v[60:63]
buffer_load_dwordx4 v[164:167], v38, s[32:35], s57 offen offset:1024 sc1
v_mfma_f32_16x16x32_bf16 v[76:79], v[100:103], v[200:203], v[76:79]
ds_read_b64_tr_b16 v[236:237], v10 offset:28672
ds_read_b64_tr_b16 v[238:239], v10 offset:29184
v_mfma_f32_16x16x32_bf16 v[64:67], v[104:107], v[196:199], v[64:67]
ds_read_b64_tr_b16 v[240:241], v11 offset:28672
ds_read_b64_tr_b16 v[242:243], v11 offset:29184
v_mfma_f32_16x16x32_bf16 v[80:83], v[104:107], v[200:203], v[80:83]
buffer_load_dwordx4 v[168:171], v39, s[32:35], s57 offen offset:1024 sc1
v_mfma_f32_16x16x32_bf16 v[68:71], v[108:111], v[196:199], v[68:71]
ds_read_b64_tr_b16 v[244:245], v12 offset:28672
ds_read_b64_tr_b16 v[246:247], v12 offset:29184
v_mfma_f32_16x16x32_bf16 v[84:87], v[108:111], v[200:203], v[84:87]
ds_read_b64_tr_b16 v[248:249], v13 offset:28672
ds_read_b64_tr_b16 v[250:251], v13 offset:29184
v_mfma_f32_16x16x32_bf16 v[72:75], v[112:115], v[196:199], v[72:75]
s_add_u32 s57, s57, 2048
s_and_b32 s57, s57, 0x7fff
v_mfma_f32_16x16x32_bf16 v[88:91], v[112:115], v[200:203], v[88:91]
s_waitcnt vmcnt(6) lgkmcnt(8)
v_mfma_f32_16x16x32_bf16 v[60:63], v[220:223], v[204:207], v[60:63]
buffer_load_dwordx4 v[172:175], v38, s[32:35], s57 offen sc1
v_mfma_f32_16x16x32_bf16 v[76:79], v[220:223], v[208:211], v[76:79]
ds_read_b64_tr_b16 v[100:101], v10 offset:32768
ds_read_b64_tr_b16 v[102:103], v10 offset:33280
v_mfma_f32_16x16x32_bf16 v[64:67], v[224:227], v[204:207], v[64:67]
ds_read_b64_tr_b16 v[104:105], v11 offset:32768
ds_read_b64_tr_b16 v[106:107], v11 offset:33280
v_mfma_f32_16x16x32_bf16 v[80:83], v[224:227], v[208:211], v[80:83]
buffer_load_dwordx4 v[176:179], v39, s[32:35], s57 offen sc1
v_mfma_f32_16x16x32_bf16 v[68:71], v[228:231], v[204:207], v[68:71]
ds_read_b64_tr_b16 v[108:109], v12 offset:32768
ds_read_b64_tr_b16 v[110:111], v12 offset:33280
v_mfma_f32_16x16x32_bf16 v[84:87], v[228:231], v[208:211], v[84:87]
ds_read_b64_tr_b16 v[112:113], v13 offset:32768
ds_read_b64_tr_b16 v[114:115], v13 offset:33280
v_mfma_f32_16x16x32_bf16 v[72:75], v[232:235], v[204:207], v[72:75]
v_mfma_f32_16x16x32_bf16 v[88:91], v[232:235], v[208:211], v[88:91]
s_waitcnt vmcnt(6) lgkmcnt(8)
v_mfma_f32_16x16x32_bf16 v[60:63], v[236:239], v[212:215], v[60:63]
buffer_load_dwordx4 v[180:183], v38, s[32:35], s57 offen offset:1024 sc1
v_mfma_f32_16x16x32_bf16 v[76:79], v[236:239], v[216:219], v[76:79]
ds_read_b64_tr_b16 v[220:221], v10 offset:36864
ds_read_b64_tr_b16 v[222:223], v10 offset:37376
v_mfma_f32_16x16x32_bf16 v[64:67], v[240:243], v[212:215], v[64:67]
ds_read_b64_tr_b16 v[224:225], v11 offset:36864
ds_read_b64_tr_b16 v[226:227], v11 offset:37376
v_mfma_f32_16x16x32_bf16 v[80:83], v[240:243], v[216:219], v[80:83]
buffer_load_dwordx4 v[184:187], v39, s[32:35], s57 offen offset:1024 sc1
v_mfma_f32_16x16x32_bf16 v[68:71], v[244:247], v[212:215], v[68:71]
ds_read_b64_tr_b16 v[228:229], v12 offset:36864
ds_read_b64_tr_b16 v[230:231], v12 offset:37376
v_mfma_f32_16x16x32_bf16 v[84:87], v[244:247], v[216:219], v[84:87]
ds_read_b64_tr_b16 v[232:233], v13 offset:36864
ds_read_b64_tr_b16 v[234:235], v13 offset:37376
v_mfma_f32_16x16x32_bf16 v[72:75], v[248:251], v[212:215], v[72:75]
s_add_u32 s57, s57, 2048
s_and_b32 s57, s57, 0x7fff
v_mfma_f32_16x16x32_bf16 v[88:91], v[248:251], v[216:219], v[88:91]
s_waitcnt vmcnt(6) lgkmcnt(8)
v_mfma_f32_16x16x32_bf16 v[60:63], v[100:103], v[156:159], v[60:63]
buffer_load_dwordx4 v[188:191], v38, s[32:35], s57 offen sc1
v_mfma_f32_16x16x32_bf16 v[76:79], v[100:103], v[160:163], v[76:79]
ds_read_b64_tr_b16 v[236:237], v10 offset:40960
ds_read_b64_tr_b16 v[238:239], v10 offset:41472
v_mfma_f32_16x16x32_bf16 v[64:67], v[104:107], v[156:159], v[64:67]
ds_read_b64_tr_b16 v[240:241], v11 offset:40960
ds_read_b64_tr_b16 v[242:243], v11 offset:41472
v_mfma_f32_16x16x32_bf16 v[80:83], v[104:107], v[160:163], v[80:83]
buffer_load_dwordx4 v[192:195], v39, s[32:35], s57 offen sc1
v_mfma_f32_16x16x32_bf16 v[68:71], v[108:111], v[156:159], v[68:71]
ds_read_b64_tr_b16 v[244:245], v12 offset:40960
ds_read_b64_tr_b16 v[246:247], v12 offset:41472
v_mfma_f32_16x16x32_bf16 v[84:87], v[108:111], v[160:163], v[84:87]
ds_read_b64_tr_b16 v[248:249], v13 offset:40960
ds_read_b64_tr_b16 v[250:251], v13 offset:41472
v_mfma_f32_16x16x32_bf16 v[72:75], v[112:115], v[156:159], v[72:75]
v_mfma_f32_16x16x32_bf16 v[88:91], v[112:115], v[160:163], v[88:91]
s_waitcnt vmcnt(6) lgkmcnt(8)
v_mfma_f32_16x16x32_bf16 v[60:63], v[220:223], v[164:167], v[60:63]
buffer_load_dwordx4 v[196:199], v38, s[32:35], s57 offen offset:1024 sc1
v_mfma_f32_16x16x32_bf16 v[76:79], v[220:223], v[168:171], v[76:79]
ds_read_b64_tr_b16 v[100:101], v10 offset:45056
ds_read_b64_tr_b16 v[102:103], v10 offset:45568
v_mfma_f32_16x16x32_bf16 v[64:67], v[224:227], v[164:167], v[64:67]
ds_read_b64_tr_b16 v[104:105], v11 offset:45056
ds_read_b64_tr_b16 v[106:107], v11 offset:45568
v_mfma_f32_16x16x32_bf16 v[80:83], v[224:227], v[168:171], v[80:83]
buffer_load_dwordx4 v[200:203], v39, s[32:35], s57 offen offset:1024 sc1
v_mfma_f32_16x16x32_bf16 v[68:71], v[228:231], v[164:167], v[68:71]
ds_read_b64_tr_b16 v[108:109], v12 offset:45056
ds_read_b64_tr_b16 v[110:111], v12 offset:45568
v_mfma_f32_16x16x32_bf16 v[84:87], v[228:231], v[168:171], v[84:87]
ds_read_b64_tr_b16 v[112:113], v13 offset:45056
ds_read_b64_tr_b16 v[114:115], v13 offset:45568
v_mfma_f32_16x16x32_bf16 v[72:75], v[232:235], v[164:167], v[72:75]
s_add_u32 s57, s57, 2048
s_and_b32 s57, s57, 0x7fff
v_mfma_f32_16x16x32_bf16 v[88:91], v[232:235], v[168:171], v[88:91]
s_waitcnt vmcnt(6) lgkmcnt(8)
v_mfma_f32_16x16x32_bf16 v[60:63], v[236:239], v[172:175], v[60:63]
buffer_load_dwordx4 v[204:207], v38, s[32:35], s57 offen sc1
v_mfma_f32_16x16x32_bf16 v[76:79], v[236:239], v[176:179], v[76:79]
ds_read_b64_tr_b16 v[220:221], v10 offset:49152
ds_read_b64_tr_b16 v[222:223], v10 offset:49664
v_mfma_f32_16x16x32_bf16 v[64:67], v[240:243], v[172:175], v[64:67]
ds_read_b64_tr_b16 v[224:225], v11 offset:49152
ds_read_b64_tr_b16 v[226:227], v11 offset:49664
v_mfma_f32_16x16x32_bf16 v[80:83], v[240:243], v[176:179], v[80:83]
buffer_load_dwordx4 v[208:211], v39, s[32:35], s57 offen sc1
v_mfma_f32_16x16x32_bf16 v[68:71], v[244:247], v[172:175], v[68:71]
ds_read_b64_tr_b16 v[228:229], v12 offset:49152
ds_read_b64_tr_b16 v[230:231], v12 offset:49664
v_mfma_f32_16x16x32_bf16 v[84:87], v[244:247], v[176:179], v[84:87]
ds_read_b64_tr_b16 v[232:233], v13 offset:49152
ds_read_b64_tr_b16 v[234:235], v13 offset:49664
v_mfma_f32_16x16x32_bf16 v[72:75], v[248:251], v[172:175], v[72:75]
v_mfma_f32_16x16x32_bf16 v[88:91], v[248:251], v[176:179], v[88:91]
s_waitcnt vmcnt(6) lgkmcnt(8)
v_mfma_f32_16x16x32_bf16 v[60:63], v[100:103], v[180:183], v[60:63]
buffer_load_dwordx4 v[212:215], v38, s[32:35], s57 offen offset:1024 sc1
v_mfma_f32_16x16x32_bf16 v[76:79], v[100:103], v[184:187], v[76:79]
ds_read_b64_tr_b16 v[236:237], v10 offset:53248
ds_read_b64_tr_b16 v[238:239], v10 offset:53760
v_mfma_f32_16x16x32_bf16 v[64:67], v[104:107], v[180:183], v[64:67]
ds_read_b64_tr_b16 v[240:241], v11 offset:53248
ds_read_b64_tr_b16 v[242:243], v11 offset:53760
v_mfma_f32_16x16x32_bf16 v[80:83], v[104:107], v[184:187], v[80:83]
buffer_load_dwordx4 v[216:219], v39, s[32:35], s57 offen offset:1024 sc1
v_mfma_f32_16x16x32_bf16 v[68:71], v[108:111], v[180:183], v[68:71]
ds_read_b64_tr_b16 v[244:245], v12 offset:53248
ds_read_b64_tr_b16 v[246:247], v12 offset:53760
v_mfma_f32_16x16x32_bf16 v[84:87], v[108:111], v[184:187], v[84:87]
ds_read_b64_tr_b16 v[248:249], v13 offset:53248
ds_read_b64_tr_b16 v[250:251], v13 offset:53760
v_mfma_f32_16x16x32_bf16 v[72:75], v[112:115], v[180:183], v[72:75]
s_add_u32 s57, s57, 2048
s_and_b32 s57, s57, 0x7fff
v_mfma_f32_16x16x32_bf16 v[88:91], v[112:115], v[184:187], v[88:91]
s_waitcnt vmcnt(6) lgkmcnt(8)
v_mfma_f32_16x16x32_bf16 v[60:63], v[220:223], v[188:191], v[60:63]
buffer_load_dwordx4 v[156:159], v38, s[32:35], s57 offen sc1
v_mfma_f32_16x16x32_bf16 v[76:79], v[220:223], v[192:195], v[76:79]
ds_read_b64_tr_b16 v[100:101], v10 offset:57344
ds_read_b64_tr_b16 v[102:103], v10 offset:57856
v_mfma_f32_16x16x32_bf16 v[64:67], v[224:227], v[188:191], v[64:67]
ds_read_b64_tr_b16 v[104:105], v11 offset:57344
ds_read_b64_tr_b16 v[106:107], v11 offset:57856
v_mfma_f32_16x16x32_bf16 v[80:83], v[224:227], v[192:195], v[80:83]
buffer_load_dwordx4 v[160:163], v39, s[32:35], s57 offen sc1
v_mfma_f32_16x16x32_bf16 v[68:71], v[228:231], v[188:191], v[68:71]
ds_read_b64_tr_b16 v[108:109], v12 offset:57344
ds_read_b64_tr_b16 v[110:111], v12 offset:57856
v_mfma_f32_16x16x32_bf16 v[84:87], v[228:231], v[192:195], v[84:87]
ds_read_b64_tr_b16 v[112:113], v13 offset:57344
ds_read_b64_tr_b16 v[114:115], v13 offset:57856
v_mfma_f32_16x16x32_bf16 v[72:75], v[232:235], v[188:191], v[72:75]
v_mfma_f32_16x16x32_bf16 v[88:91], v[232:235], v[192:195], v[88:91]
s_waitcnt vmcnt(6) lgkmcnt(8)
v_mfma_f32_16x16x32_bf16 v[60:63], v[236:239], v[196:199], v[60:63]
buffer_load_dwordx4 v[164:167], v38, s[32:35], s57 offen offset:1024 sc1
v_mfma_f32_16x16x32_bf16 v[76:79], v[236:239], v[200:203], v[76:79]
ds_read_b64_tr_b16 v[220:221], v10 offset:61440
ds_read_b64_tr_b16 v[222:223], v10 offset:61952
v_mfma_f32_16x16x32_bf16 v[64:67], v[240:243], v[196:199], v[64:67]
ds_read_b64_tr_b16 v[224:225], v11 offset:61440
ds_read_b64_tr_b16 v[226:227], v11 offset:61952
v_mfma_f32_16x16x32_bf16 v[80:83], v[240:243], v[200:203], v[80:83]
buffer_load_dwordx4 v[168:171], v39, s[32:35], s57 offen offset:1024 sc1
v_mfma_f32_16x16x32_bf16 v[68:71], v[244:247], v[196:199], v[68:71]
ds_read_b64_tr_b16 v[228:229], v12 offset:61440
ds_read_b64_tr_b16 v[230:231], v12 offset:61952
v_mfma_f32_16x16x32_bf16 v[84:87], v[244:247], v[200:203], v[84:87]
ds_read_b64_tr_b16 v[232:233], v13 offset:61440
ds_read_b64_tr_b16 v[234:235], v13 offset:61952
v_mfma_f32_16x16x32_bf16 v[72:75], v[248:251], v[196:199], v[72:75]
s_add_u32 s57, s57, 2048
s_and_b32 s57, s57, 0x7fff
v_mfma_f32_16x16x32_bf16 v[88:91], v[248:251], v[200:203], v[88:91]
s_waitcnt vmcnt(6) lgkmcnt(8)
v_mfma_f32_16x16x32_bf16 v[60:63], v[100:103], v[204:207], v[60:63]
buffer_load_dwordx4 v[172:175], v38, s[32:35], s57 offen sc1
v_mfma_f32_16x16x32_bf16 v[76:79], v[100:103], v[208:211], v[76:79]
ds_read_b64_tr_b16 v[236:237], v14 offset:0
ds_read_b64_tr_b16 v[238:239], v14 offset:512
v_mfma_f32_16x16x32_bf16 v[64:67], v[104:107], v[204:207], v[64:67]
ds_read_b64_tr_b16 v[240:241], v15 offset:0
ds_read_b64_tr_b16 v[242:243], v15 offset:512
v_mfma_f32_16x16x32_bf16 v[80:83], v[104:107], v[208:211], v[80:83]
buffer_load_dwordx4 v[176:179], v39, s[32:35], s57 offen sc1
v_mfma_f32_16x16x32_bf16 v[68:71], v[108:111], v[204:207], v[68:71]
ds_read_b64_tr_b16 v[244:245], v16 offset:0
ds_read_b64_tr_b16 v[246:247], v16 offset:512
v_mfma_f32_16x16x32_bf16 v[84:87], v[108:111], v[208:211], v[84:87]
ds_read_b64_tr_b16 v[248:249], v17 offset:0
ds_read_b64_tr_b16 v[250:251], v17 offset:512
v_mfma_f32_16x16x32_bf16 v[72:75], v[112:115], v[204:207], v[72:75]
v_mfma_f32_16x16x32_bf16 v[88:91], v[112:115], v[208:211], v[88:91]
s_waitcnt vmcnt(6) lgkmcnt(8)
v_mfma_f32_16x16x32_bf16 v[60:63], v[220:223], v[212:215], v[60:63]
buffer_load_dwordx4 v[180:183], v38, s[32:35], s57 offen offset:1024 sc1
v_mfma_f32_16x16x32_bf16 v[76:79], v[220:223], v[216:219], v[76:79]
ds_read_b64_tr_b16 v[100:101], v14 offset:4096
ds_read_b64_tr_b16 v[102:103], v14 offset:4608
v_mfma_f32_16x16x32_bf16 v[64:67], v[224:227], v[212:215], v[64:67]
ds_read_b64_tr_b16 v[104:105], v15 offset:4096
ds_read_b64_tr_b16 v[106:107], v15 offset:4608
v_mfma_f32_16x16x32_bf16 v[80:83], v[224:227], v[216:219], v[80:83]
buffer_load_dwordx4 v[184:187], v39, s[32:35], s57 offen offset:1024 sc1
v_mfma_f32_16x16x32_bf16 v[68:71], v[228:231], v[212:215], v[68:71]
ds_read_b64_tr_b16 v[108:109], v16 offset:4096
ds_read_b64_tr_b16 v[110:111], v16 offset:4608
v_mfma_f32_16x16x32_bf16 v[84:87], v[228:231], v[216:219], v[84:87]
ds_read_b64_tr_b16 v[112:113], v17 offset:4096
ds_read_b64_tr_b16 v[114:115], v17 offset:4608
v_mfma_f32_16x16x32_bf16 v[72:75], v[232:235], v[212:215], v[72:75]
s_add_u32 s57, s57, 2048
s_and_b32 s57, s57, 0x7fff
v_mfma_f32_16x16x32_bf16 v[88:91], v[232:235], v[216:219], v[88:91]
s_waitcnt vmcnt(6) lgkmcnt(8)
v_mfma_f32_16x16x32_bf16 v[60:63], v[236:239], v[156:159], v[60:63]
buffer_load_dwordx4 v[188:191], v38, s[32:35], s57 offen sc1
v_mfma_f32_16x16x32_bf16 v[76:79], v[236:239], v[160:163], v[76:79]
ds_read_b64_tr_b16 v[220:221], v14 offset:8192
ds_read_b64_tr_b16 v[222:223], v14 offset:8704
v_mfma_f32_16x16x32_bf16 v[64:67], v[240:243], v[156:159], v[64:67]
ds_read_b64_tr_b16 v[224:225], v15 offset:8192
ds_read_b64_tr_b16 v[226:227], v15 offset:8704
v_mfma_f32_16x16x32_bf16 v[80:83], v[240:243], v[160:163], v[80:83]
buffer_load_dwordx4 v[192:195], v39, s[32:35], s57 offen sc1
v_mfma_f32_16x16x32_bf16 v[68:71], v[244:247], v[156:159], v[68:71]
ds_read_b64_tr_b16 v[228:229], v16 offset:8192
ds_read_b64_tr_b16 v[230:231], v16 offset:8704
v_mfma_f32_16x16x32_bf16 v[84:87], v[244:247], v[160:163], v[84:87]
ds_read_b64_tr_b16 v[232:233], v17 offset:8192
ds_read_b64_tr_b16 v[234:235], v17 offset:8704
v_mfma_f32_16x16x32_bf16 v[72:75], v[248:251], v[156:159], v[72:75]
v_mfma_f32_16x16x32_bf16 v[88:91], v[248:251], v[160:163], v[88:91]
s_waitcnt vmcnt(6) lgkmcnt(8)
v_mfma_f32_16x16x32_bf16 v[60:63], v[100:103], v[164:167], v[60:63]
buffer_load_dwordx4 v[196:199], v38, s[32:35], s57 offen offset:1024 sc1
v_mfma_f32_16x16x32_bf16 v[76:79], v[100:103], v[168:171], v[76:79]
ds_read_b64_tr_b16 v[236:237], v14 offset:12288
ds_read_b64_tr_b16 v[238:239], v14 offset:12800
v_mfma_f32_16x16x32_bf16 v[64:67], v[104:107], v[164:167], v[64:67]
ds_read_b64_tr_b16 v[240:241], v15 offset:12288
ds_read_b64_tr_b16 v[242:243], v15 offset:12800
v_mfma_f32_16x16x32_bf16 v[80:83], v[104:107], v[168:171], v[80:83]
buffer_load_dwordx4 v[200:203], v39, s[32:35], s57 offen offset:1024 sc1
v_mfma_f32_16x16x32_bf16 v[68:71], v[108:111], v[164:167], v[68:71]
ds_read_b64_tr_b16 v[244:245], v16 offset:12288
ds_read_b64_tr_b16 v[246:247], v16 offset:12800
v_mfma_f32_16x16x32_bf16 v[84:87], v[108:111], v[168:171], v[84:87]
ds_read_b64_tr_b16 v[248:249], v17 offset:12288
ds_read_b64_tr_b16 v[250:251], v17 offset:12800
v_mfma_f32_16x16x32_bf16 v[72:75], v[112:115], v[164:167], v[72:75]
s_add_u32 s57, s57, 2048
s_and_b32 s57, s57, 0x7fff
v_mfma_f32_16x16x32_bf16 v[88:91], v[112:115], v[168:171], v[88:91]
s_waitcnt vmcnt(6) lgkmcnt(8)
v_mfma_f32_16x16x32_bf16 v[60:63], v[220:223], v[172:175], v[60:63]
buffer_load_dwordx4 v[204:207], v38, s[32:35], s57 offen sc1
v_mfma_f32_16x16x32_bf16 v[76:79], v[220:223], v[176:179], v[76:79]
ds_read_b64_tr_b16 v[100:101], v14 offset:16384
ds_read_b64_tr_b16 v[102:103], v14 offset:16896
v_mfma_f32_16x16x32_bf16 v[64:67], v[224:227], v[172:175], v[64:67]
ds_read_b64_tr_b16 v[104:105], v15 offset:16384
ds_read_b64_tr_b16 v[106:107], v15 offset:16896
v_mfma_f32_16x16x32_bf16 v[80:83], v[224:227], v[176:179], v[80:83]
buffer_load_dwordx4 v[208:211], v39, s[32:35], s57 offen sc1
v_mfma_f32_16x16x32_bf16 v[68:71], v[228:231], v[172:175], v[68:71]
ds_read_b64_tr_b16 v[108:109], v16 offset:16384
ds_read_b64_tr_b16 v[110:111], v16 offset:16896
v_mfma_f32_16x16x32_bf16 v[84:87], v[228:231], v[176:179], v[84:87]
ds_read_b64_tr_b16 v[112:113], v17 offset:16384
ds_read_b64_tr_b16 v[114:115], v17 offset:16896
v_mfma_f32_16x16x32_bf16 v[72:75], v[232:235], v[172:175], v[72:75]
v_mfma_f32_16x16x32_bf16 v[88:91], v[232:235], v[176:179], v[88:91]
s_waitcnt vmcnt(6) lgkmcnt(8)
v_mfma_f32_16x16x32_bf16 v[60:63], v[236:239], v[180:183], v[60:63]
buffer_load_dwordx4 v[212:215], v38, s[32:35], s57 offen offset:1024 sc1
v_mfma_f32_16x16x32_bf16 v[76:79], v[236:239], v[184:187], v[76:79]
ds_read_b64_tr_b16 v[220:221], v14 offset:20480
ds_read_b64_tr_b16 v[222:223], v14 offset:20992
v_mfma_f32_16x16x32_bf16 v[64:67], v[240:243], v[180:183], v[64:67]
ds_read_b64_tr_b16 v[224:225], v15 offset:20480
ds_read_b64_tr_b16 v[226:227], v15 offset:20992
v_mfma_f32_16x16x32_bf16 v[80:83], v[240:243], v[184:187], v[80:83]
buffer_load_dwordx4 v[216:219], v39, s[32:35], s57 offen offset:1024 sc1
v_mfma_f32_16x16x32_bf16 v[68:71], v[244:247], v[180:183], v[68:71]
ds_read_b64_tr_b16 v[228:229], v16 offset:20480
ds_read_b64_tr_b16 v[230:231], v16 offset:20992
v_mfma_f32_16x16x32_bf16 v[84:87], v[244:247], v[184:187], v[84:87]
ds_read_b64_tr_b16 v[232:233], v17 offset:20480
ds_read_b64_tr_b16 v[234:235], v17 offset:20992
v_mfma_f32_16x16x32_bf16 v[72:75], v[248:251], v[180:183], v[72:75]
s_add_u32 s57, s57, 2048
s_and_b32 s57, s57, 0x7fff
v_mfma_f32_16x16x32_bf16 v[88:91], v[248:251], v[184:187], v[88:91]
s_waitcnt vmcnt(6) lgkmcnt(8)
v_mfma_f32_16x16x32_bf16 v[60:63], v[100:103], v[188:191], v[60:63]
buffer_load_dwordx4 v[156:159], v38, s[32:35], s57 offen sc1
v_mfma_f32_16x16x32_bf16 v[76:79], v[100:103], v[192:195], v[76:79]
ds_read_b64_tr_b16 v[236:237], v14 offset:24576
ds_read_b64_tr_b16 v[238:239], v14 offset:25088
v_mfma_f32_16x16x32_bf16 v[64:67], v[104:107], v[188:191], v[64:67]
ds_read_b64_tr_b16 v[240:241], v15 offset:24576
ds_read_b64_tr_b16 v[242:243], v15 offset:25088
v_mfma_f32_16x16x32_bf16 v[80:83], v[104:107], v[192:195], v[80:83]
buffer_load_dwordx4 v[160:163], v39, s[32:35], s57 offen sc1
v_mfma_f32_16x16x32_bf16 v[68:71], v[108:111], v[188:191], v[68:71]
ds_read_b64_tr_b16 v[244:245], v16 offset:24576
ds_read_b64_tr_b16 v[246:247], v16 offset:25088
v_mfma_f32_16x16x32_bf16 v[84:87], v[108:111], v[192:195], v[84:87]
ds_read_b64_tr_b16 v[248:249], v17 offset:24576
ds_read_b64_tr_b16 v[250:251], v17 offset:25088
v_mfma_f32_16x16x32_bf16 v[72:75], v[112:115], v[188:191], v[72:75]
v_mfma_f32_16x16x32_bf16 v[88:91], v[112:115], v[192:195], v[88:91]
s_waitcnt vmcnt(6) lgkmcnt(8)
v_mfma_f32_16x16x32_bf16 v[60:63], v[220:223], v[196:199], v[60:63]
buffer_load_dwordx4 v[164:167], v38, s[32:35], s57 offen offset:1024 sc1
v_mfma_f32_16x16x32_bf16 v[76:79], v[220:223], v[200:203], v[76:79]
ds_read_b64_tr_b16 v[100:101], v14 offset:28672
ds_read_b64_tr_b16 v[102:103], v14 offset:29184
v_mfma_f32_16x16x32_bf16 v[64:67], v[224:227], v[196:199], v[64:67]
ds_read_b64_tr_b16 v[104:105], v15 offset:28672
ds_read_b64_tr_b16 v[106:107], v15 offset:29184
v_mfma_f32_16x16x32_bf16 v[80:83], v[224:227], v[200:203], v[80:83]
buffer_load_dwordx4 v[168:171], v39, s[32:35], s57 offen offset:1024 sc1
v_mfma_f32_16x16x32_bf16 v[68:71], v[228:231], v[196:199], v[68:71]
ds_read_b64_tr_b16 v[108:109], v16 offset:28672
ds_read_b64_tr_b16 v[110:111], v16 offset:29184
v_mfma_f32_16x16x32_bf16 v[84:87], v[228:231], v[200:203], v[84:87]
ds_read_b64_tr_b16 v[112:113], v17 offset:28672
ds_read_b64_tr_b16 v[114:115], v17 offset:29184
v_mfma_f32_16x16x32_bf16 v[72:75], v[232:235], v[196:199], v[72:75]
s_add_u32 s57, s57, 2048
s_and_b32 s57, s57, 0x7fff
v_mfma_f32_16x16x32_bf16 v[88:91], v[232:235], v[200:203], v[88:91]
s_waitcnt vmcnt(6) lgkmcnt(8)
v_mfma_f32_16x16x32_bf16 v[60:63], v[236:239], v[204:207], v[60:63]
buffer_load_dwordx4 v[172:175], v38, s[32:35], s57 offen sc1
v_mfma_f32_16x16x32_bf16 v[76:79], v[236:239], v[208:211], v[76:79]
ds_read_b64_tr_b16 v[220:221], v14 offset:32768
ds_read_b64_tr_b16 v[222:223], v14 offset:33280
v_mfma_f32_16x16x32_bf16 v[64:67], v[240:243], v[204:207], v[64:67]
ds_read_b64_tr_b16 v[224:225], v15 offset:32768
ds_read_b64_tr_b16 v[226:227], v15 offset:33280
v_mfma_f32_16x16x32_bf16 v[80:83], v[240:243], v[208:211], v[80:83]
buffer_load_dwordx4 v[176:179], v39, s[32:35], s57 offen sc1
v_mfma_f32_16x16x32_bf16 v[68:71], v[244:247], v[204:207], v[68:71]
ds_read_b64_tr_b16 v[228:229], v16 offset:32768
ds_read_b64_tr_b16 v[230:231], v16 offset:33280
v_mfma_f32_16x16x32_bf16 v[84:87], v[244:247], v[208:211], v[84:87]
ds_read_b64_tr_b16 v[232:233], v17 offset:32768
ds_read_b64_tr_b16 v[234:235], v17 offset:33280
v_mfma_f32_16x16x32_bf16 v[72:75], v[248:251], v[204:207], v[72:75]
v_mfma_f32_16x16x32_bf16 v[88:91], v[248:251], v[208:211], v[88:91]
s_waitcnt vmcnt(6) lgkmcnt(8)
v_mfma_f32_16x16x32_bf16 v[60:63], v[100:103], v[212:215], v[60:63]
buffer_load_dwordx4 v[180:183], v38, s[32:35], s57 offen offset:1024 sc1
v_mfma_f32_16x16x32_bf16 v[76:79], v[100:103], v[216:219], v[76:79]
ds_read_b64_tr_b16 v[236:237], v14 offset:36864
ds_read_b64_tr_b16 v[238:239], v14 offset:37376
v_mfma_f32_16x16x32_bf16 v[64:67], v[104:107], v[212:215], v[64:67]
ds_read_b64_tr_b16 v[240:241], v15 offset:36864
ds_read_b64_tr_b16 v[242:243], v15 offset:37376
v_mfma_f32_16x16x32_bf16 v[80:83], v[104:107], v[216:219], v[80:83]
buffer_load_dwordx4 v[184:187], v39, s[32:35], s57 offen offset:1024 sc1
v_mfma_f32_16x16x32_bf16 v[68:71], v[108:111], v[212:215], v[68:71]
ds_read_b64_tr_b16 v[244:245], v16 offset:36864
ds_read_b64_tr_b16 v[246:247], v16 offset:37376
v_mfma_f32_16x16x32_bf16 v[84:87], v[108:111], v[216:219], v[84:87]
ds_read_b64_tr_b16 v[248:249], v17 offset:36864
ds_read_b64_tr_b16 v[250:251], v17 offset:37376
v_mfma_f32_16x16x32_bf16 v[72:75], v[112:115], v[212:215], v[72:75]
s_add_u32 s57, s57, 2048
s_and_b32 s57, s57, 0x7fff
v_mfma_f32_16x16x32_bf16 v[88:91], v[112:115], v[216:219], v[88:91]
s_waitcnt vmcnt(6) lgkmcnt(8)
v_mfma_f32_16x16x32_bf16 v[60:63], v[220:223], v[156:159], v[60:63]
buffer_load_dwordx4 v[188:191], v38, s[32:35], s57 offen sc1
v_mfma_f32_16x16x32_bf16 v[76:79], v[220:223], v[160:163], v[76:79]
ds_read_b64_tr_b16 v[100:101], v14 offset:40960
ds_read_b64_tr_b16 v[102:103], v14 offset:41472
v_mfma_f32_16x16x32_bf16 v[64:67], v[224:227], v[156:159], v[64:67]
ds_read_b64_tr_b16 v[104:105], v15 offset:40960
ds_read_b64_tr_b16 v[106:107], v15 offset:41472
v_mfma_f32_16x16x32_bf16 v[80:83], v[224:227], v[160:163], v[80:83]
buffer_load_dwordx4 v[192:195], v39, s[32:35], s57 offen sc1
v_mfma_f32_16x16x32_bf16 v[68:71], v[228:231], v[156:159], v[68:71]
ds_read_b64_tr_b16 v[108:109], v16 offset:40960
ds_read_b64_tr_b16 v[110:111], v16 offset:41472
v_mfma_f32_16x16x32_bf16 v[84:87], v[228:231], v[160:163], v[84:87]
ds_read_b64_tr_b16 v[112:113], v17 offset:40960
ds_read_b64_tr_b16 v[114:115], v17 offset:41472
v_mfma_f32_16x16x32_bf16 v[72:75], v[232:235], v[156:159], v[72:75]
v_mfma_f32_16x16x32_bf16 v[88:91], v[232:235], v[160:163], v[88:91]
s_waitcnt vmcnt(6) lgkmcnt(8)
v_mfma_f32_16x16x32_bf16 v[60:63], v[236:239], v[164:167], v[60:63]
buffer_load_dwordx4 v[196:199], v38, s[32:35], s57 offen offset:1024 sc1
v_mfma_f32_16x16x32_bf16 v[76:79], v[236:239], v[168:171], v[76:79]
ds_read_b64_tr_b16 v[220:221], v14 offset:45056
ds_read_b64_tr_b16 v[222:223], v14 offset:45568
v_mfma_f32_16x16x32_bf16 v[64:67], v[240:243], v[164:167], v[64:67]
ds_read_b64_tr_b16 v[224:225], v15 offset:45056
ds_read_b64_tr_b16 v[226:227], v15 offset:45568
v_mfma_f32_16x16x32_bf16 v[80:83], v[240:243], v[168:171], v[80:83]
buffer_load_dwordx4 v[200:203], v39, s[32:35], s57 offen offset:1024 sc1
v_mfma_f32_16x16x32_bf16 v[68:71], v[244:247], v[164:167], v[68:71]
ds_read_b64_tr_b16 v[228:229], v16 offset:45056
ds_read_b64_tr_b16 v[230:231], v16 offset:45568
v_mfma_f32_16x16x32_bf16 v[84:87], v[244:247], v[168:171], v[84:87]
ds_read_b64_tr_b16 v[232:233], v17 offset:45056
ds_read_b64_tr_b16 v[234:235], v17 offset:45568
v_mfma_f32_16x16x32_bf16 v[72:75], v[248:251], v[164:167], v[72:75]
s_add_u32 s57, s57, 2048
s_and_b32 s57, s57, 0x7fff
v_mfma_f32_16x16x32_bf16 v[88:91], v[248:251], v[168:171], v[88:91]
s_waitcnt vmcnt(6) lgkmcnt(8)
v_mfma_f32_16x16x32_bf16 v[60:63], v[100:103], v[172:175], v[60:63]
buffer_load_dwordx4 v[204:207], v38, s[32:35], s57 offen sc1
v_mfma_f32_16x16x32_bf16 v[76:79], v[100:103], v[176:179], v[76:79]
ds_read_b64_tr_b16 v[236:237], v14 offset:49152
ds_read_b64_tr_b16 v[238:239], v14 offset:49664
v_mfma_f32_16x16x32_bf16 v[64:67], v[104:107], v[172:175], v[64:67]
ds_read_b64_tr_b16 v[240:241], v15 offset:49152
ds_read_b64_tr_b16 v[242:243], v15 offset:49664
v_mfma_f32_16x16x32_bf16 v[80:83], v[104:107], v[176:179], v[80:83]
buffer_load_dwordx4 v[208:211], v39, s[32:35], s57 offen sc1
v_mfma_f32_16x16x32_bf16 v[68:71], v[108:111], v[172:175], v[68:71]
ds_read_b64_tr_b16 v[244:245], v16 offset:49152
ds_read_b64_tr_b16 v[246:247], v16 offset:49664
v_mfma_f32_16x16x32_bf16 v[84:87], v[108:111], v[176:179], v[84:87]
ds_read_b64_tr_b16 v[248:249], v17 offset:49152
ds_read_b64_tr_b16 v[250:251], v17 offset:49664
v_mfma_f32_16x16x32_bf16 v[72:75], v[112:115], v[172:175], v[72:75]
v_mfma_f32_16x16x32_bf16 v[88:91], v[112:115], v[176:179], v[88:91]
s_waitcnt vmcnt(6) lgkmcnt(8)
v_mfma_f32_16x16x32_bf16 v[60:63], v[220:223], v[180:183], v[60:63]
buffer_load_dwordx4 v[212:215], v38, s[32:35], s57 offen offset:1024 sc1
v_mfma_f32_16x16x32_bf16 v[76:79], v[220:223], v[184:187], v[76:79]
ds_read_b64_tr_b16 v[100:101], v14 offset:53248
ds_read_b64_tr_b16 v[102:103], v14 offset:53760
v_mfma_f32_16x16x32_bf16 v[64:67], v[224:227], v[180:183], v[64:67]
ds_read_b64_tr_b16 v[104:105], v15 offset:53248
ds_read_b64_tr_b16 v[106:107], v15 offset:53760
v_mfma_f32_16x16x32_bf16 v[80:83], v[224:227], v[184:187], v[80:83]
buffer_load_dwordx4 v[216:219], v39, s[32:35], s57 offen offset:1024 sc1
v_mfma_f32_16x16x32_bf16 v[68:71], v[228:231], v[180:183], v[68:71]
ds_read_b64_tr_b16 v[108:109], v16 offset:53248
ds_read_b64_tr_b16 v[110:111], v16 offset:53760
v_mfma_f32_16x16x32_bf16 v[84:87], v[228:231], v[184:187], v[84:87]
ds_read_b64_tr_b16 v[112:113], v17 offset:53248
ds_read_b64_tr_b16 v[114:115], v17 offset:53760
v_mfma_f32_16x16x32_bf16 v[72:75], v[232:235], v[180:183], v[72:75]
v_mfma_f32_16x16x32_bf16 v[88:91], v[232:235], v[184:187], v[88:91]
s_waitcnt vmcnt(6) lgkmcnt(8)
v_mfma_f32_16x16x32_bf16 v[60:63], v[236:239], v[188:191], v[60:63]
v_mfma_f32_16x16x32_bf16 v[76:79], v[236:239], v[192:195], v[76:79]
ds_read_b64_tr_b16 v[220:221], v14 offset:57344
ds_read_b64_tr_b16 v[222:223], v14 offset:57856
v_mfma_f32_16x16x32_bf16 v[64:67], v[240:243], v[188:191], v[64:67]
ds_read_b64_tr_b16 v[224:225], v15 offset:57344
ds_read_b64_tr_b16 v[226:227], v15 offset:57856
v_mfma_f32_16x16x32_bf16 v[80:83], v[240:243], v[192:195], v[80:83]
v_mfma_f32_16x16x32_bf16 v[68:71], v[244:247], v[188:191], v[68:71]
ds_read_b64_tr_b16 v[228:229], v16 offset:57344
ds_read_b64_tr_b16 v[230:231], v16 offset:57856
v_mfma_f32_16x16x32_bf16 v[84:87], v[244:247], v[192:195], v[84:87]
ds_read_b64_tr_b16 v[232:233], v17 offset:57344
ds_read_b64_tr_b16 v[234:235], v17 offset:57856
v_mfma_f32_16x16x32_bf16 v[72:75], v[248:251], v[188:191], v[72:75]
v_mfma_f32_16x16x32_bf16 v[88:91], v[248:251], v[192:195], v[88:91]
s_waitcnt vmcnt(4) lgkmcnt(8)
v_mfma_f32_16x16x32_bf16 v[60:63], v[100:103], v[196:199], v[60:63]
v_mfma_f32_16x16x32_bf16 v[76:79], v[100:103], v[200:203], v[76:79]
ds_read_b64_tr_b16 v[236:237], v14 offset:61440
ds_read_b64_tr_b16 v[238:239], v14 offset:61952
v_mfma_f32_16x16x32_bf16 v[64:67], v[104:107], v[196:199], v[64:67]
ds_read_b64_tr_b16 v[240:241], v15 offset:61440
ds_read_b64_tr_b16 v[242:243], v15 offset:61952
v_mfma_f32_16x16x32_bf16 v[80:83], v[104:107], v[200:203], v[80:83]
v_mfma_f32_16x16x32_bf16 v[68:71], v[108:111], v[196:199], v[68:71]
ds_read_b64_tr_b16 v[244:245], v16 offset:61440
ds_read_b64_tr_b16 v[246:247], v16 offset:61952
v_mfma_f32_16x16x32_bf16 v[84:87], v[108:111], v[200:203], v[84:87]
ds_read_b64_tr_b16 v[248:249], v17 offset:61440
ds_read_b64_tr_b16 v[250:251], v17 offset:61952
v_mfma_f32_16x16x32_bf16 v[72:75], v[112:115], v[196:199], v[72:75]
v_mfma_f32_16x16x32_bf16 v[88:91], v[112:115], v[200:203], v[88:91]
s_waitcnt vmcnt(2) lgkmcnt(8)
v_mfma_f32_16x16x32_bf16 v[60:63], v[220:223], v[204:207], v[60:63]
v_mfma_f32_16x16x32_bf16 v[76:79], v[220:223], v[208:211], v[76:79]
v_mfma_f32_16x16x32_bf16 v[64:67], v[224:227], v[204:207], v[64:67]
v_mfma_f32_16x16x32_bf16 v[80:83], v[224:227], v[208:211], v[80:83]
v_mfma_f32_16x16x32_bf16 v[68:71], v[228:231], v[204:207], v[68:71]
v_mfma_f32_16x16x32_bf16 v[84:87], v[228:231], v[208:211], v[84:87]
v_mfma_f32_16x16x32_bf16 v[72:75], v[232:235], v[204:207], v[72:75]
v_mfma_f32_16x16x32_bf16 v[88:91], v[232:235], v[208:211], v[88:91]
s_waitcnt vmcnt(0) lgkmcnt(0)
v_mfma_f32_16x16x32_bf16 v[60:63], v[236:239], v[212:215], v[60:63]
v_mfma_f32_16x16x32_bf16 v[64:67], v[240:243], v[212:215], v[64:67]
v_mfma_f32_16x16x32_bf16 v[68:71], v[244:247], v[212:215], v[68:71]
v_mfma_f32_16x16x32_bf16 v[72:75], v[248:251], v[212:215], v[72:75]
v_mfma_f32_16x16x32_bf16 v[76:79], v[236:239], v[216:219], v[76:79]
v_mfma_f32_16x16x32_bf16 v[80:83], v[240:243], v[216:219], v[80:83]
v_mfma_f32_16x16x32_bf16 v[84:87], v[244:247], v[216:219], v[84:87]
v_mfma_f32_16x16x32_bf16 v[88:91], v[248:251], v[216:219], v[88:91]
s_cmp_eq_u32 s46, 0
s_cbranch_scc1 slow_77
s_nop 0
v_cvt_pk_bf16_f32 v20, v60, v61
v_cvt_pk_bf16_f32 v21, v62, v63
v_cvt_pk_bf16_f32 v22, v64, v65
v_cvt_pk_bf16_f32 v23, v66, v67
buffer_store_dwordx4 v[20:23], v18, s[32:35], s85 offen offset:0
v_cvt_pk_bf16_f32 v24, v68, v69
v_cvt_pk_bf16_f32 v25, v70, v71
v_cvt_pk_bf16_f32 v26, v72, v73
v_cvt_pk_bf16_f32 v27, v74, v75
buffer_store_dwordx4 v[24:27], v18, s[32:35], s85 offen offset:1024
v_cvt_pk_bf16_f32 v28, v76, v77
v_cvt_pk_bf16_f32 v29, v78, v79
v_cvt_pk_bf16_f32 v30, v80, v81
v_cvt_pk_bf16_f32 v31, v82, v83
buffer_store_dwordx4 v[28:31], v18, s[32:35], s86 offen offset:0
v_cvt_pk_bf16_f32 v32, v84, v85
v_cvt_pk_bf16_f32 v33, v86, v87
v_cvt_pk_bf16_f32 v34, v88, v89
v_cvt_pk_bf16_f32 v35, v90, v91
buffer_store_dwordx4 v[32:35], v18, s[32:35], s86 offen offset:1024
s_barrier
v_dot2c_f32_bf16 v6, v20, v48
v_dot2c_f32_bf16 v8, v20, v20
v_dot2c_f32_bf16 v7, v28, v48
v_dot2c_f32_bf16 v9, v28, v28
v_dot2c_f32_bf16 v6, v21, v48
v_dot2c_f32_bf16 v8, v21, v21
v_dot2c_f32_bf16 v7, v29, v48
v_dot2c_f32_bf16 v9, v29, v29
v_dot2c_f32_bf16 v6, v22, v48
v_dot2c_f32_bf16 v8, v22, v22
v_dot2c_f32_bf16 v7, v30, v48
v_dot2c_f32_bf16 v9, v30, v30
v_dot2c_f32_bf16 v6, v23, v48
v_dot2c_f32_bf16 v8, v23, v23
v_dot2c_f32_bf16 v7, v31, v48
v_dot2c_f32_bf16 v9, v31, v31
v_dot2c_f32_bf16 v6, v24, v48
v_dot2c_f32_bf16 v8, v24, v24
v_dot2c_f32_bf16 v7, v32, v48
v_dot2c_f32_bf16 v9, v32, v32
v_dot2c_f32_bf16 v6, v25, v48
v_dot2c_f32_bf16 v8, v25, v25
v_dot2c_f32_bf16 v7, v33, v48
v_dot2c_f32_bf16 v9, v33, v33
v_dot2c_f32_bf16 v6, v26, v48
v_dot2c_f32_bf16 v8, v26, v26
v_dot2c_f32_bf16 v7, v34, v48
v_dot2c_f32_bf16 v9, v34, v34
v_dot2c_f32_bf16 v6, v27, v48
v_dot2c_f32_bf16 v8, v27, v27
v_dot2c_f32_bf16 v7, v35, v48
v_dot2c_f32_bf16 v9, v35, v35
s_mov_b64 exec, 1
s_waitcnt vmcnt(0)
buffer_store_dword v5, v4, s[32:35], s88 offen
s_mov_b64 exec, -1
s_nop 1
v_permlane32_swap_b32 v6, v7
v_permlane32_swap_b32 v8, v9
v_add_f32 v6, v6, v7
v_add_f32 v8, v8, v9
s_nop 1
v_permlane16_swap_b32 v6, v8
s_nop 0
v_add_f32 v6, v6, v8
buffer_store_dword v6, v1, s[32:35], s87 offen
back_78:
s_lshl_b32 s49, s44, 13
v_add_u32 v10, s49, v18
v_add_u32 v11, 1024, v10
s_lshl_b32 s48, s43, 1
v_lshrrev_b32 v4, 2, v2
v_and_b32 v5, 3, v0
v_lshl_add_u32 v6, v3, 3, v4
v_lshlrev_b32 v6, 7, v6
v_lshl_add_u32 v6, v5, 3, v6
v_lshrrev_b32 v7, 1, v4
v_and_b32 v8, 1, v3
v_lshl_add_u32 v7, v8, 1, v7
v_xor_b32 v7, s48, v7
v_lshl_add_u32 v12, v7, 5, v6
v_add_u32 v12, 16384, v12
v_xor_b32 v13, 32, v12
v_mov_b32 v14, v10
v_mov_b32 v15, v11
v_add_u32 v16, 122880, v12
v_add_u32 v17, 122880, v13
v_mov_b32 v156, 0
v_mov_b32 v157, 0
v_mov_b32 v158, 0
v_mov_b32 v159, 0
v_mov_b32 v160, 0
v_mov_b32 v161, 0
v_mov_b32 v162, 0
v_mov_b32 v163, 0
v_mov_b32 v164, 0
v_mov_b32 v165, 0
v_mov_b32 v166, 0
v_mov_b32 v167, 0
v_mov_b32 v168, 0
v_mov_b32 v169, 0
v_mov_b32 v170, 0
v_mov_b32 v171, 0
v_mov_b32 v172, 0
v_mov_b32 v173, 0
v_mov_b32 v174, 0
v_mov_b32 v175, 0
v_mov_b32 v176, 0
v_mov_b32 v177, 0
v_mov_b32 v178, 0
v_mov_b32 v179, 0
v_mov_b32 v180, 0
v_mov_b32 v181, 0
v_mov_b32 v182, 0
v_mov_b32 v183, 0
v_mov_b32 v184, 0
v_mov_b32 v185, 0
v_mov_b32 v186, 0
v_mov_b32 v187, 0
v_mov_b32 v188, 0
v_mov_b32 v189, 0
v_mov_b32 v190, 0
v_mov_b32 v191, 0
v_mov_b32 v192, 0
v_mov_b32 v193, 0
v_mov_b32 v194, 0
v_mov_b32 v195, 0
v_mov_b32 v196, 0
v_mov_b32 v197, 0
v_mov_b32 v198, 0
v_mov_b32 v199, 0
v_mov_b32 v200, 0
v_mov_b32 v201, 0
v_mov_b32 v202, 0
v_mov_b32 v203, 0
v_mov_b32 v204, 0
v_mov_b32 v205, 0
v_mov_b32 v206, 0
v_mov_b32 v207, 0
v_mov_b32 v208, 0
v_mov_b32 v209, 0
v_mov_b32 v210, 0
v_mov_b32 v211, 0
v_mov_b32 v212, 0
v_mov_b32 v213, 0
v_mov_b32 v214, 0
v_mov_b32 v215, 0
v_mov_b32 v216, 0
v_mov_b32 v217, 0
v_mov_b32 v218, 0
v_mov_b32 v219, 0
v_mov_b32 v220, 0
v_mov_b32 v221, 0
v_mov_b32 v222, 0
v_mov_b32 v223, 0
v_mov_b32 v224, 0
v_mov_b32 v225, 0
v_mov_b32 v226, 0
v_mov_b32 v227, 0
v_mov_b32 v228, 0
v_mov_b32 v229, 0
v_mov_b32 v230, 0
v_mov_b32 v231, 0
v_mov_b32 v232, 0
v_mov_b32 v233, 0
v_mov_b32 v234, 0
v_mov_b32 v235, 0
v_mov_b32 v236, 0
v_mov_b32 v237, 0
v_mov_b32 v238, 0
v_mov_b32 v239, 0
v_mov_b32 v240, 0
v_mov_b32 v241, 0
v_mov_b32 v242, 0
v_mov_b32 v243, 0
v_mov_b32 v244, 0
v_mov_b32 v245, 0
v_mov_b32 v246, 0
v_mov_b32 v247, 0
v_mov_b32 v248, 0
v_mov_b32 v249, 0
v_mov_b32 v250, 0
v_mov_b32 v251, 0
s_mov_b32 s48, 0xf149f2ca
v_mov_b32 v9, s48
v_lshlrev_b32 v4, 2, v3
v_sub_u32 v4, v2, v4
v_subrev_u32 v5, 0, v4
v_and_b32 v6, 0x80000001, v5
v_cmp_eq_u32 vcc, 0, v6
v_add_u32 v5, 1, v5
v_and_b32 v6, 0x80000001, v5
v_cndmask_b32 v40, v9, 0, vcc
v_cmp_eq_u32 vcc, 0x80000001, v6
s_nop 1
v_cndmask_b32 v36, v9, 0, vcc
v_subrev_u32 v5, 1, v4
v_and_b32 v6, 0x80000001, v5
v_cmp_eq_u32 vcc, 0, v6
v_add_u32 v5, 1, v5
v_and_b32 v6, 0x80000001, v5
v_cndmask_b32 v41, v9, 0, vcc
v_cmp_eq_u32 vcc, 0x80000001, v6
s_nop 1
v_cndmask_b32 v37, v9, 0, vcc
v_subrev_u32 v5, 2, v4
v_and_b32 v6, 0x80000001, v5
v_cmp_eq_u32 vcc, 0, v6
v_add_u32 v5, 1, v5
v_and_b32 v6, 0x80000001, v5
v_cndmask_b32 v42, v9, 0, vcc
v_cmp_eq_u32 vcc, 0x80000001, v6
s_nop 1
v_cndmask_b32 v38, v9, 0, vcc
v_subrev_u32 v5, 3, v4
v_and_b32 v6, 0x80000001, v5
v_cmp_eq_u32 vcc, 0, v6
v_add_u32 v5, 1, v5
v_and_b32 v6, 0x80000001, v5
v_cndmask_b32 v43, v9, 0, vcc
v_cmp_eq_u32 vcc, 0x80000001, v6
s_nop 1
v_cndmask_b32 v39, v9, 0, vcc
s_or_b32 s48, s41, s44
s_cmp_eq_u32 s48, 0
s_cselect_b64 vcc, -1, 0
v_cndmask_b32 v44, v36, v9, vcc
v_cndmask_b32 v45, v37, v9, vcc
v_cndmask_b32 v46, v38, v9, vcc
v_cndmask_b32 v47, v39, v9, vcc
v_and_b32 v4, 1, v2
v_lshlrev_b32 v4, 4, v4
v_mov_b32 v5, 0xffff
v_lshlrev_b32 v52, v4, v5
s_lshl_b32 s48, s43, 11
s_add_u32 s48, s48, 135168
v_add_u32 v53, s48, v18
v_lshl_add_u32 v55, v0, 3, s48
s_add_u32 s48, s41, s44
s_sub_u32 s48, s48, 1
s_lshl_b32 s49, s48, 1
s_add_u32 s49, s49, s43
s_lshl_b32 s49, s49, 11
s_mul_i32 s50, s42, 393216
s_add_u32 s49, s49, s50
s_add_u32 s49, s49, 9699328
s_cmp_lt_i32 s48, 0
s_cselect_b32 s49, 0xf0000000, s49
v_add_u32 v58, s49, v18
v_lshl_add_u32 v59, v0, 3, s49
s_lshl_b32 s48, s43, 2
s_add_u32 s48, s48, 134672
v_mov_b32 v19, s48
s_lshl_b32 s48, s43, 7
s_add_u32 s48, s48, 133120
v_lshl_add_u32 v7, v3, 4, s48
v_lshl_add_u32 v54, v2, 2, s48
s_lshl_b32 s49, s44, 6
v_add_u32 v8, s49, v2
v_lshlrev_b32 v8, 3, v8
v_add_u32 v8, 131072, v8
v_lshl_add_u32 v9, v3, 2, s49
v_lshlrev_b32 v9, 2, v9
v_add_u32 v9, 132096, v9
s_mov_b32 s64, 0
s_mov_b32 s65, 0
s_mov_b32 s66, 0x3e8293ee
s_barrier
ds_read_b128 v[60:63], v14 offset:0
ds_read_b128 v[64:67], v14 offset:2048
ds_read_b128 v[68:71], v14 offset:4096
ds_read_b128 v[72:75], v14 offset:6144
ds_read_b64_tr_b16 v[84:85], v16 offset:8192
ds_read_b64_tr_b16 v[86:87], v16 offset:8704
ds_read_b64_tr_b16 v[88:89], v17 offset:8192
ds_read_b64_tr_b16 v[90:91], v17 offset:8704
ds_read_b64_tr_b16 v[92:93], v16 offset:16384
ds_read_b64_tr_b16 v[94:95], v16 offset:16896
ds_read_b64_tr_b16 v[96:97], v17 offset:16384
ds_read_b64_tr_b16 v[98:99], v17 offset:16896
ds_read_b64_tr_b16 v[76:77], v16 offset:0
ds_read_b64_tr_b16 v[78:79], v16 offset:512
ds_read_b64_tr_b16 v[80:81], v17 offset:0
ds_read_b64_tr_b16 v[82:83], v17 offset:512
s_waitcnt lgkmcnt(0)
c2_loop:
v_mfma_f32_16x16x32_bf16 v[212:215], v[84:87], v[72:75], v[212:215]
ds_read_b128 v[100:103], v15 offset:0
v_mfma_f32_16x16x32_bf16 v[204:207], v[84:87], v[68:71], v[204:207]
ds_read_b128 v[104:107], v15 offset:2048
v_mfma_f32_16x16x32_bf16 v[196:199], v[84:87], v[64:67], v[196:199]
ds_read_b128 v[108:111], v15 offset:4096
v_mfma_f32_16x16x32_bf16 v[188:191], v[84:87], v[60:63], v[188:191]
ds_read_b128 v[112:115], v15 offset:6144
v_mfma_f32_16x16x32_bf16 v[192:195], v[88:91], v[60:63], v[192:195]
ds_read_b64_tr_b16 v[124:125], v16 offset:12288
v_mfma_f32_16x16x32_bf16 v[200:203], v[88:91], v[64:67], v[200:203]
ds_read_b64_tr_b16 v[126:127], v16 offset:12800
v_mfma_f32_16x16x32_bf16 v[208:211], v[88:91], v[68:71], v[208:211]
ds_read_b64_tr_b16 v[128:129], v17 offset:12288
v_mfma_f32_16x16x32_bf16 v[216:219], v[88:91], v[72:75], v[216:219]
ds_read_b64_tr_b16 v[130:131], v17 offset:12800
v_mfma_f32_16x16x32_bf16 v[244:247], v[72:75], v[92:95], v[244:247]
ds_read_b64_tr_b16 v[132:133], v16 offset:20480
v_mfma_f32_16x16x32_bf16 v[236:239], v[68:71], v[92:95], v[236:239]
ds_read_b64_tr_b16 v[134:135], v16 offset:20992
v_mfma_f32_16x16x32_bf16 v[228:231], v[64:67], v[92:95], v[228:231]
ds_read_b64_tr_b16 v[136:137], v17 offset:20480
v_mfma_f32_16x16x32_bf16 v[220:223], v[60:63], v[92:95], v[220:223]
ds_read_b64_tr_b16 v[138:139], v17 offset:20992
v_mfma_f32_16x16x32_bf16 v[224:227], v[60:63], v[96:99], v[224:227]
ds_read_b64_tr_b16 v[116:117], v16 offset:4096
v_mfma_f32_16x16x32_bf16 v[232:235], v[64:67], v[96:99], v[232:235]
ds_read_b64_tr_b16 v[118:119], v16 offset:4608
v_mfma_f32_16x16x32_bf16 v[240:243], v[68:71], v[96:99], v[240:243]
ds_read_b64_tr_b16 v[120:121], v17 offset:4096
v_mfma_f32_16x16x32_bf16 v[248:251], v[72:75], v[96:99], v[248:251]
ds_read_b64_tr_b16 v[122:123], v17 offset:4608
v_mfma_f32_16x16x32_bf16 v[180:183], v[76:79], v[72:75], v[180:183]
s_add_u32 s65, s65, 40960
s_cmp_eq_u32 s65, 122880
v_mfma_f32_16x16x32_bf16 v[172:175], v[76:79], v[68:71], v[172:175]
s_cselect_b32 s65, 0, s65
s_add_u32 s64, s64, 1
v_mfma_f32_16x16x32_bf16 v[164:167], v[76:79], v[64:67], v[164:167]
v_add_u32 v14, s65, v10
v_add_u32 v15, s65, v11
v_mfma_f32_16x16x32_bf16 v[156:159], v[76:79], v[60:63], v[156:159]
v_add_u32 v16, s65, v12
v_add_u32 v17, s65, v13
v_mfma_f32_16x16x32_bf16 v[160:163], v[80:83], v[60:63], v[160:163]
v_mfma_f32_16x16x32_bf16 v[168:171], v[80:83], v[64:67], v[168:171]
s_cmp_eq_u32 s64, 16
s_cbranch_scc1 c2_last
v_mfma_f32_16x16x32_bf16 v[176:179], v[80:83], v[68:71], v[176:179]
s_waitcnt lgkmcnt(0)
v_mfma_f32_16x16x32_bf16 v[184:187], v[80:83], v[72:75], v[184:187]
s_barrier
v_mfma_f32_16x16x32_bf16 v[212:215], v[124:127], v[112:115], v[212:215]
ds_read_b128 v[60:63], v14 offset:0
v_mfma_f32_16x16x32_bf16 v[204:207], v[124:127], v[108:111], v[204:207]
ds_read_b128 v[64:67], v14 offset:2048
v_mfma_f32_16x16x32_bf16 v[196:199], v[124:127], v[104:107], v[196:199]
ds_read_b128 v[68:71], v14 offset:4096
v_mfma_f32_16x16x32_bf16 v[188:191], v[124:127], v[100:103], v[188:191]
ds_read_b128 v[72:75], v14 offset:6144
v_mfma_f32_16x16x32_bf16 v[192:195], v[128:131], v[100:103], v[192:195]
ds_read_b64_tr_b16 v[84:85], v16 offset:8192
v_mfma_f32_16x16x32_bf16 v[200:203], v[128:131], v[104:107], v[200:203]
ds_read_b64_tr_b16 v[86:87], v16 offset:8704
v_mfma_f32_16x16x32_bf16 v[208:211], v[128:131], v[108:111], v[208:211]
ds_read_b64_tr_b16 v[88:89], v17 offset:8192
v_mfma_f32_16x16x32_bf16 v[216:219], v[128:131], v[112:115], v[216:219]
ds_read_b64_tr_b16 v[90:91], v17 offset:8704
v_mfma_f32_16x16x32_bf16 v[244:247], v[112:115], v[132:135], v[244:247]
ds_read_b64_tr_b16 v[92:93], v16 offset:16384
v_mfma_f32_16x16x32_bf16 v[236:239], v[108:111], v[132:135], v[236:239]
ds_read_b64_tr_b16 v[94:95], v16 offset:16896
v_mfma_f32_16x16x32_bf16 v[228:231], v[104:107], v[132:135], v[228:231]
ds_read_b64_tr_b16 v[96:97], v17 offset:16384
v_mfma_f32_16x16x32_bf16 v[220:223], v[100:103], v[132:135], v[220:223]
ds_read_b64_tr_b16 v[98:99], v17 offset:16896
v_mfma_f32_16x16x32_bf16 v[224:227], v[100:103], v[136:139], v[224:227]
ds_read_b64_tr_b16 v[76:77], v16 offset:0
v_mfma_f32_16x16x32_bf16 v[232:235], v[104:107], v[136:139], v[232:235]
ds_read_b64_tr_b16 v[78:79], v16 offset:512
v_mfma_f32_16x16x32_bf16 v[240:243], v[108:111], v[136:139], v[240:243]
ds_read_b64_tr_b16 v[80:81], v17 offset:0
v_mfma_f32_16x16x32_bf16 v[248:251], v[112:115], v[136:139], v[248:251]
ds_read_b64_tr_b16 v[82:83], v17 offset:512
v_mfma_f32_16x16x32_bf16 v[180:183], v[116:119], v[112:115], v[180:183]
v_mfma_f32_16x16x32_bf16 v[172:175], v[116:119], v[108:111], v[172:175]
v_mfma_f32_16x16x32_bf16 v[164:167], v[116:119], v[104:107], v[164:167]
v_mfma_f32_16x16x32_bf16 v[156:159], v[116:119], v[100:103], v[156:159]
v_mfma_f32_16x16x32_bf16 v[160:163], v[120:123], v[100:103], v[160:163]
v_mfma_f32_16x16x32_bf16 v[168:171], v[120:123], v[104:107], v[168:171]
v_mfma_f32_16x16x32_bf16 v[176:179], v[120:123], v[108:111], v[176:179]
s_waitcnt lgkmcnt(0)
v_mfma_f32_16x16x32_bf16 v[184:187], v[120:123], v[112:115], v[184:187]
s_branch c2_loop
c2_last:
v_mfma_f32_16x16x32_bf16 v[176:179], v[80:83], v[68:71], v[176:179]
s_waitcnt lgkmcnt(0)
v_mfma_f32_16x16x32_bf16 v[184:187], v[80:83], v[72:75], v[184:187]
s_barrier
v_mfma_f32_16x16x32_bf16 v[212:215], v[124:127], v[112:115], v[212:215]
ds_read_b128 v[140:143], v7 offset:0
v_mfma_f32_16x16x32_bf16 v[204:207], v[124:127], v[108:111], v[204:207]
ds_read_b128 v[144:147], v7 offset:64
v_mfma_f32_16x16x32_bf16 v[196:199], v[124:127], v[104:107], v[196:199]
ds_read_b128 v[148:151], v7 offset:256
v_mfma_f32_16x16x32_bf16 v[188:191], v[124:127], v[100:103], v[188:191]
ds_read_b128 v[152:155], v7 offset:320
v_mfma_f32_16x16x32_bf16 v[192:195], v[128:131], v[100:103], v[192:195]
ds_read_b64 v[92:93], v8 offset:0
v_mfma_f32_16x16x32_bf16 v[200:203], v[128:131], v[104:107], v[200:203]
ds_read_b64 v[94:95], v8 offset:128
v_mfma_f32_16x16x32_bf16 v[208:211], v[128:131], v[108:111], v[208:211]
ds_read_b64 v[96:97], v8 offset:256
v_mfma_f32_16x16x32_bf16 v[216:219], v[128:131], v[112:115], v[216:219]
ds_read_b64 v[98:99], v8 offset:384
v_mfma_f32_16x16x32_bf16 v[244:247], v[112:115], v[132:135], v[244:247]
ds_read2_b32 v[56:57], v54 offset0:128 offset1:144
v_mfma_f32_16x16x32_bf16 v[236:239], v[108:111], v[132:135], v[236:239]
ds_read_b128 v[60:63], v9 offset:0
v_mfma_f32_16x16x32_bf16 v[228:231], v[104:107], v[132:135], v[228:231]
ds_read_b128 v[64:67], v9 offset:64
v_mfma_f32_16x16x32_bf16 v[220:223], v[100:103], v[132:135], v[220:223]
ds_read_b128 v[68:71], v9 offset:128
v_mfma_f32_16x16x32_bf16 v[224:227], v[100:103], v[136:139], v[224:227]
ds_read_b128 v[72:75], v9 offset:192
v_mfma_f32_16x16x32_bf16 v[232:235], v[104:107], v[136:139], v[232:235]
ds_read_b128 v[76:79], v9 offset:512
v_mfma_f32_16x16x32_bf16 v[240:243], v[108:111], v[136:139], v[240:243]
ds_read_b128 v[80:83], v9 offset:576
v_mfma_f32_16x16x32_bf16 v[248:251], v[112:115], v[136:139], v[248:251]
ds_read_b128 v[84:87], v9 offset:640
v_mfma_f32_16x16x32_bf16 v[180:183], v[116:119], v[112:115], v[180:183]
ds_read_b128 v[88:91], v9 offset:704
v_mfma_f32_16x16x32_bf16 v[172:175], v[116:119], v[108:111], v[172:175]
v_mfma_f32_16x16x32_bf16 v[164:167], v[116:119], v[104:107], v[164:167]
v_mfma_f32_16x16x32_bf16 v[156:159], v[116:119], v[100:103], v[156:159]
v_mfma_f32_16x16x32_bf16 v[160:163], v[120:123], v[100:103], v[160:163]
v_mfma_f32_16x16x32_bf16 v[168:171], v[120:123], v[104:107], v[168:171]
v_mfma_f32_16x16x32_bf16 v[176:179], v[120:123], v[108:111], v[176:179]
v_mfma_f32_16x16x32_bf16 v[184:187], v[120:123], v[112:115], v[184:187]
c2_epi:
s_waitcnt lgkmcnt(0)
.p2align 3
v_pk_fma_f32 v[212:213], v[148:149], v[98:99], v[212:213] op_sel:[0,1,0] op_sel_hi:[1,1,1]
v_pk_fma_f32 v[214:215], v[150:151], v[98:99], v[214:215] op_sel:[0,1,0] op_sel_hi:[1,1,1]
v_pk_fma_f32 v[216:217], v[152:153], v[98:99], v[216:217] op_sel:[0,1,0] op_sel_hi:[1,1,1]
v_pk_fma_f32 v[218:219], v[154:155], v[98:99], v[218:219] op_sel:[0,1,0] op_sel_hi:[1,1,1]
v_pk_mul_f32 v[212:213], v[212:213], v[98:99] op_sel:[0,0] op_sel_hi:[1,0]
v_pk_mul_f32 v[214:215], v[214:215], v[98:99] op_sel:[0,0] op_sel_hi:[1,0]
v_pk_mul_f32 v[216:217], v[216:217], v[98:99] op_sel:[0,0] op_sel_hi:[1,0]
v_pk_mul_f32 v[218:219], v[218:219], v[98:99] op_sel:[0,0] op_sel_hi:[1,0]
v_cvt_pk_bf16_f32 v212, v212, v213
v_cvt_pk_bf16_f32 v213, v214, v215
v_cvt_pk_bf16_f32 v214, v216, v217
v_cvt_pk_bf16_f32 v215, v218, v219
v_pk_fma_f32 v[244:245], v[88:89], v[56:57], v[244:245] op_sel:[0,0,0] op_sel_hi:[1,0,1]
v_pk_fma_f32 v[246:247], v[90:91], v[56:57], v[246:247] op_sel:[0,0,0] op_sel_hi:[1,0,1]
v_pk_mul_f32 v[244:245], v[244:245], v[72:73]
v_pk_mul_f32 v[246:247], v[246:247], v[74:75]
v_cvt_pk_bf16_f32 v108, v244, v245
v_cvt_pk_bf16_f32 v109, v246, v247
v_pk_fma_f32 v[248:249], v[88:89], v[56:57], v[248:249] op_sel:[0,1,0] op_sel_hi:[1,1,1]
v_pk_fma_f32 v[250:251], v[90:91], v[56:57], v[250:251] op_sel:[0,1,0] op_sel_hi:[1,1,1]
v_pk_mul_f32 v[248:249], v[248:249], v[72:73]
v_pk_mul_f32 v[250:251], v[250:251], v[74:75]
v_cvt_pk_bf16_f32 v118, v248, v249
v_cvt_pk_bf16_f32 v119, v250, v251
s_cmp_lg_u32 s44, 1
s_cbranch_scc1 else_79
buffer_store_dwordx4 v[212:215], v58, s[32:35], 0 offen sc1
buffer_store_dwordx2 v[108:109], v59, s[32:35], 0 offen offset:1024 sc1
buffer_store_dwordx2 v[118:119], v59, s[32:35], 0 offen offset:1536 sc1
s_branch fi_80
else_79:
ds_write_b128 v53, v[212:215]
ds_write_b64 v55, v[108:109] offset:1024
ds_write_b64 v55, v[118:119] offset:1536
v_mov_b32 v4, 3
ds_write_b32 v19, v4
fi_80:
v_mul_f32 v124, s66, v92
v_mul_f32 v125, s66, v94
v_mul_f32 v126, s66, v96
v_mul_f32 v127, s66, v98
.p2align 3
v_pk_fma_f32 v[156:157], v[140:141], v[92:93], v[156:157] op_sel:[0,1,0] op_sel_hi:[1,1,1]
v_pk_fma_f32 v[158:159], v[142:143], v[92:93], v[158:159] op_sel:[0,1,0] op_sel_hi:[1,1,1]
v_pk_fma_f32 v[160:161], v[144:145], v[92:93], v[160:161] op_sel:[0,1,0] op_sel_hi:[1,1,1]
v_pk_fma_f32 v[162:163], v[146:147], v[92:93], v[162:163] op_sel:[0,1,0] op_sel_hi:[1,1,1]
v_cvt_pk_bf16_f32 v156, v156, v157
v_cvt_pk_bf16_f32 v157, v158, v159
v_cvt_pk_bf16_f32 v158, v160, v161
v_cvt_pk_bf16_f32 v159, v162, v163
v_pk_fma_f32 v[164:165], v[140:141], v[94:95], v[164:165] op_sel:[0,1,0] op_sel_hi:[1,1,1]
v_pk_fma_f32 v[166:167], v[142:143], v[94:95], v[166:167] op_sel:[0,1,0] op_sel_hi:[1,1,1]
v_pk_fma_f32 v[168:169], v[144:145], v[94:95], v[168:169] op_sel:[0,1,0] op_sel_hi:[1,1,1]
v_pk_fma_f32 v[170:171], v[146:147], v[94:95], v[170:171] op_sel:[0,1,0] op_sel_hi:[1,1,1]
v_cvt_pk_bf16_f32 v164, v164, v165
v_cvt_pk_bf16_f32 v165, v166, v167
v_cvt_pk_bf16_f32 v166, v168, v169
v_cvt_pk_bf16_f32 v167, v170, v171
v_pk_fma_f32 v[172:173], v[140:141], v[96:97], v[172:173] op_sel:[0,1,0] op_sel_hi:[1,1,1]
v_pk_fma_f32 v[174:175], v[142:143], v[96:97], v[174:175] op_sel:[0,1,0] op_sel_hi:[1,1,1]
v_pk_fma_f32 v[176:177], v[144:145], v[96:97], v[176:177] op_sel:[0,1,0] op_sel_hi:[1,1,1]
v_pk_fma_f32 v[178:179], v[146:147], v[96:97], v[178:179] op_sel:[0,1,0] op_sel_hi:[1,1,1]
v_cvt_pk_bf16_f32 v172, v172, v173
v_cvt_pk_bf16_f32 v173, v174, v175
v_cvt_pk_bf16_f32 v174, v176, v177
v_cvt_pk_bf16_f32 v175, v178, v179
v_pk_fma_f32 v[180:181], v[140:141], v[98:99], v[180:181] op_sel:[0,1,0] op_sel_hi:[1,1,1]
v_pk_fma_f32 v[182:183], v[142:143], v[98:99], v[182:183] op_sel:[0,1,0] op_sel_hi:[1,1,1]
v_pk_fma_f32 v[184:185], v[144:145], v[98:99], v[184:185] op_sel:[0,1,0] op_sel_hi:[1,1,1]
v_pk_fma_f32 v[186:187], v[146:147], v[98:99], v[186:187] op_sel:[0,1,0] op_sel_hi:[1,1,1]
v_cvt_pk_bf16_f32 v180, v180, v181
v_cvt_pk_bf16_f32 v181, v182, v183
v_cvt_pk_bf16_f32 v182, v184, v185
v_cvt_pk_bf16_f32 v183, v186, v187
v_pk_fma_f32 v[188:189], v[148:149], v[92:93], v[188:189] op_sel:[0,1,0] op_sel_hi:[1,1,1]
v_pk_fma_f32 v[190:191], v[150:151], v[92:93], v[190:191] op_sel:[0,1,0] op_sel_hi:[1,1,1]
v_pk_fma_f32 v[192:193], v[152:153], v[92:93], v[192:193] op_sel:[0,1,0] op_sel_hi:[1,1,1]
v_pk_fma_f32 v[194:195], v[154:155], v[92:93], v[194:195] op_sel:[0,1,0] op_sel_hi:[1,1,1]
v_pk_mul_f32 v[188:189], v[188:189], v[92:93] op_sel:[0,0] op_sel_hi:[1,0]
v_pk_mul_f32 v[190:191], v[190:191], v[92:93] op_sel:[0,0] op_sel_hi:[1,0]
v_pk_mul_f32 v[192:193], v[192:193], v[92:93] op_sel:[0,0] op_sel_hi:[1,0]
v_pk_mul_f32 v[194:195], v[194:195], v[92:93] op_sel:[0,0] op_sel_hi:[1,0]
v_cvt_pk_bf16_f32 v188, v188, v189
v_cvt_pk_bf16_f32 v189, v190, v191
v_cvt_pk_bf16_f32 v190, v192, v193
v_cvt_pk_bf16_f32 v191, v194, v195
v_pk_fma_f32 v[196:197], v[148:149], v[94:95], v[196:197] op_sel:[0,1,0] op_sel_hi:[1,1,1]
v_pk_fma_f32 v[198:199], v[150:151], v[94:95], v[198:199] op_sel:[0,1,0] op_sel_hi:[1,1,1]
v_pk_fma_f32 v[200:201], v[152:153], v[94:95], v[200:201] op_sel:[0,1,0] op_sel_hi:[1,1,1]
v_pk_fma_f32 v[202:203], v[154:155], v[94:95], v[202:203] op_sel:[0,1,0] op_sel_hi:[1,1,1]
v_pk_mul_f32 v[196:197], v[196:197], v[94:95] op_sel:[0,0] op_sel_hi:[1,0]
v_pk_mul_f32 v[198:199], v[198:199], v[94:95] op_sel:[0,0] op_sel_hi:[1,0]
v_pk_mul_f32 v[200:201], v[200:201], v[94:95] op_sel:[0,0] op_sel_hi:[1,0]
v_pk_mul_f32 v[202:203], v[202:203], v[94:95] op_sel:[0,0] op_sel_hi:[1,0]
v_cvt_pk_bf16_f32 v196, v196, v197
v_cvt_pk_bf16_f32 v197, v198, v199
v_cvt_pk_bf16_f32 v198, v200, v201
v_cvt_pk_bf16_f32 v199, v202, v203
v_pk_fma_f32 v[204:205], v[148:149], v[96:97], v[204:205] op_sel:[0,1,0] op_sel_hi:[1,1,1]
v_pk_fma_f32 v[206:207], v[150:151], v[96:97], v[206:207] op_sel:[0,1,0] op_sel_hi:[1,1,1]
v_pk_fma_f32 v[208:209], v[152:153], v[96:97], v[208:209] op_sel:[0,1,0] op_sel_hi:[1,1,1]
v_pk_fma_f32 v[210:211], v[154:155], v[96:97], v[210:211] op_sel:[0,1,0] op_sel_hi:[1,1,1]
v_pk_mul_f32 v[204:205], v[204:205], v[96:97] op_sel:[0,0] op_sel_hi:[1,0]
v_pk_mul_f32 v[206:207], v[206:207], v[96:97] op_sel:[0,0] op_sel_hi:[1,0]
v_pk_mul_f32 v[208:209], v[208:209], v[96:97] op_sel:[0,0] op_sel_hi:[1,0]
v_pk_mul_f32 v[210:211], v[210:211], v[96:97] op_sel:[0,0] op_sel_hi:[1,0]
v_cvt_pk_bf16_f32 v204, v204, v205
v_cvt_pk_bf16_f32 v205, v206, v207
v_cvt_pk_bf16_f32 v206, v208, v209
v_cvt_pk_bf16_f32 v207, v210, v211
s_cmp_lg_u32 s44, 0
s_cbranch_scc1 else_81
buffer_load_dwordx4 v[120:123], v58, s[32:35], 0 offen sc1
buffer_load_dwordx2 v[100:101], v59, s[32:35], 0 offen offset:1024 sc1
buffer_load_dwordx2 v[110:111], v59, s[32:35], 0 offen offset:1536 sc1
else_81:
.p2align 3
v_mfma_f32_16x16x32_bf16 v[216:219], v[212:215], v[180:183], v[40:43]
v_pk_fma_f32 v[220:221], v[76:77], v[56:57], v[220:221] op_sel:[0,0,0] op_sel_hi:[1,0,1]
v_pk_fma_f32 v[222:223], v[78:79], v[56:57], v[222:223] op_sel:[0,0,0] op_sel_hi:[1,0,1]
v_pk_mul_f32 v[220:221], v[220:221], v[60:61]
v_pk_mul_f32 v[222:223], v[222:223], v[62:63]
v_cvt_pk_bf16_f32 v102, v220, v221
v_mfma_f32_16x16x32_bf16 v[192:195], v[188:191], v[156:159], v[40:43]
v_cvt_pk_bf16_f32 v103, v222, v223
v_pk_fma_f32 v[224:225], v[76:77], v[56:57], v[224:225] op_sel:[0,1,0] op_sel_hi:[1,1,1]
v_pk_fma_f32 v[226:227], v[78:79], v[56:57], v[226:227] op_sel:[0,1,0] op_sel_hi:[1,1,1]
v_pk_mul_f32 v[224:225], v[224:225], v[60:61]
v_pk_mul_f32 v[226:227], v[226:227], v[62:63]
v_cvt_pk_bf16_f32 v112, v224, v225
v_mfma_f32_16x16x32_bf16 v[168:171], v[188:191], v[164:167], v[36:39]
v_cvt_pk_bf16_f32 v113, v226, v227
v_pk_fma_f32 v[228:229], v[80:81], v[56:57], v[228:229] op_sel:[0,0,0] op_sel_hi:[1,0,1]
v_pk_fma_f32 v[230:231], v[82:83], v[56:57], v[230:231] op_sel:[0,0,0] op_sel_hi:[1,0,1]
v_pk_mul_f32 v[228:229], v[228:229], v[64:65]
v_pk_mul_f32 v[230:231], v[230:231], v[66:67]
v_cvt_pk_bf16_f32 v104, v228, v229
v_mfma_f32_16x16x32_bf16 v[200:203], v[196:199], v[164:167], v[40:43]
v_cvt_pk_bf16_f32 v105, v230, v231
v_pk_fma_f32 v[232:233], v[80:81], v[56:57], v[232:233] op_sel:[0,1,0] op_sel_hi:[1,1,1]
v_pk_fma_f32 v[234:235], v[82:83], v[56:57], v[234:235] op_sel:[0,1,0] op_sel_hi:[1,1,1]
v_pk_mul_f32 v[232:233], v[232:233], v[64:65]
v_pk_mul_f32 v[234:235], v[234:235], v[66:67]
v_cvt_pk_bf16_f32 v114, v232, v233
v_mfma_f32_16x16x32_bf16 v[176:179], v[196:199], v[172:175], v[36:39]
v_cvt_pk_bf16_f32 v115, v234, v235
v_pk_fma_f32 v[236:237], v[84:85], v[56:57], v[236:237] op_sel:[0,0,0] op_sel_hi:[1,0,1]
v_pk_fma_f32 v[238:239], v[86:87], v[56:57], v[238:239] op_sel:[0,0,0] op_sel_hi:[1,0,1]
v_pk_mul_f32 v[236:237], v[236:237], v[68:69]
v_pk_mul_f32 v[238:239], v[238:239], v[70:71]
v_cvt_pk_bf16_f32 v106, v236, v237
v_mfma_f32_16x16x32_bf16 v[208:211], v[204:207], v[172:175], v[40:43]
v_cvt_pk_bf16_f32 v107, v238, v239
v_pk_fma_f32 v[240:241], v[84:85], v[56:57], v[240:241] op_sel:[0,1,0] op_sel_hi:[1,1,1]
v_pk_fma_f32 v[242:243], v[86:87], v[56:57], v[242:243] op_sel:[0,1,0] op_sel_hi:[1,1,1]
v_pk_mul_f32 v[240:241], v[240:241], v[68:69]
v_pk_mul_f32 v[242:243], v[242:243], v[70:71]
v_cvt_pk_bf16_f32 v116, v240, v241
v_mfma_f32_16x16x32_bf16 v[184:187], v[204:207], v[180:183], v[36:39]
v_cvt_pk_bf16_f32 v117, v242, v243
v_max_f32 v166, v200, v201
v_max_f32 v167, v202, v203
v_max_f32 v164, v168, v169
v_max_f32 v165, v170, v171
v_max3_f32 v129, v164, v165, v166
v_max_f32 v129, v129, v167
s_cmp_lg_u32 s44, 0
s_cbranch_scc1 else_83
s_mov_b32 s63, 0
sent_85:
s_waitcnt vmcnt(0)
v_max_u32 v4, v120, v121
v_max3_u32 v4, v4, v122, v123
v_max3_u32 v4, v4, v100, v101
v_max3_u32 v4, v4, v110, v111
v_cmp_eq_u32 vcc, -1, v4
s_cbranch_vccz sentd_86
buffer_load_dwordx4 v[120:123], v58, s[32:35], 0 offen sc1
buffer_load_dwordx2 v[100:101], v59, s[32:35], 0 offen offset:1024 sc1
buffer_load_dwordx2 v[110:111], v59, s[32:35], 0 offen offset:1536 sc1
s_add_u32 s63, s63, 1
s_cmp_lt_u32 s63, 0x80000
s_cbranch_scc1 sent_85
s_waitcnt vmcnt(0)
sentd_86:
s_branch fi_84
else_83:
s_mov_b32 s63, 0
px_87:
ds_read_b32 v4, v19
ds_read_b128 v[120:123], v53
ds_read_b64 v[100:101], v55 offset:1024
ds_read_b64 v[110:111], v55 offset:1536
s_add_u32 s63, s63, 1
s_cmp_lt_u32 s63, 0x400000
s_waitcnt lgkmcnt(0)
v_cmp_ne_u32 vcc, 3, v4
s_cbranch_vccz pxd_88
s_cbranch_scc1 px_87
pxd_88:
fi_84:
v_mfma_f32_16x16x32_bf16 v[160:163], v[120:123], v[156:159], v[44:47]
v_max_f32 v174, v208, v209
v_max_f32 v175, v210, v211
v_max_f32 v172, v176, v177
v_max_f32 v173, v178, v179
v_max3_f32 v130, v172, v173, v174
v_max_f32 v130, v130, v175
v_max_f32 v182, v216, v217
v_max_f32 v183, v218, v219
v_max_f32 v180, v184, v185
v_max_f32 v181, v186, v187
v_max3_f32 v131, v180, v181, v182
v_max_f32 v131, v131, v183
v_max_f32 v158, v192, v193
v_max_f32 v159, v194, v195
v_max_f32 v156, v160, v161
v_max_f32 v157, v162, v163
v_max3_f32 v128, v156, v157, v158
v_max_f32 v128, v128, v159
s_nop 1
v_permlane32_swap_b32 v128, v129
v_permlane32_swap_b32 v130, v131
v_max_f32 v128, v128, v129
v_max_f32 v130, v130, v131
s_nop 1
v_permlane16_swap_b32 v128, v130
s_nop 0
v_max_f32 v128, v128, v130
v_mov_b32 v130, v128
s_nop 1
v_permlane16_swap_b32 v128, v130
s_nop 0
v_mov_b32 v129, v128
v_mov_b32 v131, v130
s_nop 0
v_permlane32_swap_b32 v128, v129
v_permlane32_swap_b32 v130, v131
v_pk_mul_f32 v[128:129], v[128:129], v[124:125]
v_pk_mul_f32 v[130:131], v[130:131], v[126:127]
v_pk_fma_f32 v[156:157], v[156:157], v[124:125], v[128:129] op_sel:[0,0,0] op_sel_hi:[1,0,0] neg_lo:[0,0,1] neg_hi:[0,0,1]
v_pk_fma_f32 v[158:159], v[158:159], v[124:125], v[128:129] op_sel:[0,0,0] op_sel_hi:[1,0,0] neg_lo:[0,0,1] neg_hi:[0,0,1]
v_exp_f32 v156, v156
v_exp_f32 v157, v157
v_exp_f32 v158, v158
v_exp_f32 v159, v159
v_cvt_pk_bf16_f32 v156, v156, v156
v_cvt_pk_bf16_f32 v157, v157, v157
v_cvt_pk_bf16_f32 v158, v158, v158
v_cvt_pk_bf16_f32 v159, v159, v159
v_and_b32 v156, v52, v156
v_and_b32 v157, v52, v157
v_and_b32 v158, v52, v158
v_and_b32 v159, v52, v159
v_pk_fma_f32 v[164:165], v[164:165], v[124:125], v[128:129] op_sel:[0,1,1] op_sel_hi:[1,1,1] neg_lo:[0,0,1] neg_hi:[0,0,1]
v_pk_fma_f32 v[166:167], v[166:167], v[124:125], v[128:129] op_sel:[0,1,1] op_sel_hi:[1,1,1] neg_lo:[0,0,1] neg_hi:[0,0,1]
v_exp_f32 v164, v164
v_mfma_f32_16x16x32_bf16 v[160:163], v[48:51], v[156:159], 0
v_exp_f32 v165, v165
v_exp_f32 v166, v166
v_exp_f32 v167, v167
v_cvt_pk_bf16_f32 v164, v164, v164
v_mfma_f32_16x16x32_bf16 v[220:223], v[100:103], v[156:159], 0
v_cvt_pk_bf16_f32 v165, v165, v165
v_cvt_pk_bf16_f32 v166, v166, v166
v_cvt_pk_bf16_f32 v167, v167, v167
v_and_b32 v164, v52, v164
v_mfma_f32_16x16x32_bf16 v[224:227], v[110:113], v[156:159], 0
v_and_b32 v165, v52, v165
v_and_b32 v166, v52, v166
v_and_b32 v167, v52, v167
v_pk_fma_f32 v[172:173], v[172:173], v[126:127], v[130:131] op_sel:[0,0,0] op_sel_hi:[1,0,0] neg_lo:[0,0,1] neg_hi:[0,0,1]
v_pk_fma_f32 v[174:175], v[174:175], v[126:127], v[130:131] op_sel:[0,0,0] op_sel_hi:[1,0,0] neg_lo:[0,0,1] neg_hi:[0,0,1]
v_exp_f32 v172, v172
v_mfma_f32_16x16x32_bf16 v[168:171], v[48:51], v[164:167], 0
v_exp_f32 v173, v173
v_exp_f32 v174, v174
v_exp_f32 v175, v175
v_cvt_pk_bf16_f32 v172, v172, v172
v_mfma_f32_16x16x32_bf16 v[228:231], v[102:105], v[164:167], 0
v_cvt_pk_bf16_f32 v173, v173, v173
v_cvt_pk_bf16_f32 v174, v174, v174
v_cvt_pk_bf16_f32 v175, v175, v175
v_and_b32 v172, v52, v172
v_mfma_f32_16x16x32_bf16 v[232:235], v[112:115], v[164:167], 0
v_and_b32 v173, v52, v173
v_and_b32 v174, v52, v174
v_and_b32 v175, v52, v175
v_pk_fma_f32 v[180:181], v[180:181], v[126:127], v[130:131] op_sel:[0,1,1] op_sel_hi:[1,1,1] neg_lo:[0,0,1] neg_hi:[0,0,1]
v_pk_fma_f32 v[182:183], v[182:183], v[126:127], v[130:131] op_sel:[0,1,1] op_sel_hi:[1,1,1] neg_lo:[0,0,1] neg_hi:[0,0,1]
v_exp_f32 v180, v180
v_mfma_f32_16x16x32_bf16 v[176:179], v[48:51], v[172:175], 0
v_exp_f32 v181, v181
v_exp_f32 v182, v182
v_exp_f32 v183, v183
v_cvt_pk_bf16_f32 v180, v180, v180
v_mfma_f32_16x16x32_bf16 v[236:239], v[104:107], v[172:175], 0
v_cvt_pk_bf16_f32 v181, v181, v181
v_cvt_pk_bf16_f32 v182, v182, v182
v_cvt_pk_bf16_f32 v183, v183, v183
v_and_b32 v180, v52, v180
v_mfma_f32_16x16x32_bf16 v[240:243], v[114:117], v[172:175], 0
v_and_b32 v181, v52, v181
v_and_b32 v182, v52, v182
v_and_b32 v183, v52, v183
v_rcp_f32 v160, v160
v_rcp_f32 v168, v168
v_mfma_f32_16x16x32_bf16 v[184:187], v[48:51], v[180:183], 0
v_mfma_f32_16x16x32_bf16 v[244:247], v[106:109], v[180:183], 0
v_mfma_f32_16x16x32_bf16 v[248:251], v[116:119], v[180:183], 0
v_rcp_f32 v176, v176
s_nop 4
v_rcp_f32 v184, v184
s_cmp_eq_u32 s46, 0
s_cbranch_scc1 slow_89
.p2align 3
v_pk_mul_f32 v[220:221], v[220:221], v[160:161] op_sel:[0,0] op_sel_hi:[1,0]
v_pk_mul_f32 v[222:223], v[222:223], v[160:161] op_sel:[0,0] op_sel_hi:[1,0]
v_pk_mul_f32 v[224:225], v[224:225], v[160:161] op_sel:[0,0] op_sel_hi:[1,0]
v_pk_mul_f32 v[226:227], v[226:227], v[160:161] op_sel:[0,0] op_sel_hi:[1,0]
v_cvt_pk_bf16_f32 v220, v220, v221
v_cvt_pk_bf16_f32 v221, v222, v223
v_cvt_pk_bf16_f32 v222, v224, v225
v_cvt_pk_bf16_f32 v223, v226, v227
buffer_store_dwordx4 v[220:223], v18, s[32:35], s80 offen
v_pk_mul_f32 v[228:229], v[228:229], v[168:169] op_sel:[0,0] op_sel_hi:[1,0]
v_pk_mul_f32 v[230:231], v[230:231], v[168:169] op_sel:[0,0] op_sel_hi:[1,0]
v_pk_mul_f32 v[232:233], v[232:233], v[168:169] op_sel:[0,0] op_sel_hi:[1,0]
v_pk_mul_f32 v[234:235], v[234:235], v[168:169] op_sel:[0,0] op_sel_hi:[1,0]
v_cvt_pk_bf16_f32 v228, v228, v229
v_cvt_pk_bf16_f32 v229, v230, v231
v_cvt_pk_bf16_f32 v230, v232, v233
v_cvt_pk_bf16_f32 v231, v234, v235
buffer_store_dwordx4 v[228:231], v18, s[32:35], s81 offen
v_pk_mul_f32 v[236:237], v[236:237], v[176:177] op_sel:[0,0] op_sel_hi:[1,0]
v_pk_mul_f32 v[238:239], v[238:239], v[176:177] op_sel:[0,0] op_sel_hi:[1,0]
v_pk_mul_f32 v[240:241], v[240:241], v[176:177] op_sel:[0,0] op_sel_hi:[1,0]
v_pk_mul_f32 v[242:243], v[242:243], v[176:177] op_sel:[0,0] op_sel_hi:[1,0]
v_cvt_pk_bf16_f32 v236, v236, v237
v_cvt_pk_bf16_f32 v237, v238, v239
v_cvt_pk_bf16_f32 v238, v240, v241
v_cvt_pk_bf16_f32 v239, v242, v243
buffer_store_dwordx4 v[236:239], v18, s[32:35], s82 offen
v_pk_mul_f32 v[244:245], v[244:245], v[184:185] op_sel:[0,0] op_sel_hi:[1,0]
v_pk_mul_f32 v[246:247], v[246:247], v[184:185] op_sel:[0,0] op_sel_hi:[1,0]
v_pk_mul_f32 v[248:249], v[248:249], v[184:185] op_sel:[0,0] op_sel_hi:[1,0]
v_pk_mul_f32 v[250:251], v[250:251], v[184:185] op_sel:[0,0] op_sel_hi:[1,0]
v_cvt_pk_bf16_f32 v244, v244, v245
v_cvt_pk_bf16_f32 v245, v246, v247
v_cvt_pk_bf16_f32 v246, v248, v249
v_cvt_pk_bf16_f32 v247, v250, v251
buffer_store_dwordx4 v[244:247], v18, s[32:35], s83 offen
s_barrier
s_lshl_b32 s62, s45, 2
v_mov_b32 v4, s62
v_mov_b32 v5, 3
s_mov_b64 exec, 1
s_waitcnt vmcnt(0)
buffer_store_dword v5, v4, s[32:35], s84 offen
s_mov_b64 exec, -1
back_90:
v_and_b32 v36, 31, v0
v_lshlrev_b32 v36, 2, v36
buffer_load_dword v37, v36, s[32:35], s84 offen sc1
v_lshrrev_b32 v4, 2, v2
v_and_b32 v5, 3, v0
v_lshl_add_u32 v6, v3, 3, v4
v_lshlrev_b32 v6, 7, v6
v_lshl_add_u32 v6, v5, 3, v6
v_lshrrev_b32 v7, 1, v4
v_and_b32 v8, 1, v3
v_lshl_add_u32 v7, v8, 1, v7
v_lshl_add_u32 v10, v7, 5, v6
v_xor_b32 v11, 32, v10
v_xor_b32 v12, 64, v10
v_xor_b32 v13, 96, v10
v_add_u32 v14, 0x10000, v10
v_add_u32 v15, 0x10000, v11
v_add_u32 v16, 0x10000, v12
v_add_u32 v17, 0x10000, v13
ds_read_b64_tr_b16 v[220:221], v10 offset:0
ds_read_b64_tr_b16 v[222:223], v10 offset:512
ds_read_b64_tr_b16 v[224:225], v11 offset:0
ds_read_b64_tr_b16 v[226:227], v11 offset:512
ds_read_b64_tr_b16 v[228:229], v12 offset:0
ds_read_b64_tr_b16 v[230:231], v12 offset:512
ds_read_b64_tr_b16 v[232:233], v13 offset:0
ds_read_b64_tr_b16 v[234:235], v13 offset:512
ds_read_b64_tr_b16 v[236:237], v10 offset:4096
ds_read_b64_tr_b16 v[238:239], v10 offset:4608
ds_read_b64_tr_b16 v[240:241], v11 offset:4096
ds_read_b64_tr_b16 v[242:243], v11 offset:4608
ds_read_b64_tr_b16 v[244:245], v12 offset:4096
ds_read_b64_tr_b16 v[246:247], v12 offset:4608
ds_read_b64_tr_b16 v[248:249], v13 offset:4096
ds_read_b64_tr_b16 v[250:251], v13 offset:4608
s_lshl_b32 s48, s41, 3
s_lshl_b32 s49, s40, 1
s_add_u32 s48, s48, s49
s_lshl_b32 s48, s48, 15
s_add_u32 s48, s48, 4194304
v_add_u32 v38, s48, v18
v_add_u32 v39, 32768, v38
s_lshl_b32 s57, s75, 11
s_add_u32 s87, s87, 262144
v_lshlrev_b32 v60, 16, v20
v_and_b32 v61, 0xffff0000, v20
v_lshlrev_b32 v62, 16, v21
v_and_b32 v63, 0xffff0000, v21
v_lshlrev_b32 v64, 16, v22
v_and_b32 v65, 0xffff0000, v22
v_lshlrev_b32 v66, 16, v23
v_and_b32 v67, 0xffff0000, v23
v_lshlrev_b32 v68, 16, v24
v_and_b32 v69, 0xffff0000, v24
v_lshlrev_b32 v70, 16, v25
v_and_b32 v71, 0xffff0000, v25
v_lshlrev_b32 v72, 16, v26
v_and_b32 v73, 0xffff0000, v26
v_lshlrev_b32 v74, 16, v27
v_and_b32 v75, 0xffff0000, v27
v_lshlrev_b32 v76, 16, v28
v_and_b32 v77, 0xffff0000, v28
v_lshlrev_b32 v78, 16, v29
v_and_b32 v79, 0xffff0000, v29
v_lshlrev_b32 v80, 16, v30
v_and_b32 v81, 0xffff0000, v30
v_lshlrev_b32 v82, 16, v31
v_and_b32 v83, 0xffff0000, v31
v_lshlrev_b32 v84, 16, v32
v_and_b32 v85, 0xffff0000, v32
v_lshlrev_b32 v86, 16, v33
v_and_b32 v87, 0xffff0000, v33
v_lshlrev_b32 v88, 16, v34
v_and_b32 v89, 0xffff0000, v34
v_lshlrev_b32 v90, 16, v35
v_and_b32 v91, 0xffff0000, v35
v_mov_b32 v6, 0
v_mov_b32 v7, 0
v_mov_b32 v8, 0
v_mov_b32 v9, 0
s_lshl_b32 s62, s42, 2
v_mov_b32 v4, s62
v_mov_b32 v5, 3
s_mov_b32 s63, 0
s_waitcnt vmcnt(0)
poll_91:
v_cmp_gt_u32 vcc, 3, v37
s_cbranch_vccz polled_92
buffer_load_dword v37, v36, s[32:35], s84 offen sc1
s_add_u32 s63, s63, 1
s_cmp_lt_u32 s63, 0x80000
s_waitcnt vmcnt(0)
s_cbranch_scc1 poll_91
polled_92:
buffer_load_dwordx4 v[156:159], v38, s[32:35], s57 offen sc1
buffer_load_dwordx4 v[160:163], v39, s[32:35], s57 offen sc1
buffer_load_dwordx4 v[164:167], v38, s[32:35], s57 offen offset:1024 sc1
buffer_load_dwordx4 v[168:171], v39, s[32:35], s57 offen offset:1024 sc1
s_add_u32 s57, s57, 2048
s_and_b32 s57, s57, 0x7fff
buffer_load_dwordx4 v[172:175], v38, s[32:35], s57 offen sc1
buffer_load_dwordx4 v[176:179], v39, s[32:35], s57 offen sc1
buffer_load_dwordx4 v[180:183], v38, s[32:35], s57 offen offset:1024 sc1
buffer_load_dwordx4 v[184:187], v39, s[32:35], s57 offen offset:1024 sc1
s_add_u32 s57, s57, 2048
s_and_b32 s57, s57, 0x7fff
s_waitcnt vmcnt(6) lgkmcnt(8)
v_mfma_f32_16x16x32_bf16 v[60:63], v[220:223], v[156:159], v[60:63]
buffer_load_dwordx4 v[188:191], v38, s[32:35], s57 offen sc1
v_mfma_f32_16x16x32_bf16 v[76:79], v[220:223], v[160:163], v[76:79]
ds_read_b64_tr_b16 v[100:101], v10 offset:8192
ds_read_b64_tr_b16 v[102:103], v10 offset:8704
v_mfma_f32_16x16x32_bf16 v[64:67], v[224:227], v[156:159], v[64:67]
ds_read_b64_tr_b16 v[104:105], v11 offset:8192
ds_read_b64_tr_b16 v[106:107], v11 offset:8704
v_mfma_f32_16x16x32_bf16 v[80:83], v[224:227], v[160:163], v[80:83]
buffer_load_dwordx4 v[192:195], v39, s[32:35], s57 offen sc1
v_mfma_f32_16x16x32_bf16 v[68:71], v[228:231], v[156:159], v[68:71]
ds_read_b64_tr_b16 v[108:109], v12 offset:8192
ds_read_b64_tr_b16 v[110:111], v12 offset:8704
v_mfma_f32_16x16x32_bf16 v[84:87], v[228:231], v[160:163], v[84:87]
ds_read_b64_tr_b16 v[112:113], v13 offset:8192
ds_read_b64_tr_b16 v[114:115], v13 offset:8704
v_mfma_f32_16x16x32_bf16 v[72:75], v[232:235], v[156:159], v[72:75]
v_mfma_f32_16x16x32_bf16 v[88:91], v[232:235], v[160:163], v[88:91]
s_waitcnt vmcnt(6) lgkmcnt(8)
v_mfma_f32_16x16x32_bf16 v[60:63], v[236:239], v[164:167], v[60:63]
buffer_load_dwordx4 v[196:199], v38, s[32:35], s57 offen offset:1024 sc1
v_mfma_f32_16x16x32_bf16 v[76:79], v[236:239], v[168:171], v[76:79]
ds_read_b64_tr_b16 v[220:221], v10 offset:12288
ds_read_b64_tr_b16 v[222:223], v10 offset:12800
v_mfma_f32_16x16x32_bf16 v[64:67], v[240:243], v[164:167], v[64:67]
ds_read_b64_tr_b16 v[224:225], v11 offset:12288
ds_read_b64_tr_b16 v[226:227], v11 offset:12800
v_mfma_f32_16x16x32_bf16 v[80:83], v[240:243], v[168:171], v[80:83]
buffer_load_dwordx4 v[200:203], v39, s[32:35], s57 offen offset:1024 sc1
v_mfma_f32_16x16x32_bf16 v[68:71], v[244:247], v[164:167], v[68:71]
ds_read_b64_tr_b16 v[228:229], v12 offset:12288
ds_read_b64_tr_b16 v[230:231], v12 offset:12800
v_mfma_f32_16x16x32_bf16 v[84:87], v[244:247], v[168:171], v[84:87]
ds_read_b64_tr_b16 v[232:233], v13 offset:12288
ds_read_b64_tr_b16 v[234:235], v13 offset:12800
v_mfma_f32_16x16x32_bf16 v[72:75], v[248:251], v[164:167], v[72:75]
s_add_u32 s57, s57, 2048
s_and_b32 s57, s57, 0x7fff
v_mfma_f32_16x16x32_bf16 v[88:91], v[248:251], v[168:171], v[88:91]
s_waitcnt vmcnt(6) lgkmcnt(8)
v_mfma_f32_16x16x32_bf16 v[60:63], v[100:103], v[172:175], v[60:63]
buffer_load_dwordx4 v[204:207], v38, s[32:35], s57 offen sc1
v_mfma_f32_16x16x32_bf16 v[76:79], v[100:103], v[176:179], v[76:79]
ds_read_b64_tr_b16 v[236:237], v10 offset:16384
ds_read_b64_tr_b16 v[238:239], v10 offset:16896
v_mfma_f32_16x16x32_bf16 v[64:67], v[104:107], v[172:175], v[64:67]
ds_read_b64_tr_b16 v[240:241], v11 offset:16384
ds_read_b64_tr_b16 v[242:243], v11 offset:16896
v_mfma_f32_16x16x32_bf16 v[80:83], v[104:107], v[176:179], v[80:83]
buffer_load_dwordx4 v[208:211], v39, s[32:35], s57 offen sc1
v_mfma_f32_16x16x32_bf16 v[68:71], v[108:111], v[172:175], v[68:71]
ds_read_b64_tr_b16 v[244:245], v12 offset:16384
ds_read_b64_tr_b16 v[246:247], v12 offset:16896
v_mfma_f32_16x16x32_bf16 v[84:87], v[108:111], v[176:179], v[84:87]
ds_read_b64_tr_b16 v[248:249], v13 offset:16384
ds_read_b64_tr_b16 v[250:251], v13 offset:16896
v_mfma_f32_16x16x32_bf16 v[72:75], v[112:115], v[172:175], v[72:75]
v_mfma_f32_16x16x32_bf16 v[88:91], v[112:115], v[176:179], v[88:91]
s_waitcnt vmcnt(6) lgkmcnt(8)
v_mfma_f32_16x16x32_bf16 v[60:63], v[220:223], v[180:183], v[60:63]
buffer_load_dwordx4 v[212:215], v38, s[32:35], s57 offen offset:1024 sc1
v_mfma_f32_16x16x32_bf16 v[76:79], v[220:223], v[184:187], v[76:79]
ds_read_b64_tr_b16 v[100:101], v10 offset:20480
ds_read_b64_tr_b16 v[102:103], v10 offset:20992
v_mfma_f32_16x16x32_bf16 v[64:67], v[224:227], v[180:183], v[64:67]
ds_read_b64_tr_b16 v[104:105], v11 offset:20480
ds_read_b64_tr_b16 v[106:107], v11 offset:20992
v_mfma_f32_16x16x32_bf16 v[80:83], v[224:227], v[184:187], v[80:83]
buffer_load_dwordx4 v[216:219], v39, s[32:35], s57 offen offset:1024 sc1
v_mfma_f32_16x16x32_bf16 v[68:71], v[228:231], v[180:183], v[68:71]
ds_read_b64_tr_b16 v[108:109], v12 offset:20480
ds_read_b64_tr_b16 v[110:111], v12 offset:20992
v_mfma_f32_16x16x32_bf16 v[84:87], v[228:231], v[184:187], v[84:87]
ds_read_b64_tr_b16 v[112:113], v13 offset:20480
ds_read_b64_tr_b16 v[114:115], v13 offset:20992
v_mfma_f32_16x16x32_bf16 v[72:75], v[232:235], v[180:183], v[72:75]
s_add_u32 s57, s57, 2048
s_and_b32 s57, s57, 0x7fff
v_mfma_f32_16x16x32_bf16 v[88:91], v[232:235], v[184:187], v[88:91]
s_waitcnt vmcnt(6) lgkmcnt(8)
v_mfma_f32_16x16x32_bf16 v[60:63], v[236:239], v[188:191], v[60:63]
buffer_load_dwordx4 v[156:159], v38, s[32:35], s57 offen sc1
v_mfma_f32_16x16x32_bf16 v[76:79], v[236:239], v[192:195], v[76:79]
ds_read_b64_tr_b16 v[220:221], v10 offset:24576
ds_read_b64_tr_b16 v[222:223], v10 offset:25088
v_mfma_f32_16x16x32_bf16 v[64:67], v[240:243], v[188:191], v[64:67]
ds_read_b64_tr_b16 v[224:225], v11 offset:24576
ds_read_b64_tr_b16 v[226:227], v11 offset:25088
v_mfma_f32_16x16x32_bf16 v[80:83], v[240:243], v[192:195], v[80:83]
buffer_load_dwordx4 v[160:163], v39, s[32:35], s57 offen sc1
v_mfma_f32_16x16x32_bf16 v[68:71], v[244:247], v[188:191], v[68:71]
ds_read_b64_tr_b16 v[228:229], v12 offset:24576
ds_read_b64_tr_b16 v[230:231], v12 offset:25088
v_mfma_f32_16x16x32_bf16 v[84:87], v[244:247], v[192:195], v[84:87]
ds_read_b64_tr_b16 v[232:233], v13 offset:24576
ds_read_b64_tr_b16 v[234:235], v13 offset:25088
v_mfma_f32_16x16x32_bf16 v[72:75], v[248:251], v[188:191], v[72:75]
v_mfma_f32_16x16x32_bf16 v[88:91], v[248:251], v[192:195], v[88:91]
s_waitcnt vmcnt(6) lgkmcnt(8)
v_mfma_f32_16x16x32_bf16 v[60:63], v[100:103], v[196:199], v[60:63]
buffer_load_dwordx4 v[164:167], v38, s[32:35], s57 offen offset:1024 sc1
v_mfma_f32_16x16x32_bf16 v[76:79], v[100:103], v[200:203], v[76:79]
ds_read_b64_tr_b16 v[236:237], v10 offset:28672
ds_read_b64_tr_b16 v[238:239], v10 offset:29184
v_mfma_f32_16x16x32_bf16 v[64:67], v[104:107], v[196:199], v[64:67]
ds_read_b64_tr_b16 v[240:241], v11 offset:28672
ds_read_b64_tr_b16 v[242:243], v11 offset:29184
v_mfma_f32_16x16x32_bf16 v[80:83], v[104:107], v[200:203], v[80:83]
buffer_load_dwordx4 v[168:171], v39, s[32:35], s57 offen offset:1024 sc1
v_mfma_f32_16x16x32_bf16 v[68:71], v[108:111], v[196:199], v[68:71]
ds_read_b64_tr_b16 v[244:245], v12 offset:28672
ds_read_b64_tr_b16 v[246:247], v12 offset:29184
v_mfma_f32_16x16x32_bf16 v[84:87], v[108:111], v[200:203], v[84:87]
ds_read_b64_tr_b16 v[248:249], v13 offset:28672
ds_read_b64_tr_b16 v[250:251], v13 offset:29184
v_mfma_f32_16x16x32_bf16 v[72:75], v[112:115], v[196:199], v[72:75]
s_add_u32 s57, s57, 2048
s_and_b32 s57, s57, 0x7fff
v_mfma_f32_16x16x32_bf16 v[88:91], v[112:115], v[200:203], v[88:91]
s_waitcnt vmcnt(6) lgkmcnt(8)
v_mfma_f32_16x16x32_bf16 v[60:63], v[220:223], v[204:207], v[60:63]
buffer_load_dwordx4 v[172:175], v38, s[32:35], s57 offen sc1
v_mfma_f32_16x16x32_bf16 v[76:79], v[220:223], v[208:211], v[76:79]
ds_read_b64_tr_b16 v[100:101], v10 offset:32768
ds_read_b64_tr_b16 v[102:103], v10 offset:33280
v_mfma_f32_16x16x32_bf16 v[64:67], v[224:227], v[204:207], v[64:67]
ds_read_b64_tr_b16 v[104:105], v11 offset:32768
ds_read_b64_tr_b16 v[106:107], v11 offset:33280
v_mfma_f32_16x16x32_bf16 v[80:83], v[224:227], v[208:211], v[80:83]
buffer_load_dwordx4 v[176:179], v39, s[32:35], s57 offen sc1
v_mfma_f32_16x16x32_bf16 v[68:71], v[228:231], v[204:207], v[68:71]
ds_read_b64_tr_b16 v[108:109], v12 offset:32768
ds_read_b64_tr_b16 v[110:111], v12 offset:33280
v_mfma_f32_16x16x32_bf16 v[84:87], v[228:231], v[208:211], v[84:87]
ds_read_b64_tr_b16 v[112:113], v13 offset:32768
ds_read_b64_tr_b16 v[114:115], v13 offset:33280
v_mfma_f32_16x16x32_bf16 v[72:75], v[232:235], v[204:207], v[72:75]
v_mfma_f32_16x16x32_bf16 v[88:91], v[232:235], v[208:211], v[88:91]
s_waitcnt vmcnt(6) lgkmcnt(8)
v_mfma_f32_16x16x32_bf16 v[60:63], v[236:239], v[212:215], v[60:63]
buffer_load_dwordx4 v[180:183], v38, s[32:35], s57 offen offset:1024 sc1
v_mfma_f32_16x16x32_bf16 v[76:79], v[236:239], v[216:219], v[76:79]
ds_read_b64_tr_b16 v[220:221], v10 offset:36864
ds_read_b64_tr_b16 v[222:223], v10 offset:37376
v_mfma_f32_16x16x32_bf16 v[64:67], v[240:243], v[212:215], v[64:67]
ds_read_b64_tr_b16 v[224:225], v11 offset:36864
ds_read_b64_tr_b16 v[226:227], v11 offset:37376
v_mfma_f32_16x16x32_bf16 v[80:83], v[240:243], v[216:219], v[80:83]
buffer_load_dwordx4 v[184:187], v39, s[32:35], s57 offen offset:1024 sc1
v_mfma_f32_16x16x32_bf16 v[68:71], v[244:247], v[212:215], v[68:71]
ds_read_b64_tr_b16 v[228:229], v12 offset:36864
ds_read_b64_tr_b16 v[230:231], v12 offset:37376
v_mfma_f32_16x16x32_bf16 v[84:87], v[244:247], v[216:219], v[84:87]
ds_read_b64_tr_b16 v[232:233], v13 offset:36864
ds_read_b64_tr_b16 v[234:235], v13 offset:37376
v_mfma_f32_16x16x32_bf16 v[72:75], v[248:251], v[212:215], v[72:75]
s_add_u32 s57, s57, 2048
s_and_b32 s57, s57, 0x7fff
v_mfma_f32_16x16x32_bf16 v[88:91], v[248:251], v[216:219], v[88:91]
s_waitcnt vmcnt(6) lgkmcnt(8)
v_mfma_f32_16x16x32_bf16 v[60:63], v[100:103], v[156:159], v[60:63]
buffer_load_dwordx4 v[188:191], v38, s[32:35], s57 offen sc1
v_mfma_f32_16x16x32_bf16 v[76:79], v[100:103], v[160:163], v[76:79]
ds_read_b64_tr_b16 v[236:237], v10 offset:40960
ds_read_b64_tr_b16 v[238:239], v10 offset:41472
v_mfma_f32_16x16x32_bf16 v[64:67], v[104:107], v[156:159], v[64:67]
ds_read_b64_tr_b16 v[240:241], v11 offset:40960
ds_read_b64_tr_b16 v[242:243], v11 offset:41472
v_mfma_f32_16x16x32_bf16 v[80:83], v[104:107], v[160:163], v[80:83]
buffer_load_dwordx4 v[192:195], v39, s[32:35], s57 offen sc1
v_mfma_f32_16x16x32_bf16 v[68:71], v[108:111], v[156:159], v[68:71]
ds_read_b64_tr_b16 v[244:245], v12 offset:40960
ds_read_b64_tr_b16 v[246:247], v12 offset:41472
v_mfma_f32_16x16x32_bf16 v[84:87], v[108:111], v[160:163], v[84:87]
ds_read_b64_tr_b16 v[248:249], v13 offset:40960
ds_read_b64_tr_b16 v[250:251], v13 offset:41472
v_mfma_f32_16x16x32_bf16 v[72:75], v[112:115], v[156:159], v[72:75]
v_mfma_f32_16x16x32_bf16 v[88:91], v[112:115], v[160:163], v[88:91]
s_waitcnt vmcnt(6) lgkmcnt(8)
v_mfma_f32_16x16x32_bf16 v[60:63], v[220:223], v[164:167], v[60:63]
buffer_load_dwordx4 v[196:199], v38, s[32:35], s57 offen offset:1024 sc1
v_mfma_f32_16x16x32_bf16 v[76:79], v[220:223], v[168:171], v[76:79]
ds_read_b64_tr_b16 v[100:101], v10 offset:45056
ds_read_b64_tr_b16 v[102:103], v10 offset:45568
v_mfma_f32_16x16x32_bf16 v[64:67], v[224:227], v[164:167], v[64:67]
ds_read_b64_tr_b16 v[104:105], v11 offset:45056
ds_read_b64_tr_b16 v[106:107], v11 offset:45568
v_mfma_f32_16x16x32_bf16 v[80:83], v[224:227], v[168:171], v[80:83]
buffer_load_dwordx4 v[200:203], v39, s[32:35], s57 offen offset:1024 sc1
v_mfma_f32_16x16x32_bf16 v[68:71], v[228:231], v[164:167], v[68:71]
ds_read_b64_tr_b16 v[108:109], v12 offset:45056
ds_read_b64_tr_b16 v[110:111], v12 offset:45568
v_mfma_f32_16x16x32_bf16 v[84:87], v[228:231], v[168:171], v[84:87]
ds_read_b64_tr_b16 v[112:113], v13 offset:45056
ds_read_b64_tr_b16 v[114:115], v13 offset:45568
v_mfma_f32_16x16x32_bf16 v[72:75], v[232:235], v[164:167], v[72:75]
s_add_u32 s57, s57, 2048
s_and_b32 s57, s57, 0x7fff
v_mfma_f32_16x16x32_bf16 v[88:91], v[232:235], v[168:171], v[88:91]
s_waitcnt vmcnt(6) lgkmcnt(8)
v_mfma_f32_16x16x32_bf16 v[60:63], v[236:239], v[172:175], v[60:63]
buffer_load_dwordx4 v[204:207], v38, s[32:35], s57 offen sc1
v_mfma_f32_16x16x32_bf16 v[76:79], v[236:239], v[176:179], v[76:79]
ds_read_b64_tr_b16 v[220:221], v10 offset:49152
ds_read_b64_tr_b16 v[222:223], v10 offset:49664
v_mfma_f32_16x16x32_bf16 v[64:67], v[240:243], v[172:175], v[64:67]
ds_read_b64_tr_b16 v[224:225], v11 offset:49152
ds_read_b64_tr_b16 v[226:227], v11 offset:49664
v_mfma_f32_16x16x32_bf16 v[80:83], v[240:243], v[176:179], v[80:83]
buffer_load_dwordx4 v[208:211], v39, s[32:35], s57 offen sc1
v_mfma_f32_16x16x32_bf16 v[68:71], v[244:247], v[172:175], v[68:71]
ds_read_b64_tr_b16 v[228:229], v12 offset:49152
ds_read_b64_tr_b16 v[230:231], v12 offset:49664
v_mfma_f32_16x16x32_bf16 v[84:87], v[244:247], v[176:179], v[84:87]
ds_read_b64_tr_b16 v[232:233], v13 offset:49152
ds_read_b64_tr_b16 v[234:235], v13 offset:49664
v_mfma_f32_16x16x32_bf16 v[72:75], v[248:251], v[172:175], v[72:75]
v_mfma_f32_16x16x32_bf16 v[88:91], v[248:251], v[176:179], v[88:91]
s_waitcnt vmcnt(6) lgkmcnt(8)
v_mfma_f32_16x16x32_bf16 v[60:63], v[100:103], v[180:183], v[60:63]
buffer_load_dwordx4 v[212:215], v38, s[32:35], s57 offen offset:1024 sc1
v_mfma_f32_16x16x32_bf16 v[76:79], v[100:103], v[184:187], v[76:79]
ds_read_b64_tr_b16 v[236:237], v10 offset:53248
ds_read_b64_tr_b16 v[238:239], v10 offset:53760
v_mfma_f32_16x16x32_bf16 v[64:67], v[104:107], v[180:183], v[64:67]
ds_read_b64_tr_b16 v[240:241], v11 offset:53248
ds_read_b64_tr_b16 v[242:243], v11 offset:53760
v_mfma_f32_16x16x32_bf16 v[80:83], v[104:107], v[184:187], v[80:83]
buffer_load_dwordx4 v[216:219], v39, s[32:35], s57 offen offset:1024 sc1
v_mfma_f32_16x16x32_bf16 v[68:71], v[108:111], v[180:183], v[68:71]
ds_read_b64_tr_b16 v[244:245], v12 offset:53248
ds_read_b64_tr_b16 v[246:247], v12 offset:53760
v_mfma_f32_16x16x32_bf16 v[84:87], v[108:111], v[184:187], v[84:87]
ds_read_b64_tr_b16 v[248:249], v13 offset:53248
ds_read_b64_tr_b16 v[250:251], v13 offset:53760
v_mfma_f32_16x16x32_bf16 v[72:75], v[112:115], v[180:183], v[72:75]
s_add_u32 s57, s57, 2048
s_and_b32 s57, s57, 0x7fff
v_mfma_f32_16x16x32_bf16 v[88:91], v[112:115], v[184:187], v[88:91]
s_waitcnt vmcnt(6) lgkmcnt(8)
v_mfma_f32_16x16x32_bf16 v[60:63], v[220:223], v[188:191], v[60:63]
buffer_load_dwordx4 v[156:159], v38, s[32:35], s57 offen sc1
v_mfma_f32_16x16x32_bf16 v[76:79], v[220:223], v[192:195], v[76:79]
ds_read_b64_tr_b16 v[100:101], v10 offset:57344
ds_read_b64_tr_b16 v[102:103], v10 offset:57856
v_mfma_f32_16x16x32_bf16 v[64:67], v[224:227], v[188:191], v[64:67]
ds_read_b64_tr_b16 v[104:105], v11 offset:57344
ds_read_b64_tr_b16 v[106:107], v11 offset:57856
v_mfma_f32_16x16x32_bf16 v[80:83], v[224:227], v[192:195], v[80:83]
buffer_load_dwordx4 v[160:163], v39, s[32:35], s57 offen sc1
v_mfma_f32_16x16x32_bf16 v[68:71], v[228:231], v[188:191], v[68:71]
ds_read_b64_tr_b16 v[108:109], v12 offset:57344
ds_read_b64_tr_b16 v[110:111], v12 offset:57856
v_mfma_f32_16x16x32_bf16 v[84:87], v[228:231], v[192:195], v[84:87]
ds_read_b64_tr_b16 v[112:113], v13 offset:57344
ds_read_b64_tr_b16 v[114:115], v13 offset:57856
v_mfma_f32_16x16x32_bf16 v[72:75], v[232:235], v[188:191], v[72:75]
v_mfma_f32_16x16x32_bf16 v[88:91], v[232:235], v[192:195], v[88:91]
s_waitcnt vmcnt(6) lgkmcnt(8)
v_mfma_f32_16x16x32_bf16 v[60:63], v[236:239], v[196:199], v[60:63]
buffer_load_dwordx4 v[164:167], v38, s[32:35], s57 offen offset:1024 sc1
v_mfma_f32_16x16x32_bf16 v[76:79], v[236:239], v[200:203], v[76:79]
ds_read_b64_tr_b16 v[220:221], v10 offset:61440
ds_read_b64_tr_b16 v[222:223], v10 offset:61952
v_mfma_f32_16x16x32_bf16 v[64:67], v[240:243], v[196:199], v[64:67]
ds_read_b64_tr_b16 v[224:225], v11 offset:61440
ds_read_b64_tr_b16 v[226:227], v11 offset:61952
v_mfma_f32_16x16x32_bf16 v[80:83], v[240:243], v[200:203], v[80:83]
buffer_load_dwordx4 v[168:171], v39, s[32:35], s57 offen offset:1024 sc1
v_mfma_f32_16x16x32_bf16 v[68:71], v[244:247], v[196:199], v[68:71]
ds_read_b64_tr_b16 v[228:229], v12 offset:61440
ds_read_b64_tr_b16 v[230:231], v12 offset:61952
v_mfma_f32_16x16x32_bf16 v[84:87], v[244:247], v[200:203], v[84:87]
ds_read_b64_tr_b16 v[232:233], v13 offset:61440
ds_read_b64_tr_b16 v[234:235], v13 offset:61952
v_mfma_f32_16x16x32_bf16 v[72:75], v[248:251], v[196:199], v[72:75]
s_add_u32 s57, s57, 2048
s_and_b32 s57, s57, 0x7fff
v_mfma_f32_16x16x32_bf16 v[88:91], v[248:251], v[200:203], v[88:91]
s_waitcnt vmcnt(6) lgkmcnt(8)
v_mfma_f32_16x16x32_bf16 v[60:63], v[100:103], v[204:207], v[60:63]
buffer_load_dwordx4 v[172:175], v38, s[32:35], s57 offen sc1
v_mfma_f32_16x16x32_bf16 v[76:79], v[100:103], v[208:211], v[76:79]
ds_read_b64_tr_b16 v[236:237], v14 offset:0
ds_read_b64_tr_b16 v[238:239], v14 offset:512
v_mfma_f32_16x16x32_bf16 v[64:67], v[104:107], v[204:207], v[64:67]
ds_read_b64_tr_b16 v[240:241], v15 offset:0
ds_read_b64_tr_b16 v[242:243], v15 offset:512
v_mfma_f32_16x16x32_bf16 v[80:83], v[104:107], v[208:211], v[80:83]
buffer_load_dwordx4 v[176:179], v39, s[32:35], s57 offen sc1
v_mfma_f32_16x16x32_bf16 v[68:71], v[108:111], v[204:207], v[68:71]
ds_read_b64_tr_b16 v[244:245], v16 offset:0
ds_read_b64_tr_b16 v[246:247], v16 offset:512
v_mfma_f32_16x16x32_bf16 v[84:87], v[108:111], v[208:211], v[84:87]
ds_read_b64_tr_b16 v[248:249], v17 offset:0
ds_read_b64_tr_b16 v[250:251], v17 offset:512
v_mfma_f32_16x16x32_bf16 v[72:75], v[112:115], v[204:207], v[72:75]
v_mfma_f32_16x16x32_bf16 v[88:91], v[112:115], v[208:211], v[88:91]
s_waitcnt vmcnt(6) lgkmcnt(8)
v_mfma_f32_16x16x32_bf16 v[60:63], v[220:223], v[212:215], v[60:63]
buffer_load_dwordx4 v[180:183], v38, s[32:35], s57 offen offset:1024 sc1
v_mfma_f32_16x16x32_bf16 v[76:79], v[220:223], v[216:219], v[76:79]
ds_read_b64_tr_b16 v[100:101], v14 offset:4096
ds_read_b64_tr_b16 v[102:103], v14 offset:4608
v_mfma_f32_16x16x32_bf16 v[64:67], v[224:227], v[212:215], v[64:67]
ds_read_b64_tr_b16 v[104:105], v15 offset:4096
ds_read_b64_tr_b16 v[106:107], v15 offset:4608
v_mfma_f32_16x16x32_bf16 v[80:83], v[224:227], v[216:219], v[80:83]
buffer_load_dwordx4 v[184:187], v39, s[32:35], s57 offen offset:1024 sc1
v_mfma_f32_16x16x32_bf16 v[68:71], v[228:231], v[212:215], v[68:71]
ds_read_b64_tr_b16 v[108:109], v16 offset:4096
ds_read_b64_tr_b16 v[110:111], v16 offset:4608
v_mfma_f32_16x16x32_bf16 v[84:87], v[228:231], v[216:219], v[84:87]
ds_read_b64_tr_b16 v[112:113], v17 offset:4096
ds_read_b64_tr_b16 v[114:115], v17 offset:4608
v_mfma_f32_16x16x32_bf16 v[72:75], v[232:235], v[212:215], v[72:75]
s_add_u32 s57, s57, 2048
s_and_b32 s57, s57, 0x7fff
v_mfma_f32_16x16x32_bf16 v[88:91], v[232:235], v[216:219], v[88:91]
s_waitcnt vmcnt(6) lgkmcnt(8)
v_mfma_f32_16x16x32_bf16 v[60:63], v[236:239], v[156:159], v[60:63]
buffer_load_dwordx4 v[188:191], v38, s[32:35], s57 offen sc1
v_mfma_f32_16x16x32_bf16 v[76:79], v[236:239], v[160:163], v[76:79]
ds_read_b64_tr_b16 v[220:221], v14 offset:8192
ds_read_b64_tr_b16 v[222:223], v14 offset:8704
v_mfma_f32_16x16x32_bf16 v[64:67], v[240:243], v[156:159], v[64:67]
ds_read_b64_tr_b16 v[224:225], v15 offset:8192
ds_read_b64_tr_b16 v[226:227], v15 offset:8704
v_mfma_f32_16x16x32_bf16 v[80:83], v[240:243], v[160:163], v[80:83]
buffer_load_dwordx4 v[192:195], v39, s[32:35], s57 offen sc1
v_mfma_f32_16x16x32_bf16 v[68:71], v[244:247], v[156:159], v[68:71]
ds_read_b64_tr_b16 v[228:229], v16 offset:8192
ds_read_b64_tr_b16 v[230:231], v16 offset:8704
v_mfma_f32_16x16x32_bf16 v[84:87], v[244:247], v[160:163], v[84:87]
ds_read_b64_tr_b16 v[232:233], v17 offset:8192
ds_read_b64_tr_b16 v[234:235], v17 offset:8704
v_mfma_f32_16x16x32_bf16 v[72:75], v[248:251], v[156:159], v[72:75]
v_mfma_f32_16x16x32_bf16 v[88:91], v[248:251], v[160:163], v[88:91]
s_waitcnt vmcnt(6) lgkmcnt(8)
v_mfma_f32_16x16x32_bf16 v[60:63], v[100:103], v[164:167], v[60:63]
buffer_load_dwordx4 v[196:199], v38, s[32:35], s57 offen offset:1024 sc1
v_mfma_f32_16x16x32_bf16 v[76:79], v[100:103], v[168:171], v[76:79]
ds_read_b64_tr_b16 v[236:237], v14 offset:12288
ds_read_b64_tr_b16 v[238:239], v14 offset:12800
v_mfma_f32_16x16x32_bf16 v[64:67], v[104:107], v[164:167], v[64:67]
ds_read_b64_tr_b16 v[240:241], v15 offset:12288
ds_read_b64_tr_b16 v[242:243], v15 offset:12800
v_mfma_f32_16x16x32_bf16 v[80:83], v[104:107], v[168:171], v[80:83]
buffer_load_dwordx4 v[200:203], v39, s[32:35], s57 offen offset:1024 sc1
v_mfma_f32_16x16x32_bf16 v[68:71], v[108:111], v[164:167], v[68:71]
ds_read_b64_tr_b16 v[244:245], v16 offset:12288
ds_read_b64_tr_b16 v[246:247], v16 offset:12800
v_mfma_f32_16x16x32_bf16 v[84:87], v[108:111], v[168:171], v[84:87]
ds_read_b64_tr_b16 v[248:249], v17 offset:12288
ds_read_b64_tr_b16 v[250:251], v17 offset:12800
v_mfma_f32_16x16x32_bf16 v[72:75], v[112:115], v[164:167], v[72:75]
s_add_u32 s57, s57, 2048
s_and_b32 s57, s57, 0x7fff
v_mfma_f32_16x16x32_bf16 v[88:91], v[112:115], v[168:171], v[88:91]
s_waitcnt vmcnt(6) lgkmcnt(8)
v_mfma_f32_16x16x32_bf16 v[60:63], v[220:223], v[172:175], v[60:63]
buffer_load_dwordx4 v[204:207], v38, s[32:35], s57 offen sc1
v_mfma_f32_16x16x32_bf16 v[76:79], v[220:223], v[176:179], v[76:79]
ds_read_b64_tr_b16 v[100:101], v14 offset:16384
ds_read_b64_tr_b16 v[102:103], v14 offset:16896
v_mfma_f32_16x16x32_bf16 v[64:67], v[224:227], v[172:175], v[64:67]
ds_read_b64_tr_b16 v[104:105], v15 offset:16384
ds_read_b64_tr_b16 v[106:107], v15 offset:16896
v_mfma_f32_16x16x32_bf16 v[80:83], v[224:227], v[176:179], v[80:83]
buffer_load_dwordx4 v[208:211], v39, s[32:35], s57 offen sc1
v_mfma_f32_16x16x32_bf16 v[68:71], v[228:231], v[172:175], v[68:71]
ds_read_b64_tr_b16 v[108:109], v16 offset:16384
ds_read_b64_tr_b16 v[110:111], v16 offset:16896
v_mfma_f32_16x16x32_bf16 v[84:87], v[228:231], v[176:179], v[84:87]
ds_read_b64_tr_b16 v[112:113], v17 offset:16384
ds_read_b64_tr_b16 v[114:115], v17 offset:16896
v_mfma_f32_16x16x32_bf16 v[72:75], v[232:235], v[172:175], v[72:75]
v_mfma_f32_16x16x32_bf16 v[88:91], v[232:235], v[176:179], v[88:91]
s_waitcnt vmcnt(6) lgkmcnt(8)
v_mfma_f32_16x16x32_bf16 v[60:63], v[236:239], v[180:183], v[60:63]
buffer_load_dwordx4 v[212:215], v38, s[32:35], s57 offen offset:1024 sc1
v_mfma_f32_16x16x32_bf16 v[76:79], v[236:239], v[184:187], v[76:79]
ds_read_b64_tr_b16 v[220:221], v14 offset:20480
ds_read_b64_tr_b16 v[222:223], v14 offset:20992
v_mfma_f32_16x16x32_bf16 v[64:67], v[240:243], v[180:183], v[64:67]
ds_read_b64_tr_b16 v[224:225], v15 offset:20480
ds_read_b64_tr_b16 v[226:227], v15 offset:20992
v_mfma_f32_16x16x32_bf16 v[80:83], v[240:243], v[184:187], v[80:83]
buffer_load_dwordx4 v[216:219], v39, s[32:35], s57 offen offset:1024 sc1
v_mfma_f32_16x16x32_bf16 v[68:71], v[244:247], v[180:183], v[68:71]
ds_read_b64_tr_b16 v[228:229], v16 offset:20480
ds_read_b64_tr_b16 v[230:231], v16 offset:20992
v_mfma_f32_16x16x32_bf16 v[84:87], v[244:247], v[184:187], v[84:87]
ds_read_b64_tr_b16 v[232:233], v17 offset:20480
ds_read_b64_tr_b16 v[234:235], v17 offset:20992
v_mfma_f32_16x16x32_bf16 v[72:75], v[248:251], v[180:183], v[72:75]
s_add_u32 s57, s57, 2048
s_and_b32 s57, s57, 0x7fff
v_mfma_f32_16x16x32_bf16 v[88:91], v[248:251], v[184:187], v[88:91]
s_waitcnt vmcnt(6) lgkmcnt(8)
v_mfma_f32_16x16x32_bf16 v[60:63], v[100:103], v[188:191], v[60:63]
buffer_load_dwordx4 v[156:159], v38, s[32:35], s57 offen sc1
v_mfma_f32_16x16x32_bf16 v[76:79], v[100:103], v[192:195], v[76:79]
ds_read_b64_tr_b16 v[236:237], v14 offset:24576
ds_read_b64_tr_b16 v[238:239], v14 offset:25088
v_mfma_f32_16x16x32_bf16 v[64:67], v[104:107], v[188:191], v[64:67]
ds_read_b64_tr_b16 v[240:241], v15 offset:24576
ds_read_b64_tr_b16 v[242:243], v15 offset:25088
v_mfma_f32_16x16x32_bf16 v[80:83], v[104:107], v[192:195], v[80:83]
buffer_load_dwordx4 v[160:163], v39, s[32:35], s57 offen sc1
v_mfma_f32_16x16x32_bf16 v[68:71], v[108:111], v[188:191], v[68:71]
ds_read_b64_tr_b16 v[244:245], v16 offset:24576
ds_read_b64_tr_b16 v[246:247], v16 offset:25088
v_mfma_f32_16x16x32_bf16 v[84:87], v[108:111], v[192:195], v[84:87]
ds_read_b64_tr_b16 v[248:249], v17 offset:24576
ds_read_b64_tr_b16 v[250:251], v17 offset:25088
v_mfma_f32_16x16x32_bf16 v[72:75], v[112:115], v[188:191], v[72:75]
v_mfma_f32_16x16x32_bf16 v[88:91], v[112:115], v[192:195], v[88:91]
s_waitcnt vmcnt(6) lgkmcnt(8)
v_mfma_f32_16x16x32_bf16 v[60:63], v[220:223], v[196:199], v[60:63]
buffer_load_dwordx4 v[164:167], v38, s[32:35], s57 offen offset:1024 sc1
v_mfma_f32_16x16x32_bf16 v[76:79], v[220:223], v[200:203], v[76:79]
ds_read_b64_tr_b16 v[100:101], v14 offset:28672
ds_read_b64_tr_b16 v[102:103], v14 offset:29184
v_mfma_f32_16x16x32_bf16 v[64:67], v[224:227], v[196:199], v[64:67]
ds_read_b64_tr_b16 v[104:105], v15 offset:28672
ds_read_b64_tr_b16 v[106:107], v15 offset:29184
v_mfma_f32_16x16x32_bf16 v[80:83], v[224:227], v[200:203], v[80:83]
buffer_load_dwordx4 v[168:171], v39, s[32:35], s57 offen offset:1024 sc1
v_mfma_f32_16x16x32_bf16 v[68:71], v[228:231], v[196:199], v[68:71]
ds_read_b64_tr_b16 v[108:109], v16 offset:28672
ds_read_b64_tr_b16 v[110:111], v16 offset:29184
v_mfma_f32_16x16x32_bf16 v[84:87], v[228:231], v[200:203], v[84:87]
ds_read_b64_tr_b16 v[112:113], v17 offset:28672
ds_read_b64_tr_b16 v[114:115], v17 offset:29184
v_mfma_f32_16x16x32_bf16 v[72:75], v[232:235], v[196:199], v[72:75]
s_add_u32 s57, s57, 2048
s_and_b32 s57, s57, 0x7fff
v_mfma_f32_16x16x32_bf16 v[88:91], v[232:235], v[200:203], v[88:91]
s_waitcnt vmcnt(6) lgkmcnt(8)
v_mfma_f32_16x16x32_bf16 v[60:63], v[236:239], v[204:207], v[60:63]
buffer_load_dwordx4 v[172:175], v38, s[32:35], s57 offen sc1
v_mfma_f32_16x16x32_bf16 v[76:79], v[236:239], v[208:211], v[76:79]
ds_read_b64_tr_b16 v[220:221], v14 offset:32768
ds_read_b64_tr_b16 v[222:223], v14 offset:33280
v_mfma_f32_16x16x32_bf16 v[64:67], v[240:243], v[204:207], v[64:67]
ds_read_b64_tr_b16 v[224:225], v15 offset:32768
ds_read_b64_tr_b16 v[226:227], v15 offset:33280
v_mfma_f32_16x16x32_bf16 v[80:83], v[240:243], v[208:211], v[80:83]
buffer_load_dwordx4 v[176:179], v39, s[32:35], s57 offen sc1
v_mfma_f32_16x16x32_bf16 v[68:71], v[244:247], v[204:207], v[68:71]
ds_read_b64_tr_b16 v[228:229], v16 offset:32768
ds_read_b64_tr_b16 v[230:231], v16 offset:33280
v_mfma_f32_16x16x32_bf16 v[84:87], v[244:247], v[208:211], v[84:87]
ds_read_b64_tr_b16 v[232:233], v17 offset:32768
ds_read_b64_tr_b16 v[234:235], v17 offset:33280
v_mfma_f32_16x16x32_bf16 v[72:75], v[248:251], v[204:207], v[72:75]
v_mfma_f32_16x16x32_bf16 v[88:91], v[248:251], v[208:211], v[88:91]
s_waitcnt vmcnt(6) lgkmcnt(8)
v_mfma_f32_16x16x32_bf16 v[60:63], v[100:103], v[212:215], v[60:63]
buffer_load_dwordx4 v[180:183], v38, s[32:35], s57 offen offset:1024 sc1
v_mfma_f32_16x16x32_bf16 v[76:79], v[100:103], v[216:219], v[76:79]
ds_read_b64_tr_b16 v[236:237], v14 offset:36864
ds_read_b64_tr_b16 v[238:239], v14 offset:37376
v_mfma_f32_16x16x32_bf16 v[64:67], v[104:107], v[212:215], v[64:67]
ds_read_b64_tr_b16 v[240:241], v15 offset:36864
ds_read_b64_tr_b16 v[242:243], v15 offset:37376
v_mfma_f32_16x16x32_bf16 v[80:83], v[104:107], v[216:219], v[80:83]
buffer_load_dwordx4 v[184:187], v39, s[32:35], s57 offen offset:1024 sc1
v_mfma_f32_16x16x32_bf16 v[68:71], v[108:111], v[212:215], v[68:71]
ds_read_b64_tr_b16 v[244:245], v16 offset:36864
ds_read_b64_tr_b16 v[246:247], v16 offset:37376
v_mfma_f32_16x16x32_bf16 v[84:87], v[108:111], v[216:219], v[84:87]
ds_read_b64_tr_b16 v[248:249], v17 offset:36864
ds_read_b64_tr_b16 v[250:251], v17 offset:37376
v_mfma_f32_16x16x32_bf16 v[72:75], v[112:115], v[212:215], v[72:75]
s_add_u32 s57, s57, 2048
s_and_b32 s57, s57, 0x7fff
v_mfma_f32_16x16x32_bf16 v[88:91], v[112:115], v[216:219], v[88:91]
s_waitcnt vmcnt(6) lgkmcnt(8)
v_mfma_f32_16x16x32_bf16 v[60:63], v[220:223], v[156:159], v[60:63]
buffer_load_dwordx4 v[188:191], v38, s[32:35], s57 offen sc1
v_mfma_f32_16x16x32_bf16 v[76:79], v[220:223], v[160:163], v[76:79]
ds_read_b64_tr_b16 v[100:101], v14 offset:40960
ds_read_b64_tr_b16 v[102:103], v14 offset:41472
v_mfma_f32_16x16x32_bf16 v[64:67], v[224:227], v[156:159], v[64:67]
ds_read_b64_tr_b16 v[104:105], v15 offset:40960
ds_read_b64_tr_b16 v[106:107], v15 offset:41472
v_mfma_f32_16x16x32_bf16 v[80:83], v[224:227], v[160:163], v[80:83]
buffer_load_dwordx4 v[192:195], v39, s[32:35], s57 offen sc1
v_mfma_f32_16x16x32_bf16 v[68:71], v[228:231], v[156:159], v[68:71]
ds_read_b64_tr_b16 v[108:109], v16 offset:40960
ds_read_b64_tr_b16 v[110:111], v16 offset:41472
v_mfma_f32_16x16x32_bf16 v[84:87], v[228:231], v[160:163], v[84:87]
ds_read_b64_tr_b16 v[112:113], v17 offset:40960
ds_read_b64_tr_b16 v[114:115], v17 offset:41472
v_mfma_f32_16x16x32_bf16 v[72:75], v[232:235], v[156:159], v[72:75]
v_mfma_f32_16x16x32_bf16 v[88:91], v[232:235], v[160:163], v[88:91]
s_waitcnt vmcnt(6) lgkmcnt(8)
v_mfma_f32_16x16x32_bf16 v[60:63], v[236:239], v[164:167], v[60:63]
buffer_load_dwordx4 v[196:199], v38, s[32:35], s57 offen offset:1024 sc1
v_mfma_f32_16x16x32_bf16 v[76:79], v[236:239], v[168:171], v[76:79]
ds_read_b64_tr_b16 v[220:221], v14 offset:45056
ds_read_b64_tr_b16 v[222:223], v14 offset:45568
v_mfma_f32_16x16x32_bf16 v[64:67], v[240:243], v[164:167], v[64:67]
ds_read_b64_tr_b16 v[224:225], v15 offset:45056
ds_read_b64_tr_b16 v[226:227], v15 offset:45568
v_mfma_f32_16x16x32_bf16 v[80:83], v[240:243], v[168:171], v[80:83]
buffer_load_dwordx4 v[200:203], v39, s[32:35], s57 offen offset:1024 sc1
v_mfma_f32_16x16x32_bf16 v[68:71], v[244:247], v[164:167], v[68:71]
ds_read_b64_tr_b16 v[228:229], v16 offset:45056
ds_read_b64_tr_b16 v[230:231], v16 offset:45568
v_mfma_f32_16x16x32_bf16 v[84:87], v[244:247], v[168:171], v[84:87]
ds_read_b64_tr_b16 v[232:233], v17 offset:45056
ds_read_b64_tr_b16 v[234:235], v17 offset:45568
v_mfma_f32_16x16x32_bf16 v[72:75], v[248:251], v[164:167], v[72:75]
s_add_u32 s57, s57, 2048
s_and_b32 s57, s57, 0x7fff
v_mfma_f32_16x16x32_bf16 v[88:91], v[248:251], v[168:171], v[88:91]
s_waitcnt vmcnt(6) lgkmcnt(8)
v_mfma_f32_16x16x32_bf16 v[60:63], v[100:103], v[172:175], v[60:63]
buffer_load_dwordx4 v[204:207], v38, s[32:35], s57 offen sc1
v_mfma_f32_16x16x32_bf16 v[76:79], v[100:103], v[176:179], v[76:79]
ds_read_b64_tr_b16 v[236:237], v14 offset:49152
ds_read_b64_tr_b16 v[238:239], v14 offset:49664
v_mfma_f32_16x16x32_bf16 v[64:67], v[104:107], v[172:175], v[64:67]
ds_read_b64_tr_b16 v[240:241], v15 offset:49152
ds_read_b64_tr_b16 v[242:243], v15 offset:49664
v_mfma_f32_16x16x32_bf16 v[80:83], v[104:107], v[176:179], v[80:83]
buffer_load_dwordx4 v[208:211], v39, s[32:35], s57 offen sc1
v_mfma_f32_16x16x32_bf16 v[68:71], v[108:111], v[172:175], v[68:71]
ds_read_b64_tr_b16 v[244:245], v16 offset:49152
ds_read_b64_tr_b16 v[246:247], v16 offset:49664
v_mfma_f32_16x16x32_bf16 v[84:87], v[108:111], v[176:179], v[84:87]
ds_read_b64_tr_b16 v[248:249], v17 offset:49152
ds_read_b64_tr_b16 v[250:251], v17 offset:49664
v_mfma_f32_16x16x32_bf16 v[72:75], v[112:115], v[172:175], v[72:75]
v_mfma_f32_16x16x32_bf16 v[88:91], v[112:115], v[176:179], v[88:91]
s_waitcnt vmcnt(6) lgkmcnt(8)
v_mfma_f32_16x16x32_bf16 v[60:63], v[220:223], v[180:183], v[60:63]
buffer_load_dwordx4 v[212:215], v38, s[32:35], s57 offen offset:1024 sc1
v_mfma_f32_16x16x32_bf16 v[76:79], v[220:223], v[184:187], v[76:79]
ds_read_b64_tr_b16 v[100:101], v14 offset:53248
ds_read_b64_tr_b16 v[102:103], v14 offset:53760
v_mfma_f32_16x16x32_bf16 v[64:67], v[224:227], v[180:183], v[64:67]
ds_read_b64_tr_b16 v[104:105], v15 offset:53248
ds_read_b64_tr_b16 v[106:107], v15 offset:53760
v_mfma_f32_16x16x32_bf16 v[80:83], v[224:227], v[184:187], v[80:83]
buffer_load_dwordx4 v[216:219], v39, s[32:35], s57 offen offset:1024 sc1
v_mfma_f32_16x16x32_bf16 v[68:71], v[228:231], v[180:183], v[68:71]
ds_read_b64_tr_b16 v[108:109], v16 offset:53248
ds_read_b64_tr_b16 v[110:111], v16 offset:53760
v_mfma_f32_16x16x32_bf16 v[84:87], v[228:231], v[184:187], v[84:87]
ds_read_b64_tr_b16 v[112:113], v17 offset:53248
ds_read_b64_tr_b16 v[114:115], v17 offset:53760
v_mfma_f32_16x16x32_bf16 v[72:75], v[232:235], v[180:183], v[72:75]
v_mfma_f32_16x16x32_bf16 v[88:91], v[232:235], v[184:187], v[88:91]
s_waitcnt vmcnt(6) lgkmcnt(8)
v_mfma_f32_16x16x32_bf16 v[60:63], v[236:239], v[188:191], v[60:63]
v_mfma_f32_16x16x32_bf16 v[76:79], v[236:239], v[192:195], v[76:79]
ds_read_b64_tr_b16 v[220:221], v14 offset:57344
ds_read_b64_tr_b16 v[222:223], v14 offset:57856
v_mfma_f32_16x16x32_bf16 v[64:67], v[240:243], v[188:191], v[64:67]
ds_read_b64_tr_b16 v[224:225], v15 offset:57344
ds_read_b64_tr_b16 v[226:227], v15 offset:57856
v_mfma_f32_16x16x32_bf16 v[80:83], v[240:243], v[192:195], v[80:83]
v_mfma_f32_16x16x32_bf16 v[68:71], v[244:247], v[188:191], v[68:71]
ds_read_b64_tr_b16 v[228:229], v16 offset:57344
ds_read_b64_tr_b16 v[230:231], v16 offset:57856
v_mfma_f32_16x16x32_bf16 v[84:87], v[244:247], v[192:195], v[84:87]
ds_read_b64_tr_b16 v[232:233], v17 offset:57344
ds_read_b64_tr_b16 v[234:235], v17 offset:57856
v_mfma_f32_16x16x32_bf16 v[72:75], v[248:251], v[188:191], v[72:75]
v_mfma_f32_16x16x32_bf16 v[88:91], v[248:251], v[192:195], v[88:91]
s_waitcnt vmcnt(4) lgkmcnt(8)
v_mfma_f32_16x16x32_bf16 v[60:63], v[100:103], v[196:199], v[60:63]
v_mfma_f32_16x16x32_bf16 v[76:79], v[100:103], v[200:203], v[76:79]
ds_read_b64_tr_b16 v[236:237], v14 offset:61440
ds_read_b64_tr_b16 v[238:239], v14 offset:61952
v_mfma_f32_16x16x32_bf16 v[64:67], v[104:107], v[196:199], v[64:67]
ds_read_b64_tr_b16 v[240:241], v15 offset:61440
ds_read_b64_tr_b16 v[242:243], v15 offset:61952
v_mfma_f32_16x16x32_bf16 v[80:83], v[104:107], v[200:203], v[80:83]
v_mfma_f32_16x16x32_bf16 v[68:71], v[108:111], v[196:199], v[68:71]
ds_read_b64_tr_b16 v[244:245], v16 offset:61440
ds_read_b64_tr_b16 v[246:247], v16 offset:61952
v_mfma_f32_16x16x32_bf16 v[84:87], v[108:111], v[200:203], v[84:87]
ds_read_b64_tr_b16 v[248:249], v17 offset:61440
ds_read_b64_tr_b16 v[250:251], v17 offset:61952
v_mfma_f32_16x16x32_bf16 v[72:75], v[112:115], v[196:199], v[72:75]
v_mfma_f32_16x16x32_bf16 v[88:91], v[112:115], v[200:203], v[88:91]
s_waitcnt vmcnt(2) lgkmcnt(8)
v_mfma_f32_16x16x32_bf16 v[60:63], v[220:223], v[204:207], v[60:63]
v_mfma_f32_16x16x32_bf16 v[76:79], v[220:223], v[208:211], v[76:79]
v_mfma_f32_16x16x32_bf16 v[64:67], v[224:227], v[204:207], v[64:67]
v_mfma_f32_16x16x32_bf16 v[80:83], v[224:227], v[208:211], v[80:83]
v_mfma_f32_16x16x32_bf16 v[68:71], v[228:231], v[204:207], v[68:71]
v_mfma_f32_16x16x32_bf16 v[84:87], v[228:231], v[208:211], v[84:87]
v_mfma_f32_16x16x32_bf16 v[72:75], v[232:235], v[204:207], v[72:75]
v_mfma_f32_16x16x32_bf16 v[88:91], v[232:235], v[208:211], v[88:91]
s_waitcnt vmcnt(0) lgkmcnt(0)
v_mfma_f32_16x16x32_bf16 v[60:63], v[236:239], v[212:215], v[60:63]
v_mfma_f32_16x16x32_bf16 v[64:67], v[240:243], v[212:215], v[64:67]
v_mfma_f32_16x16x32_bf16 v[68:71], v[244:247], v[212:215], v[68:71]
v_mfma_f32_16x16x32_bf16 v[72:75], v[248:251], v[212:215], v[72:75]
v_mfma_f32_16x16x32_bf16 v[76:79], v[236:239], v[216:219], v[76:79]
v_mfma_f32_16x16x32_bf16 v[80:83], v[240:243], v[216:219], v[80:83]
v_mfma_f32_16x16x32_bf16 v[84:87], v[244:247], v[216:219], v[84:87]
v_mfma_f32_16x16x32_bf16 v[88:91], v[248:251], v[216:219], v[88:91]
s_cmp_eq_u32 s46, 0
s_cbranch_scc1 slow_93
s_nop 0
v_cvt_pk_bf16_f32 v20, v60, v61
v_cvt_pk_bf16_f32 v21, v62, v63
v_cvt_pk_bf16_f32 v22, v64, v65
v_cvt_pk_bf16_f32 v23, v66, v67
buffer_store_dwordx4 v[20:23], v18, s[32:35], s85 offen offset:0
v_cvt_pk_bf16_f32 v24, v68, v69
v_cvt_pk_bf16_f32 v25, v70, v71
v_cvt_pk_bf16_f32 v26, v72, v73
v_cvt_pk_bf16_f32 v27, v74, v75
buffer_store_dwordx4 v[24:27], v18, s[32:35], s85 offen offset:1024
v_cvt_pk_bf16_f32 v28, v76, v77
v_cvt_pk_bf16_f32 v29, v78, v79
v_cvt_pk_bf16_f32 v30, v80, v81
v_cvt_pk_bf16_f32 v31, v82, v83
buffer_store_dwordx4 v[28:31], v18, s[32:35], s86 offen offset:0
v_cvt_pk_bf16_f32 v32, v84, v85
v_cvt_pk_bf16_f32 v33, v86, v87
v_cvt_pk_bf16_f32 v34, v88, v89
v_cvt_pk_bf16_f32 v35, v90, v91
buffer_store_dwordx4 v[32:35], v18, s[32:35], s86 offen offset:1024
s_barrier
v_dot2c_f32_bf16 v6, v20, v48
v_dot2c_f32_bf16 v8, v20, v20
v_dot2c_f32_bf16 v7, v28, v48
v_dot2c_f32_bf16 v9, v28, v28
v_dot2c_f32_bf16 v6, v21, v48
v_dot2c_f32_bf16 v8, v21, v21
v_dot2c_f32_bf16 v7, v29, v48
v_dot2c_f32_bf16 v9, v29, v29
v_dot2c_f32_bf16 v6, v22, v48
v_dot2c_f32_bf16 v8, v22, v22
v_dot2c_f32_bf16 v7, v30, v48
v_dot2c_f32_bf16 v9, v30, v30
v_dot2c_f32_bf16 v6, v23, v48
v_dot2c_f32_bf16 v8, v23, v23
v_dot2c_f32_bf16 v7, v31, v48
v_dot2c_f32_bf16 v9, v31, v31
v_dot2c_f32_bf16 v6, v24, v48
v_dot2c_f32_bf16 v8, v24, v24
v_dot2c_f32_bf16 v7, v32, v48
v_dot2c_f32_bf16 v9, v32, v32
v_dot2c_f32_bf16 v6, v25, v48
v_dot2c_f32_bf16 v8, v25, v25
v_dot2c_f32_bf16 v7, v33, v48
v_dot2c_f32_bf16 v9, v33, v33
v_dot2c_f32_bf16 v6, v26, v48
v_dot2c_f32_bf16 v8, v26, v26
v_dot2c_f32_bf16 v7, v34, v48
v_dot2c_f32_bf16 v9, v34, v34
v_dot2c_f32_bf16 v6, v27, v48
v_dot2c_f32_bf16 v8, v27, v27
v_dot2c_f32_bf16 v7, v35, v48
v_dot2c_f32_bf16 v9, v35, v35
s_mov_b64 exec, 1
s_waitcnt vmcnt(0)
buffer_store_dword v5, v4, s[32:35], s88 offen
s_mov_b64 exec, -1
s_nop 1
v_permlane32_swap_b32 v6, v7
v_permlane32_swap_b32 v8, v9
v_add_f32 v6, v6, v7
v_add_f32 v8, v8, v9
s_nop 1
v_permlane16_swap_b32 v6, v8
s_nop 0
v_add_f32 v6, v6, v8
buffer_store_dword v6, v1, s[32:35], s87 offen
back_94:
s_lshl_b32 s49, s44, 13
v_add_u32 v10, s49, v18
v_add_u32 v11, 1024, v10
s_lshl_b32 s48, s43, 1
v_lshrrev_b32 v4, 2, v2
v_and_b32 v5, 3, v0
v_lshl_add_u32 v6, v3, 3, v4
v_lshlrev_b32 v6, 7, v6
v_lshl_add_u32 v6, v5, 3, v6
v_lshrrev_b32 v7, 1, v4
v_and_b32 v8, 1, v3
v_lshl_add_u32 v7, v8, 1, v7
v_xor_b32 v7, s48, v7
v_lshl_add_u32 v12, v7, 5, v6
v_add_u32 v12, 16384, v12
v_xor_b32 v13, 32, v12
v_mov_b32 v14, v10
v_mov_b32 v15, v11
v_add_u32 v16, 122880, v12
v_add_u32 v17, 122880, v13
v_mov_b32 v156, 0
v_mov_b32 v157, 0
v_mov_b32 v158, 0
v_mov_b32 v159, 0
v_mov_b32 v160, 0
v_mov_b32 v161, 0
v_mov_b32 v162, 0
v_mov_b32 v163, 0
v_mov_b32 v164, 0
v_mov_b32 v165, 0
v_mov_b32 v166, 0
v_mov_b32 v167, 0
v_mov_b32 v168, 0
v_mov_b32 v169, 0
v_mov_b32 v170, 0
v_mov_b32 v171, 0
v_mov_b32 v172, 0
v_mov_b32 v173, 0
v_mov_b32 v174, 0
v_mov_b32 v175, 0
v_mov_b32 v176, 0
v_mov_b32 v177, 0
v_mov_b32 v178, 0
v_mov_b32 v179, 0
v_mov_b32 v180, 0
v_mov_b32 v181, 0
v_mov_b32 v182, 0
v_mov_b32 v183, 0
v_mov_b32 v184, 0
v_mov_b32 v185, 0
v_mov_b32 v186, 0
v_mov_b32 v187, 0
v_mov_b32 v188, 0
v_mov_b32 v189, 0
v_mov_b32 v190, 0
v_mov_b32 v191, 0
v_mov_b32 v192, 0
v_mov_b32 v193, 0
v_mov_b32 v194, 0
v_mov_b32 v195, 0
v_mov_b32 v196, 0
v_mov_b32 v197, 0
v_mov_b32 v198, 0
v_mov_b32 v199, 0
v_mov_b32 v200, 0
v_mov_b32 v201, 0
v_mov_b32 v202, 0
v_mov_b32 v203, 0
v_mov_b32 v204, 0
v_mov_b32 v205, 0
v_mov_b32 v206, 0
v_mov_b32 v207, 0
v_mov_b32 v208, 0
v_mov_b32 v209, 0
v_mov_b32 v210, 0
v_mov_b32 v211, 0
v_mov_b32 v212, 0
v_mov_b32 v213, 0
v_mov_b32 v214, 0
v_mov_b32 v215, 0
v_mov_b32 v216, 0
v_mov_b32 v217, 0
v_mov_b32 v218, 0
v_mov_b32 v219, 0
v_mov_b32 v220, 0
v_mov_b32 v221, 0
v_mov_b32 v222, 0
v_mov_b32 v223, 0
v_mov_b32 v224, 0
v_mov_b32 v225, 0
v_mov_b32 v226, 0
v_mov_b32 v227, 0
v_mov_b32 v228, 0
v_mov_b32 v229, 0
v_mov_b32 v230, 0
v_mov_b32 v231, 0
v_mov_b32 v232, 0
v_mov_b32 v233, 0
v_mov_b32 v234, 0
v_mov_b32 v235, 0
v_mov_b32 v236, 0
v_mov_b32 v237, 0
v_mov_b32 v238, 0
v_mov_b32 v239, 0
v_mov_b32 v240, 0
v_mov_b32 v241, 0
v_mov_b32 v242, 0
v_mov_b32 v243, 0
v_mov_b32 v244, 0
v_mov_b32 v245, 0
v_mov_b32 v246, 0
v_mov_b32 v247, 0
v_mov_b32 v248, 0
v_mov_b32 v249, 0
v_mov_b32 v250, 0
v_mov_b32 v251, 0
v_lshrrev_b32 v6, 2, v2
v_cmp_eq_u32 vcc, v6, v3
v_and_b32 v7, 1, v0
v_lshlrev_b32 v7, 4, v7
v_mov_b32 v8, 0x3f80
v_lshlrev_b32 v9, v7, v8
v_cndmask_b32 v7, 0, v9, vcc
v_and_b32 v6, 2, v0
v_cmp_eq_u32 vcc, 0, v6
v_mov_b32 v36, 0
v_mov_b32 v37, 0
v_mov_b32 v40, 0
v_mov_b32 v41, 0
v_cndmask_b32 v38, 0, v7, vcc
v_cndmask_b32 v39, v7, 0, vcc
v_lshrrev_b32 v8, 1, v2
v_cmp_eq_u32 vcc, 0, v8
s_nop 1
v_cndmask_b32 v44, 0, v9, vcc
v_cmp_eq_u32 vcc, 1, v8
s_nop 1
v_cndmask_b32 v45, 0, v9, vcc
v_cmp_eq_u32 vcc, 2, v8
s_nop 1
v_cndmask_b32 v46, 0, v9, vcc
v_cmp_eq_u32 vcc, 3, v8
s_nop 1
v_cndmask_b32 v47, 0, v9, vcc
v_lshrrev_b32 v4, 2, v2
v_lshl_add_u32 v4, v3, 2, v4
v_lshlrev_b32 v4, 6, v4
v_and_b32 v5, 3, v0
v_lshl_add_u32 v4, v5, 3, v4
s_lshl_b32 s48, s43, 11
s_add_u32 s48, s48, 135168
v_add_u32 v53, s48, v4
s_mul_i32 s48, s40, 3072
s_add_u32 s48, s48, 139264
v_add_u32 v42, s48, v18
s_xor_b32 s49, s40, 2
s_mul_i32 s48, s49, 3072
s_add_u32 s48, s48, 139264
v_add_u32 v43, s48, v18
s_lshl_b32 s49, s49, 2
s_add_u32 s49, s49, 134672
v_mov_b32 v19, s49
v_xor_b32 v52, 8, v19
v_lshrrev_b32 v4, 3, v0
v_and_b32 v5, 7, v0
v_lshlrev_b32 v4, 11, v4
v_lshl_add_u32 v55, v5, 4, v4
v_lshlrev_b32 v4, 6, v2
v_lshl_add_u32 v58, v3, 4, v4
v_lshlrev_b32 v4, 4, v2
v_lshl_add_u32 v59, v3, 3, v4
s_mul_i32 s51, s42, 393216
s_add_u32 s51, s51, 9437184
s_lshl_b32 s50, s43, 1
s_add_u32 s50, s50, s44
s_lshl_b32 s48, s50, 15
s_add_u32 s48, s48, s51
s_add_u32 s48, s48, 131072
s_lshl_b32 s49, s41, 7
s_add_u32 s53, s48, s49
s_add_u32 s54, s53, 16384
s_lshl_b32 s56, s50, 10
s_add_u32 s56, s56, s51
s_add_u32 s56, s56, 348160
s_xor_b32 s57, s56, 1024
s_lshl_b32 s58, s50, 11
s_add_u32 s58, s58, s51
s_add_u32 s58, s58, 335872
s_xor_b32 s59, s58, 2048
s_add_u32 s79, s58, s49
s_lshl_b32 s50, s41, 11
s_add_u32 s55, s48, s50
s_lshl_b32 s48, s43, 7
s_add_u32 s48, s48, 133888
v_lshl_add_u32 v7, v3, 4, s48
v_lshl_add_u32 v54, v2, 2, s48
s_lshl_b32 s49, s44, 6
v_add_u32 v8, s49, v2
v_lshlrev_b32 v8, 3, v8
v_add_u32 v8, 131072, v8
v_lshl_add_u32 v9, v3, 2, s49
v_lshlrev_b32 v9, 2, v9
v_add_u32 v9, 132096, v9
s_mov_b32 s64, 0
s_mov_b32 s65, 0
s_mov_b32 s66, 0x3fb8aa3b
s_barrier
ds_read_b128 v[60:63], v14 offset:0
ds_read_b128 v[64:67], v14 offset:2048
ds_read_b128 v[68:71], v14 offset:4096
ds_read_b128 v[72:75], v14 offset:6144
ds_read_b64_tr_b16 v[84:85], v16 offset:8192
ds_read_b64_tr_b16 v[86:87], v16 offset:8704
ds_read_b64_tr_b16 v[88:89], v17 offset:8192
ds_read_b64_tr_b16 v[90:91], v17 offset:8704
ds_read_b64_tr_b16 v[92:93], v16 offset:16384
ds_read_b64_tr_b16 v[94:95], v16 offset:16896
ds_read_b64_tr_b16 v[96:97], v17 offset:16384
ds_read_b64_tr_b16 v[98:99], v17 offset:16896
ds_read_b64_tr_b16 v[76:77], v16 offset:0
ds_read_b64_tr_b16 v[78:79], v16 offset:512
ds_read_b64_tr_b16 v[80:81], v17 offset:0
ds_read_b64_tr_b16 v[82:83], v17 offset:512
s_waitcnt lgkmcnt(0)
c3_loop:
v_mfma_f32_16x16x32_bf16 v[212:215], v[84:87], v[72:75], v[212:215]
ds_read_b128 v[100:103], v15 offset:0
v_mfma_f32_16x16x32_bf16 v[204:207], v[84:87], v[68:71], v[204:207]
ds_read_b128 v[104:107], v15 offset:2048
v_mfma_f32_16x16x32_bf16 v[196:199], v[84:87], v[64:67], v[196:199]
ds_read_b128 v[108:111], v15 offset:4096
v_mfma_f32_16x16x32_bf16 v[188:191], v[84:87], v[60:63], v[188:191]
ds_read_b128 v[112:115], v15 offset:6144
v_mfma_f32_16x16x32_bf16 v[192:195], v[88:91], v[60:63], v[192:195]
ds_read_b64_tr_b16 v[124:125], v16 offset:12288
v_mfma_f32_16x16x32_bf16 v[200:203], v[88:91], v[64:67], v[200:203]
ds_read_b64_tr_b16 v[126:127], v16 offset:12800
v_mfma_f32_16x16x32_bf16 v[208:211], v[88:91], v[68:71], v[208:211]
ds_read_b64_tr_b16 v[128:129], v17 offset:12288
v_mfma_f32_16x16x32_bf16 v[216:219], v[88:91], v[72:75], v[216:219]
ds_read_b64_tr_b16 v[130:131], v17 offset:12800
v_mfma_f32_16x16x32_bf16 v[244:247], v[72:75], v[92:95], v[244:247]
ds_read_b64_tr_b16 v[132:133], v16 offset:20480
v_mfma_f32_16x16x32_bf16 v[236:239], v[68:71], v[92:95], v[236:239]
ds_read_b64_tr_b16 v[134:135], v16 offset:20992
v_mfma_f32_16x16x32_bf16 v[228:231], v[64:67], v[92:95], v[228:231]
ds_read_b64_tr_b16 v[136:137], v17 offset:20480
v_mfma_f32_16x16x32_bf16 v[220:223], v[60:63], v[92:95], v[220:223]
ds_read_b64_tr_b16 v[138:139], v17 offset:20992
v_mfma_f32_16x16x32_bf16 v[224:227], v[60:63], v[96:99], v[224:227]
ds_read_b64_tr_b16 v[116:117], v16 offset:4096
v_mfma_f32_16x16x32_bf16 v[232:235], v[64:67], v[96:99], v[232:235]
ds_read_b64_tr_b16 v[118:119], v16 offset:4608
v_mfma_f32_16x16x32_bf16 v[240:243], v[68:71], v[96:99], v[240:243]
ds_read_b64_tr_b16 v[120:121], v17 offset:4096
v_mfma_f32_16x16x32_bf16 v[248:251], v[72:75], v[96:99], v[248:251]
ds_read_b64_tr_b16 v[122:123], v17 offset:4608
v_mfma_f32_16x16x32_bf16 v[180:183], v[76:79], v[72:75], v[180:183]
s_add_u32 s65, s65, 40960
s_cmp_eq_u32 s65, 122880
v_mfma_f32_16x16x32_bf16 v[172:175], v[76:79], v[68:71], v[172:175]
s_cselect_b32 s65, 0, s65
s_add_u32 s64, s64, 1
v_mfma_f32_16x16x32_bf16 v[164:167], v[76:79], v[64:67], v[164:167]
v_add_u32 v14, s65, v10
v_add_u32 v15, s65, v11
v_mfma_f32_16x16x32_bf16 v[156:159], v[76:79], v[60:63], v[156:159]
v_add_u32 v16, s65, v12
v_add_u32 v17, s65, v13
v_mfma_f32_16x16x32_bf16 v[160:163], v[80:83], v[60:63], v[160:163]
v_mfma_f32_16x16x32_bf16 v[168:171], v[80:83], v[64:67], v[168:171]
s_cmp_eq_u32 s64, 16
s_cbranch_scc1 c3_last
v_mfma_f32_16x16x32_bf16 v[176:179], v[80:83], v[68:71], v[176:179]
s_waitcnt lgkmcnt(0)
v_mfma_f32_16x16x32_bf16 v[184:187], v[80:83], v[72:75], v[184:187]
s_barrier
v_mfma_f32_16x16x32_bf16 v[212:215], v[124:127], v[112:115], v[212:215]
ds_read_b128 v[60:63], v14 offset:0
v_mfma_f32_16x16x32_bf16 v[204:207], v[124:127], v[108:111], v[204:207]
ds_read_b128 v[64:67], v14 offset:2048
v_mfma_f32_16x16x32_bf16 v[196:199], v[124:127], v[104:107], v[196:199]
ds_read_b128 v[68:71], v14 offset:4096
v_mfma_f32_16x16x32_bf16 v[188:191], v[124:127], v[100:103], v[188:191]
ds_read_b128 v[72:75], v14 offset:6144
v_mfma_f32_16x16x32_bf16 v[192:195], v[128:131], v[100:103], v[192:195]
ds_read_b64_tr_b16 v[84:85], v16 offset:8192
v_mfma_f32_16x16x32_bf16 v[200:203], v[128:131], v[104:107], v[200:203]
ds_read_b64_tr_b16 v[86:87], v16 offset:8704
v_mfma_f32_16x16x32_bf16 v[208:211], v[128:131], v[108:111], v[208:211]
ds_read_b64_tr_b16 v[88:89], v17 offset:8192
v_mfma_f32_16x16x32_bf16 v[216:219], v[128:131], v[112:115], v[216:219]
ds_read_b64_tr_b16 v[90:91], v17 offset:8704
v_mfma_f32_16x16x32_bf16 v[244:247], v[112:115], v[132:135], v[244:247]
ds_read_b64_tr_b16 v[92:93], v16 offset:16384
v_mfma_f32_16x16x32_bf16 v[236:239], v[108:111], v[132:135], v[236:239]
ds_read_b64_tr_b16 v[94:95], v16 offset:16896
v_mfma_f32_16x16x32_bf16 v[228:231], v[104:107], v[132:135], v[228:231]
ds_read_b64_tr_b16 v[96:97], v17 offset:16384
v_mfma_f32_16x16x32_bf16 v[220:223], v[100:103], v[132:135], v[220:223]
ds_read_b64_tr_b16 v[98:99], v17 offset:16896
v_mfma_f32_16x16x32_bf16 v[224:227], v[100:103], v[136:139], v[224:227]
ds_read_b64_tr_b16 v[76:77], v16 offset:0
v_mfma_f32_16x16x32_bf16 v[232:235], v[104:107], v[136:139], v[232:235]
ds_read_b64_tr_b16 v[78:79], v16 offset:512
v_mfma_f32_16x16x32_bf16 v[240:243], v[108:111], v[136:139], v[240:243]
ds_read_b64_tr_b16 v[80:81], v17 offset:0
v_mfma_f32_16x16x32_bf16 v[248:251], v[112:115], v[136:139], v[248:251]
ds_read_b64_tr_b16 v[82:83], v17 offset:512
v_mfma_f32_16x16x32_bf16 v[180:183], v[116:119], v[112:115], v[180:183]
v_mfma_f32_16x16x32_bf16 v[172:175], v[116:119], v[108:111], v[172:175]
v_mfma_f32_16x16x32_bf16 v[164:167], v[116:119], v[104:107], v[164:167]
v_mfma_f32_16x16x32_bf16 v[156:159], v[116:119], v[100:103], v[156:159]
v_mfma_f32_16x16x32_bf16 v[160:163], v[120:123], v[100:103], v[160:163]
v_mfma_f32_16x16x32_bf16 v[168:171], v[120:123], v[104:107], v[168:171]
v_mfma_f32_16x16x32_bf16 v[176:179], v[120:123], v[108:111], v[176:179]
s_waitcnt lgkmcnt(0)
v_mfma_f32_16x16x32_bf16 v[184:187], v[120:123], v[112:115], v[184:187]
s_branch c3_loop
c3_last:
v_mfma_f32_16x16x32_bf16 v[176:179], v[80:83], v[68:71], v[176:179]
s_waitcnt lgkmcnt(0)
v_mfma_f32_16x16x32_bf16 v[184:187], v[80:83], v[72:75], v[184:187]
s_barrier
v_mfma_f32_16x16x32_bf16 v[212:215], v[124:127], v[112:115], v[212:215]
ds_read_b128 v[140:143], v7 offset:0
v_mfma_f32_16x16x32_bf16 v[204:207], v[124:127], v[108:111], v[204:207]
ds_read_b128 v[144:147], v7 offset:64
v_mfma_f32_16x16x32_bf16 v[196:199], v[124:127], v[104:107], v[196:199]
ds_read_b128 v[148:151], v7 offset:256
v_mfma_f32_16x16x32_bf16 v[188:191], v[124:127], v[100:103], v[188:191]
ds_read_b128 v[152:155], v7 offset:320
v_mfma_f32_16x16x32_bf16 v[192:195], v[128:131], v[100:103], v[192:195]
ds_read_b64 v[92:93], v8 offset:0
v_mfma_f32_16x16x32_bf16 v[200:203], v[128:131], v[104:107], v[200:203]
ds_read_b64 v[94:95], v8 offset:128
v_mfma_f32_16x16x32_bf16 v[208:211], v[128:131], v[108:111], v[208:211]
ds_read_b64 v[96:97], v8 offset:256
v_mfma_f32_16x16x32_bf16 v[216:219], v[128:131], v[112:115], v[216:219]
ds_read_b64 v[98:99], v8 offset:384
v_mfma_f32_16x16x32_bf16 v[244:247], v[112:115], v[132:135], v[244:247]
ds_read2_b32 v[56:57], v54 offset0:128 offset1:144
v_mfma_f32_16x16x32_bf16 v[236:239], v[108:111], v[132:135], v[236:239]
ds_read_b128 v[60:63], v9 offset:0
v_mfma_f32_16x16x32_bf16 v[228:231], v[104:107], v[132:135], v[228:231]
ds_read_b128 v[64:67], v9 offset:64
v_mfma_f32_16x16x32_bf16 v[220:223], v[100:103], v[132:135], v[220:223]
ds_read_b128 v[68:71], v9 offset:128
v_mfma_f32_16x16x32_bf16 v[224:227], v[100:103], v[136:139], v[224:227]
ds_read_b128 v[72:75], v9 offset:192
v_mfma_f32_16x16x32_bf16 v[232:235], v[104:107], v[136:139], v[232:235]
ds_read_b128 v[76:79], v9 offset:512
v_mfma_f32_16x16x32_bf16 v[240:243], v[108:111], v[136:139], v[240:243]
ds_read_b128 v[80:83], v9 offset:576
v_mfma_f32_16x16x32_bf16 v[248:251], v[112:115], v[136:139], v[248:251]
ds_read_b128 v[84:87], v9 offset:640
v_mfma_f32_16x16x32_bf16 v[180:183], v[116:119], v[112:115], v[180:183]
ds_read_b128 v[88:91], v9 offset:704
v_mfma_f32_16x16x32_bf16 v[172:175], v[116:119], v[108:111], v[172:175]
ds_read_b64_tr_b16 v[10:11], v53 offset:0
v_mfma_f32_16x16x32_bf16 v[164:167], v[116:119], v[104:107], v[164:167]
ds_read_b64_tr_b16 v[12:13], v53 offset:1024
v_mfma_f32_16x16x32_bf16 v[156:159], v[116:119], v[100:103], v[156:159]
ds_read_b64_tr_b16 v[14:15], v53 offset:32
v_mfma_f32_16x16x32_bf16 v[160:163], v[120:123], v[100:103], v[160:163]
ds_read_b64_tr_b16 v[16:17], v53 offset:1056
v_mfma_f32_16x16x32_bf16 v[168:171], v[120:123], v[104:107], v[168:171]
v_mfma_f32_16x16x32_bf16 v[176:179], v[120:123], v[108:111], v[176:179]
v_mfma_f32_16x16x32_bf16 v[184:187], v[120:123], v[112:115], v[184:187]
c3_epi:
s_waitcnt lgkmcnt(0)
s_mul_i32 s48, s44, 0x80008000
v_xor_b32 v10, s48, v10
v_xor_b32 v11, s48, v11
v_xor_b32 v12, s48, v12
v_xor_b32 v13, s48, v13
v_xor_b32 v14, s48, v14
v_xor_b32 v15, s48, v15
v_xor_b32 v16, s48, v16
v_xor_b32 v17, s48, v17
v_mul_f32 v128, s66, v92
v_mul_f32 v129, s66, v94
v_mul_f32 v130, s66, v96
v_mul_f32 v131, s66, v98
.p2align 3
v_pk_fma_f32 v[220:221], v[76:77], v[56:57], v[220:221] op_sel:[0,0,0] op_sel_hi:[1,0,1]
v_pk_fma_f32 v[222:223], v[78:79], v[56:57], v[222:223] op_sel:[0,0,0] op_sel_hi:[1,0,1]
v_pk_mul_f32 v[220:221], v[220:221], v[60:61]
v_pk_mul_f32 v[222:223], v[222:223], v[62:63]
v_cvt_pk_bf16_f32 v112, v220, v221
v_cvt_pk_bf16_f32 v113, v222, v223
v_pk_fma_f32 v[228:229], v[80:81], v[56:57], v[228:229] op_sel:[0,0,0] op_sel_hi:[1,0,1]
v_pk_fma_f32 v[230:231], v[82:83], v[56:57], v[230:231] op_sel:[0,0,0] op_sel_hi:[1,0,1]
v_pk_mul_f32 v[228:229], v[228:229], v[64:65]
v_pk_mul_f32 v[230:231], v[230:231], v[66:67]
v_cvt_pk_bf16_f32 v114, v228, v229
v_cvt_pk_bf16_f32 v115, v230, v231
v_pk_fma_f32 v[236:237], v[84:85], v[56:57], v[236:237] op_sel:[0,0,0] op_sel_hi:[1,0,1]
v_pk_fma_f32 v[238:239], v[86:87], v[56:57], v[238:239] op_sel:[0,0,0] op_sel_hi:[1,0,1]
v_pk_mul_f32 v[236:237], v[236:237], v[68:69]
v_pk_mul_f32 v[238:239], v[238:239], v[70:71]
v_cvt_pk_bf16_f32 v116, v236, v237
v_cvt_pk_bf16_f32 v117, v238, v239
v_pk_fma_f32 v[244:245], v[88:89], v[56:57], v[244:245] op_sel:[0,0,0] op_sel_hi:[1,0,1]
v_pk_fma_f32 v[246:247], v[90:91], v[56:57], v[246:247] op_sel:[0,0,0] op_sel_hi:[1,0,1]
v_pk_mul_f32 v[244:245], v[244:245], v[72:73]
v_pk_mul_f32 v[246:247], v[246:247], v[74:75]
v_cvt_pk_bf16_f32 v118, v244, v245
v_cvt_pk_bf16_f32 v119, v246, v247
v_pk_fma_f32 v[224:225], v[76:77], v[56:57], v[224:225] op_sel:[0,1,0] op_sel_hi:[1,1,1]
v_pk_fma_f32 v[226:227], v[78:79], v[56:57], v[226:227] op_sel:[0,1,0] op_sel_hi:[1,1,1]
v_pk_mul_f32 v[224:225], v[224:225], v[60:61]
v_pk_mul_f32 v[226:227], v[226:227], v[62:63]
v_cvt_pk_bf16_f32 v120, v224, v225
v_cvt_pk_bf16_f32 v121, v226, v227
v_pk_fma_f32 v[232:233], v[80:81], v[56:57], v[232:233] op_sel:[0,1,0] op_sel_hi:[1,1,1]
v_pk_fma_f32 v[234:235], v[82:83], v[56:57], v[234:235] op_sel:[0,1,0] op_sel_hi:[1,1,1]
v_pk_mul_f32 v[232:233], v[232:233], v[64:65]
v_pk_mul_f32 v[234:235], v[234:235], v[66:67]
v_cvt_pk_bf16_f32 v122, v232, v233
v_cvt_pk_bf16_f32 v123, v234, v235
v_pk_fma_f32 v[240:241], v[84:85], v[56:57], v[240:241] op_sel:[0,1,0] op_sel_hi:[1,1,1]
v_pk_fma_f32 v[242:243], v[86:87], v[56:57], v[242:243] op_sel:[0,1,0] op_sel_hi:[1,1,1]
v_pk_mul_f32 v[240:241], v[240:241], v[68:69]
v_pk_mul_f32 v[242:243], v[242:243], v[70:71]
v_cvt_pk_bf16_f32 v124, v240, v241
v_cvt_pk_bf16_f32 v125, v242, v243
v_pk_fma_f32 v[248:249], v[88:89], v[56:57], v[248:249] op_sel:[0,1,0] op_sel_hi:[1,1,1]
v_pk_fma_f32 v[250:251], v[90:91], v[56:57], v[250:251] op_sel:[0,1,0] op_sel_hi:[1,1,1]
v_pk_mul_f32 v[248:249], v[248:249], v[72:73]
v_pk_mul_f32 v[250:251], v[250:251], v[74:75]
v_cvt_pk_bf16_f32 v126, v248, v249
v_cvt_pk_bf16_f32 v127, v250, v251
v_pk_fma_f32 v[188:189], v[148:149], v[92:93], v[188:189] op_sel:[0,1,0] op_sel_hi:[1,1,1]
v_pk_fma_f32 v[190:191], v[150:151], v[92:93], v[190:191] op_sel:[0,1,0] op_sel_hi:[1,1,1]
v_pk_fma_f32 v[192:193], v[152:153], v[92:93], v[192:193] op_sel:[0,1,0] op_sel_hi:[1,1,1]
v_pk_fma_f32 v[194:195], v[154:155], v[92:93], v[194:195] op_sel:[0,1,0] op_sel_hi:[1,1,1]
v_cvt_pk_bf16_f32 v188, v188, v189
v_cvt_pk_bf16_f32 v189, v190, v191
v_cvt_pk_bf16_f32 v190, v192, v193
v_cvt_pk_bf16_f32 v191, v194, v195
v_pk_fma_f32 v[196:197], v[148:149], v[94:95], v[196:197] op_sel:[0,1,0] op_sel_hi:[1,1,1]
v_pk_fma_f32 v[198:199], v[150:151], v[94:95], v[198:199] op_sel:[0,1,0] op_sel_hi:[1,1,1]
v_pk_fma_f32 v[200:201], v[152:153], v[94:95], v[200:201] op_sel:[0,1,0] op_sel_hi:[1,1,1]
v_pk_fma_f32 v[202:203], v[154:155], v[94:95], v[202:203] op_sel:[0,1,0] op_sel_hi:[1,1,1]
v_cvt_pk_bf16_f32 v196, v196, v197
v_mfma_f32_16x16x32_bf16 v[60:63], v[10:13], v[188:191], 0
v_cvt_pk_bf16_f32 v197, v198, v199
v_cvt_pk_bf16_f32 v198, v200, v201
v_mfma_f32_16x16x32_bf16 v[64:67], v[14:17], v[188:191], 0
v_cvt_pk_bf16_f32 v199, v202, v203
v_pk_fma_f32 v[204:205], v[148:149], v[96:97], v[204:205] op_sel:[0,1,0] op_sel_hi:[1,1,1]
v_pk_fma_f32 v[206:207], v[150:151], v[96:97], v[206:207] op_sel:[0,1,0] op_sel_hi:[1,1,1]
v_pk_fma_f32 v[208:209], v[152:153], v[96:97], v[208:209] op_sel:[0,1,0] op_sel_hi:[1,1,1]
v_pk_fma_f32 v[210:211], v[154:155], v[96:97], v[210:211] op_sel:[0,1,0] op_sel_hi:[1,1,1]
v_cvt_pk_bf16_f32 v204, v204, v205
v_mfma_f32_16x16x32_bf16 v[68:71], v[10:13], v[196:199], 0
v_cvt_pk_bf16_f32 v205, v206, v207
v_cvt_pk_bf16_f32 v206, v208, v209
v_mfma_f32_16x16x32_bf16 v[72:75], v[14:17], v[196:199], 0
v_cvt_pk_bf16_f32 v207, v210, v211
v_pk_fma_f32 v[212:213], v[148:149], v[98:99], v[212:213] op_sel:[0,1,0] op_sel_hi:[1,1,1]
v_pk_fma_f32 v[214:215], v[150:151], v[98:99], v[214:215] op_sel:[0,1,0] op_sel_hi:[1,1,1]
v_pk_fma_f32 v[216:217], v[152:153], v[98:99], v[216:217] op_sel:[0,1,0] op_sel_hi:[1,1,1]
v_pk_fma_f32 v[218:219], v[154:155], v[98:99], v[218:219] op_sel:[0,1,0] op_sel_hi:[1,1,1]
v_cvt_pk_bf16_f32 v212, v212, v213
v_mfma_f32_16x16x32_bf16 v[76:79], v[10:13], v[204:207], 0
v_cvt_pk_bf16_f32 v213, v214, v215
v_cvt_pk_bf16_f32 v214, v216, v217
v_mfma_f32_16x16x32_bf16 v[80:83], v[14:17], v[204:207], 0
v_cvt_pk_bf16_f32 v215, v218, v219
s_nop 1
v_mfma_f32_16x16x32_bf16 v[84:87], v[10:13], v[212:215], 0
v_mfma_f32_16x16x32_bf16 v[88:91], v[14:17], v[212:215], 0
v_max3_f32 v100, v60, v61, v62
v_min3_f32 v104, v60, v61, v62
v_max3_f32 v100, v100, v63, v64
v_min3_f32 v104, v104, v63, v64
v_max3_f32 v100, v100, v65, v66
v_min3_f32 v104, v104, v65, v66
v_max_f32 v100, v100, v67
v_min_f32 v104, v104, v67
v_max3_f32 v101, v68, v69, v70
v_min3_f32 v105, v68, v69, v70
v_max3_f32 v101, v101, v71, v72
v_min3_f32 v105, v105, v71, v72
v_max3_f32 v101, v101, v73, v74
v_min3_f32 v105, v105, v73, v74
v_max_f32 v101, v101, v75
v_min_f32 v105, v105, v75
v_max3_f32 v102, v76, v77, v78
v_min3_f32 v106, v76, v77, v78
v_max3_f32 v102, v102, v79, v80
v_min3_f32 v106, v106, v79, v80
v_max3_f32 v102, v102, v81, v82
v_min3_f32 v106, v106, v81, v82
v_max_f32 v102, v102, v83
v_min_f32 v106, v106, v83
v_max3_f32 v103, v84, v85, v86
v_min3_f32 v107, v84, v85, v86
v_max3_f32 v103, v103, v87, v88
v_min3_f32 v107, v107, v87, v88
v_max3_f32 v103, v103, v89, v90
v_min3_f32 v107, v107, v89, v90
v_max_f32 v103, v103, v91
v_min_f32 v107, v107, v91
s_nop 1
v_permlane32_swap_b32 v100, v101
v_permlane32_swap_b32 v102, v103
v_permlane32_swap_b32 v104, v105
v_permlane32_swap_b32 v106, v107
v_max_f32 v100, v100, v101
v_max_f32 v102, v102, v103
v_min_f32 v104, v104, v105
v_min_f32 v106, v106, v107
v_permlane16_swap_b32 v100, v102
s_nop 0
v_permlane16_swap_b32 v104, v106
v_max_f32 v100, v100, v102
v_min_f32 v104, v104, v106
v_mov_b32 v102, v100
v_mov_b32 v106, v104
s_nop 0
v_permlane16_swap_b32 v100, v102
v_permlane16_swap_b32 v104, v106
v_mov_b32 v101, v100
v_mov_b32 v103, v102
v_mov_b32 v105, v104
v_mov_b32 v107, v106
v_permlane32_swap_b32 v100, v101
v_permlane32_swap_b32 v102, v103
v_permlane32_swap_b32 v104, v105
v_permlane32_swap_b32 v106, v107
v_pk_mul_f32 v[100:101], v[100:101], v[128:129]
v_pk_mul_f32 v[102:103], v[102:103], v[130:131]
v_pk_mul_f32 v[104:105], v[104:105], v[128:129]
v_pk_mul_f32 v[106:107], v[106:107], v[130:131]
v_pk_fma_f32 v[220:221], v[60:61], v[128:129], v[104:105] op_sel:[0,0,0] op_sel_hi:[1,0,0] neg_lo:[1,0,0] neg_hi:[1,0,0]
v_pk_fma_f32 v[60:61], v[60:61], v[128:129], v[100:101] op_sel:[0,0,0] op_sel_hi:[1,0,0] neg_lo:[0,0,1] neg_hi:[0,0,1]
v_exp_f32 v220, v220
v_exp_f32 v60, v60
v_exp_f32 v221, v221
v_exp_f32 v61, v61
v_pk_fma_f32 v[222:223], v[62:63], v[128:129], v[104:105] op_sel:[0,0,0] op_sel_hi:[1,0,0] neg_lo:[1,0,0] neg_hi:[1,0,0]
v_pk_fma_f32 v[62:63], v[62:63], v[128:129], v[100:101] op_sel:[0,0,0] op_sel_hi:[1,0,0] neg_lo:[0,0,1] neg_hi:[0,0,1]
v_exp_f32 v222, v222
v_exp_f32 v62, v62
v_exp_f32 v223, v223
v_exp_f32 v63, v63
v_pk_fma_f32 v[224:225], v[64:65], v[128:129], v[104:105] op_sel:[0,0,0] op_sel_hi:[1,0,0] neg_lo:[1,0,0] neg_hi:[1,0,0]
v_pk_fma_f32 v[64:65], v[64:65], v[128:129], v[100:101] op_sel:[0,0,0] op_sel_hi:[1,0,0] neg_lo:[0,0,1] neg_hi:[0,0,1]
v_exp_f32 v224, v224
v_exp_f32 v64, v64
v_exp_f32 v225, v225
v_exp_f32 v65, v65
v_pk_fma_f32 v[226:227], v[66:67], v[128:129], v[104:105] op_sel:[0,0,0] op_sel_hi:[1,0,0] neg_lo:[1,0,0] neg_hi:[1,0,0]
v_pk_fma_f32 v[66:67], v[66:67], v[128:129], v[100:101] op_sel:[0,0,0] op_sel_hi:[1,0,0] neg_lo:[0,0,1] neg_hi:[0,0,1]
v_exp_f32 v226, v226
v_exp_f32 v66, v66
v_exp_f32 v227, v227
v_exp_f32 v67, v67
v_pk_fma_f32 v[228:229], v[68:69], v[128:129], v[104:105] op_sel:[0,1,1] op_sel_hi:[1,1,1] neg_lo:[1,0,0] neg_hi:[1,0,0]
v_pk_fma_f32 v[68:69], v[68:69], v[128:129], v[100:101] op_sel:[0,1,1] op_sel_hi:[1,1,1] neg_lo:[0,0,1] neg_hi:[0,0,1]
v_exp_f32 v228, v228
v_exp_f32 v68, v68
v_exp_f32 v229, v229
v_exp_f32 v69, v69
v_pk_fma_f32 v[230:231], v[70:71], v[128:129], v[104:105] op_sel:[0,1,1] op_sel_hi:[1,1,1] neg_lo:[1,0,0] neg_hi:[1,0,0]
v_pk_fma_f32 v[70:71], v[70:71], v[128:129], v[100:101] op_sel:[0,1,1] op_sel_hi:[1,1,1] neg_lo:[0,0,1] neg_hi:[0,0,1]
v_exp_f32 v230, v230
v_exp_f32 v70, v70
v_exp_f32 v231, v231
v_exp_f32 v71, v71
v_pk_fma_f32 v[232:233], v[72:73], v[128:129], v[104:105] op_sel:[0,1,1] op_sel_hi:[1,1,1] neg_lo:[1,0,0] neg_hi:[1,0,0]
v_pk_fma_f32 v[72:73], v[72:73], v[128:129], v[100:101] op_sel:[0,1,1] op_sel_hi:[1,1,1] neg_lo:[0,0,1] neg_hi:[0,0,1]
v_exp_f32 v232, v232
v_exp_f32 v72, v72
v_exp_f32 v233, v233
v_exp_f32 v73, v73
v_pk_fma_f32 v[234:235], v[74:75], v[128:129], v[104:105] op_sel:[0,1,1] op_sel_hi:[1,1,1] neg_lo:[1,0,0] neg_hi:[1,0,0]
v_pk_fma_f32 v[74:75], v[74:75], v[128:129], v[100:101] op_sel:[0,1,1] op_sel_hi:[1,1,1] neg_lo:[0,0,1] neg_hi:[0,0,1]
v_exp_f32 v234, v234
v_exp_f32 v74, v74
v_exp_f32 v235, v235
v_exp_f32 v75, v75
v_pk_fma_f32 v[236:237], v[76:77], v[130:131], v[106:107] op_sel:[0,0,0] op_sel_hi:[1,0,0] neg_lo:[1,0,0] neg_hi:[1,0,0]
v_pk_fma_f32 v[76:77], v[76:77], v[130:131], v[102:103] op_sel:[0,0,0] op_sel_hi:[1,0,0] neg_lo:[0,0,1] neg_hi:[0,0,1]
v_exp_f32 v236, v236
v_exp_f32 v76, v76
v_exp_f32 v237, v237
v_exp_f32 v77, v77
v_pk_fma_f32 v[238:239], v[78:79], v[130:131], v[106:107] op_sel:[0,0,0] op_sel_hi:[1,0,0] neg_lo:[1,0,0] neg_hi:[1,0,0]
v_pk_fma_f32 v[78:79], v[78:79], v[130:131], v[102:103] op_sel:[0,0,0] op_sel_hi:[1,0,0] neg_lo:[0,0,1] neg_hi:[0,0,1]
v_exp_f32 v238, v238
v_exp_f32 v78, v78
v_exp_f32 v239, v239
v_exp_f32 v79, v79
v_pk_fma_f32 v[240:241], v[80:81], v[130:131], v[106:107] op_sel:[0,0,0] op_sel_hi:[1,0,0] neg_lo:[1,0,0] neg_hi:[1,0,0]
v_pk_fma_f32 v[80:81], v[80:81], v[130:131], v[102:103] op_sel:[0,0,0] op_sel_hi:[1,0,0] neg_lo:[0,0,1] neg_hi:[0,0,1]
v_exp_f32 v240, v240
v_exp_f32 v80, v80
v_exp_f32 v241, v241
v_exp_f32 v81, v81
v_pk_fma_f32 v[242:243], v[82:83], v[130:131], v[106:107] op_sel:[0,0,0] op_sel_hi:[1,0,0] neg_lo:[1,0,0] neg_hi:[1,0,0]
v_pk_fma_f32 v[82:83], v[82:83], v[130:131], v[102:103] op_sel:[0,0,0] op_sel_hi:[1,0,0] neg_lo:[0,0,1] neg_hi:[0,0,1]
v_exp_f32 v242, v242
v_exp_f32 v82, v82
v_exp_f32 v243, v243
v_exp_f32 v83, v83
v_pk_fma_f32 v[244:245], v[84:85], v[130:131], v[106:107] op_sel:[0,1,1] op_sel_hi:[1,1,1] neg_lo:[1,0,0] neg_hi:[1,0,0]
v_pk_fma_f32 v[84:85], v[84:85], v[130:131], v[102:103] op_sel:[0,1,1] op_sel_hi:[1,1,1] neg_lo:[0,0,1] neg_hi:[0,0,1]
v_exp_f32 v244, v244
v_exp_f32 v84, v84
v_exp_f32 v245, v245
v_exp_f32 v85, v85
v_pk_fma_f32 v[246:247], v[86:87], v[130:131], v[106:107] op_sel:[0,1,1] op_sel_hi:[1,1,1] neg_lo:[1,0,0] neg_hi:[1,0,0]
v_pk_fma_f32 v[86:87], v[86:87], v[130:131], v[102:103] op_sel:[0,1,1] op_sel_hi:[1,1,1] neg_lo:[0,0,1] neg_hi:[0,0,1]
v_exp_f32 v246, v246
v_exp_f32 v86, v86
v_exp_f32 v247, v247
v_exp_f32 v87, v87
v_pk_fma_f32 v[248:249], v[88:89], v[130:131], v[106:107] op_sel:[0,1,1] op_sel_hi:[1,1,1] neg_lo:[1,0,0] neg_hi:[1,0,0]
v_pk_fma_f32 v[88:89], v[88:89], v[130:131], v[102:103] op_sel:[0,1,1] op_sel_hi:[1,1,1] neg_lo:[0,0,1] neg_hi:[0,0,1]
v_exp_f32 v248, v248
v_exp_f32 v88, v88
v_exp_f32 v249, v249
v_exp_f32 v89, v89
v_pk_fma_f32 v[250:251], v[90:91], v[130:131], v[106:107] op_sel:[0,1,1] op_sel_hi:[1,1,1] neg_lo:[1,0,0] neg_hi:[1,0,0]
v_pk_fma_f32 v[90:91], v[90:91], v[130:131], v[102:103] op_sel:[0,1,1] op_sel_hi:[1,1,1] neg_lo:[0,0,1] neg_hi:[0,0,1]
v_exp_f32 v250, v250
v_exp_f32 v90, v90
v_exp_f32 v251, v251
v_exp_f32 v91, v91
v_pk_add_f32 v[108:109], v[60:61], v[62:63]
v_pk_add_f32 v[110:111], v[220:221], v[222:223]
v_pk_add_f32 v[108:109], v[108:109], v[64:65]
v_pk_add_f32 v[110:111], v[110:111], v[224:225]
v_pk_add_f32 v[108:109], v[108:109], v[66:67]
v_pk_add_f32 v[110:111], v[110:111], v[226:227]
v_add_f32 v100, v108, v109
v_add_f32 v104, v110, v111
v_pk_add_f32 v[108:109], v[68:69], v[70:71]
v_pk_add_f32 v[110:111], v[228:229], v[230:231]
v_pk_add_f32 v[108:109], v[108:109], v[72:73]
v_pk_add_f32 v[110:111], v[110:111], v[232:233]
v_pk_add_f32 v[108:109], v[108:109], v[74:75]
v_pk_add_f32 v[110:111], v[110:111], v[234:235]
v_add_f32 v101, v108, v109
v_add_f32 v105, v110, v111
v_pk_add_f32 v[108:109], v[76:77], v[78:79]
v_pk_add_f32 v[110:111], v[236:237], v[238:239]
v_pk_add_f32 v[108:109], v[108:109], v[80:81]
v_pk_add_f32 v[110:111], v[110:111], v[240:241]
v_pk_add_f32 v[108:109], v[108:109], v[82:83]
v_pk_add_f32 v[110:111], v[110:111], v[242:243]
v_add_f32 v102, v108, v109
v_add_f32 v106, v110, v111
v_pk_add_f32 v[108:109], v[84:85], v[86:87]
v_pk_add_f32 v[110:111], v[244:245], v[246:247]
v_pk_add_f32 v[108:109], v[108:109], v[88:89]
v_pk_add_f32 v[110:111], v[110:111], v[248:249]
v_pk_add_f32 v[108:109], v[108:109], v[90:91]
v_pk_add_f32 v[110:111], v[110:111], v[250:251]
v_add_f32 v103, v108, v109
v_add_f32 v107, v110, v111
s_nop 1
v_permlane32_swap_b32 v100, v101
v_permlane32_swap_b32 v102, v103
v_permlane32_swap_b32 v104, v105
v_permlane32_swap_b32 v106, v107
v_add_f32 v100, v100, v101
v_add_f32 v102, v102, v103
v_add_f32 v104, v104, v105
v_add_f32 v106, v106, v107
v_permlane16_swap_b32 v100, v102
s_nop 0
v_permlane16_swap_b32 v104, v106
v_add_f32 v100, v100, v102
v_add_f32 v104, v104, v106
v_rcp_f32 v100, v100
v_rcp_f32 v104, v104
s_nop 0
v_mov_b32 v102, v100
v_mov_b32 v106, v104
s_nop 0
v_permlane16_swap_b32 v100, v102
v_permlane16_swap_b32 v104, v106
v_mov_b32 v101, v100
v_mov_b32 v103, v102
v_mov_b32 v105, v104
v_mov_b32 v107, v106
v_permlane32_swap_b32 v100, v101
v_permlane32_swap_b32 v102, v103
v_permlane32_swap_b32 v104, v105
v_permlane32_swap_b32 v106, v107
.p2align 3
v_pk_mul_f32 v[60:61], v[60:61], v[100:101] op_sel:[0,0] op_sel_hi:[1,0]
v_pk_mul_f32 v[62:63], v[62:63], v[100:101] op_sel:[0,0] op_sel_hi:[1,0]
v_pk_mul_f32 v[64:65], v[64:65], v[100:101] op_sel:[0,0] op_sel_hi:[1,0]
v_pk_mul_f32 v[66:67], v[66:67], v[100:101] op_sel:[0,0] op_sel_hi:[1,0]
v_pk_mul_f32 v[220:221], v[220:221], v[104:105] op_sel:[0,0] op_sel_hi:[1,0]
v_pk_mul_f32 v[222:223], v[222:223], v[104:105] op_sel:[0,0] op_sel_hi:[1,0]
v_pk_mul_f32 v[224:225], v[224:225], v[104:105] op_sel:[0,0] op_sel_hi:[1,0]
v_pk_mul_f32 v[226:227], v[226:227], v[104:105] op_sel:[0,0] op_sel_hi:[1,0]
v_cvt_pk_bf16_f32 v60, v60, v61
v_cvt_pk_bf16_f32 v61, v62, v63
v_cvt_pk_bf16_f32 v62, v64, v65
v_cvt_pk_bf16_f32 v63, v66, v67
v_cvt_pk_bf16_f32 v220, v220, v221
v_cvt_pk_bf16_f32 v221, v222, v223
v_cvt_pk_bf16_f32 v222, v224, v225
v_cvt_pk_bf16_f32 v223, v226, v227
v_pk_mul_f32 v[68:69], v[68:69], v[100:101] op_sel:[0,1] op_sel_hi:[1,1]
v_pk_mul_f32 v[70:71], v[70:71], v[100:101] op_sel:[0,1] op_sel_hi:[1,1]
v_pk_mul_f32 v[72:73], v[72:73], v[100:101] op_sel:[0,1] op_sel_hi:[1,1]
v_pk_mul_f32 v[74:75], v[74:75], v[100:101] op_sel:[0,1] op_sel_hi:[1,1]
v_pk_mul_f32 v[228:229], v[228:229], v[104:105] op_sel:[0,1] op_sel_hi:[1,1]
v_pk_mul_f32 v[230:231], v[230:231], v[104:105] op_sel:[0,1] op_sel_hi:[1,1]
v_pk_mul_f32 v[232:233], v[232:233], v[104:105] op_sel:[0,1] op_sel_hi:[1,1]
v_pk_mul_f32 v[234:235], v[234:235], v[104:105] op_sel:[0,1] op_sel_hi:[1,1]
v_cvt_pk_bf16_f32 v68, v68, v69
v_mfma_f32_16x16x32_bf16 v[204:207], v[60:63], v[38:41], 0
v_cvt_pk_bf16_f32 v69, v70, v71
v_cvt_pk_bf16_f32 v70, v72, v73
v_mfma_f32_16x16x32_bf16 v[208:211], v[60:63], v[36:39], 0
v_cvt_pk_bf16_f32 v71, v74, v75
v_cvt_pk_bf16_f32 v228, v228, v229
v_mfma_f32_16x16x32_bf16 v[212:215], v[220:223], v[38:41], 0
v_cvt_pk_bf16_f32 v229, v230, v231
v_cvt_pk_bf16_f32 v230, v232, v233
v_mfma_f32_16x16x32_bf16 v[216:219], v[220:223], v[36:39], 0
v_cvt_pk_bf16_f32 v231, v234, v235
v_pk_mul_f32 v[76:77], v[76:77], v[102:103] op_sel:[0,0] op_sel_hi:[1,0]
v_pk_mul_f32 v[78:79], v[78:79], v[102:103] op_sel:[0,0] op_sel_hi:[1,0]
v_pk_mul_f32 v[80:81], v[80:81], v[102:103] op_sel:[0,0] op_sel_hi:[1,0]
v_pk_mul_f32 v[82:83], v[82:83], v[102:103] op_sel:[0,0] op_sel_hi:[1,0]
v_pk_mul_f32 v[236:237], v[236:237], v[106:107] op_sel:[0,0] op_sel_hi:[1,0]
v_pk_mul_f32 v[238:239], v[238:239], v[106:107] op_sel:[0,0] op_sel_hi:[1,0]
v_pk_mul_f32 v[240:241], v[240:241], v[106:107] op_sel:[0,0] op_sel_hi:[1,0]
v_pk_mul_f32 v[242:243], v[242:243], v[106:107] op_sel:[0,0] op_sel_hi:[1,0]
v_cvt_pk_bf16_f32 v76, v76, v77
v_mfma_f32_16x16x32_bf16 v[188:191], v[68:71], v[38:41], 0
v_mfma_f32_16x16x32_bf16 v[192:195], v[68:71], v[36:39], 0
v_cvt_pk_bf16_f32 v77, v78, v79
v_mfma_f32_16x16x32_bf16 v[196:199], v[228:231], v[38:41], 0
v_cvt_pk_bf16_f32 v78, v80, v81
v_mfma_f32_16x16x32_bf16 v[200:203], v[228:231], v[36:39], 0
v_cvt_pk_bf16_f32 v64, v204, v205
v_cvt_pk_bf16_f32 v79, v82, v83
v_cvt_pk_bf16_f32 v65, v206, v207
v_cvt_pk_bf16_f32 v236, v236, v237
v_cvt_pk_bf16_f32 v72, v208, v209
v_cvt_pk_bf16_f32 v73, v210, v211
v_cvt_pk_bf16_f32 v237, v238, v239
v_cvt_pk_bf16_f32 v224, v212, v213
v_cvt_pk_bf16_f32 v238, v240, v241
v_cvt_pk_bf16_f32 v225, v214, v215
v_cvt_pk_bf16_f32 v232, v216, v217
v_cvt_pk_bf16_f32 v239, v242, v243
v_cvt_pk_bf16_f32 v233, v218, v219
v_pk_mul_f32 v[84:85], v[84:85], v[102:103] op_sel:[0,1] op_sel_hi:[1,1]
v_pk_mul_f32 v[86:87], v[86:87], v[102:103] op_sel:[0,1] op_sel_hi:[1,1]
v_pk_mul_f32 v[88:89], v[88:89], v[102:103] op_sel:[0,1] op_sel_hi:[1,1]
v_pk_mul_f32 v[90:91], v[90:91], v[102:103] op_sel:[0,1] op_sel_hi:[1,1]
v_pk_mul_f32 v[244:245], v[244:245], v[106:107] op_sel:[0,1] op_sel_hi:[1,1]
v_pk_mul_f32 v[246:247], v[246:247], v[106:107] op_sel:[0,1] op_sel_hi:[1,1]
v_pk_mul_f32 v[248:249], v[248:249], v[106:107] op_sel:[0,1] op_sel_hi:[1,1]
v_pk_mul_f32 v[250:251], v[250:251], v[106:107] op_sel:[0,1] op_sel_hi:[1,1]
v_cvt_pk_bf16_f32 v84, v84, v85
v_mfma_f32_16x16x32_bf16 v[204:207], v[76:79], v[38:41], 0
v_mfma_f32_16x16x32_bf16 v[208:211], v[76:79], v[36:39], 0
v_cvt_pk_bf16_f32 v85, v86, v87
v_mfma_f32_16x16x32_bf16 v[212:215], v[236:239], v[38:41], 0
v_cvt_pk_bf16_f32 v86, v88, v89
v_mfma_f32_16x16x32_bf16 v[216:219], v[236:239], v[36:39], 0
v_cvt_pk_bf16_f32 v66, v188, v189
v_cvt_pk_bf16_f32 v87, v90, v91
v_cvt_pk_bf16_f32 v67, v190, v191
v_cvt_pk_bf16_f32 v244, v244, v245
v_cvt_pk_bf16_f32 v74, v192, v193
v_cvt_pk_bf16_f32 v75, v194, v195
v_cvt_pk_bf16_f32 v245, v246, v247
v_cvt_pk_bf16_f32 v226, v196, v197
v_cvt_pk_bf16_f32 v246, v248, v249
v_cvt_pk_bf16_f32 v227, v198, v199
v_cvt_pk_bf16_f32 v234, v200, v201
v_cvt_pk_bf16_f32 v247, v250, v251
v_cvt_pk_bf16_f32 v235, v202, v203
v_mov_b32 v5, 4
v_cmp_eq_u32 s[50:51], s41, v2
v_mfma_f32_16x16x32_bf16 v[188:191], v[84:87], v[38:41], 0
v_mfma_f32_16x16x32_bf16 v[192:195], v[84:87], v[36:39], 0
v_mfma_f32_16x16x32_bf16 v[196:199], v[244:247], v[38:41], 0
v_mfma_f32_16x16x32_bf16 v[200:203], v[244:247], v[36:39], 0
v_mfma_f32_16x16x32_bf16 v[152:155], v[224:227], v[112:115], 0
v_cvt_pk_bf16_f32 v80, v204, v205
v_cvt_pk_bf16_f32 v81, v206, v207
v_mfma_f32_16x16x32_bf16 v[60:63], v[232:235], v[112:115], 0
v_cvt_pk_bf16_f32 v88, v208, v209
v_mfma_f32_16x16x32_bf16 v[68:71], v[224:227], v[120:123], 0
v_cvt_pk_bf16_f32 v89, v210, v211
v_mfma_f32_16x16x32_bf16 v[220:223], v[232:235], v[120:123], 0
v_cvt_pk_bf16_f32 v240, v212, v213
v_cvt_pk_bf16_f32 v241, v214, v215
v_mfma_f32_16x16x32_bf16 v[228:231], v[224:227], v[48:51], 0
v_cvt_pk_bf16_f32 v248, v216, v217
v_mfma_f32_16x16x32_bf16 v[76:79], v[232:235], v[48:51], 0
v_cvt_pk_bf16_f32 v249, v218, v219
v_mfma_f32_16x16x32_bf16 v[100:103], v[64:67], v[112:115], 0
v_cvt_pk_bf16_f32 v82, v188, v189
v_cvt_pk_bf16_f32 v83, v190, v191
v_mfma_f32_16x16x32_bf16 v[104:107], v[72:75], v[112:115], 0
v_cvt_pk_bf16_f32 v90, v192, v193
v_mfma_f32_16x16x32_bf16 v[108:111], v[64:67], v[120:123], 0
v_cvt_pk_bf16_f32 v91, v194, v195
v_mfma_f32_16x16x32_bf16 v[132:135], v[72:75], v[120:123], 0
v_cvt_pk_bf16_f32 v242, v196, v197
v_cvt_pk_bf16_f32 v243, v198, v199
v_mfma_f32_16x16x32_bf16 v[136:139], v[64:67], v[48:51], 0
v_cvt_pk_bf16_f32 v250, v200, v201
v_mfma_f32_16x16x32_bf16 v[148:151], v[72:75], v[48:51], 0
v_cvt_pk_bf16_f32 v251, v202, v203
s_nop 1
v_mfma_f32_16x16x32_bf16 v[152:155], v[240:243], v[116:119], v[152:155]
v_mfma_f32_16x16x32_bf16 v[60:63], v[248:251], v[116:119], v[60:63]
v_mfma_f32_16x16x32_bf16 v[68:71], v[240:243], v[124:127], v[68:71]
v_mfma_f32_16x16x32_bf16 v[220:223], v[248:251], v[124:127], v[220:223]
v_mfma_f32_16x16x32_bf16 v[228:231], v[240:243], v[48:51], v[228:231]
v_mfma_f32_16x16x32_bf16 v[76:79], v[248:251], v[48:51], v[76:79]
v_mfma_f32_16x16x32_bf16 v[100:103], v[80:83], v[116:119], v[100:103]
v_mfma_f32_16x16x32_bf16 v[104:107], v[88:91], v[116:119], v[104:107]
v_mfma_f32_16x16x32_bf16 v[108:111], v[80:83], v[124:127], v[108:111]
v_mfma_f32_16x16x32_bf16 v[132:135], v[88:91], v[124:127], v[132:135]
v_cvt_pk_bf16_f32 v152, v152, v153
v_cvt_pk_bf16_f32 v153, v154, v155
v_mfma_f32_16x16x32_bf16 v[136:139], v[80:83], v[48:51], v[136:139]
v_cvt_pk_bf16_f32 v154, v60, v61
v_cvt_pk_bf16_f32 v155, v62, v63
v_mfma_f32_16x16x32_bf16 v[148:151], v[88:91], v[48:51], v[148:151]
ds_write_b128 v42, v[152:155] offset:0
v_cvt_pk_bf16_f32 v68, v68, v69
v_cvt_pk_bf16_f32 v69, v70, v71
v_cvt_pk_bf16_f32 v70, v220, v221
v_cvt_pk_bf16_f32 v71, v222, v223
ds_write_b128 v42, v[68:71] offset:1024
v_cvt_pk_bf16_f32 v228, v228, v229
v_cvt_pk_bf16_f32 v229, v230, v231
v_cvt_pk_bf16_f32 v230, v76, v77
v_cvt_pk_bf16_f32 v231, v78, v79
ds_write_b128 v42, v[228:231] offset:2048
ds_write_b32 v52, v5
s_mov_b32 s63, 0
px_95:
ds_read_b32 v4, v19
ds_read_b128 v[188:191], v43 offset:0
ds_read_b128 v[192:195], v43 offset:1024
ds_read_b128 v[196:199], v43 offset:2048
s_add_u32 s63, s63, 1
s_cmp_lt_u32 s63, 0x400000
s_waitcnt lgkmcnt(0)
v_cmp_ne_u32 vcc, 4, v4
s_cbranch_vccz pxd_96
s_cbranch_scc1 px_95
pxd_96:
v_mfma_f32_16x16x32_bf16 v[100:103], v[38:41], v[188:191], v[100:103]
v_mfma_f32_16x16x32_bf16 v[104:107], v[36:39], v[188:191], v[104:107]
v_mfma_f32_16x16x32_bf16 v[108:111], v[38:41], v[192:195], v[108:111]
v_mfma_f32_16x16x32_bf16 v[132:135], v[36:39], v[192:195], v[132:135]
v_mfma_f32_16x16x32_bf16 v[136:139], v[38:41], v[196:199], v[136:139]
v_mfma_f32_16x16x32_bf16 v[148:151], v[36:39], v[196:199], v[148:151]
s_nop 2
v_cvt_pk_bf16_f32 v100, v100, v101
v_cvt_pk_bf16_f32 v101, v102, v103
v_cvt_pk_bf16_f32 v102, v104, v105
v_cvt_pk_bf16_f32 v103, v106, v107
buffer_store_dwordx4 v[100:103], v55, s[32:35], s53 offen sc1
v_cvt_pk_bf16_f32 v108, v108, v109
v_cvt_pk_bf16_f32 v109, v110, v111
v_cvt_pk_bf16_f32 v110, v132, v133
v_cvt_pk_bf16_f32 v111, v134, v135
buffer_store_dwordx4 v[108:111], v55, s[32:35], s54 offen sc1
v_cvt_pk_bf16_f32 v136, v136, v137
v_cvt_pk_bf16_f32 v137, v138, v139
v_cvt_pk_bf16_f32 v138, v148, v149
v_cvt_pk_bf16_f32 v139, v150, v151
s_mov_b64 exec, s[50:51]
buffer_store_dwordx4 v[136:139], v58, s[32:35], s56 offen sc1
s_mov_b64 exec, -1
s_mov_b32 s51, 0
.p2align 3
v_pk_fma_f32 v[156:157], v[140:141], v[92:93], v[156:157] op_sel:[0,1,0] op_sel_hi:[1,1,1]
v_pk_fma_f32 v[158:159], v[142:143], v[92:93], v[158:159] op_sel:[0,1,0] op_sel_hi:[1,1,1]
v_pk_fma_f32 v[160:161], v[144:145], v[92:93], v[160:161] op_sel:[0,1,0] op_sel_hi:[1,1,1]
v_pk_fma_f32 v[162:163], v[146:147], v[92:93], v[162:163] op_sel:[0,1,0] op_sel_hi:[1,1,1]
v_cvt_pk_bf16_f32 v156, v156, v157
v_cvt_pk_bf16_f32 v157, v158, v159
v_cvt_pk_bf16_f32 v158, v160, v161
v_cvt_pk_bf16_f32 v159, v162, v163
v_pk_fma_f32 v[164:165], v[140:141], v[94:95], v[164:165] op_sel:[0,1,0] op_sel_hi:[1,1,1]
v_pk_fma_f32 v[166:167], v[142:143], v[94:95], v[166:167] op_sel:[0,1,0] op_sel_hi:[1,1,1]
v_pk_fma_f32 v[168:169], v[144:145], v[94:95], v[168:169] op_sel:[0,1,0] op_sel_hi:[1,1,1]
v_pk_fma_f32 v[170:171], v[146:147], v[94:95], v[170:171] op_sel:[0,1,0] op_sel_hi:[1,1,1]
v_cvt_pk_bf16_f32 v164, v164, v165
v_mfma_f32_16x16x32_bf16 v[60:63], v[10:13], v[156:159], 0
v_cvt_pk_bf16_f32 v165, v166, v167
v_cvt_pk_bf16_f32 v166, v168, v169
v_mfma_f32_16x16x32_bf16 v[64:67], v[14:17], v[156:159], 0
v_cvt_pk_bf16_f32 v167, v170, v171
v_pk_fma_f32 v[172:173], v[140:141], v[96:97], v[172:173] op_sel:[0,1,0] op_sel_hi:[1,1,1]
v_pk_fma_f32 v[174:175], v[142:143], v[96:97], v[174:175] op_sel:[0,1,0] op_sel_hi:[1,1,1]
v_pk_fma_f32 v[176:177], v[144:145], v[96:97], v[176:177] op_sel:[0,1,0] op_sel_hi:[1,1,1]
v_pk_fma_f32 v[178:179], v[146:147], v[96:97], v[178:179] op_sel:[0,1,0] op_sel_hi:[1,1,1]
v_cvt_pk_bf16_f32 v172, v172, v173
v_mfma_f32_16x16x32_bf16 v[68:71], v[10:13], v[164:167], 0
v_cvt_pk_bf16_f32 v173, v174, v175
v_cvt_pk_bf16_f32 v174, v176, v177
v_mfma_f32_16x16x32_bf16 v[72:75], v[14:17], v[164:167], 0
v_cvt_pk_bf16_f32 v175, v178, v179
v_pk_fma_f32 v[180:181], v[140:141], v[98:99], v[180:181] op_sel:[0,1,0] op_sel_hi:[1,1,1]
v_pk_fma_f32 v[182:183], v[142:143], v[98:99], v[182:183] op_sel:[0,1,0] op_sel_hi:[1,1,1]
v_pk_fma_f32 v[184:185], v[144:145], v[98:99], v[184:185] op_sel:[0,1,0] op_sel_hi:[1,1,1]
v_pk_fma_f32 v[186:187], v[146:147], v[98:99], v[186:187] op_sel:[0,1,0] op_sel_hi:[1,1,1]
v_cvt_pk_bf16_f32 v180, v180, v181
v_mfma_f32_16x16x32_bf16 v[76:79], v[10:13], v[172:175], 0
v_cvt_pk_bf16_f32 v181, v182, v183
v_cvt_pk_bf16_f32 v182, v184, v185
v_mfma_f32_16x16x32_bf16 v[80:83], v[14:17], v[172:175], 0
v_cvt_pk_bf16_f32 v183, v186, v187
s_nop 1
v_mfma_f32_16x16x32_bf16 v[84:87], v[10:13], v[180:183], 0
v_mfma_f32_16x16x32_bf16 v[88:91], v[14:17], v[180:183], 0
v_max3_f32 v100, v60, v61, v62
v_min3_f32 v104, v60, v61, v62
v_max3_f32 v100, v100, v63, v64
v_min3_f32 v104, v104, v63, v64
v_max3_f32 v100, v100, v65, v66
v_min3_f32 v104, v104, v65, v66
v_max_f32 v100, v100, v67
v_min_f32 v104, v104, v67
v_max3_f32 v101, v68, v69, v70
v_min3_f32 v105, v68, v69, v70
v_max3_f32 v101, v101, v71, v72
v_min3_f32 v105, v105, v71, v72
v_max3_f32 v101, v101, v73, v74
v_min3_f32 v105, v105, v73, v74
v_max_f32 v101, v101, v75
v_min_f32 v105, v105, v75
v_max3_f32 v102, v76, v77, v78
v_min3_f32 v106, v76, v77, v78
v_max3_f32 v102, v102, v79, v80
v_min3_f32 v106, v106, v79, v80
v_max3_f32 v102, v102, v81, v82
v_min3_f32 v106, v106, v81, v82
v_max_f32 v102, v102, v83
v_min_f32 v106, v106, v83
v_max3_f32 v103, v84, v85, v86
v_min3_f32 v107, v84, v85, v86
v_max3_f32 v103, v103, v87, v88
v_min3_f32 v107, v107, v87, v88
v_max3_f32 v103, v103, v89, v90
v_min3_f32 v107, v107, v89, v90
v_max_f32 v103, v103, v91
v_min_f32 v107, v107, v91
s_nop 1
v_permlane32_swap_b32 v100, v101
v_permlane32_swap_b32 v102, v103
v_permlane32_swap_b32 v104, v105
v_permlane32_swap_b32 v106, v107
v_max_f32 v100, v100, v101
v_max_f32 v102, v102, v103
v_min_f32 v104, v104, v105
v_min_f32 v106, v106, v107
v_permlane16_swap_b32 v100, v102
s_nop 0
v_permlane16_swap_b32 v104, v106
v_max_f32 v100, v100, v102
v_min_f32 v104, v104, v106
v_mov_b32 v102, v100
v_mov_b32 v106, v104
s_nop 0
v_permlane16_swap_b32 v100, v102
v_permlane16_swap_b32 v104, v106
v_mov_b32 v101, v100
v_mov_b32 v103, v102
v_mov_b32 v105, v104
v_mov_b32 v107, v106
v_permlane32_swap_b32 v100, v101
v_permlane32_swap_b32 v102, v103
v_permlane32_swap_b32 v104, v105
v_permlane32_swap_b32 v106, v107
v_pk_mul_f32 v[100:101], v[100:101], v[128:129]
v_pk_mul_f32 v[102:103], v[102:103], v[130:131]
v_pk_mul_f32 v[104:105], v[104:105], v[128:129]
v_pk_mul_f32 v[106:107], v[106:107], v[130:131]
v_pk_fma_f32 v[220:221], v[60:61], v[128:129], v[104:105] op_sel:[0,0,0] op_sel_hi:[1,0,0] neg_lo:[1,0,0] neg_hi:[1,0,0]
v_pk_fma_f32 v[60:61], v[60:61], v[128:129], v[100:101] op_sel:[0,0,0] op_sel_hi:[1,0,0] neg_lo:[0,0,1] neg_hi:[0,0,1]
v_exp_f32 v220, v220
v_exp_f32 v60, v60
v_exp_f32 v221, v221
v_exp_f32 v61, v61
v_pk_fma_f32 v[222:223], v[62:63], v[128:129], v[104:105] op_sel:[0,0,0] op_sel_hi:[1,0,0] neg_lo:[1,0,0] neg_hi:[1,0,0]
v_pk_fma_f32 v[62:63], v[62:63], v[128:129], v[100:101] op_sel:[0,0,0] op_sel_hi:[1,0,0] neg_lo:[0,0,1] neg_hi:[0,0,1]
v_exp_f32 v222, v222
v_exp_f32 v62, v62
v_exp_f32 v223, v223
v_exp_f32 v63, v63
v_pk_fma_f32 v[224:225], v[64:65], v[128:129], v[104:105] op_sel:[0,0,0] op_sel_hi:[1,0,0] neg_lo:[1,0,0] neg_hi:[1,0,0]
v_pk_fma_f32 v[64:65], v[64:65], v[128:129], v[100:101] op_sel:[0,0,0] op_sel_hi:[1,0,0] neg_lo:[0,0,1] neg_hi:[0,0,1]
v_exp_f32 v224, v224
v_exp_f32 v64, v64
v_exp_f32 v225, v225
v_exp_f32 v65, v65
v_pk_fma_f32 v[226:227], v[66:67], v[128:129], v[104:105] op_sel:[0,0,0] op_sel_hi:[1,0,0] neg_lo:[1,0,0] neg_hi:[1,0,0]
v_pk_fma_f32 v[66:67], v[66:67], v[128:129], v[100:101] op_sel:[0,0,0] op_sel_hi:[1,0,0] neg_lo:[0,0,1] neg_hi:[0,0,1]
v_exp_f32 v226, v226
v_exp_f32 v66, v66
v_exp_f32 v227, v227
v_exp_f32 v67, v67
buffer_load_dwordx4 v[212:215], v18, s[32:35], s55 offen offset:0 sc1
buffer_load_dwordx4 v[216:219], v18, s[32:35], s55 offen offset:1024 sc1
v_pk_fma_f32 v[228:229], v[68:69], v[128:129], v[104:105] op_sel:[0,1,1] op_sel_hi:[1,1,1] neg_lo:[1,0,0] neg_hi:[1,0,0]
v_pk_fma_f32 v[68:69], v[68:69], v[128:129], v[100:101] op_sel:[0,1,1] op_sel_hi:[1,1,1] neg_lo:[0,0,1] neg_hi:[0,0,1]
v_exp_f32 v228, v228
v_exp_f32 v68, v68
v_exp_f32 v229, v229
v_exp_f32 v69, v69
v_pk_fma_f32 v[230:231], v[70:71], v[128:129], v[104:105] op_sel:[0,1,1] op_sel_hi:[1,1,1] neg_lo:[1,0,0] neg_hi:[1,0,0]
v_pk_fma_f32 v[70:71], v[70:71], v[128:129], v[100:101] op_sel:[0,1,1] op_sel_hi:[1,1,1] neg_lo:[0,0,1] neg_hi:[0,0,1]
v_exp_f32 v230, v230
v_exp_f32 v70, v70
v_exp_f32 v231, v231
v_exp_f32 v71, v71
v_pk_fma_f32 v[232:233], v[72:73], v[128:129], v[104:105] op_sel:[0,1,1] op_sel_hi:[1,1,1] neg_lo:[1,0,0] neg_hi:[1,0,0]
v_pk_fma_f32 v[72:73], v[72:73], v[128:129], v[100:101] op_sel:[0,1,1] op_sel_hi:[1,1,1] neg_lo:[0,0,1] neg_hi:[0,0,1]
v_exp_f32 v232, v232
v_exp_f32 v72, v72
v_exp_f32 v233, v233
v_exp_f32 v73, v73
v_pk_fma_f32 v[234:235], v[74:75], v[128:129], v[104:105] op_sel:[0,1,1] op_sel_hi:[1,1,1] neg_lo:[1,0,0] neg_hi:[1,0,0]
v_pk_fma_f32 v[74:75], v[74:75], v[128:129], v[100:101] op_sel:[0,1,1] op_sel_hi:[1,1,1] neg_lo:[0,0,1] neg_hi:[0,0,1]
v_exp_f32 v234, v234
v_exp_f32 v74, v74
v_exp_f32 v235, v235
v_exp_f32 v75, v75
v_pk_fma_f32 v[236:237], v[76:77], v[130:131], v[106:107] op_sel:[0,0,0] op_sel_hi:[1,0,0] neg_lo:[1,0,0] neg_hi:[1,0,0]
v_pk_fma_f32 v[76:77], v[76:77], v[130:131], v[102:103] op_sel:[0,0,0] op_sel_hi:[1,0,0] neg_lo:[0,0,1] neg_hi:[0,0,1]
v_exp_f32 v236, v236
v_exp_f32 v76, v76
v_exp_f32 v237, v237
v_exp_f32 v77, v77
v_pk_fma_f32 v[238:239], v[78:79], v[130:131], v[106:107] op_sel:[0,0,0] op_sel_hi:[1,0,0] neg_lo:[1,0,0] neg_hi:[1,0,0]
v_pk_fma_f32 v[78:79], v[78:79], v[130:131], v[102:103] op_sel:[0,0,0] op_sel_hi:[1,0,0] neg_lo:[0,0,1] neg_hi:[0,0,1]
v_exp_f32 v238, v238
v_exp_f32 v78, v78
v_exp_f32 v239, v239
v_exp_f32 v79, v79
v_pk_fma_f32 v[240:241], v[80:81], v[130:131], v[106:107] op_sel:[0,0,0] op_sel_hi:[1,0,0] neg_lo:[1,0,0] neg_hi:[1,0,0]
v_pk_fma_f32 v[80:81], v[80:81], v[130:131], v[102:103] op_sel:[0,0,0] op_sel_hi:[1,0,0] neg_lo:[0,0,1] neg_hi:[0,0,1]
v_exp_f32 v240, v240
v_exp_f32 v80, v80
v_exp_f32 v241, v241
v_exp_f32 v81, v81
v_pk_fma_f32 v[242:243], v[82:83], v[130:131], v[106:107] op_sel:[0,0,0] op_sel_hi:[1,0,0] neg_lo:[1,0,0] neg_hi:[1,0,0]
v_pk_fma_f32 v[82:83], v[82:83], v[130:131], v[102:103] op_sel:[0,0,0] op_sel_hi:[1,0,0] neg_lo:[0,0,1] neg_hi:[0,0,1]
v_exp_f32 v242, v242
v_exp_f32 v82, v82
v_exp_f32 v243, v243
v_exp_f32 v83, v83
v_pk_fma_f32 v[244:245], v[84:85], v[130:131], v[106:107] op_sel:[0,1,1] op_sel_hi:[1,1,1] neg_lo:[1,0,0] neg_hi:[1,0,0]
v_pk_fma_f32 v[84:85], v[84:85], v[130:131], v[102:103] op_sel:[0,1,1] op_sel_hi:[1,1,1] neg_lo:[0,0,1] neg_hi:[0,0,1]
v_exp_f32 v244, v244
v_exp_f32 v84, v84
v_exp_f32 v245, v245
v_exp_f32 v85, v85
v_pk_fma_f32 v[246:247], v[86:87], v[130:131], v[106:107] op_sel:[0,1,1] op_sel_hi:[1,1,1] neg_lo:[1,0,0] neg_hi:[1,0,0]
v_pk_fma_f32 v[86:87], v[86:87], v[130:131], v[102:103] op_sel:[0,1,1] op_sel_hi:[1,1,1] neg_lo:[0,0,1] neg_hi:[0,0,1]
v_exp_f32 v246, v246
v_exp_f32 v86, v86
v_exp_f32 v247, v247
v_exp_f32 v87, v87
v_pk_fma_f32 v[248:249], v[88:89], v[130:131], v[106:107] op_sel:[0,1,1] op_sel_hi:[1,1,1] neg_lo:[1,0,0] neg_hi:[1,0,0]
v_pk_fma_f32 v[88:89], v[88:89], v[130:131], v[102:103] op_sel:[0,1,1] op_sel_hi:[1,1,1] neg_lo:[0,0,1] neg_hi:[0,0,1]
v_exp_f32 v248, v248
v_exp_f32 v88, v88
v_exp_f32 v249, v249
v_exp_f32 v89, v89
v_pk_fma_f32 v[250:251], v[90:91], v[130:131], v[106:107] op_sel:[0,1,1] op_sel_hi:[1,1,1] neg_lo:[1,0,0] neg_hi:[1,0,0]
v_pk_fma_f32 v[90:91], v[90:91], v[130:131], v[102:103] op_sel:[0,1,1] op_sel_hi:[1,1,1] neg_lo:[0,0,1] neg_hi:[0,0,1]
v_exp_f32 v250, v250
v_exp_f32 v90, v90
v_exp_f32 v251, v251
v_exp_f32 v91, v91
s_cmp_eq_u32 s51, 1
s_cbranch_scc1 chk_97
s_waitcnt vmcnt(0)
v_max_u32 v4, v212, v213
v_max3_u32 v4, v4, v214, v215
v_max3_u32 v4, v4, v216, v217
v_max3_u32 v4, v4, v218, v219
v_cmp_eq_u32 vcc, -1, v4
s_cbranch_vccz red_98
buffer_load_dwordx4 v[212:215], v18, s[32:35], s55 offen offset:0 sc1
buffer_load_dwordx4 v[216:219], v18, s[32:35], s55 offen offset:1024 sc1
s_branch chk_97
red_98:
v_mfma_f32_16x16x32_bf16 v[132:135], v[44:47], v[212:215], 0
v_mfma_f32_16x16x32_bf16 v[132:135], v[44:47], v[216:219], v[132:135]
s_mov_b32 s51, 1
s_nop 6
v_add_f32_dpp v132, v132, v132 row_ror:8 row_mask:0xf bank_mask:0xf
v_add_f32_dpp v133, v133, v133 row_ror:8 row_mask:0xf bank_mask:0xf
v_add_f32_dpp v134, v134, v134 row_ror:8 row_mask:0xf bank_mask:0xf
v_add_f32_dpp v135, v135, v135 row_ror:8 row_mask:0xf bank_mask:0xf
v_cvt_pk_bf16_f32 v132, v132, v133
v_cvt_pk_bf16_f32 v133, v134, v135
s_mov_b64 exec, 0x00ff00ff
buffer_store_dwordx2 v[132:133], v59, s[32:35], s79 offen sc1
s_mov_b64 exec, -1
buffer_load_dwordx4 v[204:207], v58, s[32:35], s56 offen sc1
buffer_load_dwordx4 v[208:211], v58, s[32:35], s57 offen sc1
chk_97:
v_pk_add_f32 v[108:109], v[60:61], v[62:63]
v_pk_add_f32 v[110:111], v[220:221], v[222:223]
v_pk_add_f32 v[108:109], v[108:109], v[64:65]
v_pk_add_f32 v[110:111], v[110:111], v[224:225]
v_pk_add_f32 v[108:109], v[108:109], v[66:67]
v_pk_add_f32 v[110:111], v[110:111], v[226:227]
v_add_f32 v100, v108, v109
v_add_f32 v104, v110, v111
v_pk_add_f32 v[108:109], v[68:69], v[70:71]
v_pk_add_f32 v[110:111], v[228:229], v[230:231]
v_pk_add_f32 v[108:109], v[108:109], v[72:73]
v_pk_add_f32 v[110:111], v[110:111], v[232:233]
v_pk_add_f32 v[108:109], v[108:109], v[74:75]
v_pk_add_f32 v[110:111], v[110:111], v[234:235]
v_add_f32 v101, v108, v109
v_add_f32 v105, v110, v111
v_pk_add_f32 v[108:109], v[76:77], v[78:79]
v_pk_add_f32 v[110:111], v[236:237], v[238:239]
v_pk_add_f32 v[108:109], v[108:109], v[80:81]
v_pk_add_f32 v[110:111], v[110:111], v[240:241]
v_pk_add_f32 v[108:109], v[108:109], v[82:83]
v_pk_add_f32 v[110:111], v[110:111], v[242:243]
v_add_f32 v102, v108, v109
v_add_f32 v106, v110, v111
v_pk_add_f32 v[108:109], v[84:85], v[86:87]
v_pk_add_f32 v[110:111], v[244:245], v[246:247]
v_pk_add_f32 v[108:109], v[108:109], v[88:89]
v_pk_add_f32 v[110:111], v[110:111], v[248:249]
v_pk_add_f32 v[108:109], v[108:109], v[90:91]
v_pk_add_f32 v[110:111], v[110:111], v[250:251]
v_add_f32 v103, v108, v109
v_add_f32 v107, v110, v111
s_nop 1
v_permlane32_swap_b32 v100, v101
v_permlane32_swap_b32 v102, v103
v_permlane32_swap_b32 v104, v105
v_permlane32_swap_b32 v106, v107
v_add_f32 v100, v100, v101
v_add_f32 v102, v102, v103
v_add_f32 v104, v104, v105
v_add_f32 v106, v106, v107
v_permlane16_swap_b32 v100, v102
s_nop 0
v_permlane16_swap_b32 v104, v106
v_add_f32 v100, v100, v102
v_add_f32 v104, v104, v106
v_rcp_f32 v100, v100
v_rcp_f32 v104, v104
s_nop 0
v_mov_b32 v102, v100
v_mov_b32 v106, v104
s_nop 0
v_permlane16_swap_b32 v100, v102
v_permlane16_swap_b32 v104, v106
v_mov_b32 v101, v100
v_mov_b32 v103, v102
v_mov_b32 v105, v104
v_mov_b32 v107, v106
v_permlane32_swap_b32 v100, v101
v_permlane32_swap_b32 v102, v103
v_permlane32_swap_b32 v104, v105
v_permlane32_swap_b32 v106, v107
s_cmp_eq_u32 s51, 1
s_cbranch_scc1 chk_99
s_waitcnt vmcnt(0)
v_max_u32 v4, v212, v213
v_max3_u32 v4, v4, v214, v215
v_max3_u32 v4, v4, v216, v217
v_max3_u32 v4, v4, v218, v219
v_cmp_eq_u32 vcc, -1, v4
s_cbranch_vccz red_100
buffer_load_dwordx4 v[212:215], v18, s[32:35], s55 offen offset:0 sc1
buffer_load_dwordx4 v[216:219], v18, s[32:35], s55 offen offset:1024 sc1
s_branch chk_99
red_100:
v_mfma_f32_16x16x32_bf16 v[132:135], v[44:47], v[212:215], 0
v_mfma_f32_16x16x32_bf16 v[132:135], v[44:47], v[216:219], v[132:135]
s_mov_b32 s51, 1
s_nop 6
v_add_f32_dpp v132, v132, v132 row_ror:8 row_mask:0xf bank_mask:0xf
v_add_f32_dpp v133, v133, v133 row_ror:8 row_mask:0xf bank_mask:0xf
v_add_f32_dpp v134, v134, v134 row_ror:8 row_mask:0xf bank_mask:0xf
v_add_f32_dpp v135, v135, v135 row_ror:8 row_mask:0xf bank_mask:0xf
v_cvt_pk_bf16_f32 v132, v132, v133
v_cvt_pk_bf16_f32 v133, v134, v135
s_mov_b64 exec, 0x00ff00ff
buffer_store_dwordx2 v[132:133], v59, s[32:35], s79 offen sc1
s_mov_b64 exec, -1
buffer_load_dwordx4 v[204:207], v58, s[32:35], s56 offen sc1
buffer_load_dwordx4 v[208:211], v58, s[32:35], s57 offen sc1
chk_99:
.p2align 3
v_pk_mul_f32 v[60:61], v[60:61], v[100:101] op_sel:[0,0] op_sel_hi:[1,0]
v_pk_mul_f32 v[62:63], v[62:63], v[100:101] op_sel:[0,0] op_sel_hi:[1,0]
v_pk_mul_f32 v[64:65], v[64:65], v[100:101] op_sel:[0,0] op_sel_hi:[1,0]
v_pk_mul_f32 v[66:67], v[66:67], v[100:101] op_sel:[0,0] op_sel_hi:[1,0]
v_pk_mul_f32 v[220:221], v[220:221], v[104:105] op_sel:[0,0] op_sel_hi:[1,0]
v_pk_mul_f32 v[222:223], v[222:223], v[104:105] op_sel:[0,0] op_sel_hi:[1,0]
v_pk_mul_f32 v[224:225], v[224:225], v[104:105] op_sel:[0,0] op_sel_hi:[1,0]
v_pk_mul_f32 v[226:227], v[226:227], v[104:105] op_sel:[0,0] op_sel_hi:[1,0]
v_cvt_pk_bf16_f32 v60, v60, v61
v_cvt_pk_bf16_f32 v61, v62, v63
v_cvt_pk_bf16_f32 v62, v64, v65
v_cvt_pk_bf16_f32 v63, v66, v67
v_cvt_pk_bf16_f32 v220, v220, v221
v_cvt_pk_bf16_f32 v221, v222, v223
v_cvt_pk_bf16_f32 v222, v224, v225
v_cvt_pk_bf16_f32 v223, v226, v227
v_pk_mul_f32 v[68:69], v[68:69], v[100:101] op_sel:[0,1] op_sel_hi:[1,1]
v_pk_mul_f32 v[70:71], v[70:71], v[100:101] op_sel:[0,1] op_sel_hi:[1,1]
v_pk_mul_f32 v[72:73], v[72:73], v[100:101] op_sel:[0,1] op_sel_hi:[1,1]
v_pk_mul_f32 v[74:75], v[74:75], v[100:101] op_sel:[0,1] op_sel_hi:[1,1]
v_pk_mul_f32 v[228:229], v[228:229], v[104:105] op_sel:[0,1] op_sel_hi:[1,1]
v_pk_mul_f32 v[230:231], v[230:231], v[104:105] op_sel:[0,1] op_sel_hi:[1,1]
v_pk_mul_f32 v[232:233], v[232:233], v[104:105] op_sel:[0,1] op_sel_hi:[1,1]
v_pk_mul_f32 v[234:235], v[234:235], v[104:105] op_sel:[0,1] op_sel_hi:[1,1]
v_cvt_pk_bf16_f32 v68, v68, v69
v_cvt_pk_bf16_f32 v69, v70, v71
v_cvt_pk_bf16_f32 v70, v72, v73
v_cvt_pk_bf16_f32 v71, v74, v75
v_cvt_pk_bf16_f32 v228, v228, v229
v_cvt_pk_bf16_f32 v229, v230, v231
v_cvt_pk_bf16_f32 v230, v232, v233
v_cvt_pk_bf16_f32 v231, v234, v235
v_pk_mul_f32 v[76:77], v[76:77], v[102:103] op_sel:[0,0] op_sel_hi:[1,0]
v_pk_mul_f32 v[78:79], v[78:79], v[102:103] op_sel:[0,0] op_sel_hi:[1,0]
v_pk_mul_f32 v[80:81], v[80:81], v[102:103] op_sel:[0,0] op_sel_hi:[1,0]
v_pk_mul_f32 v[82:83], v[82:83], v[102:103] op_sel:[0,0] op_sel_hi:[1,0]
v_pk_mul_f32 v[236:237], v[236:237], v[106:107] op_sel:[0,0] op_sel_hi:[1,0]
v_pk_mul_f32 v[238:239], v[238:239], v[106:107] op_sel:[0,0] op_sel_hi:[1,0]
v_pk_mul_f32 v[240:241], v[240:241], v[106:107] op_sel:[0,0] op_sel_hi:[1,0]
v_pk_mul_f32 v[242:243], v[242:243], v[106:107] op_sel:[0,0] op_sel_hi:[1,0]
v_cvt_pk_bf16_f32 v76, v76, v77
v_cvt_pk_bf16_f32 v77, v78, v79
v_cvt_pk_bf16_f32 v78, v80, v81
v_cvt_pk_bf16_f32 v79, v82, v83
v_cvt_pk_bf16_f32 v236, v236, v237
v_cvt_pk_bf16_f32 v237, v238, v239
v_cvt_pk_bf16_f32 v238, v240, v241
v_cvt_pk_bf16_f32 v239, v242, v243
v_pk_mul_f32 v[84:85], v[84:85], v[102:103] op_sel:[0,1] op_sel_hi:[1,1]
v_pk_mul_f32 v[86:87], v[86:87], v[102:103] op_sel:[0,1] op_sel_hi:[1,1]
v_pk_mul_f32 v[88:89], v[88:89], v[102:103] op_sel:[0,1] op_sel_hi:[1,1]
v_pk_mul_f32 v[90:91], v[90:91], v[102:103] op_sel:[0,1] op_sel_hi:[1,1]
v_pk_mul_f32 v[244:245], v[244:245], v[106:107] op_sel:[0,1] op_sel_hi:[1,1]
v_pk_mul_f32 v[246:247], v[246:247], v[106:107] op_sel:[0,1] op_sel_hi:[1,1]
v_pk_mul_f32 v[248:249], v[248:249], v[106:107] op_sel:[0,1] op_sel_hi:[1,1]
v_pk_mul_f32 v[250:251], v[250:251], v[106:107] op_sel:[0,1] op_sel_hi:[1,1]
v_cvt_pk_bf16_f32 v84, v84, v85
v_cvt_pk_bf16_f32 v85, v86, v87
v_cvt_pk_bf16_f32 v86, v88, v89
v_cvt_pk_bf16_f32 v87, v90, v91
v_cvt_pk_bf16_f32 v244, v244, v245
v_cvt_pk_bf16_f32 v245, v246, v247
v_cvt_pk_bf16_f32 v246, v248, v249
v_cvt_pk_bf16_f32 v247, v250, v251
s_cmp_lg_u32 s51, 0
s_cbranch_scc1 else_101
s_mov_b32 s63, 0
sent_103:
s_waitcnt vmcnt(0)
v_max_u32 v4, v212, v213
v_max3_u32 v4, v4, v214, v215
v_max3_u32 v4, v4, v216, v217
v_max3_u32 v4, v4, v218, v219
v_cmp_eq_u32 vcc, -1, v4
s_cbranch_vccz sentd_104
buffer_load_dwordx4 v[212:215], v18, s[32:35], s55 offen offset:0 sc1
buffer_load_dwordx4 v[216:219], v18, s[32:35], s55 offen offset:1024 sc1
s_add_u32 s63, s63, 1
s_cmp_lt_u32 s63, 0x80000
s_cbranch_scc1 sent_103
s_waitcnt vmcnt(0)
sentd_104:
v_mfma_f32_16x16x32_bf16 v[132:135], v[44:47], v[212:215], 0
v_mfma_f32_16x16x32_bf16 v[132:135], v[44:47], v[216:219], v[132:135]
s_mov_b32 s51, 1
s_nop 6
v_add_f32_dpp v132, v132, v132 row_ror:8 row_mask:0xf bank_mask:0xf
v_add_f32_dpp v133, v133, v133 row_ror:8 row_mask:0xf bank_mask:0xf
v_add_f32_dpp v134, v134, v134 row_ror:8 row_mask:0xf bank_mask:0xf
v_add_f32_dpp v135, v135, v135 row_ror:8 row_mask:0xf bank_mask:0xf
v_cvt_pk_bf16_f32 v132, v132, v133
v_cvt_pk_bf16_f32 v133, v134, v135
s_mov_b64 exec, 0x00ff00ff
buffer_store_dwordx2 v[132:133], v59, s[32:35], s79 offen sc1
s_mov_b64 exec, -1
buffer_load_dwordx4 v[204:207], v58, s[32:35], s56 offen sc1
buffer_load_dwordx4 v[208:211], v58, s[32:35], s57 offen sc1
else_101:
s_mov_b32 s63, 0
sent_105:
s_waitcnt vmcnt(0)
v_max_u32 v4, v204, v205
v_max3_u32 v4, v4, v206, v207
v_max3_u32 v4, v4, v208, v209
v_max3_u32 v4, v4, v210, v211
v_cmp_eq_u32 vcc, -1, v4
s_cbranch_vccz sentd_106
buffer_load_dwordx4 v[204:207], v58, s[32:35], s56 offen sc1
buffer_load_dwordx4 v[208:211], v58, s[32:35], s57 offen sc1
s_add_u32 s63, s63, 1
s_cmp_lt_u32 s63, 0x80000
s_cbranch_scc1 sent_105
s_waitcnt vmcnt(0)
sentd_106:
buffer_load_dwordx4 v[188:191], v18, s[32:35], s58 offen offset:0 sc1
buffer_load_dwordx4 v[192:195], v18, s[32:35], s58 offen offset:1024 sc1
buffer_load_dwordx4 v[196:199], v18, s[32:35], s59 offen offset:0 sc1
buffer_load_dwordx4 v[200:203], v18, s[32:35], s59 offen offset:1024 sc1
v_mfma_f32_16x16x32_bf16 v[112:115], v[204:207], v[60:63], 0
v_mfma_f32_16x16x32_bf16 v[116:119], v[204:207], v[68:71], 0
v_mfma_f32_16x16x32_bf16 v[120:123], v[204:207], v[76:79], 0
v_mfma_f32_16x16x32_bf16 v[124:127], v[204:207], v[84:87], 0
v_mfma_f32_16x16x32_bf16 v[112:115], v[208:211], v[220:223], v[112:115]
v_mfma_f32_16x16x32_bf16 v[116:119], v[208:211], v[228:231], v[116:119]
v_mfma_f32_16x16x32_bf16 v[120:123], v[208:211], v[236:239], v[120:123]
v_mfma_f32_16x16x32_bf16 v[124:127], v[208:211], v[244:247], v[124:127]
s_nop 4
v_add_f32 v100, v112, v113
v_add_f32 v114, v114, v115
v_add_f32 v100, v100, v114
v_add_f32 v101, v116, v117
v_add_f32 v118, v118, v119
v_add_f32 v101, v101, v118
v_add_f32 v102, v120, v121
v_add_f32 v122, v122, v123
v_add_f32 v102, v102, v122
v_add_f32 v103, v124, v125
v_add_f32 v126, v126, v127
v_add_f32 v103, v103, v126
s_nop 1
v_permlane32_swap_b32 v100, v101
v_permlane32_swap_b32 v102, v103
v_add_f32 v100, v100, v101
v_add_f32 v102, v102, v103
s_nop 1
v_permlane16_swap_b32 v100, v102
s_nop 0
v_add_f32 v100, v100, v102
v_add_f32 v100, 0x358637bd, v100
v_rcp_f32 v100, v100
s_nop 0
v_mov_b32 v102, v100
s_nop 1
v_permlane16_swap_b32 v100, v102
s_nop 0
v_mov_b32 v101, v100
v_mov_b32 v103, v102
s_nop 0
v_permlane32_swap_b32 v100, v101
v_permlane32_swap_b32 v102, v103
s_mov_b32 s63, 0
sent_107:
s_waitcnt vmcnt(0)
v_max_u32 v4, v188, v189
v_max3_u32 v4, v4, v190, v191
v_max3_u32 v4, v4, v192, v193
v_max3_u32 v4, v4, v194, v195
v_max3_u32 v4, v4, v196, v197
v_max3_u32 v4, v4, v198, v199
v_max3_u32 v4, v4, v200, v201
v_max3_u32 v4, v4, v202, v203
v_cmp_eq_u32 vcc, -1, v4
s_cbranch_vccz sentd_108
buffer_load_dwordx4 v[188:191], v18, s[32:35], s58 offen offset:0 sc1
buffer_load_dwordx4 v[192:195], v18, s[32:35], s58 offen offset:1024 sc1
buffer_load_dwordx4 v[196:199], v18, s[32:35], s59 offen offset:0 sc1
buffer_load_dwordx4 v[200:203], v18, s[32:35], s59 offen offset:1024 sc1
s_add_u32 s63, s63, 1
s_cmp_lt_u32 s63, 0x80000
s_cbranch_scc1 sent_107
s_waitcnt vmcnt(0)
sentd_108:
v_mfma_f32_16x16x32_bf16 v[156:159], v[188:191], v[60:63], 0
v_mfma_f32_16x16x32_bf16 v[160:163], v[192:195], v[60:63], 0
v_mfma_f32_16x16x32_bf16 v[156:159], v[196:199], v[220:223], v[156:159]
v_mfma_f32_16x16x32_bf16 v[160:163], v[200:203], v[220:223], v[160:163]
v_mfma_f32_16x16x32_bf16 v[164:167], v[188:191], v[68:71], 0
v_mfma_f32_16x16x32_bf16 v[168:171], v[192:195], v[68:71], 0
v_mfma_f32_16x16x32_bf16 v[164:167], v[196:199], v[228:231], v[164:167]
v_mfma_f32_16x16x32_bf16 v[168:171], v[200:203], v[228:231], v[168:171]
v_mfma_f32_16x16x32_bf16 v[172:175], v[188:191], v[76:79], 0
v_mfma_f32_16x16x32_bf16 v[176:179], v[192:195], v[76:79], 0
v_mfma_f32_16x16x32_bf16 v[172:175], v[196:199], v[236:239], v[172:175]
v_mfma_f32_16x16x32_bf16 v[176:179], v[200:203], v[236:239], v[176:179]
v_mfma_f32_16x16x32_bf16 v[180:183], v[188:191], v[84:87], 0
v_mfma_f32_16x16x32_bf16 v[184:187], v[192:195], v[84:87], 0
v_mfma_f32_16x16x32_bf16 v[180:183], v[196:199], v[244:247], v[180:183]
v_mfma_f32_16x16x32_bf16 v[184:187], v[200:203], v[244:247], v[184:187]
s_cmp_eq_u32 s46, 0
s_cbranch_scc1 slow_109
.p2align 3
v_pk_mul_f32 v[156:157], v[156:157], v[100:101] op_sel:[0,0] op_sel_hi:[1,0]
v_pk_mul_f32 v[158:159], v[158:159], v[100:101] op_sel:[0,0] op_sel_hi:[1,0]
v_pk_mul_f32 v[160:161], v[160:161], v[100:101] op_sel:[0,0] op_sel_hi:[1,0]
v_pk_mul_f32 v[162:163], v[162:163], v[100:101] op_sel:[0,0] op_sel_hi:[1,0]
v_cvt_pk_bf16_f32 v156, v156, v157
v_cvt_pk_bf16_f32 v157, v158, v159
v_cvt_pk_bf16_f32 v158, v160, v161
v_cvt_pk_bf16_f32 v159, v162, v163
buffer_store_dwordx4 v[156:159], v18, s[32:35], s80 offen
v_pk_mul_f32 v[164:165], v[164:165], v[100:101] op_sel:[0,1] op_sel_hi:[1,1]
v_pk_mul_f32 v[166:167], v[166:167], v[100:101] op_sel:[0,1] op_sel_hi:[1,1]
v_pk_mul_f32 v[168:169], v[168:169], v[100:101] op_sel:[0,1] op_sel_hi:[1,1]
v_pk_mul_f32 v[170:171], v[170:171], v[100:101] op_sel:[0,1] op_sel_hi:[1,1]
v_cvt_pk_bf16_f32 v164, v164, v165
v_cvt_pk_bf16_f32 v165, v166, v167
v_cvt_pk_bf16_f32 v166, v168, v169
v_cvt_pk_bf16_f32 v167, v170, v171
buffer_store_dwordx4 v[164:167], v18, s[32:35], s81 offen
v_pk_mul_f32 v[172:173], v[172:173], v[102:103] op_sel:[0,0] op_sel_hi:[1,0]
v_pk_mul_f32 v[174:175], v[174:175], v[102:103] op_sel:[0,0] op_sel_hi:[1,0]
v_pk_mul_f32 v[176:177], v[176:177], v[102:103] op_sel:[0,0] op_sel_hi:[1,0]
v_pk_mul_f32 v[178:179], v[178:179], v[102:103] op_sel:[0,0] op_sel_hi:[1,0]
v_cvt_pk_bf16_f32 v172, v172, v173
v_cvt_pk_bf16_f32 v173, v174, v175
v_cvt_pk_bf16_f32 v174, v176, v177
v_cvt_pk_bf16_f32 v175, v178, v179
buffer_store_dwordx4 v[172:175], v18, s[32:35], s82 offen
v_pk_mul_f32 v[180:181], v[180:181], v[102:103] op_sel:[0,1] op_sel_hi:[1,1]
v_pk_mul_f32 v[182:183], v[182:183], v[102:103] op_sel:[0,1] op_sel_hi:[1,1]
v_pk_mul_f32 v[184:185], v[184:185], v[102:103] op_sel:[0,1] op_sel_hi:[1,1]
v_pk_mul_f32 v[186:187], v[186:187], v[102:103] op_sel:[0,1] op_sel_hi:[1,1]
v_cvt_pk_bf16_f32 v180, v180, v181
v_cvt_pk_bf16_f32 v181, v182, v183
v_cvt_pk_bf16_f32 v182, v184, v185
v_cvt_pk_bf16_f32 v183, v186, v187
buffer_store_dwordx4 v[180:183], v18, s[32:35], s83 offen
s_barrier
s_lshl_b32 s62, s45, 2
v_mov_b32 v4, s62
v_mov_b32 v5, 4
s_mov_b64 exec, 1
s_waitcnt vmcnt(0)
buffer_store_dword v5, v4, s[32:35], s84 offen
s_mov_b64 exec, -1
back_110:
v_and_b32 v36, 31, v0
v_lshlrev_b32 v36, 2, v36
buffer_load_dword v37, v36, s[32:35], s84 offen sc1
v_lshrrev_b32 v4, 2, v2
v_and_b32 v5, 3, v0
v_lshl_add_u32 v6, v3, 3, v4
v_lshlrev_b32 v6, 7, v6
v_lshl_add_u32 v6, v5, 3, v6
v_lshrrev_b32 v7, 1, v4
v_and_b32 v8, 1, v3
v_lshl_add_u32 v7, v8, 1, v7
v_lshl_add_u32 v10, v7, 5, v6
v_xor_b32 v11, 32, v10
v_xor_b32 v12, 64, v10
v_xor_b32 v13, 96, v10
v_add_u32 v14, 0x10000, v10
v_add_u32 v15, 0x10000, v11
v_add_u32 v16, 0x10000, v12
v_add_u32 v17, 0x10000, v13
ds_read_b64_tr_b16 v[220:221], v10 offset:0
ds_read_b64_tr_b16 v[222:223], v10 offset:512
ds_read_b64_tr_b16 v[224:225], v11 offset:0
ds_read_b64_tr_b16 v[226:227], v11 offset:512
ds_read_b64_tr_b16 v[228:229], v12 offset:0
ds_read_b64_tr_b16 v[230:231], v12 offset:512
ds_read_b64_tr_b16 v[232:233], v13 offset:0
ds_read_b64_tr_b16 v[234:235], v13 offset:512
ds_read_b64_tr_b16 v[236:237], v10 offset:4096
ds_read_b64_tr_b16 v[238:239], v10 offset:4608
ds_read_b64_tr_b16 v[240:241], v11 offset:4096
ds_read_b64_tr_b16 v[242:243], v11 offset:4608
ds_read_b64_tr_b16 v[244:245], v12 offset:4096
ds_read_b64_tr_b16 v[246:247], v12 offset:4608
ds_read_b64_tr_b16 v[248:249], v13 offset:4096
ds_read_b64_tr_b16 v[250:251], v13 offset:4608
s_lshl_b32 s48, s41, 3
s_lshl_b32 s49, s40, 1
s_add_u32 s48, s48, s49
s_lshl_b32 s48, s48, 15
s_add_u32 s48, s48, 4194304
v_add_u32 v38, s48, v18
v_add_u32 v39, 32768, v38
s_lshl_b32 s57, s75, 11
s_add_u32 s87, s87, 262144
v_lshlrev_b32 v60, 16, v20
v_and_b32 v61, 0xffff0000, v20
v_lshlrev_b32 v62, 16, v21
v_and_b32 v63, 0xffff0000, v21
v_lshlrev_b32 v64, 16, v22
v_and_b32 v65, 0xffff0000, v22
v_lshlrev_b32 v66, 16, v23
v_and_b32 v67, 0xffff0000, v23
v_lshlrev_b32 v68, 16, v24
v_and_b32 v69, 0xffff0000, v24
v_lshlrev_b32 v70, 16, v25
v_and_b32 v71, 0xffff0000, v25
v_lshlrev_b32 v72, 16, v26
v_and_b32 v73, 0xffff0000, v26
v_lshlrev_b32 v74, 16, v27
v_and_b32 v75, 0xffff0000, v27
v_lshlrev_b32 v76, 16, v28
v_and_b32 v77, 0xffff0000, v28
v_lshlrev_b32 v78, 16, v29
v_and_b32 v79, 0xffff0000, v29
v_lshlrev_b32 v80, 16, v30
v_and_b32 v81, 0xffff0000, v30
v_lshlrev_b32 v82, 16, v31
v_and_b32 v83, 0xffff0000, v31
v_lshlrev_b32 v84, 16, v32
v_and_b32 v85, 0xffff0000, v32
v_lshlrev_b32 v86, 16, v33
v_and_b32 v87, 0xffff0000, v33
v_lshlrev_b32 v88, 16, v34
v_and_b32 v89, 0xffff0000, v34
v_lshlrev_b32 v90, 16, v35
v_and_b32 v91, 0xffff0000, v35
s_mov_b32 s24, s18
s_and_b32 s25, s19, 0xffff
s_mov_b32 s26, 4194304
s_mov_b32 s27, 0x00020000
s_lshl_b32 s48, s41, 7
s_lshl_b32 s49, s40, 5
s_add_u32 s48, s48, s49
v_add_u32 v4, s48, v2
v_lshlrev_b32 v4, 11, v4
v_and_b32 v5, 1, v3
v_lshl_add_u32 v4, v5, 5, v4
v_lshrrev_b32 v5, 1, v3
v_lshl_add_u32 v4, v5, 4, v4
s_lshl_b32 s49, s78, 7
v_add_u32 v40, s49, v4
v_add_u32 v41, 32768, v40
s_mov_b32 s63, 0
s_waitcnt vmcnt(0)
poll_111:
v_cmp_gt_u32 vcc, 4, v37
s_cbranch_vccz polled_112
buffer_load_dword v37, v36, s[32:35], s84 offen sc1
s_add_u32 s63, s63, 1
s_cmp_lt_u32 s63, 0x80000
s_waitcnt vmcnt(0)
s_cbranch_scc1 poll_111
polled_112:
buffer_load_dwordx4 v[156:159], v38, s[32:35], s57 offen sc1
buffer_load_dwordx4 v[160:163], v39, s[32:35], s57 offen sc1
buffer_load_dwordx4 v[164:167], v38, s[32:35], s57 offen offset:1024 sc1
buffer_load_dwordx4 v[168:171], v39, s[32:35], s57 offen offset:1024 sc1
s_add_u32 s57, s57, 2048
s_and_b32 s57, s57, 0x7fff
buffer_load_dwordx4 v[172:175], v38, s[32:35], s57 offen sc1
buffer_load_dwordx4 v[176:179], v39, s[32:35], s57 offen sc1
buffer_load_dwordx4 v[180:183], v38, s[32:35], s57 offen offset:1024 sc1
buffer_load_dwordx4 v[184:187], v39, s[32:35], s57 offen offset:1024 sc1
s_add_u32 s57, s57, 2048
s_and_b32 s57, s57, 0x7fff
s_waitcnt vmcnt(6) lgkmcnt(8)
v_mfma_f32_16x16x32_bf16 v[60:63], v[220:223], v[156:159], v[60:63]
buffer_load_dwordx4 v[188:191], v38, s[32:35], s57 offen sc1
v_mfma_f32_16x16x32_bf16 v[76:79], v[220:223], v[160:163], v[76:79]
ds_read_b64_tr_b16 v[100:101], v10 offset:8192
ds_read_b64_tr_b16 v[102:103], v10 offset:8704
v_mfma_f32_16x16x32_bf16 v[64:67], v[224:227], v[156:159], v[64:67]
ds_read_b64_tr_b16 v[104:105], v11 offset:8192
ds_read_b64_tr_b16 v[106:107], v11 offset:8704
v_mfma_f32_16x16x32_bf16 v[80:83], v[224:227], v[160:163], v[80:83]
buffer_load_dwordx4 v[192:195], v39, s[32:35], s57 offen sc1
v_mfma_f32_16x16x32_bf16 v[68:71], v[228:231], v[156:159], v[68:71]
ds_read_b64_tr_b16 v[108:109], v12 offset:8192
ds_read_b64_tr_b16 v[110:111], v12 offset:8704
v_mfma_f32_16x16x32_bf16 v[84:87], v[228:231], v[160:163], v[84:87]
ds_read_b64_tr_b16 v[112:113], v13 offset:8192
ds_read_b64_tr_b16 v[114:115], v13 offset:8704
v_mfma_f32_16x16x32_bf16 v[72:75], v[232:235], v[156:159], v[72:75]
v_mfma_f32_16x16x32_bf16 v[88:91], v[232:235], v[160:163], v[88:91]
s_waitcnt vmcnt(6) lgkmcnt(8)
v_mfma_f32_16x16x32_bf16 v[60:63], v[236:239], v[164:167], v[60:63]
buffer_load_dwordx4 v[196:199], v38, s[32:35], s57 offen offset:1024 sc1
v_mfma_f32_16x16x32_bf16 v[76:79], v[236:239], v[168:171], v[76:79]
ds_read_b64_tr_b16 v[220:221], v10 offset:12288
ds_read_b64_tr_b16 v[222:223], v10 offset:12800
v_mfma_f32_16x16x32_bf16 v[64:67], v[240:243], v[164:167], v[64:67]
ds_read_b64_tr_b16 v[224:225], v11 offset:12288
ds_read_b64_tr_b16 v[226:227], v11 offset:12800
v_mfma_f32_16x16x32_bf16 v[80:83], v[240:243], v[168:171], v[80:83]
buffer_load_dwordx4 v[200:203], v39, s[32:35], s57 offen offset:1024 sc1
v_mfma_f32_16x16x32_bf16 v[68:71], v[244:247], v[164:167], v[68:71]
ds_read_b64_tr_b16 v[228:229], v12 offset:12288
ds_read_b64_tr_b16 v[230:231], v12 offset:12800
v_mfma_f32_16x16x32_bf16 v[84:87], v[244:247], v[168:171], v[84:87]
ds_read_b64_tr_b16 v[232:233], v13 offset:12288
ds_read_b64_tr_b16 v[234:235], v13 offset:12800
v_mfma_f32_16x16x32_bf16 v[72:75], v[248:251], v[164:167], v[72:75]
s_add_u32 s57, s57, 2048
s_and_b32 s57, s57, 0x7fff
v_mfma_f32_16x16x32_bf16 v[88:91], v[248:251], v[168:171], v[88:91]
s_waitcnt vmcnt(6) lgkmcnt(8)
v_mfma_f32_16x16x32_bf16 v[60:63], v[100:103], v[172:175], v[60:63]
buffer_load_dwordx4 v[204:207], v38, s[32:35], s57 offen sc1
v_mfma_f32_16x16x32_bf16 v[76:79], v[100:103], v[176:179], v[76:79]
ds_read_b64_tr_b16 v[236:237], v10 offset:16384
ds_read_b64_tr_b16 v[238:239], v10 offset:16896
v_mfma_f32_16x16x32_bf16 v[64:67], v[104:107], v[172:175], v[64:67]
ds_read_b64_tr_b16 v[240:241], v11 offset:16384
ds_read_b64_tr_b16 v[242:243], v11 offset:16896
v_mfma_f32_16x16x32_bf16 v[80:83], v[104:107], v[176:179], v[80:83]
buffer_load_dwordx4 v[208:211], v39, s[32:35], s57 offen sc1
v_mfma_f32_16x16x32_bf16 v[68:71], v[108:111], v[172:175], v[68:71]
ds_read_b64_tr_b16 v[244:245], v12 offset:16384
ds_read_b64_tr_b16 v[246:247], v12 offset:16896
v_mfma_f32_16x16x32_bf16 v[84:87], v[108:111], v[176:179], v[84:87]
ds_read_b64_tr_b16 v[248:249], v13 offset:16384
ds_read_b64_tr_b16 v[250:251], v13 offset:16896
v_mfma_f32_16x16x32_bf16 v[72:75], v[112:115], v[172:175], v[72:75]
v_mfma_f32_16x16x32_bf16 v[88:91], v[112:115], v[176:179], v[88:91]
s_waitcnt vmcnt(6) lgkmcnt(8)
v_mfma_f32_16x16x32_bf16 v[60:63], v[220:223], v[180:183], v[60:63]
buffer_load_dwordx4 v[212:215], v38, s[32:35], s57 offen offset:1024 sc1
v_mfma_f32_16x16x32_bf16 v[76:79], v[220:223], v[184:187], v[76:79]
ds_read_b64_tr_b16 v[100:101], v10 offset:20480
ds_read_b64_tr_b16 v[102:103], v10 offset:20992
v_mfma_f32_16x16x32_bf16 v[64:67], v[224:227], v[180:183], v[64:67]
ds_read_b64_tr_b16 v[104:105], v11 offset:20480
ds_read_b64_tr_b16 v[106:107], v11 offset:20992
v_mfma_f32_16x16x32_bf16 v[80:83], v[224:227], v[184:187], v[80:83]
buffer_load_dwordx4 v[216:219], v39, s[32:35], s57 offen offset:1024 sc1
v_mfma_f32_16x16x32_bf16 v[68:71], v[228:231], v[180:183], v[68:71]
ds_read_b64_tr_b16 v[108:109], v12 offset:20480
ds_read_b64_tr_b16 v[110:111], v12 offset:20992
v_mfma_f32_16x16x32_bf16 v[84:87], v[228:231], v[184:187], v[84:87]
ds_read_b64_tr_b16 v[112:113], v13 offset:20480
ds_read_b64_tr_b16 v[114:115], v13 offset:20992
v_mfma_f32_16x16x32_bf16 v[72:75], v[232:235], v[180:183], v[72:75]
s_add_u32 s57, s57, 2048
s_and_b32 s57, s57, 0x7fff
v_mfma_f32_16x16x32_bf16 v[88:91], v[232:235], v[184:187], v[88:91]
s_waitcnt vmcnt(6) lgkmcnt(8)
v_mfma_f32_16x16x32_bf16 v[60:63], v[236:239], v[188:191], v[60:63]
buffer_load_dwordx4 v[156:159], v38, s[32:35], s57 offen sc1
v_mfma_f32_16x16x32_bf16 v[76:79], v[236:239], v[192:195], v[76:79]
ds_read_b64_tr_b16 v[220:221], v10 offset:24576
ds_read_b64_tr_b16 v[222:223], v10 offset:25088
v_mfma_f32_16x16x32_bf16 v[64:67], v[240:243], v[188:191], v[64:67]
ds_read_b64_tr_b16 v[224:225], v11 offset:24576
ds_read_b64_tr_b16 v[226:227], v11 offset:25088
v_mfma_f32_16x16x32_bf16 v[80:83], v[240:243], v[192:195], v[80:83]
buffer_load_dwordx4 v[160:163], v39, s[32:35], s57 offen sc1
v_mfma_f32_16x16x32_bf16 v[68:71], v[244:247], v[188:191], v[68:71]
ds_read_b64_tr_b16 v[228:229], v12 offset:24576
ds_read_b64_tr_b16 v[230:231], v12 offset:25088
v_mfma_f32_16x16x32_bf16 v[84:87], v[244:247], v[192:195], v[84:87]
ds_read_b64_tr_b16 v[232:233], v13 offset:24576
ds_read_b64_tr_b16 v[234:235], v13 offset:25088
v_mfma_f32_16x16x32_bf16 v[72:75], v[248:251], v[188:191], v[72:75]
v_mfma_f32_16x16x32_bf16 v[88:91], v[248:251], v[192:195], v[88:91]
s_waitcnt vmcnt(6) lgkmcnt(8)
v_mfma_f32_16x16x32_bf16 v[60:63], v[100:103], v[196:199], v[60:63]
buffer_load_dwordx4 v[164:167], v38, s[32:35], s57 offen offset:1024 sc1
v_mfma_f32_16x16x32_bf16 v[76:79], v[100:103], v[200:203], v[76:79]
ds_read_b64_tr_b16 v[236:237], v10 offset:28672
ds_read_b64_tr_b16 v[238:239], v10 offset:29184
v_mfma_f32_16x16x32_bf16 v[64:67], v[104:107], v[196:199], v[64:67]
ds_read_b64_tr_b16 v[240:241], v11 offset:28672
ds_read_b64_tr_b16 v[242:243], v11 offset:29184
v_mfma_f32_16x16x32_bf16 v[80:83], v[104:107], v[200:203], v[80:83]
buffer_load_dwordx4 v[168:171], v39, s[32:35], s57 offen offset:1024 sc1
v_mfma_f32_16x16x32_bf16 v[68:71], v[108:111], v[196:199], v[68:71]
ds_read_b64_tr_b16 v[244:245], v12 offset:28672
ds_read_b64_tr_b16 v[246:247], v12 offset:29184
v_mfma_f32_16x16x32_bf16 v[84:87], v[108:111], v[200:203], v[84:87]
ds_read_b64_tr_b16 v[248:249], v13 offset:28672
ds_read_b64_tr_b16 v[250:251], v13 offset:29184
v_mfma_f32_16x16x32_bf16 v[72:75], v[112:115], v[196:199], v[72:75]
s_add_u32 s57, s57, 2048
s_and_b32 s57, s57, 0x7fff
v_mfma_f32_16x16x32_bf16 v[88:91], v[112:115], v[200:203], v[88:91]
s_waitcnt vmcnt(6) lgkmcnt(8)
v_mfma_f32_16x16x32_bf16 v[60:63], v[220:223], v[204:207], v[60:63]
buffer_load_dwordx4 v[172:175], v38, s[32:35], s57 offen sc1
v_mfma_f32_16x16x32_bf16 v[76:79], v[220:223], v[208:211], v[76:79]
ds_read_b64_tr_b16 v[100:101], v10 offset:32768
ds_read_b64_tr_b16 v[102:103], v10 offset:33280
v_mfma_f32_16x16x32_bf16 v[64:67], v[224:227], v[204:207], v[64:67]
ds_read_b64_tr_b16 v[104:105], v11 offset:32768
ds_read_b64_tr_b16 v[106:107], v11 offset:33280
v_mfma_f32_16x16x32_bf16 v[80:83], v[224:227], v[208:211], v[80:83]
buffer_load_dwordx4 v[176:179], v39, s[32:35], s57 offen sc1
v_mfma_f32_16x16x32_bf16 v[68:71], v[228:231], v[204:207], v[68:71]
ds_read_b64_tr_b16 v[108:109], v12 offset:32768
ds_read_b64_tr_b16 v[110:111], v12 offset:33280
v_mfma_f32_16x16x32_bf16 v[84:87], v[228:231], v[208:211], v[84:87]
ds_read_b64_tr_b16 v[112:113], v13 offset:32768
ds_read_b64_tr_b16 v[114:115], v13 offset:33280
v_mfma_f32_16x16x32_bf16 v[72:75], v[232:235], v[204:207], v[72:75]
v_mfma_f32_16x16x32_bf16 v[88:91], v[232:235], v[208:211], v[88:91]
s_waitcnt vmcnt(6) lgkmcnt(8)
v_mfma_f32_16x16x32_bf16 v[60:63], v[236:239], v[212:215], v[60:63]
buffer_load_dwordx4 v[180:183], v38, s[32:35], s57 offen offset:1024 sc1
v_mfma_f32_16x16x32_bf16 v[76:79], v[236:239], v[216:219], v[76:79]
ds_read_b64_tr_b16 v[220:221], v10 offset:36864
ds_read_b64_tr_b16 v[222:223], v10 offset:37376
v_mfma_f32_16x16x32_bf16 v[64:67], v[240:243], v[212:215], v[64:67]
ds_read_b64_tr_b16 v[224:225], v11 offset:36864
ds_read_b64_tr_b16 v[226:227], v11 offset:37376
v_mfma_f32_16x16x32_bf16 v[80:83], v[240:243], v[216:219], v[80:83]
buffer_load_dwordx4 v[184:187], v39, s[32:35], s57 offen offset:1024 sc1
v_mfma_f32_16x16x32_bf16 v[68:71], v[244:247], v[212:215], v[68:71]
ds_read_b64_tr_b16 v[228:229], v12 offset:36864
ds_read_b64_tr_b16 v[230:231], v12 offset:37376
v_mfma_f32_16x16x32_bf16 v[84:87], v[244:247], v[216:219], v[84:87]
ds_read_b64_tr_b16 v[232:233], v13 offset:36864
ds_read_b64_tr_b16 v[234:235], v13 offset:37376
v_mfma_f32_16x16x32_bf16 v[72:75], v[248:251], v[212:215], v[72:75]
s_add_u32 s57, s57, 2048
s_and_b32 s57, s57, 0x7fff
v_mfma_f32_16x16x32_bf16 v[88:91], v[248:251], v[216:219], v[88:91]
s_waitcnt vmcnt(6) lgkmcnt(8)
v_mfma_f32_16x16x32_bf16 v[60:63], v[100:103], v[156:159], v[60:63]
buffer_load_dwordx4 v[188:191], v38, s[32:35], s57 offen sc1
v_mfma_f32_16x16x32_bf16 v[76:79], v[100:103], v[160:163], v[76:79]
ds_read_b64_tr_b16 v[236:237], v10 offset:40960
ds_read_b64_tr_b16 v[238:239], v10 offset:41472
v_mfma_f32_16x16x32_bf16 v[64:67], v[104:107], v[156:159], v[64:67]
ds_read_b64_tr_b16 v[240:241], v11 offset:40960
ds_read_b64_tr_b16 v[242:243], v11 offset:41472
v_mfma_f32_16x16x32_bf16 v[80:83], v[104:107], v[160:163], v[80:83]
buffer_load_dwordx4 v[192:195], v39, s[32:35], s57 offen sc1
v_mfma_f32_16x16x32_bf16 v[68:71], v[108:111], v[156:159], v[68:71]
ds_read_b64_tr_b16 v[244:245], v12 offset:40960
ds_read_b64_tr_b16 v[246:247], v12 offset:41472
v_mfma_f32_16x16x32_bf16 v[84:87], v[108:111], v[160:163], v[84:87]
ds_read_b64_tr_b16 v[248:249], v13 offset:40960
ds_read_b64_tr_b16 v[250:251], v13 offset:41472
v_mfma_f32_16x16x32_bf16 v[72:75], v[112:115], v[156:159], v[72:75]
v_mfma_f32_16x16x32_bf16 v[88:91], v[112:115], v[160:163], v[88:91]
s_waitcnt vmcnt(6) lgkmcnt(8)
v_mfma_f32_16x16x32_bf16 v[60:63], v[220:223], v[164:167], v[60:63]
buffer_load_dwordx4 v[196:199], v38, s[32:35], s57 offen offset:1024 sc1
v_mfma_f32_16x16x32_bf16 v[76:79], v[220:223], v[168:171], v[76:79]
ds_read_b64_tr_b16 v[100:101], v10 offset:45056
ds_read_b64_tr_b16 v[102:103], v10 offset:45568
v_mfma_f32_16x16x32_bf16 v[64:67], v[224:227], v[164:167], v[64:67]
ds_read_b64_tr_b16 v[104:105], v11 offset:45056
ds_read_b64_tr_b16 v[106:107], v11 offset:45568
v_mfma_f32_16x16x32_bf16 v[80:83], v[224:227], v[168:171], v[80:83]
buffer_load_dwordx4 v[200:203], v39, s[32:35], s57 offen offset:1024 sc1
v_mfma_f32_16x16x32_bf16 v[68:71], v[228:231], v[164:167], v[68:71]
ds_read_b64_tr_b16 v[108:109], v12 offset:45056
ds_read_b64_tr_b16 v[110:111], v12 offset:45568
v_mfma_f32_16x16x32_bf16 v[84:87], v[228:231], v[168:171], v[84:87]
ds_read_b64_tr_b16 v[112:113], v13 offset:45056
ds_read_b64_tr_b16 v[114:115], v13 offset:45568
v_mfma_f32_16x16x32_bf16 v[72:75], v[232:235], v[164:167], v[72:75]
s_add_u32 s57, s57, 2048
s_and_b32 s57, s57, 0x7fff
v_mfma_f32_16x16x32_bf16 v[88:91], v[232:235], v[168:171], v[88:91]
s_waitcnt vmcnt(6) lgkmcnt(8)
v_mfma_f32_16x16x32_bf16 v[60:63], v[236:239], v[172:175], v[60:63]
buffer_load_dwordx4 v[204:207], v38, s[32:35], s57 offen sc1
v_mfma_f32_16x16x32_bf16 v[76:79], v[236:239], v[176:179], v[76:79]
ds_read_b64_tr_b16 v[220:221], v10 offset:49152
ds_read_b64_tr_b16 v[222:223], v10 offset:49664
v_mfma_f32_16x16x32_bf16 v[64:67], v[240:243], v[172:175], v[64:67]
ds_read_b64_tr_b16 v[224:225], v11 offset:49152
ds_read_b64_tr_b16 v[226:227], v11 offset:49664
v_mfma_f32_16x16x32_bf16 v[80:83], v[240:243], v[176:179], v[80:83]
buffer_load_dwordx4 v[208:211], v39, s[32:35], s57 offen sc1
v_mfma_f32_16x16x32_bf16 v[68:71], v[244:247], v[172:175], v[68:71]
ds_read_b64_tr_b16 v[228:229], v12 offset:49152
ds_read_b64_tr_b16 v[230:231], v12 offset:49664
v_mfma_f32_16x16x32_bf16 v[84:87], v[244:247], v[176:179], v[84:87]
ds_read_b64_tr_b16 v[232:233], v13 offset:49152
ds_read_b64_tr_b16 v[234:235], v13 offset:49664
v_mfma_f32_16x16x32_bf16 v[72:75], v[248:251], v[172:175], v[72:75]
v_mfma_f32_16x16x32_bf16 v[88:91], v[248:251], v[176:179], v[88:91]
s_waitcnt vmcnt(6) lgkmcnt(8)
v_mfma_f32_16x16x32_bf16 v[60:63], v[100:103], v[180:183], v[60:63]
buffer_load_dwordx4 v[212:215], v38, s[32:35], s57 offen offset:1024 sc1
v_mfma_f32_16x16x32_bf16 v[76:79], v[100:103], v[184:187], v[76:79]
ds_read_b64_tr_b16 v[236:237], v10 offset:53248
ds_read_b64_tr_b16 v[238:239], v10 offset:53760
v_mfma_f32_16x16x32_bf16 v[64:67], v[104:107], v[180:183], v[64:67]
ds_read_b64_tr_b16 v[240:241], v11 offset:53248
ds_read_b64_tr_b16 v[242:243], v11 offset:53760
v_mfma_f32_16x16x32_bf16 v[80:83], v[104:107], v[184:187], v[80:83]
buffer_load_dwordx4 v[216:219], v39, s[32:35], s57 offen offset:1024 sc1
v_mfma_f32_16x16x32_bf16 v[68:71], v[108:111], v[180:183], v[68:71]
ds_read_b64_tr_b16 v[244:245], v12 offset:53248
ds_read_b64_tr_b16 v[246:247], v12 offset:53760
v_mfma_f32_16x16x32_bf16 v[84:87], v[108:111], v[184:187], v[84:87]
ds_read_b64_tr_b16 v[248:249], v13 offset:53248
ds_read_b64_tr_b16 v[250:251], v13 offset:53760
v_mfma_f32_16x16x32_bf16 v[72:75], v[112:115], v[180:183], v[72:75]
s_add_u32 s57, s57, 2048
s_and_b32 s57, s57, 0x7fff
v_mfma_f32_16x16x32_bf16 v[88:91], v[112:115], v[184:187], v[88:91]
s_waitcnt vmcnt(6) lgkmcnt(8)
v_mfma_f32_16x16x32_bf16 v[60:63], v[220:223], v[188:191], v[60:63]
buffer_load_dwordx4 v[156:159], v38, s[32:35], s57 offen sc1
v_mfma_f32_16x16x32_bf16 v[76:79], v[220:223], v[192:195], v[76:79]
ds_read_b64_tr_b16 v[100:101], v10 offset:57344
ds_read_b64_tr_b16 v[102:103], v10 offset:57856
v_mfma_f32_16x16x32_bf16 v[64:67], v[224:227], v[188:191], v[64:67]
ds_read_b64_tr_b16 v[104:105], v11 offset:57344
ds_read_b64_tr_b16 v[106:107], v11 offset:57856
v_mfma_f32_16x16x32_bf16 v[80:83], v[224:227], v[192:195], v[80:83]
buffer_load_dwordx4 v[160:163], v39, s[32:35], s57 offen sc1
v_mfma_f32_16x16x32_bf16 v[68:71], v[228:231], v[188:191], v[68:71]
ds_read_b64_tr_b16 v[108:109], v12 offset:57344
ds_read_b64_tr_b16 v[110:111], v12 offset:57856
v_mfma_f32_16x16x32_bf16 v[84:87], v[228:231], v[192:195], v[84:87]
ds_read_b64_tr_b16 v[112:113], v13 offset:57344
ds_read_b64_tr_b16 v[114:115], v13 offset:57856
v_mfma_f32_16x16x32_bf16 v[72:75], v[232:235], v[188:191], v[72:75]
v_mfma_f32_16x16x32_bf16 v[88:91], v[232:235], v[192:195], v[88:91]
s_waitcnt vmcnt(6) lgkmcnt(8)
v_mfma_f32_16x16x32_bf16 v[60:63], v[236:239], v[196:199], v[60:63]
buffer_load_dwordx4 v[164:167], v38, s[32:35], s57 offen offset:1024 sc1
v_mfma_f32_16x16x32_bf16 v[76:79], v[236:239], v[200:203], v[76:79]
ds_read_b64_tr_b16 v[220:221], v10 offset:61440
ds_read_b64_tr_b16 v[222:223], v10 offset:61952
v_mfma_f32_16x16x32_bf16 v[64:67], v[240:243], v[196:199], v[64:67]
ds_read_b64_tr_b16 v[224:225], v11 offset:61440
ds_read_b64_tr_b16 v[226:227], v11 offset:61952
v_mfma_f32_16x16x32_bf16 v[80:83], v[240:243], v[200:203], v[80:83]
buffer_load_dwordx4 v[168:171], v39, s[32:35], s57 offen offset:1024 sc1
v_mfma_f32_16x16x32_bf16 v[68:71], v[244:247], v[196:199], v[68:71]
ds_read_b64_tr_b16 v[228:229], v12 offset:61440
ds_read_b64_tr_b16 v[230:231], v12 offset:61952
v_mfma_f32_16x16x32_bf16 v[84:87], v[244:247], v[200:203], v[84:87]
ds_read_b64_tr_b16 v[232:233], v13 offset:61440
ds_read_b64_tr_b16 v[234:235], v13 offset:61952
v_mfma_f32_16x16x32_bf16 v[72:75], v[248:251], v[196:199], v[72:75]
s_add_u32 s57, s57, 2048
s_and_b32 s57, s57, 0x7fff
v_mfma_f32_16x16x32_bf16 v[88:91], v[248:251], v[200:203], v[88:91]
s_waitcnt vmcnt(6) lgkmcnt(8)
v_mfma_f32_16x16x32_bf16 v[60:63], v[100:103], v[204:207], v[60:63]
buffer_load_dwordx4 v[172:175], v38, s[32:35], s57 offen sc1
v_mfma_f32_16x16x32_bf16 v[76:79], v[100:103], v[208:211], v[76:79]
ds_read_b64_tr_b16 v[236:237], v14 offset:0
ds_read_b64_tr_b16 v[238:239], v14 offset:512
v_mfma_f32_16x16x32_bf16 v[64:67], v[104:107], v[204:207], v[64:67]
ds_read_b64_tr_b16 v[240:241], v15 offset:0
ds_read_b64_tr_b16 v[242:243], v15 offset:512
v_mfma_f32_16x16x32_bf16 v[80:83], v[104:107], v[208:211], v[80:83]
buffer_load_dwordx4 v[176:179], v39, s[32:35], s57 offen sc1
v_mfma_f32_16x16x32_bf16 v[68:71], v[108:111], v[204:207], v[68:71]
ds_read_b64_tr_b16 v[244:245], v16 offset:0
ds_read_b64_tr_b16 v[246:247], v16 offset:512
v_mfma_f32_16x16x32_bf16 v[84:87], v[108:111], v[208:211], v[84:87]
ds_read_b64_tr_b16 v[248:249], v17 offset:0
ds_read_b64_tr_b16 v[250:251], v17 offset:512
v_mfma_f32_16x16x32_bf16 v[72:75], v[112:115], v[204:207], v[72:75]
v_mfma_f32_16x16x32_bf16 v[88:91], v[112:115], v[208:211], v[88:91]
s_waitcnt vmcnt(6) lgkmcnt(8)
v_mfma_f32_16x16x32_bf16 v[60:63], v[220:223], v[212:215], v[60:63]
buffer_load_dwordx4 v[180:183], v38, s[32:35], s57 offen offset:1024 sc1
v_mfma_f32_16x16x32_bf16 v[76:79], v[220:223], v[216:219], v[76:79]
ds_read_b64_tr_b16 v[100:101], v14 offset:4096
ds_read_b64_tr_b16 v[102:103], v14 offset:4608
v_mfma_f32_16x16x32_bf16 v[64:67], v[224:227], v[212:215], v[64:67]
ds_read_b64_tr_b16 v[104:105], v15 offset:4096
ds_read_b64_tr_b16 v[106:107], v15 offset:4608
v_mfma_f32_16x16x32_bf16 v[80:83], v[224:227], v[216:219], v[80:83]
buffer_load_dwordx4 v[184:187], v39, s[32:35], s57 offen offset:1024 sc1
v_mfma_f32_16x16x32_bf16 v[68:71], v[228:231], v[212:215], v[68:71]
ds_read_b64_tr_b16 v[108:109], v16 offset:4096
ds_read_b64_tr_b16 v[110:111], v16 offset:4608
v_mfma_f32_16x16x32_bf16 v[84:87], v[228:231], v[216:219], v[84:87]
ds_read_b64_tr_b16 v[112:113], v17 offset:4096
ds_read_b64_tr_b16 v[114:115], v17 offset:4608
v_mfma_f32_16x16x32_bf16 v[72:75], v[232:235], v[212:215], v[72:75]
s_add_u32 s57, s57, 2048
s_and_b32 s57, s57, 0x7fff
v_mfma_f32_16x16x32_bf16 v[88:91], v[232:235], v[216:219], v[88:91]
s_waitcnt vmcnt(6) lgkmcnt(8)
v_mfma_f32_16x16x32_bf16 v[60:63], v[236:239], v[156:159], v[60:63]
buffer_load_dwordx4 v[188:191], v38, s[32:35], s57 offen sc1
v_mfma_f32_16x16x32_bf16 v[76:79], v[236:239], v[160:163], v[76:79]
ds_read_b64_tr_b16 v[220:221], v14 offset:8192
ds_read_b64_tr_b16 v[222:223], v14 offset:8704
v_mfma_f32_16x16x32_bf16 v[64:67], v[240:243], v[156:159], v[64:67]
ds_read_b64_tr_b16 v[224:225], v15 offset:8192
ds_read_b64_tr_b16 v[226:227], v15 offset:8704
v_mfma_f32_16x16x32_bf16 v[80:83], v[240:243], v[160:163], v[80:83]
buffer_load_dwordx4 v[192:195], v39, s[32:35], s57 offen sc1
v_mfma_f32_16x16x32_bf16 v[68:71], v[244:247], v[156:159], v[68:71]
ds_read_b64_tr_b16 v[228:229], v16 offset:8192
ds_read_b64_tr_b16 v[230:231], v16 offset:8704
v_mfma_f32_16x16x32_bf16 v[84:87], v[244:247], v[160:163], v[84:87]
ds_read_b64_tr_b16 v[232:233], v17 offset:8192
ds_read_b64_tr_b16 v[234:235], v17 offset:8704
v_mfma_f32_16x16x32_bf16 v[72:75], v[248:251], v[156:159], v[72:75]
v_mfma_f32_16x16x32_bf16 v[88:91], v[248:251], v[160:163], v[88:91]
s_waitcnt vmcnt(6) lgkmcnt(8)
v_mfma_f32_16x16x32_bf16 v[60:63], v[100:103], v[164:167], v[60:63]
buffer_load_dwordx4 v[196:199], v38, s[32:35], s57 offen offset:1024 sc1
v_mfma_f32_16x16x32_bf16 v[76:79], v[100:103], v[168:171], v[76:79]
ds_read_b64_tr_b16 v[236:237], v14 offset:12288
ds_read_b64_tr_b16 v[238:239], v14 offset:12800
v_mfma_f32_16x16x32_bf16 v[64:67], v[104:107], v[164:167], v[64:67]
ds_read_b64_tr_b16 v[240:241], v15 offset:12288
ds_read_b64_tr_b16 v[242:243], v15 offset:12800
v_mfma_f32_16x16x32_bf16 v[80:83], v[104:107], v[168:171], v[80:83]
buffer_load_dwordx4 v[200:203], v39, s[32:35], s57 offen offset:1024 sc1
v_mfma_f32_16x16x32_bf16 v[68:71], v[108:111], v[164:167], v[68:71]
ds_read_b64_tr_b16 v[244:245], v16 offset:12288
ds_read_b64_tr_b16 v[246:247], v16 offset:12800
v_mfma_f32_16x16x32_bf16 v[84:87], v[108:111], v[168:171], v[84:87]
ds_read_b64_tr_b16 v[248:249], v17 offset:12288
ds_read_b64_tr_b16 v[250:251], v17 offset:12800
v_mfma_f32_16x16x32_bf16 v[72:75], v[112:115], v[164:167], v[72:75]
s_add_u32 s57, s57, 2048
s_and_b32 s57, s57, 0x7fff
v_mfma_f32_16x16x32_bf16 v[88:91], v[112:115], v[168:171], v[88:91]
s_waitcnt vmcnt(6) lgkmcnt(8)
v_mfma_f32_16x16x32_bf16 v[60:63], v[220:223], v[172:175], v[60:63]
buffer_load_dwordx4 v[204:207], v38, s[32:35], s57 offen sc1
v_mfma_f32_16x16x32_bf16 v[76:79], v[220:223], v[176:179], v[76:79]
ds_read_b64_tr_b16 v[100:101], v14 offset:16384
ds_read_b64_tr_b16 v[102:103], v14 offset:16896
v_mfma_f32_16x16x32_bf16 v[64:67], v[224:227], v[172:175], v[64:67]
ds_read_b64_tr_b16 v[104:105], v15 offset:16384
ds_read_b64_tr_b16 v[106:107], v15 offset:16896
v_mfma_f32_16x16x32_bf16 v[80:83], v[224:227], v[176:179], v[80:83]
buffer_load_dwordx4 v[208:211], v39, s[32:35], s57 offen sc1
v_mfma_f32_16x16x32_bf16 v[68:71], v[228:231], v[172:175], v[68:71]
ds_read_b64_tr_b16 v[108:109], v16 offset:16384
ds_read_b64_tr_b16 v[110:111], v16 offset:16896
v_mfma_f32_16x16x32_bf16 v[84:87], v[228:231], v[176:179], v[84:87]
ds_read_b64_tr_b16 v[112:113], v17 offset:16384
ds_read_b64_tr_b16 v[114:115], v17 offset:16896
v_mfma_f32_16x16x32_bf16 v[72:75], v[232:235], v[172:175], v[72:75]
v_mfma_f32_16x16x32_bf16 v[88:91], v[232:235], v[176:179], v[88:91]
s_waitcnt vmcnt(6) lgkmcnt(8)
v_mfma_f32_16x16x32_bf16 v[60:63], v[236:239], v[180:183], v[60:63]
buffer_load_dwordx4 v[212:215], v38, s[32:35], s57 offen offset:1024 sc1
v_mfma_f32_16x16x32_bf16 v[76:79], v[236:239], v[184:187], v[76:79]
ds_read_b64_tr_b16 v[220:221], v14 offset:20480
ds_read_b64_tr_b16 v[222:223], v14 offset:20992
v_mfma_f32_16x16x32_bf16 v[64:67], v[240:243], v[180:183], v[64:67]
ds_read_b64_tr_b16 v[224:225], v15 offset:20480
ds_read_b64_tr_b16 v[226:227], v15 offset:20992
v_mfma_f32_16x16x32_bf16 v[80:83], v[240:243], v[184:187], v[80:83]
buffer_load_dwordx4 v[216:219], v39, s[32:35], s57 offen offset:1024 sc1
v_mfma_f32_16x16x32_bf16 v[68:71], v[244:247], v[180:183], v[68:71]
ds_read_b64_tr_b16 v[228:229], v16 offset:20480
ds_read_b64_tr_b16 v[230:231], v16 offset:20992
v_mfma_f32_16x16x32_bf16 v[84:87], v[244:247], v[184:187], v[84:87]
ds_read_b64_tr_b16 v[232:233], v17 offset:20480
ds_read_b64_tr_b16 v[234:235], v17 offset:20992
v_mfma_f32_16x16x32_bf16 v[72:75], v[248:251], v[180:183], v[72:75]
s_add_u32 s57, s57, 2048
s_and_b32 s57, s57, 0x7fff
v_mfma_f32_16x16x32_bf16 v[88:91], v[248:251], v[184:187], v[88:91]
s_waitcnt vmcnt(6) lgkmcnt(8)
v_mfma_f32_16x16x32_bf16 v[60:63], v[100:103], v[188:191], v[60:63]
buffer_load_dwordx4 v[156:159], v38, s[32:35], s57 offen sc1
v_mfma_f32_16x16x32_bf16 v[76:79], v[100:103], v[192:195], v[76:79]
ds_read_b64_tr_b16 v[236:237], v14 offset:24576
ds_read_b64_tr_b16 v[238:239], v14 offset:25088
v_mfma_f32_16x16x32_bf16 v[64:67], v[104:107], v[188:191], v[64:67]
ds_read_b64_tr_b16 v[240:241], v15 offset:24576
ds_read_b64_tr_b16 v[242:243], v15 offset:25088
v_mfma_f32_16x16x32_bf16 v[80:83], v[104:107], v[192:195], v[80:83]
buffer_load_dwordx4 v[160:163], v39, s[32:35], s57 offen sc1
v_mfma_f32_16x16x32_bf16 v[68:71], v[108:111], v[188:191], v[68:71]
ds_read_b64_tr_b16 v[244:245], v16 offset:24576
ds_read_b64_tr_b16 v[246:247], v16 offset:25088
v_mfma_f32_16x16x32_bf16 v[84:87], v[108:111], v[192:195], v[84:87]
ds_read_b64_tr_b16 v[248:249], v17 offset:24576
ds_read_b64_tr_b16 v[250:251], v17 offset:25088
v_mfma_f32_16x16x32_bf16 v[72:75], v[112:115], v[188:191], v[72:75]
v_mfma_f32_16x16x32_bf16 v[88:91], v[112:115], v[192:195], v[88:91]
s_waitcnt vmcnt(6) lgkmcnt(8)
v_mfma_f32_16x16x32_bf16 v[60:63], v[220:223], v[196:199], v[60:63]
buffer_load_dwordx4 v[164:167], v38, s[32:35], s57 offen offset:1024 sc1
v_mfma_f32_16x16x32_bf16 v[76:79], v[220:223], v[200:203], v[76:79]
ds_read_b64_tr_b16 v[100:101], v14 offset:28672
ds_read_b64_tr_b16 v[102:103], v14 offset:29184
v_mfma_f32_16x16x32_bf16 v[64:67], v[224:227], v[196:199], v[64:67]
ds_read_b64_tr_b16 v[104:105], v15 offset:28672
ds_read_b64_tr_b16 v[106:107], v15 offset:29184
v_mfma_f32_16x16x32_bf16 v[80:83], v[224:227], v[200:203], v[80:83]
buffer_load_dwordx4 v[168:171], v39, s[32:35], s57 offen offset:1024 sc1
v_mfma_f32_16x16x32_bf16 v[68:71], v[228:231], v[196:199], v[68:71]
ds_read_b64_tr_b16 v[108:109], v16 offset:28672
ds_read_b64_tr_b16 v[110:111], v16 offset:29184
v_mfma_f32_16x16x32_bf16 v[84:87], v[228:231], v[200:203], v[84:87]
ds_read_b64_tr_b16 v[112:113], v17 offset:28672
ds_read_b64_tr_b16 v[114:115], v17 offset:29184
v_mfma_f32_16x16x32_bf16 v[72:75], v[232:235], v[196:199], v[72:75]
s_add_u32 s57, s57, 2048
s_and_b32 s57, s57, 0x7fff
v_mfma_f32_16x16x32_bf16 v[88:91], v[232:235], v[200:203], v[88:91]
s_waitcnt vmcnt(6) lgkmcnt(8)
v_mfma_f32_16x16x32_bf16 v[60:63], v[236:239], v[204:207], v[60:63]
buffer_load_dwordx4 v[172:175], v38, s[32:35], s57 offen sc1
v_mfma_f32_16x16x32_bf16 v[76:79], v[236:239], v[208:211], v[76:79]
ds_read_b64_tr_b16 v[220:221], v14 offset:32768
ds_read_b64_tr_b16 v[222:223], v14 offset:33280
v_mfma_f32_16x16x32_bf16 v[64:67], v[240:243], v[204:207], v[64:67]
ds_read_b64_tr_b16 v[224:225], v15 offset:32768
ds_read_b64_tr_b16 v[226:227], v15 offset:33280
v_mfma_f32_16x16x32_bf16 v[80:83], v[240:243], v[208:211], v[80:83]
buffer_load_dwordx4 v[176:179], v39, s[32:35], s57 offen sc1
v_mfma_f32_16x16x32_bf16 v[68:71], v[244:247], v[204:207], v[68:71]
ds_read_b64_tr_b16 v[228:229], v16 offset:32768
ds_read_b64_tr_b16 v[230:231], v16 offset:33280
v_mfma_f32_16x16x32_bf16 v[84:87], v[244:247], v[208:211], v[84:87]
ds_read_b64_tr_b16 v[232:233], v17 offset:32768
ds_read_b64_tr_b16 v[234:235], v17 offset:33280
v_mfma_f32_16x16x32_bf16 v[72:75], v[248:251], v[204:207], v[72:75]
v_mfma_f32_16x16x32_bf16 v[88:91], v[248:251], v[208:211], v[88:91]
s_waitcnt vmcnt(6) lgkmcnt(8)
v_mfma_f32_16x16x32_bf16 v[60:63], v[100:103], v[212:215], v[60:63]
buffer_load_dwordx4 v[180:183], v38, s[32:35], s57 offen offset:1024 sc1
v_mfma_f32_16x16x32_bf16 v[76:79], v[100:103], v[216:219], v[76:79]
ds_read_b64_tr_b16 v[236:237], v14 offset:36864
ds_read_b64_tr_b16 v[238:239], v14 offset:37376
v_mfma_f32_16x16x32_bf16 v[64:67], v[104:107], v[212:215], v[64:67]
ds_read_b64_tr_b16 v[240:241], v15 offset:36864
ds_read_b64_tr_b16 v[242:243], v15 offset:37376
v_mfma_f32_16x16x32_bf16 v[80:83], v[104:107], v[216:219], v[80:83]
buffer_load_dwordx4 v[184:187], v39, s[32:35], s57 offen offset:1024 sc1
v_mfma_f32_16x16x32_bf16 v[68:71], v[108:111], v[212:215], v[68:71]
ds_read_b64_tr_b16 v[244:245], v16 offset:36864
ds_read_b64_tr_b16 v[246:247], v16 offset:37376
v_mfma_f32_16x16x32_bf16 v[84:87], v[108:111], v[216:219], v[84:87]
ds_read_b64_tr_b16 v[248:249], v17 offset:36864
ds_read_b64_tr_b16 v[250:251], v17 offset:37376
v_mfma_f32_16x16x32_bf16 v[72:75], v[112:115], v[212:215], v[72:75]
s_add_u32 s57, s57, 2048
s_and_b32 s57, s57, 0x7fff
v_mfma_f32_16x16x32_bf16 v[88:91], v[112:115], v[216:219], v[88:91]
s_waitcnt vmcnt(6) lgkmcnt(8)
v_mfma_f32_16x16x32_bf16 v[60:63], v[220:223], v[156:159], v[60:63]
buffer_load_dwordx4 v[188:191], v38, s[32:35], s57 offen sc1
v_mfma_f32_16x16x32_bf16 v[76:79], v[220:223], v[160:163], v[76:79]
ds_read_b64_tr_b16 v[100:101], v14 offset:40960
ds_read_b64_tr_b16 v[102:103], v14 offset:41472
v_mfma_f32_16x16x32_bf16 v[64:67], v[224:227], v[156:159], v[64:67]
ds_read_b64_tr_b16 v[104:105], v15 offset:40960
ds_read_b64_tr_b16 v[106:107], v15 offset:41472
v_mfma_f32_16x16x32_bf16 v[80:83], v[224:227], v[160:163], v[80:83]
buffer_load_dwordx4 v[192:195], v39, s[32:35], s57 offen sc1
v_mfma_f32_16x16x32_bf16 v[68:71], v[228:231], v[156:159], v[68:71]
ds_read_b64_tr_b16 v[108:109], v16 offset:40960
ds_read_b64_tr_b16 v[110:111], v16 offset:41472
v_mfma_f32_16x16x32_bf16 v[84:87], v[228:231], v[160:163], v[84:87]
ds_read_b64_tr_b16 v[112:113], v17 offset:40960
ds_read_b64_tr_b16 v[114:115], v17 offset:41472
v_mfma_f32_16x16x32_bf16 v[72:75], v[232:235], v[156:159], v[72:75]
v_mfma_f32_16x16x32_bf16 v[88:91], v[232:235], v[160:163], v[88:91]
s_waitcnt vmcnt(6) lgkmcnt(8)
v_mfma_f32_16x16x32_bf16 v[60:63], v[236:239], v[164:167], v[60:63]
buffer_load_dwordx4 v[196:199], v38, s[32:35], s57 offen offset:1024 sc1
v_mfma_f32_16x16x32_bf16 v[76:79], v[236:239], v[168:171], v[76:79]
ds_read_b64_tr_b16 v[220:221], v14 offset:45056
ds_read_b64_tr_b16 v[222:223], v14 offset:45568
v_mfma_f32_16x16x32_bf16 v[64:67], v[240:243], v[164:167], v[64:67]
ds_read_b64_tr_b16 v[224:225], v15 offset:45056
ds_read_b64_tr_b16 v[226:227], v15 offset:45568
v_mfma_f32_16x16x32_bf16 v[80:83], v[240:243], v[168:171], v[80:83]
buffer_load_dwordx4 v[200:203], v39, s[32:35], s57 offen offset:1024 sc1
v_mfma_f32_16x16x32_bf16 v[68:71], v[244:247], v[164:167], v[68:71]
ds_read_b64_tr_b16 v[228:229], v16 offset:45056
ds_read_b64_tr_b16 v[230:231], v16 offset:45568
v_mfma_f32_16x16x32_bf16 v[84:87], v[244:247], v[168:171], v[84:87]
ds_read_b64_tr_b16 v[232:233], v17 offset:45056
ds_read_b64_tr_b16 v[234:235], v17 offset:45568
v_mfma_f32_16x16x32_bf16 v[72:75], v[248:251], v[164:167], v[72:75]
s_add_u32 s57, s57, 2048
s_and_b32 s57, s57, 0x7fff
v_mfma_f32_16x16x32_bf16 v[88:91], v[248:251], v[168:171], v[88:91]
s_waitcnt vmcnt(6) lgkmcnt(8)
v_mfma_f32_16x16x32_bf16 v[60:63], v[100:103], v[172:175], v[60:63]
buffer_load_dwordx4 v[204:207], v38, s[32:35], s57 offen sc1
v_mfma_f32_16x16x32_bf16 v[76:79], v[100:103], v[176:179], v[76:79]
ds_read_b64_tr_b16 v[236:237], v14 offset:49152
ds_read_b64_tr_b16 v[238:239], v14 offset:49664
v_mfma_f32_16x16x32_bf16 v[64:67], v[104:107], v[172:175], v[64:67]
ds_read_b64_tr_b16 v[240:241], v15 offset:49152
ds_read_b64_tr_b16 v[242:243], v15 offset:49664
v_mfma_f32_16x16x32_bf16 v[80:83], v[104:107], v[176:179], v[80:83]
buffer_load_dwordx4 v[208:211], v39, s[32:35], s57 offen sc1
v_mfma_f32_16x16x32_bf16 v[68:71], v[108:111], v[172:175], v[68:71]
ds_read_b64_tr_b16 v[244:245], v16 offset:49152
ds_read_b64_tr_b16 v[246:247], v16 offset:49664
v_mfma_f32_16x16x32_bf16 v[84:87], v[108:111], v[176:179], v[84:87]
ds_read_b64_tr_b16 v[248:249], v17 offset:49152
ds_read_b64_tr_b16 v[250:251], v17 offset:49664
v_mfma_f32_16x16x32_bf16 v[72:75], v[112:115], v[172:175], v[72:75]
v_mfma_f32_16x16x32_bf16 v[88:91], v[112:115], v[176:179], v[88:91]
s_waitcnt vmcnt(6) lgkmcnt(8)
v_mfma_f32_16x16x32_bf16 v[60:63], v[220:223], v[180:183], v[60:63]
buffer_load_dwordx4 v[212:215], v38, s[32:35], s57 offen offset:1024 sc1
v_mfma_f32_16x16x32_bf16 v[76:79], v[220:223], v[184:187], v[76:79]
ds_read_b64_tr_b16 v[100:101], v14 offset:53248
ds_read_b64_tr_b16 v[102:103], v14 offset:53760
v_mfma_f32_16x16x32_bf16 v[64:67], v[224:227], v[180:183], v[64:67]
ds_read_b64_tr_b16 v[104:105], v15 offset:53248
ds_read_b64_tr_b16 v[106:107], v15 offset:53760
v_mfma_f32_16x16x32_bf16 v[80:83], v[224:227], v[184:187], v[80:83]
buffer_load_dwordx4 v[216:219], v39, s[32:35], s57 offen offset:1024 sc1
v_mfma_f32_16x16x32_bf16 v[68:71], v[228:231], v[180:183], v[68:71]
ds_read_b64_tr_b16 v[108:109], v16 offset:53248
ds_read_b64_tr_b16 v[110:111], v16 offset:53760
v_mfma_f32_16x16x32_bf16 v[84:87], v[228:231], v[184:187], v[84:87]
ds_read_b64_tr_b16 v[112:113], v17 offset:53248
ds_read_b64_tr_b16 v[114:115], v17 offset:53760
v_mfma_f32_16x16x32_bf16 v[72:75], v[232:235], v[180:183], v[72:75]
v_mfma_f32_16x16x32_bf16 v[88:91], v[232:235], v[184:187], v[88:91]
s_waitcnt vmcnt(6) lgkmcnt(8)
v_mfma_f32_16x16x32_bf16 v[60:63], v[236:239], v[188:191], v[60:63]
v_mfma_f32_16x16x32_bf16 v[76:79], v[236:239], v[192:195], v[76:79]
ds_read_b64_tr_b16 v[220:221], v14 offset:57344
ds_read_b64_tr_b16 v[222:223], v14 offset:57856
v_mfma_f32_16x16x32_bf16 v[64:67], v[240:243], v[188:191], v[64:67]
ds_read_b64_tr_b16 v[224:225], v15 offset:57344
ds_read_b64_tr_b16 v[226:227], v15 offset:57856
v_mfma_f32_16x16x32_bf16 v[80:83], v[240:243], v[192:195], v[80:83]
v_mfma_f32_16x16x32_bf16 v[68:71], v[244:247], v[188:191], v[68:71]
ds_read_b64_tr_b16 v[228:229], v16 offset:57344
ds_read_b64_tr_b16 v[230:231], v16 offset:57856
v_mfma_f32_16x16x32_bf16 v[84:87], v[244:247], v[192:195], v[84:87]
ds_read_b64_tr_b16 v[232:233], v17 offset:57344
ds_read_b64_tr_b16 v[234:235], v17 offset:57856
v_mfma_f32_16x16x32_bf16 v[72:75], v[248:251], v[188:191], v[72:75]
v_mfma_f32_16x16x32_bf16 v[88:91], v[248:251], v[192:195], v[88:91]
s_waitcnt vmcnt(4) lgkmcnt(8)
v_mfma_f32_16x16x32_bf16 v[60:63], v[100:103], v[196:199], v[60:63]
v_mfma_f32_16x16x32_bf16 v[76:79], v[100:103], v[200:203], v[76:79]
ds_read_b64_tr_b16 v[236:237], v14 offset:61440
ds_read_b64_tr_b16 v[238:239], v14 offset:61952
v_mfma_f32_16x16x32_bf16 v[64:67], v[104:107], v[196:199], v[64:67]
ds_read_b64_tr_b16 v[240:241], v15 offset:61440
ds_read_b64_tr_b16 v[242:243], v15 offset:61952
v_mfma_f32_16x16x32_bf16 v[80:83], v[104:107], v[200:203], v[80:83]
v_mfma_f32_16x16x32_bf16 v[68:71], v[108:111], v[196:199], v[68:71]
ds_read_b64_tr_b16 v[244:245], v16 offset:61440
ds_read_b64_tr_b16 v[246:247], v16 offset:61952
v_mfma_f32_16x16x32_bf16 v[84:87], v[108:111], v[200:203], v[84:87]
ds_read_b64_tr_b16 v[248:249], v17 offset:61440
ds_read_b64_tr_b16 v[250:251], v17 offset:61952
v_mfma_f32_16x16x32_bf16 v[72:75], v[112:115], v[196:199], v[72:75]
v_mfma_f32_16x16x32_bf16 v[88:91], v[112:115], v[200:203], v[88:91]
s_waitcnt vmcnt(2) lgkmcnt(8)
v_mfma_f32_16x16x32_bf16 v[60:63], v[220:223], v[204:207], v[60:63]
v_mfma_f32_16x16x32_bf16 v[76:79], v[220:223], v[208:211], v[76:79]
v_mfma_f32_16x16x32_bf16 v[64:67], v[224:227], v[204:207], v[64:67]
v_mfma_f32_16x16x32_bf16 v[80:83], v[224:227], v[208:211], v[80:83]
v_mfma_f32_16x16x32_bf16 v[68:71], v[228:231], v[204:207], v[68:71]
v_mfma_f32_16x16x32_bf16 v[84:87], v[228:231], v[208:211], v[84:87]
v_mfma_f32_16x16x32_bf16 v[72:75], v[232:235], v[204:207], v[72:75]
v_mfma_f32_16x16x32_bf16 v[88:91], v[232:235], v[208:211], v[88:91]
s_waitcnt vmcnt(0) lgkmcnt(0)
v_mfma_f32_16x16x32_bf16 v[60:63], v[236:239], v[212:215], v[60:63]
v_mfma_f32_16x16x32_bf16 v[64:67], v[240:243], v[212:215], v[64:67]
v_mfma_f32_16x16x32_bf16 v[68:71], v[244:247], v[212:215], v[68:71]
v_mfma_f32_16x16x32_bf16 v[72:75], v[248:251], v[212:215], v[72:75]
v_mfma_f32_16x16x32_bf16 v[76:79], v[236:239], v[216:219], v[76:79]
v_mfma_f32_16x16x32_bf16 v[80:83], v[240:243], v[216:219], v[80:83]
v_mfma_f32_16x16x32_bf16 v[84:87], v[244:247], v[216:219], v[84:87]
v_mfma_f32_16x16x32_bf16 v[88:91], v[248:251], v[216:219], v[88:91]
s_nop 0
v_cvt_pk_bf16_f32 v20, v60, v61
v_cvt_pk_bf16_f32 v21, v62, v63
v_cvt_pk_bf16_f32 v22, v64, v65
v_cvt_pk_bf16_f32 v23, v66, v67
s_nop 1
v_permlane16_swap_b32 v20, v22
v_permlane16_swap_b32 v21, v23
buffer_store_dwordx4 v[20:23], v40, s[24:27], 0 offen offset:0 sc1
v_cvt_pk_bf16_f32 v24, v68, v69
v_cvt_pk_bf16_f32 v25, v70, v71
v_cvt_pk_bf16_f32 v26, v72, v73
v_cvt_pk_bf16_f32 v27, v74, v75
s_nop 1
v_permlane16_swap_b32 v24, v26
v_permlane16_swap_b32 v25, v27
buffer_store_dwordx4 v[24:27], v40, s[24:27], 0 offen offset:64 sc1
v_cvt_pk_bf16_f32 v28, v76, v77
v_cvt_pk_bf16_f32 v29, v78, v79
v_cvt_pk_bf16_f32 v30, v80, v81
v_cvt_pk_bf16_f32 v31, v82, v83
s_nop 1
v_permlane16_swap_b32 v28, v30
v_permlane16_swap_b32 v29, v31
buffer_store_dwordx4 v[28:31], v41, s[24:27], 0 offen offset:0 sc1
v_cvt_pk_bf16_f32 v32, v84, v85
v_cvt_pk_bf16_f32 v33, v86, v87
v_cvt_pk_bf16_f32 v34, v88, v89
v_cvt_pk_bf16_f32 v35, v90, v91
s_nop 1
v_permlane16_swap_b32 v32, v34
v_permlane16_swap_b32 v33, v35
buffer_store_dwordx4 v[32:35], v41, s[24:27], 0 offen offset:64 sc1
s_endpgm
L_code_end:
again_6:
s_mov_b32 s63, 0
retry_8:
buffer_load_dwordx4 v[80:83], v37, s[32:35], 0 offen offset:0 sc1
buffer_load_dwordx4 v[84:87], v37, s[32:35], 0 offen offset:1024 sc1
buffer_load_dwordx4 v[88:91], v37, s[32:35], 0 offen offset:2048 sc1
buffer_load_dwordx4 v[92:95], v37, s[32:35], 0 offen offset:3072 sc1
s_waitcnt vmcnt(0)
v_add_f32 v80, v80, v88
v_add_f32 v81, v81, v89
v_add_f32 v82, v82, v90
v_add_f32 v83, v83, v91
v_add_f32 v84, v84, v92
v_add_f32 v85, v85, v93
v_add_f32 v86, v86, v94
v_add_f32 v87, v87, v95
v_add_f32 v80, v80, v84
v_add_f32 v81, v81, v85
v_add_f32 v82, v82, v86
v_add_f32 v83, v83, v87
s_nop 1
v_permlane32_swap_b32 v80, v81
v_permlane32_swap_b32 v82, v83
v_add_f32 v80, v80, v81
v_add_f32 v82, v82, v83
s_nop 1
v_permlane16_swap_b32 v80, v82
s_nop 0
v_add_f32 v80, v80, v82
v_cmp_u_f32 vcc, v80, v80
s_cbranch_vccz summed_7
s_add_u32 s63, s63, 1
s_cmp_lt_u32 s63, 0x10000
s_cbranch_scc1 retry_8
s_branch summed_7
again_9:
s_mov_b32 s63, 0
retry_11:
buffer_load_dwordx4 v[64:67], v38, s[32:35], 0 offen offset:0 sc1
buffer_load_dwordx4 v[68:71], v38, s[32:35], 0 offen offset:1024 sc1
buffer_load_dwordx4 v[72:75], v38, s[32:35], 0 offen offset:2048 sc1
buffer_load_dwordx4 v[76:79], v38, s[32:35], 0 offen offset:3072 sc1
s_waitcnt vmcnt(0)
v_add_f32 v64, v64, v72
v_add_f32 v65, v65, v73
v_add_f32 v66, v66, v74
v_add_f32 v67, v67, v75
v_add_f32 v68, v68, v76
v_add_f32 v69, v69, v77
v_add_f32 v70, v70, v78
v_add_f32 v71, v71, v79
v_add_f32 v64, v64, v68
v_add_f32 v65, v65, v69
v_add_f32 v66, v66, v70
v_add_f32 v67, v67, v71
s_nop 1
v_permlane32_swap_b32 v64, v65
v_permlane32_swap_b32 v66, v67
v_add_f32 v64, v64, v65
v_add_f32 v66, v66, v67
s_nop 1
v_permlane16_swap_b32 v64, v66
s_nop 0
v_add_f32 v64, v64, v66
v_cmp_u_f32 vcc, v64, v64
s_cbranch_vccz summed_10
s_add_u32 s63, s63, 1
s_cmp_lt_u32 s63, 0x10000
s_cbranch_scc1 retry_11
s_branch summed_10
again_17:
s_mov_b32 s63, 0
retry_19:
buffer_load_dwordx4 v[80:83], v37, s[32:35], 0 offen offset:0 sc1
buffer_load_dwordx4 v[84:87], v37, s[32:35], 0 offen offset:1024 sc1
buffer_load_dwordx4 v[88:91], v37, s[32:35], 0 offen offset:2048 sc1
buffer_load_dwordx4 v[92:95], v37, s[32:35], 0 offen offset:3072 sc1
s_waitcnt vmcnt(0)
v_add_f32 v80, v80, v88
v_add_f32 v81, v81, v89
v_add_f32 v82, v82, v90
v_add_f32 v83, v83, v91
v_add_f32 v84, v84, v92
v_add_f32 v85, v85, v93
v_add_f32 v86, v86, v94
v_add_f32 v87, v87, v95
v_add_f32 v80, v80, v84
v_add_f32 v81, v81, v85
v_add_f32 v82, v82, v86
v_add_f32 v83, v83, v87
s_nop 1
v_permlane32_swap_b32 v80, v81
v_permlane32_swap_b32 v82, v83
v_add_f32 v80, v80, v81
v_add_f32 v82, v82, v83
s_nop 1
v_permlane16_swap_b32 v80, v82
s_nop 0
v_add_f32 v80, v80, v82
v_cmp_u_f32 vcc, v80, v80
s_cbranch_vccz summed_18
s_add_u32 s63, s63, 1
s_cmp_lt_u32 s63, 0x10000
s_cbranch_scc1 retry_19
s_branch summed_18
again_20:
s_mov_b32 s63, 0
retry_22:
buffer_load_dwordx4 v[64:67], v38, s[32:35], 0 offen offset:0 sc1
buffer_load_dwordx4 v[68:71], v38, s[32:35], 0 offen offset:1024 sc1
buffer_load_dwordx4 v[72:75], v38, s[32:35], 0 offen offset:2048 sc1
buffer_load_dwordx4 v[76:79], v38, s[32:35], 0 offen offset:3072 sc1
s_waitcnt vmcnt(0)
v_add_f32 v64, v64, v72
v_add_f32 v65, v65, v73
v_add_f32 v66, v66, v74
v_add_f32 v67, v67, v75
v_add_f32 v68, v68, v76
v_add_f32 v69, v69, v77
v_add_f32 v70, v70, v78
v_add_f32 v71, v71, v79
v_add_f32 v64, v64, v68
v_add_f32 v65, v65, v69
v_add_f32 v66, v66, v70
v_add_f32 v67, v67, v71
s_nop 1
v_permlane32_swap_b32 v64, v65
v_permlane32_swap_b32 v66, v67
v_add_f32 v64, v64, v65
v_add_f32 v66, v66, v67
s_nop 1
v_permlane16_swap_b32 v64, v66
s_nop 0
v_add_f32 v64, v64, v66
v_cmp_u_f32 vcc, v64, v64
s_cbranch_vccz summed_21
s_add_u32 s63, s63, 1
s_cmp_lt_u32 s63, 0x10000
s_cbranch_scc1 retry_22
s_branch summed_21
again_26:
s_mov_b32 s63, 0
retry_28:
buffer_load_dwordx4 v[80:83], v37, s[32:35], 0 offen offset:0 sc1
buffer_load_dwordx4 v[84:87], v37, s[32:35], 0 offen offset:1024 sc1
buffer_load_dwordx4 v[88:91], v37, s[32:35], 0 offen offset:2048 sc1
buffer_load_dwordx4 v[92:95], v37, s[32:35], 0 offen offset:3072 sc1
s_waitcnt vmcnt(0)
v_add_f32 v80, v80, v88
v_add_f32 v81, v81, v89
v_add_f32 v82, v82, v90
v_add_f32 v83, v83, v91
v_add_f32 v84, v84, v92
v_add_f32 v85, v85, v93
v_add_f32 v86, v86, v94
v_add_f32 v87, v87, v95
v_add_f32 v80, v80, v84
v_add_f32 v81, v81, v85
v_add_f32 v82, v82, v86
v_add_f32 v83, v83, v87
s_nop 1
v_permlane32_swap_b32 v80, v81
v_permlane32_swap_b32 v82, v83
v_add_f32 v80, v80, v81
v_add_f32 v82, v82, v83
s_nop 1
v_permlane16_swap_b32 v80, v82
s_nop 0
v_add_f32 v80, v80, v82
v_cmp_u_f32 vcc, v80, v80
s_cbranch_vccz summed_27
s_add_u32 s63, s63, 1
s_cmp_lt_u32 s63, 0x10000
s_cbranch_scc1 retry_28
s_branch summed_27
again_32:
s_mov_b32 s63, 0
retry_34:
buffer_load_dwordx4 v[80:83], v37, s[32:35], 0 offen offset:0 sc1
buffer_load_dwordx4 v[84:87], v37, s[32:35], 0 offen offset:1024 sc1
buffer_load_dwordx4 v[88:91], v37, s[32:35], 0 offen offset:2048 sc1
buffer_load_dwordx4 v[92:95], v37, s[32:35], 0 offen offset:3072 sc1
s_waitcnt vmcnt(0)
v_add_f32 v80, v80, v88
v_add_f32 v81, v81, v89
v_add_f32 v82, v82, v90
v_add_f32 v83, v83, v91
v_add_f32 v84, v84, v92
v_add_f32 v85, v85, v93
v_add_f32 v86, v86, v94
v_add_f32 v87, v87, v95
v_add_f32 v80, v80, v84
v_add_f32 v81, v81, v85
v_add_f32 v82, v82, v86
v_add_f32 v83, v83, v87
s_nop 1
v_permlane32_swap_b32 v80, v81
v_permlane32_swap_b32 v82, v83
v_add_f32 v80, v80, v81
v_add_f32 v82, v82, v83
s_nop 1
v_permlane16_swap_b32 v80, v82
s_nop 0
v_add_f32 v80, v80, v82
v_cmp_u_f32 vcc, v80, v80
s_cbranch_vccz summed_33
s_add_u32 s63, s63, 1
s_cmp_lt_u32 s63, 0x10000
s_cbranch_scc1 retry_34
s_branch summed_33
slow_51:
.p2align 3
v_pk_mul_f32 v[220:221], v[220:221], v[160:161] op_sel:[0,0] op_sel_hi:[1,0]
v_pk_mul_f32 v[222:223], v[222:223], v[160:161] op_sel:[0,0] op_sel_hi:[1,0]
v_pk_mul_f32 v[224:225], v[224:225], v[160:161] op_sel:[0,0] op_sel_hi:[1,0]
v_pk_mul_f32 v[226:227], v[226:227], v[160:161] op_sel:[0,0] op_sel_hi:[1,0]
v_cvt_pk_bf16_f32 v220, v220, v221
v_cvt_pk_bf16_f32 v221, v222, v223
v_cvt_pk_bf16_f32 v222, v224, v225
v_cvt_pk_bf16_f32 v223, v226, v227
buffer_store_dwordx4 v[220:223], v18, s[32:35], s80 offen sc1
v_pk_mul_f32 v[228:229], v[228:229], v[168:169] op_sel:[0,0] op_sel_hi:[1,0]
v_pk_mul_f32 v[230:231], v[230:231], v[168:169] op_sel:[0,0] op_sel_hi:[1,0]
v_pk_mul_f32 v[232:233], v[232:233], v[168:169] op_sel:[0,0] op_sel_hi:[1,0]
v_pk_mul_f32 v[234:235], v[234:235], v[168:169] op_sel:[0,0] op_sel_hi:[1,0]
v_cvt_pk_bf16_f32 v228, v228, v229
v_cvt_pk_bf16_f32 v229, v230, v231
v_cvt_pk_bf16_f32 v230, v232, v233
v_cvt_pk_bf16_f32 v231, v234, v235
buffer_store_dwordx4 v[228:231], v18, s[32:35], s81 offen sc1
v_pk_mul_f32 v[236:237], v[236:237], v[176:177] op_sel:[0,0] op_sel_hi:[1,0]
v_pk_mul_f32 v[238:239], v[238:239], v[176:177] op_sel:[0,0] op_sel_hi:[1,0]
v_pk_mul_f32 v[240:241], v[240:241], v[176:177] op_sel:[0,0] op_sel_hi:[1,0]
v_pk_mul_f32 v[242:243], v[242:243], v[176:177] op_sel:[0,0] op_sel_hi:[1,0]
v_cvt_pk_bf16_f32 v236, v236, v237
v_cvt_pk_bf16_f32 v237, v238, v239
v_cvt_pk_bf16_f32 v238, v240, v241
v_cvt_pk_bf16_f32 v239, v242, v243
buffer_store_dwordx4 v[236:239], v18, s[32:35], s82 offen sc1
v_pk_mul_f32 v[244:245], v[244:245], v[184:185] op_sel:[0,0] op_sel_hi:[1,0]
v_pk_mul_f32 v[246:247], v[246:247], v[184:185] op_sel:[0,0] op_sel_hi:[1,0]
v_pk_mul_f32 v[248:249], v[248:249], v[184:185] op_sel:[0,0] op_sel_hi:[1,0]
v_pk_mul_f32 v[250:251], v[250:251], v[184:185] op_sel:[0,0] op_sel_hi:[1,0]
v_cvt_pk_bf16_f32 v244, v244, v245
v_cvt_pk_bf16_f32 v245, v246, v247
v_cvt_pk_bf16_f32 v246, v248, v249
v_cvt_pk_bf16_f32 v247, v250, v251
buffer_store_dwordx4 v[244:247], v18, s[32:35], s83 offen sc1
s_barrier
s_lshl_b32 s62, s45, 2
v_mov_b32 v4, s62
v_mov_b32 v5, 1
s_mov_b64 exec, 1
s_waitcnt vmcnt(0)
buffer_store_dword v5, v4, s[32:35], s84 offen sc1
s_mov_b64 exec, -1
s_branch back_52
slow_55:
s_nop 0
v_cvt_pk_bf16_f32 v20, v60, v61
v_cvt_pk_bf16_f32 v21, v62, v63
v_cvt_pk_bf16_f32 v22, v64, v65
v_cvt_pk_bf16_f32 v23, v66, v67
buffer_store_dwordx4 v[20:23], v18, s[32:35], s85 offen offset:0 sc1
v_cvt_pk_bf16_f32 v24, v68, v69
v_cvt_pk_bf16_f32 v25, v70, v71
v_cvt_pk_bf16_f32 v26, v72, v73
v_cvt_pk_bf16_f32 v27, v74, v75
buffer_store_dwordx4 v[24:27], v18, s[32:35], s85 offen offset:1024 sc1
v_cvt_pk_bf16_f32 v28, v76, v77
v_cvt_pk_bf16_f32 v29, v78, v79
v_cvt_pk_bf16_f32 v30, v80, v81
v_cvt_pk_bf16_f32 v31, v82, v83
buffer_store_dwordx4 v[28:31], v18, s[32:35], s86 offen offset:0 sc1
v_cvt_pk_bf16_f32 v32, v84, v85
v_cvt_pk_bf16_f32 v33, v86, v87
v_cvt_pk_bf16_f32 v34, v88, v89
v_cvt_pk_bf16_f32 v35, v90, v91
buffer_store_dwordx4 v[32:35], v18, s[32:35], s86 offen offset:1024 sc1
s_barrier
v_dot2c_f32_bf16 v6, v20, v48
v_dot2c_f32_bf16 v8, v20, v20
v_dot2c_f32_bf16 v7, v28, v48
v_dot2c_f32_bf16 v9, v28, v28
v_dot2c_f32_bf16 v6, v21, v48
v_dot2c_f32_bf16 v8, v21, v21
v_dot2c_f32_bf16 v7, v29, v48
v_dot2c_f32_bf16 v9, v29, v29
v_dot2c_f32_bf16 v6, v22, v48
v_dot2c_f32_bf16 v8, v22, v22
v_dot2c_f32_bf16 v7, v30, v48
v_dot2c_f32_bf16 v9, v30, v30
v_dot2c_f32_bf16 v6, v23, v48
v_dot2c_f32_bf16 v8, v23, v23
v_dot2c_f32_bf16 v7, v31, v48
v_dot2c_f32_bf16 v9, v31, v31
v_dot2c_f32_bf16 v6, v24, v48
v_dot2c_f32_bf16 v8, v24, v24
v_dot2c_f32_bf16 v7, v32, v48
v_dot2c_f32_bf16 v9, v32, v32
v_dot2c_f32_bf16 v6, v25, v48
v_dot2c_f32_bf16 v8, v25, v25
v_dot2c_f32_bf16 v7, v33, v48
v_dot2c_f32_bf16 v9, v33, v33
v_dot2c_f32_bf16 v6, v26, v48
v_dot2c_f32_bf16 v8, v26, v26
v_dot2c_f32_bf16 v7, v34, v48
v_dot2c_f32_bf16 v9, v34, v34
v_dot2c_f32_bf16 v6, v27, v48
v_dot2c_f32_bf16 v8, v27, v27
v_dot2c_f32_bf16 v7, v35, v48
v_dot2c_f32_bf16 v9, v35, v35
s_mov_b64 exec, 1
s_waitcnt vmcnt(0)
buffer_store_dword v5, v4, s[32:35], s88 offen sc1
s_mov_b64 exec, -1
s_nop 1
v_permlane32_swap_b32 v6, v7
v_permlane32_swap_b32 v8, v9
v_add_f32 v6, v6, v7
v_add_f32 v8, v8, v9
s_nop 1
v_permlane16_swap_b32 v6, v8
s_nop 0
v_add_f32 v6, v6, v8
buffer_store_dword v6, v1, s[32:35], s87 offen sc1
s_branch back_56
slow_73:
.p2align 3
v_pk_mul_f32 v[156:157], v[156:157], v[100:101] op_sel:[0,0] op_sel_hi:[1,0]
v_pk_mul_f32 v[158:159], v[158:159], v[100:101] op_sel:[0,0] op_sel_hi:[1,0]
v_pk_mul_f32 v[160:161], v[160:161], v[100:101] op_sel:[0,0] op_sel_hi:[1,0]
v_pk_mul_f32 v[162:163], v[162:163], v[100:101] op_sel:[0,0] op_sel_hi:[1,0]
v_cvt_pk_bf16_f32 v156, v156, v157
v_cvt_pk_bf16_f32 v157, v158, v159
v_cvt_pk_bf16_f32 v158, v160, v161
v_cvt_pk_bf16_f32 v159, v162, v163
buffer_store_dwordx4 v[156:159], v18, s[32:35], s80 offen sc1
v_pk_mul_f32 v[164:165], v[164:165], v[100:101] op_sel:[0,1] op_sel_hi:[1,1]
v_pk_mul_f32 v[166:167], v[166:167], v[100:101] op_sel:[0,1] op_sel_hi:[1,1]
v_pk_mul_f32 v[168:169], v[168:169], v[100:101] op_sel:[0,1] op_sel_hi:[1,1]
v_pk_mul_f32 v[170:171], v[170:171], v[100:101] op_sel:[0,1] op_sel_hi:[1,1]
v_cvt_pk_bf16_f32 v164, v164, v165
v_cvt_pk_bf16_f32 v165, v166, v167
v_cvt_pk_bf16_f32 v166, v168, v169
v_cvt_pk_bf16_f32 v167, v170, v171
buffer_store_dwordx4 v[164:167], v18, s[32:35], s81 offen sc1
v_pk_mul_f32 v[172:173], v[172:173], v[102:103] op_sel:[0,0] op_sel_hi:[1,0]
v_pk_mul_f32 v[174:175], v[174:175], v[102:103] op_sel:[0,0] op_sel_hi:[1,0]
v_pk_mul_f32 v[176:177], v[176:177], v[102:103] op_sel:[0,0] op_sel_hi:[1,0]
v_pk_mul_f32 v[178:179], v[178:179], v[102:103] op_sel:[0,0] op_sel_hi:[1,0]
v_cvt_pk_bf16_f32 v172, v172, v173
v_cvt_pk_bf16_f32 v173, v174, v175
v_cvt_pk_bf16_f32 v174, v176, v177
v_cvt_pk_bf16_f32 v175, v178, v179
buffer_store_dwordx4 v[172:175], v18, s[32:35], s82 offen sc1
v_pk_mul_f32 v[180:181], v[180:181], v[102:103] op_sel:[0,1] op_sel_hi:[1,1]
v_pk_mul_f32 v[182:183], v[182:183], v[102:103] op_sel:[0,1] op_sel_hi:[1,1]
v_pk_mul_f32 v[184:185], v[184:185], v[102:103] op_sel:[0,1] op_sel_hi:[1,1]
v_pk_mul_f32 v[186:187], v[186:187], v[102:103] op_sel:[0,1] op_sel_hi:[1,1]
v_cvt_pk_bf16_f32 v180, v180, v181
v_cvt_pk_bf16_f32 v181, v182, v183
v_cvt_pk_bf16_f32 v182, v184, v185
v_cvt_pk_bf16_f32 v183, v186, v187
buffer_store_dwordx4 v[180:183], v18, s[32:35], s83 offen sc1
s_barrier
s_lshl_b32 s62, s45, 2
v_mov_b32 v4, s62
v_mov_b32 v5, 2
s_mov_b64 exec, 1
s_waitcnt vmcnt(0)
buffer_store_dword v5, v4, s[32:35], s84 offen sc1
s_mov_b64 exec, -1
s_branch back_74
slow_77:
s_nop 0
v_cvt_pk_bf16_f32 v20, v60, v61
v_cvt_pk_bf16_f32 v21, v62, v63
v_cvt_pk_bf16_f32 v22, v64, v65
v_cvt_pk_bf16_f32 v23, v66, v67
buffer_store_dwordx4 v[20:23], v18, s[32:35], s85 offen offset:0 sc1
v_cvt_pk_bf16_f32 v24, v68, v69
v_cvt_pk_bf16_f32 v25, v70, v71
v_cvt_pk_bf16_f32 v26, v72, v73
v_cvt_pk_bf16_f32 v27, v74, v75
buffer_store_dwordx4 v[24:27], v18, s[32:35], s85 offen offset:1024 sc1
v_cvt_pk_bf16_f32 v28, v76, v77
v_cvt_pk_bf16_f32 v29, v78, v79
v_cvt_pk_bf16_f32 v30, v80, v81
v_cvt_pk_bf16_f32 v31, v82, v83
buffer_store_dwordx4 v[28:31], v18, s[32:35], s86 offen offset:0 sc1
v_cvt_pk_bf16_f32 v32, v84, v85
v_cvt_pk_bf16_f32 v33, v86, v87
v_cvt_pk_bf16_f32 v34, v88, v89
v_cvt_pk_bf16_f32 v35, v90, v91
buffer_store_dwordx4 v[32:35], v18, s[32:35], s86 offen offset:1024 sc1
s_barrier
v_dot2c_f32_bf16 v6, v20, v48
v_dot2c_f32_bf16 v8, v20, v20
v_dot2c_f32_bf16 v7, v28, v48
v_dot2c_f32_bf16 v9, v28, v28
v_dot2c_f32_bf16 v6, v21, v48
v_dot2c_f32_bf16 v8, v21, v21
v_dot2c_f32_bf16 v7, v29, v48
v_dot2c_f32_bf16 v9, v29, v29
v_dot2c_f32_bf16 v6, v22, v48
v_dot2c_f32_bf16 v8, v22, v22
v_dot2c_f32_bf16 v7, v30, v48
v_dot2c_f32_bf16 v9, v30, v30
v_dot2c_f32_bf16 v6, v23, v48
v_dot2c_f32_bf16 v8, v23, v23
v_dot2c_f32_bf16 v7, v31, v48
v_dot2c_f32_bf16 v9, v31, v31
v_dot2c_f32_bf16 v6, v24, v48
v_dot2c_f32_bf16 v8, v24, v24
v_dot2c_f32_bf16 v7, v32, v48
v_dot2c_f32_bf16 v9, v32, v32
v_dot2c_f32_bf16 v6, v25, v48
v_dot2c_f32_bf16 v8, v25, v25
v_dot2c_f32_bf16 v7, v33, v48
v_dot2c_f32_bf16 v9, v33, v33
v_dot2c_f32_bf16 v6, v26, v48
v_dot2c_f32_bf16 v8, v26, v26
v_dot2c_f32_bf16 v7, v34, v48
v_dot2c_f32_bf16 v9, v34, v34
v_dot2c_f32_bf16 v6, v27, v48
v_dot2c_f32_bf16 v8, v27, v27
v_dot2c_f32_bf16 v7, v35, v48
v_dot2c_f32_bf16 v9, v35, v35
s_mov_b64 exec, 1
s_waitcnt vmcnt(0)
buffer_store_dword v5, v4, s[32:35], s88 offen sc1
s_mov_b64 exec, -1
s_nop 1
v_permlane32_swap_b32 v6, v7
v_permlane32_swap_b32 v8, v9
v_add_f32 v6, v6, v7
v_add_f32 v8, v8, v9
s_nop 1
v_permlane16_swap_b32 v6, v8
s_nop 0
v_add_f32 v6, v6, v8
buffer_store_dword v6, v1, s[32:35], s87 offen sc1
s_branch back_78
slow_89:
.p2align 3
v_pk_mul_f32 v[220:221], v[220:221], v[160:161] op_sel:[0,0] op_sel_hi:[1,0]
v_pk_mul_f32 v[222:223], v[222:223], v[160:161] op_sel:[0,0] op_sel_hi:[1,0]
v_pk_mul_f32 v[224:225], v[224:225], v[160:161] op_sel:[0,0] op_sel_hi:[1,0]
v_pk_mul_f32 v[226:227], v[226:227], v[160:161] op_sel:[0,0] op_sel_hi:[1,0]
v_cvt_pk_bf16_f32 v220, v220, v221
v_cvt_pk_bf16_f32 v221, v222, v223
v_cvt_pk_bf16_f32 v222, v224, v225
v_cvt_pk_bf16_f32 v223, v226, v227
buffer_store_dwordx4 v[220:223], v18, s[32:35], s80 offen sc1
v_pk_mul_f32 v[228:229], v[228:229], v[168:169] op_sel:[0,0] op_sel_hi:[1,0]
v_pk_mul_f32 v[230:231], v[230:231], v[168:169] op_sel:[0,0] op_sel_hi:[1,0]
v_pk_mul_f32 v[232:233], v[232:233], v[168:169] op_sel:[0,0] op_sel_hi:[1,0]
v_pk_mul_f32 v[234:235], v[234:235], v[168:169] op_sel:[0,0] op_sel_hi:[1,0]
v_cvt_pk_bf16_f32 v228, v228, v229
v_cvt_pk_bf16_f32 v229, v230, v231
v_cvt_pk_bf16_f32 v230, v232, v233
v_cvt_pk_bf16_f32 v231, v234, v235
buffer_store_dwordx4 v[228:231], v18, s[32:35], s81 offen sc1
v_pk_mul_f32 v[236:237], v[236:237], v[176:177] op_sel:[0,0] op_sel_hi:[1,0]
v_pk_mul_f32 v[238:239], v[238:239], v[176:177] op_sel:[0,0] op_sel_hi:[1,0]
v_pk_mul_f32 v[240:241], v[240:241], v[176:177] op_sel:[0,0] op_sel_hi:[1,0]
v_pk_mul_f32 v[242:243], v[242:243], v[176:177] op_sel:[0,0] op_sel_hi:[1,0]
v_cvt_pk_bf16_f32 v236, v236, v237
v_cvt_pk_bf16_f32 v237, v238, v239
v_cvt_pk_bf16_f32 v238, v240, v241
v_cvt_pk_bf16_f32 v239, v242, v243
buffer_store_dwordx4 v[236:239], v18, s[32:35], s82 offen sc1
v_pk_mul_f32 v[244:245], v[244:245], v[184:185] op_sel:[0,0] op_sel_hi:[1,0]
v_pk_mul_f32 v[246:247], v[246:247], v[184:185] op_sel:[0,0] op_sel_hi:[1,0]
v_pk_mul_f32 v[248:249], v[248:249], v[184:185] op_sel:[0,0] op_sel_hi:[1,0]
v_pk_mul_f32 v[250:251], v[250:251], v[184:185] op_sel:[0,0] op_sel_hi:[1,0]
v_cvt_pk_bf16_f32 v244, v244, v245
v_cvt_pk_bf16_f32 v245, v246, v247
v_cvt_pk_bf16_f32 v246, v248, v249
v_cvt_pk_bf16_f32 v247, v250, v251
buffer_store_dwordx4 v[244:247], v18, s[32:35], s83 offen sc1
s_barrier
s_lshl_b32 s62, s45, 2
v_mov_b32 v4, s62
v_mov_b32 v5, 3
s_mov_b64 exec, 1
s_waitcnt vmcnt(0)
buffer_store_dword v5, v4, s[32:35], s84 offen sc1
s_mov_b64 exec, -1
s_branch back_90
slow_93:
s_nop 0
v_cvt_pk_bf16_f32 v20, v60, v61
v_cvt_pk_bf16_f32 v21, v62, v63
v_cvt_pk_bf16_f32 v22, v64, v65
v_cvt_pk_bf16_f32 v23, v66, v67
buffer_store_dwordx4 v[20:23], v18, s[32:35], s85 offen offset:0 sc1
v_cvt_pk_bf16_f32 v24, v68, v69
v_cvt_pk_bf16_f32 v25, v70, v71
v_cvt_pk_bf16_f32 v26, v72, v73
v_cvt_pk_bf16_f32 v27, v74, v75
buffer_store_dwordx4 v[24:27], v18, s[32:35], s85 offen offset:1024 sc1
v_cvt_pk_bf16_f32 v28, v76, v77
v_cvt_pk_bf16_f32 v29, v78, v79
v_cvt_pk_bf16_f32 v30, v80, v81
v_cvt_pk_bf16_f32 v31, v82, v83
buffer_store_dwordx4 v[28:31], v18, s[32:35], s86 offen offset:0 sc1
v_cvt_pk_bf16_f32 v32, v84, v85
v_cvt_pk_bf16_f32 v33, v86, v87
v_cvt_pk_bf16_f32 v34, v88, v89
v_cvt_pk_bf16_f32 v35, v90, v91
buffer_store_dwordx4 v[32:35], v18, s[32:35], s86 offen offset:1024 sc1
s_barrier
v_dot2c_f32_bf16 v6, v20, v48
v_dot2c_f32_bf16 v8, v20, v20
v_dot2c_f32_bf16 v7, v28, v48
v_dot2c_f32_bf16 v9, v28, v28
v_dot2c_f32_bf16 v6, v21, v48
v_dot2c_f32_bf16 v8, v21, v21
v_dot2c_f32_bf16 v7, v29, v48
v_dot2c_f32_bf16 v9, v29, v29
v_dot2c_f32_bf16 v6, v22, v48
v_dot2c_f32_bf16 v8, v22, v22
v_dot2c_f32_bf16 v7, v30, v48
v_dot2c_f32_bf16 v9, v30, v30
v_dot2c_f32_bf16 v6, v23, v48
v_dot2c_f32_bf16 v8, v23, v23
v_dot2c_f32_bf16 v7, v31, v48
v_dot2c_f32_bf16 v9, v31, v31
v_dot2c_f32_bf16 v6, v24, v48
v_dot2c_f32_bf16 v8, v24, v24
v_dot2c_f32_bf16 v7, v32, v48
v_dot2c_f32_bf16 v9, v32, v32
v_dot2c_f32_bf16 v6, v25, v48
v_dot2c_f32_bf16 v8, v25, v25
v_dot2c_f32_bf16 v7, v33, v48
v_dot2c_f32_bf16 v9, v33, v33
v_dot2c_f32_bf16 v6, v26, v48
v_dot2c_f32_bf16 v8, v26, v26
v_dot2c_f32_bf16 v7, v34, v48
v_dot2c_f32_bf16 v9, v34, v34
v_dot2c_f32_bf16 v6, v27, v48
v_dot2c_f32_bf16 v8, v27, v27
v_dot2c_f32_bf16 v7, v35, v48
v_dot2c_f32_bf16 v9, v35, v35
s_mov_b64 exec, 1
s_waitcnt vmcnt(0)
buffer_store_dword v5, v4, s[32:35], s88 offen sc1
s_mov_b64 exec, -1
s_nop 1
v_permlane32_swap_b32 v6, v7
v_permlane32_swap_b32 v8, v9
v_add_f32 v6, v6, v7
v_add_f32 v8, v8, v9
s_nop 1
v_permlane16_swap_b32 v6, v8
s_nop 0
v_add_f32 v6, v6, v8
buffer_store_dword v6, v1, s[32:35], s87 offen sc1
s_branch back_94
slow_109:
.p2align 3
v_pk_mul_f32 v[156:157], v[156:157], v[100:101] op_sel:[0,0] op_sel_hi:[1,0]
v_pk_mul_f32 v[158:159], v[158:159], v[100:101] op_sel:[0,0] op_sel_hi:[1,0]
v_pk_mul_f32 v[160:161], v[160:161], v[100:101] op_sel:[0,0] op_sel_hi:[1,0]
v_pk_mul_f32 v[162:163], v[162:163], v[100:101] op_sel:[0,0] op_sel_hi:[1,0]
v_cvt_pk_bf16_f32 v156, v156, v157
v_cvt_pk_bf16_f32 v157, v158, v159
v_cvt_pk_bf16_f32 v158, v160, v161
v_cvt_pk_bf16_f32 v159, v162, v163
buffer_store_dwordx4 v[156:159], v18, s[32:35], s80 offen sc1
v_pk_mul_f32 v[164:165], v[164:165], v[100:101] op_sel:[0,1] op_sel_hi:[1,1]
v_pk_mul_f32 v[166:167], v[166:167], v[100:101] op_sel:[0,1] op_sel_hi:[1,1]
v_pk_mul_f32 v[168:169], v[168:169], v[100:101] op_sel:[0,1] op_sel_hi:[1,1]
v_pk_mul_f32 v[170:171], v[170:171], v[100:101] op_sel:[0,1] op_sel_hi:[1,1]
v_cvt_pk_bf16_f32 v164, v164, v165
v_cvt_pk_bf16_f32 v165, v166, v167
v_cvt_pk_bf16_f32 v166, v168, v169
v_cvt_pk_bf16_f32 v167, v170, v171
buffer_store_dwordx4 v[164:167], v18, s[32:35], s81 offen sc1
v_pk_mul_f32 v[172:173], v[172:173], v[102:103] op_sel:[0,0] op_sel_hi:[1,0]
v_pk_mul_f32 v[174:175], v[174:175], v[102:103] op_sel:[0,0] op_sel_hi:[1,0]
v_pk_mul_f32 v[176:177], v[176:177], v[102:103] op_sel:[0,0] op_sel_hi:[1,0]
v_pk_mul_f32 v[178:179], v[178:179], v[102:103] op_sel:[0,0] op_sel_hi:[1,0]
v_cvt_pk_bf16_f32 v172, v172, v173
v_cvt_pk_bf16_f32 v173, v174, v175
v_cvt_pk_bf16_f32 v174, v176, v177
v_cvt_pk_bf16_f32 v175, v178, v179
buffer_store_dwordx4 v[172:175], v18, s[32:35], s82 offen sc1
v_pk_mul_f32 v[180:181], v[180:181], v[102:103] op_sel:[0,1] op_sel_hi:[1,1]
v_pk_mul_f32 v[182:183], v[182:183], v[102:103] op_sel:[0,1] op_sel_hi:[1,1]
v_pk_mul_f32 v[184:185], v[184:185], v[102:103] op_sel:[0,1] op_sel_hi:[1,1]
v_pk_mul_f32 v[186:187], v[186:187], v[102:103] op_sel:[0,1] op_sel_hi:[1,1]
v_cvt_pk_bf16_f32 v180, v180, v181
v_cvt_pk_bf16_f32 v181, v182, v183
v_cvt_pk_bf16_f32 v182, v184, v185
v_cvt_pk_bf16_f32 v183, v186, v187
buffer_store_dwordx4 v[180:183], v18, s[32:35], s83 offen sc1
s_barrier
s_lshl_b32 s62, s45, 2
v_mov_b32 v4, s62
v_mov_b32 v5, 4
s_mov_b64 exec, 1
s_waitcnt vmcnt(0)
buffer_store_dword v5, v4, s[32:35], s84 offen sc1
s_mov_b64 exec, -1
s_branch back_110
s_endpgm
.section .rodata,"a"
.p2align 6
.amdhsa_kernel interleave_layers__sliding_local_dilated__linear_kernel_hedgehog__prompt_kernel
  .amdhsa_next_free_vgpr 256
  .amdhsa_next_free_sgpr 102
  .amdhsa_accum_offset 256
  .amdhsa_group_segment_fixed_size 0
  .amdhsa_kernarg_size 80
  .amdhsa_user_sgpr_count 2
  .amdhsa_user_sgpr_kernarg_segment_ptr 1
  .amdhsa_system_sgpr_workgroup_id_x 1
.end_amdhsa_kernel
```

```asm
; @launch grid=(256,1,1) block=(512,1,1) lds=163840
.amdgcn_target "amdgcn-amd-amdhsa--gfx950"
.text
.globl interleave_layers__sliding_local_dilated__linear_kernel_hedgehog__prompt_kernel
.p2align 8
.type interleave_layers__sliding_local_dilated__linear_kernel_hedgehog__prompt_kernel,@function
interleave_layers__sliding_local_dilated__linear_kernel_hedgehog__prompt_kernel:
s_cmp_ge_u32 s2, 256
s_cbranch_scc1 L_end
s_load_dwordx16 s[4:19], s[0:1], 0
s_load_dwordx4 s[20:23], s[0:1], 64
v_lshrrev_b32 v1, 6, v0
v_and_b32 v0, 63, v0
v_readfirstlane_b32 s40, v1
v_and_b32 v2, 15, v0
v_lshrrev_b32 v3, 4, v0
v_lshlrev_b32 v18, 4, v0
s_and_b32 s48, s2, 7
s_lshr_b32 s49, s2, 3
s_and_b32 s74, s49, 1
s_lshl_b32 s41, s48, 1
s_add_u32 s41, s41, s74
s_lshr_b32 s42, s49, 1
s_and_b32 s48, s2, 7
s_add_u32 s47, s42, s48
s_and_b32 s47, s47, 3
s_mul_i32 s47, s47, 4
s_lshr_b32 s48, s2, 2
s_and_b32 s48, s48, 1
s_lshl_b32 s48, s48, 1
s_add_u32 s48, s48, s74
s_lshr_b32 s49, s42, 2
s_xor_b32 s77, s48, s49
s_add_u32 s77, s77, 4
s_add_u32 s78, s47, s77
s_and_b32 s78, s78, 15
s_and_b32 s48, s2, 7
s_add_u32 s75, s78, s48
s_and_b32 s75, s75, 7
s_mul_i32 s75, s75, 2
s_mov_b32 s46, 0
s_and_b32 s43, s40, 3
s_lshl_b32 s70, s43, 12
s_lshl_b32 s71, s43, 11
s_add_u32 s71, s71, 16384
s_cmp_lt_u32 s40, 4
s_cbranch_scc1 L_compute
v_lshrrev_b32 v4, 3, v0
v_and_b32 v5, 7, v0
s_lshl_b32 s48, s43, 4
v_add_u32 v6, s48, v4
s_lshl_b32 s48, s42, 7
s_mov_b32 s49, 6144
v_mul_u32_u24 v6, s49, v6
v_and_b32 v7, 2, v4
v_xor_b32 v7, v7, v5
v_lshl_add_u32 v26, v7, 4, v6
v_add_u32 v26, s48, v26
s_mul_i32 s49, s49, 8
s_sub_u32 s49, s49, 1024
v_xor_b32 v27, 64, v26
v_add_u32 v27, s49, v27
s_mov_b32 s53, 2048
s_mov_b32 s54, 393216
s_mov_b32 s57, 131072
s_lshl_b32 s48, s41, 7
s_lshl_b32 s49, s43, 5
s_add_u32 s48, s48, s49
v_add_u32 v6, s48, v4
v_lshlrev_b32 v6, 11, v6
v_lshrrev_b32 v7, 1, v4
v_xor_b32 v7, v7, v5
v_lshl_add_u32 v20, v7, 4, v6
v_xor_b32 v21, 64, v20
v_add_u32 v21, 15360, v21
v_add_u32 v22, 30720, v20
v_add_u32 v23, 30720, v21
s_add_u32 s69, s47, 0
s_and_b32 s69, s69, 15
s_mul_i32 s67, s69, 128
s_mul_i32 s68, s69, s54
s_waitcnt lgkmcnt(0)
s_mov_b32 s24, s4
s_and_b32 s25, s5, 0xffff
s_mov_b32 s26, 4194304
s_mov_b32 s27, 0x00020000
s_mov_b32 s28, s6
s_and_b32 s29, s7, 0xffff
s_mov_b32 s30, 6291456
s_mov_b32 s31, 0x00020000
s_add_u32 m0, s70, 0
s_nop 0
buffer_load_dwordx4 v20, s[24:27], s67 offen offset:0  lds
buffer_load_dwordx4 v21, s[24:27], s67 offen offset:1024  lds
buffer_load_dwordx4 v22, s[24:27], s67 offen offset:2048  lds
buffer_load_dwordx4 v23, s[24:27], s67 offen offset:3072  lds
s_add_u32 s60, s71, 0
s_add_u32 m0, s60, 0
s_mov_b32 s61, s68
buffer_load_dwordx4 v26, s[28:31], s61 offen lds
buffer_load_dwordx4 v27, s[28:31], s61 offen offset:1024 lds
s_add_u32 m0, s60, 8192
s_add_u32 s61, s61, s53
buffer_load_dwordx4 v26, s[28:31], s61 offen lds
buffer_load_dwordx4 v27, s[28:31], s61 offen offset:1024 lds
s_add_u32 m0, s60, 16384
s_add_u32 s61, s61, s53
buffer_load_dwordx4 v26, s[28:31], s61 offen lds
buffer_load_dwordx4 v27, s[28:31], s61 offen offset:1024 lds
s_mov_b32 s32, s22
s_and_b32 s33, s23, 0xffff
s_mov_b32 s34, 268435456
s_mov_b32 s35, 0x00020000
s_mov_b32 s36, s8
s_and_b32 s37, s9, 0xffff
s_mov_b32 s38, 2097152
s_mov_b32 s39, 0x00020000
v_mov_b32 v56, -1
v_mov_b32 v57, -1
v_mov_b32 v58, -1
v_mov_b32 v59, -1
s_lshl_b32 s52, s41, 6
s_add_u32 s52, s52, s42
s_lshl_b32 s52, s52, 8
s_add_u32 s52, s52, 16777216
s_getreg_b32 s50, hwreg(HW_REG_XCC_ID)
s_and_b32 s50, s50, 7
s_lshl_b32 s50, s50, 3
s_lshl_b64 s[94:95], 1, s50
s_and_b32 s96, s2, 7
s_lshl_b32 s96, s96, 5
s_and_b32 s51, s42, 7
s_cmp_gt_u32 s51, 3
s_cselect_b32 s49, 1, 0
s_sub_u32 s49, s51, s49
s_lshl_b32 s49, s49, 1
s_add_u32 s49, s49, s74
s_lshl_b32 s49, s49, 2
s_add_u32 s49, s49, s43
s_lshr_b32 s50, s49, 4
s_lshl_b32 s50, s50, 11
s_and_b32 s49, s49, 15
s_mul_i32 s49, s49, 24576
s_add_u32 s49, s49, s50
s_and_b32 s50, s42, 8
s_or_b32 s50, s50, 3
s_and_b32 s48, s2, 7
s_add_u32 s76, s50, s48
s_and_b32 s76, s76, 3
s_mul_i32 s76, s76, 4
s_lshl_b32 s50, s50, 7
s_add_u32 s49, s49, s50
s_and_b32 s51, s51, 3
s_cmp_eq_u32 s51, 3
s_cselect_b32 s49, 0x70000000, s49
v_mul_u32_u24 v4, 6144, v4
v_lshl_add_u32 v4, v5, 4, v4
v_lshrrev_b32 v5, 5, v0
v_lshlrev_b32 v5, 30, v5
v_add3_u32 v36, v4, v5, s49
s_mov_b32 s55, -1
s_mov_b32 s56, -1
v_lshrrev_b32 v4, 3, v0
v_and_b32 v5, 7, v0
s_lshr_b32 s48, s43, 1
s_lshl_b32 s48, s48, 5
s_and_b32 s49, s43, 1
s_lshl_b32 s49, s49, 3
s_add_u32 s48, s48, s49
v_lshrrev_b32 v6, 2, v4
v_lshlrev_b32 v6, 4, v6
v_and_b32 v7, 3, v4
v_add3_u32 v6, v6, v7, s48
s_lshl_b32 s48, s78, 7
s_mov_b32 s49, 2048
v_mul_u32_u24 v6, s49, v6
v_and_b32 v7, 2, v4
v_xor_b32 v7, v7, v5
v_lshl_add_u32 v28, v7, 4, v6
v_add_u32 v28, s48, v28
s_mul_i32 s49, s49, 4
s_sub_u32 s49, s49, 1024
v_xor_b32 v29, 64, v28
v_add_u32 v29, s49, v29
v_lshrrev_b32 v4, 3, v0
v_and_b32 v5, 7, v0
s_lshr_b32 s48, s43, 1
s_lshl_b32 s48, s48, 5
s_and_b32 s49, s43, 1
s_lshl_b32 s49, s49, 3
s_add_u32 s48, s48, s49
v_lshrrev_b32 v6, 2, v4
v_lshlrev_b32 v6, 4, v6
v_and_b32 v7, 3, v4
v_add3_u32 v6, v6, v7, s48
s_lshl_b32 s48, s42, 7
s_mov_b32 s49, 6144
s_cmp_ge_i32 s55, 0
s_cselect_b32 s48, 1024, s48
s_cselect_b32 s49, 384, s49
v_mul_u32_u24 v6, s49, v6
v_and_b32 v7, 2, v4
v_xor_b32 v7, v7, v5
v_lshl_add_u32 v60, v7, 4, v6
v_add_u32 v60, s48, v60
s_mul_i32 s49, s49, 4
s_sub_u32 s49, s49, 1024
v_xor_b32 v61, 64, v60
v_add_u32 v61, s49, v61
v_lshrrev_b32 v4, 3, v0
v_and_b32 v5, 7, v0
s_lshr_b32 s48, s43, 1
s_lshl_b32 s48, s48, 5
s_and_b32 s49, s43, 1
s_lshl_b32 s49, s49, 3
s_add_u32 s48, s48, s49
v_lshrrev_b32 v6, 2, v4
v_lshlrev_b32 v6, 4, v6
v_and_b32 v7, 3, v4
v_add3_u32 v6, v6, v7, s48
s_lshl_b32 s48, s78, 7
s_mov_b32 s49, 2048
s_cmp_ge_i32 s56, 0
s_cselect_b32 s48, 1024, s48
s_cselect_b32 s49, 128, s49
v_mul_u32_u24 v6, s49, v6
v_and_b32 v7, 2, v4
v_xor_b32 v7, v7, v5
v_lshl_add_u32 v24, v7, 4, v6
v_add_u32 v24, s48, v24
s_mul_i32 s49, s49, 4
s_sub_u32 s49, s49, 1024
v_xor_b32 v25, 64, v24
v_add_u32 v25, s49, v25
v_lshlrev_b32 v30, 2, v2
v_and_b32 v32, 7, v0
v_lshlrev_b32 v32, 5, v32
s_lshl_b32 s50, s41, 2
s_add_u32 s50, s50, s43
s_lshl_b32 s50, s50, 12
s_add_u32 s50, s50, 16777216
v_add_u32 v37, s50, v18
v_lshrrev_b32 v4, 5, v0
v_lshl_add_u32 v4, v4, 4, v2
s_lshl_b32 s48, s43, 5
v_add_u32 v4, s48, v4
v_lshlrev_b32 v49, 3, v4
v_add_u32 v49, 131072, v49
v_lshlrev_b32 v50, 2, v4
v_add_u32 v50, 132096, v50
s_lshl_b32 s79, s41, 2
s_add_u32 s79, s79, s43
s_lshl_b32 s79, s79, 7
s_add_u32 s79, s79, 18358272
s_lshl_b32 s48, s41, 3
s_lshl_b32 s49, s43, 1
s_add_u32 s48, s48, s49
s_lshl_b32 s80, s48, 15
s_lshl_b32 s49, s42, 11
s_add_u32 s81, s80, s49
s_add_u32 s81, s81, 4194304
s_add_u32 s82, s81, 32768
s_lshl_b32 s48, s43, 11
v_add_u32 v51, s48, v18
v_add_u32 v52, 0x10000, v51
s_lshl_b32 s48, s2, 2
s_add_u32 s48, s48, s43
s_lshl_b32 s83, s48, 11
s_mul_i32 s87, s48, 6144
v_add_u32 v62, s83, v18
s_add_u32 s87, s87, 3072
v_add_u32 v63, s87, v18
s_mul_i32 s48, s42, 393216
s_lshl_b32 s49, s41, 2
s_add_u32 s49, s49, s43
s_mul_i32 s49, s49, 6144
s_add_u32 s48, s48, s49
s_add_u32 s86, s48, 9437184
s_lshl_b32 s50, s43, 12
s_add_u32 s50, s50, s52
s_add_u32 s50, s50, 262144
v_min_u32 v8, 2, v3
v_lshlrev_b32 v8, 18, v8
v_lshl_add_u32 v8, v2, 4, v8
v_add_u32 v55, s50, v8
s_lshl_b32 s50, s42, 2
s_add_u32 s50, s50, s43
s_lshl_b32 s50, s50, 12
s_add_u32 s50, s50, 17825792
v_add_u32 v38, s50, v18
v_min_u32 v4, 2, v3
v_lshlrev_b32 v4, 8, v4
v_lshl_add_u32 v4, v2, 2, v4
s_and_b32 s48, s43, 1
s_lshl_b32 s48, s48, 7
s_lshr_b32 s49, s43, 1
s_lshl_b32 s49, s49, 6
s_add_u32 s48, s48, s49
s_add_u32 s48, s48, 133120
v_add_u32 v53, s48, v4
s_getpc_b64 s[98:99]
pc_1:
s_add_u32 s98, s98, c0_last - pc_1
s_addc_u32 s99, s99, 0
s_lshr_b32 s50, s2, 3
s_lshl_b32 s50, s50, 2
s_add_u32 s50, s50, s43
s_lshl_b32 s50, s50, 7
v_and_b32 v4, 1, v0
v_lshl_add_u32 v4, v4, 6, s50
v_min_u32 v54, L_code_end - c0_last, v4
s_add_u32 s69, s47, 1
s_and_b32 s69, s69, 15
s_mul_i32 s67, s69, 128
s_mul_i32 s68, s69, s54
s_add_u32 m0, s70, 40960
s_nop 0
buffer_load_dwordx4 v20, s[24:27], s67 offen offset:0  lds
buffer_load_dwordx4 v21, s[24:27], s67 offen offset:1024  lds
buffer_load_dwordx4 v22, s[24:27], s67 offen offset:2048  lds
buffer_load_dwordx4 v23, s[24:27], s67 offen offset:3072  lds
s_add_u32 s60, s71, 40960
s_add_u32 m0, s60, 0
s_mov_b32 s61, s68
buffer_load_dwordx4 v26, s[28:31], s61 offen lds
buffer_load_dwordx4 v27, s[28:31], s61 offen offset:1024 lds
s_add_u32 m0, s60, 8192
s_add_u32 s61, s61, s53
buffer_load_dwordx4 v26, s[28:31], s61 offen lds
buffer_load_dwordx4 v27, s[28:31], s61 offen offset:1024 lds
s_add_u32 m0, s60, 16384
s_add_u32 s61, s61, s53
buffer_load_dwordx4 v26, s[28:31], s61 offen lds
buffer_load_dwordx4 v27, s[28:31], s61 offen offset:1024 lds
s_waitcnt vmcnt(10)
s_barrier
s_cmp_lg_u32 s43, 3
s_cbranch_scc1 else_2
s_atomic_add_x2 s[94:95], s[20:21], s96
else_2:
s_add_u32 s49, s76, 2
s_and_b32 s49, s49, 15
s_mul_i32 s49, s49, 393216
buffer_load_dwordx4 v[40:43], v36, s[28:31], s49 offen
s_add_u32 s49, s76, 3
s_and_b32 s49, s49, 15
s_mul_i32 s49, s49, 393216
buffer_load_dwordx4 v[40:43], v36, s[28:31], s49 offen
s_add_u32 s69, s47, 2
s_and_b32 s69, s69, 15
s_mul_i32 s67, s69, 128
s_mul_i32 s68, s69, s54
s_add_u32 m0, s70, 81920
s_nop 0
buffer_load_dwordx4 v20, s[24:27], s67 offen offset:0  lds
buffer_load_dwordx4 v21, s[24:27], s67 offen offset:1024  lds
buffer_load_dwordx4 v22, s[24:27], s67 offen offset:2048  lds
buffer_load_dwordx4 v23, s[24:27], s67 offen offset:3072  lds
s_add_u32 s60, s71, 81920
s_add_u32 m0, s60, 0
s_mov_b32 s61, s68
buffer_load_dwordx4 v26, s[28:31], s61 offen lds
buffer_load_dwordx4 v27, s[28:31], s61 offen offset:1024 lds
s_add_u32 m0, s60, 8192
s_add_u32 s61, s61, s53
buffer_load_dwordx4 v26, s[28:31], s61 offen lds
buffer_load_dwordx4 v27, s[28:31], s61 offen offset:1024 lds
s_add_u32 m0, s60, 16384
s_add_u32 s61, s61, s53
buffer_load_dwordx4 v26, s[28:31], s61 offen lds
buffer_load_dwordx4 v27, s[28:31], s61 offen offset:1024 lds
s_add_u32 s49, s76, 4
s_and_b32 s49, s49, 15
s_mul_i32 s49, s49, 393216
buffer_load_dwordx4 v[40:43], v36, s[28:31], s49 offen
s_mov_b32 s64, 0
s_mov_b32 s65, 0
s_waitcnt vmcnt(11)
s_barrier
s_add_u32 s69, s69, 1
s_and_b32 s69, s69, 15
s_mul_i32 s67, s69, 128
s_mul_i32 s68, s69, s54
s_add_u32 m0, s70, s65
s_nop 0
buffer_load_dwordx4 v20, s[24:27], s67 offen offset:0  lds
buffer_load_dwordx4 v21, s[24:27], s67 offen offset:1024  lds
buffer_load_dwordx4 v22, s[24:27], s67 offen offset:2048  lds
buffer_load_dwordx4 v23, s[24:27], s67 offen offset:3072  lds
s_add_u32 s60, s71, s65
s_add_u32 m0, s60, 0
s_mov_b32 s61, s68
buffer_load_dwordx4 v26, s[28:31], s61 offen lds
buffer_load_dwordx4 v27, s[28:31], s61 offen offset:1024 lds
s_add_u32 m0, s60, 8192
s_add_u32 s61, s61, s53
buffer_load_dwordx4 v26, s[28:31], s61 offen lds
buffer_load_dwordx4 v27, s[28:31], s61 offen offset:1024 lds
s_add_u32 m0, s60, 16384
s_add_u32 s61, s61, s53
buffer_load_dwordx4 v26, s[28:31], s61 offen lds
buffer_load_dwordx4 v27, s[28:31], s61 offen offset:1024 lds
s_add_u32 s48, s64, 5
s_min_u32 s48, s48, 15
s_add_u32 s49, s48, s76
s_and_b32 s49, s49, 15
s_mul_i32 s49, s49, 393216
buffer_load_dwordx4 v[40:43], v36, s[28:31], s49 offen
s_add_u32 s65, s65, 40960
s_cmp_eq_u32 s65, 122880
s_cselect_b32 s65, 0, s65
s_add_u32 s64, s64, 1
s_waitcnt vmcnt(11)
s_barrier
s_add_u32 s69, s69, 1
s_and_b32 s69, s69, 15
s_mul_i32 s67, s69, 128
s_mul_i32 s68, s69, s54
s_add_u32 m0, s70, s65
s_nop 0
buffer_load_dwordx4 v20, s[24:27], s67 offen offset:0  lds
buffer_load_dwordx4 v21, s[24:27], s67 offen offset:1024  lds
buffer_load_dwordx4 v22, s[24:27], s67 offen offset:2048  lds
buffer_load_dwordx4 v23, s[24:27], s67 offen offset:3072  lds
s_add_u32 s60, s71, s65
s_add_u32 m0, s60, 0
s_mov_b32 s61, s68
buffer_load_dwordx4 v26, s[28:31], s61 offen lds
buffer_load_dwordx4 v27, s[28:31], s61 offen offset:1024 lds
s_add_u32 m0, s60, 8192
s_add_u32 s61, s61, s53
buffer_load_dwordx4 v26, s[28:31], s61 offen lds
buffer_load_dwordx4 v27, s[28:31], s61 offen offset:1024 lds
s_add_u32 m0, s60, 16384
s_add_u32 s61, s61, s53
buffer_load_dwordx4 v26, s[28:31], s61 offen lds
buffer_load_dwordx4 v27, s[28:31], s61 offen offset:1024 lds
s_add_u32 s48, s64, 5
s_min_u32 s48, s48, 15
s_add_u32 s49, s48, s76
s_and_b32 s49, s49, 15
s_mul_i32 s49, s49, 393216
buffer_load_dwordx4 v[40:43], v36, s[28:31], s49 offen
s_add_u32 s65, s65, 40960
s_cmp_eq_u32 s65, 122880
s_cselect_b32 s65, 0, s65
s_add_u32 s64, s64, 1
s_waitcnt vmcnt(11)
s_barrier
buffer_store_dwordx4 v[56:59], v18, s[32:35], s86 offen sc1
s_add_u32 s86, s86, 1024
s_add_u32 s69, s69, 1
s_and_b32 s69, s69, 15
s_mul_i32 s67, s69, 128
s_mul_i32 s68, s69, s54
s_add_u32 m0, s70, s65
s_nop 0
buffer_load_dwordx4 v20, s[24:27], s67 offen offset:0  lds
buffer_load_dwordx4 v21, s[24:27], s67 offen offset:1024  lds
buffer_load_dwordx4 v22, s[24:27], s67 offen offset:2048  lds
buffer_load_dwordx4 v23, s[24:27], s67 offen offset:3072  lds
s_add_u32 s60, s71, s65
s_add_u32 m0, s60, 0
s_mov_b32 s61, s68
buffer_load_dwordx4 v26, s[28:31], s61 offen lds
buffer_load_dwordx4 v27, s[28:31], s61 offen offset:1024 lds
s_add_u32 m0, s60, 8192
s_add_u32 s61, s61, s53
buffer_load_dwordx4 v26, s[28:31], s61 offen lds
buffer_load_dwordx4 v27, s[28:31], s61 offen offset:1024 lds
s_add_u32 m0, s60, 16384
s_add_u32 s61, s61, s53
buffer_load_dwordx4 v26, s[28:31], s61 offen lds
buffer_load_dwordx4 v27, s[28:31], s61 offen offset:1024 lds
s_add_u32 s48, s64, 5
s_min_u32 s48, s48, 15
s_add_u32 s49, s48, s76
s_and_b32 s49, s49, 15
s_mul_i32 s49, s49, 393216
buffer_load_dwordx4 v[40:43], v36, s[28:31], s49 offen
s_add_u32 s65, s65, 40960
s_cmp_eq_u32 s65, 122880
s_cselect_b32 s65, 0, s65
s_add_u32 s64, s64, 1
s_waitcnt vmcnt(11)
s_barrier
buffer_store_dwordx4 v[56:59], v18, s[32:35], s86 offen sc1
s_add_u32 s86, s86, 1024
s_add_u32 s69, s69, 1
s_and_b32 s69, s69, 15
s_mul_i32 s67, s69, 128
s_mul_i32 s68, s69, s54
s_add_u32 m0, s70, s65
s_nop 0
buffer_load_dwordx4 v20, s[24:27], s67 offen offset:0  lds
buffer_load_dwordx4 v21, s[24:27], s67 offen offset:1024  lds
buffer_load_dwordx4 v22, s[24:27], s67 offen offset:2048  lds
buffer_load_dwordx4 v23, s[24:27], s67 offen offset:3072  lds
s_add_u32 s60, s71, s65
s_add_u32 m0, s60, 0
s_mov_b32 s61, s68
buffer_load_dwordx4 v26, s[28:31], s61 offen lds
buffer_load_dwordx4 v27, s[28:31], s61 offen offset:1024 lds
s_add_u32 m0, s60, 8192
s_add_u32 s61, s61, s53
buffer_load_dwordx4 v26, s[28:31], s61 offen lds
buffer_load_dwordx4 v27, s[28:31], s61 offen offset:1024 lds
s_add_u32 m0, s60, 16384
s_add_u32 s61, s61, s53
buffer_load_dwordx4 v26, s[28:31], s61 offen lds
buffer_load_dwordx4 v27, s[28:31], s61 offen offset:1024 lds
s_add_u32 s48, s64, 5
s_min_u32 s48, s48, 15
s_add_u32 s49, s48, s76
s_and_b32 s49, s49, 15
s_mul_i32 s49, s49, 393216
buffer_load_dwordx4 v[40:43], v36, s[28:31], s49 offen
s_add_u32 s65, s65, 40960
s_cmp_eq_u32 s65, 122880
s_cselect_b32 s65, 0, s65
s_add_u32 s64, s64, 1
s_waitcnt vmcnt(11)
s_barrier
buffer_store_dwordx4 v[56:59], v18, s[32:35], s86 offen sc1
s_add_u32 s86, s86, 1024
s_add_u32 s69, s69, 1
s_and_b32 s69, s69, 15
s_mul_i32 s67, s69, 128
s_mul_i32 s68, s69, s54
s_add_u32 m0, s70, s65
s_nop 0
buffer_load_dwordx4 v20, s[24:27], s67 offen offset:0  lds
buffer_load_dwordx4 v21, s[24:27], s67 offen offset:1024  lds
buffer_load_dwordx4 v22, s[24:27], s67 offen offset:2048  lds
buffer_load_dwordx4 v23, s[24:27], s67 offen offset:3072  lds
s_add_u32 s60, s71, s65
s_add_u32 m0, s60, 0
s_mov_b32 s61, s68
buffer_load_dwordx4 v26, s[28:31], s61 offen lds
buffer_load_dwordx4 v27, s[28:31], s61 offen offset:1024 lds
s_add_u32 m0, s60, 8192
s_add_u32 s61, s61, s53
buffer_load_dwordx4 v26, s[28:31], s61 offen lds
buffer_load_dwordx4 v27, s[28:31], s61 offen offset:1024 lds
s_add_u32 m0, s60, 16384
s_add_u32 s61, s61, s53
buffer_load_dwordx4 v26, s[28:31], s61 offen lds
buffer_load_dwordx4 v27, s[28:31], s61 offen offset:1024 lds
s_add_u32 s48, s64, 5
s_min_u32 s48, s48, 15
s_add_u32 s49, s48, s76
s_and_b32 s49, s49, 15
s_mul_i32 s49, s49, 393216
buffer_load_dwordx4 v[40:43], v36, s[28:31], s49 offen
s_add_u32 s65, s65, 40960
s_cmp_eq_u32 s65, 122880
s_cselect_b32 s65, 0, s65
s_add_u32 s64, s64, 1
s_waitcnt vmcnt(11)
s_barrier
buffer_store_dwordx4 v[56:59], v18, s[32:35], s86 offen sc1
s_add_u32 s86, s86, 1024
s_add_u32 s69, s69, 1
s_and_b32 s69, s69, 15
s_mul_i32 s67, s69, 128
s_mul_i32 s68, s69, s54
s_add_u32 m0, s70, s65
s_nop 0
buffer_load_dwordx4 v20, s[24:27], s67 offen offset:0  lds
buffer_load_dwordx4 v21, s[24:27], s67 offen offset:1024  lds
buffer_load_dwordx4 v22, s[24:27], s67 offen offset:2048  lds
buffer_load_dwordx4 v23, s[24:27], s67 offen offset:3072  lds
s_add_u32 s60, s71, s65
s_add_u32 m0, s60, 0
s_mov_b32 s61, s68
buffer_load_dwordx4 v26, s[28:31], s61 offen lds
buffer_load_dwordx4 v27, s[28:31], s61 offen offset:1024 lds
s_add_u32 m0, s60, 8192
s_add_u32 s61, s61, s53
buffer_load_dwordx4 v26, s[28:31], s61 offen lds
buffer_load_dwordx4 v27, s[28:31], s61 offen offset:1024 lds
s_add_u32 m0, s60, 16384
s_add_u32 s61, s61, s53
buffer_load_dwordx4 v26, s[28:31], s61 offen lds
buffer_load_dwordx4 v27, s[28:31], s61 offen offset:1024 lds
s_add_u32 s48, s64, 5
s_min_u32 s48, s48, 15
s_add_u32 s49, s48, s76
s_and_b32 s49, s49, 15
s_mul_i32 s49, s49, 393216
buffer_load_dwordx4 v[40:43], v36, s[28:31], s49 offen
s_add_u32 s65, s65, 40960
s_cmp_eq_u32 s65, 122880
s_cselect_b32 s65, 0, s65
s_add_u32 s64, s64, 1
s_waitcnt vmcnt(11)
s_barrier
buffer_store_dwordx4 v[56:59], v18, s[32:35], s86 offen sc1
s_add_u32 s86, s86, 1024
s_add_u32 s69, s69, 1
s_and_b32 s69, s69, 15
s_mul_i32 s67, s69, 128
s_mul_i32 s68, s69, s54
s_add_u32 m0, s70, s65
s_nop 0
buffer_load_dwordx4 v20, s[24:27], s67 offen offset:0  lds
buffer_load_dwordx4 v21, s[24:27], s67 offen offset:1024  lds
buffer_load_dwordx4 v22, s[24:27], s67 offen offset:2048  lds
buffer_load_dwordx4 v23, s[24:27], s67 offen offset:3072  lds
s_add_u32 s60, s71, s65
s_add_u32 m0, s60, 0
s_mov_b32 s61, s68
buffer_load_dwordx4 v26, s[28:31], s61 offen lds
buffer_load_dwordx4 v27, s[28:31], s61 offen offset:1024 lds
s_add_u32 m0, s60, 8192
s_add_u32 s61, s61, s53
buffer_load_dwordx4 v26, s[28:31], s61 offen lds
buffer_load_dwordx4 v27, s[28:31], s61 offen offset:1024 lds
s_add_u32 m0, s60, 16384
s_add_u32 s61, s61, s53
buffer_load_dwordx4 v26, s[28:31], s61 offen lds
buffer_load_dwordx4 v27, s[28:31], s61 offen offset:1024 lds
s_add_u32 s48, s64, 5
s_min_u32 s48, s48, 15
s_add_u32 s49, s48, s76
s_and_b32 s49, s49, 15
s_mul_i32 s49, s49, 393216
buffer_load_dwordx4 v[40:43], v36, s[28:31], s49 offen
s_add_u32 s65, s65, 40960
s_cmp_eq_u32 s65, 122880
s_cselect_b32 s65, 0, s65
s_add_u32 s64, s64, 1
s_waitcnt vmcnt(11)
s_barrier
buffer_store_dwordx4 v[56:59], v18, s[32:35], s86 offen sc1
s_add_u32 s86, s86, 1024
s_add_u32 s69, s69, 1
s_and_b32 s69, s69, 15
s_mul_i32 s67, s69, 128
s_mul_i32 s68, s69, s54
s_add_u32 m0, s70, s65
s_nop 0
buffer_load_dwordx4 v20, s[24:27], s67 offen offset:0  lds
buffer_load_dwordx4 v21, s[24:27], s67 offen offset:1024  lds
buffer_load_dwordx4 v22, s[24:27], s67 offen offset:2048  lds
buffer_load_dwordx4 v23, s[24:27], s67 offen offset:3072  lds
s_add_u32 s60, s71, s65
s_add_u32 m0, s60, 0
s_mov_b32 s61, s68
buffer_load_dwordx4 v26, s[28:31], s61 offen lds
buffer_load_dwordx4 v27, s[28:31], s61 offen offset:1024 lds
s_add_u32 m0, s60, 8192
s_add_u32 s61, s61, s53
buffer_load_dwordx4 v26, s[28:31], s61 offen lds
buffer_load_dwordx4 v27, s[28:31], s61 offen offset:1024 lds
s_add_u32 m0, s60, 16384
s_add_u32 s61, s61, s53
buffer_load_dwordx4 v26, s[28:31], s61 offen lds
buffer_load_dwordx4 v27, s[28:31], s61 offen offset:1024 lds
s_add_u32 s48, s64, 5
s_min_u32 s48, s48, 15
s_add_u32 s49, s48, s76
s_and_b32 s49, s49, 15
s_mul_i32 s49, s49, 393216
buffer_load_dwordx4 v[40:43], v36, s[28:31], s49 offen
s_add_u32 s65, s65, 40960
s_cmp_eq_u32 s65, 122880
s_cselect_b32 s65, 0, s65
s_add_u32 s64, s64, 1
s_waitcnt vmcnt(11)
s_barrier
s_add_u32 s69, s69, 1
s_and_b32 s69, s69, 15
s_mul_i32 s67, s69, 128
s_mul_i32 s68, s69, s54
s_add_u32 m0, s70, s65
s_nop 0
buffer_load_dwordx4 v20, s[24:27], s67 offen offset:0  lds
buffer_load_dwordx4 v21, s[24:27], s67 offen offset:1024  lds
buffer_load_dwordx4 v22, s[24:27], s67 offen offset:2048  lds
buffer_load_dwordx4 v23, s[24:27], s67 offen offset:3072  lds
s_add_u32 s60, s71, s65
s_add_u32 m0, s60, 0
s_mov_b32 s61, s68
buffer_load_dwordx4 v26, s[28:31], s61 offen lds
buffer_load_dwordx4 v27, s[28:31], s61 offen offset:1024 lds
s_add_u32 m0, s60, 8192
s_add_u32 s61, s61, s53
buffer_load_dwordx4 v26, s[28:31], s61 offen lds
buffer_load_dwordx4 v27, s[28:31], s61 offen offset:1024 lds
s_add_u32 m0, s60, 16384
s_add_u32 s61, s61, s53
buffer_load_dwordx4 v26, s[28:31], s61 offen lds
buffer_load_dwordx4 v27, s[28:31], s61 offen offset:1024 lds
s_add_u32 s48, s64, 5
s_min_u32 s48, s48, 15
s_add_u32 s49, s48, s76
s_and_b32 s49, s49, 15
s_mul_i32 s49, s49, 393216
buffer_load_dwordx4 v[40:43], v36, s[28:31], s49 offen
s_add_u32 s65, s65, 40960
s_cmp_eq_u32 s65, 122880
s_cselect_b32 s65, 0, s65
s_add_u32 s64, s64, 1
s_waitcnt vmcnt(11)
s_barrier
s_add_u32 s69, s69, 1
s_and_b32 s69, s69, 15
s_mul_i32 s67, s69, 128
s_mul_i32 s68, s69, s54
s_add_u32 m0, s70, s65
s_nop 0
buffer_load_dwordx4 v20, s[24:27], s67 offen offset:0  lds
buffer_load_dwordx4 v21, s[24:27], s67 offen offset:1024  lds
buffer_load_dwordx4 v22, s[24:27], s67 offen offset:2048  lds
buffer_load_dwordx4 v23, s[24:27], s67 offen offset:3072  lds
s_add_u32 s60, s71, s65
s_add_u32 m0, s60, 0
s_mov_b32 s61, s68
buffer_load_dwordx4 v26, s[28:31], s61 offen lds
buffer_load_dwordx4 v27, s[28:31], s61 offen offset:1024 lds
s_add_u32 m0, s60, 8192
s_add_u32 s61, s61, s53
buffer_load_dwordx4 v26, s[28:31], s61 offen lds
buffer_load_dwordx4 v27, s[28:31], s61 offen offset:1024 lds
s_add_u32 m0, s60, 16384
s_add_u32 s61, s61, s53
buffer_load_dwordx4 v26, s[28:31], s61 offen lds
buffer_load_dwordx4 v27, s[28:31], s61 offen offset:1024 lds
s_add_u32 s48, s64, 5
s_min_u32 s48, s48, 15
s_add_u32 s49, s48, s76
s_and_b32 s49, s49, 15
s_mul_i32 s49, s49, 393216
buffer_load_dwordx4 v[40:43], v36, s[28:31], s49 offen
s_add_u32 s65, s65, 40960
s_cmp_eq_u32 s65, 122880
s_cselect_b32 s65, 0, s65
s_add_u32 s64, s64, 1
s_waitcnt vmcnt(11)
s_barrier
s_add_u32 s69, s69, 1
s_and_b32 s69, s69, 15
s_mul_i32 s67, s69, 128
s_mul_i32 s68, s69, s54
s_add_u32 m0, s70, s65
s_nop 0
buffer_load_dwordx4 v20, s[24:27], s67 offen offset:0  lds
buffer_load_dwordx4 v21, s[24:27], s67 offen offset:1024  lds
buffer_load_dwordx4 v22, s[24:27], s67 offen offset:2048  lds
buffer_load_dwordx4 v23, s[24:27], s67 offen offset:3072  lds
s_add_u32 s60, s71, s65
s_add_u32 m0, s60, 0
s_mov_b32 s61, s68
buffer_load_dwordx4 v26, s[28:31], s61 offen lds
buffer_load_dwordx4 v27, s[28:31], s61 offen offset:1024 lds
s_add_u32 m0, s60, 8192
s_add_u32 s61, s61, s53
buffer_load_dwordx4 v26, s[28:31], s61 offen lds
buffer_load_dwordx4 v27, s[28:31], s61 offen offset:1024 lds
s_add_u32 m0, s60, 16384
s_add_u32 s61, s61, s53
buffer_load_dwordx4 v26, s[28:31], s61 offen lds
buffer_load_dwordx4 v27, s[28:31], s61 offen offset:1024 lds
s_add_u32 s48, s64, 5
s_min_u32 s48, s48, 15
s_add_u32 s49, s48, s76
s_and_b32 s49, s49, 15
s_mul_i32 s49, s49, 393216
buffer_load_dwordx4 v[40:43], v36, s[28:31], s49 offen
s_add_u32 s65, s65, 40960
s_cmp_eq_u32 s65, 122880
s_cselect_b32 s65, 0, s65
s_add_u32 s64, s64, 1
s_waitcnt vmcnt(11)
s_barrier
global_load_dwordx2 v[34:35], v32, s[20:21] sc1
s_add_u32 s69, s69, 1
s_and_b32 s69, s69, 15
s_mul_i32 s67, s69, 128
s_mul_i32 s68, s69, s54
s_add_u32 m0, s70, s65
s_nop 0
buffer_load_dwordx4 v20, s[24:27], s67 offen offset:0  lds
buffer_load_dwordx4 v21, s[24:27], s67 offen offset:1024  lds
buffer_load_dwordx4 v22, s[24:27], s67 offen offset:2048  lds
buffer_load_dwordx4 v23, s[24:27], s67 offen offset:3072  lds
s_add_u32 s60, s71, s65
s_add_u32 m0, s60, 0
s_mov_b32 s61, s68
buffer_load_dwordx4 v26, s[28:31], s61 offen lds
buffer_load_dwordx4 v27, s[28:31], s61 offen offset:1024 lds
s_add_u32 m0, s60, 8192
s_add_u32 s61, s61, s53
buffer_load_dwordx4 v26, s[28:31], s61 offen lds
buffer_load_dwordx4 v27, s[28:31], s61 offen offset:1024 lds
s_add_u32 m0, s60, 16384
s_add_u32 s61, s61, s53
buffer_load_dwordx4 v26, s[28:31], s61 offen lds
buffer_load_dwordx4 v27, s[28:31], s61 offen offset:1024 lds
s_add_u32 s65, s65, 40960
s_cmp_eq_u32 s65, 122880
s_cselect_b32 s65, 0, s65
s_add_u32 s64, s64, 1
s_waitcnt vmcnt(10)
s_barrier
s_mov_b32 s63, 0
ipoll_4:
v_sad_u8 v4, v34, 0, 0
v_sad_u8 v4, v35, 0, v4
v_cmp_gt_u32 vcc, 32, v4
s_cbranch_vccz ipolled_5
global_load_dwordx2 v[34:35], v32, s[20:21] sc1
s_add_u32 s63, s63, 1
s_cmp_lt_u32 s63, 0x80000
s_waitcnt vmcnt(0)
s_cbranch_scc1 ipoll_4
ipolled_5:
buffer_load_dwordx4 v[80:83], v37, s[32:35], 0 offen offset:0 sc1
buffer_load_dwordx4 v[84:87], v37, s[32:35], 0 offen offset:1024 sc1
buffer_load_dwordx4 v[88:91], v37, s[32:35], 0 offen offset:2048 sc1
buffer_load_dwordx4 v[92:95], v37, s[32:35], 0 offen offset:3072 sc1
s_add_u32 s69, s47, 15
s_and_b32 s69, s69, 15
s_mul_i32 s67, s69, 128
s_mul_i32 s68, s69, s54
s_add_u32 m0, s70, 0
s_nop 0
buffer_load_dwordx4 v20, s[24:27], s67 offen offset:0  lds
buffer_load_dwordx4 v21, s[24:27], s67 offen offset:1024  lds
buffer_load_dwordx4 v22, s[24:27], s67 offen offset:2048  lds
buffer_load_dwordx4 v23, s[24:27], s67 offen offset:3072  lds
s_add_u32 s60, s71, 0
s_add_u32 m0, s60, 0
s_mov_b32 s61, s68
buffer_load_dwordx4 v26, s[28:31], s61 offen lds
buffer_load_dwordx4 v27, s[28:31], s61 offen offset:1024 lds
s_waitcnt vmcnt(10)
s_barrier
s_setprio 0
s_add_u32 m0, s60, 8192
s_add_u32 s61, s61, s53
buffer_load_dwordx4 v26, s[28:31], s61 offen lds
buffer_load_dwordx4 v27, s[28:31], s61 offen offset:1024 lds
s_waitcnt vmcnt(8)
s_add_u32 m0, s60, 16384
s_add_u32 s61, s61, s53
buffer_load_dwordx4 v26, s[28:31], s61 offen lds
v_add_f32 v80, v80, v88
v_add_f32 v81, v81, v89
v_add_f32 v82, v82, v90
v_add_f32 v83, v83, v91
v_add_f32 v84, v84, v92
buffer_load_dwordx4 v27, s[28:31], s61 offen offset:1024 lds
v_add_f32 v85, v85, v93
v_add_f32 v86, v86, v94
v_add_f32 v87, v87, v95
v_add_f32 v80, v80, v84
global_load_dword v48, v54, s[98:99]
v_add_f32 v81, v81, v85
v_add_f32 v82, v82, v86
v_add_f32 v83, v83, v87
s_nop 1
buffer_load_dwordx4 v[64:67], v38, s[32:35], 0 offen offset:0 sc1
v_permlane32_swap_b32 v80, v81
v_permlane32_swap_b32 v82, v83
v_add_f32 v80, v80, v81
v_add_f32 v82, v82, v83
buffer_load_dwordx4 v[68:71], v38, s[32:35], 0 offen offset:1024 sc1
s_nop 1
v_permlane16_swap_b32 v80, v82
s_nop 0
v_add_f32 v80, v80, v82
buffer_load_dwordx4 v[72:75], v38, s[32:35], 0 offen offset:2048 sc1
v_cmp_u_f32 vcc, v80, v80
s_cbranch_vccnz again_6
summed_7:
v_mul_f32 v44, 0x3a800000, v80
buffer_load_dwordx4 v[76:79], v38, s[32:35], 0 offen offset:3072 sc1
v_mov_b32 v45, v44
s_nop 1
v_permlane16_swap_b32 v44, v45
s_nop 0
s_add_u32 s48, s75, 15
s_and_b32 s48, s48, 15
s_mul_i32 s48, s48, s57
s_add_u32 m0, s71, 106496
s_nop 0
buffer_load_dwordx4 v28, s[36:39], s48 offen lds
v_fma_f32 v45, -v44, v44, v45
v_max_f32 v45, 0, v45
v_add_f32 v45, 0x3727c5ac, v45
v_rsq_f32 v46, v45
buffer_load_dwordx4 v29, s[36:39], s48 offen offset:1024 lds
v_sub_f32 v47, 0, v44
ds_write_b32 v50, v47 offset:512
ds_write_b64 v49, v[46:47]
ds_write_b32 v50, v46
s_waitcnt vmcnt(7)
s_barrier
s_add_u32 s48, s75, 5
s_and_b32 s48, s48, 15
s_mul_i32 s48, s48, s57
s_add_u32 m0, s71, 24576
s_nop 0
buffer_load_dwordx4 v28, s[36:39], s48 offen lds
buffer_load_dwordx4 v29, s[36:39], s48 offen offset:1024 lds
s_waitcnt vmcnt(4)
s_add_u32 s48, s75, 6
s_and_b32 s48, s48, 15
s_mul_i32 s48, s48, s57
s_add_u32 m0, s71, 32768
s_nop 0
buffer_load_dwordx4 v28, s[36:39], s48 offen lds
v_add_f32 v64, v64, v72
v_add_f32 v65, v65, v73
v_add_f32 v66, v66, v74
v_add_f32 v67, v67, v75
v_add_f32 v68, v68, v76
buffer_load_dwordx4 v29, s[36:39], s48 offen offset:1024 lds
v_add_f32 v69, v69, v77
v_add_f32 v70, v70, v78
v_add_f32 v71, v71, v79
v_add_f32 v64, v64, v68
s_add_u32 s48, s75, 7
s_and_b32 s48, s48, 15
s_mul_i32 s48, s48, s57
s_add_u32 m0, s71, 40960
s_nop 0
buffer_load_dwordx4 v28, s[36:39], s48 offen lds
v_add_f32 v65, v65, v69
v_add_f32 v66, v66, v70
v_add_f32 v67, v67, v71
s_nop 1
buffer_load_dwordx4 v29, s[36:39], s48 offen offset:1024 lds
v_permlane32_swap_b32 v64, v65
v_permlane32_swap_b32 v66, v67
v_add_f32 v64, v64, v65
v_add_f32 v66, v66, v67
s_add_u32 s48, s75, 8
s_and_b32 s48, s48, 15
s_mul_i32 s48, s48, s57
s_add_u32 m0, s71, 49152
s_nop 0
buffer_load_dwordx4 v28, s[36:39], s48 offen lds
s_nop 1
v_permlane16_swap_b32 v64, v66
s_nop 0
v_add_f32 v64, v64, v66
buffer_load_dwordx4 v29, s[36:39], s48 offen offset:1024 lds
v_cmp_u_f32 vcc, v64, v64
s_cbranch_vccnz again_9
summed_10:
ds_write_b32 v53, v64
s_cmp_lg_u32 s43, 2
s_cbranch_scc1 else_12
s_and_b32 s50, s2, 7
v_readlane_b32 s58, v34, s50
v_readlane_b32 s59, v35, s50
s_lshl_b64 s[48:49], s[94:95], 5
v_mov_b32 v4, 134656
s_nop 1
s_cmp_eq_u64 s[48:49], s[58:59]
s_cselect_b32 s48, 1, 0
v_mov_b32 v5, s48
ds_write_b32 v4, v5
else_12:
s_setprio 0
s_waitcnt lgkmcnt(0)
s_waitcnt vmcnt(63)
s_barrier
s_waitcnt vmcnt(4)
s_add_u32 s48, s75, 9
s_and_b32 s48, s48, 15
s_mul_i32 s48, s48, s57
s_add_u32 m0, s71, 57344
s_nop 0
buffer_load_dwordx4 v28, s[36:39], s48 offen lds
buffer_load_dwordx4 v29, s[36:39], s48 offen offset:1024 lds
s_waitcnt vmcnt(4)
s_add_u32 s48, s75, 10
s_and_b32 s48, s48, 15
s_mul_i32 s48, s48, s57
s_add_u32 m0, s71, 65536
s_nop 0
buffer_load_dwordx4 v28, s[36:39], s48 offen lds
buffer_load_dwordx4 v29, s[36:39], s48 offen offset:1024 lds
s_waitcnt vmcnt(4)
s_add_u32 s48, s75, 11
s_and_b32 s48, s48, 15
s_mul_i32 s48, s48, s57
s_add_u32 m0, s71, 73728
s_nop 0
buffer_load_dwordx4 v28, s[36:39], s48 offen lds
buffer_load_dwordx4 v29, s[36:39], s48 offen offset:1024 lds
s_waitcnt vmcnt(4)
s_add_u32 s48, s75, 12
s_and_b32 s48, s48, 15
s_mul_i32 s48, s48, s57
s_add_u32 m0, s71, 81920
s_nop 0
buffer_load_dwordx4 v28, s[36:39], s48 offen lds
buffer_load_dwordx4 v29, s[36:39], s48 offen offset:1024 lds
s_waitcnt vmcnt(4)
s_add_u32 s48, s75, 13
s_and_b32 s48, s48, 15
s_mul_i32 s48, s48, s57
s_add_u32 m0, s71, 90112
s_nop 0
buffer_load_dwordx4 v28, s[36:39], s48 offen lds
buffer_load_dwordx4 v29, s[36:39], s48 offen offset:1024 lds
s_waitcnt vmcnt(4)
s_add_u32 s48, s75, 14
s_and_b32 s48, s48, 15
s_mul_i32 s48, s48, s57
s_add_u32 m0, s71, 98304
s_nop 0
buffer_load_dwordx4 v28, s[36:39], s48 offen lds
buffer_load_dwordx4 v29, s[36:39], s48 offen offset:1024 lds
s_waitcnt vmcnt(4)
s_add_u32 s48, s75, 0
s_and_b32 s48, s48, 15
s_mul_i32 s48, s48, s57
s_add_u32 m0, s71, 4294950912
s_nop 0
buffer_load_dwordx4 v28, s[36:39], s48 offen lds
buffer_load_dwordx4 v29, s[36:39], s48 offen offset:1024 lds
s_waitcnt vmcnt(4)
s_add_u32 s48, s75, 1
s_and_b32 s48, s48, 15
s_mul_i32 s48, s48, s57
s_add_u32 m0, s71, 4294959104
s_nop 0
buffer_load_dwordx4 v28, s[36:39], s48 offen lds
buffer_load_dwordx4 v29, s[36:39], s48 offen offset:1024 lds
s_waitcnt vmcnt(4)
s_add_u32 s48, s75, 2
s_and_b32 s48, s48, 15
s_mul_i32 s48, s48, s57
s_add_u32 m0, s71, 0
s_nop 0
buffer_load_dwordx4 v28, s[36:39], s48 offen lds
buffer_load_dwordx4 v29, s[36:39], s48 offen offset:1024 lds
s_waitcnt vmcnt(4)
s_add_u32 s48, s75, 3
s_and_b32 s48, s48, 15
s_mul_i32 s48, s48, s57
s_add_u32 m0, s71, 8192
s_nop 0
buffer_load_dwordx4 v28, s[36:39], s48 offen lds
buffer_load_dwordx4 v29, s[36:39], s48 offen offset:1024 lds
s_waitcnt vmcnt(4)
s_add_u32 s48, s75, 4
s_and_b32 s48, s48, 15
s_mul_i32 s48, s48, s57
s_add_u32 m0, s71, 16384
s_nop 0
buffer_load_dwordx4 v28, s[36:39], s48 offen lds
buffer_load_dwordx4 v29, s[36:39], s48 offen offset:1024 lds
s_waitcnt vmcnt(4)
buffer_store_dwordx4 v[56:59], v55, s[32:35], 0 offen sc1
s_mov_b32 s28, s12
s_and_b32 s29, s13, 0xffff
s_mov_b32 s30, 6291456
s_mov_b32 s31, 0x00020000
v_mov_b32 v26, v60
v_mov_b32 v27, v61
v_mov_b32 v28, v24
v_mov_b32 v29, v25
s_cmp_ge_i32 s55, 0
s_cselect_b32 s53, 128, s53
s_cselect_b32 s54, 24576, s54
s_cmp_ge_i32 s56, 0
s_cselect_b32 s57, 8192, s57
s_and_b32 s48, s2, 7
s_lshl_b32 s48, s48, 1
s_add_u32 s47, s42, s48
s_and_b32 s47, s47, 15
s_and_b32 s50, s42, 8
s_or_b32 s50, s50, 3
s_and_b32 s48, s2, 7
s_lshl_b32 s48, s48, 1
s_add_u32 s76, s50, s48
s_and_b32 s76, s76, 15
s_add_u32 s69, s47, 0
s_and_b32 s69, s69, 15
s_mul_i32 s67, s69, 128
s_mul_i32 s68, s69, s54
s_waitcnt vmcnt(0) lgkmcnt(0)
s_barrier
s_add_u32 s60, s71, 122880
s_add_u32 m0, s60, 0
s_mov_b32 s61, s68
buffer_load_dwordx4 v26, s[28:31], s61 offen lds
buffer_load_dwordx4 v27, s[28:31], s61 offen offset:1024 lds
s_add_u32 m0, s60, 8192
s_add_u32 s61, s61, s53
buffer_load_dwordx4 v26, s[28:31], s61 offen lds
buffer_load_dwordx4 v27, s[28:31], s61 offen offset:1024 lds
s_add_u32 m0, s60, 16384
s_add_u32 s61, s61, s53
buffer_load_dwordx4 v26, s[28:31], s61 offen lds
buffer_load_dwordx4 v27, s[28:31], s61 offen offset:1024 lds
s_mov_b32 s36, s14
s_and_b32 s37, s15, 0xffff
s_mov_b32 s38, 65536
s_mov_b32 s39, 0x00020000
s_lshl_b32 s48, s42, 12
s_lshl_b32 s49, s43, 10
s_add_u32 s48, s48, s49
s_add_u32 m0, s49, 135168
s_nop 0
buffer_load_dwordx4 v18, s[36:39], s48 offen lds
ds_read_b128 v[232:235], v52 offset:57344
ds_read_b128 v[236:239], v52 offset:58368
ds_read_b128 v[152:155], v51 offset:40960
ds_read_b128 v[156:159], v51 offset:41984
ds_read_b128 v[160:163], v51 offset:49152
ds_read_b128 v[164:167], v51 offset:50176
ds_read_b128 v[168:171], v51 offset:57344
ds_read_b128 v[172:175], v51 offset:58368
ds_read_b128 v[176:179], v52 offset:0
ds_read_b128 v[180:183], v52 offset:1024
ds_read_b128 v[184:187], v52 offset:8192
ds_read_b128 v[188:191], v52 offset:9216
ds_read_b128 v[192:195], v52 offset:16384
ds_read_b128 v[196:199], v52 offset:17408
ds_read_b128 v[200:203], v52 offset:24576
ds_read_b128 v[204:207], v52 offset:25600
ds_read_b128 v[208:211], v52 offset:32768
ds_read_b128 v[212:215], v52 offset:33792
ds_read_b128 v[216:219], v52 offset:40960
ds_read_b128 v[220:223], v52 offset:41984
ds_read_b128 v[224:227], v52 offset:49152
ds_read_b128 v[228:231], v52 offset:50176
ds_read_b128 v[112:115], v51 offset:0
ds_read_b128 v[116:119], v51 offset:1024
ds_read_b128 v[120:123], v51 offset:8192
ds_read_b128 v[124:127], v51 offset:9216
ds_read_b128 v[128:131], v51 offset:16384
ds_read_b128 v[132:135], v51 offset:17408
ds_read_b128 v[136:139], v51 offset:24576
ds_read_b128 v[140:143], v51 offset:25600
ds_read_b128 v[144:147], v51 offset:32768
ds_read_b128 v[148:151], v51 offset:33792
s_add_u32 s48, s80, 0
v_add_u32 v20, s48, v18
v_mov_b32 v21, v20
v_add_u32 v22, 30720, v20
v_mov_b32 v23, v22
v_add_u32 v37, 262144, v37
s_lshl_b32 s50, s42, 2
s_add_u32 s50, s50, s43
s_lshl_b32 s50, s50, 12
s_add_u32 s50, s50, 18087936
v_add_u32 v38, s50, v18
v_min_u32 v4, 2, v3
v_lshlrev_b32 v4, 8, v4
v_lshl_add_u32 v4, v2, 2, v4
s_and_b32 s48, s43, 1
s_lshl_b32 s48, s48, 7
s_lshr_b32 s49, s43, 1
s_lshl_b32 s49, s49, 6
s_add_u32 s48, s48, s49
s_add_u32 s48, s48, 133888
v_add_u32 v53, s48, v4
s_getpc_b64 s[98:99]
pc_14:
s_add_u32 s98, s98, c1_last - pc_14
s_addc_u32 s99, s99, 0
s_lshr_b32 s50, s2, 3
s_lshl_b32 s50, s50, 2
s_add_u32 s50, s50, s43
s_lshl_b32 s50, s50, 7
v_and_b32 v4, 1, v0
v_lshl_add_u32 v4, v4, 6, s50
v_min_u32 v54, L_code_end - c1_last, v4
s_waitcnt vmcnt(0) lgkmcnt(0)
s_add_u32 s69, s47, 1
s_and_b32 s69, s69, 15
s_mul_i32 s67, s69, 2048
s_mul_i32 s68, s69, s54
s_barrier
s_add_u32 s60, s71, 40960
s_add_u32 m0, s60, 0
s_mov_b32 s61, s68
buffer_load_dwordx4 v26, s[28:31], s61 offen lds
buffer_load_dwordx4 v27, s[28:31], s61 offen offset:1024 lds
s_add_u32 m0, s60, 8192
s_add_u32 s61, s61, s53
buffer_load_dwordx4 v26, s[28:31], s61 offen lds
buffer_load_dwordx4 v27, s[28:31], s61 offen offset:1024 lds
s_add_u32 m0, s60, 16384
s_add_u32 s61, s61, s53
buffer_load_dwordx4 v26, s[28:31], s61 offen lds
buffer_load_dwordx4 v27, s[28:31], s61 offen offset:1024 lds
s_add_u32 s49, s76, 2
s_and_b32 s49, s49, 15
s_mul_i32 s49, s49, 393216
buffer_load_dwordx4 v[40:43], v36, s[28:31], s49 offen
s_add_u32 s49, s76, 3
s_and_b32 s49, s49, 15
s_mul_i32 s49, s49, 393216
buffer_load_dwordx4 v[40:43], v36, s[28:31], s49 offen
buffer_load_dword v5, v30, s[32:35], s79 offen sc1
s_mov_b32 s63, 0
s_waitcnt vmcnt(0)
poll_15:
v_cmp_gt_u32 vcc, 1, v5
s_cbranch_vccz polled_16
buffer_load_dword v5, v30, s[32:35], s79 offen sc1
s_add_u32 s63, s63, 1
s_cmp_lt_u32 s63, 0x80000
s_waitcnt vmcnt(0)
s_cbranch_scc1 poll_15
polled_16:
s_add_u32 s69, s47, 0
s_and_b32 s69, s69, 15
s_mul_i32 s67, s69, 2048
s_mul_i32 s68, s69, s54
s_add_u32 m0, s70, 0
s_nop 0
buffer_load_dwordx4 v20, s[32:35], s67 offen offset:0 sc1 lds
buffer_load_dwordx4 v21, s[32:35], s67 offen offset:1024 sc1 lds
buffer_load_dwordx4 v22, s[32:35], s67 offen offset:2048 sc1 lds
buffer_load_dwordx4 v23, s[32:35], s67 offen offset:3072 sc1 lds
s_add_u32 s69, s47, 1
s_and_b32 s69, s69, 15
s_mul_i32 s67, s69, 2048
s_mul_i32 s68, s69, s54
s_add_u32 m0, s70, 40960
s_nop 0
buffer_load_dwordx4 v20, s[32:35], s67 offen offset:0 sc1 lds
buffer_load_dwordx4 v21, s[32:35], s67 offen offset:1024 sc1 lds
buffer_load_dwordx4 v22, s[32:35], s67 offen offset:2048 sc1 lds
buffer_load_dwordx4 v23, s[32:35], s67 offen offset:3072 sc1 lds
s_waitcnt vmcnt(4)
s_barrier
s_add_u32 s69, s47, 2
s_and_b32 s69, s69, 15
s_mul_i32 s67, s69, 2048
s_mul_i32 s68, s69, s54
s_add_u32 m0, s70, 81920
s_nop 0
buffer_load_dwordx4 v20, s[32:35], s67 offen offset:0 sc1 lds
buffer_load_dwordx4 v21, s[32:35], s67 offen offset:1024 sc1 lds
buffer_load_dwordx4 v22, s[32:35], s67 offen offset:2048 sc1 lds
buffer_load_dwordx4 v23, s[32:35], s67 offen offset:3072 sc1 lds
s_add_u32 s60, s71, 81920
s_add_u32 m0, s60, 0
s_mov_b32 s61, s68
buffer_load_dwordx4 v26, s[28:31], s61 offen lds
buffer_load_dwordx4 v27, s[28:31], s61 offen offset:1024 lds
s_add_u32 m0, s60, 8192
s_add_u32 s61, s61, s53
buffer_load_dwordx4 v26, s[28:31], s61 offen lds
buffer_load_dwordx4 v27, s[28:31], s61 offen offset:1024 lds
s_add_u32 m0, s60, 16384
s_add_u32 s61, s61, s53
buffer_load_dwordx4 v26, s[28:31], s61 offen lds
buffer_load_dwordx4 v27, s[28:31], s61 offen offset:1024 lds
s_add_u32 s49, s76, 4
s_and_b32 s49, s49, 15
s_mul_i32 s49, s49, 393216
buffer_load_dwordx4 v[40:43], v36, s[28:31], s49 offen
s_mov_b32 s64, 0
s_mov_b32 s65, 0
h1_loop:
s_waitcnt vmcnt(11)
s_barrier
s_add_u32 s69, s69, 1
s_and_b32 s69, s69, 15
s_mul_i32 s67, s69, 2048
s_mul_i32 s68, s69, s54
s_add_u32 m0, s70, s65
s_nop 0
buffer_load_dwordx4 v20, s[32:35], s67 offen offset:0 sc1 lds
buffer_load_dwordx4 v21, s[32:35], s67 offen offset:1024 sc1 lds
buffer_load_dwordx4 v22, s[32:35], s67 offen offset:2048 sc1 lds
buffer_load_dwordx4 v23, s[32:35], s67 offen offset:3072 sc1 lds
s_add_u32 s60, s71, s65
s_add_u32 m0, s60, 0
s_mov_b32 s61, s68
buffer_load_dwordx4 v26, s[28:31], s61 offen lds
buffer_load_dwordx4 v27, s[28:31], s61 offen offset:1024 lds
s_add_u32 m0, s60, 8192
s_add_u32 s61, s61, s53
buffer_load_dwordx4 v26, s[28:31], s61 offen lds
buffer_load_dwordx4 v27, s[28:31], s61 offen offset:1024 lds
s_add_u32 m0, s60, 16384
s_add_u32 s61, s61, s53
buffer_load_dwordx4 v26, s[28:31], s61 offen lds
buffer_load_dwordx4 v27, s[28:31], s61 offen offset:1024 lds
s_add_u32 s48, s64, 5
s_min_u32 s48, s48, 15
s_add_u32 s49, s48, s76
s_and_b32 s49, s49, 15
s_mul_i32 s49, s49, 393216
buffer_load_dwordx4 v[40:43], v36, s[28:31], s49 offen
s_add_u32 s65, s65, 40960
s_cmp_eq_u32 s65, 122880
s_cselect_b32 s65, 0, s65
s_add_u32 s64, s64, 1
s_cmp_lt_u32 s64, 11
s_cbranch_scc1 h1_loop
s_waitcnt vmcnt(11)
s_barrier
s_add_u32 s69, s69, 1
s_and_b32 s69, s69, 15
s_mul_i32 s67, s69, 2048
s_mul_i32 s68, s69, s54
s_add_u32 m0, s70, s65
s_nop 0
buffer_load_dwordx4 v20, s[32:35], s67 offen offset:0 sc1 lds
buffer_load_dwordx4 v21, s[32:35], s67 offen offset:1024 sc1 lds
buffer_load_dwordx4 v22, s[32:35], s67 offen offset:2048 sc1 lds
buffer_load_dwordx4 v23, s[32:35], s67 offen offset:3072 sc1 lds
s_add_u32 s60, s71, s65
s_add_u32 m0, s60, 0
s_mov_b32 s61, s68
buffer_load_dwordx4 v26, s[28:31], s61 offen lds
buffer_load_dwordx4 v27, s[28:31], s61 offen offset:1024 lds
s_add_u32 m0, s60, 8192
s_add_u32 s61, s61, s53
buffer_load_dwordx4 v26, s[28:31], s61 offen lds
buffer_load_dwordx4 v27, s[28:31], s61 offen offset:1024 lds
s_add_u32 m0, s60, 16384
s_add_u32 s61, s61, s53
buffer_load_dwordx4 v26, s[28:31], s61 offen lds
buffer_load_dwordx4 v27, s[28:31], s61 offen offset:1024 lds
s_add_u32 s65, s65, 40960
s_cmp_eq_u32 s65, 122880
s_cselect_b32 s65, 0, s65
s_add_u32 s64, s64, 1
s_mov_b32 s36, s16
s_and_b32 s37, s17, 0xffff
s_mov_b32 s38, 2097152
s_mov_b32 s39, 0x00020000
s_waitcnt vmcnt(10)
s_barrier
buffer_load_dwordx4 v[80:83], v37, s[32:35], 0 offen offset:0 sc1
buffer_load_dwordx4 v[84:87], v37, s[32:35], 0 offen offset:1024 sc1
buffer_load_dwordx4 v[88:91], v37, s[32:35], 0 offen offset:2048 sc1
buffer_load_dwordx4 v[92:95], v37, s[32:35], 0 offen offset:3072 sc1
s_add_u32 s69, s47, 15
s_and_b32 s69, s69, 15
s_mul_i32 s67, s69, 2048
s_mul_i32 s68, s69, s54
s_add_u32 m0, s70, 0
s_nop 0
buffer_load_dwordx4 v20, s[32:35], s67 offen offset:0 sc1 lds
buffer_load_dwordx4 v21, s[32:35], s67 offen offset:1024 sc1 lds
buffer_load_dwordx4 v22, s[32:35], s67 offen offset:2048 sc1 lds
buffer_load_dwordx4 v23, s[32:35], s67 offen offset:3072 sc1 lds
s_add_u32 s60, s71, 0
s_add_u32 m0, s60, 0
s_mov_b32 s61, s68
buffer_load_dwordx4 v26, s[28:31], s61 offen lds
buffer_load_dwordx4 v27, s[28:31], s61 offen offset:1024 lds
s_waitcnt vmcnt(10)
s_barrier
s_setprio 0
s_add_u32 m0, s60, 8192
s_add_u32 s61, s61, s53
buffer_load_dwordx4 v26, s[28:31], s61 offen lds
buffer_load_dwordx4 v27, s[28:31], s61 offen offset:1024 lds
s_waitcnt vmcnt(8)
s_add_u32 m0, s60, 16384
s_add_u32 s61, s61, s53
buffer_load_dwordx4 v26, s[28:31], s61 offen lds
v_add_f32 v80, v80, v88
v_add_f32 v81, v81, v89
v_add_f32 v82, v82, v90
v_add_f32 v83, v83, v91
v_add_f32 v84, v84, v92
buffer_load_dwordx4 v27, s[28:31], s61 offen offset:1024 lds
v_add_f32 v85, v85, v93
v_add_f32 v86, v86, v94
v_add_f32 v87, v87, v95
v_add_f32 v80, v80, v84
global_load_dword v48, v54, s[98:99]
v_add_f32 v81, v81, v85
v_add_f32 v82, v82, v86
v_add_f32 v83, v83, v87
s_nop 1
buffer_load_dwordx4 v[64:67], v38, s[32:35], 0 offen offset:0 sc1
v_permlane32_swap_b32 v80, v81
v_permlane32_swap_b32 v82, v83
v_add_f32 v80, v80, v81
v_add_f32 v82, v82, v83
buffer_load_dwordx4 v[68:71], v38, s[32:35], 0 offen offset:1024 sc1
s_nop 1
v_permlane16_swap_b32 v80, v82
s_nop 0
v_add_f32 v80, v80, v82
buffer_load_dwordx4 v[72:75], v38, s[32:35], 0 offen offset:2048 sc1
v_cmp_u_f32 vcc, v80, v80
s_cbranch_vccnz again_17
summed_18:
v_mul_f32 v44, 0x3a800000, v80
buffer_load_dwordx4 v[76:79], v38, s[32:35], 0 offen offset:3072 sc1
v_mov_b32 v45, v44
s_nop 1
v_permlane16_swap_b32 v44, v45
s_nop 0
s_add_u32 s48, s75, 15
s_and_b32 s48, s48, 15
s_mul_i32 s48, s48, s57
s_add_u32 m0, s71, 106496
s_nop 0
buffer_load_dwordx4 v28, s[36:39], s48 offen lds
v_fma_f32 v45, -v44, v44, v45
v_max_f32 v45, 0, v45
v_add_f32 v45, 0x3727c5ac, v45
v_rsq_f32 v46, v45
buffer_load_dwordx4 v29, s[36:39], s48 offen offset:1024 lds
v_sub_f32 v47, 0, v44
ds_write_b32 v50, v47 offset:512
ds_write_b64 v49, v[46:47]
ds_write_b32 v50, v46
s_waitcnt vmcnt(7)
s_barrier
s_add_u32 s48, s75, 5
s_and_b32 s48, s48, 15
s_mul_i32 s48, s48, s57
s_add_u32 m0, s71, 24576
s_nop 0
buffer_load_dwordx4 v28, s[36:39], s48 offen lds
buffer_load_dwordx4 v29, s[36:39], s48 offen offset:1024 lds
s_waitcnt vmcnt(4)
s_add_u32 s48, s75, 6
s_and_b32 s48, s48, 15
s_mul_i32 s48, s48, s57
s_add_u32 m0, s71, 32768
s_nop 0
buffer_load_dwordx4 v28, s[36:39], s48 offen lds
v_add_f32 v64, v64, v72
v_add_f32 v65, v65, v73
v_add_f32 v66, v66, v74
v_add_f32 v67, v67, v75
v_add_f32 v68, v68, v76
buffer_load_dwordx4 v29, s[36:39], s48 offen offset:1024 lds
v_add_f32 v69, v69, v77
v_add_f32 v70, v70, v78
v_add_f32 v71, v71, v79
v_add_f32 v64, v64, v68
s_add_u32 s48, s75, 7
s_and_b32 s48, s48, 15
s_mul_i32 s48, s48, s57
s_add_u32 m0, s71, 40960
s_nop 0
buffer_load_dwordx4 v28, s[36:39], s48 offen lds
v_add_f32 v65, v65, v69
v_add_f32 v66, v66, v70
v_add_f32 v67, v67, v71
s_nop 1
buffer_load_dwordx4 v29, s[36:39], s48 offen offset:1024 lds
v_permlane32_swap_b32 v64, v65
v_permlane32_swap_b32 v66, v67
v_add_f32 v64, v64, v65
v_add_f32 v66, v66, v67
s_add_u32 s48, s75, 8
s_and_b32 s48, s48, 15
s_mul_i32 s48, s48, s57
s_add_u32 m0, s71, 49152
s_nop 0
buffer_load_dwordx4 v28, s[36:39], s48 offen lds
s_nop 1
v_permlane16_swap_b32 v64, v66
s_nop 0
v_add_f32 v64, v64, v66
buffer_load_dwordx4 v29, s[36:39], s48 offen offset:1024 lds
v_cmp_u_f32 vcc, v64, v64
s_cbranch_vccnz again_20
summed_21:
ds_write_b32 v53, v64
s_setprio 0
s_waitcnt lgkmcnt(0)
s_waitcnt vmcnt(63)
s_barrier
s_waitcnt vmcnt(4)
s_add_u32 s48, s75, 9
s_and_b32 s48, s48, 15
s_mul_i32 s48, s48, s57
s_add_u32 m0, s71, 57344
s_nop 0
buffer_load_dwordx4 v28, s[36:39], s48 offen lds
buffer_load_dwordx4 v29, s[36:39], s48 offen offset:1024 lds
s_waitcnt vmcnt(4)
s_add_u32 s48, s75, 10
s_and_b32 s48, s48, 15
s_mul_i32 s48, s48, s57
s_add_u32 m0, s71, 65536
s_nop 0
buffer_load_dwordx4 v28, s[36:39], s48 offen lds
buffer_load_dwordx4 v29, s[36:39], s48 offen offset:1024 lds
s_waitcnt vmcnt(4)
s_add_u32 s48, s75, 11
s_and_b32 s48, s48, 15
s_mul_i32 s48, s48, s57
s_add_u32 m0, s71, 73728
s_nop 0
buffer_load_dwordx4 v28, s[36:39], s48 offen lds
buffer_load_dwordx4 v29, s[36:39], s48 offen offset:1024 lds
s_waitcnt vmcnt(4)
s_add_u32 s48, s75, 12
s_and_b32 s48, s48, 15
s_mul_i32 s48, s48, s57
s_add_u32 m0, s71, 81920
s_nop 0
buffer_load_dwordx4 v28, s[36:39], s48 offen lds
buffer_load_dwordx4 v29, s[36:39], s48 offen offset:1024 lds
s_waitcnt vmcnt(4)
s_add_u32 s48, s75, 13
s_and_b32 s48, s48, 15
s_mul_i32 s48, s48, s57
s_add_u32 m0, s71, 90112
s_nop 0
buffer_load_dwordx4 v28, s[36:39], s48 offen lds
buffer_load_dwordx4 v29, s[36:39], s48 offen offset:1024 lds
s_waitcnt vmcnt(4)
s_add_u32 s48, s75, 14
s_and_b32 s48, s48, 15
s_mul_i32 s48, s48, s57
s_add_u32 m0, s71, 98304
s_nop 0
buffer_load_dwordx4 v28, s[36:39], s48 offen lds
buffer_load_dwordx4 v29, s[36:39], s48 offen offset:1024 lds
s_waitcnt vmcnt(4)
s_add_u32 s48, s75, 0
s_and_b32 s48, s48, 15
s_mul_i32 s48, s48, s57
s_add_u32 m0, s71, 4294950912
s_nop 0
buffer_load_dwordx4 v28, s[36:39], s48 offen lds
buffer_load_dwordx4 v29, s[36:39], s48 offen offset:1024 lds
s_waitcnt vmcnt(4)
s_add_u32 s48, s75, 1
s_and_b32 s48, s48, 15
s_mul_i32 s48, s48, s57
s_add_u32 m0, s71, 4294959104
s_nop 0
buffer_load_dwordx4 v28, s[36:39], s48 offen lds
buffer_load_dwordx4 v29, s[36:39], s48 offen offset:1024 lds
s_waitcnt vmcnt(4)
s_add_u32 s48, s75, 2
s_and_b32 s48, s48, 15
s_mul_i32 s48, s48, s57
s_add_u32 m0, s71, 0
s_nop 0
buffer_load_dwordx4 v28, s[36:39], s48 offen lds
buffer_load_dwordx4 v29, s[36:39], s48 offen offset:1024 lds
s_waitcnt vmcnt(4)
s_add_u32 s48, s75, 3
s_and_b32 s48, s48, 15
s_mul_i32 s48, s48, s57
s_add_u32 m0, s71, 8192
s_nop 0
buffer_load_dwordx4 v28, s[36:39], s48 offen lds
buffer_load_dwordx4 v29, s[36:39], s48 offen offset:1024 lds
s_waitcnt vmcnt(4)
s_add_u32 s48, s75, 4
s_and_b32 s48, s48, 15
s_mul_i32 s48, s48, s57
s_add_u32 m0, s71, 16384
s_nop 0
buffer_load_dwordx4 v28, s[36:39], s48 offen lds
buffer_load_dwordx4 v29, s[36:39], s48 offen offset:1024 lds
s_waitcnt vmcnt(4)
buffer_load_dwordx4 v[96:99], v18, s[32:35], s81 offen offset:0 sc1
buffer_load_dwordx4 v[100:103], v18, s[32:35], s81 offen offset:1024 sc1
s_waitcnt vmcnt(4)
buffer_load_dwordx4 v[104:107], v18, s[32:35], s82 offen offset:0 sc1
buffer_load_dwordx4 v[108:111], v18, s[32:35], s82 offen offset:1024 sc1
s_mov_b32 s28, s6
s_and_b32 s29, s7, 0xffff
s_mov_b32 s30, 6291456
s_mov_b32 s31, 0x00020000
s_add_u32 s69, s47, 0
s_and_b32 s69, s69, 15
s_mul_i32 s67, s69, 2048
s_mul_i32 s68, s69, s54
s_waitcnt vmcnt(0) lgkmcnt(0)
s_barrier
s_add_u32 s60, s71, 122880
s_add_u32 m0, s60, 0
s_mov_b32 s61, s68
buffer_load_dwordx4 v26, s[28:31], s61 offen lds
buffer_load_dwordx4 v27, s[28:31], s61 offen offset:1024 lds
s_add_u32 m0, s60, 8192
s_add_u32 s61, s61, s53
buffer_load_dwordx4 v26, s[28:31], s61 offen lds
buffer_load_dwordx4 v27, s[28:31], s61 offen offset:1024 lds
s_add_u32 m0, s60, 16384
s_add_u32 s61, s61, s53
buffer_load_dwordx4 v26, s[28:31], s61 offen lds
buffer_load_dwordx4 v27, s[28:31], s61 offen offset:1024 lds
v_add_u32 v37, 262144, v37
s_getpc_b64 s[98:99]
pc_23:
s_add_u32 s98, s98, c2_last - pc_23
s_addc_u32 s99, s99, 0
s_lshr_b32 s50, s2, 3
s_lshl_b32 s50, s50, 2
s_add_u32 s50, s50, s43
s_lshl_b32 s50, s50, 7
v_and_b32 v4, 1, v0
v_lshl_add_u32 v4, v4, 6, s50
v_min_u32 v54, L_code_end - c2_last, v4
s_waitcnt vmcnt(0) lgkmcnt(0)
s_add_u32 s69, s47, 1
s_and_b32 s69, s69, 15
s_mul_i32 s67, s69, 2048
s_mul_i32 s68, s69, s54
s_barrier
s_add_u32 s60, s71, 40960
s_add_u32 m0, s60, 0
s_mov_b32 s61, s68
buffer_load_dwordx4 v26, s[28:31], s61 offen lds
buffer_load_dwordx4 v27, s[28:31], s61 offen offset:1024 lds
s_add_u32 m0, s60, 8192
s_add_u32 s61, s61, s53
buffer_load_dwordx4 v26, s[28:31], s61 offen lds
buffer_load_dwordx4 v27, s[28:31], s61 offen offset:1024 lds
s_add_u32 m0, s60, 16384
s_add_u32 s61, s61, s53
buffer_load_dwordx4 v26, s[28:31], s61 offen lds
buffer_load_dwordx4 v27, s[28:31], s61 offen offset:1024 lds
s_add_u32 s49, s76, 2
s_and_b32 s49, s49, 15
s_mul_i32 s49, s49, 393216
buffer_load_dwordx4 v[40:43], v36, s[28:31], s49 offen
s_add_u32 s49, s76, 3
s_and_b32 s49, s49, 15
s_mul_i32 s49, s49, 393216
buffer_load_dwordx4 v[40:43], v36, s[28:31], s49 offen
buffer_load_dword v5, v30, s[32:35], s79 offen sc1
s_mov_b32 s63, 0
s_waitcnt vmcnt(0)
poll_24:
v_cmp_gt_u32 vcc, 2, v5
s_cbranch_vccz polled_25
buffer_load_dword v5, v30, s[32:35], s79 offen sc1
s_add_u32 s63, s63, 1
s_cmp_lt_u32 s63, 0x80000
s_waitcnt vmcnt(0)
s_cbranch_scc1 poll_24
polled_25:
s_add_u32 s69, s47, 0
s_and_b32 s69, s69, 15
s_mul_i32 s67, s69, 2048
s_mul_i32 s68, s69, s54
s_add_u32 m0, s70, 0
s_nop 0
buffer_load_dwordx4 v20, s[32:35], s67 offen offset:0 sc1 lds
buffer_load_dwordx4 v21, s[32:35], s67 offen offset:1024 sc1 lds
buffer_load_dwordx4 v22, s[32:35], s67 offen offset:2048 sc1 lds
buffer_load_dwordx4 v23, s[32:35], s67 offen offset:3072 sc1 lds
s_add_u32 s69, s47, 1
s_and_b32 s69, s69, 15
s_mul_i32 s67, s69, 2048
s_mul_i32 s68, s69, s54
s_add_u32 m0, s70, 40960
s_nop 0
buffer_load_dwordx4 v20, s[32:35], s67 offen offset:0 sc1 lds
buffer_load_dwordx4 v21, s[32:35], s67 offen offset:1024 sc1 lds
buffer_load_dwordx4 v22, s[32:35], s67 offen offset:2048 sc1 lds
buffer_load_dwordx4 v23, s[32:35], s67 offen offset:3072 sc1 lds
s_waitcnt vmcnt(4)
s_barrier
s_add_u32 s69, s47, 2
s_and_b32 s69, s69, 15
s_mul_i32 s67, s69, 2048
s_mul_i32 s68, s69, s54
s_add_u32 m0, s70, 81920
s_nop 0
buffer_load_dwordx4 v20, s[32:35], s67 offen offset:0 sc1 lds
buffer_load_dwordx4 v21, s[32:35], s67 offen offset:1024 sc1 lds
buffer_load_dwordx4 v22, s[32:35], s67 offen offset:2048 sc1 lds
buffer_load_dwordx4 v23, s[32:35], s67 offen offset:3072 sc1 lds
s_add_u32 s60, s71, 81920
s_add_u32 m0, s60, 0
s_mov_b32 s61, s68
buffer_load_dwordx4 v26, s[28:31], s61 offen lds
buffer_load_dwordx4 v27, s[28:31], s61 offen offset:1024 lds
s_add_u32 m0, s60, 8192
s_add_u32 s61, s61, s53
buffer_load_dwordx4 v26, s[28:31], s61 offen lds
buffer_load_dwordx4 v27, s[28:31], s61 offen offset:1024 lds
s_add_u32 m0, s60, 16384
s_add_u32 s61, s61, s53
buffer_load_dwordx4 v26, s[28:31], s61 offen lds
buffer_load_dwordx4 v27, s[28:31], s61 offen offset:1024 lds
s_add_u32 s49, s76, 4
s_and_b32 s49, s49, 15
s_mul_i32 s49, s49, 393216
buffer_load_dwordx4 v[40:43], v36, s[28:31], s49 offen
s_mov_b32 s64, 0
s_mov_b32 s65, 0
h2_loop:
s_waitcnt vmcnt(11)
s_barrier
s_add_u32 s69, s69, 1
s_and_b32 s69, s69, 15
s_mul_i32 s67, s69, 2048
s_mul_i32 s68, s69, s54
s_add_u32 m0, s70, s65
s_nop 0
buffer_load_dwordx4 v20, s[32:35], s67 offen offset:0 sc1 lds
buffer_load_dwordx4 v21, s[32:35], s67 offen offset:1024 sc1 lds
buffer_load_dwordx4 v22, s[32:35], s67 offen offset:2048 sc1 lds
buffer_load_dwordx4 v23, s[32:35], s67 offen offset:3072 sc1 lds
s_add_u32 s60, s71, s65
s_add_u32 m0, s60, 0
s_mov_b32 s61, s68
buffer_load_dwordx4 v26, s[28:31], s61 offen lds
buffer_load_dwordx4 v27, s[28:31], s61 offen offset:1024 lds
s_add_u32 m0, s60, 8192
s_add_u32 s61, s61, s53
buffer_load_dwordx4 v26, s[28:31], s61 offen lds
buffer_load_dwordx4 v27, s[28:31], s61 offen offset:1024 lds
s_add_u32 m0, s60, 16384
s_add_u32 s61, s61, s53
buffer_load_dwordx4 v26, s[28:31], s61 offen lds
buffer_load_dwordx4 v27, s[28:31], s61 offen offset:1024 lds
s_add_u32 s48, s64, 5
s_min_u32 s48, s48, 15
s_add_u32 s49, s48, s76
s_and_b32 s49, s49, 15
s_mul_i32 s49, s49, 393216
buffer_load_dwordx4 v[40:43], v36, s[28:31], s49 offen
s_add_u32 s65, s65, 40960
s_cmp_eq_u32 s65, 122880
s_cselect_b32 s65, 0, s65
s_add_u32 s64, s64, 1
s_cmp_lt_u32 s64, 11
s_cbranch_scc1 h2_loop
s_waitcnt vmcnt(11)
s_barrier
s_add_u32 s69, s69, 1
s_and_b32 s69, s69, 15
s_mul_i32 s67, s69, 2048
s_mul_i32 s68, s69, s54
s_add_u32 m0, s70, s65
s_nop 0
buffer_load_dwordx4 v20, s[32:35], s67 offen offset:0 sc1 lds
buffer_load_dwordx4 v21, s[32:35], s67 offen offset:1024 sc1 lds
buffer_load_dwordx4 v22, s[32:35], s67 offen offset:2048 sc1 lds
buffer_load_dwordx4 v23, s[32:35], s67 offen offset:3072 sc1 lds
s_add_u32 s60, s71, s65
s_add_u32 m0, s60, 0
s_mov_b32 s61, s68
buffer_load_dwordx4 v26, s[28:31], s61 offen lds
buffer_load_dwordx4 v27, s[28:31], s61 offen offset:1024 lds
s_add_u32 m0, s60, 8192
s_add_u32 s61, s61, s53
buffer_load_dwordx4 v26, s[28:31], s61 offen lds
buffer_load_dwordx4 v27, s[28:31], s61 offen offset:1024 lds
s_add_u32 m0, s60, 16384
s_add_u32 s61, s61, s53
buffer_load_dwordx4 v26, s[28:31], s61 offen lds
buffer_load_dwordx4 v27, s[28:31], s61 offen offset:1024 lds
s_add_u32 s65, s65, 40960
s_cmp_eq_u32 s65, 122880
s_cselect_b32 s65, 0, s65
s_add_u32 s64, s64, 1
s_mov_b32 s36, s12
s_and_b32 s37, s13, 0xffff
s_mov_b32 s38, 6291456
s_mov_b32 s39, 0x00020000
s_waitcnt vmcnt(10)
s_barrier
s_add_u32 s69, s47, 15
s_and_b32 s69, s69, 15
s_mul_i32 s67, s69, 2048
s_mul_i32 s68, s69, s54
s_add_u32 m0, s70, 0
s_nop 0
buffer_load_dwordx4 v20, s[32:35], s67 offen offset:0 sc1 lds
buffer_load_dwordx4 v21, s[32:35], s67 offen offset:1024 sc1 lds
buffer_load_dwordx4 v22, s[32:35], s67 offen offset:2048 sc1 lds
buffer_load_dwordx4 v23, s[32:35], s67 offen offset:3072 sc1 lds
s_add_u32 s60, s71, 0
s_add_u32 m0, s60, 0
s_mov_b32 s61, s68
buffer_load_dwordx4 v26, s[28:31], s61 offen lds
buffer_load_dwordx4 v27, s[28:31], s61 offen offset:1024 lds
s_add_u32 m0, s60, 8192
s_add_u32 s61, s61, s53
buffer_load_dwordx4 v26, s[28:31], s61 offen lds
buffer_load_dwordx4 v27, s[28:31], s61 offen offset:1024 lds
s_add_u32 m0, s60, 16384
s_add_u32 s61, s61, s53
buffer_load_dwordx4 v26, s[28:31], s61 offen lds
buffer_load_dwordx4 v27, s[28:31], s61 offen offset:1024 lds
s_waitcnt vmcnt(10)
s_barrier
s_setprio 0
buffer_load_dwordx4 v[80:83], v37, s[32:35], 0 offen offset:0 sc1
buffer_load_dwordx4 v[84:87], v37, s[32:35], 0 offen offset:1024 sc1
buffer_load_dwordx4 v[88:91], v37, s[32:35], 0 offen offset:2048 sc1
buffer_load_dwordx4 v[92:95], v37, s[32:35], 0 offen offset:3072 sc1
global_load_dword v48, v54, s[98:99]
s_add_u32 s69, s47, 0
s_and_b32 s69, s69, 15
s_mul_i32 s67, s69, 2048
s_mul_i32 s68, s69, s54
s_add_u32 s60, s71, 122880
s_add_u32 m0, s60, 0
s_mov_b32 s61, s68
buffer_load_dwordx4 v26, s[36:39], s61 offen lds
buffer_load_dwordx4 v27, s[36:39], s61 offen offset:1024 lds
s_add_u32 m0, s60, 8192
s_add_u32 s61, s61, s53
buffer_load_dwordx4 v26, s[36:39], s61 offen lds
buffer_load_dwordx4 v27, s[36:39], s61 offen offset:1024 lds
s_add_u32 m0, s60, 16384
s_add_u32 s61, s61, s53
buffer_load_dwordx4 v26, s[36:39], s61 offen lds
buffer_load_dwordx4 v27, s[36:39], s61 offen offset:1024 lds
s_waitcnt vmcnt(11)
s_barrier
s_waitcnt vmcnt(7)
buffer_load_dwordx4 v[96:99], v18, s[32:35], s81 offen offset:0 sc1
v_add_f32 v80, v80, v88
v_add_f32 v81, v81, v89
v_add_f32 v82, v82, v90
v_add_f32 v83, v83, v91
v_add_f32 v84, v84, v92
v_add_f32 v85, v85, v93
v_add_f32 v86, v86, v94
v_add_f32 v87, v87, v95
v_add_f32 v80, v80, v84
v_add_f32 v81, v81, v85
buffer_load_dwordx4 v[100:103], v18, s[32:35], s81 offen offset:1024 sc1
v_add_f32 v82, v82, v86
v_add_f32 v83, v83, v87
s_nop 1
v_permlane32_swap_b32 v80, v81
v_permlane32_swap_b32 v82, v83
v_add_f32 v80, v80, v81
v_add_f32 v82, v82, v83
s_nop 1
v_permlane16_swap_b32 v80, v82
buffer_load_dwordx4 v[104:107], v18, s[32:35], s82 offen offset:0 sc1
s_nop 0
v_add_f32 v80, v80, v82
v_cmp_u_f32 vcc, v80, v80
s_cbranch_vccnz again_26
summed_27:
v_mul_f32 v44, 0x3a800000, v80
v_mov_b32 v45, v44
s_nop 1
v_permlane16_swap_b32 v44, v45
buffer_load_dwordx4 v[108:111], v18, s[32:35], s82 offen offset:1024 sc1
s_nop 0
v_fma_f32 v45, -v44, v44, v45
v_max_f32 v45, 0, v45
v_add_f32 v45, 0x3727c5ac, v45
v_rsq_f32 v46, v45
v_sub_f32 v47, 0, v44
ds_write_b32 v50, v47 offset:512
ds_write_b64 v49, v[46:47]
ds_write_b32 v50, v46
s_setprio 0
s_waitcnt lgkmcnt(0)
s_waitcnt vmcnt(63)
s_barrier
ds_write_b128 v52, v[232:235] offset:57344
ds_write_b128 v52, v[236:239] offset:58368
ds_write_b128 v51, v[152:155] offset:40960
ds_write_b128 v51, v[156:159] offset:41984
ds_write_b128 v51, v[160:163] offset:49152
ds_write_b128 v51, v[164:167] offset:50176
ds_write_b128 v51, v[168:171] offset:57344
ds_write_b128 v51, v[172:175] offset:58368
ds_write_b128 v52, v[176:179] offset:0
ds_write_b128 v52, v[180:183] offset:1024
ds_write_b128 v52, v[184:187] offset:8192
ds_write_b128 v52, v[188:191] offset:9216
ds_write_b128 v52, v[192:195] offset:16384
ds_write_b128 v52, v[196:199] offset:17408
ds_write_b128 v52, v[200:203] offset:24576
ds_write_b128 v52, v[204:207] offset:25600
ds_write_b128 v52, v[208:211] offset:32768
ds_write_b128 v52, v[212:215] offset:33792
ds_write_b128 v52, v[216:219] offset:40960
ds_write_b128 v52, v[220:223] offset:41984
ds_write_b128 v52, v[224:227] offset:49152
ds_write_b128 v52, v[228:231] offset:50176
ds_write_b128 v51, v[112:115] offset:0
ds_write_b128 v51, v[116:119] offset:1024
ds_write_b128 v51, v[120:123] offset:8192
ds_write_b128 v51, v[124:127] offset:9216
ds_write_b128 v51, v[128:131] offset:16384
ds_write_b128 v51, v[132:135] offset:17408
ds_write_b128 v51, v[136:139] offset:24576
ds_write_b128 v51, v[140:143] offset:25600
ds_write_b128 v51, v[144:147] offset:32768
ds_write_b128 v51, v[148:151] offset:33792
s_mov_b32 s28, s12
s_and_b32 s29, s13, 0xffff
s_mov_b32 s30, 6291456
s_mov_b32 s31, 0x00020000
s_add_u32 s69, s47, 0
s_and_b32 s69, s69, 15
s_mul_i32 s67, s69, 2048
s_mul_i32 s68, s69, s54
s_waitcnt vmcnt(0) lgkmcnt(0)
s_barrier
s_mov_b32 s36, s14
s_and_b32 s37, s15, 0xffff
s_mov_b32 s38, 65536
s_mov_b32 s39, 0x00020000
s_lshl_b32 s48, s42, 12
s_lshl_b32 s49, s43, 10
s_add_u32 s48, s48, s49
s_add_u32 m0, s49, 135168
s_nop 0
buffer_load_dwordx4 v18, s[36:39], s48 offen lds
v_add_u32 v37, 262144, v37
s_getpc_b64 s[98:99]
pc_29:
s_add_u32 s98, s98, c3_last - pc_29
s_addc_u32 s99, s99, 0
s_lshr_b32 s50, s2, 3
s_lshl_b32 s50, s50, 2
s_add_u32 s50, s50, s43
s_lshl_b32 s50, s50, 7
v_and_b32 v4, 1, v0
v_lshl_add_u32 v4, v4, 6, s50
v_min_u32 v54, L_code_end - c3_last, v4
s_waitcnt vmcnt(0) lgkmcnt(0)
s_add_u32 s69, s47, 1
s_and_b32 s69, s69, 15
s_mul_i32 s67, s69, 2048
s_mul_i32 s68, s69, s54
s_barrier
s_add_u32 s60, s71, 40960
s_add_u32 m0, s60, 0
s_mov_b32 s61, s68
buffer_load_dwordx4 v26, s[28:31], s61 offen lds
buffer_load_dwordx4 v27, s[28:31], s61 offen offset:1024 lds
s_add_u32 m0, s60, 8192
s_add_u32 s61, s61, s53
buffer_load_dwordx4 v26, s[28:31], s61 offen lds
buffer_load_dwordx4 v27, s[28:31], s61 offen offset:1024 lds
s_add_u32 m0, s60, 16384
s_add_u32 s61, s61, s53
buffer_load_dwordx4 v26, s[28:31], s61 offen lds
buffer_load_dwordx4 v27, s[28:31], s61 offen offset:1024 lds
s_add_u32 s49, s76, 2
s_and_b32 s49, s49, 15
s_mul_i32 s49, s49, 393216
buffer_load_dwordx4 v[40:43], v36, s[28:31], s49 offen
s_add_u32 s49, s76, 3
s_and_b32 s49, s49, 15
s_mul_i32 s49, s49, 393216
buffer_load_dwordx4 v[40:43], v36, s[28:31], s49 offen
buffer_load_dword v5, v30, s[32:35], s79 offen sc1
s_mov_b32 s63, 0
s_waitcnt vmcnt(0)
poll_30:
v_cmp_gt_u32 vcc, 3, v5
s_cbranch_vccz polled_31
buffer_load_dword v5, v30, s[32:35], s79 offen sc1
s_add_u32 s63, s63, 1
s_cmp_lt_u32 s63, 0x80000
s_waitcnt vmcnt(0)
s_cbranch_scc1 poll_30
polled_31:
s_add_u32 s69, s47, 0
s_and_b32 s69, s69, 15
s_mul_i32 s67, s69, 2048
s_mul_i32 s68, s69, s54
s_add_u32 m0, s70, 0
s_nop 0
buffer_load_dwordx4 v20, s[32:35], s67 offen offset:0 sc1 lds
buffer_load_dwordx4 v21, s[32:35], s67 offen offset:1024 sc1 lds
buffer_load_dwordx4 v22, s[32:35], s67 offen offset:2048 sc1 lds
buffer_load_dwordx4 v23, s[32:35], s67 offen offset:3072 sc1 lds
s_add_u32 s69, s47, 1
s_and_b32 s69, s69, 15
s_mul_i32 s67, s69, 2048
s_mul_i32 s68, s69, s54
s_add_u32 m0, s70, 40960
s_nop 0
buffer_load_dwordx4 v20, s[32:35], s67 offen offset:0 sc1 lds
buffer_load_dwordx4 v21, s[32:35], s67 offen offset:1024 sc1 lds
buffer_load_dwordx4 v22, s[32:35], s67 offen offset:2048 sc1 lds
buffer_load_dwordx4 v23, s[32:35], s67 offen offset:3072 sc1 lds
s_waitcnt vmcnt(4)
s_barrier
s_add_u32 s69, s47, 2
s_and_b32 s69, s69, 15
s_mul_i32 s67, s69, 2048
s_mul_i32 s68, s69, s54
s_add_u32 m0, s70, 81920
s_nop 0
buffer_load_dwordx4 v20, s[32:35], s67 offen offset:0 sc1 lds
buffer_load_dwordx4 v21, s[32:35], s67 offen offset:1024 sc1 lds
buffer_load_dwordx4 v22, s[32:35], s67 offen offset:2048 sc1 lds
buffer_load_dwordx4 v23, s[32:35], s67 offen offset:3072 sc1 lds
s_add_u32 s60, s71, 81920
s_add_u32 m0, s60, 0
s_mov_b32 s61, s68
buffer_load_dwordx4 v26, s[28:31], s61 offen lds
buffer_load_dwordx4 v27, s[28:31], s61 offen offset:1024 lds
s_add_u32 m0, s60, 8192
s_add_u32 s61, s61, s53
buffer_load_dwordx4 v26, s[28:31], s61 offen lds
buffer_load_dwordx4 v27, s[28:31], s61 offen offset:1024 lds
s_add_u32 m0, s60, 16384
s_add_u32 s61, s61, s53
buffer_load_dwordx4 v26, s[28:31], s61 offen lds
buffer_load_dwordx4 v27, s[28:31], s61 offen offset:1024 lds
s_add_u32 s49, s76, 4
s_and_b32 s49, s49, 15
s_mul_i32 s49, s49, 393216
buffer_load_dwordx4 v[40:43], v36, s[28:31], s49 offen
s_mov_b32 s64, 0
s_mov_b32 s65, 0
h3_loop:
s_waitcnt vmcnt(11)
s_barrier
s_add_u32 s69, s69, 1
s_and_b32 s69, s69, 15
s_mul_i32 s67, s69, 2048
s_mul_i32 s68, s69, s54
s_add_u32 m0, s70, s65
s_nop 0
buffer_load_dwordx4 v20, s[32:35], s67 offen offset:0 sc1 lds
buffer_load_dwordx4 v21, s[32:35], s67 offen offset:1024 sc1 lds
buffer_load_dwordx4 v22, s[32:35], s67 offen offset:2048 sc1 lds
buffer_load_dwordx4 v23, s[32:35], s67 offen offset:3072 sc1 lds
s_add_u32 s60, s71, s65
s_add_u32 m0, s60, 0
s_mov_b32 s61, s68
buffer_load_dwordx4 v26, s[28:31], s61 offen lds
buffer_load_dwordx4 v27, s[28:31], s61 offen offset:1024 lds
s_add_u32 m0, s60, 8192
s_add_u32 s61, s61, s53
buffer_load_dwordx4 v26, s[28:31], s61 offen lds
buffer_load_dwordx4 v27, s[28:31], s61 offen offset:1024 lds
s_add_u32 m0, s60, 16384
s_add_u32 s61, s61, s53
buffer_load_dwordx4 v26, s[28:31], s61 offen lds
buffer_load_dwordx4 v27, s[28:31], s61 offen offset:1024 lds
s_add_u32 s48, s64, 5
s_min_u32 s48, s48, 15
s_add_u32 s49, s48, s76
s_and_b32 s49, s49, 15
s_mul_i32 s49, s49, 393216
buffer_load_dwordx4 v[40:43], v36, s[28:31], s49 offen
s_add_u32 s65, s65, 40960
s_cmp_eq_u32 s65, 122880
s_cselect_b32 s65, 0, s65
s_add_u32 s64, s64, 1
s_cmp_lt_u32 s64, 11
s_cbranch_scc1 h3_loop
s_waitcnt vmcnt(11)
s_barrier
s_add_u32 s69, s69, 1
s_and_b32 s69, s69, 15
s_mul_i32 s67, s69, 2048
s_mul_i32 s68, s69, s54
s_add_u32 m0, s70, s65
s_nop 0
buffer_load_dwordx4 v20, s[32:35], s67 offen offset:0 sc1 lds
buffer_load_dwordx4 v21, s[32:35], s67 offen offset:1024 sc1 lds
buffer_load_dwordx4 v22, s[32:35], s67 offen offset:2048 sc1 lds
buffer_load_dwordx4 v23, s[32:35], s67 offen offset:3072 sc1 lds
s_add_u32 s60, s71, s65
s_add_u32 m0, s60, 0
s_mov_b32 s61, s68
buffer_load_dwordx4 v26, s[28:31], s61 offen lds
buffer_load_dwordx4 v27, s[28:31], s61 offen offset:1024 lds
s_add_u32 m0, s60, 8192
s_add_u32 s61, s61, s53
buffer_load_dwordx4 v26, s[28:31], s61 offen lds
buffer_load_dwordx4 v27, s[28:31], s61 offen offset:1024 lds
s_add_u32 m0, s60, 16384
s_add_u32 s61, s61, s53
buffer_load_dwordx4 v26, s[28:31], s61 offen lds
buffer_load_dwordx4 v27, s[28:31], s61 offen offset:1024 lds
s_add_u32 s65, s65, 40960
s_cmp_eq_u32 s65, 122880
s_cselect_b32 s65, 0, s65
s_add_u32 s64, s64, 1
s_mov_b32 s36, s16
s_and_b32 s37, s17, 0xffff
s_mov_b32 s38, 2097152
s_mov_b32 s39, 0x00020000
s_waitcnt vmcnt(10)
s_barrier
s_add_u32 s69, s47, 15
s_and_b32 s69, s69, 15
s_mul_i32 s67, s69, 2048
s_mul_i32 s68, s69, s54
s_add_u32 m0, s70, 0
s_nop 0
buffer_load_dwordx4 v20, s[32:35], s67 offen offset:0 sc1 lds
buffer_load_dwordx4 v21, s[32:35], s67 offen offset:1024 sc1 lds
buffer_load_dwordx4 v22, s[32:35], s67 offen offset:2048 sc1 lds
buffer_load_dwordx4 v23, s[32:35], s67 offen offset:3072 sc1 lds
s_add_u32 s60, s71, 0
s_add_u32 m0, s60, 0
s_mov_b32 s61, s68
buffer_load_dwordx4 v26, s[28:31], s61 offen lds
buffer_load_dwordx4 v27, s[28:31], s61 offen offset:1024 lds
s_add_u32 m0, s60, 8192
s_add_u32 s61, s61, s53
buffer_load_dwordx4 v26, s[28:31], s61 offen lds
buffer_load_dwordx4 v27, s[28:31], s61 offen offset:1024 lds
s_add_u32 m0, s60, 16384
s_add_u32 s61, s61, s53
buffer_load_dwordx4 v26, s[28:31], s61 offen lds
buffer_load_dwordx4 v27, s[28:31], s61 offen offset:1024 lds
s_waitcnt vmcnt(10)
s_barrier
s_setprio 0
buffer_load_dwordx4 v[80:83], v37, s[32:35], 0 offen offset:0 sc1
buffer_load_dwordx4 v[84:87], v37, s[32:35], 0 offen offset:1024 sc1
buffer_load_dwordx4 v[88:91], v37, s[32:35], 0 offen offset:2048 sc1
buffer_load_dwordx4 v[92:95], v37, s[32:35], 0 offen offset:3072 sc1
global_load_dword v48, v54, s[98:99]
s_add_u32 s48, s75, 15
s_and_b32 s48, s48, 15
s_mul_i32 s48, s48, s57
s_add_u32 m0, s71, 106496
s_nop 0
buffer_load_dwordx4 v28, s[36:39], s48 offen lds
buffer_load_dwordx4 v29, s[36:39], s48 offen offset:1024 lds
s_add_u32 s48, s75, 5
s_and_b32 s48, s48, 15
s_mul_i32 s48, s48, s57
s_add_u32 m0, s71, 24576
s_nop 0
buffer_load_dwordx4 v28, s[36:39], s48 offen lds
buffer_load_dwordx4 v29, s[36:39], s48 offen offset:1024 lds
s_add_u32 s48, s75, 6
s_and_b32 s48, s48, 15
s_mul_i32 s48, s48, s57
s_add_u32 m0, s71, 32768
s_nop 0
buffer_load_dwordx4 v28, s[36:39], s48 offen lds
buffer_load_dwordx4 v29, s[36:39], s48 offen offset:1024 lds
s_waitcnt vmcnt(11)
s_barrier
s_waitcnt vmcnt(7)
s_add_u32 s48, s75, 7
s_and_b32 s48, s48, 15
s_mul_i32 s48, s48, s57
s_add_u32 m0, s71, 40960
s_nop 0
buffer_load_dwordx4 v28, s[36:39], s48 offen lds
v_add_f32 v80, v80, v88
v_add_f32 v81, v81, v89
v_add_f32 v82, v82, v90
v_add_f32 v83, v83, v91
v_add_f32 v84, v84, v92
buffer_load_dwordx4 v29, s[36:39], s48 offen offset:1024 lds
v_add_f32 v85, v85, v93
v_add_f32 v86, v86, v94
v_add_f32 v87, v87, v95
v_add_f32 v80, v80, v84
v_add_f32 v81, v81, v85
s_add_u32 s48, s75, 8
s_and_b32 s48, s48, 15
s_mul_i32 s48, s48, s57
s_add_u32 m0, s71, 49152
s_nop 0
buffer_load_dwordx4 v28, s[36:39], s48 offen lds
v_add_f32 v82, v82, v86
v_add_f32 v83, v83, v87
s_nop 1
v_permlane32_swap_b32 v80, v81
buffer_load_dwordx4 v29, s[36:39], s48 offen offset:1024 lds
v_permlane32_swap_b32 v82, v83
v_add_f32 v80, v80, v81
v_add_f32 v82, v82, v83
s_nop 1
v_permlane16_swap_b32 v80, v82
s_add_u32 s48, s75, 9
s_and_b32 s48, s48, 15
s_mul_i32 s48, s48, s57
s_add_u32 m0, s71, 57344
s_nop 0
buffer_load_dwordx4 v28, s[36:39], s48 offen lds
s_nop 0
v_add_f32 v80, v80, v82
v_cmp_u_f32 vcc, v80, v80
s_cbranch_vccnz again_32
summed_33:
buffer_load_dwordx4 v29, s[36:39], s48 offen offset:1024 lds
v_mul_f32 v44, 0x3a800000, v80
v_mov_b32 v45, v44
s_nop 1
v_permlane16_swap_b32 v44, v45
s_add_u32 s48, s75, 10
s_and_b32 s48, s48, 15
s_mul_i32 s48, s48, s57
s_add_u32 m0, s71, 65536
s_nop 0
buffer_load_dwordx4 v28, s[36:39], s48 offen lds
s_nop 0
v_fma_f32 v45, -v44, v44, v45
v_max_f32 v45, 0, v45
v_add_f32 v45, 0x3727c5ac, v45
v_rsq_f32 v46, v45
buffer_load_dwordx4 v29, s[36:39], s48 offen offset:1024 lds
v_sub_f32 v47, 0, v44
ds_write_b32 v50, v47 offset:512
ds_write_b64 v49, v[46:47]
ds_write_b32 v50, v46
s_setprio 0
s_waitcnt lgkmcnt(0)
s_waitcnt vmcnt(63)
s_barrier
s_waitcnt vmcnt(4)
s_add_u32 s48, s75, 11
s_and_b32 s48, s48, 15
s_mul_i32 s48, s48, s57
s_add_u32 m0, s71, 73728
s_nop 0
buffer_load_dwordx4 v28, s[36:39], s48 offen lds
buffer_load_dwordx4 v29, s[36:39], s48 offen offset:1024 lds
s_waitcnt vmcnt(4)
s_add_u32 s48, s75, 12
s_and_b32 s48, s48, 15
s_mul_i32 s48, s48, s57
s_add_u32 m0, s71, 81920
s_nop 0
buffer_load_dwordx4 v28, s[36:39], s48 offen lds
buffer_load_dwordx4 v29, s[36:39], s48 offen offset:1024 lds
s_waitcnt vmcnt(4)
s_add_u32 s48, s75, 13
s_and_b32 s48, s48, 15
s_mul_i32 s48, s48, s57
s_add_u32 m0, s71, 90112
s_nop 0
buffer_load_dwordx4 v28, s[36:39], s48 offen lds
buffer_load_dwordx4 v29, s[36:39], s48 offen offset:1024 lds
s_waitcnt vmcnt(4)
s_add_u32 s48, s75, 14
s_and_b32 s48, s48, 15
s_mul_i32 s48, s48, s57
s_add_u32 m0, s71, 98304
s_nop 0
buffer_load_dwordx4 v28, s[36:39], s48 offen lds
buffer_load_dwordx4 v29, s[36:39], s48 offen offset:1024 lds
s_waitcnt vmcnt(4)
s_add_u32 s48, s75, 0
s_and_b32 s48, s48, 15
s_mul_i32 s48, s48, s57
s_add_u32 m0, s71, 4294950912
s_nop 0
buffer_load_dwordx4 v28, s[36:39], s48 offen lds
buffer_load_dwordx4 v29, s[36:39], s48 offen offset:1024 lds
s_waitcnt vmcnt(4)
s_add_u32 s48, s75, 1
s_and_b32 s48, s48, 15
s_mul_i32 s48, s48, s57
s_add_u32 m0, s71, 4294959104
s_nop 0
buffer_load_dwordx4 v28, s[36:39], s48 offen lds
buffer_load_dwordx4 v29, s[36:39], s48 offen offset:1024 lds
s_waitcnt vmcnt(4)
s_add_u32 s48, s75, 2
s_and_b32 s48, s48, 15
s_mul_i32 s48, s48, s57
s_add_u32 m0, s71, 0
s_nop 0
buffer_load_dwordx4 v28, s[36:39], s48 offen lds
buffer_load_dwordx4 v29, s[36:39], s48 offen offset:1024 lds
s_waitcnt vmcnt(4)
s_add_u32 s48, s75, 3
s_and_b32 s48, s48, 15
s_mul_i32 s48, s48, s57
s_add_u32 m0, s71, 8192
s_nop 0
buffer_load_dwordx4 v28, s[36:39], s48 offen lds
buffer_load_dwordx4 v29, s[36:39], s48 offen offset:1024 lds
s_waitcnt vmcnt(4)
s_add_u32 s48, s75, 4
s_and_b32 s48, s48, 15
s_mul_i32 s48, s48, s57
s_add_u32 m0, s71, 16384
s_nop 0
buffer_load_dwordx4 v28, s[36:39], s48 offen lds
buffer_load_dwordx4 v29, s[36:39], s48 offen offset:1024 lds
s_waitcnt vmcnt(4)
buffer_load_dwordx4 v[96:99], v18, s[32:35], s81 offen offset:0 sc1
buffer_load_dwordx4 v[100:103], v18, s[32:35], s81 offen offset:1024 sc1
s_waitcnt vmcnt(4)
buffer_load_dwordx4 v[104:107], v18, s[32:35], s82 offen offset:0 sc1
buffer_load_dwordx4 v[108:111], v18, s[32:35], s82 offen offset:1024 sc1
s_waitcnt vmcnt(0) lgkmcnt(0)
s_barrier
L_end:
s_endpgm
L_compute:
s_waitcnt lgkmcnt(0)
s_mov_b32 s32, s22
s_and_b32 s33, s23, 0xffff
s_mov_b32 s34, 268435456
s_mov_b32 s35, 0x00020000
s_mov_b32 s24, s18
s_and_b32 s25, s19, 0xffff
s_mov_b32 s26, 4194304
s_mov_b32 s27, 0x00020000
s_setprio 1
s_and_b32 s43, s40, 1
s_lshr_b32 s44, s40, 1
s_lshl_b32 s45, s42, 1
s_add_u32 s45, s45, s43
s_cmp_lg_u32 s40, 1
s_cbranch_scc1 else_35
s_getpc_b64 s[48:49]
L_pc:
s_sub_u32 s48, s48, L_pc - interleave_layers__sliding_local_dilated__linear_kernel_hedgehog__prompt_kernel
s_subb_u32 s49, s49, 0
s_lshr_b32 s50, s2, 3
s_lshl_b32 s50, s50, 12
v_lshl_add_u32 v8, v0, 6, s50
v_cmp_gt_u32 vcc, L_code_end - interleave_layers__sliding_local_dilated__linear_kernel_hedgehog__prompt_kernel, v8
s_and_saveexec_b64 s[50:51], vcc
s_cbranch_execz nopf_37
global_load_dword v254, v8, s[48:49]
nopf_37:
s_mov_b64 exec, -1
else_35:
s_lshl_b32 s48, s41, 3
s_lshl_b32 s49, s44, 2
s_add_u32 s48, s48, s49
s_lshl_b32 s48, s48, 5
s_add_u32 s48, s48, s45
s_lshl_b32 s48, s48, 10
s_add_u32 s80, s48, 4194304
s_add_u32 s81, s80, 32768
s_add_u32 s82, s80, 65536
s_add_u32 s83, s80, 98304
s_lshl_b32 s84, s41, 2
s_add_u32 s84, s84, s44
s_lshl_b32 s84, s84, 7
s_add_u32 s84, s84, 18350080
s_lshl_b32 s48, s41, 3
s_lshl_b32 s49, s40, 1
s_add_u32 s48, s48, s49
s_lshl_b32 s48, s48, 15
s_lshl_b32 s49, s78, 11
s_add_u32 s85, s48, s49
s_add_u32 s86, s85, 32768
s_lshl_b32 s50, s41, 2
s_add_u32 s50, s50, s40
s_lshl_b32 s50, s50, 4
s_add_u32 s50, s50, s42
s_lshl_b32 s50, s50, 8
s_add_u32 s87, s50, 16777216
s_lshl_b32 s88, s41, 2
s_add_u32 s88, s88, s40
s_lshl_b32 s88, s88, 7
s_add_u32 s88, s88, 18358272
v_lshrrev_b32 v4, 1, v3
v_lshl_add_u32 v4, v2, 2, v4
v_and_b32 v5, 1, v3
v_lshl_add_u32 v4, v5, 1, v4
v_lshlrev_b32 v1, 2, v4
s_lshl_b32 s48, s40, 2
s_add_u32 s48, s48, 134672
v_mov_b32 v10, s48
v_mov_b32 v11, 0
ds_write_b32 v10, v11
v_mov_b32 v140, -1
v_mov_b32 v141, -1
v_mov_b32 v142, -1
v_mov_b32 v143, -1
s_lshl_b32 s50, s42, 2
s_add_u32 s50, s50, s40
s_lshl_b32 s50, s50, 4
s_add_u32 s50, s50, s41
s_lshl_b32 s50, s50, 8
s_add_u32 s50, s50, 17825792
v_mov_b32 v4, s87
v_mov_b32 v5, s50
v_cmp_eq_u32 vcc, 0, v3
v_lshrrev_b32 v6, 1, v3
v_mul_u32_u24 v6, 262144, v6
v_add_u32 v5, v5, v6
v_cndmask_b32 v4, v5, v4, vcc
v_lshl_add_u32 v4, v2, 4, v4
buffer_store_dwordx4 v[140:143], v4, s[32:35], 0 offen sc1
s_lshl_b32 s48, s2, 2
s_add_u32 s49, s48, s40
s_lshl_b32 s48, s49, 10
s_add_u32 s48, s48, 8388608
buffer_store_dwordx4 v[140:143], v18, s[32:35], s48 offen sc1
s_and_b32 s48, s49, 15
s_cmp_lg_u32 s48, 0
s_cbranch_scc1 nofl_38
s_lshl_b32 s48, s49, 4
s_add_u32 s48, s48, 18350080
v_lshlrev_b32 v6, 2, v0
buffer_store_dword v11, v6, s[32:35], s48 offen sc1
nofl_38:
s_lshl_b32 s49, s44, 13
v_lshrrev_b32 v4, 1, v2
v_xor_b32 v4, v4, v3
v_lshlrev_b32 v4, 4, v4
v_lshl_add_u32 v10, v2, 7, v4
v_add_u32 v10, s49, v10
v_xor_b32 v11, 64, v10
s_lshl_b32 s48, s43, 1
v_lshrrev_b32 v4, 2, v2
v_and_b32 v5, 3, v0
v_lshl_add_u32 v6, v3, 3, v4
v_lshlrev_b32 v6, 7, v6
v_lshl_add_u32 v6, v5, 3, v6
v_lshrrev_b32 v7, 1, v4
v_and_b32 v8, 1, v3
v_lshl_add_u32 v7, v8, 1, v7
v_xor_b32 v7, s48, v7
v_lshl_add_u32 v12, v7, 5, v6
v_add_u32 v12, 16384, v12
v_xor_b32 v13, 32, v12
v_mov_b32 v14, v10
v_mov_b32 v15, v11
v_add_u32 v16, 0, v12
v_add_u32 v17, 0, v13
v_mov_b32 v156, 0
v_mov_b32 v157, 0
v_mov_b32 v158, 0
v_mov_b32 v159, 0
v_mov_b32 v160, 0
v_mov_b32 v161, 0
v_mov_b32 v162, 0
v_mov_b32 v163, 0
v_mov_b32 v164, 0
v_mov_b32 v165, 0
v_mov_b32 v166, 0
v_mov_b32 v167, 0
v_mov_b32 v168, 0
v_mov_b32 v169, 0
v_mov_b32 v170, 0
v_mov_b32 v171, 0
v_mov_b32 v172, 0
v_mov_b32 v173, 0
v_mov_b32 v174, 0
v_mov_b32 v175, 0
v_mov_b32 v176, 0
v_mov_b32 v177, 0
v_mov_b32 v178, 0
v_mov_b32 v179, 0
v_mov_b32 v180, 0
v_mov_b32 v181, 0
v_mov_b32 v182, 0
v_mov_b32 v183, 0
v_mov_b32 v184, 0
v_mov_b32 v185, 0
v_mov_b32 v186, 0
v_mov_b32 v187, 0
v_mov_b32 v188, 0
v_mov_b32 v189, 0
v_mov_b32 v190, 0
v_mov_b32 v191, 0
v_mov_b32 v192, 0
v_mov_b32 v193, 0
v_mov_b32 v194, 0
v_mov_b32 v195, 0
v_mov_b32 v196, 0
v_mov_b32 v197, 0
v_mov_b32 v198, 0
v_mov_b32 v199, 0
v_mov_b32 v200, 0
v_mov_b32 v201, 0
v_mov_b32 v202, 0
v_mov_b32 v203, 0
v_mov_b32 v204, 0
v_mov_b32 v205, 0
v_mov_b32 v206, 0
v_mov_b32 v207, 0
v_mov_b32 v208, 0
v_mov_b32 v209, 0
v_mov_b32 v210, 0
v_mov_b32 v211, 0
v_mov_b32 v212, 0
v_mov_b32 v213, 0
v_mov_b32 v214, 0
v_mov_b32 v215, 0
v_mov_b32 v216, 0
v_mov_b32 v217, 0
v_mov_b32 v218, 0
v_mov_b32 v219, 0
v_mov_b32 v220, 0
v_mov_b32 v221, 0
v_mov_b32 v222, 0
v_mov_b32 v223, 0
v_mov_b32 v224, 0
v_mov_b32 v225, 0
v_mov_b32 v226, 0
v_mov_b32 v227, 0
v_mov_b32 v228, 0
v_mov_b32 v229, 0
v_mov_b32 v230, 0
v_mov_b32 v231, 0
v_mov_b32 v232, 0
v_mov_b32 v233, 0
v_mov_b32 v234, 0
v_mov_b32 v235, 0
v_mov_b32 v236, 0
v_mov_b32 v237, 0
v_mov_b32 v238, 0
v_mov_b32 v239, 0
v_mov_b32 v240, 0
v_mov_b32 v241, 0
v_mov_b32 v242, 0
v_mov_b32 v243, 0
v_mov_b32 v244, 0
v_mov_b32 v245, 0
v_mov_b32 v246, 0
v_mov_b32 v247, 0
v_mov_b32 v248, 0
v_mov_b32 v249, 0
v_mov_b32 v250, 0
v_mov_b32 v251, 0
v_mov_b32 v48, 0x3f803f80
v_mov_b32 v49, 0x3f803f80
v_mov_b32 v50, 0x3f803f80
v_mov_b32 v51, 0x3f803f80
s_mov_b32 s48, 0xf149f2ca
v_mov_b32 v9, s48
v_lshlrev_b32 v4, 2, v3
v_sub_u32 v4, v2, v4
v_subrev_u32 v5, 0, v4
v_and_b32 v6, 0x80000001, v5
v_cmp_eq_u32 vcc, 0, v6
v_add_u32 v5, 1, v5
v_and_b32 v6, 0x80000001, v5
v_cndmask_b32 v40, v9, 0, vcc
v_cmp_eq_u32 vcc, 0x80000001, v6
s_nop 1
v_cndmask_b32 v36, v9, 0, vcc
v_subrev_u32 v5, 1, v4
v_and_b32 v6, 0x80000001, v5
v_cmp_eq_u32 vcc, 0, v6
v_add_u32 v5, 1, v5
v_and_b32 v6, 0x80000001, v5
v_cndmask_b32 v41, v9, 0, vcc
v_cmp_eq_u32 vcc, 0x80000001, v6
s_nop 1
v_cndmask_b32 v37, v9, 0, vcc
v_subrev_u32 v5, 2, v4
v_and_b32 v6, 0x80000001, v5
v_cmp_eq_u32 vcc, 0, v6
v_add_u32 v5, 1, v5
v_and_b32 v6, 0x80000001, v5
v_cndmask_b32 v42, v9, 0, vcc
v_cmp_eq_u32 vcc, 0x80000001, v6
s_nop 1
v_cndmask_b32 v38, v9, 0, vcc
v_subrev_u32 v5, 3, v4
v_and_b32 v6, 0x80000001, v5
v_cmp_eq_u32 vcc, 0, v6
v_add_u32 v5, 1, v5
v_and_b32 v6, 0x80000001, v5
v_cndmask_b32 v43, v9, 0, vcc
v_cmp_eq_u32 vcc, 0x80000001, v6
s_nop 1
v_cndmask_b32 v39, v9, 0, vcc
s_or_b32 s48, s41, s44
s_cmp_eq_u32 s48, 0
s_cselect_b64 vcc, -1, 0
v_cndmask_b32 v44, v36, v9, vcc
v_cndmask_b32 v45, v37, v9, vcc
v_cndmask_b32 v46, v38, v9, vcc
v_cndmask_b32 v47, v39, v9, vcc
v_and_b32 v4, 1, v2
v_lshlrev_b32 v4, 4, v4
v_mov_b32 v5, 0xffff
v_lshlrev_b32 v52, v4, v5
s_lshl_b32 s48, s43, 11
s_add_u32 s48, s48, 135168
v_add_u32 v53, s48, v18
v_lshl_add_u32 v55, v0, 3, s48
s_add_u32 s48, s41, s44
s_sub_u32 s48, s48, 1
s_lshl_b32 s49, s48, 1
s_add_u32 s49, s49, s43
s_lshl_b32 s49, s49, 11
s_mul_i32 s50, s42, 65536
s_add_u32 s49, s49, s50
s_add_u32 s49, s49, 8388608
s_cmp_lt_i32 s48, 0
s_cselect_b32 s49, 0xf0000000, s49
v_add_u32 v58, s49, v18
v_lshl_add_u32 v59, v0, 3, s49
s_lshl_b32 s48, s43, 2
s_add_u32 s48, s48, 134672
v_mov_b32 v19, s48
s_lshl_b32 s48, s43, 7
s_add_u32 s48, s48, 133120
v_lshl_add_u32 v7, v3, 4, s48
v_lshl_add_u32 v54, v2, 2, s48
s_lshl_b32 s49, s44, 6
v_add_u32 v8, s49, v2
v_lshlrev_b32 v8, 3, v8
v_add_u32 v8, 131072, v8
v_lshl_add_u32 v9, v3, 2, s49
v_lshlrev_b32 v9, 2, v9
v_add_u32 v9, 132096, v9
s_mov_b32 s64, 0
s_mov_b32 s65, 0
s_mov_b32 s66, 0x3e8293ee
s_lshl_b32 s50, s42, 2
s_add_u32 s50, s50, s40
s_lshl_b32 s50, s50, 4
s_add_u32 s50, s50, s41
s_lshl_b32 s50, s50, 8
s_add_u32 s52, s50, 17825792
v_lshrrev_b32 v4, 1, v2
v_lshrrev_b32 v5, 1, v3
v_xor_b32 v4, v4, v5
v_lshlrev_b32 v4, 4, v4
v_and_b32 v5, 1, v3
v_lshl_add_u32 v4, v5, 3, v4
v_lshl_add_u32 v4, v2, 7, v4
s_lshl_b32 s48, s40, 12
v_add_u32 v155, s48, v4
v_mov_b32 v152, 0
v_mov_b32 v153, 0
v_mov_b32 v56, 0
v_mov_b32 v57, 0
s_waitcnt vmcnt(0)
s_barrier
ds_read_b128 v[60:63], v14 offset:0
ds_read_b128 v[64:67], v14 offset:2048
ds_read_b128 v[68:71], v14 offset:4096
ds_read_b128 v[72:75], v14 offset:6144
ds_read_b64_tr_b16 v[84:85], v16 offset:8192
ds_read_b64_tr_b16 v[86:87], v16 offset:8704
ds_read_b64_tr_b16 v[88:89], v17 offset:8192
ds_read_b64_tr_b16 v[90:91], v17 offset:8704
ds_read_b64_tr_b16 v[92:93], v16 offset:16384
ds_read_b64_tr_b16 v[94:95], v16 offset:16896
ds_read_b64_tr_b16 v[96:97], v17 offset:16384
ds_read_b64_tr_b16 v[98:99], v17 offset:16896
ds_read_b64_tr_b16 v[76:77], v16 offset:0
ds_read_b64_tr_b16 v[78:79], v16 offset:512
ds_read_b64_tr_b16 v[80:81], v17 offset:0
ds_read_b64_tr_b16 v[82:83], v17 offset:512
s_waitcnt lgkmcnt(0)
c0_loop:
v_mfma_f32_16x16x32_bf16 v[212:215], v[84:87], v[72:75], v[212:215]
ds_read_b128 v[100:103], v15 offset:0
v_mfma_f32_16x16x32_bf16 v[204:207], v[84:87], v[68:71], v[204:207]
ds_read_b128 v[104:107], v15 offset:2048
v_mfma_f32_16x16x32_bf16 v[196:199], v[84:87], v[64:67], v[196:199]
ds_read_b128 v[108:111], v15 offset:4096
v_mfma_f32_16x16x32_bf16 v[188:191], v[84:87], v[60:63], v[188:191]
ds_read_b128 v[112:115], v15 offset:6144
v_mfma_f32_16x16x32_bf16 v[192:195], v[88:91], v[60:63], v[192:195]
ds_read_b64_tr_b16 v[124:125], v16 offset:12288
v_mfma_f32_16x16x32_bf16 v[200:203], v[88:91], v[64:67], v[200:203]
ds_read_b64_tr_b16 v[126:127], v16 offset:12800
v_mfma_f32_16x16x32_bf16 v[208:211], v[88:91], v[68:71], v[208:211]
ds_read_b64_tr_b16 v[128:129], v17 offset:12288
v_mfma_f32_16x16x32_bf16 v[216:219], v[88:91], v[72:75], v[216:219]
ds_read_b64_tr_b16 v[130:131], v17 offset:12800
v_mfma_f32_16x16x32_bf16 v[244:247], v[72:75], v[92:95], v[244:247]
ds_read_b64_tr_b16 v[132:133], v16 offset:20480
v_mfma_f32_16x16x32_bf16 v[236:239], v[68:71], v[92:95], v[236:239]
ds_read_b64_tr_b16 v[134:135], v16 offset:20992
v_mfma_f32_16x16x32_bf16 v[228:231], v[64:67], v[92:95], v[228:231]
ds_read_b64_tr_b16 v[136:137], v17 offset:20480
v_mfma_f32_16x16x32_bf16 v[220:223], v[60:63], v[92:95], v[220:223]
ds_read_b64_tr_b16 v[138:139], v17 offset:20992
v_mfma_f32_16x16x32_bf16 v[224:227], v[60:63], v[96:99], v[224:227]
ds_read_b64_tr_b16 v[116:117], v16 offset:4096
v_mfma_f32_16x16x32_bf16 v[232:235], v[64:67], v[96:99], v[232:235]
ds_read_b64_tr_b16 v[118:119], v16 offset:4608
v_mfma_f32_16x16x32_bf16 v[240:243], v[68:71], v[96:99], v[240:243]
ds_read_b64_tr_b16 v[120:121], v17 offset:4096
v_mfma_f32_16x16x32_bf16 v[248:251], v[72:75], v[96:99], v[248:251]
ds_read_b64_tr_b16 v[122:123], v17 offset:4608
v_mfma_f32_16x16x32_bf16 v[180:183], v[76:79], v[72:75], v[180:183]
s_cmp_eq_u32 s77, s64
s_cbranch_scc1 c0_hook
c0_hook_ret:
v_mfma_f32_16x16x32_bf16 v[172:175], v[76:79], v[68:71], v[172:175]
s_add_u32 s65, s65, 40960
s_cmp_eq_u32 s65, 122880
v_mfma_f32_16x16x32_bf16 v[164:167], v[76:79], v[64:67], v[164:167]
s_cselect_b32 s65, 0, s65
s_add_u32 s64, s64, 1
v_mfma_f32_16x16x32_bf16 v[156:159], v[76:79], v[60:63], v[156:159]
v_add_u32 v14, s65, v10
v_add_u32 v15, s65, v11
v_mfma_f32_16x16x32_bf16 v[160:163], v[80:83], v[60:63], v[160:163]
v_add_u32 v16, s65, v12
v_add_u32 v17, s65, v13
v_mfma_f32_16x16x32_bf16 v[168:171], v[80:83], v[64:67], v[168:171]
s_cmp_eq_u32 s64, 16
s_cbranch_scc1 c0_last
v_mfma_f32_16x16x32_bf16 v[176:179], v[80:83], v[68:71], v[176:179]
s_waitcnt lgkmcnt(0)
v_mfma_f32_16x16x32_bf16 v[184:187], v[80:83], v[72:75], v[184:187]
s_barrier
v_mfma_f32_16x16x32_bf16 v[212:215], v[124:127], v[112:115], v[212:215]
ds_read_b128 v[60:63], v14 offset:0
v_mfma_f32_16x16x32_bf16 v[204:207], v[124:127], v[108:111], v[204:207]
ds_read_b128 v[64:67], v14 offset:2048
v_mfma_f32_16x16x32_bf16 v[196:199], v[124:127], v[104:107], v[196:199]
ds_read_b128 v[68:71], v14 offset:4096
v_mfma_f32_16x16x32_bf16 v[188:191], v[124:127], v[100:103], v[188:191]
ds_read_b128 v[72:75], v14 offset:6144
v_mfma_f32_16x16x32_bf16 v[192:195], v[128:131], v[100:103], v[192:195]
ds_read_b64_tr_b16 v[84:85], v16 offset:8192
v_mfma_f32_16x16x32_bf16 v[200:203], v[128:131], v[104:107], v[200:203]
ds_read_b64_tr_b16 v[86:87], v16 offset:8704
v_mfma_f32_16x16x32_bf16 v[208:211], v[128:131], v[108:111], v[208:211]
ds_read_b64_tr_b16 v[88:89], v17 offset:8192
v_mfma_f32_16x16x32_bf16 v[216:219], v[128:131], v[112:115], v[216:219]
ds_read_b64_tr_b16 v[90:91], v17 offset:8704
v_mfma_f32_16x16x32_bf16 v[244:247], v[112:115], v[132:135], v[244:247]
ds_read_b64_tr_b16 v[92:93], v16 offset:16384
v_mfma_f32_16x16x32_bf16 v[236:239], v[108:111], v[132:135], v[236:239]
ds_read_b64_tr_b16 v[94:95], v16 offset:16896
v_mfma_f32_16x16x32_bf16 v[228:231], v[104:107], v[132:135], v[228:231]
ds_read_b64_tr_b16 v[96:97], v17 offset:16384
v_mfma_f32_16x16x32_bf16 v[220:223], v[100:103], v[132:135], v[220:223]
ds_read_b64_tr_b16 v[98:99], v17 offset:16896
v_mfma_f32_16x16x32_bf16 v[224:227], v[100:103], v[136:139], v[224:227]
ds_read_b64_tr_b16 v[76:77], v16 offset:0
v_mfma_f32_16x16x32_bf16 v[232:235], v[104:107], v[136:139], v[232:235]
ds_read_b64_tr_b16 v[78:79], v16 offset:512
v_mfma_f32_16x16x32_bf16 v[240:243], v[108:111], v[136:139], v[240:243]
ds_read_b64_tr_b16 v[80:81], v17 offset:0
v_mfma_f32_16x16x32_bf16 v[248:251], v[112:115], v[136:139], v[248:251]
ds_read_b64_tr_b16 v[82:83], v17 offset:512
v_mfma_f32_16x16x32_bf16 v[180:183], v[116:119], v[112:115], v[180:183]
v_mfma_f32_16x16x32_bf16 v[172:175], v[116:119], v[108:111], v[172:175]
v_mfma_f32_16x16x32_bf16 v[164:167], v[116:119], v[104:107], v[164:167]
v_mfma_f32_16x16x32_bf16 v[156:159], v[116:119], v[100:103], v[156:159]
v_mfma_f32_16x16x32_bf16 v[160:163], v[120:123], v[100:103], v[160:163]
v_mfma_f32_16x16x32_bf16 v[168:171], v[120:123], v[104:107], v[168:171]
v_mfma_f32_16x16x32_bf16 v[176:179], v[120:123], v[108:111], v[176:179]
s_waitcnt lgkmcnt(0)
v_mfma_f32_16x16x32_bf16 v[184:187], v[120:123], v[112:115], v[184:187]
s_branch c0_loop
c0_hook:
v_add_u32 v4, s65, v155
ds_read_b64 v[20:21], v4 offset:0
ds_read_b64 v[28:29], v4 offset:2048
v_xor_b32 v5, 32, v4
ds_read_b64 v[22:23], v5 offset:0
ds_read_b64 v[30:31], v5 offset:2048
v_xor_b32 v5, 64, v4
ds_read_b64 v[24:25], v5 offset:0
ds_read_b64 v[32:33], v5 offset:2048
v_xor_b32 v5, 96, v4
ds_read_b64 v[26:27], v5 offset:0
ds_read_b64 v[34:35], v5 offset:2048
s_waitcnt lgkmcnt(8)
s_cmp_lg_u32 s44, 0
s_cbranch_scc1 else_39
v_mfma_f32_16x16x32_bf16 v[140:143], v[48:51], v[76:79], 0
v_mfma_f32_16x16x32_bf16 v[144:147], v[48:51], v[84:87], 0
v_mfma_f32_16x16x32_bf16 v[148:151], v[48:51], v[92:95], 0
v_mfma_f32_16x16x32_bf16 v[140:143], v[48:51], v[116:119], v[140:143]
v_mfma_f32_16x16x32_bf16 v[144:147], v[48:51], v[124:127], v[144:147]
v_mfma_f32_16x16x32_bf16 v[148:151], v[48:51], v[132:135], v[148:151]
s_branch fi_40
else_39:
v_mfma_f32_16x16x32_bf16 v[140:143], v[48:51], v[80:83], 0
v_mfma_f32_16x16x32_bf16 v[144:147], v[48:51], v[88:91], 0
v_mfma_f32_16x16x32_bf16 v[148:151], v[48:51], v[96:99], 0
v_mfma_f32_16x16x32_bf16 v[140:143], v[48:51], v[120:123], v[140:143]
v_mfma_f32_16x16x32_bf16 v[144:147], v[48:51], v[128:131], v[144:147]
v_mfma_f32_16x16x32_bf16 v[148:151], v[48:51], v[136:139], v[148:151]
fi_40:
s_waitcnt lgkmcnt(0)
v_dot2c_f32_bf16 v152, v20, v48
v_dot2c_f32_bf16 v56, v20, v20
v_dot2c_f32_bf16 v153, v28, v48
v_dot2c_f32_bf16 v57, v28, v28
v_dot2c_f32_bf16 v152, v21, v48
v_dot2c_f32_bf16 v56, v21, v21
v_dot2c_f32_bf16 v153, v29, v48
v_dot2c_f32_bf16 v57, v29, v29
v_dot2c_f32_bf16 v152, v22, v48
v_dot2c_f32_bf16 v56, v22, v22
v_dot2c_f32_bf16 v153, v30, v48
v_dot2c_f32_bf16 v57, v30, v30
v_dot2c_f32_bf16 v152, v23, v48
v_dot2c_f32_bf16 v56, v23, v23
v_dot2c_f32_bf16 v153, v31, v48
v_dot2c_f32_bf16 v57, v31, v31
v_dot2c_f32_bf16 v152, v24, v48
v_dot2c_f32_bf16 v56, v24, v24
v_dot2c_f32_bf16 v153, v32, v48
v_dot2c_f32_bf16 v57, v32, v32
v_dot2c_f32_bf16 v152, v25, v48
v_dot2c_f32_bf16 v56, v25, v25
v_dot2c_f32_bf16 v153, v33, v48
v_dot2c_f32_bf16 v57, v33, v33
v_dot2c_f32_bf16 v152, v26, v48
v_dot2c_f32_bf16 v56, v26, v26
v_dot2c_f32_bf16 v153, v34, v48
v_dot2c_f32_bf16 v57, v34, v34
v_dot2c_f32_bf16 v152, v27, v48
v_dot2c_f32_bf16 v56, v27, v27
v_dot2c_f32_bf16 v153, v35, v48
v_dot2c_f32_bf16 v57, v35, v35
v_cmp_eq_u32 vcc, 0, v3
v_cmp_eq_u32 s[48:49], 1, v3
s_nop 1
v_cndmask_b32 v4, v148, v144, s[48:49]
v_cndmask_b32 v4, v4, v140, vcc
buffer_store_dword v4, v1, s[32:35], s52 offen sc1
s_nop 1
v_permlane32_swap_b32 v152, v153
v_permlane32_swap_b32 v56, v57
v_add_f32 v152, v152, v153
v_add_f32 v56, v56, v57
s_nop 1
v_permlane16_swap_b32 v152, v56
s_nop 0
v_add_f32 v152, v152, v56
buffer_store_dword v152, v1, s[32:35], s87 offen sc1
s_branch c0_hook_ret
c0_last:
v_mfma_f32_16x16x32_bf16 v[176:179], v[80:83], v[68:71], v[176:179]
s_waitcnt lgkmcnt(0)
v_mfma_f32_16x16x32_bf16 v[184:187], v[80:83], v[72:75], v[184:187]
s_barrier
v_mfma_f32_16x16x32_bf16 v[212:215], v[124:127], v[112:115], v[212:215]
ds_read_b128 v[140:143], v7 offset:0
v_mfma_f32_16x16x32_bf16 v[204:207], v[124:127], v[108:111], v[204:207]
ds_read_b128 v[144:147], v7 offset:64
v_mfma_f32_16x16x32_bf16 v[196:199], v[124:127], v[104:107], v[196:199]
ds_read_b128 v[148:151], v7 offset:256
v_mfma_f32_16x16x32_bf16 v[188:191], v[124:127], v[100:103], v[188:191]
ds_read_b128 v[152:155], v7 offset:320
v_mfma_f32_16x16x32_bf16 v[192:195], v[128:131], v[100:103], v[192:195]
ds_read_b64 v[92:93], v8 offset:0
v_mfma_f32_16x16x32_bf16 v[200:203], v[128:131], v[104:107], v[200:203]
ds_read_b64 v[94:95], v8 offset:128
v_mfma_f32_16x16x32_bf16 v[208:211], v[128:131], v[108:111], v[208:211]
ds_read_b64 v[96:97], v8 offset:256
v_mfma_f32_16x16x32_bf16 v[216:219], v[128:131], v[112:115], v[216:219]
ds_read_b64 v[98:99], v8 offset:384
v_mfma_f32_16x16x32_bf16 v[244:247], v[112:115], v[132:135], v[244:247]
ds_read2_b32 v[56:57], v54 offset0:128 offset1:144
v_mfma_f32_16x16x32_bf16 v[236:239], v[108:111], v[132:135], v[236:239]
ds_read_b128 v[60:63], v9 offset:0
v_mfma_f32_16x16x32_bf16 v[228:231], v[104:107], v[132:135], v[228:231]
ds_read_b128 v[64:67], v9 offset:64
v_mfma_f32_16x16x32_bf16 v[220:223], v[100:103], v[132:135], v[220:223]
ds_read_b128 v[68:71], v9 offset:128
v_mfma_f32_16x16x32_bf16 v[224:227], v[100:103], v[136:139], v[224:227]
ds_read_b128 v[72:75], v9 offset:192
v_mfma_f32_16x16x32_bf16 v[232:235], v[104:107], v[136:139], v[232:235]
ds_read_b128 v[76:79], v9 offset:512
v_mfma_f32_16x16x32_bf16 v[240:243], v[108:111], v[136:139], v[240:243]
ds_read_b128 v[80:83], v9 offset:576
v_mfma_f32_16x16x32_bf16 v[248:251], v[112:115], v[136:139], v[248:251]
ds_read_b128 v[84:87], v9 offset:640
v_mfma_f32_16x16x32_bf16 v[180:183], v[116:119], v[112:115], v[180:183]
ds_read_b128 v[88:91], v9 offset:704
v_mfma_f32_16x16x32_bf16 v[172:175], v[116:119], v[108:111], v[172:175]
v_mov_b32 v6, 134656
ds_read_b32 v6, v6
v_mfma_f32_16x16x32_bf16 v[164:167], v[116:119], v[104:107], v[164:167]
v_mfma_f32_16x16x32_bf16 v[156:159], v[116:119], v[100:103], v[156:159]
v_mfma_f32_16x16x32_bf16 v[160:163], v[120:123], v[100:103], v[160:163]
v_mfma_f32_16x16x32_bf16 v[168:171], v[120:123], v[104:107], v[168:171]
v_mfma_f32_16x16x32_bf16 v[176:179], v[120:123], v[108:111], v[176:179]
v_mfma_f32_16x16x32_bf16 v[184:187], v[120:123], v[112:115], v[184:187]
c0_epi:
s_waitcnt lgkmcnt(0)
v_readfirstlane_b32 s46, v6
.p2align 3
v_pk_fma_f32 v[212:213], v[148:149], v[98:99], v[212:213] op_sel:[0,1,0] op_sel_hi:[1,1,1]
v_pk_fma_f32 v[214:215], v[150:151], v[98:99], v[214:215] op_sel:[0,1,0] op_sel_hi:[1,1,1]
v_pk_fma_f32 v[216:217], v[152:153], v[98:99], v[216:217] op_sel:[0,1,0] op_sel_hi:[1,1,1]
v_pk_fma_f32 v[218:219], v[154:155], v[98:99], v[218:219] op_sel:[0,1,0] op_sel_hi:[1,1,1]
v_pk_mul_f32 v[212:213], v[212:213], v[98:99] op_sel:[0,0] op_sel_hi:[1,0]
v_pk_mul_f32 v[214:215], v[214:215], v[98:99] op_sel:[0,0] op_sel_hi:[1,0]
v_pk_mul_f32 v[216:217], v[216:217], v[98:99] op_sel:[0,0] op_sel_hi:[1,0]
v_pk_mul_f32 v[218:219], v[218:219], v[98:99] op_sel:[0,0] op_sel_hi:[1,0]
v_cvt_pk_bf16_f32 v212, v212, v213
v_cvt_pk_bf16_f32 v213, v214, v215
v_cvt_pk_bf16_f32 v214, v216, v217
v_cvt_pk_bf16_f32 v215, v218, v219
v_pk_fma_f32 v[244:245], v[88:89], v[56:57], v[244:245] op_sel:[0,0,0] op_sel_hi:[1,0,1]
v_pk_fma_f32 v[246:247], v[90:91], v[56:57], v[246:247] op_sel:[0,0,0] op_sel_hi:[1,0,1]
v_pk_mul_f32 v[244:245], v[244:245], v[72:73]
v_pk_mul_f32 v[246:247], v[246:247], v[74:75]
v_cvt_pk_bf16_f32 v108, v244, v245
v_cvt_pk_bf16_f32 v109, v246, v247
v_pk_fma_f32 v[248:249], v[88:89], v[56:57], v[248:249] op_sel:[0,1,0] op_sel_hi:[1,1,1]
v_pk_fma_f32 v[250:251], v[90:91], v[56:57], v[250:251] op_sel:[0,1,0] op_sel_hi:[1,1,1]
v_pk_mul_f32 v[248:249], v[248:249], v[72:73]
v_pk_mul_f32 v[250:251], v[250:251], v[74:75]
v_cvt_pk_bf16_f32 v118, v248, v249
v_cvt_pk_bf16_f32 v119, v250, v251
s_cmp_lg_u32 s44, 1
s_cbranch_scc1 else_41
buffer_store_dwordx4 v[212:215], v58, s[32:35], 0 offen sc1
buffer_store_dwordx2 v[108:109], v59, s[32:35], 0 offen offset:1024 sc1
buffer_store_dwordx2 v[118:119], v59, s[32:35], 0 offen offset:1536 sc1
s_branch fi_42
else_41:
ds_write_b128 v53, v[212:215]
ds_write_b64 v55, v[108:109] offset:1024
ds_write_b64 v55, v[118:119] offset:1536
v_mov_b32 v4, 1
ds_write_b32 v19, v4
fi_42:
v_mul_f32 v124, s66, v92
v_mul_f32 v125, s66, v94
v_mul_f32 v126, s66, v96
v_mul_f32 v127, s66, v98
.p2align 3
v_pk_fma_f32 v[156:157], v[140:141], v[92:93], v[156:157] op_sel:[0,1,0] op_sel_hi:[1,1,1]
v_pk_fma_f32 v[158:159], v[142:143], v[92:93], v[158:159] op_sel:[0,1,0] op_sel_hi:[1,1,1]
v_pk_fma_f32 v[160:161], v[144:145], v[92:93], v[160:161] op_sel:[0,1,0] op_sel_hi:[1,1,1]
v_pk_fma_f32 v[162:163], v[146:147], v[92:93], v[162:163] op_sel:[0,1,0] op_sel_hi:[1,1,1]
v_cvt_pk_bf16_f32 v156, v156, v157
v_cvt_pk_bf16_f32 v157, v158, v159
v_cvt_pk_bf16_f32 v158, v160, v161
v_cvt_pk_bf16_f32 v159, v162, v163
v_pk_fma_f32 v[164:165], v[140:141], v[94:95], v[164:165] op_sel:[0,1,0] op_sel_hi:[1,1,1]
v_pk_fma_f32 v[166:167], v[142:143], v[94:95], v[166:167] op_sel:[0,1,0] op_sel_hi:[1,1,1]
v_pk_fma_f32 v[168:169], v[144:145], v[94:95], v[168:169] op_sel:[0,1,0] op_sel_hi:[1,1,1]
v_pk_fma_f32 v[170:171], v[146:147], v[94:95], v[170:171] op_sel:[0,1,0] op_sel_hi:[1,1,1]
v_cvt_pk_bf16_f32 v164, v164, v165
v_cvt_pk_bf16_f32 v165, v166, v167
v_cvt_pk_bf16_f32 v166, v168, v169
v_cvt_pk_bf16_f32 v167, v170, v171
v_pk_fma_f32 v[172:173], v[140:141], v[96:97], v[172:173] op_sel:[0,1,0] op_sel_hi:[1,1,1]
v_pk_fma_f32 v[174:175], v[142:143], v[96:97], v[174:175] op_sel:[0,1,0] op_sel_hi:[1,1,1]
v_pk_fma_f32 v[176:177], v[144:145], v[96:97], v[176:177] op_sel:[0,1,0] op_sel_hi:[1,1,1]
v_pk_fma_f32 v[178:179], v[146:147], v[96:97], v[178:179] op_sel:[0,1,0] op_sel_hi:[1,1,1]
v_cvt_pk_bf16_f32 v172, v172, v173
v_cvt_pk_bf16_f32 v173, v174, v175
v_cvt_pk_bf16_f32 v174, v176, v177
v_cvt_pk_bf16_f32 v175, v178, v179
v_pk_fma_f32 v[180:181], v[140:141], v[98:99], v[180:181] op_sel:[0,1,0] op_sel_hi:[1,1,1]
v_pk_fma_f32 v[182:183], v[142:143], v[98:99], v[182:183] op_sel:[0,1,0] op_sel_hi:[1,1,1]
v_pk_fma_f32 v[184:185], v[144:145], v[98:99], v[184:185] op_sel:[0,1,0] op_sel_hi:[1,1,1]
v_pk_fma_f32 v[186:187], v[146:147], v[98:99], v[186:187] op_sel:[0,1,0] op_sel_hi:[1,1,1]
v_cvt_pk_bf16_f32 v180, v180, v181
v_cvt_pk_bf16_f32 v181, v182, v183
v_cvt_pk_bf16_f32 v182, v184, v185
v_cvt_pk_bf16_f32 v183, v186, v187
v_pk_fma_f32 v[188:189], v[148:149], v[92:93], v[188:189] op_sel:[0,1,0] op_sel_hi:[1,1,1]
v_pk_fma_f32 v[190:191], v[150:151], v[92:93], v[190:191] op_sel:[0,1,0] op_sel_hi:[1,1,1]
v_pk_fma_f32 v[192:193], v[152:153], v[92:93], v[192:193] op_sel:[0,1,0] op_sel_hi:[1,1,1]
v_pk_fma_f32 v[194:195], v[154:155], v[92:93], v[194:195] op_sel:[0,1,0] op_sel_hi:[1,1,1]
v_pk_mul_f32 v[188:189], v[188:189], v[92:93] op_sel:[0,0] op_sel_hi:[1,0]
v_pk_mul_f32 v[190:191], v[190:191], v[92:93] op_sel:[0,0] op_sel_hi:[1,0]
v_pk_mul_f32 v[192:193], v[192:193], v[92:93] op_sel:[0,0] op_sel_hi:[1,0]
v_pk_mul_f32 v[194:195], v[194:195], v[92:93] op_sel:[0,0] op_sel_hi:[1,0]
v_cvt_pk_bf16_f32 v188, v188, v189
v_cvt_pk_bf16_f32 v189, v190, v191
v_cvt_pk_bf16_f32 v190, v192, v193
v_cvt_pk_bf16_f32 v191, v194, v195
v_pk_fma_f32 v[196:197], v[148:149], v[94:95], v[196:197] op_sel:[0,1,0] op_sel_hi:[1,1,1]
v_pk_fma_f32 v[198:199], v[150:151], v[94:95], v[198:199] op_sel:[0,1,0] op_sel_hi:[1,1,1]
v_pk_fma_f32 v[200:201], v[152:153], v[94:95], v[200:201] op_sel:[0,1,0] op_sel_hi:[1,1,1]
v_pk_fma_f32 v[202:203], v[154:155], v[94:95], v[202:203] op_sel:[0,1,0] op_sel_hi:[1,1,1]
v_pk_mul_f32 v[196:197], v[196:197], v[94:95] op_sel:[0,0] op_sel_hi:[1,0]
v_pk_mul_f32 v[198:199], v[198:199], v[94:95] op_sel:[0,0] op_sel_hi:[1,0]
v_pk_mul_f32 v[200:201], v[200:201], v[94:95] op_sel:[0,0] op_sel_hi:[1,0]
v_pk_mul_f32 v[202:203], v[202:203], v[94:95] op_sel:[0,0] op_sel_hi:[1,0]
v_cvt_pk_bf16_f32 v196, v196, v197
v_cvt_pk_bf16_f32 v197, v198, v199
v_cvt_pk_bf16_f32 v198, v200, v201
v_cvt_pk_bf16_f32 v199, v202, v203
v_pk_fma_f32 v[204:205], v[148:149], v[96:97], v[204:205] op_sel:[0,1,0] op_sel_hi:[1,1,1]
v_pk_fma_f32 v[206:207], v[150:151], v[96:97], v[206:207] op_sel:[0,1,0] op_sel_hi:[1,1,1]
v_pk_fma_f32 v[208:209], v[152:153], v[96:97], v[208:209] op_sel:[0,1,0] op_sel_hi:[1,1,1]
v_pk_fma_f32 v[210:211], v[154:155], v[96:97], v[210:211] op_sel:[0,1,0] op_sel_hi:[1,1,1]
v_pk_mul_f32 v[204:205], v[204:205], v[96:97] op_sel:[0,0] op_sel_hi:[1,0]
v_pk_mul_f32 v[206:207], v[206:207], v[96:97] op_sel:[0,0] op_sel_hi:[1,0]
v_pk_mul_f32 v[208:209], v[208:209], v[96:97] op_sel:[0,0] op_sel_hi:[1,0]
v_pk_mul_f32 v[210:211], v[210:211], v[96:97] op_sel:[0,0] op_sel_hi:[1,0]
v_cvt_pk_bf16_f32 v204, v204, v205
v_cvt_pk_bf16_f32 v205, v206, v207
v_cvt_pk_bf16_f32 v206, v208, v209
v_cvt_pk_bf16_f32 v207, v210, v211
s_cmp_lg_u32 s44, 0
s_cbranch_scc1 else_43
buffer_load_dwordx4 v[120:123], v58, s[32:35], 0 offen sc1
buffer_load_dwordx2 v[100:101], v59, s[32:35], 0 offen offset:1024 sc1
buffer_load_dwordx2 v[110:111], v59, s[32:35], 0 offen offset:1536 sc1
else_43:
.p2align 3
v_mfma_f32_16x16x32_bf16 v[216:219], v[212:215], v[180:183], v[40:43]
v_pk_fma_f32 v[220:221], v[76:77], v[56:57], v[220:221] op_sel:[0,0,0] op_sel_hi:[1,0,1]
v_pk_fma_f32 v[222:223], v[78:79], v[56:57], v[222:223] op_sel:[0,0,0] op_sel_hi:[1,0,1]
v_pk_mul_f32 v[220:221], v[220:221], v[60:61]
v_pk_mul_f32 v[222:223], v[222:223], v[62:63]
v_cvt_pk_bf16_f32 v102, v220, v221
v_mfma_f32_16x16x32_bf16 v[192:195], v[188:191], v[156:159], v[40:43]
v_cvt_pk_bf16_f32 v103, v222, v223
v_pk_fma_f32 v[224:225], v[76:77], v[56:57], v[224:225] op_sel:[0,1,0] op_sel_hi:[1,1,1]
v_pk_fma_f32 v[226:227], v[78:79], v[56:57], v[226:227] op_sel:[0,1,0] op_sel_hi:[1,1,1]
v_pk_mul_f32 v[224:225], v[224:225], v[60:61]
v_pk_mul_f32 v[226:227], v[226:227], v[62:63]
v_cvt_pk_bf16_f32 v112, v224, v225
v_mfma_f32_16x16x32_bf16 v[168:171], v[188:191], v[164:167], v[36:39]
v_cvt_pk_bf16_f32 v113, v226, v227
v_pk_fma_f32 v[228:229], v[80:81], v[56:57], v[228:229] op_sel:[0,0,0] op_sel_hi:[1,0,1]
v_pk_fma_f32 v[230:231], v[82:83], v[56:57], v[230:231] op_sel:[0,0,0] op_sel_hi:[1,0,1]
v_pk_mul_f32 v[228:229], v[228:229], v[64:65]
v_pk_mul_f32 v[230:231], v[230:231], v[66:67]
v_cvt_pk_bf16_f32 v104, v228, v229
v_mfma_f32_16x16x32_bf16 v[200:203], v[196:199], v[164:167], v[40:43]
v_cvt_pk_bf16_f32 v105, v230, v231
v_pk_fma_f32 v[232:233], v[80:81], v[56:57], v[232:233] op_sel:[0,1,0] op_sel_hi:[1,1,1]
v_pk_fma_f32 v[234:235], v[82:83], v[56:57], v[234:235] op_sel:[0,1,0] op_sel_hi:[1,1,1]
v_pk_mul_f32 v[232:233], v[232:233], v[64:65]
v_pk_mul_f32 v[234:235], v[234:235], v[66:67]
v_cvt_pk_bf16_f32 v114, v232, v233
v_mfma_f32_16x16x32_bf16 v[176:179], v[196:199], v[172:175], v[36:39]
v_cvt_pk_bf16_f32 v115, v234, v235
v_pk_fma_f32 v[236:237], v[84:85], v[56:57], v[236:237] op_sel:[0,0,0] op_sel_hi:[1,0,1]
v_pk_fma_f32 v[238:239], v[86:87], v[56:57], v[238:239] op_sel:[0,0,0] op_sel_hi:[1,0,1]
v_pk_mul_f32 v[236:237], v[236:237], v[68:69]
v_pk_mul_f32 v[238:239], v[238:239], v[70:71]
v_cvt_pk_bf16_f32 v106, v236, v237
v_mfma_f32_16x16x32_bf16 v[208:211], v[204:207], v[172:175], v[40:43]
v_cvt_pk_bf16_f32 v107, v238, v239
v_pk_fma_f32 v[240:241], v[84:85], v[56:57], v[240:241] op_sel:[0,1,0] op_sel_hi:[1,1,1]
v_pk_fma_f32 v[242:243], v[86:87], v[56:57], v[242:243] op_sel:[0,1,0] op_sel_hi:[1,1,1]
v_pk_mul_f32 v[240:241], v[240:241], v[68:69]
v_pk_mul_f32 v[242:243], v[242:243], v[70:71]
v_cvt_pk_bf16_f32 v116, v240, v241
v_mfma_f32_16x16x32_bf16 v[184:187], v[204:207], v[180:183], v[36:39]
v_cvt_pk_bf16_f32 v117, v242, v243
v_max_f32 v166, v200, v201
v_max_f32 v167, v202, v203
v_max_f32 v164, v168, v169
v_max_f32 v165, v170, v171
v_max3_f32 v129, v164, v165, v166
v_max_f32 v129, v129, v167
s_cmp_lg_u32 s44, 0
s_cbranch_scc1 else_45
s_mov_b32 s63, 0
sent_47:
s_waitcnt vmcnt(0)
v_max_u32 v4, v120, v121
v_max3_u32 v4, v4, v122, v123
v_max3_u32 v4, v4, v100, v101
v_max3_u32 v4, v4, v110, v111
v_cmp_eq_u32 vcc, -1, v4
s_cbranch_vccz sentd_48
buffer_load_dwordx4 v[120:123], v58, s[32:35], 0 offen sc1
buffer_load_dwordx2 v[100:101], v59, s[32:35], 0 offen offset:1024 sc1
buffer_load_dwordx2 v[110:111], v59, s[32:35], 0 offen offset:1536 sc1
s_add_u32 s63, s63, 1
s_cmp_lt_u32 s63, 0x80000
s_cbranch_scc1 sent_47
s_waitcnt vmcnt(0)
sentd_48:
s_branch fi_46
else_45:
s_mov_b32 s63, 0
px_49:
ds_read_b32 v4, v19
ds_read_b128 v[120:123], v53
ds_read_b64 v[100:101], v55 offset:1024
ds_read_b64 v[110:111], v55 offset:1536
s_add_u32 s63, s63, 1
s_cmp_lt_u32 s63, 0x400000
s_waitcnt lgkmcnt(0)
v_cmp_ne_u32 vcc, 1, v4
s_cbranch_vccz pxd_50
s_cbranch_scc1 px_49
pxd_50:
fi_46:
v_mfma_f32_16x16x32_bf16 v[160:163], v[120:123], v[156:159], v[44:47]
v_max_f32 v174, v208, v209
v_max_f32 v175, v210, v211
v_max_f32 v172, v176, v177
v_max_f32 v173, v178, v179
v_max3_f32 v130, v172, v173, v174
v_max_f32 v130, v130, v175
v_max_f32 v182, v216, v217
v_max_f32 v183, v218, v219
v_max_f32 v180, v184, v185
v_max_f32 v181, v186, v187
v_max3_f32 v131, v180, v181, v182
v_max_f32 v131, v131, v183
v_max_f32 v158, v192, v193
v_max_f32 v159, v194, v195
v_max_f32 v156, v160, v161
v_max_f32 v157, v162, v163
v_max3_f32 v128, v156, v157, v158
v_max_f32 v128, v128, v159
s_nop 1
v_permlane32_swap_b32 v128, v129
v_permlane32_swap_b32 v130, v131
v_max_f32 v128, v128, v129
v_max_f32 v130, v130, v131
s_nop 1
v_permlane16_swap_b32 v128, v130
s_nop 0
v_max_f32 v128, v128, v130
v_mov_b32 v130, v128
s_nop 1
v_permlane16_swap_b32 v128, v130
s_nop 0
v_mov_b32 v129, v128
v_mov_b32 v131, v130
s_nop 0
v_permlane32_swap_b32 v128, v129
v_permlane32_swap_b32 v130, v131
v_pk_mul_f32 v[128:129], v[128:129], v[124:125]
v_pk_mul_f32 v[130:131], v[130:131], v[126:127]
v_pk_fma_f32 v[156:157], v[156:157], v[124:125], v[128:129] op_sel:[0,0,0] op_sel_hi:[1,0,0] neg_lo:[0,0,1] neg_hi:[0,0,1]
v_pk_fma_f32 v[158:159], v[158:159], v[124:125], v[128:129] op_sel:[0,0,0] op_sel_hi:[1,0,0] neg_lo:[0,0,1] neg_hi:[0,0,1]
v_exp_f32 v156, v156
v_exp_f32 v157, v157
v_exp_f32 v158, v158
v_exp_f32 v159, v159
v_cvt_pk_bf16_f32 v156, v156, v156
v_cvt_pk_bf16_f32 v157, v157, v157
v_cvt_pk_bf16_f32 v158, v158, v158
v_cvt_pk_bf16_f32 v159, v159, v159
v_and_b32 v156, v52, v156
v_and_b32 v157, v52, v157
v_and_b32 v158, v52, v158
v_and_b32 v159, v52, v159
v_pk_fma_f32 v[164:165], v[164:165], v[124:125], v[128:129] op_sel:[0,1,1] op_sel_hi:[1,1,1] neg_lo:[0,0,1] neg_hi:[0,0,1]
v_pk_fma_f32 v[166:167], v[166:167], v[124:125], v[128:129] op_sel:[0,1,1] op_sel_hi:[1,1,1] neg_lo:[0,0,1] neg_hi:[0,0,1]
v_exp_f32 v164, v164
v_mfma_f32_16x16x32_bf16 v[160:163], v[48:51], v[156:159], 0
v_exp_f32 v165, v165
v_exp_f32 v166, v166
v_exp_f32 v167, v167
v_cvt_pk_bf16_f32 v164, v164, v164
v_mfma_f32_16x16x32_bf16 v[220:223], v[100:103], v[156:159], 0
v_cvt_pk_bf16_f32 v165, v165, v165
v_cvt_pk_bf16_f32 v166, v166, v166
v_cvt_pk_bf16_f32 v167, v167, v167
v_and_b32 v164, v52, v164
v_mfma_f32_16x16x32_bf16 v[224:227], v[110:113], v[156:159], 0
v_and_b32 v165, v52, v165
v_and_b32 v166, v52, v166
v_and_b32 v167, v52, v167
v_pk_fma_f32 v[172:173], v[172:173], v[126:127], v[130:131] op_sel:[0,0,0] op_sel_hi:[1,0,0] neg_lo:[0,0,1] neg_hi:[0,0,1]
v_pk_fma_f32 v[174:175], v[174:175], v[126:127], v[130:131] op_sel:[0,0,0] op_sel_hi:[1,0,0] neg_lo:[0,0,1] neg_hi:[0,0,1]
v_exp_f32 v172, v172
v_mfma_f32_16x16x32_bf16 v[168:171], v[48:51], v[164:167], 0
v_exp_f32 v173, v173
v_exp_f32 v174, v174
v_exp_f32 v175, v175
v_cvt_pk_bf16_f32 v172, v172, v172
v_mfma_f32_16x16x32_bf16 v[228:231], v[102:105], v[164:167], 0
v_cvt_pk_bf16_f32 v173, v173, v173
v_cvt_pk_bf16_f32 v174, v174, v174
v_cvt_pk_bf16_f32 v175, v175, v175
v_and_b32 v172, v52, v172
v_mfma_f32_16x16x32_bf16 v[232:235], v[112:115], v[164:167], 0
v_and_b32 v173, v52, v173
v_and_b32 v174, v52, v174
v_and_b32 v175, v52, v175
v_pk_fma_f32 v[180:181], v[180:181], v[126:127], v[130:131] op_sel:[0,1,1] op_sel_hi:[1,1,1] neg_lo:[0,0,1] neg_hi:[0,0,1]
v_pk_fma_f32 v[182:183], v[182:183], v[126:127], v[130:131] op_sel:[0,1,1] op_sel_hi:[1,1,1] neg_lo:[0,0,1] neg_hi:[0,0,1]
v_exp_f32 v180, v180
v_mfma_f32_16x16x32_bf16 v[176:179], v[48:51], v[172:175], 0
v_exp_f32 v181, v181
v_exp_f32 v182, v182
v_exp_f32 v183, v183
v_cvt_pk_bf16_f32 v180, v180, v180
v_mfma_f32_16x16x32_bf16 v[236:239], v[104:107], v[172:175], 0
v_cvt_pk_bf16_f32 v181, v181, v181
v_cvt_pk_bf16_f32 v182, v182, v182
v_cvt_pk_bf16_f32 v183, v183, v183
v_and_b32 v180, v52, v180
v_mfma_f32_16x16x32_bf16 v[240:243], v[114:117], v[172:175], 0
v_and_b32 v181, v52, v181
v_and_b32 v182, v52, v182
v_and_b32 v183, v52, v183
v_rcp_f32 v160, v160
v_rcp_f32 v168, v168
v_mfma_f32_16x16x32_bf16 v[184:187], v[48:51], v[180:183], 0
v_mfma_f32_16x16x32_bf16 v[244:247], v[106:109], v[180:183], 0
v_mfma_f32_16x16x32_bf16 v[248:251], v[116:119], v[180:183], 0
v_rcp_f32 v176, v176
s_nop 4
v_rcp_f32 v184, v184
s_cmp_eq_u32 s46, 0
s_cbranch_scc1 slow_51
.p2align 3
v_pk_mul_f32 v[220:221], v[220:221], v[160:161] op_sel:[0,0] op_sel_hi:[1,0]
v_pk_mul_f32 v[222:223], v[222:223], v[160:161] op_sel:[0,0] op_sel_hi:[1,0]
v_pk_mul_f32 v[224:225], v[224:225], v[160:161] op_sel:[0,0] op_sel_hi:[1,0]
v_pk_mul_f32 v[226:227], v[226:227], v[160:161] op_sel:[0,0] op_sel_hi:[1,0]
v_cvt_pk_bf16_f32 v220, v220, v221
v_cvt_pk_bf16_f32 v221, v222, v223
v_cvt_pk_bf16_f32 v222, v224, v225
v_cvt_pk_bf16_f32 v223, v226, v227
buffer_store_dwordx4 v[220:223], v18, s[32:35], s80 offen sc1
v_pk_mul_f32 v[228:229], v[228:229], v[168:169] op_sel:[0,0] op_sel_hi:[1,0]
v_pk_mul_f32 v[230:231], v[230:231], v[168:169] op_sel:[0,0] op_sel_hi:[1,0]
v_pk_mul_f32 v[232:233], v[232:233], v[168:169] op_sel:[0,0] op_sel_hi:[1,0]
v_pk_mul_f32 v[234:235], v[234:235], v[168:169] op_sel:[0,0] op_sel_hi:[1,0]
v_cvt_pk_bf16_f32 v228, v228, v229
v_cvt_pk_bf16_f32 v229, v230, v231
v_cvt_pk_bf16_f32 v230, v232, v233
v_cvt_pk_bf16_f32 v231, v234, v235
buffer_store_dwordx4 v[228:231], v18, s[32:35], s81 offen sc1
v_pk_mul_f32 v[236:237], v[236:237], v[176:177] op_sel:[0,0] op_sel_hi:[1,0]
v_pk_mul_f32 v[238:239], v[238:239], v[176:177] op_sel:[0,0] op_sel_hi:[1,0]
v_pk_mul_f32 v[240:241], v[240:241], v[176:177] op_sel:[0,0] op_sel_hi:[1,0]
v_pk_mul_f32 v[242:243], v[242:243], v[176:177] op_sel:[0,0] op_sel_hi:[1,0]
v_cvt_pk_bf16_f32 v236, v236, v237
v_cvt_pk_bf16_f32 v237, v238, v239
v_cvt_pk_bf16_f32 v238, v240, v241
v_cvt_pk_bf16_f32 v239, v242, v243
buffer_store_dwordx4 v[236:239], v18, s[32:35], s82 offen sc1
v_pk_mul_f32 v[244:245], v[244:245], v[184:185] op_sel:[0,0] op_sel_hi:[1,0]
v_pk_mul_f32 v[246:247], v[246:247], v[184:185] op_sel:[0,0] op_sel_hi:[1,0]
v_pk_mul_f32 v[248:249], v[248:249], v[184:185] op_sel:[0,0] op_sel_hi:[1,0]
v_pk_mul_f32 v[250:251], v[250:251], v[184:185] op_sel:[0,0] op_sel_hi:[1,0]
v_cvt_pk_bf16_f32 v244, v244, v245
v_cvt_pk_bf16_f32 v245, v246, v247
v_cvt_pk_bf16_f32 v246, v248, v249
v_cvt_pk_bf16_f32 v247, v250, v251
buffer_store_dwordx4 v[244:247], v18, s[32:35], s83 offen sc1
s_barrier
s_lshl_b32 s62, s45, 2
v_mov_b32 v4, s62
v_mov_b32 v5, 1
s_mov_b64 exec, 1
s_waitcnt vmcnt(0)
buffer_store_dword v5, v4, s[32:35], s84 offen
s_mov_b64 exec, -1
back_52:
v_and_b32 v36, 31, v0
v_lshlrev_b32 v36, 2, v36
buffer_load_dword v37, v36, s[32:35], s84 offen sc1
v_lshrrev_b32 v4, 2, v2
v_and_b32 v5, 3, v0
v_lshl_add_u32 v6, v3, 3, v4
v_lshlrev_b32 v6, 7, v6
v_lshl_add_u32 v6, v5, 3, v6
v_lshrrev_b32 v7, 1, v4
v_and_b32 v8, 1, v3
v_lshl_add_u32 v7, v8, 1, v7
v_lshl_add_u32 v10, v7, 5, v6
v_xor_b32 v11, 32, v10
v_xor_b32 v12, 64, v10
v_xor_b32 v13, 96, v10
v_add_u32 v14, 0x10000, v10
v_add_u32 v15, 0x10000, v11
v_add_u32 v16, 0x10000, v12
v_add_u32 v17, 0x10000, v13
ds_read_b64_tr_b16 v[220:221], v10 offset:0
ds_read_b64_tr_b16 v[222:223], v10 offset:512
ds_read_b64_tr_b16 v[224:225], v11 offset:0
ds_read_b64_tr_b16 v[226:227], v11 offset:512
ds_read_b64_tr_b16 v[228:229], v12 offset:0
ds_read_b64_tr_b16 v[230:231], v12 offset:512
ds_read_b64_tr_b16 v[232:233], v13 offset:0
ds_read_b64_tr_b16 v[234:235], v13 offset:512
ds_read_b64_tr_b16 v[236:237], v10 offset:4096
ds_read_b64_tr_b16 v[238:239], v10 offset:4608
ds_read_b64_tr_b16 v[240:241], v11 offset:4096
ds_read_b64_tr_b16 v[242:243], v11 offset:4608
ds_read_b64_tr_b16 v[244:245], v12 offset:4096
ds_read_b64_tr_b16 v[246:247], v12 offset:4608
ds_read_b64_tr_b16 v[248:249], v13 offset:4096
ds_read_b64_tr_b16 v[250:251], v13 offset:4608
s_lshl_b32 s48, s41, 3
s_lshl_b32 s49, s40, 1
s_add_u32 s48, s48, s49
s_lshl_b32 s48, s48, 15
s_add_u32 s48, s48, 4194304
v_add_u32 v38, s48, v18
v_add_u32 v39, 32768, v38
s_lshl_b32 s57, s75, 11
s_add_u32 s87, s87, 262144
v_lshlrev_b32 v60, 16, v20
v_and_b32 v61, 0xffff0000, v20
v_lshlrev_b32 v62, 16, v21
v_and_b32 v63, 0xffff0000, v21
v_lshlrev_b32 v64, 16, v22
v_and_b32 v65, 0xffff0000, v22
v_lshlrev_b32 v66, 16, v23
v_and_b32 v67, 0xffff0000, v23
v_lshlrev_b32 v68, 16, v24
v_and_b32 v69, 0xffff0000, v24
v_lshlrev_b32 v70, 16, v25
v_and_b32 v71, 0xffff0000, v25
v_lshlrev_b32 v72, 16, v26
v_and_b32 v73, 0xffff0000, v26
v_lshlrev_b32 v74, 16, v27
v_and_b32 v75, 0xffff0000, v27
v_lshlrev_b32 v76, 16, v28
v_and_b32 v77, 0xffff0000, v28
v_lshlrev_b32 v78, 16, v29
v_and_b32 v79, 0xffff0000, v29
v_lshlrev_b32 v80, 16, v30
v_and_b32 v81, 0xffff0000, v30
v_lshlrev_b32 v82, 16, v31
v_and_b32 v83, 0xffff0000, v31
v_lshlrev_b32 v84, 16, v32
v_and_b32 v85, 0xffff0000, v32
v_lshlrev_b32 v86, 16, v33
v_and_b32 v87, 0xffff0000, v33
v_lshlrev_b32 v88, 16, v34
v_and_b32 v89, 0xffff0000, v34
v_lshlrev_b32 v90, 16, v35
v_and_b32 v91, 0xffff0000, v35
v_mov_b32 v6, 0
v_mov_b32 v7, 0
v_mov_b32 v8, 0
v_mov_b32 v9, 0
s_lshl_b32 s62, s42, 2
v_mov_b32 v4, s62
v_mov_b32 v5, 1
s_mov_b32 s63, 0
s_waitcnt vmcnt(0)
poll_53:
v_cmp_gt_u32 vcc, 1, v37
s_cbranch_vccz polled_54
buffer_load_dword v37, v36, s[32:35], s84 offen sc1
s_add_u32 s63, s63, 1
s_cmp_lt_u32 s63, 0x80000
s_waitcnt vmcnt(0)
s_cbranch_scc1 poll_53
polled_54:
buffer_load_dwordx4 v[156:159], v38, s[32:35], s57 offen sc1
buffer_load_dwordx4 v[160:163], v39, s[32:35], s57 offen sc1
buffer_load_dwordx4 v[164:167], v38, s[32:35], s57 offen offset:1024 sc1
buffer_load_dwordx4 v[168:171], v39, s[32:35], s57 offen offset:1024 sc1
s_add_u32 s57, s57, 2048
s_and_b32 s57, s57, 0x7fff
buffer_load_dwordx4 v[172:175], v38, s[32:35], s57 offen sc1
buffer_load_dwordx4 v[176:179], v39, s[32:35], s57 offen sc1
buffer_load_dwordx4 v[180:183], v38, s[32:35], s57 offen offset:1024 sc1
buffer_load_dwordx4 v[184:187], v39, s[32:35], s57 offen offset:1024 sc1
s_add_u32 s57, s57, 2048
s_and_b32 s57, s57, 0x7fff
s_waitcnt vmcnt(6) lgkmcnt(8)
v_mfma_f32_16x16x32_bf16 v[60:63], v[220:223], v[156:159], v[60:63]
buffer_load_dwordx4 v[188:191], v38, s[32:35], s57 offen sc1
v_mfma_f32_16x16x32_bf16 v[76:79], v[220:223], v[160:163], v[76:79]
ds_read_b64_tr_b16 v[100:101], v10 offset:8192
ds_read_b64_tr_b16 v[102:103], v10 offset:8704
v_mfma_f32_16x16x32_bf16 v[64:67], v[224:227], v[156:159], v[64:67]
ds_read_b64_tr_b16 v[104:105], v11 offset:8192
ds_read_b64_tr_b16 v[106:107], v11 offset:8704
v_mfma_f32_16x16x32_bf16 v[80:83], v[224:227], v[160:163], v[80:83]
buffer_load_dwordx4 v[192:195], v39, s[32:35], s57 offen sc1
v_mfma_f32_16x16x32_bf16 v[68:71], v[228:231], v[156:159], v[68:71]
ds_read_b64_tr_b16 v[108:109], v12 offset:8192
ds_read_b64_tr_b16 v[110:111], v12 offset:8704
v_mfma_f32_16x16x32_bf16 v[84:87], v[228:231], v[160:163], v[84:87]
ds_read_b64_tr_b16 v[112:113], v13 offset:8192
ds_read_b64_tr_b16 v[114:115], v13 offset:8704
v_mfma_f32_16x16x32_bf16 v[72:75], v[232:235], v[156:159], v[72:75]
v_mfma_f32_16x16x32_bf16 v[88:91], v[232:235], v[160:163], v[88:91]
s_waitcnt vmcnt(6) lgkmcnt(8)
v_mfma_f32_16x16x32_bf16 v[60:63], v[236:239], v[164:167], v[60:63]
buffer_load_dwordx4 v[196:199], v38, s[32:35], s57 offen offset:1024 sc1
v_mfma_f32_16x16x32_bf16 v[76:79], v[236:239], v[168:171], v[76:79]
ds_read_b64_tr_b16 v[220:221], v10 offset:12288
ds_read_b64_tr_b16 v[222:223], v10 offset:12800
v_mfma_f32_16x16x32_bf16 v[64:67], v[240:243], v[164:167], v[64:67]
ds_read_b64_tr_b16 v[224:225], v11 offset:12288
ds_read_b64_tr_b16 v[226:227], v11 offset:12800
v_mfma_f32_16x16x32_bf16 v[80:83], v[240:243], v[168:171], v[80:83]
buffer_load_dwordx4 v[200:203], v39, s[32:35], s57 offen offset:1024 sc1
v_mfma_f32_16x16x32_bf16 v[68:71], v[244:247], v[164:167], v[68:71]
ds_read_b64_tr_b16 v[228:229], v12 offset:12288
ds_read_b64_tr_b16 v[230:231], v12 offset:12800
v_mfma_f32_16x16x32_bf16 v[84:87], v[244:247], v[168:171], v[84:87]
ds_read_b64_tr_b16 v[232:233], v13 offset:12288
ds_read_b64_tr_b16 v[234:235], v13 offset:12800
v_mfma_f32_16x16x32_bf16 v[72:75], v[248:251], v[164:167], v[72:75]
s_add_u32 s57, s57, 2048
s_and_b32 s57, s57, 0x7fff
v_mfma_f32_16x16x32_bf16 v[88:91], v[248:251], v[168:171], v[88:91]
s_waitcnt vmcnt(6) lgkmcnt(8)
v_mfma_f32_16x16x32_bf16 v[60:63], v[100:103], v[172:175], v[60:63]
buffer_load_dwordx4 v[204:207], v38, s[32:35], s57 offen sc1
v_mfma_f32_16x16x32_bf16 v[76:79], v[100:103], v[176:179], v[76:79]
ds_read_b64_tr_b16 v[236:237], v10 offset:16384
ds_read_b64_tr_b16 v[238:239], v10 offset:16896
v_mfma_f32_16x16x32_bf16 v[64:67], v[104:107], v[172:175], v[64:67]
ds_read_b64_tr_b16 v[240:241], v11 offset:16384
ds_read_b64_tr_b16 v[242:243], v11 offset:16896
v_mfma_f32_16x16x32_bf16 v[80:83], v[104:107], v[176:179], v[80:83]
buffer_load_dwordx4 v[208:211], v39, s[32:35], s57 offen sc1
v_mfma_f32_16x16x32_bf16 v[68:71], v[108:111], v[172:175], v[68:71]
ds_read_b64_tr_b16 v[244:245], v12 offset:16384
ds_read_b64_tr_b16 v[246:247], v12 offset:16896
v_mfma_f32_16x16x32_bf16 v[84:87], v[108:111], v[176:179], v[84:87]
ds_read_b64_tr_b16 v[248:249], v13 offset:16384
ds_read_b64_tr_b16 v[250:251], v13 offset:16896
v_mfma_f32_16x16x32_bf16 v[72:75], v[112:115], v[172:175], v[72:75]
v_mfma_f32_16x16x32_bf16 v[88:91], v[112:115], v[176:179], v[88:91]
s_waitcnt vmcnt(6) lgkmcnt(8)
v_mfma_f32_16x16x32_bf16 v[60:63], v[220:223], v[180:183], v[60:63]
buffer_load_dwordx4 v[212:215], v38, s[32:35], s57 offen offset:1024 sc1
v_mfma_f32_16x16x32_bf16 v[76:79], v[220:223], v[184:187], v[76:79]
ds_read_b64_tr_b16 v[100:101], v10 offset:20480
ds_read_b64_tr_b16 v[102:103], v10 offset:20992
v_mfma_f32_16x16x32_bf16 v[64:67], v[224:227], v[180:183], v[64:67]
ds_read_b64_tr_b16 v[104:105], v11 offset:20480
ds_read_b64_tr_b16 v[106:107], v11 offset:20992
v_mfma_f32_16x16x32_bf16 v[80:83], v[224:227], v[184:187], v[80:83]
buffer_load_dwordx4 v[216:219], v39, s[32:35], s57 offen offset:1024 sc1
v_mfma_f32_16x16x32_bf16 v[68:71], v[228:231], v[180:183], v[68:71]
ds_read_b64_tr_b16 v[108:109], v12 offset:20480
ds_read_b64_tr_b16 v[110:111], v12 offset:20992
v_mfma_f32_16x16x32_bf16 v[84:87], v[228:231], v[184:187], v[84:87]
ds_read_b64_tr_b16 v[112:113], v13 offset:20480
ds_read_b64_tr_b16 v[114:115], v13 offset:20992
v_mfma_f32_16x16x32_bf16 v[72:75], v[232:235], v[180:183], v[72:75]
s_add_u32 s57, s57, 2048
s_and_b32 s57, s57, 0x7fff
v_mfma_f32_16x16x32_bf16 v[88:91], v[232:235], v[184:187], v[88:91]
s_waitcnt vmcnt(6) lgkmcnt(8)
v_mfma_f32_16x16x32_bf16 v[60:63], v[236:239], v[188:191], v[60:63]
buffer_load_dwordx4 v[156:159], v38, s[32:35], s57 offen sc1
v_mfma_f32_16x16x32_bf16 v[76:79], v[236:239], v[192:195], v[76:79]
ds_read_b64_tr_b16 v[220:221], v10 offset:24576
ds_read_b64_tr_b16 v[222:223], v10 offset:25088
v_mfma_f32_16x16x32_bf16 v[64:67], v[240:243], v[188:191], v[64:67]
ds_read_b64_tr_b16 v[224:225], v11 offset:24576
ds_read_b64_tr_b16 v[226:227], v11 offset:25088
v_mfma_f32_16x16x32_bf16 v[80:83], v[240:243], v[192:195], v[80:83]
buffer_load_dwordx4 v[160:163], v39, s[32:35], s57 offen sc1
v_mfma_f32_16x16x32_bf16 v[68:71], v[244:247], v[188:191], v[68:71]
ds_read_b64_tr_b16 v[228:229], v12 offset:24576
ds_read_b64_tr_b16 v[230:231], v12 offset:25088
v_mfma_f32_16x16x32_bf16 v[84:87], v[244:247], v[192:195], v[84:87]
ds_read_b64_tr_b16 v[232:233], v13 offset:24576
ds_read_b64_tr_b16 v[234:235], v13 offset:25088
v_mfma_f32_16x16x32_bf16 v[72:75], v[248:251], v[188:191], v[72:75]
v_mfma_f32_16x16x32_bf16 v[88:91], v[248:251], v[192:195], v[88:91]
s_waitcnt vmcnt(6) lgkmcnt(8)
v_mfma_f32_16x16x32_bf16 v[60:63], v[100:103], v[196:199], v[60:63]
buffer_load_dwordx4 v[164:167], v38, s[32:35], s57 offen offset:1024 sc1
v_mfma_f32_16x16x32_bf16 v[76:79], v[100:103], v[200:203], v[76:79]
ds_read_b64_tr_b16 v[236:237], v10 offset:28672
ds_read_b64_tr_b16 v[238:239], v10 offset:29184
v_mfma_f32_16x16x32_bf16 v[64:67], v[104:107], v[196:199], v[64:67]
ds_read_b64_tr_b16 v[240:241], v11 offset:28672
ds_read_b64_tr_b16 v[242:243], v11 offset:29184
v_mfma_f32_16x16x32_bf16 v[80:83], v[104:107], v[200:203], v[80:83]
buffer_load_dwordx4 v[168:171], v39, s[32:35], s57 offen offset:1024 sc1
v_mfma_f32_16x16x32_bf16 v[68:71], v[108:111], v[196:199], v[68:71]
ds_read_b64_tr_b16 v[244:245], v12 offset:28672
ds_read_b64_tr_b16 v[246:247], v12 offset:29184
v_mfma_f32_16x16x32_bf16 v[84:87], v[108:111], v[200:203], v[84:87]
ds_read_b64_tr_b16 v[248:249], v13 offset:28672
ds_read_b64_tr_b16 v[250:251], v13 offset:29184
v_mfma_f32_16x16x32_bf16 v[72:75], v[112:115], v[196:199], v[72:75]
s_add_u32 s57, s57, 2048
s_and_b32 s57, s57, 0x7fff
v_mfma_f32_16x16x32_bf16 v[88:91], v[112:115], v[200:203], v[88:91]
s_waitcnt vmcnt(6) lgkmcnt(8)
v_mfma_f32_16x16x32_bf16 v[60:63], v[220:223], v[204:207], v[60:63]
buffer_load_dwordx4 v[172:175], v38, s[32:35], s57 offen sc1
v_mfma_f32_16x16x32_bf16 v[76:79], v[220:223], v[208:211], v[76:79]
ds_read_b64_tr_b16 v[100:101], v10 offset:32768
ds_read_b64_tr_b16 v[102:103], v10 offset:33280
v_mfma_f32_16x16x32_bf16 v[64:67], v[224:227], v[204:207], v[64:67]
ds_read_b64_tr_b16 v[104:105], v11 offset:32768
ds_read_b64_tr_b16 v[106:107], v11 offset:33280
v_mfma_f32_16x16x32_bf16 v[80:83], v[224:227], v[208:211], v[80:83]
buffer_load_dwordx4 v[176:179], v39, s[32:35], s57 offen sc1
v_mfma_f32_16x16x32_bf16 v[68:71], v[228:231], v[204:207], v[68:71]
ds_read_b64_tr_b16 v[108:109], v12 offset:32768
ds_read_b64_tr_b16 v[110:111], v12 offset:33280
v_mfma_f32_16x16x32_bf16 v[84:87], v[228:231], v[208:211], v[84:87]
ds_read_b64_tr_b16 v[112:113], v13 offset:32768
ds_read_b64_tr_b16 v[114:115], v13 offset:33280
v_mfma_f32_16x16x32_bf16 v[72:75], v[232:235], v[204:207], v[72:75]
v_mfma_f32_16x16x32_bf16 v[88:91], v[232:235], v[208:211], v[88:91]
s_waitcnt vmcnt(6) lgkmcnt(8)
v_mfma_f32_16x16x32_bf16 v[60:63], v[236:239], v[212:215], v[60:63]
buffer_load_dwordx4 v[180:183], v38, s[32:35], s57 offen offset:1024 sc1
v_mfma_f32_16x16x32_bf16 v[76:79], v[236:239], v[216:219], v[76:79]
ds_read_b64_tr_b16 v[220:221], v10 offset:36864
ds_read_b64_tr_b16 v[222:223], v10 offset:37376
v_mfma_f32_16x16x32_bf16 v[64:67], v[240:243], v[212:215], v[64:67]
ds_read_b64_tr_b16 v[224:225], v11 offset:36864
ds_read_b64_tr_b16 v[226:227], v11 offset:37376
v_mfma_f32_16x16x32_bf16 v[80:83], v[240:243], v[216:219], v[80:83]
buffer_load_dwordx4 v[184:187], v39, s[32:35], s57 offen offset:1024 sc1
v_mfma_f32_16x16x32_bf16 v[68:71], v[244:247], v[212:215], v[68:71]
ds_read_b64_tr_b16 v[228:229], v12 offset:36864
ds_read_b64_tr_b16 v[230:231], v12 offset:37376
v_mfma_f32_16x16x32_bf16 v[84:87], v[244:247], v[216:219], v[84:87]
ds_read_b64_tr_b16 v[232:233], v13 offset:36864
ds_read_b64_tr_b16 v[234:235], v13 offset:37376
v_mfma_f32_16x16x32_bf16 v[72:75], v[248:251], v[212:215], v[72:75]
s_add_u32 s57, s57, 2048
s_and_b32 s57, s57, 0x7fff
v_mfma_f32_16x16x32_bf16 v[88:91], v[248:251], v[216:219], v[88:91]
s_waitcnt vmcnt(6) lgkmcnt(8)
v_mfma_f32_16x16x32_bf16 v[60:63], v[100:103], v[156:159], v[60:63]
buffer_load_dwordx4 v[188:191], v38, s[32:35], s57 offen sc1
v_mfma_f32_16x16x32_bf16 v[76:79], v[100:103], v[160:163], v[76:79]
ds_read_b64_tr_b16 v[236:237], v10 offset:40960
ds_read_b64_tr_b16 v[238:239], v10 offset:41472
v_mfma_f32_16x16x32_bf16 v[64:67], v[104:107], v[156:159], v[64:67]
ds_read_b64_tr_b16 v[240:241], v11 offset:40960
ds_read_b64_tr_b16 v[242:243], v11 offset:41472
v_mfma_f32_16x16x32_bf16 v[80:83], v[104:107], v[160:163], v[80:83]
buffer_load_dwordx4 v[192:195], v39, s[32:35], s57 offen sc1
v_mfma_f32_16x16x32_bf16 v[68:71], v[108:111], v[156:159], v[68:71]
ds_read_b64_tr_b16 v[244:245], v12 offset:40960
ds_read_b64_tr_b16 v[246:247], v12 offset:41472
v_mfma_f32_16x16x32_bf16 v[84:87], v[108:111], v[160:163], v[84:87]
ds_read_b64_tr_b16 v[248:249], v13 offset:40960
ds_read_b64_tr_b16 v[250:251], v13 offset:41472
v_mfma_f32_16x16x32_bf16 v[72:75], v[112:115], v[156:159], v[72:75]
v_mfma_f32_16x16x32_bf16 v[88:91], v[112:115], v[160:163], v[88:91]
s_waitcnt vmcnt(6) lgkmcnt(8)
v_mfma_f32_16x16x32_bf16 v[60:63], v[220:223], v[164:167], v[60:63]
buffer_load_dwordx4 v[196:199], v38, s[32:35], s57 offen offset:1024 sc1
v_mfma_f32_16x16x32_bf16 v[76:79], v[220:223], v[168:171], v[76:79]
ds_read_b64_tr_b16 v[100:101], v10 offset:45056
ds_read_b64_tr_b16 v[102:103], v10 offset:45568
v_mfma_f32_16x16x32_bf16 v[64:67], v[224:227], v[164:167], v[64:67]
ds_read_b64_tr_b16 v[104:105], v11 offset:45056
ds_read_b64_tr_b16 v[106:107], v11 offset:45568
v_mfma_f32_16x16x32_bf16 v[80:83], v[224:227], v[168:171], v[80:83]
buffer_load_dwordx4 v[200:203], v39, s[32:35], s57 offen offset:1024 sc1
v_mfma_f32_16x16x32_bf16 v[68:71], v[228:231], v[164:167], v[68:71]
ds_read_b64_tr_b16 v[108:109], v12 offset:45056
ds_read_b64_tr_b16 v[110:111], v12 offset:45568
v_mfma_f32_16x16x32_bf16 v[84:87], v[228:231], v[168:171], v[84:87]
ds_read_b64_tr_b16 v[112:113], v13 offset:45056
ds_read_b64_tr_b16 v[114:115], v13 offset:45568
v_mfma_f32_16x16x32_bf16 v[72:75], v[232:235], v[164:167], v[72:75]
s_add_u32 s57, s57, 2048
s_and_b32 s57, s57, 0x7fff
v_mfma_f32_16x16x32_bf16 v[88:91], v[232:235], v[168:171], v[88:91]
s_waitcnt vmcnt(6) lgkmcnt(8)
v_mfma_f32_16x16x32_bf16 v[60:63], v[236:239], v[172:175], v[60:63]
buffer_load_dwordx4 v[204:207], v38, s[32:35], s57 offen sc1
v_mfma_f32_16x16x32_bf16 v[76:79], v[236:239], v[176:179], v[76:79]
ds_read_b64_tr_b16 v[220:221], v10 offset:49152
ds_read_b64_tr_b16 v[222:223], v10 offset:49664
v_mfma_f32_16x16x32_bf16 v[64:67], v[240:243], v[172:175], v[64:67]
ds_read_b64_tr_b16 v[224:225], v11 offset:49152
ds_read_b64_tr_b16 v[226:227], v11 offset:49664
v_mfma_f32_16x16x32_bf16 v[80:83], v[240:243], v[176:179], v[80:83]
buffer_load_dwordx4 v[208:211], v39, s[32:35], s57 offen sc1
v_mfma_f32_16x16x32_bf16 v[68:71], v[244:247], v[172:175], v[68:71]
ds_read_b64_tr_b16 v[228:229], v12 offset:49152
ds_read_b64_tr_b16 v[230:231], v12 offset:49664
v_mfma_f32_16x16x32_bf16 v[84:87], v[244:247], v[176:179], v[84:87]
ds_read_b64_tr_b16 v[232:233], v13 offset:49152
ds_read_b64_tr_b16 v[234:235], v13 offset:49664
v_mfma_f32_16x16x32_bf16 v[72:75], v[248:251], v[172:175], v[72:75]
v_mfma_f32_16x16x32_bf16 v[88:91], v[248:251], v[176:179], v[88:91]
s_waitcnt vmcnt(6) lgkmcnt(8)
v_mfma_f32_16x16x32_bf16 v[60:63], v[100:103], v[180:183], v[60:63]
buffer_load_dwordx4 v[212:215], v38, s[32:35], s57 offen offset:1024 sc1
v_mfma_f32_16x16x32_bf16 v[76:79], v[100:103], v[184:187], v[76:79]
ds_read_b64_tr_b16 v[236:237], v10 offset:53248
ds_read_b64_tr_b16 v[238:239], v10 offset:53760
v_mfma_f32_16x16x32_bf16 v[64:67], v[104:107], v[180:183], v[64:67]
ds_read_b64_tr_b16 v[240:241], v11 offset:53248
ds_read_b64_tr_b16 v[242:243], v11 offset:53760
v_mfma_f32_16x16x32_bf16 v[80:83], v[104:107], v[184:187], v[80:83]
buffer_load_dwordx4 v[216:219], v39, s[32:35], s57 offen offset:1024 sc1
v_mfma_f32_16x16x32_bf16 v[68:71], v[108:111], v[180:183], v[68:71]
ds_read_b64_tr_b16 v[244:245], v12 offset:53248
ds_read_b64_tr_b16 v[246:247], v12 offset:53760
v_mfma_f32_16x16x32_bf16 v[84:87], v[108:111], v[184:187], v[84:87]
ds_read_b64_tr_b16 v[248:249], v13 offset:53248
ds_read_b64_tr_b16 v[250:251], v13 offset:53760
v_mfma_f32_16x16x32_bf16 v[72:75], v[112:115], v[180:183], v[72:75]
s_add_u32 s57, s57, 2048
s_and_b32 s57, s57, 0x7fff
v_mfma_f32_16x16x32_bf16 v[88:91], v[112:115], v[184:187], v[88:91]
s_waitcnt vmcnt(6) lgkmcnt(8)
v_mfma_f32_16x16x32_bf16 v[60:63], v[220:223], v[188:191], v[60:63]
buffer_load_dwordx4 v[156:159], v38, s[32:35], s57 offen sc1
v_mfma_f32_16x16x32_bf16 v[76:79], v[220:223], v[192:195], v[76:79]
ds_read_b64_tr_b16 v[100:101], v10 offset:57344
ds_read_b64_tr_b16 v[102:103], v10 offset:57856
v_mfma_f32_16x16x32_bf16 v[64:67], v[224:227], v[188:191], v[64:67]
ds_read_b64_tr_b16 v[104:105], v11 offset:57344
ds_read_b64_tr_b16 v[106:107], v11 offset:57856
v_mfma_f32_16x16x32_bf16 v[80:83], v[224:227], v[192:195], v[80:83]
buffer_load_dwordx4 v[160:163], v39, s[32:35], s57 offen sc1
v_mfma_f32_16x16x32_bf16 v[68:71], v[228:231], v[188:191], v[68:71]
ds_read_b64_tr_b16 v[108:109], v12 offset:57344
ds_read_b64_tr_b16 v[110:111], v12 offset:57856
v_mfma_f32_16x16x32_bf16 v[84:87], v[228:231], v[192:195], v[84:87]
ds_read_b64_tr_b16 v[112:113], v13 offset:57344
ds_read_b64_tr_b16 v[114:115], v13 offset:57856
v_mfma_f32_16x16x32_bf16 v[72:75], v[232:235], v[188:191], v[72:75]
v_mfma_f32_16x16x32_bf16 v[88:91], v[232:235], v[192:195], v[88:91]
s_waitcnt vmcnt(6) lgkmcnt(8)
v_mfma_f32_16x16x32_bf16 v[60:63], v[236:239], v[196:199], v[60:63]
buffer_load_dwordx4 v[164:167], v38, s[32:35], s57 offen offset:1024 sc1
v_mfma_f32_16x16x32_bf16 v[76:79], v[236:239], v[200:203], v[76:79]
ds_read_b64_tr_b16 v[220:221], v10 offset:61440
ds_read_b64_tr_b16 v[222:223], v10 offset:61952
v_mfma_f32_16x16x32_bf16 v[64:67], v[240:243], v[196:199], v[64:67]
ds_read_b64_tr_b16 v[224:225], v11 offset:61440
ds_read_b64_tr_b16 v[226:227], v11 offset:61952
v_mfma_f32_16x16x32_bf16 v[80:83], v[240:243], v[200:203], v[80:83]
buffer_load_dwordx4 v[168:171], v39, s[32:35], s57 offen offset:1024 sc1
v_mfma_f32_16x16x32_bf16 v[68:71], v[244:247], v[196:199], v[68:71]
ds_read_b64_tr_b16 v[228:229], v12 offset:61440
ds_read_b64_tr_b16 v[230:231], v12 offset:61952
v_mfma_f32_16x16x32_bf16 v[84:87], v[244:247], v[200:203], v[84:87]
ds_read_b64_tr_b16 v[232:233], v13 offset:61440
ds_read_b64_tr_b16 v[234:235], v13 offset:61952
v_mfma_f32_16x16x32_bf16 v[72:75], v[248:251], v[196:199], v[72:75]
s_add_u32 s57, s57, 2048
s_and_b32 s57, s57, 0x7fff
v_mfma_f32_16x16x32_bf16 v[88:91], v[248:251], v[200:203], v[88:91]
s_waitcnt vmcnt(6) lgkmcnt(8)
v_mfma_f32_16x16x32_bf16 v[60:63], v[100:103], v[204:207], v[60:63]
buffer_load_dwordx4 v[172:175], v38, s[32:35], s57 offen sc1
v_mfma_f32_16x16x32_bf16 v[76:79], v[100:103], v[208:211], v[76:79]
ds_read_b64_tr_b16 v[236:237], v14 offset:0
ds_read_b64_tr_b16 v[238:239], v14 offset:512
v_mfma_f32_16x16x32_bf16 v[64:67], v[104:107], v[204:207], v[64:67]
ds_read_b64_tr_b16 v[240:241], v15 offset:0
ds_read_b64_tr_b16 v[242:243], v15 offset:512
v_mfma_f32_16x16x32_bf16 v[80:83], v[104:107], v[208:211], v[80:83]
buffer_load_dwordx4 v[176:179], v39, s[32:35], s57 offen sc1
v_mfma_f32_16x16x32_bf16 v[68:71], v[108:111], v[204:207], v[68:71]
ds_read_b64_tr_b16 v[244:245], v16 offset:0
ds_read_b64_tr_b16 v[246:247], v16 offset:512
v_mfma_f32_16x16x32_bf16 v[84:87], v[108:111], v[208:211], v[84:87]
ds_read_b64_tr_b16 v[248:249], v17 offset:0
ds_read_b64_tr_b16 v[250:251], v17 offset:512
v_mfma_f32_16x16x32_bf16 v[72:75], v[112:115], v[204:207], v[72:75]
v_mfma_f32_16x16x32_bf16 v[88:91], v[112:115], v[208:211], v[88:91]
s_waitcnt vmcnt(6) lgkmcnt(8)
v_mfma_f32_16x16x32_bf16 v[60:63], v[220:223], v[212:215], v[60:63]
buffer_load_dwordx4 v[180:183], v38, s[32:35], s57 offen offset:1024 sc1
v_mfma_f32_16x16x32_bf16 v[76:79], v[220:223], v[216:219], v[76:79]
ds_read_b64_tr_b16 v[100:101], v14 offset:4096
ds_read_b64_tr_b16 v[102:103], v14 offset:4608
v_mfma_f32_16x16x32_bf16 v[64:67], v[224:227], v[212:215], v[64:67]
ds_read_b64_tr_b16 v[104:105], v15 offset:4096
ds_read_b64_tr_b16 v[106:107], v15 offset:4608
v_mfma_f32_16x16x32_bf16 v[80:83], v[224:227], v[216:219], v[80:83]
buffer_load_dwordx4 v[184:187], v39, s[32:35], s57 offen offset:1024 sc1
v_mfma_f32_16x16x32_bf16 v[68:71], v[228:231], v[212:215], v[68:71]
ds_read_b64_tr_b16 v[108:109], v16 offset:4096
ds_read_b64_tr_b16 v[110:111], v16 offset:4608
v_mfma_f32_16x16x32_bf16 v[84:87], v[228:231], v[216:219], v[84:87]
ds_read_b64_tr_b16 v[112:113], v17 offset:4096
ds_read_b64_tr_b16 v[114:115], v17 offset:4608
v_mfma_f32_16x16x32_bf16 v[72:75], v[232:235], v[212:215], v[72:75]
s_add_u32 s57, s57, 2048
s_and_b32 s57, s57, 0x7fff
v_mfma_f32_16x16x32_bf16 v[88:91], v[232:235], v[216:219], v[88:91]
s_waitcnt vmcnt(6) lgkmcnt(8)
v_mfma_f32_16x16x32_bf16 v[60:63], v[236:239], v[156:159], v[60:63]
buffer_load_dwordx4 v[188:191], v38, s[32:35], s57 offen sc1
v_mfma_f32_16x16x32_bf16 v[76:79], v[236:239], v[160:163], v[76:79]
ds_read_b64_tr_b16 v[220:221], v14 offset:8192
ds_read_b64_tr_b16 v[222:223], v14 offset:8704
v_mfma_f32_16x16x32_bf16 v[64:67], v[240:243], v[156:159], v[64:67]
ds_read_b64_tr_b16 v[224:225], v15 offset:8192
ds_read_b64_tr_b16 v[226:227], v15 offset:8704
v_mfma_f32_16x16x32_bf16 v[80:83], v[240:243], v[160:163], v[80:83]
buffer_load_dwordx4 v[192:195], v39, s[32:35], s57 offen sc1
v_mfma_f32_16x16x32_bf16 v[68:71], v[244:247], v[156:159], v[68:71]
ds_read_b64_tr_b16 v[228:229], v16 offset:8192
ds_read_b64_tr_b16 v[230:231], v16 offset:8704
v_mfma_f32_16x16x32_bf16 v[84:87], v[244:247], v[160:163], v[84:87]
ds_read_b64_tr_b16 v[232:233], v17 offset:8192
ds_read_b64_tr_b16 v[234:235], v17 offset:8704
v_mfma_f32_16x16x32_bf16 v[72:75], v[248:251], v[156:159], v[72:75]
v_mfma_f32_16x16x32_bf16 v[88:91], v[248:251], v[160:163], v[88:91]
s_waitcnt vmcnt(6) lgkmcnt(8)
v_mfma_f32_16x16x32_bf16 v[60:63], v[100:103], v[164:167], v[60:63]
buffer_load_dwordx4 v[196:199], v38, s[32:35], s57 offen offset:1024 sc1
v_mfma_f32_16x16x32_bf16 v[76:79], v[100:103], v[168:171], v[76:79]
ds_read_b64_tr_b16 v[236:237], v14 offset:12288
ds_read_b64_tr_b16 v[238:239], v14 offset:12800
v_mfma_f32_16x16x32_bf16 v[64:67], v[104:107], v[164:167], v[64:67]
ds_read_b64_tr_b16 v[240:241], v15 offset:12288
ds_read_b64_tr_b16 v[242:243], v15 offset:12800
v_mfma_f32_16x16x32_bf16 v[80:83], v[104:107], v[168:171], v[80:83]
buffer_load_dwordx4 v[200:203], v39, s[32:35], s57 offen offset:1024 sc1
v_mfma_f32_16x16x32_bf16 v[68:71], v[108:111], v[164:167], v[68:71]
ds_read_b64_tr_b16 v[244:245], v16 offset:12288
ds_read_b64_tr_b16 v[246:247], v16 offset:12800
v_mfma_f32_16x16x32_bf16 v[84:87], v[108:111], v[168:171], v[84:87]
ds_read_b64_tr_b16 v[248:249], v17 offset:12288
ds_read_b64_tr_b16 v[250:251], v17 offset:12800
v_mfma_f32_16x16x32_bf16 v[72:75], v[112:115], v[164:167], v[72:75]
s_add_u32 s57, s57, 2048
s_and_b32 s57, s57, 0x7fff
v_mfma_f32_16x16x32_bf16 v[88:91], v[112:115], v[168:171], v[88:91]
s_waitcnt vmcnt(6) lgkmcnt(8)
v_mfma_f32_16x16x32_bf16 v[60:63], v[220:223], v[172:175], v[60:63]
buffer_load_dwordx4 v[204:207], v38, s[32:35], s57 offen sc1
v_mfma_f32_16x16x32_bf16 v[76:79], v[220:223], v[176:179], v[76:79]
ds_read_b64_tr_b16 v[100:101], v14 offset:16384
ds_read_b64_tr_b16 v[102:103], v14 offset:16896
v_mfma_f32_16x16x32_bf16 v[64:67], v[224:227], v[172:175], v[64:67]
ds_read_b64_tr_b16 v[104:105], v15 offset:16384
ds_read_b64_tr_b16 v[106:107], v15 offset:16896
v_mfma_f32_16x16x32_bf16 v[80:83], v[224:227], v[176:179], v[80:83]
buffer_load_dwordx4 v[208:211], v39, s[32:35], s57 offen sc1
v_mfma_f32_16x16x32_bf16 v[68:71], v[228:231], v[172:175], v[68:71]
ds_read_b64_tr_b16 v[108:109], v16 offset:16384
ds_read_b64_tr_b16 v[110:111], v16 offset:16896
v_mfma_f32_16x16x32_bf16 v[84:87], v[228:231], v[176:179], v[84:87]
ds_read_b64_tr_b16 v[112:113], v17 offset:16384
ds_read_b64_tr_b16 v[114:115], v17 offset:16896
v_mfma_f32_16x16x32_bf16 v[72:75], v[232:235], v[172:175], v[72:75]
v_mfma_f32_16x16x32_bf16 v[88:91], v[232:235], v[176:179], v[88:91]
s_waitcnt vmcnt(6) lgkmcnt(8)
v_mfma_f32_16x16x32_bf16 v[60:63], v[236:239], v[180:183], v[60:63]
buffer_load_dwordx4 v[212:215], v38, s[32:35], s57 offen offset:1024 sc1
v_mfma_f32_16x16x32_bf16 v[76:79], v[236:239], v[184:187], v[76:79]
ds_read_b64_tr_b16 v[220:221], v14 offset:20480
ds_read_b64_tr_b16 v[222:223], v14 offset:20992
v_mfma_f32_16x16x32_bf16 v[64:67], v[240:243], v[180:183], v[64:67]
ds_read_b64_tr_b16 v[224:225], v15 offset:20480
ds_read_b64_tr_b16 v[226:227], v15 offset:20992
v_mfma_f32_16x16x32_bf16 v[80:83], v[240:243], v[184:187], v[80:83]
buffer_load_dwordx4 v[216:219], v39, s[32:35], s57 offen offset:1024 sc1
v_mfma_f32_16x16x32_bf16 v[68:71], v[244:247], v[180:183], v[68:71]
ds_read_b64_tr_b16 v[228:229], v16 offset:20480
ds_read_b64_tr_b16 v[230:231], v16 offset:20992
v_mfma_f32_16x16x32_bf16 v[84:87], v[244:247], v[184:187], v[84:87]
ds_read_b64_tr_b16 v[232:233], v17 offset:20480
ds_read_b64_tr_b16 v[234:235], v17 offset:20992
v_mfma_f32_16x16x32_bf16 v[72:75], v[248:251], v[180:183], v[72:75]
s_add_u32 s57, s57, 2048
s_and_b32 s57, s57, 0x7fff
v_mfma_f32_16x16x32_bf16 v[88:91], v[248:251], v[184:187], v[88:91]
s_waitcnt vmcnt(6) lgkmcnt(8)
v_mfma_f32_16x16x32_bf16 v[60:63], v[100:103], v[188:191], v[60:63]
buffer_load_dwordx4 v[156:159], v38, s[32:35], s57 offen sc1
v_mfma_f32_16x16x32_bf16 v[76:79], v[100:103], v[192:195], v[76:79]
ds_read_b64_tr_b16 v[236:237], v14 offset:24576
ds_read_b64_tr_b16 v[238:239], v14 offset:25088
v_mfma_f32_16x16x32_bf16 v[64:67], v[104:107], v[188:191], v[64:67]
ds_read_b64_tr_b16 v[240:241], v15 offset:24576
ds_read_b64_tr_b16 v[242:243], v15 offset:25088
v_mfma_f32_16x16x32_bf16 v[80:83], v[104:107], v[192:195], v[80:83]
buffer_load_dwordx4 v[160:163], v39, s[32:35], s57 offen sc1
v_mfma_f32_16x16x32_bf16 v[68:71], v[108:111], v[188:191], v[68:71]
ds_read_b64_tr_b16 v[244:245], v16 offset:24576
ds_read_b64_tr_b16 v[246:247], v16 offset:25088
v_mfma_f32_16x16x32_bf16 v[84:87], v[108:111], v[192:195], v[84:87]
ds_read_b64_tr_b16 v[248:249], v17 offset:24576
ds_read_b64_tr_b16 v[250:251], v17 offset:25088
v_mfma_f32_16x16x32_bf16 v[72:75], v[112:115], v[188:191], v[72:75]
v_mfma_f32_16x16x32_bf16 v[88:91], v[112:115], v[192:195], v[88:91]
s_waitcnt vmcnt(6) lgkmcnt(8)
v_mfma_f32_16x16x32_bf16 v[60:63], v[220:223], v[196:199], v[60:63]
buffer_load_dwordx4 v[164:167], v38, s[32:35], s57 offen offset:1024 sc1
v_mfma_f32_16x16x32_bf16 v[76:79], v[220:223], v[200:203], v[76:79]
ds_read_b64_tr_b16 v[100:101], v14 offset:28672
ds_read_b64_tr_b16 v[102:103], v14 offset:29184
v_mfma_f32_16x16x32_bf16 v[64:67], v[224:227], v[196:199], v[64:67]
ds_read_b64_tr_b16 v[104:105], v15 offset:28672
ds_read_b64_tr_b16 v[106:107], v15 offset:29184
v_mfma_f32_16x16x32_bf16 v[80:83], v[224:227], v[200:203], v[80:83]
buffer_load_dwordx4 v[168:171], v39, s[32:35], s57 offen offset:1024 sc1
v_mfma_f32_16x16x32_bf16 v[68:71], v[228:231], v[196:199], v[68:71]
ds_read_b64_tr_b16 v[108:109], v16 offset:28672
ds_read_b64_tr_b16 v[110:111], v16 offset:29184
v_mfma_f32_16x16x32_bf16 v[84:87], v[228:231], v[200:203], v[84:87]
ds_read_b64_tr_b16 v[112:113], v17 offset:28672
ds_read_b64_tr_b16 v[114:115], v17 offset:29184
v_mfma_f32_16x16x32_bf16 v[72:75], v[232:235], v[196:199], v[72:75]
s_add_u32 s57, s57, 2048
s_and_b32 s57, s57, 0x7fff
v_mfma_f32_16x16x32_bf16 v[88:91], v[232:235], v[200:203], v[88:91]
s_waitcnt vmcnt(6) lgkmcnt(8)
v_mfma_f32_16x16x32_bf16 v[60:63], v[236:239], v[204:207], v[60:63]
buffer_load_dwordx4 v[172:175], v38, s[32:35], s57 offen sc1
v_mfma_f32_16x16x32_bf16 v[76:79], v[236:239], v[208:211], v[76:79]
ds_read_b64_tr_b16 v[220:221], v14 offset:32768
ds_read_b64_tr_b16 v[222:223], v14 offset:33280
v_mfma_f32_16x16x32_bf16 v[64:67], v[240:243], v[204:207], v[64:67]
ds_read_b64_tr_b16 v[224:225], v15 offset:32768
ds_read_b64_tr_b16 v[226:227], v15 offset:33280
v_mfma_f32_16x16x32_bf16 v[80:83], v[240:243], v[208:211], v[80:83]
buffer_load_dwordx4 v[176:179], v39, s[32:35], s57 offen sc1
v_mfma_f32_16x16x32_bf16 v[68:71], v[244:247], v[204:207], v[68:71]
ds_read_b64_tr_b16 v[228:229], v16 offset:32768
ds_read_b64_tr_b16 v[230:231], v16 offset:33280
v_mfma_f32_16x16x32_bf16 v[84:87], v[244:247], v[208:211], v[84:87]
ds_read_b64_tr_b16 v[232:233], v17 offset:32768
ds_read_b64_tr_b16 v[234:235], v17 offset:33280
v_mfma_f32_16x16x32_bf16 v[72:75], v[248:251], v[204:207], v[72:75]
v_mfma_f32_16x16x32_bf16 v[88:91], v[248:251], v[208:211], v[88:91]
s_waitcnt vmcnt(6) lgkmcnt(8)
v_mfma_f32_16x16x32_bf16 v[60:63], v[100:103], v[212:215], v[60:63]
buffer_load_dwordx4 v[180:183], v38, s[32:35], s57 offen offset:1024 sc1
v_mfma_f32_16x16x32_bf16 v[76:79], v[100:103], v[216:219], v[76:79]
ds_read_b64_tr_b16 v[236:237], v14 offset:36864
ds_read_b64_tr_b16 v[238:239], v14 offset:37376
v_mfma_f32_16x16x32_bf16 v[64:67], v[104:107], v[212:215], v[64:67]
ds_read_b64_tr_b16 v[240:241], v15 offset:36864
ds_read_b64_tr_b16 v[242:243], v15 offset:37376
v_mfma_f32_16x16x32_bf16 v[80:83], v[104:107], v[216:219], v[80:83]
buffer_load_dwordx4 v[184:187], v39, s[32:35], s57 offen offset:1024 sc1
v_mfma_f32_16x16x32_bf16 v[68:71], v[108:111], v[212:215], v[68:71]
ds_read_b64_tr_b16 v[244:245], v16 offset:36864
ds_read_b64_tr_b16 v[246:247], v16 offset:37376
v_mfma_f32_16x16x32_bf16 v[84:87], v[108:111], v[216:219], v[84:87]
ds_read_b64_tr_b16 v[248:249], v17 offset:36864
ds_read_b64_tr_b16 v[250:251], v17 offset:37376
v_mfma_f32_16x16x32_bf16 v[72:75], v[112:115], v[212:215], v[72:75]
s_add_u32 s57, s57, 2048
s_and_b32 s57, s57, 0x7fff
v_mfma_f32_16x16x32_bf16 v[88:91], v[112:115], v[216:219], v[88:91]
s_waitcnt vmcnt(6) lgkmcnt(8)
v_mfma_f32_16x16x32_bf16 v[60:63], v[220:223], v[156:159], v[60:63]
buffer_load_dwordx4 v[188:191], v38, s[32:35], s57 offen sc1
v_mfma_f32_16x16x32_bf16 v[76:79], v[220:223], v[160:163], v[76:79]
ds_read_b64_tr_b16 v[100:101], v14 offset:40960
ds_read_b64_tr_b16 v[102:103], v14 offset:41472
v_mfma_f32_16x16x32_bf16 v[64:67], v[224:227], v[156:159], v[64:67]
ds_read_b64_tr_b16 v[104:105], v15 offset:40960
ds_read_b64_tr_b16 v[106:107], v15 offset:41472
v_mfma_f32_16x16x32_bf16 v[80:83], v[224:227], v[160:163], v[80:83]
buffer_load_dwordx4 v[192:195], v39, s[32:35], s57 offen sc1
v_mfma_f32_16x16x32_bf16 v[68:71], v[228:231], v[156:159], v[68:71]
ds_read_b64_tr_b16 v[108:109], v16 offset:40960
ds_read_b64_tr_b16 v[110:111], v16 offset:41472
v_mfma_f32_16x16x32_bf16 v[84:87], v[228:231], v[160:163], v[84:87]
ds_read_b64_tr_b16 v[112:113], v17 offset:40960
ds_read_b64_tr_b16 v[114:115], v17 offset:41472
v_mfma_f32_16x16x32_bf16 v[72:75], v[232:235], v[156:159], v[72:75]
v_mfma_f32_16x16x32_bf16 v[88:91], v[232:235], v[160:163], v[88:91]
s_waitcnt vmcnt(6) lgkmcnt(8)
v_mfma_f32_16x16x32_bf16 v[60:63], v[236:239], v[164:167], v[60:63]
buffer_load_dwordx4 v[196:199], v38, s[32:35], s57 offen offset:1024 sc1
v_mfma_f32_16x16x32_bf16 v[76:79], v[236:239], v[168:171], v[76:79]
ds_read_b64_tr_b16 v[220:221], v14 offset:45056
ds_read_b64_tr_b16 v[222:223], v14 offset:45568
v_mfma_f32_16x16x32_bf16 v[64:67], v[240:243], v[164:167], v[64:67]
ds_read_b64_tr_b16 v[224:225], v15 offset:45056
ds_read_b64_tr_b16 v[226:227], v15 offset:45568
v_mfma_f32_16x16x32_bf16 v[80:83], v[240:243], v[168:171], v[80:83]
buffer_load_dwordx4 v[200:203], v39, s[32:35], s57 offen offset:1024 sc1
v_mfma_f32_16x16x32_bf16 v[68:71], v[244:247], v[164:167], v[68:71]
ds_read_b64_tr_b16 v[228:229], v16 offset:45056
ds_read_b64_tr_b16 v[230:231], v16 offset:45568
v_mfma_f32_16x16x32_bf16 v[84:87], v[244:247], v[168:171], v[84:87]
ds_read_b64_tr_b16 v[232:233], v17 offset:45056
ds_read_b64_tr_b16 v[234:235], v17 offset:45568
v_mfma_f32_16x16x32_bf16 v[72:75], v[248:251], v[164:167], v[72:75]
s_add_u32 s57, s57, 2048
s_and_b32 s57, s57, 0x7fff
v_mfma_f32_16x16x32_bf16 v[88:91], v[248:251], v[168:171], v[88:91]
s_waitcnt vmcnt(6) lgkmcnt(8)
v_mfma_f32_16x16x32_bf16 v[60:63], v[100:103], v[172:175], v[60:63]
buffer_load_dwordx4 v[204:207], v38, s[32:35], s57 offen sc1
v_mfma_f32_16x16x32_bf16 v[76:79], v[100:103], v[176:179], v[76:79]
ds_read_b64_tr_b16 v[236:237], v14 offset:49152
ds_read_b64_tr_b16 v[238:239], v14 offset:49664
v_mfma_f32_16x16x32_bf16 v[64:67], v[104:107], v[172:175], v[64:67]
ds_read_b64_tr_b16 v[240:241], v15 offset:49152
ds_read_b64_tr_b16 v[242:243], v15 offset:49664
v_mfma_f32_16x16x32_bf16 v[80:83], v[104:107], v[176:179], v[80:83]
buffer_load_dwordx4 v[208:211], v39, s[32:35], s57 offen sc1
v_mfma_f32_16x16x32_bf16 v[68:71], v[108:111], v[172:175], v[68:71]
ds_read_b64_tr_b16 v[244:245], v16 offset:49152
ds_read_b64_tr_b16 v[246:247], v16 offset:49664
v_mfma_f32_16x16x32_bf16 v[84:87], v[108:111], v[176:179], v[84:87]
ds_read_b64_tr_b16 v[248:249], v17 offset:49152
ds_read_b64_tr_b16 v[250:251], v17 offset:49664
v_mfma_f32_16x16x32_bf16 v[72:75], v[112:115], v[172:175], v[72:75]
v_mfma_f32_16x16x32_bf16 v[88:91], v[112:115], v[176:179], v[88:91]
s_waitcnt vmcnt(6) lgkmcnt(8)
v_mfma_f32_16x16x32_bf16 v[60:63], v[220:223], v[180:183], v[60:63]
buffer_load_dwordx4 v[212:215], v38, s[32:35], s57 offen offset:1024 sc1
v_mfma_f32_16x16x32_bf16 v[76:79], v[220:223], v[184:187], v[76:79]
ds_read_b64_tr_b16 v[100:101], v14 offset:53248
ds_read_b64_tr_b16 v[102:103], v14 offset:53760
v_mfma_f32_16x16x32_bf16 v[64:67], v[224:227], v[180:183], v[64:67]
ds_read_b64_tr_b16 v[104:105], v15 offset:53248
ds_read_b64_tr_b16 v[106:107], v15 offset:53760
v_mfma_f32_16x16x32_bf16 v[80:83], v[224:227], v[184:187], v[80:83]
buffer_load_dwordx4 v[216:219], v39, s[32:35], s57 offen offset:1024 sc1
v_mfma_f32_16x16x32_bf16 v[68:71], v[228:231], v[180:183], v[68:71]
ds_read_b64_tr_b16 v[108:109], v16 offset:53248
ds_read_b64_tr_b16 v[110:111], v16 offset:53760
v_mfma_f32_16x16x32_bf16 v[84:87], v[228:231], v[184:187], v[84:87]
ds_read_b64_tr_b16 v[112:113], v17 offset:53248
ds_read_b64_tr_b16 v[114:115], v17 offset:53760
v_mfma_f32_16x16x32_bf16 v[72:75], v[232:235], v[180:183], v[72:75]
v_mfma_f32_16x16x32_bf16 v[88:91], v[232:235], v[184:187], v[88:91]
s_waitcnt vmcnt(6) lgkmcnt(8)
v_mfma_f32_16x16x32_bf16 v[60:63], v[236:239], v[188:191], v[60:63]
v_mfma_f32_16x16x32_bf16 v[76:79], v[236:239], v[192:195], v[76:79]
ds_read_b64_tr_b16 v[220:221], v14 offset:57344
ds_read_b64_tr_b16 v[222:223], v14 offset:57856
v_mfma_f32_16x16x32_bf16 v[64:67], v[240:243], v[188:191], v[64:67]
ds_read_b64_tr_b16 v[224:225], v15 offset:57344
ds_read_b64_tr_b16 v[226:227], v15 offset:57856
v_mfma_f32_16x16x32_bf16 v[80:83], v[240:243], v[192:195], v[80:83]
v_mfma_f32_16x16x32_bf16 v[68:71], v[244:247], v[188:191], v[68:71]
ds_read_b64_tr_b16 v[228:229], v16 offset:57344
ds_read_b64_tr_b16 v[230:231], v16 offset:57856
v_mfma_f32_16x16x32_bf16 v[84:87], v[244:247], v[192:195], v[84:87]
ds_read_b64_tr_b16 v[232:233], v17 offset:57344
ds_read_b64_tr_b16 v[234:235], v17 offset:57856
v_mfma_f32_16x16x32_bf16 v[72:75], v[248:251], v[188:191], v[72:75]
v_mfma_f32_16x16x32_bf16 v[88:91], v[248:251], v[192:195], v[88:91]
s_waitcnt vmcnt(4) lgkmcnt(8)
v_mfma_f32_16x16x32_bf16 v[60:63], v[100:103], v[196:199], v[60:63]
v_mfma_f32_16x16x32_bf16 v[76:79], v[100:103], v[200:203], v[76:79]
ds_read_b64_tr_b16 v[236:237], v14 offset:61440
ds_read_b64_tr_b16 v[238:239], v14 offset:61952
v_mfma_f32_16x16x32_bf16 v[64:67], v[104:107], v[196:199], v[64:67]
ds_read_b64_tr_b16 v[240:241], v15 offset:61440
ds_read_b64_tr_b16 v[242:243], v15 offset:61952
v_mfma_f32_16x16x32_bf16 v[80:83], v[104:107], v[200:203], v[80:83]
v_mfma_f32_16x16x32_bf16 v[68:71], v[108:111], v[196:199], v[68:71]
ds_read_b64_tr_b16 v[244:245], v16 offset:61440
ds_read_b64_tr_b16 v[246:247], v16 offset:61952
v_mfma_f32_16x16x32_bf16 v[84:87], v[108:111], v[200:203], v[84:87]
ds_read_b64_tr_b16 v[248:249], v17 offset:61440
ds_read_b64_tr_b16 v[250:251], v17 offset:61952
v_mfma_f32_16x16x32_bf16 v[72:75], v[112:115], v[196:199], v[72:75]
v_mfma_f32_16x16x32_bf16 v[88:91], v[112:115], v[200:203], v[88:91]
s_waitcnt vmcnt(2) lgkmcnt(8)
v_mfma_f32_16x16x32_bf16 v[60:63], v[220:223], v[204:207], v[60:63]
v_mfma_f32_16x16x32_bf16 v[76:79], v[220:223], v[208:211], v[76:79]
v_mfma_f32_16x16x32_bf16 v[64:67], v[224:227], v[204:207], v[64:67]
v_mfma_f32_16x16x32_bf16 v[80:83], v[224:227], v[208:211], v[80:83]
v_mfma_f32_16x16x32_bf16 v[68:71], v[228:231], v[204:207], v[68:71]
v_mfma_f32_16x16x32_bf16 v[84:87], v[228:231], v[208:211], v[84:87]
v_mfma_f32_16x16x32_bf16 v[72:75], v[232:235], v[204:207], v[72:75]
v_mfma_f32_16x16x32_bf16 v[88:91], v[232:235], v[208:211], v[88:91]
s_waitcnt vmcnt(0) lgkmcnt(0)
v_mfma_f32_16x16x32_bf16 v[60:63], v[236:239], v[212:215], v[60:63]
v_mfma_f32_16x16x32_bf16 v[64:67], v[240:243], v[212:215], v[64:67]
v_mfma_f32_16x16x32_bf16 v[68:71], v[244:247], v[212:215], v[68:71]
v_mfma_f32_16x16x32_bf16 v[72:75], v[248:251], v[212:215], v[72:75]
v_mfma_f32_16x16x32_bf16 v[76:79], v[236:239], v[216:219], v[76:79]
v_mfma_f32_16x16x32_bf16 v[80:83], v[240:243], v[216:219], v[80:83]
v_mfma_f32_16x16x32_bf16 v[84:87], v[244:247], v[216:219], v[84:87]
v_mfma_f32_16x16x32_bf16 v[88:91], v[248:251], v[216:219], v[88:91]
s_cmp_eq_u32 s46, 0
s_cbranch_scc1 slow_55
s_nop 0
v_cvt_pk_bf16_f32 v20, v60, v61
v_cvt_pk_bf16_f32 v21, v62, v63
v_cvt_pk_bf16_f32 v22, v64, v65
v_cvt_pk_bf16_f32 v23, v66, v67
buffer_store_dwordx4 v[20:23], v18, s[32:35], s85 offen offset:0 sc1
v_cvt_pk_bf16_f32 v24, v68, v69
v_cvt_pk_bf16_f32 v25, v70, v71
v_cvt_pk_bf16_f32 v26, v72, v73
v_cvt_pk_bf16_f32 v27, v74, v75
buffer_store_dwordx4 v[24:27], v18, s[32:35], s85 offen offset:1024 sc1
v_cvt_pk_bf16_f32 v28, v76, v77
v_cvt_pk_bf16_f32 v29, v78, v79
v_cvt_pk_bf16_f32 v30, v80, v81
v_cvt_pk_bf16_f32 v31, v82, v83
buffer_store_dwordx4 v[28:31], v18, s[32:35], s86 offen offset:0 sc1
v_cvt_pk_bf16_f32 v32, v84, v85
v_cvt_pk_bf16_f32 v33, v86, v87
v_cvt_pk_bf16_f32 v34, v88, v89
v_cvt_pk_bf16_f32 v35, v90, v91
buffer_store_dwordx4 v[32:35], v18, s[32:35], s86 offen offset:1024 sc1
s_barrier
v_dot2c_f32_bf16 v6, v20, v48
v_dot2c_f32_bf16 v8, v20, v20
v_dot2c_f32_bf16 v7, v28, v48
v_dot2c_f32_bf16 v9, v28, v28
v_dot2c_f32_bf16 v6, v21, v48
v_dot2c_f32_bf16 v8, v21, v21
v_dot2c_f32_bf16 v7, v29, v48
v_dot2c_f32_bf16 v9, v29, v29
v_dot2c_f32_bf16 v6, v22, v48
v_dot2c_f32_bf16 v8, v22, v22
v_dot2c_f32_bf16 v7, v30, v48
v_dot2c_f32_bf16 v9, v30, v30
v_dot2c_f32_bf16 v6, v23, v48
v_dot2c_f32_bf16 v8, v23, v23
v_dot2c_f32_bf16 v7, v31, v48
v_dot2c_f32_bf16 v9, v31, v31
v_dot2c_f32_bf16 v6, v24, v48
v_dot2c_f32_bf16 v8, v24, v24
v_dot2c_f32_bf16 v7, v32, v48
v_dot2c_f32_bf16 v9, v32, v32
v_dot2c_f32_bf16 v6, v25, v48
v_dot2c_f32_bf16 v8, v25, v25
v_dot2c_f32_bf16 v7, v33, v48
v_dot2c_f32_bf16 v9, v33, v33
v_dot2c_f32_bf16 v6, v26, v48
v_dot2c_f32_bf16 v8, v26, v26
v_dot2c_f32_bf16 v7, v34, v48
v_dot2c_f32_bf16 v9, v34, v34
v_dot2c_f32_bf16 v6, v27, v48
v_dot2c_f32_bf16 v8, v27, v27
v_dot2c_f32_bf16 v7, v35, v48
v_dot2c_f32_bf16 v9, v35, v35
s_mov_b64 exec, 1
s_waitcnt vmcnt(0)
buffer_store_dword v5, v4, s[32:35], s88 offen
s_mov_b64 exec, -1
s_nop 1
v_permlane32_swap_b32 v6, v7
v_permlane32_swap_b32 v8, v9
v_add_f32 v6, v6, v7
v_add_f32 v8, v8, v9
s_nop 1
v_permlane16_swap_b32 v6, v8
s_nop 0
v_add_f32 v6, v6, v8
buffer_store_dword v6, v1, s[32:35], s87 offen
back_56:
s_lshl_b32 s49, s44, 13
v_add_u32 v10, s49, v18
v_add_u32 v11, 1024, v10
s_lshl_b32 s48, s43, 1
v_lshrrev_b32 v4, 2, v2
v_and_b32 v5, 3, v0
v_lshl_add_u32 v6, v3, 3, v4
v_lshlrev_b32 v6, 7, v6
v_lshl_add_u32 v6, v5, 3, v6
v_lshrrev_b32 v7, 1, v4
v_and_b32 v8, 1, v3
v_lshl_add_u32 v7, v8, 1, v7
v_xor_b32 v7, s48, v7
v_lshl_add_u32 v12, v7, 5, v6
v_add_u32 v12, 16384, v12
v_xor_b32 v13, 32, v12
v_mov_b32 v14, v10
v_mov_b32 v15, v11
v_add_u32 v16, 122880, v12
v_add_u32 v17, 122880, v13
v_mov_b32 v156, 0
v_mov_b32 v157, 0
v_mov_b32 v158, 0
v_mov_b32 v159, 0
v_mov_b32 v160, 0
v_mov_b32 v161, 0
v_mov_b32 v162, 0
v_mov_b32 v163, 0
v_mov_b32 v164, 0
v_mov_b32 v165, 0
v_mov_b32 v166, 0
v_mov_b32 v167, 0
v_mov_b32 v168, 0
v_mov_b32 v169, 0
v_mov_b32 v170, 0
v_mov_b32 v171, 0
v_mov_b32 v172, 0
v_mov_b32 v173, 0
v_mov_b32 v174, 0
v_mov_b32 v175, 0
v_mov_b32 v176, 0
v_mov_b32 v177, 0
v_mov_b32 v178, 0
v_mov_b32 v179, 0
v_mov_b32 v180, 0
v_mov_b32 v181, 0
v_mov_b32 v182, 0
v_mov_b32 v183, 0
v_mov_b32 v184, 0
v_mov_b32 v185, 0
v_mov_b32 v186, 0
v_mov_b32 v187, 0
v_mov_b32 v188, 0
v_mov_b32 v189, 0
v_mov_b32 v190, 0
v_mov_b32 v191, 0
v_mov_b32 v192, 0
v_mov_b32 v193, 0
v_mov_b32 v194, 0
v_mov_b32 v195, 0
v_mov_b32 v196, 0
v_mov_b32 v197, 0
v_mov_b32 v198, 0
v_mov_b32 v199, 0
v_mov_b32 v200, 0
v_mov_b32 v201, 0
v_mov_b32 v202, 0
v_mov_b32 v203, 0
v_mov_b32 v204, 0
v_mov_b32 v205, 0
v_mov_b32 v206, 0
v_mov_b32 v207, 0
v_mov_b32 v208, 0
v_mov_b32 v209, 0
v_mov_b32 v210, 0
v_mov_b32 v211, 0
v_mov_b32 v212, 0
v_mov_b32 v213, 0
v_mov_b32 v214, 0
v_mov_b32 v215, 0
v_mov_b32 v216, 0
v_mov_b32 v217, 0
v_mov_b32 v218, 0
v_mov_b32 v219, 0
v_mov_b32 v220, 0
v_mov_b32 v221, 0
v_mov_b32 v222, 0
v_mov_b32 v223, 0
v_mov_b32 v224, 0
v_mov_b32 v225, 0
v_mov_b32 v226, 0
v_mov_b32 v227, 0
v_mov_b32 v228, 0
v_mov_b32 v229, 0
v_mov_b32 v230, 0
v_mov_b32 v231, 0
v_mov_b32 v232, 0
v_mov_b32 v233, 0
v_mov_b32 v234, 0
v_mov_b32 v235, 0
v_mov_b32 v236, 0
v_mov_b32 v237, 0
v_mov_b32 v238, 0
v_mov_b32 v239, 0
v_mov_b32 v240, 0
v_mov_b32 v241, 0
v_mov_b32 v242, 0
v_mov_b32 v243, 0
v_mov_b32 v244, 0
v_mov_b32 v245, 0
v_mov_b32 v246, 0
v_mov_b32 v247, 0
v_mov_b32 v248, 0
v_mov_b32 v249, 0
v_mov_b32 v250, 0
v_mov_b32 v251, 0
v_lshrrev_b32 v6, 2, v2
v_cmp_eq_u32 vcc, v6, v3
v_and_b32 v7, 1, v0
v_lshlrev_b32 v7, 4, v7
v_mov_b32 v8, 0x3f80
v_lshlrev_b32 v9, v7, v8
v_cndmask_b32 v7, 0, v9, vcc
v_and_b32 v6, 2, v0
v_cmp_eq_u32 vcc, 0, v6
v_mov_b32 v36, 0
v_mov_b32 v37, 0
v_mov_b32 v40, 0
v_mov_b32 v41, 0
v_cndmask_b32 v38, 0, v7, vcc
v_cndmask_b32 v39, v7, 0, vcc
v_lshrrev_b32 v8, 1, v2
v_cmp_eq_u32 vcc, 0, v8
s_nop 1
v_cndmask_b32 v44, 0, v9, vcc
v_cmp_eq_u32 vcc, 1, v8
s_nop 1
v_cndmask_b32 v45, 0, v9, vcc
v_cmp_eq_u32 vcc, 2, v8
s_nop 1
v_cndmask_b32 v46, 0, v9, vcc
v_cmp_eq_u32 vcc, 3, v8
s_nop 1
v_cndmask_b32 v47, 0, v9, vcc
v_lshrrev_b32 v4, 2, v2
v_lshl_add_u32 v4, v3, 2, v4
v_lshlrev_b32 v4, 6, v4
v_and_b32 v5, 3, v0
v_lshl_add_u32 v4, v5, 3, v4
s_lshl_b32 s48, s43, 11
s_add_u32 s48, s48, 135168
v_add_u32 v53, s48, v4
s_mul_i32 s48, s40, 3072
s_add_u32 s48, s48, 139264
v_add_u32 v42, s48, v18
s_xor_b32 s49, s40, 2
s_mul_i32 s48, s49, 3072
s_add_u32 s48, s48, 139264
v_add_u32 v43, s48, v18
s_lshl_b32 s49, s49, 2
s_add_u32 s49, s49, 134672
v_mov_b32 v19, s49
v_xor_b32 v52, 8, v19
v_lshrrev_b32 v4, 3, v0
v_and_b32 v5, 7, v0
v_lshlrev_b32 v4, 11, v4
v_lshl_add_u32 v55, v5, 4, v4
v_lshlrev_b32 v4, 6, v2
v_lshl_add_u32 v58, v3, 4, v4
v_lshlrev_b32 v4, 4, v2
v_lshl_add_u32 v59, v3, 3, v4
s_mul_i32 s51, s42, 393216
s_add_u32 s51, s51, 9437184
s_lshl_b32 s50, s43, 1
s_add_u32 s50, s50, s44
s_lshl_b32 s48, s50, 15
s_add_u32 s48, s48, s51
s_add_u32 s48, s48, 0
s_lshl_b32 s49, s41, 7
s_add_u32 s53, s48, s49
s_add_u32 s54, s53, 16384
s_lshl_b32 s56, s50, 10
s_add_u32 s56, s56, s51
s_add_u32 s56, s56, 344064
s_xor_b32 s57, s56, 1024
s_lshl_b32 s58, s50, 11
s_add_u32 s58, s58, s51
s_add_u32 s58, s58, 327680
s_xor_b32 s59, s58, 2048
s_add_u32 s79, s58, s49
s_lshl_b32 s50, s41, 11
s_add_u32 s55, s48, s50
s_lshl_b32 s48, s43, 7
s_add_u32 s48, s48, 133888
v_lshl_add_u32 v7, v3, 4, s48
v_lshl_add_u32 v54, v2, 2, s48
s_lshl_b32 s49, s44, 6
v_add_u32 v8, s49, v2
v_lshlrev_b32 v8, 3, v8
v_add_u32 v8, 131072, v8
v_lshl_add_u32 v9, v3, 2, s49
v_lshlrev_b32 v9, 2, v9
v_add_u32 v9, 132096, v9
s_mov_b32 s64, 0
s_mov_b32 s65, 0
s_mov_b32 s66, 0x3fb8aa3b
s_mov_b32 s77, s74
s_add_u32 s77, s77, 4
s_lshl_b32 s50, s42, 2
s_add_u32 s50, s50, s40
s_lshl_b32 s50, s50, 4
s_add_u32 s50, s50, s41
s_lshl_b32 s50, s50, 8
s_add_u32 s52, s50, 18087936
s_barrier
ds_read_b128 v[60:63], v14 offset:0
ds_read_b128 v[64:67], v14 offset:2048
ds_read_b128 v[68:71], v14 offset:4096
ds_read_b128 v[72:75], v14 offset:6144
ds_read_b64_tr_b16 v[84:85], v16 offset:8192
ds_read_b64_tr_b16 v[86:87], v16 offset:8704
ds_read_b64_tr_b16 v[88:89], v17 offset:8192
ds_read_b64_tr_b16 v[90:91], v17 offset:8704
ds_read_b64_tr_b16 v[92:93], v16 offset:16384
ds_read_b64_tr_b16 v[94:95], v16 offset:16896
ds_read_b64_tr_b16 v[96:97], v17 offset:16384
ds_read_b64_tr_b16 v[98:99], v17 offset:16896
ds_read_b64_tr_b16 v[76:77], v16 offset:0
ds_read_b64_tr_b16 v[78:79], v16 offset:512
ds_read_b64_tr_b16 v[80:81], v17 offset:0
ds_read_b64_tr_b16 v[82:83], v17 offset:512
s_waitcnt lgkmcnt(0)
c1_loop:
v_mfma_f32_16x16x32_bf16 v[212:215], v[84:87], v[72:75], v[212:215]
ds_read_b128 v[100:103], v15 offset:0
v_mfma_f32_16x16x32_bf16 v[204:207], v[84:87], v[68:71], v[204:207]
ds_read_b128 v[104:107], v15 offset:2048
v_mfma_f32_16x16x32_bf16 v[196:199], v[84:87], v[64:67], v[196:199]
ds_read_b128 v[108:111], v15 offset:4096
v_mfma_f32_16x16x32_bf16 v[188:191], v[84:87], v[60:63], v[188:191]
ds_read_b128 v[112:115], v15 offset:6144
v_mfma_f32_16x16x32_bf16 v[192:195], v[88:91], v[60:63], v[192:195]
ds_read_b64_tr_b16 v[124:125], v16 offset:12288
v_mfma_f32_16x16x32_bf16 v[200:203], v[88:91], v[64:67], v[200:203]
ds_read_b64_tr_b16 v[126:127], v16 offset:12800
v_mfma_f32_16x16x32_bf16 v[208:211], v[88:91], v[68:71], v[208:211]
ds_read_b64_tr_b16 v[128:129], v17 offset:12288
v_mfma_f32_16x16x32_bf16 v[216:219], v[88:91], v[72:75], v[216:219]
ds_read_b64_tr_b16 v[130:131], v17 offset:12800
v_mfma_f32_16x16x32_bf16 v[244:247], v[72:75], v[92:95], v[244:247]
ds_read_b64_tr_b16 v[132:133], v16 offset:20480
v_mfma_f32_16x16x32_bf16 v[236:239], v[68:71], v[92:95], v[236:239]
ds_read_b64_tr_b16 v[134:135], v16 offset:20992
v_mfma_f32_16x16x32_bf16 v[228:231], v[64:67], v[92:95], v[228:231]
ds_read_b64_tr_b16 v[136:137], v17 offset:20480
v_mfma_f32_16x16x32_bf16 v[220:223], v[60:63], v[92:95], v[220:223]
ds_read_b64_tr_b16 v[138:139], v17 offset:20992
v_mfma_f32_16x16x32_bf16 v[224:227], v[60:63], v[96:99], v[224:227]
ds_read_b64_tr_b16 v[116:117], v16 offset:4096
v_mfma_f32_16x16x32_bf16 v[232:235], v[64:67], v[96:99], v[232:235]
ds_read_b64_tr_b16 v[118:119], v16 offset:4608
v_mfma_f32_16x16x32_bf16 v[240:243], v[68:71], v[96:99], v[240:243]
ds_read_b64_tr_b16 v[120:121], v17 offset:4096
v_mfma_f32_16x16x32_bf16 v[248:251], v[72:75], v[96:99], v[248:251]
ds_read_b64_tr_b16 v[122:123], v17 offset:4608
v_mfma_f32_16x16x32_bf16 v[180:183], v[76:79], v[72:75], v[180:183]
s_cmp_eq_u32 s77, s64
s_cbranch_scc1 c1_hook
c1_hook_ret:
v_mfma_f32_16x16x32_bf16 v[172:175], v[76:79], v[68:71], v[172:175]
s_add_u32 s65, s65, 40960
s_cmp_eq_u32 s65, 122880
v_mfma_f32_16x16x32_bf16 v[164:167], v[76:79], v[64:67], v[164:167]
s_cselect_b32 s65, 0, s65
s_add_u32 s64, s64, 1
v_mfma_f32_16x16x32_bf16 v[156:159], v[76:79], v[60:63], v[156:159]
v_add_u32 v14, s65, v10
v_add_u32 v15, s65, v11
v_mfma_f32_16x16x32_bf16 v[160:163], v[80:83], v[60:63], v[160:163]
v_add_u32 v16, s65, v12
v_add_u32 v17, s65, v13
v_mfma_f32_16x16x32_bf16 v[168:171], v[80:83], v[64:67], v[168:171]
s_cmp_eq_u32 s64, 16
s_cbranch_scc1 c1_last
v_mfma_f32_16x16x32_bf16 v[176:179], v[80:83], v[68:71], v[176:179]
s_waitcnt lgkmcnt(0)
v_mfma_f32_16x16x32_bf16 v[184:187], v[80:83], v[72:75], v[184:187]
s_barrier
v_mfma_f32_16x16x32_bf16 v[212:215], v[124:127], v[112:115], v[212:215]
ds_read_b128 v[60:63], v14 offset:0
v_mfma_f32_16x16x32_bf16 v[204:207], v[124:127], v[108:111], v[204:207]
ds_read_b128 v[64:67], v14 offset:2048
v_mfma_f32_16x16x32_bf16 v[196:199], v[124:127], v[104:107], v[196:199]
ds_read_b128 v[68:71], v14 offset:4096
v_mfma_f32_16x16x32_bf16 v[188:191], v[124:127], v[100:103], v[188:191]
ds_read_b128 v[72:75], v14 offset:6144
v_mfma_f32_16x16x32_bf16 v[192:195], v[128:131], v[100:103], v[192:195]
ds_read_b64_tr_b16 v[84:85], v16 offset:8192
v_mfma_f32_16x16x32_bf16 v[200:203], v[128:131], v[104:107], v[200:203]
ds_read_b64_tr_b16 v[86:87], v16 offset:8704
v_mfma_f32_16x16x32_bf16 v[208:211], v[128:131], v[108:111], v[208:211]
ds_read_b64_tr_b16 v[88:89], v17 offset:8192
v_mfma_f32_16x16x32_bf16 v[216:219], v[128:131], v[112:115], v[216:219]
ds_read_b64_tr_b16 v[90:91], v17 offset:8704
v_mfma_f32_16x16x32_bf16 v[244:247], v[112:115], v[132:135], v[244:247]
ds_read_b64_tr_b16 v[92:93], v16 offset:16384
v_mfma_f32_16x16x32_bf16 v[236:239], v[108:111], v[132:135], v[236:239]
ds_read_b64_tr_b16 v[94:95], v16 offset:16896
v_mfma_f32_16x16x32_bf16 v[228:231], v[104:107], v[132:135], v[228:231]
ds_read_b64_tr_b16 v[96:97], v17 offset:16384
v_mfma_f32_16x16x32_bf16 v[220:223], v[100:103], v[132:135], v[220:223]
ds_read_b64_tr_b16 v[98:99], v17 offset:16896
v_mfma_f32_16x16x32_bf16 v[224:227], v[100:103], v[136:139], v[224:227]
ds_read_b64_tr_b16 v[76:77], v16 offset:0
v_mfma_f32_16x16x32_bf16 v[232:235], v[104:107], v[136:139], v[232:235]
ds_read_b64_tr_b16 v[78:79], v16 offset:512
v_mfma_f32_16x16x32_bf16 v[240:243], v[108:111], v[136:139], v[240:243]
ds_read_b64_tr_b16 v[80:81], v17 offset:0
v_mfma_f32_16x16x32_bf16 v[248:251], v[112:115], v[136:139], v[248:251]
ds_read_b64_tr_b16 v[82:83], v17 offset:512
v_mfma_f32_16x16x32_bf16 v[180:183], v[116:119], v[112:115], v[180:183]
v_mfma_f32_16x16x32_bf16 v[172:175], v[116:119], v[108:111], v[172:175]
v_mfma_f32_16x16x32_bf16 v[164:167], v[116:119], v[104:107], v[164:167]
v_mfma_f32_16x16x32_bf16 v[156:159], v[116:119], v[100:103], v[156:159]
v_mfma_f32_16x16x32_bf16 v[160:163], v[120:123], v[100:103], v[160:163]
v_mfma_f32_16x16x32_bf16 v[168:171], v[120:123], v[104:107], v[168:171]
v_mfma_f32_16x16x32_bf16 v[176:179], v[120:123], v[108:111], v[176:179]
s_waitcnt lgkmcnt(0)
v_mfma_f32_16x16x32_bf16 v[184:187], v[120:123], v[112:115], v[184:187]
s_branch c1_loop
c1_hook:
s_waitcnt lgkmcnt(0)
s_cmp_lg_u32 s44, 0
s_cbranch_scc1 else_57
v_mfma_f32_16x16x32_bf16 v[140:143], v[48:51], v[76:79], 0
v_mfma_f32_16x16x32_bf16 v[144:147], v[48:51], v[84:87], 0
v_mfma_f32_16x16x32_bf16 v[148:151], v[48:51], v[92:95], 0
v_mfma_f32_16x16x32_bf16 v[140:143], v[48:51], v[116:119], v[140:143]
v_mfma_f32_16x16x32_bf16 v[144:147], v[48:51], v[124:127], v[144:147]
v_mfma_f32_16x16x32_bf16 v[148:151], v[48:51], v[132:135], v[148:151]
s_branch fi_58
else_57:
v_mfma_f32_16x16x32_bf16 v[140:143], v[48:51], v[80:83], 0
v_mfma_f32_16x16x32_bf16 v[144:147], v[48:51], v[88:91], 0
v_mfma_f32_16x16x32_bf16 v[148:151], v[48:51], v[96:99], 0
v_mfma_f32_16x16x32_bf16 v[140:143], v[48:51], v[120:123], v[140:143]
v_mfma_f32_16x16x32_bf16 v[144:147], v[48:51], v[128:131], v[144:147]
v_mfma_f32_16x16x32_bf16 v[148:151], v[48:51], v[136:139], v[148:151]
fi_58:
s_nop 4
v_cmp_eq_u32 vcc, 0, v3
v_cmp_eq_u32 s[48:49], 1, v3
s_nop 1
v_cndmask_b32 v4, v148, v144, s[48:49]
v_cndmask_b32 v4, v4, v140, vcc
buffer_store_dword v4, v1, s[32:35], s52 offen sc1
s_branch c1_hook_ret
c1_last:
v_mfma_f32_16x16x32_bf16 v[176:179], v[80:83], v[68:71], v[176:179]
s_waitcnt lgkmcnt(0)
v_mfma_f32_16x16x32_bf16 v[184:187], v[80:83], v[72:75], v[184:187]
s_barrier
v_mfma_f32_16x16x32_bf16 v[212:215], v[124:127], v[112:115], v[212:215]
ds_read_b128 v[140:143], v7 offset:0
v_mfma_f32_16x16x32_bf16 v[204:207], v[124:127], v[108:111], v[204:207]
ds_read_b128 v[144:147], v7 offset:64
v_mfma_f32_16x16x32_bf16 v[196:199], v[124:127], v[104:107], v[196:199]
ds_read_b128 v[148:151], v7 offset:256
v_mfma_f32_16x16x32_bf16 v[188:191], v[124:127], v[100:103], v[188:191]
ds_read_b128 v[152:155], v7 offset:320
v_mfma_f32_16x16x32_bf16 v[192:195], v[128:131], v[100:103], v[192:195]
ds_read_b64 v[92:93], v8 offset:0
v_mfma_f32_16x16x32_bf16 v[200:203], v[128:131], v[104:107], v[200:203]
ds_read_b64 v[94:95], v8 offset:128
v_mfma_f32_16x16x32_bf16 v[208:211], v[128:131], v[108:111], v[208:211]
ds_read_b64 v[96:97], v8 offset:256
v_mfma_f32_16x16x32_bf16 v[216:219], v[128:131], v[112:115], v[216:219]
ds_read_b64 v[98:99], v8 offset:384
v_mfma_f32_16x16x32_bf16 v[244:247], v[112:115], v[132:135], v[244:247]
ds_read2_b32 v[56:57], v54 offset0:128 offset1:144
v_mfma_f32_16x16x32_bf16 v[236:239], v[108:111], v[132:135], v[236:239]
ds_read_b128 v[60:63], v9 offset:0
v_mfma_f32_16x16x32_bf16 v[228:231], v[104:107], v[132:135], v[228:231]
ds_read_b128 v[64:67], v9 offset:64
v_mfma_f32_16x16x32_bf16 v[220:223], v[100:103], v[132:135], v[220:223]
ds_read_b128 v[68:71], v9 offset:128
v_mfma_f32_16x16x32_bf16 v[224:227], v[100:103], v[136:139], v[224:227]
ds_read_b128 v[72:75], v9 offset:192
v_mfma_f32_16x16x32_bf16 v[232:235], v[104:107], v[136:139], v[232:235]
ds_read_b128 v[76:79], v9 offset:512
v_mfma_f32_16x16x32_bf16 v[240:243], v[108:111], v[136:139], v[240:243]
ds_read_b128 v[80:83], v9 offset:576
v_mfma_f32_16x16x32_bf16 v[248:251], v[112:115], v[136:139], v[248:251]
ds_read_b128 v[84:87], v9 offset:640
v_mfma_f32_16x16x32_bf16 v[180:183], v[116:119], v[112:115], v[180:183]
ds_read_b128 v[88:91], v9 offset:704
v_mfma_f32_16x16x32_bf16 v[172:175], v[116:119], v[108:111], v[172:175]
ds_read_b64_tr_b16 v[10:11], v53 offset:0
v_mfma_f32_16x16x32_bf16 v[164:167], v[116:119], v[104:107], v[164:167]
ds_read_b64_tr_b16 v[12:13], v53 offset:1024
v_mfma_f32_16x16x32_bf16 v[156:159], v[116:119], v[100:103], v[156:159]
ds_read_b64_tr_b16 v[14:15], v53 offset:32
v_mfma_f32_16x16x32_bf16 v[160:163], v[120:123], v[100:103], v[160:163]
ds_read_b64_tr_b16 v[16:17], v53 offset:1056
v_mfma_f32_16x16x32_bf16 v[168:171], v[120:123], v[104:107], v[168:171]
v_mfma_f32_16x16x32_bf16 v[176:179], v[120:123], v[108:111], v[176:179]
v_mfma_f32_16x16x32_bf16 v[184:187], v[120:123], v[112:115], v[184:187]
c1_epi:
s_waitcnt lgkmcnt(0)
s_mul_i32 s48, s44, 0x80008000
v_xor_b32 v10, s48, v10
v_xor_b32 v11, s48, v11
v_xor_b32 v12, s48, v12
v_xor_b32 v13, s48, v13
v_xor_b32 v14, s48, v14
v_xor_b32 v15, s48, v15
v_xor_b32 v16, s48, v16
v_xor_b32 v17, s48, v17
v_mul_f32 v128, s66, v92
v_mul_f32 v129, s66, v94
v_mul_f32 v130, s66, v96
v_mul_f32 v131, s66, v98
.p2align 3
v_pk_fma_f32 v[220:221], v[76:77], v[56:57], v[220:221] op_sel:[0,0,0] op_sel_hi:[1,0,1]
v_pk_fma_f32 v[222:223], v[78:79], v[56:57], v[222:223] op_sel:[0,0,0] op_sel_hi:[1,0,1]
v_pk_mul_f32 v[220:221], v[220:221], v[60:61]
v_pk_mul_f32 v[222:223], v[222:223], v[62:63]
v_cvt_pk_bf16_f32 v112, v220, v221
v_cvt_pk_bf16_f32 v113, v222, v223
v_pk_fma_f32 v[228:229], v[80:81], v[56:57], v[228:229] op_sel:[0,0,0] op_sel_hi:[1,0,1]
v_pk_fma_f32 v[230:231], v[82:83], v[56:57], v[230:231] op_sel:[0,0,0] op_sel_hi:[1,0,1]
v_pk_mul_f32 v[228:229], v[228:229], v[64:65]
v_pk_mul_f32 v[230:231], v[230:231], v[66:67]
v_cvt_pk_bf16_f32 v114, v228, v229
v_cvt_pk_bf16_f32 v115, v230, v231
v_pk_fma_f32 v[236:237], v[84:85], v[56:57], v[236:237] op_sel:[0,0,0] op_sel_hi:[1,0,1]
v_pk_fma_f32 v[238:239], v[86:87], v[56:57], v[238:239] op_sel:[0,0,0] op_sel_hi:[1,0,1]
v_pk_mul_f32 v[236:237], v[236:237], v[68:69]
v_pk_mul_f32 v[238:239], v[238:239], v[70:71]
v_cvt_pk_bf16_f32 v116, v236, v237
v_cvt_pk_bf16_f32 v117, v238, v239
v_pk_fma_f32 v[244:245], v[88:89], v[56:57], v[244:245] op_sel:[0,0,0] op_sel_hi:[1,0,1]
v_pk_fma_f32 v[246:247], v[90:91], v[56:57], v[246:247] op_sel:[0,0,0] op_sel_hi:[1,0,1]
v_pk_mul_f32 v[244:245], v[244:245], v[72:73]
v_pk_mul_f32 v[246:247], v[246:247], v[74:75]
v_cvt_pk_bf16_f32 v118, v244, v245
v_cvt_pk_bf16_f32 v119, v246, v247
v_pk_fma_f32 v[224:225], v[76:77], v[56:57], v[224:225] op_sel:[0,1,0] op_sel_hi:[1,1,1]
v_pk_fma_f32 v[226:227], v[78:79], v[56:57], v[226:227] op_sel:[0,1,0] op_sel_hi:[1,1,1]
v_pk_mul_f32 v[224:225], v[224:225], v[60:61]
v_pk_mul_f32 v[226:227], v[226:227], v[62:63]
v_cvt_pk_bf16_f32 v120, v224, v225
v_cvt_pk_bf16_f32 v121, v226, v227
v_pk_fma_f32 v[232:233], v[80:81], v[56:57], v[232:233] op_sel:[0,1,0] op_sel_hi:[1,1,1]
v_pk_fma_f32 v[234:235], v[82:83], v[56:57], v[234:235] op_sel:[0,1,0] op_sel_hi:[1,1,1]
v_pk_mul_f32 v[232:233], v[232:233], v[64:65]
v_pk_mul_f32 v[234:235], v[234:235], v[66:67]
v_cvt_pk_bf16_f32 v122, v232, v233
v_cvt_pk_bf16_f32 v123, v234, v235
v_pk_fma_f32 v[240:241], v[84:85], v[56:57], v[240:241] op_sel:[0,1,0] op_sel_hi:[1,1,1]
v_pk_fma_f32 v[242:243], v[86:87], v[56:57], v[242:243] op_sel:[0,1,0] op_sel_hi:[1,1,1]
v_pk_mul_f32 v[240:241], v[240:241], v[68:69]
v_pk_mul_f32 v[242:243], v[242:243], v[70:71]
v_cvt_pk_bf16_f32 v124, v240, v241
v_cvt_pk_bf16_f32 v125, v242, v243
v_pk_fma_f32 v[248:249], v[88:89], v[56:57], v[248:249] op_sel:[0,1,0] op_sel_hi:[1,1,1]
v_pk_fma_f32 v[250:251], v[90:91], v[56:57], v[250:251] op_sel:[0,1,0] op_sel_hi:[1,1,1]
v_pk_mul_f32 v[248:249], v[248:249], v[72:73]
v_pk_mul_f32 v[250:251], v[250:251], v[74:75]
v_cvt_pk_bf16_f32 v126, v248, v249
v_cvt_pk_bf16_f32 v127, v250, v251
v_pk_fma_f32 v[188:189], v[148:149], v[92:93], v[188:189] op_sel:[0,1,0] op_sel_hi:[1,1,1]
v_pk_fma_f32 v[190:191], v[150:151], v[92:93], v[190:191] op_sel:[0,1,0] op_sel_hi:[1,1,1]
v_pk_fma_f32 v[192:193], v[152:153], v[92:93], v[192:193] op_sel:[0,1,0] op_sel_hi:[1,1,1]
v_pk_fma_f32 v[194:195], v[154:155], v[92:93], v[194:195] op_sel:[0,1,0] op_sel_hi:[1,1,1]
v_cvt_pk_bf16_f32 v188, v188, v189
v_cvt_pk_bf16_f32 v189, v190, v191
v_cvt_pk_bf16_f32 v190, v192, v193
v_cvt_pk_bf16_f32 v191, v194, v195
v_pk_fma_f32 v[196:197], v[148:149], v[94:95], v[196:197] op_sel:[0,1,0] op_sel_hi:[1,1,1]
v_pk_fma_f32 v[198:199], v[150:151], v[94:95], v[198:199] op_sel:[0,1,0] op_sel_hi:[1,1,1]
v_pk_fma_f32 v[200:201], v[152:153], v[94:95], v[200:201] op_sel:[0,1,0] op_sel_hi:[1,1,1]
v_pk_fma_f32 v[202:203], v[154:155], v[94:95], v[202:203] op_sel:[0,1,0] op_sel_hi:[1,1,1]
v_cvt_pk_bf16_f32 v196, v196, v197
v_mfma_f32_16x16x32_bf16 v[60:63], v[10:13], v[188:191], 0
v_cvt_pk_bf16_f32 v197, v198, v199
v_cvt_pk_bf16_f32 v198, v200, v201
v_mfma_f32_16x16x32_bf16 v[64:67], v[14:17], v[188:191], 0
v_cvt_pk_bf16_f32 v199, v202, v203
v_pk_fma_f32 v[204:205], v[148:149], v[96:97], v[204:205] op_sel:[0,1,0] op_sel_hi:[1,1,1]
v_pk_fma_f32 v[206:207], v[150:151], v[96:97], v[206:207] op_sel:[0,1,0] op_sel_hi:[1,1,1]
v_pk_fma_f32 v[208:209], v[152:153], v[96:97], v[208:209] op_sel:[0,1,0] op_sel_hi:[1,1,1]
v_pk_fma_f32 v[210:211], v[154:155], v[96:97], v[210:211] op_sel:[0,1,0] op_sel_hi:[1,1,1]
v_cvt_pk_bf16_f32 v204, v204, v205
v_mfma_f32_16x16x32_bf16 v[68:71], v[10:13], v[196:199], 0
v_cvt_pk_bf16_f32 v205, v206, v207
v_cvt_pk_bf16_f32 v206, v208, v209
v_mfma_f32_16x16x32_bf16 v[72:75], v[14:17], v[196:199], 0
v_cvt_pk_bf16_f32 v207, v210, v211
v_pk_fma_f32 v[212:213], v[148:149], v[98:99], v[212:213] op_sel:[0,1,0] op_sel_hi:[1,1,1]
v_pk_fma_f32 v[214:215], v[150:151], v[98:99], v[214:215] op_sel:[0,1,0] op_sel_hi:[1,1,1]
v_pk_fma_f32 v[216:217], v[152:153], v[98:99], v[216:217] op_sel:[0,1,0] op_sel_hi:[1,1,1]
v_pk_fma_f32 v[218:219], v[154:155], v[98:99], v[218:219] op_sel:[0,1,0] op_sel_hi:[1,1,1]
v_cvt_pk_bf16_f32 v212, v212, v213
v_mfma_f32_16x16x32_bf16 v[76:79], v[10:13], v[204:207], 0
v_cvt_pk_bf16_f32 v213, v214, v215
v_cvt_pk_bf16_f32 v214, v216, v217
v_mfma_f32_16x16x32_bf16 v[80:83], v[14:17], v[204:207], 0
v_cvt_pk_bf16_f32 v215, v218, v219
s_nop 1
v_mfma_f32_16x16x32_bf16 v[84:87], v[10:13], v[212:215], 0
v_mfma_f32_16x16x32_bf16 v[88:91], v[14:17], v[212:215], 0
v_max3_f32 v100, v60, v61, v62
v_min3_f32 v104, v60, v61, v62
v_max3_f32 v100, v100, v63, v64
v_min3_f32 v104, v104, v63, v64
v_max3_f32 v100, v100, v65, v66
v_min3_f32 v104, v104, v65, v66
v_max_f32 v100, v100, v67
v_min_f32 v104, v104, v67
v_max3_f32 v101, v68, v69, v70
v_min3_f32 v105, v68, v69, v70
v_max3_f32 v101, v101, v71, v72
v_min3_f32 v105, v105, v71, v72
v_max3_f32 v101, v101, v73, v74
v_min3_f32 v105, v105, v73, v74
v_max_f32 v101, v101, v75
v_min_f32 v105, v105, v75
v_max3_f32 v102, v76, v77, v78
v_min3_f32 v106, v76, v77, v78
v_max3_f32 v102, v102, v79, v80
v_min3_f32 v106, v106, v79, v80
v_max3_f32 v102, v102, v81, v82
v_min3_f32 v106, v106, v81, v82
v_max_f32 v102, v102, v83
v_min_f32 v106, v106, v83
v_max3_f32 v103, v84, v85, v86
v_min3_f32 v107, v84, v85, v86
v_max3_f32 v103, v103, v87, v88
v_min3_f32 v107, v107, v87, v88
v_max3_f32 v103, v103, v89, v90
v_min3_f32 v107, v107, v89, v90
v_max_f32 v103, v103, v91
v_min_f32 v107, v107, v91
s_nop 1
v_permlane32_swap_b32 v100, v101
v_permlane32_swap_b32 v102, v103
v_permlane32_swap_b32 v104, v105
v_permlane32_swap_b32 v106, v107
v_max_f32 v100, v100, v101
v_max_f32 v102, v102, v103
v_min_f32 v104, v104, v105
v_min_f32 v106, v106, v107
v_permlane16_swap_b32 v100, v102
s_nop 0
v_permlane16_swap_b32 v104, v106
v_max_f32 v100, v100, v102
v_min_f32 v104, v104, v106
v_mov_b32 v102, v100
v_mov_b32 v106, v104
s_nop 0
v_permlane16_swap_b32 v100, v102
v_permlane16_swap_b32 v104, v106
v_mov_b32 v101, v100
v_mov_b32 v103, v102
v_mov_b32 v105, v104
v_mov_b32 v107, v106
v_permlane32_swap_b32 v100, v101
v_permlane32_swap_b32 v102, v103
v_permlane32_swap_b32 v104, v105
v_permlane32_swap_b32 v106, v107
v_pk_mul_f32 v[100:101], v[100:101], v[128:129]
v_pk_mul_f32 v[102:103], v[102:103], v[130:131]
v_pk_mul_f32 v[104:105], v[104:105], v[128:129]
v_pk_mul_f32 v[106:107], v[106:107], v[130:131]
v_pk_fma_f32 v[220:221], v[60:61], v[128:129], v[104:105] op_sel:[0,0,0] op_sel_hi:[1,0,0] neg_lo:[1,0,0] neg_hi:[1,0,0]
v_pk_fma_f32 v[60:61], v[60:61], v[128:129], v[100:101] op_sel:[0,0,0] op_sel_hi:[1,0,0] neg_lo:[0,0,1] neg_hi:[0,0,1]
v_exp_f32 v220, v220
v_exp_f32 v60, v60
v_exp_f32 v221, v221
v_exp_f32 v61, v61
v_pk_fma_f32 v[222:223], v[62:63], v[128:129], v[104:105] op_sel:[0,0,0] op_sel_hi:[1,0,0] neg_lo:[1,0,0] neg_hi:[1,0,0]
v_pk_fma_f32 v[62:63], v[62:63], v[128:129], v[100:101] op_sel:[0,0,0] op_sel_hi:[1,0,0] neg_lo:[0,0,1] neg_hi:[0,0,1]
v_exp_f32 v222, v222
v_exp_f32 v62, v62
v_exp_f32 v223, v223
v_exp_f32 v63, v63
v_pk_fma_f32 v[224:225], v[64:65], v[128:129], v[104:105] op_sel:[0,0,0] op_sel_hi:[1,0,0] neg_lo:[1,0,0] neg_hi:[1,0,0]
v_pk_fma_f32 v[64:65], v[64:65], v[128:129], v[100:101] op_sel:[0,0,0] op_sel_hi:[1,0,0] neg_lo:[0,0,1] neg_hi:[0,0,1]
v_exp_f32 v224, v224
v_exp_f32 v64, v64
v_exp_f32 v225, v225
v_exp_f32 v65, v65
v_pk_fma_f32 v[226:227], v[66:67], v[128:129], v[104:105] op_sel:[0,0,0] op_sel_hi:[1,0,0] neg_lo:[1,0,0] neg_hi:[1,0,0]
v_pk_fma_f32 v[66:67], v[66:67], v[128:129], v[100:101] op_sel:[0,0,0] op_sel_hi:[1,0,0] neg_lo:[0,0,1] neg_hi:[0,0,1]
v_exp_f32 v226, v226
v_exp_f32 v66, v66
v_exp_f32 v227, v227
v_exp_f32 v67, v67
v_pk_fma_f32 v[228:229], v[68:69], v[128:129], v[104:105] op_sel:[0,1,1] op_sel_hi:[1,1,1] neg_lo:[1,0,0] neg_hi:[1,0,0]
v_pk_fma_f32 v[68:69], v[68:69], v[128:129], v[100:101] op_sel:[0,1,1] op_sel_hi:[1,1,1] neg_lo:[0,0,1] neg_hi:[0,0,1]
v_exp_f32 v228, v228
v_exp_f32 v68, v68
v_exp_f32 v229, v229
v_exp_f32 v69, v69
v_pk_fma_f32 v[230:231], v[70:71], v[128:129], v[104:105] op_sel:[0,1,1] op_sel_hi:[1,1,1] neg_lo:[1,0,0] neg_hi:[1,0,0]
v_pk_fma_f32 v[70:71], v[70:71], v[128:129], v[100:101] op_sel:[0,1,1] op_sel_hi:[1,1,1] neg_lo:[0,0,1] neg_hi:[0,0,1]
v_exp_f32 v230, v230
v_exp_f32 v70, v70
v_exp_f32 v231, v231
v_exp_f32 v71, v71
v_pk_fma_f32 v[232:233], v[72:73], v[128:129], v[104:105] op_sel:[0,1,1] op_sel_hi:[1,1,1] neg_lo:[1,0,0] neg_hi:[1,0,0]
v_pk_fma_f32 v[72:73], v[72:73], v[128:129], v[100:101] op_sel:[0,1,1] op_sel_hi:[1,1,1] neg_lo:[0,0,1] neg_hi:[0,0,1]
v_exp_f32 v232, v232
v_exp_f32 v72, v72
v_exp_f32 v233, v233
v_exp_f32 v73, v73
v_pk_fma_f32 v[234:235], v[74:75], v[128:129], v[104:105] op_sel:[0,1,1] op_sel_hi:[1,1,1] neg_lo:[1,0,0] neg_hi:[1,0,0]
v_pk_fma_f32 v[74:75], v[74:75], v[128:129], v[100:101] op_sel:[0,1,1] op_sel_hi:[1,1,1] neg_lo:[0,0,1] neg_hi:[0,0,1]
v_exp_f32 v234, v234
v_exp_f32 v74, v74
v_exp_f32 v235, v235
v_exp_f32 v75, v75
v_pk_fma_f32 v[236:237], v[76:77], v[130:131], v[106:107] op_sel:[0,0,0] op_sel_hi:[1,0,0] neg_lo:[1,0,0] neg_hi:[1,0,0]
v_pk_fma_f32 v[76:77], v[76:77], v[130:131], v[102:103] op_sel:[0,0,0] op_sel_hi:[1,0,0] neg_lo:[0,0,1] neg_hi:[0,0,1]
v_exp_f32 v236, v236
v_exp_f32 v76, v76
v_exp_f32 v237, v237
v_exp_f32 v77, v77
v_pk_fma_f32 v[238:239], v[78:79], v[130:131], v[106:107] op_sel:[0,0,0] op_sel_hi:[1,0,0] neg_lo:[1,0,0] neg_hi:[1,0,0]
v_pk_fma_f32 v[78:79], v[78:79], v[130:131], v[102:103] op_sel:[0,0,0] op_sel_hi:[1,0,0] neg_lo:[0,0,1] neg_hi:[0,0,1]
v_exp_f32 v238, v238
v_exp_f32 v78, v78
v_exp_f32 v239, v239
v_exp_f32 v79, v79
v_pk_fma_f32 v[240:241], v[80:81], v[130:131], v[106:107] op_sel:[0,0,0] op_sel_hi:[1,0,0] neg_lo:[1,0,0] neg_hi:[1,0,0]
v_pk_fma_f32 v[80:81], v[80:81], v[130:131], v[102:103] op_sel:[0,0,0] op_sel_hi:[1,0,0] neg_lo:[0,0,1] neg_hi:[0,0,1]
v_exp_f32 v240, v240
v_exp_f32 v80, v80
v_exp_f32 v241, v241
v_exp_f32 v81, v81
v_pk_fma_f32 v[242:243], v[82:83], v[130:131], v[106:107] op_sel:[0,0,0] op_sel_hi:[1,0,0] neg_lo:[1,0,0] neg_hi:[1,0,0]
v_pk_fma_f32 v[82:83], v[82:83], v[130:131], v[102:103] op_sel:[0,0,0] op_sel_hi:[1,0,0] neg_lo:[0,0,1] neg_hi:[0,0,1]
v_exp_f32 v242, v242
v_exp_f32 v82, v82
v_exp_f32 v243, v243
v_exp_f32 v83, v83
v_pk_fma_f32 v[244:245], v[84:85], v[130:131], v[106:107] op_sel:[0,1,1] op_sel_hi:[1,1,1] neg_lo:[1,0,0] neg_hi:[1,0,0]
v_pk_fma_f32 v[84:85], v[84:85], v[130:131], v[102:103] op_sel:[0,1,1] op_sel_hi:[1,1,1] neg_lo:[0,0,1] neg_hi:[0,0,1]
v_exp_f32 v244, v244
v_exp_f32 v84, v84
v_exp_f32 v245, v245
v_exp_f32 v85, v85
v_pk_fma_f32 v[246:247], v[86:87], v[130:131], v[106:107] op_sel:[0,1,1] op_sel_hi:[1,1,1] neg_lo:[1,0,0] neg_hi:[1,0,0]
v_pk_fma_f32 v[86:87], v[86:87], v[130:131], v[102:103] op_sel:[0,1,1] op_sel_hi:[1,1,1] neg_lo:[0,0,1] neg_hi:[0,0,1]
v_exp_f32 v246, v246
v_exp_f32 v86, v86
v_exp_f32 v247, v247
v_exp_f32 v87, v87
v_pk_fma_f32 v[248:249], v[88:89], v[130:131], v[106:107] op_sel:[0,1,1] op_sel_hi:[1,1,1] neg_lo:[1,0,0] neg_hi:[1,0,0]
v_pk_fma_f32 v[88:89], v[88:89], v[130:131], v[102:103] op_sel:[0,1,1] op_sel_hi:[1,1,1] neg_lo:[0,0,1] neg_hi:[0,0,1]
v_exp_f32 v248, v248
v_exp_f32 v88, v88
v_exp_f32 v249, v249
v_exp_f32 v89, v89
v_pk_fma_f32 v[250:251], v[90:91], v[130:131], v[106:107] op_sel:[0,1,1] op_sel_hi:[1,1,1] neg_lo:[1,0,0] neg_hi:[1,0,0]
v_pk_fma_f32 v[90:91], v[90:91], v[130:131], v[102:103] op_sel:[0,1,1] op_sel_hi:[1,1,1] neg_lo:[0,0,1] neg_hi:[0,0,1]
v_exp_f32 v250, v250
v_exp_f32 v90, v90
v_exp_f32 v251, v251
v_exp_f32 v91, v91
v_pk_add_f32 v[108:109], v[60:61], v[62:63]
v_pk_add_f32 v[110:111], v[220:221], v[222:223]
v_pk_add_f32 v[108:109], v[108:109], v[64:65]
v_pk_add_f32 v[110:111], v[110:111], v[224:225]
v_pk_add_f32 v[108:109], v[108:109], v[66:67]
v_pk_add_f32 v[110:111], v[110:111], v[226:227]
v_add_f32 v100, v108, v109
v_add_f32 v104, v110, v111
v_pk_add_f32 v[108:109], v[68:69], v[70:71]
v_pk_add_f32 v[110:111], v[228:229], v[230:231]
v_pk_add_f32 v[108:109], v[108:109], v[72:73]
v_pk_add_f32 v[110:111], v[110:111], v[232:233]
v_pk_add_f32 v[108:109], v[108:109], v[74:75]
v_pk_add_f32 v[110:111], v[110:111], v[234:235]
v_add_f32 v101, v108, v109
v_add_f32 v105, v110, v111
v_pk_add_f32 v[108:109], v[76:77], v[78:79]
v_pk_add_f32 v[110:111], v[236:237], v[238:239]
v_pk_add_f32 v[108:109], v[108:109], v[80:81]
v_pk_add_f32 v[110:111], v[110:111], v[240:241]
v_pk_add_f32 v[108:109], v[108:109], v[82:83]
v_pk_add_f32 v[110:111], v[110:111], v[242:243]
v_add_f32 v102, v108, v109
v_add_f32 v106, v110, v111
v_pk_add_f32 v[108:109], v[84:85], v[86:87]
v_pk_add_f32 v[110:111], v[244:245], v[246:247]
v_pk_add_f32 v[108:109], v[108:109], v[88:89]
v_pk_add_f32 v[110:111], v[110:111], v[248:249]
v_pk_add_f32 v[108:109], v[108:109], v[90:91]
v_pk_add_f32 v[110:111], v[110:111], v[250:251]
v_add_f32 v103, v108, v109
v_add_f32 v107, v110, v111
s_nop 1
v_permlane32_swap_b32 v100, v101
v_permlane32_swap_b32 v102, v103
v_permlane32_swap_b32 v104, v105
v_permlane32_swap_b32 v106, v107
v_add_f32 v100, v100, v101
v_add_f32 v102, v102, v103
v_add_f32 v104, v104, v105
v_add_f32 v106, v106, v107
v_permlane16_swap_b32 v100, v102
s_nop 0
v_permlane16_swap_b32 v104, v106
v_add_f32 v100, v100, v102
v_add_f32 v104, v104, v106
v_rcp_f32 v100, v100
v_rcp_f32 v104, v104
s_nop 0
v_mov_b32 v102, v100
v_mov_b32 v106, v104
s_nop 0
v_permlane16_swap_b32 v100, v102
v_permlane16_swap_b32 v104, v106
v_mov_b32 v101, v100
v_mov_b32 v103, v102
v_mov_b32 v105, v104
v_mov_b32 v107, v106
v_permlane32_swap_b32 v100, v101
v_permlane32_swap_b32 v102, v103
v_permlane32_swap_b32 v104, v105
v_permlane32_swap_b32 v106, v107
.p2align 3
v_pk_mul_f32 v[60:61], v[60:61], v[100:101] op_sel:[0,0] op_sel_hi:[1,0]
v_pk_mul_f32 v[62:63], v[62:63], v[100:101] op_sel:[0,0] op_sel_hi:[1,0]
v_pk_mul_f32 v[64:65], v[64:65], v[100:101] op_sel:[0,0] op_sel_hi:[1,0]
v_pk_mul_f32 v[66:67], v[66:67], v[100:101] op_sel:[0,0] op_sel_hi:[1,0]
v_pk_mul_f32 v[220:221], v[220:221], v[104:105] op_sel:[0,0] op_sel_hi:[1,0]
v_pk_mul_f32 v[222:223], v[222:223], v[104:105] op_sel:[0,0] op_sel_hi:[1,0]
v_pk_mul_f32 v[224:225], v[224:225], v[104:105] op_sel:[0,0] op_sel_hi:[1,0]
v_pk_mul_f32 v[226:227], v[226:227], v[104:105] op_sel:[0,0] op_sel_hi:[1,0]
v_cvt_pk_bf16_f32 v60, v60, v61
v_cvt_pk_bf16_f32 v61, v62, v63
v_cvt_pk_bf16_f32 v62, v64, v65
v_cvt_pk_bf16_f32 v63, v66, v67
v_cvt_pk_bf16_f32 v220, v220, v221
v_cvt_pk_bf16_f32 v221, v222, v223
v_cvt_pk_bf16_f32 v222, v224, v225
v_cvt_pk_bf16_f32 v223, v226, v227
v_pk_mul_f32 v[68:69], v[68:69], v[100:101] op_sel:[0,1] op_sel_hi:[1,1]
v_pk_mul_f32 v[70:71], v[70:71], v[100:101] op_sel:[0,1] op_sel_hi:[1,1]
v_pk_mul_f32 v[72:73], v[72:73], v[100:101] op_sel:[0,1] op_sel_hi:[1,1]
v_pk_mul_f32 v[74:75], v[74:75], v[100:101] op_sel:[0,1] op_sel_hi:[1,1]
v_pk_mul_f32 v[228:229], v[228:229], v[104:105] op_sel:[0,1] op_sel_hi:[1,1]
v_pk_mul_f32 v[230:231], v[230:231], v[104:105] op_sel:[0,1] op_sel_hi:[1,1]
v_pk_mul_f32 v[232:233], v[232:233], v[104:105] op_sel:[0,1] op_sel_hi:[1,1]
v_pk_mul_f32 v[234:235], v[234:235], v[104:105] op_sel:[0,1] op_sel_hi:[1,1]
v_cvt_pk_bf16_f32 v68, v68, v69
v_mfma_f32_16x16x32_bf16 v[204:207], v[60:63], v[38:41], 0
v_cvt_pk_bf16_f32 v69, v70, v71
v_cvt_pk_bf16_f32 v70, v72, v73
v_mfma_f32_16x16x32_bf16 v[208:211], v[60:63], v[36:39], 0
v_cvt_pk_bf16_f32 v71, v74, v75
v_cvt_pk_bf16_f32 v228, v228, v229
v_mfma_f32_16x16x32_bf16 v[212:215], v[220:223], v[38:41], 0
v_cvt_pk_bf16_f32 v229, v230, v231
v_cvt_pk_bf16_f32 v230, v232, v233
v_mfma_f32_16x16x32_bf16 v[216:219], v[220:223], v[36:39], 0
v_cvt_pk_bf16_f32 v231, v234, v235
v_pk_mul_f32 v[76:77], v[76:77], v[102:103] op_sel:[0,0] op_sel_hi:[1,0]
v_pk_mul_f32 v[78:79], v[78:79], v[102:103] op_sel:[0,0] op_sel_hi:[1,0]
v_pk_mul_f32 v[80:81], v[80:81], v[102:103] op_sel:[0,0] op_sel_hi:[1,0]
v_pk_mul_f32 v[82:83], v[82:83], v[102:103] op_sel:[0,0] op_sel_hi:[1,0]
v_pk_mul_f32 v[236:237], v[236:237], v[106:107] op_sel:[0,0] op_sel_hi:[1,0]
v_pk_mul_f32 v[238:239], v[238:239], v[106:107] op_sel:[0,0] op_sel_hi:[1,0]
v_pk_mul_f32 v[240:241], v[240:241], v[106:107] op_sel:[0,0] op_sel_hi:[1,0]
v_pk_mul_f32 v[242:243], v[242:243], v[106:107] op_sel:[0,0] op_sel_hi:[1,0]
v_cvt_pk_bf16_f32 v76, v76, v77
v_mfma_f32_16x16x32_bf16 v[188:191], v[68:71], v[38:41], 0
v_mfma_f32_16x16x32_bf16 v[192:195], v[68:71], v[36:39], 0
v_cvt_pk_bf16_f32 v77, v78, v79
v_mfma_f32_16x16x32_bf16 v[196:199], v[228:231], v[38:41], 0
v_cvt_pk_bf16_f32 v78, v80, v81
v_mfma_f32_16x16x32_bf16 v[200:203], v[228:231], v[36:39], 0
v_cvt_pk_bf16_f32 v64, v204, v205
v_cvt_pk_bf16_f32 v79, v82, v83
v_cvt_pk_bf16_f32 v65, v206, v207
v_cvt_pk_bf16_f32 v236, v236, v237
v_cvt_pk_bf16_f32 v72, v208, v209
v_cvt_pk_bf16_f32 v73, v210, v211
v_cvt_pk_bf16_f32 v237, v238, v239
v_cvt_pk_bf16_f32 v224, v212, v213
v_cvt_pk_bf16_f32 v238, v240, v241
v_cvt_pk_bf16_f32 v225, v214, v215
v_cvt_pk_bf16_f32 v232, v216, v217
v_cvt_pk_bf16_f32 v239, v242, v243
v_cvt_pk_bf16_f32 v233, v218, v219
v_pk_mul_f32 v[84:85], v[84:85], v[102:103] op_sel:[0,1] op_sel_hi:[1,1]
v_pk_mul_f32 v[86:87], v[86:87], v[102:103] op_sel:[0,1] op_sel_hi:[1,1]
v_pk_mul_f32 v[88:89], v[88:89], v[102:103] op_sel:[0,1] op_sel_hi:[1,1]
v_pk_mul_f32 v[90:91], v[90:91], v[102:103] op_sel:[0,1] op_sel_hi:[1,1]
v_pk_mul_f32 v[244:245], v[244:245], v[106:107] op_sel:[0,1] op_sel_hi:[1,1]
v_pk_mul_f32 v[246:247], v[246:247], v[106:107] op_sel:[0,1] op_sel_hi:[1,1]
v_pk_mul_f32 v[248:249], v[248:249], v[106:107] op_sel:[0,1] op_sel_hi:[1,1]
v_pk_mul_f32 v[250:251], v[250:251], v[106:107] op_sel:[0,1] op_sel_hi:[1,1]
v_cvt_pk_bf16_f32 v84, v84, v85
v_mfma_f32_16x16x32_bf16 v[204:207], v[76:79], v[38:41], 0
v_mfma_f32_16x16x32_bf16 v[208:211], v[76:79], v[36:39], 0
v_cvt_pk_bf16_f32 v85, v86, v87
v_mfma_f32_16x16x32_bf16 v[212:215], v[236:239], v[38:41], 0
v_cvt_pk_bf16_f32 v86, v88, v89
v_mfma_f32_16x16x32_bf16 v[216:219], v[236:239], v[36:39], 0
v_cvt_pk_bf16_f32 v66, v188, v189
v_cvt_pk_bf16_f32 v87, v90, v91
v_cvt_pk_bf16_f32 v67, v190, v191
v_cvt_pk_bf16_f32 v244, v244, v245
v_cvt_pk_bf16_f32 v74, v192, v193
v_cvt_pk_bf16_f32 v75, v194, v195
v_cvt_pk_bf16_f32 v245, v246, v247
v_cvt_pk_bf16_f32 v226, v196, v197
v_cvt_pk_bf16_f32 v246, v248, v249
v_cvt_pk_bf16_f32 v227, v198, v199
v_cvt_pk_bf16_f32 v234, v200, v201
v_cvt_pk_bf16_f32 v247, v250, v251
v_cvt_pk_bf16_f32 v235, v202, v203
v_mov_b32 v5, 2
v_cmp_eq_u32 s[50:51], s41, v2
v_mfma_f32_16x16x32_bf16 v[188:191], v[84:87], v[38:41], 0
v_mfma_f32_16x16x32_bf16 v[192:195], v[84:87], v[36:39], 0
v_mfma_f32_16x16x32_bf16 v[196:199], v[244:247], v[38:41], 0
v_mfma_f32_16x16x32_bf16 v[200:203], v[244:247], v[36:39], 0
v_mfma_f32_16x16x32_bf16 v[152:155], v[224:227], v[112:115], 0
v_cvt_pk_bf16_f32 v80, v204, v205
v_cvt_pk_bf16_f32 v81, v206, v207
v_mfma_f32_16x16x32_bf16 v[60:63], v[232:235], v[112:115], 0
v_cvt_pk_bf16_f32 v88, v208, v209
v_mfma_f32_16x16x32_bf16 v[68:71], v[224:227], v[120:123], 0
v_cvt_pk_bf16_f32 v89, v210, v211
v_mfma_f32_16x16x32_bf16 v[220:223], v[232:235], v[120:123], 0
v_cvt_pk_bf16_f32 v240, v212, v213
v_cvt_pk_bf16_f32 v241, v214, v215
v_mfma_f32_16x16x32_bf16 v[228:231], v[224:227], v[48:51], 0
v_cvt_pk_bf16_f32 v248, v216, v217
v_mfma_f32_16x16x32_bf16 v[76:79], v[232:235], v[48:51], 0
v_cvt_pk_bf16_f32 v249, v218, v219
v_mfma_f32_16x16x32_bf16 v[100:103], v[64:67], v[112:115], 0
v_cvt_pk_bf16_f32 v82, v188, v189
v_cvt_pk_bf16_f32 v83, v190, v191
v_mfma_f32_16x16x32_bf16 v[104:107], v[72:75], v[112:115], 0
v_cvt_pk_bf16_f32 v90, v192, v193
v_mfma_f32_16x16x32_bf16 v[108:111], v[64:67], v[120:123], 0
v_cvt_pk_bf16_f32 v91, v194, v195
v_mfma_f32_16x16x32_bf16 v[132:135], v[72:75], v[120:123], 0
v_cvt_pk_bf16_f32 v242, v196, v197
v_cvt_pk_bf16_f32 v243, v198, v199
v_mfma_f32_16x16x32_bf16 v[136:139], v[64:67], v[48:51], 0
v_cvt_pk_bf16_f32 v250, v200, v201
v_mfma_f32_16x16x32_bf16 v[148:151], v[72:75], v[48:51], 0
v_cvt_pk_bf16_f32 v251, v202, v203
s_nop 1
v_mfma_f32_16x16x32_bf16 v[152:155], v[240:243], v[116:119], v[152:155]
v_mfma_f32_16x16x32_bf16 v[60:63], v[248:251], v[116:119], v[60:63]
v_mfma_f32_16x16x32_bf16 v[68:71], v[240:243], v[124:127], v[68:71]
v_mfma_f32_16x16x32_bf16 v[220:223], v[248:251], v[124:127], v[220:223]
v_mfma_f32_16x16x32_bf16 v[228:231], v[240:243], v[48:51], v[228:231]
v_mfma_f32_16x16x32_bf16 v[76:79], v[248:251], v[48:51], v[76:79]
v_mfma_f32_16x16x32_bf16 v[100:103], v[80:83], v[116:119], v[100:103]
v_mfma_f32_16x16x32_bf16 v[104:107], v[88:91], v[116:119], v[104:107]
v_mfma_f32_16x16x32_bf16 v[108:111], v[80:83], v[124:127], v[108:111]
v_mfma_f32_16x16x32_bf16 v[132:135], v[88:91], v[124:127], v[132:135]
v_cvt_pk_bf16_f32 v152, v152, v153
v_cvt_pk_bf16_f32 v153, v154, v155
v_mfma_f32_16x16x32_bf16 v[136:139], v[80:83], v[48:51], v[136:139]
v_cvt_pk_bf16_f32 v154, v60, v61
v_cvt_pk_bf16_f32 v155, v62, v63
v_mfma_f32_16x16x32_bf16 v[148:151], v[88:91], v[48:51], v[148:151]
ds_write_b128 v42, v[152:155] offset:0
v_cvt_pk_bf16_f32 v68, v68, v69
v_cvt_pk_bf16_f32 v69, v70, v71
v_cvt_pk_bf16_f32 v70, v220, v221
v_cvt_pk_bf16_f32 v71, v222, v223
ds_write_b128 v42, v[68:71] offset:1024
v_cvt_pk_bf16_f32 v228, v228, v229
v_cvt_pk_bf16_f32 v229, v230, v231
v_cvt_pk_bf16_f32 v230, v76, v77
v_cvt_pk_bf16_f32 v231, v78, v79
ds_write_b128 v42, v[228:231] offset:2048
ds_write_b32 v52, v5
s_mov_b32 s63, 0
px_59:
ds_read_b32 v4, v19
ds_read_b128 v[188:191], v43 offset:0
ds_read_b128 v[192:195], v43 offset:1024
ds_read_b128 v[196:199], v43 offset:2048
s_add_u32 s63, s63, 1
s_cmp_lt_u32 s63, 0x400000
s_waitcnt lgkmcnt(0)
v_cmp_ne_u32 vcc, 2, v4
s_cbranch_vccz pxd_60
s_cbranch_scc1 px_59
pxd_60:
v_mfma_f32_16x16x32_bf16 v[100:103], v[38:41], v[188:191], v[100:103]
v_mfma_f32_16x16x32_bf16 v[104:107], v[36:39], v[188:191], v[104:107]
v_mfma_f32_16x16x32_bf16 v[108:111], v[38:41], v[192:195], v[108:111]
v_mfma_f32_16x16x32_bf16 v[132:135], v[36:39], v[192:195], v[132:135]
v_mfma_f32_16x16x32_bf16 v[136:139], v[38:41], v[196:199], v[136:139]
v_mfma_f32_16x16x32_bf16 v[148:151], v[36:39], v[196:199], v[148:151]
s_nop 2
v_cvt_pk_bf16_f32 v100, v100, v101
v_cvt_pk_bf16_f32 v101, v102, v103
v_cvt_pk_bf16_f32 v102, v104, v105
v_cvt_pk_bf16_f32 v103, v106, v107
buffer_store_dwordx4 v[100:103], v55, s[32:35], s53 offen sc1
v_cvt_pk_bf16_f32 v108, v108, v109
v_cvt_pk_bf16_f32 v109, v110, v111
v_cvt_pk_bf16_f32 v110, v132, v133
v_cvt_pk_bf16_f32 v111, v134, v135
buffer_store_dwordx4 v[108:111], v55, s[32:35], s54 offen sc1
v_cvt_pk_bf16_f32 v136, v136, v137
v_cvt_pk_bf16_f32 v137, v138, v139
v_cvt_pk_bf16_f32 v138, v148, v149
v_cvt_pk_bf16_f32 v139, v150, v151
s_mov_b64 exec, s[50:51]
buffer_store_dwordx4 v[136:139], v58, s[32:35], s56 offen sc1
s_mov_b64 exec, -1
s_mov_b32 s51, 0
.p2align 3
v_pk_fma_f32 v[156:157], v[140:141], v[92:93], v[156:157] op_sel:[0,1,0] op_sel_hi:[1,1,1]
v_pk_fma_f32 v[158:159], v[142:143], v[92:93], v[158:159] op_sel:[0,1,0] op_sel_hi:[1,1,1]
v_pk_fma_f32 v[160:161], v[144:145], v[92:93], v[160:161] op_sel:[0,1,0] op_sel_hi:[1,1,1]
v_pk_fma_f32 v[162:163], v[146:147], v[92:93], v[162:163] op_sel:[0,1,0] op_sel_hi:[1,1,1]
v_cvt_pk_bf16_f32 v156, v156, v157
v_cvt_pk_bf16_f32 v157, v158, v159
v_cvt_pk_bf16_f32 v158, v160, v161
v_cvt_pk_bf16_f32 v159, v162, v163
v_pk_fma_f32 v[164:165], v[140:141], v[94:95], v[164:165] op_sel:[0,1,0] op_sel_hi:[1,1,1]
v_pk_fma_f32 v[166:167], v[142:143], v[94:95], v[166:167] op_sel:[0,1,0] op_sel_hi:[1,1,1]
v_pk_fma_f32 v[168:169], v[144:145], v[94:95], v[168:169] op_sel:[0,1,0] op_sel_hi:[1,1,1]
v_pk_fma_f32 v[170:171], v[146:147], v[94:95], v[170:171] op_sel:[0,1,0] op_sel_hi:[1,1,1]
v_cvt_pk_bf16_f32 v164, v164, v165
v_mfma_f32_16x16x32_bf16 v[60:63], v[10:13], v[156:159], 0
v_cvt_pk_bf16_f32 v165, v166, v167
v_cvt_pk_bf16_f32 v166, v168, v169
v_mfma_f32_16x16x32_bf16 v[64:67], v[14:17], v[156:159], 0
v_cvt_pk_bf16_f32 v167, v170, v171
v_pk_fma_f32 v[172:173], v[140:141], v[96:97], v[172:173] op_sel:[0,1,0] op_sel_hi:[1,1,1]
v_pk_fma_f32 v[174:175], v[142:143], v[96:97], v[174:175] op_sel:[0,1,0] op_sel_hi:[1,1,1]
v_pk_fma_f32 v[176:177], v[144:145], v[96:97], v[176:177] op_sel:[0,1,0] op_sel_hi:[1,1,1]
v_pk_fma_f32 v[178:179], v[146:147], v[96:97], v[178:179] op_sel:[0,1,0] op_sel_hi:[1,1,1]
v_cvt_pk_bf16_f32 v172, v172, v173
v_mfma_f32_16x16x32_bf16 v[68:71], v[10:13], v[164:167], 0
v_cvt_pk_bf16_f32 v173, v174, v175
v_cvt_pk_bf16_f32 v174, v176, v177
v_mfma_f32_16x16x32_bf16 v[72:75], v[14:17], v[164:167], 0
v_cvt_pk_bf16_f32 v175, v178, v179
v_pk_fma_f32 v[180:181], v[140:141], v[98:99], v[180:181] op_sel:[0,1,0] op_sel_hi:[1,1,1]
v_pk_fma_f32 v[182:183], v[142:143], v[98:99], v[182:183] op_sel:[0,1,0] op_sel_hi:[1,1,1]
v_pk_fma_f32 v[184:185], v[144:145], v[98:99], v[184:185] op_sel:[0,1,0] op_sel_hi:[1,1,1]
v_pk_fma_f32 v[186:187], v[146:147], v[98:99], v[186:187] op_sel:[0,1,0] op_sel_hi:[1,1,1]
v_cvt_pk_bf16_f32 v180, v180, v181
v_mfma_f32_16x16x32_bf16 v[76:79], v[10:13], v[172:175], 0
v_cvt_pk_bf16_f32 v181, v182, v183
v_cvt_pk_bf16_f32 v182, v184, v185
v_mfma_f32_16x16x32_bf16 v[80:83], v[14:17], v[172:175], 0
v_cvt_pk_bf16_f32 v183, v186, v187
s_nop 1
v_mfma_f32_16x16x32_bf16 v[84:87], v[10:13], v[180:183], 0
v_mfma_f32_16x16x32_bf16 v[88:91], v[14:17], v[180:183], 0
v_max3_f32 v100, v60, v61, v62
v_min3_f32 v104, v60, v61, v62
v_max3_f32 v100, v100, v63, v64
v_min3_f32 v104, v104, v63, v64
v_max3_f32 v100, v100, v65, v66
v_min3_f32 v104, v104, v65, v66
v_max_f32 v100, v100, v67
v_min_f32 v104, v104, v67
v_max3_f32 v101, v68, v69, v70
v_min3_f32 v105, v68, v69, v70
v_max3_f32 v101, v101, v71, v72
v_min3_f32 v105, v105, v71, v72
v_max3_f32 v101, v101, v73, v74
v_min3_f32 v105, v105, v73, v74
v_max_f32 v101, v101, v75
v_min_f32 v105, v105, v75
v_max3_f32 v102, v76, v77, v78
v_min3_f32 v106, v76, v77, v78
v_max3_f32 v102, v102, v79, v80
v_min3_f32 v106, v106, v79, v80
v_max3_f32 v102, v102, v81, v82
v_min3_f32 v106, v106, v81, v82
v_max_f32 v102, v102, v83
v_min_f32 v106, v106, v83
v_max3_f32 v103, v84, v85, v86
v_min3_f32 v107, v84, v85, v86
v_max3_f32 v103, v103, v87, v88
v_min3_f32 v107, v107, v87, v88
v_max3_f32 v103, v103, v89, v90
v_min3_f32 v107, v107, v89, v90
v_max_f32 v103, v103, v91
v_min_f32 v107, v107, v91
s_nop 1
v_permlane32_swap_b32 v100, v101
v_permlane32_swap_b32 v102, v103
v_permlane32_swap_b32 v104, v105
v_permlane32_swap_b32 v106, v107
v_max_f32 v100, v100, v101
v_max_f32 v102, v102, v103
v_min_f32 v104, v104, v105
v_min_f32 v106, v106, v107
v_permlane16_swap_b32 v100, v102
s_nop 0
v_permlane16_swap_b32 v104, v106
v_max_f32 v100, v100, v102
v_min_f32 v104, v104, v106
v_mov_b32 v102, v100
v_mov_b32 v106, v104
s_nop 0
v_permlane16_swap_b32 v100, v102
v_permlane16_swap_b32 v104, v106
v_mov_b32 v101, v100
v_mov_b32 v103, v102
v_mov_b32 v105, v104
v_mov_b32 v107, v106
v_permlane32_swap_b32 v100, v101
v_permlane32_swap_b32 v102, v103
v_permlane32_swap_b32 v104, v105
v_permlane32_swap_b32 v106, v107
v_pk_mul_f32 v[100:101], v[100:101], v[128:129]
v_pk_mul_f32 v[102:103], v[102:103], v[130:131]
v_pk_mul_f32 v[104:105], v[104:105], v[128:129]
v_pk_mul_f32 v[106:107], v[106:107], v[130:131]
v_pk_fma_f32 v[220:221], v[60:61], v[128:129], v[104:105] op_sel:[0,0,0] op_sel_hi:[1,0,0] neg_lo:[1,0,0] neg_hi:[1,0,0]
v_pk_fma_f32 v[60:61], v[60:61], v[128:129], v[100:101] op_sel:[0,0,0] op_sel_hi:[1,0,0] neg_lo:[0,0,1] neg_hi:[0,0,1]
v_exp_f32 v220, v220
v_exp_f32 v60, v60
v_exp_f32 v221, v221
v_exp_f32 v61, v61
v_pk_fma_f32 v[222:223], v[62:63], v[128:129], v[104:105] op_sel:[0,0,0] op_sel_hi:[1,0,0] neg_lo:[1,0,0] neg_hi:[1,0,0]
v_pk_fma_f32 v[62:63], v[62:63], v[128:129], v[100:101] op_sel:[0,0,0] op_sel_hi:[1,0,0] neg_lo:[0,0,1] neg_hi:[0,0,1]
v_exp_f32 v222, v222
v_exp_f32 v62, v62
v_exp_f32 v223, v223
v_exp_f32 v63, v63
v_pk_fma_f32 v[224:225], v[64:65], v[128:129], v[104:105] op_sel:[0,0,0] op_sel_hi:[1,0,0] neg_lo:[1,0,0] neg_hi:[1,0,0]
v_pk_fma_f32 v[64:65], v[64:65], v[128:129], v[100:101] op_sel:[0,0,0] op_sel_hi:[1,0,0] neg_lo:[0,0,1] neg_hi:[0,0,1]
v_exp_f32 v224, v224
v_exp_f32 v64, v64
v_exp_f32 v225, v225
v_exp_f32 v65, v65
v_pk_fma_f32 v[226:227], v[66:67], v[128:129], v[104:105] op_sel:[0,0,0] op_sel_hi:[1,0,0] neg_lo:[1,0,0] neg_hi:[1,0,0]
v_pk_fma_f32 v[66:67], v[66:67], v[128:129], v[100:101] op_sel:[0,0,0] op_sel_hi:[1,0,0] neg_lo:[0,0,1] neg_hi:[0,0,1]
v_exp_f32 v226, v226
v_exp_f32 v66, v66
v_exp_f32 v227, v227
v_exp_f32 v67, v67
v_pk_fma_f32 v[228:229], v[68:69], v[128:129], v[104:105] op_sel:[0,1,1] op_sel_hi:[1,1,1] neg_lo:[1,0,0] neg_hi:[1,0,0]
v_pk_fma_f32 v[68:69], v[68:69], v[128:129], v[100:101] op_sel:[0,1,1] op_sel_hi:[1,1,1] neg_lo:[0,0,1] neg_hi:[0,0,1]
v_exp_f32 v228, v228
v_exp_f32 v68, v68
v_exp_f32 v229, v229
v_exp_f32 v69, v69
v_pk_fma_f32 v[230:231], v[70:71], v[128:129], v[104:105] op_sel:[0,1,1] op_sel_hi:[1,1,1] neg_lo:[1,0,0] neg_hi:[1,0,0]
v_pk_fma_f32 v[70:71], v[70:71], v[128:129], v[100:101] op_sel:[0,1,1] op_sel_hi:[1,1,1] neg_lo:[0,0,1] neg_hi:[0,0,1]
v_exp_f32 v230, v230
v_exp_f32 v70, v70
v_exp_f32 v231, v231
v_exp_f32 v71, v71
v_pk_fma_f32 v[232:233], v[72:73], v[128:129], v[104:105] op_sel:[0,1,1] op_sel_hi:[1,1,1] neg_lo:[1,0,0] neg_hi:[1,0,0]
v_pk_fma_f32 v[72:73], v[72:73], v[128:129], v[100:101] op_sel:[0,1,1] op_sel_hi:[1,1,1] neg_lo:[0,0,1] neg_hi:[0,0,1]
v_exp_f32 v232, v232
v_exp_f32 v72, v72
v_exp_f32 v233, v233
v_exp_f32 v73, v73
v_pk_fma_f32 v[234:235], v[74:75], v[128:129], v[104:105] op_sel:[0,1,1] op_sel_hi:[1,1,1] neg_lo:[1,0,0] neg_hi:[1,0,0]
v_pk_fma_f32 v[74:75], v[74:75], v[128:129], v[100:101] op_sel:[0,1,1] op_sel_hi:[1,1,1] neg_lo:[0,0,1] neg_hi:[0,0,1]
v_exp_f32 v234, v234
v_exp_f32 v74, v74
v_exp_f32 v235, v235
v_exp_f32 v75, v75
buffer_load_dwordx4 v[212:215], v18, s[32:35], s55 offen offset:0 sc1
buffer_load_dwordx4 v[216:219], v18, s[32:35], s55 offen offset:1024 sc1
v_pk_fma_f32 v[236:237], v[76:77], v[130:131], v[106:107] op_sel:[0,0,0] op_sel_hi:[1,0,0] neg_lo:[1,0,0] neg_hi:[1,0,0]
v_pk_fma_f32 v[76:77], v[76:77], v[130:131], v[102:103] op_sel:[0,0,0] op_sel_hi:[1,0,0] neg_lo:[0,0,1] neg_hi:[0,0,1]
v_exp_f32 v236, v236
v_exp_f32 v76, v76
v_exp_f32 v237, v237
v_exp_f32 v77, v77
v_pk_fma_f32 v[238:239], v[78:79], v[130:131], v[106:107] op_sel:[0,0,0] op_sel_hi:[1,0,0] neg_lo:[1,0,0] neg_hi:[1,0,0]
v_pk_fma_f32 v[78:79], v[78:79], v[130:131], v[102:103] op_sel:[0,0,0] op_sel_hi:[1,0,0] neg_lo:[0,0,1] neg_hi:[0,0,1]
v_exp_f32 v238, v238
v_exp_f32 v78, v78
v_exp_f32 v239, v239
v_exp_f32 v79, v79
v_pk_fma_f32 v[240:241], v[80:81], v[130:131], v[106:107] op_sel:[0,0,0] op_sel_hi:[1,0,0] neg_lo:[1,0,0] neg_hi:[1,0,0]
v_pk_fma_f32 v[80:81], v[80:81], v[130:131], v[102:103] op_sel:[0,0,0] op_sel_hi:[1,0,0] neg_lo:[0,0,1] neg_hi:[0,0,1]
v_exp_f32 v240, v240
v_exp_f32 v80, v80
v_exp_f32 v241, v241
v_exp_f32 v81, v81
v_pk_fma_f32 v[242:243], v[82:83], v[130:131], v[106:107] op_sel:[0,0,0] op_sel_hi:[1,0,0] neg_lo:[1,0,0] neg_hi:[1,0,0]
v_pk_fma_f32 v[82:83], v[82:83], v[130:131], v[102:103] op_sel:[0,0,0] op_sel_hi:[1,0,0] neg_lo:[0,0,1] neg_hi:[0,0,1]
v_exp_f32 v242, v242
v_exp_f32 v82, v82
v_exp_f32 v243, v243
v_exp_f32 v83, v83
v_pk_fma_f32 v[244:245], v[84:85], v[130:131], v[106:107] op_sel:[0,1,1] op_sel_hi:[1,1,1] neg_lo:[1,0,0] neg_hi:[1,0,0]
v_pk_fma_f32 v[84:85], v[84:85], v[130:131], v[102:103] op_sel:[0,1,1] op_sel_hi:[1,1,1] neg_lo:[0,0,1] neg_hi:[0,0,1]
v_exp_f32 v244, v244
v_exp_f32 v84, v84
v_exp_f32 v245, v245
v_exp_f32 v85, v85
v_pk_fma_f32 v[246:247], v[86:87], v[130:131], v[106:107] op_sel:[0,1,1] op_sel_hi:[1,1,1] neg_lo:[1,0,0] neg_hi:[1,0,0]
v_pk_fma_f32 v[86:87], v[86:87], v[130:131], v[102:103] op_sel:[0,1,1] op_sel_hi:[1,1,1] neg_lo:[0,0,1] neg_hi:[0,0,1]
v_exp_f32 v246, v246
v_exp_f32 v86, v86
v_exp_f32 v247, v247
v_exp_f32 v87, v87
v_pk_fma_f32 v[248:249], v[88:89], v[130:131], v[106:107] op_sel:[0,1,1] op_sel_hi:[1,1,1] neg_lo:[1,0,0] neg_hi:[1,0,0]
v_pk_fma_f32 v[88:89], v[88:89], v[130:131], v[102:103] op_sel:[0,1,1] op_sel_hi:[1,1,1] neg_lo:[0,0,1] neg_hi:[0,0,1]
v_exp_f32 v248, v248
v_exp_f32 v88, v88
v_exp_f32 v249, v249
v_exp_f32 v89, v89
v_pk_fma_f32 v[250:251], v[90:91], v[130:131], v[106:107] op_sel:[0,1,1] op_sel_hi:[1,1,1] neg_lo:[1,0,0] neg_hi:[1,0,0]
v_pk_fma_f32 v[90:91], v[90:91], v[130:131], v[102:103] op_sel:[0,1,1] op_sel_hi:[1,1,1] neg_lo:[0,0,1] neg_hi:[0,0,1]
v_exp_f32 v250, v250
v_exp_f32 v90, v90
v_exp_f32 v251, v251
v_exp_f32 v91, v91
v_pk_add_f32 v[108:109], v[60:61], v[62:63]
v_pk_add_f32 v[110:111], v[220:221], v[222:223]
v_pk_add_f32 v[108:109], v[108:109], v[64:65]
v_pk_add_f32 v[110:111], v[110:111], v[224:225]
v_pk_add_f32 v[108:109], v[108:109], v[66:67]
v_pk_add_f32 v[110:111], v[110:111], v[226:227]
v_add_f32 v100, v108, v109
v_add_f32 v104, v110, v111
v_pk_add_f32 v[108:109], v[68:69], v[70:71]
v_pk_add_f32 v[110:111], v[228:229], v[230:231]
v_pk_add_f32 v[108:109], v[108:109], v[72:73]
v_pk_add_f32 v[110:111], v[110:111], v[232:233]
v_pk_add_f32 v[108:109], v[108:109], v[74:75]
v_pk_add_f32 v[110:111], v[110:111], v[234:235]
v_add_f32 v101, v108, v109
v_add_f32 v105, v110, v111
v_pk_add_f32 v[108:109], v[76:77], v[78:79]
v_pk_add_f32 v[110:111], v[236:237], v[238:239]
v_pk_add_f32 v[108:109], v[108:109], v[80:81]
v_pk_add_f32 v[110:111], v[110:111], v[240:241]
v_pk_add_f32 v[108:109], v[108:109], v[82:83]
v_pk_add_f32 v[110:111], v[110:111], v[242:243]
v_add_f32 v102, v108, v109
v_add_f32 v106, v110, v111
v_pk_add_f32 v[108:109], v[84:85], v[86:87]
v_pk_add_f32 v[110:111], v[244:245], v[246:247]
v_pk_add_f32 v[108:109], v[108:109], v[88:89]
v_pk_add_f32 v[110:111], v[110:111], v[248:249]
v_pk_add_f32 v[108:109], v[108:109], v[90:91]
v_pk_add_f32 v[110:111], v[110:111], v[250:251]
v_add_f32 v103, v108, v109
v_add_f32 v107, v110, v111
s_cmp_eq_u32 s51, 1
s_cbranch_scc1 chk_61
s_waitcnt vmcnt(0)
v_max_u32 v4, v212, v213
v_max3_u32 v4, v4, v214, v215
v_max3_u32 v4, v4, v216, v217
v_max3_u32 v4, v4, v218, v219
v_cmp_eq_u32 vcc, -1, v4
s_cbranch_vccz red_62
buffer_load_dwordx4 v[212:215], v18, s[32:35], s55 offen offset:0 sc1
buffer_load_dwordx4 v[216:219], v18, s[32:35], s55 offen offset:1024 sc1
s_branch chk_61
red_62:
v_mfma_f32_16x16x32_bf16 v[132:135], v[44:47], v[212:215], 0
v_mfma_f32_16x16x32_bf16 v[132:135], v[44:47], v[216:219], v[132:135]
s_mov_b32 s51, 1
s_nop 6
v_add_f32_dpp v132, v132, v132 row_ror:8 row_mask:0xf bank_mask:0xf
v_add_f32_dpp v133, v133, v133 row_ror:8 row_mask:0xf bank_mask:0xf
v_add_f32_dpp v134, v134, v134 row_ror:8 row_mask:0xf bank_mask:0xf
v_add_f32_dpp v135, v135, v135 row_ror:8 row_mask:0xf bank_mask:0xf
v_cvt_pk_bf16_f32 v132, v132, v133
v_cvt_pk_bf16_f32 v133, v134, v135
s_mov_b64 exec, 0x00ff00ff
buffer_store_dwordx2 v[132:133], v59, s[32:35], s79 offen sc1
s_mov_b64 exec, -1
buffer_load_dwordx4 v[204:207], v58, s[32:35], s56 offen sc1
buffer_load_dwordx4 v[208:211], v58, s[32:35], s57 offen sc1
chk_61:
s_nop 1
v_permlane32_swap_b32 v100, v101
v_permlane32_swap_b32 v102, v103
v_permlane32_swap_b32 v104, v105
v_permlane32_swap_b32 v106, v107
v_add_f32 v100, v100, v101
v_add_f32 v102, v102, v103
v_add_f32 v104, v104, v105
v_add_f32 v106, v106, v107
v_permlane16_swap_b32 v100, v102
s_nop 0
v_permlane16_swap_b32 v104, v106
v_add_f32 v100, v100, v102
v_add_f32 v104, v104, v106
v_rcp_f32 v100, v100
v_rcp_f32 v104, v104
s_nop 0
v_mov_b32 v102, v100
v_mov_b32 v106, v104
s_nop 0
v_permlane16_swap_b32 v100, v102
v_permlane16_swap_b32 v104, v106
v_mov_b32 v101, v100
v_mov_b32 v103, v102
v_mov_b32 v105, v104
v_mov_b32 v107, v106
v_permlane32_swap_b32 v100, v101
v_permlane32_swap_b32 v102, v103
v_permlane32_swap_b32 v104, v105
v_permlane32_swap_b32 v106, v107
.p2align 3
v_pk_mul_f32 v[60:61], v[60:61], v[100:101] op_sel:[0,0] op_sel_hi:[1,0]
v_pk_mul_f32 v[62:63], v[62:63], v[100:101] op_sel:[0,0] op_sel_hi:[1,0]
v_pk_mul_f32 v[64:65], v[64:65], v[100:101] op_sel:[0,0] op_sel_hi:[1,0]
v_pk_mul_f32 v[66:67], v[66:67], v[100:101] op_sel:[0,0] op_sel_hi:[1,0]
v_pk_mul_f32 v[220:221], v[220:221], v[104:105] op_sel:[0,0] op_sel_hi:[1,0]
v_pk_mul_f32 v[222:223], v[222:223], v[104:105] op_sel:[0,0] op_sel_hi:[1,0]
v_pk_mul_f32 v[224:225], v[224:225], v[104:105] op_sel:[0,0] op_sel_hi:[1,0]
v_pk_mul_f32 v[226:227], v[226:227], v[104:105] op_sel:[0,0] op_sel_hi:[1,0]
v_cvt_pk_bf16_f32 v60, v60, v61
v_cvt_pk_bf16_f32 v61, v62, v63
v_cvt_pk_bf16_f32 v62, v64, v65
v_cvt_pk_bf16_f32 v63, v66, v67
v_cvt_pk_bf16_f32 v220, v220, v221
v_cvt_pk_bf16_f32 v221, v222, v223
v_cvt_pk_bf16_f32 v222, v224, v225
v_cvt_pk_bf16_f32 v223, v226, v227
v_pk_mul_f32 v[68:69], v[68:69], v[100:101] op_sel:[0,1] op_sel_hi:[1,1]
v_pk_mul_f32 v[70:71], v[70:71], v[100:101] op_sel:[0,1] op_sel_hi:[1,1]
v_pk_mul_f32 v[72:73], v[72:73], v[100:101] op_sel:[0,1] op_sel_hi:[1,1]
v_pk_mul_f32 v[74:75], v[74:75], v[100:101] op_sel:[0,1] op_sel_hi:[1,1]
v_pk_mul_f32 v[228:229], v[228:229], v[104:105] op_sel:[0,1] op_sel_hi:[1,1]
v_pk_mul_f32 v[230:231], v[230:231], v[104:105] op_sel:[0,1] op_sel_hi:[1,1]
v_pk_mul_f32 v[232:233], v[232:233], v[104:105] op_sel:[0,1] op_sel_hi:[1,1]
v_pk_mul_f32 v[234:235], v[234:235], v[104:105] op_sel:[0,1] op_sel_hi:[1,1]
v_cvt_pk_bf16_f32 v68, v68, v69
v_cvt_pk_bf16_f32 v69, v70, v71
v_cvt_pk_bf16_f32 v70, v72, v73
v_cvt_pk_bf16_f32 v71, v74, v75
v_cvt_pk_bf16_f32 v228, v228, v229
v_cvt_pk_bf16_f32 v229, v230, v231
v_cvt_pk_bf16_f32 v230, v232, v233
v_cvt_pk_bf16_f32 v231, v234, v235
v_pk_mul_f32 v[76:77], v[76:77], v[102:103] op_sel:[0,0] op_sel_hi:[1,0]
v_pk_mul_f32 v[78:79], v[78:79], v[102:103] op_sel:[0,0] op_sel_hi:[1,0]
v_pk_mul_f32 v[80:81], v[80:81], v[102:103] op_sel:[0,0] op_sel_hi:[1,0]
v_pk_mul_f32 v[82:83], v[82:83], v[102:103] op_sel:[0,0] op_sel_hi:[1,0]
v_pk_mul_f32 v[236:237], v[236:237], v[106:107] op_sel:[0,0] op_sel_hi:[1,0]
v_pk_mul_f32 v[238:239], v[238:239], v[106:107] op_sel:[0,0] op_sel_hi:[1,0]
v_pk_mul_f32 v[240:241], v[240:241], v[106:107] op_sel:[0,0] op_sel_hi:[1,0]
v_pk_mul_f32 v[242:243], v[242:243], v[106:107] op_sel:[0,0] op_sel_hi:[1,0]
v_cvt_pk_bf16_f32 v76, v76, v77
v_cvt_pk_bf16_f32 v77, v78, v79
v_cvt_pk_bf16_f32 v78, v80, v81
v_cvt_pk_bf16_f32 v79, v82, v83
v_cvt_pk_bf16_f32 v236, v236, v237
v_cvt_pk_bf16_f32 v237, v238, v239
v_cvt_pk_bf16_f32 v238, v240, v241
v_cvt_pk_bf16_f32 v239, v242, v243
v_pk_mul_f32 v[84:85], v[84:85], v[102:103] op_sel:[0,1] op_sel_hi:[1,1]
v_pk_mul_f32 v[86:87], v[86:87], v[102:103] op_sel:[0,1] op_sel_hi:[1,1]
v_pk_mul_f32 v[88:89], v[88:89], v[102:103] op_sel:[0,1] op_sel_hi:[1,1]
v_pk_mul_f32 v[90:91], v[90:91], v[102:103] op_sel:[0,1] op_sel_hi:[1,1]
v_pk_mul_f32 v[244:245], v[244:245], v[106:107] op_sel:[0,1] op_sel_hi:[1,1]
v_pk_mul_f32 v[246:247], v[246:247], v[106:107] op_sel:[0,1] op_sel_hi:[1,1]
v_pk_mul_f32 v[248:249], v[248:249], v[106:107] op_sel:[0,1] op_sel_hi:[1,1]
v_pk_mul_f32 v[250:251], v[250:251], v[106:107] op_sel:[0,1] op_sel_hi:[1,1]
v_cvt_pk_bf16_f32 v84, v84, v85
v_cvt_pk_bf16_f32 v85, v86, v87
v_cvt_pk_bf16_f32 v86, v88, v89
v_cvt_pk_bf16_f32 v87, v90, v91
v_cvt_pk_bf16_f32 v244, v244, v245
v_cvt_pk_bf16_f32 v245, v246, v247
v_cvt_pk_bf16_f32 v246, v248, v249
v_cvt_pk_bf16_f32 v247, v250, v251
s_cmp_lg_u32 s51, 0
s_cbranch_scc1 else_63
s_mov_b32 s63, 0
sent_65:
s_waitcnt vmcnt(0)
v_max_u32 v4, v212, v213
v_max3_u32 v4, v4, v214, v215
v_max3_u32 v4, v4, v216, v217
v_max3_u32 v4, v4, v218, v219
v_cmp_eq_u32 vcc, -1, v4
s_cbranch_vccz sentd_66
buffer_load_dwordx4 v[212:215], v18, s[32:35], s55 offen offset:0 sc1
buffer_load_dwordx4 v[216:219], v18, s[32:35], s55 offen offset:1024 sc1
s_add_u32 s63, s63, 1
s_cmp_lt_u32 s63, 0x80000
s_cbranch_scc1 sent_65
s_waitcnt vmcnt(0)
sentd_66:
v_mfma_f32_16x16x32_bf16 v[132:135], v[44:47], v[212:215], 0
v_mfma_f32_16x16x32_bf16 v[132:135], v[44:47], v[216:219], v[132:135]
s_mov_b32 s51, 1
s_nop 6
v_add_f32_dpp v132, v132, v132 row_ror:8 row_mask:0xf bank_mask:0xf
v_add_f32_dpp v133, v133, v133 row_ror:8 row_mask:0xf bank_mask:0xf
v_add_f32_dpp v134, v134, v134 row_ror:8 row_mask:0xf bank_mask:0xf
v_add_f32_dpp v135, v135, v135 row_ror:8 row_mask:0xf bank_mask:0xf
v_cvt_pk_bf16_f32 v132, v132, v133
v_cvt_pk_bf16_f32 v133, v134, v135
s_mov_b64 exec, 0x00ff00ff
buffer_store_dwordx2 v[132:133], v59, s[32:35], s79 offen sc1
s_mov_b64 exec, -1
buffer_load_dwordx4 v[204:207], v58, s[32:35], s56 offen sc1
buffer_load_dwordx4 v[208:211], v58, s[32:35], s57 offen sc1
else_63:
s_mov_b32 s63, 0
sent_67:
s_waitcnt vmcnt(0)
v_max_u32 v4, v204, v205
v_max3_u32 v4, v4, v206, v207
v_max3_u32 v4, v4, v208, v209
v_max3_u32 v4, v4, v210, v211
v_cmp_eq_u32 vcc, -1, v4
s_cbranch_vccz sentd_68
buffer_load_dwordx4 v[204:207], v58, s[32:35], s56 offen sc1
buffer_load_dwordx4 v[208:211], v58, s[32:35], s57 offen sc1
s_add_u32 s63, s63, 1
s_cmp_lt_u32 s63, 0x80000
s_cbranch_scc1 sent_67
s_waitcnt vmcnt(0)
sentd_68:
buffer_load_dwordx4 v[188:191], v18, s[32:35], s58 offen offset:0 sc1
buffer_load_dwordx4 v[192:195], v18, s[32:35], s58 offen offset:1024 sc1
buffer_load_dwordx4 v[196:199], v18, s[32:35], s59 offen offset:0 sc1
buffer_load_dwordx4 v[200:203], v18, s[32:35], s59 offen offset:1024 sc1
v_mfma_f32_16x16x32_bf16 v[112:115], v[204:207], v[60:63], 0
v_mfma_f32_16x16x32_bf16 v[116:119], v[204:207], v[68:71], 0
v_mfma_f32_16x16x32_bf16 v[120:123], v[204:207], v[76:79], 0
v_mfma_f32_16x16x32_bf16 v[124:127], v[204:207], v[84:87], 0
v_mfma_f32_16x16x32_bf16 v[112:115], v[208:211], v[220:223], v[112:115]
v_mfma_f32_16x16x32_bf16 v[116:119], v[208:211], v[228:231], v[116:119]
v_mfma_f32_16x16x32_bf16 v[120:123], v[208:211], v[236:239], v[120:123]
v_mfma_f32_16x16x32_bf16 v[124:127], v[208:211], v[244:247], v[124:127]
s_nop 4
v_add_f32 v100, v112, v113
v_add_f32 v114, v114, v115
v_add_f32 v100, v100, v114
v_add_f32 v101, v116, v117
v_add_f32 v118, v118, v119
v_add_f32 v101, v101, v118
v_add_f32 v102, v120, v121
v_add_f32 v122, v122, v123
v_add_f32 v102, v102, v122
v_add_f32 v103, v124, v125
v_add_f32 v126, v126, v127
v_add_f32 v103, v103, v126
s_nop 1
v_permlane32_swap_b32 v100, v101
v_permlane32_swap_b32 v102, v103
v_add_f32 v100, v100, v101
v_add_f32 v102, v102, v103
s_nop 1
v_permlane16_swap_b32 v100, v102
s_nop 0
v_add_f32 v100, v100, v102
v_add_f32 v100, 0x358637bd, v100
v_rcp_f32 v100, v100
s_nop 0
v_mov_b32 v102, v100
s_nop 1
v_permlane16_swap_b32 v100, v102
s_nop 0
v_mov_b32 v101, v100
v_mov_b32 v103, v102
s_nop 0
v_permlane32_swap_b32 v100, v101
v_permlane32_swap_b32 v102, v103
s_mov_b32 s63, 0
sent_69:
s_waitcnt vmcnt(0)
v_max_u32 v4, v188, v189
v_max3_u32 v4, v4, v190, v191
v_max3_u32 v4, v4, v192, v193
v_max3_u32 v4, v4, v194, v195
v_max3_u32 v4, v4, v196, v197
v_max3_u32 v4, v4, v198, v199
v_max3_u32 v4, v4, v200, v201
v_max3_u32 v4, v4, v202, v203
v_cmp_eq_u32 vcc, -1, v4
s_cbranch_vccz sentd_70
buffer_load_dwordx4 v[188:191], v18, s[32:35], s58 offen offset:0 sc1
buffer_load_dwordx4 v[192:195], v18, s[32:35], s58 offen offset:1024 sc1
buffer_load_dwordx4 v[196:199], v18, s[32:35], s59 offen offset:0 sc1
buffer_load_dwordx4 v[200:203], v18, s[32:35], s59 offen offset:1024 sc1
s_add_u32 s63, s63, 1
s_cmp_lt_u32 s63, 0x80000
s_cbranch_scc1 sent_69
s_waitcnt vmcnt(0)
sentd_70:
v_mfma_f32_16x16x32_bf16 v[156:159], v[188:191], v[60:63], 0
v_mfma_f32_16x16x32_bf16 v[160:163], v[192:195], v[60:63], 0
v_mfma_f32_16x16x32_bf16 v[156:159], v[196:199], v[220:223], v[156:159]
v_mfma_f32_16x16x32_bf16 v[160:163], v[200:203], v[220:223], v[160:163]
v_mfma_f32_16x16x32_bf16 v[164:167], v[188:191], v[68:71], 0
v_mfma_f32_16x16x32_bf16 v[168:171], v[192:195], v[68:71], 0
v_mfma_f32_16x16x32_bf16 v[164:167], v[196:199], v[228:231], v[164:167]
v_mfma_f32_16x16x32_bf16 v[168:171], v[200:203], v[228:231], v[168:171]
v_mfma_f32_16x16x32_bf16 v[172:175], v[188:191], v[76:79], 0
v_mfma_f32_16x16x32_bf16 v[176:179], v[192:195], v[76:79], 0
v_mfma_f32_16x16x32_bf16 v[172:175], v[196:199], v[236:239], v[172:175]
v_mfma_f32_16x16x32_bf16 v[176:179], v[200:203], v[236:239], v[176:179]
v_mfma_f32_16x16x32_bf16 v[180:183], v[188:191], v[84:87], 0
v_mfma_f32_16x16x32_bf16 v[184:187], v[192:195], v[84:87], 0
v_mfma_f32_16x16x32_bf16 v[180:183], v[196:199], v[244:247], v[180:183]
v_mfma_f32_16x16x32_bf16 v[184:187], v[200:203], v[244:247], v[184:187]
s_cmp_eq_u32 s46, 0
s_cbranch_scc1 slow_71
.p2align 3
v_pk_mul_f32 v[156:157], v[156:157], v[100:101] op_sel:[0,0] op_sel_hi:[1,0]
v_pk_mul_f32 v[158:159], v[158:159], v[100:101] op_sel:[0,0] op_sel_hi:[1,0]
v_pk_mul_f32 v[160:161], v[160:161], v[100:101] op_sel:[0,0] op_sel_hi:[1,0]
v_pk_mul_f32 v[162:163], v[162:163], v[100:101] op_sel:[0,0] op_sel_hi:[1,0]
v_cvt_pk_bf16_f32 v156, v156, v157
v_cvt_pk_bf16_f32 v157, v158, v159
v_cvt_pk_bf16_f32 v158, v160, v161
v_cvt_pk_bf16_f32 v159, v162, v163
buffer_store_dwordx4 v[156:159], v18, s[32:35], s80 offen
v_pk_mul_f32 v[164:165], v[164:165], v[100:101] op_sel:[0,1] op_sel_hi:[1,1]
v_pk_mul_f32 v[166:167], v[166:167], v[100:101] op_sel:[0,1] op_sel_hi:[1,1]
v_pk_mul_f32 v[168:169], v[168:169], v[100:101] op_sel:[0,1] op_sel_hi:[1,1]
v_pk_mul_f32 v[170:171], v[170:171], v[100:101] op_sel:[0,1] op_sel_hi:[1,1]
v_cvt_pk_bf16_f32 v164, v164, v165
v_cvt_pk_bf16_f32 v165, v166, v167
v_cvt_pk_bf16_f32 v166, v168, v169
v_cvt_pk_bf16_f32 v167, v170, v171
buffer_store_dwordx4 v[164:167], v18, s[32:35], s81 offen
v_pk_mul_f32 v[172:173], v[172:173], v[102:103] op_sel:[0,0] op_sel_hi:[1,0]
v_pk_mul_f32 v[174:175], v[174:175], v[102:103] op_sel:[0,0] op_sel_hi:[1,0]
v_pk_mul_f32 v[176:177], v[176:177], v[102:103] op_sel:[0,0] op_sel_hi:[1,0]
v_pk_mul_f32 v[178:179], v[178:179], v[102:103] op_sel:[0,0] op_sel_hi:[1,0]
v_cvt_pk_bf16_f32 v172, v172, v173
v_cvt_pk_bf16_f32 v173, v174, v175
v_cvt_pk_bf16_f32 v174, v176, v177
v_cvt_pk_bf16_f32 v175, v178, v179
buffer_store_dwordx4 v[172:175], v18, s[32:35], s82 offen
v_pk_mul_f32 v[180:181], v[180:181], v[102:103] op_sel:[0,1] op_sel_hi:[1,1]
v_pk_mul_f32 v[182:183], v[182:183], v[102:103] op_sel:[0,1] op_sel_hi:[1,1]
v_pk_mul_f32 v[184:185], v[184:185], v[102:103] op_sel:[0,1] op_sel_hi:[1,1]
v_pk_mul_f32 v[186:187], v[186:187], v[102:103] op_sel:[0,1] op_sel_hi:[1,1]
v_cvt_pk_bf16_f32 v180, v180, v181
v_cvt_pk_bf16_f32 v181, v182, v183
v_cvt_pk_bf16_f32 v182, v184, v185
v_cvt_pk_bf16_f32 v183, v186, v187
buffer_store_dwordx4 v[180:183], v18, s[32:35], s83 offen
s_barrier
s_lshl_b32 s62, s45, 2
v_mov_b32 v4, s62
v_mov_b32 v5, 2
s_mov_b64 exec, 1
s_waitcnt vmcnt(0)
buffer_store_dword v5, v4, s[32:35], s84 offen
s_mov_b64 exec, -1
back_72:
v_and_b32 v36, 31, v0
v_lshlrev_b32 v36, 2, v36
buffer_load_dword v37, v36, s[32:35], s84 offen sc1
v_lshrrev_b32 v4, 2, v2
v_and_b32 v5, 3, v0
v_lshl_add_u32 v6, v3, 3, v4
v_lshlrev_b32 v6, 7, v6
v_lshl_add_u32 v6, v5, 3, v6
v_lshrrev_b32 v7, 1, v4
v_and_b32 v8, 1, v3
v_lshl_add_u32 v7, v8, 1, v7
v_lshl_add_u32 v10, v7, 5, v6
v_xor_b32 v11, 32, v10
v_xor_b32 v12, 64, v10
v_xor_b32 v13, 96, v10
v_add_u32 v14, 0x10000, v10
v_add_u32 v15, 0x10000, v11
v_add_u32 v16, 0x10000, v12
v_add_u32 v17, 0x10000, v13
ds_read_b64_tr_b16 v[220:221], v10 offset:0
ds_read_b64_tr_b16 v[222:223], v10 offset:512
ds_read_b64_tr_b16 v[224:225], v11 offset:0
ds_read_b64_tr_b16 v[226:227], v11 offset:512
ds_read_b64_tr_b16 v[228:229], v12 offset:0
ds_read_b64_tr_b16 v[230:231], v12 offset:512
ds_read_b64_tr_b16 v[232:233], v13 offset:0
ds_read_b64_tr_b16 v[234:235], v13 offset:512
ds_read_b64_tr_b16 v[236:237], v10 offset:4096
ds_read_b64_tr_b16 v[238:239], v10 offset:4608
ds_read_b64_tr_b16 v[240:241], v11 offset:4096
ds_read_b64_tr_b16 v[242:243], v11 offset:4608
ds_read_b64_tr_b16 v[244:245], v12 offset:4096
ds_read_b64_tr_b16 v[246:247], v12 offset:4608
ds_read_b64_tr_b16 v[248:249], v13 offset:4096
ds_read_b64_tr_b16 v[250:251], v13 offset:4608
s_lshl_b32 s48, s41, 3
s_lshl_b32 s49, s40, 1
s_add_u32 s48, s48, s49
s_lshl_b32 s48, s48, 15
s_add_u32 s48, s48, 4194304
v_add_u32 v38, s48, v18
v_add_u32 v39, 32768, v38
s_lshl_b32 s57, s75, 11
s_add_u32 s87, s87, 262144
v_lshlrev_b32 v60, 16, v20
v_and_b32 v61, 0xffff0000, v20
v_lshlrev_b32 v62, 16, v21
v_and_b32 v63, 0xffff0000, v21
v_lshlrev_b32 v64, 16, v22
v_and_b32 v65, 0xffff0000, v22
v_lshlrev_b32 v66, 16, v23
v_and_b32 v67, 0xffff0000, v23
v_lshlrev_b32 v68, 16, v24
v_and_b32 v69, 0xffff0000, v24
v_lshlrev_b32 v70, 16, v25
v_and_b32 v71, 0xffff0000, v25
v_lshlrev_b32 v72, 16, v26
v_and_b32 v73, 0xffff0000, v26
v_lshlrev_b32 v74, 16, v27
v_and_b32 v75, 0xffff0000, v27
v_lshlrev_b32 v76, 16, v28
v_and_b32 v77, 0xffff0000, v28
v_lshlrev_b32 v78, 16, v29
v_and_b32 v79, 0xffff0000, v29
v_lshlrev_b32 v80, 16, v30
v_and_b32 v81, 0xffff0000, v30
v_lshlrev_b32 v82, 16, v31
v_and_b32 v83, 0xffff0000, v31
v_lshlrev_b32 v84, 16, v32
v_and_b32 v85, 0xffff0000, v32
v_lshlrev_b32 v86, 16, v33
v_and_b32 v87, 0xffff0000, v33
v_lshlrev_b32 v88, 16, v34
v_and_b32 v89, 0xffff0000, v34
v_lshlrev_b32 v90, 16, v35
v_and_b32 v91, 0xffff0000, v35
v_mov_b32 v6, 0
v_mov_b32 v7, 0
v_mov_b32 v8, 0
v_mov_b32 v9, 0
s_lshl_b32 s62, s42, 2
v_mov_b32 v4, s62
v_mov_b32 v5, 2
s_mov_b32 s63, 0
s_waitcnt vmcnt(0)
poll_73:
v_cmp_gt_u32 vcc, 2, v37
s_cbranch_vccz polled_74
buffer_load_dword v37, v36, s[32:35], s84 offen sc1
s_add_u32 s63, s63, 1
s_cmp_lt_u32 s63, 0x80000
s_waitcnt vmcnt(0)
s_cbranch_scc1 poll_73
polled_74:
buffer_load_dwordx4 v[156:159], v38, s[32:35], s57 offen sc1
buffer_load_dwordx4 v[160:163], v39, s[32:35], s57 offen sc1
buffer_load_dwordx4 v[164:167], v38, s[32:35], s57 offen offset:1024 sc1
buffer_load_dwordx4 v[168:171], v39, s[32:35], s57 offen offset:1024 sc1
s_add_u32 s57, s57, 2048
s_and_b32 s57, s57, 0x7fff
buffer_load_dwordx4 v[172:175], v38, s[32:35], s57 offen sc1
buffer_load_dwordx4 v[176:179], v39, s[32:35], s57 offen sc1
buffer_load_dwordx4 v[180:183], v38, s[32:35], s57 offen offset:1024 sc1
buffer_load_dwordx4 v[184:187], v39, s[32:35], s57 offen offset:1024 sc1
s_add_u32 s57, s57, 2048
s_and_b32 s57, s57, 0x7fff
s_waitcnt vmcnt(6) lgkmcnt(8)
v_mfma_f32_16x16x32_bf16 v[60:63], v[220:223], v[156:159], v[60:63]
buffer_load_dwordx4 v[188:191], v38, s[32:35], s57 offen sc1
v_mfma_f32_16x16x32_bf16 v[76:79], v[220:223], v[160:163], v[76:79]
ds_read_b64_tr_b16 v[100:101], v10 offset:8192
ds_read_b64_tr_b16 v[102:103], v10 offset:8704
v_mfma_f32_16x16x32_bf16 v[64:67], v[224:227], v[156:159], v[64:67]
ds_read_b64_tr_b16 v[104:105], v11 offset:8192
ds_read_b64_tr_b16 v[106:107], v11 offset:8704
v_mfma_f32_16x16x32_bf16 v[80:83], v[224:227], v[160:163], v[80:83]
buffer_load_dwordx4 v[192:195], v39, s[32:35], s57 offen sc1
v_mfma_f32_16x16x32_bf16 v[68:71], v[228:231], v[156:159], v[68:71]
ds_read_b64_tr_b16 v[108:109], v12 offset:8192
ds_read_b64_tr_b16 v[110:111], v12 offset:8704
v_mfma_f32_16x16x32_bf16 v[84:87], v[228:231], v[160:163], v[84:87]
ds_read_b64_tr_b16 v[112:113], v13 offset:8192
ds_read_b64_tr_b16 v[114:115], v13 offset:8704
v_mfma_f32_16x16x32_bf16 v[72:75], v[232:235], v[156:159], v[72:75]
v_mfma_f32_16x16x32_bf16 v[88:91], v[232:235], v[160:163], v[88:91]
s_waitcnt vmcnt(6) lgkmcnt(8)
v_mfma_f32_16x16x32_bf16 v[60:63], v[236:239], v[164:167], v[60:63]
buffer_load_dwordx4 v[196:199], v38, s[32:35], s57 offen offset:1024 sc1
v_mfma_f32_16x16x32_bf16 v[76:79], v[236:239], v[168:171], v[76:79]
ds_read_b64_tr_b16 v[220:221], v10 offset:12288
ds_read_b64_tr_b16 v[222:223], v10 offset:12800
v_mfma_f32_16x16x32_bf16 v[64:67], v[240:243], v[164:167], v[64:67]
ds_read_b64_tr_b16 v[224:225], v11 offset:12288
ds_read_b64_tr_b16 v[226:227], v11 offset:12800
v_mfma_f32_16x16x32_bf16 v[80:83], v[240:243], v[168:171], v[80:83]
buffer_load_dwordx4 v[200:203], v39, s[32:35], s57 offen offset:1024 sc1
v_mfma_f32_16x16x32_bf16 v[68:71], v[244:247], v[164:167], v[68:71]
ds_read_b64_tr_b16 v[228:229], v12 offset:12288
ds_read_b64_tr_b16 v[230:231], v12 offset:12800
v_mfma_f32_16x16x32_bf16 v[84:87], v[244:247], v[168:171], v[84:87]
ds_read_b64_tr_b16 v[232:233], v13 offset:12288
ds_read_b64_tr_b16 v[234:235], v13 offset:12800
v_mfma_f32_16x16x32_bf16 v[72:75], v[248:251], v[164:167], v[72:75]
s_add_u32 s57, s57, 2048
s_and_b32 s57, s57, 0x7fff
v_mfma_f32_16x16x32_bf16 v[88:91], v[248:251], v[168:171], v[88:91]
s_waitcnt vmcnt(6) lgkmcnt(8)
v_mfma_f32_16x16x32_bf16 v[60:63], v[100:103], v[172:175], v[60:63]
buffer_load_dwordx4 v[204:207], v38, s[32:35], s57 offen sc1
v_mfma_f32_16x16x32_bf16 v[76:79], v[100:103], v[176:179], v[76:79]
ds_read_b64_tr_b16 v[236:237], v10 offset:16384
ds_read_b64_tr_b16 v[238:239], v10 offset:16896
v_mfma_f32_16x16x32_bf16 v[64:67], v[104:107], v[172:175], v[64:67]
ds_read_b64_tr_b16 v[240:241], v11 offset:16384
ds_read_b64_tr_b16 v[242:243], v11 offset:16896
v_mfma_f32_16x16x32_bf16 v[80:83], v[104:107], v[176:179], v[80:83]
buffer_load_dwordx4 v[208:211], v39, s[32:35], s57 offen sc1
v_mfma_f32_16x16x32_bf16 v[68:71], v[108:111], v[172:175], v[68:71]
ds_read_b64_tr_b16 v[244:245], v12 offset:16384
ds_read_b64_tr_b16 v[246:247], v12 offset:16896
v_mfma_f32_16x16x32_bf16 v[84:87], v[108:111], v[176:179], v[84:87]
ds_read_b64_tr_b16 v[248:249], v13 offset:16384
ds_read_b64_tr_b16 v[250:251], v13 offset:16896
v_mfma_f32_16x16x32_bf16 v[72:75], v[112:115], v[172:175], v[72:75]
v_mfma_f32_16x16x32_bf16 v[88:91], v[112:115], v[176:179], v[88:91]
s_waitcnt vmcnt(6) lgkmcnt(8)
v_mfma_f32_16x16x32_bf16 v[60:63], v[220:223], v[180:183], v[60:63]
buffer_load_dwordx4 v[212:215], v38, s[32:35], s57 offen offset:1024 sc1
v_mfma_f32_16x16x32_bf16 v[76:79], v[220:223], v[184:187], v[76:79]
ds_read_b64_tr_b16 v[100:101], v10 offset:20480
ds_read_b64_tr_b16 v[102:103], v10 offset:20992
v_mfma_f32_16x16x32_bf16 v[64:67], v[224:227], v[180:183], v[64:67]
ds_read_b64_tr_b16 v[104:105], v11 offset:20480
ds_read_b64_tr_b16 v[106:107], v11 offset:20992
v_mfma_f32_16x16x32_bf16 v[80:83], v[224:227], v[184:187], v[80:83]
buffer_load_dwordx4 v[216:219], v39, s[32:35], s57 offen offset:1024 sc1
v_mfma_f32_16x16x32_bf16 v[68:71], v[228:231], v[180:183], v[68:71]
ds_read_b64_tr_b16 v[108:109], v12 offset:20480
ds_read_b64_tr_b16 v[110:111], v12 offset:20992
v_mfma_f32_16x16x32_bf16 v[84:87], v[228:231], v[184:187], v[84:87]
ds_read_b64_tr_b16 v[112:113], v13 offset:20480
ds_read_b64_tr_b16 v[114:115], v13 offset:20992
v_mfma_f32_16x16x32_bf16 v[72:75], v[232:235], v[180:183], v[72:75]
s_add_u32 s57, s57, 2048
s_and_b32 s57, s57, 0x7fff
v_mfma_f32_16x16x32_bf16 v[88:91], v[232:235], v[184:187], v[88:91]
s_waitcnt vmcnt(6) lgkmcnt(8)
v_mfma_f32_16x16x32_bf16 v[60:63], v[236:239], v[188:191], v[60:63]
buffer_load_dwordx4 v[156:159], v38, s[32:35], s57 offen sc1
v_mfma_f32_16x16x32_bf16 v[76:79], v[236:239], v[192:195], v[76:79]
ds_read_b64_tr_b16 v[220:221], v10 offset:24576
ds_read_b64_tr_b16 v[222:223], v10 offset:25088
v_mfma_f32_16x16x32_bf16 v[64:67], v[240:243], v[188:191], v[64:67]
ds_read_b64_tr_b16 v[224:225], v11 offset:24576
ds_read_b64_tr_b16 v[226:227], v11 offset:25088
v_mfma_f32_16x16x32_bf16 v[80:83], v[240:243], v[192:195], v[80:83]
buffer_load_dwordx4 v[160:163], v39, s[32:35], s57 offen sc1
v_mfma_f32_16x16x32_bf16 v[68:71], v[244:247], v[188:191], v[68:71]
ds_read_b64_tr_b16 v[228:229], v12 offset:24576
ds_read_b64_tr_b16 v[230:231], v12 offset:25088
v_mfma_f32_16x16x32_bf16 v[84:87], v[244:247], v[192:195], v[84:87]
ds_read_b64_tr_b16 v[232:233], v13 offset:24576
ds_read_b64_tr_b16 v[234:235], v13 offset:25088
v_mfma_f32_16x16x32_bf16 v[72:75], v[248:251], v[188:191], v[72:75]
v_mfma_f32_16x16x32_bf16 v[88:91], v[248:251], v[192:195], v[88:91]
s_waitcnt vmcnt(6) lgkmcnt(8)
v_mfma_f32_16x16x32_bf16 v[60:63], v[100:103], v[196:199], v[60:63]
buffer_load_dwordx4 v[164:167], v38, s[32:35], s57 offen offset:1024 sc1
v_mfma_f32_16x16x32_bf16 v[76:79], v[100:103], v[200:203], v[76:79]
ds_read_b64_tr_b16 v[236:237], v10 offset:28672
ds_read_b64_tr_b16 v[238:239], v10 offset:29184
v_mfma_f32_16x16x32_bf16 v[64:67], v[104:107], v[196:199], v[64:67]
ds_read_b64_tr_b16 v[240:241], v11 offset:28672
ds_read_b64_tr_b16 v[242:243], v11 offset:29184
v_mfma_f32_16x16x32_bf16 v[80:83], v[104:107], v[200:203], v[80:83]
buffer_load_dwordx4 v[168:171], v39, s[32:35], s57 offen offset:1024 sc1
v_mfma_f32_16x16x32_bf16 v[68:71], v[108:111], v[196:199], v[68:71]
ds_read_b64_tr_b16 v[244:245], v12 offset:28672
ds_read_b64_tr_b16 v[246:247], v12 offset:29184
v_mfma_f32_16x16x32_bf16 v[84:87], v[108:111], v[200:203], v[84:87]
ds_read_b64_tr_b16 v[248:249], v13 offset:28672
ds_read_b64_tr_b16 v[250:251], v13 offset:29184
v_mfma_f32_16x16x32_bf16 v[72:75], v[112:115], v[196:199], v[72:75]
s_add_u32 s57, s57, 2048
s_and_b32 s57, s57, 0x7fff
v_mfma_f32_16x16x32_bf16 v[88:91], v[112:115], v[200:203], v[88:91]
s_waitcnt vmcnt(6) lgkmcnt(8)
v_mfma_f32_16x16x32_bf16 v[60:63], v[220:223], v[204:207], v[60:63]
buffer_load_dwordx4 v[172:175], v38, s[32:35], s57 offen sc1
v_mfma_f32_16x16x32_bf16 v[76:79], v[220:223], v[208:211], v[76:79]
ds_read_b64_tr_b16 v[100:101], v10 offset:32768
ds_read_b64_tr_b16 v[102:103], v10 offset:33280
v_mfma_f32_16x16x32_bf16 v[64:67], v[224:227], v[204:207], v[64:67]
ds_read_b64_tr_b16 v[104:105], v11 offset:32768
ds_read_b64_tr_b16 v[106:107], v11 offset:33280
v_mfma_f32_16x16x32_bf16 v[80:83], v[224:227], v[208:211], v[80:83]
buffer_load_dwordx4 v[176:179], v39, s[32:35], s57 offen sc1
v_mfma_f32_16x16x32_bf16 v[68:71], v[228:231], v[204:207], v[68:71]
ds_read_b64_tr_b16 v[108:109], v12 offset:32768
ds_read_b64_tr_b16 v[110:111], v12 offset:33280
v_mfma_f32_16x16x32_bf16 v[84:87], v[228:231], v[208:211], v[84:87]
ds_read_b64_tr_b16 v[112:113], v13 offset:32768
ds_read_b64_tr_b16 v[114:115], v13 offset:33280
v_mfma_f32_16x16x32_bf16 v[72:75], v[232:235], v[204:207], v[72:75]
v_mfma_f32_16x16x32_bf16 v[88:91], v[232:235], v[208:211], v[88:91]
s_waitcnt vmcnt(6) lgkmcnt(8)
v_mfma_f32_16x16x32_bf16 v[60:63], v[236:239], v[212:215], v[60:63]
buffer_load_dwordx4 v[180:183], v38, s[32:35], s57 offen offset:1024 sc1
v_mfma_f32_16x16x32_bf16 v[76:79], v[236:239], v[216:219], v[76:79]
ds_read_b64_tr_b16 v[220:221], v10 offset:36864
ds_read_b64_tr_b16 v[222:223], v10 offset:37376
v_mfma_f32_16x16x32_bf16 v[64:67], v[240:243], v[212:215], v[64:67]
ds_read_b64_tr_b16 v[224:225], v11 offset:36864
ds_read_b64_tr_b16 v[226:227], v11 offset:37376
v_mfma_f32_16x16x32_bf16 v[80:83], v[240:243], v[216:219], v[80:83]
buffer_load_dwordx4 v[184:187], v39, s[32:35], s57 offen offset:1024 sc1
v_mfma_f32_16x16x32_bf16 v[68:71], v[244:247], v[212:215], v[68:71]
ds_read_b64_tr_b16 v[228:229], v12 offset:36864
ds_read_b64_tr_b16 v[230:231], v12 offset:37376
v_mfma_f32_16x16x32_bf16 v[84:87], v[244:247], v[216:219], v[84:87]
ds_read_b64_tr_b16 v[232:233], v13 offset:36864
ds_read_b64_tr_b16 v[234:235], v13 offset:37376
v_mfma_f32_16x16x32_bf16 v[72:75], v[248:251], v[212:215], v[72:75]
s_add_u32 s57, s57, 2048
s_and_b32 s57, s57, 0x7fff
v_mfma_f32_16x16x32_bf16 v[88:91], v[248:251], v[216:219], v[88:91]
s_waitcnt vmcnt(6) lgkmcnt(8)
v_mfma_f32_16x16x32_bf16 v[60:63], v[100:103], v[156:159], v[60:63]
buffer_load_dwordx4 v[188:191], v38, s[32:35], s57 offen sc1
v_mfma_f32_16x16x32_bf16 v[76:79], v[100:103], v[160:163], v[76:79]
ds_read_b64_tr_b16 v[236:237], v10 offset:40960
ds_read_b64_tr_b16 v[238:239], v10 offset:41472
v_mfma_f32_16x16x32_bf16 v[64:67], v[104:107], v[156:159], v[64:67]
ds_read_b64_tr_b16 v[240:241], v11 offset:40960
ds_read_b64_tr_b16 v[242:243], v11 offset:41472
v_mfma_f32_16x16x32_bf16 v[80:83], v[104:107], v[160:163], v[80:83]
buffer_load_dwordx4 v[192:195], v39, s[32:35], s57 offen sc1
v_mfma_f32_16x16x32_bf16 v[68:71], v[108:111], v[156:159], v[68:71]
ds_read_b64_tr_b16 v[244:245], v12 offset:40960
ds_read_b64_tr_b16 v[246:247], v12 offset:41472
v_mfma_f32_16x16x32_bf16 v[84:87], v[108:111], v[160:163], v[84:87]
ds_read_b64_tr_b16 v[248:249], v13 offset:40960
ds_read_b64_tr_b16 v[250:251], v13 offset:41472
v_mfma_f32_16x16x32_bf16 v[72:75], v[112:115], v[156:159], v[72:75]
v_mfma_f32_16x16x32_bf16 v[88:91], v[112:115], v[160:163], v[88:91]
s_waitcnt vmcnt(6) lgkmcnt(8)
v_mfma_f32_16x16x32_bf16 v[60:63], v[220:223], v[164:167], v[60:63]
buffer_load_dwordx4 v[196:199], v38, s[32:35], s57 offen offset:1024 sc1
v_mfma_f32_16x16x32_bf16 v[76:79], v[220:223], v[168:171], v[76:79]
ds_read_b64_tr_b16 v[100:101], v10 offset:45056
ds_read_b64_tr_b16 v[102:103], v10 offset:45568
v_mfma_f32_16x16x32_bf16 v[64:67], v[224:227], v[164:167], v[64:67]
ds_read_b64_tr_b16 v[104:105], v11 offset:45056
ds_read_b64_tr_b16 v[106:107], v11 offset:45568
v_mfma_f32_16x16x32_bf16 v[80:83], v[224:227], v[168:171], v[80:83]
buffer_load_dwordx4 v[200:203], v39, s[32:35], s57 offen offset:1024 sc1
v_mfma_f32_16x16x32_bf16 v[68:71], v[228:231], v[164:167], v[68:71]
ds_read_b64_tr_b16 v[108:109], v12 offset:45056
ds_read_b64_tr_b16 v[110:111], v12 offset:45568
v_mfma_f32_16x16x32_bf16 v[84:87], v[228:231], v[168:171], v[84:87]
ds_read_b64_tr_b16 v[112:113], v13 offset:45056
ds_read_b64_tr_b16 v[114:115], v13 offset:45568
v_mfma_f32_16x16x32_bf16 v[72:75], v[232:235], v[164:167], v[72:75]
s_add_u32 s57, s57, 2048
s_and_b32 s57, s57, 0x7fff
v_mfma_f32_16x16x32_bf16 v[88:91], v[232:235], v[168:171], v[88:91]
s_waitcnt vmcnt(6) lgkmcnt(8)
v_mfma_f32_16x16x32_bf16 v[60:63], v[236:239], v[172:175], v[60:63]
buffer_load_dwordx4 v[204:207], v38, s[32:35], s57 offen sc1
v_mfma_f32_16x16x32_bf16 v[76:79], v[236:239], v[176:179], v[76:79]
ds_read_b64_tr_b16 v[220:221], v10 offset:49152
ds_read_b64_tr_b16 v[222:223], v10 offset:49664
v_mfma_f32_16x16x32_bf16 v[64:67], v[240:243], v[172:175], v[64:67]
ds_read_b64_tr_b16 v[224:225], v11 offset:49152
ds_read_b64_tr_b16 v[226:227], v11 offset:49664
v_mfma_f32_16x16x32_bf16 v[80:83], v[240:243], v[176:179], v[80:83]
buffer_load_dwordx4 v[208:211], v39, s[32:35], s57 offen sc1
v_mfma_f32_16x16x32_bf16 v[68:71], v[244:247], v[172:175], v[68:71]
ds_read_b64_tr_b16 v[228:229], v12 offset:49152
ds_read_b64_tr_b16 v[230:231], v12 offset:49664
v_mfma_f32_16x16x32_bf16 v[84:87], v[244:247], v[176:179], v[84:87]
ds_read_b64_tr_b16 v[232:233], v13 offset:49152
ds_read_b64_tr_b16 v[234:235], v13 offset:49664
v_mfma_f32_16x16x32_bf16 v[72:75], v[248:251], v[172:175], v[72:75]
v_mfma_f32_16x16x32_bf16 v[88:91], v[248:251], v[176:179], v[88:91]
s_waitcnt vmcnt(6) lgkmcnt(8)
v_mfma_f32_16x16x32_bf16 v[60:63], v[100:103], v[180:183], v[60:63]
buffer_load_dwordx4 v[212:215], v38, s[32:35], s57 offen offset:1024 sc1
v_mfma_f32_16x16x32_bf16 v[76:79], v[100:103], v[184:187], v[76:79]
ds_read_b64_tr_b16 v[236:237], v10 offset:53248
ds_read_b64_tr_b16 v[238:239], v10 offset:53760
v_mfma_f32_16x16x32_bf16 v[64:67], v[104:107], v[180:183], v[64:67]
ds_read_b64_tr_b16 v[240:241], v11 offset:53248
ds_read_b64_tr_b16 v[242:243], v11 offset:53760
v_mfma_f32_16x16x32_bf16 v[80:83], v[104:107], v[184:187], v[80:83]
buffer_load_dwordx4 v[216:219], v39, s[32:35], s57 offen offset:1024 sc1
v_mfma_f32_16x16x32_bf16 v[68:71], v[108:111], v[180:183], v[68:71]
ds_read_b64_tr_b16 v[244:245], v12 offset:53248
ds_read_b64_tr_b16 v[246:247], v12 offset:53760
v_mfma_f32_16x16x32_bf16 v[84:87], v[108:111], v[184:187], v[84:87]
ds_read_b64_tr_b16 v[248:249], v13 offset:53248
ds_read_b64_tr_b16 v[250:251], v13 offset:53760
v_mfma_f32_16x16x32_bf16 v[72:75], v[112:115], v[180:183], v[72:75]
s_add_u32 s57, s57, 2048
s_and_b32 s57, s57, 0x7fff
v_mfma_f32_16x16x32_bf16 v[88:91], v[112:115], v[184:187], v[88:91]
s_waitcnt vmcnt(6) lgkmcnt(8)
v_mfma_f32_16x16x32_bf16 v[60:63], v[220:223], v[188:191], v[60:63]
buffer_load_dwordx4 v[156:159], v38, s[32:35], s57 offen sc1
v_mfma_f32_16x16x32_bf16 v[76:79], v[220:223], v[192:195], v[76:79]
ds_read_b64_tr_b16 v[100:101], v10 offset:57344
ds_read_b64_tr_b16 v[102:103], v10 offset:57856
v_mfma_f32_16x16x32_bf16 v[64:67], v[224:227], v[188:191], v[64:67]
ds_read_b64_tr_b16 v[104:105], v11 offset:57344
ds_read_b64_tr_b16 v[106:107], v11 offset:57856
v_mfma_f32_16x16x32_bf16 v[80:83], v[224:227], v[192:195], v[80:83]
buffer_load_dwordx4 v[160:163], v39, s[32:35], s57 offen sc1
v_mfma_f32_16x16x32_bf16 v[68:71], v[228:231], v[188:191], v[68:71]
ds_read_b64_tr_b16 v[108:109], v12 offset:57344
ds_read_b64_tr_b16 v[110:111], v12 offset:57856
v_mfma_f32_16x16x32_bf16 v[84:87], v[228:231], v[192:195], v[84:87]
ds_read_b64_tr_b16 v[112:113], v13 offset:57344
ds_read_b64_tr_b16 v[114:115], v13 offset:57856
v_mfma_f32_16x16x32_bf16 v[72:75], v[232:235], v[188:191], v[72:75]
v_mfma_f32_16x16x32_bf16 v[88:91], v[232:235], v[192:195], v[88:91]
s_waitcnt vmcnt(6) lgkmcnt(8)
v_mfma_f32_16x16x32_bf16 v[60:63], v[236:239], v[196:199], v[60:63]
buffer_load_dwordx4 v[164:167], v38, s[32:35], s57 offen offset:1024 sc1
v_mfma_f32_16x16x32_bf16 v[76:79], v[236:239], v[200:203], v[76:79]
ds_read_b64_tr_b16 v[220:221], v10 offset:61440
ds_read_b64_tr_b16 v[222:223], v10 offset:61952
v_mfma_f32_16x16x32_bf16 v[64:67], v[240:243], v[196:199], v[64:67]
ds_read_b64_tr_b16 v[224:225], v11 offset:61440
ds_read_b64_tr_b16 v[226:227], v11 offset:61952
v_mfma_f32_16x16x32_bf16 v[80:83], v[240:243], v[200:203], v[80:83]
buffer_load_dwordx4 v[168:171], v39, s[32:35], s57 offen offset:1024 sc1
v_mfma_f32_16x16x32_bf16 v[68:71], v[244:247], v[196:199], v[68:71]
ds_read_b64_tr_b16 v[228:229], v12 offset:61440
ds_read_b64_tr_b16 v[230:231], v12 offset:61952
v_mfma_f32_16x16x32_bf16 v[84:87], v[244:247], v[200:203], v[84:87]
ds_read_b64_tr_b16 v[232:233], v13 offset:61440
ds_read_b64_tr_b16 v[234:235], v13 offset:61952
v_mfma_f32_16x16x32_bf16 v[72:75], v[248:251], v[196:199], v[72:75]
s_add_u32 s57, s57, 2048
s_and_b32 s57, s57, 0x7fff
v_mfma_f32_16x16x32_bf16 v[88:91], v[248:251], v[200:203], v[88:91]
s_waitcnt vmcnt(6) lgkmcnt(8)
v_mfma_f32_16x16x32_bf16 v[60:63], v[100:103], v[204:207], v[60:63]
buffer_load_dwordx4 v[172:175], v38, s[32:35], s57 offen sc1
v_mfma_f32_16x16x32_bf16 v[76:79], v[100:103], v[208:211], v[76:79]
ds_read_b64_tr_b16 v[236:237], v14 offset:0
ds_read_b64_tr_b16 v[238:239], v14 offset:512
v_mfma_f32_16x16x32_bf16 v[64:67], v[104:107], v[204:207], v[64:67]
ds_read_b64_tr_b16 v[240:241], v15 offset:0
ds_read_b64_tr_b16 v[242:243], v15 offset:512
v_mfma_f32_16x16x32_bf16 v[80:83], v[104:107], v[208:211], v[80:83]
buffer_load_dwordx4 v[176:179], v39, s[32:35], s57 offen sc1
v_mfma_f32_16x16x32_bf16 v[68:71], v[108:111], v[204:207], v[68:71]
ds_read_b64_tr_b16 v[244:245], v16 offset:0
ds_read_b64_tr_b16 v[246:247], v16 offset:512
v_mfma_f32_16x16x32_bf16 v[84:87], v[108:111], v[208:211], v[84:87]
ds_read_b64_tr_b16 v[248:249], v17 offset:0
ds_read_b64_tr_b16 v[250:251], v17 offset:512
v_mfma_f32_16x16x32_bf16 v[72:75], v[112:115], v[204:207], v[72:75]
v_mfma_f32_16x16x32_bf16 v[88:91], v[112:115], v[208:211], v[88:91]
s_waitcnt vmcnt(6) lgkmcnt(8)
v_mfma_f32_16x16x32_bf16 v[60:63], v[220:223], v[212:215], v[60:63]
buffer_load_dwordx4 v[180:183], v38, s[32:35], s57 offen offset:1024 sc1
v_mfma_f32_16x16x32_bf16 v[76:79], v[220:223], v[216:219], v[76:79]
ds_read_b64_tr_b16 v[100:101], v14 offset:4096
ds_read_b64_tr_b16 v[102:103], v14 offset:4608
v_mfma_f32_16x16x32_bf16 v[64:67], v[224:227], v[212:215], v[64:67]
ds_read_b64_tr_b16 v[104:105], v15 offset:4096
ds_read_b64_tr_b16 v[106:107], v15 offset:4608
v_mfma_f32_16x16x32_bf16 v[80:83], v[224:227], v[216:219], v[80:83]
buffer_load_dwordx4 v[184:187], v39, s[32:35], s57 offen offset:1024 sc1
v_mfma_f32_16x16x32_bf16 v[68:71], v[228:231], v[212:215], v[68:71]
ds_read_b64_tr_b16 v[108:109], v16 offset:4096
ds_read_b64_tr_b16 v[110:111], v16 offset:4608
v_mfma_f32_16x16x32_bf16 v[84:87], v[228:231], v[216:219], v[84:87]
ds_read_b64_tr_b16 v[112:113], v17 offset:4096
ds_read_b64_tr_b16 v[114:115], v17 offset:4608
v_mfma_f32_16x16x32_bf16 v[72:75], v[232:235], v[212:215], v[72:75]
s_add_u32 s57, s57, 2048
s_and_b32 s57, s57, 0x7fff
v_mfma_f32_16x16x32_bf16 v[88:91], v[232:235], v[216:219], v[88:91]
s_waitcnt vmcnt(6) lgkmcnt(8)
v_mfma_f32_16x16x32_bf16 v[60:63], v[236:239], v[156:159], v[60:63]
buffer_load_dwordx4 v[188:191], v38, s[32:35], s57 offen sc1
v_mfma_f32_16x16x32_bf16 v[76:79], v[236:239], v[160:163], v[76:79]
ds_read_b64_tr_b16 v[220:221], v14 offset:8192
ds_read_b64_tr_b16 v[222:223], v14 offset:8704
v_mfma_f32_16x16x32_bf16 v[64:67], v[240:243], v[156:159], v[64:67]
ds_read_b64_tr_b16 v[224:225], v15 offset:8192
ds_read_b64_tr_b16 v[226:227], v15 offset:8704
v_mfma_f32_16x16x32_bf16 v[80:83], v[240:243], v[160:163], v[80:83]
buffer_load_dwordx4 v[192:195], v39, s[32:35], s57 offen sc1
v_mfma_f32_16x16x32_bf16 v[68:71], v[244:247], v[156:159], v[68:71]
ds_read_b64_tr_b16 v[228:229], v16 offset:8192
ds_read_b64_tr_b16 v[230:231], v16 offset:8704
v_mfma_f32_16x16x32_bf16 v[84:87], v[244:247], v[160:163], v[84:87]
ds_read_b64_tr_b16 v[232:233], v17 offset:8192
ds_read_b64_tr_b16 v[234:235], v17 offset:8704
v_mfma_f32_16x16x32_bf16 v[72:75], v[248:251], v[156:159], v[72:75]
v_mfma_f32_16x16x32_bf16 v[88:91], v[248:251], v[160:163], v[88:91]
s_waitcnt vmcnt(6) lgkmcnt(8)
v_mfma_f32_16x16x32_bf16 v[60:63], v[100:103], v[164:167], v[60:63]
buffer_load_dwordx4 v[196:199], v38, s[32:35], s57 offen offset:1024 sc1
v_mfma_f32_16x16x32_bf16 v[76:79], v[100:103], v[168:171], v[76:79]
ds_read_b64_tr_b16 v[236:237], v14 offset:12288
ds_read_b64_tr_b16 v[238:239], v14 offset:12800
v_mfma_f32_16x16x32_bf16 v[64:67], v[104:107], v[164:167], v[64:67]
ds_read_b64_tr_b16 v[240:241], v15 offset:12288
ds_read_b64_tr_b16 v[242:243], v15 offset:12800
v_mfma_f32_16x16x32_bf16 v[80:83], v[104:107], v[168:171], v[80:83]
buffer_load_dwordx4 v[200:203], v39, s[32:35], s57 offen offset:1024 sc1
v_mfma_f32_16x16x32_bf16 v[68:71], v[108:111], v[164:167], v[68:71]
ds_read_b64_tr_b16 v[244:245], v16 offset:12288
ds_read_b64_tr_b16 v[246:247], v16 offset:12800
v_mfma_f32_16x16x32_bf16 v[84:87], v[108:111], v[168:171], v[84:87]
ds_read_b64_tr_b16 v[248:249], v17 offset:12288
ds_read_b64_tr_b16 v[250:251], v17 offset:12800
v_mfma_f32_16x16x32_bf16 v[72:75], v[112:115], v[164:167], v[72:75]
s_add_u32 s57, s57, 2048
s_and_b32 s57, s57, 0x7fff
v_mfma_f32_16x16x32_bf16 v[88:91], v[112:115], v[168:171], v[88:91]
s_waitcnt vmcnt(6) lgkmcnt(8)
v_mfma_f32_16x16x32_bf16 v[60:63], v[220:223], v[172:175], v[60:63]
buffer_load_dwordx4 v[204:207], v38, s[32:35], s57 offen sc1
v_mfma_f32_16x16x32_bf16 v[76:79], v[220:223], v[176:179], v[76:79]
ds_read_b64_tr_b16 v[100:101], v14 offset:16384
ds_read_b64_tr_b16 v[102:103], v14 offset:16896
v_mfma_f32_16x16x32_bf16 v[64:67], v[224:227], v[172:175], v[64:67]
ds_read_b64_tr_b16 v[104:105], v15 offset:16384
ds_read_b64_tr_b16 v[106:107], v15 offset:16896
v_mfma_f32_16x16x32_bf16 v[80:83], v[224:227], v[176:179], v[80:83]
buffer_load_dwordx4 v[208:211], v39, s[32:35], s57 offen sc1
v_mfma_f32_16x16x32_bf16 v[68:71], v[228:231], v[172:175], v[68:71]
ds_read_b64_tr_b16 v[108:109], v16 offset:16384
ds_read_b64_tr_b16 v[110:111], v16 offset:16896
v_mfma_f32_16x16x32_bf16 v[84:87], v[228:231], v[176:179], v[84:87]
ds_read_b64_tr_b16 v[112:113], v17 offset:16384
ds_read_b64_tr_b16 v[114:115], v17 offset:16896
v_mfma_f32_16x16x32_bf16 v[72:75], v[232:235], v[172:175], v[72:75]
v_mfma_f32_16x16x32_bf16 v[88:91], v[232:235], v[176:179], v[88:91]
s_waitcnt vmcnt(6) lgkmcnt(8)
v_mfma_f32_16x16x32_bf16 v[60:63], v[236:239], v[180:183], v[60:63]
buffer_load_dwordx4 v[212:215], v38, s[32:35], s57 offen offset:1024 sc1
v_mfma_f32_16x16x32_bf16 v[76:79], v[236:239], v[184:187], v[76:79]
ds_read_b64_tr_b16 v[220:221], v14 offset:20480
ds_read_b64_tr_b16 v[222:223], v14 offset:20992
v_mfma_f32_16x16x32_bf16 v[64:67], v[240:243], v[180:183], v[64:67]
ds_read_b64_tr_b16 v[224:225], v15 offset:20480
ds_read_b64_tr_b16 v[226:227], v15 offset:20992
v_mfma_f32_16x16x32_bf16 v[80:83], v[240:243], v[184:187], v[80:83]
buffer_load_dwordx4 v[216:219], v39, s[32:35], s57 offen offset:1024 sc1
v_mfma_f32_16x16x32_bf16 v[68:71], v[244:247], v[180:183], v[68:71]
ds_read_b64_tr_b16 v[228:229], v16 offset:20480
ds_read_b64_tr_b16 v[230:231], v16 offset:20992
v_mfma_f32_16x16x32_bf16 v[84:87], v[244:247], v[184:187], v[84:87]
ds_read_b64_tr_b16 v[232:233], v17 offset:20480
ds_read_b64_tr_b16 v[234:235], v17 offset:20992
v_mfma_f32_16x16x32_bf16 v[72:75], v[248:251], v[180:183], v[72:75]
s_add_u32 s57, s57, 2048
s_and_b32 s57, s57, 0x7fff
v_mfma_f32_16x16x32_bf16 v[88:91], v[248:251], v[184:187], v[88:91]
s_waitcnt vmcnt(6) lgkmcnt(8)
v_mfma_f32_16x16x32_bf16 v[60:63], v[100:103], v[188:191], v[60:63]
buffer_load_dwordx4 v[156:159], v38, s[32:35], s57 offen sc1
v_mfma_f32_16x16x32_bf16 v[76:79], v[100:103], v[192:195], v[76:79]
ds_read_b64_tr_b16 v[236:237], v14 offset:24576
ds_read_b64_tr_b16 v[238:239], v14 offset:25088
v_mfma_f32_16x16x32_bf16 v[64:67], v[104:107], v[188:191], v[64:67]
ds_read_b64_tr_b16 v[240:241], v15 offset:24576
ds_read_b64_tr_b16 v[242:243], v15 offset:25088
v_mfma_f32_16x16x32_bf16 v[80:83], v[104:107], v[192:195], v[80:83]
buffer_load_dwordx4 v[160:163], v39, s[32:35], s57 offen sc1
v_mfma_f32_16x16x32_bf16 v[68:71], v[108:111], v[188:191], v[68:71]
ds_read_b64_tr_b16 v[244:245], v16 offset:24576
ds_read_b64_tr_b16 v[246:247], v16 offset:25088
v_mfma_f32_16x16x32_bf16 v[84:87], v[108:111], v[192:195], v[84:87]
ds_read_b64_tr_b16 v[248:249], v17 offset:24576
ds_read_b64_tr_b16 v[250:251], v17 offset:25088
v_mfma_f32_16x16x32_bf16 v[72:75], v[112:115], v[188:191], v[72:75]
v_mfma_f32_16x16x32_bf16 v[88:91], v[112:115], v[192:195], v[88:91]
s_waitcnt vmcnt(6) lgkmcnt(8)
v_mfma_f32_16x16x32_bf16 v[60:63], v[220:223], v[196:199], v[60:63]
buffer_load_dwordx4 v[164:167], v38, s[32:35], s57 offen offset:1024 sc1
v_mfma_f32_16x16x32_bf16 v[76:79], v[220:223], v[200:203], v[76:79]
ds_read_b64_tr_b16 v[100:101], v14 offset:28672
ds_read_b64_tr_b16 v[102:103], v14 offset:29184
v_mfma_f32_16x16x32_bf16 v[64:67], v[224:227], v[196:199], v[64:67]
ds_read_b64_tr_b16 v[104:105], v15 offset:28672
ds_read_b64_tr_b16 v[106:107], v15 offset:29184
v_mfma_f32_16x16x32_bf16 v[80:83], v[224:227], v[200:203], v[80:83]
buffer_load_dwordx4 v[168:171], v39, s[32:35], s57 offen offset:1024 sc1
v_mfma_f32_16x16x32_bf16 v[68:71], v[228:231], v[196:199], v[68:71]
ds_read_b64_tr_b16 v[108:109], v16 offset:28672
ds_read_b64_tr_b16 v[110:111], v16 offset:29184
v_mfma_f32_16x16x32_bf16 v[84:87], v[228:231], v[200:203], v[84:87]
ds_read_b64_tr_b16 v[112:113], v17 offset:28672
ds_read_b64_tr_b16 v[114:115], v17 offset:29184
v_mfma_f32_16x16x32_bf16 v[72:75], v[232:235], v[196:199], v[72:75]
s_add_u32 s57, s57, 2048
s_and_b32 s57, s57, 0x7fff
v_mfma_f32_16x16x32_bf16 v[88:91], v[232:235], v[200:203], v[88:91]
s_waitcnt vmcnt(6) lgkmcnt(8)
v_mfma_f32_16x16x32_bf16 v[60:63], v[236:239], v[204:207], v[60:63]
buffer_load_dwordx4 v[172:175], v38, s[32:35], s57 offen sc1
v_mfma_f32_16x16x32_bf16 v[76:79], v[236:239], v[208:211], v[76:79]
ds_read_b64_tr_b16 v[220:221], v14 offset:32768
ds_read_b64_tr_b16 v[222:223], v14 offset:33280
v_mfma_f32_16x16x32_bf16 v[64:67], v[240:243], v[204:207], v[64:67]
ds_read_b64_tr_b16 v[224:225], v15 offset:32768
ds_read_b64_tr_b16 v[226:227], v15 offset:33280
v_mfma_f32_16x16x32_bf16 v[80:83], v[240:243], v[208:211], v[80:83]
buffer_load_dwordx4 v[176:179], v39, s[32:35], s57 offen sc1
v_mfma_f32_16x16x32_bf16 v[68:71], v[244:247], v[204:207], v[68:71]
ds_read_b64_tr_b16 v[228:229], v16 offset:32768
ds_read_b64_tr_b16 v[230:231], v16 offset:33280
v_mfma_f32_16x16x32_bf16 v[84:87], v[244:247], v[208:211], v[84:87]
ds_read_b64_tr_b16 v[232:233], v17 offset:32768
ds_read_b64_tr_b16 v[234:235], v17 offset:33280
v_mfma_f32_16x16x32_bf16 v[72:75], v[248:251], v[204:207], v[72:75]
v_mfma_f32_16x16x32_bf16 v[88:91], v[248:251], v[208:211], v[88:91]
s_waitcnt vmcnt(6) lgkmcnt(8)
v_mfma_f32_16x16x32_bf16 v[60:63], v[100:103], v[212:215], v[60:63]
buffer_load_dwordx4 v[180:183], v38, s[32:35], s57 offen offset:1024 sc1
v_mfma_f32_16x16x32_bf16 v[76:79], v[100:103], v[216:219], v[76:79]
ds_read_b64_tr_b16 v[236:237], v14 offset:36864
ds_read_b64_tr_b16 v[238:239], v14 offset:37376
v_mfma_f32_16x16x32_bf16 v[64:67], v[104:107], v[212:215], v[64:67]
ds_read_b64_tr_b16 v[240:241], v15 offset:36864
ds_read_b64_tr_b16 v[242:243], v15 offset:37376
v_mfma_f32_16x16x32_bf16 v[80:83], v[104:107], v[216:219], v[80:83]
buffer_load_dwordx4 v[184:187], v39, s[32:35], s57 offen offset:1024 sc1
v_mfma_f32_16x16x32_bf16 v[68:71], v[108:111], v[212:215], v[68:71]
ds_read_b64_tr_b16 v[244:245], v16 offset:36864
ds_read_b64_tr_b16 v[246:247], v16 offset:37376
v_mfma_f32_16x16x32_bf16 v[84:87], v[108:111], v[216:219], v[84:87]
ds_read_b64_tr_b16 v[248:249], v17 offset:36864
ds_read_b64_tr_b16 v[250:251], v17 offset:37376
v_mfma_f32_16x16x32_bf16 v[72:75], v[112:115], v[212:215], v[72:75]
s_add_u32 s57, s57, 2048
s_and_b32 s57, s57, 0x7fff
v_mfma_f32_16x16x32_bf16 v[88:91], v[112:115], v[216:219], v[88:91]
s_waitcnt vmcnt(6) lgkmcnt(8)
v_mfma_f32_16x16x32_bf16 v[60:63], v[220:223], v[156:159], v[60:63]
buffer_load_dwordx4 v[188:191], v38, s[32:35], s57 offen sc1
v_mfma_f32_16x16x32_bf16 v[76:79], v[220:223], v[160:163], v[76:79]
ds_read_b64_tr_b16 v[100:101], v14 offset:40960
ds_read_b64_tr_b16 v[102:103], v14 offset:41472
v_mfma_f32_16x16x32_bf16 v[64:67], v[224:227], v[156:159], v[64:67]
ds_read_b64_tr_b16 v[104:105], v15 offset:40960
ds_read_b64_tr_b16 v[106:107], v15 offset:41472
v_mfma_f32_16x16x32_bf16 v[80:83], v[224:227], v[160:163], v[80:83]
buffer_load_dwordx4 v[192:195], v39, s[32:35], s57 offen sc1
v_mfma_f32_16x16x32_bf16 v[68:71], v[228:231], v[156:159], v[68:71]
ds_read_b64_tr_b16 v[108:109], v16 offset:40960
ds_read_b64_tr_b16 v[110:111], v16 offset:41472
v_mfma_f32_16x16x32_bf16 v[84:87], v[228:231], v[160:163], v[84:87]
ds_read_b64_tr_b16 v[112:113], v17 offset:40960
ds_read_b64_tr_b16 v[114:115], v17 offset:41472
v_mfma_f32_16x16x32_bf16 v[72:75], v[232:235], v[156:159], v[72:75]
v_mfma_f32_16x16x32_bf16 v[88:91], v[232:235], v[160:163], v[88:91]
s_waitcnt vmcnt(6) lgkmcnt(8)
v_mfma_f32_16x16x32_bf16 v[60:63], v[236:239], v[164:167], v[60:63]
buffer_load_dwordx4 v[196:199], v38, s[32:35], s57 offen offset:1024 sc1
v_mfma_f32_16x16x32_bf16 v[76:79], v[236:239], v[168:171], v[76:79]
ds_read_b64_tr_b16 v[220:221], v14 offset:45056
ds_read_b64_tr_b16 v[222:223], v14 offset:45568
v_mfma_f32_16x16x32_bf16 v[64:67], v[240:243], v[164:167], v[64:67]
ds_read_b64_tr_b16 v[224:225], v15 offset:45056
ds_read_b64_tr_b16 v[226:227], v15 offset:45568
v_mfma_f32_16x16x32_bf16 v[80:83], v[240:243], v[168:171], v[80:83]
buffer_load_dwordx4 v[200:203], v39, s[32:35], s57 offen offset:1024 sc1
v_mfma_f32_16x16x32_bf16 v[68:71], v[244:247], v[164:167], v[68:71]
ds_read_b64_tr_b16 v[228:229], v16 offset:45056
ds_read_b64_tr_b16 v[230:231], v16 offset:45568
v_mfma_f32_16x16x32_bf16 v[84:87], v[244:247], v[168:171], v[84:87]
ds_read_b64_tr_b16 v[232:233], v17 offset:45056
ds_read_b64_tr_b16 v[234:235], v17 offset:45568
v_mfma_f32_16x16x32_bf16 v[72:75], v[248:251], v[164:167], v[72:75]
s_add_u32 s57, s57, 2048
s_and_b32 s57, s57, 0x7fff
v_mfma_f32_16x16x32_bf16 v[88:91], v[248:251], v[168:171], v[88:91]
s_waitcnt vmcnt(6) lgkmcnt(8)
v_mfma_f32_16x16x32_bf16 v[60:63], v[100:103], v[172:175], v[60:63]
buffer_load_dwordx4 v[204:207], v38, s[32:35], s57 offen sc1
v_mfma_f32_16x16x32_bf16 v[76:79], v[100:103], v[176:179], v[76:79]
ds_read_b64_tr_b16 v[236:237], v14 offset:49152
ds_read_b64_tr_b16 v[238:239], v14 offset:49664
v_mfma_f32_16x16x32_bf16 v[64:67], v[104:107], v[172:175], v[64:67]
ds_read_b64_tr_b16 v[240:241], v15 offset:49152
ds_read_b64_tr_b16 v[242:243], v15 offset:49664
v_mfma_f32_16x16x32_bf16 v[80:83], v[104:107], v[176:179], v[80:83]
buffer_load_dwordx4 v[208:211], v39, s[32:35], s57 offen sc1
v_mfma_f32_16x16x32_bf16 v[68:71], v[108:111], v[172:175], v[68:71]
ds_read_b64_tr_b16 v[244:245], v16 offset:49152
ds_read_b64_tr_b16 v[246:247], v16 offset:49664
v_mfma_f32_16x16x32_bf16 v[84:87], v[108:111], v[176:179], v[84:87]
ds_read_b64_tr_b16 v[248:249], v17 offset:49152
ds_read_b64_tr_b16 v[250:251], v17 offset:49664
v_mfma_f32_16x16x32_bf16 v[72:75], v[112:115], v[172:175], v[72:75]
v_mfma_f32_16x16x32_bf16 v[88:91], v[112:115], v[176:179], v[88:91]
s_waitcnt vmcnt(6) lgkmcnt(8)
v_mfma_f32_16x16x32_bf16 v[60:63], v[220:223], v[180:183], v[60:63]
buffer_load_dwordx4 v[212:215], v38, s[32:35], s57 offen offset:1024 sc1
v_mfma_f32_16x16x32_bf16 v[76:79], v[220:223], v[184:187], v[76:79]
ds_read_b64_tr_b16 v[100:101], v14 offset:53248
ds_read_b64_tr_b16 v[102:103], v14 offset:53760
v_mfma_f32_16x16x32_bf16 v[64:67], v[224:227], v[180:183], v[64:67]
ds_read_b64_tr_b16 v[104:105], v15 offset:53248
ds_read_b64_tr_b16 v[106:107], v15 offset:53760
v_mfma_f32_16x16x32_bf16 v[80:83], v[224:227], v[184:187], v[80:83]
buffer_load_dwordx4 v[216:219], v39, s[32:35], s57 offen offset:1024 sc1
v_mfma_f32_16x16x32_bf16 v[68:71], v[228:231], v[180:183], v[68:71]
ds_read_b64_tr_b16 v[108:109], v16 offset:53248
ds_read_b64_tr_b16 v[110:111], v16 offset:53760
v_mfma_f32_16x16x32_bf16 v[84:87], v[228:231], v[184:187], v[84:87]
ds_read_b64_tr_b16 v[112:113], v17 offset:53248
ds_read_b64_tr_b16 v[114:115], v17 offset:53760
v_mfma_f32_16x16x32_bf16 v[72:75], v[232:235], v[180:183], v[72:75]
v_mfma_f32_16x16x32_bf16 v[88:91], v[232:235], v[184:187], v[88:91]
s_waitcnt vmcnt(6) lgkmcnt(8)
v_mfma_f32_16x16x32_bf16 v[60:63], v[236:239], v[188:191], v[60:63]
v_mfma_f32_16x16x32_bf16 v[76:79], v[236:239], v[192:195], v[76:79]
ds_read_b64_tr_b16 v[220:221], v14 offset:57344
ds_read_b64_tr_b16 v[222:223], v14 offset:57856
v_mfma_f32_16x16x32_bf16 v[64:67], v[240:243], v[188:191], v[64:67]
ds_read_b64_tr_b16 v[224:225], v15 offset:57344
ds_read_b64_tr_b16 v[226:227], v15 offset:57856
v_mfma_f32_16x16x32_bf16 v[80:83], v[240:243], v[192:195], v[80:83]
v_mfma_f32_16x16x32_bf16 v[68:71], v[244:247], v[188:191], v[68:71]
ds_read_b64_tr_b16 v[228:229], v16 offset:57344
ds_read_b64_tr_b16 v[230:231], v16 offset:57856
v_mfma_f32_16x16x32_bf16 v[84:87], v[244:247], v[192:195], v[84:87]
ds_read_b64_tr_b16 v[232:233], v17 offset:57344
ds_read_b64_tr_b16 v[234:235], v17 offset:57856
v_mfma_f32_16x16x32_bf16 v[72:75], v[248:251], v[188:191], v[72:75]
v_mfma_f32_16x16x32_bf16 v[88:91], v[248:251], v[192:195], v[88:91]
s_waitcnt vmcnt(4) lgkmcnt(8)
v_mfma_f32_16x16x32_bf16 v[60:63], v[100:103], v[196:199], v[60:63]
v_mfma_f32_16x16x32_bf16 v[76:79], v[100:103], v[200:203], v[76:79]
ds_read_b64_tr_b16 v[236:237], v14 offset:61440
ds_read_b64_tr_b16 v[238:239], v14 offset:61952
v_mfma_f32_16x16x32_bf16 v[64:67], v[104:107], v[196:199], v[64:67]
ds_read_b64_tr_b16 v[240:241], v15 offset:61440
ds_read_b64_tr_b16 v[242:243], v15 offset:61952
v_mfma_f32_16x16x32_bf16 v[80:83], v[104:107], v[200:203], v[80:83]
v_mfma_f32_16x16x32_bf16 v[68:71], v[108:111], v[196:199], v[68:71]
ds_read_b64_tr_b16 v[244:245], v16 offset:61440
ds_read_b64_tr_b16 v[246:247], v16 offset:61952
v_mfma_f32_16x16x32_bf16 v[84:87], v[108:111], v[200:203], v[84:87]
ds_read_b64_tr_b16 v[248:249], v17 offset:61440
ds_read_b64_tr_b16 v[250:251], v17 offset:61952
v_mfma_f32_16x16x32_bf16 v[72:75], v[112:115], v[196:199], v[72:75]
v_mfma_f32_16x16x32_bf16 v[88:91], v[112:115], v[200:203], v[88:91]
s_waitcnt vmcnt(2) lgkmcnt(8)
v_mfma_f32_16x16x32_bf16 v[60:63], v[220:223], v[204:207], v[60:63]
v_mfma_f32_16x16x32_bf16 v[76:79], v[220:223], v[208:211], v[76:79]
v_mfma_f32_16x16x32_bf16 v[64:67], v[224:227], v[204:207], v[64:67]
v_mfma_f32_16x16x32_bf16 v[80:83], v[224:227], v[208:211], v[80:83]
v_mfma_f32_16x16x32_bf16 v[68:71], v[228:231], v[204:207], v[68:71]
v_mfma_f32_16x16x32_bf16 v[84:87], v[228:231], v[208:211], v[84:87]
v_mfma_f32_16x16x32_bf16 v[72:75], v[232:235], v[204:207], v[72:75]
v_mfma_f32_16x16x32_bf16 v[88:91], v[232:235], v[208:211], v[88:91]
s_waitcnt vmcnt(0) lgkmcnt(0)
v_mfma_f32_16x16x32_bf16 v[60:63], v[236:239], v[212:215], v[60:63]
v_mfma_f32_16x16x32_bf16 v[64:67], v[240:243], v[212:215], v[64:67]
v_mfma_f32_16x16x32_bf16 v[68:71], v[244:247], v[212:215], v[68:71]
v_mfma_f32_16x16x32_bf16 v[72:75], v[248:251], v[212:215], v[72:75]
v_mfma_f32_16x16x32_bf16 v[76:79], v[236:239], v[216:219], v[76:79]
v_mfma_f32_16x16x32_bf16 v[80:83], v[240:243], v[216:219], v[80:83]
v_mfma_f32_16x16x32_bf16 v[84:87], v[244:247], v[216:219], v[84:87]
v_mfma_f32_16x16x32_bf16 v[88:91], v[248:251], v[216:219], v[88:91]
s_cmp_eq_u32 s46, 0
s_cbranch_scc1 slow_75
s_nop 0
v_cvt_pk_bf16_f32 v20, v60, v61
v_cvt_pk_bf16_f32 v21, v62, v63
v_cvt_pk_bf16_f32 v22, v64, v65
v_cvt_pk_bf16_f32 v23, v66, v67
buffer_store_dwordx4 v[20:23], v18, s[32:35], s85 offen offset:0
v_cvt_pk_bf16_f32 v24, v68, v69
v_cvt_pk_bf16_f32 v25, v70, v71
v_cvt_pk_bf16_f32 v26, v72, v73
v_cvt_pk_bf16_f32 v27, v74, v75
buffer_store_dwordx4 v[24:27], v18, s[32:35], s85 offen offset:1024
v_cvt_pk_bf16_f32 v28, v76, v77
v_cvt_pk_bf16_f32 v29, v78, v79
v_cvt_pk_bf16_f32 v30, v80, v81
v_cvt_pk_bf16_f32 v31, v82, v83
buffer_store_dwordx4 v[28:31], v18, s[32:35], s86 offen offset:0
v_cvt_pk_bf16_f32 v32, v84, v85
v_cvt_pk_bf16_f32 v33, v86, v87
v_cvt_pk_bf16_f32 v34, v88, v89
v_cvt_pk_bf16_f32 v35, v90, v91
buffer_store_dwordx4 v[32:35], v18, s[32:35], s86 offen offset:1024
s_barrier
v_dot2c_f32_bf16 v6, v20, v48
v_dot2c_f32_bf16 v8, v20, v20
v_dot2c_f32_bf16 v7, v28, v48
v_dot2c_f32_bf16 v9, v28, v28
v_dot2c_f32_bf16 v6, v21, v48
v_dot2c_f32_bf16 v8, v21, v21
v_dot2c_f32_bf16 v7, v29, v48
v_dot2c_f32_bf16 v9, v29, v29
v_dot2c_f32_bf16 v6, v22, v48
v_dot2c_f32_bf16 v8, v22, v22
v_dot2c_f32_bf16 v7, v30, v48
v_dot2c_f32_bf16 v9, v30, v30
v_dot2c_f32_bf16 v6, v23, v48
v_dot2c_f32_bf16 v8, v23, v23
v_dot2c_f32_bf16 v7, v31, v48
v_dot2c_f32_bf16 v9, v31, v31
v_dot2c_f32_bf16 v6, v24, v48
v_dot2c_f32_bf16 v8, v24, v24
v_dot2c_f32_bf16 v7, v32, v48
v_dot2c_f32_bf16 v9, v32, v32
v_dot2c_f32_bf16 v6, v25, v48
v_dot2c_f32_bf16 v8, v25, v25
v_dot2c_f32_bf16 v7, v33, v48
v_dot2c_f32_bf16 v9, v33, v33
v_dot2c_f32_bf16 v6, v26, v48
v_dot2c_f32_bf16 v8, v26, v26
v_dot2c_f32_bf16 v7, v34, v48
v_dot2c_f32_bf16 v9, v34, v34
v_dot2c_f32_bf16 v6, v27, v48
v_dot2c_f32_bf16 v8, v27, v27
v_dot2c_f32_bf16 v7, v35, v48
v_dot2c_f32_bf16 v9, v35, v35
s_mov_b64 exec, 1
s_waitcnt vmcnt(0)
buffer_store_dword v5, v4, s[32:35], s88 offen
s_mov_b64 exec, -1
s_nop 1
v_permlane32_swap_b32 v6, v7
v_permlane32_swap_b32 v8, v9
v_add_f32 v6, v6, v7
v_add_f32 v8, v8, v9
s_nop 1
v_permlane16_swap_b32 v6, v8
s_nop 0
v_add_f32 v6, v6, v8
buffer_store_dword v6, v1, s[32:35], s87 offen
back_76:
s_lshl_b32 s49, s44, 13
v_add_u32 v10, s49, v18
v_add_u32 v11, 1024, v10
s_lshl_b32 s48, s43, 1
v_lshrrev_b32 v4, 2, v2
v_and_b32 v5, 3, v0
v_lshl_add_u32 v6, v3, 3, v4
v_lshlrev_b32 v6, 7, v6
v_lshl_add_u32 v6, v5, 3, v6
v_lshrrev_b32 v7, 1, v4
v_and_b32 v8, 1, v3
v_lshl_add_u32 v7, v8, 1, v7
v_xor_b32 v7, s48, v7
v_lshl_add_u32 v12, v7, 5, v6
v_add_u32 v12, 16384, v12
v_xor_b32 v13, 32, v12
v_mov_b32 v14, v10
v_mov_b32 v15, v11
v_add_u32 v16, 122880, v12
v_add_u32 v17, 122880, v13
v_mov_b32 v156, 0
v_mov_b32 v157, 0
v_mov_b32 v158, 0
v_mov_b32 v159, 0
v_mov_b32 v160, 0
v_mov_b32 v161, 0
v_mov_b32 v162, 0
v_mov_b32 v163, 0
v_mov_b32 v164, 0
v_mov_b32 v165, 0
v_mov_b32 v166, 0
v_mov_b32 v167, 0
v_mov_b32 v168, 0
v_mov_b32 v169, 0
v_mov_b32 v170, 0
v_mov_b32 v171, 0
v_mov_b32 v172, 0
v_mov_b32 v173, 0
v_mov_b32 v174, 0
v_mov_b32 v175, 0
v_mov_b32 v176, 0
v_mov_b32 v177, 0
v_mov_b32 v178, 0
v_mov_b32 v179, 0
v_mov_b32 v180, 0
v_mov_b32 v181, 0
v_mov_b32 v182, 0
v_mov_b32 v183, 0
v_mov_b32 v184, 0
v_mov_b32 v185, 0
v_mov_b32 v186, 0
v_mov_b32 v187, 0
v_mov_b32 v188, 0
v_mov_b32 v189, 0
v_mov_b32 v190, 0
v_mov_b32 v191, 0
v_mov_b32 v192, 0
v_mov_b32 v193, 0
v_mov_b32 v194, 0
v_mov_b32 v195, 0
v_mov_b32 v196, 0
v_mov_b32 v197, 0
v_mov_b32 v198, 0
v_mov_b32 v199, 0
v_mov_b32 v200, 0
v_mov_b32 v201, 0
v_mov_b32 v202, 0
v_mov_b32 v203, 0
v_mov_b32 v204, 0
v_mov_b32 v205, 0
v_mov_b32 v206, 0
v_mov_b32 v207, 0
v_mov_b32 v208, 0
v_mov_b32 v209, 0
v_mov_b32 v210, 0
v_mov_b32 v211, 0
v_mov_b32 v212, 0
v_mov_b32 v213, 0
v_mov_b32 v214, 0
v_mov_b32 v215, 0
v_mov_b32 v216, 0
v_mov_b32 v217, 0
v_mov_b32 v218, 0
v_mov_b32 v219, 0
v_mov_b32 v220, 0
v_mov_b32 v221, 0
v_mov_b32 v222, 0
v_mov_b32 v223, 0
v_mov_b32 v224, 0
v_mov_b32 v225, 0
v_mov_b32 v226, 0
v_mov_b32 v227, 0
v_mov_b32 v228, 0
v_mov_b32 v229, 0
v_mov_b32 v230, 0
v_mov_b32 v231, 0
v_mov_b32 v232, 0
v_mov_b32 v233, 0
v_mov_b32 v234, 0
v_mov_b32 v235, 0
v_mov_b32 v236, 0
v_mov_b32 v237, 0
v_mov_b32 v238, 0
v_mov_b32 v239, 0
v_mov_b32 v240, 0
v_mov_b32 v241, 0
v_mov_b32 v242, 0
v_mov_b32 v243, 0
v_mov_b32 v244, 0
v_mov_b32 v245, 0
v_mov_b32 v246, 0
v_mov_b32 v247, 0
v_mov_b32 v248, 0
v_mov_b32 v249, 0
v_mov_b32 v250, 0
v_mov_b32 v251, 0
s_mov_b32 s48, 0xf149f2ca
v_mov_b32 v9, s48
v_lshlrev_b32 v4, 2, v3
v_sub_u32 v4, v2, v4
v_subrev_u32 v5, 0, v4
v_and_b32 v6, 0x80000001, v5
v_cmp_eq_u32 vcc, 0, v6
v_add_u32 v5, 1, v5
v_and_b32 v6, 0x80000001, v5
v_cndmask_b32 v40, v9, 0, vcc
v_cmp_eq_u32 vcc, 0x80000001, v6
s_nop 1
v_cndmask_b32 v36, v9, 0, vcc
v_subrev_u32 v5, 1, v4
v_and_b32 v6, 0x80000001, v5
v_cmp_eq_u32 vcc, 0, v6
v_add_u32 v5, 1, v5
v_and_b32 v6, 0x80000001, v5
v_cndmask_b32 v41, v9, 0, vcc
v_cmp_eq_u32 vcc, 0x80000001, v6
s_nop 1
v_cndmask_b32 v37, v9, 0, vcc
v_subrev_u32 v5, 2, v4
v_and_b32 v6, 0x80000001, v5
v_cmp_eq_u32 vcc, 0, v6
v_add_u32 v5, 1, v5
v_and_b32 v6, 0x80000001, v5
v_cndmask_b32 v42, v9, 0, vcc
v_cmp_eq_u32 vcc, 0x80000001, v6
s_nop 1
v_cndmask_b32 v38, v9, 0, vcc
v_subrev_u32 v5, 3, v4
v_and_b32 v6, 0x80000001, v5
v_cmp_eq_u32 vcc, 0, v6
v_add_u32 v5, 1, v5
v_and_b32 v6, 0x80000001, v5
v_cndmask_b32 v43, v9, 0, vcc
v_cmp_eq_u32 vcc, 0x80000001, v6
s_nop 1
v_cndmask_b32 v39, v9, 0, vcc
s_or_b32 s48, s41, s44
s_cmp_eq_u32 s48, 0
s_cselect_b64 vcc, -1, 0
v_cndmask_b32 v44, v36, v9, vcc
v_cndmask_b32 v45, v37, v9, vcc
v_cndmask_b32 v46, v38, v9, vcc
v_cndmask_b32 v47, v39, v9, vcc
v_and_b32 v4, 1, v2
v_lshlrev_b32 v4, 4, v4
v_mov_b32 v5, 0xffff
v_lshlrev_b32 v52, v4, v5
s_lshl_b32 s48, s43, 11
s_add_u32 s48, s48, 135168
v_add_u32 v53, s48, v18
v_lshl_add_u32 v55, v0, 3, s48
s_add_u32 s48, s41, s44
s_sub_u32 s48, s48, 1
s_lshl_b32 s49, s48, 1
s_add_u32 s49, s49, s43
s_lshl_b32 s49, s49, 11
s_mul_i32 s50, s42, 393216
s_add_u32 s49, s49, s50
s_add_u32 s49, s49, 9699328
s_cmp_lt_i32 s48, 0
s_cselect_b32 s49, 0xf0000000, s49
v_add_u32 v58, s49, v18
v_lshl_add_u32 v59, v0, 3, s49
s_lshl_b32 s48, s43, 2
s_add_u32 s48, s48, 134672
v_mov_b32 v19, s48
s_lshl_b32 s48, s43, 7
s_add_u32 s48, s48, 133120
v_lshl_add_u32 v7, v3, 4, s48
v_lshl_add_u32 v54, v2, 2, s48
s_lshl_b32 s49, s44, 6
v_add_u32 v8, s49, v2
v_lshlrev_b32 v8, 3, v8
v_add_u32 v8, 131072, v8
v_lshl_add_u32 v9, v3, 2, s49
v_lshlrev_b32 v9, 2, v9
v_add_u32 v9, 132096, v9
s_mov_b32 s64, 0
s_mov_b32 s65, 0
s_mov_b32 s66, 0x3e8293ee
s_barrier
ds_read_b128 v[60:63], v14 offset:0
ds_read_b128 v[64:67], v14 offset:2048
ds_read_b128 v[68:71], v14 offset:4096
ds_read_b128 v[72:75], v14 offset:6144
ds_read_b64_tr_b16 v[84:85], v16 offset:8192
ds_read_b64_tr_b16 v[86:87], v16 offset:8704
ds_read_b64_tr_b16 v[88:89], v17 offset:8192
ds_read_b64_tr_b16 v[90:91], v17 offset:8704
ds_read_b64_tr_b16 v[92:93], v16 offset:16384
ds_read_b64_tr_b16 v[94:95], v16 offset:16896
ds_read_b64_tr_b16 v[96:97], v17 offset:16384
ds_read_b64_tr_b16 v[98:99], v17 offset:16896
ds_read_b64_tr_b16 v[76:77], v16 offset:0
ds_read_b64_tr_b16 v[78:79], v16 offset:512
ds_read_b64_tr_b16 v[80:81], v17 offset:0
ds_read_b64_tr_b16 v[82:83], v17 offset:512
s_waitcnt lgkmcnt(0)
c2_loop:
v_mfma_f32_16x16x32_bf16 v[212:215], v[84:87], v[72:75], v[212:215]
ds_read_b128 v[100:103], v15 offset:0
v_mfma_f32_16x16x32_bf16 v[204:207], v[84:87], v[68:71], v[204:207]
ds_read_b128 v[104:107], v15 offset:2048
v_mfma_f32_16x16x32_bf16 v[196:199], v[84:87], v[64:67], v[196:199]
ds_read_b128 v[108:111], v15 offset:4096
v_mfma_f32_16x16x32_bf16 v[188:191], v[84:87], v[60:63], v[188:191]
ds_read_b128 v[112:115], v15 offset:6144
v_mfma_f32_16x16x32_bf16 v[192:195], v[88:91], v[60:63], v[192:195]
ds_read_b64_tr_b16 v[124:125], v16 offset:12288
v_mfma_f32_16x16x32_bf16 v[200:203], v[88:91], v[64:67], v[200:203]
ds_read_b64_tr_b16 v[126:127], v16 offset:12800
v_mfma_f32_16x16x32_bf16 v[208:211], v[88:91], v[68:71], v[208:211]
ds_read_b64_tr_b16 v[128:129], v17 offset:12288
v_mfma_f32_16x16x32_bf16 v[216:219], v[88:91], v[72:75], v[216:219]
ds_read_b64_tr_b16 v[130:131], v17 offset:12800
v_mfma_f32_16x16x32_bf16 v[244:247], v[72:75], v[92:95], v[244:247]
ds_read_b64_tr_b16 v[132:133], v16 offset:20480
v_mfma_f32_16x16x32_bf16 v[236:239], v[68:71], v[92:95], v[236:239]
ds_read_b64_tr_b16 v[134:135], v16 offset:20992
v_mfma_f32_16x16x32_bf16 v[228:231], v[64:67], v[92:95], v[228:231]
ds_read_b64_tr_b16 v[136:137], v17 offset:20480
v_mfma_f32_16x16x32_bf16 v[220:223], v[60:63], v[92:95], v[220:223]
ds_read_b64_tr_b16 v[138:139], v17 offset:20992
v_mfma_f32_16x16x32_bf16 v[224:227], v[60:63], v[96:99], v[224:227]
ds_read_b64_tr_b16 v[116:117], v16 offset:4096
v_mfma_f32_16x16x32_bf16 v[232:235], v[64:67], v[96:99], v[232:235]
ds_read_b64_tr_b16 v[118:119], v16 offset:4608
v_mfma_f32_16x16x32_bf16 v[240:243], v[68:71], v[96:99], v[240:243]
ds_read_b64_tr_b16 v[120:121], v17 offset:4096
v_mfma_f32_16x16x32_bf16 v[248:251], v[72:75], v[96:99], v[248:251]
ds_read_b64_tr_b16 v[122:123], v17 offset:4608
v_mfma_f32_16x16x32_bf16 v[180:183], v[76:79], v[72:75], v[180:183]
s_add_u32 s65, s65, 40960
s_cmp_eq_u32 s65, 122880
v_mfma_f32_16x16x32_bf16 v[172:175], v[76:79], v[68:71], v[172:175]
s_cselect_b32 s65, 0, s65
s_add_u32 s64, s64, 1
v_mfma_f32_16x16x32_bf16 v[164:167], v[76:79], v[64:67], v[164:167]
v_add_u32 v14, s65, v10
v_add_u32 v15, s65, v11
v_mfma_f32_16x16x32_bf16 v[156:159], v[76:79], v[60:63], v[156:159]
v_add_u32 v16, s65, v12
v_add_u32 v17, s65, v13
v_mfma_f32_16x16x32_bf16 v[160:163], v[80:83], v[60:63], v[160:163]
v_mfma_f32_16x16x32_bf16 v[168:171], v[80:83], v[64:67], v[168:171]
s_cmp_eq_u32 s64, 16
s_cbranch_scc1 c2_last
v_mfma_f32_16x16x32_bf16 v[176:179], v[80:83], v[68:71], v[176:179]
s_waitcnt lgkmcnt(0)
v_mfma_f32_16x16x32_bf16 v[184:187], v[80:83], v[72:75], v[184:187]
s_barrier
v_mfma_f32_16x16x32_bf16 v[212:215], v[124:127], v[112:115], v[212:215]
ds_read_b128 v[60:63], v14 offset:0
v_mfma_f32_16x16x32_bf16 v[204:207], v[124:127], v[108:111], v[204:207]
ds_read_b128 v[64:67], v14 offset:2048
v_mfma_f32_16x16x32_bf16 v[196:199], v[124:127], v[104:107], v[196:199]
ds_read_b128 v[68:71], v14 offset:4096
v_mfma_f32_16x16x32_bf16 v[188:191], v[124:127], v[100:103], v[188:191]
ds_read_b128 v[72:75], v14 offset:6144
v_mfma_f32_16x16x32_bf16 v[192:195], v[128:131], v[100:103], v[192:195]
ds_read_b64_tr_b16 v[84:85], v16 offset:8192
v_mfma_f32_16x16x32_bf16 v[200:203], v[128:131], v[104:107], v[200:203]
ds_read_b64_tr_b16 v[86:87], v16 offset:8704
v_mfma_f32_16x16x32_bf16 v[208:211], v[128:131], v[108:111], v[208:211]
ds_read_b64_tr_b16 v[88:89], v17 offset:8192
v_mfma_f32_16x16x32_bf16 v[216:219], v[128:131], v[112:115], v[216:219]
ds_read_b64_tr_b16 v[90:91], v17 offset:8704
v_mfma_f32_16x16x32_bf16 v[244:247], v[112:115], v[132:135], v[244:247]
ds_read_b64_tr_b16 v[92:93], v16 offset:16384
v_mfma_f32_16x16x32_bf16 v[236:239], v[108:111], v[132:135], v[236:239]
ds_read_b64_tr_b16 v[94:95], v16 offset:16896
v_mfma_f32_16x16x32_bf16 v[228:231], v[104:107], v[132:135], v[228:231]
ds_read_b64_tr_b16 v[96:97], v17 offset:16384
v_mfma_f32_16x16x32_bf16 v[220:223], v[100:103], v[132:135], v[220:223]
ds_read_b64_tr_b16 v[98:99], v17 offset:16896
v_mfma_f32_16x16x32_bf16 v[224:227], v[100:103], v[136:139], v[224:227]
ds_read_b64_tr_b16 v[76:77], v16 offset:0
v_mfma_f32_16x16x32_bf16 v[232:235], v[104:107], v[136:139], v[232:235]
ds_read_b64_tr_b16 v[78:79], v16 offset:512
v_mfma_f32_16x16x32_bf16 v[240:243], v[108:111], v[136:139], v[240:243]
ds_read_b64_tr_b16 v[80:81], v17 offset:0
v_mfma_f32_16x16x32_bf16 v[248:251], v[112:115], v[136:139], v[248:251]
ds_read_b64_tr_b16 v[82:83], v17 offset:512
v_mfma_f32_16x16x32_bf16 v[180:183], v[116:119], v[112:115], v[180:183]
v_mfma_f32_16x16x32_bf16 v[172:175], v[116:119], v[108:111], v[172:175]
v_mfma_f32_16x16x32_bf16 v[164:167], v[116:119], v[104:107], v[164:167]
v_mfma_f32_16x16x32_bf16 v[156:159], v[116:119], v[100:103], v[156:159]
v_mfma_f32_16x16x32_bf16 v[160:163], v[120:123], v[100:103], v[160:163]
v_mfma_f32_16x16x32_bf16 v[168:171], v[120:123], v[104:107], v[168:171]
v_mfma_f32_16x16x32_bf16 v[176:179], v[120:123], v[108:111], v[176:179]
s_waitcnt lgkmcnt(0)
v_mfma_f32_16x16x32_bf16 v[184:187], v[120:123], v[112:115], v[184:187]
s_branch c2_loop
c2_last:
v_mfma_f32_16x16x32_bf16 v[176:179], v[80:83], v[68:71], v[176:179]
s_waitcnt lgkmcnt(0)
v_mfma_f32_16x16x32_bf16 v[184:187], v[80:83], v[72:75], v[184:187]
s_barrier
v_mfma_f32_16x16x32_bf16 v[212:215], v[124:127], v[112:115], v[212:215]
ds_read_b128 v[140:143], v7 offset:0
v_mfma_f32_16x16x32_bf16 v[204:207], v[124:127], v[108:111], v[204:207]
ds_read_b128 v[144:147], v7 offset:64
v_mfma_f32_16x16x32_bf16 v[196:199], v[124:127], v[104:107], v[196:199]
ds_read_b128 v[148:151], v7 offset:256
v_mfma_f32_16x16x32_bf16 v[188:191], v[124:127], v[100:103], v[188:191]
ds_read_b128 v[152:155], v7 offset:320
v_mfma_f32_16x16x32_bf16 v[192:195], v[128:131], v[100:103], v[192:195]
ds_read_b64 v[92:93], v8 offset:0
v_mfma_f32_16x16x32_bf16 v[200:203], v[128:131], v[104:107], v[200:203]
ds_read_b64 v[94:95], v8 offset:128
v_mfma_f32_16x16x32_bf16 v[208:211], v[128:131], v[108:111], v[208:211]
ds_read_b64 v[96:97], v8 offset:256
v_mfma_f32_16x16x32_bf16 v[216:219], v[128:131], v[112:115], v[216:219]
ds_read_b64 v[98:99], v8 offset:384
v_mfma_f32_16x16x32_bf16 v[244:247], v[112:115], v[132:135], v[244:247]
ds_read2_b32 v[56:57], v54 offset0:128 offset1:144
v_mfma_f32_16x16x32_bf16 v[236:239], v[108:111], v[132:135], v[236:239]
ds_read_b128 v[60:63], v9 offset:0
v_mfma_f32_16x16x32_bf16 v[228:231], v[104:107], v[132:135], v[228:231]
ds_read_b128 v[64:67], v9 offset:64
v_mfma_f32_16x16x32_bf16 v[220:223], v[100:103], v[132:135], v[220:223]
ds_read_b128 v[68:71], v9 offset:128
v_mfma_f32_16x16x32_bf16 v[224:227], v[100:103], v[136:139], v[224:227]
ds_read_b128 v[72:75], v9 offset:192
v_mfma_f32_16x16x32_bf16 v[232:235], v[104:107], v[136:139], v[232:235]
ds_read_b128 v[76:79], v9 offset:512
v_mfma_f32_16x16x32_bf16 v[240:243], v[108:111], v[136:139], v[240:243]
ds_read_b128 v[80:83], v9 offset:576
v_mfma_f32_16x16x32_bf16 v[248:251], v[112:115], v[136:139], v[248:251]
ds_read_b128 v[84:87], v9 offset:640
v_mfma_f32_16x16x32_bf16 v[180:183], v[116:119], v[112:115], v[180:183]
ds_read_b128 v[88:91], v9 offset:704
v_mfma_f32_16x16x32_bf16 v[172:175], v[116:119], v[108:111], v[172:175]
v_mfma_f32_16x16x32_bf16 v[164:167], v[116:119], v[104:107], v[164:167]
v_mfma_f32_16x16x32_bf16 v[156:159], v[116:119], v[100:103], v[156:159]
v_mfma_f32_16x16x32_bf16 v[160:163], v[120:123], v[100:103], v[160:163]
v_mfma_f32_16x16x32_bf16 v[168:171], v[120:123], v[104:107], v[168:171]
v_mfma_f32_16x16x32_bf16 v[176:179], v[120:123], v[108:111], v[176:179]
v_mfma_f32_16x16x32_bf16 v[184:187], v[120:123], v[112:115], v[184:187]
c2_epi:
s_waitcnt lgkmcnt(0)
.p2align 3
v_pk_fma_f32 v[212:213], v[148:149], v[98:99], v[212:213] op_sel:[0,1,0] op_sel_hi:[1,1,1]
v_pk_fma_f32 v[214:215], v[150:151], v[98:99], v[214:215] op_sel:[0,1,0] op_sel_hi:[1,1,1]
v_pk_fma_f32 v[216:217], v[152:153], v[98:99], v[216:217] op_sel:[0,1,0] op_sel_hi:[1,1,1]
v_pk_fma_f32 v[218:219], v[154:155], v[98:99], v[218:219] op_sel:[0,1,0] op_sel_hi:[1,1,1]
v_pk_mul_f32 v[212:213], v[212:213], v[98:99] op_sel:[0,0] op_sel_hi:[1,0]
v_pk_mul_f32 v[214:215], v[214:215], v[98:99] op_sel:[0,0] op_sel_hi:[1,0]
v_pk_mul_f32 v[216:217], v[216:217], v[98:99] op_sel:[0,0] op_sel_hi:[1,0]
v_pk_mul_f32 v[218:219], v[218:219], v[98:99] op_sel:[0,0] op_sel_hi:[1,0]
v_cvt_pk_bf16_f32 v212, v212, v213
v_cvt_pk_bf16_f32 v213, v214, v215
v_cvt_pk_bf16_f32 v214, v216, v217
v_cvt_pk_bf16_f32 v215, v218, v219
v_pk_fma_f32 v[244:245], v[88:89], v[56:57], v[244:245] op_sel:[0,0,0] op_sel_hi:[1,0,1]
v_pk_fma_f32 v[246:247], v[90:91], v[56:57], v[246:247] op_sel:[0,0,0] op_sel_hi:[1,0,1]
v_pk_mul_f32 v[244:245], v[244:245], v[72:73]
v_pk_mul_f32 v[246:247], v[246:247], v[74:75]
v_cvt_pk_bf16_f32 v108, v244, v245
v_cvt_pk_bf16_f32 v109, v246, v247
v_pk_fma_f32 v[248:249], v[88:89], v[56:57], v[248:249] op_sel:[0,1,0] op_sel_hi:[1,1,1]
v_pk_fma_f32 v[250:251], v[90:91], v[56:57], v[250:251] op_sel:[0,1,0] op_sel_hi:[1,1,1]
v_pk_mul_f32 v[248:249], v[248:249], v[72:73]
v_pk_mul_f32 v[250:251], v[250:251], v[74:75]
v_cvt_pk_bf16_f32 v118, v248, v249
v_cvt_pk_bf16_f32 v119, v250, v251
s_cmp_lg_u32 s44, 1
s_cbranch_scc1 else_77
buffer_store_dwordx4 v[212:215], v58, s[32:35], 0 offen sc1
buffer_store_dwordx2 v[108:109], v59, s[32:35], 0 offen offset:1024 sc1
buffer_store_dwordx2 v[118:119], v59, s[32:35], 0 offen offset:1536 sc1
s_branch fi_78
else_77:
ds_write_b128 v53, v[212:215]
ds_write_b64 v55, v[108:109] offset:1024
ds_write_b64 v55, v[118:119] offset:1536
v_mov_b32 v4, 3
ds_write_b32 v19, v4
fi_78:
v_mul_f32 v124, s66, v92
v_mul_f32 v125, s66, v94
v_mul_f32 v126, s66, v96
v_mul_f32 v127, s66, v98
.p2align 3
v_pk_fma_f32 v[156:157], v[140:141], v[92:93], v[156:157] op_sel:[0,1,0] op_sel_hi:[1,1,1]
v_pk_fma_f32 v[158:159], v[142:143], v[92:93], v[158:159] op_sel:[0,1,0] op_sel_hi:[1,1,1]
v_pk_fma_f32 v[160:161], v[144:145], v[92:93], v[160:161] op_sel:[0,1,0] op_sel_hi:[1,1,1]
v_pk_fma_f32 v[162:163], v[146:147], v[92:93], v[162:163] op_sel:[0,1,0] op_sel_hi:[1,1,1]
v_cvt_pk_bf16_f32 v156, v156, v157
v_cvt_pk_bf16_f32 v157, v158, v159
v_cvt_pk_bf16_f32 v158, v160, v161
v_cvt_pk_bf16_f32 v159, v162, v163
v_pk_fma_f32 v[164:165], v[140:141], v[94:95], v[164:165] op_sel:[0,1,0] op_sel_hi:[1,1,1]
v_pk_fma_f32 v[166:167], v[142:143], v[94:95], v[166:167] op_sel:[0,1,0] op_sel_hi:[1,1,1]
v_pk_fma_f32 v[168:169], v[144:145], v[94:95], v[168:169] op_sel:[0,1,0] op_sel_hi:[1,1,1]
v_pk_fma_f32 v[170:171], v[146:147], v[94:95], v[170:171] op_sel:[0,1,0] op_sel_hi:[1,1,1]
v_cvt_pk_bf16_f32 v164, v164, v165
v_cvt_pk_bf16_f32 v165, v166, v167
v_cvt_pk_bf16_f32 v166, v168, v169
v_cvt_pk_bf16_f32 v167, v170, v171
v_pk_fma_f32 v[172:173], v[140:141], v[96:97], v[172:173] op_sel:[0,1,0] op_sel_hi:[1,1,1]
v_pk_fma_f32 v[174:175], v[142:143], v[96:97], v[174:175] op_sel:[0,1,0] op_sel_hi:[1,1,1]
v_pk_fma_f32 v[176:177], v[144:145], v[96:97], v[176:177] op_sel:[0,1,0] op_sel_hi:[1,1,1]
v_pk_fma_f32 v[178:179], v[146:147], v[96:97], v[178:179] op_sel:[0,1,0] op_sel_hi:[1,1,1]
v_cvt_pk_bf16_f32 v172, v172, v173
v_cvt_pk_bf16_f32 v173, v174, v175
v_cvt_pk_bf16_f32 v174, v176, v177
v_cvt_pk_bf16_f32 v175, v178, v179
v_pk_fma_f32 v[180:181], v[140:141], v[98:99], v[180:181] op_sel:[0,1,0] op_sel_hi:[1,1,1]
v_pk_fma_f32 v[182:183], v[142:143], v[98:99], v[182:183] op_sel:[0,1,0] op_sel_hi:[1,1,1]
v_pk_fma_f32 v[184:185], v[144:145], v[98:99], v[184:185] op_sel:[0,1,0] op_sel_hi:[1,1,1]
v_pk_fma_f32 v[186:187], v[146:147], v[98:99], v[186:187] op_sel:[0,1,0] op_sel_hi:[1,1,1]
v_cvt_pk_bf16_f32 v180, v180, v181
v_cvt_pk_bf16_f32 v181, v182, v183
v_cvt_pk_bf16_f32 v182, v184, v185
v_cvt_pk_bf16_f32 v183, v186, v187
v_pk_fma_f32 v[188:189], v[148:149], v[92:93], v[188:189] op_sel:[0,1,0] op_sel_hi:[1,1,1]
v_pk_fma_f32 v[190:191], v[150:151], v[92:93], v[190:191] op_sel:[0,1,0] op_sel_hi:[1,1,1]
v_pk_fma_f32 v[192:193], v[152:153], v[92:93], v[192:193] op_sel:[0,1,0] op_sel_hi:[1,1,1]
v_pk_fma_f32 v[194:195], v[154:155], v[92:93], v[194:195] op_sel:[0,1,0] op_sel_hi:[1,1,1]
v_pk_mul_f32 v[188:189], v[188:189], v[92:93] op_sel:[0,0] op_sel_hi:[1,0]
v_pk_mul_f32 v[190:191], v[190:191], v[92:93] op_sel:[0,0] op_sel_hi:[1,0]
v_pk_mul_f32 v[192:193], v[192:193], v[92:93] op_sel:[0,0] op_sel_hi:[1,0]
v_pk_mul_f32 v[194:195], v[194:195], v[92:93] op_sel:[0,0] op_sel_hi:[1,0]
v_cvt_pk_bf16_f32 v188, v188, v189
v_cvt_pk_bf16_f32 v189, v190, v191
v_cvt_pk_bf16_f32 v190, v192, v193
v_cvt_pk_bf16_f32 v191, v194, v195
v_pk_fma_f32 v[196:197], v[148:149], v[94:95], v[196:197] op_sel:[0,1,0] op_sel_hi:[1,1,1]
v_pk_fma_f32 v[198:199], v[150:151], v[94:95], v[198:199] op_sel:[0,1,0] op_sel_hi:[1,1,1]
v_pk_fma_f32 v[200:201], v[152:153], v[94:95], v[200:201] op_sel:[0,1,0] op_sel_hi:[1,1,1]
v_pk_fma_f32 v[202:203], v[154:155], v[94:95], v[202:203] op_sel:[0,1,0] op_sel_hi:[1,1,1]
v_pk_mul_f32 v[196:197], v[196:197], v[94:95] op_sel:[0,0] op_sel_hi:[1,0]
v_pk_mul_f32 v[198:199], v[198:199], v[94:95] op_sel:[0,0] op_sel_hi:[1,0]
v_pk_mul_f32 v[200:201], v[200:201], v[94:95] op_sel:[0,0] op_sel_hi:[1,0]
v_pk_mul_f32 v[202:203], v[202:203], v[94:95] op_sel:[0,0] op_sel_hi:[1,0]
v_cvt_pk_bf16_f32 v196, v196, v197
v_cvt_pk_bf16_f32 v197, v198, v199
v_cvt_pk_bf16_f32 v198, v200, v201
v_cvt_pk_bf16_f32 v199, v202, v203
v_pk_fma_f32 v[204:205], v[148:149], v[96:97], v[204:205] op_sel:[0,1,0] op_sel_hi:[1,1,1]
v_pk_fma_f32 v[206:207], v[150:151], v[96:97], v[206:207] op_sel:[0,1,0] op_sel_hi:[1,1,1]
v_pk_fma_f32 v[208:209], v[152:153], v[96:97], v[208:209] op_sel:[0,1,0] op_sel_hi:[1,1,1]
v_pk_fma_f32 v[210:211], v[154:155], v[96:97], v[210:211] op_sel:[0,1,0] op_sel_hi:[1,1,1]
v_pk_mul_f32 v[204:205], v[204:205], v[96:97] op_sel:[0,0] op_sel_hi:[1,0]
v_pk_mul_f32 v[206:207], v[206:207], v[96:97] op_sel:[0,0] op_sel_hi:[1,0]
v_pk_mul_f32 v[208:209], v[208:209], v[96:97] op_sel:[0,0] op_sel_hi:[1,0]
v_pk_mul_f32 v[210:211], v[210:211], v[96:97] op_sel:[0,0] op_sel_hi:[1,0]
v_cvt_pk_bf16_f32 v204, v204, v205
v_cvt_pk_bf16_f32 v205, v206, v207
v_cvt_pk_bf16_f32 v206, v208, v209
v_cvt_pk_bf16_f32 v207, v210, v211
s_cmp_lg_u32 s44, 0
s_cbranch_scc1 else_79
buffer_load_dwordx4 v[120:123], v58, s[32:35], 0 offen sc1
buffer_load_dwordx2 v[100:101], v59, s[32:35], 0 offen offset:1024 sc1
buffer_load_dwordx2 v[110:111], v59, s[32:35], 0 offen offset:1536 sc1
else_79:
.p2align 3
v_mfma_f32_16x16x32_bf16 v[216:219], v[212:215], v[180:183], v[40:43]
v_pk_fma_f32 v[220:221], v[76:77], v[56:57], v[220:221] op_sel:[0,0,0] op_sel_hi:[1,0,1]
v_pk_fma_f32 v[222:223], v[78:79], v[56:57], v[222:223] op_sel:[0,0,0] op_sel_hi:[1,0,1]
v_pk_mul_f32 v[220:221], v[220:221], v[60:61]
v_pk_mul_f32 v[222:223], v[222:223], v[62:63]
v_cvt_pk_bf16_f32 v102, v220, v221
v_mfma_f32_16x16x32_bf16 v[192:195], v[188:191], v[156:159], v[40:43]
v_cvt_pk_bf16_f32 v103, v222, v223
v_pk_fma_f32 v[224:225], v[76:77], v[56:57], v[224:225] op_sel:[0,1,0] op_sel_hi:[1,1,1]
v_pk_fma_f32 v[226:227], v[78:79], v[56:57], v[226:227] op_sel:[0,1,0] op_sel_hi:[1,1,1]
v_pk_mul_f32 v[224:225], v[224:225], v[60:61]
v_pk_mul_f32 v[226:227], v[226:227], v[62:63]
v_cvt_pk_bf16_f32 v112, v224, v225
v_mfma_f32_16x16x32_bf16 v[168:171], v[188:191], v[164:167], v[36:39]
v_cvt_pk_bf16_f32 v113, v226, v227
v_pk_fma_f32 v[228:229], v[80:81], v[56:57], v[228:229] op_sel:[0,0,0] op_sel_hi:[1,0,1]
v_pk_fma_f32 v[230:231], v[82:83], v[56:57], v[230:231] op_sel:[0,0,0] op_sel_hi:[1,0,1]
v_pk_mul_f32 v[228:229], v[228:229], v[64:65]
v_pk_mul_f32 v[230:231], v[230:231], v[66:67]
v_cvt_pk_bf16_f32 v104, v228, v229
v_mfma_f32_16x16x32_bf16 v[200:203], v[196:199], v[164:167], v[40:43]
v_cvt_pk_bf16_f32 v105, v230, v231
v_pk_fma_f32 v[232:233], v[80:81], v[56:57], v[232:233] op_sel:[0,1,0] op_sel_hi:[1,1,1]
v_pk_fma_f32 v[234:235], v[82:83], v[56:57], v[234:235] op_sel:[0,1,0] op_sel_hi:[1,1,1]
v_pk_mul_f32 v[232:233], v[232:233], v[64:65]
v_pk_mul_f32 v[234:235], v[234:235], v[66:67]
v_cvt_pk_bf16_f32 v114, v232, v233
v_mfma_f32_16x16x32_bf16 v[176:179], v[196:199], v[172:175], v[36:39]
v_cvt_pk_bf16_f32 v115, v234, v235
v_pk_fma_f32 v[236:237], v[84:85], v[56:57], v[236:237] op_sel:[0,0,0] op_sel_hi:[1,0,1]
v_pk_fma_f32 v[238:239], v[86:87], v[56:57], v[238:239] op_sel:[0,0,0] op_sel_hi:[1,0,1]
v_pk_mul_f32 v[236:237], v[236:237], v[68:69]
v_pk_mul_f32 v[238:239], v[238:239], v[70:71]
v_cvt_pk_bf16_f32 v106, v236, v237
v_mfma_f32_16x16x32_bf16 v[208:211], v[204:207], v[172:175], v[40:43]
v_cvt_pk_bf16_f32 v107, v238, v239
v_pk_fma_f32 v[240:241], v[84:85], v[56:57], v[240:241] op_sel:[0,1,0] op_sel_hi:[1,1,1]
v_pk_fma_f32 v[242:243], v[86:87], v[56:57], v[242:243] op_sel:[0,1,0] op_sel_hi:[1,1,1]
v_pk_mul_f32 v[240:241], v[240:241], v[68:69]
v_pk_mul_f32 v[242:243], v[242:243], v[70:71]
v_cvt_pk_bf16_f32 v116, v240, v241
v_mfma_f32_16x16x32_bf16 v[184:187], v[204:207], v[180:183], v[36:39]
v_cvt_pk_bf16_f32 v117, v242, v243
v_max_f32 v166, v200, v201
v_max_f32 v167, v202, v203
v_max_f32 v164, v168, v169
v_max_f32 v165, v170, v171
v_max3_f32 v129, v164, v165, v166
v_max_f32 v129, v129, v167
s_cmp_lg_u32 s44, 0
s_cbranch_scc1 else_81
s_mov_b32 s63, 0
sent_83:
s_waitcnt vmcnt(0)
v_max_u32 v4, v120, v121
v_max3_u32 v4, v4, v122, v123
v_max3_u32 v4, v4, v100, v101
v_max3_u32 v4, v4, v110, v111
v_cmp_eq_u32 vcc, -1, v4
s_cbranch_vccz sentd_84
buffer_load_dwordx4 v[120:123], v58, s[32:35], 0 offen sc1
buffer_load_dwordx2 v[100:101], v59, s[32:35], 0 offen offset:1024 sc1
buffer_load_dwordx2 v[110:111], v59, s[32:35], 0 offen offset:1536 sc1
s_add_u32 s63, s63, 1
s_cmp_lt_u32 s63, 0x80000
s_cbranch_scc1 sent_83
s_waitcnt vmcnt(0)
sentd_84:
s_branch fi_82
else_81:
s_mov_b32 s63, 0
px_85:
ds_read_b32 v4, v19
ds_read_b128 v[120:123], v53
ds_read_b64 v[100:101], v55 offset:1024
ds_read_b64 v[110:111], v55 offset:1536
s_add_u32 s63, s63, 1
s_cmp_lt_u32 s63, 0x400000
s_waitcnt lgkmcnt(0)
v_cmp_ne_u32 vcc, 3, v4
s_cbranch_vccz pxd_86
s_cbranch_scc1 px_85
pxd_86:
fi_82:
v_mfma_f32_16x16x32_bf16 v[160:163], v[120:123], v[156:159], v[44:47]
v_max_f32 v174, v208, v209
v_max_f32 v175, v210, v211
v_max_f32 v172, v176, v177
v_max_f32 v173, v178, v179
v_max3_f32 v130, v172, v173, v174
v_max_f32 v130, v130, v175
v_max_f32 v182, v216, v217
v_max_f32 v183, v218, v219
v_max_f32 v180, v184, v185
v_max_f32 v181, v186, v187
v_max3_f32 v131, v180, v181, v182
v_max_f32 v131, v131, v183
v_max_f32 v158, v192, v193
v_max_f32 v159, v194, v195
v_max_f32 v156, v160, v161
v_max_f32 v157, v162, v163
v_max3_f32 v128, v156, v157, v158
v_max_f32 v128, v128, v159
s_nop 1
v_permlane32_swap_b32 v128, v129
v_permlane32_swap_b32 v130, v131
v_max_f32 v128, v128, v129
v_max_f32 v130, v130, v131
s_nop 1
v_permlane16_swap_b32 v128, v130
s_nop 0
v_max_f32 v128, v128, v130
v_mov_b32 v130, v128
s_nop 1
v_permlane16_swap_b32 v128, v130
s_nop 0
v_mov_b32 v129, v128
v_mov_b32 v131, v130
s_nop 0
v_permlane32_swap_b32 v128, v129
v_permlane32_swap_b32 v130, v131
v_pk_mul_f32 v[128:129], v[128:129], v[124:125]
v_pk_mul_f32 v[130:131], v[130:131], v[126:127]
v_pk_fma_f32 v[156:157], v[156:157], v[124:125], v[128:129] op_sel:[0,0,0] op_sel_hi:[1,0,0] neg_lo:[0,0,1] neg_hi:[0,0,1]
v_pk_fma_f32 v[158:159], v[158:159], v[124:125], v[128:129] op_sel:[0,0,0] op_sel_hi:[1,0,0] neg_lo:[0,0,1] neg_hi:[0,0,1]
v_exp_f32 v156, v156
v_exp_f32 v157, v157
v_exp_f32 v158, v158
v_exp_f32 v159, v159
v_cvt_pk_bf16_f32 v156, v156, v156
v_cvt_pk_bf16_f32 v157, v157, v157
v_cvt_pk_bf16_f32 v158, v158, v158
v_cvt_pk_bf16_f32 v159, v159, v159
v_and_b32 v156, v52, v156
v_and_b32 v157, v52, v157
v_and_b32 v158, v52, v158
v_and_b32 v159, v52, v159
v_pk_fma_f32 v[164:165], v[164:165], v[124:125], v[128:129] op_sel:[0,1,1] op_sel_hi:[1,1,1] neg_lo:[0,0,1] neg_hi:[0,0,1]
v_pk_fma_f32 v[166:167], v[166:167], v[124:125], v[128:129] op_sel:[0,1,1] op_sel_hi:[1,1,1] neg_lo:[0,0,1] neg_hi:[0,0,1]
v_exp_f32 v164, v164
v_mfma_f32_16x16x32_bf16 v[160:163], v[48:51], v[156:159], 0
v_exp_f32 v165, v165
v_exp_f32 v166, v166
v_exp_f32 v167, v167
v_cvt_pk_bf16_f32 v164, v164, v164
v_mfma_f32_16x16x32_bf16 v[220:223], v[100:103], v[156:159], 0
v_cvt_pk_bf16_f32 v165, v165, v165
v_cvt_pk_bf16_f32 v166, v166, v166
v_cvt_pk_bf16_f32 v167, v167, v167
v_and_b32 v164, v52, v164
v_mfma_f32_16x16x32_bf16 v[224:227], v[110:113], v[156:159], 0
v_and_b32 v165, v52, v165
v_and_b32 v166, v52, v166
v_and_b32 v167, v52, v167
v_pk_fma_f32 v[172:173], v[172:173], v[126:127], v[130:131] op_sel:[0,0,0] op_sel_hi:[1,0,0] neg_lo:[0,0,1] neg_hi:[0,0,1]
v_pk_fma_f32 v[174:175], v[174:175], v[126:127], v[130:131] op_sel:[0,0,0] op_sel_hi:[1,0,0] neg_lo:[0,0,1] neg_hi:[0,0,1]
v_exp_f32 v172, v172
v_mfma_f32_16x16x32_bf16 v[168:171], v[48:51], v[164:167], 0
v_exp_f32 v173, v173
v_exp_f32 v174, v174
v_exp_f32 v175, v175
v_cvt_pk_bf16_f32 v172, v172, v172
v_mfma_f32_16x16x32_bf16 v[228:231], v[102:105], v[164:167], 0
v_cvt_pk_bf16_f32 v173, v173, v173
v_cvt_pk_bf16_f32 v174, v174, v174
v_cvt_pk_bf16_f32 v175, v175, v175
v_and_b32 v172, v52, v172
v_mfma_f32_16x16x32_bf16 v[232:235], v[112:115], v[164:167], 0
v_and_b32 v173, v52, v173
v_and_b32 v174, v52, v174
v_and_b32 v175, v52, v175
v_pk_fma_f32 v[180:181], v[180:181], v[126:127], v[130:131] op_sel:[0,1,1] op_sel_hi:[1,1,1] neg_lo:[0,0,1] neg_hi:[0,0,1]
v_pk_fma_f32 v[182:183], v[182:183], v[126:127], v[130:131] op_sel:[0,1,1] op_sel_hi:[1,1,1] neg_lo:[0,0,1] neg_hi:[0,0,1]
v_exp_f32 v180, v180
v_mfma_f32_16x16x32_bf16 v[176:179], v[48:51], v[172:175], 0
v_exp_f32 v181, v181
v_exp_f32 v182, v182
v_exp_f32 v183, v183
v_cvt_pk_bf16_f32 v180, v180, v180
v_mfma_f32_16x16x32_bf16 v[236:239], v[104:107], v[172:175], 0
v_cvt_pk_bf16_f32 v181, v181, v181
v_cvt_pk_bf16_f32 v182, v182, v182
v_cvt_pk_bf16_f32 v183, v183, v183
v_and_b32 v180, v52, v180
v_mfma_f32_16x16x32_bf16 v[240:243], v[114:117], v[172:175], 0
v_and_b32 v181, v52, v181
v_and_b32 v182, v52, v182
v_and_b32 v183, v52, v183
v_rcp_f32 v160, v160
v_rcp_f32 v168, v168
v_mfma_f32_16x16x32_bf16 v[184:187], v[48:51], v[180:183], 0
v_mfma_f32_16x16x32_bf16 v[244:247], v[106:109], v[180:183], 0
v_mfma_f32_16x16x32_bf16 v[248:251], v[116:119], v[180:183], 0
v_rcp_f32 v176, v176
s_nop 4
v_rcp_f32 v184, v184
s_cmp_eq_u32 s46, 0
s_cbranch_scc1 slow_87
.p2align 3
v_pk_mul_f32 v[220:221], v[220:221], v[160:161] op_sel:[0,0] op_sel_hi:[1,0]
v_pk_mul_f32 v[222:223], v[222:223], v[160:161] op_sel:[0,0] op_sel_hi:[1,0]
v_pk_mul_f32 v[224:225], v[224:225], v[160:161] op_sel:[0,0] op_sel_hi:[1,0]
v_pk_mul_f32 v[226:227], v[226:227], v[160:161] op_sel:[0,0] op_sel_hi:[1,0]
v_cvt_pk_bf16_f32 v220, v220, v221
v_cvt_pk_bf16_f32 v221, v222, v223
v_cvt_pk_bf16_f32 v222, v224, v225
v_cvt_pk_bf16_f32 v223, v226, v227
buffer_store_dwordx4 v[220:223], v18, s[32:35], s80 offen
v_pk_mul_f32 v[228:229], v[228:229], v[168:169] op_sel:[0,0] op_sel_hi:[1,0]
v_pk_mul_f32 v[230:231], v[230:231], v[168:169] op_sel:[0,0] op_sel_hi:[1,0]
v_pk_mul_f32 v[232:233], v[232:233], v[168:169] op_sel:[0,0] op_sel_hi:[1,0]
v_pk_mul_f32 v[234:235], v[234:235], v[168:169] op_sel:[0,0] op_sel_hi:[1,0]
v_cvt_pk_bf16_f32 v228, v228, v229
v_cvt_pk_bf16_f32 v229, v230, v231
v_cvt_pk_bf16_f32 v230, v232, v233
v_cvt_pk_bf16_f32 v231, v234, v235
buffer_store_dwordx4 v[228:231], v18, s[32:35], s81 offen
v_pk_mul_f32 v[236:237], v[236:237], v[176:177] op_sel:[0,0] op_sel_hi:[1,0]
v_pk_mul_f32 v[238:239], v[238:239], v[176:177] op_sel:[0,0] op_sel_hi:[1,0]
v_pk_mul_f32 v[240:241], v[240:241], v[176:177] op_sel:[0,0] op_sel_hi:[1,0]
v_pk_mul_f32 v[242:243], v[242:243], v[176:177] op_sel:[0,0] op_sel_hi:[1,0]
v_cvt_pk_bf16_f32 v236, v236, v237
v_cvt_pk_bf16_f32 v237, v238, v239
v_cvt_pk_bf16_f32 v238, v240, v241
v_cvt_pk_bf16_f32 v239, v242, v243
buffer_store_dwordx4 v[236:239], v18, s[32:35], s82 offen
v_pk_mul_f32 v[244:245], v[244:245], v[184:185] op_sel:[0,0] op_sel_hi:[1,0]
v_pk_mul_f32 v[246:247], v[246:247], v[184:185] op_sel:[0,0] op_sel_hi:[1,0]
v_pk_mul_f32 v[248:249], v[248:249], v[184:185] op_sel:[0,0] op_sel_hi:[1,0]
v_pk_mul_f32 v[250:251], v[250:251], v[184:185] op_sel:[0,0] op_sel_hi:[1,0]
v_cvt_pk_bf16_f32 v244, v244, v245
v_cvt_pk_bf16_f32 v245, v246, v247
v_cvt_pk_bf16_f32 v246, v248, v249
v_cvt_pk_bf16_f32 v247, v250, v251
buffer_store_dwordx4 v[244:247], v18, s[32:35], s83 offen
s_barrier
s_lshl_b32 s62, s45, 2
v_mov_b32 v4, s62
v_mov_b32 v5, 3
s_mov_b64 exec, 1
s_waitcnt vmcnt(0)
buffer_store_dword v5, v4, s[32:35], s84 offen
s_mov_b64 exec, -1
back_88:
v_and_b32 v36, 31, v0
v_lshlrev_b32 v36, 2, v36
buffer_load_dword v37, v36, s[32:35], s84 offen sc1
v_lshrrev_b32 v4, 2, v2
v_and_b32 v5, 3, v0
v_lshl_add_u32 v6, v3, 3, v4
v_lshlrev_b32 v6, 7, v6
v_lshl_add_u32 v6, v5, 3, v6
v_lshrrev_b32 v7, 1, v4
v_and_b32 v8, 1, v3
v_lshl_add_u32 v7, v8, 1, v7
v_lshl_add_u32 v10, v7, 5, v6
v_xor_b32 v11, 32, v10
v_xor_b32 v12, 64, v10
v_xor_b32 v13, 96, v10
v_add_u32 v14, 0x10000, v10
v_add_u32 v15, 0x10000, v11
v_add_u32 v16, 0x10000, v12
v_add_u32 v17, 0x10000, v13
ds_read_b64_tr_b16 v[220:221], v10 offset:0
ds_read_b64_tr_b16 v[222:223], v10 offset:512
ds_read_b64_tr_b16 v[224:225], v11 offset:0
ds_read_b64_tr_b16 v[226:227], v11 offset:512
ds_read_b64_tr_b16 v[228:229], v12 offset:0
ds_read_b64_tr_b16 v[230:231], v12 offset:512
ds_read_b64_tr_b16 v[232:233], v13 offset:0
ds_read_b64_tr_b16 v[234:235], v13 offset:512
ds_read_b64_tr_b16 v[236:237], v10 offset:4096
ds_read_b64_tr_b16 v[238:239], v10 offset:4608
ds_read_b64_tr_b16 v[240:241], v11 offset:4096
ds_read_b64_tr_b16 v[242:243], v11 offset:4608
ds_read_b64_tr_b16 v[244:245], v12 offset:4096
ds_read_b64_tr_b16 v[246:247], v12 offset:4608
ds_read_b64_tr_b16 v[248:249], v13 offset:4096
ds_read_b64_tr_b16 v[250:251], v13 offset:4608
s_lshl_b32 s48, s41, 3
s_lshl_b32 s49, s40, 1
s_add_u32 s48, s48, s49
s_lshl_b32 s48, s48, 15
s_add_u32 s48, s48, 4194304
v_add_u32 v38, s48, v18
v_add_u32 v39, 32768, v38
s_lshl_b32 s57, s75, 11
s_add_u32 s87, s87, 262144
v_lshlrev_b32 v60, 16, v20
v_and_b32 v61, 0xffff0000, v20
v_lshlrev_b32 v62, 16, v21
v_and_b32 v63, 0xffff0000, v21
v_lshlrev_b32 v64, 16, v22
v_and_b32 v65, 0xffff0000, v22
v_lshlrev_b32 v66, 16, v23
v_and_b32 v67, 0xffff0000, v23
v_lshlrev_b32 v68, 16, v24
v_and_b32 v69, 0xffff0000, v24
v_lshlrev_b32 v70, 16, v25
v_and_b32 v71, 0xffff0000, v25
v_lshlrev_b32 v72, 16, v26
v_and_b32 v73, 0xffff0000, v26
v_lshlrev_b32 v74, 16, v27
v_and_b32 v75, 0xffff0000, v27
v_lshlrev_b32 v76, 16, v28
v_and_b32 v77, 0xffff0000, v28
v_lshlrev_b32 v78, 16, v29
v_and_b32 v79, 0xffff0000, v29
v_lshlrev_b32 v80, 16, v30
v_and_b32 v81, 0xffff0000, v30
v_lshlrev_b32 v82, 16, v31
v_and_b32 v83, 0xffff0000, v31
v_lshlrev_b32 v84, 16, v32
v_and_b32 v85, 0xffff0000, v32
v_lshlrev_b32 v86, 16, v33
v_and_b32 v87, 0xffff0000, v33
v_lshlrev_b32 v88, 16, v34
v_and_b32 v89, 0xffff0000, v34
v_lshlrev_b32 v90, 16, v35
v_and_b32 v91, 0xffff0000, v35
v_mov_b32 v6, 0
v_mov_b32 v7, 0
v_mov_b32 v8, 0
v_mov_b32 v9, 0
s_lshl_b32 s62, s42, 2
v_mov_b32 v4, s62
v_mov_b32 v5, 3
s_mov_b32 s63, 0
s_waitcnt vmcnt(0)
poll_89:
v_cmp_gt_u32 vcc, 3, v37
s_cbranch_vccz polled_90
buffer_load_dword v37, v36, s[32:35], s84 offen sc1
s_add_u32 s63, s63, 1
s_cmp_lt_u32 s63, 0x80000
s_waitcnt vmcnt(0)
s_cbranch_scc1 poll_89
polled_90:
buffer_load_dwordx4 v[156:159], v38, s[32:35], s57 offen sc1
buffer_load_dwordx4 v[160:163], v39, s[32:35], s57 offen sc1
buffer_load_dwordx4 v[164:167], v38, s[32:35], s57 offen offset:1024 sc1
buffer_load_dwordx4 v[168:171], v39, s[32:35], s57 offen offset:1024 sc1
s_add_u32 s57, s57, 2048
s_and_b32 s57, s57, 0x7fff
buffer_load_dwordx4 v[172:175], v38, s[32:35], s57 offen sc1
buffer_load_dwordx4 v[176:179], v39, s[32:35], s57 offen sc1
buffer_load_dwordx4 v[180:183], v38, s[32:35], s57 offen offset:1024 sc1
buffer_load_dwordx4 v[184:187], v39, s[32:35], s57 offen offset:1024 sc1
s_add_u32 s57, s57, 2048
s_and_b32 s57, s57, 0x7fff
s_waitcnt vmcnt(6) lgkmcnt(8)
v_mfma_f32_16x16x32_bf16 v[60:63], v[220:223], v[156:159], v[60:63]
buffer_load_dwordx4 v[188:191], v38, s[32:35], s57 offen sc1
v_mfma_f32_16x16x32_bf16 v[76:79], v[220:223], v[160:163], v[76:79]
ds_read_b64_tr_b16 v[100:101], v10 offset:8192
ds_read_b64_tr_b16 v[102:103], v10 offset:8704
v_mfma_f32_16x16x32_bf16 v[64:67], v[224:227], v[156:159], v[64:67]
ds_read_b64_tr_b16 v[104:105], v11 offset:8192
ds_read_b64_tr_b16 v[106:107], v11 offset:8704
v_mfma_f32_16x16x32_bf16 v[80:83], v[224:227], v[160:163], v[80:83]
buffer_load_dwordx4 v[192:195], v39, s[32:35], s57 offen sc1
v_mfma_f32_16x16x32_bf16 v[68:71], v[228:231], v[156:159], v[68:71]
ds_read_b64_tr_b16 v[108:109], v12 offset:8192
ds_read_b64_tr_b16 v[110:111], v12 offset:8704
v_mfma_f32_16x16x32_bf16 v[84:87], v[228:231], v[160:163], v[84:87]
ds_read_b64_tr_b16 v[112:113], v13 offset:8192
ds_read_b64_tr_b16 v[114:115], v13 offset:8704
v_mfma_f32_16x16x32_bf16 v[72:75], v[232:235], v[156:159], v[72:75]
v_mfma_f32_16x16x32_bf16 v[88:91], v[232:235], v[160:163], v[88:91]
s_waitcnt vmcnt(6) lgkmcnt(8)
v_mfma_f32_16x16x32_bf16 v[60:63], v[236:239], v[164:167], v[60:63]
buffer_load_dwordx4 v[196:199], v38, s[32:35], s57 offen offset:1024 sc1
v_mfma_f32_16x16x32_bf16 v[76:79], v[236:239], v[168:171], v[76:79]
ds_read_b64_tr_b16 v[220:221], v10 offset:12288
ds_read_b64_tr_b16 v[222:223], v10 offset:12800
v_mfma_f32_16x16x32_bf16 v[64:67], v[240:243], v[164:167], v[64:67]
ds_read_b64_tr_b16 v[224:225], v11 offset:12288
ds_read_b64_tr_b16 v[226:227], v11 offset:12800
v_mfma_f32_16x16x32_bf16 v[80:83], v[240:243], v[168:171], v[80:83]
buffer_load_dwordx4 v[200:203], v39, s[32:35], s57 offen offset:1024 sc1
v_mfma_f32_16x16x32_bf16 v[68:71], v[244:247], v[164:167], v[68:71]
ds_read_b64_tr_b16 v[228:229], v12 offset:12288
ds_read_b64_tr_b16 v[230:231], v12 offset:12800
v_mfma_f32_16x16x32_bf16 v[84:87], v[244:247], v[168:171], v[84:87]
ds_read_b64_tr_b16 v[232:233], v13 offset:12288
ds_read_b64_tr_b16 v[234:235], v13 offset:12800
v_mfma_f32_16x16x32_bf16 v[72:75], v[248:251], v[164:167], v[72:75]
s_add_u32 s57, s57, 2048
s_and_b32 s57, s57, 0x7fff
v_mfma_f32_16x16x32_bf16 v[88:91], v[248:251], v[168:171], v[88:91]
s_waitcnt vmcnt(6) lgkmcnt(8)
v_mfma_f32_16x16x32_bf16 v[60:63], v[100:103], v[172:175], v[60:63]
buffer_load_dwordx4 v[204:207], v38, s[32:35], s57 offen sc1
v_mfma_f32_16x16x32_bf16 v[76:79], v[100:103], v[176:179], v[76:79]
ds_read_b64_tr_b16 v[236:237], v10 offset:16384
ds_read_b64_tr_b16 v[238:239], v10 offset:16896
v_mfma_f32_16x16x32_bf16 v[64:67], v[104:107], v[172:175], v[64:67]
ds_read_b64_tr_b16 v[240:241], v11 offset:16384
ds_read_b64_tr_b16 v[242:243], v11 offset:16896
v_mfma_f32_16x16x32_bf16 v[80:83], v[104:107], v[176:179], v[80:83]
buffer_load_dwordx4 v[208:211], v39, s[32:35], s57 offen sc1
v_mfma_f32_16x16x32_bf16 v[68:71], v[108:111], v[172:175], v[68:71]
ds_read_b64_tr_b16 v[244:245], v12 offset:16384
ds_read_b64_tr_b16 v[246:247], v12 offset:16896
v_mfma_f32_16x16x32_bf16 v[84:87], v[108:111], v[176:179], v[84:87]
ds_read_b64_tr_b16 v[248:249], v13 offset:16384
ds_read_b64_tr_b16 v[250:251], v13 offset:16896
v_mfma_f32_16x16x32_bf16 v[72:75], v[112:115], v[172:175], v[72:75]
v_mfma_f32_16x16x32_bf16 v[88:91], v[112:115], v[176:179], v[88:91]
s_waitcnt vmcnt(6) lgkmcnt(8)
v_mfma_f32_16x16x32_bf16 v[60:63], v[220:223], v[180:183], v[60:63]
buffer_load_dwordx4 v[212:215], v38, s[32:35], s57 offen offset:1024 sc1
v_mfma_f32_16x16x32_bf16 v[76:79], v[220:223], v[184:187], v[76:79]
ds_read_b64_tr_b16 v[100:101], v10 offset:20480
ds_read_b64_tr_b16 v[102:103], v10 offset:20992
v_mfma_f32_16x16x32_bf16 v[64:67], v[224:227], v[180:183], v[64:67]
ds_read_b64_tr_b16 v[104:105], v11 offset:20480
ds_read_b64_tr_b16 v[106:107], v11 offset:20992
v_mfma_f32_16x16x32_bf16 v[80:83], v[224:227], v[184:187], v[80:83]
buffer_load_dwordx4 v[216:219], v39, s[32:35], s57 offen offset:1024 sc1
v_mfma_f32_16x16x32_bf16 v[68:71], v[228:231], v[180:183], v[68:71]
ds_read_b64_tr_b16 v[108:109], v12 offset:20480
ds_read_b64_tr_b16 v[110:111], v12 offset:20992
v_mfma_f32_16x16x32_bf16 v[84:87], v[228:231], v[184:187], v[84:87]
ds_read_b64_tr_b16 v[112:113], v13 offset:20480
ds_read_b64_tr_b16 v[114:115], v13 offset:20992
v_mfma_f32_16x16x32_bf16 v[72:75], v[232:235], v[180:183], v[72:75]
s_add_u32 s57, s57, 2048
s_and_b32 s57, s57, 0x7fff
v_mfma_f32_16x16x32_bf16 v[88:91], v[232:235], v[184:187], v[88:91]
s_waitcnt vmcnt(6) lgkmcnt(8)
v_mfma_f32_16x16x32_bf16 v[60:63], v[236:239], v[188:191], v[60:63]
buffer_load_dwordx4 v[156:159], v38, s[32:35], s57 offen sc1
v_mfma_f32_16x16x32_bf16 v[76:79], v[236:239], v[192:195], v[76:79]
ds_read_b64_tr_b16 v[220:221], v10 offset:24576
ds_read_b64_tr_b16 v[222:223], v10 offset:25088
v_mfma_f32_16x16x32_bf16 v[64:67], v[240:243], v[188:191], v[64:67]
ds_read_b64_tr_b16 v[224:225], v11 offset:24576
ds_read_b64_tr_b16 v[226:227], v11 offset:25088
v_mfma_f32_16x16x32_bf16 v[80:83], v[240:243], v[192:195], v[80:83]
buffer_load_dwordx4 v[160:163], v39, s[32:35], s57 offen sc1
v_mfma_f32_16x16x32_bf16 v[68:71], v[244:247], v[188:191], v[68:71]
ds_read_b64_tr_b16 v[228:229], v12 offset:24576
ds_read_b64_tr_b16 v[230:231], v12 offset:25088
v_mfma_f32_16x16x32_bf16 v[84:87], v[244:247], v[192:195], v[84:87]
ds_read_b64_tr_b16 v[232:233], v13 offset:24576
ds_read_b64_tr_b16 v[234:235], v13 offset:25088
v_mfma_f32_16x16x32_bf16 v[72:75], v[248:251], v[188:191], v[72:75]
v_mfma_f32_16x16x32_bf16 v[88:91], v[248:251], v[192:195], v[88:91]
s_waitcnt vmcnt(6) lgkmcnt(8)
v_mfma_f32_16x16x32_bf16 v[60:63], v[100:103], v[196:199], v[60:63]
buffer_load_dwordx4 v[164:167], v38, s[32:35], s57 offen offset:1024 sc1
v_mfma_f32_16x16x32_bf16 v[76:79], v[100:103], v[200:203], v[76:79]
ds_read_b64_tr_b16 v[236:237], v10 offset:28672
ds_read_b64_tr_b16 v[238:239], v10 offset:29184
v_mfma_f32_16x16x32_bf16 v[64:67], v[104:107], v[196:199], v[64:67]
ds_read_b64_tr_b16 v[240:241], v11 offset:28672
ds_read_b64_tr_b16 v[242:243], v11 offset:29184
v_mfma_f32_16x16x32_bf16 v[80:83], v[104:107], v[200:203], v[80:83]
buffer_load_dwordx4 v[168:171], v39, s[32:35], s57 offen offset:1024 sc1
v_mfma_f32_16x16x32_bf16 v[68:71], v[108:111], v[196:199], v[68:71]
ds_read_b64_tr_b16 v[244:245], v12 offset:28672
ds_read_b64_tr_b16 v[246:247], v12 offset:29184
v_mfma_f32_16x16x32_bf16 v[84:87], v[108:111], v[200:203], v[84:87]
ds_read_b64_tr_b16 v[248:249], v13 offset:28672
ds_read_b64_tr_b16 v[250:251], v13 offset:29184
v_mfma_f32_16x16x32_bf16 v[72:75], v[112:115], v[196:199], v[72:75]
s_add_u32 s57, s57, 2048
s_and_b32 s57, s57, 0x7fff
v_mfma_f32_16x16x32_bf16 v[88:91], v[112:115], v[200:203], v[88:91]
s_waitcnt vmcnt(6) lgkmcnt(8)
v_mfma_f32_16x16x32_bf16 v[60:63], v[220:223], v[204:207], v[60:63]
buffer_load_dwordx4 v[172:175], v38, s[32:35], s57 offen sc1
v_mfma_f32_16x16x32_bf16 v[76:79], v[220:223], v[208:211], v[76:79]
ds_read_b64_tr_b16 v[100:101], v10 offset:32768
ds_read_b64_tr_b16 v[102:103], v10 offset:33280
v_mfma_f32_16x16x32_bf16 v[64:67], v[224:227], v[204:207], v[64:67]
ds_read_b64_tr_b16 v[104:105], v11 offset:32768
ds_read_b64_tr_b16 v[106:107], v11 offset:33280
v_mfma_f32_16x16x32_bf16 v[80:83], v[224:227], v[208:211], v[80:83]
buffer_load_dwordx4 v[176:179], v39, s[32:35], s57 offen sc1
v_mfma_f32_16x16x32_bf16 v[68:71], v[228:231], v[204:207], v[68:71]
ds_read_b64_tr_b16 v[108:109], v12 offset:32768
ds_read_b64_tr_b16 v[110:111], v12 offset:33280
v_mfma_f32_16x16x32_bf16 v[84:87], v[228:231], v[208:211], v[84:87]
ds_read_b64_tr_b16 v[112:113], v13 offset:32768
ds_read_b64_tr_b16 v[114:115], v13 offset:33280
v_mfma_f32_16x16x32_bf16 v[72:75], v[232:235], v[204:207], v[72:75]
v_mfma_f32_16x16x32_bf16 v[88:91], v[232:235], v[208:211], v[88:91]
s_waitcnt vmcnt(6) lgkmcnt(8)
v_mfma_f32_16x16x32_bf16 v[60:63], v[236:239], v[212:215], v[60:63]
buffer_load_dwordx4 v[180:183], v38, s[32:35], s57 offen offset:1024 sc1
v_mfma_f32_16x16x32_bf16 v[76:79], v[236:239], v[216:219], v[76:79]
ds_read_b64_tr_b16 v[220:221], v10 offset:36864
ds_read_b64_tr_b16 v[222:223], v10 offset:37376
v_mfma_f32_16x16x32_bf16 v[64:67], v[240:243], v[212:215], v[64:67]
ds_read_b64_tr_b16 v[224:225], v11 offset:36864
ds_read_b64_tr_b16 v[226:227], v11 offset:37376
v_mfma_f32_16x16x32_bf16 v[80:83], v[240:243], v[216:219], v[80:83]
buffer_load_dwordx4 v[184:187], v39, s[32:35], s57 offen offset:1024 sc1
v_mfma_f32_16x16x32_bf16 v[68:71], v[244:247], v[212:215], v[68:71]
ds_read_b64_tr_b16 v[228:229], v12 offset:36864
ds_read_b64_tr_b16 v[230:231], v12 offset:37376
v_mfma_f32_16x16x32_bf16 v[84:87], v[244:247], v[216:219], v[84:87]
ds_read_b64_tr_b16 v[232:233], v13 offset:36864
ds_read_b64_tr_b16 v[234:235], v13 offset:37376
v_mfma_f32_16x16x32_bf16 v[72:75], v[248:251], v[212:215], v[72:75]
s_add_u32 s57, s57, 2048
s_and_b32 s57, s57, 0x7fff
v_mfma_f32_16x16x32_bf16 v[88:91], v[248:251], v[216:219], v[88:91]
s_waitcnt vmcnt(6) lgkmcnt(8)
v_mfma_f32_16x16x32_bf16 v[60:63], v[100:103], v[156:159], v[60:63]
buffer_load_dwordx4 v[188:191], v38, s[32:35], s57 offen sc1
v_mfma_f32_16x16x32_bf16 v[76:79], v[100:103], v[160:163], v[76:79]
ds_read_b64_tr_b16 v[236:237], v10 offset:40960
ds_read_b64_tr_b16 v[238:239], v10 offset:41472
v_mfma_f32_16x16x32_bf16 v[64:67], v[104:107], v[156:159], v[64:67]
ds_read_b64_tr_b16 v[240:241], v11 offset:40960
ds_read_b64_tr_b16 v[242:243], v11 offset:41472
v_mfma_f32_16x16x32_bf16 v[80:83], v[104:107], v[160:163], v[80:83]
buffer_load_dwordx4 v[192:195], v39, s[32:35], s57 offen sc1
v_mfma_f32_16x16x32_bf16 v[68:71], v[108:111], v[156:159], v[68:71]
ds_read_b64_tr_b16 v[244:245], v12 offset:40960
ds_read_b64_tr_b16 v[246:247], v12 offset:41472
v_mfma_f32_16x16x32_bf16 v[84:87], v[108:111], v[160:163], v[84:87]
ds_read_b64_tr_b16 v[248:249], v13 offset:40960
ds_read_b64_tr_b16 v[250:251], v13 offset:41472
v_mfma_f32_16x16x32_bf16 v[72:75], v[112:115], v[156:159], v[72:75]
v_mfma_f32_16x16x32_bf16 v[88:91], v[112:115], v[160:163], v[88:91]
s_waitcnt vmcnt(6) lgkmcnt(8)
v_mfma_f32_16x16x32_bf16 v[60:63], v[220:223], v[164:167], v[60:63]
buffer_load_dwordx4 v[196:199], v38, s[32:35], s57 offen offset:1024 sc1
v_mfma_f32_16x16x32_bf16 v[76:79], v[220:223], v[168:171], v[76:79]
ds_read_b64_tr_b16 v[100:101], v10 offset:45056
ds_read_b64_tr_b16 v[102:103], v10 offset:45568
v_mfma_f32_16x16x32_bf16 v[64:67], v[224:227], v[164:167], v[64:67]
ds_read_b64_tr_b16 v[104:105], v11 offset:45056
ds_read_b64_tr_b16 v[106:107], v11 offset:45568
v_mfma_f32_16x16x32_bf16 v[80:83], v[224:227], v[168:171], v[80:83]
buffer_load_dwordx4 v[200:203], v39, s[32:35], s57 offen offset:1024 sc1
v_mfma_f32_16x16x32_bf16 v[68:71], v[228:231], v[164:167], v[68:71]
ds_read_b64_tr_b16 v[108:109], v12 offset:45056
ds_read_b64_tr_b16 v[110:111], v12 offset:45568
v_mfma_f32_16x16x32_bf16 v[84:87], v[228:231], v[168:171], v[84:87]
ds_read_b64_tr_b16 v[112:113], v13 offset:45056
ds_read_b64_tr_b16 v[114:115], v13 offset:45568
v_mfma_f32_16x16x32_bf16 v[72:75], v[232:235], v[164:167], v[72:75]
s_add_u32 s57, s57, 2048
s_and_b32 s57, s57, 0x7fff
v_mfma_f32_16x16x32_bf16 v[88:91], v[232:235], v[168:171], v[88:91]
s_waitcnt vmcnt(6) lgkmcnt(8)
v_mfma_f32_16x16x32_bf16 v[60:63], v[236:239], v[172:175], v[60:63]
buffer_load_dwordx4 v[204:207], v38, s[32:35], s57 offen sc1
v_mfma_f32_16x16x32_bf16 v[76:79], v[236:239], v[176:179], v[76:79]
ds_read_b64_tr_b16 v[220:221], v10 offset:49152
ds_read_b64_tr_b16 v[222:223], v10 offset:49664
v_mfma_f32_16x16x32_bf16 v[64:67], v[240:243], v[172:175], v[64:67]
ds_read_b64_tr_b16 v[224:225], v11 offset:49152
ds_read_b64_tr_b16 v[226:227], v11 offset:49664
v_mfma_f32_16x16x32_bf16 v[80:83], v[240:243], v[176:179], v[80:83]
buffer_load_dwordx4 v[208:211], v39, s[32:35], s57 offen sc1
v_mfma_f32_16x16x32_bf16 v[68:71], v[244:247], v[172:175], v[68:71]
ds_read_b64_tr_b16 v[228:229], v12 offset:49152
ds_read_b64_tr_b16 v[230:231], v12 offset:49664
v_mfma_f32_16x16x32_bf16 v[84:87], v[244:247], v[176:179], v[84:87]
ds_read_b64_tr_b16 v[232:233], v13 offset:49152
ds_read_b64_tr_b16 v[234:235], v13 offset:49664
v_mfma_f32_16x16x32_bf16 v[72:75], v[248:251], v[172:175], v[72:75]
v_mfma_f32_16x16x32_bf16 v[88:91], v[248:251], v[176:179], v[88:91]
s_waitcnt vmcnt(6) lgkmcnt(8)
v_mfma_f32_16x16x32_bf16 v[60:63], v[100:103], v[180:183], v[60:63]
buffer_load_dwordx4 v[212:215], v38, s[32:35], s57 offen offset:1024 sc1
v_mfma_f32_16x16x32_bf16 v[76:79], v[100:103], v[184:187], v[76:79]
ds_read_b64_tr_b16 v[236:237], v10 offset:53248
ds_read_b64_tr_b16 v[238:239], v10 offset:53760
v_mfma_f32_16x16x32_bf16 v[64:67], v[104:107], v[180:183], v[64:67]
ds_read_b64_tr_b16 v[240:241], v11 offset:53248
ds_read_b64_tr_b16 v[242:243], v11 offset:53760
v_mfma_f32_16x16x32_bf16 v[80:83], v[104:107], v[184:187], v[80:83]
buffer_load_dwordx4 v[216:219], v39, s[32:35], s57 offen offset:1024 sc1
v_mfma_f32_16x16x32_bf16 v[68:71], v[108:111], v[180:183], v[68:71]
ds_read_b64_tr_b16 v[244:245], v12 offset:53248
ds_read_b64_tr_b16 v[246:247], v12 offset:53760
v_mfma_f32_16x16x32_bf16 v[84:87], v[108:111], v[184:187], v[84:87]
ds_read_b64_tr_b16 v[248:249], v13 offset:53248
ds_read_b64_tr_b16 v[250:251], v13 offset:53760
v_mfma_f32_16x16x32_bf16 v[72:75], v[112:115], v[180:183], v[72:75]
s_add_u32 s57, s57, 2048
s_and_b32 s57, s57, 0x7fff
v_mfma_f32_16x16x32_bf16 v[88:91], v[112:115], v[184:187], v[88:91]
s_waitcnt vmcnt(6) lgkmcnt(8)
v_mfma_f32_16x16x32_bf16 v[60:63], v[220:223], v[188:191], v[60:63]
buffer_load_dwordx4 v[156:159], v38, s[32:35], s57 offen sc1
v_mfma_f32_16x16x32_bf16 v[76:79], v[220:223], v[192:195], v[76:79]
ds_read_b64_tr_b16 v[100:101], v10 offset:57344
ds_read_b64_tr_b16 v[102:103], v10 offset:57856
v_mfma_f32_16x16x32_bf16 v[64:67], v[224:227], v[188:191], v[64:67]
ds_read_b64_tr_b16 v[104:105], v11 offset:57344
ds_read_b64_tr_b16 v[106:107], v11 offset:57856
v_mfma_f32_16x16x32_bf16 v[80:83], v[224:227], v[192:195], v[80:83]
buffer_load_dwordx4 v[160:163], v39, s[32:35], s57 offen sc1
v_mfma_f32_16x16x32_bf16 v[68:71], v[228:231], v[188:191], v[68:71]
ds_read_b64_tr_b16 v[108:109], v12 offset:57344
ds_read_b64_tr_b16 v[110:111], v12 offset:57856
v_mfma_f32_16x16x32_bf16 v[84:87], v[228:231], v[192:195], v[84:87]
ds_read_b64_tr_b16 v[112:113], v13 offset:57344
ds_read_b64_tr_b16 v[114:115], v13 offset:57856
v_mfma_f32_16x16x32_bf16 v[72:75], v[232:235], v[188:191], v[72:75]
v_mfma_f32_16x16x32_bf16 v[88:91], v[232:235], v[192:195], v[88:91]
s_waitcnt vmcnt(6) lgkmcnt(8)
v_mfma_f32_16x16x32_bf16 v[60:63], v[236:239], v[196:199], v[60:63]
buffer_load_dwordx4 v[164:167], v38, s[32:35], s57 offen offset:1024 sc1
v_mfma_f32_16x16x32_bf16 v[76:79], v[236:239], v[200:203], v[76:79]
ds_read_b64_tr_b16 v[220:221], v10 offset:61440
ds_read_b64_tr_b16 v[222:223], v10 offset:61952
v_mfma_f32_16x16x32_bf16 v[64:67], v[240:243], v[196:199], v[64:67]
ds_read_b64_tr_b16 v[224:225], v11 offset:61440
ds_read_b64_tr_b16 v[226:227], v11 offset:61952
v_mfma_f32_16x16x32_bf16 v[80:83], v[240:243], v[200:203], v[80:83]
buffer_load_dwordx4 v[168:171], v39, s[32:35], s57 offen offset:1024 sc1
v_mfma_f32_16x16x32_bf16 v[68:71], v[244:247], v[196:199], v[68:71]
ds_read_b64_tr_b16 v[228:229], v12 offset:61440
ds_read_b64_tr_b16 v[230:231], v12 offset:61952
v_mfma_f32_16x16x32_bf16 v[84:87], v[244:247], v[200:203], v[84:87]
ds_read_b64_tr_b16 v[232:233], v13 offset:61440
ds_read_b64_tr_b16 v[234:235], v13 offset:61952
v_mfma_f32_16x16x32_bf16 v[72:75], v[248:251], v[196:199], v[72:75]
s_add_u32 s57, s57, 2048
s_and_b32 s57, s57, 0x7fff
v_mfma_f32_16x16x32_bf16 v[88:91], v[248:251], v[200:203], v[88:91]
s_waitcnt vmcnt(6) lgkmcnt(8)
v_mfma_f32_16x16x32_bf16 v[60:63], v[100:103], v[204:207], v[60:63]
buffer_load_dwordx4 v[172:175], v38, s[32:35], s57 offen sc1
v_mfma_f32_16x16x32_bf16 v[76:79], v[100:103], v[208:211], v[76:79]
ds_read_b64_tr_b16 v[236:237], v14 offset:0
ds_read_b64_tr_b16 v[238:239], v14 offset:512
v_mfma_f32_16x16x32_bf16 v[64:67], v[104:107], v[204:207], v[64:67]
ds_read_b64_tr_b16 v[240:241], v15 offset:0
ds_read_b64_tr_b16 v[242:243], v15 offset:512
v_mfma_f32_16x16x32_bf16 v[80:83], v[104:107], v[208:211], v[80:83]
buffer_load_dwordx4 v[176:179], v39, s[32:35], s57 offen sc1
v_mfma_f32_16x16x32_bf16 v[68:71], v[108:111], v[204:207], v[68:71]
ds_read_b64_tr_b16 v[244:245], v16 offset:0
ds_read_b64_tr_b16 v[246:247], v16 offset:512
v_mfma_f32_16x16x32_bf16 v[84:87], v[108:111], v[208:211], v[84:87]
ds_read_b64_tr_b16 v[248:249], v17 offset:0
ds_read_b64_tr_b16 v[250:251], v17 offset:512
v_mfma_f32_16x16x32_bf16 v[72:75], v[112:115], v[204:207], v[72:75]
v_mfma_f32_16x16x32_bf16 v[88:91], v[112:115], v[208:211], v[88:91]
s_waitcnt vmcnt(6) lgkmcnt(8)
v_mfma_f32_16x16x32_bf16 v[60:63], v[220:223], v[212:215], v[60:63]
buffer_load_dwordx4 v[180:183], v38, s[32:35], s57 offen offset:1024 sc1
v_mfma_f32_16x16x32_bf16 v[76:79], v[220:223], v[216:219], v[76:79]
ds_read_b64_tr_b16 v[100:101], v14 offset:4096
ds_read_b64_tr_b16 v[102:103], v14 offset:4608
v_mfma_f32_16x16x32_bf16 v[64:67], v[224:227], v[212:215], v[64:67]
ds_read_b64_tr_b16 v[104:105], v15 offset:4096
ds_read_b64_tr_b16 v[106:107], v15 offset:4608
v_mfma_f32_16x16x32_bf16 v[80:83], v[224:227], v[216:219], v[80:83]
buffer_load_dwordx4 v[184:187], v39, s[32:35], s57 offen offset:1024 sc1
v_mfma_f32_16x16x32_bf16 v[68:71], v[228:231], v[212:215], v[68:71]
ds_read_b64_tr_b16 v[108:109], v16 offset:4096
ds_read_b64_tr_b16 v[110:111], v16 offset:4608
v_mfma_f32_16x16x32_bf16 v[84:87], v[228:231], v[216:219], v[84:87]
ds_read_b64_tr_b16 v[112:113], v17 offset:4096
ds_read_b64_tr_b16 v[114:115], v17 offset:4608
v_mfma_f32_16x16x32_bf16 v[72:75], v[232:235], v[212:215], v[72:75]
s_add_u32 s57, s57, 2048
s_and_b32 s57, s57, 0x7fff
v_mfma_f32_16x16x32_bf16 v[88:91], v[232:235], v[216:219], v[88:91]
s_waitcnt vmcnt(6) lgkmcnt(8)
v_mfma_f32_16x16x32_bf16 v[60:63], v[236:239], v[156:159], v[60:63]
buffer_load_dwordx4 v[188:191], v38, s[32:35], s57 offen sc1
v_mfma_f32_16x16x32_bf16 v[76:79], v[236:239], v[160:163], v[76:79]
ds_read_b64_tr_b16 v[220:221], v14 offset:8192
ds_read_b64_tr_b16 v[222:223], v14 offset:8704
v_mfma_f32_16x16x32_bf16 v[64:67], v[240:243], v[156:159], v[64:67]
ds_read_b64_tr_b16 v[224:225], v15 offset:8192
ds_read_b64_tr_b16 v[226:227], v15 offset:8704
v_mfma_f32_16x16x32_bf16 v[80:83], v[240:243], v[160:163], v[80:83]
buffer_load_dwordx4 v[192:195], v39, s[32:35], s57 offen sc1
v_mfma_f32_16x16x32_bf16 v[68:71], v[244:247], v[156:159], v[68:71]
ds_read_b64_tr_b16 v[228:229], v16 offset:8192
ds_read_b64_tr_b16 v[230:231], v16 offset:8704
v_mfma_f32_16x16x32_bf16 v[84:87], v[244:247], v[160:163], v[84:87]
ds_read_b64_tr_b16 v[232:233], v17 offset:8192
ds_read_b64_tr_b16 v[234:235], v17 offset:8704
v_mfma_f32_16x16x32_bf16 v[72:75], v[248:251], v[156:159], v[72:75]
v_mfma_f32_16x16x32_bf16 v[88:91], v[248:251], v[160:163], v[88:91]
s_waitcnt vmcnt(6) lgkmcnt(8)
v_mfma_f32_16x16x32_bf16 v[60:63], v[100:103], v[164:167], v[60:63]
buffer_load_dwordx4 v[196:199], v38, s[32:35], s57 offen offset:1024 sc1
v_mfma_f32_16x16x32_bf16 v[76:79], v[100:103], v[168:171], v[76:79]
ds_read_b64_tr_b16 v[236:237], v14 offset:12288
ds_read_b64_tr_b16 v[238:239], v14 offset:12800
v_mfma_f32_16x16x32_bf16 v[64:67], v[104:107], v[164:167], v[64:67]
ds_read_b64_tr_b16 v[240:241], v15 offset:12288
ds_read_b64_tr_b16 v[242:243], v15 offset:12800
v_mfma_f32_16x16x32_bf16 v[80:83], v[104:107], v[168:171], v[80:83]
buffer_load_dwordx4 v[200:203], v39, s[32:35], s57 offen offset:1024 sc1
v_mfma_f32_16x16x32_bf16 v[68:71], v[108:111], v[164:167], v[68:71]
ds_read_b64_tr_b16 v[244:245], v16 offset:12288
ds_read_b64_tr_b16 v[246:247], v16 offset:12800
v_mfma_f32_16x16x32_bf16 v[84:87], v[108:111], v[168:171], v[84:87]
ds_read_b64_tr_b16 v[248:249], v17 offset:12288
ds_read_b64_tr_b16 v[250:251], v17 offset:12800
v_mfma_f32_16x16x32_bf16 v[72:75], v[112:115], v[164:167], v[72:75]
s_add_u32 s57, s57, 2048
s_and_b32 s57, s57, 0x7fff
v_mfma_f32_16x16x32_bf16 v[88:91], v[112:115], v[168:171], v[88:91]
s_waitcnt vmcnt(6) lgkmcnt(8)
v_mfma_f32_16x16x32_bf16 v[60:63], v[220:223], v[172:175], v[60:63]
buffer_load_dwordx4 v[204:207], v38, s[32:35], s57 offen sc1
v_mfma_f32_16x16x32_bf16 v[76:79], v[220:223], v[176:179], v[76:79]
ds_read_b64_tr_b16 v[100:101], v14 offset:16384
ds_read_b64_tr_b16 v[102:103], v14 offset:16896
v_mfma_f32_16x16x32_bf16 v[64:67], v[224:227], v[172:175], v[64:67]
ds_read_b64_tr_b16 v[104:105], v15 offset:16384
ds_read_b64_tr_b16 v[106:107], v15 offset:16896
v_mfma_f32_16x16x32_bf16 v[80:83], v[224:227], v[176:179], v[80:83]
buffer_load_dwordx4 v[208:211], v39, s[32:35], s57 offen sc1
v_mfma_f32_16x16x32_bf16 v[68:71], v[228:231], v[172:175], v[68:71]
ds_read_b64_tr_b16 v[108:109], v16 offset:16384
ds_read_b64_tr_b16 v[110:111], v16 offset:16896
v_mfma_f32_16x16x32_bf16 v[84:87], v[228:231], v[176:179], v[84:87]
ds_read_b64_tr_b16 v[112:113], v17 offset:16384
ds_read_b64_tr_b16 v[114:115], v17 offset:16896
v_mfma_f32_16x16x32_bf16 v[72:75], v[232:235], v[172:175], v[72:75]
v_mfma_f32_16x16x32_bf16 v[88:91], v[232:235], v[176:179], v[88:91]
s_waitcnt vmcnt(6) lgkmcnt(8)
v_mfma_f32_16x16x32_bf16 v[60:63], v[236:239], v[180:183], v[60:63]
buffer_load_dwordx4 v[212:215], v38, s[32:35], s57 offen offset:1024 sc1
v_mfma_f32_16x16x32_bf16 v[76:79], v[236:239], v[184:187], v[76:79]
ds_read_b64_tr_b16 v[220:221], v14 offset:20480
ds_read_b64_tr_b16 v[222:223], v14 offset:20992
v_mfma_f32_16x16x32_bf16 v[64:67], v[240:243], v[180:183], v[64:67]
ds_read_b64_tr_b16 v[224:225], v15 offset:20480
ds_read_b64_tr_b16 v[226:227], v15 offset:20992
v_mfma_f32_16x16x32_bf16 v[80:83], v[240:243], v[184:187], v[80:83]
buffer_load_dwordx4 v[216:219], v39, s[32:35], s57 offen offset:1024 sc1
v_mfma_f32_16x16x32_bf16 v[68:71], v[244:247], v[180:183], v[68:71]
ds_read_b64_tr_b16 v[228:229], v16 offset:20480
ds_read_b64_tr_b16 v[230:231], v16 offset:20992
v_mfma_f32_16x16x32_bf16 v[84:87], v[244:247], v[184:187], v[84:87]
ds_read_b64_tr_b16 v[232:233], v17 offset:20480
ds_read_b64_tr_b16 v[234:235], v17 offset:20992
v_mfma_f32_16x16x32_bf16 v[72:75], v[248:251], v[180:183], v[72:75]
s_add_u32 s57, s57, 2048
s_and_b32 s57, s57, 0x7fff
v_mfma_f32_16x16x32_bf16 v[88:91], v[248:251], v[184:187], v[88:91]
s_waitcnt vmcnt(6) lgkmcnt(8)
v_mfma_f32_16x16x32_bf16 v[60:63], v[100:103], v[188:191], v[60:63]
buffer_load_dwordx4 v[156:159], v38, s[32:35], s57 offen sc1
v_mfma_f32_16x16x32_bf16 v[76:79], v[100:103], v[192:195], v[76:79]
ds_read_b64_tr_b16 v[236:237], v14 offset:24576
ds_read_b64_tr_b16 v[238:239], v14 offset:25088
v_mfma_f32_16x16x32_bf16 v[64:67], v[104:107], v[188:191], v[64:67]
ds_read_b64_tr_b16 v[240:241], v15 offset:24576
ds_read_b64_tr_b16 v[242:243], v15 offset:25088
v_mfma_f32_16x16x32_bf16 v[80:83], v[104:107], v[192:195], v[80:83]
buffer_load_dwordx4 v[160:163], v39, s[32:35], s57 offen sc1
v_mfma_f32_16x16x32_bf16 v[68:71], v[108:111], v[188:191], v[68:71]
ds_read_b64_tr_b16 v[244:245], v16 offset:24576
ds_read_b64_tr_b16 v[246:247], v16 offset:25088
v_mfma_f32_16x16x32_bf16 v[84:87], v[108:111], v[192:195], v[84:87]
ds_read_b64_tr_b16 v[248:249], v17 offset:24576
ds_read_b64_tr_b16 v[250:251], v17 offset:25088
v_mfma_f32_16x16x32_bf16 v[72:75], v[112:115], v[188:191], v[72:75]
v_mfma_f32_16x16x32_bf16 v[88:91], v[112:115], v[192:195], v[88:91]
s_waitcnt vmcnt(6) lgkmcnt(8)
v_mfma_f32_16x16x32_bf16 v[60:63], v[220:223], v[196:199], v[60:63]
buffer_load_dwordx4 v[164:167], v38, s[32:35], s57 offen offset:1024 sc1
v_mfma_f32_16x16x32_bf16 v[76:79], v[220:223], v[200:203], v[76:79]
ds_read_b64_tr_b16 v[100:101], v14 offset:28672
ds_read_b64_tr_b16 v[102:103], v14 offset:29184
v_mfma_f32_16x16x32_bf16 v[64:67], v[224:227], v[196:199], v[64:67]
ds_read_b64_tr_b16 v[104:105], v15 offset:28672
ds_read_b64_tr_b16 v[106:107], v15 offset:29184
v_mfma_f32_16x16x32_bf16 v[80:83], v[224:227], v[200:203], v[80:83]
buffer_load_dwordx4 v[168:171], v39, s[32:35], s57 offen offset:1024 sc1
v_mfma_f32_16x16x32_bf16 v[68:71], v[228:231], v[196:199], v[68:71]
ds_read_b64_tr_b16 v[108:109], v16 offset:28672
ds_read_b64_tr_b16 v[110:111], v16 offset:29184
v_mfma_f32_16x16x32_bf16 v[84:87], v[228:231], v[200:203], v[84:87]
ds_read_b64_tr_b16 v[112:113], v17 offset:28672
ds_read_b64_tr_b16 v[114:115], v17 offset:29184
v_mfma_f32_16x16x32_bf16 v[72:75], v[232:235], v[196:199], v[72:75]
s_add_u32 s57, s57, 2048
s_and_b32 s57, s57, 0x7fff
v_mfma_f32_16x16x32_bf16 v[88:91], v[232:235], v[200:203], v[88:91]
s_waitcnt vmcnt(6) lgkmcnt(8)
v_mfma_f32_16x16x32_bf16 v[60:63], v[236:239], v[204:207], v[60:63]
buffer_load_dwordx4 v[172:175], v38, s[32:35], s57 offen sc1
v_mfma_f32_16x16x32_bf16 v[76:79], v[236:239], v[208:211], v[76:79]
ds_read_b64_tr_b16 v[220:221], v14 offset:32768
ds_read_b64_tr_b16 v[222:223], v14 offset:33280
v_mfma_f32_16x16x32_bf16 v[64:67], v[240:243], v[204:207], v[64:67]
ds_read_b64_tr_b16 v[224:225], v15 offset:32768
ds_read_b64_tr_b16 v[226:227], v15 offset:33280
v_mfma_f32_16x16x32_bf16 v[80:83], v[240:243], v[208:211], v[80:83]
buffer_load_dwordx4 v[176:179], v39, s[32:35], s57 offen sc1
v_mfma_f32_16x16x32_bf16 v[68:71], v[244:247], v[204:207], v[68:71]
ds_read_b64_tr_b16 v[228:229], v16 offset:32768
ds_read_b64_tr_b16 v[230:231], v16 offset:33280
v_mfma_f32_16x16x32_bf16 v[84:87], v[244:247], v[208:211], v[84:87]
ds_read_b64_tr_b16 v[232:233], v17 offset:32768
ds_read_b64_tr_b16 v[234:235], v17 offset:33280
v_mfma_f32_16x16x32_bf16 v[72:75], v[248:251], v[204:207], v[72:75]
v_mfma_f32_16x16x32_bf16 v[88:91], v[248:251], v[208:211], v[88:91]
s_waitcnt vmcnt(6) lgkmcnt(8)
v_mfma_f32_16x16x32_bf16 v[60:63], v[100:103], v[212:215], v[60:63]
buffer_load_dwordx4 v[180:183], v38, s[32:35], s57 offen offset:1024 sc1
v_mfma_f32_16x16x32_bf16 v[76:79], v[100:103], v[216:219], v[76:79]
ds_read_b64_tr_b16 v[236:237], v14 offset:36864
ds_read_b64_tr_b16 v[238:239], v14 offset:37376
v_mfma_f32_16x16x32_bf16 v[64:67], v[104:107], v[212:215], v[64:67]
ds_read_b64_tr_b16 v[240:241], v15 offset:36864
ds_read_b64_tr_b16 v[242:243], v15 offset:37376
v_mfma_f32_16x16x32_bf16 v[80:83], v[104:107], v[216:219], v[80:83]
buffer_load_dwordx4 v[184:187], v39, s[32:35], s57 offen offset:1024 sc1
v_mfma_f32_16x16x32_bf16 v[68:71], v[108:111], v[212:215], v[68:71]
ds_read_b64_tr_b16 v[244:245], v16 offset:36864
ds_read_b64_tr_b16 v[246:247], v16 offset:37376
v_mfma_f32_16x16x32_bf16 v[84:87], v[108:111], v[216:219], v[84:87]
ds_read_b64_tr_b16 v[248:249], v17 offset:36864
ds_read_b64_tr_b16 v[250:251], v17 offset:37376
v_mfma_f32_16x16x32_bf16 v[72:75], v[112:115], v[212:215], v[72:75]
s_add_u32 s57, s57, 2048
s_and_b32 s57, s57, 0x7fff
v_mfma_f32_16x16x32_bf16 v[88:91], v[112:115], v[216:219], v[88:91]
s_waitcnt vmcnt(6) lgkmcnt(8)
v_mfma_f32_16x16x32_bf16 v[60:63], v[220:223], v[156:159], v[60:63]
buffer_load_dwordx4 v[188:191], v38, s[32:35], s57 offen sc1
v_mfma_f32_16x16x32_bf16 v[76:79], v[220:223], v[160:163], v[76:79]
ds_read_b64_tr_b16 v[100:101], v14 offset:40960
ds_read_b64_tr_b16 v[102:103], v14 offset:41472
v_mfma_f32_16x16x32_bf16 v[64:67], v[224:227], v[156:159], v[64:67]
ds_read_b64_tr_b16 v[104:105], v15 offset:40960
ds_read_b64_tr_b16 v[106:107], v15 offset:41472
v_mfma_f32_16x16x32_bf16 v[80:83], v[224:227], v[160:163], v[80:83]
buffer_load_dwordx4 v[192:195], v39, s[32:35], s57 offen sc1
v_mfma_f32_16x16x32_bf16 v[68:71], v[228:231], v[156:159], v[68:71]
ds_read_b64_tr_b16 v[108:109], v16 offset:40960
ds_read_b64_tr_b16 v[110:111], v16 offset:41472
v_mfma_f32_16x16x32_bf16 v[84:87], v[228:231], v[160:163], v[84:87]
ds_read_b64_tr_b16 v[112:113], v17 offset:40960
ds_read_b64_tr_b16 v[114:115], v17 offset:41472
v_mfma_f32_16x16x32_bf16 v[72:75], v[232:235], v[156:159], v[72:75]
v_mfma_f32_16x16x32_bf16 v[88:91], v[232:235], v[160:163], v[88:91]
s_waitcnt vmcnt(6) lgkmcnt(8)
v_mfma_f32_16x16x32_bf16 v[60:63], v[236:239], v[164:167], v[60:63]
buffer_load_dwordx4 v[196:199], v38, s[32:35], s57 offen offset:1024 sc1
v_mfma_f32_16x16x32_bf16 v[76:79], v[236:239], v[168:171], v[76:79]
ds_read_b64_tr_b16 v[220:221], v14 offset:45056
ds_read_b64_tr_b16 v[222:223], v14 offset:45568
v_mfma_f32_16x16x32_bf16 v[64:67], v[240:243], v[164:167], v[64:67]
ds_read_b64_tr_b16 v[224:225], v15 offset:45056
ds_read_b64_tr_b16 v[226:227], v15 offset:45568
v_mfma_f32_16x16x32_bf16 v[80:83], v[240:243], v[168:171], v[80:83]
buffer_load_dwordx4 v[200:203], v39, s[32:35], s57 offen offset:1024 sc1
v_mfma_f32_16x16x32_bf16 v[68:71], v[244:247], v[164:167], v[68:71]
ds_read_b64_tr_b16 v[228:229], v16 offset:45056
ds_read_b64_tr_b16 v[230:231], v16 offset:45568
v_mfma_f32_16x16x32_bf16 v[84:87], v[244:247], v[168:171], v[84:87]
ds_read_b64_tr_b16 v[232:233], v17 offset:45056
ds_read_b64_tr_b16 v[234:235], v17 offset:45568
v_mfma_f32_16x16x32_bf16 v[72:75], v[248:251], v[164:167], v[72:75]
s_add_u32 s57, s57, 2048
s_and_b32 s57, s57, 0x7fff
v_mfma_f32_16x16x32_bf16 v[88:91], v[248:251], v[168:171], v[88:91]
s_waitcnt vmcnt(6) lgkmcnt(8)
v_mfma_f32_16x16x32_bf16 v[60:63], v[100:103], v[172:175], v[60:63]
buffer_load_dwordx4 v[204:207], v38, s[32:35], s57 offen sc1
v_mfma_f32_16x16x32_bf16 v[76:79], v[100:103], v[176:179], v[76:79]
ds_read_b64_tr_b16 v[236:237], v14 offset:49152
ds_read_b64_tr_b16 v[238:239], v14 offset:49664
v_mfma_f32_16x16x32_bf16 v[64:67], v[104:107], v[172:175], v[64:67]
ds_read_b64_tr_b16 v[240:241], v15 offset:49152
ds_read_b64_tr_b16 v[242:243], v15 offset:49664
v_mfma_f32_16x16x32_bf16 v[80:83], v[104:107], v[176:179], v[80:83]
buffer_load_dwordx4 v[208:211], v39, s[32:35], s57 offen sc1
v_mfma_f32_16x16x32_bf16 v[68:71], v[108:111], v[172:175], v[68:71]
ds_read_b64_tr_b16 v[244:245], v16 offset:49152
ds_read_b64_tr_b16 v[246:247], v16 offset:49664
v_mfma_f32_16x16x32_bf16 v[84:87], v[108:111], v[176:179], v[84:87]
ds_read_b64_tr_b16 v[248:249], v17 offset:49152
ds_read_b64_tr_b16 v[250:251], v17 offset:49664
v_mfma_f32_16x16x32_bf16 v[72:75], v[112:115], v[172:175], v[72:75]
v_mfma_f32_16x16x32_bf16 v[88:91], v[112:115], v[176:179], v[88:91]
s_waitcnt vmcnt(6) lgkmcnt(8)
v_mfma_f32_16x16x32_bf16 v[60:63], v[220:223], v[180:183], v[60:63]
buffer_load_dwordx4 v[212:215], v38, s[32:35], s57 offen offset:1024 sc1
v_mfma_f32_16x16x32_bf16 v[76:79], v[220:223], v[184:187], v[76:79]
ds_read_b64_tr_b16 v[100:101], v14 offset:53248
ds_read_b64_tr_b16 v[102:103], v14 offset:53760
v_mfma_f32_16x16x32_bf16 v[64:67], v[224:227], v[180:183], v[64:67]
ds_read_b64_tr_b16 v[104:105], v15 offset:53248
ds_read_b64_tr_b16 v[106:107], v15 offset:53760
v_mfma_f32_16x16x32_bf16 v[80:83], v[224:227], v[184:187], v[80:83]
buffer_load_dwordx4 v[216:219], v39, s[32:35], s57 offen offset:1024 sc1
v_mfma_f32_16x16x32_bf16 v[68:71], v[228:231], v[180:183], v[68:71]
ds_read_b64_tr_b16 v[108:109], v16 offset:53248
ds_read_b64_tr_b16 v[110:111], v16 offset:53760
v_mfma_f32_16x16x32_bf16 v[84:87], v[228:231], v[184:187], v[84:87]
ds_read_b64_tr_b16 v[112:113], v17 offset:53248
ds_read_b64_tr_b16 v[114:115], v17 offset:53760
v_mfma_f32_16x16x32_bf16 v[72:75], v[232:235], v[180:183], v[72:75]
v_mfma_f32_16x16x32_bf16 v[88:91], v[232:235], v[184:187], v[88:91]
s_waitcnt vmcnt(6) lgkmcnt(8)
v_mfma_f32_16x16x32_bf16 v[60:63], v[236:239], v[188:191], v[60:63]
v_mfma_f32_16x16x32_bf16 v[76:79], v[236:239], v[192:195], v[76:79]
ds_read_b64_tr_b16 v[220:221], v14 offset:57344
ds_read_b64_tr_b16 v[222:223], v14 offset:57856
v_mfma_f32_16x16x32_bf16 v[64:67], v[240:243], v[188:191], v[64:67]
ds_read_b64_tr_b16 v[224:225], v15 offset:57344
ds_read_b64_tr_b16 v[226:227], v15 offset:57856
v_mfma_f32_16x16x32_bf16 v[80:83], v[240:243], v[192:195], v[80:83]
v_mfma_f32_16x16x32_bf16 v[68:71], v[244:247], v[188:191], v[68:71]
ds_read_b64_tr_b16 v[228:229], v16 offset:57344
ds_read_b64_tr_b16 v[230:231], v16 offset:57856
v_mfma_f32_16x16x32_bf16 v[84:87], v[244:247], v[192:195], v[84:87]
ds_read_b64_tr_b16 v[232:233], v17 offset:57344
ds_read_b64_tr_b16 v[234:235], v17 offset:57856
v_mfma_f32_16x16x32_bf16 v[72:75], v[248:251], v[188:191], v[72:75]
v_mfma_f32_16x16x32_bf16 v[88:91], v[248:251], v[192:195], v[88:91]
s_waitcnt vmcnt(4) lgkmcnt(8)
v_mfma_f32_16x16x32_bf16 v[60:63], v[100:103], v[196:199], v[60:63]
v_mfma_f32_16x16x32_bf16 v[76:79], v[100:103], v[200:203], v[76:79]
ds_read_b64_tr_b16 v[236:237], v14 offset:61440
ds_read_b64_tr_b16 v[238:239], v14 offset:61952
v_mfma_f32_16x16x32_bf16 v[64:67], v[104:107], v[196:199], v[64:67]
ds_read_b64_tr_b16 v[240:241], v15 offset:61440
ds_read_b64_tr_b16 v[242:243], v15 offset:61952
v_mfma_f32_16x16x32_bf16 v[80:83], v[104:107], v[200:203], v[80:83]
v_mfma_f32_16x16x32_bf16 v[68:71], v[108:111], v[196:199], v[68:71]
ds_read_b64_tr_b16 v[244:245], v16 offset:61440
ds_read_b64_tr_b16 v[246:247], v16 offset:61952
v_mfma_f32_16x16x32_bf16 v[84:87], v[108:111], v[200:203], v[84:87]
ds_read_b64_tr_b16 v[248:249], v17 offset:61440
ds_read_b64_tr_b16 v[250:251], v17 offset:61952
v_mfma_f32_16x16x32_bf16 v[72:75], v[112:115], v[196:199], v[72:75]
v_mfma_f32_16x16x32_bf16 v[88:91], v[112:115], v[200:203], v[88:91]
s_waitcnt vmcnt(2) lgkmcnt(8)
v_mfma_f32_16x16x32_bf16 v[60:63], v[220:223], v[204:207], v[60:63]
v_mfma_f32_16x16x32_bf16 v[76:79], v[220:223], v[208:211], v[76:79]
v_mfma_f32_16x16x32_bf16 v[64:67], v[224:227], v[204:207], v[64:67]
v_mfma_f32_16x16x32_bf16 v[80:83], v[224:227], v[208:211], v[80:83]
v_mfma_f32_16x16x32_bf16 v[68:71], v[228:231], v[204:207], v[68:71]
v_mfma_f32_16x16x32_bf16 v[84:87], v[228:231], v[208:211], v[84:87]
v_mfma_f32_16x16x32_bf16 v[72:75], v[232:235], v[204:207], v[72:75]
v_mfma_f32_16x16x32_bf16 v[88:91], v[232:235], v[208:211], v[88:91]
s_waitcnt vmcnt(0) lgkmcnt(0)
v_mfma_f32_16x16x32_bf16 v[60:63], v[236:239], v[212:215], v[60:63]
v_mfma_f32_16x16x32_bf16 v[64:67], v[240:243], v[212:215], v[64:67]
v_mfma_f32_16x16x32_bf16 v[68:71], v[244:247], v[212:215], v[68:71]
v_mfma_f32_16x16x32_bf16 v[72:75], v[248:251], v[212:215], v[72:75]
v_mfma_f32_16x16x32_bf16 v[76:79], v[236:239], v[216:219], v[76:79]
v_mfma_f32_16x16x32_bf16 v[80:83], v[240:243], v[216:219], v[80:83]
v_mfma_f32_16x16x32_bf16 v[84:87], v[244:247], v[216:219], v[84:87]
v_mfma_f32_16x16x32_bf16 v[88:91], v[248:251], v[216:219], v[88:91]
s_cmp_eq_u32 s46, 0
s_cbranch_scc1 slow_91
s_nop 0
v_cvt_pk_bf16_f32 v20, v60, v61
v_cvt_pk_bf16_f32 v21, v62, v63
v_cvt_pk_bf16_f32 v22, v64, v65
v_cvt_pk_bf16_f32 v23, v66, v67
buffer_store_dwordx4 v[20:23], v18, s[32:35], s85 offen offset:0
v_cvt_pk_bf16_f32 v24, v68, v69
v_cvt_pk_bf16_f32 v25, v70, v71
v_cvt_pk_bf16_f32 v26, v72, v73
v_cvt_pk_bf16_f32 v27, v74, v75
buffer_store_dwordx4 v[24:27], v18, s[32:35], s85 offen offset:1024
v_cvt_pk_bf16_f32 v28, v76, v77
v_cvt_pk_bf16_f32 v29, v78, v79
v_cvt_pk_bf16_f32 v30, v80, v81
v_cvt_pk_bf16_f32 v31, v82, v83
buffer_store_dwordx4 v[28:31], v18, s[32:35], s86 offen offset:0
v_cvt_pk_bf16_f32 v32, v84, v85
v_cvt_pk_bf16_f32 v33, v86, v87
v_cvt_pk_bf16_f32 v34, v88, v89
v_cvt_pk_bf16_f32 v35, v90, v91
buffer_store_dwordx4 v[32:35], v18, s[32:35], s86 offen offset:1024
s_barrier
v_dot2c_f32_bf16 v6, v20, v48
v_dot2c_f32_bf16 v8, v20, v20
v_dot2c_f32_bf16 v7, v28, v48
v_dot2c_f32_bf16 v9, v28, v28
v_dot2c_f32_bf16 v6, v21, v48
v_dot2c_f32_bf16 v8, v21, v21
v_dot2c_f32_bf16 v7, v29, v48
v_dot2c_f32_bf16 v9, v29, v29
v_dot2c_f32_bf16 v6, v22, v48
v_dot2c_f32_bf16 v8, v22, v22
v_dot2c_f32_bf16 v7, v30, v48
v_dot2c_f32_bf16 v9, v30, v30
v_dot2c_f32_bf16 v6, v23, v48
v_dot2c_f32_bf16 v8, v23, v23
v_dot2c_f32_bf16 v7, v31, v48
v_dot2c_f32_bf16 v9, v31, v31
v_dot2c_f32_bf16 v6, v24, v48
v_dot2c_f32_bf16 v8, v24, v24
v_dot2c_f32_bf16 v7, v32, v48
v_dot2c_f32_bf16 v9, v32, v32
v_dot2c_f32_bf16 v6, v25, v48
v_dot2c_f32_bf16 v8, v25, v25
v_dot2c_f32_bf16 v7, v33, v48
v_dot2c_f32_bf16 v9, v33, v33
v_dot2c_f32_bf16 v6, v26, v48
v_dot2c_f32_bf16 v8, v26, v26
v_dot2c_f32_bf16 v7, v34, v48
v_dot2c_f32_bf16 v9, v34, v34
v_dot2c_f32_bf16 v6, v27, v48
v_dot2c_f32_bf16 v8, v27, v27
v_dot2c_f32_bf16 v7, v35, v48
v_dot2c_f32_bf16 v9, v35, v35
s_mov_b64 exec, 1
s_waitcnt vmcnt(0)
buffer_store_dword v5, v4, s[32:35], s88 offen
s_mov_b64 exec, -1
s_nop 1
v_permlane32_swap_b32 v6, v7
v_permlane32_swap_b32 v8, v9
v_add_f32 v6, v6, v7
v_add_f32 v8, v8, v9
s_nop 1
v_permlane16_swap_b32 v6, v8
s_nop 0
v_add_f32 v6, v6, v8
buffer_store_dword v6, v1, s[32:35], s87 offen
back_92:
s_lshl_b32 s49, s44, 13
v_add_u32 v10, s49, v18
v_add_u32 v11, 1024, v10
s_lshl_b32 s48, s43, 1
v_lshrrev_b32 v4, 2, v2
v_and_b32 v5, 3, v0
v_lshl_add_u32 v6, v3, 3, v4
v_lshlrev_b32 v6, 7, v6
v_lshl_add_u32 v6, v5, 3, v6
v_lshrrev_b32 v7, 1, v4
v_and_b32 v8, 1, v3
v_lshl_add_u32 v7, v8, 1, v7
v_xor_b32 v7, s48, v7
v_lshl_add_u32 v12, v7, 5, v6
v_add_u32 v12, 16384, v12
v_xor_b32 v13, 32, v12
v_mov_b32 v14, v10
v_mov_b32 v15, v11
v_add_u32 v16, 122880, v12
v_add_u32 v17, 122880, v13
v_mov_b32 v156, 0
v_mov_b32 v157, 0
v_mov_b32 v158, 0
v_mov_b32 v159, 0
v_mov_b32 v160, 0
v_mov_b32 v161, 0
v_mov_b32 v162, 0
v_mov_b32 v163, 0
v_mov_b32 v164, 0
v_mov_b32 v165, 0
v_mov_b32 v166, 0
v_mov_b32 v167, 0
v_mov_b32 v168, 0
v_mov_b32 v169, 0
v_mov_b32 v170, 0
v_mov_b32 v171, 0
v_mov_b32 v172, 0
v_mov_b32 v173, 0
v_mov_b32 v174, 0
v_mov_b32 v175, 0
v_mov_b32 v176, 0
v_mov_b32 v177, 0
v_mov_b32 v178, 0
v_mov_b32 v179, 0
v_mov_b32 v180, 0
v_mov_b32 v181, 0
v_mov_b32 v182, 0
v_mov_b32 v183, 0
v_mov_b32 v184, 0
v_mov_b32 v185, 0
v_mov_b32 v186, 0
v_mov_b32 v187, 0
v_mov_b32 v188, 0
v_mov_b32 v189, 0
v_mov_b32 v190, 0
v_mov_b32 v191, 0
v_mov_b32 v192, 0
v_mov_b32 v193, 0
v_mov_b32 v194, 0
v_mov_b32 v195, 0
v_mov_b32 v196, 0
v_mov_b32 v197, 0
v_mov_b32 v198, 0
v_mov_b32 v199, 0
v_mov_b32 v200, 0
v_mov_b32 v201, 0
v_mov_b32 v202, 0
v_mov_b32 v203, 0
v_mov_b32 v204, 0
v_mov_b32 v205, 0
v_mov_b32 v206, 0
v_mov_b32 v207, 0
v_mov_b32 v208, 0
v_mov_b32 v209, 0
v_mov_b32 v210, 0
v_mov_b32 v211, 0
v_mov_b32 v212, 0
v_mov_b32 v213, 0
v_mov_b32 v214, 0
v_mov_b32 v215, 0
v_mov_b32 v216, 0
v_mov_b32 v217, 0
v_mov_b32 v218, 0
v_mov_b32 v219, 0
v_mov_b32 v220, 0
v_mov_b32 v221, 0
v_mov_b32 v222, 0
v_mov_b32 v223, 0
v_mov_b32 v224, 0
v_mov_b32 v225, 0
v_mov_b32 v226, 0
v_mov_b32 v227, 0
v_mov_b32 v228, 0
v_mov_b32 v229, 0
v_mov_b32 v230, 0
v_mov_b32 v231, 0
v_mov_b32 v232, 0
v_mov_b32 v233, 0
v_mov_b32 v234, 0
v_mov_b32 v235, 0
v_mov_b32 v236, 0
v_mov_b32 v237, 0
v_mov_b32 v238, 0
v_mov_b32 v239, 0
v_mov_b32 v240, 0
v_mov_b32 v241, 0
v_mov_b32 v242, 0
v_mov_b32 v243, 0
v_mov_b32 v244, 0
v_mov_b32 v245, 0
v_mov_b32 v246, 0
v_mov_b32 v247, 0
v_mov_b32 v248, 0
v_mov_b32 v249, 0
v_mov_b32 v250, 0
v_mov_b32 v251, 0
v_lshrrev_b32 v6, 2, v2
v_cmp_eq_u32 vcc, v6, v3
v_and_b32 v7, 1, v0
v_lshlrev_b32 v7, 4, v7
v_mov_b32 v8, 0x3f80
v_lshlrev_b32 v9, v7, v8
v_cndmask_b32 v7, 0, v9, vcc
v_and_b32 v6, 2, v0
v_cmp_eq_u32 vcc, 0, v6
v_mov_b32 v36, 0
v_mov_b32 v37, 0
v_mov_b32 v40, 0
v_mov_b32 v41, 0
v_cndmask_b32 v38, 0, v7, vcc
v_cndmask_b32 v39, v7, 0, vcc
v_lshrrev_b32 v8, 1, v2
v_cmp_eq_u32 vcc, 0, v8
s_nop 1
v_cndmask_b32 v44, 0, v9, vcc
v_cmp_eq_u32 vcc, 1, v8
s_nop 1
v_cndmask_b32 v45, 0, v9, vcc
v_cmp_eq_u32 vcc, 2, v8
s_nop 1
v_cndmask_b32 v46, 0, v9, vcc
v_cmp_eq_u32 vcc, 3, v8
s_nop 1
v_cndmask_b32 v47, 0, v9, vcc
v_lshrrev_b32 v4, 2, v2
v_lshl_add_u32 v4, v3, 2, v4
v_lshlrev_b32 v4, 6, v4
v_and_b32 v5, 3, v0
v_lshl_add_u32 v4, v5, 3, v4
s_lshl_b32 s48, s43, 11
s_add_u32 s48, s48, 135168
v_add_u32 v53, s48, v4
s_mul_i32 s48, s40, 3072
s_add_u32 s48, s48, 139264
v_add_u32 v42, s48, v18
s_xor_b32 s49, s40, 2
s_mul_i32 s48, s49, 3072
s_add_u32 s48, s48, 139264
v_add_u32 v43, s48, v18
s_lshl_b32 s49, s49, 2
s_add_u32 s49, s49, 134672
v_mov_b32 v19, s49
v_xor_b32 v52, 8, v19
v_lshrrev_b32 v4, 3, v0
v_and_b32 v5, 7, v0
v_lshlrev_b32 v4, 11, v4
v_lshl_add_u32 v55, v5, 4, v4
v_lshlrev_b32 v4, 6, v2
v_lshl_add_u32 v58, v3, 4, v4
v_lshlrev_b32 v4, 4, v2
v_lshl_add_u32 v59, v3, 3, v4
s_mul_i32 s51, s42, 393216
s_add_u32 s51, s51, 9437184
s_lshl_b32 s50, s43, 1
s_add_u32 s50, s50, s44
s_lshl_b32 s48, s50, 15
s_add_u32 s48, s48, s51
s_add_u32 s48, s48, 131072
s_lshl_b32 s49, s41, 7
s_add_u32 s53, s48, s49
s_add_u32 s54, s53, 16384
s_lshl_b32 s56, s50, 10
s_add_u32 s56, s56, s51
s_add_u32 s56, s56, 348160
s_xor_b32 s57, s56, 1024
s_lshl_b32 s58, s50, 11
s_add_u32 s58, s58, s51
s_add_u32 s58, s58, 335872
s_xor_b32 s59, s58, 2048
s_add_u32 s79, s58, s49
s_lshl_b32 s50, s41, 11
s_add_u32 s55, s48, s50
s_lshl_b32 s48, s43, 7
s_add_u32 s48, s48, 133888
v_lshl_add_u32 v7, v3, 4, s48
v_lshl_add_u32 v54, v2, 2, s48
s_lshl_b32 s49, s44, 6
v_add_u32 v8, s49, v2
v_lshlrev_b32 v8, 3, v8
v_add_u32 v8, 131072, v8
v_lshl_add_u32 v9, v3, 2, s49
v_lshlrev_b32 v9, 2, v9
v_add_u32 v9, 132096, v9
s_mov_b32 s64, 0
s_mov_b32 s65, 0
s_mov_b32 s66, 0x3fb8aa3b
s_barrier
ds_read_b128 v[60:63], v14 offset:0
ds_read_b128 v[64:67], v14 offset:2048
ds_read_b128 v[68:71], v14 offset:4096
ds_read_b128 v[72:75], v14 offset:6144
ds_read_b64_tr_b16 v[84:85], v16 offset:8192
ds_read_b64_tr_b16 v[86:87], v16 offset:8704
ds_read_b64_tr_b16 v[88:89], v17 offset:8192
ds_read_b64_tr_b16 v[90:91], v17 offset:8704
ds_read_b64_tr_b16 v[92:93], v16 offset:16384
ds_read_b64_tr_b16 v[94:95], v16 offset:16896
ds_read_b64_tr_b16 v[96:97], v17 offset:16384
ds_read_b64_tr_b16 v[98:99], v17 offset:16896
ds_read_b64_tr_b16 v[76:77], v16 offset:0
ds_read_b64_tr_b16 v[78:79], v16 offset:512
ds_read_b64_tr_b16 v[80:81], v17 offset:0
ds_read_b64_tr_b16 v[82:83], v17 offset:512
s_waitcnt lgkmcnt(0)
c3_loop:
v_mfma_f32_16x16x32_bf16 v[212:215], v[84:87], v[72:75], v[212:215]
ds_read_b128 v[100:103], v15 offset:0
v_mfma_f32_16x16x32_bf16 v[204:207], v[84:87], v[68:71], v[204:207]
ds_read_b128 v[104:107], v15 offset:2048
v_mfma_f32_16x16x32_bf16 v[196:199], v[84:87], v[64:67], v[196:199]
ds_read_b128 v[108:111], v15 offset:4096
v_mfma_f32_16x16x32_bf16 v[188:191], v[84:87], v[60:63], v[188:191]
ds_read_b128 v[112:115], v15 offset:6144
v_mfma_f32_16x16x32_bf16 v[192:195], v[88:91], v[60:63], v[192:195]
ds_read_b64_tr_b16 v[124:125], v16 offset:12288
v_mfma_f32_16x16x32_bf16 v[200:203], v[88:91], v[64:67], v[200:203]
ds_read_b64_tr_b16 v[126:127], v16 offset:12800
v_mfma_f32_16x16x32_bf16 v[208:211], v[88:91], v[68:71], v[208:211]
ds_read_b64_tr_b16 v[128:129], v17 offset:12288
v_mfma_f32_16x16x32_bf16 v[216:219], v[88:91], v[72:75], v[216:219]
ds_read_b64_tr_b16 v[130:131], v17 offset:12800
v_mfma_f32_16x16x32_bf16 v[244:247], v[72:75], v[92:95], v[244:247]
ds_read_b64_tr_b16 v[132:133], v16 offset:20480
v_mfma_f32_16x16x32_bf16 v[236:239], v[68:71], v[92:95], v[236:239]
ds_read_b64_tr_b16 v[134:135], v16 offset:20992
v_mfma_f32_16x16x32_bf16 v[228:231], v[64:67], v[92:95], v[228:231]
ds_read_b64_tr_b16 v[136:137], v17 offset:20480
v_mfma_f32_16x16x32_bf16 v[220:223], v[60:63], v[92:95], v[220:223]
ds_read_b64_tr_b16 v[138:139], v17 offset:20992
v_mfma_f32_16x16x32_bf16 v[224:227], v[60:63], v[96:99], v[224:227]
ds_read_b64_tr_b16 v[116:117], v16 offset:4096
v_mfma_f32_16x16x32_bf16 v[232:235], v[64:67], v[96:99], v[232:235]
ds_read_b64_tr_b16 v[118:119], v16 offset:4608
v_mfma_f32_16x16x32_bf16 v[240:243], v[68:71], v[96:99], v[240:243]
ds_read_b64_tr_b16 v[120:121], v17 offset:4096
v_mfma_f32_16x16x32_bf16 v[248:251], v[72:75], v[96:99], v[248:251]
ds_read_b64_tr_b16 v[122:123], v17 offset:4608
v_mfma_f32_16x16x32_bf16 v[180:183], v[76:79], v[72:75], v[180:183]
s_add_u32 s65, s65, 40960
s_cmp_eq_u32 s65, 122880
v_mfma_f32_16x16x32_bf16 v[172:175], v[76:79], v[68:71], v[172:175]
s_cselect_b32 s65, 0, s65
s_add_u32 s64, s64, 1
v_mfma_f32_16x16x32_bf16 v[164:167], v[76:79], v[64:67], v[164:167]
v_add_u32 v14, s65, v10
v_add_u32 v15, s65, v11
v_mfma_f32_16x16x32_bf16 v[156:159], v[76:79], v[60:63], v[156:159]
v_add_u32 v16, s65, v12
v_add_u32 v17, s65, v13
v_mfma_f32_16x16x32_bf16 v[160:163], v[80:83], v[60:63], v[160:163]
v_mfma_f32_16x16x32_bf16 v[168:171], v[80:83], v[64:67], v[168:171]
s_cmp_eq_u32 s64, 16
s_cbranch_scc1 c3_last
v_mfma_f32_16x16x32_bf16 v[176:179], v[80:83], v[68:71], v[176:179]
s_waitcnt lgkmcnt(0)
v_mfma_f32_16x16x32_bf16 v[184:187], v[80:83], v[72:75], v[184:187]
s_barrier
v_mfma_f32_16x16x32_bf16 v[212:215], v[124:127], v[112:115], v[212:215]
ds_read_b128 v[60:63], v14 offset:0
v_mfma_f32_16x16x32_bf16 v[204:207], v[124:127], v[108:111], v[204:207]
ds_read_b128 v[64:67], v14 offset:2048
v_mfma_f32_16x16x32_bf16 v[196:199], v[124:127], v[104:107], v[196:199]
ds_read_b128 v[68:71], v14 offset:4096
v_mfma_f32_16x16x32_bf16 v[188:191], v[124:127], v[100:103], v[188:191]
ds_read_b128 v[72:75], v14 offset:6144
v_mfma_f32_16x16x32_bf16 v[192:195], v[128:131], v[100:103], v[192:195]
ds_read_b64_tr_b16 v[84:85], v16 offset:8192
v_mfma_f32_16x16x32_bf16 v[200:203], v[128:131], v[104:107], v[200:203]
ds_read_b64_tr_b16 v[86:87], v16 offset:8704
v_mfma_f32_16x16x32_bf16 v[208:211], v[128:131], v[108:111], v[208:211]
ds_read_b64_tr_b16 v[88:89], v17 offset:8192
v_mfma_f32_16x16x32_bf16 v[216:219], v[128:131], v[112:115], v[216:219]
ds_read_b64_tr_b16 v[90:91], v17 offset:8704
v_mfma_f32_16x16x32_bf16 v[244:247], v[112:115], v[132:135], v[244:247]
ds_read_b64_tr_b16 v[92:93], v16 offset:16384
v_mfma_f32_16x16x32_bf16 v[236:239], v[108:111], v[132:135], v[236:239]
ds_read_b64_tr_b16 v[94:95], v16 offset:16896
v_mfma_f32_16x16x32_bf16 v[228:231], v[104:107], v[132:135], v[228:231]
ds_read_b64_tr_b16 v[96:97], v17 offset:16384
v_mfma_f32_16x16x32_bf16 v[220:223], v[100:103], v[132:135], v[220:223]
ds_read_b64_tr_b16 v[98:99], v17 offset:16896
v_mfma_f32_16x16x32_bf16 v[224:227], v[100:103], v[136:139], v[224:227]
ds_read_b64_tr_b16 v[76:77], v16 offset:0
v_mfma_f32_16x16x32_bf16 v[232:235], v[104:107], v[136:139], v[232:235]
ds_read_b64_tr_b16 v[78:79], v16 offset:512
v_mfma_f32_16x16x32_bf16 v[240:243], v[108:111], v[136:139], v[240:243]
ds_read_b64_tr_b16 v[80:81], v17 offset:0
v_mfma_f32_16x16x32_bf16 v[248:251], v[112:115], v[136:139], v[248:251]
ds_read_b64_tr_b16 v[82:83], v17 offset:512
v_mfma_f32_16x16x32_bf16 v[180:183], v[116:119], v[112:115], v[180:183]
v_mfma_f32_16x16x32_bf16 v[172:175], v[116:119], v[108:111], v[172:175]
v_mfma_f32_16x16x32_bf16 v[164:167], v[116:119], v[104:107], v[164:167]
v_mfma_f32_16x16x32_bf16 v[156:159], v[116:119], v[100:103], v[156:159]
v_mfma_f32_16x16x32_bf16 v[160:163], v[120:123], v[100:103], v[160:163]
v_mfma_f32_16x16x32_bf16 v[168:171], v[120:123], v[104:107], v[168:171]
v_mfma_f32_16x16x32_bf16 v[176:179], v[120:123], v[108:111], v[176:179]
s_waitcnt lgkmcnt(0)
v_mfma_f32_16x16x32_bf16 v[184:187], v[120:123], v[112:115], v[184:187]
s_branch c3_loop
c3_last:
v_mfma_f32_16x16x32_bf16 v[176:179], v[80:83], v[68:71], v[176:179]
s_waitcnt lgkmcnt(0)
v_mfma_f32_16x16x32_bf16 v[184:187], v[80:83], v[72:75], v[184:187]
s_barrier
v_mfma_f32_16x16x32_bf16 v[212:215], v[124:127], v[112:115], v[212:215]
ds_read_b128 v[140:143], v7 offset:0
v_mfma_f32_16x16x32_bf16 v[204:207], v[124:127], v[108:111], v[204:207]
ds_read_b128 v[144:147], v7 offset:64
v_mfma_f32_16x16x32_bf16 v[196:199], v[124:127], v[104:107], v[196:199]
ds_read_b128 v[148:151], v7 offset:256
v_mfma_f32_16x16x32_bf16 v[188:191], v[124:127], v[100:103], v[188:191]
ds_read_b128 v[152:155], v7 offset:320
v_mfma_f32_16x16x32_bf16 v[192:195], v[128:131], v[100:103], v[192:195]
ds_read_b64 v[92:93], v8 offset:0
v_mfma_f32_16x16x32_bf16 v[200:203], v[128:131], v[104:107], v[200:203]
ds_read_b64 v[94:95], v8 offset:128
v_mfma_f32_16x16x32_bf16 v[208:211], v[128:131], v[108:111], v[208:211]
ds_read_b64 v[96:97], v8 offset:256
v_mfma_f32_16x16x32_bf16 v[216:219], v[128:131], v[112:115], v[216:219]
ds_read_b64 v[98:99], v8 offset:384
v_mfma_f32_16x16x32_bf16 v[244:247], v[112:115], v[132:135], v[244:247]
ds_read2_b32 v[56:57], v54 offset0:128 offset1:144
v_mfma_f32_16x16x32_bf16 v[236:239], v[108:111], v[132:135], v[236:239]
ds_read_b128 v[60:63], v9 offset:0
v_mfma_f32_16x16x32_bf16 v[228:231], v[104:107], v[132:135], v[228:231]
ds_read_b128 v[64:67], v9 offset:64
v_mfma_f32_16x16x32_bf16 v[220:223], v[100:103], v[132:135], v[220:223]
ds_read_b128 v[68:71], v9 offset:128
v_mfma_f32_16x16x32_bf16 v[224:227], v[100:103], v[136:139], v[224:227]
ds_read_b128 v[72:75], v9 offset:192
v_mfma_f32_16x16x32_bf16 v[232:235], v[104:107], v[136:139], v[232:235]
ds_read_b128 v[76:79], v9 offset:512
v_mfma_f32_16x16x32_bf16 v[240:243], v[108:111], v[136:139], v[240:243]
ds_read_b128 v[80:83], v9 offset:576
v_mfma_f32_16x16x32_bf16 v[248:251], v[112:115], v[136:139], v[248:251]
ds_read_b128 v[84:87], v9 offset:640
v_mfma_f32_16x16x32_bf16 v[180:183], v[116:119], v[112:115], v[180:183]
ds_read_b128 v[88:91], v9 offset:704
v_mfma_f32_16x16x32_bf16 v[172:175], v[116:119], v[108:111], v[172:175]
ds_read_b64_tr_b16 v[10:11], v53 offset:0
v_mfma_f32_16x16x32_bf16 v[164:167], v[116:119], v[104:107], v[164:167]
ds_read_b64_tr_b16 v[12:13], v53 offset:1024
v_mfma_f32_16x16x32_bf16 v[156:159], v[116:119], v[100:103], v[156:159]
ds_read_b64_tr_b16 v[14:15], v53 offset:32
v_mfma_f32_16x16x32_bf16 v[160:163], v[120:123], v[100:103], v[160:163]
ds_read_b64_tr_b16 v[16:17], v53 offset:1056
v_mfma_f32_16x16x32_bf16 v[168:171], v[120:123], v[104:107], v[168:171]
v_mfma_f32_16x16x32_bf16 v[176:179], v[120:123], v[108:111], v[176:179]
v_mfma_f32_16x16x32_bf16 v[184:187], v[120:123], v[112:115], v[184:187]
c3_epi:
s_waitcnt lgkmcnt(0)
s_mul_i32 s48, s44, 0x80008000
v_xor_b32 v10, s48, v10
v_xor_b32 v11, s48, v11
v_xor_b32 v12, s48, v12
v_xor_b32 v13, s48, v13
v_xor_b32 v14, s48, v14
v_xor_b32 v15, s48, v15
v_xor_b32 v16, s48, v16
v_xor_b32 v17, s48, v17
v_mul_f32 v128, s66, v92
v_mul_f32 v129, s66, v94
v_mul_f32 v130, s66, v96
v_mul_f32 v131, s66, v98
.p2align 3
v_pk_fma_f32 v[220:221], v[76:77], v[56:57], v[220:221] op_sel:[0,0,0] op_sel_hi:[1,0,1]
v_pk_fma_f32 v[222:223], v[78:79], v[56:57], v[222:223] op_sel:[0,0,0] op_sel_hi:[1,0,1]
v_pk_mul_f32 v[220:221], v[220:221], v[60:61]
v_pk_mul_f32 v[222:223], v[222:223], v[62:63]
v_cvt_pk_bf16_f32 v112, v220, v221
v_cvt_pk_bf16_f32 v113, v222, v223
v_pk_fma_f32 v[228:229], v[80:81], v[56:57], v[228:229] op_sel:[0,0,0] op_sel_hi:[1,0,1]
v_pk_fma_f32 v[230:231], v[82:83], v[56:57], v[230:231] op_sel:[0,0,0] op_sel_hi:[1,0,1]
v_pk_mul_f32 v[228:229], v[228:229], v[64:65]
v_pk_mul_f32 v[230:231], v[230:231], v[66:67]
v_cvt_pk_bf16_f32 v114, v228, v229
v_cvt_pk_bf16_f32 v115, v230, v231
v_pk_fma_f32 v[236:237], v[84:85], v[56:57], v[236:237] op_sel:[0,0,0] op_sel_hi:[1,0,1]
v_pk_fma_f32 v[238:239], v[86:87], v[56:57], v[238:239] op_sel:[0,0,0] op_sel_hi:[1,0,1]
v_pk_mul_f32 v[236:237], v[236:237], v[68:69]
v_pk_mul_f32 v[238:239], v[238:239], v[70:71]
v_cvt_pk_bf16_f32 v116, v236, v237
v_cvt_pk_bf16_f32 v117, v238, v239
v_pk_fma_f32 v[244:245], v[88:89], v[56:57], v[244:245] op_sel:[0,0,0] op_sel_hi:[1,0,1]
v_pk_fma_f32 v[246:247], v[90:91], v[56:57], v[246:247] op_sel:[0,0,0] op_sel_hi:[1,0,1]
v_pk_mul_f32 v[244:245], v[244:245], v[72:73]
v_pk_mul_f32 v[246:247], v[246:247], v[74:75]
v_cvt_pk_bf16_f32 v118, v244, v245
v_cvt_pk_bf16_f32 v119, v246, v247
v_pk_fma_f32 v[224:225], v[76:77], v[56:57], v[224:225] op_sel:[0,1,0] op_sel_hi:[1,1,1]
v_pk_fma_f32 v[226:227], v[78:79], v[56:57], v[226:227] op_sel:[0,1,0] op_sel_hi:[1,1,1]
v_pk_mul_f32 v[224:225], v[224:225], v[60:61]
v_pk_mul_f32 v[226:227], v[226:227], v[62:63]
v_cvt_pk_bf16_f32 v120, v224, v225
v_cvt_pk_bf16_f32 v121, v226, v227
v_pk_fma_f32 v[232:233], v[80:81], v[56:57], v[232:233] op_sel:[0,1,0] op_sel_hi:[1,1,1]
v_pk_fma_f32 v[234:235], v[82:83], v[56:57], v[234:235] op_sel:[0,1,0] op_sel_hi:[1,1,1]
v_pk_mul_f32 v[232:233], v[232:233], v[64:65]
v_pk_mul_f32 v[234:235], v[234:235], v[66:67]
v_cvt_pk_bf16_f32 v122, v232, v233
v_cvt_pk_bf16_f32 v123, v234, v235
v_pk_fma_f32 v[240:241], v[84:85], v[56:57], v[240:241] op_sel:[0,1,0] op_sel_hi:[1,1,1]
v_pk_fma_f32 v[242:243], v[86:87], v[56:57], v[242:243] op_sel:[0,1,0] op_sel_hi:[1,1,1]
v_pk_mul_f32 v[240:241], v[240:241], v[68:69]
v_pk_mul_f32 v[242:243], v[242:243], v[70:71]
v_cvt_pk_bf16_f32 v124, v240, v241
v_cvt_pk_bf16_f32 v125, v242, v243
v_pk_fma_f32 v[248:249], v[88:89], v[56:57], v[248:249] op_sel:[0,1,0] op_sel_hi:[1,1,1]
v_pk_fma_f32 v[250:251], v[90:91], v[56:57], v[250:251] op_sel:[0,1,0] op_sel_hi:[1,1,1]
v_pk_mul_f32 v[248:249], v[248:249], v[72:73]
v_pk_mul_f32 v[250:251], v[250:251], v[74:75]
v_cvt_pk_bf16_f32 v126, v248, v249
v_cvt_pk_bf16_f32 v127, v250, v251
v_pk_fma_f32 v[188:189], v[148:149], v[92:93], v[188:189] op_sel:[0,1,0] op_sel_hi:[1,1,1]
v_pk_fma_f32 v[190:191], v[150:151], v[92:93], v[190:191] op_sel:[0,1,0] op_sel_hi:[1,1,1]
v_pk_fma_f32 v[192:193], v[152:153], v[92:93], v[192:193] op_sel:[0,1,0] op_sel_hi:[1,1,1]
v_pk_fma_f32 v[194:195], v[154:155], v[92:93], v[194:195] op_sel:[0,1,0] op_sel_hi:[1,1,1]
v_cvt_pk_bf16_f32 v188, v188, v189
v_cvt_pk_bf16_f32 v189, v190, v191
v_cvt_pk_bf16_f32 v190, v192, v193
v_cvt_pk_bf16_f32 v191, v194, v195
v_pk_fma_f32 v[196:197], v[148:149], v[94:95], v[196:197] op_sel:[0,1,0] op_sel_hi:[1,1,1]
v_pk_fma_f32 v[198:199], v[150:151], v[94:95], v[198:199] op_sel:[0,1,0] op_sel_hi:[1,1,1]
v_pk_fma_f32 v[200:201], v[152:153], v[94:95], v[200:201] op_sel:[0,1,0] op_sel_hi:[1,1,1]
v_pk_fma_f32 v[202:203], v[154:155], v[94:95], v[202:203] op_sel:[0,1,0] op_sel_hi:[1,1,1]
v_cvt_pk_bf16_f32 v196, v196, v197
v_mfma_f32_16x16x32_bf16 v[60:63], v[10:13], v[188:191], 0
v_cvt_pk_bf16_f32 v197, v198, v199
v_cvt_pk_bf16_f32 v198, v200, v201
v_mfma_f32_16x16x32_bf16 v[64:67], v[14:17], v[188:191], 0
v_cvt_pk_bf16_f32 v199, v202, v203
v_pk_fma_f32 v[204:205], v[148:149], v[96:97], v[204:205] op_sel:[0,1,0] op_sel_hi:[1,1,1]
v_pk_fma_f32 v[206:207], v[150:151], v[96:97], v[206:207] op_sel:[0,1,0] op_sel_hi:[1,1,1]
v_pk_fma_f32 v[208:209], v[152:153], v[96:97], v[208:209] op_sel:[0,1,0] op_sel_hi:[1,1,1]
v_pk_fma_f32 v[210:211], v[154:155], v[96:97], v[210:211] op_sel:[0,1,0] op_sel_hi:[1,1,1]
v_cvt_pk_bf16_f32 v204, v204, v205
v_mfma_f32_16x16x32_bf16 v[68:71], v[10:13], v[196:199], 0
v_cvt_pk_bf16_f32 v205, v206, v207
v_cvt_pk_bf16_f32 v206, v208, v209
v_mfma_f32_16x16x32_bf16 v[72:75], v[14:17], v[196:199], 0
v_cvt_pk_bf16_f32 v207, v210, v211
v_pk_fma_f32 v[212:213], v[148:149], v[98:99], v[212:213] op_sel:[0,1,0] op_sel_hi:[1,1,1]
v_pk_fma_f32 v[214:215], v[150:151], v[98:99], v[214:215] op_sel:[0,1,0] op_sel_hi:[1,1,1]
v_pk_fma_f32 v[216:217], v[152:153], v[98:99], v[216:217] op_sel:[0,1,0] op_sel_hi:[1,1,1]
v_pk_fma_f32 v[218:219], v[154:155], v[98:99], v[218:219] op_sel:[0,1,0] op_sel_hi:[1,1,1]
v_cvt_pk_bf16_f32 v212, v212, v213
v_mfma_f32_16x16x32_bf16 v[76:79], v[10:13], v[204:207], 0
v_cvt_pk_bf16_f32 v213, v214, v215
v_cvt_pk_bf16_f32 v214, v216, v217
v_mfma_f32_16x16x32_bf16 v[80:83], v[14:17], v[204:207], 0
v_cvt_pk_bf16_f32 v215, v218, v219
s_nop 1
v_mfma_f32_16x16x32_bf16 v[84:87], v[10:13], v[212:215], 0
v_mfma_f32_16x16x32_bf16 v[88:91], v[14:17], v[212:215], 0
v_max3_f32 v100, v60, v61, v62
v_min3_f32 v104, v60, v61, v62
v_max3_f32 v100, v100, v63, v64
v_min3_f32 v104, v104, v63, v64
v_max3_f32 v100, v100, v65, v66
v_min3_f32 v104, v104, v65, v66
v_max_f32 v100, v100, v67
v_min_f32 v104, v104, v67
v_max3_f32 v101, v68, v69, v70
v_min3_f32 v105, v68, v69, v70
v_max3_f32 v101, v101, v71, v72
v_min3_f32 v105, v105, v71, v72
v_max3_f32 v101, v101, v73, v74
v_min3_f32 v105, v105, v73, v74
v_max_f32 v101, v101, v75
v_min_f32 v105, v105, v75
v_max3_f32 v102, v76, v77, v78
v_min3_f32 v106, v76, v77, v78
v_max3_f32 v102, v102, v79, v80
v_min3_f32 v106, v106, v79, v80
v_max3_f32 v102, v102, v81, v82
v_min3_f32 v106, v106, v81, v82
v_max_f32 v102, v102, v83
v_min_f32 v106, v106, v83
v_max3_f32 v103, v84, v85, v86
v_min3_f32 v107, v84, v85, v86
v_max3_f32 v103, v103, v87, v88
v_min3_f32 v107, v107, v87, v88
v_max3_f32 v103, v103, v89, v90
v_min3_f32 v107, v107, v89, v90
v_max_f32 v103, v103, v91
v_min_f32 v107, v107, v91
s_nop 1
v_permlane32_swap_b32 v100, v101
v_permlane32_swap_b32 v102, v103
v_permlane32_swap_b32 v104, v105
v_permlane32_swap_b32 v106, v107
v_max_f32 v100, v100, v101
v_max_f32 v102, v102, v103
v_min_f32 v104, v104, v105
v_min_f32 v106, v106, v107
v_permlane16_swap_b32 v100, v102
s_nop 0
v_permlane16_swap_b32 v104, v106
v_max_f32 v100, v100, v102
v_min_f32 v104, v104, v106
v_mov_b32 v102, v100
v_mov_b32 v106, v104
s_nop 0
v_permlane16_swap_b32 v100, v102
v_permlane16_swap_b32 v104, v106
v_mov_b32 v101, v100
v_mov_b32 v103, v102
v_mov_b32 v105, v104
v_mov_b32 v107, v106
v_permlane32_swap_b32 v100, v101
v_permlane32_swap_b32 v102, v103
v_permlane32_swap_b32 v104, v105
v_permlane32_swap_b32 v106, v107
v_pk_mul_f32 v[100:101], v[100:101], v[128:129]
v_pk_mul_f32 v[102:103], v[102:103], v[130:131]
v_pk_mul_f32 v[104:105], v[104:105], v[128:129]
v_pk_mul_f32 v[106:107], v[106:107], v[130:131]
v_pk_fma_f32 v[220:221], v[60:61], v[128:129], v[104:105] op_sel:[0,0,0] op_sel_hi:[1,0,0] neg_lo:[1,0,0] neg_hi:[1,0,0]
v_pk_fma_f32 v[60:61], v[60:61], v[128:129], v[100:101] op_sel:[0,0,0] op_sel_hi:[1,0,0] neg_lo:[0,0,1] neg_hi:[0,0,1]
v_exp_f32 v220, v220
v_exp_f32 v60, v60
v_exp_f32 v221, v221
v_exp_f32 v61, v61
v_pk_fma_f32 v[222:223], v[62:63], v[128:129], v[104:105] op_sel:[0,0,0] op_sel_hi:[1,0,0] neg_lo:[1,0,0] neg_hi:[1,0,0]
v_pk_fma_f32 v[62:63], v[62:63], v[128:129], v[100:101] op_sel:[0,0,0] op_sel_hi:[1,0,0] neg_lo:[0,0,1] neg_hi:[0,0,1]
v_exp_f32 v222, v222
v_exp_f32 v62, v62
v_exp_f32 v223, v223
v_exp_f32 v63, v63
v_pk_fma_f32 v[224:225], v[64:65], v[128:129], v[104:105] op_sel:[0,0,0] op_sel_hi:[1,0,0] neg_lo:[1,0,0] neg_hi:[1,0,0]
v_pk_fma_f32 v[64:65], v[64:65], v[128:129], v[100:101] op_sel:[0,0,0] op_sel_hi:[1,0,0] neg_lo:[0,0,1] neg_hi:[0,0,1]
v_exp_f32 v224, v224
v_exp_f32 v64, v64
v_exp_f32 v225, v225
v_exp_f32 v65, v65
v_pk_fma_f32 v[226:227], v[66:67], v[128:129], v[104:105] op_sel:[0,0,0] op_sel_hi:[1,0,0] neg_lo:[1,0,0] neg_hi:[1,0,0]
v_pk_fma_f32 v[66:67], v[66:67], v[128:129], v[100:101] op_sel:[0,0,0] op_sel_hi:[1,0,0] neg_lo:[0,0,1] neg_hi:[0,0,1]
v_exp_f32 v226, v226
v_exp_f32 v66, v66
v_exp_f32 v227, v227
v_exp_f32 v67, v67
v_pk_fma_f32 v[228:229], v[68:69], v[128:129], v[104:105] op_sel:[0,1,1] op_sel_hi:[1,1,1] neg_lo:[1,0,0] neg_hi:[1,0,0]
v_pk_fma_f32 v[68:69], v[68:69], v[128:129], v[100:101] op_sel:[0,1,1] op_sel_hi:[1,1,1] neg_lo:[0,0,1] neg_hi:[0,0,1]
v_exp_f32 v228, v228
v_exp_f32 v68, v68
v_exp_f32 v229, v229
v_exp_f32 v69, v69
v_pk_fma_f32 v[230:231], v[70:71], v[128:129], v[104:105] op_sel:[0,1,1] op_sel_hi:[1,1,1] neg_lo:[1,0,0] neg_hi:[1,0,0]
v_pk_fma_f32 v[70:71], v[70:71], v[128:129], v[100:101] op_sel:[0,1,1] op_sel_hi:[1,1,1] neg_lo:[0,0,1] neg_hi:[0,0,1]
v_exp_f32 v230, v230
v_exp_f32 v70, v70
v_exp_f32 v231, v231
v_exp_f32 v71, v71
v_pk_fma_f32 v[232:233], v[72:73], v[128:129], v[104:105] op_sel:[0,1,1] op_sel_hi:[1,1,1] neg_lo:[1,0,0] neg_hi:[1,0,0]
v_pk_fma_f32 v[72:73], v[72:73], v[128:129], v[100:101] op_sel:[0,1,1] op_sel_hi:[1,1,1] neg_lo:[0,0,1] neg_hi:[0,0,1]
v_exp_f32 v232, v232
v_exp_f32 v72, v72
v_exp_f32 v233, v233
v_exp_f32 v73, v73
v_pk_fma_f32 v[234:235], v[74:75], v[128:129], v[104:105] op_sel:[0,1,1] op_sel_hi:[1,1,1] neg_lo:[1,0,0] neg_hi:[1,0,0]
v_pk_fma_f32 v[74:75], v[74:75], v[128:129], v[100:101] op_sel:[0,1,1] op_sel_hi:[1,1,1] neg_lo:[0,0,1] neg_hi:[0,0,1]
v_exp_f32 v234, v234
v_exp_f32 v74, v74
v_exp_f32 v235, v235
v_exp_f32 v75, v75
v_pk_fma_f32 v[236:237], v[76:77], v[130:131], v[106:107] op_sel:[0,0,0] op_sel_hi:[1,0,0] neg_lo:[1,0,0] neg_hi:[1,0,0]
v_pk_fma_f32 v[76:77], v[76:77], v[130:131], v[102:103] op_sel:[0,0,0] op_sel_hi:[1,0,0] neg_lo:[0,0,1] neg_hi:[0,0,1]
v_exp_f32 v236, v236
v_exp_f32 v76, v76
v_exp_f32 v237, v237
v_exp_f32 v77, v77
v_pk_fma_f32 v[238:239], v[78:79], v[130:131], v[106:107] op_sel:[0,0,0] op_sel_hi:[1,0,0] neg_lo:[1,0,0] neg_hi:[1,0,0]
v_pk_fma_f32 v[78:79], v[78:79], v[130:131], v[102:103] op_sel:[0,0,0] op_sel_hi:[1,0,0] neg_lo:[0,0,1] neg_hi:[0,0,1]
v_exp_f32 v238, v238
v_exp_f32 v78, v78
v_exp_f32 v239, v239
v_exp_f32 v79, v79
v_pk_fma_f32 v[240:241], v[80:81], v[130:131], v[106:107] op_sel:[0,0,0] op_sel_hi:[1,0,0] neg_lo:[1,0,0] neg_hi:[1,0,0]
v_pk_fma_f32 v[80:81], v[80:81], v[130:131], v[102:103] op_sel:[0,0,0] op_sel_hi:[1,0,0] neg_lo:[0,0,1] neg_hi:[0,0,1]
v_exp_f32 v240, v240
v_exp_f32 v80, v80
v_exp_f32 v241, v241
v_exp_f32 v81, v81
v_pk_fma_f32 v[242:243], v[82:83], v[130:131], v[106:107] op_sel:[0,0,0] op_sel_hi:[1,0,0] neg_lo:[1,0,0] neg_hi:[1,0,0]
v_pk_fma_f32 v[82:83], v[82:83], v[130:131], v[102:103] op_sel:[0,0,0] op_sel_hi:[1,0,0] neg_lo:[0,0,1] neg_hi:[0,0,1]
v_exp_f32 v242, v242
v_exp_f32 v82, v82
v_exp_f32 v243, v243
v_exp_f32 v83, v83
v_pk_fma_f32 v[244:245], v[84:85], v[130:131], v[106:107] op_sel:[0,1,1] op_sel_hi:[1,1,1] neg_lo:[1,0,0] neg_hi:[1,0,0]
v_pk_fma_f32 v[84:85], v[84:85], v[130:131], v[102:103] op_sel:[0,1,1] op_sel_hi:[1,1,1] neg_lo:[0,0,1] neg_hi:[0,0,1]
v_exp_f32 v244, v244
v_exp_f32 v84, v84
v_exp_f32 v245, v245
v_exp_f32 v85, v85
v_pk_fma_f32 v[246:247], v[86:87], v[130:131], v[106:107] op_sel:[0,1,1] op_sel_hi:[1,1,1] neg_lo:[1,0,0] neg_hi:[1,0,0]
v_pk_fma_f32 v[86:87], v[86:87], v[130:131], v[102:103] op_sel:[0,1,1] op_sel_hi:[1,1,1] neg_lo:[0,0,1] neg_hi:[0,0,1]
v_exp_f32 v246, v246
v_exp_f32 v86, v86
v_exp_f32 v247, v247
v_exp_f32 v87, v87
v_pk_fma_f32 v[248:249], v[88:89], v[130:131], v[106:107] op_sel:[0,1,1] op_sel_hi:[1,1,1] neg_lo:[1,0,0] neg_hi:[1,0,0]
v_pk_fma_f32 v[88:89], v[88:89], v[130:131], v[102:103] op_sel:[0,1,1] op_sel_hi:[1,1,1] neg_lo:[0,0,1] neg_hi:[0,0,1]
v_exp_f32 v248, v248
v_exp_f32 v88, v88
v_exp_f32 v249, v249
v_exp_f32 v89, v89
v_pk_fma_f32 v[250:251], v[90:91], v[130:131], v[106:107] op_sel:[0,1,1] op_sel_hi:[1,1,1] neg_lo:[1,0,0] neg_hi:[1,0,0]
v_pk_fma_f32 v[90:91], v[90:91], v[130:131], v[102:103] op_sel:[0,1,1] op_sel_hi:[1,1,1] neg_lo:[0,0,1] neg_hi:[0,0,1]
v_exp_f32 v250, v250
v_exp_f32 v90, v90
v_exp_f32 v251, v251
v_exp_f32 v91, v91
v_pk_add_f32 v[108:109], v[60:61], v[62:63]
v_pk_add_f32 v[110:111], v[220:221], v[222:223]
v_pk_add_f32 v[108:109], v[108:109], v[64:65]
v_pk_add_f32 v[110:111], v[110:111], v[224:225]
v_pk_add_f32 v[108:109], v[108:109], v[66:67]
v_pk_add_f32 v[110:111], v[110:111], v[226:227]
v_add_f32 v100, v108, v109
v_add_f32 v104, v110, v111
v_pk_add_f32 v[108:109], v[68:69], v[70:71]
v_pk_add_f32 v[110:111], v[228:229], v[230:231]
v_pk_add_f32 v[108:109], v[108:109], v[72:73]
v_pk_add_f32 v[110:111], v[110:111], v[232:233]
v_pk_add_f32 v[108:109], v[108:109], v[74:75]
v_pk_add_f32 v[110:111], v[110:111], v[234:235]
v_add_f32 v101, v108, v109
v_add_f32 v105, v110, v111
v_pk_add_f32 v[108:109], v[76:77], v[78:79]
v_pk_add_f32 v[110:111], v[236:237], v[238:239]
v_pk_add_f32 v[108:109], v[108:109], v[80:81]
v_pk_add_f32 v[110:111], v[110:111], v[240:241]
v_pk_add_f32 v[108:109], v[108:109], v[82:83]
v_pk_add_f32 v[110:111], v[110:111], v[242:243]
v_add_f32 v102, v108, v109
v_add_f32 v106, v110, v111
v_pk_add_f32 v[108:109], v[84:85], v[86:87]
v_pk_add_f32 v[110:111], v[244:245], v[246:247]
v_pk_add_f32 v[108:109], v[108:109], v[88:89]
v_pk_add_f32 v[110:111], v[110:111], v[248:249]
v_pk_add_f32 v[108:109], v[108:109], v[90:91]
v_pk_add_f32 v[110:111], v[110:111], v[250:251]
v_add_f32 v103, v108, v109
v_add_f32 v107, v110, v111
s_nop 1
v_permlane32_swap_b32 v100, v101
v_permlane32_swap_b32 v102, v103
v_permlane32_swap_b32 v104, v105
v_permlane32_swap_b32 v106, v107
v_add_f32 v100, v100, v101
v_add_f32 v102, v102, v103
v_add_f32 v104, v104, v105
v_add_f32 v106, v106, v107
v_permlane16_swap_b32 v100, v102
s_nop 0
v_permlane16_swap_b32 v104, v106
v_add_f32 v100, v100, v102
v_add_f32 v104, v104, v106
v_rcp_f32 v100, v100
v_rcp_f32 v104, v104
s_nop 0
v_mov_b32 v102, v100
v_mov_b32 v106, v104
s_nop 0
v_permlane16_swap_b32 v100, v102
v_permlane16_swap_b32 v104, v106
v_mov_b32 v101, v100
v_mov_b32 v103, v102
v_mov_b32 v105, v104
v_mov_b32 v107, v106
v_permlane32_swap_b32 v100, v101
v_permlane32_swap_b32 v102, v103
v_permlane32_swap_b32 v104, v105
v_permlane32_swap_b32 v106, v107
.p2align 3
v_pk_mul_f32 v[60:61], v[60:61], v[100:101] op_sel:[0,0] op_sel_hi:[1,0]
v_pk_mul_f32 v[62:63], v[62:63], v[100:101] op_sel:[0,0] op_sel_hi:[1,0]
v_pk_mul_f32 v[64:65], v[64:65], v[100:101] op_sel:[0,0] op_sel_hi:[1,0]
v_pk_mul_f32 v[66:67], v[66:67], v[100:101] op_sel:[0,0] op_sel_hi:[1,0]
v_pk_mul_f32 v[220:221], v[220:221], v[104:105] op_sel:[0,0] op_sel_hi:[1,0]
v_pk_mul_f32 v[222:223], v[222:223], v[104:105] op_sel:[0,0] op_sel_hi:[1,0]
v_pk_mul_f32 v[224:225], v[224:225], v[104:105] op_sel:[0,0] op_sel_hi:[1,0]
v_pk_mul_f32 v[226:227], v[226:227], v[104:105] op_sel:[0,0] op_sel_hi:[1,0]
v_cvt_pk_bf16_f32 v60, v60, v61
v_cvt_pk_bf16_f32 v61, v62, v63
v_cvt_pk_bf16_f32 v62, v64, v65
v_cvt_pk_bf16_f32 v63, v66, v67
v_cvt_pk_bf16_f32 v220, v220, v221
v_cvt_pk_bf16_f32 v221, v222, v223
v_cvt_pk_bf16_f32 v222, v224, v225
v_cvt_pk_bf16_f32 v223, v226, v227
v_pk_mul_f32 v[68:69], v[68:69], v[100:101] op_sel:[0,1] op_sel_hi:[1,1]
v_pk_mul_f32 v[70:71], v[70:71], v[100:101] op_sel:[0,1] op_sel_hi:[1,1]
v_pk_mul_f32 v[72:73], v[72:73], v[100:101] op_sel:[0,1] op_sel_hi:[1,1]
v_pk_mul_f32 v[74:75], v[74:75], v[100:101] op_sel:[0,1] op_sel_hi:[1,1]
v_pk_mul_f32 v[228:229], v[228:229], v[104:105] op_sel:[0,1] op_sel_hi:[1,1]
v_pk_mul_f32 v[230:231], v[230:231], v[104:105] op_sel:[0,1] op_sel_hi:[1,1]
v_pk_mul_f32 v[232:233], v[232:233], v[104:105] op_sel:[0,1] op_sel_hi:[1,1]
v_pk_mul_f32 v[234:235], v[234:235], v[104:105] op_sel:[0,1] op_sel_hi:[1,1]
v_cvt_pk_bf16_f32 v68, v68, v69
v_mfma_f32_16x16x32_bf16 v[204:207], v[60:63], v[38:41], 0
v_cvt_pk_bf16_f32 v69, v70, v71
v_cvt_pk_bf16_f32 v70, v72, v73
v_mfma_f32_16x16x32_bf16 v[208:211], v[60:63], v[36:39], 0
v_cvt_pk_bf16_f32 v71, v74, v75
v_cvt_pk_bf16_f32 v228, v228, v229
v_mfma_f32_16x16x32_bf16 v[212:215], v[220:223], v[38:41], 0
v_cvt_pk_bf16_f32 v229, v230, v231
v_cvt_pk_bf16_f32 v230, v232, v233
v_mfma_f32_16x16x32_bf16 v[216:219], v[220:223], v[36:39], 0
v_cvt_pk_bf16_f32 v231, v234, v235
v_pk_mul_f32 v[76:77], v[76:77], v[102:103] op_sel:[0,0] op_sel_hi:[1,0]
v_pk_mul_f32 v[78:79], v[78:79], v[102:103] op_sel:[0,0] op_sel_hi:[1,0]
v_pk_mul_f32 v[80:81], v[80:81], v[102:103] op_sel:[0,0] op_sel_hi:[1,0]
v_pk_mul_f32 v[82:83], v[82:83], v[102:103] op_sel:[0,0] op_sel_hi:[1,0]
v_pk_mul_f32 v[236:237], v[236:237], v[106:107] op_sel:[0,0] op_sel_hi:[1,0]
v_pk_mul_f32 v[238:239], v[238:239], v[106:107] op_sel:[0,0] op_sel_hi:[1,0]
v_pk_mul_f32 v[240:241], v[240:241], v[106:107] op_sel:[0,0] op_sel_hi:[1,0]
v_pk_mul_f32 v[242:243], v[242:243], v[106:107] op_sel:[0,0] op_sel_hi:[1,0]
v_cvt_pk_bf16_f32 v76, v76, v77
v_mfma_f32_16x16x32_bf16 v[188:191], v[68:71], v[38:41], 0
v_mfma_f32_16x16x32_bf16 v[192:195], v[68:71], v[36:39], 0
v_cvt_pk_bf16_f32 v77, v78, v79
v_mfma_f32_16x16x32_bf16 v[196:199], v[228:231], v[38:41], 0
v_cvt_pk_bf16_f32 v78, v80, v81
v_mfma_f32_16x16x32_bf16 v[200:203], v[228:231], v[36:39], 0
v_cvt_pk_bf16_f32 v64, v204, v205
v_cvt_pk_bf16_f32 v79, v82, v83
v_cvt_pk_bf16_f32 v65, v206, v207
v_cvt_pk_bf16_f32 v236, v236, v237
v_cvt_pk_bf16_f32 v72, v208, v209
v_cvt_pk_bf16_f32 v73, v210, v211
v_cvt_pk_bf16_f32 v237, v238, v239
v_cvt_pk_bf16_f32 v224, v212, v213
v_cvt_pk_bf16_f32 v238, v240, v241
v_cvt_pk_bf16_f32 v225, v214, v215
v_cvt_pk_bf16_f32 v232, v216, v217
v_cvt_pk_bf16_f32 v239, v242, v243
v_cvt_pk_bf16_f32 v233, v218, v219
v_pk_mul_f32 v[84:85], v[84:85], v[102:103] op_sel:[0,1] op_sel_hi:[1,1]
v_pk_mul_f32 v[86:87], v[86:87], v[102:103] op_sel:[0,1] op_sel_hi:[1,1]
v_pk_mul_f32 v[88:89], v[88:89], v[102:103] op_sel:[0,1] op_sel_hi:[1,1]
v_pk_mul_f32 v[90:91], v[90:91], v[102:103] op_sel:[0,1] op_sel_hi:[1,1]
v_pk_mul_f32 v[244:245], v[244:245], v[106:107] op_sel:[0,1] op_sel_hi:[1,1]
v_pk_mul_f32 v[246:247], v[246:247], v[106:107] op_sel:[0,1] op_sel_hi:[1,1]
v_pk_mul_f32 v[248:249], v[248:249], v[106:107] op_sel:[0,1] op_sel_hi:[1,1]
v_pk_mul_f32 v[250:251], v[250:251], v[106:107] op_sel:[0,1] op_sel_hi:[1,1]
v_cvt_pk_bf16_f32 v84, v84, v85
v_mfma_f32_16x16x32_bf16 v[204:207], v[76:79], v[38:41], 0
v_mfma_f32_16x16x32_bf16 v[208:211], v[76:79], v[36:39], 0
v_cvt_pk_bf16_f32 v85, v86, v87
v_mfma_f32_16x16x32_bf16 v[212:215], v[236:239], v[38:41], 0
v_cvt_pk_bf16_f32 v86, v88, v89
v_mfma_f32_16x16x32_bf16 v[216:219], v[236:239], v[36:39], 0
v_cvt_pk_bf16_f32 v66, v188, v189
v_cvt_pk_bf16_f32 v87, v90, v91
v_cvt_pk_bf16_f32 v67, v190, v191
v_cvt_pk_bf16_f32 v244, v244, v245
v_cvt_pk_bf16_f32 v74, v192, v193
v_cvt_pk_bf16_f32 v75, v194, v195
v_cvt_pk_bf16_f32 v245, v246, v247
v_cvt_pk_bf16_f32 v226, v196, v197
v_cvt_pk_bf16_f32 v246, v248, v249
v_cvt_pk_bf16_f32 v227, v198, v199
v_cvt_pk_bf16_f32 v234, v200, v201
v_cvt_pk_bf16_f32 v247, v250, v251
v_cvt_pk_bf16_f32 v235, v202, v203
v_mov_b32 v5, 4
v_cmp_eq_u32 s[50:51], s41, v2
v_mfma_f32_16x16x32_bf16 v[188:191], v[84:87], v[38:41], 0
v_mfma_f32_16x16x32_bf16 v[192:195], v[84:87], v[36:39], 0
v_mfma_f32_16x16x32_bf16 v[196:199], v[244:247], v[38:41], 0
v_mfma_f32_16x16x32_bf16 v[200:203], v[244:247], v[36:39], 0
v_mfma_f32_16x16x32_bf16 v[152:155], v[224:227], v[112:115], 0
v_cvt_pk_bf16_f32 v80, v204, v205
v_cvt_pk_bf16_f32 v81, v206, v207
v_mfma_f32_16x16x32_bf16 v[60:63], v[232:235], v[112:115], 0
v_cvt_pk_bf16_f32 v88, v208, v209
v_mfma_f32_16x16x32_bf16 v[68:71], v[224:227], v[120:123], 0
v_cvt_pk_bf16_f32 v89, v210, v211
v_mfma_f32_16x16x32_bf16 v[220:223], v[232:235], v[120:123], 0
v_cvt_pk_bf16_f32 v240, v212, v213
v_cvt_pk_bf16_f32 v241, v214, v215
v_mfma_f32_16x16x32_bf16 v[228:231], v[224:227], v[48:51], 0
v_cvt_pk_bf16_f32 v248, v216, v217
v_mfma_f32_16x16x32_bf16 v[76:79], v[232:235], v[48:51], 0
v_cvt_pk_bf16_f32 v249, v218, v219
v_mfma_f32_16x16x32_bf16 v[100:103], v[64:67], v[112:115], 0
v_cvt_pk_bf16_f32 v82, v188, v189
v_cvt_pk_bf16_f32 v83, v190, v191
v_mfma_f32_16x16x32_bf16 v[104:107], v[72:75], v[112:115], 0
v_cvt_pk_bf16_f32 v90, v192, v193
v_mfma_f32_16x16x32_bf16 v[108:111], v[64:67], v[120:123], 0
v_cvt_pk_bf16_f32 v91, v194, v195
v_mfma_f32_16x16x32_bf16 v[132:135], v[72:75], v[120:123], 0
v_cvt_pk_bf16_f32 v242, v196, v197
v_cvt_pk_bf16_f32 v243, v198, v199
v_mfma_f32_16x16x32_bf16 v[136:139], v[64:67], v[48:51], 0
v_cvt_pk_bf16_f32 v250, v200, v201
v_mfma_f32_16x16x32_bf16 v[148:151], v[72:75], v[48:51], 0
v_cvt_pk_bf16_f32 v251, v202, v203
s_nop 1
v_mfma_f32_16x16x32_bf16 v[152:155], v[240:243], v[116:119], v[152:155]
v_mfma_f32_16x16x32_bf16 v[60:63], v[248:251], v[116:119], v[60:63]
v_mfma_f32_16x16x32_bf16 v[68:71], v[240:243], v[124:127], v[68:71]
v_mfma_f32_16x16x32_bf16 v[220:223], v[248:251], v[124:127], v[220:223]
v_mfma_f32_16x16x32_bf16 v[228:231], v[240:243], v[48:51], v[228:231]
v_mfma_f32_16x16x32_bf16 v[76:79], v[248:251], v[48:51], v[76:79]
v_mfma_f32_16x16x32_bf16 v[100:103], v[80:83], v[116:119], v[100:103]
v_mfma_f32_16x16x32_bf16 v[104:107], v[88:91], v[116:119], v[104:107]
v_mfma_f32_16x16x32_bf16 v[108:111], v[80:83], v[124:127], v[108:111]
v_mfma_f32_16x16x32_bf16 v[132:135], v[88:91], v[124:127], v[132:135]
v_cvt_pk_bf16_f32 v152, v152, v153
v_cvt_pk_bf16_f32 v153, v154, v155
v_mfma_f32_16x16x32_bf16 v[136:139], v[80:83], v[48:51], v[136:139]
v_cvt_pk_bf16_f32 v154, v60, v61
v_cvt_pk_bf16_f32 v155, v62, v63
v_mfma_f32_16x16x32_bf16 v[148:151], v[88:91], v[48:51], v[148:151]
ds_write_b128 v42, v[152:155] offset:0
v_cvt_pk_bf16_f32 v68, v68, v69
v_cvt_pk_bf16_f32 v69, v70, v71
v_cvt_pk_bf16_f32 v70, v220, v221
v_cvt_pk_bf16_f32 v71, v222, v223
ds_write_b128 v42, v[68:71] offset:1024
v_cvt_pk_bf16_f32 v228, v228, v229
v_cvt_pk_bf16_f32 v229, v230, v231
v_cvt_pk_bf16_f32 v230, v76, v77
v_cvt_pk_bf16_f32 v231, v78, v79
ds_write_b128 v42, v[228:231] offset:2048
ds_write_b32 v52, v5
s_mov_b32 s63, 0
px_93:
ds_read_b32 v4, v19
ds_read_b128 v[188:191], v43 offset:0
ds_read_b128 v[192:195], v43 offset:1024
ds_read_b128 v[196:199], v43 offset:2048
s_add_u32 s63, s63, 1
s_cmp_lt_u32 s63, 0x400000
s_waitcnt lgkmcnt(0)
v_cmp_ne_u32 vcc, 4, v4
s_cbranch_vccz pxd_94
s_cbranch_scc1 px_93
pxd_94:
v_mfma_f32_16x16x32_bf16 v[100:103], v[38:41], v[188:191], v[100:103]
v_mfma_f32_16x16x32_bf16 v[104:107], v[36:39], v[188:191], v[104:107]
v_mfma_f32_16x16x32_bf16 v[108:111], v[38:41], v[192:195], v[108:111]
v_mfma_f32_16x16x32_bf16 v[132:135], v[36:39], v[192:195], v[132:135]
v_mfma_f32_16x16x32_bf16 v[136:139], v[38:41], v[196:199], v[136:139]
v_mfma_f32_16x16x32_bf16 v[148:151], v[36:39], v[196:199], v[148:151]
s_nop 2
v_cvt_pk_bf16_f32 v100, v100, v101
v_cvt_pk_bf16_f32 v101, v102, v103
v_cvt_pk_bf16_f32 v102, v104, v105
v_cvt_pk_bf16_f32 v103, v106, v107
buffer_store_dwordx4 v[100:103], v55, s[32:35], s53 offen sc1
v_cvt_pk_bf16_f32 v108, v108, v109
v_cvt_pk_bf16_f32 v109, v110, v111
v_cvt_pk_bf16_f32 v110, v132, v133
v_cvt_pk_bf16_f32 v111, v134, v135
buffer_store_dwordx4 v[108:111], v55, s[32:35], s54 offen sc1
v_cvt_pk_bf16_f32 v136, v136, v137
v_cvt_pk_bf16_f32 v137, v138, v139
v_cvt_pk_bf16_f32 v138, v148, v149
v_cvt_pk_bf16_f32 v139, v150, v151
s_mov_b64 exec, s[50:51]
buffer_store_dwordx4 v[136:139], v58, s[32:35], s56 offen sc1
s_mov_b64 exec, -1
s_mov_b32 s51, 0
.p2align 3
v_pk_fma_f32 v[156:157], v[140:141], v[92:93], v[156:157] op_sel:[0,1,0] op_sel_hi:[1,1,1]
v_pk_fma_f32 v[158:159], v[142:143], v[92:93], v[158:159] op_sel:[0,1,0] op_sel_hi:[1,1,1]
v_pk_fma_f32 v[160:161], v[144:145], v[92:93], v[160:161] op_sel:[0,1,0] op_sel_hi:[1,1,1]
v_pk_fma_f32 v[162:163], v[146:147], v[92:93], v[162:163] op_sel:[0,1,0] op_sel_hi:[1,1,1]
v_cvt_pk_bf16_f32 v156, v156, v157
v_cvt_pk_bf16_f32 v157, v158, v159
v_cvt_pk_bf16_f32 v158, v160, v161
v_cvt_pk_bf16_f32 v159, v162, v163
v_pk_fma_f32 v[164:165], v[140:141], v[94:95], v[164:165] op_sel:[0,1,0] op_sel_hi:[1,1,1]
v_pk_fma_f32 v[166:167], v[142:143], v[94:95], v[166:167] op_sel:[0,1,0] op_sel_hi:[1,1,1]
v_pk_fma_f32 v[168:169], v[144:145], v[94:95], v[168:169] op_sel:[0,1,0] op_sel_hi:[1,1,1]
v_pk_fma_f32 v[170:171], v[146:147], v[94:95], v[170:171] op_sel:[0,1,0] op_sel_hi:[1,1,1]
v_cvt_pk_bf16_f32 v164, v164, v165
v_mfma_f32_16x16x32_bf16 v[60:63], v[10:13], v[156:159], 0
v_cvt_pk_bf16_f32 v165, v166, v167
v_cvt_pk_bf16_f32 v166, v168, v169
v_mfma_f32_16x16x32_bf16 v[64:67], v[14:17], v[156:159], 0
v_cvt_pk_bf16_f32 v167, v170, v171
v_pk_fma_f32 v[172:173], v[140:141], v[96:97], v[172:173] op_sel:[0,1,0] op_sel_hi:[1,1,1]
v_pk_fma_f32 v[174:175], v[142:143], v[96:97], v[174:175] op_sel:[0,1,0] op_sel_hi:[1,1,1]
v_pk_fma_f32 v[176:177], v[144:145], v[96:97], v[176:177] op_sel:[0,1,0] op_sel_hi:[1,1,1]
v_pk_fma_f32 v[178:179], v[146:147], v[96:97], v[178:179] op_sel:[0,1,0] op_sel_hi:[1,1,1]
v_cvt_pk_bf16_f32 v172, v172, v173
v_mfma_f32_16x16x32_bf16 v[68:71], v[10:13], v[164:167], 0
v_cvt_pk_bf16_f32 v173, v174, v175
v_cvt_pk_bf16_f32 v174, v176, v177
v_mfma_f32_16x16x32_bf16 v[72:75], v[14:17], v[164:167], 0
v_cvt_pk_bf16_f32 v175, v178, v179
v_pk_fma_f32 v[180:181], v[140:141], v[98:99], v[180:181] op_sel:[0,1,0] op_sel_hi:[1,1,1]
v_pk_fma_f32 v[182:183], v[142:143], v[98:99], v[182:183] op_sel:[0,1,0] op_sel_hi:[1,1,1]
v_pk_fma_f32 v[184:185], v[144:145], v[98:99], v[184:185] op_sel:[0,1,0] op_sel_hi:[1,1,1]
v_pk_fma_f32 v[186:187], v[146:147], v[98:99], v[186:187] op_sel:[0,1,0] op_sel_hi:[1,1,1]
v_cvt_pk_bf16_f32 v180, v180, v181
v_mfma_f32_16x16x32_bf16 v[76:79], v[10:13], v[172:175], 0
v_cvt_pk_bf16_f32 v181, v182, v183
v_cvt_pk_bf16_f32 v182, v184, v185
v_mfma_f32_16x16x32_bf16 v[80:83], v[14:17], v[172:175], 0
v_cvt_pk_bf16_f32 v183, v186, v187
s_nop 1
v_mfma_f32_16x16x32_bf16 v[84:87], v[10:13], v[180:183], 0
v_mfma_f32_16x16x32_bf16 v[88:91], v[14:17], v[180:183], 0
v_max3_f32 v100, v60, v61, v62
v_min3_f32 v104, v60, v61, v62
v_max3_f32 v100, v100, v63, v64
v_min3_f32 v104, v104, v63, v64
v_max3_f32 v100, v100, v65, v66
v_min3_f32 v104, v104, v65, v66
v_max_f32 v100, v100, v67
v_min_f32 v104, v104, v67
v_max3_f32 v101, v68, v69, v70
v_min3_f32 v105, v68, v69, v70
v_max3_f32 v101, v101, v71, v72
v_min3_f32 v105, v105, v71, v72
v_max3_f32 v101, v101, v73, v74
v_min3_f32 v105, v105, v73, v74
v_max_f32 v101, v101, v75
v_min_f32 v105, v105, v75
v_max3_f32 v102, v76, v77, v78
v_min3_f32 v106, v76, v77, v78
v_max3_f32 v102, v102, v79, v80
v_min3_f32 v106, v106, v79, v80
v_max3_f32 v102, v102, v81, v82
v_min3_f32 v106, v106, v81, v82
v_max_f32 v102, v102, v83
v_min_f32 v106, v106, v83
v_max3_f32 v103, v84, v85, v86
v_min3_f32 v107, v84, v85, v86
v_max3_f32 v103, v103, v87, v88
v_min3_f32 v107, v107, v87, v88
v_max3_f32 v103, v103, v89, v90
v_min3_f32 v107, v107, v89, v90
v_max_f32 v103, v103, v91
v_min_f32 v107, v107, v91
s_nop 1
v_permlane32_swap_b32 v100, v101
v_permlane32_swap_b32 v102, v103
v_permlane32_swap_b32 v104, v105
v_permlane32_swap_b32 v106, v107
v_max_f32 v100, v100, v101
v_max_f32 v102, v102, v103
v_min_f32 v104, v104, v105
v_min_f32 v106, v106, v107
v_permlane16_swap_b32 v100, v102
s_nop 0
v_permlane16_swap_b32 v104, v106
v_max_f32 v100, v100, v102
v_min_f32 v104, v104, v106
v_mov_b32 v102, v100
v_mov_b32 v106, v104
s_nop 0
v_permlane16_swap_b32 v100, v102
v_permlane16_swap_b32 v104, v106
v_mov_b32 v101, v100
v_mov_b32 v103, v102
v_mov_b32 v105, v104
v_mov_b32 v107, v106
v_permlane32_swap_b32 v100, v101
v_permlane32_swap_b32 v102, v103
v_permlane32_swap_b32 v104, v105
v_permlane32_swap_b32 v106, v107
v_pk_mul_f32 v[100:101], v[100:101], v[128:129]
v_pk_mul_f32 v[102:103], v[102:103], v[130:131]
v_pk_mul_f32 v[104:105], v[104:105], v[128:129]
v_pk_mul_f32 v[106:107], v[106:107], v[130:131]
v_pk_fma_f32 v[220:221], v[60:61], v[128:129], v[104:105] op_sel:[0,0,0] op_sel_hi:[1,0,0] neg_lo:[1,0,0] neg_hi:[1,0,0]
v_pk_fma_f32 v[60:61], v[60:61], v[128:129], v[100:101] op_sel:[0,0,0] op_sel_hi:[1,0,0] neg_lo:[0,0,1] neg_hi:[0,0,1]
v_exp_f32 v220, v220
v_exp_f32 v60, v60
v_exp_f32 v221, v221
v_exp_f32 v61, v61
v_pk_fma_f32 v[222:223], v[62:63], v[128:129], v[104:105] op_sel:[0,0,0] op_sel_hi:[1,0,0] neg_lo:[1,0,0] neg_hi:[1,0,0]
v_pk_fma_f32 v[62:63], v[62:63], v[128:129], v[100:101] op_sel:[0,0,0] op_sel_hi:[1,0,0] neg_lo:[0,0,1] neg_hi:[0,0,1]
v_exp_f32 v222, v222
v_exp_f32 v62, v62
v_exp_f32 v223, v223
v_exp_f32 v63, v63
v_pk_fma_f32 v[224:225], v[64:65], v[128:129], v[104:105] op_sel:[0,0,0] op_sel_hi:[1,0,0] neg_lo:[1,0,0] neg_hi:[1,0,0]
v_pk_fma_f32 v[64:65], v[64:65], v[128:129], v[100:101] op_sel:[0,0,0] op_sel_hi:[1,0,0] neg_lo:[0,0,1] neg_hi:[0,0,1]
v_exp_f32 v224, v224
v_exp_f32 v64, v64
v_exp_f32 v225, v225
v_exp_f32 v65, v65
v_pk_fma_f32 v[226:227], v[66:67], v[128:129], v[104:105] op_sel:[0,0,0] op_sel_hi:[1,0,0] neg_lo:[1,0,0] neg_hi:[1,0,0]
v_pk_fma_f32 v[66:67], v[66:67], v[128:129], v[100:101] op_sel:[0,0,0] op_sel_hi:[1,0,0] neg_lo:[0,0,1] neg_hi:[0,0,1]
v_exp_f32 v226, v226
v_exp_f32 v66, v66
v_exp_f32 v227, v227
v_exp_f32 v67, v67
v_pk_fma_f32 v[228:229], v[68:69], v[128:129], v[104:105] op_sel:[0,1,1] op_sel_hi:[1,1,1] neg_lo:[1,0,0] neg_hi:[1,0,0]
v_pk_fma_f32 v[68:69], v[68:69], v[128:129], v[100:101] op_sel:[0,1,1] op_sel_hi:[1,1,1] neg_lo:[0,0,1] neg_hi:[0,0,1]
v_exp_f32 v228, v228
v_exp_f32 v68, v68
v_exp_f32 v229, v229
v_exp_f32 v69, v69
v_pk_fma_f32 v[230:231], v[70:71], v[128:129], v[104:105] op_sel:[0,1,1] op_sel_hi:[1,1,1] neg_lo:[1,0,0] neg_hi:[1,0,0]
v_pk_fma_f32 v[70:71], v[70:71], v[128:129], v[100:101] op_sel:[0,1,1] op_sel_hi:[1,1,1] neg_lo:[0,0,1] neg_hi:[0,0,1]
v_exp_f32 v230, v230
v_exp_f32 v70, v70
v_exp_f32 v231, v231
v_exp_f32 v71, v71
v_pk_fma_f32 v[232:233], v[72:73], v[128:129], v[104:105] op_sel:[0,1,1] op_sel_hi:[1,1,1] neg_lo:[1,0,0] neg_hi:[1,0,0]
v_pk_fma_f32 v[72:73], v[72:73], v[128:129], v[100:101] op_sel:[0,1,1] op_sel_hi:[1,1,1] neg_lo:[0,0,1] neg_hi:[0,0,1]
v_exp_f32 v232, v232
v_exp_f32 v72, v72
v_exp_f32 v233, v233
v_exp_f32 v73, v73
v_pk_fma_f32 v[234:235], v[74:75], v[128:129], v[104:105] op_sel:[0,1,1] op_sel_hi:[1,1,1] neg_lo:[1,0,0] neg_hi:[1,0,0]
v_pk_fma_f32 v[74:75], v[74:75], v[128:129], v[100:101] op_sel:[0,1,1] op_sel_hi:[1,1,1] neg_lo:[0,0,1] neg_hi:[0,0,1]
v_exp_f32 v234, v234
v_exp_f32 v74, v74
v_exp_f32 v235, v235
v_exp_f32 v75, v75
buffer_load_dwordx4 v[212:215], v18, s[32:35], s55 offen offset:0 sc1
buffer_load_dwordx4 v[216:219], v18, s[32:35], s55 offen offset:1024 sc1
v_pk_fma_f32 v[236:237], v[76:77], v[130:131], v[106:107] op_sel:[0,0,0] op_sel_hi:[1,0,0] neg_lo:[1,0,0] neg_hi:[1,0,0]
v_pk_fma_f32 v[76:77], v[76:77], v[130:131], v[102:103] op_sel:[0,0,0] op_sel_hi:[1,0,0] neg_lo:[0,0,1] neg_hi:[0,0,1]
v_exp_f32 v236, v236
v_exp_f32 v76, v76
v_exp_f32 v237, v237
v_exp_f32 v77, v77
v_pk_fma_f32 v[238:239], v[78:79], v[130:131], v[106:107] op_sel:[0,0,0] op_sel_hi:[1,0,0] neg_lo:[1,0,0] neg_hi:[1,0,0]
v_pk_fma_f32 v[78:79], v[78:79], v[130:131], v[102:103] op_sel:[0,0,0] op_sel_hi:[1,0,0] neg_lo:[0,0,1] neg_hi:[0,0,1]
v_exp_f32 v238, v238
v_exp_f32 v78, v78
v_exp_f32 v239, v239
v_exp_f32 v79, v79
v_pk_fma_f32 v[240:241], v[80:81], v[130:131], v[106:107] op_sel:[0,0,0] op_sel_hi:[1,0,0] neg_lo:[1,0,0] neg_hi:[1,0,0]
v_pk_fma_f32 v[80:81], v[80:81], v[130:131], v[102:103] op_sel:[0,0,0] op_sel_hi:[1,0,0] neg_lo:[0,0,1] neg_hi:[0,0,1]
v_exp_f32 v240, v240
v_exp_f32 v80, v80
v_exp_f32 v241, v241
v_exp_f32 v81, v81
v_pk_fma_f32 v[242:243], v[82:83], v[130:131], v[106:107] op_sel:[0,0,0] op_sel_hi:[1,0,0] neg_lo:[1,0,0] neg_hi:[1,0,0]
v_pk_fma_f32 v[82:83], v[82:83], v[130:131], v[102:103] op_sel:[0,0,0] op_sel_hi:[1,0,0] neg_lo:[0,0,1] neg_hi:[0,0,1]
v_exp_f32 v242, v242
v_exp_f32 v82, v82
v_exp_f32 v243, v243
v_exp_f32 v83, v83
v_pk_fma_f32 v[244:245], v[84:85], v[130:131], v[106:107] op_sel:[0,1,1] op_sel_hi:[1,1,1] neg_lo:[1,0,0] neg_hi:[1,0,0]
v_pk_fma_f32 v[84:85], v[84:85], v[130:131], v[102:103] op_sel:[0,1,1] op_sel_hi:[1,1,1] neg_lo:[0,0,1] neg_hi:[0,0,1]
v_exp_f32 v244, v244
v_exp_f32 v84, v84
v_exp_f32 v245, v245
v_exp_f32 v85, v85
v_pk_fma_f32 v[246:247], v[86:87], v[130:131], v[106:107] op_sel:[0,1,1] op_sel_hi:[1,1,1] neg_lo:[1,0,0] neg_hi:[1,0,0]
v_pk_fma_f32 v[86:87], v[86:87], v[130:131], v[102:103] op_sel:[0,1,1] op_sel_hi:[1,1,1] neg_lo:[0,0,1] neg_hi:[0,0,1]
v_exp_f32 v246, v246
v_exp_f32 v86, v86
v_exp_f32 v247, v247
v_exp_f32 v87, v87
v_pk_fma_f32 v[248:249], v[88:89], v[130:131], v[106:107] op_sel:[0,1,1] op_sel_hi:[1,1,1] neg_lo:[1,0,0] neg_hi:[1,0,0]
v_pk_fma_f32 v[88:89], v[88:89], v[130:131], v[102:103] op_sel:[0,1,1] op_sel_hi:[1,1,1] neg_lo:[0,0,1] neg_hi:[0,0,1]
v_exp_f32 v248, v248
v_exp_f32 v88, v88
v_exp_f32 v249, v249
v_exp_f32 v89, v89
v_pk_fma_f32 v[250:251], v[90:91], v[130:131], v[106:107] op_sel:[0,1,1] op_sel_hi:[1,1,1] neg_lo:[1,0,0] neg_hi:[1,0,0]
v_pk_fma_f32 v[90:91], v[90:91], v[130:131], v[102:103] op_sel:[0,1,1] op_sel_hi:[1,1,1] neg_lo:[0,0,1] neg_hi:[0,0,1]
v_exp_f32 v250, v250
v_exp_f32 v90, v90
v_exp_f32 v251, v251
v_exp_f32 v91, v91
v_pk_add_f32 v[108:109], v[60:61], v[62:63]
v_pk_add_f32 v[110:111], v[220:221], v[222:223]
v_pk_add_f32 v[108:109], v[108:109], v[64:65]
v_pk_add_f32 v[110:111], v[110:111], v[224:225]
v_pk_add_f32 v[108:109], v[108:109], v[66:67]
v_pk_add_f32 v[110:111], v[110:111], v[226:227]
v_add_f32 v100, v108, v109
v_add_f32 v104, v110, v111
v_pk_add_f32 v[108:109], v[68:69], v[70:71]
v_pk_add_f32 v[110:111], v[228:229], v[230:231]
v_pk_add_f32 v[108:109], v[108:109], v[72:73]
v_pk_add_f32 v[110:111], v[110:111], v[232:233]
v_pk_add_f32 v[108:109], v[108:109], v[74:75]
v_pk_add_f32 v[110:111], v[110:111], v[234:235]
v_add_f32 v101, v108, v109
v_add_f32 v105, v110, v111
v_pk_add_f32 v[108:109], v[76:77], v[78:79]
v_pk_add_f32 v[110:111], v[236:237], v[238:239]
v_pk_add_f32 v[108:109], v[108:109], v[80:81]
v_pk_add_f32 v[110:111], v[110:111], v[240:241]
v_pk_add_f32 v[108:109], v[108:109], v[82:83]
v_pk_add_f32 v[110:111], v[110:111], v[242:243]
v_add_f32 v102, v108, v109
v_add_f32 v106, v110, v111
v_pk_add_f32 v[108:109], v[84:85], v[86:87]
v_pk_add_f32 v[110:111], v[244:245], v[246:247]
v_pk_add_f32 v[108:109], v[108:109], v[88:89]
v_pk_add_f32 v[110:111], v[110:111], v[248:249]
v_pk_add_f32 v[108:109], v[108:109], v[90:91]
v_pk_add_f32 v[110:111], v[110:111], v[250:251]
v_add_f32 v103, v108, v109
v_add_f32 v107, v110, v111
s_cmp_eq_u32 s51, 1
s_cbranch_scc1 chk_95
s_waitcnt vmcnt(0)
v_max_u32 v4, v212, v213
v_max3_u32 v4, v4, v214, v215
v_max3_u32 v4, v4, v216, v217
v_max3_u32 v4, v4, v218, v219
v_cmp_eq_u32 vcc, -1, v4
s_cbranch_vccz red_96
buffer_load_dwordx4 v[212:215], v18, s[32:35], s55 offen offset:0 sc1
buffer_load_dwordx4 v[216:219], v18, s[32:35], s55 offen offset:1024 sc1
s_branch chk_95
red_96:
v_mfma_f32_16x16x32_bf16 v[132:135], v[44:47], v[212:215], 0
v_mfma_f32_16x16x32_bf16 v[132:135], v[44:47], v[216:219], v[132:135]
s_mov_b32 s51, 1
s_nop 6
v_add_f32_dpp v132, v132, v132 row_ror:8 row_mask:0xf bank_mask:0xf
v_add_f32_dpp v133, v133, v133 row_ror:8 row_mask:0xf bank_mask:0xf
v_add_f32_dpp v134, v134, v134 row_ror:8 row_mask:0xf bank_mask:0xf
v_add_f32_dpp v135, v135, v135 row_ror:8 row_mask:0xf bank_mask:0xf
v_cvt_pk_bf16_f32 v132, v132, v133
v_cvt_pk_bf16_f32 v133, v134, v135
s_mov_b64 exec, 0x00ff00ff
buffer_store_dwordx2 v[132:133], v59, s[32:35], s79 offen sc1
s_mov_b64 exec, -1
buffer_load_dwordx4 v[204:207], v58, s[32:35], s56 offen sc1
buffer_load_dwordx4 v[208:211], v58, s[32:35], s57 offen sc1
chk_95:
s_nop 1
v_permlane32_swap_b32 v100, v101
v_permlane32_swap_b32 v102, v103
v_permlane32_swap_b32 v104, v105
v_permlane32_swap_b32 v106, v107
v_add_f32 v100, v100, v101
v_add_f32 v102, v102, v103
v_add_f32 v104, v104, v105
v_add_f32 v106, v106, v107
v_permlane16_swap_b32 v100, v102
s_nop 0
v_permlane16_swap_b32 v104, v106
v_add_f32 v100, v100, v102
v_add_f32 v104, v104, v106
v_rcp_f32 v100, v100
v_rcp_f32 v104, v104
s_nop 0
v_mov_b32 v102, v100
v_mov_b32 v106, v104
s_nop 0
v_permlane16_swap_b32 v100, v102
v_permlane16_swap_b32 v104, v106
v_mov_b32 v101, v100
v_mov_b32 v103, v102
v_mov_b32 v105, v104
v_mov_b32 v107, v106
v_permlane32_swap_b32 v100, v101
v_permlane32_swap_b32 v102, v103
v_permlane32_swap_b32 v104, v105
v_permlane32_swap_b32 v106, v107
.p2align 3
v_pk_mul_f32 v[60:61], v[60:61], v[100:101] op_sel:[0,0] op_sel_hi:[1,0]
v_pk_mul_f32 v[62:63], v[62:63], v[100:101] op_sel:[0,0] op_sel_hi:[1,0]
v_pk_mul_f32 v[64:65], v[64:65], v[100:101] op_sel:[0,0] op_sel_hi:[1,0]
v_pk_mul_f32 v[66:67], v[66:67], v[100:101] op_sel:[0,0] op_sel_hi:[1,0]
v_pk_mul_f32 v[220:221], v[220:221], v[104:105] op_sel:[0,0] op_sel_hi:[1,0]
v_pk_mul_f32 v[222:223], v[222:223], v[104:105] op_sel:[0,0] op_sel_hi:[1,0]
v_pk_mul_f32 v[224:225], v[224:225], v[104:105] op_sel:[0,0] op_sel_hi:[1,0]
v_pk_mul_f32 v[226:227], v[226:227], v[104:105] op_sel:[0,0] op_sel_hi:[1,0]
v_cvt_pk_bf16_f32 v60, v60, v61
v_cvt_pk_bf16_f32 v61, v62, v63
v_cvt_pk_bf16_f32 v62, v64, v65
v_cvt_pk_bf16_f32 v63, v66, v67
v_cvt_pk_bf16_f32 v220, v220, v221
v_cvt_pk_bf16_f32 v221, v222, v223
v_cvt_pk_bf16_f32 v222, v224, v225
v_cvt_pk_bf16_f32 v223, v226, v227
v_pk_mul_f32 v[68:69], v[68:69], v[100:101] op_sel:[0,1] op_sel_hi:[1,1]
v_pk_mul_f32 v[70:71], v[70:71], v[100:101] op_sel:[0,1] op_sel_hi:[1,1]
v_pk_mul_f32 v[72:73], v[72:73], v[100:101] op_sel:[0,1] op_sel_hi:[1,1]
v_pk_mul_f32 v[74:75], v[74:75], v[100:101] op_sel:[0,1] op_sel_hi:[1,1]
v_pk_mul_f32 v[228:229], v[228:229], v[104:105] op_sel:[0,1] op_sel_hi:[1,1]
v_pk_mul_f32 v[230:231], v[230:231], v[104:105] op_sel:[0,1] op_sel_hi:[1,1]
v_pk_mul_f32 v[232:233], v[232:233], v[104:105] op_sel:[0,1] op_sel_hi:[1,1]
v_pk_mul_f32 v[234:235], v[234:235], v[104:105] op_sel:[0,1] op_sel_hi:[1,1]
v_cvt_pk_bf16_f32 v68, v68, v69
v_cvt_pk_bf16_f32 v69, v70, v71
v_cvt_pk_bf16_f32 v70, v72, v73
v_cvt_pk_bf16_f32 v71, v74, v75
v_cvt_pk_bf16_f32 v228, v228, v229
v_cvt_pk_bf16_f32 v229, v230, v231
v_cvt_pk_bf16_f32 v230, v232, v233
v_cvt_pk_bf16_f32 v231, v234, v235
v_pk_mul_f32 v[76:77], v[76:77], v[102:103] op_sel:[0,0] op_sel_hi:[1,0]
v_pk_mul_f32 v[78:79], v[78:79], v[102:103] op_sel:[0,0] op_sel_hi:[1,0]
v_pk_mul_f32 v[80:81], v[80:81], v[102:103] op_sel:[0,0] op_sel_hi:[1,0]
v_pk_mul_f32 v[82:83], v[82:83], v[102:103] op_sel:[0,0] op_sel_hi:[1,0]
v_pk_mul_f32 v[236:237], v[236:237], v[106:107] op_sel:[0,0] op_sel_hi:[1,0]
v_pk_mul_f32 v[238:239], v[238:239], v[106:107] op_sel:[0,0] op_sel_hi:[1,0]
v_pk_mul_f32 v[240:241], v[240:241], v[106:107] op_sel:[0,0] op_sel_hi:[1,0]
v_pk_mul_f32 v[242:243], v[242:243], v[106:107] op_sel:[0,0] op_sel_hi:[1,0]
v_cvt_pk_bf16_f32 v76, v76, v77
v_cvt_pk_bf16_f32 v77, v78, v79
v_cvt_pk_bf16_f32 v78, v80, v81
v_cvt_pk_bf16_f32 v79, v82, v83
v_cvt_pk_bf16_f32 v236, v236, v237
v_cvt_pk_bf16_f32 v237, v238, v239
v_cvt_pk_bf16_f32 v238, v240, v241
v_cvt_pk_bf16_f32 v239, v242, v243
v_pk_mul_f32 v[84:85], v[84:85], v[102:103] op_sel:[0,1] op_sel_hi:[1,1]
v_pk_mul_f32 v[86:87], v[86:87], v[102:103] op_sel:[0,1] op_sel_hi:[1,1]
v_pk_mul_f32 v[88:89], v[88:89], v[102:103] op_sel:[0,1] op_sel_hi:[1,1]
v_pk_mul_f32 v[90:91], v[90:91], v[102:103] op_sel:[0,1] op_sel_hi:[1,1]
v_pk_mul_f32 v[244:245], v[244:245], v[106:107] op_sel:[0,1] op_sel_hi:[1,1]
v_pk_mul_f32 v[246:247], v[246:247], v[106:107] op_sel:[0,1] op_sel_hi:[1,1]
v_pk_mul_f32 v[248:249], v[248:249], v[106:107] op_sel:[0,1] op_sel_hi:[1,1]
v_pk_mul_f32 v[250:251], v[250:251], v[106:107] op_sel:[0,1] op_sel_hi:[1,1]
v_cvt_pk_bf16_f32 v84, v84, v85
v_cvt_pk_bf16_f32 v85, v86, v87
v_cvt_pk_bf16_f32 v86, v88, v89
v_cvt_pk_bf16_f32 v87, v90, v91
v_cvt_pk_bf16_f32 v244, v244, v245
v_cvt_pk_bf16_f32 v245, v246, v247
v_cvt_pk_bf16_f32 v246, v248, v249
v_cvt_pk_bf16_f32 v247, v250, v251
s_cmp_lg_u32 s51, 0
s_cbranch_scc1 else_97
s_mov_b32 s63, 0
sent_99:
s_waitcnt vmcnt(0)
v_max_u32 v4, v212, v213
v_max3_u32 v4, v4, v214, v215
v_max3_u32 v4, v4, v216, v217
v_max3_u32 v4, v4, v218, v219
v_cmp_eq_u32 vcc, -1, v4
s_cbranch_vccz sentd_100
buffer_load_dwordx4 v[212:215], v18, s[32:35], s55 offen offset:0 sc1
buffer_load_dwordx4 v[216:219], v18, s[32:35], s55 offen offset:1024 sc1
s_add_u32 s63, s63, 1
s_cmp_lt_u32 s63, 0x80000
s_cbranch_scc1 sent_99
s_waitcnt vmcnt(0)
sentd_100:
v_mfma_f32_16x16x32_bf16 v[132:135], v[44:47], v[212:215], 0
v_mfma_f32_16x16x32_bf16 v[132:135], v[44:47], v[216:219], v[132:135]
s_mov_b32 s51, 1
s_nop 6
v_add_f32_dpp v132, v132, v132 row_ror:8 row_mask:0xf bank_mask:0xf
v_add_f32_dpp v133, v133, v133 row_ror:8 row_mask:0xf bank_mask:0xf
v_add_f32_dpp v134, v134, v134 row_ror:8 row_mask:0xf bank_mask:0xf
v_add_f32_dpp v135, v135, v135 row_ror:8 row_mask:0xf bank_mask:0xf
v_cvt_pk_bf16_f32 v132, v132, v133
v_cvt_pk_bf16_f32 v133, v134, v135
s_mov_b64 exec, 0x00ff00ff
buffer_store_dwordx2 v[132:133], v59, s[32:35], s79 offen sc1
s_mov_b64 exec, -1
buffer_load_dwordx4 v[204:207], v58, s[32:35], s56 offen sc1
buffer_load_dwordx4 v[208:211], v58, s[32:35], s57 offen sc1
else_97:
s_mov_b32 s63, 0
sent_101:
s_waitcnt vmcnt(0)
v_max_u32 v4, v204, v205
v_max3_u32 v4, v4, v206, v207
v_max3_u32 v4, v4, v208, v209
v_max3_u32 v4, v4, v210, v211
v_cmp_eq_u32 vcc, -1, v4
s_cbranch_vccz sentd_102
buffer_load_dwordx4 v[204:207], v58, s[32:35], s56 offen sc1
buffer_load_dwordx4 v[208:211], v58, s[32:35], s57 offen sc1
s_add_u32 s63, s63, 1
s_cmp_lt_u32 s63, 0x80000
s_cbranch_scc1 sent_101
s_waitcnt vmcnt(0)
sentd_102:
buffer_load_dwordx4 v[188:191], v18, s[32:35], s58 offen offset:0 sc1
buffer_load_dwordx4 v[192:195], v18, s[32:35], s58 offen offset:1024 sc1
buffer_load_dwordx4 v[196:199], v18, s[32:35], s59 offen offset:0 sc1
buffer_load_dwordx4 v[200:203], v18, s[32:35], s59 offen offset:1024 sc1
v_mfma_f32_16x16x32_bf16 v[112:115], v[204:207], v[60:63], 0
v_mfma_f32_16x16x32_bf16 v[116:119], v[204:207], v[68:71], 0
v_mfma_f32_16x16x32_bf16 v[120:123], v[204:207], v[76:79], 0
v_mfma_f32_16x16x32_bf16 v[124:127], v[204:207], v[84:87], 0
v_mfma_f32_16x16x32_bf16 v[112:115], v[208:211], v[220:223], v[112:115]
v_mfma_f32_16x16x32_bf16 v[116:119], v[208:211], v[228:231], v[116:119]
v_mfma_f32_16x16x32_bf16 v[120:123], v[208:211], v[236:239], v[120:123]
v_mfma_f32_16x16x32_bf16 v[124:127], v[208:211], v[244:247], v[124:127]
s_nop 4
v_add_f32 v100, v112, v113
v_add_f32 v114, v114, v115
v_add_f32 v100, v100, v114
v_add_f32 v101, v116, v117
v_add_f32 v118, v118, v119
v_add_f32 v101, v101, v118
v_add_f32 v102, v120, v121
v_add_f32 v122, v122, v123
v_add_f32 v102, v102, v122
v_add_f32 v103, v124, v125
v_add_f32 v126, v126, v127
v_add_f32 v103, v103, v126
s_nop 1
v_permlane32_swap_b32 v100, v101
v_permlane32_swap_b32 v102, v103
v_add_f32 v100, v100, v101
v_add_f32 v102, v102, v103
s_nop 1
v_permlane16_swap_b32 v100, v102
s_nop 0
v_add_f32 v100, v100, v102
v_add_f32 v100, 0x358637bd, v100
v_rcp_f32 v100, v100
s_nop 0
v_mov_b32 v102, v100
s_nop 1
v_permlane16_swap_b32 v100, v102
s_nop 0
v_mov_b32 v101, v100
v_mov_b32 v103, v102
s_nop 0
v_permlane32_swap_b32 v100, v101
v_permlane32_swap_b32 v102, v103
s_mov_b32 s63, 0
sent_103:
s_waitcnt vmcnt(0)
v_max_u32 v4, v188, v189
v_max3_u32 v4, v4, v190, v191
v_max3_u32 v4, v4, v192, v193
v_max3_u32 v4, v4, v194, v195
v_max3_u32 v4, v4, v196, v197
v_max3_u32 v4, v4, v198, v199
v_max3_u32 v4, v4, v200, v201
v_max3_u32 v4, v4, v202, v203
v_cmp_eq_u32 vcc, -1, v4
s_cbranch_vccz sentd_104
buffer_load_dwordx4 v[188:191], v18, s[32:35], s58 offen offset:0 sc1
buffer_load_dwordx4 v[192:195], v18, s[32:35], s58 offen offset:1024 sc1
buffer_load_dwordx4 v[196:199], v18, s[32:35], s59 offen offset:0 sc1
buffer_load_dwordx4 v[200:203], v18, s[32:35], s59 offen offset:1024 sc1
s_add_u32 s63, s63, 1
s_cmp_lt_u32 s63, 0x80000
s_cbranch_scc1 sent_103
s_waitcnt vmcnt(0)
sentd_104:
v_mfma_f32_16x16x32_bf16 v[156:159], v[188:191], v[60:63], 0
v_mfma_f32_16x16x32_bf16 v[160:163], v[192:195], v[60:63], 0
v_mfma_f32_16x16x32_bf16 v[156:159], v[196:199], v[220:223], v[156:159]
v_mfma_f32_16x16x32_bf16 v[160:163], v[200:203], v[220:223], v[160:163]
v_mfma_f32_16x16x32_bf16 v[164:167], v[188:191], v[68:71], 0
v_mfma_f32_16x16x32_bf16 v[168:171], v[192:195], v[68:71], 0
v_mfma_f32_16x16x32_bf16 v[164:167], v[196:199], v[228:231], v[164:167]
v_mfma_f32_16x16x32_bf16 v[168:171], v[200:203], v[228:231], v[168:171]
v_mfma_f32_16x16x32_bf16 v[172:175], v[188:191], v[76:79], 0
v_mfma_f32_16x16x32_bf16 v[176:179], v[192:195], v[76:79], 0
v_mfma_f32_16x16x32_bf16 v[172:175], v[196:199], v[236:239], v[172:175]
v_mfma_f32_16x16x32_bf16 v[176:179], v[200:203], v[236:239], v[176:179]
v_mfma_f32_16x16x32_bf16 v[180:183], v[188:191], v[84:87], 0
v_mfma_f32_16x16x32_bf16 v[184:187], v[192:195], v[84:87], 0
v_mfma_f32_16x16x32_bf16 v[180:183], v[196:199], v[244:247], v[180:183]
v_mfma_f32_16x16x32_bf16 v[184:187], v[200:203], v[244:247], v[184:187]
s_cmp_eq_u32 s46, 0
s_cbranch_scc1 slow_105
.p2align 3
v_pk_mul_f32 v[156:157], v[156:157], v[100:101] op_sel:[0,0] op_sel_hi:[1,0]
v_pk_mul_f32 v[158:159], v[158:159], v[100:101] op_sel:[0,0] op_sel_hi:[1,0]
v_pk_mul_f32 v[160:161], v[160:161], v[100:101] op_sel:[0,0] op_sel_hi:[1,0]
v_pk_mul_f32 v[162:163], v[162:163], v[100:101] op_sel:[0,0] op_sel_hi:[1,0]
v_cvt_pk_bf16_f32 v156, v156, v157
v_cvt_pk_bf16_f32 v157, v158, v159
v_cvt_pk_bf16_f32 v158, v160, v161
v_cvt_pk_bf16_f32 v159, v162, v163
buffer_store_dwordx4 v[156:159], v18, s[32:35], s80 offen
v_pk_mul_f32 v[164:165], v[164:165], v[100:101] op_sel:[0,1] op_sel_hi:[1,1]
v_pk_mul_f32 v[166:167], v[166:167], v[100:101] op_sel:[0,1] op_sel_hi:[1,1]
v_pk_mul_f32 v[168:169], v[168:169], v[100:101] op_sel:[0,1] op_sel_hi:[1,1]
v_pk_mul_f32 v[170:171], v[170:171], v[100:101] op_sel:[0,1] op_sel_hi:[1,1]
v_cvt_pk_bf16_f32 v164, v164, v165
v_cvt_pk_bf16_f32 v165, v166, v167
v_cvt_pk_bf16_f32 v166, v168, v169
v_cvt_pk_bf16_f32 v167, v170, v171
buffer_store_dwordx4 v[164:167], v18, s[32:35], s81 offen
v_pk_mul_f32 v[172:173], v[172:173], v[102:103] op_sel:[0,0] op_sel_hi:[1,0]
v_pk_mul_f32 v[174:175], v[174:175], v[102:103] op_sel:[0,0] op_sel_hi:[1,0]
v_pk_mul_f32 v[176:177], v[176:177], v[102:103] op_sel:[0,0] op_sel_hi:[1,0]
v_pk_mul_f32 v[178:179], v[178:179], v[102:103] op_sel:[0,0] op_sel_hi:[1,0]
v_cvt_pk_bf16_f32 v172, v172, v173
v_cvt_pk_bf16_f32 v173, v174, v175
v_cvt_pk_bf16_f32 v174, v176, v177
v_cvt_pk_bf16_f32 v175, v178, v179
buffer_store_dwordx4 v[172:175], v18, s[32:35], s82 offen
v_pk_mul_f32 v[180:181], v[180:181], v[102:103] op_sel:[0,1] op_sel_hi:[1,1]
v_pk_mul_f32 v[182:183], v[182:183], v[102:103] op_sel:[0,1] op_sel_hi:[1,1]
v_pk_mul_f32 v[184:185], v[184:185], v[102:103] op_sel:[0,1] op_sel_hi:[1,1]
v_pk_mul_f32 v[186:187], v[186:187], v[102:103] op_sel:[0,1] op_sel_hi:[1,1]
v_cvt_pk_bf16_f32 v180, v180, v181
v_cvt_pk_bf16_f32 v181, v182, v183
v_cvt_pk_bf16_f32 v182, v184, v185
v_cvt_pk_bf16_f32 v183, v186, v187
buffer_store_dwordx4 v[180:183], v18, s[32:35], s83 offen
s_barrier
s_lshl_b32 s62, s45, 2
v_mov_b32 v4, s62
v_mov_b32 v5, 4
s_mov_b64 exec, 1
s_waitcnt vmcnt(0)
buffer_store_dword v5, v4, s[32:35], s84 offen
s_mov_b64 exec, -1
back_106:
v_and_b32 v36, 31, v0
v_lshlrev_b32 v36, 2, v36
buffer_load_dword v37, v36, s[32:35], s84 offen sc1
v_lshrrev_b32 v4, 2, v2
v_and_b32 v5, 3, v0
v_lshl_add_u32 v6, v3, 3, v4
v_lshlrev_b32 v6, 7, v6
v_lshl_add_u32 v6, v5, 3, v6
v_lshrrev_b32 v7, 1, v4
v_and_b32 v8, 1, v3
v_lshl_add_u32 v7, v8, 1, v7
v_lshl_add_u32 v10, v7, 5, v6
v_xor_b32 v11, 32, v10
v_xor_b32 v12, 64, v10
v_xor_b32 v13, 96, v10
v_add_u32 v14, 0x10000, v10
v_add_u32 v15, 0x10000, v11
v_add_u32 v16, 0x10000, v12
v_add_u32 v17, 0x10000, v13
ds_read_b64_tr_b16 v[220:221], v10 offset:0
ds_read_b64_tr_b16 v[222:223], v10 offset:512
ds_read_b64_tr_b16 v[224:225], v11 offset:0
ds_read_b64_tr_b16 v[226:227], v11 offset:512
ds_read_b64_tr_b16 v[228:229], v12 offset:0
ds_read_b64_tr_b16 v[230:231], v12 offset:512
ds_read_b64_tr_b16 v[232:233], v13 offset:0
ds_read_b64_tr_b16 v[234:235], v13 offset:512
ds_read_b64_tr_b16 v[236:237], v10 offset:4096
ds_read_b64_tr_b16 v[238:239], v10 offset:4608
ds_read_b64_tr_b16 v[240:241], v11 offset:4096
ds_read_b64_tr_b16 v[242:243], v11 offset:4608
ds_read_b64_tr_b16 v[244:245], v12 offset:4096
ds_read_b64_tr_b16 v[246:247], v12 offset:4608
ds_read_b64_tr_b16 v[248:249], v13 offset:4096
ds_read_b64_tr_b16 v[250:251], v13 offset:4608
s_lshl_b32 s48, s41, 3
s_lshl_b32 s49, s40, 1
s_add_u32 s48, s48, s49
s_lshl_b32 s48, s48, 15
s_add_u32 s48, s48, 4194304
v_add_u32 v38, s48, v18
v_add_u32 v39, 32768, v38
s_lshl_b32 s57, s75, 11
s_add_u32 s87, s87, 262144
v_lshlrev_b32 v60, 16, v20
v_and_b32 v61, 0xffff0000, v20
v_lshlrev_b32 v62, 16, v21
v_and_b32 v63, 0xffff0000, v21
v_lshlrev_b32 v64, 16, v22
v_and_b32 v65, 0xffff0000, v22
v_lshlrev_b32 v66, 16, v23
v_and_b32 v67, 0xffff0000, v23
v_lshlrev_b32 v68, 16, v24
v_and_b32 v69, 0xffff0000, v24
v_lshlrev_b32 v70, 16, v25
v_and_b32 v71, 0xffff0000, v25
v_lshlrev_b32 v72, 16, v26
v_and_b32 v73, 0xffff0000, v26
v_lshlrev_b32 v74, 16, v27
v_and_b32 v75, 0xffff0000, v27
v_lshlrev_b32 v76, 16, v28
v_and_b32 v77, 0xffff0000, v28
v_lshlrev_b32 v78, 16, v29
v_and_b32 v79, 0xffff0000, v29
v_lshlrev_b32 v80, 16, v30
v_and_b32 v81, 0xffff0000, v30
v_lshlrev_b32 v82, 16, v31
v_and_b32 v83, 0xffff0000, v31
v_lshlrev_b32 v84, 16, v32
v_and_b32 v85, 0xffff0000, v32
v_lshlrev_b32 v86, 16, v33
v_and_b32 v87, 0xffff0000, v33
v_lshlrev_b32 v88, 16, v34
v_and_b32 v89, 0xffff0000, v34
v_lshlrev_b32 v90, 16, v35
v_and_b32 v91, 0xffff0000, v35
s_lshl_b32 s48, s41, 7
s_lshl_b32 s49, s40, 5
s_add_u32 s48, s48, s49
v_add_u32 v4, s48, v2
v_lshlrev_b32 v4, 11, v4
v_and_b32 v5, 1, v3
v_lshl_add_u32 v4, v5, 5, v4
v_lshrrev_b32 v5, 1, v3
v_lshl_add_u32 v4, v5, 4, v4
s_lshl_b32 s49, s78, 7
v_add_u32 v40, s49, v4
v_add_u32 v41, 32768, v40
s_mov_b32 s63, 0
s_waitcnt vmcnt(0)
poll_107:
v_cmp_gt_u32 vcc, 4, v37
s_cbranch_vccz polled_108
buffer_load_dword v37, v36, s[32:35], s84 offen sc1
s_add_u32 s63, s63, 1
s_cmp_lt_u32 s63, 0x80000
s_waitcnt vmcnt(0)
s_cbranch_scc1 poll_107
polled_108:
buffer_load_dwordx4 v[156:159], v38, s[32:35], s57 offen sc1
buffer_load_dwordx4 v[160:163], v39, s[32:35], s57 offen sc1
buffer_load_dwordx4 v[164:167], v38, s[32:35], s57 offen offset:1024 sc1
buffer_load_dwordx4 v[168:171], v39, s[32:35], s57 offen offset:1024 sc1
s_add_u32 s57, s57, 2048
s_and_b32 s57, s57, 0x7fff
buffer_load_dwordx4 v[172:175], v38, s[32:35], s57 offen sc1
buffer_load_dwordx4 v[176:179], v39, s[32:35], s57 offen sc1
buffer_load_dwordx4 v[180:183], v38, s[32:35], s57 offen offset:1024 sc1
buffer_load_dwordx4 v[184:187], v39, s[32:35], s57 offen offset:1024 sc1
s_add_u32 s57, s57, 2048
s_and_b32 s57, s57, 0x7fff
s_waitcnt vmcnt(6) lgkmcnt(8)
v_mfma_f32_16x16x32_bf16 v[60:63], v[220:223], v[156:159], v[60:63]
buffer_load_dwordx4 v[188:191], v38, s[32:35], s57 offen sc1
v_mfma_f32_16x16x32_bf16 v[76:79], v[220:223], v[160:163], v[76:79]
ds_read_b64_tr_b16 v[100:101], v10 offset:8192
ds_read_b64_tr_b16 v[102:103], v10 offset:8704
v_mfma_f32_16x16x32_bf16 v[64:67], v[224:227], v[156:159], v[64:67]
ds_read_b64_tr_b16 v[104:105], v11 offset:8192
ds_read_b64_tr_b16 v[106:107], v11 offset:8704
v_mfma_f32_16x16x32_bf16 v[80:83], v[224:227], v[160:163], v[80:83]
buffer_load_dwordx4 v[192:195], v39, s[32:35], s57 offen sc1
v_mfma_f32_16x16x32_bf16 v[68:71], v[228:231], v[156:159], v[68:71]
ds_read_b64_tr_b16 v[108:109], v12 offset:8192
ds_read_b64_tr_b16 v[110:111], v12 offset:8704
v_mfma_f32_16x16x32_bf16 v[84:87], v[228:231], v[160:163], v[84:87]
ds_read_b64_tr_b16 v[112:113], v13 offset:8192
ds_read_b64_tr_b16 v[114:115], v13 offset:8704
v_mfma_f32_16x16x32_bf16 v[72:75], v[232:235], v[156:159], v[72:75]
v_mfma_f32_16x16x32_bf16 v[88:91], v[232:235], v[160:163], v[88:91]
s_waitcnt vmcnt(6) lgkmcnt(8)
v_mfma_f32_16x16x32_bf16 v[60:63], v[236:239], v[164:167], v[60:63]
buffer_load_dwordx4 v[196:199], v38, s[32:35], s57 offen offset:1024 sc1
v_mfma_f32_16x16x32_bf16 v[76:79], v[236:239], v[168:171], v[76:79]
ds_read_b64_tr_b16 v[220:221], v10 offset:12288
ds_read_b64_tr_b16 v[222:223], v10 offset:12800
v_mfma_f32_16x16x32_bf16 v[64:67], v[240:243], v[164:167], v[64:67]
ds_read_b64_tr_b16 v[224:225], v11 offset:12288
ds_read_b64_tr_b16 v[226:227], v11 offset:12800
v_mfma_f32_16x16x32_bf16 v[80:83], v[240:243], v[168:171], v[80:83]
buffer_load_dwordx4 v[200:203], v39, s[32:35], s57 offen offset:1024 sc1
v_mfma_f32_16x16x32_bf16 v[68:71], v[244:247], v[164:167], v[68:71]
ds_read_b64_tr_b16 v[228:229], v12 offset:12288
ds_read_b64_tr_b16 v[230:231], v12 offset:12800
v_mfma_f32_16x16x32_bf16 v[84:87], v[244:247], v[168:171], v[84:87]
ds_read_b64_tr_b16 v[232:233], v13 offset:12288
ds_read_b64_tr_b16 v[234:235], v13 offset:12800
v_mfma_f32_16x16x32_bf16 v[72:75], v[248:251], v[164:167], v[72:75]
s_add_u32 s57, s57, 2048
s_and_b32 s57, s57, 0x7fff
v_mfma_f32_16x16x32_bf16 v[88:91], v[248:251], v[168:171], v[88:91]
s_waitcnt vmcnt(6) lgkmcnt(8)
v_mfma_f32_16x16x32_bf16 v[60:63], v[100:103], v[172:175], v[60:63]
buffer_load_dwordx4 v[204:207], v38, s[32:35], s57 offen sc1
v_mfma_f32_16x16x32_bf16 v[76:79], v[100:103], v[176:179], v[76:79]
ds_read_b64_tr_b16 v[236:237], v10 offset:16384
ds_read_b64_tr_b16 v[238:239], v10 offset:16896
v_mfma_f32_16x16x32_bf16 v[64:67], v[104:107], v[172:175], v[64:67]
ds_read_b64_tr_b16 v[240:241], v11 offset:16384
ds_read_b64_tr_b16 v[242:243], v11 offset:16896
v_mfma_f32_16x16x32_bf16 v[80:83], v[104:107], v[176:179], v[80:83]
buffer_load_dwordx4 v[208:211], v39, s[32:35], s57 offen sc1
v_mfma_f32_16x16x32_bf16 v[68:71], v[108:111], v[172:175], v[68:71]
ds_read_b64_tr_b16 v[244:245], v12 offset:16384
ds_read_b64_tr_b16 v[246:247], v12 offset:16896
v_mfma_f32_16x16x32_bf16 v[84:87], v[108:111], v[176:179], v[84:87]
ds_read_b64_tr_b16 v[248:249], v13 offset:16384
ds_read_b64_tr_b16 v[250:251], v13 offset:16896
v_mfma_f32_16x16x32_bf16 v[72:75], v[112:115], v[172:175], v[72:75]
v_mfma_f32_16x16x32_bf16 v[88:91], v[112:115], v[176:179], v[88:91]
s_waitcnt vmcnt(6) lgkmcnt(8)
v_mfma_f32_16x16x32_bf16 v[60:63], v[220:223], v[180:183], v[60:63]
buffer_load_dwordx4 v[212:215], v38, s[32:35], s57 offen offset:1024 sc1
v_mfma_f32_16x16x32_bf16 v[76:79], v[220:223], v[184:187], v[76:79]
ds_read_b64_tr_b16 v[100:101], v10 offset:20480
ds_read_b64_tr_b16 v[102:103], v10 offset:20992
v_mfma_f32_16x16x32_bf16 v[64:67], v[224:227], v[180:183], v[64:67]
ds_read_b64_tr_b16 v[104:105], v11 offset:20480
ds_read_b64_tr_b16 v[106:107], v11 offset:20992
v_mfma_f32_16x16x32_bf16 v[80:83], v[224:227], v[184:187], v[80:83]
buffer_load_dwordx4 v[216:219], v39, s[32:35], s57 offen offset:1024 sc1
v_mfma_f32_16x16x32_bf16 v[68:71], v[228:231], v[180:183], v[68:71]
ds_read_b64_tr_b16 v[108:109], v12 offset:20480
ds_read_b64_tr_b16 v[110:111], v12 offset:20992
v_mfma_f32_16x16x32_bf16 v[84:87], v[228:231], v[184:187], v[84:87]
ds_read_b64_tr_b16 v[112:113], v13 offset:20480
ds_read_b64_tr_b16 v[114:115], v13 offset:20992
v_mfma_f32_16x16x32_bf16 v[72:75], v[232:235], v[180:183], v[72:75]
s_add_u32 s57, s57, 2048
s_and_b32 s57, s57, 0x7fff
v_mfma_f32_16x16x32_bf16 v[88:91], v[232:235], v[184:187], v[88:91]
s_waitcnt vmcnt(6) lgkmcnt(8)
v_mfma_f32_16x16x32_bf16 v[60:63], v[236:239], v[188:191], v[60:63]
buffer_load_dwordx4 v[156:159], v38, s[32:35], s57 offen sc1
v_mfma_f32_16x16x32_bf16 v[76:79], v[236:239], v[192:195], v[76:79]
ds_read_b64_tr_b16 v[220:221], v10 offset:24576
ds_read_b64_tr_b16 v[222:223], v10 offset:25088
v_mfma_f32_16x16x32_bf16 v[64:67], v[240:243], v[188:191], v[64:67]
ds_read_b64_tr_b16 v[224:225], v11 offset:24576
ds_read_b64_tr_b16 v[226:227], v11 offset:25088
v_mfma_f32_16x16x32_bf16 v[80:83], v[240:243], v[192:195], v[80:83]
buffer_load_dwordx4 v[160:163], v39, s[32:35], s57 offen sc1
v_mfma_f32_16x16x32_bf16 v[68:71], v[244:247], v[188:191], v[68:71]
ds_read_b64_tr_b16 v[228:229], v12 offset:24576
ds_read_b64_tr_b16 v[230:231], v12 offset:25088
v_mfma_f32_16x16x32_bf16 v[84:87], v[244:247], v[192:195], v[84:87]
ds_read_b64_tr_b16 v[232:233], v13 offset:24576
ds_read_b64_tr_b16 v[234:235], v13 offset:25088
v_mfma_f32_16x16x32_bf16 v[72:75], v[248:251], v[188:191], v[72:75]
v_mfma_f32_16x16x32_bf16 v[88:91], v[248:251], v[192:195], v[88:91]
s_waitcnt vmcnt(6) lgkmcnt(8)
v_mfma_f32_16x16x32_bf16 v[60:63], v[100:103], v[196:199], v[60:63]
buffer_load_dwordx4 v[164:167], v38, s[32:35], s57 offen offset:1024 sc1
v_mfma_f32_16x16x32_bf16 v[76:79], v[100:103], v[200:203], v[76:79]
ds_read_b64_tr_b16 v[236:237], v10 offset:28672
ds_read_b64_tr_b16 v[238:239], v10 offset:29184
v_mfma_f32_16x16x32_bf16 v[64:67], v[104:107], v[196:199], v[64:67]
ds_read_b64_tr_b16 v[240:241], v11 offset:28672
ds_read_b64_tr_b16 v[242:243], v11 offset:29184
v_mfma_f32_16x16x32_bf16 v[80:83], v[104:107], v[200:203], v[80:83]
buffer_load_dwordx4 v[168:171], v39, s[32:35], s57 offen offset:1024 sc1
v_mfma_f32_16x16x32_bf16 v[68:71], v[108:111], v[196:199], v[68:71]
ds_read_b64_tr_b16 v[244:245], v12 offset:28672
ds_read_b64_tr_b16 v[246:247], v12 offset:29184
v_mfma_f32_16x16x32_bf16 v[84:87], v[108:111], v[200:203], v[84:87]
ds_read_b64_tr_b16 v[248:249], v13 offset:28672
ds_read_b64_tr_b16 v[250:251], v13 offset:29184
v_mfma_f32_16x16x32_bf16 v[72:75], v[112:115], v[196:199], v[72:75]
s_add_u32 s57, s57, 2048
s_and_b32 s57, s57, 0x7fff
v_mfma_f32_16x16x32_bf16 v[88:91], v[112:115], v[200:203], v[88:91]
s_waitcnt vmcnt(6) lgkmcnt(8)
v_mfma_f32_16x16x32_bf16 v[60:63], v[220:223], v[204:207], v[60:63]
buffer_load_dwordx4 v[172:175], v38, s[32:35], s57 offen sc1
v_mfma_f32_16x16x32_bf16 v[76:79], v[220:223], v[208:211], v[76:79]
ds_read_b64_tr_b16 v[100:101], v10 offset:32768
ds_read_b64_tr_b16 v[102:103], v10 offset:33280
v_mfma_f32_16x16x32_bf16 v[64:67], v[224:227], v[204:207], v[64:67]
ds_read_b64_tr_b16 v[104:105], v11 offset:32768
ds_read_b64_tr_b16 v[106:107], v11 offset:33280
v_mfma_f32_16x16x32_bf16 v[80:83], v[224:227], v[208:211], v[80:83]
buffer_load_dwordx4 v[176:179], v39, s[32:35], s57 offen sc1
v_mfma_f32_16x16x32_bf16 v[68:71], v[228:231], v[204:207], v[68:71]
ds_read_b64_tr_b16 v[108:109], v12 offset:32768
ds_read_b64_tr_b16 v[110:111], v12 offset:33280
v_mfma_f32_16x16x32_bf16 v[84:87], v[228:231], v[208:211], v[84:87]
ds_read_b64_tr_b16 v[112:113], v13 offset:32768
ds_read_b64_tr_b16 v[114:115], v13 offset:33280
v_mfma_f32_16x16x32_bf16 v[72:75], v[232:235], v[204:207], v[72:75]
v_mfma_f32_16x16x32_bf16 v[88:91], v[232:235], v[208:211], v[88:91]
s_waitcnt vmcnt(6) lgkmcnt(8)
v_mfma_f32_16x16x32_bf16 v[60:63], v[236:239], v[212:215], v[60:63]
buffer_load_dwordx4 v[180:183], v38, s[32:35], s57 offen offset:1024 sc1
v_mfma_f32_16x16x32_bf16 v[76:79], v[236:239], v[216:219], v[76:79]
ds_read_b64_tr_b16 v[220:221], v10 offset:36864
ds_read_b64_tr_b16 v[222:223], v10 offset:37376
v_mfma_f32_16x16x32_bf16 v[64:67], v[240:243], v[212:215], v[64:67]
ds_read_b64_tr_b16 v[224:225], v11 offset:36864
ds_read_b64_tr_b16 v[226:227], v11 offset:37376
v_mfma_f32_16x16x32_bf16 v[80:83], v[240:243], v[216:219], v[80:83]
buffer_load_dwordx4 v[184:187], v39, s[32:35], s57 offen offset:1024 sc1
v_mfma_f32_16x16x32_bf16 v[68:71], v[244:247], v[212:215], v[68:71]
ds_read_b64_tr_b16 v[228:229], v12 offset:36864
ds_read_b64_tr_b16 v[230:231], v12 offset:37376
v_mfma_f32_16x16x32_bf16 v[84:87], v[244:247], v[216:219], v[84:87]
ds_read_b64_tr_b16 v[232:233], v13 offset:36864
ds_read_b64_tr_b16 v[234:235], v13 offset:37376
v_mfma_f32_16x16x32_bf16 v[72:75], v[248:251], v[212:215], v[72:75]
s_add_u32 s57, s57, 2048
s_and_b32 s57, s57, 0x7fff
v_mfma_f32_16x16x32_bf16 v[88:91], v[248:251], v[216:219], v[88:91]
s_waitcnt vmcnt(6) lgkmcnt(8)
v_mfma_f32_16x16x32_bf16 v[60:63], v[100:103], v[156:159], v[60:63]
buffer_load_dwordx4 v[188:191], v38, s[32:35], s57 offen sc1
v_mfma_f32_16x16x32_bf16 v[76:79], v[100:103], v[160:163], v[76:79]
ds_read_b64_tr_b16 v[236:237], v10 offset:40960
ds_read_b64_tr_b16 v[238:239], v10 offset:41472
v_mfma_f32_16x16x32_bf16 v[64:67], v[104:107], v[156:159], v[64:67]
ds_read_b64_tr_b16 v[240:241], v11 offset:40960
ds_read_b64_tr_b16 v[242:243], v11 offset:41472
v_mfma_f32_16x16x32_bf16 v[80:83], v[104:107], v[160:163], v[80:83]
buffer_load_dwordx4 v[192:195], v39, s[32:35], s57 offen sc1
v_mfma_f32_16x16x32_bf16 v[68:71], v[108:111], v[156:159], v[68:71]
ds_read_b64_tr_b16 v[244:245], v12 offset:40960
ds_read_b64_tr_b16 v[246:247], v12 offset:41472
v_mfma_f32_16x16x32_bf16 v[84:87], v[108:111], v[160:163], v[84:87]
ds_read_b64_tr_b16 v[248:249], v13 offset:40960
ds_read_b64_tr_b16 v[250:251], v13 offset:41472
v_mfma_f32_16x16x32_bf16 v[72:75], v[112:115], v[156:159], v[72:75]
v_mfma_f32_16x16x32_bf16 v[88:91], v[112:115], v[160:163], v[88:91]
s_waitcnt vmcnt(6) lgkmcnt(8)
v_mfma_f32_16x16x32_bf16 v[60:63], v[220:223], v[164:167], v[60:63]
buffer_load_dwordx4 v[196:199], v38, s[32:35], s57 offen offset:1024 sc1
v_mfma_f32_16x16x32_bf16 v[76:79], v[220:223], v[168:171], v[76:79]
ds_read_b64_tr_b16 v[100:101], v10 offset:45056
ds_read_b64_tr_b16 v[102:103], v10 offset:45568
v_mfma_f32_16x16x32_bf16 v[64:67], v[224:227], v[164:167], v[64:67]
ds_read_b64_tr_b16 v[104:105], v11 offset:45056
ds_read_b64_tr_b16 v[106:107], v11 offset:45568
v_mfma_f32_16x16x32_bf16 v[80:83], v[224:227], v[168:171], v[80:83]
buffer_load_dwordx4 v[200:203], v39, s[32:35], s57 offen offset:1024 sc1
v_mfma_f32_16x16x32_bf16 v[68:71], v[228:231], v[164:167], v[68:71]
ds_read_b64_tr_b16 v[108:109], v12 offset:45056
ds_read_b64_tr_b16 v[110:111], v12 offset:45568
v_mfma_f32_16x16x32_bf16 v[84:87], v[228:231], v[168:171], v[84:87]
ds_read_b64_tr_b16 v[112:113], v13 offset:45056
ds_read_b64_tr_b16 v[114:115], v13 offset:45568
v_mfma_f32_16x16x32_bf16 v[72:75], v[232:235], v[164:167], v[72:75]
s_add_u32 s57, s57, 2048
s_and_b32 s57, s57, 0x7fff
v_mfma_f32_16x16x32_bf16 v[88:91], v[232:235], v[168:171], v[88:91]
s_waitcnt vmcnt(6) lgkmcnt(8)
v_mfma_f32_16x16x32_bf16 v[60:63], v[236:239], v[172:175], v[60:63]
buffer_load_dwordx4 v[204:207], v38, s[32:35], s57 offen sc1
v_mfma_f32_16x16x32_bf16 v[76:79], v[236:239], v[176:179], v[76:79]
ds_read_b64_tr_b16 v[220:221], v10 offset:49152
ds_read_b64_tr_b16 v[222:223], v10 offset:49664
v_mfma_f32_16x16x32_bf16 v[64:67], v[240:243], v[172:175], v[64:67]
ds_read_b64_tr_b16 v[224:225], v11 offset:49152
ds_read_b64_tr_b16 v[226:227], v11 offset:49664
v_mfma_f32_16x16x32_bf16 v[80:83], v[240:243], v[176:179], v[80:83]
buffer_load_dwordx4 v[208:211], v39, s[32:35], s57 offen sc1
v_mfma_f32_16x16x32_bf16 v[68:71], v[244:247], v[172:175], v[68:71]
ds_read_b64_tr_b16 v[228:229], v12 offset:49152
ds_read_b64_tr_b16 v[230:231], v12 offset:49664
v_mfma_f32_16x16x32_bf16 v[84:87], v[244:247], v[176:179], v[84:87]
ds_read_b64_tr_b16 v[232:233], v13 offset:49152
ds_read_b64_tr_b16 v[234:235], v13 offset:49664
v_mfma_f32_16x16x32_bf16 v[72:75], v[248:251], v[172:175], v[72:75]
v_mfma_f32_16x16x32_bf16 v[88:91], v[248:251], v[176:179], v[88:91]
s_waitcnt vmcnt(6) lgkmcnt(8)
v_mfma_f32_16x16x32_bf16 v[60:63], v[100:103], v[180:183], v[60:63]
buffer_load_dwordx4 v[212:215], v38, s[32:35], s57 offen offset:1024 sc1
v_mfma_f32_16x16x32_bf16 v[76:79], v[100:103], v[184:187], v[76:79]
ds_read_b64_tr_b16 v[236:237], v10 offset:53248
ds_read_b64_tr_b16 v[238:239], v10 offset:53760
v_mfma_f32_16x16x32_bf16 v[64:67], v[104:107], v[180:183], v[64:67]
ds_read_b64_tr_b16 v[240:241], v11 offset:53248
ds_read_b64_tr_b16 v[242:243], v11 offset:53760
v_mfma_f32_16x16x32_bf16 v[80:83], v[104:107], v[184:187], v[80:83]
buffer_load_dwordx4 v[216:219], v39, s[32:35], s57 offen offset:1024 sc1
v_mfma_f32_16x16x32_bf16 v[68:71], v[108:111], v[180:183], v[68:71]
ds_read_b64_tr_b16 v[244:245], v12 offset:53248
ds_read_b64_tr_b16 v[246:247], v12 offset:53760
v_mfma_f32_16x16x32_bf16 v[84:87], v[108:111], v[184:187], v[84:87]
ds_read_b64_tr_b16 v[248:249], v13 offset:53248
ds_read_b64_tr_b16 v[250:251], v13 offset:53760
v_mfma_f32_16x16x32_bf16 v[72:75], v[112:115], v[180:183], v[72:75]
s_add_u32 s57, s57, 2048
s_and_b32 s57, s57, 0x7fff
v_mfma_f32_16x16x32_bf16 v[88:91], v[112:115], v[184:187], v[88:91]
s_waitcnt vmcnt(6) lgkmcnt(8)
v_mfma_f32_16x16x32_bf16 v[60:63], v[220:223], v[188:191], v[60:63]
buffer_load_dwordx4 v[156:159], v38, s[32:35], s57 offen sc1
v_mfma_f32_16x16x32_bf16 v[76:79], v[220:223], v[192:195], v[76:79]
ds_read_b64_tr_b16 v[100:101], v10 offset:57344
ds_read_b64_tr_b16 v[102:103], v10 offset:57856
v_mfma_f32_16x16x32_bf16 v[64:67], v[224:227], v[188:191], v[64:67]
ds_read_b64_tr_b16 v[104:105], v11 offset:57344
ds_read_b64_tr_b16 v[106:107], v11 offset:57856
v_mfma_f32_16x16x32_bf16 v[80:83], v[224:227], v[192:195], v[80:83]
buffer_load_dwordx4 v[160:163], v39, s[32:35], s57 offen sc1
v_mfma_f32_16x16x32_bf16 v[68:71], v[228:231], v[188:191], v[68:71]
ds_read_b64_tr_b16 v[108:109], v12 offset:57344
ds_read_b64_tr_b16 v[110:111], v12 offset:57856
v_mfma_f32_16x16x32_bf16 v[84:87], v[228:231], v[192:195], v[84:87]
ds_read_b64_tr_b16 v[112:113], v13 offset:57344
ds_read_b64_tr_b16 v[114:115], v13 offset:57856
v_mfma_f32_16x16x32_bf16 v[72:75], v[232:235], v[188:191], v[72:75]
v_mfma_f32_16x16x32_bf16 v[88:91], v[232:235], v[192:195], v[88:91]
s_waitcnt vmcnt(6) lgkmcnt(8)
v_mfma_f32_16x16x32_bf16 v[60:63], v[236:239], v[196:199], v[60:63]
buffer_load_dwordx4 v[164:167], v38, s[32:35], s57 offen offset:1024 sc1
v_mfma_f32_16x16x32_bf16 v[76:79], v[236:239], v[200:203], v[76:79]
ds_read_b64_tr_b16 v[220:221], v10 offset:61440
ds_read_b64_tr_b16 v[222:223], v10 offset:61952
v_mfma_f32_16x16x32_bf16 v[64:67], v[240:243], v[196:199], v[64:67]
ds_read_b64_tr_b16 v[224:225], v11 offset:61440
ds_read_b64_tr_b16 v[226:227], v11 offset:61952
v_mfma_f32_16x16x32_bf16 v[80:83], v[240:243], v[200:203], v[80:83]
buffer_load_dwordx4 v[168:171], v39, s[32:35], s57 offen offset:1024 sc1
v_mfma_f32_16x16x32_bf16 v[68:71], v[244:247], v[196:199], v[68:71]
ds_read_b64_tr_b16 v[228:229], v12 offset:61440
ds_read_b64_tr_b16 v[230:231], v12 offset:61952
v_mfma_f32_16x16x32_bf16 v[84:87], v[244:247], v[200:203], v[84:87]
ds_read_b64_tr_b16 v[232:233], v13 offset:61440
ds_read_b64_tr_b16 v[234:235], v13 offset:61952
v_mfma_f32_16x16x32_bf16 v[72:75], v[248:251], v[196:199], v[72:75]
s_add_u32 s57, s57, 2048
s_and_b32 s57, s57, 0x7fff
v_mfma_f32_16x16x32_bf16 v[88:91], v[248:251], v[200:203], v[88:91]
s_waitcnt vmcnt(6) lgkmcnt(8)
v_mfma_f32_16x16x32_bf16 v[60:63], v[100:103], v[204:207], v[60:63]
buffer_load_dwordx4 v[172:175], v38, s[32:35], s57 offen sc1
v_mfma_f32_16x16x32_bf16 v[76:79], v[100:103], v[208:211], v[76:79]
ds_read_b64_tr_b16 v[236:237], v14 offset:0
ds_read_b64_tr_b16 v[238:239], v14 offset:512
v_mfma_f32_16x16x32_bf16 v[64:67], v[104:107], v[204:207], v[64:67]
ds_read_b64_tr_b16 v[240:241], v15 offset:0
ds_read_b64_tr_b16 v[242:243], v15 offset:512
v_mfma_f32_16x16x32_bf16 v[80:83], v[104:107], v[208:211], v[80:83]
buffer_load_dwordx4 v[176:179], v39, s[32:35], s57 offen sc1
v_mfma_f32_16x16x32_bf16 v[68:71], v[108:111], v[204:207], v[68:71]
ds_read_b64_tr_b16 v[244:245], v16 offset:0
ds_read_b64_tr_b16 v[246:247], v16 offset:512
v_mfma_f32_16x16x32_bf16 v[84:87], v[108:111], v[208:211], v[84:87]
ds_read_b64_tr_b16 v[248:249], v17 offset:0
ds_read_b64_tr_b16 v[250:251], v17 offset:512
v_mfma_f32_16x16x32_bf16 v[72:75], v[112:115], v[204:207], v[72:75]
v_mfma_f32_16x16x32_bf16 v[88:91], v[112:115], v[208:211], v[88:91]
s_waitcnt vmcnt(6) lgkmcnt(8)
v_mfma_f32_16x16x32_bf16 v[60:63], v[220:223], v[212:215], v[60:63]
buffer_load_dwordx4 v[180:183], v38, s[32:35], s57 offen offset:1024 sc1
v_mfma_f32_16x16x32_bf16 v[76:79], v[220:223], v[216:219], v[76:79]
ds_read_b64_tr_b16 v[100:101], v14 offset:4096
ds_read_b64_tr_b16 v[102:103], v14 offset:4608
v_mfma_f32_16x16x32_bf16 v[64:67], v[224:227], v[212:215], v[64:67]
ds_read_b64_tr_b16 v[104:105], v15 offset:4096
ds_read_b64_tr_b16 v[106:107], v15 offset:4608
v_mfma_f32_16x16x32_bf16 v[80:83], v[224:227], v[216:219], v[80:83]
buffer_load_dwordx4 v[184:187], v39, s[32:35], s57 offen offset:1024 sc1
v_mfma_f32_16x16x32_bf16 v[68:71], v[228:231], v[212:215], v[68:71]
ds_read_b64_tr_b16 v[108:109], v16 offset:4096
ds_read_b64_tr_b16 v[110:111], v16 offset:4608
v_mfma_f32_16x16x32_bf16 v[84:87], v[228:231], v[216:219], v[84:87]
ds_read_b64_tr_b16 v[112:113], v17 offset:4096
ds_read_b64_tr_b16 v[114:115], v17 offset:4608
v_mfma_f32_16x16x32_bf16 v[72:75], v[232:235], v[212:215], v[72:75]
s_add_u32 s57, s57, 2048
s_and_b32 s57, s57, 0x7fff
v_mfma_f32_16x16x32_bf16 v[88:91], v[232:235], v[216:219], v[88:91]
s_waitcnt vmcnt(6) lgkmcnt(8)
v_mfma_f32_16x16x32_bf16 v[60:63], v[236:239], v[156:159], v[60:63]
buffer_load_dwordx4 v[188:191], v38, s[32:35], s57 offen sc1
v_mfma_f32_16x16x32_bf16 v[76:79], v[236:239], v[160:163], v[76:79]
ds_read_b64_tr_b16 v[220:221], v14 offset:8192
ds_read_b64_tr_b16 v[222:223], v14 offset:8704
v_mfma_f32_16x16x32_bf16 v[64:67], v[240:243], v[156:159], v[64:67]
ds_read_b64_tr_b16 v[224:225], v15 offset:8192
ds_read_b64_tr_b16 v[226:227], v15 offset:8704
v_mfma_f32_16x16x32_bf16 v[80:83], v[240:243], v[160:163], v[80:83]
buffer_load_dwordx4 v[192:195], v39, s[32:35], s57 offen sc1
v_mfma_f32_16x16x32_bf16 v[68:71], v[244:247], v[156:159], v[68:71]
ds_read_b64_tr_b16 v[228:229], v16 offset:8192
ds_read_b64_tr_b16 v[230:231], v16 offset:8704
v_mfma_f32_16x16x32_bf16 v[84:87], v[244:247], v[160:163], v[84:87]
ds_read_b64_tr_b16 v[232:233], v17 offset:8192
ds_read_b64_tr_b16 v[234:235], v17 offset:8704
v_mfma_f32_16x16x32_bf16 v[72:75], v[248:251], v[156:159], v[72:75]
v_mfma_f32_16x16x32_bf16 v[88:91], v[248:251], v[160:163], v[88:91]
s_waitcnt vmcnt(6) lgkmcnt(8)
v_mfma_f32_16x16x32_bf16 v[60:63], v[100:103], v[164:167], v[60:63]
buffer_load_dwordx4 v[196:199], v38, s[32:35], s57 offen offset:1024 sc1
v_mfma_f32_16x16x32_bf16 v[76:79], v[100:103], v[168:171], v[76:79]
ds_read_b64_tr_b16 v[236:237], v14 offset:12288
ds_read_b64_tr_b16 v[238:239], v14 offset:12800
v_mfma_f32_16x16x32_bf16 v[64:67], v[104:107], v[164:167], v[64:67]
ds_read_b64_tr_b16 v[240:241], v15 offset:12288
ds_read_b64_tr_b16 v[242:243], v15 offset:12800
v_mfma_f32_16x16x32_bf16 v[80:83], v[104:107], v[168:171], v[80:83]
buffer_load_dwordx4 v[200:203], v39, s[32:35], s57 offen offset:1024 sc1
v_mfma_f32_16x16x32_bf16 v[68:71], v[108:111], v[164:167], v[68:71]
ds_read_b64_tr_b16 v[244:245], v16 offset:12288
ds_read_b64_tr_b16 v[246:247], v16 offset:12800
v_mfma_f32_16x16x32_bf16 v[84:87], v[108:111], v[168:171], v[84:87]
ds_read_b64_tr_b16 v[248:249], v17 offset:12288
ds_read_b64_tr_b16 v[250:251], v17 offset:12800
v_mfma_f32_16x16x32_bf16 v[72:75], v[112:115], v[164:167], v[72:75]
s_add_u32 s57, s57, 2048
s_and_b32 s57, s57, 0x7fff
v_mfma_f32_16x16x32_bf16 v[88:91], v[112:115], v[168:171], v[88:91]
s_waitcnt vmcnt(6) lgkmcnt(8)
v_mfma_f32_16x16x32_bf16 v[60:63], v[220:223], v[172:175], v[60:63]
buffer_load_dwordx4 v[204:207], v38, s[32:35], s57 offen sc1
v_mfma_f32_16x16x32_bf16 v[76:79], v[220:223], v[176:179], v[76:79]
ds_read_b64_tr_b16 v[100:101], v14 offset:16384
ds_read_b64_tr_b16 v[102:103], v14 offset:16896
v_mfma_f32_16x16x32_bf16 v[64:67], v[224:227], v[172:175], v[64:67]
ds_read_b64_tr_b16 v[104:105], v15 offset:16384
ds_read_b64_tr_b16 v[106:107], v15 offset:16896
v_mfma_f32_16x16x32_bf16 v[80:83], v[224:227], v[176:179], v[80:83]
buffer_load_dwordx4 v[208:211], v39, s[32:35], s57 offen sc1
v_mfma_f32_16x16x32_bf16 v[68:71], v[228:231], v[172:175], v[68:71]
ds_read_b64_tr_b16 v[108:109], v16 offset:16384
ds_read_b64_tr_b16 v[110:111], v16 offset:16896
v_mfma_f32_16x16x32_bf16 v[84:87], v[228:231], v[176:179], v[84:87]
ds_read_b64_tr_b16 v[112:113], v17 offset:16384
ds_read_b64_tr_b16 v[114:115], v17 offset:16896
v_mfma_f32_16x16x32_bf16 v[72:75], v[232:235], v[172:175], v[72:75]
v_mfma_f32_16x16x32_bf16 v[88:91], v[232:235], v[176:179], v[88:91]
s_waitcnt vmcnt(6) lgkmcnt(8)
v_mfma_f32_16x16x32_bf16 v[60:63], v[236:239], v[180:183], v[60:63]
buffer_load_dwordx4 v[212:215], v38, s[32:35], s57 offen offset:1024 sc1
v_mfma_f32_16x16x32_bf16 v[76:79], v[236:239], v[184:187], v[76:79]
ds_read_b64_tr_b16 v[220:221], v14 offset:20480
ds_read_b64_tr_b16 v[222:223], v14 offset:20992
v_mfma_f32_16x16x32_bf16 v[64:67], v[240:243], v[180:183], v[64:67]
ds_read_b64_tr_b16 v[224:225], v15 offset:20480
ds_read_b64_tr_b16 v[226:227], v15 offset:20992
v_mfma_f32_16x16x32_bf16 v[80:83], v[240:243], v[184:187], v[80:83]
buffer_load_dwordx4 v[216:219], v39, s[32:35], s57 offen offset:1024 sc1
v_mfma_f32_16x16x32_bf16 v[68:71], v[244:247], v[180:183], v[68:71]
ds_read_b64_tr_b16 v[228:229], v16 offset:20480
ds_read_b64_tr_b16 v[230:231], v16 offset:20992
v_mfma_f32_16x16x32_bf16 v[84:87], v[244:247], v[184:187], v[84:87]
ds_read_b64_tr_b16 v[232:233], v17 offset:20480
ds_read_b64_tr_b16 v[234:235], v17 offset:20992
v_mfma_f32_16x16x32_bf16 v[72:75], v[248:251], v[180:183], v[72:75]
s_add_u32 s57, s57, 2048
s_and_b32 s57, s57, 0x7fff
v_mfma_f32_16x16x32_bf16 v[88:91], v[248:251], v[184:187], v[88:91]
s_waitcnt vmcnt(6) lgkmcnt(8)
v_mfma_f32_16x16x32_bf16 v[60:63], v[100:103], v[188:191], v[60:63]
buffer_load_dwordx4 v[156:159], v38, s[32:35], s57 offen sc1
v_mfma_f32_16x16x32_bf16 v[76:79], v[100:103], v[192:195], v[76:79]
ds_read_b64_tr_b16 v[236:237], v14 offset:24576
ds_read_b64_tr_b16 v[238:239], v14 offset:25088
v_mfma_f32_16x16x32_bf16 v[64:67], v[104:107], v[188:191], v[64:67]
ds_read_b64_tr_b16 v[240:241], v15 offset:24576
ds_read_b64_tr_b16 v[242:243], v15 offset:25088
v_mfma_f32_16x16x32_bf16 v[80:83], v[104:107], v[192:195], v[80:83]
buffer_load_dwordx4 v[160:163], v39, s[32:35], s57 offen sc1
v_mfma_f32_16x16x32_bf16 v[68:71], v[108:111], v[188:191], v[68:71]
ds_read_b64_tr_b16 v[244:245], v16 offset:24576
ds_read_b64_tr_b16 v[246:247], v16 offset:25088
v_mfma_f32_16x16x32_bf16 v[84:87], v[108:111], v[192:195], v[84:87]
ds_read_b64_tr_b16 v[248:249], v17 offset:24576
ds_read_b64_tr_b16 v[250:251], v17 offset:25088
v_mfma_f32_16x16x32_bf16 v[72:75], v[112:115], v[188:191], v[72:75]
v_mfma_f32_16x16x32_bf16 v[88:91], v[112:115], v[192:195], v[88:91]
s_waitcnt vmcnt(6) lgkmcnt(8)
v_mfma_f32_16x16x32_bf16 v[60:63], v[220:223], v[196:199], v[60:63]
buffer_load_dwordx4 v[164:167], v38, s[32:35], s57 offen offset:1024 sc1
v_mfma_f32_16x16x32_bf16 v[76:79], v[220:223], v[200:203], v[76:79]
ds_read_b64_tr_b16 v[100:101], v14 offset:28672
ds_read_b64_tr_b16 v[102:103], v14 offset:29184
v_mfma_f32_16x16x32_bf16 v[64:67], v[224:227], v[196:199], v[64:67]
ds_read_b64_tr_b16 v[104:105], v15 offset:28672
ds_read_b64_tr_b16 v[106:107], v15 offset:29184
v_mfma_f32_16x16x32_bf16 v[80:83], v[224:227], v[200:203], v[80:83]
buffer_load_dwordx4 v[168:171], v39, s[32:35], s57 offen offset:1024 sc1
v_mfma_f32_16x16x32_bf16 v[68:71], v[228:231], v[196:199], v[68:71]
ds_read_b64_tr_b16 v[108:109], v16 offset:28672
ds_read_b64_tr_b16 v[110:111], v16 offset:29184
v_mfma_f32_16x16x32_bf16 v[84:87], v[228:231], v[200:203], v[84:87]
ds_read_b64_tr_b16 v[112:113], v17 offset:28672
ds_read_b64_tr_b16 v[114:115], v17 offset:29184
v_mfma_f32_16x16x32_bf16 v[72:75], v[232:235], v[196:199], v[72:75]
s_add_u32 s57, s57, 2048
s_and_b32 s57, s57, 0x7fff
v_mfma_f32_16x16x32_bf16 v[88:91], v[232:235], v[200:203], v[88:91]
s_waitcnt vmcnt(6) lgkmcnt(8)
v_mfma_f32_16x16x32_bf16 v[60:63], v[236:239], v[204:207], v[60:63]
buffer_load_dwordx4 v[172:175], v38, s[32:35], s57 offen sc1
v_mfma_f32_16x16x32_bf16 v[76:79], v[236:239], v[208:211], v[76:79]
ds_read_b64_tr_b16 v[220:221], v14 offset:32768
ds_read_b64_tr_b16 v[222:223], v14 offset:33280
v_mfma_f32_16x16x32_bf16 v[64:67], v[240:243], v[204:207], v[64:67]
ds_read_b64_tr_b16 v[224:225], v15 offset:32768
ds_read_b64_tr_b16 v[226:227], v15 offset:33280
v_mfma_f32_16x16x32_bf16 v[80:83], v[240:243], v[208:211], v[80:83]
buffer_load_dwordx4 v[176:179], v39, s[32:35], s57 offen sc1
v_mfma_f32_16x16x32_bf16 v[68:71], v[244:247], v[204:207], v[68:71]
ds_read_b64_tr_b16 v[228:229], v16 offset:32768
ds_read_b64_tr_b16 v[230:231], v16 offset:33280
v_mfma_f32_16x16x32_bf16 v[84:87], v[244:247], v[208:211], v[84:87]
ds_read_b64_tr_b16 v[232:233], v17 offset:32768
ds_read_b64_tr_b16 v[234:235], v17 offset:33280
v_mfma_f32_16x16x32_bf16 v[72:75], v[248:251], v[204:207], v[72:75]
v_mfma_f32_16x16x32_bf16 v[88:91], v[248:251], v[208:211], v[88:91]
s_waitcnt vmcnt(6) lgkmcnt(8)
v_mfma_f32_16x16x32_bf16 v[60:63], v[100:103], v[212:215], v[60:63]
buffer_load_dwordx4 v[180:183], v38, s[32:35], s57 offen offset:1024 sc1
v_mfma_f32_16x16x32_bf16 v[76:79], v[100:103], v[216:219], v[76:79]
ds_read_b64_tr_b16 v[236:237], v14 offset:36864
ds_read_b64_tr_b16 v[238:239], v14 offset:37376
v_mfma_f32_16x16x32_bf16 v[64:67], v[104:107], v[212:215], v[64:67]
ds_read_b64_tr_b16 v[240:241], v15 offset:36864
ds_read_b64_tr_b16 v[242:243], v15 offset:37376
v_mfma_f32_16x16x32_bf16 v[80:83], v[104:107], v[216:219], v[80:83]
buffer_load_dwordx4 v[184:187], v39, s[32:35], s57 offen offset:1024 sc1
v_mfma_f32_16x16x32_bf16 v[68:71], v[108:111], v[212:215], v[68:71]
ds_read_b64_tr_b16 v[244:245], v16 offset:36864
ds_read_b64_tr_b16 v[246:247], v16 offset:37376
v_mfma_f32_16x16x32_bf16 v[84:87], v[108:111], v[216:219], v[84:87]
ds_read_b64_tr_b16 v[248:249], v17 offset:36864
ds_read_b64_tr_b16 v[250:251], v17 offset:37376
v_mfma_f32_16x16x32_bf16 v[72:75], v[112:115], v[212:215], v[72:75]
s_add_u32 s57, s57, 2048
s_and_b32 s57, s57, 0x7fff
v_mfma_f32_16x16x32_bf16 v[88:91], v[112:115], v[216:219], v[88:91]
s_waitcnt vmcnt(6) lgkmcnt(8)
v_mfma_f32_16x16x32_bf16 v[60:63], v[220:223], v[156:159], v[60:63]
buffer_load_dwordx4 v[188:191], v38, s[32:35], s57 offen sc1
v_mfma_f32_16x16x32_bf16 v[76:79], v[220:223], v[160:163], v[76:79]
ds_read_b64_tr_b16 v[100:101], v14 offset:40960
ds_read_b64_tr_b16 v[102:103], v14 offset:41472
v_mfma_f32_16x16x32_bf16 v[64:67], v[224:227], v[156:159], v[64:67]
ds_read_b64_tr_b16 v[104:105], v15 offset:40960
ds_read_b64_tr_b16 v[106:107], v15 offset:41472
v_mfma_f32_16x16x32_bf16 v[80:83], v[224:227], v[160:163], v[80:83]
buffer_load_dwordx4 v[192:195], v39, s[32:35], s57 offen sc1
v_mfma_f32_16x16x32_bf16 v[68:71], v[228:231], v[156:159], v[68:71]
ds_read_b64_tr_b16 v[108:109], v16 offset:40960
ds_read_b64_tr_b16 v[110:111], v16 offset:41472
v_mfma_f32_16x16x32_bf16 v[84:87], v[228:231], v[160:163], v[84:87]
ds_read_b64_tr_b16 v[112:113], v17 offset:40960
ds_read_b64_tr_b16 v[114:115], v17 offset:41472
v_mfma_f32_16x16x32_bf16 v[72:75], v[232:235], v[156:159], v[72:75]
v_mfma_f32_16x16x32_bf16 v[88:91], v[232:235], v[160:163], v[88:91]
s_waitcnt vmcnt(6) lgkmcnt(8)
v_mfma_f32_16x16x32_bf16 v[60:63], v[236:239], v[164:167], v[60:63]
buffer_load_dwordx4 v[196:199], v38, s[32:35], s57 offen offset:1024 sc1
v_mfma_f32_16x16x32_bf16 v[76:79], v[236:239], v[168:171], v[76:79]
ds_read_b64_tr_b16 v[220:221], v14 offset:45056
ds_read_b64_tr_b16 v[222:223], v14 offset:45568
v_mfma_f32_16x16x32_bf16 v[64:67], v[240:243], v[164:167], v[64:67]
ds_read_b64_tr_b16 v[224:225], v15 offset:45056
ds_read_b64_tr_b16 v[226:227], v15 offset:45568
v_mfma_f32_16x16x32_bf16 v[80:83], v[240:243], v[168:171], v[80:83]
buffer_load_dwordx4 v[200:203], v39, s[32:35], s57 offen offset:1024 sc1
v_mfma_f32_16x16x32_bf16 v[68:71], v[244:247], v[164:167], v[68:71]
ds_read_b64_tr_b16 v[228:229], v16 offset:45056
ds_read_b64_tr_b16 v[230:231], v16 offset:45568
v_mfma_f32_16x16x32_bf16 v[84:87], v[244:247], v[168:171], v[84:87]
ds_read_b64_tr_b16 v[232:233], v17 offset:45056
ds_read_b64_tr_b16 v[234:235], v17 offset:45568
v_mfma_f32_16x16x32_bf16 v[72:75], v[248:251], v[164:167], v[72:75]
s_add_u32 s57, s57, 2048
s_and_b32 s57, s57, 0x7fff
v_mfma_f32_16x16x32_bf16 v[88:91], v[248:251], v[168:171], v[88:91]
s_waitcnt vmcnt(6) lgkmcnt(8)
v_mfma_f32_16x16x32_bf16 v[60:63], v[100:103], v[172:175], v[60:63]
buffer_load_dwordx4 v[204:207], v38, s[32:35], s57 offen sc1
v_mfma_f32_16x16x32_bf16 v[76:79], v[100:103], v[176:179], v[76:79]
ds_read_b64_tr_b16 v[236:237], v14 offset:49152
ds_read_b64_tr_b16 v[238:239], v14 offset:49664
v_mfma_f32_16x16x32_bf16 v[64:67], v[104:107], v[172:175], v[64:67]
ds_read_b64_tr_b16 v[240:241], v15 offset:49152
ds_read_b64_tr_b16 v[242:243], v15 offset:49664
v_mfma_f32_16x16x32_bf16 v[80:83], v[104:107], v[176:179], v[80:83]
buffer_load_dwordx4 v[208:211], v39, s[32:35], s57 offen sc1
v_mfma_f32_16x16x32_bf16 v[68:71], v[108:111], v[172:175], v[68:71]
ds_read_b64_tr_b16 v[244:245], v16 offset:49152
ds_read_b64_tr_b16 v[246:247], v16 offset:49664
v_mfma_f32_16x16x32_bf16 v[84:87], v[108:111], v[176:179], v[84:87]
ds_read_b64_tr_b16 v[248:249], v17 offset:49152
ds_read_b64_tr_b16 v[250:251], v17 offset:49664
v_mfma_f32_16x16x32_bf16 v[72:75], v[112:115], v[172:175], v[72:75]
v_mfma_f32_16x16x32_bf16 v[88:91], v[112:115], v[176:179], v[88:91]
s_waitcnt vmcnt(6) lgkmcnt(8)
v_mfma_f32_16x16x32_bf16 v[60:63], v[220:223], v[180:183], v[60:63]
buffer_load_dwordx4 v[212:215], v38, s[32:35], s57 offen offset:1024 sc1
v_mfma_f32_16x16x32_bf16 v[76:79], v[220:223], v[184:187], v[76:79]
ds_read_b64_tr_b16 v[100:101], v14 offset:53248
ds_read_b64_tr_b16 v[102:103], v14 offset:53760
v_mfma_f32_16x16x32_bf16 v[64:67], v[224:227], v[180:183], v[64:67]
ds_read_b64_tr_b16 v[104:105], v15 offset:53248
ds_read_b64_tr_b16 v[106:107], v15 offset:53760
v_mfma_f32_16x16x32_bf16 v[80:83], v[224:227], v[184:187], v[80:83]
buffer_load_dwordx4 v[216:219], v39, s[32:35], s57 offen offset:1024 sc1
v_mfma_f32_16x16x32_bf16 v[68:71], v[228:231], v[180:183], v[68:71]
ds_read_b64_tr_b16 v[108:109], v16 offset:53248
ds_read_b64_tr_b16 v[110:111], v16 offset:53760
v_mfma_f32_16x16x32_bf16 v[84:87], v[228:231], v[184:187], v[84:87]
ds_read_b64_tr_b16 v[112:113], v17 offset:53248
ds_read_b64_tr_b16 v[114:115], v17 offset:53760
v_mfma_f32_16x16x32_bf16 v[72:75], v[232:235], v[180:183], v[72:75]
v_mfma_f32_16x16x32_bf16 v[88:91], v[232:235], v[184:187], v[88:91]
s_waitcnt vmcnt(6) lgkmcnt(8)
v_mfma_f32_16x16x32_bf16 v[60:63], v[236:239], v[188:191], v[60:63]
v_mfma_f32_16x16x32_bf16 v[76:79], v[236:239], v[192:195], v[76:79]
ds_read_b64_tr_b16 v[220:221], v14 offset:57344
ds_read_b64_tr_b16 v[222:223], v14 offset:57856
v_mfma_f32_16x16x32_bf16 v[64:67], v[240:243], v[188:191], v[64:67]
ds_read_b64_tr_b16 v[224:225], v15 offset:57344
ds_read_b64_tr_b16 v[226:227], v15 offset:57856
v_mfma_f32_16x16x32_bf16 v[80:83], v[240:243], v[192:195], v[80:83]
v_mfma_f32_16x16x32_bf16 v[68:71], v[244:247], v[188:191], v[68:71]
ds_read_b64_tr_b16 v[228:229], v16 offset:57344
ds_read_b64_tr_b16 v[230:231], v16 offset:57856
v_mfma_f32_16x16x32_bf16 v[84:87], v[244:247], v[192:195], v[84:87]
ds_read_b64_tr_b16 v[232:233], v17 offset:57344
ds_read_b64_tr_b16 v[234:235], v17 offset:57856
v_mfma_f32_16x16x32_bf16 v[72:75], v[248:251], v[188:191], v[72:75]
v_mfma_f32_16x16x32_bf16 v[88:91], v[248:251], v[192:195], v[88:91]
s_waitcnt vmcnt(4) lgkmcnt(8)
v_mfma_f32_16x16x32_bf16 v[60:63], v[100:103], v[196:199], v[60:63]
v_mfma_f32_16x16x32_bf16 v[76:79], v[100:103], v[200:203], v[76:79]
ds_read_b64_tr_b16 v[236:237], v14 offset:61440
ds_read_b64_tr_b16 v[238:239], v14 offset:61952
v_mfma_f32_16x16x32_bf16 v[64:67], v[104:107], v[196:199], v[64:67]
ds_read_b64_tr_b16 v[240:241], v15 offset:61440
ds_read_b64_tr_b16 v[242:243], v15 offset:61952
v_mfma_f32_16x16x32_bf16 v[80:83], v[104:107], v[200:203], v[80:83]
v_mfma_f32_16x16x32_bf16 v[68:71], v[108:111], v[196:199], v[68:71]
ds_read_b64_tr_b16 v[244:245], v16 offset:61440
ds_read_b64_tr_b16 v[246:247], v16 offset:61952
v_mfma_f32_16x16x32_bf16 v[84:87], v[108:111], v[200:203], v[84:87]
ds_read_b64_tr_b16 v[248:249], v17 offset:61440
ds_read_b64_tr_b16 v[250:251], v17 offset:61952
v_mfma_f32_16x16x32_bf16 v[72:75], v[112:115], v[196:199], v[72:75]
v_mfma_f32_16x16x32_bf16 v[88:91], v[112:115], v[200:203], v[88:91]
s_waitcnt vmcnt(2) lgkmcnt(8)
v_mfma_f32_16x16x32_bf16 v[60:63], v[220:223], v[204:207], v[60:63]
v_mfma_f32_16x16x32_bf16 v[76:79], v[220:223], v[208:211], v[76:79]
v_mfma_f32_16x16x32_bf16 v[64:67], v[224:227], v[204:207], v[64:67]
v_mfma_f32_16x16x32_bf16 v[80:83], v[224:227], v[208:211], v[80:83]
v_mfma_f32_16x16x32_bf16 v[68:71], v[228:231], v[204:207], v[68:71]
v_mfma_f32_16x16x32_bf16 v[84:87], v[228:231], v[208:211], v[84:87]
v_mfma_f32_16x16x32_bf16 v[72:75], v[232:235], v[204:207], v[72:75]
v_mfma_f32_16x16x32_bf16 v[88:91], v[232:235], v[208:211], v[88:91]
s_waitcnt vmcnt(0) lgkmcnt(0)
v_mfma_f32_16x16x32_bf16 v[60:63], v[236:239], v[212:215], v[60:63]
v_mfma_f32_16x16x32_bf16 v[64:67], v[240:243], v[212:215], v[64:67]
v_mfma_f32_16x16x32_bf16 v[68:71], v[244:247], v[212:215], v[68:71]
v_mfma_f32_16x16x32_bf16 v[72:75], v[248:251], v[212:215], v[72:75]
v_mfma_f32_16x16x32_bf16 v[76:79], v[236:239], v[216:219], v[76:79]
v_mfma_f32_16x16x32_bf16 v[80:83], v[240:243], v[216:219], v[80:83]
v_mfma_f32_16x16x32_bf16 v[84:87], v[244:247], v[216:219], v[84:87]
v_mfma_f32_16x16x32_bf16 v[88:91], v[248:251], v[216:219], v[88:91]
s_nop 0
v_cvt_pk_bf16_f32 v20, v60, v61
v_cvt_pk_bf16_f32 v21, v62, v63
v_cvt_pk_bf16_f32 v22, v64, v65
v_cvt_pk_bf16_f32 v23, v66, v67
s_nop 1
v_permlane16_swap_b32 v20, v22
v_permlane16_swap_b32 v21, v23
buffer_store_dwordx4 v[20:23], v40, s[24:27], 0 offen offset:0 sc1
v_cvt_pk_bf16_f32 v24, v68, v69
v_cvt_pk_bf16_f32 v25, v70, v71
v_cvt_pk_bf16_f32 v26, v72, v73
v_cvt_pk_bf16_f32 v27, v74, v75
s_nop 1
v_permlane16_swap_b32 v24, v26
v_permlane16_swap_b32 v25, v27
buffer_store_dwordx4 v[24:27], v40, s[24:27], 0 offen offset:64 sc1
v_cvt_pk_bf16_f32 v28, v76, v77
v_cvt_pk_bf16_f32 v29, v78, v79
v_cvt_pk_bf16_f32 v30, v80, v81
v_cvt_pk_bf16_f32 v31, v82, v83
s_nop 1
v_permlane16_swap_b32 v28, v30
v_permlane16_swap_b32 v29, v31
buffer_store_dwordx4 v[28:31], v41, s[24:27], 0 offen offset:0 sc1
v_cvt_pk_bf16_f32 v32, v84, v85
v_cvt_pk_bf16_f32 v33, v86, v87
v_cvt_pk_bf16_f32 v34, v88, v89
v_cvt_pk_bf16_f32 v35, v90, v91
s_nop 1
v_permlane16_swap_b32 v32, v34
v_permlane16_swap_b32 v33, v35
buffer_store_dwordx4 v[32:35], v41, s[24:27], 0 offen offset:64 sc1
s_endpgm
L_code_end:
again_6:
s_mov_b32 s63, 0
retry_8:
buffer_load_dwordx4 v[80:83], v37, s[32:35], 0 offen offset:0 sc1
buffer_load_dwordx4 v[84:87], v37, s[32:35], 0 offen offset:1024 sc1
buffer_load_dwordx4 v[88:91], v37, s[32:35], 0 offen offset:2048 sc1
buffer_load_dwordx4 v[92:95], v37, s[32:35], 0 offen offset:3072 sc1
s_waitcnt vmcnt(0)
v_add_f32 v80, v80, v88
v_add_f32 v81, v81, v89
v_add_f32 v82, v82, v90
v_add_f32 v83, v83, v91
v_add_f32 v84, v84, v92
v_add_f32 v85, v85, v93
v_add_f32 v86, v86, v94
v_add_f32 v87, v87, v95
v_add_f32 v80, v80, v84
v_add_f32 v81, v81, v85
v_add_f32 v82, v82, v86
v_add_f32 v83, v83, v87
s_nop 1
v_permlane32_swap_b32 v80, v81
v_permlane32_swap_b32 v82, v83
v_add_f32 v80, v80, v81
v_add_f32 v82, v82, v83
s_nop 1
v_permlane16_swap_b32 v80, v82
s_nop 0
v_add_f32 v80, v80, v82
v_cmp_u_f32 vcc, v80, v80
s_cbranch_vccz summed_7
s_add_u32 s63, s63, 1
s_cmp_lt_u32 s63, 0x10000
s_cbranch_scc1 retry_8
s_branch summed_7
again_9:
s_mov_b32 s63, 0
retry_11:
buffer_load_dwordx4 v[64:67], v38, s[32:35], 0 offen offset:0 sc1
buffer_load_dwordx4 v[68:71], v38, s[32:35], 0 offen offset:1024 sc1
buffer_load_dwordx4 v[72:75], v38, s[32:35], 0 offen offset:2048 sc1
buffer_load_dwordx4 v[76:79], v38, s[32:35], 0 offen offset:3072 sc1
s_waitcnt vmcnt(0)
v_add_f32 v64, v64, v72
v_add_f32 v65, v65, v73
v_add_f32 v66, v66, v74
v_add_f32 v67, v67, v75
v_add_f32 v68, v68, v76
v_add_f32 v69, v69, v77
v_add_f32 v70, v70, v78
v_add_f32 v71, v71, v79
v_add_f32 v64, v64, v68
v_add_f32 v65, v65, v69
v_add_f32 v66, v66, v70
v_add_f32 v67, v67, v71
s_nop 1
v_permlane32_swap_b32 v64, v65
v_permlane32_swap_b32 v66, v67
v_add_f32 v64, v64, v65
v_add_f32 v66, v66, v67
s_nop 1
v_permlane16_swap_b32 v64, v66
s_nop 0
v_add_f32 v64, v64, v66
v_cmp_u_f32 vcc, v64, v64
s_cbranch_vccz summed_10
s_add_u32 s63, s63, 1
s_cmp_lt_u32 s63, 0x10000
s_cbranch_scc1 retry_11
s_branch summed_10
again_17:
s_mov_b32 s63, 0
retry_19:
buffer_load_dwordx4 v[80:83], v37, s[32:35], 0 offen offset:0 sc1
buffer_load_dwordx4 v[84:87], v37, s[32:35], 0 offen offset:1024 sc1
buffer_load_dwordx4 v[88:91], v37, s[32:35], 0 offen offset:2048 sc1
buffer_load_dwordx4 v[92:95], v37, s[32:35], 0 offen offset:3072 sc1
s_waitcnt vmcnt(0)
v_add_f32 v80, v80, v88
v_add_f32 v81, v81, v89
v_add_f32 v82, v82, v90
v_add_f32 v83, v83, v91
v_add_f32 v84, v84, v92
v_add_f32 v85, v85, v93
v_add_f32 v86, v86, v94
v_add_f32 v87, v87, v95
v_add_f32 v80, v80, v84
v_add_f32 v81, v81, v85
v_add_f32 v82, v82, v86
v_add_f32 v83, v83, v87
s_nop 1
v_permlane32_swap_b32 v80, v81
v_permlane32_swap_b32 v82, v83
v_add_f32 v80, v80, v81
v_add_f32 v82, v82, v83
s_nop 1
v_permlane16_swap_b32 v80, v82
s_nop 0
v_add_f32 v80, v80, v82
v_cmp_u_f32 vcc, v80, v80
s_cbranch_vccz summed_18
s_add_u32 s63, s63, 1
s_cmp_lt_u32 s63, 0x10000
s_cbranch_scc1 retry_19
s_branch summed_18
again_20:
s_mov_b32 s63, 0
retry_22:
buffer_load_dwordx4 v[64:67], v38, s[32:35], 0 offen offset:0 sc1
buffer_load_dwordx4 v[68:71], v38, s[32:35], 0 offen offset:1024 sc1
buffer_load_dwordx4 v[72:75], v38, s[32:35], 0 offen offset:2048 sc1
buffer_load_dwordx4 v[76:79], v38, s[32:35], 0 offen offset:3072 sc1
s_waitcnt vmcnt(0)
v_add_f32 v64, v64, v72
v_add_f32 v65, v65, v73
v_add_f32 v66, v66, v74
v_add_f32 v67, v67, v75
v_add_f32 v68, v68, v76
v_add_f32 v69, v69, v77
v_add_f32 v70, v70, v78
v_add_f32 v71, v71, v79
v_add_f32 v64, v64, v68
v_add_f32 v65, v65, v69
v_add_f32 v66, v66, v70
v_add_f32 v67, v67, v71
s_nop 1
v_permlane32_swap_b32 v64, v65
v_permlane32_swap_b32 v66, v67
v_add_f32 v64, v64, v65
v_add_f32 v66, v66, v67
s_nop 1
v_permlane16_swap_b32 v64, v66
s_nop 0
v_add_f32 v64, v64, v66
v_cmp_u_f32 vcc, v64, v64
s_cbranch_vccz summed_21
s_add_u32 s63, s63, 1
s_cmp_lt_u32 s63, 0x10000
s_cbranch_scc1 retry_22
s_branch summed_21
again_26:
s_mov_b32 s63, 0
retry_28:
buffer_load_dwordx4 v[80:83], v37, s[32:35], 0 offen offset:0 sc1
buffer_load_dwordx4 v[84:87], v37, s[32:35], 0 offen offset:1024 sc1
buffer_load_dwordx4 v[88:91], v37, s[32:35], 0 offen offset:2048 sc1
buffer_load_dwordx4 v[92:95], v37, s[32:35], 0 offen offset:3072 sc1
s_waitcnt vmcnt(0)
v_add_f32 v80, v80, v88
v_add_f32 v81, v81, v89
v_add_f32 v82, v82, v90
v_add_f32 v83, v83, v91
v_add_f32 v84, v84, v92
v_add_f32 v85, v85, v93
v_add_f32 v86, v86, v94
v_add_f32 v87, v87, v95
v_add_f32 v80, v80, v84
v_add_f32 v81, v81, v85
v_add_f32 v82, v82, v86
v_add_f32 v83, v83, v87
s_nop 1
v_permlane32_swap_b32 v80, v81
v_permlane32_swap_b32 v82, v83
v_add_f32 v80, v80, v81
v_add_f32 v82, v82, v83
s_nop 1
v_permlane16_swap_b32 v80, v82
s_nop 0
v_add_f32 v80, v80, v82
v_cmp_u_f32 vcc, v80, v80
s_cbranch_vccz summed_27
s_add_u32 s63, s63, 1
s_cmp_lt_u32 s63, 0x10000
s_cbranch_scc1 retry_28
s_branch summed_27
again_32:
s_mov_b32 s63, 0
retry_34:
buffer_load_dwordx4 v[80:83], v37, s[32:35], 0 offen offset:0 sc1
buffer_load_dwordx4 v[84:87], v37, s[32:35], 0 offen offset:1024 sc1
buffer_load_dwordx4 v[88:91], v37, s[32:35], 0 offen offset:2048 sc1
buffer_load_dwordx4 v[92:95], v37, s[32:35], 0 offen offset:3072 sc1
s_waitcnt vmcnt(0)
v_add_f32 v80, v80, v88
v_add_f32 v81, v81, v89
v_add_f32 v82, v82, v90
v_add_f32 v83, v83, v91
v_add_f32 v84, v84, v92
v_add_f32 v85, v85, v93
v_add_f32 v86, v86, v94
v_add_f32 v87, v87, v95
v_add_f32 v80, v80, v84
v_add_f32 v81, v81, v85
v_add_f32 v82, v82, v86
v_add_f32 v83, v83, v87
s_nop 1
v_permlane32_swap_b32 v80, v81
v_permlane32_swap_b32 v82, v83
v_add_f32 v80, v80, v81
v_add_f32 v82, v82, v83
s_nop 1
v_permlane16_swap_b32 v80, v82
s_nop 0
v_add_f32 v80, v80, v82
v_cmp_u_f32 vcc, v80, v80
s_cbranch_vccz summed_33
s_add_u32 s63, s63, 1
s_cmp_lt_u32 s63, 0x10000
s_cbranch_scc1 retry_34
s_branch summed_33
slow_51:
.p2align 3
v_pk_mul_f32 v[220:221], v[220:221], v[160:161] op_sel:[0,0] op_sel_hi:[1,0]
v_pk_mul_f32 v[222:223], v[222:223], v[160:161] op_sel:[0,0] op_sel_hi:[1,0]
v_pk_mul_f32 v[224:225], v[224:225], v[160:161] op_sel:[0,0] op_sel_hi:[1,0]
v_pk_mul_f32 v[226:227], v[226:227], v[160:161] op_sel:[0,0] op_sel_hi:[1,0]
v_cvt_pk_bf16_f32 v220, v220, v221
v_cvt_pk_bf16_f32 v221, v222, v223
v_cvt_pk_bf16_f32 v222, v224, v225
v_cvt_pk_bf16_f32 v223, v226, v227
buffer_store_dwordx4 v[220:223], v18, s[32:35], s80 offen sc1
v_pk_mul_f32 v[228:229], v[228:229], v[168:169] op_sel:[0,0] op_sel_hi:[1,0]
v_pk_mul_f32 v[230:231], v[230:231], v[168:169] op_sel:[0,0] op_sel_hi:[1,0]
v_pk_mul_f32 v[232:233], v[232:233], v[168:169] op_sel:[0,0] op_sel_hi:[1,0]
v_pk_mul_f32 v[234:235], v[234:235], v[168:169] op_sel:[0,0] op_sel_hi:[1,0]
v_cvt_pk_bf16_f32 v228, v228, v229
v_cvt_pk_bf16_f32 v229, v230, v231
v_cvt_pk_bf16_f32 v230, v232, v233
v_cvt_pk_bf16_f32 v231, v234, v235
buffer_store_dwordx4 v[228:231], v18, s[32:35], s81 offen sc1
v_pk_mul_f32 v[236:237], v[236:237], v[176:177] op_sel:[0,0] op_sel_hi:[1,0]
v_pk_mul_f32 v[238:239], v[238:239], v[176:177] op_sel:[0,0] op_sel_hi:[1,0]
v_pk_mul_f32 v[240:241], v[240:241], v[176:177] op_sel:[0,0] op_sel_hi:[1,0]
v_pk_mul_f32 v[242:243], v[242:243], v[176:177] op_sel:[0,0] op_sel_hi:[1,0]
v_cvt_pk_bf16_f32 v236, v236, v237
v_cvt_pk_bf16_f32 v237, v238, v239
v_cvt_pk_bf16_f32 v238, v240, v241
v_cvt_pk_bf16_f32 v239, v242, v243
buffer_store_dwordx4 v[236:239], v18, s[32:35], s82 offen sc1
v_pk_mul_f32 v[244:245], v[244:245], v[184:185] op_sel:[0,0] op_sel_hi:[1,0]
v_pk_mul_f32 v[246:247], v[246:247], v[184:185] op_sel:[0,0] op_sel_hi:[1,0]
v_pk_mul_f32 v[248:249], v[248:249], v[184:185] op_sel:[0,0] op_sel_hi:[1,0]
v_pk_mul_f32 v[250:251], v[250:251], v[184:185] op_sel:[0,0] op_sel_hi:[1,0]
v_cvt_pk_bf16_f32 v244, v244, v245
v_cvt_pk_bf16_f32 v245, v246, v247
v_cvt_pk_bf16_f32 v246, v248, v249
v_cvt_pk_bf16_f32 v247, v250, v251
buffer_store_dwordx4 v[244:247], v18, s[32:35], s83 offen sc1
s_barrier
s_lshl_b32 s62, s45, 2
v_mov_b32 v4, s62
v_mov_b32 v5, 1
s_mov_b64 exec, 1
s_waitcnt vmcnt(0)
buffer_store_dword v5, v4, s[32:35], s84 offen sc1
s_mov_b64 exec, -1
s_branch back_52
slow_55:
s_nop 0
v_cvt_pk_bf16_f32 v20, v60, v61
v_cvt_pk_bf16_f32 v21, v62, v63
v_cvt_pk_bf16_f32 v22, v64, v65
v_cvt_pk_bf16_f32 v23, v66, v67
buffer_store_dwordx4 v[20:23], v18, s[32:35], s85 offen offset:0 sc1
v_cvt_pk_bf16_f32 v24, v68, v69
v_cvt_pk_bf16_f32 v25, v70, v71
v_cvt_pk_bf16_f32 v26, v72, v73
v_cvt_pk_bf16_f32 v27, v74, v75
buffer_store_dwordx4 v[24:27], v18, s[32:35], s85 offen offset:1024 sc1
v_cvt_pk_bf16_f32 v28, v76, v77
v_cvt_pk_bf16_f32 v29, v78, v79
v_cvt_pk_bf16_f32 v30, v80, v81
v_cvt_pk_bf16_f32 v31, v82, v83
buffer_store_dwordx4 v[28:31], v18, s[32:35], s86 offen offset:0 sc1
v_cvt_pk_bf16_f32 v32, v84, v85
v_cvt_pk_bf16_f32 v33, v86, v87
v_cvt_pk_bf16_f32 v34, v88, v89
v_cvt_pk_bf16_f32 v35, v90, v91
buffer_store_dwordx4 v[32:35], v18, s[32:35], s86 offen offset:1024 sc1
s_barrier
v_dot2c_f32_bf16 v6, v20, v48
v_dot2c_f32_bf16 v8, v20, v20
v_dot2c_f32_bf16 v7, v28, v48
v_dot2c_f32_bf16 v9, v28, v28
v_dot2c_f32_bf16 v6, v21, v48
v_dot2c_f32_bf16 v8, v21, v21
v_dot2c_f32_bf16 v7, v29, v48
v_dot2c_f32_bf16 v9, v29, v29
v_dot2c_f32_bf16 v6, v22, v48
v_dot2c_f32_bf16 v8, v22, v22
v_dot2c_f32_bf16 v7, v30, v48
v_dot2c_f32_bf16 v9, v30, v30
v_dot2c_f32_bf16 v6, v23, v48
v_dot2c_f32_bf16 v8, v23, v23
v_dot2c_f32_bf16 v7, v31, v48
v_dot2c_f32_bf16 v9, v31, v31
v_dot2c_f32_bf16 v6, v24, v48
v_dot2c_f32_bf16 v8, v24, v24
v_dot2c_f32_bf16 v7, v32, v48
v_dot2c_f32_bf16 v9, v32, v32
v_dot2c_f32_bf16 v6, v25, v48
v_dot2c_f32_bf16 v8, v25, v25
v_dot2c_f32_bf16 v7, v33, v48
v_dot2c_f32_bf16 v9, v33, v33
v_dot2c_f32_bf16 v6, v26, v48
v_dot2c_f32_bf16 v8, v26, v26
v_dot2c_f32_bf16 v7, v34, v48
v_dot2c_f32_bf16 v9, v34, v34
v_dot2c_f32_bf16 v6, v27, v48
v_dot2c_f32_bf16 v8, v27, v27
v_dot2c_f32_bf16 v7, v35, v48
v_dot2c_f32_bf16 v9, v35, v35
s_mov_b64 exec, 1
s_waitcnt vmcnt(0)
buffer_store_dword v5, v4, s[32:35], s88 offen sc1
s_mov_b64 exec, -1
s_nop 1
v_permlane32_swap_b32 v6, v7
v_permlane32_swap_b32 v8, v9
v_add_f32 v6, v6, v7
v_add_f32 v8, v8, v9
s_nop 1
v_permlane16_swap_b32 v6, v8
s_nop 0
v_add_f32 v6, v6, v8
buffer_store_dword v6, v1, s[32:35], s87 offen sc1
s_branch back_56
slow_71:
.p2align 3
v_pk_mul_f32 v[156:157], v[156:157], v[100:101] op_sel:[0,0] op_sel_hi:[1,0]
v_pk_mul_f32 v[158:159], v[158:159], v[100:101] op_sel:[0,0] op_sel_hi:[1,0]
v_pk_mul_f32 v[160:161], v[160:161], v[100:101] op_sel:[0,0] op_sel_hi:[1,0]
v_pk_mul_f32 v[162:163], v[162:163], v[100:101] op_sel:[0,0] op_sel_hi:[1,0]
v_cvt_pk_bf16_f32 v156, v156, v157
v_cvt_pk_bf16_f32 v157, v158, v159
v_cvt_pk_bf16_f32 v158, v160, v161
v_cvt_pk_bf16_f32 v159, v162, v163
buffer_store_dwordx4 v[156:159], v18, s[32:35], s80 offen sc1
v_pk_mul_f32 v[164:165], v[164:165], v[100:101] op_sel:[0,1] op_sel_hi:[1,1]
v_pk_mul_f32 v[166:167], v[166:167], v[100:101] op_sel:[0,1] op_sel_hi:[1,1]
v_pk_mul_f32 v[168:169], v[168:169], v[100:101] op_sel:[0,1] op_sel_hi:[1,1]
v_pk_mul_f32 v[170:171], v[170:171], v[100:101] op_sel:[0,1] op_sel_hi:[1,1]
v_cvt_pk_bf16_f32 v164, v164, v165
v_cvt_pk_bf16_f32 v165, v166, v167
v_cvt_pk_bf16_f32 v166, v168, v169
v_cvt_pk_bf16_f32 v167, v170, v171
buffer_store_dwordx4 v[164:167], v18, s[32:35], s81 offen sc1
v_pk_mul_f32 v[172:173], v[172:173], v[102:103] op_sel:[0,0] op_sel_hi:[1,0]
v_pk_mul_f32 v[174:175], v[174:175], v[102:103] op_sel:[0,0] op_sel_hi:[1,0]
v_pk_mul_f32 v[176:177], v[176:177], v[102:103] op_sel:[0,0] op_sel_hi:[1,0]
v_pk_mul_f32 v[178:179], v[178:179], v[102:103] op_sel:[0,0] op_sel_hi:[1,0]
v_cvt_pk_bf16_f32 v172, v172, v173
v_cvt_pk_bf16_f32 v173, v174, v175
v_cvt_pk_bf16_f32 v174, v176, v177
v_cvt_pk_bf16_f32 v175, v178, v179
buffer_store_dwordx4 v[172:175], v18, s[32:35], s82 offen sc1
v_pk_mul_f32 v[180:181], v[180:181], v[102:103] op_sel:[0,1] op_sel_hi:[1,1]
v_pk_mul_f32 v[182:183], v[182:183], v[102:103] op_sel:[0,1] op_sel_hi:[1,1]
v_pk_mul_f32 v[184:185], v[184:185], v[102:103] op_sel:[0,1] op_sel_hi:[1,1]
v_pk_mul_f32 v[186:187], v[186:187], v[102:103] op_sel:[0,1] op_sel_hi:[1,1]
v_cvt_pk_bf16_f32 v180, v180, v181
v_cvt_pk_bf16_f32 v181, v182, v183
v_cvt_pk_bf16_f32 v182, v184, v185
v_cvt_pk_bf16_f32 v183, v186, v187
buffer_store_dwordx4 v[180:183], v18, s[32:35], s83 offen sc1
s_barrier
s_lshl_b32 s62, s45, 2
v_mov_b32 v4, s62
v_mov_b32 v5, 2
s_mov_b64 exec, 1
s_waitcnt vmcnt(0)
buffer_store_dword v5, v4, s[32:35], s84 offen sc1
s_mov_b64 exec, -1
s_branch back_72
slow_75:
s_nop 0
v_cvt_pk_bf16_f32 v20, v60, v61
v_cvt_pk_bf16_f32 v21, v62, v63
v_cvt_pk_bf16_f32 v22, v64, v65
v_cvt_pk_bf16_f32 v23, v66, v67
buffer_store_dwordx4 v[20:23], v18, s[32:35], s85 offen offset:0 sc1
v_cvt_pk_bf16_f32 v24, v68, v69
v_cvt_pk_bf16_f32 v25, v70, v71
v_cvt_pk_bf16_f32 v26, v72, v73
v_cvt_pk_bf16_f32 v27, v74, v75
buffer_store_dwordx4 v[24:27], v18, s[32:35], s85 offen offset:1024 sc1
v_cvt_pk_bf16_f32 v28, v76, v77
v_cvt_pk_bf16_f32 v29, v78, v79
v_cvt_pk_bf16_f32 v30, v80, v81
v_cvt_pk_bf16_f32 v31, v82, v83
buffer_store_dwordx4 v[28:31], v18, s[32:35], s86 offen offset:0 sc1
v_cvt_pk_bf16_f32 v32, v84, v85
v_cvt_pk_bf16_f32 v33, v86, v87
v_cvt_pk_bf16_f32 v34, v88, v89
v_cvt_pk_bf16_f32 v35, v90, v91
buffer_store_dwordx4 v[32:35], v18, s[32:35], s86 offen offset:1024 sc1
s_barrier
v_dot2c_f32_bf16 v6, v20, v48
v_dot2c_f32_bf16 v8, v20, v20
v_dot2c_f32_bf16 v7, v28, v48
v_dot2c_f32_bf16 v9, v28, v28
v_dot2c_f32_bf16 v6, v21, v48
v_dot2c_f32_bf16 v8, v21, v21
v_dot2c_f32_bf16 v7, v29, v48
v_dot2c_f32_bf16 v9, v29, v29
v_dot2c_f32_bf16 v6, v22, v48
v_dot2c_f32_bf16 v8, v22, v22
v_dot2c_f32_bf16 v7, v30, v48
v_dot2c_f32_bf16 v9, v30, v30
v_dot2c_f32_bf16 v6, v23, v48
v_dot2c_f32_bf16 v8, v23, v23
v_dot2c_f32_bf16 v7, v31, v48
v_dot2c_f32_bf16 v9, v31, v31
v_dot2c_f32_bf16 v6, v24, v48
v_dot2c_f32_bf16 v8, v24, v24
v_dot2c_f32_bf16 v7, v32, v48
v_dot2c_f32_bf16 v9, v32, v32
v_dot2c_f32_bf16 v6, v25, v48
v_dot2c_f32_bf16 v8, v25, v25
v_dot2c_f32_bf16 v7, v33, v48
v_dot2c_f32_bf16 v9, v33, v33
v_dot2c_f32_bf16 v6, v26, v48
v_dot2c_f32_bf16 v8, v26, v26
v_dot2c_f32_bf16 v7, v34, v48
v_dot2c_f32_bf16 v9, v34, v34
v_dot2c_f32_bf16 v6, v27, v48
v_dot2c_f32_bf16 v8, v27, v27
v_dot2c_f32_bf16 v7, v35, v48
v_dot2c_f32_bf16 v9, v35, v35
s_mov_b64 exec, 1
s_waitcnt vmcnt(0)
buffer_store_dword v5, v4, s[32:35], s88 offen sc1
s_mov_b64 exec, -1
s_nop 1
v_permlane32_swap_b32 v6, v7
v_permlane32_swap_b32 v8, v9
v_add_f32 v6, v6, v7
v_add_f32 v8, v8, v9
s_nop 1
v_permlane16_swap_b32 v6, v8
s_nop 0
v_add_f32 v6, v6, v8
buffer_store_dword v6, v1, s[32:35], s87 offen sc1
s_branch back_76
slow_87:
.p2align 3
v_pk_mul_f32 v[220:221], v[220:221], v[160:161] op_sel:[0,0] op_sel_hi:[1,0]
v_pk_mul_f32 v[222:223], v[222:223], v[160:161] op_sel:[0,0] op_sel_hi:[1,0]
v_pk_mul_f32 v[224:225], v[224:225], v[160:161] op_sel:[0,0] op_sel_hi:[1,0]
v_pk_mul_f32 v[226:227], v[226:227], v[160:161] op_sel:[0,0] op_sel_hi:[1,0]
v_cvt_pk_bf16_f32 v220, v220, v221
v_cvt_pk_bf16_f32 v221, v222, v223
v_cvt_pk_bf16_f32 v222, v224, v225
v_cvt_pk_bf16_f32 v223, v226, v227
buffer_store_dwordx4 v[220:223], v18, s[32:35], s80 offen sc1
v_pk_mul_f32 v[228:229], v[228:229], v[168:169] op_sel:[0,0] op_sel_hi:[1,0]
v_pk_mul_f32 v[230:231], v[230:231], v[168:169] op_sel:[0,0] op_sel_hi:[1,0]
v_pk_mul_f32 v[232:233], v[232:233], v[168:169] op_sel:[0,0] op_sel_hi:[1,0]
v_pk_mul_f32 v[234:235], v[234:235], v[168:169] op_sel:[0,0] op_sel_hi:[1,0]
v_cvt_pk_bf16_f32 v228, v228, v229
v_cvt_pk_bf16_f32 v229, v230, v231
v_cvt_pk_bf16_f32 v230, v232, v233
v_cvt_pk_bf16_f32 v231, v234, v235
buffer_store_dwordx4 v[228:231], v18, s[32:35], s81 offen sc1
v_pk_mul_f32 v[236:237], v[236:237], v[176:177] op_sel:[0,0] op_sel_hi:[1,0]
v_pk_mul_f32 v[238:239], v[238:239], v[176:177] op_sel:[0,0] op_sel_hi:[1,0]
v_pk_mul_f32 v[240:241], v[240:241], v[176:177] op_sel:[0,0] op_sel_hi:[1,0]
v_pk_mul_f32 v[242:243], v[242:243], v[176:177] op_sel:[0,0] op_sel_hi:[1,0]
v_cvt_pk_bf16_f32 v236, v236, v237
v_cvt_pk_bf16_f32 v237, v238, v239
v_cvt_pk_bf16_f32 v238, v240, v241
v_cvt_pk_bf16_f32 v239, v242, v243
buffer_store_dwordx4 v[236:239], v18, s[32:35], s82 offen sc1
v_pk_mul_f32 v[244:245], v[244:245], v[184:185] op_sel:[0,0] op_sel_hi:[1,0]
v_pk_mul_f32 v[246:247], v[246:247], v[184:185] op_sel:[0,0] op_sel_hi:[1,0]
v_pk_mul_f32 v[248:249], v[248:249], v[184:185] op_sel:[0,0] op_sel_hi:[1,0]
v_pk_mul_f32 v[250:251], v[250:251], v[184:185] op_sel:[0,0] op_sel_hi:[1,0]
v_cvt_pk_bf16_f32 v244, v244, v245
v_cvt_pk_bf16_f32 v245, v246, v247
v_cvt_pk_bf16_f32 v246, v248, v249
v_cvt_pk_bf16_f32 v247, v250, v251
buffer_store_dwordx4 v[244:247], v18, s[32:35], s83 offen sc1
s_barrier
s_lshl_b32 s62, s45, 2
v_mov_b32 v4, s62
v_mov_b32 v5, 3
s_mov_b64 exec, 1
s_waitcnt vmcnt(0)
buffer_store_dword v5, v4, s[32:35], s84 offen sc1
s_mov_b64 exec, -1
s_branch back_88
slow_91:
s_nop 0
v_cvt_pk_bf16_f32 v20, v60, v61
v_cvt_pk_bf16_f32 v21, v62, v63
v_cvt_pk_bf16_f32 v22, v64, v65
v_cvt_pk_bf16_f32 v23, v66, v67
buffer_store_dwordx4 v[20:23], v18, s[32:35], s85 offen offset:0 sc1
v_cvt_pk_bf16_f32 v24, v68, v69
v_cvt_pk_bf16_f32 v25, v70, v71
v_cvt_pk_bf16_f32 v26, v72, v73
v_cvt_pk_bf16_f32 v27, v74, v75
buffer_store_dwordx4 v[24:27], v18, s[32:35], s85 offen offset:1024 sc1
v_cvt_pk_bf16_f32 v28, v76, v77
v_cvt_pk_bf16_f32 v29, v78, v79
v_cvt_pk_bf16_f32 v30, v80, v81
v_cvt_pk_bf16_f32 v31, v82, v83
buffer_store_dwordx4 v[28:31], v18, s[32:35], s86 offen offset:0 sc1
v_cvt_pk_bf16_f32 v32, v84, v85
v_cvt_pk_bf16_f32 v33, v86, v87
v_cvt_pk_bf16_f32 v34, v88, v89
v_cvt_pk_bf16_f32 v35, v90, v91
buffer_store_dwordx4 v[32:35], v18, s[32:35], s86 offen offset:1024 sc1
s_barrier
v_dot2c_f32_bf16 v6, v20, v48
v_dot2c_f32_bf16 v8, v20, v20
v_dot2c_f32_bf16 v7, v28, v48
v_dot2c_f32_bf16 v9, v28, v28
v_dot2c_f32_bf16 v6, v21, v48
v_dot2c_f32_bf16 v8, v21, v21
v_dot2c_f32_bf16 v7, v29, v48
v_dot2c_f32_bf16 v9, v29, v29
v_dot2c_f32_bf16 v6, v22, v48
v_dot2c_f32_bf16 v8, v22, v22
v_dot2c_f32_bf16 v7, v30, v48
v_dot2c_f32_bf16 v9, v30, v30
v_dot2c_f32_bf16 v6, v23, v48
v_dot2c_f32_bf16 v8, v23, v23
v_dot2c_f32_bf16 v7, v31, v48
v_dot2c_f32_bf16 v9, v31, v31
v_dot2c_f32_bf16 v6, v24, v48
v_dot2c_f32_bf16 v8, v24, v24
v_dot2c_f32_bf16 v7, v32, v48
v_dot2c_f32_bf16 v9, v32, v32
v_dot2c_f32_bf16 v6, v25, v48
v_dot2c_f32_bf16 v8, v25, v25
v_dot2c_f32_bf16 v7, v33, v48
v_dot2c_f32_bf16 v9, v33, v33
v_dot2c_f32_bf16 v6, v26, v48
v_dot2c_f32_bf16 v8, v26, v26
v_dot2c_f32_bf16 v7, v34, v48
v_dot2c_f32_bf16 v9, v34, v34
v_dot2c_f32_bf16 v6, v27, v48
v_dot2c_f32_bf16 v8, v27, v27
v_dot2c_f32_bf16 v7, v35, v48
v_dot2c_f32_bf16 v9, v35, v35
s_mov_b64 exec, 1
s_waitcnt vmcnt(0)
buffer_store_dword v5, v4, s[32:35], s88 offen sc1
s_mov_b64 exec, -1
s_nop 1
v_permlane32_swap_b32 v6, v7
v_permlane32_swap_b32 v8, v9
v_add_f32 v6, v6, v7
v_add_f32 v8, v8, v9
s_nop 1
v_permlane16_swap_b32 v6, v8
s_nop 0
v_add_f32 v6, v6, v8
buffer_store_dword v6, v1, s[32:35], s87 offen sc1
s_branch back_92
slow_105:
.p2align 3
v_pk_mul_f32 v[156:157], v[156:157], v[100:101] op_sel:[0,0] op_sel_hi:[1,0]
v_pk_mul_f32 v[158:159], v[158:159], v[100:101] op_sel:[0,0] op_sel_hi:[1,0]
v_pk_mul_f32 v[160:161], v[160:161], v[100:101] op_sel:[0,0] op_sel_hi:[1,0]
v_pk_mul_f32 v[162:163], v[162:163], v[100:101] op_sel:[0,0] op_sel_hi:[1,0]
v_cvt_pk_bf16_f32 v156, v156, v157
v_cvt_pk_bf16_f32 v157, v158, v159
v_cvt_pk_bf16_f32 v158, v160, v161
v_cvt_pk_bf16_f32 v159, v162, v163
buffer_store_dwordx4 v[156:159], v18, s[32:35], s80 offen sc1
v_pk_mul_f32 v[164:165], v[164:165], v[100:101] op_sel:[0,1] op_sel_hi:[1,1]
v_pk_mul_f32 v[166:167], v[166:167], v[100:101] op_sel:[0,1] op_sel_hi:[1,1]
v_pk_mul_f32 v[168:169], v[168:169], v[100:101] op_sel:[0,1] op_sel_hi:[1,1]
v_pk_mul_f32 v[170:171], v[170:171], v[100:101] op_sel:[0,1] op_sel_hi:[1,1]
v_cvt_pk_bf16_f32 v164, v164, v165
v_cvt_pk_bf16_f32 v165, v166, v167
v_cvt_pk_bf16_f32 v166, v168, v169
v_cvt_pk_bf16_f32 v167, v170, v171
buffer_store_dwordx4 v[164:167], v18, s[32:35], s81 offen sc1
v_pk_mul_f32 v[172:173], v[172:173], v[102:103] op_sel:[0,0] op_sel_hi:[1,0]
v_pk_mul_f32 v[174:175], v[174:175], v[102:103] op_sel:[0,0] op_sel_hi:[1,0]
v_pk_mul_f32 v[176:177], v[176:177], v[102:103] op_sel:[0,0] op_sel_hi:[1,0]
v_pk_mul_f32 v[178:179], v[178:179], v[102:103] op_sel:[0,0] op_sel_hi:[1,0]
v_cvt_pk_bf16_f32 v172, v172, v173
v_cvt_pk_bf16_f32 v173, v174, v175
v_cvt_pk_bf16_f32 v174, v176, v177
v_cvt_pk_bf16_f32 v175, v178, v179
buffer_store_dwordx4 v[172:175], v18, s[32:35], s82 offen sc1
v_pk_mul_f32 v[180:181], v[180:181], v[102:103] op_sel:[0,1] op_sel_hi:[1,1]
v_pk_mul_f32 v[182:183], v[182:183], v[102:103] op_sel:[0,1] op_sel_hi:[1,1]
v_pk_mul_f32 v[184:185], v[184:185], v[102:103] op_sel:[0,1] op_sel_hi:[1,1]
v_pk_mul_f32 v[186:187], v[186:187], v[102:103] op_sel:[0,1] op_sel_hi:[1,1]
v_cvt_pk_bf16_f32 v180, v180, v181
v_cvt_pk_bf16_f32 v181, v182, v183
v_cvt_pk_bf16_f32 v182, v184, v185
v_cvt_pk_bf16_f32 v183, v186, v187
buffer_store_dwordx4 v[180:183], v18, s[32:35], s83 offen sc1
s_barrier
s_lshl_b32 s62, s45, 2
v_mov_b32 v4, s62
v_mov_b32 v5, 4
s_mov_b64 exec, 1
s_waitcnt vmcnt(0)
buffer_store_dword v5, v4, s[32:35], s84 offen sc1
s_mov_b64 exec, -1
s_branch back_106
s_endpgm
.section .rodata,"a"
.p2align 6
.amdhsa_kernel interleave_layers__sliding_local_dilated__linear_kernel_hedgehog__prompt_kernel
  .amdhsa_next_free_vgpr 256
  .amdhsa_next_free_sgpr 102
  .amdhsa_accum_offset 256
  .amdhsa_group_segment_fixed_size 0
  .amdhsa_kernarg_size 80
  .amdhsa_user_sgpr_count 2
  .amdhsa_user_sgpr_kernarg_segment_ptr 1
  .amdhsa_system_sgpr_workgroup_id_x 1
.end_amdhsa_kernel
```

```asm
; @launch grid=(256,1,1) block=(512,1,1) lds=163840
.amdgcn_target "amdgcn-amd-amdhsa--gfx950"
.text
.globl interleave_layers__sliding_local_dilated__linear_kernel_hedgehog__prompt_kernel
.p2align 8
.type interleave_layers__sliding_local_dilated__linear_kernel_hedgehog__prompt_kernel,@function
interleave_layers__sliding_local_dilated__linear_kernel_hedgehog__prompt_kernel:
s_cmp_ge_u32 s2, 256
s_cbranch_scc1 L_end
s_load_dwordx16 s[4:19], s[0:1], 0
s_load_dwordx4 s[20:23], s[0:1], 64
v_lshrrev_b32 v1, 6, v0
v_and_b32 v0, 63, v0
v_readfirstlane_b32 s40, v1
v_and_b32 v2, 15, v0
v_lshrrev_b32 v3, 4, v0
v_lshlrev_b32 v18, 4, v0
s_and_b32 s48, s2, 7
s_lshr_b32 s49, s2, 3
s_and_b32 s74, s49, 1
s_lshl_b32 s41, s48, 1
s_add_u32 s41, s41, s74
s_lshr_b32 s42, s49, 1
s_and_b32 s48, s2, 7
s_lshr_b32 s47, s42, 2
s_add_u32 s47, s47, s48
s_and_b32 s47, s47, 3
s_and_b32 s43, s40, 3
s_lshl_b32 s70, s43, 12
s_lshl_b32 s71, s43, 11
s_add_u32 s71, s71, 16384
s_cmp_lt_u32 s40, 4
s_cbranch_scc1 L_compute
v_lshrrev_b32 v4, 3, v0
v_and_b32 v5, 7, v0
s_lshl_b32 s48, s43, 4
v_add_u32 v6, s48, v4
s_lshl_b32 s48, s42, 7
s_mov_b32 s49, 6144
v_mul_u32_u24 v6, s49, v6
v_and_b32 v7, 2, v4
v_xor_b32 v7, v7, v5
v_lshl_add_u32 v26, v7, 4, v6
v_add_u32 v26, s48, v26
s_mul_i32 s49, s49, 8
s_sub_u32 s49, s49, 1024
v_xor_b32 v27, 64, v26
v_add_u32 v27, s49, v27
s_mov_b32 s53, 2048
s_mov_b32 s54, 393216
s_mov_b32 s57, 131072
s_lshl_b32 s48, s41, 7
s_lshl_b32 s49, s43, 5
s_add_u32 s48, s48, s49
v_add_u32 v6, s48, v4
v_lshlrev_b32 v6, 11, v6
v_lshrrev_b32 v7, 1, v4
v_xor_b32 v7, v7, v5
v_lshl_add_u32 v20, v7, 4, v6
v_xor_b32 v21, 64, v20
v_add_u32 v21, 15360, v21
v_add_u32 v22, 30720, v20
v_add_u32 v23, 30720, v21
s_add_u32 s69, s47, 0
s_and_b32 s69, s69, 3
s_add_u32 s69, s69, 0
s_mul_i32 s67, s69, 128
s_mul_i32 s68, s69, s54
s_waitcnt lgkmcnt(0)
s_mov_b32 s24, s4
s_and_b32 s25, s5, 0xffff
s_mov_b32 s26, 4194304
s_mov_b32 s27, 0x00020000
s_mov_b32 s28, s6
s_and_b32 s29, s7, 0xffff
s_mov_b32 s30, 6291456
s_mov_b32 s31, 0x00020000
s_add_u32 m0, s70, 0
s_nop 0
buffer_load_dwordx4 v20, s[24:27], s67 offen offset:0  lds
buffer_load_dwordx4 v21, s[24:27], s67 offen offset:1024  lds
buffer_load_dwordx4 v22, s[24:27], s67 offen offset:2048  lds
buffer_load_dwordx4 v23, s[24:27], s67 offen offset:3072  lds
s_add_u32 s60, s71, 0
s_add_u32 m0, s60, 0
s_mov_b32 s61, s68
buffer_load_dwordx4 v26, s[28:31], s61 offen lds
buffer_load_dwordx4 v27, s[28:31], s61 offen offset:1024 lds
s_add_u32 m0, s60, 8192
s_add_u32 s61, s61, s53
buffer_load_dwordx4 v26, s[28:31], s61 offen lds
buffer_load_dwordx4 v27, s[28:31], s61 offen offset:1024 lds
s_add_u32 m0, s60, 16384
s_add_u32 s61, s61, s53
buffer_load_dwordx4 v26, s[28:31], s61 offen lds
buffer_load_dwordx4 v27, s[28:31], s61 offen offset:1024 lds
s_lshr_b32 s48, s2, 2
s_and_b32 s48, s48, 1
s_lshl_b32 s48, s48, 1
s_add_u32 s48, s48, s74
s_and_b32 s49, s42, 3
s_xor_b32 s77, s48, s49
s_add_u32 s77, s77, 4
s_add_u32 s48, s47, 1
s_and_b32 s48, s48, 3
s_and_b32 s49, s77, 3
s_lshl_b32 s49, s49, 2
s_add_u32 s78, s48, s49
s_and_b32 s48, s2, 7
s_lshl_b32 s48, s48, 1
s_add_u32 s75, s78, s48
s_and_b32 s75, s75, 15
s_mov_b32 s46, 0
s_mov_b32 s32, s22
s_and_b32 s33, s23, 0xffff
s_mov_b32 s34, 268435456
s_mov_b32 s35, 0x00020000
s_mov_b32 s36, s8
s_and_b32 s37, s9, 0xffff
s_mov_b32 s38, 2097152
s_mov_b32 s39, 0x00020000
v_mov_b32 v56, -1
v_mov_b32 v57, -1
v_mov_b32 v58, -1
v_mov_b32 v59, -1
s_lshl_b32 s52, s41, 6
s_add_u32 s52, s52, s42
s_lshl_b32 s52, s52, 8
s_add_u32 s52, s52, 16777216
s_getreg_b32 s50, hwreg(HW_REG_XCC_ID)
s_and_b32 s50, s50, 7
s_lshl_b32 s50, s50, 3
s_lshl_b64 s[94:95], 1, s50
s_and_b32 s96, s2, 7
s_lshl_b32 s96, s96, 5
s_and_b32 s51, s42, 7
s_cmp_gt_u32 s51, 3
s_cselect_b32 s49, 1, 0
s_sub_u32 s49, s51, s49
s_lshl_b32 s49, s49, 1
s_add_u32 s49, s49, s74
s_lshl_b32 s49, s49, 2
s_add_u32 s49, s49, s43
s_lshr_b32 s50, s49, 4
s_lshl_b32 s50, s50, 11
s_and_b32 s49, s49, 15
s_mul_i32 s49, s49, 24576
s_add_u32 s49, s49, s50
s_and_b32 s50, s42, 8
s_or_b32 s50, s50, 3
s_and_b32 s48, s2, 7
s_lshr_b32 s76, s50, 2
s_add_u32 s76, s76, s48
s_and_b32 s76, s76, 3
s_lshl_b32 s50, s50, 7
s_add_u32 s49, s49, s50
s_and_b32 s51, s51, 3
s_cmp_eq_u32 s51, 3
s_cselect_b32 s49, 0x70000000, s49
v_mul_u32_u24 v4, 6144, v4
v_lshl_add_u32 v4, v5, 4, v4
v_lshrrev_b32 v5, 5, v0
v_lshlrev_b32 v5, 30, v5
v_add3_u32 v36, v4, v5, s49
s_mov_b32 s55, -1
s_mov_b32 s56, -1
v_lshrrev_b32 v4, 3, v0
v_and_b32 v5, 7, v0
s_lshr_b32 s48, s43, 1
s_lshl_b32 s48, s48, 5
s_and_b32 s49, s43, 1
s_lshl_b32 s49, s49, 3
s_add_u32 s48, s48, s49
v_lshrrev_b32 v6, 2, v4
v_lshlrev_b32 v6, 4, v6
v_and_b32 v7, 3, v4
v_add3_u32 v6, v6, v7, s48
s_lshl_b32 s48, s78, 7
s_mov_b32 s49, 2048
v_mul_u32_u24 v6, s49, v6
v_and_b32 v7, 2, v4
v_xor_b32 v7, v7, v5
v_lshl_add_u32 v28, v7, 4, v6
v_add_u32 v28, s48, v28
s_mul_i32 s49, s49, 4
s_sub_u32 s49, s49, 1024
v_xor_b32 v29, 64, v28
v_add_u32 v29, s49, v29
v_lshrrev_b32 v4, 3, v0
v_and_b32 v5, 7, v0
s_lshr_b32 s48, s43, 1
s_lshl_b32 s48, s48, 5
s_and_b32 s49, s43, 1
s_lshl_b32 s49, s49, 3
s_add_u32 s48, s48, s49
v_lshrrev_b32 v6, 2, v4
v_lshlrev_b32 v6, 4, v6
v_and_b32 v7, 3, v4
v_add3_u32 v6, v6, v7, s48
s_lshl_b32 s48, s42, 7
s_mov_b32 s49, 6144
s_cmp_ge_i32 s55, 0
s_cselect_b32 s48, 1024, s48
s_cselect_b32 s49, 384, s49
v_mul_u32_u24 v6, s49, v6
v_and_b32 v7, 2, v4
v_xor_b32 v7, v7, v5
v_lshl_add_u32 v60, v7, 4, v6
v_add_u32 v60, s48, v60
s_mul_i32 s49, s49, 4
s_sub_u32 s49, s49, 1024
v_xor_b32 v61, 64, v60
v_add_u32 v61, s49, v61
v_lshrrev_b32 v4, 3, v0
v_and_b32 v5, 7, v0
s_lshr_b32 s48, s43, 1
s_lshl_b32 s48, s48, 5
s_and_b32 s49, s43, 1
s_lshl_b32 s49, s49, 3
s_add_u32 s48, s48, s49
v_lshrrev_b32 v6, 2, v4
v_lshlrev_b32 v6, 4, v6
v_and_b32 v7, 3, v4
v_add3_u32 v6, v6, v7, s48
s_lshl_b32 s48, s78, 7
s_mov_b32 s49, 2048
s_cmp_ge_i32 s56, 0
s_cselect_b32 s48, 1024, s48
s_cselect_b32 s49, 128, s49
v_mul_u32_u24 v6, s49, v6
v_and_b32 v7, 2, v4
v_xor_b32 v7, v7, v5
v_lshl_add_u32 v24, v7, 4, v6
v_add_u32 v24, s48, v24
s_mul_i32 s49, s49, 4
s_sub_u32 s49, s49, 1024
v_xor_b32 v25, 64, v24
v_add_u32 v25, s49, v25
v_lshlrev_b32 v30, 2, v2
v_and_b32 v32, 7, v0
v_lshlrev_b32 v32, 5, v32
s_lshl_b32 s50, s41, 2
s_add_u32 s50, s50, s43
s_lshl_b32 s50, s50, 12
s_add_u32 s50, s50, 16777216
v_add_u32 v37, s50, v18
v_lshrrev_b32 v4, 5, v0
v_lshl_add_u32 v4, v4, 4, v2
s_lshl_b32 s48, s43, 5
v_add_u32 v4, s48, v4
v_lshlrev_b32 v49, 3, v4
v_add_u32 v49, 131072, v49
v_lshlrev_b32 v50, 2, v4
v_add_u32 v50, 132096, v50
s_lshl_b32 s79, s41, 2
s_add_u32 s79, s79, s43
s_lshl_b32 s79, s79, 7
s_add_u32 s79, s79, 18358272
s_lshl_b32 s48, s41, 3
s_lshl_b32 s49, s43, 1
s_add_u32 s48, s48, s49
s_lshl_b32 s80, s48, 15
s_lshl_b32 s49, s42, 11
s_add_u32 s81, s80, s49
s_add_u32 s81, s81, 4194304
s_add_u32 s82, s81, 32768
s_lshl_b32 s48, s43, 11
v_add_u32 v51, s48, v18
v_add_u32 v52, 0x10000, v51
s_lshl_b32 s48, s2, 2
s_add_u32 s48, s48, s43
s_lshl_b32 s83, s48, 11
s_mul_i32 s87, s48, 6144
v_add_u32 v62, s83, v18
s_add_u32 s87, s87, 3072
v_add_u32 v63, s87, v18
s_lshr_b32 s48, s2, 4
s_and_b32 s49, s2, 7
s_add_u32 s48, s48, s49
s_mul_i32 s49, s48, 16385
s_lshr_b32 s49, s49, 16
s_mul_i32 s49, s49, 4
s_sub_u32 s88, s48, s49
s_mul_i32 s48, s42, 163840
s_add_u32 s48, s48, 9437184
s_lshl_b32 s49, s43, 4
s_add_u32 s49, s49, s41
s_lshl_b32 s50, s49, 11
s_add_u32 s86, s48, s50
s_lshl_b32 s50, s49, 9
s_add_u32 s89, s48, s50
s_add_u32 s89, s89, 131072
v_lshlrev_b32 v39, 3, v0
s_lshl_b32 s73, s42, 2
s_add_u32 s73, s73, 0
s_lshl_b32 s73, s73, 7
s_add_u32 s73, s73, 18366464
s_lshl_b32 s48, s41, 2
v_mov_b32 v12, s48
v_mov_b32 v13, 1
s_lshl_b32 s50, s43, 12
s_add_u32 s50, s50, s52
s_add_u32 s50, s50, 262144
v_min_u32 v8, 2, v3
v_lshlrev_b32 v8, 18, v8
v_lshl_add_u32 v8, v2, 4, v8
v_add_u32 v55, s50, v8
s_lshl_b32 s50, s42, 2
s_add_u32 s50, s50, s43
s_lshl_b32 s50, s50, 12
s_add_u32 s50, s50, 17825792
v_add_u32 v38, s50, v18
v_min_u32 v4, 2, v3
v_lshlrev_b32 v4, 8, v4
v_lshl_add_u32 v4, v2, 2, v4
s_and_b32 s48, s43, 1
s_lshl_b32 s48, s48, 7
s_lshr_b32 s49, s43, 1
s_lshl_b32 s49, s49, 6
s_add_u32 s48, s48, s49
s_add_u32 s48, s48, 133120
v_add_u32 v53, s48, v4
s_getpc_b64 s[98:99]
pc_1:
s_add_u32 s98, s98, c0_last - pc_1
s_addc_u32 s99, s99, 0
s_lshr_b32 s50, s2, 3
s_lshl_b32 s50, s50, 2
s_add_u32 s50, s50, s43
s_lshl_b32 s50, s50, 7
v_and_b32 v4, 1, v0
v_lshl_add_u32 v4, v4, 6, s50
v_min_u32 v54, L_code_end - c0_last, v4
s_add_u32 s69, s47, 0
s_and_b32 s69, s69, 3
s_add_u32 s69, s69, 4
s_mul_i32 s67, s69, 128
s_mul_i32 s68, s69, s54
s_add_u32 m0, s70, 40960
s_nop 0
buffer_load_dwordx4 v20, s[24:27], s67 offen offset:0  lds
buffer_load_dwordx4 v21, s[24:27], s67 offen offset:1024  lds
buffer_load_dwordx4 v22, s[24:27], s67 offen offset:2048  lds
buffer_load_dwordx4 v23, s[24:27], s67 offen offset:3072  lds
s_add_u32 s60, s71, 40960
s_add_u32 m0, s60, 0
s_mov_b32 s61, s68
buffer_load_dwordx4 v26, s[28:31], s61 offen lds
buffer_load_dwordx4 v27, s[28:31], s61 offen offset:1024 lds
s_add_u32 m0, s60, 8192
s_add_u32 s61, s61, s53
buffer_load_dwordx4 v26, s[28:31], s61 offen lds
buffer_load_dwordx4 v27, s[28:31], s61 offen offset:1024 lds
s_add_u32 m0, s60, 16384
s_add_u32 s61, s61, s53
buffer_load_dwordx4 v26, s[28:31], s61 offen lds
buffer_load_dwordx4 v27, s[28:31], s61 offen offset:1024 lds
s_waitcnt vmcnt(10)
s_barrier
s_cmp_lg_u32 s43, 3
s_cbranch_scc1 else_2
s_atomic_add_x2 s[94:95], s[20:21], s96
else_2:
s_add_u32 s49, s76, 0
s_and_b32 s49, s49, 3
s_add_u32 s49, s49, 8
s_mul_i32 s49, s49, 393216
buffer_load_dwordx4 v[40:43], v36, s[28:31], s49 offen
s_add_u32 s49, s76, 0
s_and_b32 s49, s49, 3
s_add_u32 s49, s49, 12
s_mul_i32 s49, s49, 393216
buffer_load_dwordx4 v[40:43], v36, s[28:31], s49 offen
s_add_u32 s69, s47, 0
s_and_b32 s69, s69, 3
s_add_u32 s69, s69, 8
s_mul_i32 s67, s69, 128
s_mul_i32 s68, s69, s54
s_add_u32 m0, s70, 81920
s_nop 0
buffer_load_dwordx4 v20, s[24:27], s67 offen offset:0  lds
buffer_load_dwordx4 v21, s[24:27], s67 offen offset:1024  lds
buffer_load_dwordx4 v22, s[24:27], s67 offen offset:2048  lds
buffer_load_dwordx4 v23, s[24:27], s67 offen offset:3072  lds
s_add_u32 s60, s71, 81920
s_add_u32 m0, s60, 0
s_mov_b32 s61, s68
buffer_load_dwordx4 v26, s[28:31], s61 offen lds
buffer_load_dwordx4 v27, s[28:31], s61 offen offset:1024 lds
s_add_u32 m0, s60, 8192
s_add_u32 s61, s61, s53
buffer_load_dwordx4 v26, s[28:31], s61 offen lds
buffer_load_dwordx4 v27, s[28:31], s61 offen offset:1024 lds
s_add_u32 m0, s60, 16384
s_add_u32 s61, s61, s53
buffer_load_dwordx4 v26, s[28:31], s61 offen lds
buffer_load_dwordx4 v27, s[28:31], s61 offen offset:1024 lds
s_add_u32 s49, s76, 1
s_and_b32 s49, s49, 3
s_add_u32 s49, s49, 0
s_mul_i32 s49, s49, 393216
buffer_load_dwordx4 v[40:43], v36, s[28:31], s49 offen
s_mov_b32 s64, 0
s_mov_b32 s65, 0
s_waitcnt vmcnt(11)
s_barrier
s_add_u32 s69, s47, 0
s_and_b32 s69, s69, 3
s_add_u32 s69, s69, 12
s_mul_i32 s67, s69, 128
s_mul_i32 s68, s69, s54
s_add_u32 m0, s70, s65
s_nop 0
buffer_load_dwordx4 v20, s[24:27], s67 offen offset:0  lds
buffer_load_dwordx4 v21, s[24:27], s67 offen offset:1024  lds
buffer_load_dwordx4 v22, s[24:27], s67 offen offset:2048  lds
buffer_load_dwordx4 v23, s[24:27], s67 offen offset:3072  lds
s_add_u32 s60, s71, s65
s_add_u32 m0, s60, 0
s_mov_b32 s61, s68
buffer_load_dwordx4 v26, s[28:31], s61 offen lds
buffer_load_dwordx4 v27, s[28:31], s61 offen offset:1024 lds
s_add_u32 m0, s60, 8192
s_add_u32 s61, s61, s53
buffer_load_dwordx4 v26, s[28:31], s61 offen lds
buffer_load_dwordx4 v27, s[28:31], s61 offen offset:1024 lds
s_add_u32 m0, s60, 16384
s_add_u32 s61, s61, s53
buffer_load_dwordx4 v26, s[28:31], s61 offen lds
buffer_load_dwordx4 v27, s[28:31], s61 offen offset:1024 lds
s_add_u32 s49, s76, 1
s_and_b32 s49, s49, 3
s_add_u32 s49, s49, 4
s_mul_i32 s49, s49, 393216
buffer_load_dwordx4 v[40:43], v36, s[28:31], s49 offen
s_add_u32 s65, s65, 40960
s_cmp_eq_u32 s65, 122880
s_cselect_b32 s65, 0, s65
s_add_u32 s64, s64, 1
s_waitcnt vmcnt(11)
s_barrier
s_add_u32 s69, s47, 1
s_and_b32 s69, s69, 3
s_add_u32 s69, s69, 0
s_mul_i32 s67, s69, 128
s_mul_i32 s68, s69, s54
s_add_u32 m0, s70, s65
s_nop 0
buffer_load_dwordx4 v20, s[24:27], s67 offen offset:0  lds
buffer_load_dwordx4 v21, s[24:27], s67 offen offset:1024  lds
buffer_load_dwordx4 v22, s[24:27], s67 offen offset:2048  lds
buffer_load_dwordx4 v23, s[24:27], s67 offen offset:3072  lds
s_add_u32 s60, s71, s65
s_add_u32 m0, s60, 0
s_mov_b32 s61, s68
buffer_load_dwordx4 v26, s[28:31], s61 offen lds
buffer_load_dwordx4 v27, s[28:31], s61 offen offset:1024 lds
s_add_u32 m0, s60, 8192
s_add_u32 s61, s61, s53
buffer_load_dwordx4 v26, s[28:31], s61 offen lds
buffer_load_dwordx4 v27, s[28:31], s61 offen offset:1024 lds
s_add_u32 m0, s60, 16384
s_add_u32 s61, s61, s53
buffer_load_dwordx4 v26, s[28:31], s61 offen lds
buffer_load_dwordx4 v27, s[28:31], s61 offen offset:1024 lds
s_add_u32 s49, s76, 1
s_and_b32 s49, s49, 3
s_add_u32 s49, s49, 8
s_mul_i32 s49, s49, 393216
buffer_load_dwordx4 v[40:43], v36, s[28:31], s49 offen
s_add_u32 s65, s65, 40960
s_cmp_eq_u32 s65, 122880
s_cselect_b32 s65, 0, s65
s_add_u32 s64, s64, 1
s_waitcnt vmcnt(11)
s_barrier
s_cmp_lg_u32 s88, 0
s_cbranch_scc1 else_4
buffer_load_dwordx4 v[108:111], v18, s[36:39], s83 offen offset:0
buffer_load_dwordx4 v[108:111], v18, s[36:39], s83 offen offset:1024
global_load_dwordx4 v[108:111], v63, s[12:13] offset:-3072
global_load_dwordx4 v[108:111], v63, s[12:13] offset:-2048
buffer_store_dwordx4 v[56:59], v18, s[32:35], s86 offen offset:0 sc1
buffer_store_dwordx4 v[56:59], v18, s[32:35], s86 offen offset:1024 sc1
else_4:
s_add_u32 s69, s47, 1
s_and_b32 s69, s69, 3
s_add_u32 s69, s69, 4
s_mul_i32 s67, s69, 128
s_mul_i32 s68, s69, s54
s_add_u32 m0, s70, s65
s_nop 0
buffer_load_dwordx4 v20, s[24:27], s67 offen offset:0  lds
buffer_load_dwordx4 v21, s[24:27], s67 offen offset:1024  lds
buffer_load_dwordx4 v22, s[24:27], s67 offen offset:2048  lds
buffer_load_dwordx4 v23, s[24:27], s67 offen offset:3072  lds
s_add_u32 s60, s71, s65
s_add_u32 m0, s60, 0
s_mov_b32 s61, s68
buffer_load_dwordx4 v26, s[28:31], s61 offen lds
buffer_load_dwordx4 v27, s[28:31], s61 offen offset:1024 lds
s_add_u32 m0, s60, 8192
s_add_u32 s61, s61, s53
buffer_load_dwordx4 v26, s[28:31], s61 offen lds
buffer_load_dwordx4 v27, s[28:31], s61 offen offset:1024 lds
s_add_u32 m0, s60, 16384
s_add_u32 s61, s61, s53
buffer_load_dwordx4 v26, s[28:31], s61 offen lds
buffer_load_dwordx4 v27, s[28:31], s61 offen offset:1024 lds
s_add_u32 s49, s76, 1
s_and_b32 s49, s49, 3
s_add_u32 s49, s49, 12
s_mul_i32 s49, s49, 393216
buffer_load_dwordx4 v[40:43], v36, s[28:31], s49 offen
s_add_u32 s65, s65, 40960
s_cmp_eq_u32 s65, 122880
s_cselect_b32 s65, 0, s65
s_add_u32 s64, s64, 1
s_waitcnt vmcnt(11)
s_barrier
s_cmp_lg_u32 s88, 1
s_cbranch_scc1 else_6
buffer_load_dwordx4 v[108:111], v18, s[36:39], s83 offen offset:0
buffer_load_dwordx4 v[108:111], v18, s[36:39], s83 offen offset:1024
global_load_dwordx4 v[108:111], v63, s[12:13] offset:-3072
global_load_dwordx4 v[108:111], v63, s[12:13] offset:-2048
buffer_store_dwordx4 v[56:59], v18, s[32:35], s86 offen offset:0 sc1
buffer_store_dwordx4 v[56:59], v18, s[32:35], s86 offen offset:1024 sc1
else_6:
s_add_u32 s69, s47, 1
s_and_b32 s69, s69, 3
s_add_u32 s69, s69, 8
s_mul_i32 s67, s69, 128
s_mul_i32 s68, s69, s54
s_add_u32 m0, s70, s65
s_nop 0
buffer_load_dwordx4 v20, s[24:27], s67 offen offset:0  lds
buffer_load_dwordx4 v21, s[24:27], s67 offen offset:1024  lds
buffer_load_dwordx4 v22, s[24:27], s67 offen offset:2048  lds
buffer_load_dwordx4 v23, s[24:27], s67 offen offset:3072  lds
s_add_u32 s60, s71, s65
s_add_u32 m0, s60, 0
s_mov_b32 s61, s68
buffer_load_dwordx4 v26, s[28:31], s61 offen lds
buffer_load_dwordx4 v27, s[28:31], s61 offen offset:1024 lds
s_add_u32 m0, s60, 8192
s_add_u32 s61, s61, s53
buffer_load_dwordx4 v26, s[28:31], s61 offen lds
buffer_load_dwordx4 v27, s[28:31], s61 offen offset:1024 lds
s_add_u32 m0, s60, 16384
s_add_u32 s61, s61, s53
buffer_load_dwordx4 v26, s[28:31], s61 offen lds
buffer_load_dwordx4 v27, s[28:31], s61 offen offset:1024 lds
s_add_u32 s49, s76, 2
s_and_b32 s49, s49, 3
s_add_u32 s49, s49, 0
s_mul_i32 s49, s49, 393216
buffer_load_dwordx4 v[40:43], v36, s[28:31], s49 offen
s_add_u32 s65, s65, 40960
s_cmp_eq_u32 s65, 122880
s_cselect_b32 s65, 0, s65
s_add_u32 s64, s64, 1
s_waitcnt vmcnt(11)
s_barrier
s_cmp_lg_u32 s88, 2
s_cbranch_scc1 else_8
buffer_load_dwordx4 v[108:111], v18, s[36:39], s83 offen offset:0
buffer_load_dwordx4 v[108:111], v18, s[36:39], s83 offen offset:1024
global_load_dwordx4 v[108:111], v63, s[12:13] offset:-3072
global_load_dwordx4 v[108:111], v63, s[12:13] offset:-2048
buffer_store_dwordx4 v[56:59], v18, s[32:35], s86 offen offset:0 sc1
buffer_store_dwordx4 v[56:59], v18, s[32:35], s86 offen offset:1024 sc1
else_8:
s_add_u32 s69, s47, 1
s_and_b32 s69, s69, 3
s_add_u32 s69, s69, 12
s_mul_i32 s67, s69, 128
s_mul_i32 s68, s69, s54
s_add_u32 m0, s70, s65
s_nop 0
buffer_load_dwordx4 v20, s[24:27], s67 offen offset:0  lds
buffer_load_dwordx4 v21, s[24:27], s67 offen offset:1024  lds
buffer_load_dwordx4 v22, s[24:27], s67 offen offset:2048  lds
buffer_load_dwordx4 v23, s[24:27], s67 offen offset:3072  lds
s_add_u32 s60, s71, s65
s_add_u32 m0, s60, 0
s_mov_b32 s61, s68
buffer_load_dwordx4 v26, s[28:31], s61 offen lds
buffer_load_dwordx4 v27, s[28:31], s61 offen offset:1024 lds
s_add_u32 m0, s60, 8192
s_add_u32 s61, s61, s53
buffer_load_dwordx4 v26, s[28:31], s61 offen lds
buffer_load_dwordx4 v27, s[28:31], s61 offen offset:1024 lds
s_add_u32 m0, s60, 16384
s_add_u32 s61, s61, s53
buffer_load_dwordx4 v26, s[28:31], s61 offen lds
buffer_load_dwordx4 v27, s[28:31], s61 offen offset:1024 lds
s_add_u32 s49, s76, 2
s_and_b32 s49, s49, 3
s_add_u32 s49, s49, 4
s_mul_i32 s49, s49, 393216
buffer_load_dwordx4 v[40:43], v36, s[28:31], s49 offen
s_add_u32 s65, s65, 40960
s_cmp_eq_u32 s65, 122880
s_cselect_b32 s65, 0, s65
s_add_u32 s64, s64, 1
s_waitcnt vmcnt(11)
s_barrier
s_cmp_lg_u32 s88, 3
s_cbranch_scc1 else_10
buffer_load_dwordx4 v[108:111], v18, s[36:39], s83 offen offset:0
buffer_load_dwordx4 v[108:111], v18, s[36:39], s83 offen offset:1024
global_load_dwordx4 v[108:111], v63, s[12:13] offset:-3072
global_load_dwordx4 v[108:111], v63, s[12:13] offset:-2048
buffer_store_dwordx4 v[56:59], v18, s[32:35], s86 offen offset:0 sc1
buffer_store_dwordx4 v[56:59], v18, s[32:35], s86 offen offset:1024 sc1
else_10:
s_add_u32 s69, s47, 2
s_and_b32 s69, s69, 3
s_add_u32 s69, s69, 0
s_mul_i32 s67, s69, 128
s_mul_i32 s68, s69, s54
s_add_u32 m0, s70, s65
s_nop 0
buffer_load_dwordx4 v20, s[24:27], s67 offen offset:0  lds
buffer_load_dwordx4 v21, s[24:27], s67 offen offset:1024  lds
buffer_load_dwordx4 v22, s[24:27], s67 offen offset:2048  lds
buffer_load_dwordx4 v23, s[24:27], s67 offen offset:3072  lds
s_add_u32 s60, s71, s65
s_add_u32 m0, s60, 0
s_mov_b32 s61, s68
buffer_load_dwordx4 v26, s[28:31], s61 offen lds
buffer_load_dwordx4 v27, s[28:31], s61 offen offset:1024 lds
s_add_u32 m0, s60, 8192
s_add_u32 s61, s61, s53
buffer_load_dwordx4 v26, s[28:31], s61 offen lds
buffer_load_dwordx4 v27, s[28:31], s61 offen offset:1024 lds
s_add_u32 m0, s60, 16384
s_add_u32 s61, s61, s53
buffer_load_dwordx4 v26, s[28:31], s61 offen lds
buffer_load_dwordx4 v27, s[28:31], s61 offen offset:1024 lds
s_add_u32 s49, s76, 2
s_and_b32 s49, s49, 3
s_add_u32 s49, s49, 8
s_mul_i32 s49, s49, 393216
buffer_load_dwordx4 v[40:43], v36, s[28:31], s49 offen
s_add_u32 s65, s65, 40960
s_cmp_eq_u32 s65, 122880
s_cselect_b32 s65, 0, s65
s_add_u32 s64, s64, 1
s_waitcnt vmcnt(11)
s_barrier
s_cmp_lg_u32 s88, 0
s_cbranch_scc1 else_12
global_load_dwordx4 v[108:111], v63, s[12:13] offset:-1024
global_load_dwordx4 v[108:111], v63, s[12:13] offset:0
global_load_dwordx4 v[108:111], v63, s[12:13] offset:1024
global_load_dwordx4 v[108:111], v63, s[12:13] offset:2048
buffer_store_dwordx2 v[56:57], v39, s[32:35], s89 offen sc1
buffer_store_dwordx4 v[56:59], v55, s[32:35], 0 offen sc1
else_12:
s_add_u32 s69, s47, 2
s_and_b32 s69, s69, 3
s_add_u32 s69, s69, 4
s_mul_i32 s67, s69, 128
s_mul_i32 s68, s69, s54
s_add_u32 m0, s70, s65
s_nop 0
buffer_load_dwordx4 v20, s[24:27], s67 offen offset:0  lds
buffer_load_dwordx4 v21, s[24:27], s67 offen offset:1024  lds
buffer_load_dwordx4 v22, s[24:27], s67 offen offset:2048  lds
buffer_load_dwordx4 v23, s[24:27], s67 offen offset:3072  lds
s_add_u32 s60, s71, s65
s_add_u32 m0, s60, 0
s_mov_b32 s61, s68
buffer_load_dwordx4 v26, s[28:31], s61 offen lds
buffer_load_dwordx4 v27, s[28:31], s61 offen offset:1024 lds
s_add_u32 m0, s60, 8192
s_add_u32 s61, s61, s53
buffer_load_dwordx4 v26, s[28:31], s61 offen lds
buffer_load_dwordx4 v27, s[28:31], s61 offen offset:1024 lds
s_add_u32 m0, s60, 16384
s_add_u32 s61, s61, s53
buffer_load_dwordx4 v26, s[28:31], s61 offen lds
buffer_load_dwordx4 v27, s[28:31], s61 offen offset:1024 lds
s_add_u32 s49, s76, 2
s_and_b32 s49, s49, 3
s_add_u32 s49, s49, 12
s_mul_i32 s49, s49, 393216
buffer_load_dwordx4 v[40:43], v36, s[28:31], s49 offen
s_add_u32 s65, s65, 40960
s_cmp_eq_u32 s65, 122880
s_cselect_b32 s65, 0, s65
s_add_u32 s64, s64, 1
s_waitcnt vmcnt(11)
s_barrier
s_cmp_lg_u32 s88, 1
s_cbranch_scc1 else_14
global_load_dwordx4 v[108:111], v63, s[12:13] offset:-1024
global_load_dwordx4 v[108:111], v63, s[12:13] offset:0
global_load_dwordx4 v[108:111], v63, s[12:13] offset:1024
global_load_dwordx4 v[108:111], v63, s[12:13] offset:2048
buffer_store_dwordx2 v[56:57], v39, s[32:35], s89 offen sc1
buffer_store_dwordx4 v[56:59], v55, s[32:35], 0 offen sc1
else_14:
s_add_u32 s69, s47, 2
s_and_b32 s69, s69, 3
s_add_u32 s69, s69, 8
s_mul_i32 s67, s69, 128
s_mul_i32 s68, s69, s54
s_add_u32 m0, s70, s65
s_nop 0
buffer_load_dwordx4 v20, s[24:27], s67 offen offset:0  lds
buffer_load_dwordx4 v21, s[24:27], s67 offen offset:1024  lds
buffer_load_dwordx4 v22, s[24:27], s67 offen offset:2048  lds
buffer_load_dwordx4 v23, s[24:27], s67 offen offset:3072  lds
s_add_u32 s60, s71, s65
s_add_u32 m0, s60, 0
s_mov_b32 s61, s68
buffer_load_dwordx4 v26, s[28:31], s61 offen lds
buffer_load_dwordx4 v27, s[28:31], s61 offen offset:1024 lds
s_add_u32 m0, s60, 8192
s_add_u32 s61, s61, s53
buffer_load_dwordx4 v26, s[28:31], s61 offen lds
buffer_load_dwordx4 v27, s[28:31], s61 offen offset:1024 lds
s_add_u32 m0, s60, 16384
s_add_u32 s61, s61, s53
buffer_load_dwordx4 v26, s[28:31], s61 offen lds
buffer_load_dwordx4 v27, s[28:31], s61 offen offset:1024 lds
s_add_u32 s49, s76, 3
s_and_b32 s49, s49, 3
s_add_u32 s49, s49, 0
s_mul_i32 s49, s49, 393216
buffer_load_dwordx4 v[40:43], v36, s[28:31], s49 offen
s_add_u32 s65, s65, 40960
s_cmp_eq_u32 s65, 122880
s_cselect_b32 s65, 0, s65
s_add_u32 s64, s64, 1
s_waitcnt vmcnt(11)
s_barrier
s_cmp_lg_u32 s88, 2
s_cbranch_scc1 else_16
global_load_dwordx4 v[108:111], v63, s[12:13] offset:-1024
global_load_dwordx4 v[108:111], v63, s[12:13] offset:0
global_load_dwordx4 v[108:111], v63, s[12:13] offset:1024
global_load_dwordx4 v[108:111], v63, s[12:13] offset:2048
buffer_store_dwordx2 v[56:57], v39, s[32:35], s89 offen sc1
buffer_store_dwordx4 v[56:59], v55, s[32:35], 0 offen sc1
else_16:
s_add_u32 s69, s47, 2
s_and_b32 s69, s69, 3
s_add_u32 s69, s69, 12
s_mul_i32 s67, s69, 128
s_mul_i32 s68, s69, s54
s_add_u32 m0, s70, s65
s_nop 0
buffer_load_dwordx4 v20, s[24:27], s67 offen offset:0  lds
buffer_load_dwordx4 v21, s[24:27], s67 offen offset:1024  lds
buffer_load_dwordx4 v22, s[24:27], s67 offen offset:2048  lds
buffer_load_dwordx4 v23, s[24:27], s67 offen offset:3072  lds
s_add_u32 s60, s71, s65
s_add_u32 m0, s60, 0
s_mov_b32 s61, s68
buffer_load_dwordx4 v26, s[28:31], s61 offen lds
buffer_load_dwordx4 v27, s[28:31], s61 offen offset:1024 lds
s_add_u32 m0, s60, 8192
s_add_u32 s61, s61, s53
buffer_load_dwordx4 v26, s[28:31], s61 offen lds
buffer_load_dwordx4 v27, s[28:31], s61 offen offset:1024 lds
s_add_u32 m0, s60, 16384
s_add_u32 s61, s61, s53
buffer_load_dwordx4 v26, s[28:31], s61 offen lds
buffer_load_dwordx4 v27, s[28:31], s61 offen offset:1024 lds
s_add_u32 s49, s76, 3
s_and_b32 s49, s49, 3
s_add_u32 s49, s49, 4
s_mul_i32 s49, s49, 393216
buffer_load_dwordx4 v[40:43], v36, s[28:31], s49 offen
s_add_u32 s65, s65, 40960
s_cmp_eq_u32 s65, 122880
s_cselect_b32 s65, 0, s65
s_add_u32 s64, s64, 1
s_waitcnt vmcnt(11)
s_barrier
s_cmp_lg_u32 s88, 3
s_cbranch_scc1 else_18
global_load_dwordx4 v[108:111], v63, s[12:13] offset:-1024
global_load_dwordx4 v[108:111], v63, s[12:13] offset:0
global_load_dwordx4 v[108:111], v63, s[12:13] offset:1024
global_load_dwordx4 v[108:111], v63, s[12:13] offset:2048
buffer_store_dwordx2 v[56:57], v39, s[32:35], s89 offen sc1
buffer_store_dwordx4 v[56:59], v55, s[32:35], 0 offen sc1
else_18:
s_add_u32 s69, s47, 3
s_and_b32 s69, s69, 3
s_add_u32 s69, s69, 0
s_mul_i32 s67, s69, 128
s_mul_i32 s68, s69, s54
s_add_u32 m0, s70, s65
s_nop 0
buffer_load_dwordx4 v20, s[24:27], s67 offen offset:0  lds
buffer_load_dwordx4 v21, s[24:27], s67 offen offset:1024  lds
buffer_load_dwordx4 v22, s[24:27], s67 offen offset:2048  lds
buffer_load_dwordx4 v23, s[24:27], s67 offen offset:3072  lds
s_add_u32 s60, s71, s65
s_add_u32 m0, s60, 0
s_mov_b32 s61, s68
buffer_load_dwordx4 v26, s[28:31], s61 offen lds
buffer_load_dwordx4 v27, s[28:31], s61 offen offset:1024 lds
s_add_u32 m0, s60, 8192
s_add_u32 s61, s61, s53
buffer_load_dwordx4 v26, s[28:31], s61 offen lds
buffer_load_dwordx4 v27, s[28:31], s61 offen offset:1024 lds
s_add_u32 m0, s60, 16384
s_add_u32 s61, s61, s53
buffer_load_dwordx4 v26, s[28:31], s61 offen lds
buffer_load_dwordx4 v27, s[28:31], s61 offen offset:1024 lds
s_add_u32 s49, s76, 3
s_and_b32 s49, s49, 3
s_add_u32 s49, s49, 8
s_mul_i32 s49, s49, 393216
buffer_load_dwordx4 v[40:43], v36, s[28:31], s49 offen
s_add_u32 s65, s65, 40960
s_cmp_eq_u32 s65, 122880
s_cselect_b32 s65, 0, s65
s_add_u32 s64, s64, 1
s_waitcnt vmcnt(11)
s_barrier
s_add_u32 s69, s47, 3
s_and_b32 s69, s69, 3
s_add_u32 s69, s69, 4
s_mul_i32 s67, s69, 128
s_mul_i32 s68, s69, s54
s_add_u32 m0, s70, s65
s_nop 0
buffer_load_dwordx4 v20, s[24:27], s67 offen offset:0  lds
buffer_load_dwordx4 v21, s[24:27], s67 offen offset:1024  lds
buffer_load_dwordx4 v22, s[24:27], s67 offen offset:2048  lds
buffer_load_dwordx4 v23, s[24:27], s67 offen offset:3072  lds
s_add_u32 s60, s71, s65
s_add_u32 m0, s60, 0
s_mov_b32 s61, s68
buffer_load_dwordx4 v26, s[28:31], s61 offen lds
buffer_load_dwordx4 v27, s[28:31], s61 offen offset:1024 lds
s_add_u32 m0, s60, 8192
s_add_u32 s61, s61, s53
buffer_load_dwordx4 v26, s[28:31], s61 offen lds
buffer_load_dwordx4 v27, s[28:31], s61 offen offset:1024 lds
s_add_u32 m0, s60, 16384
s_add_u32 s61, s61, s53
buffer_load_dwordx4 v26, s[28:31], s61 offen lds
buffer_load_dwordx4 v27, s[28:31], s61 offen offset:1024 lds
s_add_u32 s49, s76, 3
s_and_b32 s49, s49, 3
s_add_u32 s49, s49, 12
s_mul_i32 s49, s49, 393216
buffer_load_dwordx4 v[40:43], v36, s[28:31], s49 offen
s_add_u32 s65, s65, 40960
s_cmp_eq_u32 s65, 122880
s_cselect_b32 s65, 0, s65
s_add_u32 s64, s64, 1
s_waitcnt vmcnt(11)
s_barrier
global_load_dwordx2 v[34:35], v32, s[20:21] sc1
s_add_u32 s69, s47, 3
s_and_b32 s69, s69, 3
s_add_u32 s69, s69, 8
s_mul_i32 s67, s69, 128
s_mul_i32 s68, s69, s54
s_add_u32 m0, s70, s65
s_nop 0
buffer_load_dwordx4 v20, s[24:27], s67 offen offset:0  lds
buffer_load_dwordx4 v21, s[24:27], s67 offen offset:1024  lds
buffer_load_dwordx4 v22, s[24:27], s67 offen offset:2048  lds
buffer_load_dwordx4 v23, s[24:27], s67 offen offset:3072  lds
s_add_u32 s60, s71, s65
s_add_u32 m0, s60, 0
s_mov_b32 s61, s68
buffer_load_dwordx4 v26, s[28:31], s61 offen lds
buffer_load_dwordx4 v27, s[28:31], s61 offen offset:1024 lds
s_add_u32 m0, s60, 8192
s_add_u32 s61, s61, s53
buffer_load_dwordx4 v26, s[28:31], s61 offen lds
buffer_load_dwordx4 v27, s[28:31], s61 offen offset:1024 lds
s_add_u32 m0, s60, 16384
s_add_u32 s61, s61, s53
buffer_load_dwordx4 v26, s[28:31], s61 offen lds
buffer_load_dwordx4 v27, s[28:31], s61 offen offset:1024 lds
s_add_u32 s65, s65, 40960
s_cmp_eq_u32 s65, 122880
s_cselect_b32 s65, 0, s65
s_add_u32 s64, s64, 1
s_waitcnt vmcnt(10)
s_barrier
s_mov_b32 s63, 0
ipoll_20:
v_sad_u8 v4, v34, 0, 0
v_sad_u8 v4, v35, 0, v4
v_cmp_gt_u32 vcc, 32, v4
s_cbranch_vccz ipolled_21
global_load_dwordx2 v[34:35], v32, s[20:21] sc1
s_add_u32 s63, s63, 1
s_cmp_lt_u32 s63, 0x80000
s_waitcnt vmcnt(0)
s_cbranch_scc1 ipoll_20
ipolled_21:
s_add_u32 s69, s47, 3
s_and_b32 s69, s69, 3
s_add_u32 s69, s69, 12
s_mul_i32 s67, s69, 128
s_mul_i32 s68, s69, s54
s_add_u32 m0, s70, 0
s_nop 0
buffer_load_dwordx4 v20, s[24:27], s67 offen offset:0  lds
buffer_load_dwordx4 v21, s[24:27], s67 offen offset:1024  lds
buffer_load_dwordx4 v22, s[24:27], s67 offen offset:2048  lds
buffer_load_dwordx4 v23, s[24:27], s67 offen offset:3072  lds
s_add_u32 s60, s71, 0
s_add_u32 m0, s60, 0
s_mov_b32 s61, s68
buffer_load_dwordx4 v26, s[28:31], s61 offen lds
buffer_load_dwordx4 v27, s[28:31], s61 offen offset:1024 lds
s_add_u32 m0, s60, 8192
s_add_u32 s61, s61, s53
buffer_load_dwordx4 v26, s[28:31], s61 offen lds
buffer_load_dwordx4 v27, s[28:31], s61 offen offset:1024 lds
s_add_u32 m0, s60, 16384
s_add_u32 s61, s61, s53
buffer_load_dwordx4 v26, s[28:31], s61 offen lds
buffer_load_dwordx4 v27, s[28:31], s61 offen offset:1024 lds
s_waitcnt vmcnt(10)
s_barrier
s_setprio 0
buffer_load_dwordx4 v[80:83], v37, s[32:35], 0 offen offset:0 sc1
buffer_load_dwordx4 v[84:87], v37, s[32:35], 0 offen offset:1024 sc1
buffer_load_dwordx4 v[88:91], v37, s[32:35], 0 offen offset:2048 sc1
buffer_load_dwordx4 v[92:95], v37, s[32:35], 0 offen offset:3072 sc1
global_load_dword v48, v54, s[98:99]
buffer_load_dwordx4 v[64:67], v38, s[32:35], 0 offen offset:0 sc1
buffer_load_dwordx4 v[68:71], v38, s[32:35], 0 offen offset:1024 sc1
buffer_load_dwordx4 v[72:75], v38, s[32:35], 0 offen offset:2048 sc1
buffer_load_dwordx4 v[76:79], v38, s[32:35], 0 offen offset:3072 sc1
s_add_u32 s48, s75, 15
s_and_b32 s48, s48, 15
s_mul_i32 s48, s48, s57
s_add_u32 m0, s71, 106496
s_nop 0
buffer_load_dwordx4 v28, s[36:39], s48 offen lds
buffer_load_dwordx4 v29, s[36:39], s48 offen offset:1024 lds
s_waitcnt vmcnt(11)
s_barrier
s_add_u32 s48, s75, 5
s_and_b32 s48, s48, 15
s_mul_i32 s48, s48, s57
s_add_u32 m0, s71, 24576
s_nop 0
buffer_load_dwordx4 v28, s[36:39], s48 offen lds
buffer_load_dwordx4 v29, s[36:39], s48 offen offset:1024 lds
s_waitcnt vmcnt(4)
s_add_u32 s48, s75, 6
s_and_b32 s48, s48, 15
s_mul_i32 s48, s48, s57
s_add_u32 m0, s71, 32768
s_nop 0
buffer_load_dwordx4 v28, s[36:39], s48 offen lds
v_add_f32 v80, v80, v88
v_add_f32 v64, v64, v72
v_add_f32 v81, v81, v89
v_add_f32 v65, v65, v73
v_add_f32 v82, v82, v90
v_add_f32 v66, v66, v74
v_add_f32 v83, v83, v91
v_add_f32 v67, v67, v75
v_add_f32 v84, v84, v92
v_add_f32 v68, v68, v76
buffer_load_dwordx4 v29, s[36:39], s48 offen offset:1024 lds
v_add_f32 v85, v85, v93
v_add_f32 v69, v69, v77
v_add_f32 v86, v86, v94
v_add_f32 v70, v70, v78
v_add_f32 v87, v87, v95
v_add_f32 v71, v71, v79
v_add_f32 v80, v80, v84
v_add_f32 v64, v64, v68
v_add_f32 v81, v81, v85
v_add_f32 v65, v65, v69
s_add_u32 s48, s75, 7
s_and_b32 s48, s48, 15
s_mul_i32 s48, s48, s57
s_add_u32 m0, s71, 40960
s_nop 0
buffer_load_dwordx4 v28, s[36:39], s48 offen lds
v_add_f32 v82, v82, v86
v_add_f32 v66, v66, v70
v_add_f32 v83, v83, v87
v_add_f32 v67, v67, v71
s_nop 1
s_nop 1
v_permlane32_swap_b32 v80, v81
v_permlane32_swap_b32 v64, v65
v_permlane32_swap_b32 v82, v83
buffer_load_dwordx4 v29, s[36:39], s48 offen offset:1024 lds
v_permlane32_swap_b32 v66, v67
v_add_f32 v80, v80, v81
v_add_f32 v64, v64, v65
v_add_f32 v82, v82, v83
v_add_f32 v66, v66, v67
s_nop 1
s_nop 1
v_permlane16_swap_b32 v80, v82
v_permlane16_swap_b32 v64, v66
s_nop 0
s_add_u32 s48, s75, 8
s_and_b32 s48, s48, 15
s_mul_i32 s48, s48, s57
s_add_u32 m0, s71, 49152
s_nop 0
buffer_load_dwordx4 v28, s[36:39], s48 offen lds
s_nop 0
v_add_f32 v80, v80, v82
v_add_f32 v64, v64, v66
v_cmp_u_f32 vcc, v80, v80
s_cbranch_vccnz again_22
summed_23:
v_cmp_u_f32 vcc, v64, v64
s_cbranch_vccnz again_25
summed_26:
v_mul_f32 v44, 0x3a800000, v80
ds_write_b32 v53, v64
v_mov_b32 v45, v44
s_nop 1
v_permlane16_swap_b32 v44, v45
buffer_load_dwordx4 v29, s[36:39], s48 offen offset:1024 lds
s_nop 0
v_fma_f32 v45, -v44, v44, v45
v_max_f32 v45, 0, v45
v_add_f32 v45, 0x3727c5ac, v45
v_rsq_f32 v46, v45
v_sub_f32 v47, 0, v44
ds_write_b32 v50, v47 offset:512
ds_write_b64 v49, v[46:47]
ds_write_b32 v50, v46
s_cmp_lg_u32 s43, 2
s_cbranch_scc1 else_28
s_and_b32 s50, s2, 7
v_readlane_b32 s58, v34, s50
v_readlane_b32 s59, v35, s50
s_lshl_b64 s[48:49], s[94:95], 5
v_mov_b32 v4, 134656
s_nop 1
s_cmp_eq_u64 s[48:49], s[58:59]
s_cselect_b32 s48, 1, 0
v_mov_b32 v5, s48
ds_write_b32 v4, v5
else_28:
s_setprio 0
s_waitcnt lgkmcnt(0)
s_waitcnt vmcnt(63)
s_barrier
s_waitcnt vmcnt(4)
s_add_u32 s48, s75, 9
s_and_b32 s48, s48, 15
s_mul_i32 s48, s48, s57
s_add_u32 m0, s71, 57344
s_nop 0
buffer_load_dwordx4 v28, s[36:39], s48 offen lds
buffer_load_dwordx4 v29, s[36:39], s48 offen offset:1024 lds
s_waitcnt vmcnt(4)
s_add_u32 s48, s75, 10
s_and_b32 s48, s48, 15
s_mul_i32 s48, s48, s57
s_add_u32 m0, s71, 65536
s_nop 0
buffer_load_dwordx4 v28, s[36:39], s48 offen lds
buffer_load_dwordx4 v29, s[36:39], s48 offen offset:1024 lds
s_waitcnt vmcnt(4)
s_add_u32 s48, s75, 11
s_and_b32 s48, s48, 15
s_mul_i32 s48, s48, s57
s_add_u32 m0, s71, 73728
s_nop 0
buffer_load_dwordx4 v28, s[36:39], s48 offen lds
buffer_load_dwordx4 v29, s[36:39], s48 offen offset:1024 lds
s_waitcnt vmcnt(4)
s_add_u32 s48, s75, 12
s_and_b32 s48, s48, 15
s_mul_i32 s48, s48, s57
s_add_u32 m0, s71, 81920
s_nop 0
buffer_load_dwordx4 v28, s[36:39], s48 offen lds
buffer_load_dwordx4 v29, s[36:39], s48 offen offset:1024 lds
s_waitcnt vmcnt(4)
s_add_u32 s48, s75, 13
s_and_b32 s48, s48, 15
s_mul_i32 s48, s48, s57
s_add_u32 m0, s71, 90112
s_nop 0
buffer_load_dwordx4 v28, s[36:39], s48 offen lds
buffer_load_dwordx4 v29, s[36:39], s48 offen offset:1024 lds
s_waitcnt vmcnt(4)
s_add_u32 s48, s75, 14
s_and_b32 s48, s48, 15
s_mul_i32 s48, s48, s57
s_add_u32 m0, s71, 98304
s_nop 0
buffer_load_dwordx4 v28, s[36:39], s48 offen lds
buffer_load_dwordx4 v29, s[36:39], s48 offen offset:1024 lds
s_waitcnt vmcnt(4)
s_add_u32 s48, s75, 0
s_and_b32 s48, s48, 15
s_mul_i32 s48, s48, s57
s_add_u32 m0, s71, 4294950912
s_nop 0
buffer_load_dwordx4 v28, s[36:39], s48 offen lds
buffer_load_dwordx4 v29, s[36:39], s48 offen offset:1024 lds
s_waitcnt vmcnt(4)
s_add_u32 s48, s75, 1
s_and_b32 s48, s48, 15
s_mul_i32 s48, s48, s57
s_add_u32 m0, s71, 4294959104
s_nop 0
buffer_load_dwordx4 v28, s[36:39], s48 offen lds
buffer_load_dwordx4 v29, s[36:39], s48 offen offset:1024 lds
s_waitcnt vmcnt(4)
s_add_u32 s48, s75, 2
s_and_b32 s48, s48, 15
s_mul_i32 s48, s48, s57
s_add_u32 m0, s71, 0
s_nop 0
buffer_load_dwordx4 v28, s[36:39], s48 offen lds
buffer_load_dwordx4 v29, s[36:39], s48 offen offset:1024 lds
s_waitcnt vmcnt(4)
s_add_u32 s48, s75, 3
s_and_b32 s48, s48, 15
s_mul_i32 s48, s48, s57
s_add_u32 m0, s71, 8192
s_nop 0
buffer_load_dwordx4 v28, s[36:39], s48 offen lds
buffer_load_dwordx4 v29, s[36:39], s48 offen offset:1024 lds
s_waitcnt vmcnt(4)
s_add_u32 s48, s75, 4
s_and_b32 s48, s48, 15
s_mul_i32 s48, s48, s57
s_add_u32 m0, s71, 16384
s_nop 0
buffer_load_dwordx4 v28, s[36:39], s48 offen lds
buffer_load_dwordx4 v29, s[36:39], s48 offen offset:1024 lds
s_mov_b32 s28, s12
s_and_b32 s29, s13, 0xffff
s_mov_b32 s30, 6291456
s_mov_b32 s31, 0x00020000
v_mov_b32 v26, v60
v_mov_b32 v27, v61
v_mov_b32 v28, v24
v_mov_b32 v29, v25
s_cmp_ge_i32 s55, 0
s_cselect_b32 s53, 128, s53
s_cselect_b32 s54, 24576, s54
s_cmp_ge_i32 s56, 0
s_cselect_b32 s57, 8192, s57
s_and_b32 s48, s2, 7
s_lshl_b32 s48, s48, 1
s_add_u32 s47, s42, s48
s_and_b32 s47, s47, 15
s_and_b32 s50, s42, 8
s_or_b32 s50, s50, 3
s_and_b32 s48, s2, 7
s_lshl_b32 s48, s48, 1
s_add_u32 s76, s50, s48
s_and_b32 s76, s76, 15
s_add_u32 s69, s47, 0
s_and_b32 s69, s69, 15
s_mul_i32 s67, s69, 128
s_mul_i32 s68, s69, s54
s_waitcnt vmcnt(0) lgkmcnt(0)
s_barrier
s_add_u32 s60, s71, 122880
s_add_u32 m0, s60, 0
s_mov_b32 s61, s68
buffer_load_dwordx4 v26, s[28:31], s61 offen lds
buffer_load_dwordx4 v27, s[28:31], s61 offen offset:1024 lds
s_add_u32 m0, s60, 8192
s_add_u32 s61, s61, s53
buffer_load_dwordx4 v26, s[28:31], s61 offen lds
buffer_load_dwordx4 v27, s[28:31], s61 offen offset:1024 lds
s_add_u32 m0, s60, 16384
s_add_u32 s61, s61, s53
buffer_load_dwordx4 v26, s[28:31], s61 offen lds
buffer_load_dwordx4 v27, s[28:31], s61 offen offset:1024 lds
s_mov_b32 s36, s14
s_and_b32 s37, s15, 0xffff
s_mov_b32 s38, 65536
s_mov_b32 s39, 0x00020000
s_lshl_b32 s48, s42, 12
s_lshl_b32 s49, s43, 10
s_add_u32 s48, s48, s49
s_add_u32 m0, s49, 135168
s_nop 0
buffer_load_dwordx4 v18, s[36:39], s48 offen lds
ds_read_b128 v[232:235], v52 offset:57344
ds_read_b128 v[236:239], v52 offset:58368
ds_read_b128 v[152:155], v51 offset:40960
ds_read_b128 v[156:159], v51 offset:41984
ds_read_b128 v[160:163], v51 offset:49152
ds_read_b128 v[164:167], v51 offset:50176
ds_read_b128 v[168:171], v51 offset:57344
ds_read_b128 v[172:175], v51 offset:58368
ds_read_b128 v[176:179], v52 offset:0
ds_read_b128 v[180:183], v52 offset:1024
ds_read_b128 v[184:187], v52 offset:8192
ds_read_b128 v[188:191], v52 offset:9216
ds_read_b128 v[192:195], v52 offset:16384
ds_read_b128 v[196:199], v52 offset:17408
ds_read_b128 v[200:203], v52 offset:24576
ds_read_b128 v[204:207], v52 offset:25600
ds_read_b128 v[208:211], v52 offset:32768
ds_read_b128 v[212:215], v52 offset:33792
ds_read_b128 v[216:219], v52 offset:40960
ds_read_b128 v[220:223], v52 offset:41984
ds_read_b128 v[224:227], v52 offset:49152
ds_read_b128 v[228:231], v52 offset:50176
ds_read_b128 v[112:115], v51 offset:0
ds_read_b128 v[116:119], v51 offset:1024
ds_read_b128 v[120:123], v51 offset:8192
ds_read_b128 v[124:127], v51 offset:9216
ds_read_b128 v[128:131], v51 offset:16384
ds_read_b128 v[132:135], v51 offset:17408
ds_read_b128 v[136:139], v51 offset:24576
ds_read_b128 v[140:143], v51 offset:25600
ds_read_b128 v[144:147], v51 offset:32768
ds_read_b128 v[148:151], v51 offset:33792
s_add_u32 s48, s80, 0
v_add_u32 v20, s48, v18
v_mov_b32 v21, v20
v_add_u32 v22, 30720, v20
v_mov_b32 v23, v22
v_add_u32 v37, 262144, v37
s_lshl_b32 s50, s42, 2
s_add_u32 s50, s50, s43
s_lshl_b32 s50, s50, 12
s_add_u32 s50, s50, 18087936
v_add_u32 v38, s50, v18
v_min_u32 v4, 2, v3
v_lshlrev_b32 v4, 8, v4
v_lshl_add_u32 v4, v2, 2, v4
s_and_b32 s48, s43, 1
s_lshl_b32 s48, s48, 7
s_lshr_b32 s49, s43, 1
s_lshl_b32 s49, s49, 6
s_add_u32 s48, s48, s49
s_add_u32 s48, s48, 133888
v_add_u32 v53, s48, v4
s_getpc_b64 s[98:99]
pc_30:
s_add_u32 s98, s98, c1_last - pc_30
s_addc_u32 s99, s99, 0
s_lshr_b32 s50, s2, 3
s_lshl_b32 s50, s50, 2
s_add_u32 s50, s50, s43
s_lshl_b32 s50, s50, 7
v_and_b32 v4, 1, v0
v_lshl_add_u32 v4, v4, 6, s50
v_min_u32 v54, L_code_end - c1_last, v4
s_waitcnt vmcnt(0) lgkmcnt(0)
s_add_u32 s69, s47, 1
s_and_b32 s69, s69, 15
s_mul_i32 s67, s69, 2048
s_mul_i32 s68, s69, s54
s_barrier
s_add_u32 s60, s71, 40960
s_add_u32 m0, s60, 0
s_mov_b32 s61, s68
buffer_load_dwordx4 v26, s[28:31], s61 offen lds
buffer_load_dwordx4 v27, s[28:31], s61 offen offset:1024 lds
s_add_u32 m0, s60, 8192
s_add_u32 s61, s61, s53
buffer_load_dwordx4 v26, s[28:31], s61 offen lds
buffer_load_dwordx4 v27, s[28:31], s61 offen offset:1024 lds
s_add_u32 m0, s60, 16384
s_add_u32 s61, s61, s53
buffer_load_dwordx4 v26, s[28:31], s61 offen lds
buffer_load_dwordx4 v27, s[28:31], s61 offen offset:1024 lds
s_add_u32 s49, s76, 2
s_and_b32 s49, s49, 15
s_mul_i32 s49, s49, 393216
buffer_load_dwordx4 v[40:43], v36, s[28:31], s49 offen
s_add_u32 s49, s76, 3
s_and_b32 s49, s49, 15
s_mul_i32 s49, s49, 393216
buffer_load_dwordx4 v[40:43], v36, s[28:31], s49 offen
buffer_load_dword v5, v30, s[32:35], s79 offen sc1
s_mov_b32 s63, 0
s_waitcnt vmcnt(0)
poll_31:
v_cmp_gt_u32 vcc, 1, v5
s_cbranch_vccz polled_32
buffer_load_dword v5, v30, s[32:35], s79 offen sc1
s_add_u32 s63, s63, 1
s_cmp_lt_u32 s63, 0x80000
s_waitcnt vmcnt(0)
s_cbranch_scc1 poll_31
polled_32:
s_add_u32 s69, s47, 0
s_and_b32 s69, s69, 15
s_mul_i32 s67, s69, 2048
s_mul_i32 s68, s69, s54
s_add_u32 m0, s70, 0
s_nop 0
buffer_load_dwordx4 v20, s[32:35], s67 offen offset:0 sc1 lds
buffer_load_dwordx4 v21, s[32:35], s67 offen offset:1024 sc1 lds
buffer_load_dwordx4 v22, s[32:35], s67 offen offset:2048 sc1 lds
buffer_load_dwordx4 v23, s[32:35], s67 offen offset:3072 sc1 lds
s_add_u32 s69, s47, 1
s_and_b32 s69, s69, 15
s_mul_i32 s67, s69, 2048
s_mul_i32 s68, s69, s54
s_add_u32 m0, s70, 40960
s_nop 0
buffer_load_dwordx4 v20, s[32:35], s67 offen offset:0 sc1 lds
buffer_load_dwordx4 v21, s[32:35], s67 offen offset:1024 sc1 lds
buffer_load_dwordx4 v22, s[32:35], s67 offen offset:2048 sc1 lds
buffer_load_dwordx4 v23, s[32:35], s67 offen offset:3072 sc1 lds
s_waitcnt vmcnt(4)
s_barrier
s_add_u32 s69, s47, 2
s_and_b32 s69, s69, 15
s_mul_i32 s67, s69, 2048
s_mul_i32 s68, s69, s54
s_add_u32 m0, s70, 81920
s_nop 0
buffer_load_dwordx4 v20, s[32:35], s67 offen offset:0 sc1 lds
buffer_load_dwordx4 v21, s[32:35], s67 offen offset:1024 sc1 lds
buffer_load_dwordx4 v22, s[32:35], s67 offen offset:2048 sc1 lds
buffer_load_dwordx4 v23, s[32:35], s67 offen offset:3072 sc1 lds
s_add_u32 s60, s71, 81920
s_add_u32 m0, s60, 0
s_mov_b32 s61, s68
buffer_load_dwordx4 v26, s[28:31], s61 offen lds
buffer_load_dwordx4 v27, s[28:31], s61 offen offset:1024 lds
s_add_u32 m0, s60, 8192
s_add_u32 s61, s61, s53
buffer_load_dwordx4 v26, s[28:31], s61 offen lds
buffer_load_dwordx4 v27, s[28:31], s61 offen offset:1024 lds
s_add_u32 m0, s60, 16384
s_add_u32 s61, s61, s53
buffer_load_dwordx4 v26, s[28:31], s61 offen lds
buffer_load_dwordx4 v27, s[28:31], s61 offen offset:1024 lds
s_add_u32 s49, s76, 4
s_and_b32 s49, s49, 15
s_mul_i32 s49, s49, 393216
buffer_load_dwordx4 v[40:43], v36, s[28:31], s49 offen
s_mov_b32 s64, 0
s_mov_b32 s65, 0
h1_loop:
s_waitcnt vmcnt(11)
s_barrier
s_add_u32 s69, s69, 1
s_and_b32 s69, s69, 15
s_mul_i32 s67, s69, 2048
s_mul_i32 s68, s69, s54
s_add_u32 m0, s70, s65
s_nop 0
buffer_load_dwordx4 v20, s[32:35], s67 offen offset:0 sc1 lds
buffer_load_dwordx4 v21, s[32:35], s67 offen offset:1024 sc1 lds
buffer_load_dwordx4 v22, s[32:35], s67 offen offset:2048 sc1 lds
buffer_load_dwordx4 v23, s[32:35], s67 offen offset:3072 sc1 lds
s_add_u32 s60, s71, s65
s_add_u32 m0, s60, 0
s_mov_b32 s61, s68
buffer_load_dwordx4 v26, s[28:31], s61 offen lds
buffer_load_dwordx4 v27, s[28:31], s61 offen offset:1024 lds
s_add_u32 m0, s60, 8192
s_add_u32 s61, s61, s53
buffer_load_dwordx4 v26, s[28:31], s61 offen lds
buffer_load_dwordx4 v27, s[28:31], s61 offen offset:1024 lds
s_add_u32 m0, s60, 16384
s_add_u32 s61, s61, s53
buffer_load_dwordx4 v26, s[28:31], s61 offen lds
buffer_load_dwordx4 v27, s[28:31], s61 offen offset:1024 lds
s_add_u32 s48, s64, 5
s_min_u32 s48, s48, 15
s_add_u32 s49, s48, s76
s_and_b32 s49, s49, 15
s_mul_i32 s49, s49, 393216
buffer_load_dwordx4 v[40:43], v36, s[28:31], s49 offen
s_add_u32 s65, s65, 40960
s_cmp_eq_u32 s65, 122880
s_cselect_b32 s65, 0, s65
s_add_u32 s64, s64, 1
s_cmp_lt_u32 s64, 11
s_cbranch_scc1 h1_loop
s_waitcnt vmcnt(11)
s_barrier
s_add_u32 s69, s47, 14
s_and_b32 s69, s69, 15
s_mul_i32 s67, s69, 2048
s_mul_i32 s68, s69, s54
s_add_u32 m0, s70, s65
s_nop 0
buffer_load_dwordx4 v20, s[32:35], s67 offen offset:0 sc1 lds
buffer_load_dwordx4 v21, s[32:35], s67 offen offset:1024 sc1 lds
buffer_load_dwordx4 v22, s[32:35], s67 offen offset:2048 sc1 lds
buffer_load_dwordx4 v23, s[32:35], s67 offen offset:3072 sc1 lds
s_add_u32 s60, s71, s65
s_add_u32 m0, s60, 0
s_mov_b32 s61, s68
buffer_load_dwordx4 v26, s[28:31], s61 offen lds
buffer_load_dwordx4 v27, s[28:31], s61 offen offset:1024 lds
s_add_u32 m0, s60, 8192
s_add_u32 s61, s61, s53
buffer_load_dwordx4 v26, s[28:31], s61 offen lds
buffer_load_dwordx4 v27, s[28:31], s61 offen offset:1024 lds
s_add_u32 m0, s60, 16384
s_add_u32 s61, s61, s53
buffer_load_dwordx4 v26, s[28:31], s61 offen lds
buffer_load_dwordx4 v27, s[28:31], s61 offen offset:1024 lds
s_add_u32 s65, s65, 40960
s_cmp_eq_u32 s65, 122880
s_cselect_b32 s65, 0, s65
s_add_u32 s64, s64, 1
s_mov_b32 s36, s16
s_and_b32 s37, s17, 0xffff
s_mov_b32 s38, 2097152
s_mov_b32 s39, 0x00020000
s_waitcnt vmcnt(10)
s_barrier
s_add_u32 s69, s47, 15
s_and_b32 s69, s69, 15
s_mul_i32 s67, s69, 2048
s_mul_i32 s68, s69, s54
s_add_u32 m0, s70, 0
s_nop 0
buffer_load_dwordx4 v20, s[32:35], s67 offen offset:0 sc1 lds
buffer_load_dwordx4 v21, s[32:35], s67 offen offset:1024 sc1 lds
buffer_load_dwordx4 v22, s[32:35], s67 offen offset:2048 sc1 lds
buffer_load_dwordx4 v23, s[32:35], s67 offen offset:3072 sc1 lds
s_add_u32 s60, s71, 0
s_add_u32 m0, s60, 0
s_mov_b32 s61, s68
buffer_load_dwordx4 v26, s[28:31], s61 offen lds
buffer_load_dwordx4 v27, s[28:31], s61 offen offset:1024 lds
s_add_u32 m0, s60, 8192
s_add_u32 s61, s61, s53
buffer_load_dwordx4 v26, s[28:31], s61 offen lds
buffer_load_dwordx4 v27, s[28:31], s61 offen offset:1024 lds
s_add_u32 m0, s60, 16384
s_add_u32 s61, s61, s53
buffer_load_dwordx4 v26, s[28:31], s61 offen lds
buffer_load_dwordx4 v27, s[28:31], s61 offen offset:1024 lds
s_waitcnt vmcnt(10)
s_barrier
s_setprio 0
buffer_load_dwordx4 v[80:83], v37, s[32:35], 0 offen offset:0 sc1
buffer_load_dwordx4 v[84:87], v37, s[32:35], 0 offen offset:1024 sc1
buffer_load_dwordx4 v[88:91], v37, s[32:35], 0 offen offset:2048 sc1
buffer_load_dwordx4 v[92:95], v37, s[32:35], 0 offen offset:3072 sc1
global_load_dword v48, v54, s[98:99]
buffer_load_dwordx4 v[64:67], v38, s[32:35], 0 offen offset:0 sc1
buffer_load_dwordx4 v[68:71], v38, s[32:35], 0 offen offset:1024 sc1
buffer_load_dwordx4 v[72:75], v38, s[32:35], 0 offen offset:2048 sc1
buffer_load_dwordx4 v[76:79], v38, s[32:35], 0 offen offset:3072 sc1
s_add_u32 s48, s75, 15
s_and_b32 s48, s48, 15
s_mul_i32 s48, s48, s57
s_add_u32 m0, s71, 106496
s_nop 0
buffer_load_dwordx4 v28, s[36:39], s48 offen lds
buffer_load_dwordx4 v29, s[36:39], s48 offen offset:1024 lds
s_waitcnt vmcnt(11)
s_barrier
s_add_u32 s48, s75, 5
s_and_b32 s48, s48, 15
s_mul_i32 s48, s48, s57
s_add_u32 m0, s71, 24576
s_nop 0
buffer_load_dwordx4 v28, s[36:39], s48 offen lds
buffer_load_dwordx4 v29, s[36:39], s48 offen offset:1024 lds
s_waitcnt vmcnt(4)
s_add_u32 s48, s75, 6
s_and_b32 s48, s48, 15
s_mul_i32 s48, s48, s57
s_add_u32 m0, s71, 32768
s_nop 0
buffer_load_dwordx4 v28, s[36:39], s48 offen lds
v_add_f32 v80, v80, v88
v_add_f32 v64, v64, v72
v_add_f32 v81, v81, v89
v_add_f32 v65, v65, v73
v_add_f32 v82, v82, v90
v_add_f32 v66, v66, v74
v_add_f32 v83, v83, v91
v_add_f32 v67, v67, v75
v_add_f32 v84, v84, v92
v_add_f32 v68, v68, v76
buffer_load_dwordx4 v29, s[36:39], s48 offen offset:1024 lds
v_add_f32 v85, v85, v93
v_add_f32 v69, v69, v77
v_add_f32 v86, v86, v94
v_add_f32 v70, v70, v78
v_add_f32 v87, v87, v95
v_add_f32 v71, v71, v79
v_add_f32 v80, v80, v84
v_add_f32 v64, v64, v68
v_add_f32 v81, v81, v85
v_add_f32 v65, v65, v69
s_add_u32 s48, s75, 7
s_and_b32 s48, s48, 15
s_mul_i32 s48, s48, s57
s_add_u32 m0, s71, 40960
s_nop 0
buffer_load_dwordx4 v28, s[36:39], s48 offen lds
v_add_f32 v82, v82, v86
v_add_f32 v66, v66, v70
v_add_f32 v83, v83, v87
v_add_f32 v67, v67, v71
s_nop 1
s_nop 1
v_permlane32_swap_b32 v80, v81
v_permlane32_swap_b32 v64, v65
v_permlane32_swap_b32 v82, v83
buffer_load_dwordx4 v29, s[36:39], s48 offen offset:1024 lds
v_permlane32_swap_b32 v66, v67
v_add_f32 v80, v80, v81
v_add_f32 v64, v64, v65
v_add_f32 v82, v82, v83
v_add_f32 v66, v66, v67
s_nop 1
s_nop 1
v_permlane16_swap_b32 v80, v82
v_permlane16_swap_b32 v64, v66
s_nop 0
s_add_u32 s48, s75, 8
s_and_b32 s48, s48, 15
s_mul_i32 s48, s48, s57
s_add_u32 m0, s71, 49152
s_nop 0
buffer_load_dwordx4 v28, s[36:39], s48 offen lds
s_nop 0
v_add_f32 v80, v80, v82
v_add_f32 v64, v64, v66
v_cmp_u_f32 vcc, v80, v80
s_cbranch_vccnz again_33
summed_34:
v_cmp_u_f32 vcc, v64, v64
s_cbranch_vccnz again_36
summed_37:
v_mul_f32 v44, 0x3a800000, v80
ds_write_b32 v53, v64
v_mov_b32 v45, v44
s_nop 1
v_permlane16_swap_b32 v44, v45
buffer_load_dwordx4 v29, s[36:39], s48 offen offset:1024 lds
s_nop 0
v_fma_f32 v45, -v44, v44, v45
v_max_f32 v45, 0, v45
v_add_f32 v45, 0x3727c5ac, v45
v_rsq_f32 v46, v45
v_sub_f32 v47, 0, v44
ds_write_b32 v50, v47 offset:512
ds_write_b64 v49, v[46:47]
ds_write_b32 v50, v46
s_setprio 0
s_waitcnt lgkmcnt(0)
s_waitcnt vmcnt(63)
s_barrier
s_waitcnt vmcnt(4)
s_add_u32 s48, s75, 9
s_and_b32 s48, s48, 15
s_mul_i32 s48, s48, s57
s_add_u32 m0, s71, 57344
s_nop 0
buffer_load_dwordx4 v28, s[36:39], s48 offen lds
buffer_load_dwordx4 v29, s[36:39], s48 offen offset:1024 lds
s_waitcnt vmcnt(4)
s_add_u32 s48, s75, 10
s_and_b32 s48, s48, 15
s_mul_i32 s48, s48, s57
s_add_u32 m0, s71, 65536
s_nop 0
buffer_load_dwordx4 v28, s[36:39], s48 offen lds
buffer_load_dwordx4 v29, s[36:39], s48 offen offset:1024 lds
s_waitcnt vmcnt(4)
s_add_u32 s48, s75, 11
s_and_b32 s48, s48, 15
s_mul_i32 s48, s48, s57
s_add_u32 m0, s71, 73728
s_nop 0
buffer_load_dwordx4 v28, s[36:39], s48 offen lds
buffer_load_dwordx4 v29, s[36:39], s48 offen offset:1024 lds
s_waitcnt vmcnt(4)
s_add_u32 s48, s75, 12
s_and_b32 s48, s48, 15
s_mul_i32 s48, s48, s57
s_add_u32 m0, s71, 81920
s_nop 0
buffer_load_dwordx4 v28, s[36:39], s48 offen lds
buffer_load_dwordx4 v29, s[36:39], s48 offen offset:1024 lds
s_waitcnt vmcnt(4)
s_add_u32 s48, s75, 13
s_and_b32 s48, s48, 15
s_mul_i32 s48, s48, s57
s_add_u32 m0, s71, 90112
s_nop 0
buffer_load_dwordx4 v28, s[36:39], s48 offen lds
buffer_load_dwordx4 v29, s[36:39], s48 offen offset:1024 lds
s_waitcnt vmcnt(4)
s_add_u32 s48, s75, 14
s_and_b32 s48, s48, 15
s_mul_i32 s48, s48, s57
s_add_u32 m0, s71, 98304
s_nop 0
buffer_load_dwordx4 v28, s[36:39], s48 offen lds
buffer_load_dwordx4 v29, s[36:39], s48 offen offset:1024 lds
s_waitcnt vmcnt(4)
s_add_u32 s48, s75, 0
s_and_b32 s48, s48, 15
s_mul_i32 s48, s48, s57
s_add_u32 m0, s71, 4294950912
s_nop 0
buffer_load_dwordx4 v28, s[36:39], s48 offen lds
buffer_load_dwordx4 v29, s[36:39], s48 offen offset:1024 lds
s_waitcnt vmcnt(4)
s_add_u32 s48, s75, 1
s_and_b32 s48, s48, 15
s_mul_i32 s48, s48, s57
s_add_u32 m0, s71, 4294959104
s_nop 0
buffer_load_dwordx4 v28, s[36:39], s48 offen lds
buffer_load_dwordx4 v29, s[36:39], s48 offen offset:1024 lds
s_waitcnt vmcnt(4)
s_add_u32 s48, s75, 2
s_and_b32 s48, s48, 15
s_mul_i32 s48, s48, s57
s_add_u32 m0, s71, 0
s_nop 0
buffer_load_dwordx4 v28, s[36:39], s48 offen lds
buffer_load_dwordx4 v29, s[36:39], s48 offen offset:1024 lds
s_waitcnt vmcnt(4)
s_add_u32 s48, s75, 3
s_and_b32 s48, s48, 15
s_mul_i32 s48, s48, s57
s_add_u32 m0, s71, 8192
s_nop 0
buffer_load_dwordx4 v28, s[36:39], s48 offen lds
buffer_load_dwordx4 v29, s[36:39], s48 offen offset:1024 lds
s_waitcnt vmcnt(4)
s_add_u32 s48, s75, 4
s_and_b32 s48, s48, 15
s_mul_i32 s48, s48, s57
s_add_u32 m0, s71, 16384
s_nop 0
buffer_load_dwordx4 v28, s[36:39], s48 offen lds
buffer_load_dwordx4 v29, s[36:39], s48 offen offset:1024 lds
s_waitcnt vmcnt(4)
buffer_load_dwordx4 v[96:99], v18, s[32:35], s81 offen offset:0 sc1
buffer_load_dwordx4 v[100:103], v18, s[32:35], s81 offen offset:1024 sc1
s_waitcnt vmcnt(4)
buffer_load_dwordx4 v[104:107], v18, s[32:35], s82 offen offset:0 sc1
buffer_load_dwordx4 v[108:111], v18, s[32:35], s82 offen offset:1024 sc1
s_mov_b32 s28, s6
s_and_b32 s29, s7, 0xffff
s_mov_b32 s30, 6291456
s_mov_b32 s31, 0x00020000
s_add_u32 s69, s47, 0
s_and_b32 s69, s69, 15
s_mul_i32 s67, s69, 2048
s_mul_i32 s68, s69, s54
s_waitcnt vmcnt(0) lgkmcnt(0)
s_barrier
s_add_u32 s60, s71, 122880
s_add_u32 m0, s60, 0
s_mov_b32 s61, s68
buffer_load_dwordx4 v26, s[28:31], s61 offen lds
buffer_load_dwordx4 v27, s[28:31], s61 offen offset:1024 lds
s_add_u32 m0, s60, 8192
s_add_u32 s61, s61, s53
buffer_load_dwordx4 v26, s[28:31], s61 offen lds
buffer_load_dwordx4 v27, s[28:31], s61 offen offset:1024 lds
s_add_u32 m0, s60, 16384
s_add_u32 s61, s61, s53
buffer_load_dwordx4 v26, s[28:31], s61 offen lds
buffer_load_dwordx4 v27, s[28:31], s61 offen offset:1024 lds
v_add_u32 v37, 262144, v37
s_getpc_b64 s[98:99]
pc_39:
s_add_u32 s98, s98, c2_last - pc_39
s_addc_u32 s99, s99, 0
s_lshr_b32 s50, s2, 3
s_lshl_b32 s50, s50, 2
s_add_u32 s50, s50, s43
s_lshl_b32 s50, s50, 7
v_and_b32 v4, 1, v0
v_lshl_add_u32 v4, v4, 6, s50
v_min_u32 v54, L_code_end - c2_last, v4
s_waitcnt vmcnt(0) lgkmcnt(0)
s_add_u32 s69, s47, 1
s_and_b32 s69, s69, 15
s_mul_i32 s67, s69, 2048
s_mul_i32 s68, s69, s54
s_barrier
s_add_u32 s60, s71, 40960
s_add_u32 m0, s60, 0
s_mov_b32 s61, s68
buffer_load_dwordx4 v26, s[28:31], s61 offen lds
buffer_load_dwordx4 v27, s[28:31], s61 offen offset:1024 lds
s_add_u32 m0, s60, 8192
s_add_u32 s61, s61, s53
buffer_load_dwordx4 v26, s[28:31], s61 offen lds
buffer_load_dwordx4 v27, s[28:31], s61 offen offset:1024 lds
s_add_u32 m0, s60, 16384
s_add_u32 s61, s61, s53
buffer_load_dwordx4 v26, s[28:31], s61 offen lds
buffer_load_dwordx4 v27, s[28:31], s61 offen offset:1024 lds
s_add_u32 s49, s76, 2
s_and_b32 s49, s49, 15
s_mul_i32 s49, s49, 393216
buffer_load_dwordx4 v[40:43], v36, s[28:31], s49 offen
s_add_u32 s49, s76, 3
s_and_b32 s49, s49, 15
s_mul_i32 s49, s49, 393216
buffer_load_dwordx4 v[40:43], v36, s[28:31], s49 offen
buffer_load_dword v5, v30, s[32:35], s79 offen sc1
s_mov_b32 s63, 0
s_waitcnt vmcnt(0)
poll_40:
v_cmp_gt_u32 vcc, 2, v5
s_cbranch_vccz polled_41
buffer_load_dword v5, v30, s[32:35], s79 offen sc1
s_add_u32 s63, s63, 1
s_cmp_lt_u32 s63, 0x80000
s_waitcnt vmcnt(0)
s_cbranch_scc1 poll_40
polled_41:
s_add_u32 s69, s47, 0
s_and_b32 s69, s69, 15
s_mul_i32 s67, s69, 2048
s_mul_i32 s68, s69, s54
s_add_u32 m0, s70, 0
s_nop 0
buffer_load_dwordx4 v20, s[32:35], s67 offen offset:0 sc1 lds
buffer_load_dwordx4 v21, s[32:35], s67 offen offset:1024 sc1 lds
buffer_load_dwordx4 v22, s[32:35], s67 offen offset:2048 sc1 lds
buffer_load_dwordx4 v23, s[32:35], s67 offen offset:3072 sc1 lds
s_add_u32 s69, s47, 1
s_and_b32 s69, s69, 15
s_mul_i32 s67, s69, 2048
s_mul_i32 s68, s69, s54
s_add_u32 m0, s70, 40960
s_nop 0
buffer_load_dwordx4 v20, s[32:35], s67 offen offset:0 sc1 lds
buffer_load_dwordx4 v21, s[32:35], s67 offen offset:1024 sc1 lds
buffer_load_dwordx4 v22, s[32:35], s67 offen offset:2048 sc1 lds
buffer_load_dwordx4 v23, s[32:35], s67 offen offset:3072 sc1 lds
s_waitcnt vmcnt(4)
s_barrier
s_add_u32 s69, s47, 2
s_and_b32 s69, s69, 15
s_mul_i32 s67, s69, 2048
s_mul_i32 s68, s69, s54
s_add_u32 m0, s70, 81920
s_nop 0
buffer_load_dwordx4 v20, s[32:35], s67 offen offset:0 sc1 lds
buffer_load_dwordx4 v21, s[32:35], s67 offen offset:1024 sc1 lds
buffer_load_dwordx4 v22, s[32:35], s67 offen offset:2048 sc1 lds
buffer_load_dwordx4 v23, s[32:35], s67 offen offset:3072 sc1 lds
s_add_u32 s60, s71, 81920
s_add_u32 m0, s60, 0
s_mov_b32 s61, s68
buffer_load_dwordx4 v26, s[28:31], s61 offen lds
buffer_load_dwordx4 v27, s[28:31], s61 offen offset:1024 lds
s_add_u32 m0, s60, 8192
s_add_u32 s61, s61, s53
buffer_load_dwordx4 v26, s[28:31], s61 offen lds
buffer_load_dwordx4 v27, s[28:31], s61 offen offset:1024 lds
s_add_u32 m0, s60, 16384
s_add_u32 s61, s61, s53
buffer_load_dwordx4 v26, s[28:31], s61 offen lds
buffer_load_dwordx4 v27, s[28:31], s61 offen offset:1024 lds
s_add_u32 s49, s76, 4
s_and_b32 s49, s49, 15
s_mul_i32 s49, s49, 393216
buffer_load_dwordx4 v[40:43], v36, s[28:31], s49 offen
s_mov_b32 s64, 0
s_mov_b32 s65, 0
h2_loop:
s_waitcnt vmcnt(11)
s_barrier
s_add_u32 s69, s69, 1
s_and_b32 s69, s69, 15
s_mul_i32 s67, s69, 2048
s_mul_i32 s68, s69, s54
s_add_u32 m0, s70, s65
s_nop 0
buffer_load_dwordx4 v20, s[32:35], s67 offen offset:0 sc1 lds
buffer_load_dwordx4 v21, s[32:35], s67 offen offset:1024 sc1 lds
buffer_load_dwordx4 v22, s[32:35], s67 offen offset:2048 sc1 lds
buffer_load_dwordx4 v23, s[32:35], s67 offen offset:3072 sc1 lds
s_add_u32 s60, s71, s65
s_add_u32 m0, s60, 0
s_mov_b32 s61, s68
buffer_load_dwordx4 v26, s[28:31], s61 offen lds
buffer_load_dwordx4 v27, s[28:31], s61 offen offset:1024 lds
s_add_u32 m0, s60, 8192
s_add_u32 s61, s61, s53
buffer_load_dwordx4 v26, s[28:31], s61 offen lds
buffer_load_dwordx4 v27, s[28:31], s61 offen offset:1024 lds
s_add_u32 m0, s60, 16384
s_add_u32 s61, s61, s53
buffer_load_dwordx4 v26, s[28:31], s61 offen lds
buffer_load_dwordx4 v27, s[28:31], s61 offen offset:1024 lds
s_add_u32 s48, s64, 5
s_min_u32 s48, s48, 15
s_add_u32 s49, s48, s76
s_and_b32 s49, s49, 15
s_mul_i32 s49, s49, 393216
buffer_load_dwordx4 v[40:43], v36, s[28:31], s49 offen
s_add_u32 s65, s65, 40960
s_cmp_eq_u32 s65, 122880
s_cselect_b32 s65, 0, s65
s_add_u32 s64, s64, 1
s_cmp_lt_u32 s64, 11
s_cbranch_scc1 h2_loop
s_waitcnt vmcnt(11)
s_barrier
s_add_u32 s69, s47, 14
s_and_b32 s69, s69, 15
s_mul_i32 s67, s69, 2048
s_mul_i32 s68, s69, s54
s_add_u32 m0, s70, s65
s_nop 0
buffer_load_dwordx4 v20, s[32:35], s67 offen offset:0 sc1 lds
buffer_load_dwordx4 v21, s[32:35], s67 offen offset:1024 sc1 lds
buffer_load_dwordx4 v22, s[32:35], s67 offen offset:2048 sc1 lds
buffer_load_dwordx4 v23, s[32:35], s67 offen offset:3072 sc1 lds
s_add_u32 s60, s71, s65
s_add_u32 m0, s60, 0
s_mov_b32 s61, s68
buffer_load_dwordx4 v26, s[28:31], s61 offen lds
buffer_load_dwordx4 v27, s[28:31], s61 offen offset:1024 lds
s_add_u32 m0, s60, 8192
s_add_u32 s61, s61, s53
buffer_load_dwordx4 v26, s[28:31], s61 offen lds
buffer_load_dwordx4 v27, s[28:31], s61 offen offset:1024 lds
s_add_u32 m0, s60, 16384
s_add_u32 s61, s61, s53
buffer_load_dwordx4 v26, s[28:31], s61 offen lds
buffer_load_dwordx4 v27, s[28:31], s61 offen offset:1024 lds
s_add_u32 s65, s65, 40960
s_cmp_eq_u32 s65, 122880
s_cselect_b32 s65, 0, s65
s_add_u32 s64, s64, 1
s_mov_b32 s36, s12
s_and_b32 s37, s13, 0xffff
s_mov_b32 s38, 6291456
s_mov_b32 s39, 0x00020000
s_waitcnt vmcnt(10)
s_barrier
s_add_u32 s69, s47, 15
s_and_b32 s69, s69, 15
s_mul_i32 s67, s69, 2048
s_mul_i32 s68, s69, s54
s_add_u32 m0, s70, 0
s_nop 0
buffer_load_dwordx4 v20, s[32:35], s67 offen offset:0 sc1 lds
buffer_load_dwordx4 v21, s[32:35], s67 offen offset:1024 sc1 lds
buffer_load_dwordx4 v22, s[32:35], s67 offen offset:2048 sc1 lds
buffer_load_dwordx4 v23, s[32:35], s67 offen offset:3072 sc1 lds
s_add_u32 s60, s71, 0
s_add_u32 m0, s60, 0
s_mov_b32 s61, s68
buffer_load_dwordx4 v26, s[28:31], s61 offen lds
buffer_load_dwordx4 v27, s[28:31], s61 offen offset:1024 lds
s_add_u32 m0, s60, 8192
s_add_u32 s61, s61, s53
buffer_load_dwordx4 v26, s[28:31], s61 offen lds
buffer_load_dwordx4 v27, s[28:31], s61 offen offset:1024 lds
s_add_u32 m0, s60, 16384
s_add_u32 s61, s61, s53
buffer_load_dwordx4 v26, s[28:31], s61 offen lds
buffer_load_dwordx4 v27, s[28:31], s61 offen offset:1024 lds
s_waitcnt vmcnt(10)
s_barrier
s_setprio 0
buffer_load_dwordx4 v[80:83], v37, s[32:35], 0 offen offset:0 sc1
buffer_load_dwordx4 v[84:87], v37, s[32:35], 0 offen offset:1024 sc1
buffer_load_dwordx4 v[88:91], v37, s[32:35], 0 offen offset:2048 sc1
buffer_load_dwordx4 v[92:95], v37, s[32:35], 0 offen offset:3072 sc1
global_load_dword v48, v54, s[98:99]
s_add_u32 s69, s47, 0
s_and_b32 s69, s69, 15
s_mul_i32 s67, s69, 2048
s_mul_i32 s68, s69, s54
s_add_u32 s60, s71, 122880
s_add_u32 m0, s60, 0
s_mov_b32 s61, s68
buffer_load_dwordx4 v26, s[36:39], s61 offen lds
buffer_load_dwordx4 v27, s[36:39], s61 offen offset:1024 lds
s_add_u32 m0, s60, 8192
s_add_u32 s61, s61, s53
buffer_load_dwordx4 v26, s[36:39], s61 offen lds
buffer_load_dwordx4 v27, s[36:39], s61 offen offset:1024 lds
s_add_u32 m0, s60, 16384
s_add_u32 s61, s61, s53
buffer_load_dwordx4 v26, s[36:39], s61 offen lds
buffer_load_dwordx4 v27, s[36:39], s61 offen offset:1024 lds
s_waitcnt vmcnt(11)
s_barrier
s_waitcnt vmcnt(7)
buffer_store_dwordx4 v[56:59], v18, s[32:35], s86 offen offset:0 sc1
v_add_f32 v80, v80, v88
v_add_f32 v81, v81, v89
v_add_f32 v82, v82, v90
v_add_f32 v83, v83, v91
v_add_f32 v84, v84, v92
v_add_f32 v85, v85, v93
v_add_f32 v86, v86, v94
buffer_store_dwordx4 v[56:59], v18, s[32:35], s86 offen offset:1024 sc1
v_add_f32 v87, v87, v95
v_add_f32 v80, v80, v84
v_add_f32 v81, v81, v85
v_add_f32 v82, v82, v86
v_add_f32 v83, v83, v87
s_nop 1
buffer_load_dwordx4 v[96:99], v18, s[32:35], s81 offen offset:0 sc1
v_permlane32_swap_b32 v80, v81
v_permlane32_swap_b32 v82, v83
v_add_f32 v80, v80, v81
v_add_f32 v82, v82, v83
s_nop 1
v_permlane16_swap_b32 v80, v82
buffer_load_dwordx4 v[100:103], v18, s[32:35], s81 offen offset:1024 sc1
s_nop 0
v_add_f32 v80, v80, v82
v_cmp_u_f32 vcc, v80, v80
s_cbranch_vccnz again_42
summed_43:
v_mul_f32 v44, 0x3a800000, v80
buffer_load_dwordx4 v[104:107], v18, s[32:35], s82 offen offset:0 sc1
v_mov_b32 v45, v44
s_nop 1
v_permlane16_swap_b32 v44, v45
s_nop 0
v_fma_f32 v45, -v44, v44, v45
v_max_f32 v45, 0, v45
buffer_load_dwordx4 v[108:111], v18, s[32:35], s82 offen offset:1024 sc1
v_add_f32 v45, 0x3727c5ac, v45
v_rsq_f32 v46, v45
v_sub_f32 v47, 0, v44
ds_write_b32 v50, v47 offset:512
ds_write_b64 v49, v[46:47]
ds_write_b32 v50, v46
s_setprio 0
s_waitcnt lgkmcnt(0)
s_waitcnt vmcnt(63)
s_barrier
ds_write_b128 v52, v[232:235] offset:57344
ds_write_b128 v52, v[236:239] offset:58368
ds_write_b128 v51, v[152:155] offset:40960
ds_write_b128 v51, v[156:159] offset:41984
ds_write_b128 v51, v[160:163] offset:49152
ds_write_b128 v51, v[164:167] offset:50176
ds_write_b128 v51, v[168:171] offset:57344
ds_write_b128 v51, v[172:175] offset:58368
ds_write_b128 v52, v[176:179] offset:0
ds_write_b128 v52, v[180:183] offset:1024
ds_write_b128 v52, v[184:187] offset:8192
ds_write_b128 v52, v[188:191] offset:9216
ds_write_b128 v52, v[192:195] offset:16384
ds_write_b128 v52, v[196:199] offset:17408
ds_write_b128 v52, v[200:203] offset:24576
ds_write_b128 v52, v[204:207] offset:25600
ds_write_b128 v52, v[208:211] offset:32768
ds_write_b128 v52, v[212:215] offset:33792
ds_write_b128 v52, v[216:219] offset:40960
ds_write_b128 v52, v[220:223] offset:41984
ds_write_b128 v52, v[224:227] offset:49152
ds_write_b128 v52, v[228:231] offset:50176
ds_write_b128 v51, v[112:115] offset:0
ds_write_b128 v51, v[116:119] offset:1024
ds_write_b128 v51, v[120:123] offset:8192
ds_write_b128 v51, v[124:127] offset:9216
ds_write_b128 v51, v[128:131] offset:16384
ds_write_b128 v51, v[132:135] offset:17408
ds_write_b128 v51, v[136:139] offset:24576
ds_write_b128 v51, v[140:143] offset:25600
ds_write_b128 v51, v[144:147] offset:32768
ds_write_b128 v51, v[148:151] offset:33792
s_mov_b32 s28, s12
s_and_b32 s29, s13, 0xffff
s_mov_b32 s30, 6291456
s_mov_b32 s31, 0x00020000
s_add_u32 s69, s47, 0
s_and_b32 s69, s69, 15
s_mul_i32 s67, s69, 2048
s_mul_i32 s68, s69, s54
s_waitcnt vmcnt(0) lgkmcnt(0)
s_barrier
s_mov_b32 s36, s14
s_and_b32 s37, s15, 0xffff
s_mov_b32 s38, 65536
s_mov_b32 s39, 0x00020000
s_lshl_b32 s48, s42, 12
s_lshl_b32 s49, s43, 10
s_add_u32 s48, s48, s49
s_add_u32 m0, s49, 135168
s_nop 0
buffer_load_dwordx4 v18, s[36:39], s48 offen lds
v_add_u32 v37, 262144, v37
s_getpc_b64 s[98:99]
pc_45:
s_add_u32 s98, s98, c3_last - pc_45
s_addc_u32 s99, s99, 0
s_lshr_b32 s50, s2, 3
s_lshl_b32 s50, s50, 2
s_add_u32 s50, s50, s43
s_lshl_b32 s50, s50, 7
v_and_b32 v4, 1, v0
v_lshl_add_u32 v4, v4, 6, s50
v_min_u32 v54, L_code_end - c3_last, v4
s_lshl_b32 s83, s41, 2
s_add_u32 s83, s83, 0
s_lshl_b32 s83, s83, 7
s_add_u32 s83, s83, 18350080
s_cmp_lg_u32 s43, 0
s_cbranch_scc1 else_46
buffer_load_dword v5, v30, s[32:35], s83 offen sc1
s_mov_b32 s63, 0
s_waitcnt vmcnt(0)
poll_48:
v_cmp_gt_u32 vcc, 3, v5
s_cbranch_vccz polled_49
buffer_load_dword v5, v30, s[32:35], s83 offen sc1
s_add_u32 s63, s63, 1
s_cmp_lt_u32 s63, 0x80000
s_waitcnt vmcnt(0)
s_cbranch_scc1 poll_48
polled_49:
s_mov_b64 exec, 1
buffer_store_dword v13, v12, s[32:35], s73 offen sc1
s_mov_b64 exec, -1
else_46:
s_waitcnt vmcnt(0) lgkmcnt(0)
s_add_u32 s69, s47, 1
s_and_b32 s69, s69, 15
s_mul_i32 s67, s69, 2048
s_mul_i32 s68, s69, s54
s_barrier
s_add_u32 s60, s71, 40960
s_add_u32 m0, s60, 0
s_mov_b32 s61, s68
buffer_load_dwordx4 v26, s[28:31], s61 offen lds
buffer_load_dwordx4 v27, s[28:31], s61 offen offset:1024 lds
s_add_u32 m0, s60, 8192
s_add_u32 s61, s61, s53
buffer_load_dwordx4 v26, s[28:31], s61 offen lds
buffer_load_dwordx4 v27, s[28:31], s61 offen offset:1024 lds
s_add_u32 m0, s60, 16384
s_add_u32 s61, s61, s53
buffer_load_dwordx4 v26, s[28:31], s61 offen lds
buffer_load_dwordx4 v27, s[28:31], s61 offen offset:1024 lds
s_add_u32 s49, s76, 2
s_and_b32 s49, s49, 15
s_mul_i32 s49, s49, 393216
buffer_load_dwordx4 v[40:43], v36, s[28:31], s49 offen
s_add_u32 s49, s76, 3
s_and_b32 s49, s49, 15
s_mul_i32 s49, s49, 393216
buffer_load_dwordx4 v[40:43], v36, s[28:31], s49 offen
buffer_load_dword v5, v30, s[32:35], s79 offen sc1
s_mov_b32 s63, 0
s_waitcnt vmcnt(0)
poll_50:
v_cmp_gt_u32 vcc, 3, v5
s_cbranch_vccz polled_51
buffer_load_dword v5, v30, s[32:35], s79 offen sc1
s_add_u32 s63, s63, 1
s_cmp_lt_u32 s63, 0x80000
s_waitcnt vmcnt(0)
s_cbranch_scc1 poll_50
polled_51:
s_add_u32 s69, s47, 0
s_and_b32 s69, s69, 15
s_mul_i32 s67, s69, 2048
s_mul_i32 s68, s69, s54
s_add_u32 m0, s70, 0
s_nop 0
buffer_load_dwordx4 v20, s[32:35], s67 offen offset:0 sc1 lds
buffer_load_dwordx4 v21, s[32:35], s67 offen offset:1024 sc1 lds
buffer_load_dwordx4 v22, s[32:35], s67 offen offset:2048 sc1 lds
buffer_load_dwordx4 v23, s[32:35], s67 offen offset:3072 sc1 lds
s_add_u32 s69, s47, 1
s_and_b32 s69, s69, 15
s_mul_i32 s67, s69, 2048
s_mul_i32 s68, s69, s54
s_add_u32 m0, s70, 40960
s_nop 0
buffer_load_dwordx4 v20, s[32:35], s67 offen offset:0 sc1 lds
buffer_load_dwordx4 v21, s[32:35], s67 offen offset:1024 sc1 lds
buffer_load_dwordx4 v22, s[32:35], s67 offen offset:2048 sc1 lds
buffer_load_dwordx4 v23, s[32:35], s67 offen offset:3072 sc1 lds
s_waitcnt vmcnt(4)
s_barrier
s_add_u32 s69, s47, 2
s_and_b32 s69, s69, 15
s_mul_i32 s67, s69, 2048
s_mul_i32 s68, s69, s54
s_add_u32 m0, s70, 81920
s_nop 0
buffer_load_dwordx4 v20, s[32:35], s67 offen offset:0 sc1 lds
buffer_load_dwordx4 v21, s[32:35], s67 offen offset:1024 sc1 lds
buffer_load_dwordx4 v22, s[32:35], s67 offen offset:2048 sc1 lds
buffer_load_dwordx4 v23, s[32:35], s67 offen offset:3072 sc1 lds
s_add_u32 s60, s71, 81920
s_add_u32 m0, s60, 0
s_mov_b32 s61, s68
buffer_load_dwordx4 v26, s[28:31], s61 offen lds
buffer_load_dwordx4 v27, s[28:31], s61 offen offset:1024 lds
s_add_u32 m0, s60, 8192
s_add_u32 s61, s61, s53
buffer_load_dwordx4 v26, s[28:31], s61 offen lds
buffer_load_dwordx4 v27, s[28:31], s61 offen offset:1024 lds
s_add_u32 m0, s60, 16384
s_add_u32 s61, s61, s53
buffer_load_dwordx4 v26, s[28:31], s61 offen lds
buffer_load_dwordx4 v27, s[28:31], s61 offen offset:1024 lds
s_add_u32 s49, s76, 4
s_and_b32 s49, s49, 15
s_mul_i32 s49, s49, 393216
buffer_load_dwordx4 v[40:43], v36, s[28:31], s49 offen
s_mov_b32 s64, 0
s_mov_b32 s65, 0
h3_loop:
s_waitcnt vmcnt(11)
s_barrier
s_add_u32 s69, s69, 1
s_and_b32 s69, s69, 15
s_mul_i32 s67, s69, 2048
s_mul_i32 s68, s69, s54
s_add_u32 m0, s70, s65
s_nop 0
buffer_load_dwordx4 v20, s[32:35], s67 offen offset:0 sc1 lds
buffer_load_dwordx4 v21, s[32:35], s67 offen offset:1024 sc1 lds
buffer_load_dwordx4 v22, s[32:35], s67 offen offset:2048 sc1 lds
buffer_load_dwordx4 v23, s[32:35], s67 offen offset:3072 sc1 lds
s_add_u32 s60, s71, s65
s_add_u32 m0, s60, 0
s_mov_b32 s61, s68
buffer_load_dwordx4 v26, s[28:31], s61 offen lds
buffer_load_dwordx4 v27, s[28:31], s61 offen offset:1024 lds
s_add_u32 m0, s60, 8192
s_add_u32 s61, s61, s53
buffer_load_dwordx4 v26, s[28:31], s61 offen lds
buffer_load_dwordx4 v27, s[28:31], s61 offen offset:1024 lds
s_add_u32 m0, s60, 16384
s_add_u32 s61, s61, s53
buffer_load_dwordx4 v26, s[28:31], s61 offen lds
buffer_load_dwordx4 v27, s[28:31], s61 offen offset:1024 lds
s_add_u32 s48, s64, 5
s_min_u32 s48, s48, 15
s_add_u32 s49, s48, s76
s_and_b32 s49, s49, 15
s_mul_i32 s49, s49, 393216
buffer_load_dwordx4 v[40:43], v36, s[28:31], s49 offen
s_add_u32 s65, s65, 40960
s_cmp_eq_u32 s65, 122880
s_cselect_b32 s65, 0, s65
s_add_u32 s64, s64, 1
s_cmp_lt_u32 s64, 11
s_cbranch_scc1 h3_loop
s_waitcnt vmcnt(11)
s_barrier
s_add_u32 s69, s47, 14
s_and_b32 s69, s69, 15
s_mul_i32 s67, s69, 2048
s_mul_i32 s68, s69, s54
s_add_u32 m0, s70, s65
s_nop 0
buffer_load_dwordx4 v20, s[32:35], s67 offen offset:0 sc1 lds
buffer_load_dwordx4 v21, s[32:35], s67 offen offset:1024 sc1 lds
buffer_load_dwordx4 v22, s[32:35], s67 offen offset:2048 sc1 lds
buffer_load_dwordx4 v23, s[32:35], s67 offen offset:3072 sc1 lds
s_add_u32 s60, s71, s65
s_add_u32 m0, s60, 0
s_mov_b32 s61, s68
buffer_load_dwordx4 v26, s[28:31], s61 offen lds
buffer_load_dwordx4 v27, s[28:31], s61 offen offset:1024 lds
s_add_u32 m0, s60, 8192
s_add_u32 s61, s61, s53
buffer_load_dwordx4 v26, s[28:31], s61 offen lds
buffer_load_dwordx4 v27, s[28:31], s61 offen offset:1024 lds
s_add_u32 m0, s60, 16384
s_add_u32 s61, s61, s53
buffer_load_dwordx4 v26, s[28:31], s61 offen lds
buffer_load_dwordx4 v27, s[28:31], s61 offen offset:1024 lds
s_add_u32 s65, s65, 40960
s_cmp_eq_u32 s65, 122880
s_cselect_b32 s65, 0, s65
s_add_u32 s64, s64, 1
s_mov_b32 s36, s16
s_and_b32 s37, s17, 0xffff
s_mov_b32 s38, 2097152
s_mov_b32 s39, 0x00020000
s_waitcnt vmcnt(10)
s_barrier
s_add_u32 s69, s47, 15
s_and_b32 s69, s69, 15
s_mul_i32 s67, s69, 2048
s_mul_i32 s68, s69, s54
s_add_u32 m0, s70, 0
s_nop 0
buffer_load_dwordx4 v20, s[32:35], s67 offen offset:0 sc1 lds
buffer_load_dwordx4 v21, s[32:35], s67 offen offset:1024 sc1 lds
buffer_load_dwordx4 v22, s[32:35], s67 offen offset:2048 sc1 lds
buffer_load_dwordx4 v23, s[32:35], s67 offen offset:3072 sc1 lds
s_add_u32 s60, s71, 0
s_add_u32 m0, s60, 0
s_mov_b32 s61, s68
buffer_load_dwordx4 v26, s[28:31], s61 offen lds
buffer_load_dwordx4 v27, s[28:31], s61 offen offset:1024 lds
s_add_u32 m0, s60, 8192
s_add_u32 s61, s61, s53
buffer_load_dwordx4 v26, s[28:31], s61 offen lds
buffer_load_dwordx4 v27, s[28:31], s61 offen offset:1024 lds
s_add_u32 m0, s60, 16384
s_add_u32 s61, s61, s53
buffer_load_dwordx4 v26, s[28:31], s61 offen lds
buffer_load_dwordx4 v27, s[28:31], s61 offen offset:1024 lds
s_waitcnt vmcnt(10)
s_barrier
s_setprio 0
buffer_load_dword v33, v30, s[32:35], s73 offen sc1
buffer_load_dwordx4 v[80:83], v37, s[32:35], 0 offen offset:0 sc1
buffer_load_dwordx4 v[84:87], v37, s[32:35], 0 offen offset:1024 sc1
buffer_load_dwordx4 v[88:91], v37, s[32:35], 0 offen offset:2048 sc1
buffer_load_dwordx4 v[92:95], v37, s[32:35], 0 offen offset:3072 sc1
global_load_dword v48, v54, s[98:99]
s_add_u32 s48, s75, 15
s_and_b32 s48, s48, 15
s_mul_i32 s48, s48, s57
s_add_u32 m0, s71, 106496
s_nop 0
buffer_load_dwordx4 v28, s[36:39], s48 offen lds
buffer_load_dwordx4 v29, s[36:39], s48 offen offset:1024 lds
s_add_u32 s48, s75, 5
s_and_b32 s48, s48, 15
s_mul_i32 s48, s48, s57
s_add_u32 m0, s71, 24576
s_nop 0
buffer_load_dwordx4 v28, s[36:39], s48 offen lds
buffer_load_dwordx4 v29, s[36:39], s48 offen offset:1024 lds
s_add_u32 s48, s75, 6
s_and_b32 s48, s48, 15
s_mul_i32 s48, s48, s57
s_add_u32 m0, s71, 32768
s_nop 0
buffer_load_dwordx4 v28, s[36:39], s48 offen lds
buffer_load_dwordx4 v29, s[36:39], s48 offen offset:1024 lds
s_waitcnt vmcnt(12)
s_barrier
s_waitcnt vmcnt(7)
s_mov_b32 s63, 0
poll_55:
v_cmp_gt_u32 vcc, 1, v33
s_cbranch_vccz polled_56
buffer_load_dword v33, v30, s[32:35], s73 offen sc1
s_add_u32 s63, s63, 1
s_cmp_lt_u32 s63, 0x80000
s_waitcnt vmcnt(0)
s_cbranch_scc1 poll_55
polled_56:
s_add_u32 s48, s75, 7
s_and_b32 s48, s48, 15
s_mul_i32 s48, s48, s57
s_add_u32 m0, s71, 40960
s_nop 0
buffer_load_dwordx4 v28, s[36:39], s48 offen lds
v_add_f32 v80, v80, v88
v_add_f32 v81, v81, v89
v_add_f32 v82, v82, v90
v_add_f32 v83, v83, v91
v_add_f32 v84, v84, v92
buffer_load_dwordx4 v29, s[36:39], s48 offen offset:1024 lds
v_add_f32 v85, v85, v93
v_add_f32 v86, v86, v94
v_add_f32 v87, v87, v95
v_add_f32 v80, v80, v84
v_add_f32 v81, v81, v85
s_add_u32 s48, s75, 8
s_and_b32 s48, s48, 15
s_mul_i32 s48, s48, s57
s_add_u32 m0, s71, 49152
s_nop 0
buffer_load_dwordx4 v28, s[36:39], s48 offen lds
v_add_f32 v82, v82, v86
v_add_f32 v83, v83, v87
s_nop 1
v_permlane32_swap_b32 v80, v81
buffer_load_dwordx4 v29, s[36:39], s48 offen offset:1024 lds
v_permlane32_swap_b32 v82, v83
v_add_f32 v80, v80, v81
v_add_f32 v82, v82, v83
s_nop 1
v_permlane16_swap_b32 v80, v82
s_add_u32 s48, s75, 9
s_and_b32 s48, s48, 15
s_mul_i32 s48, s48, s57
s_add_u32 m0, s71, 57344
s_nop 0
buffer_load_dwordx4 v28, s[36:39], s48 offen lds
s_nop 0
v_add_f32 v80, v80, v82
v_cmp_u_f32 vcc, v80, v80
s_cbranch_vccnz again_52
summed_53:
buffer_load_dwordx4 v29, s[36:39], s48 offen offset:1024 lds
v_mul_f32 v44, 0x3a800000, v80
v_mov_b32 v45, v44
s_nop 1
v_permlane16_swap_b32 v44, v45
s_add_u32 s48, s75, 10
s_and_b32 s48, s48, 15
s_mul_i32 s48, s48, s57
s_add_u32 m0, s71, 65536
s_nop 0
buffer_load_dwordx4 v28, s[36:39], s48 offen lds
s_nop 0
v_fma_f32 v45, -v44, v44, v45
v_max_f32 v45, 0, v45
v_add_f32 v45, 0x3727c5ac, v45
v_rsq_f32 v46, v45
buffer_load_dwordx4 v29, s[36:39], s48 offen offset:1024 lds
v_sub_f32 v47, 0, v44
ds_write_b32 v50, v47 offset:512
ds_write_b64 v49, v[46:47]
ds_write_b32 v50, v46
s_setprio 0
s_waitcnt lgkmcnt(0)
s_waitcnt vmcnt(63)
s_barrier
s_waitcnt vmcnt(4)
s_add_u32 s48, s75, 11
s_and_b32 s48, s48, 15
s_mul_i32 s48, s48, s57
s_add_u32 m0, s71, 73728
s_nop 0
buffer_load_dwordx4 v28, s[36:39], s48 offen lds
buffer_load_dwordx4 v29, s[36:39], s48 offen offset:1024 lds
s_waitcnt vmcnt(4)
s_add_u32 s48, s75, 12
s_and_b32 s48, s48, 15
s_mul_i32 s48, s48, s57
s_add_u32 m0, s71, 81920
s_nop 0
buffer_load_dwordx4 v28, s[36:39], s48 offen lds
buffer_load_dwordx4 v29, s[36:39], s48 offen offset:1024 lds
s_waitcnt vmcnt(4)
s_add_u32 s48, s75, 13
s_and_b32 s48, s48, 15
s_mul_i32 s48, s48, s57
s_add_u32 m0, s71, 90112
s_nop 0
buffer_load_dwordx4 v28, s[36:39], s48 offen lds
buffer_load_dwordx4 v29, s[36:39], s48 offen offset:1024 lds
s_waitcnt vmcnt(4)
s_add_u32 s48, s75, 14
s_and_b32 s48, s48, 15
s_mul_i32 s48, s48, s57
s_add_u32 m0, s71, 98304
s_nop 0
buffer_load_dwordx4 v28, s[36:39], s48 offen lds
buffer_load_dwordx4 v29, s[36:39], s48 offen offset:1024 lds
s_waitcnt vmcnt(4)
s_add_u32 s48, s75, 0
s_and_b32 s48, s48, 15
s_mul_i32 s48, s48, s57
s_add_u32 m0, s71, 4294950912
s_nop 0
buffer_load_dwordx4 v28, s[36:39], s48 offen lds
buffer_load_dwordx4 v29, s[36:39], s48 offen offset:1024 lds
s_waitcnt vmcnt(4)
s_add_u32 s48, s75, 1
s_and_b32 s48, s48, 15
s_mul_i32 s48, s48, s57
s_add_u32 m0, s71, 4294959104
s_nop 0
buffer_load_dwordx4 v28, s[36:39], s48 offen lds
buffer_load_dwordx4 v29, s[36:39], s48 offen offset:1024 lds
s_waitcnt vmcnt(4)
s_add_u32 s48, s75, 2
s_and_b32 s48, s48, 15
s_mul_i32 s48, s48, s57
s_add_u32 m0, s71, 0
s_nop 0
buffer_load_dwordx4 v28, s[36:39], s48 offen lds
buffer_load_dwordx4 v29, s[36:39], s48 offen offset:1024 lds
s_waitcnt vmcnt(4)
s_add_u32 s48, s75, 3
s_and_b32 s48, s48, 15
s_mul_i32 s48, s48, s57
s_add_u32 m0, s71, 8192
s_nop 0
buffer_load_dwordx4 v28, s[36:39], s48 offen lds
buffer_load_dwordx4 v29, s[36:39], s48 offen offset:1024 lds
s_waitcnt vmcnt(4)
s_add_u32 s48, s75, 4
s_and_b32 s48, s48, 15
s_mul_i32 s48, s48, s57
s_add_u32 m0, s71, 16384
s_nop 0
buffer_load_dwordx4 v28, s[36:39], s48 offen lds
buffer_load_dwordx4 v29, s[36:39], s48 offen offset:1024 lds
s_waitcnt vmcnt(4)
buffer_load_dwordx4 v[96:99], v18, s[32:35], s81 offen offset:0 sc1
buffer_load_dwordx4 v[100:103], v18, s[32:35], s81 offen offset:1024 sc1
s_waitcnt vmcnt(4)
buffer_load_dwordx4 v[104:107], v18, s[32:35], s82 offen offset:0 sc1
buffer_load_dwordx4 v[108:111], v18, s[32:35], s82 offen offset:1024 sc1
s_waitcnt vmcnt(0) lgkmcnt(0)
s_barrier
L_end:
s_endpgm
L_compute:
s_lshr_b32 s48, s2, 2
s_and_b32 s48, s48, 1
s_lshl_b32 s48, s48, 1
s_add_u32 s48, s48, s74
s_and_b32 s49, s42, 3
s_xor_b32 s77, s48, s49
s_add_u32 s77, s77, 4
s_add_u32 s48, s47, 1
s_and_b32 s48, s48, 3
s_and_b32 s49, s77, 3
s_lshl_b32 s49, s49, 2
s_add_u32 s78, s48, s49
s_and_b32 s48, s2, 7
s_lshl_b32 s48, s48, 1
s_add_u32 s75, s78, s48
s_and_b32 s75, s75, 15
s_mov_b32 s46, 0
s_waitcnt lgkmcnt(0)
s_mov_b32 s32, s22
s_and_b32 s33, s23, 0xffff
s_mov_b32 s34, 268435456
s_mov_b32 s35, 0x00020000
s_mov_b32 s24, s18
s_and_b32 s25, s19, 0xffff
s_mov_b32 s26, 4194304
s_mov_b32 s27, 0x00020000
s_setprio 1
s_and_b32 s43, s40, 1
s_lshr_b32 s44, s40, 1
s_lshl_b32 s45, s42, 1
s_add_u32 s45, s45, s43
s_cmp_lg_u32 s40, 1
s_cbranch_scc1 else_57
s_getpc_b64 s[48:49]
L_pc:
s_sub_u32 s48, s48, L_pc - interleave_layers__sliding_local_dilated__linear_kernel_hedgehog__prompt_kernel
s_subb_u32 s49, s49, 0
s_lshr_b32 s50, s2, 3
s_lshl_b32 s50, s50, 12
v_lshl_add_u32 v8, v0, 6, s50
v_cmp_gt_u32 vcc, L_code_end - interleave_layers__sliding_local_dilated__linear_kernel_hedgehog__prompt_kernel, v8
s_and_saveexec_b64 s[50:51], vcc
s_cbranch_execz nopf_59
global_load_dword v254, v8, s[48:49]
nopf_59:
s_mov_b64 exec, -1
else_57:
s_lshl_b32 s48, s41, 3
s_lshl_b32 s49, s44, 2
s_add_u32 s48, s48, s49
s_lshl_b32 s48, s48, 5
s_add_u32 s48, s48, s45
s_lshl_b32 s48, s48, 10
s_add_u32 s80, s48, 4194304
s_add_u32 s81, s80, 32768
s_add_u32 s82, s80, 65536
s_add_u32 s83, s80, 98304
s_lshl_b32 s84, s41, 2
s_add_u32 s84, s84, s44
s_lshl_b32 s84, s84, 7
s_add_u32 s84, s84, 18350080
s_lshl_b32 s48, s41, 3
s_lshl_b32 s49, s40, 1
s_add_u32 s48, s48, s49
s_lshl_b32 s48, s48, 15
s_lshl_b32 s49, s78, 11
s_add_u32 s85, s48, s49
s_add_u32 s86, s85, 32768
s_lshl_b32 s50, s41, 2
s_add_u32 s50, s50, s40
s_lshl_b32 s50, s50, 4
s_add_u32 s50, s50, s42
s_lshl_b32 s50, s50, 8
s_add_u32 s87, s50, 16777216
s_lshl_b32 s88, s41, 2
s_add_u32 s88, s88, s40
s_lshl_b32 s88, s88, 7
s_add_u32 s88, s88, 18358272
v_lshrrev_b32 v4, 1, v3
v_lshl_add_u32 v4, v2, 2, v4
v_and_b32 v5, 1, v3
v_lshl_add_u32 v4, v5, 1, v4
v_lshlrev_b32 v1, 2, v4
s_lshl_b32 s48, s40, 2
s_add_u32 s48, s48, 134672
v_mov_b32 v10, s48
v_mov_b32 v11, 0
ds_write_b32 v10, v11
v_mov_b32 v140, -1
v_mov_b32 v141, -1
v_mov_b32 v142, -1
v_mov_b32 v143, -1
s_lshl_b32 s50, s42, 2
s_add_u32 s50, s50, s40
s_lshl_b32 s50, s50, 4
s_add_u32 s50, s50, s41
s_lshl_b32 s50, s50, 8
s_add_u32 s50, s50, 17825792
v_mov_b32 v4, s87
v_mov_b32 v5, s50
v_cmp_eq_u32 vcc, 0, v3
v_lshrrev_b32 v6, 1, v3
v_mul_u32_u24 v6, 262144, v6
v_add_u32 v5, v5, v6
v_cndmask_b32 v4, v5, v4, vcc
v_lshl_add_u32 v4, v2, 4, v4
buffer_store_dwordx4 v[140:143], v4, s[32:35], 0 offen sc1
s_lshl_b32 s48, s2, 2
s_add_u32 s49, s48, s40
s_lshl_b32 s48, s49, 10
s_add_u32 s48, s48, 8388608
buffer_store_dwordx4 v[140:143], v18, s[32:35], s48 offen sc1
s_and_b32 s48, s49, 7
s_cmp_lg_u32 s48, 0
s_cbranch_scc1 nofl_60
s_lshl_b32 s48, s49, 5
s_add_u32 s48, s48, 18350080
v_lshlrev_b32 v6, 2, v0
buffer_store_dword v11, v6, s[32:35], s48 offen sc1
nofl_60:
s_lshl_b32 s49, s44, 13
v_lshrrev_b32 v4, 1, v2
v_xor_b32 v4, v4, v3
v_lshlrev_b32 v4, 4, v4
v_lshl_add_u32 v10, v2, 7, v4
v_add_u32 v10, s49, v10
v_xor_b32 v11, 64, v10
s_lshl_b32 s48, s43, 1
v_lshrrev_b32 v4, 2, v2
v_and_b32 v5, 3, v0
v_lshl_add_u32 v6, v3, 3, v4
v_lshlrev_b32 v6, 7, v6
v_lshl_add_u32 v6, v5, 3, v6
v_lshrrev_b32 v7, 1, v4
v_and_b32 v8, 1, v3
v_lshl_add_u32 v7, v8, 1, v7
v_xor_b32 v7, s48, v7
v_lshl_add_u32 v12, v7, 5, v6
v_add_u32 v12, 16384, v12
v_xor_b32 v13, 32, v12
v_mov_b32 v14, v10
v_mov_b32 v15, v11
v_add_u32 v16, 0, v12
v_add_u32 v17, 0, v13
v_mov_b32 v156, 0
v_mov_b32 v157, 0
v_mov_b32 v158, 0
v_mov_b32 v159, 0
v_mov_b32 v160, 0
v_mov_b32 v161, 0
v_mov_b32 v162, 0
v_mov_b32 v163, 0
v_mov_b32 v164, 0
v_mov_b32 v165, 0
v_mov_b32 v166, 0
v_mov_b32 v167, 0
v_mov_b32 v168, 0
v_mov_b32 v169, 0
v_mov_b32 v170, 0
v_mov_b32 v171, 0
v_mov_b32 v172, 0
v_mov_b32 v173, 0
v_mov_b32 v174, 0
v_mov_b32 v175, 0
v_mov_b32 v176, 0
v_mov_b32 v177, 0
v_mov_b32 v178, 0
v_mov_b32 v179, 0
v_mov_b32 v180, 0
v_mov_b32 v181, 0
v_mov_b32 v182, 0
v_mov_b32 v183, 0
v_mov_b32 v184, 0
v_mov_b32 v185, 0
v_mov_b32 v186, 0
v_mov_b32 v187, 0
v_mov_b32 v188, 0
v_mov_b32 v189, 0
v_mov_b32 v190, 0
v_mov_b32 v191, 0
v_mov_b32 v192, 0
v_mov_b32 v193, 0
v_mov_b32 v194, 0
v_mov_b32 v195, 0
v_mov_b32 v196, 0
v_mov_b32 v197, 0
v_mov_b32 v198, 0
v_mov_b32 v199, 0
v_mov_b32 v200, 0
v_mov_b32 v201, 0
v_mov_b32 v202, 0
v_mov_b32 v203, 0
v_mov_b32 v204, 0
v_mov_b32 v205, 0
v_mov_b32 v206, 0
v_mov_b32 v207, 0
v_mov_b32 v208, 0
v_mov_b32 v209, 0
v_mov_b32 v210, 0
v_mov_b32 v211, 0
v_mov_b32 v212, 0
v_mov_b32 v213, 0
v_mov_b32 v214, 0
v_mov_b32 v215, 0
v_mov_b32 v216, 0
v_mov_b32 v217, 0
v_mov_b32 v218, 0
v_mov_b32 v219, 0
v_mov_b32 v220, 0
v_mov_b32 v221, 0
v_mov_b32 v222, 0
v_mov_b32 v223, 0
v_mov_b32 v224, 0
v_mov_b32 v225, 0
v_mov_b32 v226, 0
v_mov_b32 v227, 0
v_mov_b32 v228, 0
v_mov_b32 v229, 0
v_mov_b32 v230, 0
v_mov_b32 v231, 0
v_mov_b32 v232, 0
v_mov_b32 v233, 0
v_mov_b32 v234, 0
v_mov_b32 v235, 0
v_mov_b32 v236, 0
v_mov_b32 v237, 0
v_mov_b32 v238, 0
v_mov_b32 v239, 0
v_mov_b32 v240, 0
v_mov_b32 v241, 0
v_mov_b32 v242, 0
v_mov_b32 v243, 0
v_mov_b32 v244, 0
v_mov_b32 v245, 0
v_mov_b32 v246, 0
v_mov_b32 v247, 0
v_mov_b32 v248, 0
v_mov_b32 v249, 0
v_mov_b32 v250, 0
v_mov_b32 v251, 0
v_mov_b32 v48, 0x3f803f80
v_mov_b32 v49, 0x3f803f80
v_mov_b32 v50, 0x3f803f80
v_mov_b32 v51, 0x3f803f80
s_mov_b32 s48, 0xf149f2ca
v_mov_b32 v9, s48
v_lshlrev_b32 v4, 2, v3
v_sub_u32 v4, v2, v4
v_subrev_u32 v5, 0, v4
v_and_b32 v6, 0x80000001, v5
v_cmp_eq_u32 vcc, 0, v6
v_add_u32 v5, 1, v5
v_and_b32 v6, 0x80000001, v5
v_cndmask_b32 v40, v9, 0, vcc
v_cmp_eq_u32 vcc, 0x80000001, v6
s_nop 1
v_cndmask_b32 v36, v9, 0, vcc
v_subrev_u32 v5, 1, v4
v_and_b32 v6, 0x80000001, v5
v_cmp_eq_u32 vcc, 0, v6
v_add_u32 v5, 1, v5
v_and_b32 v6, 0x80000001, v5
v_cndmask_b32 v41, v9, 0, vcc
v_cmp_eq_u32 vcc, 0x80000001, v6
s_nop 1
v_cndmask_b32 v37, v9, 0, vcc
v_subrev_u32 v5, 2, v4
v_and_b32 v6, 0x80000001, v5
v_cmp_eq_u32 vcc, 0, v6
v_add_u32 v5, 1, v5
v_and_b32 v6, 0x80000001, v5
v_cndmask_b32 v42, v9, 0, vcc
v_cmp_eq_u32 vcc, 0x80000001, v6
s_nop 1
v_cndmask_b32 v38, v9, 0, vcc
v_subrev_u32 v5, 3, v4
v_and_b32 v6, 0x80000001, v5
v_cmp_eq_u32 vcc, 0, v6
v_add_u32 v5, 1, v5
v_and_b32 v6, 0x80000001, v5
v_cndmask_b32 v43, v9, 0, vcc
v_cmp_eq_u32 vcc, 0x80000001, v6
s_nop 1
v_cndmask_b32 v39, v9, 0, vcc
s_or_b32 s48, s41, s44
s_cmp_eq_u32 s48, 0
s_cselect_b64 vcc, -1, 0
v_cndmask_b32 v44, v36, v9, vcc
v_cndmask_b32 v45, v37, v9, vcc
v_cndmask_b32 v46, v38, v9, vcc
v_cndmask_b32 v47, v39, v9, vcc
v_and_b32 v4, 1, v2
v_lshlrev_b32 v4, 4, v4
v_mov_b32 v5, 0xffff
v_lshlrev_b32 v52, v4, v5
s_lshl_b32 s48, s43, 11
s_add_u32 s48, s48, 135168
v_add_u32 v53, s48, v18
v_lshl_add_u32 v55, v0, 3, s48
s_add_u32 s48, s41, s44
s_sub_u32 s48, s48, 1
s_lshl_b32 s49, s48, 1
s_add_u32 s49, s49, s43
s_lshl_b32 s49, s49, 11
s_mul_i32 s50, s42, 65536
s_add_u32 s49, s49, s50
s_add_u32 s49, s49, 8388608
s_cmp_lt_i32 s48, 0
s_cselect_b32 s49, 0xf0000000, s49
v_add_u32 v58, s49, v18
v_lshl_add_u32 v59, v0, 3, s49
s_lshl_b32 s48, s43, 2
s_add_u32 s48, s48, 134672
v_mov_b32 v19, s48
s_lshl_b32 s48, s43, 7
s_add_u32 s48, s48, 133120
v_lshl_add_u32 v7, v3, 4, s48
v_lshl_add_u32 v54, v2, 2, s48
s_lshl_b32 s49, s44, 6
v_add_u32 v8, s49, v2
v_lshlrev_b32 v8, 3, v8
v_add_u32 v8, 131072, v8
v_lshl_add_u32 v9, v3, 2, s49
v_lshlrev_b32 v9, 2, v9
v_add_u32 v9, 132096, v9
s_mov_b32 s64, 0
s_mov_b32 s65, 0
s_mov_b32 s66, 0x3e8293ee
s_lshl_b32 s50, s42, 2
s_add_u32 s50, s50, s40
s_lshl_b32 s50, s50, 4
s_add_u32 s50, s50, s41
s_lshl_b32 s50, s50, 8
s_add_u32 s52, s50, 17825792
v_lshrrev_b32 v4, 1, v2
v_lshrrev_b32 v5, 1, v3
v_xor_b32 v4, v4, v5
v_lshlrev_b32 v4, 4, v4
v_and_b32 v5, 1, v3
v_lshl_add_u32 v4, v5, 3, v4
v_lshl_add_u32 v4, v2, 7, v4
s_lshl_b32 s48, s40, 12
v_add_u32 v155, s48, v4
v_mov_b32 v152, 0
v_mov_b32 v153, 0
v_mov_b32 v56, 0
v_mov_b32 v57, 0
s_waitcnt vmcnt(0)
s_barrier
ds_read_b128 v[60:63], v14 offset:0
ds_read_b128 v[64:67], v14 offset:2048
ds_read_b128 v[68:71], v14 offset:4096
ds_read_b128 v[72:75], v14 offset:6144
ds_read_b64_tr_b16 v[84:85], v16 offset:8192
ds_read_b64_tr_b16 v[86:87], v16 offset:8704
ds_read_b64_tr_b16 v[88:89], v17 offset:8192
ds_read_b64_tr_b16 v[90:91], v17 offset:8704
ds_read_b64_tr_b16 v[92:93], v16 offset:16384
ds_read_b64_tr_b16 v[94:95], v16 offset:16896
ds_read_b64_tr_b16 v[96:97], v17 offset:16384
ds_read_b64_tr_b16 v[98:99], v17 offset:16896
ds_read_b64_tr_b16 v[76:77], v16 offset:0
ds_read_b64_tr_b16 v[78:79], v16 offset:512
ds_read_b64_tr_b16 v[80:81], v17 offset:0
ds_read_b64_tr_b16 v[82:83], v17 offset:512
s_waitcnt lgkmcnt(0)
c0_loop:
v_mfma_f32_16x16x32_bf16 v[212:215], v[84:87], v[72:75], v[212:215]
ds_read_b128 v[100:103], v15 offset:0
v_mfma_f32_16x16x32_bf16 v[204:207], v[84:87], v[68:71], v[204:207]
ds_read_b128 v[104:107], v15 offset:2048
v_mfma_f32_16x16x32_bf16 v[196:199], v[84:87], v[64:67], v[196:199]
ds_read_b128 v[108:111], v15 offset:4096
v_mfma_f32_16x16x32_bf16 v[188:191], v[84:87], v[60:63], v[188:191]
ds_read_b128 v[112:115], v15 offset:6144
v_mfma_f32_16x16x32_bf16 v[192:195], v[88:91], v[60:63], v[192:195]
ds_read_b64_tr_b16 v[124:125], v16 offset:12288
v_mfma_f32_16x16x32_bf16 v[200:203], v[88:91], v[64:67], v[200:203]
ds_read_b64_tr_b16 v[126:127], v16 offset:12800
v_mfma_f32_16x16x32_bf16 v[208:211], v[88:91], v[68:71], v[208:211]
ds_read_b64_tr_b16 v[128:129], v17 offset:12288
v_mfma_f32_16x16x32_bf16 v[216:219], v[88:91], v[72:75], v[216:219]
ds_read_b64_tr_b16 v[130:131], v17 offset:12800
v_mfma_f32_16x16x32_bf16 v[244:247], v[72:75], v[92:95], v[244:247]
ds_read_b64_tr_b16 v[132:133], v16 offset:20480
v_mfma_f32_16x16x32_bf16 v[236:239], v[68:71], v[92:95], v[236:239]
ds_read_b64_tr_b16 v[134:135], v16 offset:20992
v_mfma_f32_16x16x32_bf16 v[228:231], v[64:67], v[92:95], v[228:231]
ds_read_b64_tr_b16 v[136:137], v17 offset:20480
v_mfma_f32_16x16x32_bf16 v[220:223], v[60:63], v[92:95], v[220:223]
ds_read_b64_tr_b16 v[138:139], v17 offset:20992
v_mfma_f32_16x16x32_bf16 v[224:227], v[60:63], v[96:99], v[224:227]
ds_read_b64_tr_b16 v[116:117], v16 offset:4096
v_mfma_f32_16x16x32_bf16 v[232:235], v[64:67], v[96:99], v[232:235]
ds_read_b64_tr_b16 v[118:119], v16 offset:4608
v_mfma_f32_16x16x32_bf16 v[240:243], v[68:71], v[96:99], v[240:243]
ds_read_b64_tr_b16 v[120:121], v17 offset:4096
v_mfma_f32_16x16x32_bf16 v[248:251], v[72:75], v[96:99], v[248:251]
ds_read_b64_tr_b16 v[122:123], v17 offset:4608
v_mfma_f32_16x16x32_bf16 v[180:183], v[76:79], v[72:75], v[180:183]
s_cmp_eq_u32 s77, s64
s_cbranch_scc1 c0_hook
c0_hook_ret:
v_mfma_f32_16x16x32_bf16 v[172:175], v[76:79], v[68:71], v[172:175]
s_add_u32 s65, s65, 40960
s_cmp_eq_u32 s65, 122880
v_mfma_f32_16x16x32_bf16 v[164:167], v[76:79], v[64:67], v[164:167]
s_cselect_b32 s65, 0, s65
s_add_u32 s64, s64, 1
v_mfma_f32_16x16x32_bf16 v[156:159], v[76:79], v[60:63], v[156:159]
v_add_u32 v14, s65, v10
v_add_u32 v15, s65, v11
v_mfma_f32_16x16x32_bf16 v[160:163], v[80:83], v[60:63], v[160:163]
v_add_u32 v16, s65, v12
v_add_u32 v17, s65, v13
v_mfma_f32_16x16x32_bf16 v[168:171], v[80:83], v[64:67], v[168:171]
s_cmp_eq_u32 s64, 16
s_cbranch_scc1 c0_last
v_mfma_f32_16x16x32_bf16 v[176:179], v[80:83], v[68:71], v[176:179]
s_waitcnt lgkmcnt(0)
v_mfma_f32_16x16x32_bf16 v[184:187], v[80:83], v[72:75], v[184:187]
s_barrier
v_mfma_f32_16x16x32_bf16 v[212:215], v[124:127], v[112:115], v[212:215]
ds_read_b128 v[60:63], v14 offset:0
v_mfma_f32_16x16x32_bf16 v[204:207], v[124:127], v[108:111], v[204:207]
ds_read_b128 v[64:67], v14 offset:2048
v_mfma_f32_16x16x32_bf16 v[196:199], v[124:127], v[104:107], v[196:199]
ds_read_b128 v[68:71], v14 offset:4096
v_mfma_f32_16x16x32_bf16 v[188:191], v[124:127], v[100:103], v[188:191]
ds_read_b128 v[72:75], v14 offset:6144
v_mfma_f32_16x16x32_bf16 v[192:195], v[128:131], v[100:103], v[192:195]
ds_read_b64_tr_b16 v[84:85], v16 offset:8192
v_mfma_f32_16x16x32_bf16 v[200:203], v[128:131], v[104:107], v[200:203]
ds_read_b64_tr_b16 v[86:87], v16 offset:8704
v_mfma_f32_16x16x32_bf16 v[208:211], v[128:131], v[108:111], v[208:211]
ds_read_b64_tr_b16 v[88:89], v17 offset:8192
v_mfma_f32_16x16x32_bf16 v[216:219], v[128:131], v[112:115], v[216:219]
ds_read_b64_tr_b16 v[90:91], v17 offset:8704
v_mfma_f32_16x16x32_bf16 v[244:247], v[112:115], v[132:135], v[244:247]
ds_read_b64_tr_b16 v[92:93], v16 offset:16384
v_mfma_f32_16x16x32_bf16 v[236:239], v[108:111], v[132:135], v[236:239]
ds_read_b64_tr_b16 v[94:95], v16 offset:16896
v_mfma_f32_16x16x32_bf16 v[228:231], v[104:107], v[132:135], v[228:231]
ds_read_b64_tr_b16 v[96:97], v17 offset:16384
v_mfma_f32_16x16x32_bf16 v[220:223], v[100:103], v[132:135], v[220:223]
ds_read_b64_tr_b16 v[98:99], v17 offset:16896
v_mfma_f32_16x16x32_bf16 v[224:227], v[100:103], v[136:139], v[224:227]
ds_read_b64_tr_b16 v[76:77], v16 offset:0
v_mfma_f32_16x16x32_bf16 v[232:235], v[104:107], v[136:139], v[232:235]
ds_read_b64_tr_b16 v[78:79], v16 offset:512
v_mfma_f32_16x16x32_bf16 v[240:243], v[108:111], v[136:139], v[240:243]
ds_read_b64_tr_b16 v[80:81], v17 offset:0
v_mfma_f32_16x16x32_bf16 v[248:251], v[112:115], v[136:139], v[248:251]
ds_read_b64_tr_b16 v[82:83], v17 offset:512
v_mfma_f32_16x16x32_bf16 v[180:183], v[116:119], v[112:115], v[180:183]
v_mfma_f32_16x16x32_bf16 v[172:175], v[116:119], v[108:111], v[172:175]
v_mfma_f32_16x16x32_bf16 v[164:167], v[116:119], v[104:107], v[164:167]
v_mfma_f32_16x16x32_bf16 v[156:159], v[116:119], v[100:103], v[156:159]
v_mfma_f32_16x16x32_bf16 v[160:163], v[120:123], v[100:103], v[160:163]
v_mfma_f32_16x16x32_bf16 v[168:171], v[120:123], v[104:107], v[168:171]
v_mfma_f32_16x16x32_bf16 v[176:179], v[120:123], v[108:111], v[176:179]
s_waitcnt lgkmcnt(0)
v_mfma_f32_16x16x32_bf16 v[184:187], v[120:123], v[112:115], v[184:187]
s_branch c0_loop
c0_hook:
v_add_u32 v4, s65, v155
ds_read_b64 v[20:21], v4 offset:0
ds_read_b64 v[28:29], v4 offset:2048
v_xor_b32 v5, 32, v4
ds_read_b64 v[22:23], v5 offset:0
ds_read_b64 v[30:31], v5 offset:2048
v_xor_b32 v5, 64, v4
ds_read_b64 v[24:25], v5 offset:0
ds_read_b64 v[32:33], v5 offset:2048
v_xor_b32 v5, 96, v4
ds_read_b64 v[26:27], v5 offset:0
ds_read_b64 v[34:35], v5 offset:2048
s_waitcnt lgkmcnt(8)
s_cmp_lg_u32 s44, 0
s_cbranch_scc1 else_61
v_mfma_f32_16x16x32_bf16 v[140:143], v[48:51], v[76:79], 0
v_mfma_f32_16x16x32_bf16 v[144:147], v[48:51], v[84:87], 0
v_mfma_f32_16x16x32_bf16 v[148:151], v[48:51], v[92:95], 0
v_mfma_f32_16x16x32_bf16 v[140:143], v[48:51], v[116:119], v[140:143]
v_mfma_f32_16x16x32_bf16 v[144:147], v[48:51], v[124:127], v[144:147]
v_mfma_f32_16x16x32_bf16 v[148:151], v[48:51], v[132:135], v[148:151]
s_branch fi_62
else_61:
v_mfma_f32_16x16x32_bf16 v[140:143], v[48:51], v[80:83], 0
v_mfma_f32_16x16x32_bf16 v[144:147], v[48:51], v[88:91], 0
v_mfma_f32_16x16x32_bf16 v[148:151], v[48:51], v[96:99], 0
v_mfma_f32_16x16x32_bf16 v[140:143], v[48:51], v[120:123], v[140:143]
v_mfma_f32_16x16x32_bf16 v[144:147], v[48:51], v[128:131], v[144:147]
v_mfma_f32_16x16x32_bf16 v[148:151], v[48:51], v[136:139], v[148:151]
fi_62:
s_waitcnt lgkmcnt(0)
v_dot2c_f32_bf16 v152, v20, v48
v_dot2c_f32_bf16 v56, v20, v20
v_dot2c_f32_bf16 v153, v28, v48
v_dot2c_f32_bf16 v57, v28, v28
v_dot2c_f32_bf16 v152, v21, v48
v_dot2c_f32_bf16 v56, v21, v21
v_dot2c_f32_bf16 v153, v29, v48
v_dot2c_f32_bf16 v57, v29, v29
v_dot2c_f32_bf16 v152, v22, v48
v_dot2c_f32_bf16 v56, v22, v22
v_dot2c_f32_bf16 v153, v30, v48
v_dot2c_f32_bf16 v57, v30, v30
v_dot2c_f32_bf16 v152, v23, v48
v_dot2c_f32_bf16 v56, v23, v23
v_dot2c_f32_bf16 v153, v31, v48
v_dot2c_f32_bf16 v57, v31, v31
v_dot2c_f32_bf16 v152, v24, v48
v_dot2c_f32_bf16 v56, v24, v24
v_dot2c_f32_bf16 v153, v32, v48
v_dot2c_f32_bf16 v57, v32, v32
v_dot2c_f32_bf16 v152, v25, v48
v_dot2c_f32_bf16 v56, v25, v25
v_dot2c_f32_bf16 v153, v33, v48
v_dot2c_f32_bf16 v57, v33, v33
v_dot2c_f32_bf16 v152, v26, v48
v_dot2c_f32_bf16 v56, v26, v26
v_dot2c_f32_bf16 v153, v34, v48
v_dot2c_f32_bf16 v57, v34, v34
v_dot2c_f32_bf16 v152, v27, v48
v_dot2c_f32_bf16 v56, v27, v27
v_dot2c_f32_bf16 v153, v35, v48
v_dot2c_f32_bf16 v57, v35, v35
v_cmp_eq_u32 vcc, 0, v3
v_cmp_eq_u32 s[48:49], 1, v3
s_nop 1
v_cndmask_b32 v4, v148, v144, s[48:49]
v_cndmask_b32 v4, v4, v140, vcc
buffer_store_dword v4, v1, s[32:35], s52 offen sc1
s_nop 1
v_permlane32_swap_b32 v152, v153
v_permlane32_swap_b32 v56, v57
v_add_f32 v152, v152, v153
v_add_f32 v56, v56, v57
s_nop 1
v_permlane16_swap_b32 v152, v56
s_nop 0
v_add_f32 v152, v152, v56
buffer_store_dword v152, v1, s[32:35], s87 offen sc1
s_branch c0_hook_ret
c0_last:
v_mfma_f32_16x16x32_bf16 v[176:179], v[80:83], v[68:71], v[176:179]
s_waitcnt lgkmcnt(0)
v_mfma_f32_16x16x32_bf16 v[184:187], v[80:83], v[72:75], v[184:187]
v_mfma_f32_16x16x32_bf16 v[212:215], v[124:127], v[112:115], v[212:215]
v_mfma_f32_16x16x32_bf16 v[204:207], v[124:127], v[108:111], v[204:207]
v_mfma_f32_16x16x32_bf16 v[196:199], v[124:127], v[104:107], v[196:199]
v_mfma_f32_16x16x32_bf16 v[188:191], v[124:127], v[100:103], v[188:191]
v_mfma_f32_16x16x32_bf16 v[192:195], v[128:131], v[100:103], v[192:195]
v_mfma_f32_16x16x32_bf16 v[200:203], v[128:131], v[104:107], v[200:203]
v_mfma_f32_16x16x32_bf16 v[208:211], v[128:131], v[108:111], v[208:211]
v_mfma_f32_16x16x32_bf16 v[216:219], v[128:131], v[112:115], v[216:219]
s_barrier
v_mfma_f32_16x16x32_bf16 v[244:247], v[112:115], v[132:135], v[244:247]
ds_read_b128 v[140:143], v7 offset:0
ds_read_b128 v[144:147], v7 offset:64
v_mfma_f32_16x16x32_bf16 v[236:239], v[108:111], v[132:135], v[236:239]
ds_read_b128 v[148:151], v7 offset:256
ds_read_b128 v[152:155], v7 offset:320
v_mfma_f32_16x16x32_bf16 v[228:231], v[104:107], v[132:135], v[228:231]
ds_read_b64 v[92:93], v8 offset:0
ds_read_b64 v[94:95], v8 offset:128
v_mfma_f32_16x16x32_bf16 v[220:223], v[100:103], v[132:135], v[220:223]
ds_read_b64 v[96:97], v8 offset:256
ds_read_b64 v[98:99], v8 offset:384
v_mfma_f32_16x16x32_bf16 v[224:227], v[100:103], v[136:139], v[224:227]
ds_read2_b32 v[56:57], v54 offset0:128 offset1:144
ds_read_b128 v[60:63], v9 offset:0
v_mfma_f32_16x16x32_bf16 v[232:235], v[104:107], v[136:139], v[232:235]
ds_read_b128 v[64:67], v9 offset:64
v_mfma_f32_16x16x32_bf16 v[240:243], v[108:111], v[136:139], v[240:243]
ds_read_b128 v[68:71], v9 offset:128
v_mfma_f32_16x16x32_bf16 v[248:251], v[112:115], v[136:139], v[248:251]
ds_read_b128 v[72:75], v9 offset:192
v_mfma_f32_16x16x32_bf16 v[180:183], v[116:119], v[112:115], v[180:183]
ds_read_b128 v[76:79], v9 offset:512
v_mfma_f32_16x16x32_bf16 v[172:175], v[116:119], v[108:111], v[172:175]
ds_read_b128 v[80:83], v9 offset:576
v_mfma_f32_16x16x32_bf16 v[164:167], v[116:119], v[104:107], v[164:167]
ds_read_b128 v[84:87], v9 offset:640
v_mfma_f32_16x16x32_bf16 v[156:159], v[116:119], v[100:103], v[156:159]
ds_read_b128 v[88:91], v9 offset:704
v_mfma_f32_16x16x32_bf16 v[160:163], v[120:123], v[100:103], v[160:163]
v_mov_b32 v6, 134656
ds_read_b32 v6, v6
v_mfma_f32_16x16x32_bf16 v[168:171], v[120:123], v[104:107], v[168:171]
v_mfma_f32_16x16x32_bf16 v[176:179], v[120:123], v[108:111], v[176:179]
v_mfma_f32_16x16x32_bf16 v[184:187], v[120:123], v[112:115], v[184:187]
c0_epi:
s_waitcnt lgkmcnt(0)
v_readfirstlane_b32 s46, v6
.p2align 3
v_pk_fma_f32 v[212:213], v[148:149], v[98:99], v[212:213] op_sel:[0,1,0] op_sel_hi:[1,1,1]
v_pk_fma_f32 v[214:215], v[150:151], v[98:99], v[214:215] op_sel:[0,1,0] op_sel_hi:[1,1,1]
v_pk_fma_f32 v[216:217], v[152:153], v[98:99], v[216:217] op_sel:[0,1,0] op_sel_hi:[1,1,1]
v_pk_fma_f32 v[218:219], v[154:155], v[98:99], v[218:219] op_sel:[0,1,0] op_sel_hi:[1,1,1]
v_pk_mul_f32 v[212:213], v[212:213], v[98:99] op_sel:[0,0] op_sel_hi:[1,0]
v_pk_mul_f32 v[214:215], v[214:215], v[98:99] op_sel:[0,0] op_sel_hi:[1,0]
v_pk_mul_f32 v[216:217], v[216:217], v[98:99] op_sel:[0,0] op_sel_hi:[1,0]
v_pk_mul_f32 v[218:219], v[218:219], v[98:99] op_sel:[0,0] op_sel_hi:[1,0]
v_cvt_pk_bf16_f32 v212, v212, v213
v_cvt_pk_bf16_f32 v213, v214, v215
v_cvt_pk_bf16_f32 v214, v216, v217
v_cvt_pk_bf16_f32 v215, v218, v219
v_pk_fma_f32 v[244:245], v[88:89], v[56:57], v[244:245] op_sel:[0,0,0] op_sel_hi:[1,0,1]
v_pk_fma_f32 v[246:247], v[90:91], v[56:57], v[246:247] op_sel:[0,0,0] op_sel_hi:[1,0,1]
v_pk_mul_f32 v[244:245], v[244:245], v[72:73]
v_pk_mul_f32 v[246:247], v[246:247], v[74:75]
v_cvt_pk_bf16_f32 v108, v244, v245
v_cvt_pk_bf16_f32 v109, v246, v247
v_pk_fma_f32 v[248:249], v[88:89], v[56:57], v[248:249] op_sel:[0,1,0] op_sel_hi:[1,1,1]
v_pk_fma_f32 v[250:251], v[90:91], v[56:57], v[250:251] op_sel:[0,1,0] op_sel_hi:[1,1,1]
v_pk_mul_f32 v[248:249], v[248:249], v[72:73]
v_pk_mul_f32 v[250:251], v[250:251], v[74:75]
v_cvt_pk_bf16_f32 v118, v248, v249
v_cvt_pk_bf16_f32 v119, v250, v251
s_cmp_lg_u32 s44, 1
s_cbranch_scc1 else_63
buffer_store_dwordx4 v[212:215], v58, s[32:35], 0 offen sc1
buffer_store_dwordx2 v[108:109], v59, s[32:35], 0 offen offset:1024 sc1
buffer_store_dwordx2 v[118:119], v59, s[32:35], 0 offen offset:1536 sc1
s_branch fi_64
else_63:
ds_write_b128 v53, v[212:215]
ds_write_b64 v55, v[108:109] offset:1024
ds_write_b64 v55, v[118:119] offset:1536
v_mov_b32 v4, 1
ds_write_b32 v19, v4
fi_64:
v_mul_f32 v124, s66, v92
v_mul_f32 v125, s66, v94
v_mul_f32 v126, s66, v96
v_mul_f32 v127, s66, v98
.p2align 3
v_pk_fma_f32 v[156:157], v[140:141], v[92:93], v[156:157] op_sel:[0,1,0] op_sel_hi:[1,1,1]
v_pk_fma_f32 v[158:159], v[142:143], v[92:93], v[158:159] op_sel:[0,1,0] op_sel_hi:[1,1,1]
v_pk_fma_f32 v[160:161], v[144:145], v[92:93], v[160:161] op_sel:[0,1,0] op_sel_hi:[1,1,1]
v_pk_fma_f32 v[162:163], v[146:147], v[92:93], v[162:163] op_sel:[0,1,0] op_sel_hi:[1,1,1]
v_cvt_pk_bf16_f32 v156, v156, v157
v_cvt_pk_bf16_f32 v157, v158, v159
v_cvt_pk_bf16_f32 v158, v160, v161
v_cvt_pk_bf16_f32 v159, v162, v163
v_pk_fma_f32 v[164:165], v[140:141], v[94:95], v[164:165] op_sel:[0,1,0] op_sel_hi:[1,1,1]
v_pk_fma_f32 v[166:167], v[142:143], v[94:95], v[166:167] op_sel:[0,1,0] op_sel_hi:[1,1,1]
v_pk_fma_f32 v[168:169], v[144:145], v[94:95], v[168:169] op_sel:[0,1,0] op_sel_hi:[1,1,1]
v_pk_fma_f32 v[170:171], v[146:147], v[94:95], v[170:171] op_sel:[0,1,0] op_sel_hi:[1,1,1]
v_cvt_pk_bf16_f32 v164, v164, v165
v_cvt_pk_bf16_f32 v165, v166, v167
v_cvt_pk_bf16_f32 v166, v168, v169
v_cvt_pk_bf16_f32 v167, v170, v171
v_pk_fma_f32 v[172:173], v[140:141], v[96:97], v[172:173] op_sel:[0,1,0] op_sel_hi:[1,1,1]
v_pk_fma_f32 v[174:175], v[142:143], v[96:97], v[174:175] op_sel:[0,1,0] op_sel_hi:[1,1,1]
v_pk_fma_f32 v[176:177], v[144:145], v[96:97], v[176:177] op_sel:[0,1,0] op_sel_hi:[1,1,1]
v_pk_fma_f32 v[178:179], v[146:147], v[96:97], v[178:179] op_sel:[0,1,0] op_sel_hi:[1,1,1]
v_cvt_pk_bf16_f32 v172, v172, v173
v_cvt_pk_bf16_f32 v173, v174, v175
v_cvt_pk_bf16_f32 v174, v176, v177
v_cvt_pk_bf16_f32 v175, v178, v179
v_pk_fma_f32 v[180:181], v[140:141], v[98:99], v[180:181] op_sel:[0,1,0] op_sel_hi:[1,1,1]
v_pk_fma_f32 v[182:183], v[142:143], v[98:99], v[182:183] op_sel:[0,1,0] op_sel_hi:[1,1,1]
v_pk_fma_f32 v[184:185], v[144:145], v[98:99], v[184:185] op_sel:[0,1,0] op_sel_hi:[1,1,1]
v_pk_fma_f32 v[186:187], v[146:147], v[98:99], v[186:187] op_sel:[0,1,0] op_sel_hi:[1,1,1]
v_cvt_pk_bf16_f32 v180, v180, v181
v_cvt_pk_bf16_f32 v181, v182, v183
v_cvt_pk_bf16_f32 v182, v184, v185
v_cvt_pk_bf16_f32 v183, v186, v187
v_pk_fma_f32 v[188:189], v[148:149], v[92:93], v[188:189] op_sel:[0,1,0] op_sel_hi:[1,1,1]
v_pk_fma_f32 v[190:191], v[150:151], v[92:93], v[190:191] op_sel:[0,1,0] op_sel_hi:[1,1,1]
v_pk_fma_f32 v[192:193], v[152:153], v[92:93], v[192:193] op_sel:[0,1,0] op_sel_hi:[1,1,1]
v_pk_fma_f32 v[194:195], v[154:155], v[92:93], v[194:195] op_sel:[0,1,0] op_sel_hi:[1,1,1]
v_pk_mul_f32 v[188:189], v[188:189], v[92:93] op_sel:[0,0] op_sel_hi:[1,0]
v_pk_mul_f32 v[190:191], v[190:191], v[92:93] op_sel:[0,0] op_sel_hi:[1,0]
v_pk_mul_f32 v[192:193], v[192:193], v[92:93] op_sel:[0,0] op_sel_hi:[1,0]
v_pk_mul_f32 v[194:195], v[194:195], v[92:93] op_sel:[0,0] op_sel_hi:[1,0]
v_cvt_pk_bf16_f32 v188, v188, v189
v_cvt_pk_bf16_f32 v189, v190, v191
v_cvt_pk_bf16_f32 v190, v192, v193
v_cvt_pk_bf16_f32 v191, v194, v195
v_pk_fma_f32 v[196:197], v[148:149], v[94:95], v[196:197] op_sel:[0,1,0] op_sel_hi:[1,1,1]
v_pk_fma_f32 v[198:199], v[150:151], v[94:95], v[198:199] op_sel:[0,1,0] op_sel_hi:[1,1,1]
v_pk_fma_f32 v[200:201], v[152:153], v[94:95], v[200:201] op_sel:[0,1,0] op_sel_hi:[1,1,1]
v_pk_fma_f32 v[202:203], v[154:155], v[94:95], v[202:203] op_sel:[0,1,0] op_sel_hi:[1,1,1]
v_pk_mul_f32 v[196:197], v[196:197], v[94:95] op_sel:[0,0] op_sel_hi:[1,0]
v_pk_mul_f32 v[198:199], v[198:199], v[94:95] op_sel:[0,0] op_sel_hi:[1,0]
v_pk_mul_f32 v[200:201], v[200:201], v[94:95] op_sel:[0,0] op_sel_hi:[1,0]
v_pk_mul_f32 v[202:203], v[202:203], v[94:95] op_sel:[0,0] op_sel_hi:[1,0]
v_cvt_pk_bf16_f32 v196, v196, v197
v_cvt_pk_bf16_f32 v197, v198, v199
v_cvt_pk_bf16_f32 v198, v200, v201
v_cvt_pk_bf16_f32 v199, v202, v203
v_pk_fma_f32 v[204:205], v[148:149], v[96:97], v[204:205] op_sel:[0,1,0] op_sel_hi:[1,1,1]
v_pk_fma_f32 v[206:207], v[150:151], v[96:97], v[206:207] op_sel:[0,1,0] op_sel_hi:[1,1,1]
v_pk_fma_f32 v[208:209], v[152:153], v[96:97], v[208:209] op_sel:[0,1,0] op_sel_hi:[1,1,1]
v_pk_fma_f32 v[210:211], v[154:155], v[96:97], v[210:211] op_sel:[0,1,0] op_sel_hi:[1,1,1]
v_pk_mul_f32 v[204:205], v[204:205], v[96:97] op_sel:[0,0] op_sel_hi:[1,0]
v_pk_mul_f32 v[206:207], v[206:207], v[96:97] op_sel:[0,0] op_sel_hi:[1,0]
v_pk_mul_f32 v[208:209], v[208:209], v[96:97] op_sel:[0,0] op_sel_hi:[1,0]
v_pk_mul_f32 v[210:211], v[210:211], v[96:97] op_sel:[0,0] op_sel_hi:[1,0]
v_cvt_pk_bf16_f32 v204, v204, v205
v_cvt_pk_bf16_f32 v205, v206, v207
v_cvt_pk_bf16_f32 v206, v208, v209
v_cvt_pk_bf16_f32 v207, v210, v211
s_cmp_lg_u32 s44, 0
s_cbranch_scc1 else_65
buffer_load_dwordx4 v[120:123], v58, s[32:35], 0 offen sc1
buffer_load_dwordx2 v[100:101], v59, s[32:35], 0 offen offset:1024 sc1
buffer_load_dwordx2 v[110:111], v59, s[32:35], 0 offen offset:1536 sc1
else_65:
.p2align 3
v_mfma_f32_16x16x32_bf16 v[216:219], v[212:215], v[180:183], v[40:43]
v_pk_fma_f32 v[220:221], v[76:77], v[56:57], v[220:221] op_sel:[0,0,0] op_sel_hi:[1,0,1]
v_pk_fma_f32 v[222:223], v[78:79], v[56:57], v[222:223] op_sel:[0,0,0] op_sel_hi:[1,0,1]
v_pk_mul_f32 v[220:221], v[220:221], v[60:61]
v_pk_mul_f32 v[222:223], v[222:223], v[62:63]
v_cvt_pk_bf16_f32 v102, v220, v221
v_mfma_f32_16x16x32_bf16 v[192:195], v[188:191], v[156:159], v[40:43]
v_cvt_pk_bf16_f32 v103, v222, v223
v_pk_fma_f32 v[224:225], v[76:77], v[56:57], v[224:225] op_sel:[0,1,0] op_sel_hi:[1,1,1]
v_pk_fma_f32 v[226:227], v[78:79], v[56:57], v[226:227] op_sel:[0,1,0] op_sel_hi:[1,1,1]
v_pk_mul_f32 v[224:225], v[224:225], v[60:61]
v_pk_mul_f32 v[226:227], v[226:227], v[62:63]
v_cvt_pk_bf16_f32 v112, v224, v225
v_mfma_f32_16x16x32_bf16 v[168:171], v[188:191], v[164:167], v[36:39]
v_cvt_pk_bf16_f32 v113, v226, v227
v_pk_fma_f32 v[228:229], v[80:81], v[56:57], v[228:229] op_sel:[0,0,0] op_sel_hi:[1,0,1]
v_pk_fma_f32 v[230:231], v[82:83], v[56:57], v[230:231] op_sel:[0,0,0] op_sel_hi:[1,0,1]
v_pk_mul_f32 v[228:229], v[228:229], v[64:65]
v_pk_mul_f32 v[230:231], v[230:231], v[66:67]
v_cvt_pk_bf16_f32 v104, v228, v229
v_mfma_f32_16x16x32_bf16 v[200:203], v[196:199], v[164:167], v[40:43]
v_cvt_pk_bf16_f32 v105, v230, v231
v_pk_fma_f32 v[232:233], v[80:81], v[56:57], v[232:233] op_sel:[0,1,0] op_sel_hi:[1,1,1]
v_pk_fma_f32 v[234:235], v[82:83], v[56:57], v[234:235] op_sel:[0,1,0] op_sel_hi:[1,1,1]
v_pk_mul_f32 v[232:233], v[232:233], v[64:65]
v_pk_mul_f32 v[234:235], v[234:235], v[66:67]
v_cvt_pk_bf16_f32 v114, v232, v233
v_mfma_f32_16x16x32_bf16 v[176:179], v[196:199], v[172:175], v[36:39]
v_cvt_pk_bf16_f32 v115, v234, v235
v_pk_fma_f32 v[236:237], v[84:85], v[56:57], v[236:237] op_sel:[0,0,0] op_sel_hi:[1,0,1]
v_pk_fma_f32 v[238:239], v[86:87], v[56:57], v[238:239] op_sel:[0,0,0] op_sel_hi:[1,0,1]
v_pk_mul_f32 v[236:237], v[236:237], v[68:69]
v_pk_mul_f32 v[238:239], v[238:239], v[70:71]
v_cvt_pk_bf16_f32 v106, v236, v237
v_mfma_f32_16x16x32_bf16 v[208:211], v[204:207], v[172:175], v[40:43]
v_cvt_pk_bf16_f32 v107, v238, v239
v_pk_fma_f32 v[240:241], v[84:85], v[56:57], v[240:241] op_sel:[0,1,0] op_sel_hi:[1,1,1]
v_pk_fma_f32 v[242:243], v[86:87], v[56:57], v[242:243] op_sel:[0,1,0] op_sel_hi:[1,1,1]
v_pk_mul_f32 v[240:241], v[240:241], v[68:69]
v_pk_mul_f32 v[242:243], v[242:243], v[70:71]
v_cvt_pk_bf16_f32 v116, v240, v241
v_mfma_f32_16x16x32_bf16 v[184:187], v[204:207], v[180:183], v[36:39]
v_cvt_pk_bf16_f32 v117, v242, v243
v_max_f32 v166, v200, v201
v_max_f32 v167, v202, v203
v_max_f32 v164, v168, v169
v_max_f32 v165, v170, v171
v_max3_f32 v129, v164, v165, v166
v_max_f32 v129, v129, v167
s_cmp_lg_u32 s44, 0
s_cbranch_scc1 else_67
s_mov_b32 s63, 0
sent_69:
s_waitcnt vmcnt(0)
v_max_u32 v4, v120, v121
v_max3_u32 v4, v4, v122, v123
v_max3_u32 v4, v4, v100, v101
v_max3_u32 v4, v4, v110, v111
v_cmp_eq_u32 vcc, -1, v4
s_cbranch_vccz sentd_70
buffer_load_dwordx4 v[120:123], v58, s[32:35], 0 offen sc1
buffer_load_dwordx2 v[100:101], v59, s[32:35], 0 offen offset:1024 sc1
buffer_load_dwordx2 v[110:111], v59, s[32:35], 0 offen offset:1536 sc1
s_add_u32 s63, s63, 1
s_cmp_lt_u32 s63, 0x80000
s_cbranch_scc1 sent_69
s_waitcnt vmcnt(0)
sentd_70:
v_mov_b32 v132, -1
v_mov_b32 v133, -1
v_mov_b32 v134, -1
v_mov_b32 v135, -1
buffer_store_dwordx4 v[132:135], v58, s[32:35], 0 offen offset:0 sc1
buffer_store_dwordx4 v[132:135], v58, s[32:35], 0 offen offset:1024 sc1
s_branch fi_68
else_67:
s_mov_b32 s63, 0
px_71:
ds_read_b32 v4, v19
ds_read_b128 v[120:123], v53
ds_read_b64 v[100:101], v55 offset:1024
ds_read_b64 v[110:111], v55 offset:1536
s_add_u32 s63, s63, 1
s_cmp_lt_u32 s63, 0x400000
s_waitcnt lgkmcnt(0)
v_cmp_ne_u32 vcc, 1, v4
s_cbranch_vccz pxd_72
s_cbranch_scc1 px_71
pxd_72:
fi_68:
v_mfma_f32_16x16x32_bf16 v[160:163], v[120:123], v[156:159], v[44:47]
v_max_f32 v174, v208, v209
v_max_f32 v175, v210, v211
v_max_f32 v172, v176, v177
v_max_f32 v173, v178, v179
v_max3_f32 v130, v172, v173, v174
v_max_f32 v130, v130, v175
v_max_f32 v182, v216, v217
v_max_f32 v183, v218, v219
v_max_f32 v180, v184, v185
v_max_f32 v181, v186, v187
v_max3_f32 v131, v180, v181, v182
v_max_f32 v131, v131, v183
v_max_f32 v158, v192, v193
v_max_f32 v159, v194, v195
v_max_f32 v156, v160, v161
v_max_f32 v157, v162, v163
v_max3_f32 v128, v156, v157, v158
v_max_f32 v128, v128, v159
s_nop 1
v_permlane32_swap_b32 v128, v129
v_permlane32_swap_b32 v130, v131
v_max_f32 v128, v128, v129
v_max_f32 v130, v130, v131
s_nop 1
v_permlane16_swap_b32 v128, v130
s_nop 0
v_max_f32 v128, v128, v130
v_mov_b32 v130, v128
s_nop 1
v_permlane16_swap_b32 v128, v130
s_nop 0
v_mov_b32 v129, v128
v_mov_b32 v131, v130
s_nop 0
v_permlane32_swap_b32 v128, v129
v_permlane32_swap_b32 v130, v131
v_pk_mul_f32 v[128:129], v[128:129], v[124:125]
v_pk_mul_f32 v[130:131], v[130:131], v[126:127]
v_pk_fma_f32 v[156:157], v[156:157], v[124:125], v[128:129] op_sel:[0,0,0] op_sel_hi:[1,0,0] neg_lo:[0,0,1] neg_hi:[0,0,1]
v_pk_fma_f32 v[158:159], v[158:159], v[124:125], v[128:129] op_sel:[0,0,0] op_sel_hi:[1,0,0] neg_lo:[0,0,1] neg_hi:[0,0,1]
v_exp_f32 v156, v156
v_exp_f32 v157, v157
v_exp_f32 v158, v158
v_exp_f32 v159, v159
v_cvt_pk_bf16_f32 v156, v156, v156
v_cvt_pk_bf16_f32 v157, v157, v157
v_cvt_pk_bf16_f32 v158, v158, v158
v_cvt_pk_bf16_f32 v159, v159, v159
v_and_b32 v156, v52, v156
v_and_b32 v157, v52, v157
v_and_b32 v158, v52, v158
v_and_b32 v159, v52, v159
v_pk_fma_f32 v[164:165], v[164:165], v[124:125], v[128:129] op_sel:[0,1,1] op_sel_hi:[1,1,1] neg_lo:[0,0,1] neg_hi:[0,0,1]
v_pk_fma_f32 v[166:167], v[166:167], v[124:125], v[128:129] op_sel:[0,1,1] op_sel_hi:[1,1,1] neg_lo:[0,0,1] neg_hi:[0,0,1]
v_exp_f32 v164, v164
v_mfma_f32_16x16x32_bf16 v[160:163], v[48:51], v[156:159], 0
v_exp_f32 v165, v165
v_exp_f32 v166, v166
v_exp_f32 v167, v167
v_cvt_pk_bf16_f32 v164, v164, v164
v_mfma_f32_16x16x32_bf16 v[220:223], v[100:103], v[156:159], 0
v_cvt_pk_bf16_f32 v165, v165, v165
v_cvt_pk_bf16_f32 v166, v166, v166
v_cvt_pk_bf16_f32 v167, v167, v167
v_and_b32 v164, v52, v164
v_mfma_f32_16x16x32_bf16 v[224:227], v[110:113], v[156:159], 0
v_and_b32 v165, v52, v165
v_and_b32 v166, v52, v166
v_and_b32 v167, v52, v167
v_pk_fma_f32 v[172:173], v[172:173], v[126:127], v[130:131] op_sel:[0,0,0] op_sel_hi:[1,0,0] neg_lo:[0,0,1] neg_hi:[0,0,1]
v_pk_fma_f32 v[174:175], v[174:175], v[126:127], v[130:131] op_sel:[0,0,0] op_sel_hi:[1,0,0] neg_lo:[0,0,1] neg_hi:[0,0,1]
v_exp_f32 v172, v172
v_mfma_f32_16x16x32_bf16 v[168:171], v[48:51], v[164:167], 0
v_exp_f32 v173, v173
v_exp_f32 v174, v174
v_exp_f32 v175, v175
v_cvt_pk_bf16_f32 v172, v172, v172
v_mfma_f32_16x16x32_bf16 v[228:231], v[102:105], v[164:167], 0
v_cvt_pk_bf16_f32 v173, v173, v173
v_cvt_pk_bf16_f32 v174, v174, v174
v_cvt_pk_bf16_f32 v175, v175, v175
v_and_b32 v172, v52, v172
v_mfma_f32_16x16x32_bf16 v[232:235], v[112:115], v[164:167], 0
v_and_b32 v173, v52, v173
v_and_b32 v174, v52, v174
v_and_b32 v175, v52, v175
v_pk_fma_f32 v[180:181], v[180:181], v[126:127], v[130:131] op_sel:[0,1,1] op_sel_hi:[1,1,1] neg_lo:[0,0,1] neg_hi:[0,0,1]
v_pk_fma_f32 v[182:183], v[182:183], v[126:127], v[130:131] op_sel:[0,1,1] op_sel_hi:[1,1,1] neg_lo:[0,0,1] neg_hi:[0,0,1]
v_exp_f32 v180, v180
v_mfma_f32_16x16x32_bf16 v[176:179], v[48:51], v[172:175], 0
v_exp_f32 v181, v181
v_exp_f32 v182, v182
v_exp_f32 v183, v183
v_cvt_pk_bf16_f32 v180, v180, v180
v_mfma_f32_16x16x32_bf16 v[236:239], v[104:107], v[172:175], 0
v_cvt_pk_bf16_f32 v181, v181, v181
v_cvt_pk_bf16_f32 v182, v182, v182
v_cvt_pk_bf16_f32 v183, v183, v183
v_and_b32 v180, v52, v180
v_mfma_f32_16x16x32_bf16 v[240:243], v[114:117], v[172:175], 0
v_and_b32 v181, v52, v181
v_and_b32 v182, v52, v182
v_and_b32 v183, v52, v183
v_rcp_f32 v160, v160
v_rcp_f32 v168, v168
v_mfma_f32_16x16x32_bf16 v[184:187], v[48:51], v[180:183], 0
v_mfma_f32_16x16x32_bf16 v[244:247], v[106:109], v[180:183], 0
v_mfma_f32_16x16x32_bf16 v[248:251], v[116:119], v[180:183], 0
v_rcp_f32 v176, v176
s_nop 4
v_rcp_f32 v184, v184
s_cmp_eq_u32 s46, 0
s_cbranch_scc1 slow_73
.p2align 3
v_pk_mul_f32 v[220:221], v[220:221], v[160:161] op_sel:[0,0] op_sel_hi:[1,0]
v_pk_mul_f32 v[222:223], v[222:223], v[160:161] op_sel:[0,0] op_sel_hi:[1,0]
v_pk_mul_f32 v[224:225], v[224:225], v[160:161] op_sel:[0,0] op_sel_hi:[1,0]
v_pk_mul_f32 v[226:227], v[226:227], v[160:161] op_sel:[0,0] op_sel_hi:[1,0]
v_cvt_pk_bf16_f32 v220, v220, v221
v_cvt_pk_bf16_f32 v221, v222, v223
v_cvt_pk_bf16_f32 v222, v224, v225
v_cvt_pk_bf16_f32 v223, v226, v227
buffer_store_dwordx4 v[220:223], v18, s[32:35], s80 offen sc1
v_pk_mul_f32 v[228:229], v[228:229], v[168:169] op_sel:[0,0] op_sel_hi:[1,0]
v_pk_mul_f32 v[230:231], v[230:231], v[168:169] op_sel:[0,0] op_sel_hi:[1,0]
v_pk_mul_f32 v[232:233], v[232:233], v[168:169] op_sel:[0,0] op_sel_hi:[1,0]
v_pk_mul_f32 v[234:235], v[234:235], v[168:169] op_sel:[0,0] op_sel_hi:[1,0]
v_cvt_pk_bf16_f32 v228, v228, v229
v_cvt_pk_bf16_f32 v229, v230, v231
v_cvt_pk_bf16_f32 v230, v232, v233
v_cvt_pk_bf16_f32 v231, v234, v235
buffer_store_dwordx4 v[228:231], v18, s[32:35], s81 offen sc1
v_pk_mul_f32 v[236:237], v[236:237], v[176:177] op_sel:[0,0] op_sel_hi:[1,0]
v_pk_mul_f32 v[238:239], v[238:239], v[176:177] op_sel:[0,0] op_sel_hi:[1,0]
v_pk_mul_f32 v[240:241], v[240:241], v[176:177] op_sel:[0,0] op_sel_hi:[1,0]
v_pk_mul_f32 v[242:243], v[242:243], v[176:177] op_sel:[0,0] op_sel_hi:[1,0]
v_cvt_pk_bf16_f32 v236, v236, v237
v_cvt_pk_bf16_f32 v237, v238, v239
v_cvt_pk_bf16_f32 v238, v240, v241
v_cvt_pk_bf16_f32 v239, v242, v243
buffer_store_dwordx4 v[236:239], v18, s[32:35], s82 offen sc1
v_pk_mul_f32 v[244:245], v[244:245], v[184:185] op_sel:[0,0] op_sel_hi:[1,0]
v_pk_mul_f32 v[246:247], v[246:247], v[184:185] op_sel:[0,0] op_sel_hi:[1,0]
v_pk_mul_f32 v[248:249], v[248:249], v[184:185] op_sel:[0,0] op_sel_hi:[1,0]
v_pk_mul_f32 v[250:251], v[250:251], v[184:185] op_sel:[0,0] op_sel_hi:[1,0]
v_cvt_pk_bf16_f32 v244, v244, v245
v_cvt_pk_bf16_f32 v245, v246, v247
v_cvt_pk_bf16_f32 v246, v248, v249
v_cvt_pk_bf16_f32 v247, v250, v251
buffer_store_dwordx4 v[244:247], v18, s[32:35], s83 offen sc1
back_74:
s_barrier
v_and_b32 v36, 31, v0
v_lshlrev_b32 v36, 2, v36
s_lshl_b32 s62, s45, 2
v_mov_b32 v4, s62
v_mov_b32 v5, 1
s_mov_b64 exec, 1
s_waitcnt vmcnt(0)
s_cmp_eq_u32 s46, 0
s_cbranch_scc1 slow_75
buffer_store_dword v5, v4, s[32:35], s84 offen
back_76:
s_mov_b64 exec, -1
v_lshrrev_b32 v4, 2, v2
v_and_b32 v5, 3, v0
v_lshl_add_u32 v6, v3, 3, v4
v_lshlrev_b32 v6, 7, v6
v_lshl_add_u32 v6, v5, 3, v6
v_lshrrev_b32 v7, 1, v4
v_and_b32 v8, 1, v3
v_lshl_add_u32 v7, v8, 1, v7
v_lshl_add_u32 v10, v7, 5, v6
v_xor_b32 v11, 32, v10
v_xor_b32 v12, 64, v10
v_xor_b32 v13, 96, v10
v_add_u32 v14, 0x10000, v10
v_add_u32 v15, 0x10000, v11
v_add_u32 v16, 0x10000, v12
v_add_u32 v17, 0x10000, v13
ds_read_b64_tr_b16 v[220:221], v10 offset:0
ds_read_b64_tr_b16 v[222:223], v10 offset:512
ds_read_b64_tr_b16 v[224:225], v11 offset:0
ds_read_b64_tr_b16 v[226:227], v11 offset:512
ds_read_b64_tr_b16 v[228:229], v12 offset:0
ds_read_b64_tr_b16 v[230:231], v12 offset:512
ds_read_b64_tr_b16 v[232:233], v13 offset:0
ds_read_b64_tr_b16 v[234:235], v13 offset:512
ds_read_b64_tr_b16 v[236:237], v10 offset:4096
ds_read_b64_tr_b16 v[238:239], v10 offset:4608
ds_read_b64_tr_b16 v[240:241], v11 offset:4096
ds_read_b64_tr_b16 v[242:243], v11 offset:4608
ds_read_b64_tr_b16 v[244:245], v12 offset:4096
ds_read_b64_tr_b16 v[246:247], v12 offset:4608
ds_read_b64_tr_b16 v[248:249], v13 offset:4096
ds_read_b64_tr_b16 v[250:251], v13 offset:4608
s_lshl_b32 s48, s41, 3
s_lshl_b32 s49, s40, 1
s_add_u32 s48, s48, s49
s_lshl_b32 s48, s48, 15
s_add_u32 s48, s48, 4194304
v_add_u32 v38, s48, v18
v_add_u32 v39, 32768, v38
s_lshl_b32 s57, s75, 11
s_add_u32 s87, s87, 262144
v_lshlrev_b32 v60, 16, v20
v_and_b32 v61, 0xffff0000, v20
v_lshlrev_b32 v62, 16, v21
v_and_b32 v63, 0xffff0000, v21
v_lshlrev_b32 v64, 16, v22
v_and_b32 v65, 0xffff0000, v22
v_lshlrev_b32 v66, 16, v23
v_and_b32 v67, 0xffff0000, v23
v_lshlrev_b32 v68, 16, v24
v_and_b32 v69, 0xffff0000, v24
v_lshlrev_b32 v70, 16, v25
v_and_b32 v71, 0xffff0000, v25
v_lshlrev_b32 v72, 16, v26
v_and_b32 v73, 0xffff0000, v26
v_lshlrev_b32 v74, 16, v27
v_and_b32 v75, 0xffff0000, v27
v_lshlrev_b32 v76, 16, v28
v_and_b32 v77, 0xffff0000, v28
v_lshlrev_b32 v78, 16, v29
v_and_b32 v79, 0xffff0000, v29
v_lshlrev_b32 v80, 16, v30
v_and_b32 v81, 0xffff0000, v30
v_lshlrev_b32 v82, 16, v31
v_and_b32 v83, 0xffff0000, v31
v_lshlrev_b32 v84, 16, v32
v_and_b32 v85, 0xffff0000, v32
v_lshlrev_b32 v86, 16, v33
v_and_b32 v87, 0xffff0000, v33
v_lshlrev_b32 v88, 16, v34
v_and_b32 v89, 0xffff0000, v34
v_lshlrev_b32 v90, 16, v35
v_and_b32 v91, 0xffff0000, v35
v_mov_b32 v6, 0
v_mov_b32 v7, 0
v_mov_b32 v8, 0
v_mov_b32 v9, 0
s_lshl_b32 s62, s42, 2
v_mov_b32 v4, s62
v_mov_b32 v5, 1
buffer_load_dword v37, v36, s[32:35], s84 offen sc1
s_mov_b32 s63, 0
s_waitcnt vmcnt(0)
poll_77:
v_cmp_gt_u32 vcc, 1, v37
s_cbranch_vccz polled_78
buffer_load_dword v37, v36, s[32:35], s84 offen sc1
s_add_u32 s63, s63, 1
s_cmp_lt_u32 s63, 0x80000
s_waitcnt vmcnt(0)
s_cbranch_scc1 poll_77
polled_78:
buffer_load_dwordx4 v[156:159], v38, s[32:35], s57 offen sc1
buffer_load_dwordx4 v[160:163], v39, s[32:35], s57 offen sc1
buffer_load_dwordx4 v[164:167], v38, s[32:35], s57 offen offset:1024 sc1
buffer_load_dwordx4 v[168:171], v39, s[32:35], s57 offen offset:1024 sc1
s_add_u32 s57, s57, 2048
s_and_b32 s57, s57, 0x7fff
buffer_load_dwordx4 v[172:175], v38, s[32:35], s57 offen sc1
buffer_load_dwordx4 v[176:179], v39, s[32:35], s57 offen sc1
buffer_load_dwordx4 v[180:183], v38, s[32:35], s57 offen offset:1024 sc1
buffer_load_dwordx4 v[184:187], v39, s[32:35], s57 offen offset:1024 sc1
s_add_u32 s57, s57, 2048
s_and_b32 s57, s57, 0x7fff
s_waitcnt vmcnt(6) lgkmcnt(8)
v_mfma_f32_16x16x32_bf16 v[60:63], v[220:223], v[156:159], v[60:63]
buffer_load_dwordx4 v[188:191], v38, s[32:35], s57 offen sc1
v_mfma_f32_16x16x32_bf16 v[76:79], v[220:223], v[160:163], v[76:79]
ds_read_b64_tr_b16 v[100:101], v10 offset:8192
ds_read_b64_tr_b16 v[102:103], v10 offset:8704
v_mfma_f32_16x16x32_bf16 v[64:67], v[224:227], v[156:159], v[64:67]
ds_read_b64_tr_b16 v[104:105], v11 offset:8192
ds_read_b64_tr_b16 v[106:107], v11 offset:8704
v_mfma_f32_16x16x32_bf16 v[80:83], v[224:227], v[160:163], v[80:83]
buffer_load_dwordx4 v[192:195], v39, s[32:35], s57 offen sc1
v_mfma_f32_16x16x32_bf16 v[68:71], v[228:231], v[156:159], v[68:71]
ds_read_b64_tr_b16 v[108:109], v12 offset:8192
ds_read_b64_tr_b16 v[110:111], v12 offset:8704
v_mfma_f32_16x16x32_bf16 v[84:87], v[228:231], v[160:163], v[84:87]
ds_read_b64_tr_b16 v[112:113], v13 offset:8192
ds_read_b64_tr_b16 v[114:115], v13 offset:8704
v_mfma_f32_16x16x32_bf16 v[72:75], v[232:235], v[156:159], v[72:75]
v_mfma_f32_16x16x32_bf16 v[88:91], v[232:235], v[160:163], v[88:91]
s_waitcnt vmcnt(6) lgkmcnt(8)
v_mfma_f32_16x16x32_bf16 v[60:63], v[236:239], v[164:167], v[60:63]
buffer_load_dwordx4 v[196:199], v38, s[32:35], s57 offen offset:1024 sc1
v_mfma_f32_16x16x32_bf16 v[76:79], v[236:239], v[168:171], v[76:79]
ds_read_b64_tr_b16 v[220:221], v10 offset:12288
ds_read_b64_tr_b16 v[222:223], v10 offset:12800
v_mfma_f32_16x16x32_bf16 v[64:67], v[240:243], v[164:167], v[64:67]
ds_read_b64_tr_b16 v[224:225], v11 offset:12288
ds_read_b64_tr_b16 v[226:227], v11 offset:12800
v_mfma_f32_16x16x32_bf16 v[80:83], v[240:243], v[168:171], v[80:83]
buffer_load_dwordx4 v[200:203], v39, s[32:35], s57 offen offset:1024 sc1
v_mfma_f32_16x16x32_bf16 v[68:71], v[244:247], v[164:167], v[68:71]
ds_read_b64_tr_b16 v[228:229], v12 offset:12288
ds_read_b64_tr_b16 v[230:231], v12 offset:12800
v_mfma_f32_16x16x32_bf16 v[84:87], v[244:247], v[168:171], v[84:87]
ds_read_b64_tr_b16 v[232:233], v13 offset:12288
ds_read_b64_tr_b16 v[234:235], v13 offset:12800
v_mfma_f32_16x16x32_bf16 v[72:75], v[248:251], v[164:167], v[72:75]
s_add_u32 s57, s57, 2048
s_and_b32 s57, s57, 0x7fff
v_mfma_f32_16x16x32_bf16 v[88:91], v[248:251], v[168:171], v[88:91]
s_waitcnt vmcnt(6) lgkmcnt(8)
v_mfma_f32_16x16x32_bf16 v[60:63], v[100:103], v[172:175], v[60:63]
buffer_load_dwordx4 v[204:207], v38, s[32:35], s57 offen sc1
v_mfma_f32_16x16x32_bf16 v[76:79], v[100:103], v[176:179], v[76:79]
ds_read_b64_tr_b16 v[236:237], v10 offset:16384
ds_read_b64_tr_b16 v[238:239], v10 offset:16896
v_mfma_f32_16x16x32_bf16 v[64:67], v[104:107], v[172:175], v[64:67]
ds_read_b64_tr_b16 v[240:241], v11 offset:16384
ds_read_b64_tr_b16 v[242:243], v11 offset:16896
v_mfma_f32_16x16x32_bf16 v[80:83], v[104:107], v[176:179], v[80:83]
buffer_load_dwordx4 v[208:211], v39, s[32:35], s57 offen sc1
v_mfma_f32_16x16x32_bf16 v[68:71], v[108:111], v[172:175], v[68:71]
ds_read_b64_tr_b16 v[244:245], v12 offset:16384
ds_read_b64_tr_b16 v[246:247], v12 offset:16896
v_mfma_f32_16x16x32_bf16 v[84:87], v[108:111], v[176:179], v[84:87]
ds_read_b64_tr_b16 v[248:249], v13 offset:16384
ds_read_b64_tr_b16 v[250:251], v13 offset:16896
v_mfma_f32_16x16x32_bf16 v[72:75], v[112:115], v[172:175], v[72:75]
v_mfma_f32_16x16x32_bf16 v[88:91], v[112:115], v[176:179], v[88:91]
s_waitcnt vmcnt(6) lgkmcnt(8)
v_mfma_f32_16x16x32_bf16 v[60:63], v[220:223], v[180:183], v[60:63]
buffer_load_dwordx4 v[212:215], v38, s[32:35], s57 offen offset:1024 sc1
v_mfma_f32_16x16x32_bf16 v[76:79], v[220:223], v[184:187], v[76:79]
ds_read_b64_tr_b16 v[100:101], v10 offset:20480
ds_read_b64_tr_b16 v[102:103], v10 offset:20992
v_mfma_f32_16x16x32_bf16 v[64:67], v[224:227], v[180:183], v[64:67]
ds_read_b64_tr_b16 v[104:105], v11 offset:20480
ds_read_b64_tr_b16 v[106:107], v11 offset:20992
v_mfma_f32_16x16x32_bf16 v[80:83], v[224:227], v[184:187], v[80:83]
buffer_load_dwordx4 v[216:219], v39, s[32:35], s57 offen offset:1024 sc1
v_mfma_f32_16x16x32_bf16 v[68:71], v[228:231], v[180:183], v[68:71]
ds_read_b64_tr_b16 v[108:109], v12 offset:20480
ds_read_b64_tr_b16 v[110:111], v12 offset:20992
v_mfma_f32_16x16x32_bf16 v[84:87], v[228:231], v[184:187], v[84:87]
ds_read_b64_tr_b16 v[112:113], v13 offset:20480
ds_read_b64_tr_b16 v[114:115], v13 offset:20992
v_mfma_f32_16x16x32_bf16 v[72:75], v[232:235], v[180:183], v[72:75]
s_add_u32 s57, s57, 2048
s_and_b32 s57, s57, 0x7fff
v_mfma_f32_16x16x32_bf16 v[88:91], v[232:235], v[184:187], v[88:91]
s_waitcnt vmcnt(6) lgkmcnt(8)
v_mfma_f32_16x16x32_bf16 v[60:63], v[236:239], v[188:191], v[60:63]
buffer_load_dwordx4 v[156:159], v38, s[32:35], s57 offen sc1
v_mfma_f32_16x16x32_bf16 v[76:79], v[236:239], v[192:195], v[76:79]
ds_read_b64_tr_b16 v[220:221], v10 offset:24576
ds_read_b64_tr_b16 v[222:223], v10 offset:25088
v_mfma_f32_16x16x32_bf16 v[64:67], v[240:243], v[188:191], v[64:67]
ds_read_b64_tr_b16 v[224:225], v11 offset:24576
ds_read_b64_tr_b16 v[226:227], v11 offset:25088
v_mfma_f32_16x16x32_bf16 v[80:83], v[240:243], v[192:195], v[80:83]
buffer_load_dwordx4 v[160:163], v39, s[32:35], s57 offen sc1
v_mfma_f32_16x16x32_bf16 v[68:71], v[244:247], v[188:191], v[68:71]
ds_read_b64_tr_b16 v[228:229], v12 offset:24576
ds_read_b64_tr_b16 v[230:231], v12 offset:25088
v_mfma_f32_16x16x32_bf16 v[84:87], v[244:247], v[192:195], v[84:87]
ds_read_b64_tr_b16 v[232:233], v13 offset:24576
ds_read_b64_tr_b16 v[234:235], v13 offset:25088
v_mfma_f32_16x16x32_bf16 v[72:75], v[248:251], v[188:191], v[72:75]
v_mfma_f32_16x16x32_bf16 v[88:91], v[248:251], v[192:195], v[88:91]
s_waitcnt vmcnt(6) lgkmcnt(8)
v_mfma_f32_16x16x32_bf16 v[60:63], v[100:103], v[196:199], v[60:63]
buffer_load_dwordx4 v[164:167], v38, s[32:35], s57 offen offset:1024 sc1
v_mfma_f32_16x16x32_bf16 v[76:79], v[100:103], v[200:203], v[76:79]
ds_read_b64_tr_b16 v[236:237], v10 offset:28672
ds_read_b64_tr_b16 v[238:239], v10 offset:29184
v_mfma_f32_16x16x32_bf16 v[64:67], v[104:107], v[196:199], v[64:67]
ds_read_b64_tr_b16 v[240:241], v11 offset:28672
ds_read_b64_tr_b16 v[242:243], v11 offset:29184
v_mfma_f32_16x16x32_bf16 v[80:83], v[104:107], v[200:203], v[80:83]
buffer_load_dwordx4 v[168:171], v39, s[32:35], s57 offen offset:1024 sc1
v_mfma_f32_16x16x32_bf16 v[68:71], v[108:111], v[196:199], v[68:71]
ds_read_b64_tr_b16 v[244:245], v12 offset:28672
ds_read_b64_tr_b16 v[246:247], v12 offset:29184
v_mfma_f32_16x16x32_bf16 v[84:87], v[108:111], v[200:203], v[84:87]
ds_read_b64_tr_b16 v[248:249], v13 offset:28672
ds_read_b64_tr_b16 v[250:251], v13 offset:29184
v_mfma_f32_16x16x32_bf16 v[72:75], v[112:115], v[196:199], v[72:75]
s_add_u32 s57, s57, 2048
s_and_b32 s57, s57, 0x7fff
v_mfma_f32_16x16x32_bf16 v[88:91], v[112:115], v[200:203], v[88:91]
s_waitcnt vmcnt(6) lgkmcnt(8)
v_mfma_f32_16x16x32_bf16 v[60:63], v[220:223], v[204:207], v[60:63]
buffer_load_dwordx4 v[172:175], v38, s[32:35], s57 offen sc1
v_mfma_f32_16x16x32_bf16 v[76:79], v[220:223], v[208:211], v[76:79]
ds_read_b64_tr_b16 v[100:101], v10 offset:32768
ds_read_b64_tr_b16 v[102:103], v10 offset:33280
v_mfma_f32_16x16x32_bf16 v[64:67], v[224:227], v[204:207], v[64:67]
ds_read_b64_tr_b16 v[104:105], v11 offset:32768
ds_read_b64_tr_b16 v[106:107], v11 offset:33280
v_mfma_f32_16x16x32_bf16 v[80:83], v[224:227], v[208:211], v[80:83]
buffer_load_dwordx4 v[176:179], v39, s[32:35], s57 offen sc1
v_mfma_f32_16x16x32_bf16 v[68:71], v[228:231], v[204:207], v[68:71]
ds_read_b64_tr_b16 v[108:109], v12 offset:32768
ds_read_b64_tr_b16 v[110:111], v12 offset:33280
v_mfma_f32_16x16x32_bf16 v[84:87], v[228:231], v[208:211], v[84:87]
ds_read_b64_tr_b16 v[112:113], v13 offset:32768
ds_read_b64_tr_b16 v[114:115], v13 offset:33280
v_mfma_f32_16x16x32_bf16 v[72:75], v[232:235], v[204:207], v[72:75]
v_mfma_f32_16x16x32_bf16 v[88:91], v[232:235], v[208:211], v[88:91]
s_waitcnt vmcnt(6) lgkmcnt(8)
v_mfma_f32_16x16x32_bf16 v[60:63], v[236:239], v[212:215], v[60:63]
buffer_load_dwordx4 v[180:183], v38, s[32:35], s57 offen offset:1024 sc1
v_mfma_f32_16x16x32_bf16 v[76:79], v[236:239], v[216:219], v[76:79]
ds_read_b64_tr_b16 v[220:221], v10 offset:36864
ds_read_b64_tr_b16 v[222:223], v10 offset:37376
v_mfma_f32_16x16x32_bf16 v[64:67], v[240:243], v[212:215], v[64:67]
ds_read_b64_tr_b16 v[224:225], v11 offset:36864
ds_read_b64_tr_b16 v[226:227], v11 offset:37376
v_mfma_f32_16x16x32_bf16 v[80:83], v[240:243], v[216:219], v[80:83]
buffer_load_dwordx4 v[184:187], v39, s[32:35], s57 offen offset:1024 sc1
v_mfma_f32_16x16x32_bf16 v[68:71], v[244:247], v[212:215], v[68:71]
ds_read_b64_tr_b16 v[228:229], v12 offset:36864
ds_read_b64_tr_b16 v[230:231], v12 offset:37376
v_mfma_f32_16x16x32_bf16 v[84:87], v[244:247], v[216:219], v[84:87]
ds_read_b64_tr_b16 v[232:233], v13 offset:36864
ds_read_b64_tr_b16 v[234:235], v13 offset:37376
v_mfma_f32_16x16x32_bf16 v[72:75], v[248:251], v[212:215], v[72:75]
s_add_u32 s57, s57, 2048
s_and_b32 s57, s57, 0x7fff
v_mfma_f32_16x16x32_bf16 v[88:91], v[248:251], v[216:219], v[88:91]
s_waitcnt vmcnt(6) lgkmcnt(8)
v_mfma_f32_16x16x32_bf16 v[60:63], v[100:103], v[156:159], v[60:63]
buffer_load_dwordx4 v[188:191], v38, s[32:35], s57 offen sc1
v_mfma_f32_16x16x32_bf16 v[76:79], v[100:103], v[160:163], v[76:79]
ds_read_b64_tr_b16 v[236:237], v10 offset:40960
ds_read_b64_tr_b16 v[238:239], v10 offset:41472
v_mfma_f32_16x16x32_bf16 v[64:67], v[104:107], v[156:159], v[64:67]
ds_read_b64_tr_b16 v[240:241], v11 offset:40960
ds_read_b64_tr_b16 v[242:243], v11 offset:41472
v_mfma_f32_16x16x32_bf16 v[80:83], v[104:107], v[160:163], v[80:83]
buffer_load_dwordx4 v[192:195], v39, s[32:35], s57 offen sc1
v_mfma_f32_16x16x32_bf16 v[68:71], v[108:111], v[156:159], v[68:71]
ds_read_b64_tr_b16 v[244:245], v12 offset:40960
ds_read_b64_tr_b16 v[246:247], v12 offset:41472
v_mfma_f32_16x16x32_bf16 v[84:87], v[108:111], v[160:163], v[84:87]
ds_read_b64_tr_b16 v[248:249], v13 offset:40960
ds_read_b64_tr_b16 v[250:251], v13 offset:41472
v_mfma_f32_16x16x32_bf16 v[72:75], v[112:115], v[156:159], v[72:75]
v_mfma_f32_16x16x32_bf16 v[88:91], v[112:115], v[160:163], v[88:91]
s_waitcnt vmcnt(6) lgkmcnt(8)
v_mfma_f32_16x16x32_bf16 v[60:63], v[220:223], v[164:167], v[60:63]
buffer_load_dwordx4 v[196:199], v38, s[32:35], s57 offen offset:1024 sc1
v_mfma_f32_16x16x32_bf16 v[76:79], v[220:223], v[168:171], v[76:79]
ds_read_b64_tr_b16 v[100:101], v10 offset:45056
ds_read_b64_tr_b16 v[102:103], v10 offset:45568
v_mfma_f32_16x16x32_bf16 v[64:67], v[224:227], v[164:167], v[64:67]
ds_read_b64_tr_b16 v[104:105], v11 offset:45056
ds_read_b64_tr_b16 v[106:107], v11 offset:45568
v_mfma_f32_16x16x32_bf16 v[80:83], v[224:227], v[168:171], v[80:83]
buffer_load_dwordx4 v[200:203], v39, s[32:35], s57 offen offset:1024 sc1
v_mfma_f32_16x16x32_bf16 v[68:71], v[228:231], v[164:167], v[68:71]
ds_read_b64_tr_b16 v[108:109], v12 offset:45056
ds_read_b64_tr_b16 v[110:111], v12 offset:45568
v_mfma_f32_16x16x32_bf16 v[84:87], v[228:231], v[168:171], v[84:87]
ds_read_b64_tr_b16 v[112:113], v13 offset:45056
ds_read_b64_tr_b16 v[114:115], v13 offset:45568
v_mfma_f32_16x16x32_bf16 v[72:75], v[232:235], v[164:167], v[72:75]
s_add_u32 s57, s57, 2048
s_and_b32 s57, s57, 0x7fff
v_mfma_f32_16x16x32_bf16 v[88:91], v[232:235], v[168:171], v[88:91]
s_waitcnt vmcnt(6) lgkmcnt(8)
v_mfma_f32_16x16x32_bf16 v[60:63], v[236:239], v[172:175], v[60:63]
buffer_load_dwordx4 v[204:207], v38, s[32:35], s57 offen sc1
v_mfma_f32_16x16x32_bf16 v[76:79], v[236:239], v[176:179], v[76:79]
ds_read_b64_tr_b16 v[220:221], v10 offset:49152
ds_read_b64_tr_b16 v[222:223], v10 offset:49664
v_mfma_f32_16x16x32_bf16 v[64:67], v[240:243], v[172:175], v[64:67]
ds_read_b64_tr_b16 v[224:225], v11 offset:49152
ds_read_b64_tr_b16 v[226:227], v11 offset:49664
v_mfma_f32_16x16x32_bf16 v[80:83], v[240:243], v[176:179], v[80:83]
buffer_load_dwordx4 v[208:211], v39, s[32:35], s57 offen sc1
v_mfma_f32_16x16x32_bf16 v[68:71], v[244:247], v[172:175], v[68:71]
ds_read_b64_tr_b16 v[228:229], v12 offset:49152
ds_read_b64_tr_b16 v[230:231], v12 offset:49664
v_mfma_f32_16x16x32_bf16 v[84:87], v[244:247], v[176:179], v[84:87]
ds_read_b64_tr_b16 v[232:233], v13 offset:49152
ds_read_b64_tr_b16 v[234:235], v13 offset:49664
v_mfma_f32_16x16x32_bf16 v[72:75], v[248:251], v[172:175], v[72:75]
v_mfma_f32_16x16x32_bf16 v[88:91], v[248:251], v[176:179], v[88:91]
s_waitcnt vmcnt(6) lgkmcnt(8)
v_mfma_f32_16x16x32_bf16 v[60:63], v[100:103], v[180:183], v[60:63]
buffer_load_dwordx4 v[212:215], v38, s[32:35], s57 offen offset:1024 sc1
v_mfma_f32_16x16x32_bf16 v[76:79], v[100:103], v[184:187], v[76:79]
ds_read_b64_tr_b16 v[236:237], v10 offset:53248
ds_read_b64_tr_b16 v[238:239], v10 offset:53760
v_mfma_f32_16x16x32_bf16 v[64:67], v[104:107], v[180:183], v[64:67]
ds_read_b64_tr_b16 v[240:241], v11 offset:53248
ds_read_b64_tr_b16 v[242:243], v11 offset:53760
v_mfma_f32_16x16x32_bf16 v[80:83], v[104:107], v[184:187], v[80:83]
buffer_load_dwordx4 v[216:219], v39, s[32:35], s57 offen offset:1024 sc1
v_mfma_f32_16x16x32_bf16 v[68:71], v[108:111], v[180:183], v[68:71]
ds_read_b64_tr_b16 v[244:245], v12 offset:53248
ds_read_b64_tr_b16 v[246:247], v12 offset:53760
v_mfma_f32_16x16x32_bf16 v[84:87], v[108:111], v[184:187], v[84:87]
ds_read_b64_tr_b16 v[248:249], v13 offset:53248
ds_read_b64_tr_b16 v[250:251], v13 offset:53760
v_mfma_f32_16x16x32_bf16 v[72:75], v[112:115], v[180:183], v[72:75]
s_add_u32 s57, s57, 2048
s_and_b32 s57, s57, 0x7fff
v_mfma_f32_16x16x32_bf16 v[88:91], v[112:115], v[184:187], v[88:91]
s_waitcnt vmcnt(6) lgkmcnt(8)
v_mfma_f32_16x16x32_bf16 v[60:63], v[220:223], v[188:191], v[60:63]
buffer_load_dwordx4 v[156:159], v38, s[32:35], s57 offen sc1
v_mfma_f32_16x16x32_bf16 v[76:79], v[220:223], v[192:195], v[76:79]
ds_read_b64_tr_b16 v[100:101], v10 offset:57344
ds_read_b64_tr_b16 v[102:103], v10 offset:57856
v_mfma_f32_16x16x32_bf16 v[64:67], v[224:227], v[188:191], v[64:67]
ds_read_b64_tr_b16 v[104:105], v11 offset:57344
ds_read_b64_tr_b16 v[106:107], v11 offset:57856
v_mfma_f32_16x16x32_bf16 v[80:83], v[224:227], v[192:195], v[80:83]
buffer_load_dwordx4 v[160:163], v39, s[32:35], s57 offen sc1
v_mfma_f32_16x16x32_bf16 v[68:71], v[228:231], v[188:191], v[68:71]
ds_read_b64_tr_b16 v[108:109], v12 offset:57344
ds_read_b64_tr_b16 v[110:111], v12 offset:57856
v_mfma_f32_16x16x32_bf16 v[84:87], v[228:231], v[192:195], v[84:87]
ds_read_b64_tr_b16 v[112:113], v13 offset:57344
ds_read_b64_tr_b16 v[114:115], v13 offset:57856
v_mfma_f32_16x16x32_bf16 v[72:75], v[232:235], v[188:191], v[72:75]
v_mfma_f32_16x16x32_bf16 v[88:91], v[232:235], v[192:195], v[88:91]
s_waitcnt vmcnt(6) lgkmcnt(8)
v_mfma_f32_16x16x32_bf16 v[60:63], v[236:239], v[196:199], v[60:63]
buffer_load_dwordx4 v[164:167], v38, s[32:35], s57 offen offset:1024 sc1
v_mfma_f32_16x16x32_bf16 v[76:79], v[236:239], v[200:203], v[76:79]
ds_read_b64_tr_b16 v[220:221], v10 offset:61440
ds_read_b64_tr_b16 v[222:223], v10 offset:61952
v_mfma_f32_16x16x32_bf16 v[64:67], v[240:243], v[196:199], v[64:67]
ds_read_b64_tr_b16 v[224:225], v11 offset:61440
ds_read_b64_tr_b16 v[226:227], v11 offset:61952
v_mfma_f32_16x16x32_bf16 v[80:83], v[240:243], v[200:203], v[80:83]
buffer_load_dwordx4 v[168:171], v39, s[32:35], s57 offen offset:1024 sc1
v_mfma_f32_16x16x32_bf16 v[68:71], v[244:247], v[196:199], v[68:71]
ds_read_b64_tr_b16 v[228:229], v12 offset:61440
ds_read_b64_tr_b16 v[230:231], v12 offset:61952
v_mfma_f32_16x16x32_bf16 v[84:87], v[244:247], v[200:203], v[84:87]
ds_read_b64_tr_b16 v[232:233], v13 offset:61440
ds_read_b64_tr_b16 v[234:235], v13 offset:61952
v_mfma_f32_16x16x32_bf16 v[72:75], v[248:251], v[196:199], v[72:75]
s_add_u32 s57, s57, 2048
s_and_b32 s57, s57, 0x7fff
v_mfma_f32_16x16x32_bf16 v[88:91], v[248:251], v[200:203], v[88:91]
s_waitcnt vmcnt(6) lgkmcnt(8)
v_mfma_f32_16x16x32_bf16 v[60:63], v[100:103], v[204:207], v[60:63]
buffer_load_dwordx4 v[172:175], v38, s[32:35], s57 offen sc1
v_mfma_f32_16x16x32_bf16 v[76:79], v[100:103], v[208:211], v[76:79]
ds_read_b64_tr_b16 v[236:237], v14 offset:0
ds_read_b64_tr_b16 v[238:239], v14 offset:512
v_mfma_f32_16x16x32_bf16 v[64:67], v[104:107], v[204:207], v[64:67]
ds_read_b64_tr_b16 v[240:241], v15 offset:0
ds_read_b64_tr_b16 v[242:243], v15 offset:512
v_mfma_f32_16x16x32_bf16 v[80:83], v[104:107], v[208:211], v[80:83]
buffer_load_dwordx4 v[176:179], v39, s[32:35], s57 offen sc1
v_mfma_f32_16x16x32_bf16 v[68:71], v[108:111], v[204:207], v[68:71]
ds_read_b64_tr_b16 v[244:245], v16 offset:0
ds_read_b64_tr_b16 v[246:247], v16 offset:512
v_mfma_f32_16x16x32_bf16 v[84:87], v[108:111], v[208:211], v[84:87]
ds_read_b64_tr_b16 v[248:249], v17 offset:0
ds_read_b64_tr_b16 v[250:251], v17 offset:512
v_mfma_f32_16x16x32_bf16 v[72:75], v[112:115], v[204:207], v[72:75]
v_mfma_f32_16x16x32_bf16 v[88:91], v[112:115], v[208:211], v[88:91]
s_waitcnt vmcnt(6) lgkmcnt(8)
v_mfma_f32_16x16x32_bf16 v[60:63], v[220:223], v[212:215], v[60:63]
buffer_load_dwordx4 v[180:183], v38, s[32:35], s57 offen offset:1024 sc1
v_mfma_f32_16x16x32_bf16 v[76:79], v[220:223], v[216:219], v[76:79]
ds_read_b64_tr_b16 v[100:101], v14 offset:4096
ds_read_b64_tr_b16 v[102:103], v14 offset:4608
v_mfma_f32_16x16x32_bf16 v[64:67], v[224:227], v[212:215], v[64:67]
ds_read_b64_tr_b16 v[104:105], v15 offset:4096
ds_read_b64_tr_b16 v[106:107], v15 offset:4608
v_mfma_f32_16x16x32_bf16 v[80:83], v[224:227], v[216:219], v[80:83]
buffer_load_dwordx4 v[184:187], v39, s[32:35], s57 offen offset:1024 sc1
v_mfma_f32_16x16x32_bf16 v[68:71], v[228:231], v[212:215], v[68:71]
ds_read_b64_tr_b16 v[108:109], v16 offset:4096
ds_read_b64_tr_b16 v[110:111], v16 offset:4608
v_mfma_f32_16x16x32_bf16 v[84:87], v[228:231], v[216:219], v[84:87]
ds_read_b64_tr_b16 v[112:113], v17 offset:4096
ds_read_b64_tr_b16 v[114:115], v17 offset:4608
v_mfma_f32_16x16x32_bf16 v[72:75], v[232:235], v[212:215], v[72:75]
s_add_u32 s57, s57, 2048
s_and_b32 s57, s57, 0x7fff
v_mfma_f32_16x16x32_bf16 v[88:91], v[232:235], v[216:219], v[88:91]
s_waitcnt vmcnt(6) lgkmcnt(8)
v_mfma_f32_16x16x32_bf16 v[60:63], v[236:239], v[156:159], v[60:63]
buffer_load_dwordx4 v[188:191], v38, s[32:35], s57 offen sc1
v_mfma_f32_16x16x32_bf16 v[76:79], v[236:239], v[160:163], v[76:79]
ds_read_b64_tr_b16 v[220:221], v14 offset:8192
ds_read_b64_tr_b16 v[222:223], v14 offset:8704
v_mfma_f32_16x16x32_bf16 v[64:67], v[240:243], v[156:159], v[64:67]
ds_read_b64_tr_b16 v[224:225], v15 offset:8192
ds_read_b64_tr_b16 v[226:227], v15 offset:8704
v_mfma_f32_16x16x32_bf16 v[80:83], v[240:243], v[160:163], v[80:83]
buffer_load_dwordx4 v[192:195], v39, s[32:35], s57 offen sc1
v_mfma_f32_16x16x32_bf16 v[68:71], v[244:247], v[156:159], v[68:71]
ds_read_b64_tr_b16 v[228:229], v16 offset:8192
ds_read_b64_tr_b16 v[230:231], v16 offset:8704
v_mfma_f32_16x16x32_bf16 v[84:87], v[244:247], v[160:163], v[84:87]
ds_read_b64_tr_b16 v[232:233], v17 offset:8192
ds_read_b64_tr_b16 v[234:235], v17 offset:8704
v_mfma_f32_16x16x32_bf16 v[72:75], v[248:251], v[156:159], v[72:75]
v_mfma_f32_16x16x32_bf16 v[88:91], v[248:251], v[160:163], v[88:91]
s_waitcnt vmcnt(6) lgkmcnt(8)
v_mfma_f32_16x16x32_bf16 v[60:63], v[100:103], v[164:167], v[60:63]
buffer_load_dwordx4 v[196:199], v38, s[32:35], s57 offen offset:1024 sc1
v_mfma_f32_16x16x32_bf16 v[76:79], v[100:103], v[168:171], v[76:79]
ds_read_b64_tr_b16 v[236:237], v14 offset:12288
ds_read_b64_tr_b16 v[238:239], v14 offset:12800
v_mfma_f32_16x16x32_bf16 v[64:67], v[104:107], v[164:167], v[64:67]
ds_read_b64_tr_b16 v[240:241], v15 offset:12288
ds_read_b64_tr_b16 v[242:243], v15 offset:12800
v_mfma_f32_16x16x32_bf16 v[80:83], v[104:107], v[168:171], v[80:83]
buffer_load_dwordx4 v[200:203], v39, s[32:35], s57 offen offset:1024 sc1
v_mfma_f32_16x16x32_bf16 v[68:71], v[108:111], v[164:167], v[68:71]
ds_read_b64_tr_b16 v[244:245], v16 offset:12288
ds_read_b64_tr_b16 v[246:247], v16 offset:12800
v_mfma_f32_16x16x32_bf16 v[84:87], v[108:111], v[168:171], v[84:87]
ds_read_b64_tr_b16 v[248:249], v17 offset:12288
ds_read_b64_tr_b16 v[250:251], v17 offset:12800
v_mfma_f32_16x16x32_bf16 v[72:75], v[112:115], v[164:167], v[72:75]
s_add_u32 s57, s57, 2048
s_and_b32 s57, s57, 0x7fff
v_mfma_f32_16x16x32_bf16 v[88:91], v[112:115], v[168:171], v[88:91]
s_waitcnt vmcnt(6) lgkmcnt(8)
v_mfma_f32_16x16x32_bf16 v[60:63], v[220:223], v[172:175], v[60:63]
buffer_load_dwordx4 v[204:207], v38, s[32:35], s57 offen sc1
v_mfma_f32_16x16x32_bf16 v[76:79], v[220:223], v[176:179], v[76:79]
ds_read_b64_tr_b16 v[100:101], v14 offset:16384
ds_read_b64_tr_b16 v[102:103], v14 offset:16896
v_mfma_f32_16x16x32_bf16 v[64:67], v[224:227], v[172:175], v[64:67]
ds_read_b64_tr_b16 v[104:105], v15 offset:16384
ds_read_b64_tr_b16 v[106:107], v15 offset:16896
v_mfma_f32_16x16x32_bf16 v[80:83], v[224:227], v[176:179], v[80:83]
buffer_load_dwordx4 v[208:211], v39, s[32:35], s57 offen sc1
v_mfma_f32_16x16x32_bf16 v[68:71], v[228:231], v[172:175], v[68:71]
ds_read_b64_tr_b16 v[108:109], v16 offset:16384
ds_read_b64_tr_b16 v[110:111], v16 offset:16896
v_mfma_f32_16x16x32_bf16 v[84:87], v[228:231], v[176:179], v[84:87]
ds_read_b64_tr_b16 v[112:113], v17 offset:16384
ds_read_b64_tr_b16 v[114:115], v17 offset:16896
v_mfma_f32_16x16x32_bf16 v[72:75], v[232:235], v[172:175], v[72:75]
v_mfma_f32_16x16x32_bf16 v[88:91], v[232:235], v[176:179], v[88:91]
s_waitcnt vmcnt(6) lgkmcnt(8)
v_mfma_f32_16x16x32_bf16 v[60:63], v[236:239], v[180:183], v[60:63]
buffer_load_dwordx4 v[212:215], v38, s[32:35], s57 offen offset:1024 sc1
v_mfma_f32_16x16x32_bf16 v[76:79], v[236:239], v[184:187], v[76:79]
ds_read_b64_tr_b16 v[220:221], v14 offset:20480
ds_read_b64_tr_b16 v[222:223], v14 offset:20992
v_mfma_f32_16x16x32_bf16 v[64:67], v[240:243], v[180:183], v[64:67]
ds_read_b64_tr_b16 v[224:225], v15 offset:20480
ds_read_b64_tr_b16 v[226:227], v15 offset:20992
v_mfma_f32_16x16x32_bf16 v[80:83], v[240:243], v[184:187], v[80:83]
buffer_load_dwordx4 v[216:219], v39, s[32:35], s57 offen offset:1024 sc1
v_mfma_f32_16x16x32_bf16 v[68:71], v[244:247], v[180:183], v[68:71]
ds_read_b64_tr_b16 v[228:229], v16 offset:20480
ds_read_b64_tr_b16 v[230:231], v16 offset:20992
v_mfma_f32_16x16x32_bf16 v[84:87], v[244:247], v[184:187], v[84:87]
ds_read_b64_tr_b16 v[232:233], v17 offset:20480
ds_read_b64_tr_b16 v[234:235], v17 offset:20992
v_mfma_f32_16x16x32_bf16 v[72:75], v[248:251], v[180:183], v[72:75]
s_add_u32 s57, s57, 2048
s_and_b32 s57, s57, 0x7fff
v_mfma_f32_16x16x32_bf16 v[88:91], v[248:251], v[184:187], v[88:91]
s_waitcnt vmcnt(6) lgkmcnt(8)
v_mfma_f32_16x16x32_bf16 v[60:63], v[100:103], v[188:191], v[60:63]
buffer_load_dwordx4 v[156:159], v38, s[32:35], s57 offen sc1
v_mfma_f32_16x16x32_bf16 v[76:79], v[100:103], v[192:195], v[76:79]
ds_read_b64_tr_b16 v[236:237], v14 offset:24576
ds_read_b64_tr_b16 v[238:239], v14 offset:25088
v_mfma_f32_16x16x32_bf16 v[64:67], v[104:107], v[188:191], v[64:67]
ds_read_b64_tr_b16 v[240:241], v15 offset:24576
ds_read_b64_tr_b16 v[242:243], v15 offset:25088
v_mfma_f32_16x16x32_bf16 v[80:83], v[104:107], v[192:195], v[80:83]
buffer_load_dwordx4 v[160:163], v39, s[32:35], s57 offen sc1
v_mfma_f32_16x16x32_bf16 v[68:71], v[108:111], v[188:191], v[68:71]
ds_read_b64_tr_b16 v[244:245], v16 offset:24576
ds_read_b64_tr_b16 v[246:247], v16 offset:25088
v_mfma_f32_16x16x32_bf16 v[84:87], v[108:111], v[192:195], v[84:87]
ds_read_b64_tr_b16 v[248:249], v17 offset:24576
ds_read_b64_tr_b16 v[250:251], v17 offset:25088
v_mfma_f32_16x16x32_bf16 v[72:75], v[112:115], v[188:191], v[72:75]
v_mfma_f32_16x16x32_bf16 v[88:91], v[112:115], v[192:195], v[88:91]
s_waitcnt vmcnt(6) lgkmcnt(8)
v_mfma_f32_16x16x32_bf16 v[60:63], v[220:223], v[196:199], v[60:63]
buffer_load_dwordx4 v[164:167], v38, s[32:35], s57 offen offset:1024 sc1
v_mfma_f32_16x16x32_bf16 v[76:79], v[220:223], v[200:203], v[76:79]
ds_read_b64_tr_b16 v[100:101], v14 offset:28672
ds_read_b64_tr_b16 v[102:103], v14 offset:29184
v_mfma_f32_16x16x32_bf16 v[64:67], v[224:227], v[196:199], v[64:67]
ds_read_b64_tr_b16 v[104:105], v15 offset:28672
ds_read_b64_tr_b16 v[106:107], v15 offset:29184
v_mfma_f32_16x16x32_bf16 v[80:83], v[224:227], v[200:203], v[80:83]
buffer_load_dwordx4 v[168:171], v39, s[32:35], s57 offen offset:1024 sc1
v_mfma_f32_16x16x32_bf16 v[68:71], v[228:231], v[196:199], v[68:71]
ds_read_b64_tr_b16 v[108:109], v16 offset:28672
ds_read_b64_tr_b16 v[110:111], v16 offset:29184
v_mfma_f32_16x16x32_bf16 v[84:87], v[228:231], v[200:203], v[84:87]
ds_read_b64_tr_b16 v[112:113], v17 offset:28672
ds_read_b64_tr_b16 v[114:115], v17 offset:29184
v_mfma_f32_16x16x32_bf16 v[72:75], v[232:235], v[196:199], v[72:75]
s_add_u32 s57, s57, 2048
s_and_b32 s57, s57, 0x7fff
v_mfma_f32_16x16x32_bf16 v[88:91], v[232:235], v[200:203], v[88:91]
s_waitcnt vmcnt(6) lgkmcnt(8)
v_mfma_f32_16x16x32_bf16 v[60:63], v[236:239], v[204:207], v[60:63]
buffer_load_dwordx4 v[172:175], v38, s[32:35], s57 offen sc1
v_mfma_f32_16x16x32_bf16 v[76:79], v[236:239], v[208:211], v[76:79]
ds_read_b64_tr_b16 v[220:221], v14 offset:32768
ds_read_b64_tr_b16 v[222:223], v14 offset:33280
v_mfma_f32_16x16x32_bf16 v[64:67], v[240:243], v[204:207], v[64:67]
ds_read_b64_tr_b16 v[224:225], v15 offset:32768
ds_read_b64_tr_b16 v[226:227], v15 offset:33280
v_mfma_f32_16x16x32_bf16 v[80:83], v[240:243], v[208:211], v[80:83]
buffer_load_dwordx4 v[176:179], v39, s[32:35], s57 offen sc1
v_mfma_f32_16x16x32_bf16 v[68:71], v[244:247], v[204:207], v[68:71]
ds_read_b64_tr_b16 v[228:229], v16 offset:32768
ds_read_b64_tr_b16 v[230:231], v16 offset:33280
v_mfma_f32_16x16x32_bf16 v[84:87], v[244:247], v[208:211], v[84:87]
ds_read_b64_tr_b16 v[232:233], v17 offset:32768
ds_read_b64_tr_b16 v[234:235], v17 offset:33280
v_mfma_f32_16x16x32_bf16 v[72:75], v[248:251], v[204:207], v[72:75]
v_mfma_f32_16x16x32_bf16 v[88:91], v[248:251], v[208:211], v[88:91]
s_waitcnt vmcnt(6) lgkmcnt(8)
v_mfma_f32_16x16x32_bf16 v[60:63], v[100:103], v[212:215], v[60:63]
buffer_load_dwordx4 v[180:183], v38, s[32:35], s57 offen offset:1024 sc1
v_mfma_f32_16x16x32_bf16 v[76:79], v[100:103], v[216:219], v[76:79]
ds_read_b64_tr_b16 v[236:237], v14 offset:36864
ds_read_b64_tr_b16 v[238:239], v14 offset:37376
v_mfma_f32_16x16x32_bf16 v[64:67], v[104:107], v[212:215], v[64:67]
ds_read_b64_tr_b16 v[240:241], v15 offset:36864
ds_read_b64_tr_b16 v[242:243], v15 offset:37376
v_mfma_f32_16x16x32_bf16 v[80:83], v[104:107], v[216:219], v[80:83]
buffer_load_dwordx4 v[184:187], v39, s[32:35], s57 offen offset:1024 sc1
v_mfma_f32_16x16x32_bf16 v[68:71], v[108:111], v[212:215], v[68:71]
ds_read_b64_tr_b16 v[244:245], v16 offset:36864
ds_read_b64_tr_b16 v[246:247], v16 offset:37376
v_mfma_f32_16x16x32_bf16 v[84:87], v[108:111], v[216:219], v[84:87]
ds_read_b64_tr_b16 v[248:249], v17 offset:36864
ds_read_b64_tr_b16 v[250:251], v17 offset:37376
v_mfma_f32_16x16x32_bf16 v[72:75], v[112:115], v[212:215], v[72:75]
s_add_u32 s57, s57, 2048
s_and_b32 s57, s57, 0x7fff
v_mfma_f32_16x16x32_bf16 v[88:91], v[112:115], v[216:219], v[88:91]
s_waitcnt vmcnt(6) lgkmcnt(8)
v_mfma_f32_16x16x32_bf16 v[60:63], v[220:223], v[156:159], v[60:63]
buffer_load_dwordx4 v[188:191], v38, s[32:35], s57 offen sc1
v_mfma_f32_16x16x32_bf16 v[76:79], v[220:223], v[160:163], v[76:79]
ds_read_b64_tr_b16 v[100:101], v14 offset:40960
ds_read_b64_tr_b16 v[102:103], v14 offset:41472
v_mfma_f32_16x16x32_bf16 v[64:67], v[224:227], v[156:159], v[64:67]
ds_read_b64_tr_b16 v[104:105], v15 offset:40960
ds_read_b64_tr_b16 v[106:107], v15 offset:41472
v_mfma_f32_16x16x32_bf16 v[80:83], v[224:227], v[160:163], v[80:83]
buffer_load_dwordx4 v[192:195], v39, s[32:35], s57 offen sc1
v_mfma_f32_16x16x32_bf16 v[68:71], v[228:231], v[156:159], v[68:71]
ds_read_b64_tr_b16 v[108:109], v16 offset:40960
ds_read_b64_tr_b16 v[110:111], v16 offset:41472
v_mfma_f32_16x16x32_bf16 v[84:87], v[228:231], v[160:163], v[84:87]
ds_read_b64_tr_b16 v[112:113], v17 offset:40960
ds_read_b64_tr_b16 v[114:115], v17 offset:41472
v_mfma_f32_16x16x32_bf16 v[72:75], v[232:235], v[156:159], v[72:75]
v_mfma_f32_16x16x32_bf16 v[88:91], v[232:235], v[160:163], v[88:91]
s_waitcnt vmcnt(6) lgkmcnt(8)
v_mfma_f32_16x16x32_bf16 v[60:63], v[236:239], v[164:167], v[60:63]
buffer_load_dwordx4 v[196:199], v38, s[32:35], s57 offen offset:1024 sc1
v_mfma_f32_16x16x32_bf16 v[76:79], v[236:239], v[168:171], v[76:79]
ds_read_b64_tr_b16 v[220:221], v14 offset:45056
ds_read_b64_tr_b16 v[222:223], v14 offset:45568
v_mfma_f32_16x16x32_bf16 v[64:67], v[240:243], v[164:167], v[64:67]
ds_read_b64_tr_b16 v[224:225], v15 offset:45056
ds_read_b64_tr_b16 v[226:227], v15 offset:45568
v_mfma_f32_16x16x32_bf16 v[80:83], v[240:243], v[168:171], v[80:83]
buffer_load_dwordx4 v[200:203], v39, s[32:35], s57 offen offset:1024 sc1
v_mfma_f32_16x16x32_bf16 v[68:71], v[244:247], v[164:167], v[68:71]
ds_read_b64_tr_b16 v[228:229], v16 offset:45056
ds_read_b64_tr_b16 v[230:231], v16 offset:45568
v_mfma_f32_16x16x32_bf16 v[84:87], v[244:247], v[168:171], v[84:87]
ds_read_b64_tr_b16 v[232:233], v17 offset:45056
ds_read_b64_tr_b16 v[234:235], v17 offset:45568
v_mfma_f32_16x16x32_bf16 v[72:75], v[248:251], v[164:167], v[72:75]
s_add_u32 s57, s57, 2048
s_and_b32 s57, s57, 0x7fff
v_mfma_f32_16x16x32_bf16 v[88:91], v[248:251], v[168:171], v[88:91]
s_waitcnt vmcnt(6) lgkmcnt(8)
v_mfma_f32_16x16x32_bf16 v[60:63], v[100:103], v[172:175], v[60:63]
buffer_load_dwordx4 v[204:207], v38, s[32:35], s57 offen sc1
v_mfma_f32_16x16x32_bf16 v[76:79], v[100:103], v[176:179], v[76:79]
ds_read_b64_tr_b16 v[236:237], v14 offset:49152
ds_read_b64_tr_b16 v[238:239], v14 offset:49664
v_mfma_f32_16x16x32_bf16 v[64:67], v[104:107], v[172:175], v[64:67]
ds_read_b64_tr_b16 v[240:241], v15 offset:49152
ds_read_b64_tr_b16 v[242:243], v15 offset:49664
v_mfma_f32_16x16x32_bf16 v[80:83], v[104:107], v[176:179], v[80:83]
buffer_load_dwordx4 v[208:211], v39, s[32:35], s57 offen sc1
v_mfma_f32_16x16x32_bf16 v[68:71], v[108:111], v[172:175], v[68:71]
ds_read_b64_tr_b16 v[244:245], v16 offset:49152
ds_read_b64_tr_b16 v[246:247], v16 offset:49664
v_mfma_f32_16x16x32_bf16 v[84:87], v[108:111], v[176:179], v[84:87]
ds_read_b64_tr_b16 v[248:249], v17 offset:49152
ds_read_b64_tr_b16 v[250:251], v17 offset:49664
v_mfma_f32_16x16x32_bf16 v[72:75], v[112:115], v[172:175], v[72:75]
v_mfma_f32_16x16x32_bf16 v[88:91], v[112:115], v[176:179], v[88:91]
s_waitcnt vmcnt(6) lgkmcnt(8)
v_mfma_f32_16x16x32_bf16 v[60:63], v[220:223], v[180:183], v[60:63]
buffer_load_dwordx4 v[212:215], v38, s[32:35], s57 offen offset:1024 sc1
v_mfma_f32_16x16x32_bf16 v[76:79], v[220:223], v[184:187], v[76:79]
ds_read_b64_tr_b16 v[100:101], v14 offset:53248
ds_read_b64_tr_b16 v[102:103], v14 offset:53760
v_mfma_f32_16x16x32_bf16 v[64:67], v[224:227], v[180:183], v[64:67]
ds_read_b64_tr_b16 v[104:105], v15 offset:53248
ds_read_b64_tr_b16 v[106:107], v15 offset:53760
v_mfma_f32_16x16x32_bf16 v[80:83], v[224:227], v[184:187], v[80:83]
buffer_load_dwordx4 v[216:219], v39, s[32:35], s57 offen offset:1024 sc1
v_mfma_f32_16x16x32_bf16 v[68:71], v[228:231], v[180:183], v[68:71]
ds_read_b64_tr_b16 v[108:109], v16 offset:53248
ds_read_b64_tr_b16 v[110:111], v16 offset:53760
v_mfma_f32_16x16x32_bf16 v[84:87], v[228:231], v[184:187], v[84:87]
ds_read_b64_tr_b16 v[112:113], v17 offset:53248
ds_read_b64_tr_b16 v[114:115], v17 offset:53760
v_mfma_f32_16x16x32_bf16 v[72:75], v[232:235], v[180:183], v[72:75]
v_mfma_f32_16x16x32_bf16 v[88:91], v[232:235], v[184:187], v[88:91]
s_waitcnt vmcnt(6) lgkmcnt(8)
v_mfma_f32_16x16x32_bf16 v[60:63], v[236:239], v[188:191], v[60:63]
v_mfma_f32_16x16x32_bf16 v[76:79], v[236:239], v[192:195], v[76:79]
ds_read_b64_tr_b16 v[220:221], v14 offset:57344
ds_read_b64_tr_b16 v[222:223], v14 offset:57856
v_mfma_f32_16x16x32_bf16 v[64:67], v[240:243], v[188:191], v[64:67]
ds_read_b64_tr_b16 v[224:225], v15 offset:57344
ds_read_b64_tr_b16 v[226:227], v15 offset:57856
v_mfma_f32_16x16x32_bf16 v[80:83], v[240:243], v[192:195], v[80:83]
v_mfma_f32_16x16x32_bf16 v[68:71], v[244:247], v[188:191], v[68:71]
ds_read_b64_tr_b16 v[228:229], v16 offset:57344
ds_read_b64_tr_b16 v[230:231], v16 offset:57856
v_mfma_f32_16x16x32_bf16 v[84:87], v[244:247], v[192:195], v[84:87]
ds_read_b64_tr_b16 v[232:233], v17 offset:57344
ds_read_b64_tr_b16 v[234:235], v17 offset:57856
v_mfma_f32_16x16x32_bf16 v[72:75], v[248:251], v[188:191], v[72:75]
v_mfma_f32_16x16x32_bf16 v[88:91], v[248:251], v[192:195], v[88:91]
s_waitcnt vmcnt(4) lgkmcnt(8)
v_mfma_f32_16x16x32_bf16 v[60:63], v[100:103], v[196:199], v[60:63]
v_mfma_f32_16x16x32_bf16 v[76:79], v[100:103], v[200:203], v[76:79]
ds_read_b64_tr_b16 v[236:237], v14 offset:61440
ds_read_b64_tr_b16 v[238:239], v14 offset:61952
v_mfma_f32_16x16x32_bf16 v[64:67], v[104:107], v[196:199], v[64:67]
ds_read_b64_tr_b16 v[240:241], v15 offset:61440
ds_read_b64_tr_b16 v[242:243], v15 offset:61952
v_mfma_f32_16x16x32_bf16 v[80:83], v[104:107], v[200:203], v[80:83]
v_mfma_f32_16x16x32_bf16 v[68:71], v[108:111], v[196:199], v[68:71]
ds_read_b64_tr_b16 v[244:245], v16 offset:61440
ds_read_b64_tr_b16 v[246:247], v16 offset:61952
v_mfma_f32_16x16x32_bf16 v[84:87], v[108:111], v[200:203], v[84:87]
ds_read_b64_tr_b16 v[248:249], v17 offset:61440
ds_read_b64_tr_b16 v[250:251], v17 offset:61952
v_mfma_f32_16x16x32_bf16 v[72:75], v[112:115], v[196:199], v[72:75]
v_mfma_f32_16x16x32_bf16 v[88:91], v[112:115], v[200:203], v[88:91]
s_waitcnt vmcnt(2) lgkmcnt(8)
v_mfma_f32_16x16x32_bf16 v[60:63], v[220:223], v[204:207], v[60:63]
v_mfma_f32_16x16x32_bf16 v[76:79], v[220:223], v[208:211], v[76:79]
v_mfma_f32_16x16x32_bf16 v[64:67], v[224:227], v[204:207], v[64:67]
v_mfma_f32_16x16x32_bf16 v[80:83], v[224:227], v[208:211], v[80:83]
v_mfma_f32_16x16x32_bf16 v[68:71], v[228:231], v[204:207], v[68:71]
v_mfma_f32_16x16x32_bf16 v[84:87], v[228:231], v[208:211], v[84:87]
v_mfma_f32_16x16x32_bf16 v[72:75], v[232:235], v[204:207], v[72:75]
v_mfma_f32_16x16x32_bf16 v[88:91], v[232:235], v[208:211], v[88:91]
s_waitcnt vmcnt(0) lgkmcnt(0)
v_mfma_f32_16x16x32_bf16 v[60:63], v[236:239], v[212:215], v[60:63]
v_mfma_f32_16x16x32_bf16 v[64:67], v[240:243], v[212:215], v[64:67]
v_mfma_f32_16x16x32_bf16 v[68:71], v[244:247], v[212:215], v[68:71]
v_mfma_f32_16x16x32_bf16 v[72:75], v[248:251], v[212:215], v[72:75]
v_mfma_f32_16x16x32_bf16 v[76:79], v[236:239], v[216:219], v[76:79]
v_mfma_f32_16x16x32_bf16 v[80:83], v[240:243], v[216:219], v[80:83]
v_mfma_f32_16x16x32_bf16 v[84:87], v[244:247], v[216:219], v[84:87]
v_mfma_f32_16x16x32_bf16 v[88:91], v[248:251], v[216:219], v[88:91]
s_cmp_eq_u32 s46, 0
s_cbranch_scc1 slow_79
s_nop 0
v_cvt_pk_bf16_f32 v20, v60, v61
v_cvt_pk_bf16_f32 v21, v62, v63
v_cvt_pk_bf16_f32 v22, v64, v65
v_cvt_pk_bf16_f32 v23, v66, v67
buffer_store_dwordx4 v[20:23], v18, s[32:35], s85 offen offset:0 sc1
v_cvt_pk_bf16_f32 v24, v68, v69
v_cvt_pk_bf16_f32 v25, v70, v71
v_cvt_pk_bf16_f32 v26, v72, v73
v_cvt_pk_bf16_f32 v27, v74, v75
buffer_store_dwordx4 v[24:27], v18, s[32:35], s85 offen offset:1024 sc1
v_cvt_pk_bf16_f32 v28, v76, v77
v_cvt_pk_bf16_f32 v29, v78, v79
v_cvt_pk_bf16_f32 v30, v80, v81
v_cvt_pk_bf16_f32 v31, v82, v83
buffer_store_dwordx4 v[28:31], v18, s[32:35], s86 offen offset:0 sc1
v_cvt_pk_bf16_f32 v32, v84, v85
v_cvt_pk_bf16_f32 v33, v86, v87
v_cvt_pk_bf16_f32 v34, v88, v89
v_cvt_pk_bf16_f32 v35, v90, v91
buffer_store_dwordx4 v[32:35], v18, s[32:35], s86 offen offset:1024 sc1
s_barrier
v_dot2c_f32_bf16 v6, v20, v48
v_dot2c_f32_bf16 v8, v20, v20
v_dot2c_f32_bf16 v7, v28, v48
v_dot2c_f32_bf16 v9, v28, v28
v_dot2c_f32_bf16 v6, v21, v48
v_dot2c_f32_bf16 v8, v21, v21
v_dot2c_f32_bf16 v7, v29, v48
v_dot2c_f32_bf16 v9, v29, v29
v_dot2c_f32_bf16 v6, v22, v48
v_dot2c_f32_bf16 v8, v22, v22
v_dot2c_f32_bf16 v7, v30, v48
v_dot2c_f32_bf16 v9, v30, v30
v_dot2c_f32_bf16 v6, v23, v48
v_dot2c_f32_bf16 v8, v23, v23
v_dot2c_f32_bf16 v7, v31, v48
v_dot2c_f32_bf16 v9, v31, v31
v_dot2c_f32_bf16 v6, v24, v48
v_dot2c_f32_bf16 v8, v24, v24
v_dot2c_f32_bf16 v7, v32, v48
v_dot2c_f32_bf16 v9, v32, v32
v_dot2c_f32_bf16 v6, v25, v48
v_dot2c_f32_bf16 v8, v25, v25
v_dot2c_f32_bf16 v7, v33, v48
v_dot2c_f32_bf16 v9, v33, v33
v_dot2c_f32_bf16 v6, v26, v48
v_dot2c_f32_bf16 v8, v26, v26
v_dot2c_f32_bf16 v7, v34, v48
v_dot2c_f32_bf16 v9, v34, v34
v_dot2c_f32_bf16 v6, v27, v48
v_dot2c_f32_bf16 v8, v27, v27
v_dot2c_f32_bf16 v7, v35, v48
v_dot2c_f32_bf16 v9, v35, v35
s_mov_b64 exec, 1
s_waitcnt vmcnt(0)
buffer_store_dword v5, v4, s[32:35], s88 offen
s_mov_b64 exec, -1
s_nop 1
v_permlane32_swap_b32 v6, v7
v_permlane32_swap_b32 v8, v9
v_add_f32 v6, v6, v7
v_add_f32 v8, v8, v9
s_nop 1
v_permlane16_swap_b32 v6, v8
s_nop 0
v_add_f32 v6, v6, v8
buffer_store_dword v6, v1, s[32:35], s87 offen
back_80:
s_lshl_b32 s49, s44, 13
v_add_u32 v10, s49, v18
v_add_u32 v11, 1024, v10
s_lshl_b32 s48, s43, 1
v_lshrrev_b32 v4, 2, v2
v_and_b32 v5, 3, v0
v_lshl_add_u32 v6, v3, 3, v4
v_lshlrev_b32 v6, 7, v6
v_lshl_add_u32 v6, v5, 3, v6
v_lshrrev_b32 v7, 1, v4
v_and_b32 v8, 1, v3
v_lshl_add_u32 v7, v8, 1, v7
v_xor_b32 v7, s48, v7
v_lshl_add_u32 v12, v7, 5, v6
v_add_u32 v12, 16384, v12
v_xor_b32 v13, 32, v12
v_mov_b32 v14, v10
v_mov_b32 v15, v11
v_add_u32 v16, 122880, v12
v_add_u32 v17, 122880, v13
v_mov_b32 v156, 0
v_mov_b32 v157, 0
v_mov_b32 v158, 0
v_mov_b32 v159, 0
v_mov_b32 v160, 0
v_mov_b32 v161, 0
v_mov_b32 v162, 0
v_mov_b32 v163, 0
v_mov_b32 v164, 0
v_mov_b32 v165, 0
v_mov_b32 v166, 0
v_mov_b32 v167, 0
v_mov_b32 v168, 0
v_mov_b32 v169, 0
v_mov_b32 v170, 0
v_mov_b32 v171, 0
v_mov_b32 v172, 0
v_mov_b32 v173, 0
v_mov_b32 v174, 0
v_mov_b32 v175, 0
v_mov_b32 v176, 0
v_mov_b32 v177, 0
v_mov_b32 v178, 0
v_mov_b32 v179, 0
v_mov_b32 v180, 0
v_mov_b32 v181, 0
v_mov_b32 v182, 0
v_mov_b32 v183, 0
v_mov_b32 v184, 0
v_mov_b32 v185, 0
v_mov_b32 v186, 0
v_mov_b32 v187, 0
v_mov_b32 v188, 0
v_mov_b32 v189, 0
v_mov_b32 v190, 0
v_mov_b32 v191, 0
v_mov_b32 v192, 0
v_mov_b32 v193, 0
v_mov_b32 v194, 0
v_mov_b32 v195, 0
v_mov_b32 v196, 0
v_mov_b32 v197, 0
v_mov_b32 v198, 0
v_mov_b32 v199, 0
v_mov_b32 v200, 0
v_mov_b32 v201, 0
v_mov_b32 v202, 0
v_mov_b32 v203, 0
v_mov_b32 v204, 0
v_mov_b32 v205, 0
v_mov_b32 v206, 0
v_mov_b32 v207, 0
v_mov_b32 v208, 0
v_mov_b32 v209, 0
v_mov_b32 v210, 0
v_mov_b32 v211, 0
v_mov_b32 v212, 0
v_mov_b32 v213, 0
v_mov_b32 v214, 0
v_mov_b32 v215, 0
v_mov_b32 v216, 0
v_mov_b32 v217, 0
v_mov_b32 v218, 0
v_mov_b32 v219, 0
v_mov_b32 v220, 0
v_mov_b32 v221, 0
v_mov_b32 v222, 0
v_mov_b32 v223, 0
v_mov_b32 v224, 0
v_mov_b32 v225, 0
v_mov_b32 v226, 0
v_mov_b32 v227, 0
v_mov_b32 v228, 0
v_mov_b32 v229, 0
v_mov_b32 v230, 0
v_mov_b32 v231, 0
v_mov_b32 v232, 0
v_mov_b32 v233, 0
v_mov_b32 v234, 0
v_mov_b32 v235, 0
v_mov_b32 v236, 0
v_mov_b32 v237, 0
v_mov_b32 v238, 0
v_mov_b32 v239, 0
v_mov_b32 v240, 0
v_mov_b32 v241, 0
v_mov_b32 v242, 0
v_mov_b32 v243, 0
v_mov_b32 v244, 0
v_mov_b32 v245, 0
v_mov_b32 v246, 0
v_mov_b32 v247, 0
v_mov_b32 v248, 0
v_mov_b32 v249, 0
v_mov_b32 v250, 0
v_mov_b32 v251, 0
v_lshrrev_b32 v6, 2, v2
v_cmp_eq_u32 vcc, v6, v3
v_and_b32 v7, 1, v0
v_lshlrev_b32 v7, 4, v7
v_mov_b32 v8, 0x3f80
v_lshlrev_b32 v9, v7, v8
v_cndmask_b32 v7, 0, v9, vcc
v_and_b32 v6, 2, v0
v_cmp_eq_u32 vcc, 0, v6
v_mov_b32 v36, 0
v_mov_b32 v37, 0
v_mov_b32 v40, 0
v_mov_b32 v41, 0
v_cndmask_b32 v38, 0, v7, vcc
v_cndmask_b32 v39, v7, 0, vcc
v_lshrrev_b32 v8, 1, v2
v_cmp_eq_u32 vcc, 0, v8
s_nop 1
v_cndmask_b32 v44, 0, v9, vcc
v_cmp_eq_u32 vcc, 1, v8
s_nop 1
v_cndmask_b32 v45, 0, v9, vcc
v_cmp_eq_u32 vcc, 2, v8
s_nop 1
v_cndmask_b32 v46, 0, v9, vcc
v_cmp_eq_u32 vcc, 3, v8
s_nop 1
v_cndmask_b32 v47, 0, v9, vcc
v_lshrrev_b32 v4, 2, v2
v_lshl_add_u32 v4, v3, 2, v4
v_lshlrev_b32 v4, 6, v4
v_and_b32 v5, 3, v0
v_lshl_add_u32 v4, v5, 3, v4
s_lshl_b32 s48, s43, 11
s_add_u32 s48, s48, 135168
v_add_u32 v53, s48, v4
s_mul_i32 s48, s40, 3072
s_add_u32 s48, s48, 139264
v_add_u32 v42, s48, v18
s_xor_b32 s49, s40, 2
s_mul_i32 s48, s49, 3072
s_add_u32 s48, s48, 139264
v_add_u32 v43, s48, v18
s_lshl_b32 s49, s49, 2
s_add_u32 s49, s49, 134672
v_mov_b32 v19, s49
v_xor_b32 v52, 8, v19
v_lshrrev_b32 v4, 3, v0
v_and_b32 v5, 7, v0
v_lshlrev_b32 v4, 11, v4
v_lshl_add_u32 v55, v5, 4, v4
v_lshlrev_b32 v4, 6, v2
v_lshl_add_u32 v58, v3, 4, v4
v_lshlrev_b32 v4, 4, v2
v_lshl_add_u32 v59, v3, 3, v4
s_mul_i32 s51, s42, 163840
s_add_u32 s51, s51, 9437184
s_lshl_b32 s50, s43, 1
s_add_u32 s50, s50, s44
s_lshl_b32 s48, s50, 15
s_add_u32 s48, s48, s51
s_add_u32 s48, s48, 0
s_lshl_b32 s49, s41, 7
s_add_u32 s53, s48, s49
s_add_u32 s54, s53, 16384
s_lshl_b32 s56, s50, 10
s_add_u32 s56, s56, s51
s_add_u32 s56, s56, 147456
s_xor_b32 s57, s56, 1024
s_lshl_b32 s58, s50, 11
s_add_u32 s58, s58, s51
s_add_u32 s58, s58, 131072
s_xor_b32 s59, s58, 2048
s_add_u32 s79, s58, s49
s_lshl_b32 s50, s41, 11
s_add_u32 s55, s48, s50
s_lshl_b32 s48, s43, 7
s_add_u32 s48, s48, 133888
v_lshl_add_u32 v7, v3, 4, s48
v_lshl_add_u32 v54, v2, 2, s48
s_lshl_b32 s49, s44, 6
v_add_u32 v8, s49, v2
v_lshlrev_b32 v8, 3, v8
v_add_u32 v8, 131072, v8
v_lshl_add_u32 v9, v3, 2, s49
v_lshlrev_b32 v9, 2, v9
v_add_u32 v9, 132096, v9
s_mov_b32 s64, 0
s_mov_b32 s65, 0
s_mov_b32 s66, 0x3fb8aa3b
s_mov_b32 s77, s74
s_add_u32 s77, s77, 4
s_lshl_b32 s50, s42, 2
s_add_u32 s50, s50, s40
s_lshl_b32 s50, s50, 4
s_add_u32 s50, s50, s41
s_lshl_b32 s50, s50, 8
s_add_u32 s52, s50, 18087936
s_barrier
ds_read_b128 v[60:63], v14 offset:0
ds_read_b128 v[64:67], v14 offset:2048
ds_read_b128 v[68:71], v14 offset:4096
ds_read_b128 v[72:75], v14 offset:6144
ds_read_b64_tr_b16 v[84:85], v16 offset:8192
ds_read_b64_tr_b16 v[86:87], v16 offset:8704
ds_read_b64_tr_b16 v[88:89], v17 offset:8192
ds_read_b64_tr_b16 v[90:91], v17 offset:8704
ds_read_b64_tr_b16 v[92:93], v16 offset:16384
ds_read_b64_tr_b16 v[94:95], v16 offset:16896
ds_read_b64_tr_b16 v[96:97], v17 offset:16384
ds_read_b64_tr_b16 v[98:99], v17 offset:16896
ds_read_b64_tr_b16 v[76:77], v16 offset:0
ds_read_b64_tr_b16 v[78:79], v16 offset:512
ds_read_b64_tr_b16 v[80:81], v17 offset:0
ds_read_b64_tr_b16 v[82:83], v17 offset:512
s_waitcnt lgkmcnt(0)
c1_loop:
v_mfma_f32_16x16x32_bf16 v[212:215], v[84:87], v[72:75], v[212:215]
ds_read_b128 v[100:103], v15 offset:0
v_mfma_f32_16x16x32_bf16 v[204:207], v[84:87], v[68:71], v[204:207]
ds_read_b128 v[104:107], v15 offset:2048
v_mfma_f32_16x16x32_bf16 v[196:199], v[84:87], v[64:67], v[196:199]
ds_read_b128 v[108:111], v15 offset:4096
v_mfma_f32_16x16x32_bf16 v[188:191], v[84:87], v[60:63], v[188:191]
ds_read_b128 v[112:115], v15 offset:6144
v_mfma_f32_16x16x32_bf16 v[192:195], v[88:91], v[60:63], v[192:195]
ds_read_b64_tr_b16 v[124:125], v16 offset:12288
v_mfma_f32_16x16x32_bf16 v[200:203], v[88:91], v[64:67], v[200:203]
ds_read_b64_tr_b16 v[126:127], v16 offset:12800
v_mfma_f32_16x16x32_bf16 v[208:211], v[88:91], v[68:71], v[208:211]
ds_read_b64_tr_b16 v[128:129], v17 offset:12288
v_mfma_f32_16x16x32_bf16 v[216:219], v[88:91], v[72:75], v[216:219]
ds_read_b64_tr_b16 v[130:131], v17 offset:12800
v_mfma_f32_16x16x32_bf16 v[244:247], v[72:75], v[92:95], v[244:247]
ds_read_b64_tr_b16 v[132:133], v16 offset:20480
v_mfma_f32_16x16x32_bf16 v[236:239], v[68:71], v[92:95], v[236:239]
ds_read_b64_tr_b16 v[134:135], v16 offset:20992
v_mfma_f32_16x16x32_bf16 v[228:231], v[64:67], v[92:95], v[228:231]
ds_read_b64_tr_b16 v[136:137], v17 offset:20480
v_mfma_f32_16x16x32_bf16 v[220:223], v[60:63], v[92:95], v[220:223]
ds_read_b64_tr_b16 v[138:139], v17 offset:20992
v_mfma_f32_16x16x32_bf16 v[224:227], v[60:63], v[96:99], v[224:227]
ds_read_b64_tr_b16 v[116:117], v16 offset:4096
v_mfma_f32_16x16x32_bf16 v[232:235], v[64:67], v[96:99], v[232:235]
ds_read_b64_tr_b16 v[118:119], v16 offset:4608
v_mfma_f32_16x16x32_bf16 v[240:243], v[68:71], v[96:99], v[240:243]
ds_read_b64_tr_b16 v[120:121], v17 offset:4096
v_mfma_f32_16x16x32_bf16 v[248:251], v[72:75], v[96:99], v[248:251]
ds_read_b64_tr_b16 v[122:123], v17 offset:4608
v_mfma_f32_16x16x32_bf16 v[180:183], v[76:79], v[72:75], v[180:183]
s_cmp_eq_u32 s77, s64
s_cbranch_scc1 c1_hook
c1_hook_ret:
v_mfma_f32_16x16x32_bf16 v[172:175], v[76:79], v[68:71], v[172:175]
s_add_u32 s65, s65, 40960
s_cmp_eq_u32 s65, 122880
v_mfma_f32_16x16x32_bf16 v[164:167], v[76:79], v[64:67], v[164:167]
s_cselect_b32 s65, 0, s65
s_add_u32 s64, s64, 1
v_mfma_f32_16x16x32_bf16 v[156:159], v[76:79], v[60:63], v[156:159]
v_add_u32 v14, s65, v10
v_add_u32 v15, s65, v11
v_mfma_f32_16x16x32_bf16 v[160:163], v[80:83], v[60:63], v[160:163]
v_add_u32 v16, s65, v12
v_add_u32 v17, s65, v13
v_mfma_f32_16x16x32_bf16 v[168:171], v[80:83], v[64:67], v[168:171]
s_cmp_eq_u32 s64, 16
s_cbranch_scc1 c1_last
v_mfma_f32_16x16x32_bf16 v[176:179], v[80:83], v[68:71], v[176:179]
s_waitcnt lgkmcnt(0)
v_mfma_f32_16x16x32_bf16 v[184:187], v[80:83], v[72:75], v[184:187]
s_barrier
v_mfma_f32_16x16x32_bf16 v[212:215], v[124:127], v[112:115], v[212:215]
ds_read_b128 v[60:63], v14 offset:0
v_mfma_f32_16x16x32_bf16 v[204:207], v[124:127], v[108:111], v[204:207]
ds_read_b128 v[64:67], v14 offset:2048
v_mfma_f32_16x16x32_bf16 v[196:199], v[124:127], v[104:107], v[196:199]
ds_read_b128 v[68:71], v14 offset:4096
v_mfma_f32_16x16x32_bf16 v[188:191], v[124:127], v[100:103], v[188:191]
ds_read_b128 v[72:75], v14 offset:6144
v_mfma_f32_16x16x32_bf16 v[192:195], v[128:131], v[100:103], v[192:195]
ds_read_b64_tr_b16 v[84:85], v16 offset:8192
v_mfma_f32_16x16x32_bf16 v[200:203], v[128:131], v[104:107], v[200:203]
ds_read_b64_tr_b16 v[86:87], v16 offset:8704
v_mfma_f32_16x16x32_bf16 v[208:211], v[128:131], v[108:111], v[208:211]
ds_read_b64_tr_b16 v[88:89], v17 offset:8192
v_mfma_f32_16x16x32_bf16 v[216:219], v[128:131], v[112:115], v[216:219]
ds_read_b64_tr_b16 v[90:91], v17 offset:8704
v_mfma_f32_16x16x32_bf16 v[244:247], v[112:115], v[132:135], v[244:247]
ds_read_b64_tr_b16 v[92:93], v16 offset:16384
v_mfma_f32_16x16x32_bf16 v[236:239], v[108:111], v[132:135], v[236:239]
ds_read_b64_tr_b16 v[94:95], v16 offset:16896
v_mfma_f32_16x16x32_bf16 v[228:231], v[104:107], v[132:135], v[228:231]
ds_read_b64_tr_b16 v[96:97], v17 offset:16384
v_mfma_f32_16x16x32_bf16 v[220:223], v[100:103], v[132:135], v[220:223]
ds_read_b64_tr_b16 v[98:99], v17 offset:16896
v_mfma_f32_16x16x32_bf16 v[224:227], v[100:103], v[136:139], v[224:227]
ds_read_b64_tr_b16 v[76:77], v16 offset:0
v_mfma_f32_16x16x32_bf16 v[232:235], v[104:107], v[136:139], v[232:235]
ds_read_b64_tr_b16 v[78:79], v16 offset:512
v_mfma_f32_16x16x32_bf16 v[240:243], v[108:111], v[136:139], v[240:243]
ds_read_b64_tr_b16 v[80:81], v17 offset:0
v_mfma_f32_16x16x32_bf16 v[248:251], v[112:115], v[136:139], v[248:251]
ds_read_b64_tr_b16 v[82:83], v17 offset:512
v_mfma_f32_16x16x32_bf16 v[180:183], v[116:119], v[112:115], v[180:183]
v_mfma_f32_16x16x32_bf16 v[172:175], v[116:119], v[108:111], v[172:175]
v_mfma_f32_16x16x32_bf16 v[164:167], v[116:119], v[104:107], v[164:167]
v_mfma_f32_16x16x32_bf16 v[156:159], v[116:119], v[100:103], v[156:159]
v_mfma_f32_16x16x32_bf16 v[160:163], v[120:123], v[100:103], v[160:163]
v_mfma_f32_16x16x32_bf16 v[168:171], v[120:123], v[104:107], v[168:171]
v_mfma_f32_16x16x32_bf16 v[176:179], v[120:123], v[108:111], v[176:179]
s_waitcnt lgkmcnt(0)
v_mfma_f32_16x16x32_bf16 v[184:187], v[120:123], v[112:115], v[184:187]
s_branch c1_loop
c1_hook:
s_waitcnt lgkmcnt(0)
s_cmp_lg_u32 s44, 0
s_cbranch_scc1 else_81
v_mfma_f32_16x16x32_bf16 v[140:143], v[48:51], v[76:79], 0
v_mfma_f32_16x16x32_bf16 v[144:147], v[48:51], v[84:87], 0
v_mfma_f32_16x16x32_bf16 v[148:151], v[48:51], v[92:95], 0
v_mfma_f32_16x16x32_bf16 v[140:143], v[48:51], v[116:119], v[140:143]
v_mfma_f32_16x16x32_bf16 v[144:147], v[48:51], v[124:127], v[144:147]
v_mfma_f32_16x16x32_bf16 v[148:151], v[48:51], v[132:135], v[148:151]
s_branch fi_82
else_81:
v_mfma_f32_16x16x32_bf16 v[140:143], v[48:51], v[80:83], 0
v_mfma_f32_16x16x32_bf16 v[144:147], v[48:51], v[88:91], 0
v_mfma_f32_16x16x32_bf16 v[148:151], v[48:51], v[96:99], 0
v_mfma_f32_16x16x32_bf16 v[140:143], v[48:51], v[120:123], v[140:143]
v_mfma_f32_16x16x32_bf16 v[144:147], v[48:51], v[128:131], v[144:147]
v_mfma_f32_16x16x32_bf16 v[148:151], v[48:51], v[136:139], v[148:151]
fi_82:
s_nop 4
v_cmp_eq_u32 vcc, 0, v3
v_cmp_eq_u32 s[48:49], 1, v3
s_nop 1
v_cndmask_b32 v4, v148, v144, s[48:49]
v_cndmask_b32 v4, v4, v140, vcc
buffer_store_dword v4, v1, s[32:35], s52 offen sc1
s_branch c1_hook_ret
c1_last:
v_mfma_f32_16x16x32_bf16 v[176:179], v[80:83], v[68:71], v[176:179]
s_waitcnt lgkmcnt(0)
v_mfma_f32_16x16x32_bf16 v[184:187], v[80:83], v[72:75], v[184:187]
v_mfma_f32_16x16x32_bf16 v[212:215], v[124:127], v[112:115], v[212:215]
v_mfma_f32_16x16x32_bf16 v[204:207], v[124:127], v[108:111], v[204:207]
v_mfma_f32_16x16x32_bf16 v[196:199], v[124:127], v[104:107], v[196:199]
v_mfma_f32_16x16x32_bf16 v[188:191], v[124:127], v[100:103], v[188:191]
v_mfma_f32_16x16x32_bf16 v[192:195], v[128:131], v[100:103], v[192:195]
v_mfma_f32_16x16x32_bf16 v[200:203], v[128:131], v[104:107], v[200:203]
v_mfma_f32_16x16x32_bf16 v[208:211], v[128:131], v[108:111], v[208:211]
v_mfma_f32_16x16x32_bf16 v[216:219], v[128:131], v[112:115], v[216:219]
s_barrier
v_mfma_f32_16x16x32_bf16 v[244:247], v[112:115], v[132:135], v[244:247]
ds_read_b128 v[140:143], v7 offset:0
ds_read_b128 v[144:147], v7 offset:64
v_mfma_f32_16x16x32_bf16 v[236:239], v[108:111], v[132:135], v[236:239]
ds_read_b128 v[148:151], v7 offset:256
ds_read_b128 v[152:155], v7 offset:320
v_mfma_f32_16x16x32_bf16 v[228:231], v[104:107], v[132:135], v[228:231]
ds_read_b64 v[92:93], v8 offset:0
ds_read_b64 v[94:95], v8 offset:128
v_mfma_f32_16x16x32_bf16 v[220:223], v[100:103], v[132:135], v[220:223]
ds_read_b64 v[96:97], v8 offset:256
ds_read_b64 v[98:99], v8 offset:384
v_mfma_f32_16x16x32_bf16 v[224:227], v[100:103], v[136:139], v[224:227]
ds_read2_b32 v[56:57], v54 offset0:128 offset1:144
ds_read_b128 v[60:63], v9 offset:0
v_mfma_f32_16x16x32_bf16 v[232:235], v[104:107], v[136:139], v[232:235]
ds_read_b128 v[64:67], v9 offset:64
ds_read_b128 v[68:71], v9 offset:128
v_mfma_f32_16x16x32_bf16 v[240:243], v[108:111], v[136:139], v[240:243]
ds_read_b128 v[72:75], v9 offset:192
ds_read_b128 v[76:79], v9 offset:512
v_mfma_f32_16x16x32_bf16 v[248:251], v[112:115], v[136:139], v[248:251]
ds_read_b128 v[80:83], v9 offset:576
ds_read_b128 v[84:87], v9 offset:640
v_mfma_f32_16x16x32_bf16 v[180:183], v[116:119], v[112:115], v[180:183]
ds_read_b128 v[88:91], v9 offset:704
v_mfma_f32_16x16x32_bf16 v[172:175], v[116:119], v[108:111], v[172:175]
ds_read_b64_tr_b16 v[10:11], v53 offset:0
v_mfma_f32_16x16x32_bf16 v[164:167], v[116:119], v[104:107], v[164:167]
ds_read_b64_tr_b16 v[12:13], v53 offset:1024
v_mfma_f32_16x16x32_bf16 v[156:159], v[116:119], v[100:103], v[156:159]
ds_read_b64_tr_b16 v[14:15], v53 offset:32
v_mfma_f32_16x16x32_bf16 v[160:163], v[120:123], v[100:103], v[160:163]
ds_read_b64_tr_b16 v[16:17], v53 offset:1056
v_mfma_f32_16x16x32_bf16 v[168:171], v[120:123], v[104:107], v[168:171]
v_mfma_f32_16x16x32_bf16 v[176:179], v[120:123], v[108:111], v[176:179]
v_mfma_f32_16x16x32_bf16 v[184:187], v[120:123], v[112:115], v[184:187]
c1_epi:
s_waitcnt lgkmcnt(0)
s_mul_i32 s48, s44, 0x80008000
v_xor_b32 v10, s48, v10
v_xor_b32 v11, s48, v11
v_xor_b32 v12, s48, v12
v_xor_b32 v13, s48, v13
v_xor_b32 v14, s48, v14
v_xor_b32 v15, s48, v15
v_xor_b32 v16, s48, v16
v_xor_b32 v17, s48, v17
v_mul_f32 v128, s66, v92
v_mul_f32 v129, s66, v94
v_mul_f32 v130, s66, v96
v_mul_f32 v131, s66, v98
.p2align 3
v_pk_fma_f32 v[220:221], v[76:77], v[56:57], v[220:221] op_sel:[0,0,0] op_sel_hi:[1,0,1]
v_pk_fma_f32 v[222:223], v[78:79], v[56:57], v[222:223] op_sel:[0,0,0] op_sel_hi:[1,0,1]
v_pk_mul_f32 v[220:221], v[220:221], v[60:61]
v_pk_mul_f32 v[222:223], v[222:223], v[62:63]
v_cvt_pk_bf16_f32 v112, v220, v221
v_cvt_pk_bf16_f32 v113, v222, v223
v_pk_fma_f32 v[228:229], v[80:81], v[56:57], v[228:229] op_sel:[0,0,0] op_sel_hi:[1,0,1]
v_pk_fma_f32 v[230:231], v[82:83], v[56:57], v[230:231] op_sel:[0,0,0] op_sel_hi:[1,0,1]
v_pk_mul_f32 v[228:229], v[228:229], v[64:65]
v_pk_mul_f32 v[230:231], v[230:231], v[66:67]
v_cvt_pk_bf16_f32 v114, v228, v229
v_cvt_pk_bf16_f32 v115, v230, v231
v_pk_fma_f32 v[236:237], v[84:85], v[56:57], v[236:237] op_sel:[0,0,0] op_sel_hi:[1,0,1]
v_pk_fma_f32 v[238:239], v[86:87], v[56:57], v[238:239] op_sel:[0,0,0] op_sel_hi:[1,0,1]
v_pk_mul_f32 v[236:237], v[236:237], v[68:69]
v_pk_mul_f32 v[238:239], v[238:239], v[70:71]
v_cvt_pk_bf16_f32 v116, v236, v237
v_cvt_pk_bf16_f32 v117, v238, v239
v_pk_fma_f32 v[244:245], v[88:89], v[56:57], v[244:245] op_sel:[0,0,0] op_sel_hi:[1,0,1]
v_pk_fma_f32 v[246:247], v[90:91], v[56:57], v[246:247] op_sel:[0,0,0] op_sel_hi:[1,0,1]
v_pk_mul_f32 v[244:245], v[244:245], v[72:73]
v_pk_mul_f32 v[246:247], v[246:247], v[74:75]
v_cvt_pk_bf16_f32 v118, v244, v245
v_cvt_pk_bf16_f32 v119, v246, v247
v_pk_fma_f32 v[224:225], v[76:77], v[56:57], v[224:225] op_sel:[0,1,0] op_sel_hi:[1,1,1]
v_pk_fma_f32 v[226:227], v[78:79], v[56:57], v[226:227] op_sel:[0,1,0] op_sel_hi:[1,1,1]
v_pk_mul_f32 v[224:225], v[224:225], v[60:61]
v_pk_mul_f32 v[226:227], v[226:227], v[62:63]
v_cvt_pk_bf16_f32 v120, v224, v225
v_cvt_pk_bf16_f32 v121, v226, v227
v_pk_fma_f32 v[232:233], v[80:81], v[56:57], v[232:233] op_sel:[0,1,0] op_sel_hi:[1,1,1]
v_pk_fma_f32 v[234:235], v[82:83], v[56:57], v[234:235] op_sel:[0,1,0] op_sel_hi:[1,1,1]
v_pk_mul_f32 v[232:233], v[232:233], v[64:65]
v_pk_mul_f32 v[234:235], v[234:235], v[66:67]
v_cvt_pk_bf16_f32 v122, v232, v233
v_cvt_pk_bf16_f32 v123, v234, v235
v_pk_fma_f32 v[240:241], v[84:85], v[56:57], v[240:241] op_sel:[0,1,0] op_sel_hi:[1,1,1]
v_pk_fma_f32 v[242:243], v[86:87], v[56:57], v[242:243] op_sel:[0,1,0] op_sel_hi:[1,1,1]
v_pk_mul_f32 v[240:241], v[240:241], v[68:69]
v_pk_mul_f32 v[242:243], v[242:243], v[70:71]
v_cvt_pk_bf16_f32 v124, v240, v241
v_cvt_pk_bf16_f32 v125, v242, v243
v_pk_fma_f32 v[248:249], v[88:89], v[56:57], v[248:249] op_sel:[0,1,0] op_sel_hi:[1,1,1]
v_pk_fma_f32 v[250:251], v[90:91], v[56:57], v[250:251] op_sel:[0,1,0] op_sel_hi:[1,1,1]
v_pk_mul_f32 v[248:249], v[248:249], v[72:73]
v_pk_mul_f32 v[250:251], v[250:251], v[74:75]
v_cvt_pk_bf16_f32 v126, v248, v249
v_cvt_pk_bf16_f32 v127, v250, v251
v_pk_fma_f32 v[188:189], v[148:149], v[92:93], v[188:189] op_sel:[0,1,0] op_sel_hi:[1,1,1]
v_pk_fma_f32 v[190:191], v[150:151], v[92:93], v[190:191] op_sel:[0,1,0] op_sel_hi:[1,1,1]
v_pk_fma_f32 v[192:193], v[152:153], v[92:93], v[192:193] op_sel:[0,1,0] op_sel_hi:[1,1,1]
v_pk_fma_f32 v[194:195], v[154:155], v[92:93], v[194:195] op_sel:[0,1,0] op_sel_hi:[1,1,1]
v_cvt_pk_bf16_f32 v188, v188, v189
v_cvt_pk_bf16_f32 v189, v190, v191
v_cvt_pk_bf16_f32 v190, v192, v193
v_cvt_pk_bf16_f32 v191, v194, v195
v_pk_fma_f32 v[196:197], v[148:149], v[94:95], v[196:197] op_sel:[0,1,0] op_sel_hi:[1,1,1]
v_pk_fma_f32 v[198:199], v[150:151], v[94:95], v[198:199] op_sel:[0,1,0] op_sel_hi:[1,1,1]
v_pk_fma_f32 v[200:201], v[152:153], v[94:95], v[200:201] op_sel:[0,1,0] op_sel_hi:[1,1,1]
v_pk_fma_f32 v[202:203], v[154:155], v[94:95], v[202:203] op_sel:[0,1,0] op_sel_hi:[1,1,1]
v_cvt_pk_bf16_f32 v196, v196, v197
v_mfma_f32_16x16x32_bf16 v[60:63], v[10:13], v[188:191], 0
v_cvt_pk_bf16_f32 v197, v198, v199
v_cvt_pk_bf16_f32 v198, v200, v201
v_mfma_f32_16x16x32_bf16 v[64:67], v[14:17], v[188:191], 0
v_cvt_pk_bf16_f32 v199, v202, v203
v_pk_fma_f32 v[204:205], v[148:149], v[96:97], v[204:205] op_sel:[0,1,0] op_sel_hi:[1,1,1]
v_pk_fma_f32 v[206:207], v[150:151], v[96:97], v[206:207] op_sel:[0,1,0] op_sel_hi:[1,1,1]
v_pk_fma_f32 v[208:209], v[152:153], v[96:97], v[208:209] op_sel:[0,1,0] op_sel_hi:[1,1,1]
v_pk_fma_f32 v[210:211], v[154:155], v[96:97], v[210:211] op_sel:[0,1,0] op_sel_hi:[1,1,1]
v_cvt_pk_bf16_f32 v204, v204, v205
v_mfma_f32_16x16x32_bf16 v[68:71], v[10:13], v[196:199], 0
v_cvt_pk_bf16_f32 v205, v206, v207
v_cvt_pk_bf16_f32 v206, v208, v209
v_mfma_f32_16x16x32_bf16 v[72:75], v[14:17], v[196:199], 0
v_cvt_pk_bf16_f32 v207, v210, v211
v_pk_fma_f32 v[212:213], v[148:149], v[98:99], v[212:213] op_sel:[0,1,0] op_sel_hi:[1,1,1]
v_pk_fma_f32 v[214:215], v[150:151], v[98:99], v[214:215] op_sel:[0,1,0] op_sel_hi:[1,1,1]
v_pk_fma_f32 v[216:217], v[152:153], v[98:99], v[216:217] op_sel:[0,1,0] op_sel_hi:[1,1,1]
v_pk_fma_f32 v[218:219], v[154:155], v[98:99], v[218:219] op_sel:[0,1,0] op_sel_hi:[1,1,1]
v_cvt_pk_bf16_f32 v212, v212, v213
v_mfma_f32_16x16x32_bf16 v[76:79], v[10:13], v[204:207], 0
v_cvt_pk_bf16_f32 v213, v214, v215
v_cvt_pk_bf16_f32 v214, v216, v217
v_mfma_f32_16x16x32_bf16 v[80:83], v[14:17], v[204:207], 0
v_cvt_pk_bf16_f32 v215, v218, v219
s_nop 1
v_mfma_f32_16x16x32_bf16 v[84:87], v[10:13], v[212:215], 0
v_mfma_f32_16x16x32_bf16 v[88:91], v[14:17], v[212:215], 0
v_max3_f32 v100, v60, v61, v62
v_min3_f32 v104, v60, v61, v62
v_max3_f32 v100, v100, v63, v64
v_min3_f32 v104, v104, v63, v64
v_max3_f32 v100, v100, v65, v66
v_min3_f32 v104, v104, v65, v66
v_max_f32 v100, v100, v67
v_min_f32 v104, v104, v67
v_max3_f32 v101, v68, v69, v70
v_min3_f32 v105, v68, v69, v70
v_max3_f32 v101, v101, v71, v72
v_min3_f32 v105, v105, v71, v72
v_max3_f32 v101, v101, v73, v74
v_min3_f32 v105, v105, v73, v74
v_max_f32 v101, v101, v75
v_min_f32 v105, v105, v75
v_max3_f32 v102, v76, v77, v78
v_min3_f32 v106, v76, v77, v78
v_max3_f32 v102, v102, v79, v80
v_min3_f32 v106, v106, v79, v80
v_max3_f32 v102, v102, v81, v82
v_min3_f32 v106, v106, v81, v82
v_max_f32 v102, v102, v83
v_min_f32 v106, v106, v83
v_max3_f32 v103, v84, v85, v86
v_min3_f32 v107, v84, v85, v86
v_max3_f32 v103, v103, v87, v88
v_min3_f32 v107, v107, v87, v88
v_max3_f32 v103, v103, v89, v90
v_min3_f32 v107, v107, v89, v90
v_max_f32 v103, v103, v91
v_min_f32 v107, v107, v91
s_nop 1
v_permlane32_swap_b32 v100, v101
v_permlane32_swap_b32 v102, v103
v_permlane32_swap_b32 v104, v105
v_permlane32_swap_b32 v106, v107
v_max_f32 v100, v100, v101
v_max_f32 v102, v102, v103
v_min_f32 v104, v104, v105
v_min_f32 v106, v106, v107
v_permlane16_swap_b32 v100, v102
s_nop 0
v_permlane16_swap_b32 v104, v106
v_max_f32 v100, v100, v102
v_min_f32 v104, v104, v106
v_mov_b32 v102, v100
v_mov_b32 v106, v104
s_nop 0
v_permlane16_swap_b32 v100, v102
v_permlane16_swap_b32 v104, v106
v_mov_b32 v101, v100
v_mov_b32 v103, v102
v_mov_b32 v105, v104
v_mov_b32 v107, v106
v_permlane32_swap_b32 v100, v101
v_permlane32_swap_b32 v102, v103
v_permlane32_swap_b32 v104, v105
v_permlane32_swap_b32 v106, v107
v_pk_mul_f32 v[100:101], v[100:101], v[128:129]
v_pk_mul_f32 v[102:103], v[102:103], v[130:131]
v_pk_mul_f32 v[104:105], v[104:105], v[128:129]
v_pk_mul_f32 v[106:107], v[106:107], v[130:131]
v_pk_fma_f32 v[220:221], v[60:61], v[128:129], v[104:105] op_sel:[0,0,0] op_sel_hi:[1,0,0] neg_lo:[1,0,0] neg_hi:[1,0,0]
v_pk_fma_f32 v[60:61], v[60:61], v[128:129], v[100:101] op_sel:[0,0,0] op_sel_hi:[1,0,0] neg_lo:[0,0,1] neg_hi:[0,0,1]
v_exp_f32 v220, v220
v_exp_f32 v60, v60
v_exp_f32 v221, v221
v_exp_f32 v61, v61
v_pk_fma_f32 v[222:223], v[62:63], v[128:129], v[104:105] op_sel:[0,0,0] op_sel_hi:[1,0,0] neg_lo:[1,0,0] neg_hi:[1,0,0]
v_pk_fma_f32 v[62:63], v[62:63], v[128:129], v[100:101] op_sel:[0,0,0] op_sel_hi:[1,0,0] neg_lo:[0,0,1] neg_hi:[0,0,1]
v_exp_f32 v222, v222
v_exp_f32 v62, v62
v_exp_f32 v223, v223
v_exp_f32 v63, v63
v_pk_fma_f32 v[224:225], v[64:65], v[128:129], v[104:105] op_sel:[0,0,0] op_sel_hi:[1,0,0] neg_lo:[1,0,0] neg_hi:[1,0,0]
v_pk_fma_f32 v[64:65], v[64:65], v[128:129], v[100:101] op_sel:[0,0,0] op_sel_hi:[1,0,0] neg_lo:[0,0,1] neg_hi:[0,0,1]
v_exp_f32 v224, v224
v_exp_f32 v64, v64
v_exp_f32 v225, v225
v_exp_f32 v65, v65
v_pk_fma_f32 v[226:227], v[66:67], v[128:129], v[104:105] op_sel:[0,0,0] op_sel_hi:[1,0,0] neg_lo:[1,0,0] neg_hi:[1,0,0]
v_pk_fma_f32 v[66:67], v[66:67], v[128:129], v[100:101] op_sel:[0,0,0] op_sel_hi:[1,0,0] neg_lo:[0,0,1] neg_hi:[0,0,1]
v_exp_f32 v226, v226
v_exp_f32 v66, v66
v_exp_f32 v227, v227
v_exp_f32 v67, v67
v_pk_fma_f32 v[228:229], v[68:69], v[128:129], v[104:105] op_sel:[0,1,1] op_sel_hi:[1,1,1] neg_lo:[1,0,0] neg_hi:[1,0,0]
v_pk_fma_f32 v[68:69], v[68:69], v[128:129], v[100:101] op_sel:[0,1,1] op_sel_hi:[1,1,1] neg_lo:[0,0,1] neg_hi:[0,0,1]
v_exp_f32 v228, v228
v_exp_f32 v68, v68
v_exp_f32 v229, v229
v_exp_f32 v69, v69
v_pk_fma_f32 v[230:231], v[70:71], v[128:129], v[104:105] op_sel:[0,1,1] op_sel_hi:[1,1,1] neg_lo:[1,0,0] neg_hi:[1,0,0]
v_pk_fma_f32 v[70:71], v[70:71], v[128:129], v[100:101] op_sel:[0,1,1] op_sel_hi:[1,1,1] neg_lo:[0,0,1] neg_hi:[0,0,1]
v_exp_f32 v230, v230
v_exp_f32 v70, v70
v_exp_f32 v231, v231
v_exp_f32 v71, v71
v_pk_fma_f32 v[232:233], v[72:73], v[128:129], v[104:105] op_sel:[0,1,1] op_sel_hi:[1,1,1] neg_lo:[1,0,0] neg_hi:[1,0,0]
v_pk_fma_f32 v[72:73], v[72:73], v[128:129], v[100:101] op_sel:[0,1,1] op_sel_hi:[1,1,1] neg_lo:[0,0,1] neg_hi:[0,0,1]
v_exp_f32 v232, v232
v_exp_f32 v72, v72
v_exp_f32 v233, v233
v_exp_f32 v73, v73
v_pk_fma_f32 v[234:235], v[74:75], v[128:129], v[104:105] op_sel:[0,1,1] op_sel_hi:[1,1,1] neg_lo:[1,0,0] neg_hi:[1,0,0]
v_pk_fma_f32 v[74:75], v[74:75], v[128:129], v[100:101] op_sel:[0,1,1] op_sel_hi:[1,1,1] neg_lo:[0,0,1] neg_hi:[0,0,1]
v_exp_f32 v234, v234
v_exp_f32 v74, v74
v_exp_f32 v235, v235
v_exp_f32 v75, v75
v_pk_fma_f32 v[236:237], v[76:77], v[130:131], v[106:107] op_sel:[0,0,0] op_sel_hi:[1,0,0] neg_lo:[1,0,0] neg_hi:[1,0,0]
v_pk_fma_f32 v[76:77], v[76:77], v[130:131], v[102:103] op_sel:[0,0,0] op_sel_hi:[1,0,0] neg_lo:[0,0,1] neg_hi:[0,0,1]
v_exp_f32 v236, v236
v_exp_f32 v76, v76
v_exp_f32 v237, v237
v_exp_f32 v77, v77
v_pk_fma_f32 v[238:239], v[78:79], v[130:131], v[106:107] op_sel:[0,0,0] op_sel_hi:[1,0,0] neg_lo:[1,0,0] neg_hi:[1,0,0]
v_pk_fma_f32 v[78:79], v[78:79], v[130:131], v[102:103] op_sel:[0,0,0] op_sel_hi:[1,0,0] neg_lo:[0,0,1] neg_hi:[0,0,1]
v_exp_f32 v238, v238
v_exp_f32 v78, v78
v_exp_f32 v239, v239
v_exp_f32 v79, v79
v_pk_fma_f32 v[240:241], v[80:81], v[130:131], v[106:107] op_sel:[0,0,0] op_sel_hi:[1,0,0] neg_lo:[1,0,0] neg_hi:[1,0,0]
v_pk_fma_f32 v[80:81], v[80:81], v[130:131], v[102:103] op_sel:[0,0,0] op_sel_hi:[1,0,0] neg_lo:[0,0,1] neg_hi:[0,0,1]
v_exp_f32 v240, v240
v_exp_f32 v80, v80
v_exp_f32 v241, v241
v_exp_f32 v81, v81
v_pk_fma_f32 v[242:243], v[82:83], v[130:131], v[106:107] op_sel:[0,0,0] op_sel_hi:[1,0,0] neg_lo:[1,0,0] neg_hi:[1,0,0]
v_pk_fma_f32 v[82:83], v[82:83], v[130:131], v[102:103] op_sel:[0,0,0] op_sel_hi:[1,0,0] neg_lo:[0,0,1] neg_hi:[0,0,1]
v_exp_f32 v242, v242
v_exp_f32 v82, v82
v_exp_f32 v243, v243
v_exp_f32 v83, v83
v_pk_fma_f32 v[244:245], v[84:85], v[130:131], v[106:107] op_sel:[0,1,1] op_sel_hi:[1,1,1] neg_lo:[1,0,0] neg_hi:[1,0,0]
v_pk_fma_f32 v[84:85], v[84:85], v[130:131], v[102:103] op_sel:[0,1,1] op_sel_hi:[1,1,1] neg_lo:[0,0,1] neg_hi:[0,0,1]
v_exp_f32 v244, v244
v_exp_f32 v84, v84
v_exp_f32 v245, v245
v_exp_f32 v85, v85
v_pk_fma_f32 v[246:247], v[86:87], v[130:131], v[106:107] op_sel:[0,1,1] op_sel_hi:[1,1,1] neg_lo:[1,0,0] neg_hi:[1,0,0]
v_pk_fma_f32 v[86:87], v[86:87], v[130:131], v[102:103] op_sel:[0,1,1] op_sel_hi:[1,1,1] neg_lo:[0,0,1] neg_hi:[0,0,1]
v_exp_f32 v246, v246
v_exp_f32 v86, v86
v_exp_f32 v247, v247
v_exp_f32 v87, v87
v_pk_fma_f32 v[248:249], v[88:89], v[130:131], v[106:107] op_sel:[0,1,1] op_sel_hi:[1,1,1] neg_lo:[1,0,0] neg_hi:[1,0,0]
v_pk_fma_f32 v[88:89], v[88:89], v[130:131], v[102:103] op_sel:[0,1,1] op_sel_hi:[1,1,1] neg_lo:[0,0,1] neg_hi:[0,0,1]
v_exp_f32 v248, v248
v_exp_f32 v88, v88
v_exp_f32 v249, v249
v_exp_f32 v89, v89
v_pk_fma_f32 v[250:251], v[90:91], v[130:131], v[106:107] op_sel:[0,1,1] op_sel_hi:[1,1,1] neg_lo:[1,0,0] neg_hi:[1,0,0]
v_pk_fma_f32 v[90:91], v[90:91], v[130:131], v[102:103] op_sel:[0,1,1] op_sel_hi:[1,1,1] neg_lo:[0,0,1] neg_hi:[0,0,1]
v_exp_f32 v250, v250
v_exp_f32 v90, v90
v_exp_f32 v251, v251
v_exp_f32 v91, v91
v_pk_add_f32 v[108:109], v[60:61], v[62:63]
v_pk_add_f32 v[110:111], v[220:221], v[222:223]
v_pk_add_f32 v[108:109], v[108:109], v[64:65]
v_pk_add_f32 v[110:111], v[110:111], v[224:225]
v_pk_add_f32 v[108:109], v[108:109], v[66:67]
v_pk_add_f32 v[110:111], v[110:111], v[226:227]
v_add_f32 v100, v108, v109
v_add_f32 v104, v110, v111
v_pk_add_f32 v[108:109], v[68:69], v[70:71]
v_pk_add_f32 v[110:111], v[228:229], v[230:231]
v_pk_add_f32 v[108:109], v[108:109], v[72:73]
v_pk_add_f32 v[110:111], v[110:111], v[232:233]
v_pk_add_f32 v[108:109], v[108:109], v[74:75]
v_pk_add_f32 v[110:111], v[110:111], v[234:235]
v_add_f32 v101, v108, v109
v_add_f32 v105, v110, v111
v_pk_add_f32 v[108:109], v[76:77], v[78:79]
v_pk_add_f32 v[110:111], v[236:237], v[238:239]
v_pk_add_f32 v[108:109], v[108:109], v[80:81]
v_pk_add_f32 v[110:111], v[110:111], v[240:241]
v_pk_add_f32 v[108:109], v[108:109], v[82:83]
v_pk_add_f32 v[110:111], v[110:111], v[242:243]
v_add_f32 v102, v108, v109
v_add_f32 v106, v110, v111
v_pk_add_f32 v[108:109], v[84:85], v[86:87]
v_pk_add_f32 v[110:111], v[244:245], v[246:247]
v_pk_add_f32 v[108:109], v[108:109], v[88:89]
v_pk_add_f32 v[110:111], v[110:111], v[248:249]
v_pk_add_f32 v[108:109], v[108:109], v[90:91]
v_pk_add_f32 v[110:111], v[110:111], v[250:251]
v_add_f32 v103, v108, v109
v_add_f32 v107, v110, v111
s_nop 1
v_permlane32_swap_b32 v100, v101
v_permlane32_swap_b32 v102, v103
v_permlane32_swap_b32 v104, v105
v_permlane32_swap_b32 v106, v107
v_add_f32 v100, v100, v101
v_add_f32 v102, v102, v103
v_add_f32 v104, v104, v105
v_add_f32 v106, v106, v107
v_permlane16_swap_b32 v100, v102
s_nop 0
v_permlane16_swap_b32 v104, v106
v_add_f32 v100, v100, v102
v_add_f32 v104, v104, v106
v_rcp_f32 v100, v100
v_rcp_f32 v104, v104
s_nop 0
v_mov_b32 v102, v100
v_mov_b32 v106, v104
s_nop 0
v_permlane16_swap_b32 v100, v102
v_permlane16_swap_b32 v104, v106
v_mov_b32 v101, v100
v_mov_b32 v103, v102
v_mov_b32 v105, v104
v_mov_b32 v107, v106
v_permlane32_swap_b32 v100, v101
v_permlane32_swap_b32 v102, v103
v_permlane32_swap_b32 v104, v105
v_permlane32_swap_b32 v106, v107
.p2align 3
v_pk_mul_f32 v[60:61], v[60:61], v[100:101] op_sel:[0,0] op_sel_hi:[1,0]
v_pk_mul_f32 v[62:63], v[62:63], v[100:101] op_sel:[0,0] op_sel_hi:[1,0]
v_pk_mul_f32 v[64:65], v[64:65], v[100:101] op_sel:[0,0] op_sel_hi:[1,0]
v_pk_mul_f32 v[66:67], v[66:67], v[100:101] op_sel:[0,0] op_sel_hi:[1,0]
v_pk_mul_f32 v[220:221], v[220:221], v[104:105] op_sel:[0,0] op_sel_hi:[1,0]
v_pk_mul_f32 v[222:223], v[222:223], v[104:105] op_sel:[0,0] op_sel_hi:[1,0]
v_pk_mul_f32 v[224:225], v[224:225], v[104:105] op_sel:[0,0] op_sel_hi:[1,0]
v_pk_mul_f32 v[226:227], v[226:227], v[104:105] op_sel:[0,0] op_sel_hi:[1,0]
v_cvt_pk_bf16_f32 v60, v60, v61
v_cvt_pk_bf16_f32 v61, v62, v63
v_cvt_pk_bf16_f32 v62, v64, v65
v_cvt_pk_bf16_f32 v63, v66, v67
v_cvt_pk_bf16_f32 v220, v220, v221
v_cvt_pk_bf16_f32 v221, v222, v223
v_cvt_pk_bf16_f32 v222, v224, v225
v_cvt_pk_bf16_f32 v223, v226, v227
v_pk_mul_f32 v[68:69], v[68:69], v[100:101] op_sel:[0,1] op_sel_hi:[1,1]
v_pk_mul_f32 v[70:71], v[70:71], v[100:101] op_sel:[0,1] op_sel_hi:[1,1]
v_pk_mul_f32 v[72:73], v[72:73], v[100:101] op_sel:[0,1] op_sel_hi:[1,1]
v_pk_mul_f32 v[74:75], v[74:75], v[100:101] op_sel:[0,1] op_sel_hi:[1,1]
v_pk_mul_f32 v[228:229], v[228:229], v[104:105] op_sel:[0,1] op_sel_hi:[1,1]
v_pk_mul_f32 v[230:231], v[230:231], v[104:105] op_sel:[0,1] op_sel_hi:[1,1]
v_pk_mul_f32 v[232:233], v[232:233], v[104:105] op_sel:[0,1] op_sel_hi:[1,1]
v_pk_mul_f32 v[234:235], v[234:235], v[104:105] op_sel:[0,1] op_sel_hi:[1,1]
v_cvt_pk_bf16_f32 v68, v68, v69
v_mfma_f32_16x16x32_bf16 v[204:207], v[60:63], v[38:41], 0
v_cvt_pk_bf16_f32 v69, v70, v71
v_cvt_pk_bf16_f32 v70, v72, v73
v_mfma_f32_16x16x32_bf16 v[208:211], v[60:63], v[36:39], 0
v_cvt_pk_bf16_f32 v71, v74, v75
v_cvt_pk_bf16_f32 v228, v228, v229
v_mfma_f32_16x16x32_bf16 v[212:215], v[220:223], v[38:41], 0
v_cvt_pk_bf16_f32 v229, v230, v231
v_cvt_pk_bf16_f32 v230, v232, v233
v_mfma_f32_16x16x32_bf16 v[216:219], v[220:223], v[36:39], 0
v_cvt_pk_bf16_f32 v231, v234, v235
v_pk_mul_f32 v[76:77], v[76:77], v[102:103] op_sel:[0,0] op_sel_hi:[1,0]
v_pk_mul_f32 v[78:79], v[78:79], v[102:103] op_sel:[0,0] op_sel_hi:[1,0]
v_pk_mul_f32 v[80:81], v[80:81], v[102:103] op_sel:[0,0] op_sel_hi:[1,0]
v_pk_mul_f32 v[82:83], v[82:83], v[102:103] op_sel:[0,0] op_sel_hi:[1,0]
v_pk_mul_f32 v[236:237], v[236:237], v[106:107] op_sel:[0,0] op_sel_hi:[1,0]
v_pk_mul_f32 v[238:239], v[238:239], v[106:107] op_sel:[0,0] op_sel_hi:[1,0]
v_pk_mul_f32 v[240:241], v[240:241], v[106:107] op_sel:[0,0] op_sel_hi:[1,0]
v_pk_mul_f32 v[242:243], v[242:243], v[106:107] op_sel:[0,0] op_sel_hi:[1,0]
v_cvt_pk_bf16_f32 v76, v76, v77
v_mfma_f32_16x16x32_bf16 v[188:191], v[68:71], v[38:41], 0
v_mfma_f32_16x16x32_bf16 v[192:195], v[68:71], v[36:39], 0
v_cvt_pk_bf16_f32 v77, v78, v79
v_mfma_f32_16x16x32_bf16 v[196:199], v[228:231], v[38:41], 0
v_cvt_pk_bf16_f32 v78, v80, v81
v_mfma_f32_16x16x32_bf16 v[200:203], v[228:231], v[36:39], 0
v_cvt_pk_bf16_f32 v64, v204, v205
v_cvt_pk_bf16_f32 v79, v82, v83
v_cvt_pk_bf16_f32 v65, v206, v207
v_cvt_pk_bf16_f32 v236, v236, v237
v_cvt_pk_bf16_f32 v72, v208, v209
v_cvt_pk_bf16_f32 v73, v210, v211
v_cvt_pk_bf16_f32 v237, v238, v239
v_cvt_pk_bf16_f32 v224, v212, v213
v_cvt_pk_bf16_f32 v238, v240, v241
v_cvt_pk_bf16_f32 v225, v214, v215
v_cvt_pk_bf16_f32 v232, v216, v217
v_cvt_pk_bf16_f32 v239, v242, v243
v_cvt_pk_bf16_f32 v233, v218, v219
v_pk_mul_f32 v[84:85], v[84:85], v[102:103] op_sel:[0,1] op_sel_hi:[1,1]
v_pk_mul_f32 v[86:87], v[86:87], v[102:103] op_sel:[0,1] op_sel_hi:[1,1]
v_pk_mul_f32 v[88:89], v[88:89], v[102:103] op_sel:[0,1] op_sel_hi:[1,1]
v_pk_mul_f32 v[90:91], v[90:91], v[102:103] op_sel:[0,1] op_sel_hi:[1,1]
v_pk_mul_f32 v[244:245], v[244:245], v[106:107] op_sel:[0,1] op_sel_hi:[1,1]
v_pk_mul_f32 v[246:247], v[246:247], v[106:107] op_sel:[0,1] op_sel_hi:[1,1]
v_pk_mul_f32 v[248:249], v[248:249], v[106:107] op_sel:[0,1] op_sel_hi:[1,1]
v_pk_mul_f32 v[250:251], v[250:251], v[106:107] op_sel:[0,1] op_sel_hi:[1,1]
v_cvt_pk_bf16_f32 v84, v84, v85
v_mfma_f32_16x16x32_bf16 v[204:207], v[76:79], v[38:41], 0
v_mfma_f32_16x16x32_bf16 v[208:211], v[76:79], v[36:39], 0
v_cvt_pk_bf16_f32 v85, v86, v87
v_mfma_f32_16x16x32_bf16 v[212:215], v[236:239], v[38:41], 0
v_cvt_pk_bf16_f32 v86, v88, v89
v_mfma_f32_16x16x32_bf16 v[216:219], v[236:239], v[36:39], 0
v_cvt_pk_bf16_f32 v66, v188, v189
v_cvt_pk_bf16_f32 v87, v90, v91
v_cvt_pk_bf16_f32 v67, v190, v191
v_cvt_pk_bf16_f32 v244, v244, v245
v_cvt_pk_bf16_f32 v74, v192, v193
v_cvt_pk_bf16_f32 v75, v194, v195
v_cvt_pk_bf16_f32 v245, v246, v247
v_cvt_pk_bf16_f32 v226, v196, v197
v_cvt_pk_bf16_f32 v246, v248, v249
v_cvt_pk_bf16_f32 v227, v198, v199
v_cvt_pk_bf16_f32 v234, v200, v201
v_cvt_pk_bf16_f32 v247, v250, v251
v_cvt_pk_bf16_f32 v235, v202, v203
v_mov_b32 v5, 2
v_cmp_eq_u32 s[50:51], s41, v2
v_mfma_f32_16x16x32_bf16 v[188:191], v[84:87], v[38:41], 0
v_mfma_f32_16x16x32_bf16 v[192:195], v[84:87], v[36:39], 0
v_mfma_f32_16x16x32_bf16 v[196:199], v[244:247], v[38:41], 0
v_mfma_f32_16x16x32_bf16 v[200:203], v[244:247], v[36:39], 0
v_mfma_f32_16x16x32_bf16 v[152:155], v[224:227], v[112:115], 0
v_cvt_pk_bf16_f32 v80, v204, v205
v_cvt_pk_bf16_f32 v81, v206, v207
v_mfma_f32_16x16x32_bf16 v[60:63], v[232:235], v[112:115], 0
v_cvt_pk_bf16_f32 v88, v208, v209
v_mfma_f32_16x16x32_bf16 v[68:71], v[224:227], v[120:123], 0
v_cvt_pk_bf16_f32 v89, v210, v211
v_mfma_f32_16x16x32_bf16 v[220:223], v[232:235], v[120:123], 0
v_cvt_pk_bf16_f32 v240, v212, v213
v_cvt_pk_bf16_f32 v241, v214, v215
v_mfma_f32_16x16x32_bf16 v[228:231], v[224:227], v[48:51], 0
v_cvt_pk_bf16_f32 v248, v216, v217
v_mfma_f32_16x16x32_bf16 v[76:79], v[232:235], v[48:51], 0
v_cvt_pk_bf16_f32 v249, v218, v219
v_mfma_f32_16x16x32_bf16 v[100:103], v[64:67], v[112:115], 0
v_cvt_pk_bf16_f32 v82, v188, v189
v_cvt_pk_bf16_f32 v83, v190, v191
v_mfma_f32_16x16x32_bf16 v[104:107], v[72:75], v[112:115], 0
v_cvt_pk_bf16_f32 v90, v192, v193
v_mfma_f32_16x16x32_bf16 v[108:111], v[64:67], v[120:123], 0
v_cvt_pk_bf16_f32 v91, v194, v195
v_mfma_f32_16x16x32_bf16 v[132:135], v[72:75], v[120:123], 0
v_cvt_pk_bf16_f32 v242, v196, v197
v_cvt_pk_bf16_f32 v243, v198, v199
v_mfma_f32_16x16x32_bf16 v[136:139], v[64:67], v[48:51], 0
v_cvt_pk_bf16_f32 v250, v200, v201
v_mfma_f32_16x16x32_bf16 v[148:151], v[72:75], v[48:51], 0
v_cvt_pk_bf16_f32 v251, v202, v203
s_nop 1
v_mfma_f32_16x16x32_bf16 v[152:155], v[240:243], v[116:119], v[152:155]
v_mfma_f32_16x16x32_bf16 v[60:63], v[248:251], v[116:119], v[60:63]
v_mfma_f32_16x16x32_bf16 v[68:71], v[240:243], v[124:127], v[68:71]
v_mfma_f32_16x16x32_bf16 v[220:223], v[248:251], v[124:127], v[220:223]
v_mfma_f32_16x16x32_bf16 v[228:231], v[240:243], v[48:51], v[228:231]
v_mfma_f32_16x16x32_bf16 v[76:79], v[248:251], v[48:51], v[76:79]
v_mfma_f32_16x16x32_bf16 v[100:103], v[80:83], v[116:119], v[100:103]
v_mfma_f32_16x16x32_bf16 v[104:107], v[88:91], v[116:119], v[104:107]
v_mfma_f32_16x16x32_bf16 v[108:111], v[80:83], v[124:127], v[108:111]
v_mfma_f32_16x16x32_bf16 v[132:135], v[88:91], v[124:127], v[132:135]
v_cvt_pk_bf16_f32 v152, v152, v153
v_cvt_pk_bf16_f32 v153, v154, v155
v_mfma_f32_16x16x32_bf16 v[136:139], v[80:83], v[48:51], v[136:139]
v_cvt_pk_bf16_f32 v154, v60, v61
v_cvt_pk_bf16_f32 v155, v62, v63
v_mfma_f32_16x16x32_bf16 v[148:151], v[88:91], v[48:51], v[148:151]
ds_write_b128 v42, v[152:155] offset:0
v_cvt_pk_bf16_f32 v68, v68, v69
v_cvt_pk_bf16_f32 v69, v70, v71
v_cvt_pk_bf16_f32 v70, v220, v221
v_cvt_pk_bf16_f32 v71, v222, v223
ds_write_b128 v42, v[68:71] offset:1024
v_cvt_pk_bf16_f32 v228, v228, v229
v_cvt_pk_bf16_f32 v229, v230, v231
v_cvt_pk_bf16_f32 v230, v76, v77
v_cvt_pk_bf16_f32 v231, v78, v79
ds_write_b128 v42, v[228:231] offset:2048
ds_write_b32 v52, v5
s_mov_b32 s63, 0
px_83:
ds_read_b32 v4, v19
ds_read_b128 v[188:191], v43 offset:0
ds_read_b128 v[192:195], v43 offset:1024
ds_read_b128 v[196:199], v43 offset:2048
s_add_u32 s63, s63, 1
s_cmp_lt_u32 s63, 0x400000
s_waitcnt lgkmcnt(0)
v_cmp_ne_u32 vcc, 2, v4
s_cbranch_vccz pxd_84
s_cbranch_scc1 px_83
pxd_84:
v_mfma_f32_16x16x32_bf16 v[100:103], v[38:41], v[188:191], v[100:103]
v_mfma_f32_16x16x32_bf16 v[104:107], v[36:39], v[188:191], v[104:107]
v_mfma_f32_16x16x32_bf16 v[108:111], v[38:41], v[192:195], v[108:111]
v_mfma_f32_16x16x32_bf16 v[132:135], v[36:39], v[192:195], v[132:135]
v_mfma_f32_16x16x32_bf16 v[136:139], v[38:41], v[196:199], v[136:139]
v_mfma_f32_16x16x32_bf16 v[148:151], v[36:39], v[196:199], v[148:151]
s_nop 2
v_cvt_pk_bf16_f32 v100, v100, v101
v_cvt_pk_bf16_f32 v101, v102, v103
v_cvt_pk_bf16_f32 v102, v104, v105
v_cvt_pk_bf16_f32 v103, v106, v107
buffer_store_dwordx4 v[100:103], v55, s[32:35], s53 offen sc1
v_cvt_pk_bf16_f32 v108, v108, v109
v_cvt_pk_bf16_f32 v109, v110, v111
v_cvt_pk_bf16_f32 v110, v132, v133
v_cvt_pk_bf16_f32 v111, v134, v135
buffer_store_dwordx4 v[108:111], v55, s[32:35], s54 offen sc1
v_cvt_pk_bf16_f32 v136, v136, v137
v_cvt_pk_bf16_f32 v137, v138, v139
v_cvt_pk_bf16_f32 v138, v148, v149
v_cvt_pk_bf16_f32 v139, v150, v151
s_mov_b64 exec, s[50:51]
buffer_store_dwordx4 v[136:139], v58, s[32:35], s56 offen sc1
s_mov_b64 exec, -1
s_mov_b32 s51, 0
.p2align 3
v_pk_fma_f32 v[156:157], v[140:141], v[92:93], v[156:157] op_sel:[0,1,0] op_sel_hi:[1,1,1]
v_pk_fma_f32 v[158:159], v[142:143], v[92:93], v[158:159] op_sel:[0,1,0] op_sel_hi:[1,1,1]
v_pk_fma_f32 v[160:161], v[144:145], v[92:93], v[160:161] op_sel:[0,1,0] op_sel_hi:[1,1,1]
v_pk_fma_f32 v[162:163], v[146:147], v[92:93], v[162:163] op_sel:[0,1,0] op_sel_hi:[1,1,1]
v_cvt_pk_bf16_f32 v156, v156, v157
v_cvt_pk_bf16_f32 v157, v158, v159
v_cvt_pk_bf16_f32 v158, v160, v161
v_cvt_pk_bf16_f32 v159, v162, v163
v_pk_fma_f32 v[164:165], v[140:141], v[94:95], v[164:165] op_sel:[0,1,0] op_sel_hi:[1,1,1]
v_pk_fma_f32 v[166:167], v[142:143], v[94:95], v[166:167] op_sel:[0,1,0] op_sel_hi:[1,1,1]
v_pk_fma_f32 v[168:169], v[144:145], v[94:95], v[168:169] op_sel:[0,1,0] op_sel_hi:[1,1,1]
v_pk_fma_f32 v[170:171], v[146:147], v[94:95], v[170:171] op_sel:[0,1,0] op_sel_hi:[1,1,1]
v_cvt_pk_bf16_f32 v164, v164, v165
v_mfma_f32_16x16x32_bf16 v[60:63], v[10:13], v[156:159], 0
v_cvt_pk_bf16_f32 v165, v166, v167
v_cvt_pk_bf16_f32 v166, v168, v169
v_mfma_f32_16x16x32_bf16 v[64:67], v[14:17], v[156:159], 0
v_cvt_pk_bf16_f32 v167, v170, v171
v_pk_fma_f32 v[172:173], v[140:141], v[96:97], v[172:173] op_sel:[0,1,0] op_sel_hi:[1,1,1]
v_pk_fma_f32 v[174:175], v[142:143], v[96:97], v[174:175] op_sel:[0,1,0] op_sel_hi:[1,1,1]
v_pk_fma_f32 v[176:177], v[144:145], v[96:97], v[176:177] op_sel:[0,1,0] op_sel_hi:[1,1,1]
v_pk_fma_f32 v[178:179], v[146:147], v[96:97], v[178:179] op_sel:[0,1,0] op_sel_hi:[1,1,1]
v_cvt_pk_bf16_f32 v172, v172, v173
v_mfma_f32_16x16x32_bf16 v[68:71], v[10:13], v[164:167], 0
v_cvt_pk_bf16_f32 v173, v174, v175
v_cvt_pk_bf16_f32 v174, v176, v177
v_mfma_f32_16x16x32_bf16 v[72:75], v[14:17], v[164:167], 0
v_cvt_pk_bf16_f32 v175, v178, v179
v_pk_fma_f32 v[180:181], v[140:141], v[98:99], v[180:181] op_sel:[0,1,0] op_sel_hi:[1,1,1]
v_pk_fma_f32 v[182:183], v[142:143], v[98:99], v[182:183] op_sel:[0,1,0] op_sel_hi:[1,1,1]
v_pk_fma_f32 v[184:185], v[144:145], v[98:99], v[184:185] op_sel:[0,1,0] op_sel_hi:[1,1,1]
v_pk_fma_f32 v[186:187], v[146:147], v[98:99], v[186:187] op_sel:[0,1,0] op_sel_hi:[1,1,1]
v_cvt_pk_bf16_f32 v180, v180, v181
v_mfma_f32_16x16x32_bf16 v[76:79], v[10:13], v[172:175], 0
v_cvt_pk_bf16_f32 v181, v182, v183
v_cvt_pk_bf16_f32 v182, v184, v185
v_mfma_f32_16x16x32_bf16 v[80:83], v[14:17], v[172:175], 0
v_cvt_pk_bf16_f32 v183, v186, v187
s_nop 1
v_mfma_f32_16x16x32_bf16 v[84:87], v[10:13], v[180:183], 0
v_mfma_f32_16x16x32_bf16 v[88:91], v[14:17], v[180:183], 0
v_max3_f32 v100, v60, v61, v62
v_min3_f32 v104, v60, v61, v62
v_max3_f32 v100, v100, v63, v64
v_min3_f32 v104, v104, v63, v64
v_max3_f32 v100, v100, v65, v66
v_min3_f32 v104, v104, v65, v66
v_max_f32 v100, v100, v67
v_min_f32 v104, v104, v67
v_max3_f32 v101, v68, v69, v70
v_min3_f32 v105, v68, v69, v70
v_max3_f32 v101, v101, v71, v72
v_min3_f32 v105, v105, v71, v72
v_max3_f32 v101, v101, v73, v74
v_min3_f32 v105, v105, v73, v74
v_max_f32 v101, v101, v75
v_min_f32 v105, v105, v75
v_max3_f32 v102, v76, v77, v78
v_min3_f32 v106, v76, v77, v78
v_max3_f32 v102, v102, v79, v80
v_min3_f32 v106, v106, v79, v80
v_max3_f32 v102, v102, v81, v82
v_min3_f32 v106, v106, v81, v82
v_max_f32 v102, v102, v83
v_min_f32 v106, v106, v83
v_max3_f32 v103, v84, v85, v86
v_min3_f32 v107, v84, v85, v86
v_max3_f32 v103, v103, v87, v88
v_min3_f32 v107, v107, v87, v88
v_max3_f32 v103, v103, v89, v90
v_min3_f32 v107, v107, v89, v90
v_max_f32 v103, v103, v91
v_min_f32 v107, v107, v91
s_nop 1
v_permlane32_swap_b32 v100, v101
v_permlane32_swap_b32 v102, v103
v_permlane32_swap_b32 v104, v105
v_permlane32_swap_b32 v106, v107
v_max_f32 v100, v100, v101
v_max_f32 v102, v102, v103
v_min_f32 v104, v104, v105
v_min_f32 v106, v106, v107
v_permlane16_swap_b32 v100, v102
s_nop 0
v_permlane16_swap_b32 v104, v106
v_max_f32 v100, v100, v102
v_min_f32 v104, v104, v106
v_mov_b32 v102, v100
v_mov_b32 v106, v104
s_nop 0
v_permlane16_swap_b32 v100, v102
v_permlane16_swap_b32 v104, v106
v_mov_b32 v101, v100
v_mov_b32 v103, v102
v_mov_b32 v105, v104
v_mov_b32 v107, v106
v_permlane32_swap_b32 v100, v101
v_permlane32_swap_b32 v102, v103
v_permlane32_swap_b32 v104, v105
v_permlane32_swap_b32 v106, v107
v_pk_mul_f32 v[100:101], v[100:101], v[128:129]
v_pk_mul_f32 v[102:103], v[102:103], v[130:131]
v_pk_mul_f32 v[104:105], v[104:105], v[128:129]
v_pk_mul_f32 v[106:107], v[106:107], v[130:131]
v_pk_fma_f32 v[220:221], v[60:61], v[128:129], v[104:105] op_sel:[0,0,0] op_sel_hi:[1,0,0] neg_lo:[1,0,0] neg_hi:[1,0,0]
v_pk_fma_f32 v[60:61], v[60:61], v[128:129], v[100:101] op_sel:[0,0,0] op_sel_hi:[1,0,0] neg_lo:[0,0,1] neg_hi:[0,0,1]
v_exp_f32 v220, v220
v_exp_f32 v60, v60
v_exp_f32 v221, v221
v_exp_f32 v61, v61
v_pk_fma_f32 v[222:223], v[62:63], v[128:129], v[104:105] op_sel:[0,0,0] op_sel_hi:[1,0,0] neg_lo:[1,0,0] neg_hi:[1,0,0]
v_pk_fma_f32 v[62:63], v[62:63], v[128:129], v[100:101] op_sel:[0,0,0] op_sel_hi:[1,0,0] neg_lo:[0,0,1] neg_hi:[0,0,1]
v_exp_f32 v222, v222
v_exp_f32 v62, v62
v_exp_f32 v223, v223
v_exp_f32 v63, v63
v_pk_fma_f32 v[224:225], v[64:65], v[128:129], v[104:105] op_sel:[0,0,0] op_sel_hi:[1,0,0] neg_lo:[1,0,0] neg_hi:[1,0,0]
v_pk_fma_f32 v[64:65], v[64:65], v[128:129], v[100:101] op_sel:[0,0,0] op_sel_hi:[1,0,0] neg_lo:[0,0,1] neg_hi:[0,0,1]
v_exp_f32 v224, v224
v_exp_f32 v64, v64
v_exp_f32 v225, v225
v_exp_f32 v65, v65
v_pk_fma_f32 v[226:227], v[66:67], v[128:129], v[104:105] op_sel:[0,0,0] op_sel_hi:[1,0,0] neg_lo:[1,0,0] neg_hi:[1,0,0]
v_pk_fma_f32 v[66:67], v[66:67], v[128:129], v[100:101] op_sel:[0,0,0] op_sel_hi:[1,0,0] neg_lo:[0,0,1] neg_hi:[0,0,1]
v_exp_f32 v226, v226
v_exp_f32 v66, v66
v_exp_f32 v227, v227
v_exp_f32 v67, v67
v_pk_fma_f32 v[228:229], v[68:69], v[128:129], v[104:105] op_sel:[0,1,1] op_sel_hi:[1,1,1] neg_lo:[1,0,0] neg_hi:[1,0,0]
v_pk_fma_f32 v[68:69], v[68:69], v[128:129], v[100:101] op_sel:[0,1,1] op_sel_hi:[1,1,1] neg_lo:[0,0,1] neg_hi:[0,0,1]
v_exp_f32 v228, v228
v_exp_f32 v68, v68
v_exp_f32 v229, v229
v_exp_f32 v69, v69
v_pk_fma_f32 v[230:231], v[70:71], v[128:129], v[104:105] op_sel:[0,1,1] op_sel_hi:[1,1,1] neg_lo:[1,0,0] neg_hi:[1,0,0]
v_pk_fma_f32 v[70:71], v[70:71], v[128:129], v[100:101] op_sel:[0,1,1] op_sel_hi:[1,1,1] neg_lo:[0,0,1] neg_hi:[0,0,1]
v_exp_f32 v230, v230
v_exp_f32 v70, v70
v_exp_f32 v231, v231
v_exp_f32 v71, v71
v_pk_fma_f32 v[232:233], v[72:73], v[128:129], v[104:105] op_sel:[0,1,1] op_sel_hi:[1,1,1] neg_lo:[1,0,0] neg_hi:[1,0,0]
v_pk_fma_f32 v[72:73], v[72:73], v[128:129], v[100:101] op_sel:[0,1,1] op_sel_hi:[1,1,1] neg_lo:[0,0,1] neg_hi:[0,0,1]
v_exp_f32 v232, v232
v_exp_f32 v72, v72
v_exp_f32 v233, v233
v_exp_f32 v73, v73
v_pk_fma_f32 v[234:235], v[74:75], v[128:129], v[104:105] op_sel:[0,1,1] op_sel_hi:[1,1,1] neg_lo:[1,0,0] neg_hi:[1,0,0]
v_pk_fma_f32 v[74:75], v[74:75], v[128:129], v[100:101] op_sel:[0,1,1] op_sel_hi:[1,1,1] neg_lo:[0,0,1] neg_hi:[0,0,1]
v_exp_f32 v234, v234
v_exp_f32 v74, v74
v_exp_f32 v235, v235
v_exp_f32 v75, v75
buffer_load_dwordx4 v[212:215], v18, s[32:35], s55 offen offset:0 sc1
buffer_load_dwordx4 v[216:219], v18, s[32:35], s55 offen offset:1024 sc1
v_pk_fma_f32 v[236:237], v[76:77], v[130:131], v[106:107] op_sel:[0,0,0] op_sel_hi:[1,0,0] neg_lo:[1,0,0] neg_hi:[1,0,0]
v_pk_fma_f32 v[76:77], v[76:77], v[130:131], v[102:103] op_sel:[0,0,0] op_sel_hi:[1,0,0] neg_lo:[0,0,1] neg_hi:[0,0,1]
v_exp_f32 v236, v236
v_exp_f32 v76, v76
v_exp_f32 v237, v237
v_exp_f32 v77, v77
v_pk_fma_f32 v[238:239], v[78:79], v[130:131], v[106:107] op_sel:[0,0,0] op_sel_hi:[1,0,0] neg_lo:[1,0,0] neg_hi:[1,0,0]
v_pk_fma_f32 v[78:79], v[78:79], v[130:131], v[102:103] op_sel:[0,0,0] op_sel_hi:[1,0,0] neg_lo:[0,0,1] neg_hi:[0,0,1]
v_exp_f32 v238, v238
v_exp_f32 v78, v78
v_exp_f32 v239, v239
v_exp_f32 v79, v79
v_pk_fma_f32 v[240:241], v[80:81], v[130:131], v[106:107] op_sel:[0,0,0] op_sel_hi:[1,0,0] neg_lo:[1,0,0] neg_hi:[1,0,0]
v_pk_fma_f32 v[80:81], v[80:81], v[130:131], v[102:103] op_sel:[0,0,0] op_sel_hi:[1,0,0] neg_lo:[0,0,1] neg_hi:[0,0,1]
v_exp_f32 v240, v240
v_exp_f32 v80, v80
v_exp_f32 v241, v241
v_exp_f32 v81, v81
v_pk_fma_f32 v[242:243], v[82:83], v[130:131], v[106:107] op_sel:[0,0,0] op_sel_hi:[1,0,0] neg_lo:[1,0,0] neg_hi:[1,0,0]
v_pk_fma_f32 v[82:83], v[82:83], v[130:131], v[102:103] op_sel:[0,0,0] op_sel_hi:[1,0,0] neg_lo:[0,0,1] neg_hi:[0,0,1]
v_exp_f32 v242, v242
v_exp_f32 v82, v82
v_exp_f32 v243, v243
v_exp_f32 v83, v83
v_pk_fma_f32 v[244:245], v[84:85], v[130:131], v[106:107] op_sel:[0,1,1] op_sel_hi:[1,1,1] neg_lo:[1,0,0] neg_hi:[1,0,0]
v_pk_fma_f32 v[84:85], v[84:85], v[130:131], v[102:103] op_sel:[0,1,1] op_sel_hi:[1,1,1] neg_lo:[0,0,1] neg_hi:[0,0,1]
v_exp_f32 v244, v244
v_exp_f32 v84, v84
v_exp_f32 v245, v245
v_exp_f32 v85, v85
v_pk_fma_f32 v[246:247], v[86:87], v[130:131], v[106:107] op_sel:[0,1,1] op_sel_hi:[1,1,1] neg_lo:[1,0,0] neg_hi:[1,0,0]
v_pk_fma_f32 v[86:87], v[86:87], v[130:131], v[102:103] op_sel:[0,1,1] op_sel_hi:[1,1,1] neg_lo:[0,0,1] neg_hi:[0,0,1]
v_exp_f32 v246, v246
v_exp_f32 v86, v86
v_exp_f32 v247, v247
v_exp_f32 v87, v87
v_pk_fma_f32 v[248:249], v[88:89], v[130:131], v[106:107] op_sel:[0,1,1] op_sel_hi:[1,1,1] neg_lo:[1,0,0] neg_hi:[1,0,0]
v_pk_fma_f32 v[88:89], v[88:89], v[130:131], v[102:103] op_sel:[0,1,1] op_sel_hi:[1,1,1] neg_lo:[0,0,1] neg_hi:[0,0,1]
v_exp_f32 v248, v248
v_exp_f32 v88, v88
v_exp_f32 v249, v249
v_exp_f32 v89, v89
v_pk_fma_f32 v[250:251], v[90:91], v[130:131], v[106:107] op_sel:[0,1,1] op_sel_hi:[1,1,1] neg_lo:[1,0,0] neg_hi:[1,0,0]
v_pk_fma_f32 v[90:91], v[90:91], v[130:131], v[102:103] op_sel:[0,1,1] op_sel_hi:[1,1,1] neg_lo:[0,0,1] neg_hi:[0,0,1]
v_exp_f32 v250, v250
v_exp_f32 v90, v90
v_exp_f32 v251, v251
v_exp_f32 v91, v91
v_pk_add_f32 v[108:109], v[60:61], v[62:63]
v_pk_add_f32 v[110:111], v[220:221], v[222:223]
v_pk_add_f32 v[108:109], v[108:109], v[64:65]
v_pk_add_f32 v[110:111], v[110:111], v[224:225]
v_pk_add_f32 v[108:109], v[108:109], v[66:67]
v_pk_add_f32 v[110:111], v[110:111], v[226:227]
v_add_f32 v100, v108, v109
v_add_f32 v104, v110, v111
v_pk_add_f32 v[108:109], v[68:69], v[70:71]
v_pk_add_f32 v[110:111], v[228:229], v[230:231]
v_pk_add_f32 v[108:109], v[108:109], v[72:73]
v_pk_add_f32 v[110:111], v[110:111], v[232:233]
v_pk_add_f32 v[108:109], v[108:109], v[74:75]
v_pk_add_f32 v[110:111], v[110:111], v[234:235]
v_add_f32 v101, v108, v109
v_add_f32 v105, v110, v111
v_pk_add_f32 v[108:109], v[76:77], v[78:79]
v_pk_add_f32 v[110:111], v[236:237], v[238:239]
v_pk_add_f32 v[108:109], v[108:109], v[80:81]
v_pk_add_f32 v[110:111], v[110:111], v[240:241]
v_pk_add_f32 v[108:109], v[108:109], v[82:83]
v_pk_add_f32 v[110:111], v[110:111], v[242:243]
v_add_f32 v102, v108, v109
v_add_f32 v106, v110, v111
v_pk_add_f32 v[108:109], v[84:85], v[86:87]
v_pk_add_f32 v[110:111], v[244:245], v[246:247]
v_pk_add_f32 v[108:109], v[108:109], v[88:89]
v_pk_add_f32 v[110:111], v[110:111], v[248:249]
v_pk_add_f32 v[108:109], v[108:109], v[90:91]
v_pk_add_f32 v[110:111], v[110:111], v[250:251]
v_add_f32 v103, v108, v109
v_add_f32 v107, v110, v111
s_cmp_eq_u32 s51, 1
s_cbranch_scc1 chk_85
s_waitcnt vmcnt(0)
v_max_u32 v4, v212, v213
v_max3_u32 v4, v4, v214, v215
v_max3_u32 v4, v4, v216, v217
v_max3_u32 v4, v4, v218, v219
v_cmp_eq_u32 vcc, -1, v4
s_cbranch_vccz red_86
buffer_load_dwordx4 v[212:215], v18, s[32:35], s55 offen offset:0 sc1
buffer_load_dwordx4 v[216:219], v18, s[32:35], s55 offen offset:1024 sc1
s_branch chk_85
red_86:
v_mfma_f32_16x16x32_bf16 v[132:135], v[44:47], v[212:215], 0
v_mfma_f32_16x16x32_bf16 v[132:135], v[44:47], v[216:219], v[132:135]
s_mov_b32 s51, 1
s_nop 6
v_add_f32_dpp v132, v132, v132 row_ror:8 row_mask:0xf bank_mask:0xf
v_add_f32_dpp v133, v133, v133 row_ror:8 row_mask:0xf bank_mask:0xf
v_add_f32_dpp v134, v134, v134 row_ror:8 row_mask:0xf bank_mask:0xf
v_add_f32_dpp v135, v135, v135 row_ror:8 row_mask:0xf bank_mask:0xf
v_cvt_pk_bf16_f32 v132, v132, v133
v_cvt_pk_bf16_f32 v133, v134, v135
s_mov_b64 exec, 0x00ff00ff
buffer_store_dwordx2 v[132:133], v59, s[32:35], s79 offen sc1
s_mov_b64 exec, -1
buffer_load_dwordx4 v[204:207], v58, s[32:35], s56 offen sc1
buffer_load_dwordx4 v[208:211], v58, s[32:35], s57 offen sc1
chk_85:
s_nop 1
v_permlane32_swap_b32 v100, v101
v_permlane32_swap_b32 v102, v103
v_permlane32_swap_b32 v104, v105
v_permlane32_swap_b32 v106, v107
v_add_f32 v100, v100, v101
v_add_f32 v102, v102, v103
v_add_f32 v104, v104, v105
v_add_f32 v106, v106, v107
v_permlane16_swap_b32 v100, v102
s_nop 0
v_permlane16_swap_b32 v104, v106
v_add_f32 v100, v100, v102
v_add_f32 v104, v104, v106
v_rcp_f32 v100, v100
v_rcp_f32 v104, v104
s_nop 0
v_mov_b32 v102, v100
v_mov_b32 v106, v104
s_nop 0
v_permlane16_swap_b32 v100, v102
v_permlane16_swap_b32 v104, v106
v_mov_b32 v101, v100
v_mov_b32 v103, v102
v_mov_b32 v105, v104
v_mov_b32 v107, v106
v_permlane32_swap_b32 v100, v101
v_permlane32_swap_b32 v102, v103
v_permlane32_swap_b32 v104, v105
v_permlane32_swap_b32 v106, v107
.p2align 3
v_pk_mul_f32 v[60:61], v[60:61], v[100:101] op_sel:[0,0] op_sel_hi:[1,0]
v_pk_mul_f32 v[62:63], v[62:63], v[100:101] op_sel:[0,0] op_sel_hi:[1,0]
v_pk_mul_f32 v[64:65], v[64:65], v[100:101] op_sel:[0,0] op_sel_hi:[1,0]
v_pk_mul_f32 v[66:67], v[66:67], v[100:101] op_sel:[0,0] op_sel_hi:[1,0]
v_pk_mul_f32 v[220:221], v[220:221], v[104:105] op_sel:[0,0] op_sel_hi:[1,0]
v_pk_mul_f32 v[222:223], v[222:223], v[104:105] op_sel:[0,0] op_sel_hi:[1,0]
v_pk_mul_f32 v[224:225], v[224:225], v[104:105] op_sel:[0,0] op_sel_hi:[1,0]
v_pk_mul_f32 v[226:227], v[226:227], v[104:105] op_sel:[0,0] op_sel_hi:[1,0]
v_cvt_pk_bf16_f32 v60, v60, v61
v_cvt_pk_bf16_f32 v61, v62, v63
v_cvt_pk_bf16_f32 v62, v64, v65
v_cvt_pk_bf16_f32 v63, v66, v67
v_cvt_pk_bf16_f32 v220, v220, v221
v_cvt_pk_bf16_f32 v221, v222, v223
v_cvt_pk_bf16_f32 v222, v224, v225
v_cvt_pk_bf16_f32 v223, v226, v227
v_pk_mul_f32 v[68:69], v[68:69], v[100:101] op_sel:[0,1] op_sel_hi:[1,1]
v_pk_mul_f32 v[70:71], v[70:71], v[100:101] op_sel:[0,1] op_sel_hi:[1,1]
v_pk_mul_f32 v[72:73], v[72:73], v[100:101] op_sel:[0,1] op_sel_hi:[1,1]
v_pk_mul_f32 v[74:75], v[74:75], v[100:101] op_sel:[0,1] op_sel_hi:[1,1]
v_pk_mul_f32 v[228:229], v[228:229], v[104:105] op_sel:[0,1] op_sel_hi:[1,1]
v_pk_mul_f32 v[230:231], v[230:231], v[104:105] op_sel:[0,1] op_sel_hi:[1,1]
v_pk_mul_f32 v[232:233], v[232:233], v[104:105] op_sel:[0,1] op_sel_hi:[1,1]
v_pk_mul_f32 v[234:235], v[234:235], v[104:105] op_sel:[0,1] op_sel_hi:[1,1]
v_cvt_pk_bf16_f32 v68, v68, v69
v_cvt_pk_bf16_f32 v69, v70, v71
v_cvt_pk_bf16_f32 v70, v72, v73
v_cvt_pk_bf16_f32 v71, v74, v75
v_cvt_pk_bf16_f32 v228, v228, v229
v_cvt_pk_bf16_f32 v229, v230, v231
v_cvt_pk_bf16_f32 v230, v232, v233
v_cvt_pk_bf16_f32 v231, v234, v235
v_pk_mul_f32 v[76:77], v[76:77], v[102:103] op_sel:[0,0] op_sel_hi:[1,0]
v_pk_mul_f32 v[78:79], v[78:79], v[102:103] op_sel:[0,0] op_sel_hi:[1,0]
v_pk_mul_f32 v[80:81], v[80:81], v[102:103] op_sel:[0,0] op_sel_hi:[1,0]
v_pk_mul_f32 v[82:83], v[82:83], v[102:103] op_sel:[0,0] op_sel_hi:[1,0]
v_pk_mul_f32 v[236:237], v[236:237], v[106:107] op_sel:[0,0] op_sel_hi:[1,0]
v_pk_mul_f32 v[238:239], v[238:239], v[106:107] op_sel:[0,0] op_sel_hi:[1,0]
v_pk_mul_f32 v[240:241], v[240:241], v[106:107] op_sel:[0,0] op_sel_hi:[1,0]
v_pk_mul_f32 v[242:243], v[242:243], v[106:107] op_sel:[0,0] op_sel_hi:[1,0]
v_cvt_pk_bf16_f32 v76, v76, v77
v_cvt_pk_bf16_f32 v77, v78, v79
v_cvt_pk_bf16_f32 v78, v80, v81
v_cvt_pk_bf16_f32 v79, v82, v83
v_cvt_pk_bf16_f32 v236, v236, v237
v_cvt_pk_bf16_f32 v237, v238, v239
v_cvt_pk_bf16_f32 v238, v240, v241
v_cvt_pk_bf16_f32 v239, v242, v243
v_pk_mul_f32 v[84:85], v[84:85], v[102:103] op_sel:[0,1] op_sel_hi:[1,1]
v_pk_mul_f32 v[86:87], v[86:87], v[102:103] op_sel:[0,1] op_sel_hi:[1,1]
v_pk_mul_f32 v[88:89], v[88:89], v[102:103] op_sel:[0,1] op_sel_hi:[1,1]
v_pk_mul_f32 v[90:91], v[90:91], v[102:103] op_sel:[0,1] op_sel_hi:[1,1]
v_pk_mul_f32 v[244:245], v[244:245], v[106:107] op_sel:[0,1] op_sel_hi:[1,1]
v_pk_mul_f32 v[246:247], v[246:247], v[106:107] op_sel:[0,1] op_sel_hi:[1,1]
v_pk_mul_f32 v[248:249], v[248:249], v[106:107] op_sel:[0,1] op_sel_hi:[1,1]
v_pk_mul_f32 v[250:251], v[250:251], v[106:107] op_sel:[0,1] op_sel_hi:[1,1]
v_cvt_pk_bf16_f32 v84, v84, v85
v_cvt_pk_bf16_f32 v85, v86, v87
v_cvt_pk_bf16_f32 v86, v88, v89
v_cvt_pk_bf16_f32 v87, v90, v91
v_cvt_pk_bf16_f32 v244, v244, v245
v_cvt_pk_bf16_f32 v245, v246, v247
v_cvt_pk_bf16_f32 v246, v248, v249
v_cvt_pk_bf16_f32 v247, v250, v251
s_cmp_lg_u32 s51, 0
s_cbranch_scc1 else_87
s_mov_b32 s63, 0
sent_89:
s_waitcnt vmcnt(0)
v_max_u32 v4, v212, v213
v_max3_u32 v4, v4, v214, v215
v_max3_u32 v4, v4, v216, v217
v_max3_u32 v4, v4, v218, v219
v_cmp_eq_u32 vcc, -1, v4
s_cbranch_vccz sentd_90
buffer_load_dwordx4 v[212:215], v18, s[32:35], s55 offen offset:0 sc1
buffer_load_dwordx4 v[216:219], v18, s[32:35], s55 offen offset:1024 sc1
s_add_u32 s63, s63, 1
s_cmp_lt_u32 s63, 0x80000
s_cbranch_scc1 sent_89
s_waitcnt vmcnt(0)
sentd_90:
v_mfma_f32_16x16x32_bf16 v[132:135], v[44:47], v[212:215], 0
v_mfma_f32_16x16x32_bf16 v[132:135], v[44:47], v[216:219], v[132:135]
s_mov_b32 s51, 1
s_nop 6
v_add_f32_dpp v132, v132, v132 row_ror:8 row_mask:0xf bank_mask:0xf
v_add_f32_dpp v133, v133, v133 row_ror:8 row_mask:0xf bank_mask:0xf
v_add_f32_dpp v134, v134, v134 row_ror:8 row_mask:0xf bank_mask:0xf
v_add_f32_dpp v135, v135, v135 row_ror:8 row_mask:0xf bank_mask:0xf
v_cvt_pk_bf16_f32 v132, v132, v133
v_cvt_pk_bf16_f32 v133, v134, v135
s_mov_b64 exec, 0x00ff00ff
buffer_store_dwordx2 v[132:133], v59, s[32:35], s79 offen sc1
s_mov_b64 exec, -1
buffer_load_dwordx4 v[204:207], v58, s[32:35], s56 offen sc1
buffer_load_dwordx4 v[208:211], v58, s[32:35], s57 offen sc1
else_87:
s_mov_b32 s63, 0
sent_91:
s_waitcnt vmcnt(0)
v_max_u32 v4, v204, v205
v_max3_u32 v4, v4, v206, v207
v_max3_u32 v4, v4, v208, v209
v_max3_u32 v4, v4, v210, v211
v_cmp_eq_u32 vcc, -1, v4
s_cbranch_vccz sentd_92
buffer_load_dwordx4 v[204:207], v58, s[32:35], s56 offen sc1
buffer_load_dwordx4 v[208:211], v58, s[32:35], s57 offen sc1
s_add_u32 s63, s63, 1
s_cmp_lt_u32 s63, 0x80000
s_cbranch_scc1 sent_91
s_waitcnt vmcnt(0)
sentd_92:
buffer_load_dwordx4 v[188:191], v18, s[32:35], s58 offen offset:0 sc1
buffer_load_dwordx4 v[192:195], v18, s[32:35], s58 offen offset:1024 sc1
buffer_load_dwordx4 v[196:199], v18, s[32:35], s59 offen offset:0 sc1
buffer_load_dwordx4 v[200:203], v18, s[32:35], s59 offen offset:1024 sc1
v_mfma_f32_16x16x32_bf16 v[112:115], v[204:207], v[60:63], 0
v_mfma_f32_16x16x32_bf16 v[116:119], v[204:207], v[68:71], 0
v_mfma_f32_16x16x32_bf16 v[120:123], v[204:207], v[76:79], 0
v_mfma_f32_16x16x32_bf16 v[124:127], v[204:207], v[84:87], 0
v_mfma_f32_16x16x32_bf16 v[112:115], v[208:211], v[220:223], v[112:115]
v_mfma_f32_16x16x32_bf16 v[116:119], v[208:211], v[228:231], v[116:119]
v_mfma_f32_16x16x32_bf16 v[120:123], v[208:211], v[236:239], v[120:123]
v_mfma_f32_16x16x32_bf16 v[124:127], v[208:211], v[244:247], v[124:127]
s_nop 4
v_add_f32 v100, v112, v113
v_add_f32 v114, v114, v115
v_add_f32 v100, v100, v114
v_add_f32 v101, v116, v117
v_add_f32 v118, v118, v119
v_add_f32 v101, v101, v118
v_add_f32 v102, v120, v121
v_add_f32 v122, v122, v123
v_add_f32 v102, v102, v122
v_add_f32 v103, v124, v125
v_add_f32 v126, v126, v127
v_add_f32 v103, v103, v126
s_nop 1
v_permlane32_swap_b32 v100, v101
v_permlane32_swap_b32 v102, v103
v_add_f32 v100, v100, v101
v_add_f32 v102, v102, v103
s_nop 1
v_permlane16_swap_b32 v100, v102
s_nop 0
v_add_f32 v100, v100, v102
v_add_f32 v100, 0x358637bd, v100
v_rcp_f32 v100, v100
s_nop 0
v_mov_b32 v102, v100
s_nop 1
v_permlane16_swap_b32 v100, v102
s_nop 0
v_mov_b32 v101, v100
v_mov_b32 v103, v102
s_nop 0
v_permlane32_swap_b32 v100, v101
v_permlane32_swap_b32 v102, v103
s_mov_b32 s63, 0
sent_93:
s_waitcnt vmcnt(0)
v_max_u32 v4, v188, v189
v_max3_u32 v4, v4, v190, v191
v_max3_u32 v4, v4, v192, v193
v_max3_u32 v4, v4, v194, v195
v_max3_u32 v4, v4, v196, v197
v_max3_u32 v4, v4, v198, v199
v_max3_u32 v4, v4, v200, v201
v_max3_u32 v4, v4, v202, v203
v_cmp_eq_u32 vcc, -1, v4
s_cbranch_vccz sentd_94
buffer_load_dwordx4 v[188:191], v18, s[32:35], s58 offen offset:0 sc1
buffer_load_dwordx4 v[192:195], v18, s[32:35], s58 offen offset:1024 sc1
buffer_load_dwordx4 v[196:199], v18, s[32:35], s59 offen offset:0 sc1
buffer_load_dwordx4 v[200:203], v18, s[32:35], s59 offen offset:1024 sc1
s_add_u32 s63, s63, 1
s_cmp_lt_u32 s63, 0x80000
s_cbranch_scc1 sent_93
s_waitcnt vmcnt(0)
sentd_94:
v_mfma_f32_16x16x32_bf16 v[156:159], v[188:191], v[60:63], 0
v_mfma_f32_16x16x32_bf16 v[160:163], v[192:195], v[60:63], 0
v_mfma_f32_16x16x32_bf16 v[156:159], v[196:199], v[220:223], v[156:159]
v_mfma_f32_16x16x32_bf16 v[160:163], v[200:203], v[220:223], v[160:163]
v_mfma_f32_16x16x32_bf16 v[164:167], v[188:191], v[68:71], 0
v_mfma_f32_16x16x32_bf16 v[168:171], v[192:195], v[68:71], 0
v_mfma_f32_16x16x32_bf16 v[164:167], v[196:199], v[228:231], v[164:167]
v_mfma_f32_16x16x32_bf16 v[168:171], v[200:203], v[228:231], v[168:171]
s_nop 1
s_cmp_eq_u32 s46, 0
s_cbranch_scc1 slow_95
.p2align 3
v_pk_mul_f32 v[156:157], v[156:157], v[100:101] op_sel:[0,0] op_sel_hi:[1,0]
v_pk_mul_f32 v[158:159], v[158:159], v[100:101] op_sel:[0,0] op_sel_hi:[1,0]
v_pk_mul_f32 v[160:161], v[160:161], v[100:101] op_sel:[0,0] op_sel_hi:[1,0]
v_pk_mul_f32 v[162:163], v[162:163], v[100:101] op_sel:[0,0] op_sel_hi:[1,0]
v_cvt_pk_bf16_f32 v156, v156, v157
v_mfma_f32_16x16x32_bf16 v[172:175], v[188:191], v[76:79], 0
v_cvt_pk_bf16_f32 v157, v158, v159
v_mfma_f32_16x16x32_bf16 v[176:179], v[192:195], v[76:79], 0
v_cvt_pk_bf16_f32 v158, v160, v161
v_mfma_f32_16x16x32_bf16 v[172:175], v[196:199], v[236:239], v[172:175]
v_cvt_pk_bf16_f32 v159, v162, v163
v_mfma_f32_16x16x32_bf16 v[176:179], v[200:203], v[236:239], v[176:179]
buffer_store_dwordx4 v[156:159], v18, s[32:35], s80 offen
v_pk_mul_f32 v[164:165], v[164:165], v[100:101] op_sel:[0,1] op_sel_hi:[1,1]
v_pk_mul_f32 v[166:167], v[166:167], v[100:101] op_sel:[0,1] op_sel_hi:[1,1]
v_pk_mul_f32 v[168:169], v[168:169], v[100:101] op_sel:[0,1] op_sel_hi:[1,1]
v_pk_mul_f32 v[170:171], v[170:171], v[100:101] op_sel:[0,1] op_sel_hi:[1,1]
v_cvt_pk_bf16_f32 v164, v164, v165
v_mfma_f32_16x16x32_bf16 v[180:183], v[188:191], v[84:87], 0
v_cvt_pk_bf16_f32 v165, v166, v167
v_mfma_f32_16x16x32_bf16 v[184:187], v[192:195], v[84:87], 0
v_cvt_pk_bf16_f32 v166, v168, v169
v_mfma_f32_16x16x32_bf16 v[180:183], v[196:199], v[244:247], v[180:183]
v_cvt_pk_bf16_f32 v167, v170, v171
v_mfma_f32_16x16x32_bf16 v[184:187], v[200:203], v[244:247], v[184:187]
buffer_store_dwordx4 v[164:167], v18, s[32:35], s81 offen
v_pk_mul_f32 v[172:173], v[172:173], v[102:103] op_sel:[0,0] op_sel_hi:[1,0]
v_pk_mul_f32 v[174:175], v[174:175], v[102:103] op_sel:[0,0] op_sel_hi:[1,0]
v_pk_mul_f32 v[176:177], v[176:177], v[102:103] op_sel:[0,0] op_sel_hi:[1,0]
v_pk_mul_f32 v[178:179], v[178:179], v[102:103] op_sel:[0,0] op_sel_hi:[1,0]
v_cvt_pk_bf16_f32 v172, v172, v173
v_cvt_pk_bf16_f32 v173, v174, v175
v_cvt_pk_bf16_f32 v174, v176, v177
v_cvt_pk_bf16_f32 v175, v178, v179
buffer_store_dwordx4 v[172:175], v18, s[32:35], s82 offen
v_pk_mul_f32 v[180:181], v[180:181], v[102:103] op_sel:[0,1] op_sel_hi:[1,1]
v_pk_mul_f32 v[182:183], v[182:183], v[102:103] op_sel:[0,1] op_sel_hi:[1,1]
v_pk_mul_f32 v[184:185], v[184:185], v[102:103] op_sel:[0,1] op_sel_hi:[1,1]
v_pk_mul_f32 v[186:187], v[186:187], v[102:103] op_sel:[0,1] op_sel_hi:[1,1]
v_cvt_pk_bf16_f32 v180, v180, v181
v_cvt_pk_bf16_f32 v181, v182, v183
v_cvt_pk_bf16_f32 v182, v184, v185
v_cvt_pk_bf16_f32 v183, v186, v187
buffer_store_dwordx4 v[180:183], v18, s[32:35], s83 offen
back_96:
s_barrier
v_and_b32 v36, 31, v0
v_lshlrev_b32 v36, 2, v36
s_lshl_b32 s62, s45, 2
v_mov_b32 v4, s62
v_mov_b32 v5, 2
s_mov_b64 exec, 1
s_waitcnt vmcnt(0)
s_cmp_eq_u32 s46, 0
s_cbranch_scc1 slow_97
buffer_store_dword v5, v4, s[32:35], s84 offen
back_98:
s_mov_b64 exec, -1
v_lshrrev_b32 v4, 2, v2
v_and_b32 v5, 3, v0
v_lshl_add_u32 v6, v3, 3, v4
v_lshlrev_b32 v6, 7, v6
v_lshl_add_u32 v6, v5, 3, v6
v_lshrrev_b32 v7, 1, v4
v_and_b32 v8, 1, v3
v_lshl_add_u32 v7, v8, 1, v7
v_lshl_add_u32 v10, v7, 5, v6
v_xor_b32 v11, 32, v10
v_xor_b32 v12, 64, v10
v_xor_b32 v13, 96, v10
v_add_u32 v14, 0x10000, v10
v_add_u32 v15, 0x10000, v11
v_add_u32 v16, 0x10000, v12
v_add_u32 v17, 0x10000, v13
ds_read_b64_tr_b16 v[220:221], v10 offset:0
ds_read_b64_tr_b16 v[222:223], v10 offset:512
ds_read_b64_tr_b16 v[224:225], v11 offset:0
ds_read_b64_tr_b16 v[226:227], v11 offset:512
ds_read_b64_tr_b16 v[228:229], v12 offset:0
ds_read_b64_tr_b16 v[230:231], v12 offset:512
ds_read_b64_tr_b16 v[232:233], v13 offset:0
ds_read_b64_tr_b16 v[234:235], v13 offset:512
ds_read_b64_tr_b16 v[236:237], v10 offset:4096
ds_read_b64_tr_b16 v[238:239], v10 offset:4608
ds_read_b64_tr_b16 v[240:241], v11 offset:4096
ds_read_b64_tr_b16 v[242:243], v11 offset:4608
ds_read_b64_tr_b16 v[244:245], v12 offset:4096
ds_read_b64_tr_b16 v[246:247], v12 offset:4608
ds_read_b64_tr_b16 v[248:249], v13 offset:4096
ds_read_b64_tr_b16 v[250:251], v13 offset:4608
s_lshl_b32 s48, s41, 3
s_lshl_b32 s49, s40, 1
s_add_u32 s48, s48, s49
s_lshl_b32 s48, s48, 15
s_add_u32 s48, s48, 4194304
v_add_u32 v38, s48, v18
v_add_u32 v39, 32768, v38
s_lshl_b32 s57, s75, 11
s_add_u32 s87, s87, 262144
v_lshlrev_b32 v60, 16, v20
v_and_b32 v61, 0xffff0000, v20
v_lshlrev_b32 v62, 16, v21
v_and_b32 v63, 0xffff0000, v21
v_lshlrev_b32 v64, 16, v22
v_and_b32 v65, 0xffff0000, v22
v_lshlrev_b32 v66, 16, v23
v_and_b32 v67, 0xffff0000, v23
v_lshlrev_b32 v68, 16, v24
v_and_b32 v69, 0xffff0000, v24
v_lshlrev_b32 v70, 16, v25
v_and_b32 v71, 0xffff0000, v25
v_lshlrev_b32 v72, 16, v26
v_and_b32 v73, 0xffff0000, v26
v_lshlrev_b32 v74, 16, v27
v_and_b32 v75, 0xffff0000, v27
v_lshlrev_b32 v76, 16, v28
v_and_b32 v77, 0xffff0000, v28
v_lshlrev_b32 v78, 16, v29
v_and_b32 v79, 0xffff0000, v29
v_lshlrev_b32 v80, 16, v30
v_and_b32 v81, 0xffff0000, v30
v_lshlrev_b32 v82, 16, v31
v_and_b32 v83, 0xffff0000, v31
v_lshlrev_b32 v84, 16, v32
v_and_b32 v85, 0xffff0000, v32
v_lshlrev_b32 v86, 16, v33
v_and_b32 v87, 0xffff0000, v33
v_lshlrev_b32 v88, 16, v34
v_and_b32 v89, 0xffff0000, v34
v_lshlrev_b32 v90, 16, v35
v_and_b32 v91, 0xffff0000, v35
v_mov_b32 v6, 0
v_mov_b32 v7, 0
v_mov_b32 v8, 0
v_mov_b32 v9, 0
s_lshl_b32 s62, s42, 2
v_mov_b32 v4, s62
v_mov_b32 v5, 2
buffer_load_dword v37, v36, s[32:35], s84 offen sc1
s_mov_b32 s63, 0
s_waitcnt vmcnt(0)
poll_99:
v_cmp_gt_u32 vcc, 2, v37
s_cbranch_vccz polled_100
buffer_load_dword v37, v36, s[32:35], s84 offen sc1
s_add_u32 s63, s63, 1
s_cmp_lt_u32 s63, 0x80000
s_waitcnt vmcnt(0)
s_cbranch_scc1 poll_99
polled_100:
buffer_load_dwordx4 v[156:159], v38, s[32:35], s57 offen sc1
buffer_load_dwordx4 v[160:163], v39, s[32:35], s57 offen sc1
buffer_load_dwordx4 v[164:167], v38, s[32:35], s57 offen offset:1024 sc1
buffer_load_dwordx4 v[168:171], v39, s[32:35], s57 offen offset:1024 sc1
s_add_u32 s57, s57, 2048
s_and_b32 s57, s57, 0x7fff
buffer_load_dwordx4 v[172:175], v38, s[32:35], s57 offen sc1
buffer_load_dwordx4 v[176:179], v39, s[32:35], s57 offen sc1
buffer_load_dwordx4 v[180:183], v38, s[32:35], s57 offen offset:1024 sc1
buffer_load_dwordx4 v[184:187], v39, s[32:35], s57 offen offset:1024 sc1
s_add_u32 s57, s57, 2048
s_and_b32 s57, s57, 0x7fff
s_waitcnt vmcnt(6) lgkmcnt(8)
v_mfma_f32_16x16x32_bf16 v[60:63], v[220:223], v[156:159], v[60:63]
buffer_load_dwordx4 v[188:191], v38, s[32:35], s57 offen sc1
v_mfma_f32_16x16x32_bf16 v[76:79], v[220:223], v[160:163], v[76:79]
ds_read_b64_tr_b16 v[100:101], v10 offset:8192
ds_read_b64_tr_b16 v[102:103], v10 offset:8704
v_mfma_f32_16x16x32_bf16 v[64:67], v[224:227], v[156:159], v[64:67]
ds_read_b64_tr_b16 v[104:105], v11 offset:8192
ds_read_b64_tr_b16 v[106:107], v11 offset:8704
v_mfma_f32_16x16x32_bf16 v[80:83], v[224:227], v[160:163], v[80:83]
buffer_load_dwordx4 v[192:195], v39, s[32:35], s57 offen sc1
v_mfma_f32_16x16x32_bf16 v[68:71], v[228:231], v[156:159], v[68:71]
ds_read_b64_tr_b16 v[108:109], v12 offset:8192
ds_read_b64_tr_b16 v[110:111], v12 offset:8704
v_mfma_f32_16x16x32_bf16 v[84:87], v[228:231], v[160:163], v[84:87]
ds_read_b64_tr_b16 v[112:113], v13 offset:8192
ds_read_b64_tr_b16 v[114:115], v13 offset:8704
v_mfma_f32_16x16x32_bf16 v[72:75], v[232:235], v[156:159], v[72:75]
v_mfma_f32_16x16x32_bf16 v[88:91], v[232:235], v[160:163], v[88:91]
s_waitcnt vmcnt(6) lgkmcnt(8)
v_mfma_f32_16x16x32_bf16 v[60:63], v[236:239], v[164:167], v[60:63]
buffer_load_dwordx4 v[196:199], v38, s[32:35], s57 offen offset:1024 sc1
v_mfma_f32_16x16x32_bf16 v[76:79], v[236:239], v[168:171], v[76:79]
ds_read_b64_tr_b16 v[220:221], v10 offset:12288
ds_read_b64_tr_b16 v[222:223], v10 offset:12800
v_mfma_f32_16x16x32_bf16 v[64:67], v[240:243], v[164:167], v[64:67]
ds_read_b64_tr_b16 v[224:225], v11 offset:12288
ds_read_b64_tr_b16 v[226:227], v11 offset:12800
v_mfma_f32_16x16x32_bf16 v[80:83], v[240:243], v[168:171], v[80:83]
buffer_load_dwordx4 v[200:203], v39, s[32:35], s57 offen offset:1024 sc1
v_mfma_f32_16x16x32_bf16 v[68:71], v[244:247], v[164:167], v[68:71]
ds_read_b64_tr_b16 v[228:229], v12 offset:12288
ds_read_b64_tr_b16 v[230:231], v12 offset:12800
v_mfma_f32_16x16x32_bf16 v[84:87], v[244:247], v[168:171], v[84:87]
ds_read_b64_tr_b16 v[232:233], v13 offset:12288
ds_read_b64_tr_b16 v[234:235], v13 offset:12800
v_mfma_f32_16x16x32_bf16 v[72:75], v[248:251], v[164:167], v[72:75]
s_add_u32 s57, s57, 2048
s_and_b32 s57, s57, 0x7fff
v_mfma_f32_16x16x32_bf16 v[88:91], v[248:251], v[168:171], v[88:91]
s_waitcnt vmcnt(6) lgkmcnt(8)
v_mfma_f32_16x16x32_bf16 v[60:63], v[100:103], v[172:175], v[60:63]
buffer_load_dwordx4 v[204:207], v38, s[32:35], s57 offen sc1
v_mfma_f32_16x16x32_bf16 v[76:79], v[100:103], v[176:179], v[76:79]
ds_read_b64_tr_b16 v[236:237], v10 offset:16384
ds_read_b64_tr_b16 v[238:239], v10 offset:16896
v_mfma_f32_16x16x32_bf16 v[64:67], v[104:107], v[172:175], v[64:67]
ds_read_b64_tr_b16 v[240:241], v11 offset:16384
ds_read_b64_tr_b16 v[242:243], v11 offset:16896
v_mfma_f32_16x16x32_bf16 v[80:83], v[104:107], v[176:179], v[80:83]
buffer_load_dwordx4 v[208:211], v39, s[32:35], s57 offen sc1
v_mfma_f32_16x16x32_bf16 v[68:71], v[108:111], v[172:175], v[68:71]
ds_read_b64_tr_b16 v[244:245], v12 offset:16384
ds_read_b64_tr_b16 v[246:247], v12 offset:16896
v_mfma_f32_16x16x32_bf16 v[84:87], v[108:111], v[176:179], v[84:87]
ds_read_b64_tr_b16 v[248:249], v13 offset:16384
ds_read_b64_tr_b16 v[250:251], v13 offset:16896
v_mfma_f32_16x16x32_bf16 v[72:75], v[112:115], v[172:175], v[72:75]
v_mfma_f32_16x16x32_bf16 v[88:91], v[112:115], v[176:179], v[88:91]
s_waitcnt vmcnt(6) lgkmcnt(8)
v_mfma_f32_16x16x32_bf16 v[60:63], v[220:223], v[180:183], v[60:63]
buffer_load_dwordx4 v[212:215], v38, s[32:35], s57 offen offset:1024 sc1
v_mfma_f32_16x16x32_bf16 v[76:79], v[220:223], v[184:187], v[76:79]
ds_read_b64_tr_b16 v[100:101], v10 offset:20480
ds_read_b64_tr_b16 v[102:103], v10 offset:20992
v_mfma_f32_16x16x32_bf16 v[64:67], v[224:227], v[180:183], v[64:67]
ds_read_b64_tr_b16 v[104:105], v11 offset:20480
ds_read_b64_tr_b16 v[106:107], v11 offset:20992
v_mfma_f32_16x16x32_bf16 v[80:83], v[224:227], v[184:187], v[80:83]
buffer_load_dwordx4 v[216:219], v39, s[32:35], s57 offen offset:1024 sc1
v_mfma_f32_16x16x32_bf16 v[68:71], v[228:231], v[180:183], v[68:71]
ds_read_b64_tr_b16 v[108:109], v12 offset:20480
ds_read_b64_tr_b16 v[110:111], v12 offset:20992
v_mfma_f32_16x16x32_bf16 v[84:87], v[228:231], v[184:187], v[84:87]
ds_read_b64_tr_b16 v[112:113], v13 offset:20480
ds_read_b64_tr_b16 v[114:115], v13 offset:20992
v_mfma_f32_16x16x32_bf16 v[72:75], v[232:235], v[180:183], v[72:75]
s_add_u32 s57, s57, 2048
s_and_b32 s57, s57, 0x7fff
v_mfma_f32_16x16x32_bf16 v[88:91], v[232:235], v[184:187], v[88:91]
s_waitcnt vmcnt(6) lgkmcnt(8)
v_mfma_f32_16x16x32_bf16 v[60:63], v[236:239], v[188:191], v[60:63]
buffer_load_dwordx4 v[156:159], v38, s[32:35], s57 offen sc1
v_mfma_f32_16x16x32_bf16 v[76:79], v[236:239], v[192:195], v[76:79]
ds_read_b64_tr_b16 v[220:221], v10 offset:24576
ds_read_b64_tr_b16 v[222:223], v10 offset:25088
v_mfma_f32_16x16x32_bf16 v[64:67], v[240:243], v[188:191], v[64:67]
ds_read_b64_tr_b16 v[224:225], v11 offset:24576
ds_read_b64_tr_b16 v[226:227], v11 offset:25088
v_mfma_f32_16x16x32_bf16 v[80:83], v[240:243], v[192:195], v[80:83]
buffer_load_dwordx4 v[160:163], v39, s[32:35], s57 offen sc1
v_mfma_f32_16x16x32_bf16 v[68:71], v[244:247], v[188:191], v[68:71]
ds_read_b64_tr_b16 v[228:229], v12 offset:24576
ds_read_b64_tr_b16 v[230:231], v12 offset:25088
v_mfma_f32_16x16x32_bf16 v[84:87], v[244:247], v[192:195], v[84:87]
ds_read_b64_tr_b16 v[232:233], v13 offset:24576
ds_read_b64_tr_b16 v[234:235], v13 offset:25088
v_mfma_f32_16x16x32_bf16 v[72:75], v[248:251], v[188:191], v[72:75]
v_mfma_f32_16x16x32_bf16 v[88:91], v[248:251], v[192:195], v[88:91]
s_waitcnt vmcnt(6) lgkmcnt(8)
v_mfma_f32_16x16x32_bf16 v[60:63], v[100:103], v[196:199], v[60:63]
buffer_load_dwordx4 v[164:167], v38, s[32:35], s57 offen offset:1024 sc1
v_mfma_f32_16x16x32_bf16 v[76:79], v[100:103], v[200:203], v[76:79]
ds_read_b64_tr_b16 v[236:237], v10 offset:28672
ds_read_b64_tr_b16 v[238:239], v10 offset:29184
v_mfma_f32_16x16x32_bf16 v[64:67], v[104:107], v[196:199], v[64:67]
ds_read_b64_tr_b16 v[240:241], v11 offset:28672
ds_read_b64_tr_b16 v[242:243], v11 offset:29184
v_mfma_f32_16x16x32_bf16 v[80:83], v[104:107], v[200:203], v[80:83]
buffer_load_dwordx4 v[168:171], v39, s[32:35], s57 offen offset:1024 sc1
v_mfma_f32_16x16x32_bf16 v[68:71], v[108:111], v[196:199], v[68:71]
ds_read_b64_tr_b16 v[244:245], v12 offset:28672
ds_read_b64_tr_b16 v[246:247], v12 offset:29184
v_mfma_f32_16x16x32_bf16 v[84:87], v[108:111], v[200:203], v[84:87]
ds_read_b64_tr_b16 v[248:249], v13 offset:28672
ds_read_b64_tr_b16 v[250:251], v13 offset:29184
v_mfma_f32_16x16x32_bf16 v[72:75], v[112:115], v[196:199], v[72:75]
s_add_u32 s57, s57, 2048
s_and_b32 s57, s57, 0x7fff
v_mfma_f32_16x16x32_bf16 v[88:91], v[112:115], v[200:203], v[88:91]
s_waitcnt vmcnt(6) lgkmcnt(8)
v_mfma_f32_16x16x32_bf16 v[60:63], v[220:223], v[204:207], v[60:63]
buffer_load_dwordx4 v[172:175], v38, s[32:35], s57 offen sc1
v_mfma_f32_16x16x32_bf16 v[76:79], v[220:223], v[208:211], v[76:79]
ds_read_b64_tr_b16 v[100:101], v10 offset:32768
ds_read_b64_tr_b16 v[102:103], v10 offset:33280
v_mfma_f32_16x16x32_bf16 v[64:67], v[224:227], v[204:207], v[64:67]
ds_read_b64_tr_b16 v[104:105], v11 offset:32768
ds_read_b64_tr_b16 v[106:107], v11 offset:33280
v_mfma_f32_16x16x32_bf16 v[80:83], v[224:227], v[208:211], v[80:83]
buffer_load_dwordx4 v[176:179], v39, s[32:35], s57 offen sc1
v_mfma_f32_16x16x32_bf16 v[68:71], v[228:231], v[204:207], v[68:71]
ds_read_b64_tr_b16 v[108:109], v12 offset:32768
ds_read_b64_tr_b16 v[110:111], v12 offset:33280
v_mfma_f32_16x16x32_bf16 v[84:87], v[228:231], v[208:211], v[84:87]
ds_read_b64_tr_b16 v[112:113], v13 offset:32768
ds_read_b64_tr_b16 v[114:115], v13 offset:33280
v_mfma_f32_16x16x32_bf16 v[72:75], v[232:235], v[204:207], v[72:75]
v_mfma_f32_16x16x32_bf16 v[88:91], v[232:235], v[208:211], v[88:91]
s_waitcnt vmcnt(6) lgkmcnt(8)
v_mfma_f32_16x16x32_bf16 v[60:63], v[236:239], v[212:215], v[60:63]
buffer_load_dwordx4 v[180:183], v38, s[32:35], s57 offen offset:1024 sc1
v_mfma_f32_16x16x32_bf16 v[76:79], v[236:239], v[216:219], v[76:79]
ds_read_b64_tr_b16 v[220:221], v10 offset:36864
ds_read_b64_tr_b16 v[222:223], v10 offset:37376
v_mfma_f32_16x16x32_bf16 v[64:67], v[240:243], v[212:215], v[64:67]
ds_read_b64_tr_b16 v[224:225], v11 offset:36864
ds_read_b64_tr_b16 v[226:227], v11 offset:37376
v_mfma_f32_16x16x32_bf16 v[80:83], v[240:243], v[216:219], v[80:83]
buffer_load_dwordx4 v[184:187], v39, s[32:35], s57 offen offset:1024 sc1
v_mfma_f32_16x16x32_bf16 v[68:71], v[244:247], v[212:215], v[68:71]
ds_read_b64_tr_b16 v[228:229], v12 offset:36864
ds_read_b64_tr_b16 v[230:231], v12 offset:37376
v_mfma_f32_16x16x32_bf16 v[84:87], v[244:247], v[216:219], v[84:87]
ds_read_b64_tr_b16 v[232:233], v13 offset:36864
ds_read_b64_tr_b16 v[234:235], v13 offset:37376
v_mfma_f32_16x16x32_bf16 v[72:75], v[248:251], v[212:215], v[72:75]
s_add_u32 s57, s57, 2048
s_and_b32 s57, s57, 0x7fff
v_mfma_f32_16x16x32_bf16 v[88:91], v[248:251], v[216:219], v[88:91]
s_waitcnt vmcnt(6) lgkmcnt(8)
v_mfma_f32_16x16x32_bf16 v[60:63], v[100:103], v[156:159], v[60:63]
buffer_load_dwordx4 v[188:191], v38, s[32:35], s57 offen sc1
v_mfma_f32_16x16x32_bf16 v[76:79], v[100:103], v[160:163], v[76:79]
ds_read_b64_tr_b16 v[236:237], v10 offset:40960
ds_read_b64_tr_b16 v[238:239], v10 offset:41472
v_mfma_f32_16x16x32_bf16 v[64:67], v[104:107], v[156:159], v[64:67]
ds_read_b64_tr_b16 v[240:241], v11 offset:40960
ds_read_b64_tr_b16 v[242:243], v11 offset:41472
v_mfma_f32_16x16x32_bf16 v[80:83], v[104:107], v[160:163], v[80:83]
buffer_load_dwordx4 v[192:195], v39, s[32:35], s57 offen sc1
v_mfma_f32_16x16x32_bf16 v[68:71], v[108:111], v[156:159], v[68:71]
ds_read_b64_tr_b16 v[244:245], v12 offset:40960
ds_read_b64_tr_b16 v[246:247], v12 offset:41472
v_mfma_f32_16x16x32_bf16 v[84:87], v[108:111], v[160:163], v[84:87]
ds_read_b64_tr_b16 v[248:249], v13 offset:40960
ds_read_b64_tr_b16 v[250:251], v13 offset:41472
v_mfma_f32_16x16x32_bf16 v[72:75], v[112:115], v[156:159], v[72:75]
v_mfma_f32_16x16x32_bf16 v[88:91], v[112:115], v[160:163], v[88:91]
s_waitcnt vmcnt(6) lgkmcnt(8)
v_mfma_f32_16x16x32_bf16 v[60:63], v[220:223], v[164:167], v[60:63]
buffer_load_dwordx4 v[196:199], v38, s[32:35], s57 offen offset:1024 sc1
v_mfma_f32_16x16x32_bf16 v[76:79], v[220:223], v[168:171], v[76:79]
ds_read_b64_tr_b16 v[100:101], v10 offset:45056
ds_read_b64_tr_b16 v[102:103], v10 offset:45568
v_mfma_f32_16x16x32_bf16 v[64:67], v[224:227], v[164:167], v[64:67]
ds_read_b64_tr_b16 v[104:105], v11 offset:45056
ds_read_b64_tr_b16 v[106:107], v11 offset:45568
v_mfma_f32_16x16x32_bf16 v[80:83], v[224:227], v[168:171], v[80:83]
buffer_load_dwordx4 v[200:203], v39, s[32:35], s57 offen offset:1024 sc1
v_mfma_f32_16x16x32_bf16 v[68:71], v[228:231], v[164:167], v[68:71]
ds_read_b64_tr_b16 v[108:109], v12 offset:45056
ds_read_b64_tr_b16 v[110:111], v12 offset:45568
v_mfma_f32_16x16x32_bf16 v[84:87], v[228:231], v[168:171], v[84:87]
ds_read_b64_tr_b16 v[112:113], v13 offset:45056
ds_read_b64_tr_b16 v[114:115], v13 offset:45568
v_mfma_f32_16x16x32_bf16 v[72:75], v[232:235], v[164:167], v[72:75]
s_add_u32 s57, s57, 2048
s_and_b32 s57, s57, 0x7fff
v_mfma_f32_16x16x32_bf16 v[88:91], v[232:235], v[168:171], v[88:91]
s_waitcnt vmcnt(6) lgkmcnt(8)
v_mfma_f32_16x16x32_bf16 v[60:63], v[236:239], v[172:175], v[60:63]
buffer_load_dwordx4 v[204:207], v38, s[32:35], s57 offen sc1
v_mfma_f32_16x16x32_bf16 v[76:79], v[236:239], v[176:179], v[76:79]
ds_read_b64_tr_b16 v[220:221], v10 offset:49152
ds_read_b64_tr_b16 v[222:223], v10 offset:49664
v_mfma_f32_16x16x32_bf16 v[64:67], v[240:243], v[172:175], v[64:67]
ds_read_b64_tr_b16 v[224:225], v11 offset:49152
ds_read_b64_tr_b16 v[226:227], v11 offset:49664
v_mfma_f32_16x16x32_bf16 v[80:83], v[240:243], v[176:179], v[80:83]
buffer_load_dwordx4 v[208:211], v39, s[32:35], s57 offen sc1
v_mfma_f32_16x16x32_bf16 v[68:71], v[244:247], v[172:175], v[68:71]
ds_read_b64_tr_b16 v[228:229], v12 offset:49152
ds_read_b64_tr_b16 v[230:231], v12 offset:49664
v_mfma_f32_16x16x32_bf16 v[84:87], v[244:247], v[176:179], v[84:87]
ds_read_b64_tr_b16 v[232:233], v13 offset:49152
ds_read_b64_tr_b16 v[234:235], v13 offset:49664
v_mfma_f32_16x16x32_bf16 v[72:75], v[248:251], v[172:175], v[72:75]
v_mfma_f32_16x16x32_bf16 v[88:91], v[248:251], v[176:179], v[88:91]
s_waitcnt vmcnt(6) lgkmcnt(8)
v_mfma_f32_16x16x32_bf16 v[60:63], v[100:103], v[180:183], v[60:63]
buffer_load_dwordx4 v[212:215], v38, s[32:35], s57 offen offset:1024 sc1
v_mfma_f32_16x16x32_bf16 v[76:79], v[100:103], v[184:187], v[76:79]
ds_read_b64_tr_b16 v[236:237], v10 offset:53248
ds_read_b64_tr_b16 v[238:239], v10 offset:53760
v_mfma_f32_16x16x32_bf16 v[64:67], v[104:107], v[180:183], v[64:67]
ds_read_b64_tr_b16 v[240:241], v11 offset:53248
ds_read_b64_tr_b16 v[242:243], v11 offset:53760
v_mfma_f32_16x16x32_bf16 v[80:83], v[104:107], v[184:187], v[80:83]
buffer_load_dwordx4 v[216:219], v39, s[32:35], s57 offen offset:1024 sc1
v_mfma_f32_16x16x32_bf16 v[68:71], v[108:111], v[180:183], v[68:71]
ds_read_b64_tr_b16 v[244:245], v12 offset:53248
ds_read_b64_tr_b16 v[246:247], v12 offset:53760
v_mfma_f32_16x16x32_bf16 v[84:87], v[108:111], v[184:187], v[84:87]
ds_read_b64_tr_b16 v[248:249], v13 offset:53248
ds_read_b64_tr_b16 v[250:251], v13 offset:53760
v_mfma_f32_16x16x32_bf16 v[72:75], v[112:115], v[180:183], v[72:75]
s_add_u32 s57, s57, 2048
s_and_b32 s57, s57, 0x7fff
v_mfma_f32_16x16x32_bf16 v[88:91], v[112:115], v[184:187], v[88:91]
s_waitcnt vmcnt(6) lgkmcnt(8)
v_mfma_f32_16x16x32_bf16 v[60:63], v[220:223], v[188:191], v[60:63]
buffer_load_dwordx4 v[156:159], v38, s[32:35], s57 offen sc1
v_mfma_f32_16x16x32_bf16 v[76:79], v[220:223], v[192:195], v[76:79]
ds_read_b64_tr_b16 v[100:101], v10 offset:57344
ds_read_b64_tr_b16 v[102:103], v10 offset:57856
v_mfma_f32_16x16x32_bf16 v[64:67], v[224:227], v[188:191], v[64:67]
ds_read_b64_tr_b16 v[104:105], v11 offset:57344
ds_read_b64_tr_b16 v[106:107], v11 offset:57856
v_mfma_f32_16x16x32_bf16 v[80:83], v[224:227], v[192:195], v[80:83]
buffer_load_dwordx4 v[160:163], v39, s[32:35], s57 offen sc1
v_mfma_f32_16x16x32_bf16 v[68:71], v[228:231], v[188:191], v[68:71]
ds_read_b64_tr_b16 v[108:109], v12 offset:57344
ds_read_b64_tr_b16 v[110:111], v12 offset:57856
v_mfma_f32_16x16x32_bf16 v[84:87], v[228:231], v[192:195], v[84:87]
ds_read_b64_tr_b16 v[112:113], v13 offset:57344
ds_read_b64_tr_b16 v[114:115], v13 offset:57856
v_mfma_f32_16x16x32_bf16 v[72:75], v[232:235], v[188:191], v[72:75]
v_mfma_f32_16x16x32_bf16 v[88:91], v[232:235], v[192:195], v[88:91]
s_waitcnt vmcnt(6) lgkmcnt(8)
v_mfma_f32_16x16x32_bf16 v[60:63], v[236:239], v[196:199], v[60:63]
buffer_load_dwordx4 v[164:167], v38, s[32:35], s57 offen offset:1024 sc1
v_mfma_f32_16x16x32_bf16 v[76:79], v[236:239], v[200:203], v[76:79]
ds_read_b64_tr_b16 v[220:221], v10 offset:61440
ds_read_b64_tr_b16 v[222:223], v10 offset:61952
v_mfma_f32_16x16x32_bf16 v[64:67], v[240:243], v[196:199], v[64:67]
ds_read_b64_tr_b16 v[224:225], v11 offset:61440
ds_read_b64_tr_b16 v[226:227], v11 offset:61952
v_mfma_f32_16x16x32_bf16 v[80:83], v[240:243], v[200:203], v[80:83]
buffer_load_dwordx4 v[168:171], v39, s[32:35], s57 offen offset:1024 sc1
v_mfma_f32_16x16x32_bf16 v[68:71], v[244:247], v[196:199], v[68:71]
ds_read_b64_tr_b16 v[228:229], v12 offset:61440
ds_read_b64_tr_b16 v[230:231], v12 offset:61952
v_mfma_f32_16x16x32_bf16 v[84:87], v[244:247], v[200:203], v[84:87]
ds_read_b64_tr_b16 v[232:233], v13 offset:61440
ds_read_b64_tr_b16 v[234:235], v13 offset:61952
v_mfma_f32_16x16x32_bf16 v[72:75], v[248:251], v[196:199], v[72:75]
s_add_u32 s57, s57, 2048
s_and_b32 s57, s57, 0x7fff
v_mfma_f32_16x16x32_bf16 v[88:91], v[248:251], v[200:203], v[88:91]
s_waitcnt vmcnt(6) lgkmcnt(8)
v_mfma_f32_16x16x32_bf16 v[60:63], v[100:103], v[204:207], v[60:63]
buffer_load_dwordx4 v[172:175], v38, s[32:35], s57 offen sc1
v_mfma_f32_16x16x32_bf16 v[76:79], v[100:103], v[208:211], v[76:79]
ds_read_b64_tr_b16 v[236:237], v14 offset:0
ds_read_b64_tr_b16 v[238:239], v14 offset:512
v_mfma_f32_16x16x32_bf16 v[64:67], v[104:107], v[204:207], v[64:67]
ds_read_b64_tr_b16 v[240:241], v15 offset:0
ds_read_b64_tr_b16 v[242:243], v15 offset:512
v_mfma_f32_16x16x32_bf16 v[80:83], v[104:107], v[208:211], v[80:83]
buffer_load_dwordx4 v[176:179], v39, s[32:35], s57 offen sc1
v_mfma_f32_16x16x32_bf16 v[68:71], v[108:111], v[204:207], v[68:71]
ds_read_b64_tr_b16 v[244:245], v16 offset:0
ds_read_b64_tr_b16 v[246:247], v16 offset:512
v_mfma_f32_16x16x32_bf16 v[84:87], v[108:111], v[208:211], v[84:87]
ds_read_b64_tr_b16 v[248:249], v17 offset:0
ds_read_b64_tr_b16 v[250:251], v17 offset:512
v_mfma_f32_16x16x32_bf16 v[72:75], v[112:115], v[204:207], v[72:75]
v_mfma_f32_16x16x32_bf16 v[88:91], v[112:115], v[208:211], v[88:91]
s_waitcnt vmcnt(6) lgkmcnt(8)
v_mfma_f32_16x16x32_bf16 v[60:63], v[220:223], v[212:215], v[60:63]
buffer_load_dwordx4 v[180:183], v38, s[32:35], s57 offen offset:1024 sc1
v_mfma_f32_16x16x32_bf16 v[76:79], v[220:223], v[216:219], v[76:79]
ds_read_b64_tr_b16 v[100:101], v14 offset:4096
ds_read_b64_tr_b16 v[102:103], v14 offset:4608
v_mfma_f32_16x16x32_bf16 v[64:67], v[224:227], v[212:215], v[64:67]
ds_read_b64_tr_b16 v[104:105], v15 offset:4096
ds_read_b64_tr_b16 v[106:107], v15 offset:4608
v_mfma_f32_16x16x32_bf16 v[80:83], v[224:227], v[216:219], v[80:83]
buffer_load_dwordx4 v[184:187], v39, s[32:35], s57 offen offset:1024 sc1
v_mfma_f32_16x16x32_bf16 v[68:71], v[228:231], v[212:215], v[68:71]
ds_read_b64_tr_b16 v[108:109], v16 offset:4096
ds_read_b64_tr_b16 v[110:111], v16 offset:4608
v_mfma_f32_16x16x32_bf16 v[84:87], v[228:231], v[216:219], v[84:87]
ds_read_b64_tr_b16 v[112:113], v17 offset:4096
ds_read_b64_tr_b16 v[114:115], v17 offset:4608
v_mfma_f32_16x16x32_bf16 v[72:75], v[232:235], v[212:215], v[72:75]
s_add_u32 s57, s57, 2048
s_and_b32 s57, s57, 0x7fff
v_mfma_f32_16x16x32_bf16 v[88:91], v[232:235], v[216:219], v[88:91]
s_waitcnt vmcnt(6) lgkmcnt(8)
v_mfma_f32_16x16x32_bf16 v[60:63], v[236:239], v[156:159], v[60:63]
buffer_load_dwordx4 v[188:191], v38, s[32:35], s57 offen sc1
v_mfma_f32_16x16x32_bf16 v[76:79], v[236:239], v[160:163], v[76:79]
ds_read_b64_tr_b16 v[220:221], v14 offset:8192
ds_read_b64_tr_b16 v[222:223], v14 offset:8704
v_mfma_f32_16x16x32_bf16 v[64:67], v[240:243], v[156:159], v[64:67]
ds_read_b64_tr_b16 v[224:225], v15 offset:8192
ds_read_b64_tr_b16 v[226:227], v15 offset:8704
v_mfma_f32_16x16x32_bf16 v[80:83], v[240:243], v[160:163], v[80:83]
buffer_load_dwordx4 v[192:195], v39, s[32:35], s57 offen sc1
v_mfma_f32_16x16x32_bf16 v[68:71], v[244:247], v[156:159], v[68:71]
ds_read_b64_tr_b16 v[228:229], v16 offset:8192
ds_read_b64_tr_b16 v[230:231], v16 offset:8704
v_mfma_f32_16x16x32_bf16 v[84:87], v[244:247], v[160:163], v[84:87]
ds_read_b64_tr_b16 v[232:233], v17 offset:8192
ds_read_b64_tr_b16 v[234:235], v17 offset:8704
v_mfma_f32_16x16x32_bf16 v[72:75], v[248:251], v[156:159], v[72:75]
v_mfma_f32_16x16x32_bf16 v[88:91], v[248:251], v[160:163], v[88:91]
s_waitcnt vmcnt(6) lgkmcnt(8)
v_mfma_f32_16x16x32_bf16 v[60:63], v[100:103], v[164:167], v[60:63]
buffer_load_dwordx4 v[196:199], v38, s[32:35], s57 offen offset:1024 sc1
v_mfma_f32_16x16x32_bf16 v[76:79], v[100:103], v[168:171], v[76:79]
ds_read_b64_tr_b16 v[236:237], v14 offset:12288
ds_read_b64_tr_b16 v[238:239], v14 offset:12800
v_mfma_f32_16x16x32_bf16 v[64:67], v[104:107], v[164:167], v[64:67]
ds_read_b64_tr_b16 v[240:241], v15 offset:12288
ds_read_b64_tr_b16 v[242:243], v15 offset:12800
v_mfma_f32_16x16x32_bf16 v[80:83], v[104:107], v[168:171], v[80:83]
buffer_load_dwordx4 v[200:203], v39, s[32:35], s57 offen offset:1024 sc1
v_mfma_f32_16x16x32_bf16 v[68:71], v[108:111], v[164:167], v[68:71]
ds_read_b64_tr_b16 v[244:245], v16 offset:12288
ds_read_b64_tr_b16 v[246:247], v16 offset:12800
v_mfma_f32_16x16x32_bf16 v[84:87], v[108:111], v[168:171], v[84:87]
ds_read_b64_tr_b16 v[248:249], v17 offset:12288
ds_read_b64_tr_b16 v[250:251], v17 offset:12800
v_mfma_f32_16x16x32_bf16 v[72:75], v[112:115], v[164:167], v[72:75]
s_add_u32 s57, s57, 2048
s_and_b32 s57, s57, 0x7fff
v_mfma_f32_16x16x32_bf16 v[88:91], v[112:115], v[168:171], v[88:91]
s_waitcnt vmcnt(6) lgkmcnt(8)
v_mfma_f32_16x16x32_bf16 v[60:63], v[220:223], v[172:175], v[60:63]
buffer_load_dwordx4 v[204:207], v38, s[32:35], s57 offen sc1
v_mfma_f32_16x16x32_bf16 v[76:79], v[220:223], v[176:179], v[76:79]
ds_read_b64_tr_b16 v[100:101], v14 offset:16384
ds_read_b64_tr_b16 v[102:103], v14 offset:16896
v_mfma_f32_16x16x32_bf16 v[64:67], v[224:227], v[172:175], v[64:67]
ds_read_b64_tr_b16 v[104:105], v15 offset:16384
ds_read_b64_tr_b16 v[106:107], v15 offset:16896
v_mfma_f32_16x16x32_bf16 v[80:83], v[224:227], v[176:179], v[80:83]
buffer_load_dwordx4 v[208:211], v39, s[32:35], s57 offen sc1
v_mfma_f32_16x16x32_bf16 v[68:71], v[228:231], v[172:175], v[68:71]
ds_read_b64_tr_b16 v[108:109], v16 offset:16384
ds_read_b64_tr_b16 v[110:111], v16 offset:16896
v_mfma_f32_16x16x32_bf16 v[84:87], v[228:231], v[176:179], v[84:87]
ds_read_b64_tr_b16 v[112:113], v17 offset:16384
ds_read_b64_tr_b16 v[114:115], v17 offset:16896
v_mfma_f32_16x16x32_bf16 v[72:75], v[232:235], v[172:175], v[72:75]
v_mfma_f32_16x16x32_bf16 v[88:91], v[232:235], v[176:179], v[88:91]
s_waitcnt vmcnt(6) lgkmcnt(8)
v_mfma_f32_16x16x32_bf16 v[60:63], v[236:239], v[180:183], v[60:63]
buffer_load_dwordx4 v[212:215], v38, s[32:35], s57 offen offset:1024 sc1
v_mfma_f32_16x16x32_bf16 v[76:79], v[236:239], v[184:187], v[76:79]
ds_read_b64_tr_b16 v[220:221], v14 offset:20480
ds_read_b64_tr_b16 v[222:223], v14 offset:20992
v_mfma_f32_16x16x32_bf16 v[64:67], v[240:243], v[180:183], v[64:67]
ds_read_b64_tr_b16 v[224:225], v15 offset:20480
ds_read_b64_tr_b16 v[226:227], v15 offset:20992
v_mfma_f32_16x16x32_bf16 v[80:83], v[240:243], v[184:187], v[80:83]
buffer_load_dwordx4 v[216:219], v39, s[32:35], s57 offen offset:1024 sc1
v_mfma_f32_16x16x32_bf16 v[68:71], v[244:247], v[180:183], v[68:71]
ds_read_b64_tr_b16 v[228:229], v16 offset:20480
ds_read_b64_tr_b16 v[230:231], v16 offset:20992
v_mfma_f32_16x16x32_bf16 v[84:87], v[244:247], v[184:187], v[84:87]
ds_read_b64_tr_b16 v[232:233], v17 offset:20480
ds_read_b64_tr_b16 v[234:235], v17 offset:20992
v_mfma_f32_16x16x32_bf16 v[72:75], v[248:251], v[180:183], v[72:75]
s_add_u32 s57, s57, 2048
s_and_b32 s57, s57, 0x7fff
v_mfma_f32_16x16x32_bf16 v[88:91], v[248:251], v[184:187], v[88:91]
s_waitcnt vmcnt(6) lgkmcnt(8)
v_mfma_f32_16x16x32_bf16 v[60:63], v[100:103], v[188:191], v[60:63]
buffer_load_dwordx4 v[156:159], v38, s[32:35], s57 offen sc1
v_mfma_f32_16x16x32_bf16 v[76:79], v[100:103], v[192:195], v[76:79]
ds_read_b64_tr_b16 v[236:237], v14 offset:24576
ds_read_b64_tr_b16 v[238:239], v14 offset:25088
v_mfma_f32_16x16x32_bf16 v[64:67], v[104:107], v[188:191], v[64:67]
ds_read_b64_tr_b16 v[240:241], v15 offset:24576
ds_read_b64_tr_b16 v[242:243], v15 offset:25088
v_mfma_f32_16x16x32_bf16 v[80:83], v[104:107], v[192:195], v[80:83]
buffer_load_dwordx4 v[160:163], v39, s[32:35], s57 offen sc1
v_mfma_f32_16x16x32_bf16 v[68:71], v[108:111], v[188:191], v[68:71]
ds_read_b64_tr_b16 v[244:245], v16 offset:24576
ds_read_b64_tr_b16 v[246:247], v16 offset:25088
v_mfma_f32_16x16x32_bf16 v[84:87], v[108:111], v[192:195], v[84:87]
ds_read_b64_tr_b16 v[248:249], v17 offset:24576
ds_read_b64_tr_b16 v[250:251], v17 offset:25088
v_mfma_f32_16x16x32_bf16 v[72:75], v[112:115], v[188:191], v[72:75]
v_mfma_f32_16x16x32_bf16 v[88:91], v[112:115], v[192:195], v[88:91]
s_waitcnt vmcnt(6) lgkmcnt(8)
v_mfma_f32_16x16x32_bf16 v[60:63], v[220:223], v[196:199], v[60:63]
buffer_load_dwordx4 v[164:167], v38, s[32:35], s57 offen offset:1024 sc1
v_mfma_f32_16x16x32_bf16 v[76:79], v[220:223], v[200:203], v[76:79]
ds_read_b64_tr_b16 v[100:101], v14 offset:28672
ds_read_b64_tr_b16 v[102:103], v14 offset:29184
v_mfma_f32_16x16x32_bf16 v[64:67], v[224:227], v[196:199], v[64:67]
ds_read_b64_tr_b16 v[104:105], v15 offset:28672
ds_read_b64_tr_b16 v[106:107], v15 offset:29184
v_mfma_f32_16x16x32_bf16 v[80:83], v[224:227], v[200:203], v[80:83]
buffer_load_dwordx4 v[168:171], v39, s[32:35], s57 offen offset:1024 sc1
v_mfma_f32_16x16x32_bf16 v[68:71], v[228:231], v[196:199], v[68:71]
ds_read_b64_tr_b16 v[108:109], v16 offset:28672
ds_read_b64_tr_b16 v[110:111], v16 offset:29184
v_mfma_f32_16x16x32_bf16 v[84:87], v[228:231], v[200:203], v[84:87]
ds_read_b64_tr_b16 v[112:113], v17 offset:28672
ds_read_b64_tr_b16 v[114:115], v17 offset:29184
v_mfma_f32_16x16x32_bf16 v[72:75], v[232:235], v[196:199], v[72:75]
s_add_u32 s57, s57, 2048
s_and_b32 s57, s57, 0x7fff
v_mfma_f32_16x16x32_bf16 v[88:91], v[232:235], v[200:203], v[88:91]
s_waitcnt vmcnt(6) lgkmcnt(8)
v_mfma_f32_16x16x32_bf16 v[60:63], v[236:239], v[204:207], v[60:63]
buffer_load_dwordx4 v[172:175], v38, s[32:35], s57 offen sc1
v_mfma_f32_16x16x32_bf16 v[76:79], v[236:239], v[208:211], v[76:79]
ds_read_b64_tr_b16 v[220:221], v14 offset:32768
ds_read_b64_tr_b16 v[222:223], v14 offset:33280
v_mfma_f32_16x16x32_bf16 v[64:67], v[240:243], v[204:207], v[64:67]
ds_read_b64_tr_b16 v[224:225], v15 offset:32768
ds_read_b64_tr_b16 v[226:227], v15 offset:33280
v_mfma_f32_16x16x32_bf16 v[80:83], v[240:243], v[208:211], v[80:83]
buffer_load_dwordx4 v[176:179], v39, s[32:35], s57 offen sc1
v_mfma_f32_16x16x32_bf16 v[68:71], v[244:247], v[204:207], v[68:71]
ds_read_b64_tr_b16 v[228:229], v16 offset:32768
ds_read_b64_tr_b16 v[230:231], v16 offset:33280
v_mfma_f32_16x16x32_bf16 v[84:87], v[244:247], v[208:211], v[84:87]
ds_read_b64_tr_b16 v[232:233], v17 offset:32768
ds_read_b64_tr_b16 v[234:235], v17 offset:33280
v_mfma_f32_16x16x32_bf16 v[72:75], v[248:251], v[204:207], v[72:75]
v_mfma_f32_16x16x32_bf16 v[88:91], v[248:251], v[208:211], v[88:91]
s_waitcnt vmcnt(6) lgkmcnt(8)
v_mfma_f32_16x16x32_bf16 v[60:63], v[100:103], v[212:215], v[60:63]
buffer_load_dwordx4 v[180:183], v38, s[32:35], s57 offen offset:1024 sc1
v_mfma_f32_16x16x32_bf16 v[76:79], v[100:103], v[216:219], v[76:79]
ds_read_b64_tr_b16 v[236:237], v14 offset:36864
ds_read_b64_tr_b16 v[238:239], v14 offset:37376
v_mfma_f32_16x16x32_bf16 v[64:67], v[104:107], v[212:215], v[64:67]
ds_read_b64_tr_b16 v[240:241], v15 offset:36864
ds_read_b64_tr_b16 v[242:243], v15 offset:37376
v_mfma_f32_16x16x32_bf16 v[80:83], v[104:107], v[216:219], v[80:83]
buffer_load_dwordx4 v[184:187], v39, s[32:35], s57 offen offset:1024 sc1
v_mfma_f32_16x16x32_bf16 v[68:71], v[108:111], v[212:215], v[68:71]
ds_read_b64_tr_b16 v[244:245], v16 offset:36864
ds_read_b64_tr_b16 v[246:247], v16 offset:37376
v_mfma_f32_16x16x32_bf16 v[84:87], v[108:111], v[216:219], v[84:87]
ds_read_b64_tr_b16 v[248:249], v17 offset:36864
ds_read_b64_tr_b16 v[250:251], v17 offset:37376
v_mfma_f32_16x16x32_bf16 v[72:75], v[112:115], v[212:215], v[72:75]
s_add_u32 s57, s57, 2048
s_and_b32 s57, s57, 0x7fff
v_mfma_f32_16x16x32_bf16 v[88:91], v[112:115], v[216:219], v[88:91]
s_waitcnt vmcnt(6) lgkmcnt(8)
v_mfma_f32_16x16x32_bf16 v[60:63], v[220:223], v[156:159], v[60:63]
buffer_load_dwordx4 v[188:191], v38, s[32:35], s57 offen sc1
v_mfma_f32_16x16x32_bf16 v[76:79], v[220:223], v[160:163], v[76:79]
ds_read_b64_tr_b16 v[100:101], v14 offset:40960
ds_read_b64_tr_b16 v[102:103], v14 offset:41472
v_mfma_f32_16x16x32_bf16 v[64:67], v[224:227], v[156:159], v[64:67]
ds_read_b64_tr_b16 v[104:105], v15 offset:40960
ds_read_b64_tr_b16 v[106:107], v15 offset:41472
v_mfma_f32_16x16x32_bf16 v[80:83], v[224:227], v[160:163], v[80:83]
buffer_load_dwordx4 v[192:195], v39, s[32:35], s57 offen sc1
v_mfma_f32_16x16x32_bf16 v[68:71], v[228:231], v[156:159], v[68:71]
ds_read_b64_tr_b16 v[108:109], v16 offset:40960
ds_read_b64_tr_b16 v[110:111], v16 offset:41472
v_mfma_f32_16x16x32_bf16 v[84:87], v[228:231], v[160:163], v[84:87]
ds_read_b64_tr_b16 v[112:113], v17 offset:40960
ds_read_b64_tr_b16 v[114:115], v17 offset:41472
v_mfma_f32_16x16x32_bf16 v[72:75], v[232:235], v[156:159], v[72:75]
v_mfma_f32_16x16x32_bf16 v[88:91], v[232:235], v[160:163], v[88:91]
s_waitcnt vmcnt(6) lgkmcnt(8)
v_mfma_f32_16x16x32_bf16 v[60:63], v[236:239], v[164:167], v[60:63]
buffer_load_dwordx4 v[196:199], v38, s[32:35], s57 offen offset:1024 sc1
v_mfma_f32_16x16x32_bf16 v[76:79], v[236:239], v[168:171], v[76:79]
ds_read_b64_tr_b16 v[220:221], v14 offset:45056
ds_read_b64_tr_b16 v[222:223], v14 offset:45568
v_mfma_f32_16x16x32_bf16 v[64:67], v[240:243], v[164:167], v[64:67]
ds_read_b64_tr_b16 v[224:225], v15 offset:45056
ds_read_b64_tr_b16 v[226:227], v15 offset:45568
v_mfma_f32_16x16x32_bf16 v[80:83], v[240:243], v[168:171], v[80:83]
buffer_load_dwordx4 v[200:203], v39, s[32:35], s57 offen offset:1024 sc1
v_mfma_f32_16x16x32_bf16 v[68:71], v[244:247], v[164:167], v[68:71]
ds_read_b64_tr_b16 v[228:229], v16 offset:45056
ds_read_b64_tr_b16 v[230:231], v16 offset:45568
v_mfma_f32_16x16x32_bf16 v[84:87], v[244:247], v[168:171], v[84:87]
ds_read_b64_tr_b16 v[232:233], v17 offset:45056
ds_read_b64_tr_b16 v[234:235], v17 offset:45568
v_mfma_f32_16x16x32_bf16 v[72:75], v[248:251], v[164:167], v[72:75]
s_add_u32 s57, s57, 2048
s_and_b32 s57, s57, 0x7fff
v_mfma_f32_16x16x32_bf16 v[88:91], v[248:251], v[168:171], v[88:91]
s_waitcnt vmcnt(6) lgkmcnt(8)
v_mfma_f32_16x16x32_bf16 v[60:63], v[100:103], v[172:175], v[60:63]
buffer_load_dwordx4 v[204:207], v38, s[32:35], s57 offen sc1
v_mfma_f32_16x16x32_bf16 v[76:79], v[100:103], v[176:179], v[76:79]
ds_read_b64_tr_b16 v[236:237], v14 offset:49152
ds_read_b64_tr_b16 v[238:239], v14 offset:49664
v_mfma_f32_16x16x32_bf16 v[64:67], v[104:107], v[172:175], v[64:67]
ds_read_b64_tr_b16 v[240:241], v15 offset:49152
ds_read_b64_tr_b16 v[242:243], v15 offset:49664
v_mfma_f32_16x16x32_bf16 v[80:83], v[104:107], v[176:179], v[80:83]
buffer_load_dwordx4 v[208:211], v39, s[32:35], s57 offen sc1
v_mfma_f32_16x16x32_bf16 v[68:71], v[108:111], v[172:175], v[68:71]
ds_read_b64_tr_b16 v[244:245], v16 offset:49152
ds_read_b64_tr_b16 v[246:247], v16 offset:49664
v_mfma_f32_16x16x32_bf16 v[84:87], v[108:111], v[176:179], v[84:87]
ds_read_b64_tr_b16 v[248:249], v17 offset:49152
ds_read_b64_tr_b16 v[250:251], v17 offset:49664
v_mfma_f32_16x16x32_bf16 v[72:75], v[112:115], v[172:175], v[72:75]
v_mfma_f32_16x16x32_bf16 v[88:91], v[112:115], v[176:179], v[88:91]
s_waitcnt vmcnt(6) lgkmcnt(8)
v_mfma_f32_16x16x32_bf16 v[60:63], v[220:223], v[180:183], v[60:63]
buffer_load_dwordx4 v[212:215], v38, s[32:35], s57 offen offset:1024 sc1
v_mfma_f32_16x16x32_bf16 v[76:79], v[220:223], v[184:187], v[76:79]
ds_read_b64_tr_b16 v[100:101], v14 offset:53248
ds_read_b64_tr_b16 v[102:103], v14 offset:53760
v_mfma_f32_16x16x32_bf16 v[64:67], v[224:227], v[180:183], v[64:67]
ds_read_b64_tr_b16 v[104:105], v15 offset:53248
ds_read_b64_tr_b16 v[106:107], v15 offset:53760
v_mfma_f32_16x16x32_bf16 v[80:83], v[224:227], v[184:187], v[80:83]
buffer_load_dwordx4 v[216:219], v39, s[32:35], s57 offen offset:1024 sc1
v_mfma_f32_16x16x32_bf16 v[68:71], v[228:231], v[180:183], v[68:71]
ds_read_b64_tr_b16 v[108:109], v16 offset:53248
ds_read_b64_tr_b16 v[110:111], v16 offset:53760
v_mfma_f32_16x16x32_bf16 v[84:87], v[228:231], v[184:187], v[84:87]
ds_read_b64_tr_b16 v[112:113], v17 offset:53248
ds_read_b64_tr_b16 v[114:115], v17 offset:53760
v_mfma_f32_16x16x32_bf16 v[72:75], v[232:235], v[180:183], v[72:75]
v_mfma_f32_16x16x32_bf16 v[88:91], v[232:235], v[184:187], v[88:91]
s_waitcnt vmcnt(6) lgkmcnt(8)
v_mfma_f32_16x16x32_bf16 v[60:63], v[236:239], v[188:191], v[60:63]
v_mfma_f32_16x16x32_bf16 v[76:79], v[236:239], v[192:195], v[76:79]
ds_read_b64_tr_b16 v[220:221], v14 offset:57344
ds_read_b64_tr_b16 v[222:223], v14 offset:57856
v_mfma_f32_16x16x32_bf16 v[64:67], v[240:243], v[188:191], v[64:67]
ds_read_b64_tr_b16 v[224:225], v15 offset:57344
ds_read_b64_tr_b16 v[226:227], v15 offset:57856
v_mfma_f32_16x16x32_bf16 v[80:83], v[240:243], v[192:195], v[80:83]
v_mfma_f32_16x16x32_bf16 v[68:71], v[244:247], v[188:191], v[68:71]
ds_read_b64_tr_b16 v[228:229], v16 offset:57344
ds_read_b64_tr_b16 v[230:231], v16 offset:57856
v_mfma_f32_16x16x32_bf16 v[84:87], v[244:247], v[192:195], v[84:87]
ds_read_b64_tr_b16 v[232:233], v17 offset:57344
ds_read_b64_tr_b16 v[234:235], v17 offset:57856
v_mfma_f32_16x16x32_bf16 v[72:75], v[248:251], v[188:191], v[72:75]
v_mfma_f32_16x16x32_bf16 v[88:91], v[248:251], v[192:195], v[88:91]
s_waitcnt vmcnt(4) lgkmcnt(8)
v_mfma_f32_16x16x32_bf16 v[60:63], v[100:103], v[196:199], v[60:63]
v_mfma_f32_16x16x32_bf16 v[76:79], v[100:103], v[200:203], v[76:79]
ds_read_b64_tr_b16 v[236:237], v14 offset:61440
ds_read_b64_tr_b16 v[238:239], v14 offset:61952
v_mfma_f32_16x16x32_bf16 v[64:67], v[104:107], v[196:199], v[64:67]
ds_read_b64_tr_b16 v[240:241], v15 offset:61440
ds_read_b64_tr_b16 v[242:243], v15 offset:61952
v_mfma_f32_16x16x32_bf16 v[80:83], v[104:107], v[200:203], v[80:83]
v_mfma_f32_16x16x32_bf16 v[68:71], v[108:111], v[196:199], v[68:71]
ds_read_b64_tr_b16 v[244:245], v16 offset:61440
ds_read_b64_tr_b16 v[246:247], v16 offset:61952
v_mfma_f32_16x16x32_bf16 v[84:87], v[108:111], v[200:203], v[84:87]
ds_read_b64_tr_b16 v[248:249], v17 offset:61440
ds_read_b64_tr_b16 v[250:251], v17 offset:61952
v_mfma_f32_16x16x32_bf16 v[72:75], v[112:115], v[196:199], v[72:75]
v_mfma_f32_16x16x32_bf16 v[88:91], v[112:115], v[200:203], v[88:91]
s_waitcnt vmcnt(2) lgkmcnt(8)
v_mfma_f32_16x16x32_bf16 v[60:63], v[220:223], v[204:207], v[60:63]
v_mfma_f32_16x16x32_bf16 v[76:79], v[220:223], v[208:211], v[76:79]
v_mfma_f32_16x16x32_bf16 v[64:67], v[224:227], v[204:207], v[64:67]
v_mfma_f32_16x16x32_bf16 v[80:83], v[224:227], v[208:211], v[80:83]
v_mfma_f32_16x16x32_bf16 v[68:71], v[228:231], v[204:207], v[68:71]
v_mfma_f32_16x16x32_bf16 v[84:87], v[228:231], v[208:211], v[84:87]
v_mfma_f32_16x16x32_bf16 v[72:75], v[232:235], v[204:207], v[72:75]
v_mfma_f32_16x16x32_bf16 v[88:91], v[232:235], v[208:211], v[88:91]
s_waitcnt vmcnt(0) lgkmcnt(0)
v_mfma_f32_16x16x32_bf16 v[60:63], v[236:239], v[212:215], v[60:63]
v_mfma_f32_16x16x32_bf16 v[64:67], v[240:243], v[212:215], v[64:67]
v_mfma_f32_16x16x32_bf16 v[68:71], v[244:247], v[212:215], v[68:71]
v_mfma_f32_16x16x32_bf16 v[72:75], v[248:251], v[212:215], v[72:75]
v_mfma_f32_16x16x32_bf16 v[76:79], v[236:239], v[216:219], v[76:79]
v_mfma_f32_16x16x32_bf16 v[80:83], v[240:243], v[216:219], v[80:83]
v_mfma_f32_16x16x32_bf16 v[84:87], v[244:247], v[216:219], v[84:87]
v_mfma_f32_16x16x32_bf16 v[88:91], v[248:251], v[216:219], v[88:91]
s_cmp_eq_u32 s46, 0
s_cbranch_scc1 slow_101
s_nop 0
v_cvt_pk_bf16_f32 v20, v60, v61
v_cvt_pk_bf16_f32 v21, v62, v63
v_cvt_pk_bf16_f32 v22, v64, v65
v_cvt_pk_bf16_f32 v23, v66, v67
buffer_store_dwordx4 v[20:23], v18, s[32:35], s85 offen offset:0
v_cvt_pk_bf16_f32 v24, v68, v69
v_cvt_pk_bf16_f32 v25, v70, v71
v_cvt_pk_bf16_f32 v26, v72, v73
v_cvt_pk_bf16_f32 v27, v74, v75
buffer_store_dwordx4 v[24:27], v18, s[32:35], s85 offen offset:1024
v_cvt_pk_bf16_f32 v28, v76, v77
v_cvt_pk_bf16_f32 v29, v78, v79
v_cvt_pk_bf16_f32 v30, v80, v81
v_cvt_pk_bf16_f32 v31, v82, v83
buffer_store_dwordx4 v[28:31], v18, s[32:35], s86 offen offset:0
v_cvt_pk_bf16_f32 v32, v84, v85
v_cvt_pk_bf16_f32 v33, v86, v87
v_cvt_pk_bf16_f32 v34, v88, v89
v_cvt_pk_bf16_f32 v35, v90, v91
buffer_store_dwordx4 v[32:35], v18, s[32:35], s86 offen offset:1024
s_barrier
v_dot2c_f32_bf16 v6, v20, v48
v_dot2c_f32_bf16 v8, v20, v20
v_dot2c_f32_bf16 v7, v28, v48
v_dot2c_f32_bf16 v9, v28, v28
v_dot2c_f32_bf16 v6, v21, v48
v_dot2c_f32_bf16 v8, v21, v21
v_dot2c_f32_bf16 v7, v29, v48
v_dot2c_f32_bf16 v9, v29, v29
v_dot2c_f32_bf16 v6, v22, v48
v_dot2c_f32_bf16 v8, v22, v22
v_dot2c_f32_bf16 v7, v30, v48
v_dot2c_f32_bf16 v9, v30, v30
v_dot2c_f32_bf16 v6, v23, v48
v_dot2c_f32_bf16 v8, v23, v23
v_dot2c_f32_bf16 v7, v31, v48
v_dot2c_f32_bf16 v9, v31, v31
v_dot2c_f32_bf16 v6, v24, v48
v_dot2c_f32_bf16 v8, v24, v24
v_dot2c_f32_bf16 v7, v32, v48
v_dot2c_f32_bf16 v9, v32, v32
v_dot2c_f32_bf16 v6, v25, v48
v_dot2c_f32_bf16 v8, v25, v25
v_dot2c_f32_bf16 v7, v33, v48
v_dot2c_f32_bf16 v9, v33, v33
v_dot2c_f32_bf16 v6, v26, v48
v_dot2c_f32_bf16 v8, v26, v26
v_dot2c_f32_bf16 v7, v34, v48
v_dot2c_f32_bf16 v9, v34, v34
v_dot2c_f32_bf16 v6, v27, v48
v_dot2c_f32_bf16 v8, v27, v27
v_dot2c_f32_bf16 v7, v35, v48
v_dot2c_f32_bf16 v9, v35, v35
s_mov_b64 exec, 1
s_waitcnt vmcnt(0)
buffer_store_dword v5, v4, s[32:35], s88 offen
s_mov_b64 exec, -1
s_nop 1
v_permlane32_swap_b32 v6, v7
v_permlane32_swap_b32 v8, v9
v_add_f32 v6, v6, v7
v_add_f32 v8, v8, v9
s_nop 1
v_permlane16_swap_b32 v6, v8
s_nop 0
v_add_f32 v6, v6, v8
buffer_store_dword v6, v1, s[32:35], s87 offen
back_102:
s_lshl_b32 s49, s44, 13
v_add_u32 v10, s49, v18
v_add_u32 v11, 1024, v10
s_lshl_b32 s48, s43, 1
v_lshrrev_b32 v4, 2, v2
v_and_b32 v5, 3, v0
v_lshl_add_u32 v6, v3, 3, v4
v_lshlrev_b32 v6, 7, v6
v_lshl_add_u32 v6, v5, 3, v6
v_lshrrev_b32 v7, 1, v4
v_and_b32 v8, 1, v3
v_lshl_add_u32 v7, v8, 1, v7
v_xor_b32 v7, s48, v7
v_lshl_add_u32 v12, v7, 5, v6
v_add_u32 v12, 16384, v12
v_xor_b32 v13, 32, v12
v_mov_b32 v14, v10
v_mov_b32 v15, v11
v_add_u32 v16, 122880, v12
v_add_u32 v17, 122880, v13
v_mov_b32 v156, 0
v_mov_b32 v157, 0
v_mov_b32 v158, 0
v_mov_b32 v159, 0
v_mov_b32 v160, 0
v_mov_b32 v161, 0
v_mov_b32 v162, 0
v_mov_b32 v163, 0
v_mov_b32 v164, 0
v_mov_b32 v165, 0
v_mov_b32 v166, 0
v_mov_b32 v167, 0
v_mov_b32 v168, 0
v_mov_b32 v169, 0
v_mov_b32 v170, 0
v_mov_b32 v171, 0
v_mov_b32 v172, 0
v_mov_b32 v173, 0
v_mov_b32 v174, 0
v_mov_b32 v175, 0
v_mov_b32 v176, 0
v_mov_b32 v177, 0
v_mov_b32 v178, 0
v_mov_b32 v179, 0
v_mov_b32 v180, 0
v_mov_b32 v181, 0
v_mov_b32 v182, 0
v_mov_b32 v183, 0
v_mov_b32 v184, 0
v_mov_b32 v185, 0
v_mov_b32 v186, 0
v_mov_b32 v187, 0
v_mov_b32 v188, 0
v_mov_b32 v189, 0
v_mov_b32 v190, 0
v_mov_b32 v191, 0
v_mov_b32 v192, 0
v_mov_b32 v193, 0
v_mov_b32 v194, 0
v_mov_b32 v195, 0
v_mov_b32 v196, 0
v_mov_b32 v197, 0
v_mov_b32 v198, 0
v_mov_b32 v199, 0
v_mov_b32 v200, 0
v_mov_b32 v201, 0
v_mov_b32 v202, 0
v_mov_b32 v203, 0
v_mov_b32 v204, 0
v_mov_b32 v205, 0
v_mov_b32 v206, 0
v_mov_b32 v207, 0
v_mov_b32 v208, 0
v_mov_b32 v209, 0
v_mov_b32 v210, 0
v_mov_b32 v211, 0
v_mov_b32 v212, 0
v_mov_b32 v213, 0
v_mov_b32 v214, 0
v_mov_b32 v215, 0
v_mov_b32 v216, 0
v_mov_b32 v217, 0
v_mov_b32 v218, 0
v_mov_b32 v219, 0
v_mov_b32 v220, 0
v_mov_b32 v221, 0
v_mov_b32 v222, 0
v_mov_b32 v223, 0
v_mov_b32 v224, 0
v_mov_b32 v225, 0
v_mov_b32 v226, 0
v_mov_b32 v227, 0
v_mov_b32 v228, 0
v_mov_b32 v229, 0
v_mov_b32 v230, 0
v_mov_b32 v231, 0
v_mov_b32 v232, 0
v_mov_b32 v233, 0
v_mov_b32 v234, 0
v_mov_b32 v235, 0
v_mov_b32 v236, 0
v_mov_b32 v237, 0
v_mov_b32 v238, 0
v_mov_b32 v239, 0
v_mov_b32 v240, 0
v_mov_b32 v241, 0
v_mov_b32 v242, 0
v_mov_b32 v243, 0
v_mov_b32 v244, 0
v_mov_b32 v245, 0
v_mov_b32 v246, 0
v_mov_b32 v247, 0
v_mov_b32 v248, 0
v_mov_b32 v249, 0
v_mov_b32 v250, 0
v_mov_b32 v251, 0
s_mov_b32 s48, 0xf149f2ca
v_mov_b32 v9, s48
v_lshlrev_b32 v4, 2, v3
v_sub_u32 v4, v2, v4
v_subrev_u32 v5, 0, v4
v_and_b32 v6, 0x80000001, v5
v_cmp_eq_u32 vcc, 0, v6
v_add_u32 v5, 1, v5
v_and_b32 v6, 0x80000001, v5
v_cndmask_b32 v40, v9, 0, vcc
v_cmp_eq_u32 vcc, 0x80000001, v6
s_nop 1
v_cndmask_b32 v36, v9, 0, vcc
v_subrev_u32 v5, 1, v4
v_and_b32 v6, 0x80000001, v5
v_cmp_eq_u32 vcc, 0, v6
v_add_u32 v5, 1, v5
v_and_b32 v6, 0x80000001, v5
v_cndmask_b32 v41, v9, 0, vcc
v_cmp_eq_u32 vcc, 0x80000001, v6
s_nop 1
v_cndmask_b32 v37, v9, 0, vcc
v_subrev_u32 v5, 2, v4
v_and_b32 v6, 0x80000001, v5
v_cmp_eq_u32 vcc, 0, v6
v_add_u32 v5, 1, v5
v_and_b32 v6, 0x80000001, v5
v_cndmask_b32 v42, v9, 0, vcc
v_cmp_eq_u32 vcc, 0x80000001, v6
s_nop 1
v_cndmask_b32 v38, v9, 0, vcc
v_subrev_u32 v5, 3, v4
v_and_b32 v6, 0x80000001, v5
v_cmp_eq_u32 vcc, 0, v6
v_add_u32 v5, 1, v5
v_and_b32 v6, 0x80000001, v5
v_cndmask_b32 v43, v9, 0, vcc
v_cmp_eq_u32 vcc, 0x80000001, v6
s_nop 1
v_cndmask_b32 v39, v9, 0, vcc
s_or_b32 s48, s41, s44
s_cmp_eq_u32 s48, 0
s_cselect_b64 vcc, -1, 0
v_cndmask_b32 v44, v36, v9, vcc
v_cndmask_b32 v45, v37, v9, vcc
v_cndmask_b32 v46, v38, v9, vcc
v_cndmask_b32 v47, v39, v9, vcc
v_and_b32 v4, 1, v2
v_lshlrev_b32 v4, 4, v4
v_mov_b32 v5, 0xffff
v_lshlrev_b32 v52, v4, v5
s_lshl_b32 s48, s43, 11
s_add_u32 s48, s48, 135168
v_add_u32 v53, s48, v18
v_lshl_add_u32 v55, v0, 3, s48
s_add_u32 s48, s41, s44
s_sub_u32 s48, s48, 1
s_lshl_b32 s49, s48, 1
s_add_u32 s49, s49, s43
s_lshl_b32 s49, s49, 11
s_mul_i32 s50, s42, 65536
s_add_u32 s49, s49, s50
s_add_u32 s49, s49, 8388608
s_cmp_lt_i32 s48, 0
s_cselect_b32 s49, 0xf0000000, s49
v_add_u32 v58, s49, v18
v_lshl_add_u32 v59, v0, 3, s49
s_lshl_b32 s48, s43, 2
s_add_u32 s48, s48, 134672
v_mov_b32 v19, s48
s_lshl_b32 s48, s43, 7
s_add_u32 s48, s48, 133120
v_lshl_add_u32 v7, v3, 4, s48
v_lshl_add_u32 v54, v2, 2, s48
s_lshl_b32 s49, s44, 6
v_add_u32 v8, s49, v2
v_lshlrev_b32 v8, 3, v8
v_add_u32 v8, 131072, v8
v_lshl_add_u32 v9, v3, 2, s49
v_lshlrev_b32 v9, 2, v9
v_add_u32 v9, 132096, v9
s_mov_b32 s64, 0
s_mov_b32 s65, 0
s_mov_b32 s66, 0x3e8293ee
s_barrier
ds_read_b128 v[60:63], v14 offset:0
ds_read_b128 v[64:67], v14 offset:2048
ds_read_b128 v[68:71], v14 offset:4096
ds_read_b128 v[72:75], v14 offset:6144
ds_read_b64_tr_b16 v[84:85], v16 offset:8192
ds_read_b64_tr_b16 v[86:87], v16 offset:8704
ds_read_b64_tr_b16 v[88:89], v17 offset:8192
ds_read_b64_tr_b16 v[90:91], v17 offset:8704
ds_read_b64_tr_b16 v[92:93], v16 offset:16384
ds_read_b64_tr_b16 v[94:95], v16 offset:16896
ds_read_b64_tr_b16 v[96:97], v17 offset:16384
ds_read_b64_tr_b16 v[98:99], v17 offset:16896
ds_read_b64_tr_b16 v[76:77], v16 offset:0
ds_read_b64_tr_b16 v[78:79], v16 offset:512
ds_read_b64_tr_b16 v[80:81], v17 offset:0
ds_read_b64_tr_b16 v[82:83], v17 offset:512
s_waitcnt lgkmcnt(0)
c2_loop:
v_mfma_f32_16x16x32_bf16 v[212:215], v[84:87], v[72:75], v[212:215]
ds_read_b128 v[100:103], v15 offset:0
v_mfma_f32_16x16x32_bf16 v[204:207], v[84:87], v[68:71], v[204:207]
ds_read_b128 v[104:107], v15 offset:2048
v_mfma_f32_16x16x32_bf16 v[196:199], v[84:87], v[64:67], v[196:199]
ds_read_b128 v[108:111], v15 offset:4096
v_mfma_f32_16x16x32_bf16 v[188:191], v[84:87], v[60:63], v[188:191]
ds_read_b128 v[112:115], v15 offset:6144
v_mfma_f32_16x16x32_bf16 v[192:195], v[88:91], v[60:63], v[192:195]
ds_read_b64_tr_b16 v[124:125], v16 offset:12288
v_mfma_f32_16x16x32_bf16 v[200:203], v[88:91], v[64:67], v[200:203]
ds_read_b64_tr_b16 v[126:127], v16 offset:12800
v_mfma_f32_16x16x32_bf16 v[208:211], v[88:91], v[68:71], v[208:211]
ds_read_b64_tr_b16 v[128:129], v17 offset:12288
v_mfma_f32_16x16x32_bf16 v[216:219], v[88:91], v[72:75], v[216:219]
ds_read_b64_tr_b16 v[130:131], v17 offset:12800
v_mfma_f32_16x16x32_bf16 v[244:247], v[72:75], v[92:95], v[244:247]
ds_read_b64_tr_b16 v[132:133], v16 offset:20480
v_mfma_f32_16x16x32_bf16 v[236:239], v[68:71], v[92:95], v[236:239]
ds_read_b64_tr_b16 v[134:135], v16 offset:20992
v_mfma_f32_16x16x32_bf16 v[228:231], v[64:67], v[92:95], v[228:231]
ds_read_b64_tr_b16 v[136:137], v17 offset:20480
v_mfma_f32_16x16x32_bf16 v[220:223], v[60:63], v[92:95], v[220:223]
ds_read_b64_tr_b16 v[138:139], v17 offset:20992
v_mfma_f32_16x16x32_bf16 v[224:227], v[60:63], v[96:99], v[224:227]
ds_read_b64_tr_b16 v[116:117], v16 offset:4096
v_mfma_f32_16x16x32_bf16 v[232:235], v[64:67], v[96:99], v[232:235]
ds_read_b64_tr_b16 v[118:119], v16 offset:4608
v_mfma_f32_16x16x32_bf16 v[240:243], v[68:71], v[96:99], v[240:243]
ds_read_b64_tr_b16 v[120:121], v17 offset:4096
v_mfma_f32_16x16x32_bf16 v[248:251], v[72:75], v[96:99], v[248:251]
ds_read_b64_tr_b16 v[122:123], v17 offset:4608
v_mfma_f32_16x16x32_bf16 v[180:183], v[76:79], v[72:75], v[180:183]
s_add_u32 s65, s65, 40960
s_cmp_eq_u32 s65, 122880
v_mfma_f32_16x16x32_bf16 v[172:175], v[76:79], v[68:71], v[172:175]
s_cselect_b32 s65, 0, s65
s_add_u32 s64, s64, 1
v_mfma_f32_16x16x32_bf16 v[164:167], v[76:79], v[64:67], v[164:167]
v_add_u32 v14, s65, v10
v_add_u32 v15, s65, v11
v_mfma_f32_16x16x32_bf16 v[156:159], v[76:79], v[60:63], v[156:159]
v_add_u32 v16, s65, v12
v_add_u32 v17, s65, v13
v_mfma_f32_16x16x32_bf16 v[160:163], v[80:83], v[60:63], v[160:163]
v_mfma_f32_16x16x32_bf16 v[168:171], v[80:83], v[64:67], v[168:171]
s_cmp_eq_u32 s64, 16
s_cbranch_scc1 c2_last
v_mfma_f32_16x16x32_bf16 v[176:179], v[80:83], v[68:71], v[176:179]
s_waitcnt lgkmcnt(0)
v_mfma_f32_16x16x32_bf16 v[184:187], v[80:83], v[72:75], v[184:187]
s_barrier
v_mfma_f32_16x16x32_bf16 v[212:215], v[124:127], v[112:115], v[212:215]
ds_read_b128 v[60:63], v14 offset:0
v_mfma_f32_16x16x32_bf16 v[204:207], v[124:127], v[108:111], v[204:207]
ds_read_b128 v[64:67], v14 offset:2048
v_mfma_f32_16x16x32_bf16 v[196:199], v[124:127], v[104:107], v[196:199]
ds_read_b128 v[68:71], v14 offset:4096
v_mfma_f32_16x16x32_bf16 v[188:191], v[124:127], v[100:103], v[188:191]
ds_read_b128 v[72:75], v14 offset:6144
v_mfma_f32_16x16x32_bf16 v[192:195], v[128:131], v[100:103], v[192:195]
ds_read_b64_tr_b16 v[84:85], v16 offset:8192
v_mfma_f32_16x16x32_bf16 v[200:203], v[128:131], v[104:107], v[200:203]
ds_read_b64_tr_b16 v[86:87], v16 offset:8704
v_mfma_f32_16x16x32_bf16 v[208:211], v[128:131], v[108:111], v[208:211]
ds_read_b64_tr_b16 v[88:89], v17 offset:8192
v_mfma_f32_16x16x32_bf16 v[216:219], v[128:131], v[112:115], v[216:219]
ds_read_b64_tr_b16 v[90:91], v17 offset:8704
v_mfma_f32_16x16x32_bf16 v[244:247], v[112:115], v[132:135], v[244:247]
ds_read_b64_tr_b16 v[92:93], v16 offset:16384
v_mfma_f32_16x16x32_bf16 v[236:239], v[108:111], v[132:135], v[236:239]
ds_read_b64_tr_b16 v[94:95], v16 offset:16896
v_mfma_f32_16x16x32_bf16 v[228:231], v[104:107], v[132:135], v[228:231]
ds_read_b64_tr_b16 v[96:97], v17 offset:16384
v_mfma_f32_16x16x32_bf16 v[220:223], v[100:103], v[132:135], v[220:223]
ds_read_b64_tr_b16 v[98:99], v17 offset:16896
v_mfma_f32_16x16x32_bf16 v[224:227], v[100:103], v[136:139], v[224:227]
ds_read_b64_tr_b16 v[76:77], v16 offset:0
v_mfma_f32_16x16x32_bf16 v[232:235], v[104:107], v[136:139], v[232:235]
ds_read_b64_tr_b16 v[78:79], v16 offset:512
v_mfma_f32_16x16x32_bf16 v[240:243], v[108:111], v[136:139], v[240:243]
ds_read_b64_tr_b16 v[80:81], v17 offset:0
v_mfma_f32_16x16x32_bf16 v[248:251], v[112:115], v[136:139], v[248:251]
ds_read_b64_tr_b16 v[82:83], v17 offset:512
v_mfma_f32_16x16x32_bf16 v[180:183], v[116:119], v[112:115], v[180:183]
v_mfma_f32_16x16x32_bf16 v[172:175], v[116:119], v[108:111], v[172:175]
v_mfma_f32_16x16x32_bf16 v[164:167], v[116:119], v[104:107], v[164:167]
v_mfma_f32_16x16x32_bf16 v[156:159], v[116:119], v[100:103], v[156:159]
v_mfma_f32_16x16x32_bf16 v[160:163], v[120:123], v[100:103], v[160:163]
v_mfma_f32_16x16x32_bf16 v[168:171], v[120:123], v[104:107], v[168:171]
v_mfma_f32_16x16x32_bf16 v[176:179], v[120:123], v[108:111], v[176:179]
s_waitcnt lgkmcnt(0)
v_mfma_f32_16x16x32_bf16 v[184:187], v[120:123], v[112:115], v[184:187]
s_branch c2_loop
c2_last:
v_mfma_f32_16x16x32_bf16 v[176:179], v[80:83], v[68:71], v[176:179]
s_waitcnt lgkmcnt(0)
v_mfma_f32_16x16x32_bf16 v[184:187], v[80:83], v[72:75], v[184:187]
v_mfma_f32_16x16x32_bf16 v[212:215], v[124:127], v[112:115], v[212:215]
v_mfma_f32_16x16x32_bf16 v[204:207], v[124:127], v[108:111], v[204:207]
v_mfma_f32_16x16x32_bf16 v[196:199], v[124:127], v[104:107], v[196:199]
v_mfma_f32_16x16x32_bf16 v[188:191], v[124:127], v[100:103], v[188:191]
v_mfma_f32_16x16x32_bf16 v[192:195], v[128:131], v[100:103], v[192:195]
v_mfma_f32_16x16x32_bf16 v[200:203], v[128:131], v[104:107], v[200:203]
v_mfma_f32_16x16x32_bf16 v[208:211], v[128:131], v[108:111], v[208:211]
v_mfma_f32_16x16x32_bf16 v[216:219], v[128:131], v[112:115], v[216:219]
s_barrier
v_mfma_f32_16x16x32_bf16 v[244:247], v[112:115], v[132:135], v[244:247]
ds_read_b128 v[140:143], v7 offset:0
ds_read_b128 v[144:147], v7 offset:64
v_mfma_f32_16x16x32_bf16 v[236:239], v[108:111], v[132:135], v[236:239]
ds_read_b128 v[148:151], v7 offset:256
ds_read_b128 v[152:155], v7 offset:320
v_mfma_f32_16x16x32_bf16 v[228:231], v[104:107], v[132:135], v[228:231]
ds_read_b64 v[92:93], v8 offset:0
ds_read_b64 v[94:95], v8 offset:128
v_mfma_f32_16x16x32_bf16 v[220:223], v[100:103], v[132:135], v[220:223]
ds_read_b64 v[96:97], v8 offset:256
ds_read_b64 v[98:99], v8 offset:384
v_mfma_f32_16x16x32_bf16 v[224:227], v[100:103], v[136:139], v[224:227]
ds_read2_b32 v[56:57], v54 offset0:128 offset1:144
v_mfma_f32_16x16x32_bf16 v[232:235], v[104:107], v[136:139], v[232:235]
ds_read_b128 v[60:63], v9 offset:0
v_mfma_f32_16x16x32_bf16 v[240:243], v[108:111], v[136:139], v[240:243]
ds_read_b128 v[64:67], v9 offset:64
v_mfma_f32_16x16x32_bf16 v[248:251], v[112:115], v[136:139], v[248:251]
ds_read_b128 v[68:71], v9 offset:128
v_mfma_f32_16x16x32_bf16 v[180:183], v[116:119], v[112:115], v[180:183]
ds_read_b128 v[72:75], v9 offset:192
v_mfma_f32_16x16x32_bf16 v[172:175], v[116:119], v[108:111], v[172:175]
ds_read_b128 v[76:79], v9 offset:512
v_mfma_f32_16x16x32_bf16 v[164:167], v[116:119], v[104:107], v[164:167]
ds_read_b128 v[80:83], v9 offset:576
v_mfma_f32_16x16x32_bf16 v[156:159], v[116:119], v[100:103], v[156:159]
ds_read_b128 v[84:87], v9 offset:640
v_mfma_f32_16x16x32_bf16 v[160:163], v[120:123], v[100:103], v[160:163]
ds_read_b128 v[88:91], v9 offset:704
v_mfma_f32_16x16x32_bf16 v[168:171], v[120:123], v[104:107], v[168:171]
v_mfma_f32_16x16x32_bf16 v[176:179], v[120:123], v[108:111], v[176:179]
v_mfma_f32_16x16x32_bf16 v[184:187], v[120:123], v[112:115], v[184:187]
c2_epi:
s_waitcnt lgkmcnt(0)
.p2align 3
v_pk_fma_f32 v[212:213], v[148:149], v[98:99], v[212:213] op_sel:[0,1,0] op_sel_hi:[1,1,1]
v_pk_fma_f32 v[214:215], v[150:151], v[98:99], v[214:215] op_sel:[0,1,0] op_sel_hi:[1,1,1]
v_pk_fma_f32 v[216:217], v[152:153], v[98:99], v[216:217] op_sel:[0,1,0] op_sel_hi:[1,1,1]
v_pk_fma_f32 v[218:219], v[154:155], v[98:99], v[218:219] op_sel:[0,1,0] op_sel_hi:[1,1,1]
v_pk_mul_f32 v[212:213], v[212:213], v[98:99] op_sel:[0,0] op_sel_hi:[1,0]
v_pk_mul_f32 v[214:215], v[214:215], v[98:99] op_sel:[0,0] op_sel_hi:[1,0]
v_pk_mul_f32 v[216:217], v[216:217], v[98:99] op_sel:[0,0] op_sel_hi:[1,0]
v_pk_mul_f32 v[218:219], v[218:219], v[98:99] op_sel:[0,0] op_sel_hi:[1,0]
v_cvt_pk_bf16_f32 v212, v212, v213
v_cvt_pk_bf16_f32 v213, v214, v215
v_cvt_pk_bf16_f32 v214, v216, v217
v_cvt_pk_bf16_f32 v215, v218, v219
v_pk_fma_f32 v[244:245], v[88:89], v[56:57], v[244:245] op_sel:[0,0,0] op_sel_hi:[1,0,1]
v_pk_fma_f32 v[246:247], v[90:91], v[56:57], v[246:247] op_sel:[0,0,0] op_sel_hi:[1,0,1]
v_pk_mul_f32 v[244:245], v[244:245], v[72:73]
v_pk_mul_f32 v[246:247], v[246:247], v[74:75]
v_cvt_pk_bf16_f32 v108, v244, v245
v_cvt_pk_bf16_f32 v109, v246, v247
v_pk_fma_f32 v[248:249], v[88:89], v[56:57], v[248:249] op_sel:[0,1,0] op_sel_hi:[1,1,1]
v_pk_fma_f32 v[250:251], v[90:91], v[56:57], v[250:251] op_sel:[0,1,0] op_sel_hi:[1,1,1]
v_pk_mul_f32 v[248:249], v[248:249], v[72:73]
v_pk_mul_f32 v[250:251], v[250:251], v[74:75]
v_cvt_pk_bf16_f32 v118, v248, v249
v_cvt_pk_bf16_f32 v119, v250, v251
s_cmp_lg_u32 s44, 1
s_cbranch_scc1 else_103
buffer_store_dwordx4 v[212:215], v58, s[32:35], 0 offen sc1
buffer_store_dwordx2 v[108:109], v59, s[32:35], 0 offen offset:1024 sc1
buffer_store_dwordx2 v[118:119], v59, s[32:35], 0 offen offset:1536 sc1
s_branch fi_104
else_103:
ds_write_b128 v53, v[212:215]
ds_write_b64 v55, v[108:109] offset:1024
ds_write_b64 v55, v[118:119] offset:1536
v_mov_b32 v4, 3
ds_write_b32 v19, v4
fi_104:
v_mul_f32 v124, s66, v92
v_mul_f32 v125, s66, v94
v_mul_f32 v126, s66, v96
v_mul_f32 v127, s66, v98
.p2align 3
v_pk_fma_f32 v[156:157], v[140:141], v[92:93], v[156:157] op_sel:[0,1,0] op_sel_hi:[1,1,1]
v_pk_fma_f32 v[158:159], v[142:143], v[92:93], v[158:159] op_sel:[0,1,0] op_sel_hi:[1,1,1]
v_pk_fma_f32 v[160:161], v[144:145], v[92:93], v[160:161] op_sel:[0,1,0] op_sel_hi:[1,1,1]
v_pk_fma_f32 v[162:163], v[146:147], v[92:93], v[162:163] op_sel:[0,1,0] op_sel_hi:[1,1,1]
v_cvt_pk_bf16_f32 v156, v156, v157
v_cvt_pk_bf16_f32 v157, v158, v159
v_cvt_pk_bf16_f32 v158, v160, v161
v_cvt_pk_bf16_f32 v159, v162, v163
v_pk_fma_f32 v[164:165], v[140:141], v[94:95], v[164:165] op_sel:[0,1,0] op_sel_hi:[1,1,1]
v_pk_fma_f32 v[166:167], v[142:143], v[94:95], v[166:167] op_sel:[0,1,0] op_sel_hi:[1,1,1]
v_pk_fma_f32 v[168:169], v[144:145], v[94:95], v[168:169] op_sel:[0,1,0] op_sel_hi:[1,1,1]
v_pk_fma_f32 v[170:171], v[146:147], v[94:95], v[170:171] op_sel:[0,1,0] op_sel_hi:[1,1,1]
v_cvt_pk_bf16_f32 v164, v164, v165
v_cvt_pk_bf16_f32 v165, v166, v167
v_cvt_pk_bf16_f32 v166, v168, v169
v_cvt_pk_bf16_f32 v167, v170, v171
v_pk_fma_f32 v[172:173], v[140:141], v[96:97], v[172:173] op_sel:[0,1,0] op_sel_hi:[1,1,1]
v_pk_fma_f32 v[174:175], v[142:143], v[96:97], v[174:175] op_sel:[0,1,0] op_sel_hi:[1,1,1]
v_pk_fma_f32 v[176:177], v[144:145], v[96:97], v[176:177] op_sel:[0,1,0] op_sel_hi:[1,1,1]
v_pk_fma_f32 v[178:179], v[146:147], v[96:97], v[178:179] op_sel:[0,1,0] op_sel_hi:[1,1,1]
v_cvt_pk_bf16_f32 v172, v172, v173
v_cvt_pk_bf16_f32 v173, v174, v175
v_cvt_pk_bf16_f32 v174, v176, v177
v_cvt_pk_bf16_f32 v175, v178, v179
v_pk_fma_f32 v[180:181], v[140:141], v[98:99], v[180:181] op_sel:[0,1,0] op_sel_hi:[1,1,1]
v_pk_fma_f32 v[182:183], v[142:143], v[98:99], v[182:183] op_sel:[0,1,0] op_sel_hi:[1,1,1]
v_pk_fma_f32 v[184:185], v[144:145], v[98:99], v[184:185] op_sel:[0,1,0] op_sel_hi:[1,1,1]
v_pk_fma_f32 v[186:187], v[146:147], v[98:99], v[186:187] op_sel:[0,1,0] op_sel_hi:[1,1,1]
v_cvt_pk_bf16_f32 v180, v180, v181
v_cvt_pk_bf16_f32 v181, v182, v183
v_cvt_pk_bf16_f32 v182, v184, v185
v_cvt_pk_bf16_f32 v183, v186, v187
v_pk_fma_f32 v[188:189], v[148:149], v[92:93], v[188:189] op_sel:[0,1,0] op_sel_hi:[1,1,1]
v_pk_fma_f32 v[190:191], v[150:151], v[92:93], v[190:191] op_sel:[0,1,0] op_sel_hi:[1,1,1]
v_pk_fma_f32 v[192:193], v[152:153], v[92:93], v[192:193] op_sel:[0,1,0] op_sel_hi:[1,1,1]
v_pk_fma_f32 v[194:195], v[154:155], v[92:93], v[194:195] op_sel:[0,1,0] op_sel_hi:[1,1,1]
v_pk_mul_f32 v[188:189], v[188:189], v[92:93] op_sel:[0,0] op_sel_hi:[1,0]
v_pk_mul_f32 v[190:191], v[190:191], v[92:93] op_sel:[0,0] op_sel_hi:[1,0]
v_pk_mul_f32 v[192:193], v[192:193], v[92:93] op_sel:[0,0] op_sel_hi:[1,0]
v_pk_mul_f32 v[194:195], v[194:195], v[92:93] op_sel:[0,0] op_sel_hi:[1,0]
v_cvt_pk_bf16_f32 v188, v188, v189
v_cvt_pk_bf16_f32 v189, v190, v191
v_cvt_pk_bf16_f32 v190, v192, v193
v_cvt_pk_bf16_f32 v191, v194, v195
v_pk_fma_f32 v[196:197], v[148:149], v[94:95], v[196:197] op_sel:[0,1,0] op_sel_hi:[1,1,1]
v_pk_fma_f32 v[198:199], v[150:151], v[94:95], v[198:199] op_sel:[0,1,0] op_sel_hi:[1,1,1]
v_pk_fma_f32 v[200:201], v[152:153], v[94:95], v[200:201] op_sel:[0,1,0] op_sel_hi:[1,1,1]
v_pk_fma_f32 v[202:203], v[154:155], v[94:95], v[202:203] op_sel:[0,1,0] op_sel_hi:[1,1,1]
v_pk_mul_f32 v[196:197], v[196:197], v[94:95] op_sel:[0,0] op_sel_hi:[1,0]
v_pk_mul_f32 v[198:199], v[198:199], v[94:95] op_sel:[0,0] op_sel_hi:[1,0]
v_pk_mul_f32 v[200:201], v[200:201], v[94:95] op_sel:[0,0] op_sel_hi:[1,0]
v_pk_mul_f32 v[202:203], v[202:203], v[94:95] op_sel:[0,0] op_sel_hi:[1,0]
v_cvt_pk_bf16_f32 v196, v196, v197
v_cvt_pk_bf16_f32 v197, v198, v199
v_cvt_pk_bf16_f32 v198, v200, v201
v_cvt_pk_bf16_f32 v199, v202, v203
v_pk_fma_f32 v[204:205], v[148:149], v[96:97], v[204:205] op_sel:[0,1,0] op_sel_hi:[1,1,1]
v_pk_fma_f32 v[206:207], v[150:151], v[96:97], v[206:207] op_sel:[0,1,0] op_sel_hi:[1,1,1]
v_pk_fma_f32 v[208:209], v[152:153], v[96:97], v[208:209] op_sel:[0,1,0] op_sel_hi:[1,1,1]
v_pk_fma_f32 v[210:211], v[154:155], v[96:97], v[210:211] op_sel:[0,1,0] op_sel_hi:[1,1,1]
v_pk_mul_f32 v[204:205], v[204:205], v[96:97] op_sel:[0,0] op_sel_hi:[1,0]
v_pk_mul_f32 v[206:207], v[206:207], v[96:97] op_sel:[0,0] op_sel_hi:[1,0]
v_pk_mul_f32 v[208:209], v[208:209], v[96:97] op_sel:[0,0] op_sel_hi:[1,0]
v_pk_mul_f32 v[210:211], v[210:211], v[96:97] op_sel:[0,0] op_sel_hi:[1,0]
v_cvt_pk_bf16_f32 v204, v204, v205
v_cvt_pk_bf16_f32 v205, v206, v207
v_cvt_pk_bf16_f32 v206, v208, v209
v_cvt_pk_bf16_f32 v207, v210, v211
s_cmp_lg_u32 s44, 0
s_cbranch_scc1 else_105
buffer_load_dwordx4 v[120:123], v58, s[32:35], 0 offen sc1
buffer_load_dwordx2 v[100:101], v59, s[32:35], 0 offen offset:1024 sc1
buffer_load_dwordx2 v[110:111], v59, s[32:35], 0 offen offset:1536 sc1
else_105:
.p2align 3
v_mfma_f32_16x16x32_bf16 v[216:219], v[212:215], v[180:183], v[40:43]
v_pk_fma_f32 v[220:221], v[76:77], v[56:57], v[220:221] op_sel:[0,0,0] op_sel_hi:[1,0,1]
v_pk_fma_f32 v[222:223], v[78:79], v[56:57], v[222:223] op_sel:[0,0,0] op_sel_hi:[1,0,1]
v_pk_mul_f32 v[220:221], v[220:221], v[60:61]
v_pk_mul_f32 v[222:223], v[222:223], v[62:63]
v_cvt_pk_bf16_f32 v102, v220, v221
v_mfma_f32_16x16x32_bf16 v[192:195], v[188:191], v[156:159], v[40:43]
v_cvt_pk_bf16_f32 v103, v222, v223
v_pk_fma_f32 v[224:225], v[76:77], v[56:57], v[224:225] op_sel:[0,1,0] op_sel_hi:[1,1,1]
v_pk_fma_f32 v[226:227], v[78:79], v[56:57], v[226:227] op_sel:[0,1,0] op_sel_hi:[1,1,1]
v_pk_mul_f32 v[224:225], v[224:225], v[60:61]
v_pk_mul_f32 v[226:227], v[226:227], v[62:63]
v_cvt_pk_bf16_f32 v112, v224, v225
v_mfma_f32_16x16x32_bf16 v[168:171], v[188:191], v[164:167], v[36:39]
v_cvt_pk_bf16_f32 v113, v226, v227
v_pk_fma_f32 v[228:229], v[80:81], v[56:57], v[228:229] op_sel:[0,0,0] op_sel_hi:[1,0,1]
v_pk_fma_f32 v[230:231], v[82:83], v[56:57], v[230:231] op_sel:[0,0,0] op_sel_hi:[1,0,1]
v_pk_mul_f32 v[228:229], v[228:229], v[64:65]
v_pk_mul_f32 v[230:231], v[230:231], v[66:67]
v_cvt_pk_bf16_f32 v104, v228, v229
v_mfma_f32_16x16x32_bf16 v[200:203], v[196:199], v[164:167], v[40:43]
v_cvt_pk_bf16_f32 v105, v230, v231
v_pk_fma_f32 v[232:233], v[80:81], v[56:57], v[232:233] op_sel:[0,1,0] op_sel_hi:[1,1,1]
v_pk_fma_f32 v[234:235], v[82:83], v[56:57], v[234:235] op_sel:[0,1,0] op_sel_hi:[1,1,1]
v_pk_mul_f32 v[232:233], v[232:233], v[64:65]
v_pk_mul_f32 v[234:235], v[234:235], v[66:67]
v_cvt_pk_bf16_f32 v114, v232, v233
v_mfma_f32_16x16x32_bf16 v[176:179], v[196:199], v[172:175], v[36:39]
v_cvt_pk_bf16_f32 v115, v234, v235
v_pk_fma_f32 v[236:237], v[84:85], v[56:57], v[236:237] op_sel:[0,0,0] op_sel_hi:[1,0,1]
v_pk_fma_f32 v[238:239], v[86:87], v[56:57], v[238:239] op_sel:[0,0,0] op_sel_hi:[1,0,1]
v_pk_mul_f32 v[236:237], v[236:237], v[68:69]
v_pk_mul_f32 v[238:239], v[238:239], v[70:71]
v_cvt_pk_bf16_f32 v106, v236, v237
v_mfma_f32_16x16x32_bf16 v[208:211], v[204:207], v[172:175], v[40:43]
v_cvt_pk_bf16_f32 v107, v238, v239
v_pk_fma_f32 v[240:241], v[84:85], v[56:57], v[240:241] op_sel:[0,1,0] op_sel_hi:[1,1,1]
v_pk_fma_f32 v[242:243], v[86:87], v[56:57], v[242:243] op_sel:[0,1,0] op_sel_hi:[1,1,1]
v_pk_mul_f32 v[240:241], v[240:241], v[68:69]
v_pk_mul_f32 v[242:243], v[242:243], v[70:71]
v_cvt_pk_bf16_f32 v116, v240, v241
v_mfma_f32_16x16x32_bf16 v[184:187], v[204:207], v[180:183], v[36:39]
v_cvt_pk_bf16_f32 v117, v242, v243
v_max_f32 v166, v200, v201
v_max_f32 v167, v202, v203
v_max_f32 v164, v168, v169
v_max_f32 v165, v170, v171
v_max3_f32 v129, v164, v165, v166
v_max_f32 v129, v129, v167
s_cmp_lg_u32 s44, 0
s_cbranch_scc1 else_107
s_mov_b32 s63, 0
sent_109:
s_waitcnt vmcnt(0)
v_max_u32 v4, v120, v121
v_max3_u32 v4, v4, v122, v123
v_max3_u32 v4, v4, v100, v101
v_max3_u32 v4, v4, v110, v111
v_cmp_eq_u32 vcc, -1, v4
s_cbranch_vccz sentd_110
buffer_load_dwordx4 v[120:123], v58, s[32:35], 0 offen sc1
buffer_load_dwordx2 v[100:101], v59, s[32:35], 0 offen offset:1024 sc1
buffer_load_dwordx2 v[110:111], v59, s[32:35], 0 offen offset:1536 sc1
s_add_u32 s63, s63, 1
s_cmp_lt_u32 s63, 0x80000
s_cbranch_scc1 sent_109
s_waitcnt vmcnt(0)
sentd_110:
s_branch fi_108
else_107:
s_mov_b32 s63, 0
px_111:
ds_read_b32 v4, v19
ds_read_b128 v[120:123], v53
ds_read_b64 v[100:101], v55 offset:1024
ds_read_b64 v[110:111], v55 offset:1536
s_add_u32 s63, s63, 1
s_cmp_lt_u32 s63, 0x400000
s_waitcnt lgkmcnt(0)
v_cmp_ne_u32 vcc, 3, v4
s_cbranch_vccz pxd_112
s_cbranch_scc1 px_111
pxd_112:
fi_108:
v_mfma_f32_16x16x32_bf16 v[160:163], v[120:123], v[156:159], v[44:47]
v_max_f32 v174, v208, v209
v_max_f32 v175, v210, v211
v_max_f32 v172, v176, v177
v_max_f32 v173, v178, v179
v_max3_f32 v130, v172, v173, v174
v_max_f32 v130, v130, v175
v_max_f32 v182, v216, v217
v_max_f32 v183, v218, v219
v_max_f32 v180, v184, v185
v_max_f32 v181, v186, v187
v_max3_f32 v131, v180, v181, v182
v_max_f32 v131, v131, v183
v_max_f32 v158, v192, v193
v_max_f32 v159, v194, v195
v_max_f32 v156, v160, v161
v_max_f32 v157, v162, v163
v_max3_f32 v128, v156, v157, v158
v_max_f32 v128, v128, v159
s_nop 1
v_permlane32_swap_b32 v128, v129
v_permlane32_swap_b32 v130, v131
v_max_f32 v128, v128, v129
v_max_f32 v130, v130, v131
s_nop 1
v_permlane16_swap_b32 v128, v130
s_nop 0
v_max_f32 v128, v128, v130
v_mov_b32 v130, v128
s_nop 1
v_permlane16_swap_b32 v128, v130
s_nop 0
v_mov_b32 v129, v128
v_mov_b32 v131, v130
s_nop 0
v_permlane32_swap_b32 v128, v129
v_permlane32_swap_b32 v130, v131
v_pk_mul_f32 v[128:129], v[128:129], v[124:125]
v_pk_mul_f32 v[130:131], v[130:131], v[126:127]
v_pk_fma_f32 v[156:157], v[156:157], v[124:125], v[128:129] op_sel:[0,0,0] op_sel_hi:[1,0,0] neg_lo:[0,0,1] neg_hi:[0,0,1]
v_pk_fma_f32 v[158:159], v[158:159], v[124:125], v[128:129] op_sel:[0,0,0] op_sel_hi:[1,0,0] neg_lo:[0,0,1] neg_hi:[0,0,1]
v_exp_f32 v156, v156
v_exp_f32 v157, v157
v_exp_f32 v158, v158
v_exp_f32 v159, v159
v_cvt_pk_bf16_f32 v156, v156, v156
v_cvt_pk_bf16_f32 v157, v157, v157
v_cvt_pk_bf16_f32 v158, v158, v158
v_cvt_pk_bf16_f32 v159, v159, v159
v_and_b32 v156, v52, v156
v_and_b32 v157, v52, v157
v_and_b32 v158, v52, v158
v_and_b32 v159, v52, v159
v_pk_fma_f32 v[164:165], v[164:165], v[124:125], v[128:129] op_sel:[0,1,1] op_sel_hi:[1,1,1] neg_lo:[0,0,1] neg_hi:[0,0,1]
v_pk_fma_f32 v[166:167], v[166:167], v[124:125], v[128:129] op_sel:[0,1,1] op_sel_hi:[1,1,1] neg_lo:[0,0,1] neg_hi:[0,0,1]
v_exp_f32 v164, v164
v_mfma_f32_16x16x32_bf16 v[160:163], v[48:51], v[156:159], 0
v_exp_f32 v165, v165
v_exp_f32 v166, v166
v_exp_f32 v167, v167
v_cvt_pk_bf16_f32 v164, v164, v164
v_mfma_f32_16x16x32_bf16 v[220:223], v[100:103], v[156:159], 0
v_cvt_pk_bf16_f32 v165, v165, v165
v_cvt_pk_bf16_f32 v166, v166, v166
v_cvt_pk_bf16_f32 v167, v167, v167
v_and_b32 v164, v52, v164
v_mfma_f32_16x16x32_bf16 v[224:227], v[110:113], v[156:159], 0
v_and_b32 v165, v52, v165
v_and_b32 v166, v52, v166
v_and_b32 v167, v52, v167
v_pk_fma_f32 v[172:173], v[172:173], v[126:127], v[130:131] op_sel:[0,0,0] op_sel_hi:[1,0,0] neg_lo:[0,0,1] neg_hi:[0,0,1]
v_pk_fma_f32 v[174:175], v[174:175], v[126:127], v[130:131] op_sel:[0,0,0] op_sel_hi:[1,0,0] neg_lo:[0,0,1] neg_hi:[0,0,1]
v_exp_f32 v172, v172
v_mfma_f32_16x16x32_bf16 v[168:171], v[48:51], v[164:167], 0
v_exp_f32 v173, v173
v_exp_f32 v174, v174
v_exp_f32 v175, v175
v_cvt_pk_bf16_f32 v172, v172, v172
v_mfma_f32_16x16x32_bf16 v[228:231], v[102:105], v[164:167], 0
v_cvt_pk_bf16_f32 v173, v173, v173
v_cvt_pk_bf16_f32 v174, v174, v174
v_cvt_pk_bf16_f32 v175, v175, v175
v_and_b32 v172, v52, v172
v_mfma_f32_16x16x32_bf16 v[232:235], v[112:115], v[164:167], 0
v_and_b32 v173, v52, v173
v_and_b32 v174, v52, v174
v_and_b32 v175, v52, v175
v_pk_fma_f32 v[180:181], v[180:181], v[126:127], v[130:131] op_sel:[0,1,1] op_sel_hi:[1,1,1] neg_lo:[0,0,1] neg_hi:[0,0,1]
v_pk_fma_f32 v[182:183], v[182:183], v[126:127], v[130:131] op_sel:[0,1,1] op_sel_hi:[1,1,1] neg_lo:[0,0,1] neg_hi:[0,0,1]
v_exp_f32 v180, v180
v_mfma_f32_16x16x32_bf16 v[176:179], v[48:51], v[172:175], 0
v_exp_f32 v181, v181
v_exp_f32 v182, v182
v_exp_f32 v183, v183
v_cvt_pk_bf16_f32 v180, v180, v180
v_mfma_f32_16x16x32_bf16 v[236:239], v[104:107], v[172:175], 0
v_cvt_pk_bf16_f32 v181, v181, v181
v_cvt_pk_bf16_f32 v182, v182, v182
v_cvt_pk_bf16_f32 v183, v183, v183
v_and_b32 v180, v52, v180
v_mfma_f32_16x16x32_bf16 v[240:243], v[114:117], v[172:175], 0
v_and_b32 v181, v52, v181
v_and_b32 v182, v52, v182
v_and_b32 v183, v52, v183
v_rcp_f32 v160, v160
v_rcp_f32 v168, v168
v_mfma_f32_16x16x32_bf16 v[184:187], v[48:51], v[180:183], 0
v_mfma_f32_16x16x32_bf16 v[244:247], v[106:109], v[180:183], 0
v_mfma_f32_16x16x32_bf16 v[248:251], v[116:119], v[180:183], 0
v_rcp_f32 v176, v176
s_nop 4
v_rcp_f32 v184, v184
s_cmp_eq_u32 s46, 0
s_cbranch_scc1 slow_113
.p2align 3
v_pk_mul_f32 v[220:221], v[220:221], v[160:161] op_sel:[0,0] op_sel_hi:[1,0]
v_pk_mul_f32 v[222:223], v[222:223], v[160:161] op_sel:[0,0] op_sel_hi:[1,0]
v_pk_mul_f32 v[224:225], v[224:225], v[160:161] op_sel:[0,0] op_sel_hi:[1,0]
v_pk_mul_f32 v[226:227], v[226:227], v[160:161] op_sel:[0,0] op_sel_hi:[1,0]
v_cvt_pk_bf16_f32 v220, v220, v221
v_cvt_pk_bf16_f32 v221, v222, v223
v_cvt_pk_bf16_f32 v222, v224, v225
v_cvt_pk_bf16_f32 v223, v226, v227
buffer_store_dwordx4 v[220:223], v18, s[32:35], s80 offen
v_pk_mul_f32 v[228:229], v[228:229], v[168:169] op_sel:[0,0] op_sel_hi:[1,0]
v_pk_mul_f32 v[230:231], v[230:231], v[168:169] op_sel:[0,0] op_sel_hi:[1,0]
v_pk_mul_f32 v[232:233], v[232:233], v[168:169] op_sel:[0,0] op_sel_hi:[1,0]
v_pk_mul_f32 v[234:235], v[234:235], v[168:169] op_sel:[0,0] op_sel_hi:[1,0]
v_cvt_pk_bf16_f32 v228, v228, v229
v_cvt_pk_bf16_f32 v229, v230, v231
v_cvt_pk_bf16_f32 v230, v232, v233
v_cvt_pk_bf16_f32 v231, v234, v235
buffer_store_dwordx4 v[228:231], v18, s[32:35], s81 offen
v_pk_mul_f32 v[236:237], v[236:237], v[176:177] op_sel:[0,0] op_sel_hi:[1,0]
v_pk_mul_f32 v[238:239], v[238:239], v[176:177] op_sel:[0,0] op_sel_hi:[1,0]
v_pk_mul_f32 v[240:241], v[240:241], v[176:177] op_sel:[0,0] op_sel_hi:[1,0]
v_pk_mul_f32 v[242:243], v[242:243], v[176:177] op_sel:[0,0] op_sel_hi:[1,0]
v_cvt_pk_bf16_f32 v236, v236, v237
v_cvt_pk_bf16_f32 v237, v238, v239
v_cvt_pk_bf16_f32 v238, v240, v241
v_cvt_pk_bf16_f32 v239, v242, v243
buffer_store_dwordx4 v[236:239], v18, s[32:35], s82 offen
v_pk_mul_f32 v[244:245], v[244:245], v[184:185] op_sel:[0,0] op_sel_hi:[1,0]
v_pk_mul_f32 v[246:247], v[246:247], v[184:185] op_sel:[0,0] op_sel_hi:[1,0]
v_pk_mul_f32 v[248:249], v[248:249], v[184:185] op_sel:[0,0] op_sel_hi:[1,0]
v_pk_mul_f32 v[250:251], v[250:251], v[184:185] op_sel:[0,0] op_sel_hi:[1,0]
v_cvt_pk_bf16_f32 v244, v244, v245
v_cvt_pk_bf16_f32 v245, v246, v247
v_cvt_pk_bf16_f32 v246, v248, v249
v_cvt_pk_bf16_f32 v247, v250, v251
buffer_store_dwordx4 v[244:247], v18, s[32:35], s83 offen
back_114:
s_barrier
v_and_b32 v36, 31, v0
v_lshlrev_b32 v36, 2, v36
s_lshl_b32 s62, s45, 2
v_mov_b32 v4, s62
v_mov_b32 v5, 3
s_mov_b64 exec, 1
s_waitcnt vmcnt(0)
s_cmp_eq_u32 s46, 0
s_cbranch_scc1 slow_115
buffer_store_dword v5, v4, s[32:35], s84 offen
back_116:
s_mov_b64 exec, -1
v_lshrrev_b32 v4, 2, v2
v_and_b32 v5, 3, v0
v_lshl_add_u32 v6, v3, 3, v4
v_lshlrev_b32 v6, 7, v6
v_lshl_add_u32 v6, v5, 3, v6
v_lshrrev_b32 v7, 1, v4
v_and_b32 v8, 1, v3
v_lshl_add_u32 v7, v8, 1, v7
v_lshl_add_u32 v10, v7, 5, v6
v_xor_b32 v11, 32, v10
v_xor_b32 v12, 64, v10
v_xor_b32 v13, 96, v10
v_add_u32 v14, 0x10000, v10
v_add_u32 v15, 0x10000, v11
v_add_u32 v16, 0x10000, v12
v_add_u32 v17, 0x10000, v13
ds_read_b64_tr_b16 v[220:221], v10 offset:0
ds_read_b64_tr_b16 v[222:223], v10 offset:512
ds_read_b64_tr_b16 v[224:225], v11 offset:0
ds_read_b64_tr_b16 v[226:227], v11 offset:512
ds_read_b64_tr_b16 v[228:229], v12 offset:0
ds_read_b64_tr_b16 v[230:231], v12 offset:512
ds_read_b64_tr_b16 v[232:233], v13 offset:0
ds_read_b64_tr_b16 v[234:235], v13 offset:512
ds_read_b64_tr_b16 v[236:237], v10 offset:4096
ds_read_b64_tr_b16 v[238:239], v10 offset:4608
ds_read_b64_tr_b16 v[240:241], v11 offset:4096
ds_read_b64_tr_b16 v[242:243], v11 offset:4608
ds_read_b64_tr_b16 v[244:245], v12 offset:4096
ds_read_b64_tr_b16 v[246:247], v12 offset:4608
ds_read_b64_tr_b16 v[248:249], v13 offset:4096
ds_read_b64_tr_b16 v[250:251], v13 offset:4608
s_lshl_b32 s48, s41, 3
s_lshl_b32 s49, s40, 1
s_add_u32 s48, s48, s49
s_lshl_b32 s48, s48, 15
s_add_u32 s48, s48, 4194304
v_add_u32 v38, s48, v18
v_add_u32 v39, 32768, v38
s_lshl_b32 s57, s75, 11
s_add_u32 s87, s87, 262144
v_lshlrev_b32 v60, 16, v20
v_and_b32 v61, 0xffff0000, v20
v_lshlrev_b32 v62, 16, v21
v_and_b32 v63, 0xffff0000, v21
v_lshlrev_b32 v64, 16, v22
v_and_b32 v65, 0xffff0000, v22
v_lshlrev_b32 v66, 16, v23
v_and_b32 v67, 0xffff0000, v23
v_lshlrev_b32 v68, 16, v24
v_and_b32 v69, 0xffff0000, v24
v_lshlrev_b32 v70, 16, v25
v_and_b32 v71, 0xffff0000, v25
v_lshlrev_b32 v72, 16, v26
v_and_b32 v73, 0xffff0000, v26
v_lshlrev_b32 v74, 16, v27
v_and_b32 v75, 0xffff0000, v27
v_lshlrev_b32 v76, 16, v28
v_and_b32 v77, 0xffff0000, v28
v_lshlrev_b32 v78, 16, v29
v_and_b32 v79, 0xffff0000, v29
v_lshlrev_b32 v80, 16, v30
v_and_b32 v81, 0xffff0000, v30
v_lshlrev_b32 v82, 16, v31
v_and_b32 v83, 0xffff0000, v31
v_lshlrev_b32 v84, 16, v32
v_and_b32 v85, 0xffff0000, v32
v_lshlrev_b32 v86, 16, v33
v_and_b32 v87, 0xffff0000, v33
v_lshlrev_b32 v88, 16, v34
v_and_b32 v89, 0xffff0000, v34
v_lshlrev_b32 v90, 16, v35
v_and_b32 v91, 0xffff0000, v35
v_mov_b32 v6, 0
v_mov_b32 v7, 0
v_mov_b32 v8, 0
v_mov_b32 v9, 0
s_lshl_b32 s62, s42, 2
v_mov_b32 v4, s62
v_mov_b32 v5, 3
buffer_load_dword v37, v36, s[32:35], s84 offen sc1
s_mov_b32 s63, 0
s_waitcnt vmcnt(0)
poll_117:
v_cmp_gt_u32 vcc, 3, v37
s_cbranch_vccz polled_118
buffer_load_dword v37, v36, s[32:35], s84 offen sc1
s_add_u32 s63, s63, 1
s_cmp_lt_u32 s63, 0x80000
s_waitcnt vmcnt(0)
s_cbranch_scc1 poll_117
polled_118:
buffer_load_dwordx4 v[156:159], v38, s[32:35], s57 offen sc1
buffer_load_dwordx4 v[160:163], v39, s[32:35], s57 offen sc1
buffer_load_dwordx4 v[164:167], v38, s[32:35], s57 offen offset:1024 sc1
buffer_load_dwordx4 v[168:171], v39, s[32:35], s57 offen offset:1024 sc1
s_add_u32 s57, s57, 2048
s_and_b32 s57, s57, 0x7fff
buffer_load_dwordx4 v[172:175], v38, s[32:35], s57 offen sc1
buffer_load_dwordx4 v[176:179], v39, s[32:35], s57 offen sc1
buffer_load_dwordx4 v[180:183], v38, s[32:35], s57 offen offset:1024 sc1
buffer_load_dwordx4 v[184:187], v39, s[32:35], s57 offen offset:1024 sc1
s_add_u32 s57, s57, 2048
s_and_b32 s57, s57, 0x7fff
s_waitcnt vmcnt(6) lgkmcnt(8)
v_mfma_f32_16x16x32_bf16 v[60:63], v[220:223], v[156:159], v[60:63]
buffer_load_dwordx4 v[188:191], v38, s[32:35], s57 offen sc1
v_mfma_f32_16x16x32_bf16 v[76:79], v[220:223], v[160:163], v[76:79]
ds_read_b64_tr_b16 v[100:101], v10 offset:8192
ds_read_b64_tr_b16 v[102:103], v10 offset:8704
v_mfma_f32_16x16x32_bf16 v[64:67], v[224:227], v[156:159], v[64:67]
ds_read_b64_tr_b16 v[104:105], v11 offset:8192
ds_read_b64_tr_b16 v[106:107], v11 offset:8704
v_mfma_f32_16x16x32_bf16 v[80:83], v[224:227], v[160:163], v[80:83]
buffer_load_dwordx4 v[192:195], v39, s[32:35], s57 offen sc1
v_mfma_f32_16x16x32_bf16 v[68:71], v[228:231], v[156:159], v[68:71]
ds_read_b64_tr_b16 v[108:109], v12 offset:8192
ds_read_b64_tr_b16 v[110:111], v12 offset:8704
v_mfma_f32_16x16x32_bf16 v[84:87], v[228:231], v[160:163], v[84:87]
ds_read_b64_tr_b16 v[112:113], v13 offset:8192
ds_read_b64_tr_b16 v[114:115], v13 offset:8704
v_mfma_f32_16x16x32_bf16 v[72:75], v[232:235], v[156:159], v[72:75]
v_mfma_f32_16x16x32_bf16 v[88:91], v[232:235], v[160:163], v[88:91]
s_waitcnt vmcnt(6) lgkmcnt(8)
v_mfma_f32_16x16x32_bf16 v[60:63], v[236:239], v[164:167], v[60:63]
buffer_load_dwordx4 v[196:199], v38, s[32:35], s57 offen offset:1024 sc1
v_mfma_f32_16x16x32_bf16 v[76:79], v[236:239], v[168:171], v[76:79]
ds_read_b64_tr_b16 v[220:221], v10 offset:12288
ds_read_b64_tr_b16 v[222:223], v10 offset:12800
v_mfma_f32_16x16x32_bf16 v[64:67], v[240:243], v[164:167], v[64:67]
ds_read_b64_tr_b16 v[224:225], v11 offset:12288
ds_read_b64_tr_b16 v[226:227], v11 offset:12800
v_mfma_f32_16x16x32_bf16 v[80:83], v[240:243], v[168:171], v[80:83]
buffer_load_dwordx4 v[200:203], v39, s[32:35], s57 offen offset:1024 sc1
v_mfma_f32_16x16x32_bf16 v[68:71], v[244:247], v[164:167], v[68:71]
ds_read_b64_tr_b16 v[228:229], v12 offset:12288
ds_read_b64_tr_b16 v[230:231], v12 offset:12800
v_mfma_f32_16x16x32_bf16 v[84:87], v[244:247], v[168:171], v[84:87]
ds_read_b64_tr_b16 v[232:233], v13 offset:12288
ds_read_b64_tr_b16 v[234:235], v13 offset:12800
v_mfma_f32_16x16x32_bf16 v[72:75], v[248:251], v[164:167], v[72:75]
s_add_u32 s57, s57, 2048
s_and_b32 s57, s57, 0x7fff
v_mfma_f32_16x16x32_bf16 v[88:91], v[248:251], v[168:171], v[88:91]
s_waitcnt vmcnt(6) lgkmcnt(8)
v_mfma_f32_16x16x32_bf16 v[60:63], v[100:103], v[172:175], v[60:63]
buffer_load_dwordx4 v[204:207], v38, s[32:35], s57 offen sc1
v_mfma_f32_16x16x32_bf16 v[76:79], v[100:103], v[176:179], v[76:79]
ds_read_b64_tr_b16 v[236:237], v10 offset:16384
ds_read_b64_tr_b16 v[238:239], v10 offset:16896
v_mfma_f32_16x16x32_bf16 v[64:67], v[104:107], v[172:175], v[64:67]
ds_read_b64_tr_b16 v[240:241], v11 offset:16384
ds_read_b64_tr_b16 v[242:243], v11 offset:16896
v_mfma_f32_16x16x32_bf16 v[80:83], v[104:107], v[176:179], v[80:83]
buffer_load_dwordx4 v[208:211], v39, s[32:35], s57 offen sc1
v_mfma_f32_16x16x32_bf16 v[68:71], v[108:111], v[172:175], v[68:71]
ds_read_b64_tr_b16 v[244:245], v12 offset:16384
ds_read_b64_tr_b16 v[246:247], v12 offset:16896
v_mfma_f32_16x16x32_bf16 v[84:87], v[108:111], v[176:179], v[84:87]
ds_read_b64_tr_b16 v[248:249], v13 offset:16384
ds_read_b64_tr_b16 v[250:251], v13 offset:16896
v_mfma_f32_16x16x32_bf16 v[72:75], v[112:115], v[172:175], v[72:75]
v_mfma_f32_16x16x32_bf16 v[88:91], v[112:115], v[176:179], v[88:91]
s_waitcnt vmcnt(6) lgkmcnt(8)
v_mfma_f32_16x16x32_bf16 v[60:63], v[220:223], v[180:183], v[60:63]
buffer_load_dwordx4 v[212:215], v38, s[32:35], s57 offen offset:1024 sc1
v_mfma_f32_16x16x32_bf16 v[76:79], v[220:223], v[184:187], v[76:79]
ds_read_b64_tr_b16 v[100:101], v10 offset:20480
ds_read_b64_tr_b16 v[102:103], v10 offset:20992
v_mfma_f32_16x16x32_bf16 v[64:67], v[224:227], v[180:183], v[64:67]
ds_read_b64_tr_b16 v[104:105], v11 offset:20480
ds_read_b64_tr_b16 v[106:107], v11 offset:20992
v_mfma_f32_16x16x32_bf16 v[80:83], v[224:227], v[184:187], v[80:83]
buffer_load_dwordx4 v[216:219], v39, s[32:35], s57 offen offset:1024 sc1
v_mfma_f32_16x16x32_bf16 v[68:71], v[228:231], v[180:183], v[68:71]
ds_read_b64_tr_b16 v[108:109], v12 offset:20480
ds_read_b64_tr_b16 v[110:111], v12 offset:20992
v_mfma_f32_16x16x32_bf16 v[84:87], v[228:231], v[184:187], v[84:87]
ds_read_b64_tr_b16 v[112:113], v13 offset:20480
ds_read_b64_tr_b16 v[114:115], v13 offset:20992
v_mfma_f32_16x16x32_bf16 v[72:75], v[232:235], v[180:183], v[72:75]
s_add_u32 s57, s57, 2048
s_and_b32 s57, s57, 0x7fff
v_mfma_f32_16x16x32_bf16 v[88:91], v[232:235], v[184:187], v[88:91]
s_waitcnt vmcnt(6) lgkmcnt(8)
v_mfma_f32_16x16x32_bf16 v[60:63], v[236:239], v[188:191], v[60:63]
buffer_load_dwordx4 v[156:159], v38, s[32:35], s57 offen sc1
v_mfma_f32_16x16x32_bf16 v[76:79], v[236:239], v[192:195], v[76:79]
ds_read_b64_tr_b16 v[220:221], v10 offset:24576
ds_read_b64_tr_b16 v[222:223], v10 offset:25088
v_mfma_f32_16x16x32_bf16 v[64:67], v[240:243], v[188:191], v[64:67]
ds_read_b64_tr_b16 v[224:225], v11 offset:24576
ds_read_b64_tr_b16 v[226:227], v11 offset:25088
v_mfma_f32_16x16x32_bf16 v[80:83], v[240:243], v[192:195], v[80:83]
buffer_load_dwordx4 v[160:163], v39, s[32:35], s57 offen sc1
v_mfma_f32_16x16x32_bf16 v[68:71], v[244:247], v[188:191], v[68:71]
ds_read_b64_tr_b16 v[228:229], v12 offset:24576
ds_read_b64_tr_b16 v[230:231], v12 offset:25088
v_mfma_f32_16x16x32_bf16 v[84:87], v[244:247], v[192:195], v[84:87]
ds_read_b64_tr_b16 v[232:233], v13 offset:24576
ds_read_b64_tr_b16 v[234:235], v13 offset:25088
v_mfma_f32_16x16x32_bf16 v[72:75], v[248:251], v[188:191], v[72:75]
v_mfma_f32_16x16x32_bf16 v[88:91], v[248:251], v[192:195], v[88:91]
s_waitcnt vmcnt(6) lgkmcnt(8)
v_mfma_f32_16x16x32_bf16 v[60:63], v[100:103], v[196:199], v[60:63]
buffer_load_dwordx4 v[164:167], v38, s[32:35], s57 offen offset:1024 sc1
v_mfma_f32_16x16x32_bf16 v[76:79], v[100:103], v[200:203], v[76:79]
ds_read_b64_tr_b16 v[236:237], v10 offset:28672
ds_read_b64_tr_b16 v[238:239], v10 offset:29184
v_mfma_f32_16x16x32_bf16 v[64:67], v[104:107], v[196:199], v[64:67]
ds_read_b64_tr_b16 v[240:241], v11 offset:28672
ds_read_b64_tr_b16 v[242:243], v11 offset:29184
v_mfma_f32_16x16x32_bf16 v[80:83], v[104:107], v[200:203], v[80:83]
buffer_load_dwordx4 v[168:171], v39, s[32:35], s57 offen offset:1024 sc1
v_mfma_f32_16x16x32_bf16 v[68:71], v[108:111], v[196:199], v[68:71]
ds_read_b64_tr_b16 v[244:245], v12 offset:28672
ds_read_b64_tr_b16 v[246:247], v12 offset:29184
v_mfma_f32_16x16x32_bf16 v[84:87], v[108:111], v[200:203], v[84:87]
ds_read_b64_tr_b16 v[248:249], v13 offset:28672
ds_read_b64_tr_b16 v[250:251], v13 offset:29184
v_mfma_f32_16x16x32_bf16 v[72:75], v[112:115], v[196:199], v[72:75]
s_add_u32 s57, s57, 2048
s_and_b32 s57, s57, 0x7fff
v_mfma_f32_16x16x32_bf16 v[88:91], v[112:115], v[200:203], v[88:91]
s_waitcnt vmcnt(6) lgkmcnt(8)
v_mfma_f32_16x16x32_bf16 v[60:63], v[220:223], v[204:207], v[60:63]
buffer_load_dwordx4 v[172:175], v38, s[32:35], s57 offen sc1
v_mfma_f32_16x16x32_bf16 v[76:79], v[220:223], v[208:211], v[76:79]
ds_read_b64_tr_b16 v[100:101], v10 offset:32768
ds_read_b64_tr_b16 v[102:103], v10 offset:33280
v_mfma_f32_16x16x32_bf16 v[64:67], v[224:227], v[204:207], v[64:67]
ds_read_b64_tr_b16 v[104:105], v11 offset:32768
ds_read_b64_tr_b16 v[106:107], v11 offset:33280
v_mfma_f32_16x16x32_bf16 v[80:83], v[224:227], v[208:211], v[80:83]
buffer_load_dwordx4 v[176:179], v39, s[32:35], s57 offen sc1
v_mfma_f32_16x16x32_bf16 v[68:71], v[228:231], v[204:207], v[68:71]
ds_read_b64_tr_b16 v[108:109], v12 offset:32768
ds_read_b64_tr_b16 v[110:111], v12 offset:33280
v_mfma_f32_16x16x32_bf16 v[84:87], v[228:231], v[208:211], v[84:87]
ds_read_b64_tr_b16 v[112:113], v13 offset:32768
ds_read_b64_tr_b16 v[114:115], v13 offset:33280
v_mfma_f32_16x16x32_bf16 v[72:75], v[232:235], v[204:207], v[72:75]
v_mfma_f32_16x16x32_bf16 v[88:91], v[232:235], v[208:211], v[88:91]
s_waitcnt vmcnt(6) lgkmcnt(8)
v_mfma_f32_16x16x32_bf16 v[60:63], v[236:239], v[212:215], v[60:63]
buffer_load_dwordx4 v[180:183], v38, s[32:35], s57 offen offset:1024 sc1
v_mfma_f32_16x16x32_bf16 v[76:79], v[236:239], v[216:219], v[76:79]
ds_read_b64_tr_b16 v[220:221], v10 offset:36864
ds_read_b64_tr_b16 v[222:223], v10 offset:37376
v_mfma_f32_16x16x32_bf16 v[64:67], v[240:243], v[212:215], v[64:67]
ds_read_b64_tr_b16 v[224:225], v11 offset:36864
ds_read_b64_tr_b16 v[226:227], v11 offset:37376
v_mfma_f32_16x16x32_bf16 v[80:83], v[240:243], v[216:219], v[80:83]
buffer_load_dwordx4 v[184:187], v39, s[32:35], s57 offen offset:1024 sc1
v_mfma_f32_16x16x32_bf16 v[68:71], v[244:247], v[212:215], v[68:71]
ds_read_b64_tr_b16 v[228:229], v12 offset:36864
ds_read_b64_tr_b16 v[230:231], v12 offset:37376
v_mfma_f32_16x16x32_bf16 v[84:87], v[244:247], v[216:219], v[84:87]
ds_read_b64_tr_b16 v[232:233], v13 offset:36864
ds_read_b64_tr_b16 v[234:235], v13 offset:37376
v_mfma_f32_16x16x32_bf16 v[72:75], v[248:251], v[212:215], v[72:75]
s_add_u32 s57, s57, 2048
s_and_b32 s57, s57, 0x7fff
v_mfma_f32_16x16x32_bf16 v[88:91], v[248:251], v[216:219], v[88:91]
s_waitcnt vmcnt(6) lgkmcnt(8)
v_mfma_f32_16x16x32_bf16 v[60:63], v[100:103], v[156:159], v[60:63]
buffer_load_dwordx4 v[188:191], v38, s[32:35], s57 offen sc1
v_mfma_f32_16x16x32_bf16 v[76:79], v[100:103], v[160:163], v[76:79]
ds_read_b64_tr_b16 v[236:237], v10 offset:40960
ds_read_b64_tr_b16 v[238:239], v10 offset:41472
v_mfma_f32_16x16x32_bf16 v[64:67], v[104:107], v[156:159], v[64:67]
ds_read_b64_tr_b16 v[240:241], v11 offset:40960
ds_read_b64_tr_b16 v[242:243], v11 offset:41472
v_mfma_f32_16x16x32_bf16 v[80:83], v[104:107], v[160:163], v[80:83]
buffer_load_dwordx4 v[192:195], v39, s[32:35], s57 offen sc1
v_mfma_f32_16x16x32_bf16 v[68:71], v[108:111], v[156:159], v[68:71]
ds_read_b64_tr_b16 v[244:245], v12 offset:40960
ds_read_b64_tr_b16 v[246:247], v12 offset:41472
v_mfma_f32_16x16x32_bf16 v[84:87], v[108:111], v[160:163], v[84:87]
ds_read_b64_tr_b16 v[248:249], v13 offset:40960
ds_read_b64_tr_b16 v[250:251], v13 offset:41472
v_mfma_f32_16x16x32_bf16 v[72:75], v[112:115], v[156:159], v[72:75]
v_mfma_f32_16x16x32_bf16 v[88:91], v[112:115], v[160:163], v[88:91]
s_waitcnt vmcnt(6) lgkmcnt(8)
v_mfma_f32_16x16x32_bf16 v[60:63], v[220:223], v[164:167], v[60:63]
buffer_load_dwordx4 v[196:199], v38, s[32:35], s57 offen offset:1024 sc1
v_mfma_f32_16x16x32_bf16 v[76:79], v[220:223], v[168:171], v[76:79]
ds_read_b64_tr_b16 v[100:101], v10 offset:45056
ds_read_b64_tr_b16 v[102:103], v10 offset:45568
v_mfma_f32_16x16x32_bf16 v[64:67], v[224:227], v[164:167], v[64:67]
ds_read_b64_tr_b16 v[104:105], v11 offset:45056
ds_read_b64_tr_b16 v[106:107], v11 offset:45568
v_mfma_f32_16x16x32_bf16 v[80:83], v[224:227], v[168:171], v[80:83]
buffer_load_dwordx4 v[200:203], v39, s[32:35], s57 offen offset:1024 sc1
v_mfma_f32_16x16x32_bf16 v[68:71], v[228:231], v[164:167], v[68:71]
ds_read_b64_tr_b16 v[108:109], v12 offset:45056
ds_read_b64_tr_b16 v[110:111], v12 offset:45568
v_mfma_f32_16x16x32_bf16 v[84:87], v[228:231], v[168:171], v[84:87]
ds_read_b64_tr_b16 v[112:113], v13 offset:45056
ds_read_b64_tr_b16 v[114:115], v13 offset:45568
v_mfma_f32_16x16x32_bf16 v[72:75], v[232:235], v[164:167], v[72:75]
s_add_u32 s57, s57, 2048
s_and_b32 s57, s57, 0x7fff
v_mfma_f32_16x16x32_bf16 v[88:91], v[232:235], v[168:171], v[88:91]
s_waitcnt vmcnt(6) lgkmcnt(8)
v_mfma_f32_16x16x32_bf16 v[60:63], v[236:239], v[172:175], v[60:63]
buffer_load_dwordx4 v[204:207], v38, s[32:35], s57 offen sc1
v_mfma_f32_16x16x32_bf16 v[76:79], v[236:239], v[176:179], v[76:79]
ds_read_b64_tr_b16 v[220:221], v10 offset:49152
ds_read_b64_tr_b16 v[222:223], v10 offset:49664
v_mfma_f32_16x16x32_bf16 v[64:67], v[240:243], v[172:175], v[64:67]
ds_read_b64_tr_b16 v[224:225], v11 offset:49152
ds_read_b64_tr_b16 v[226:227], v11 offset:49664
v_mfma_f32_16x16x32_bf16 v[80:83], v[240:243], v[176:179], v[80:83]
buffer_load_dwordx4 v[208:211], v39, s[32:35], s57 offen sc1
v_mfma_f32_16x16x32_bf16 v[68:71], v[244:247], v[172:175], v[68:71]
ds_read_b64_tr_b16 v[228:229], v12 offset:49152
ds_read_b64_tr_b16 v[230:231], v12 offset:49664
v_mfma_f32_16x16x32_bf16 v[84:87], v[244:247], v[176:179], v[84:87]
ds_read_b64_tr_b16 v[232:233], v13 offset:49152
ds_read_b64_tr_b16 v[234:235], v13 offset:49664
v_mfma_f32_16x16x32_bf16 v[72:75], v[248:251], v[172:175], v[72:75]
v_mfma_f32_16x16x32_bf16 v[88:91], v[248:251], v[176:179], v[88:91]
s_waitcnt vmcnt(6) lgkmcnt(8)
v_mfma_f32_16x16x32_bf16 v[60:63], v[100:103], v[180:183], v[60:63]
buffer_load_dwordx4 v[212:215], v38, s[32:35], s57 offen offset:1024 sc1
v_mfma_f32_16x16x32_bf16 v[76:79], v[100:103], v[184:187], v[76:79]
ds_read_b64_tr_b16 v[236:237], v10 offset:53248
ds_read_b64_tr_b16 v[238:239], v10 offset:53760
v_mfma_f32_16x16x32_bf16 v[64:67], v[104:107], v[180:183], v[64:67]
ds_read_b64_tr_b16 v[240:241], v11 offset:53248
ds_read_b64_tr_b16 v[242:243], v11 offset:53760
v_mfma_f32_16x16x32_bf16 v[80:83], v[104:107], v[184:187], v[80:83]
buffer_load_dwordx4 v[216:219], v39, s[32:35], s57 offen offset:1024 sc1
v_mfma_f32_16x16x32_bf16 v[68:71], v[108:111], v[180:183], v[68:71]
ds_read_b64_tr_b16 v[244:245], v12 offset:53248
ds_read_b64_tr_b16 v[246:247], v12 offset:53760
v_mfma_f32_16x16x32_bf16 v[84:87], v[108:111], v[184:187], v[84:87]
ds_read_b64_tr_b16 v[248:249], v13 offset:53248
ds_read_b64_tr_b16 v[250:251], v13 offset:53760
v_mfma_f32_16x16x32_bf16 v[72:75], v[112:115], v[180:183], v[72:75]
s_add_u32 s57, s57, 2048
s_and_b32 s57, s57, 0x7fff
v_mfma_f32_16x16x32_bf16 v[88:91], v[112:115], v[184:187], v[88:91]
s_waitcnt vmcnt(6) lgkmcnt(8)
v_mfma_f32_16x16x32_bf16 v[60:63], v[220:223], v[188:191], v[60:63]
buffer_load_dwordx4 v[156:159], v38, s[32:35], s57 offen sc1
v_mfma_f32_16x16x32_bf16 v[76:79], v[220:223], v[192:195], v[76:79]
ds_read_b64_tr_b16 v[100:101], v10 offset:57344
ds_read_b64_tr_b16 v[102:103], v10 offset:57856
v_mfma_f32_16x16x32_bf16 v[64:67], v[224:227], v[188:191], v[64:67]
ds_read_b64_tr_b16 v[104:105], v11 offset:57344
ds_read_b64_tr_b16 v[106:107], v11 offset:57856
v_mfma_f32_16x16x32_bf16 v[80:83], v[224:227], v[192:195], v[80:83]
buffer_load_dwordx4 v[160:163], v39, s[32:35], s57 offen sc1
v_mfma_f32_16x16x32_bf16 v[68:71], v[228:231], v[188:191], v[68:71]
ds_read_b64_tr_b16 v[108:109], v12 offset:57344
ds_read_b64_tr_b16 v[110:111], v12 offset:57856
v_mfma_f32_16x16x32_bf16 v[84:87], v[228:231], v[192:195], v[84:87]
ds_read_b64_tr_b16 v[112:113], v13 offset:57344
ds_read_b64_tr_b16 v[114:115], v13 offset:57856
v_mfma_f32_16x16x32_bf16 v[72:75], v[232:235], v[188:191], v[72:75]
v_mfma_f32_16x16x32_bf16 v[88:91], v[232:235], v[192:195], v[88:91]
s_waitcnt vmcnt(6) lgkmcnt(8)
v_mfma_f32_16x16x32_bf16 v[60:63], v[236:239], v[196:199], v[60:63]
buffer_load_dwordx4 v[164:167], v38, s[32:35], s57 offen offset:1024 sc1
v_mfma_f32_16x16x32_bf16 v[76:79], v[236:239], v[200:203], v[76:79]
ds_read_b64_tr_b16 v[220:221], v10 offset:61440
ds_read_b64_tr_b16 v[222:223], v10 offset:61952
v_mfma_f32_16x16x32_bf16 v[64:67], v[240:243], v[196:199], v[64:67]
ds_read_b64_tr_b16 v[224:225], v11 offset:61440
ds_read_b64_tr_b16 v[226:227], v11 offset:61952
v_mfma_f32_16x16x32_bf16 v[80:83], v[240:243], v[200:203], v[80:83]
buffer_load_dwordx4 v[168:171], v39, s[32:35], s57 offen offset:1024 sc1
v_mfma_f32_16x16x32_bf16 v[68:71], v[244:247], v[196:199], v[68:71]
ds_read_b64_tr_b16 v[228:229], v12 offset:61440
ds_read_b64_tr_b16 v[230:231], v12 offset:61952
v_mfma_f32_16x16x32_bf16 v[84:87], v[244:247], v[200:203], v[84:87]
ds_read_b64_tr_b16 v[232:233], v13 offset:61440
ds_read_b64_tr_b16 v[234:235], v13 offset:61952
v_mfma_f32_16x16x32_bf16 v[72:75], v[248:251], v[196:199], v[72:75]
s_add_u32 s57, s57, 2048
s_and_b32 s57, s57, 0x7fff
v_mfma_f32_16x16x32_bf16 v[88:91], v[248:251], v[200:203], v[88:91]
s_waitcnt vmcnt(6) lgkmcnt(8)
v_mfma_f32_16x16x32_bf16 v[60:63], v[100:103], v[204:207], v[60:63]
buffer_load_dwordx4 v[172:175], v38, s[32:35], s57 offen sc1
v_mfma_f32_16x16x32_bf16 v[76:79], v[100:103], v[208:211], v[76:79]
ds_read_b64_tr_b16 v[236:237], v14 offset:0
ds_read_b64_tr_b16 v[238:239], v14 offset:512
v_mfma_f32_16x16x32_bf16 v[64:67], v[104:107], v[204:207], v[64:67]
ds_read_b64_tr_b16 v[240:241], v15 offset:0
ds_read_b64_tr_b16 v[242:243], v15 offset:512
v_mfma_f32_16x16x32_bf16 v[80:83], v[104:107], v[208:211], v[80:83]
buffer_load_dwordx4 v[176:179], v39, s[32:35], s57 offen sc1
v_mfma_f32_16x16x32_bf16 v[68:71], v[108:111], v[204:207], v[68:71]
ds_read_b64_tr_b16 v[244:245], v16 offset:0
ds_read_b64_tr_b16 v[246:247], v16 offset:512
v_mfma_f32_16x16x32_bf16 v[84:87], v[108:111], v[208:211], v[84:87]
ds_read_b64_tr_b16 v[248:249], v17 offset:0
ds_read_b64_tr_b16 v[250:251], v17 offset:512
v_mfma_f32_16x16x32_bf16 v[72:75], v[112:115], v[204:207], v[72:75]
v_mfma_f32_16x16x32_bf16 v[88:91], v[112:115], v[208:211], v[88:91]
s_waitcnt vmcnt(6) lgkmcnt(8)
v_mfma_f32_16x16x32_bf16 v[60:63], v[220:223], v[212:215], v[60:63]
buffer_load_dwordx4 v[180:183], v38, s[32:35], s57 offen offset:1024 sc1
v_mfma_f32_16x16x32_bf16 v[76:79], v[220:223], v[216:219], v[76:79]
ds_read_b64_tr_b16 v[100:101], v14 offset:4096
ds_read_b64_tr_b16 v[102:103], v14 offset:4608
v_mfma_f32_16x16x32_bf16 v[64:67], v[224:227], v[212:215], v[64:67]
ds_read_b64_tr_b16 v[104:105], v15 offset:4096
ds_read_b64_tr_b16 v[106:107], v15 offset:4608
v_mfma_f32_16x16x32_bf16 v[80:83], v[224:227], v[216:219], v[80:83]
buffer_load_dwordx4 v[184:187], v39, s[32:35], s57 offen offset:1024 sc1
v_mfma_f32_16x16x32_bf16 v[68:71], v[228:231], v[212:215], v[68:71]
ds_read_b64_tr_b16 v[108:109], v16 offset:4096
ds_read_b64_tr_b16 v[110:111], v16 offset:4608
v_mfma_f32_16x16x32_bf16 v[84:87], v[228:231], v[216:219], v[84:87]
ds_read_b64_tr_b16 v[112:113], v17 offset:4096
ds_read_b64_tr_b16 v[114:115], v17 offset:4608
v_mfma_f32_16x16x32_bf16 v[72:75], v[232:235], v[212:215], v[72:75]
s_add_u32 s57, s57, 2048
s_and_b32 s57, s57, 0x7fff
v_mfma_f32_16x16x32_bf16 v[88:91], v[232:235], v[216:219], v[88:91]
s_waitcnt vmcnt(6) lgkmcnt(8)
v_mfma_f32_16x16x32_bf16 v[60:63], v[236:239], v[156:159], v[60:63]
buffer_load_dwordx4 v[188:191], v38, s[32:35], s57 offen sc1
v_mfma_f32_16x16x32_bf16 v[76:79], v[236:239], v[160:163], v[76:79]
ds_read_b64_tr_b16 v[220:221], v14 offset:8192
ds_read_b64_tr_b16 v[222:223], v14 offset:8704
v_mfma_f32_16x16x32_bf16 v[64:67], v[240:243], v[156:159], v[64:67]
ds_read_b64_tr_b16 v[224:225], v15 offset:8192
ds_read_b64_tr_b16 v[226:227], v15 offset:8704
v_mfma_f32_16x16x32_bf16 v[80:83], v[240:243], v[160:163], v[80:83]
buffer_load_dwordx4 v[192:195], v39, s[32:35], s57 offen sc1
v_mfma_f32_16x16x32_bf16 v[68:71], v[244:247], v[156:159], v[68:71]
ds_read_b64_tr_b16 v[228:229], v16 offset:8192
ds_read_b64_tr_b16 v[230:231], v16 offset:8704
v_mfma_f32_16x16x32_bf16 v[84:87], v[244:247], v[160:163], v[84:87]
ds_read_b64_tr_b16 v[232:233], v17 offset:8192
ds_read_b64_tr_b16 v[234:235], v17 offset:8704
v_mfma_f32_16x16x32_bf16 v[72:75], v[248:251], v[156:159], v[72:75]
v_mfma_f32_16x16x32_bf16 v[88:91], v[248:251], v[160:163], v[88:91]
s_waitcnt vmcnt(6) lgkmcnt(8)
v_mfma_f32_16x16x32_bf16 v[60:63], v[100:103], v[164:167], v[60:63]
buffer_load_dwordx4 v[196:199], v38, s[32:35], s57 offen offset:1024 sc1
v_mfma_f32_16x16x32_bf16 v[76:79], v[100:103], v[168:171], v[76:79]
ds_read_b64_tr_b16 v[236:237], v14 offset:12288
ds_read_b64_tr_b16 v[238:239], v14 offset:12800
v_mfma_f32_16x16x32_bf16 v[64:67], v[104:107], v[164:167], v[64:67]
ds_read_b64_tr_b16 v[240:241], v15 offset:12288
ds_read_b64_tr_b16 v[242:243], v15 offset:12800
v_mfma_f32_16x16x32_bf16 v[80:83], v[104:107], v[168:171], v[80:83]
buffer_load_dwordx4 v[200:203], v39, s[32:35], s57 offen offset:1024 sc1
v_mfma_f32_16x16x32_bf16 v[68:71], v[108:111], v[164:167], v[68:71]
ds_read_b64_tr_b16 v[244:245], v16 offset:12288
ds_read_b64_tr_b16 v[246:247], v16 offset:12800
v_mfma_f32_16x16x32_bf16 v[84:87], v[108:111], v[168:171], v[84:87]
ds_read_b64_tr_b16 v[248:249], v17 offset:12288
ds_read_b64_tr_b16 v[250:251], v17 offset:12800
v_mfma_f32_16x16x32_bf16 v[72:75], v[112:115], v[164:167], v[72:75]
s_add_u32 s57, s57, 2048
s_and_b32 s57, s57, 0x7fff
v_mfma_f32_16x16x32_bf16 v[88:91], v[112:115], v[168:171], v[88:91]
s_waitcnt vmcnt(6) lgkmcnt(8)
v_mfma_f32_16x16x32_bf16 v[60:63], v[220:223], v[172:175], v[60:63]
buffer_load_dwordx4 v[204:207], v38, s[32:35], s57 offen sc1
v_mfma_f32_16x16x32_bf16 v[76:79], v[220:223], v[176:179], v[76:79]
ds_read_b64_tr_b16 v[100:101], v14 offset:16384
ds_read_b64_tr_b16 v[102:103], v14 offset:16896
v_mfma_f32_16x16x32_bf16 v[64:67], v[224:227], v[172:175], v[64:67]
ds_read_b64_tr_b16 v[104:105], v15 offset:16384
ds_read_b64_tr_b16 v[106:107], v15 offset:16896
v_mfma_f32_16x16x32_bf16 v[80:83], v[224:227], v[176:179], v[80:83]
buffer_load_dwordx4 v[208:211], v39, s[32:35], s57 offen sc1
v_mfma_f32_16x16x32_bf16 v[68:71], v[228:231], v[172:175], v[68:71]
ds_read_b64_tr_b16 v[108:109], v16 offset:16384
ds_read_b64_tr_b16 v[110:111], v16 offset:16896
v_mfma_f32_16x16x32_bf16 v[84:87], v[228:231], v[176:179], v[84:87]
ds_read_b64_tr_b16 v[112:113], v17 offset:16384
ds_read_b64_tr_b16 v[114:115], v17 offset:16896
v_mfma_f32_16x16x32_bf16 v[72:75], v[232:235], v[172:175], v[72:75]
v_mfma_f32_16x16x32_bf16 v[88:91], v[232:235], v[176:179], v[88:91]
s_waitcnt vmcnt(6) lgkmcnt(8)
v_mfma_f32_16x16x32_bf16 v[60:63], v[236:239], v[180:183], v[60:63]
buffer_load_dwordx4 v[212:215], v38, s[32:35], s57 offen offset:1024 sc1
v_mfma_f32_16x16x32_bf16 v[76:79], v[236:239], v[184:187], v[76:79]
ds_read_b64_tr_b16 v[220:221], v14 offset:20480
ds_read_b64_tr_b16 v[222:223], v14 offset:20992
v_mfma_f32_16x16x32_bf16 v[64:67], v[240:243], v[180:183], v[64:67]
ds_read_b64_tr_b16 v[224:225], v15 offset:20480
ds_read_b64_tr_b16 v[226:227], v15 offset:20992
v_mfma_f32_16x16x32_bf16 v[80:83], v[240:243], v[184:187], v[80:83]
buffer_load_dwordx4 v[216:219], v39, s[32:35], s57 offen offset:1024 sc1
v_mfma_f32_16x16x32_bf16 v[68:71], v[244:247], v[180:183], v[68:71]
ds_read_b64_tr_b16 v[228:229], v16 offset:20480
ds_read_b64_tr_b16 v[230:231], v16 offset:20992
v_mfma_f32_16x16x32_bf16 v[84:87], v[244:247], v[184:187], v[84:87]
ds_read_b64_tr_b16 v[232:233], v17 offset:20480
ds_read_b64_tr_b16 v[234:235], v17 offset:20992
v_mfma_f32_16x16x32_bf16 v[72:75], v[248:251], v[180:183], v[72:75]
s_add_u32 s57, s57, 2048
s_and_b32 s57, s57, 0x7fff
v_mfma_f32_16x16x32_bf16 v[88:91], v[248:251], v[184:187], v[88:91]
s_waitcnt vmcnt(6) lgkmcnt(8)
v_mfma_f32_16x16x32_bf16 v[60:63], v[100:103], v[188:191], v[60:63]
buffer_load_dwordx4 v[156:159], v38, s[32:35], s57 offen sc1
v_mfma_f32_16x16x32_bf16 v[76:79], v[100:103], v[192:195], v[76:79]
ds_read_b64_tr_b16 v[236:237], v14 offset:24576
ds_read_b64_tr_b16 v[238:239], v14 offset:25088
v_mfma_f32_16x16x32_bf16 v[64:67], v[104:107], v[188:191], v[64:67]
ds_read_b64_tr_b16 v[240:241], v15 offset:24576
ds_read_b64_tr_b16 v[242:243], v15 offset:25088
v_mfma_f32_16x16x32_bf16 v[80:83], v[104:107], v[192:195], v[80:83]
buffer_load_dwordx4 v[160:163], v39, s[32:35], s57 offen sc1
v_mfma_f32_16x16x32_bf16 v[68:71], v[108:111], v[188:191], v[68:71]
ds_read_b64_tr_b16 v[244:245], v16 offset:24576
ds_read_b64_tr_b16 v[246:247], v16 offset:25088
v_mfma_f32_16x16x32_bf16 v[84:87], v[108:111], v[192:195], v[84:87]
ds_read_b64_tr_b16 v[248:249], v17 offset:24576
ds_read_b64_tr_b16 v[250:251], v17 offset:25088
v_mfma_f32_16x16x32_bf16 v[72:75], v[112:115], v[188:191], v[72:75]
v_mfma_f32_16x16x32_bf16 v[88:91], v[112:115], v[192:195], v[88:91]
s_waitcnt vmcnt(6) lgkmcnt(8)
v_mfma_f32_16x16x32_bf16 v[60:63], v[220:223], v[196:199], v[60:63]
buffer_load_dwordx4 v[164:167], v38, s[32:35], s57 offen offset:1024 sc1
v_mfma_f32_16x16x32_bf16 v[76:79], v[220:223], v[200:203], v[76:79]
ds_read_b64_tr_b16 v[100:101], v14 offset:28672
ds_read_b64_tr_b16 v[102:103], v14 offset:29184
v_mfma_f32_16x16x32_bf16 v[64:67], v[224:227], v[196:199], v[64:67]
ds_read_b64_tr_b16 v[104:105], v15 offset:28672
ds_read_b64_tr_b16 v[106:107], v15 offset:29184
v_mfma_f32_16x16x32_bf16 v[80:83], v[224:227], v[200:203], v[80:83]
buffer_load_dwordx4 v[168:171], v39, s[32:35], s57 offen offset:1024 sc1
v_mfma_f32_16x16x32_bf16 v[68:71], v[228:231], v[196:199], v[68:71]
ds_read_b64_tr_b16 v[108:109], v16 offset:28672
ds_read_b64_tr_b16 v[110:111], v16 offset:29184
v_mfma_f32_16x16x32_bf16 v[84:87], v[228:231], v[200:203], v[84:87]
ds_read_b64_tr_b16 v[112:113], v17 offset:28672
ds_read_b64_tr_b16 v[114:115], v17 offset:29184
v_mfma_f32_16x16x32_bf16 v[72:75], v[232:235], v[196:199], v[72:75]
s_add_u32 s57, s57, 2048
s_and_b32 s57, s57, 0x7fff
v_mfma_f32_16x16x32_bf16 v[88:91], v[232:235], v[200:203], v[88:91]
s_waitcnt vmcnt(6) lgkmcnt(8)
v_mfma_f32_16x16x32_bf16 v[60:63], v[236:239], v[204:207], v[60:63]
buffer_load_dwordx4 v[172:175], v38, s[32:35], s57 offen sc1
v_mfma_f32_16x16x32_bf16 v[76:79], v[236:239], v[208:211], v[76:79]
ds_read_b64_tr_b16 v[220:221], v14 offset:32768
ds_read_b64_tr_b16 v[222:223], v14 offset:33280
v_mfma_f32_16x16x32_bf16 v[64:67], v[240:243], v[204:207], v[64:67]
ds_read_b64_tr_b16 v[224:225], v15 offset:32768
ds_read_b64_tr_b16 v[226:227], v15 offset:33280
v_mfma_f32_16x16x32_bf16 v[80:83], v[240:243], v[208:211], v[80:83]
buffer_load_dwordx4 v[176:179], v39, s[32:35], s57 offen sc1
v_mfma_f32_16x16x32_bf16 v[68:71], v[244:247], v[204:207], v[68:71]
ds_read_b64_tr_b16 v[228:229], v16 offset:32768
ds_read_b64_tr_b16 v[230:231], v16 offset:33280
v_mfma_f32_16x16x32_bf16 v[84:87], v[244:247], v[208:211], v[84:87]
ds_read_b64_tr_b16 v[232:233], v17 offset:32768
ds_read_b64_tr_b16 v[234:235], v17 offset:33280
v_mfma_f32_16x16x32_bf16 v[72:75], v[248:251], v[204:207], v[72:75]
v_mfma_f32_16x16x32_bf16 v[88:91], v[248:251], v[208:211], v[88:91]
s_waitcnt vmcnt(6) lgkmcnt(8)
v_mfma_f32_16x16x32_bf16 v[60:63], v[100:103], v[212:215], v[60:63]
buffer_load_dwordx4 v[180:183], v38, s[32:35], s57 offen offset:1024 sc1
v_mfma_f32_16x16x32_bf16 v[76:79], v[100:103], v[216:219], v[76:79]
ds_read_b64_tr_b16 v[236:237], v14 offset:36864
ds_read_b64_tr_b16 v[238:239], v14 offset:37376
v_mfma_f32_16x16x32_bf16 v[64:67], v[104:107], v[212:215], v[64:67]
ds_read_b64_tr_b16 v[240:241], v15 offset:36864
ds_read_b64_tr_b16 v[242:243], v15 offset:37376
v_mfma_f32_16x16x32_bf16 v[80:83], v[104:107], v[216:219], v[80:83]
buffer_load_dwordx4 v[184:187], v39, s[32:35], s57 offen offset:1024 sc1
v_mfma_f32_16x16x32_bf16 v[68:71], v[108:111], v[212:215], v[68:71]
ds_read_b64_tr_b16 v[244:245], v16 offset:36864
ds_read_b64_tr_b16 v[246:247], v16 offset:37376
v_mfma_f32_16x16x32_bf16 v[84:87], v[108:111], v[216:219], v[84:87]
ds_read_b64_tr_b16 v[248:249], v17 offset:36864
ds_read_b64_tr_b16 v[250:251], v17 offset:37376
v_mfma_f32_16x16x32_bf16 v[72:75], v[112:115], v[212:215], v[72:75]
s_add_u32 s57, s57, 2048
s_and_b32 s57, s57, 0x7fff
v_mfma_f32_16x16x32_bf16 v[88:91], v[112:115], v[216:219], v[88:91]
s_waitcnt vmcnt(6) lgkmcnt(8)
v_mfma_f32_16x16x32_bf16 v[60:63], v[220:223], v[156:159], v[60:63]
buffer_load_dwordx4 v[188:191], v38, s[32:35], s57 offen sc1
v_mfma_f32_16x16x32_bf16 v[76:79], v[220:223], v[160:163], v[76:79]
ds_read_b64_tr_b16 v[100:101], v14 offset:40960
ds_read_b64_tr_b16 v[102:103], v14 offset:41472
v_mfma_f32_16x16x32_bf16 v[64:67], v[224:227], v[156:159], v[64:67]
ds_read_b64_tr_b16 v[104:105], v15 offset:40960
ds_read_b64_tr_b16 v[106:107], v15 offset:41472
v_mfma_f32_16x16x32_bf16 v[80:83], v[224:227], v[160:163], v[80:83]
buffer_load_dwordx4 v[192:195], v39, s[32:35], s57 offen sc1
v_mfma_f32_16x16x32_bf16 v[68:71], v[228:231], v[156:159], v[68:71]
ds_read_b64_tr_b16 v[108:109], v16 offset:40960
ds_read_b64_tr_b16 v[110:111], v16 offset:41472
v_mfma_f32_16x16x32_bf16 v[84:87], v[228:231], v[160:163], v[84:87]
ds_read_b64_tr_b16 v[112:113], v17 offset:40960
ds_read_b64_tr_b16 v[114:115], v17 offset:41472
v_mfma_f32_16x16x32_bf16 v[72:75], v[232:235], v[156:159], v[72:75]
v_mfma_f32_16x16x32_bf16 v[88:91], v[232:235], v[160:163], v[88:91]
s_waitcnt vmcnt(6) lgkmcnt(8)
v_mfma_f32_16x16x32_bf16 v[60:63], v[236:239], v[164:167], v[60:63]
buffer_load_dwordx4 v[196:199], v38, s[32:35], s57 offen offset:1024 sc1
v_mfma_f32_16x16x32_bf16 v[76:79], v[236:239], v[168:171], v[76:79]
ds_read_b64_tr_b16 v[220:221], v14 offset:45056
ds_read_b64_tr_b16 v[222:223], v14 offset:45568
v_mfma_f32_16x16x32_bf16 v[64:67], v[240:243], v[164:167], v[64:67]
ds_read_b64_tr_b16 v[224:225], v15 offset:45056
ds_read_b64_tr_b16 v[226:227], v15 offset:45568
v_mfma_f32_16x16x32_bf16 v[80:83], v[240:243], v[168:171], v[80:83]
buffer_load_dwordx4 v[200:203], v39, s[32:35], s57 offen offset:1024 sc1
v_mfma_f32_16x16x32_bf16 v[68:71], v[244:247], v[164:167], v[68:71]
ds_read_b64_tr_b16 v[228:229], v16 offset:45056
ds_read_b64_tr_b16 v[230:231], v16 offset:45568
v_mfma_f32_16x16x32_bf16 v[84:87], v[244:247], v[168:171], v[84:87]
ds_read_b64_tr_b16 v[232:233], v17 offset:45056
ds_read_b64_tr_b16 v[234:235], v17 offset:45568
v_mfma_f32_16x16x32_bf16 v[72:75], v[248:251], v[164:167], v[72:75]
s_add_u32 s57, s57, 2048
s_and_b32 s57, s57, 0x7fff
v_mfma_f32_16x16x32_bf16 v[88:91], v[248:251], v[168:171], v[88:91]
s_waitcnt vmcnt(6) lgkmcnt(8)
v_mfma_f32_16x16x32_bf16 v[60:63], v[100:103], v[172:175], v[60:63]
buffer_load_dwordx4 v[204:207], v38, s[32:35], s57 offen sc1
v_mfma_f32_16x16x32_bf16 v[76:79], v[100:103], v[176:179], v[76:79]
ds_read_b64_tr_b16 v[236:237], v14 offset:49152
ds_read_b64_tr_b16 v[238:239], v14 offset:49664
v_mfma_f32_16x16x32_bf16 v[64:67], v[104:107], v[172:175], v[64:67]
ds_read_b64_tr_b16 v[240:241], v15 offset:49152
ds_read_b64_tr_b16 v[242:243], v15 offset:49664
v_mfma_f32_16x16x32_bf16 v[80:83], v[104:107], v[176:179], v[80:83]
buffer_load_dwordx4 v[208:211], v39, s[32:35], s57 offen sc1
v_mfma_f32_16x16x32_bf16 v[68:71], v[108:111], v[172:175], v[68:71]
ds_read_b64_tr_b16 v[244:245], v16 offset:49152
ds_read_b64_tr_b16 v[246:247], v16 offset:49664
v_mfma_f32_16x16x32_bf16 v[84:87], v[108:111], v[176:179], v[84:87]
ds_read_b64_tr_b16 v[248:249], v17 offset:49152
ds_read_b64_tr_b16 v[250:251], v17 offset:49664
v_mfma_f32_16x16x32_bf16 v[72:75], v[112:115], v[172:175], v[72:75]
v_mfma_f32_16x16x32_bf16 v[88:91], v[112:115], v[176:179], v[88:91]
s_waitcnt vmcnt(6) lgkmcnt(8)
v_mfma_f32_16x16x32_bf16 v[60:63], v[220:223], v[180:183], v[60:63]
buffer_load_dwordx4 v[212:215], v38, s[32:35], s57 offen offset:1024 sc1
v_mfma_f32_16x16x32_bf16 v[76:79], v[220:223], v[184:187], v[76:79]
ds_read_b64_tr_b16 v[100:101], v14 offset:53248
ds_read_b64_tr_b16 v[102:103], v14 offset:53760
v_mfma_f32_16x16x32_bf16 v[64:67], v[224:227], v[180:183], v[64:67]
ds_read_b64_tr_b16 v[104:105], v15 offset:53248
ds_read_b64_tr_b16 v[106:107], v15 offset:53760
v_mfma_f32_16x16x32_bf16 v[80:83], v[224:227], v[184:187], v[80:83]
buffer_load_dwordx4 v[216:219], v39, s[32:35], s57 offen offset:1024 sc1
v_mfma_f32_16x16x32_bf16 v[68:71], v[228:231], v[180:183], v[68:71]
ds_read_b64_tr_b16 v[108:109], v16 offset:53248
ds_read_b64_tr_b16 v[110:111], v16 offset:53760
v_mfma_f32_16x16x32_bf16 v[84:87], v[228:231], v[184:187], v[84:87]
ds_read_b64_tr_b16 v[112:113], v17 offset:53248
ds_read_b64_tr_b16 v[114:115], v17 offset:53760
v_mfma_f32_16x16x32_bf16 v[72:75], v[232:235], v[180:183], v[72:75]
v_mfma_f32_16x16x32_bf16 v[88:91], v[232:235], v[184:187], v[88:91]
s_waitcnt vmcnt(6) lgkmcnt(8)
v_mfma_f32_16x16x32_bf16 v[60:63], v[236:239], v[188:191], v[60:63]
v_mfma_f32_16x16x32_bf16 v[76:79], v[236:239], v[192:195], v[76:79]
ds_read_b64_tr_b16 v[220:221], v14 offset:57344
ds_read_b64_tr_b16 v[222:223], v14 offset:57856
v_mfma_f32_16x16x32_bf16 v[64:67], v[240:243], v[188:191], v[64:67]
ds_read_b64_tr_b16 v[224:225], v15 offset:57344
ds_read_b64_tr_b16 v[226:227], v15 offset:57856
v_mfma_f32_16x16x32_bf16 v[80:83], v[240:243], v[192:195], v[80:83]
v_mfma_f32_16x16x32_bf16 v[68:71], v[244:247], v[188:191], v[68:71]
ds_read_b64_tr_b16 v[228:229], v16 offset:57344
ds_read_b64_tr_b16 v[230:231], v16 offset:57856
v_mfma_f32_16x16x32_bf16 v[84:87], v[244:247], v[192:195], v[84:87]
ds_read_b64_tr_b16 v[232:233], v17 offset:57344
ds_read_b64_tr_b16 v[234:235], v17 offset:57856
v_mfma_f32_16x16x32_bf16 v[72:75], v[248:251], v[188:191], v[72:75]
v_mfma_f32_16x16x32_bf16 v[88:91], v[248:251], v[192:195], v[88:91]
s_waitcnt vmcnt(4) lgkmcnt(8)
v_mfma_f32_16x16x32_bf16 v[60:63], v[100:103], v[196:199], v[60:63]
v_mfma_f32_16x16x32_bf16 v[76:79], v[100:103], v[200:203], v[76:79]
ds_read_b64_tr_b16 v[236:237], v14 offset:61440
ds_read_b64_tr_b16 v[238:239], v14 offset:61952
v_mfma_f32_16x16x32_bf16 v[64:67], v[104:107], v[196:199], v[64:67]
ds_read_b64_tr_b16 v[240:241], v15 offset:61440
ds_read_b64_tr_b16 v[242:243], v15 offset:61952
v_mfma_f32_16x16x32_bf16 v[80:83], v[104:107], v[200:203], v[80:83]
v_mfma_f32_16x16x32_bf16 v[68:71], v[108:111], v[196:199], v[68:71]
ds_read_b64_tr_b16 v[244:245], v16 offset:61440
ds_read_b64_tr_b16 v[246:247], v16 offset:61952
v_mfma_f32_16x16x32_bf16 v[84:87], v[108:111], v[200:203], v[84:87]
ds_read_b64_tr_b16 v[248:249], v17 offset:61440
ds_read_b64_tr_b16 v[250:251], v17 offset:61952
v_mfma_f32_16x16x32_bf16 v[72:75], v[112:115], v[196:199], v[72:75]
v_mfma_f32_16x16x32_bf16 v[88:91], v[112:115], v[200:203], v[88:91]
s_waitcnt vmcnt(2) lgkmcnt(8)
v_mfma_f32_16x16x32_bf16 v[60:63], v[220:223], v[204:207], v[60:63]
v_mfma_f32_16x16x32_bf16 v[76:79], v[220:223], v[208:211], v[76:79]
v_mfma_f32_16x16x32_bf16 v[64:67], v[224:227], v[204:207], v[64:67]
v_mfma_f32_16x16x32_bf16 v[80:83], v[224:227], v[208:211], v[80:83]
v_mfma_f32_16x16x32_bf16 v[68:71], v[228:231], v[204:207], v[68:71]
v_mfma_f32_16x16x32_bf16 v[84:87], v[228:231], v[208:211], v[84:87]
v_mfma_f32_16x16x32_bf16 v[72:75], v[232:235], v[204:207], v[72:75]
v_mfma_f32_16x16x32_bf16 v[88:91], v[232:235], v[208:211], v[88:91]
s_waitcnt vmcnt(0) lgkmcnt(0)
v_mfma_f32_16x16x32_bf16 v[60:63], v[236:239], v[212:215], v[60:63]
v_mfma_f32_16x16x32_bf16 v[64:67], v[240:243], v[212:215], v[64:67]
v_mfma_f32_16x16x32_bf16 v[68:71], v[244:247], v[212:215], v[68:71]
v_mfma_f32_16x16x32_bf16 v[72:75], v[248:251], v[212:215], v[72:75]
v_mfma_f32_16x16x32_bf16 v[76:79], v[236:239], v[216:219], v[76:79]
v_mfma_f32_16x16x32_bf16 v[80:83], v[240:243], v[216:219], v[80:83]
v_mfma_f32_16x16x32_bf16 v[84:87], v[244:247], v[216:219], v[84:87]
v_mfma_f32_16x16x32_bf16 v[88:91], v[248:251], v[216:219], v[88:91]
s_cmp_eq_u32 s46, 0
s_cbranch_scc1 slow_119
s_nop 0
v_cvt_pk_bf16_f32 v20, v60, v61
v_cvt_pk_bf16_f32 v21, v62, v63
v_cvt_pk_bf16_f32 v22, v64, v65
v_cvt_pk_bf16_f32 v23, v66, v67
buffer_store_dwordx4 v[20:23], v18, s[32:35], s85 offen offset:0
v_cvt_pk_bf16_f32 v24, v68, v69
v_cvt_pk_bf16_f32 v25, v70, v71
v_cvt_pk_bf16_f32 v26, v72, v73
v_cvt_pk_bf16_f32 v27, v74, v75
buffer_store_dwordx4 v[24:27], v18, s[32:35], s85 offen offset:1024
v_cvt_pk_bf16_f32 v28, v76, v77
v_cvt_pk_bf16_f32 v29, v78, v79
v_cvt_pk_bf16_f32 v30, v80, v81
v_cvt_pk_bf16_f32 v31, v82, v83
buffer_store_dwordx4 v[28:31], v18, s[32:35], s86 offen offset:0
v_cvt_pk_bf16_f32 v32, v84, v85
v_cvt_pk_bf16_f32 v33, v86, v87
v_cvt_pk_bf16_f32 v34, v88, v89
v_cvt_pk_bf16_f32 v35, v90, v91
buffer_store_dwordx4 v[32:35], v18, s[32:35], s86 offen offset:1024
s_barrier
v_dot2c_f32_bf16 v6, v20, v48
v_dot2c_f32_bf16 v8, v20, v20
v_dot2c_f32_bf16 v7, v28, v48
v_dot2c_f32_bf16 v9, v28, v28
v_dot2c_f32_bf16 v6, v21, v48
v_dot2c_f32_bf16 v8, v21, v21
v_dot2c_f32_bf16 v7, v29, v48
v_dot2c_f32_bf16 v9, v29, v29
v_dot2c_f32_bf16 v6, v22, v48
v_dot2c_f32_bf16 v8, v22, v22
v_dot2c_f32_bf16 v7, v30, v48
v_dot2c_f32_bf16 v9, v30, v30
v_dot2c_f32_bf16 v6, v23, v48
v_dot2c_f32_bf16 v8, v23, v23
v_dot2c_f32_bf16 v7, v31, v48
v_dot2c_f32_bf16 v9, v31, v31
v_dot2c_f32_bf16 v6, v24, v48
v_dot2c_f32_bf16 v8, v24, v24
v_dot2c_f32_bf16 v7, v32, v48
v_dot2c_f32_bf16 v9, v32, v32
v_dot2c_f32_bf16 v6, v25, v48
v_dot2c_f32_bf16 v8, v25, v25
v_dot2c_f32_bf16 v7, v33, v48
v_dot2c_f32_bf16 v9, v33, v33
v_dot2c_f32_bf16 v6, v26, v48
v_dot2c_f32_bf16 v8, v26, v26
v_dot2c_f32_bf16 v7, v34, v48
v_dot2c_f32_bf16 v9, v34, v34
v_dot2c_f32_bf16 v6, v27, v48
v_dot2c_f32_bf16 v8, v27, v27
v_dot2c_f32_bf16 v7, v35, v48
v_dot2c_f32_bf16 v9, v35, v35
s_mov_b64 exec, 1
s_waitcnt vmcnt(0)
buffer_store_dword v5, v4, s[32:35], s88 offen
s_mov_b64 exec, -1
s_nop 1
v_permlane32_swap_b32 v6, v7
v_permlane32_swap_b32 v8, v9
v_add_f32 v6, v6, v7
v_add_f32 v8, v8, v9
s_nop 1
v_permlane16_swap_b32 v6, v8
s_nop 0
v_add_f32 v6, v6, v8
buffer_store_dword v6, v1, s[32:35], s87 offen
back_120:
s_lshl_b32 s49, s44, 13
v_add_u32 v10, s49, v18
v_add_u32 v11, 1024, v10
s_lshl_b32 s48, s43, 1
v_lshrrev_b32 v4, 2, v2
v_and_b32 v5, 3, v0
v_lshl_add_u32 v6, v3, 3, v4
v_lshlrev_b32 v6, 7, v6
v_lshl_add_u32 v6, v5, 3, v6
v_lshrrev_b32 v7, 1, v4
v_and_b32 v8, 1, v3
v_lshl_add_u32 v7, v8, 1, v7
v_xor_b32 v7, s48, v7
v_lshl_add_u32 v12, v7, 5, v6
v_add_u32 v12, 16384, v12
v_xor_b32 v13, 32, v12
v_mov_b32 v14, v10
v_mov_b32 v15, v11
v_add_u32 v16, 122880, v12
v_add_u32 v17, 122880, v13
v_mov_b32 v156, 0
v_mov_b32 v157, 0
v_mov_b32 v158, 0
v_mov_b32 v159, 0
v_mov_b32 v160, 0
v_mov_b32 v161, 0
v_mov_b32 v162, 0
v_mov_b32 v163, 0
v_mov_b32 v164, 0
v_mov_b32 v165, 0
v_mov_b32 v166, 0
v_mov_b32 v167, 0
v_mov_b32 v168, 0
v_mov_b32 v169, 0
v_mov_b32 v170, 0
v_mov_b32 v171, 0
v_mov_b32 v172, 0
v_mov_b32 v173, 0
v_mov_b32 v174, 0
v_mov_b32 v175, 0
v_mov_b32 v176, 0
v_mov_b32 v177, 0
v_mov_b32 v178, 0
v_mov_b32 v179, 0
v_mov_b32 v180, 0
v_mov_b32 v181, 0
v_mov_b32 v182, 0
v_mov_b32 v183, 0
v_mov_b32 v184, 0
v_mov_b32 v185, 0
v_mov_b32 v186, 0
v_mov_b32 v187, 0
v_mov_b32 v188, 0
v_mov_b32 v189, 0
v_mov_b32 v190, 0
v_mov_b32 v191, 0
v_mov_b32 v192, 0
v_mov_b32 v193, 0
v_mov_b32 v194, 0
v_mov_b32 v195, 0
v_mov_b32 v196, 0
v_mov_b32 v197, 0
v_mov_b32 v198, 0
v_mov_b32 v199, 0
v_mov_b32 v200, 0
v_mov_b32 v201, 0
v_mov_b32 v202, 0
v_mov_b32 v203, 0
v_mov_b32 v204, 0
v_mov_b32 v205, 0
v_mov_b32 v206, 0
v_mov_b32 v207, 0
v_mov_b32 v208, 0
v_mov_b32 v209, 0
v_mov_b32 v210, 0
v_mov_b32 v211, 0
v_mov_b32 v212, 0
v_mov_b32 v213, 0
v_mov_b32 v214, 0
v_mov_b32 v215, 0
v_mov_b32 v216, 0
v_mov_b32 v217, 0
v_mov_b32 v218, 0
v_mov_b32 v219, 0
v_mov_b32 v220, 0
v_mov_b32 v221, 0
v_mov_b32 v222, 0
v_mov_b32 v223, 0
v_mov_b32 v224, 0
v_mov_b32 v225, 0
v_mov_b32 v226, 0
v_mov_b32 v227, 0
v_mov_b32 v228, 0
v_mov_b32 v229, 0
v_mov_b32 v230, 0
v_mov_b32 v231, 0
v_mov_b32 v232, 0
v_mov_b32 v233, 0
v_mov_b32 v234, 0
v_mov_b32 v235, 0
v_mov_b32 v236, 0
v_mov_b32 v237, 0
v_mov_b32 v238, 0
v_mov_b32 v239, 0
v_mov_b32 v240, 0
v_mov_b32 v241, 0
v_mov_b32 v242, 0
v_mov_b32 v243, 0
v_mov_b32 v244, 0
v_mov_b32 v245, 0
v_mov_b32 v246, 0
v_mov_b32 v247, 0
v_mov_b32 v248, 0
v_mov_b32 v249, 0
v_mov_b32 v250, 0
v_mov_b32 v251, 0
v_lshrrev_b32 v6, 2, v2
v_cmp_eq_u32 vcc, v6, v3
v_and_b32 v7, 1, v0
v_lshlrev_b32 v7, 4, v7
v_mov_b32 v8, 0x3f80
v_lshlrev_b32 v9, v7, v8
v_cndmask_b32 v7, 0, v9, vcc
v_and_b32 v6, 2, v0
v_cmp_eq_u32 vcc, 0, v6
v_mov_b32 v36, 0
v_mov_b32 v37, 0
v_mov_b32 v40, 0
v_mov_b32 v41, 0
v_cndmask_b32 v38, 0, v7, vcc
v_cndmask_b32 v39, v7, 0, vcc
v_lshrrev_b32 v8, 1, v2
v_cmp_eq_u32 vcc, 0, v8
s_nop 1
v_cndmask_b32 v44, 0, v9, vcc
v_cmp_eq_u32 vcc, 1, v8
s_nop 1
v_cndmask_b32 v45, 0, v9, vcc
v_cmp_eq_u32 vcc, 2, v8
s_nop 1
v_cndmask_b32 v46, 0, v9, vcc
v_cmp_eq_u32 vcc, 3, v8
s_nop 1
v_cndmask_b32 v47, 0, v9, vcc
v_lshrrev_b32 v4, 2, v2
v_lshl_add_u32 v4, v3, 2, v4
v_lshlrev_b32 v4, 6, v4
v_and_b32 v5, 3, v0
v_lshl_add_u32 v4, v5, 3, v4
s_lshl_b32 s48, s43, 11
s_add_u32 s48, s48, 135168
v_add_u32 v53, s48, v4
s_mul_i32 s48, s40, 3072
s_add_u32 s48, s48, 139264
v_add_u32 v42, s48, v18
s_xor_b32 s49, s40, 2
s_mul_i32 s48, s49, 3072
s_add_u32 s48, s48, 139264
v_add_u32 v43, s48, v18
s_lshl_b32 s49, s49, 2
s_add_u32 s49, s49, 134672
v_mov_b32 v19, s49
v_xor_b32 v52, 8, v19
v_lshrrev_b32 v4, 3, v0
v_and_b32 v5, 7, v0
v_lshlrev_b32 v4, 11, v4
v_lshl_add_u32 v55, v5, 4, v4
v_lshlrev_b32 v4, 6, v2
v_lshl_add_u32 v58, v3, 4, v4
v_lshlrev_b32 v4, 4, v2
v_lshl_add_u32 v59, v3, 3, v4
s_mul_i32 s51, s42, 163840
s_add_u32 s51, s51, 9437184
s_lshl_b32 s50, s43, 1
s_add_u32 s50, s50, s44
s_lshl_b32 s48, s50, 15
s_add_u32 s48, s48, s51
s_add_u32 s48, s48, 0
s_lshl_b32 s49, s41, 7
s_add_u32 s53, s48, s49
s_add_u32 s54, s53, 16384
s_lshl_b32 s56, s50, 10
s_add_u32 s56, s56, s51
s_add_u32 s56, s56, 151552
s_xor_b32 s57, s56, 1024
s_lshl_b32 s58, s50, 11
s_add_u32 s58, s58, s51
s_add_u32 s58, s58, 139264
s_xor_b32 s59, s58, 2048
s_add_u32 s79, s58, s49
s_lshl_b32 s50, s41, 11
s_add_u32 s55, s48, s50
s_lshl_b32 s48, s43, 7
s_add_u32 s48, s48, 133888
v_lshl_add_u32 v7, v3, 4, s48
v_lshl_add_u32 v54, v2, 2, s48
s_lshl_b32 s49, s44, 6
v_add_u32 v8, s49, v2
v_lshlrev_b32 v8, 3, v8
v_add_u32 v8, 131072, v8
v_lshl_add_u32 v9, v3, 2, s49
v_lshlrev_b32 v9, 2, v9
v_add_u32 v9, 132096, v9
s_mov_b32 s64, 0
s_mov_b32 s65, 0
s_mov_b32 s66, 0x3fb8aa3b
s_barrier
ds_read_b128 v[60:63], v14 offset:0
ds_read_b128 v[64:67], v14 offset:2048
ds_read_b128 v[68:71], v14 offset:4096
ds_read_b128 v[72:75], v14 offset:6144
ds_read_b64_tr_b16 v[84:85], v16 offset:8192
ds_read_b64_tr_b16 v[86:87], v16 offset:8704
ds_read_b64_tr_b16 v[88:89], v17 offset:8192
ds_read_b64_tr_b16 v[90:91], v17 offset:8704
ds_read_b64_tr_b16 v[92:93], v16 offset:16384
ds_read_b64_tr_b16 v[94:95], v16 offset:16896
ds_read_b64_tr_b16 v[96:97], v17 offset:16384
ds_read_b64_tr_b16 v[98:99], v17 offset:16896
ds_read_b64_tr_b16 v[76:77], v16 offset:0
ds_read_b64_tr_b16 v[78:79], v16 offset:512
ds_read_b64_tr_b16 v[80:81], v17 offset:0
ds_read_b64_tr_b16 v[82:83], v17 offset:512
s_waitcnt lgkmcnt(0)
c3_loop:
v_mfma_f32_16x16x32_bf16 v[212:215], v[84:87], v[72:75], v[212:215]
ds_read_b128 v[100:103], v15 offset:0
v_mfma_f32_16x16x32_bf16 v[204:207], v[84:87], v[68:71], v[204:207]
ds_read_b128 v[104:107], v15 offset:2048
v_mfma_f32_16x16x32_bf16 v[196:199], v[84:87], v[64:67], v[196:199]
ds_read_b128 v[108:111], v15 offset:4096
v_mfma_f32_16x16x32_bf16 v[188:191], v[84:87], v[60:63], v[188:191]
ds_read_b128 v[112:115], v15 offset:6144
v_mfma_f32_16x16x32_bf16 v[192:195], v[88:91], v[60:63], v[192:195]
ds_read_b64_tr_b16 v[124:125], v16 offset:12288
v_mfma_f32_16x16x32_bf16 v[200:203], v[88:91], v[64:67], v[200:203]
ds_read_b64_tr_b16 v[126:127], v16 offset:12800
v_mfma_f32_16x16x32_bf16 v[208:211], v[88:91], v[68:71], v[208:211]
ds_read_b64_tr_b16 v[128:129], v17 offset:12288
v_mfma_f32_16x16x32_bf16 v[216:219], v[88:91], v[72:75], v[216:219]
ds_read_b64_tr_b16 v[130:131], v17 offset:12800
v_mfma_f32_16x16x32_bf16 v[244:247], v[72:75], v[92:95], v[244:247]
ds_read_b64_tr_b16 v[132:133], v16 offset:20480
v_mfma_f32_16x16x32_bf16 v[236:239], v[68:71], v[92:95], v[236:239]
ds_read_b64_tr_b16 v[134:135], v16 offset:20992
v_mfma_f32_16x16x32_bf16 v[228:231], v[64:67], v[92:95], v[228:231]
ds_read_b64_tr_b16 v[136:137], v17 offset:20480
v_mfma_f32_16x16x32_bf16 v[220:223], v[60:63], v[92:95], v[220:223]
ds_read_b64_tr_b16 v[138:139], v17 offset:20992
v_mfma_f32_16x16x32_bf16 v[224:227], v[60:63], v[96:99], v[224:227]
ds_read_b64_tr_b16 v[116:117], v16 offset:4096
v_mfma_f32_16x16x32_bf16 v[232:235], v[64:67], v[96:99], v[232:235]
ds_read_b64_tr_b16 v[118:119], v16 offset:4608
v_mfma_f32_16x16x32_bf16 v[240:243], v[68:71], v[96:99], v[240:243]
ds_read_b64_tr_b16 v[120:121], v17 offset:4096
v_mfma_f32_16x16x32_bf16 v[248:251], v[72:75], v[96:99], v[248:251]
ds_read_b64_tr_b16 v[122:123], v17 offset:4608
v_mfma_f32_16x16x32_bf16 v[180:183], v[76:79], v[72:75], v[180:183]
s_add_u32 s65, s65, 40960
s_cmp_eq_u32 s65, 122880
v_mfma_f32_16x16x32_bf16 v[172:175], v[76:79], v[68:71], v[172:175]
s_cselect_b32 s65, 0, s65
s_add_u32 s64, s64, 1
v_mfma_f32_16x16x32_bf16 v[164:167], v[76:79], v[64:67], v[164:167]
v_add_u32 v14, s65, v10
v_add_u32 v15, s65, v11
v_mfma_f32_16x16x32_bf16 v[156:159], v[76:79], v[60:63], v[156:159]
v_add_u32 v16, s65, v12
v_add_u32 v17, s65, v13
v_mfma_f32_16x16x32_bf16 v[160:163], v[80:83], v[60:63], v[160:163]
v_mfma_f32_16x16x32_bf16 v[168:171], v[80:83], v[64:67], v[168:171]
s_cmp_eq_u32 s64, 16
s_cbranch_scc1 c3_last
v_mfma_f32_16x16x32_bf16 v[176:179], v[80:83], v[68:71], v[176:179]
s_waitcnt lgkmcnt(0)
v_mfma_f32_16x16x32_bf16 v[184:187], v[80:83], v[72:75], v[184:187]
s_barrier
v_mfma_f32_16x16x32_bf16 v[212:215], v[124:127], v[112:115], v[212:215]
ds_read_b128 v[60:63], v14 offset:0
v_mfma_f32_16x16x32_bf16 v[204:207], v[124:127], v[108:111], v[204:207]
ds_read_b128 v[64:67], v14 offset:2048
v_mfma_f32_16x16x32_bf16 v[196:199], v[124:127], v[104:107], v[196:199]
ds_read_b128 v[68:71], v14 offset:4096
v_mfma_f32_16x16x32_bf16 v[188:191], v[124:127], v[100:103], v[188:191]
ds_read_b128 v[72:75], v14 offset:6144
v_mfma_f32_16x16x32_bf16 v[192:195], v[128:131], v[100:103], v[192:195]
ds_read_b64_tr_b16 v[84:85], v16 offset:8192
v_mfma_f32_16x16x32_bf16 v[200:203], v[128:131], v[104:107], v[200:203]
ds_read_b64_tr_b16 v[86:87], v16 offset:8704
v_mfma_f32_16x16x32_bf16 v[208:211], v[128:131], v[108:111], v[208:211]
ds_read_b64_tr_b16 v[88:89], v17 offset:8192
v_mfma_f32_16x16x32_bf16 v[216:219], v[128:131], v[112:115], v[216:219]
ds_read_b64_tr_b16 v[90:91], v17 offset:8704
v_mfma_f32_16x16x32_bf16 v[244:247], v[112:115], v[132:135], v[244:247]
ds_read_b64_tr_b16 v[92:93], v16 offset:16384
v_mfma_f32_16x16x32_bf16 v[236:239], v[108:111], v[132:135], v[236:239]
ds_read_b64_tr_b16 v[94:95], v16 offset:16896
v_mfma_f32_16x16x32_bf16 v[228:231], v[104:107], v[132:135], v[228:231]
ds_read_b64_tr_b16 v[96:97], v17 offset:16384
v_mfma_f32_16x16x32_bf16 v[220:223], v[100:103], v[132:135], v[220:223]
ds_read_b64_tr_b16 v[98:99], v17 offset:16896
v_mfma_f32_16x16x32_bf16 v[224:227], v[100:103], v[136:139], v[224:227]
ds_read_b64_tr_b16 v[76:77], v16 offset:0
v_mfma_f32_16x16x32_bf16 v[232:235], v[104:107], v[136:139], v[232:235]
ds_read_b64_tr_b16 v[78:79], v16 offset:512
v_mfma_f32_16x16x32_bf16 v[240:243], v[108:111], v[136:139], v[240:243]
ds_read_b64_tr_b16 v[80:81], v17 offset:0
v_mfma_f32_16x16x32_bf16 v[248:251], v[112:115], v[136:139], v[248:251]
ds_read_b64_tr_b16 v[82:83], v17 offset:512
v_mfma_f32_16x16x32_bf16 v[180:183], v[116:119], v[112:115], v[180:183]
v_mfma_f32_16x16x32_bf16 v[172:175], v[116:119], v[108:111], v[172:175]
v_mfma_f32_16x16x32_bf16 v[164:167], v[116:119], v[104:107], v[164:167]
v_mfma_f32_16x16x32_bf16 v[156:159], v[116:119], v[100:103], v[156:159]
v_mfma_f32_16x16x32_bf16 v[160:163], v[120:123], v[100:103], v[160:163]
v_mfma_f32_16x16x32_bf16 v[168:171], v[120:123], v[104:107], v[168:171]
v_mfma_f32_16x16x32_bf16 v[176:179], v[120:123], v[108:111], v[176:179]
s_waitcnt lgkmcnt(0)
v_mfma_f32_16x16x32_bf16 v[184:187], v[120:123], v[112:115], v[184:187]
s_branch c3_loop
c3_last:
v_mfma_f32_16x16x32_bf16 v[176:179], v[80:83], v[68:71], v[176:179]
s_waitcnt lgkmcnt(0)
v_mfma_f32_16x16x32_bf16 v[184:187], v[80:83], v[72:75], v[184:187]
v_mfma_f32_16x16x32_bf16 v[212:215], v[124:127], v[112:115], v[212:215]
v_mfma_f32_16x16x32_bf16 v[204:207], v[124:127], v[108:111], v[204:207]
v_mfma_f32_16x16x32_bf16 v[196:199], v[124:127], v[104:107], v[196:199]
v_mfma_f32_16x16x32_bf16 v[188:191], v[124:127], v[100:103], v[188:191]
v_mfma_f32_16x16x32_bf16 v[192:195], v[128:131], v[100:103], v[192:195]
v_mfma_f32_16x16x32_bf16 v[200:203], v[128:131], v[104:107], v[200:203]
v_mfma_f32_16x16x32_bf16 v[208:211], v[128:131], v[108:111], v[208:211]
v_mfma_f32_16x16x32_bf16 v[216:219], v[128:131], v[112:115], v[216:219]
s_barrier
v_mfma_f32_16x16x32_bf16 v[244:247], v[112:115], v[132:135], v[244:247]
ds_read_b128 v[140:143], v7 offset:0
ds_read_b128 v[144:147], v7 offset:64
v_mfma_f32_16x16x32_bf16 v[236:239], v[108:111], v[132:135], v[236:239]
ds_read_b128 v[148:151], v7 offset:256
ds_read_b128 v[152:155], v7 offset:320
v_mfma_f32_16x16x32_bf16 v[228:231], v[104:107], v[132:135], v[228:231]
ds_read_b64 v[92:93], v8 offset:0
ds_read_b64 v[94:95], v8 offset:128
v_mfma_f32_16x16x32_bf16 v[220:223], v[100:103], v[132:135], v[220:223]
ds_read_b64 v[96:97], v8 offset:256
ds_read_b64 v[98:99], v8 offset:384
v_mfma_f32_16x16x32_bf16 v[224:227], v[100:103], v[136:139], v[224:227]
ds_read2_b32 v[56:57], v54 offset0:128 offset1:144
ds_read_b128 v[60:63], v9 offset:0
v_mfma_f32_16x16x32_bf16 v[232:235], v[104:107], v[136:139], v[232:235]
ds_read_b128 v[64:67], v9 offset:64
ds_read_b128 v[68:71], v9 offset:128
v_mfma_f32_16x16x32_bf16 v[240:243], v[108:111], v[136:139], v[240:243]
ds_read_b128 v[72:75], v9 offset:192
ds_read_b128 v[76:79], v9 offset:512
v_mfma_f32_16x16x32_bf16 v[248:251], v[112:115], v[136:139], v[248:251]
ds_read_b128 v[80:83], v9 offset:576
ds_read_b128 v[84:87], v9 offset:640
v_mfma_f32_16x16x32_bf16 v[180:183], v[116:119], v[112:115], v[180:183]
ds_read_b128 v[88:91], v9 offset:704
v_mfma_f32_16x16x32_bf16 v[172:175], v[116:119], v[108:111], v[172:175]
ds_read_b64_tr_b16 v[10:11], v53 offset:0
v_mfma_f32_16x16x32_bf16 v[164:167], v[116:119], v[104:107], v[164:167]
ds_read_b64_tr_b16 v[12:13], v53 offset:1024
v_mfma_f32_16x16x32_bf16 v[156:159], v[116:119], v[100:103], v[156:159]
ds_read_b64_tr_b16 v[14:15], v53 offset:32
v_mfma_f32_16x16x32_bf16 v[160:163], v[120:123], v[100:103], v[160:163]
ds_read_b64_tr_b16 v[16:17], v53 offset:1056
v_mfma_f32_16x16x32_bf16 v[168:171], v[120:123], v[104:107], v[168:171]
v_mfma_f32_16x16x32_bf16 v[176:179], v[120:123], v[108:111], v[176:179]
v_mfma_f32_16x16x32_bf16 v[184:187], v[120:123], v[112:115], v[184:187]
c3_epi:
s_waitcnt lgkmcnt(0)
s_mul_i32 s48, s44, 0x80008000
v_xor_b32 v10, s48, v10
v_xor_b32 v11, s48, v11
v_xor_b32 v12, s48, v12
v_xor_b32 v13, s48, v13
v_xor_b32 v14, s48, v14
v_xor_b32 v15, s48, v15
v_xor_b32 v16, s48, v16
v_xor_b32 v17, s48, v17
v_mul_f32 v128, s66, v92
v_mul_f32 v129, s66, v94
v_mul_f32 v130, s66, v96
v_mul_f32 v131, s66, v98
.p2align 3
v_pk_fma_f32 v[220:221], v[76:77], v[56:57], v[220:221] op_sel:[0,0,0] op_sel_hi:[1,0,1]
v_pk_fma_f32 v[222:223], v[78:79], v[56:57], v[222:223] op_sel:[0,0,0] op_sel_hi:[1,0,1]
v_pk_mul_f32 v[220:221], v[220:221], v[60:61]
v_pk_mul_f32 v[222:223], v[222:223], v[62:63]
v_cvt_pk_bf16_f32 v112, v220, v221
v_cvt_pk_bf16_f32 v113, v222, v223
v_pk_fma_f32 v[228:229], v[80:81], v[56:57], v[228:229] op_sel:[0,0,0] op_sel_hi:[1,0,1]
v_pk_fma_f32 v[230:231], v[82:83], v[56:57], v[230:231] op_sel:[0,0,0] op_sel_hi:[1,0,1]
v_pk_mul_f32 v[228:229], v[228:229], v[64:65]
v_pk_mul_f32 v[230:231], v[230:231], v[66:67]
v_cvt_pk_bf16_f32 v114, v228, v229
v_cvt_pk_bf16_f32 v115, v230, v231
v_pk_fma_f32 v[236:237], v[84:85], v[56:57], v[236:237] op_sel:[0,0,0] op_sel_hi:[1,0,1]
v_pk_fma_f32 v[238:239], v[86:87], v[56:57], v[238:239] op_sel:[0,0,0] op_sel_hi:[1,0,1]
v_pk_mul_f32 v[236:237], v[236:237], v[68:69]
v_pk_mul_f32 v[238:239], v[238:239], v[70:71]
v_cvt_pk_bf16_f32 v116, v236, v237
v_cvt_pk_bf16_f32 v117, v238, v239
v_pk_fma_f32 v[244:245], v[88:89], v[56:57], v[244:245] op_sel:[0,0,0] op_sel_hi:[1,0,1]
v_pk_fma_f32 v[246:247], v[90:91], v[56:57], v[246:247] op_sel:[0,0,0] op_sel_hi:[1,0,1]
v_pk_mul_f32 v[244:245], v[244:245], v[72:73]
v_pk_mul_f32 v[246:247], v[246:247], v[74:75]
v_cvt_pk_bf16_f32 v118, v244, v245
v_cvt_pk_bf16_f32 v119, v246, v247
v_pk_fma_f32 v[224:225], v[76:77], v[56:57], v[224:225] op_sel:[0,1,0] op_sel_hi:[1,1,1]
v_pk_fma_f32 v[226:227], v[78:79], v[56:57], v[226:227] op_sel:[0,1,0] op_sel_hi:[1,1,1]
v_pk_mul_f32 v[224:225], v[224:225], v[60:61]
v_pk_mul_f32 v[226:227], v[226:227], v[62:63]
v_cvt_pk_bf16_f32 v120, v224, v225
v_cvt_pk_bf16_f32 v121, v226, v227
v_pk_fma_f32 v[232:233], v[80:81], v[56:57], v[232:233] op_sel:[0,1,0] op_sel_hi:[1,1,1]
v_pk_fma_f32 v[234:235], v[82:83], v[56:57], v[234:235] op_sel:[0,1,0] op_sel_hi:[1,1,1]
v_pk_mul_f32 v[232:233], v[232:233], v[64:65]
v_pk_mul_f32 v[234:235], v[234:235], v[66:67]
v_cvt_pk_bf16_f32 v122, v232, v233
v_cvt_pk_bf16_f32 v123, v234, v235
v_pk_fma_f32 v[240:241], v[84:85], v[56:57], v[240:241] op_sel:[0,1,0] op_sel_hi:[1,1,1]
v_pk_fma_f32 v[242:243], v[86:87], v[56:57], v[242:243] op_sel:[0,1,0] op_sel_hi:[1,1,1]
v_pk_mul_f32 v[240:241], v[240:241], v[68:69]
v_pk_mul_f32 v[242:243], v[242:243], v[70:71]
v_cvt_pk_bf16_f32 v124, v240, v241
v_cvt_pk_bf16_f32 v125, v242, v243
v_pk_fma_f32 v[248:249], v[88:89], v[56:57], v[248:249] op_sel:[0,1,0] op_sel_hi:[1,1,1]
v_pk_fma_f32 v[250:251], v[90:91], v[56:57], v[250:251] op_sel:[0,1,0] op_sel_hi:[1,1,1]
v_pk_mul_f32 v[248:249], v[248:249], v[72:73]
v_pk_mul_f32 v[250:251], v[250:251], v[74:75]
v_cvt_pk_bf16_f32 v126, v248, v249
v_cvt_pk_bf16_f32 v127, v250, v251
v_pk_fma_f32 v[188:189], v[148:149], v[92:93], v[188:189] op_sel:[0,1,0] op_sel_hi:[1,1,1]
v_pk_fma_f32 v[190:191], v[150:151], v[92:93], v[190:191] op_sel:[0,1,0] op_sel_hi:[1,1,1]
v_pk_fma_f32 v[192:193], v[152:153], v[92:93], v[192:193] op_sel:[0,1,0] op_sel_hi:[1,1,1]
v_pk_fma_f32 v[194:195], v[154:155], v[92:93], v[194:195] op_sel:[0,1,0] op_sel_hi:[1,1,1]
v_cvt_pk_bf16_f32 v188, v188, v189
v_cvt_pk_bf16_f32 v189, v190, v191
v_cvt_pk_bf16_f32 v190, v192, v193
v_cvt_pk_bf16_f32 v191, v194, v195
v_pk_fma_f32 v[196:197], v[148:149], v[94:95], v[196:197] op_sel:[0,1,0] op_sel_hi:[1,1,1]
v_pk_fma_f32 v[198:199], v[150:151], v[94:95], v[198:199] op_sel:[0,1,0] op_sel_hi:[1,1,1]
v_pk_fma_f32 v[200:201], v[152:153], v[94:95], v[200:201] op_sel:[0,1,0] op_sel_hi:[1,1,1]
v_pk_fma_f32 v[202:203], v[154:155], v[94:95], v[202:203] op_sel:[0,1,0] op_sel_hi:[1,1,1]
v_cvt_pk_bf16_f32 v196, v196, v197
v_mfma_f32_16x16x32_bf16 v[60:63], v[10:13], v[188:191], 0
v_cvt_pk_bf16_f32 v197, v198, v199
v_cvt_pk_bf16_f32 v198, v200, v201
v_mfma_f32_16x16x32_bf16 v[64:67], v[14:17], v[188:191], 0
v_cvt_pk_bf16_f32 v199, v202, v203
v_pk_fma_f32 v[204:205], v[148:149], v[96:97], v[204:205] op_sel:[0,1,0] op_sel_hi:[1,1,1]
v_pk_fma_f32 v[206:207], v[150:151], v[96:97], v[206:207] op_sel:[0,1,0] op_sel_hi:[1,1,1]
v_pk_fma_f32 v[208:209], v[152:153], v[96:97], v[208:209] op_sel:[0,1,0] op_sel_hi:[1,1,1]
v_pk_fma_f32 v[210:211], v[154:155], v[96:97], v[210:211] op_sel:[0,1,0] op_sel_hi:[1,1,1]
v_cvt_pk_bf16_f32 v204, v204, v205
v_mfma_f32_16x16x32_bf16 v[68:71], v[10:13], v[196:199], 0
v_cvt_pk_bf16_f32 v205, v206, v207
v_cvt_pk_bf16_f32 v206, v208, v209
v_mfma_f32_16x16x32_bf16 v[72:75], v[14:17], v[196:199], 0
v_cvt_pk_bf16_f32 v207, v210, v211
v_pk_fma_f32 v[212:213], v[148:149], v[98:99], v[212:213] op_sel:[0,1,0] op_sel_hi:[1,1,1]
v_pk_fma_f32 v[214:215], v[150:151], v[98:99], v[214:215] op_sel:[0,1,0] op_sel_hi:[1,1,1]
v_pk_fma_f32 v[216:217], v[152:153], v[98:99], v[216:217] op_sel:[0,1,0] op_sel_hi:[1,1,1]
v_pk_fma_f32 v[218:219], v[154:155], v[98:99], v[218:219] op_sel:[0,1,0] op_sel_hi:[1,1,1]
v_cvt_pk_bf16_f32 v212, v212, v213
v_mfma_f32_16x16x32_bf16 v[76:79], v[10:13], v[204:207], 0
v_cvt_pk_bf16_f32 v213, v214, v215
v_cvt_pk_bf16_f32 v214, v216, v217
v_mfma_f32_16x16x32_bf16 v[80:83], v[14:17], v[204:207], 0
v_cvt_pk_bf16_f32 v215, v218, v219
s_nop 1
v_mfma_f32_16x16x32_bf16 v[84:87], v[10:13], v[212:215], 0
v_mfma_f32_16x16x32_bf16 v[88:91], v[14:17], v[212:215], 0
v_max3_f32 v100, v60, v61, v62
v_min3_f32 v104, v60, v61, v62
v_max3_f32 v100, v100, v63, v64
v_min3_f32 v104, v104, v63, v64
v_max3_f32 v100, v100, v65, v66
v_min3_f32 v104, v104, v65, v66
v_max_f32 v100, v100, v67
v_min_f32 v104, v104, v67
v_max3_f32 v101, v68, v69, v70
v_min3_f32 v105, v68, v69, v70
v_max3_f32 v101, v101, v71, v72
v_min3_f32 v105, v105, v71, v72
v_max3_f32 v101, v101, v73, v74
v_min3_f32 v105, v105, v73, v74
v_max_f32 v101, v101, v75
v_min_f32 v105, v105, v75
v_max3_f32 v102, v76, v77, v78
v_min3_f32 v106, v76, v77, v78
v_max3_f32 v102, v102, v79, v80
v_min3_f32 v106, v106, v79, v80
v_max3_f32 v102, v102, v81, v82
v_min3_f32 v106, v106, v81, v82
v_max_f32 v102, v102, v83
v_min_f32 v106, v106, v83
v_max3_f32 v103, v84, v85, v86
v_min3_f32 v107, v84, v85, v86
v_max3_f32 v103, v103, v87, v88
v_min3_f32 v107, v107, v87, v88
v_max3_f32 v103, v103, v89, v90
v_min3_f32 v107, v107, v89, v90
v_max_f32 v103, v103, v91
v_min_f32 v107, v107, v91
s_nop 1
v_permlane32_swap_b32 v100, v101
v_permlane32_swap_b32 v102, v103
v_permlane32_swap_b32 v104, v105
v_permlane32_swap_b32 v106, v107
v_max_f32 v100, v100, v101
v_max_f32 v102, v102, v103
v_min_f32 v104, v104, v105
v_min_f32 v106, v106, v107
v_permlane16_swap_b32 v100, v102
s_nop 0
v_permlane16_swap_b32 v104, v106
v_max_f32 v100, v100, v102
v_min_f32 v104, v104, v106
v_mov_b32 v102, v100
v_mov_b32 v106, v104
s_nop 0
v_permlane16_swap_b32 v100, v102
v_permlane16_swap_b32 v104, v106
v_mov_b32 v101, v100
v_mov_b32 v103, v102
v_mov_b32 v105, v104
v_mov_b32 v107, v106
v_permlane32_swap_b32 v100, v101
v_permlane32_swap_b32 v102, v103
v_permlane32_swap_b32 v104, v105
v_permlane32_swap_b32 v106, v107
v_pk_mul_f32 v[100:101], v[100:101], v[128:129]
v_pk_mul_f32 v[102:103], v[102:103], v[130:131]
v_pk_mul_f32 v[104:105], v[104:105], v[128:129]
v_pk_mul_f32 v[106:107], v[106:107], v[130:131]
v_pk_fma_f32 v[220:221], v[60:61], v[128:129], v[104:105] op_sel:[0,0,0] op_sel_hi:[1,0,0] neg_lo:[1,0,0] neg_hi:[1,0,0]
v_pk_fma_f32 v[60:61], v[60:61], v[128:129], v[100:101] op_sel:[0,0,0] op_sel_hi:[1,0,0] neg_lo:[0,0,1] neg_hi:[0,0,1]
v_exp_f32 v220, v220
v_exp_f32 v60, v60
v_exp_f32 v221, v221
v_exp_f32 v61, v61
v_pk_fma_f32 v[222:223], v[62:63], v[128:129], v[104:105] op_sel:[0,0,0] op_sel_hi:[1,0,0] neg_lo:[1,0,0] neg_hi:[1,0,0]
v_pk_fma_f32 v[62:63], v[62:63], v[128:129], v[100:101] op_sel:[0,0,0] op_sel_hi:[1,0,0] neg_lo:[0,0,1] neg_hi:[0,0,1]
v_exp_f32 v222, v222
v_exp_f32 v62, v62
v_exp_f32 v223, v223
v_exp_f32 v63, v63
v_pk_fma_f32 v[224:225], v[64:65], v[128:129], v[104:105] op_sel:[0,0,0] op_sel_hi:[1,0,0] neg_lo:[1,0,0] neg_hi:[1,0,0]
v_pk_fma_f32 v[64:65], v[64:65], v[128:129], v[100:101] op_sel:[0,0,0] op_sel_hi:[1,0,0] neg_lo:[0,0,1] neg_hi:[0,0,1]
v_exp_f32 v224, v224
v_exp_f32 v64, v64
v_exp_f32 v225, v225
v_exp_f32 v65, v65
v_pk_fma_f32 v[226:227], v[66:67], v[128:129], v[104:105] op_sel:[0,0,0] op_sel_hi:[1,0,0] neg_lo:[1,0,0] neg_hi:[1,0,0]
v_pk_fma_f32 v[66:67], v[66:67], v[128:129], v[100:101] op_sel:[0,0,0] op_sel_hi:[1,0,0] neg_lo:[0,0,1] neg_hi:[0,0,1]
v_exp_f32 v226, v226
v_exp_f32 v66, v66
v_exp_f32 v227, v227
v_exp_f32 v67, v67
v_pk_fma_f32 v[228:229], v[68:69], v[128:129], v[104:105] op_sel:[0,1,1] op_sel_hi:[1,1,1] neg_lo:[1,0,0] neg_hi:[1,0,0]
v_pk_fma_f32 v[68:69], v[68:69], v[128:129], v[100:101] op_sel:[0,1,1] op_sel_hi:[1,1,1] neg_lo:[0,0,1] neg_hi:[0,0,1]
v_exp_f32 v228, v228
v_exp_f32 v68, v68
v_exp_f32 v229, v229
v_exp_f32 v69, v69
v_pk_fma_f32 v[230:231], v[70:71], v[128:129], v[104:105] op_sel:[0,1,1] op_sel_hi:[1,1,1] neg_lo:[1,0,0] neg_hi:[1,0,0]
v_pk_fma_f32 v[70:71], v[70:71], v[128:129], v[100:101] op_sel:[0,1,1] op_sel_hi:[1,1,1] neg_lo:[0,0,1] neg_hi:[0,0,1]
v_exp_f32 v230, v230
v_exp_f32 v70, v70
v_exp_f32 v231, v231
v_exp_f32 v71, v71
v_pk_fma_f32 v[232:233], v[72:73], v[128:129], v[104:105] op_sel:[0,1,1] op_sel_hi:[1,1,1] neg_lo:[1,0,0] neg_hi:[1,0,0]
v_pk_fma_f32 v[72:73], v[72:73], v[128:129], v[100:101] op_sel:[0,1,1] op_sel_hi:[1,1,1] neg_lo:[0,0,1] neg_hi:[0,0,1]
v_exp_f32 v232, v232
v_exp_f32 v72, v72
v_exp_f32 v233, v233
v_exp_f32 v73, v73
v_pk_fma_f32 v[234:235], v[74:75], v[128:129], v[104:105] op_sel:[0,1,1] op_sel_hi:[1,1,1] neg_lo:[1,0,0] neg_hi:[1,0,0]
v_pk_fma_f32 v[74:75], v[74:75], v[128:129], v[100:101] op_sel:[0,1,1] op_sel_hi:[1,1,1] neg_lo:[0,0,1] neg_hi:[0,0,1]
v_exp_f32 v234, v234
v_exp_f32 v74, v74
v_exp_f32 v235, v235
v_exp_f32 v75, v75
v_pk_fma_f32 v[236:237], v[76:77], v[130:131], v[106:107] op_sel:[0,0,0] op_sel_hi:[1,0,0] neg_lo:[1,0,0] neg_hi:[1,0,0]
v_pk_fma_f32 v[76:77], v[76:77], v[130:131], v[102:103] op_sel:[0,0,0] op_sel_hi:[1,0,0] neg_lo:[0,0,1] neg_hi:[0,0,1]
v_exp_f32 v236, v236
v_exp_f32 v76, v76
v_exp_f32 v237, v237
v_exp_f32 v77, v77
v_pk_fma_f32 v[238:239], v[78:79], v[130:131], v[106:107] op_sel:[0,0,0] op_sel_hi:[1,0,0] neg_lo:[1,0,0] neg_hi:[1,0,0]
v_pk_fma_f32 v[78:79], v[78:79], v[130:131], v[102:103] op_sel:[0,0,0] op_sel_hi:[1,0,0] neg_lo:[0,0,1] neg_hi:[0,0,1]
v_exp_f32 v238, v238
v_exp_f32 v78, v78
v_exp_f32 v239, v239
v_exp_f32 v79, v79
v_pk_fma_f32 v[240:241], v[80:81], v[130:131], v[106:107] op_sel:[0,0,0] op_sel_hi:[1,0,0] neg_lo:[1,0,0] neg_hi:[1,0,0]
v_pk_fma_f32 v[80:81], v[80:81], v[130:131], v[102:103] op_sel:[0,0,0] op_sel_hi:[1,0,0] neg_lo:[0,0,1] neg_hi:[0,0,1]
v_exp_f32 v240, v240
v_exp_f32 v80, v80
v_exp_f32 v241, v241
v_exp_f32 v81, v81
v_pk_fma_f32 v[242:243], v[82:83], v[130:131], v[106:107] op_sel:[0,0,0] op_sel_hi:[1,0,0] neg_lo:[1,0,0] neg_hi:[1,0,0]
v_pk_fma_f32 v[82:83], v[82:83], v[130:131], v[102:103] op_sel:[0,0,0] op_sel_hi:[1,0,0] neg_lo:[0,0,1] neg_hi:[0,0,1]
v_exp_f32 v242, v242
v_exp_f32 v82, v82
v_exp_f32 v243, v243
v_exp_f32 v83, v83
v_pk_fma_f32 v[244:245], v[84:85], v[130:131], v[106:107] op_sel:[0,1,1] op_sel_hi:[1,1,1] neg_lo:[1,0,0] neg_hi:[1,0,0]
v_pk_fma_f32 v[84:85], v[84:85], v[130:131], v[102:103] op_sel:[0,1,1] op_sel_hi:[1,1,1] neg_lo:[0,0,1] neg_hi:[0,0,1]
v_exp_f32 v244, v244
v_exp_f32 v84, v84
v_exp_f32 v245, v245
v_exp_f32 v85, v85
v_pk_fma_f32 v[246:247], v[86:87], v[130:131], v[106:107] op_sel:[0,1,1] op_sel_hi:[1,1,1] neg_lo:[1,0,0] neg_hi:[1,0,0]
v_pk_fma_f32 v[86:87], v[86:87], v[130:131], v[102:103] op_sel:[0,1,1] op_sel_hi:[1,1,1] neg_lo:[0,0,1] neg_hi:[0,0,1]
v_exp_f32 v246, v246
v_exp_f32 v86, v86
v_exp_f32 v247, v247
v_exp_f32 v87, v87
v_pk_fma_f32 v[248:249], v[88:89], v[130:131], v[106:107] op_sel:[0,1,1] op_sel_hi:[1,1,1] neg_lo:[1,0,0] neg_hi:[1,0,0]
v_pk_fma_f32 v[88:89], v[88:89], v[130:131], v[102:103] op_sel:[0,1,1] op_sel_hi:[1,1,1] neg_lo:[0,0,1] neg_hi:[0,0,1]
v_exp_f32 v248, v248
v_exp_f32 v88, v88
v_exp_f32 v249, v249
v_exp_f32 v89, v89
v_pk_fma_f32 v[250:251], v[90:91], v[130:131], v[106:107] op_sel:[0,1,1] op_sel_hi:[1,1,1] neg_lo:[1,0,0] neg_hi:[1,0,0]
v_pk_fma_f32 v[90:91], v[90:91], v[130:131], v[102:103] op_sel:[0,1,1] op_sel_hi:[1,1,1] neg_lo:[0,0,1] neg_hi:[0,0,1]
v_exp_f32 v250, v250
v_exp_f32 v90, v90
v_exp_f32 v251, v251
v_exp_f32 v91, v91
v_pk_add_f32 v[108:109], v[60:61], v[62:63]
v_pk_add_f32 v[110:111], v[220:221], v[222:223]
v_pk_add_f32 v[108:109], v[108:109], v[64:65]
v_pk_add_f32 v[110:111], v[110:111], v[224:225]
v_pk_add_f32 v[108:109], v[108:109], v[66:67]
v_pk_add_f32 v[110:111], v[110:111], v[226:227]
v_add_f32 v100, v108, v109
v_add_f32 v104, v110, v111
v_pk_add_f32 v[108:109], v[68:69], v[70:71]
v_pk_add_f32 v[110:111], v[228:229], v[230:231]
v_pk_add_f32 v[108:109], v[108:109], v[72:73]
v_pk_add_f32 v[110:111], v[110:111], v[232:233]
v_pk_add_f32 v[108:109], v[108:109], v[74:75]
v_pk_add_f32 v[110:111], v[110:111], v[234:235]
v_add_f32 v101, v108, v109
v_add_f32 v105, v110, v111
v_pk_add_f32 v[108:109], v[76:77], v[78:79]
v_pk_add_f32 v[110:111], v[236:237], v[238:239]
v_pk_add_f32 v[108:109], v[108:109], v[80:81]
v_pk_add_f32 v[110:111], v[110:111], v[240:241]
v_pk_add_f32 v[108:109], v[108:109], v[82:83]
v_pk_add_f32 v[110:111], v[110:111], v[242:243]
v_add_f32 v102, v108, v109
v_add_f32 v106, v110, v111
v_pk_add_f32 v[108:109], v[84:85], v[86:87]
v_pk_add_f32 v[110:111], v[244:245], v[246:247]
v_pk_add_f32 v[108:109], v[108:109], v[88:89]
v_pk_add_f32 v[110:111], v[110:111], v[248:249]
v_pk_add_f32 v[108:109], v[108:109], v[90:91]
v_pk_add_f32 v[110:111], v[110:111], v[250:251]
v_add_f32 v103, v108, v109
v_add_f32 v107, v110, v111
s_nop 1
v_permlane32_swap_b32 v100, v101
v_permlane32_swap_b32 v102, v103
v_permlane32_swap_b32 v104, v105
v_permlane32_swap_b32 v106, v107
v_add_f32 v100, v100, v101
v_add_f32 v102, v102, v103
v_add_f32 v104, v104, v105
v_add_f32 v106, v106, v107
v_permlane16_swap_b32 v100, v102
s_nop 0
v_permlane16_swap_b32 v104, v106
v_add_f32 v100, v100, v102
v_add_f32 v104, v104, v106
v_rcp_f32 v100, v100
v_rcp_f32 v104, v104
s_nop 0
v_mov_b32 v102, v100
v_mov_b32 v106, v104
s_nop 0
v_permlane16_swap_b32 v100, v102
v_permlane16_swap_b32 v104, v106
v_mov_b32 v101, v100
v_mov_b32 v103, v102
v_mov_b32 v105, v104
v_mov_b32 v107, v106
v_permlane32_swap_b32 v100, v101
v_permlane32_swap_b32 v102, v103
v_permlane32_swap_b32 v104, v105
v_permlane32_swap_b32 v106, v107
.p2align 3
v_pk_mul_f32 v[60:61], v[60:61], v[100:101] op_sel:[0,0] op_sel_hi:[1,0]
v_pk_mul_f32 v[62:63], v[62:63], v[100:101] op_sel:[0,0] op_sel_hi:[1,0]
v_pk_mul_f32 v[64:65], v[64:65], v[100:101] op_sel:[0,0] op_sel_hi:[1,0]
v_pk_mul_f32 v[66:67], v[66:67], v[100:101] op_sel:[0,0] op_sel_hi:[1,0]
v_pk_mul_f32 v[220:221], v[220:221], v[104:105] op_sel:[0,0] op_sel_hi:[1,0]
v_pk_mul_f32 v[222:223], v[222:223], v[104:105] op_sel:[0,0] op_sel_hi:[1,0]
v_pk_mul_f32 v[224:225], v[224:225], v[104:105] op_sel:[0,0] op_sel_hi:[1,0]
v_pk_mul_f32 v[226:227], v[226:227], v[104:105] op_sel:[0,0] op_sel_hi:[1,0]
v_cvt_pk_bf16_f32 v60, v60, v61
v_cvt_pk_bf16_f32 v61, v62, v63
v_cvt_pk_bf16_f32 v62, v64, v65
v_cvt_pk_bf16_f32 v63, v66, v67
v_cvt_pk_bf16_f32 v220, v220, v221
v_cvt_pk_bf16_f32 v221, v222, v223
v_cvt_pk_bf16_f32 v222, v224, v225
v_cvt_pk_bf16_f32 v223, v226, v227
v_pk_mul_f32 v[68:69], v[68:69], v[100:101] op_sel:[0,1] op_sel_hi:[1,1]
v_pk_mul_f32 v[70:71], v[70:71], v[100:101] op_sel:[0,1] op_sel_hi:[1,1]
v_pk_mul_f32 v[72:73], v[72:73], v[100:101] op_sel:[0,1] op_sel_hi:[1,1]
v_pk_mul_f32 v[74:75], v[74:75], v[100:101] op_sel:[0,1] op_sel_hi:[1,1]
v_pk_mul_f32 v[228:229], v[228:229], v[104:105] op_sel:[0,1] op_sel_hi:[1,1]
v_pk_mul_f32 v[230:231], v[230:231], v[104:105] op_sel:[0,1] op_sel_hi:[1,1]
v_pk_mul_f32 v[232:233], v[232:233], v[104:105] op_sel:[0,1] op_sel_hi:[1,1]
v_pk_mul_f32 v[234:235], v[234:235], v[104:105] op_sel:[0,1] op_sel_hi:[1,1]
v_cvt_pk_bf16_f32 v68, v68, v69
v_mfma_f32_16x16x32_bf16 v[204:207], v[60:63], v[38:41], 0
v_cvt_pk_bf16_f32 v69, v70, v71
v_cvt_pk_bf16_f32 v70, v72, v73
v_mfma_f32_16x16x32_bf16 v[208:211], v[60:63], v[36:39], 0
v_cvt_pk_bf16_f32 v71, v74, v75
v_cvt_pk_bf16_f32 v228, v228, v229
v_mfma_f32_16x16x32_bf16 v[212:215], v[220:223], v[38:41], 0
v_cvt_pk_bf16_f32 v229, v230, v231
v_cvt_pk_bf16_f32 v230, v232, v233
v_mfma_f32_16x16x32_bf16 v[216:219], v[220:223], v[36:39], 0
v_cvt_pk_bf16_f32 v231, v234, v235
v_pk_mul_f32 v[76:77], v[76:77], v[102:103] op_sel:[0,0] op_sel_hi:[1,0]
v_pk_mul_f32 v[78:79], v[78:79], v[102:103] op_sel:[0,0] op_sel_hi:[1,0]
v_pk_mul_f32 v[80:81], v[80:81], v[102:103] op_sel:[0,0] op_sel_hi:[1,0]
v_pk_mul_f32 v[82:83], v[82:83], v[102:103] op_sel:[0,0] op_sel_hi:[1,0]
v_pk_mul_f32 v[236:237], v[236:237], v[106:107] op_sel:[0,0] op_sel_hi:[1,0]
v_pk_mul_f32 v[238:239], v[238:239], v[106:107] op_sel:[0,0] op_sel_hi:[1,0]
v_pk_mul_f32 v[240:241], v[240:241], v[106:107] op_sel:[0,0] op_sel_hi:[1,0]
v_pk_mul_f32 v[242:243], v[242:243], v[106:107] op_sel:[0,0] op_sel_hi:[1,0]
v_cvt_pk_bf16_f32 v76, v76, v77
v_mfma_f32_16x16x32_bf16 v[188:191], v[68:71], v[38:41], 0
v_mfma_f32_16x16x32_bf16 v[192:195], v[68:71], v[36:39], 0
v_cvt_pk_bf16_f32 v77, v78, v79
v_mfma_f32_16x16x32_bf16 v[196:199], v[228:231], v[38:41], 0
v_cvt_pk_bf16_f32 v78, v80, v81
v_mfma_f32_16x16x32_bf16 v[200:203], v[228:231], v[36:39], 0
v_cvt_pk_bf16_f32 v64, v204, v205
v_cvt_pk_bf16_f32 v79, v82, v83
v_cvt_pk_bf16_f32 v65, v206, v207
v_cvt_pk_bf16_f32 v236, v236, v237
v_cvt_pk_bf16_f32 v72, v208, v209
v_cvt_pk_bf16_f32 v73, v210, v211
v_cvt_pk_bf16_f32 v237, v238, v239
v_cvt_pk_bf16_f32 v224, v212, v213
v_cvt_pk_bf16_f32 v238, v240, v241
v_cvt_pk_bf16_f32 v225, v214, v215
v_cvt_pk_bf16_f32 v232, v216, v217
v_cvt_pk_bf16_f32 v239, v242, v243
v_cvt_pk_bf16_f32 v233, v218, v219
v_pk_mul_f32 v[84:85], v[84:85], v[102:103] op_sel:[0,1] op_sel_hi:[1,1]
v_pk_mul_f32 v[86:87], v[86:87], v[102:103] op_sel:[0,1] op_sel_hi:[1,1]
v_pk_mul_f32 v[88:89], v[88:89], v[102:103] op_sel:[0,1] op_sel_hi:[1,1]
v_pk_mul_f32 v[90:91], v[90:91], v[102:103] op_sel:[0,1] op_sel_hi:[1,1]
v_pk_mul_f32 v[244:245], v[244:245], v[106:107] op_sel:[0,1] op_sel_hi:[1,1]
v_pk_mul_f32 v[246:247], v[246:247], v[106:107] op_sel:[0,1] op_sel_hi:[1,1]
v_pk_mul_f32 v[248:249], v[248:249], v[106:107] op_sel:[0,1] op_sel_hi:[1,1]
v_pk_mul_f32 v[250:251], v[250:251], v[106:107] op_sel:[0,1] op_sel_hi:[1,1]
v_cvt_pk_bf16_f32 v84, v84, v85
v_mfma_f32_16x16x32_bf16 v[204:207], v[76:79], v[38:41], 0
v_mfma_f32_16x16x32_bf16 v[208:211], v[76:79], v[36:39], 0
v_cvt_pk_bf16_f32 v85, v86, v87
v_mfma_f32_16x16x32_bf16 v[212:215], v[236:239], v[38:41], 0
v_cvt_pk_bf16_f32 v86, v88, v89
v_mfma_f32_16x16x32_bf16 v[216:219], v[236:239], v[36:39], 0
v_cvt_pk_bf16_f32 v66, v188, v189
v_cvt_pk_bf16_f32 v87, v90, v91
v_cvt_pk_bf16_f32 v67, v190, v191
v_cvt_pk_bf16_f32 v244, v244, v245
v_cvt_pk_bf16_f32 v74, v192, v193
v_cvt_pk_bf16_f32 v75, v194, v195
v_cvt_pk_bf16_f32 v245, v246, v247
v_cvt_pk_bf16_f32 v226, v196, v197
v_cvt_pk_bf16_f32 v246, v248, v249
v_cvt_pk_bf16_f32 v227, v198, v199
v_cvt_pk_bf16_f32 v234, v200, v201
v_cvt_pk_bf16_f32 v247, v250, v251
v_cvt_pk_bf16_f32 v235, v202, v203
v_mov_b32 v5, 4
v_cmp_eq_u32 s[50:51], s41, v2
v_mfma_f32_16x16x32_bf16 v[188:191], v[84:87], v[38:41], 0
v_mfma_f32_16x16x32_bf16 v[192:195], v[84:87], v[36:39], 0
v_mfma_f32_16x16x32_bf16 v[196:199], v[244:247], v[38:41], 0
v_mfma_f32_16x16x32_bf16 v[200:203], v[244:247], v[36:39], 0
v_mfma_f32_16x16x32_bf16 v[152:155], v[224:227], v[112:115], 0
v_cvt_pk_bf16_f32 v80, v204, v205
v_cvt_pk_bf16_f32 v81, v206, v207
v_mfma_f32_16x16x32_bf16 v[60:63], v[232:235], v[112:115], 0
v_cvt_pk_bf16_f32 v88, v208, v209
v_mfma_f32_16x16x32_bf16 v[68:71], v[224:227], v[120:123], 0
v_cvt_pk_bf16_f32 v89, v210, v211
v_mfma_f32_16x16x32_bf16 v[220:223], v[232:235], v[120:123], 0
v_cvt_pk_bf16_f32 v240, v212, v213
v_cvt_pk_bf16_f32 v241, v214, v215
v_mfma_f32_16x16x32_bf16 v[228:231], v[224:227], v[48:51], 0
v_cvt_pk_bf16_f32 v248, v216, v217
v_mfma_f32_16x16x32_bf16 v[76:79], v[232:235], v[48:51], 0
v_cvt_pk_bf16_f32 v249, v218, v219
v_mfma_f32_16x16x32_bf16 v[100:103], v[64:67], v[112:115], 0
v_cvt_pk_bf16_f32 v82, v188, v189
v_cvt_pk_bf16_f32 v83, v190, v191
v_mfma_f32_16x16x32_bf16 v[104:107], v[72:75], v[112:115], 0
v_cvt_pk_bf16_f32 v90, v192, v193
v_mfma_f32_16x16x32_bf16 v[108:111], v[64:67], v[120:123], 0
v_cvt_pk_bf16_f32 v91, v194, v195
v_mfma_f32_16x16x32_bf16 v[132:135], v[72:75], v[120:123], 0
v_cvt_pk_bf16_f32 v242, v196, v197
v_cvt_pk_bf16_f32 v243, v198, v199
v_mfma_f32_16x16x32_bf16 v[136:139], v[64:67], v[48:51], 0
v_cvt_pk_bf16_f32 v250, v200, v201
v_mfma_f32_16x16x32_bf16 v[148:151], v[72:75], v[48:51], 0
v_cvt_pk_bf16_f32 v251, v202, v203
s_nop 1
v_mfma_f32_16x16x32_bf16 v[152:155], v[240:243], v[116:119], v[152:155]
v_mfma_f32_16x16x32_bf16 v[60:63], v[248:251], v[116:119], v[60:63]
v_mfma_f32_16x16x32_bf16 v[68:71], v[240:243], v[124:127], v[68:71]
v_mfma_f32_16x16x32_bf16 v[220:223], v[248:251], v[124:127], v[220:223]
v_mfma_f32_16x16x32_bf16 v[228:231], v[240:243], v[48:51], v[228:231]
v_mfma_f32_16x16x32_bf16 v[76:79], v[248:251], v[48:51], v[76:79]
v_mfma_f32_16x16x32_bf16 v[100:103], v[80:83], v[116:119], v[100:103]
v_mfma_f32_16x16x32_bf16 v[104:107], v[88:91], v[116:119], v[104:107]
v_mfma_f32_16x16x32_bf16 v[108:111], v[80:83], v[124:127], v[108:111]
v_mfma_f32_16x16x32_bf16 v[132:135], v[88:91], v[124:127], v[132:135]
v_cvt_pk_bf16_f32 v152, v152, v153
v_cvt_pk_bf16_f32 v153, v154, v155
v_mfma_f32_16x16x32_bf16 v[136:139], v[80:83], v[48:51], v[136:139]
v_cvt_pk_bf16_f32 v154, v60, v61
v_cvt_pk_bf16_f32 v155, v62, v63
v_mfma_f32_16x16x32_bf16 v[148:151], v[88:91], v[48:51], v[148:151]
ds_write_b128 v42, v[152:155] offset:0
v_cvt_pk_bf16_f32 v68, v68, v69
v_cvt_pk_bf16_f32 v69, v70, v71
v_cvt_pk_bf16_f32 v70, v220, v221
v_cvt_pk_bf16_f32 v71, v222, v223
ds_write_b128 v42, v[68:71] offset:1024
v_cvt_pk_bf16_f32 v228, v228, v229
v_cvt_pk_bf16_f32 v229, v230, v231
v_cvt_pk_bf16_f32 v230, v76, v77
v_cvt_pk_bf16_f32 v231, v78, v79
ds_write_b128 v42, v[228:231] offset:2048
ds_write_b32 v52, v5
s_mov_b32 s63, 0
px_121:
ds_read_b32 v4, v19
ds_read_b128 v[188:191], v43 offset:0
ds_read_b128 v[192:195], v43 offset:1024
ds_read_b128 v[196:199], v43 offset:2048
s_add_u32 s63, s63, 1
s_cmp_lt_u32 s63, 0x400000
s_waitcnt lgkmcnt(0)
v_cmp_ne_u32 vcc, 4, v4
s_cbranch_vccz pxd_122
s_cbranch_scc1 px_121
pxd_122:
v_mfma_f32_16x16x32_bf16 v[100:103], v[38:41], v[188:191], v[100:103]
v_mfma_f32_16x16x32_bf16 v[104:107], v[36:39], v[188:191], v[104:107]
v_mfma_f32_16x16x32_bf16 v[108:111], v[38:41], v[192:195], v[108:111]
v_mfma_f32_16x16x32_bf16 v[132:135], v[36:39], v[192:195], v[132:135]
v_mfma_f32_16x16x32_bf16 v[136:139], v[38:41], v[196:199], v[136:139]
v_mfma_f32_16x16x32_bf16 v[148:151], v[36:39], v[196:199], v[148:151]
s_nop 2
v_cvt_pk_bf16_f32 v100, v100, v101
v_cvt_pk_bf16_f32 v101, v102, v103
v_cvt_pk_bf16_f32 v102, v104, v105
v_cvt_pk_bf16_f32 v103, v106, v107
buffer_store_dwordx4 v[100:103], v55, s[32:35], s53 offen sc1
v_cvt_pk_bf16_f32 v108, v108, v109
v_cvt_pk_bf16_f32 v109, v110, v111
v_cvt_pk_bf16_f32 v110, v132, v133
v_cvt_pk_bf16_f32 v111, v134, v135
buffer_store_dwordx4 v[108:111], v55, s[32:35], s54 offen sc1
v_cvt_pk_bf16_f32 v136, v136, v137
v_cvt_pk_bf16_f32 v137, v138, v139
v_cvt_pk_bf16_f32 v138, v148, v149
v_cvt_pk_bf16_f32 v139, v150, v151
s_mov_b64 exec, s[50:51]
buffer_store_dwordx4 v[136:139], v58, s[32:35], s56 offen sc1
s_mov_b64 exec, -1
s_mov_b32 s51, 0
.p2align 3
v_pk_fma_f32 v[156:157], v[140:141], v[92:93], v[156:157] op_sel:[0,1,0] op_sel_hi:[1,1,1]
v_pk_fma_f32 v[158:159], v[142:143], v[92:93], v[158:159] op_sel:[0,1,0] op_sel_hi:[1,1,1]
v_pk_fma_f32 v[160:161], v[144:145], v[92:93], v[160:161] op_sel:[0,1,0] op_sel_hi:[1,1,1]
v_pk_fma_f32 v[162:163], v[146:147], v[92:93], v[162:163] op_sel:[0,1,0] op_sel_hi:[1,1,1]
v_cvt_pk_bf16_f32 v156, v156, v157
v_cvt_pk_bf16_f32 v157, v158, v159
v_cvt_pk_bf16_f32 v158, v160, v161
v_cvt_pk_bf16_f32 v159, v162, v163
v_pk_fma_f32 v[164:165], v[140:141], v[94:95], v[164:165] op_sel:[0,1,0] op_sel_hi:[1,1,1]
v_pk_fma_f32 v[166:167], v[142:143], v[94:95], v[166:167] op_sel:[0,1,0] op_sel_hi:[1,1,1]
v_pk_fma_f32 v[168:169], v[144:145], v[94:95], v[168:169] op_sel:[0,1,0] op_sel_hi:[1,1,1]
v_pk_fma_f32 v[170:171], v[146:147], v[94:95], v[170:171] op_sel:[0,1,0] op_sel_hi:[1,1,1]
v_cvt_pk_bf16_f32 v164, v164, v165
v_mfma_f32_16x16x32_bf16 v[60:63], v[10:13], v[156:159], 0
v_cvt_pk_bf16_f32 v165, v166, v167
v_cvt_pk_bf16_f32 v166, v168, v169
v_mfma_f32_16x16x32_bf16 v[64:67], v[14:17], v[156:159], 0
v_cvt_pk_bf16_f32 v167, v170, v171
v_pk_fma_f32 v[172:173], v[140:141], v[96:97], v[172:173] op_sel:[0,1,0] op_sel_hi:[1,1,1]
v_pk_fma_f32 v[174:175], v[142:143], v[96:97], v[174:175] op_sel:[0,1,0] op_sel_hi:[1,1,1]
v_pk_fma_f32 v[176:177], v[144:145], v[96:97], v[176:177] op_sel:[0,1,0] op_sel_hi:[1,1,1]
v_pk_fma_f32 v[178:179], v[146:147], v[96:97], v[178:179] op_sel:[0,1,0] op_sel_hi:[1,1,1]
v_cvt_pk_bf16_f32 v172, v172, v173
v_mfma_f32_16x16x32_bf16 v[68:71], v[10:13], v[164:167], 0
v_cvt_pk_bf16_f32 v173, v174, v175
v_cvt_pk_bf16_f32 v174, v176, v177
v_mfma_f32_16x16x32_bf16 v[72:75], v[14:17], v[164:167], 0
v_cvt_pk_bf16_f32 v175, v178, v179
v_pk_fma_f32 v[180:181], v[140:141], v[98:99], v[180:181] op_sel:[0,1,0] op_sel_hi:[1,1,1]
v_pk_fma_f32 v[182:183], v[142:143], v[98:99], v[182:183] op_sel:[0,1,0] op_sel_hi:[1,1,1]
v_pk_fma_f32 v[184:185], v[144:145], v[98:99], v[184:185] op_sel:[0,1,0] op_sel_hi:[1,1,1]
v_pk_fma_f32 v[186:187], v[146:147], v[98:99], v[186:187] op_sel:[0,1,0] op_sel_hi:[1,1,1]
v_cvt_pk_bf16_f32 v180, v180, v181
v_mfma_f32_16x16x32_bf16 v[76:79], v[10:13], v[172:175], 0
v_cvt_pk_bf16_f32 v181, v182, v183
v_cvt_pk_bf16_f32 v182, v184, v185
v_mfma_f32_16x16x32_bf16 v[80:83], v[14:17], v[172:175], 0
v_cvt_pk_bf16_f32 v183, v186, v187
s_nop 1
v_mfma_f32_16x16x32_bf16 v[84:87], v[10:13], v[180:183], 0
v_mfma_f32_16x16x32_bf16 v[88:91], v[14:17], v[180:183], 0
v_max3_f32 v100, v60, v61, v62
v_min3_f32 v104, v60, v61, v62
v_max3_f32 v100, v100, v63, v64
v_min3_f32 v104, v104, v63, v64
v_max3_f32 v100, v100, v65, v66
v_min3_f32 v104, v104, v65, v66
v_max_f32 v100, v100, v67
v_min_f32 v104, v104, v67
v_max3_f32 v101, v68, v69, v70
v_min3_f32 v105, v68, v69, v70
v_max3_f32 v101, v101, v71, v72
v_min3_f32 v105, v105, v71, v72
v_max3_f32 v101, v101, v73, v74
v_min3_f32 v105, v105, v73, v74
v_max_f32 v101, v101, v75
v_min_f32 v105, v105, v75
v_max3_f32 v102, v76, v77, v78
v_min3_f32 v106, v76, v77, v78
v_max3_f32 v102, v102, v79, v80
v_min3_f32 v106, v106, v79, v80
v_max3_f32 v102, v102, v81, v82
v_min3_f32 v106, v106, v81, v82
v_max_f32 v102, v102, v83
v_min_f32 v106, v106, v83
v_max3_f32 v103, v84, v85, v86
v_min3_f32 v107, v84, v85, v86
v_max3_f32 v103, v103, v87, v88
v_min3_f32 v107, v107, v87, v88
v_max3_f32 v103, v103, v89, v90
v_min3_f32 v107, v107, v89, v90
v_max_f32 v103, v103, v91
v_min_f32 v107, v107, v91
s_nop 1
v_permlane32_swap_b32 v100, v101
v_permlane32_swap_b32 v102, v103
v_permlane32_swap_b32 v104, v105
v_permlane32_swap_b32 v106, v107
v_max_f32 v100, v100, v101
v_max_f32 v102, v102, v103
v_min_f32 v104, v104, v105
v_min_f32 v106, v106, v107
v_permlane16_swap_b32 v100, v102
s_nop 0
v_permlane16_swap_b32 v104, v106
v_max_f32 v100, v100, v102
v_min_f32 v104, v104, v106
v_mov_b32 v102, v100
v_mov_b32 v106, v104
s_nop 0
v_permlane16_swap_b32 v100, v102
v_permlane16_swap_b32 v104, v106
v_mov_b32 v101, v100
v_mov_b32 v103, v102
v_mov_b32 v105, v104
v_mov_b32 v107, v106
v_permlane32_swap_b32 v100, v101
v_permlane32_swap_b32 v102, v103
v_permlane32_swap_b32 v104, v105
v_permlane32_swap_b32 v106, v107
v_pk_mul_f32 v[100:101], v[100:101], v[128:129]
v_pk_mul_f32 v[102:103], v[102:103], v[130:131]
v_pk_mul_f32 v[104:105], v[104:105], v[128:129]
v_pk_mul_f32 v[106:107], v[106:107], v[130:131]
v_pk_fma_f32 v[220:221], v[60:61], v[128:129], v[104:105] op_sel:[0,0,0] op_sel_hi:[1,0,0] neg_lo:[1,0,0] neg_hi:[1,0,0]
v_pk_fma_f32 v[60:61], v[60:61], v[128:129], v[100:101] op_sel:[0,0,0] op_sel_hi:[1,0,0] neg_lo:[0,0,1] neg_hi:[0,0,1]
v_exp_f32 v220, v220
v_exp_f32 v60, v60
v_exp_f32 v221, v221
v_exp_f32 v61, v61
v_pk_fma_f32 v[222:223], v[62:63], v[128:129], v[104:105] op_sel:[0,0,0] op_sel_hi:[1,0,0] neg_lo:[1,0,0] neg_hi:[1,0,0]
v_pk_fma_f32 v[62:63], v[62:63], v[128:129], v[100:101] op_sel:[0,0,0] op_sel_hi:[1,0,0] neg_lo:[0,0,1] neg_hi:[0,0,1]
v_exp_f32 v222, v222
v_exp_f32 v62, v62
v_exp_f32 v223, v223
v_exp_f32 v63, v63
v_pk_fma_f32 v[224:225], v[64:65], v[128:129], v[104:105] op_sel:[0,0,0] op_sel_hi:[1,0,0] neg_lo:[1,0,0] neg_hi:[1,0,0]
v_pk_fma_f32 v[64:65], v[64:65], v[128:129], v[100:101] op_sel:[0,0,0] op_sel_hi:[1,0,0] neg_lo:[0,0,1] neg_hi:[0,0,1]
v_exp_f32 v224, v224
v_exp_f32 v64, v64
v_exp_f32 v225, v225
v_exp_f32 v65, v65
v_pk_fma_f32 v[226:227], v[66:67], v[128:129], v[104:105] op_sel:[0,0,0] op_sel_hi:[1,0,0] neg_lo:[1,0,0] neg_hi:[1,0,0]
v_pk_fma_f32 v[66:67], v[66:67], v[128:129], v[100:101] op_sel:[0,0,0] op_sel_hi:[1,0,0] neg_lo:[0,0,1] neg_hi:[0,0,1]
v_exp_f32 v226, v226
v_exp_f32 v66, v66
v_exp_f32 v227, v227
v_exp_f32 v67, v67
v_pk_fma_f32 v[228:229], v[68:69], v[128:129], v[104:105] op_sel:[0,1,1] op_sel_hi:[1,1,1] neg_lo:[1,0,0] neg_hi:[1,0,0]
v_pk_fma_f32 v[68:69], v[68:69], v[128:129], v[100:101] op_sel:[0,1,1] op_sel_hi:[1,1,1] neg_lo:[0,0,1] neg_hi:[0,0,1]
v_exp_f32 v228, v228
v_exp_f32 v68, v68
v_exp_f32 v229, v229
v_exp_f32 v69, v69
v_pk_fma_f32 v[230:231], v[70:71], v[128:129], v[104:105] op_sel:[0,1,1] op_sel_hi:[1,1,1] neg_lo:[1,0,0] neg_hi:[1,0,0]
v_pk_fma_f32 v[70:71], v[70:71], v[128:129], v[100:101] op_sel:[0,1,1] op_sel_hi:[1,1,1] neg_lo:[0,0,1] neg_hi:[0,0,1]
v_exp_f32 v230, v230
v_exp_f32 v70, v70
v_exp_f32 v231, v231
v_exp_f32 v71, v71
v_pk_fma_f32 v[232:233], v[72:73], v[128:129], v[104:105] op_sel:[0,1,1] op_sel_hi:[1,1,1] neg_lo:[1,0,0] neg_hi:[1,0,0]
v_pk_fma_f32 v[72:73], v[72:73], v[128:129], v[100:101] op_sel:[0,1,1] op_sel_hi:[1,1,1] neg_lo:[0,0,1] neg_hi:[0,0,1]
v_exp_f32 v232, v232
v_exp_f32 v72, v72
v_exp_f32 v233, v233
v_exp_f32 v73, v73
v_pk_fma_f32 v[234:235], v[74:75], v[128:129], v[104:105] op_sel:[0,1,1] op_sel_hi:[1,1,1] neg_lo:[1,0,0] neg_hi:[1,0,0]
v_pk_fma_f32 v[74:75], v[74:75], v[128:129], v[100:101] op_sel:[0,1,1] op_sel_hi:[1,1,1] neg_lo:[0,0,1] neg_hi:[0,0,1]
v_exp_f32 v234, v234
v_exp_f32 v74, v74
v_exp_f32 v235, v235
v_exp_f32 v75, v75
buffer_load_dwordx4 v[212:215], v18, s[32:35], s55 offen offset:0 sc1
buffer_load_dwordx4 v[216:219], v18, s[32:35], s55 offen offset:1024 sc1
v_pk_fma_f32 v[236:237], v[76:77], v[130:131], v[106:107] op_sel:[0,0,0] op_sel_hi:[1,0,0] neg_lo:[1,0,0] neg_hi:[1,0,0]
v_pk_fma_f32 v[76:77], v[76:77], v[130:131], v[102:103] op_sel:[0,0,0] op_sel_hi:[1,0,0] neg_lo:[0,0,1] neg_hi:[0,0,1]
v_exp_f32 v236, v236
v_exp_f32 v76, v76
v_exp_f32 v237, v237
v_exp_f32 v77, v77
v_pk_fma_f32 v[238:239], v[78:79], v[130:131], v[106:107] op_sel:[0,0,0] op_sel_hi:[1,0,0] neg_lo:[1,0,0] neg_hi:[1,0,0]
v_pk_fma_f32 v[78:79], v[78:79], v[130:131], v[102:103] op_sel:[0,0,0] op_sel_hi:[1,0,0] neg_lo:[0,0,1] neg_hi:[0,0,1]
v_exp_f32 v238, v238
v_exp_f32 v78, v78
v_exp_f32 v239, v239
v_exp_f32 v79, v79
v_pk_fma_f32 v[240:241], v[80:81], v[130:131], v[106:107] op_sel:[0,0,0] op_sel_hi:[1,0,0] neg_lo:[1,0,0] neg_hi:[1,0,0]
v_pk_fma_f32 v[80:81], v[80:81], v[130:131], v[102:103] op_sel:[0,0,0] op_sel_hi:[1,0,0] neg_lo:[0,0,1] neg_hi:[0,0,1]
v_exp_f32 v240, v240
v_exp_f32 v80, v80
v_exp_f32 v241, v241
v_exp_f32 v81, v81
v_pk_fma_f32 v[242:243], v[82:83], v[130:131], v[106:107] op_sel:[0,0,0] op_sel_hi:[1,0,0] neg_lo:[1,0,0] neg_hi:[1,0,0]
v_pk_fma_f32 v[82:83], v[82:83], v[130:131], v[102:103] op_sel:[0,0,0] op_sel_hi:[1,0,0] neg_lo:[0,0,1] neg_hi:[0,0,1]
v_exp_f32 v242, v242
v_exp_f32 v82, v82
v_exp_f32 v243, v243
v_exp_f32 v83, v83
v_pk_fma_f32 v[244:245], v[84:85], v[130:131], v[106:107] op_sel:[0,1,1] op_sel_hi:[1,1,1] neg_lo:[1,0,0] neg_hi:[1,0,0]
v_pk_fma_f32 v[84:85], v[84:85], v[130:131], v[102:103] op_sel:[0,1,1] op_sel_hi:[1,1,1] neg_lo:[0,0,1] neg_hi:[0,0,1]
v_exp_f32 v244, v244
v_exp_f32 v84, v84
v_exp_f32 v245, v245
v_exp_f32 v85, v85
v_pk_fma_f32 v[246:247], v[86:87], v[130:131], v[106:107] op_sel:[0,1,1] op_sel_hi:[1,1,1] neg_lo:[1,0,0] neg_hi:[1,0,0]
v_pk_fma_f32 v[86:87], v[86:87], v[130:131], v[102:103] op_sel:[0,1,1] op_sel_hi:[1,1,1] neg_lo:[0,0,1] neg_hi:[0,0,1]
v_exp_f32 v246, v246
v_exp_f32 v86, v86
v_exp_f32 v247, v247
v_exp_f32 v87, v87
v_pk_fma_f32 v[248:249], v[88:89], v[130:131], v[106:107] op_sel:[0,1,1] op_sel_hi:[1,1,1] neg_lo:[1,0,0] neg_hi:[1,0,0]
v_pk_fma_f32 v[88:89], v[88:89], v[130:131], v[102:103] op_sel:[0,1,1] op_sel_hi:[1,1,1] neg_lo:[0,0,1] neg_hi:[0,0,1]
v_exp_f32 v248, v248
v_exp_f32 v88, v88
v_exp_f32 v249, v249
v_exp_f32 v89, v89
v_pk_fma_f32 v[250:251], v[90:91], v[130:131], v[106:107] op_sel:[0,1,1] op_sel_hi:[1,1,1] neg_lo:[1,0,0] neg_hi:[1,0,0]
v_pk_fma_f32 v[90:91], v[90:91], v[130:131], v[102:103] op_sel:[0,1,1] op_sel_hi:[1,1,1] neg_lo:[0,0,1] neg_hi:[0,0,1]
v_exp_f32 v250, v250
v_exp_f32 v90, v90
v_exp_f32 v251, v251
v_exp_f32 v91, v91
v_pk_add_f32 v[108:109], v[60:61], v[62:63]
v_pk_add_f32 v[110:111], v[220:221], v[222:223]
v_pk_add_f32 v[108:109], v[108:109], v[64:65]
v_pk_add_f32 v[110:111], v[110:111], v[224:225]
v_pk_add_f32 v[108:109], v[108:109], v[66:67]
v_pk_add_f32 v[110:111], v[110:111], v[226:227]
v_add_f32 v100, v108, v109
v_add_f32 v104, v110, v111
v_pk_add_f32 v[108:109], v[68:69], v[70:71]
v_pk_add_f32 v[110:111], v[228:229], v[230:231]
v_pk_add_f32 v[108:109], v[108:109], v[72:73]
v_pk_add_f32 v[110:111], v[110:111], v[232:233]
v_pk_add_f32 v[108:109], v[108:109], v[74:75]
v_pk_add_f32 v[110:111], v[110:111], v[234:235]
v_add_f32 v101, v108, v109
v_add_f32 v105, v110, v111
v_pk_add_f32 v[108:109], v[76:77], v[78:79]
v_pk_add_f32 v[110:111], v[236:237], v[238:239]
v_pk_add_f32 v[108:109], v[108:109], v[80:81]
v_pk_add_f32 v[110:111], v[110:111], v[240:241]
v_pk_add_f32 v[108:109], v[108:109], v[82:83]
v_pk_add_f32 v[110:111], v[110:111], v[242:243]
v_add_f32 v102, v108, v109
v_add_f32 v106, v110, v111
v_pk_add_f32 v[108:109], v[84:85], v[86:87]
v_pk_add_f32 v[110:111], v[244:245], v[246:247]
v_pk_add_f32 v[108:109], v[108:109], v[88:89]
v_pk_add_f32 v[110:111], v[110:111], v[248:249]
v_pk_add_f32 v[108:109], v[108:109], v[90:91]
v_pk_add_f32 v[110:111], v[110:111], v[250:251]
v_add_f32 v103, v108, v109
v_add_f32 v107, v110, v111
s_cmp_eq_u32 s51, 1
s_cbranch_scc1 chk_123
s_waitcnt vmcnt(0)
v_max_u32 v4, v212, v213
v_max3_u32 v4, v4, v214, v215
v_max3_u32 v4, v4, v216, v217
v_max3_u32 v4, v4, v218, v219
v_cmp_eq_u32 vcc, -1, v4
s_cbranch_vccz red_124
buffer_load_dwordx4 v[212:215], v18, s[32:35], s55 offen offset:0 sc1
buffer_load_dwordx4 v[216:219], v18, s[32:35], s55 offen offset:1024 sc1
s_branch chk_123
red_124:
v_mfma_f32_16x16x32_bf16 v[132:135], v[44:47], v[212:215], 0
v_mfma_f32_16x16x32_bf16 v[132:135], v[44:47], v[216:219], v[132:135]
s_mov_b32 s51, 1
s_nop 6
v_add_f32_dpp v132, v132, v132 row_ror:8 row_mask:0xf bank_mask:0xf
v_add_f32_dpp v133, v133, v133 row_ror:8 row_mask:0xf bank_mask:0xf
v_add_f32_dpp v134, v134, v134 row_ror:8 row_mask:0xf bank_mask:0xf
v_add_f32_dpp v135, v135, v135 row_ror:8 row_mask:0xf bank_mask:0xf
v_cvt_pk_bf16_f32 v132, v132, v133
v_cvt_pk_bf16_f32 v133, v134, v135
s_mov_b64 exec, 0x00ff00ff
buffer_store_dwordx2 v[132:133], v59, s[32:35], s79 offen sc1
s_mov_b64 exec, -1
buffer_load_dwordx4 v[204:207], v58, s[32:35], s56 offen sc1
buffer_load_dwordx4 v[208:211], v58, s[32:35], s57 offen sc1
chk_123:
s_nop 1
v_permlane32_swap_b32 v100, v101
v_permlane32_swap_b32 v102, v103
v_permlane32_swap_b32 v104, v105
v_permlane32_swap_b32 v106, v107
v_add_f32 v100, v100, v101
v_add_f32 v102, v102, v103
v_add_f32 v104, v104, v105
v_add_f32 v106, v106, v107
v_permlane16_swap_b32 v100, v102
s_nop 0
v_permlane16_swap_b32 v104, v106
v_add_f32 v100, v100, v102
v_add_f32 v104, v104, v106
v_rcp_f32 v100, v100
v_rcp_f32 v104, v104
s_nop 0
v_mov_b32 v102, v100
v_mov_b32 v106, v104
s_nop 0
v_permlane16_swap_b32 v100, v102
v_permlane16_swap_b32 v104, v106
v_mov_b32 v101, v100
v_mov_b32 v103, v102
v_mov_b32 v105, v104
v_mov_b32 v107, v106
v_permlane32_swap_b32 v100, v101
v_permlane32_swap_b32 v102, v103
v_permlane32_swap_b32 v104, v105
v_permlane32_swap_b32 v106, v107
.p2align 3
v_pk_mul_f32 v[60:61], v[60:61], v[100:101] op_sel:[0,0] op_sel_hi:[1,0]
v_pk_mul_f32 v[62:63], v[62:63], v[100:101] op_sel:[0,0] op_sel_hi:[1,0]
v_pk_mul_f32 v[64:65], v[64:65], v[100:101] op_sel:[0,0] op_sel_hi:[1,0]
v_pk_mul_f32 v[66:67], v[66:67], v[100:101] op_sel:[0,0] op_sel_hi:[1,0]
v_pk_mul_f32 v[220:221], v[220:221], v[104:105] op_sel:[0,0] op_sel_hi:[1,0]
v_pk_mul_f32 v[222:223], v[222:223], v[104:105] op_sel:[0,0] op_sel_hi:[1,0]
v_pk_mul_f32 v[224:225], v[224:225], v[104:105] op_sel:[0,0] op_sel_hi:[1,0]
v_pk_mul_f32 v[226:227], v[226:227], v[104:105] op_sel:[0,0] op_sel_hi:[1,0]
v_cvt_pk_bf16_f32 v60, v60, v61
v_cvt_pk_bf16_f32 v61, v62, v63
v_cvt_pk_bf16_f32 v62, v64, v65
v_cvt_pk_bf16_f32 v63, v66, v67
v_cvt_pk_bf16_f32 v220, v220, v221
v_cvt_pk_bf16_f32 v221, v222, v223
v_cvt_pk_bf16_f32 v222, v224, v225
v_cvt_pk_bf16_f32 v223, v226, v227
v_pk_mul_f32 v[68:69], v[68:69], v[100:101] op_sel:[0,1] op_sel_hi:[1,1]
v_pk_mul_f32 v[70:71], v[70:71], v[100:101] op_sel:[0,1] op_sel_hi:[1,1]
v_pk_mul_f32 v[72:73], v[72:73], v[100:101] op_sel:[0,1] op_sel_hi:[1,1]
v_pk_mul_f32 v[74:75], v[74:75], v[100:101] op_sel:[0,1] op_sel_hi:[1,1]
v_pk_mul_f32 v[228:229], v[228:229], v[104:105] op_sel:[0,1] op_sel_hi:[1,1]
v_pk_mul_f32 v[230:231], v[230:231], v[104:105] op_sel:[0,1] op_sel_hi:[1,1]
v_pk_mul_f32 v[232:233], v[232:233], v[104:105] op_sel:[0,1] op_sel_hi:[1,1]
v_pk_mul_f32 v[234:235], v[234:235], v[104:105] op_sel:[0,1] op_sel_hi:[1,1]
v_cvt_pk_bf16_f32 v68, v68, v69
v_cvt_pk_bf16_f32 v69, v70, v71
v_cvt_pk_bf16_f32 v70, v72, v73
v_cvt_pk_bf16_f32 v71, v74, v75
v_cvt_pk_bf16_f32 v228, v228, v229
v_cvt_pk_bf16_f32 v229, v230, v231
v_cvt_pk_bf16_f32 v230, v232, v233
v_cvt_pk_bf16_f32 v231, v234, v235
v_pk_mul_f32 v[76:77], v[76:77], v[102:103] op_sel:[0,0] op_sel_hi:[1,0]
v_pk_mul_f32 v[78:79], v[78:79], v[102:103] op_sel:[0,0] op_sel_hi:[1,0]
v_pk_mul_f32 v[80:81], v[80:81], v[102:103] op_sel:[0,0] op_sel_hi:[1,0]
v_pk_mul_f32 v[82:83], v[82:83], v[102:103] op_sel:[0,0] op_sel_hi:[1,0]
v_pk_mul_f32 v[236:237], v[236:237], v[106:107] op_sel:[0,0] op_sel_hi:[1,0]
v_pk_mul_f32 v[238:239], v[238:239], v[106:107] op_sel:[0,0] op_sel_hi:[1,0]
v_pk_mul_f32 v[240:241], v[240:241], v[106:107] op_sel:[0,0] op_sel_hi:[1,0]
v_pk_mul_f32 v[242:243], v[242:243], v[106:107] op_sel:[0,0] op_sel_hi:[1,0]
v_cvt_pk_bf16_f32 v76, v76, v77
v_cvt_pk_bf16_f32 v77, v78, v79
v_cvt_pk_bf16_f32 v78, v80, v81
v_cvt_pk_bf16_f32 v79, v82, v83
v_cvt_pk_bf16_f32 v236, v236, v237
v_cvt_pk_bf16_f32 v237, v238, v239
v_cvt_pk_bf16_f32 v238, v240, v241
v_cvt_pk_bf16_f32 v239, v242, v243
v_pk_mul_f32 v[84:85], v[84:85], v[102:103] op_sel:[0,1] op_sel_hi:[1,1]
v_pk_mul_f32 v[86:87], v[86:87], v[102:103] op_sel:[0,1] op_sel_hi:[1,1]
v_pk_mul_f32 v[88:89], v[88:89], v[102:103] op_sel:[0,1] op_sel_hi:[1,1]
v_pk_mul_f32 v[90:91], v[90:91], v[102:103] op_sel:[0,1] op_sel_hi:[1,1]
v_pk_mul_f32 v[244:245], v[244:245], v[106:107] op_sel:[0,1] op_sel_hi:[1,1]
v_pk_mul_f32 v[246:247], v[246:247], v[106:107] op_sel:[0,1] op_sel_hi:[1,1]
v_pk_mul_f32 v[248:249], v[248:249], v[106:107] op_sel:[0,1] op_sel_hi:[1,1]
v_pk_mul_f32 v[250:251], v[250:251], v[106:107] op_sel:[0,1] op_sel_hi:[1,1]
v_cvt_pk_bf16_f32 v84, v84, v85
v_cvt_pk_bf16_f32 v85, v86, v87
v_cvt_pk_bf16_f32 v86, v88, v89
v_cvt_pk_bf16_f32 v87, v90, v91
v_cvt_pk_bf16_f32 v244, v244, v245
v_cvt_pk_bf16_f32 v245, v246, v247
v_cvt_pk_bf16_f32 v246, v248, v249
v_cvt_pk_bf16_f32 v247, v250, v251
s_cmp_lg_u32 s51, 0
s_cbranch_scc1 else_125
s_mov_b32 s63, 0
sent_127:
s_waitcnt vmcnt(0)
v_max_u32 v4, v212, v213
v_max3_u32 v4, v4, v214, v215
v_max3_u32 v4, v4, v216, v217
v_max3_u32 v4, v4, v218, v219
v_cmp_eq_u32 vcc, -1, v4
s_cbranch_vccz sentd_128
buffer_load_dwordx4 v[212:215], v18, s[32:35], s55 offen offset:0 sc1
buffer_load_dwordx4 v[216:219], v18, s[32:35], s55 offen offset:1024 sc1
s_add_u32 s63, s63, 1
s_cmp_lt_u32 s63, 0x80000
s_cbranch_scc1 sent_127
s_waitcnt vmcnt(0)
sentd_128:
v_mfma_f32_16x16x32_bf16 v[132:135], v[44:47], v[212:215], 0
v_mfma_f32_16x16x32_bf16 v[132:135], v[44:47], v[216:219], v[132:135]
s_mov_b32 s51, 1
s_nop 6
v_add_f32_dpp v132, v132, v132 row_ror:8 row_mask:0xf bank_mask:0xf
v_add_f32_dpp v133, v133, v133 row_ror:8 row_mask:0xf bank_mask:0xf
v_add_f32_dpp v134, v134, v134 row_ror:8 row_mask:0xf bank_mask:0xf
v_add_f32_dpp v135, v135, v135 row_ror:8 row_mask:0xf bank_mask:0xf
v_cvt_pk_bf16_f32 v132, v132, v133
v_cvt_pk_bf16_f32 v133, v134, v135
s_mov_b64 exec, 0x00ff00ff
buffer_store_dwordx2 v[132:133], v59, s[32:35], s79 offen sc1
s_mov_b64 exec, -1
buffer_load_dwordx4 v[204:207], v58, s[32:35], s56 offen sc1
buffer_load_dwordx4 v[208:211], v58, s[32:35], s57 offen sc1
else_125:
s_mov_b32 s63, 0
sent_129:
s_waitcnt vmcnt(0)
v_max_u32 v4, v204, v205
v_max3_u32 v4, v4, v206, v207
v_max3_u32 v4, v4, v208, v209
v_max3_u32 v4, v4, v210, v211
v_cmp_eq_u32 vcc, -1, v4
s_cbranch_vccz sentd_130
buffer_load_dwordx4 v[204:207], v58, s[32:35], s56 offen sc1
buffer_load_dwordx4 v[208:211], v58, s[32:35], s57 offen sc1
s_add_u32 s63, s63, 1
s_cmp_lt_u32 s63, 0x80000
s_cbranch_scc1 sent_129
s_waitcnt vmcnt(0)
sentd_130:
buffer_load_dwordx4 v[188:191], v18, s[32:35], s58 offen offset:0 sc1
buffer_load_dwordx4 v[192:195], v18, s[32:35], s58 offen offset:1024 sc1
buffer_load_dwordx4 v[196:199], v18, s[32:35], s59 offen offset:0 sc1
buffer_load_dwordx4 v[200:203], v18, s[32:35], s59 offen offset:1024 sc1
v_mfma_f32_16x16x32_bf16 v[112:115], v[204:207], v[60:63], 0
v_mfma_f32_16x16x32_bf16 v[116:119], v[204:207], v[68:71], 0
v_mfma_f32_16x16x32_bf16 v[120:123], v[204:207], v[76:79], 0
v_mfma_f32_16x16x32_bf16 v[124:127], v[204:207], v[84:87], 0
v_mfma_f32_16x16x32_bf16 v[112:115], v[208:211], v[220:223], v[112:115]
v_mfma_f32_16x16x32_bf16 v[116:119], v[208:211], v[228:231], v[116:119]
v_mfma_f32_16x16x32_bf16 v[120:123], v[208:211], v[236:239], v[120:123]
v_mfma_f32_16x16x32_bf16 v[124:127], v[208:211], v[244:247], v[124:127]
s_nop 4
v_add_f32 v100, v112, v113
v_add_f32 v114, v114, v115
v_add_f32 v100, v100, v114
v_add_f32 v101, v116, v117
v_add_f32 v118, v118, v119
v_add_f32 v101, v101, v118
v_add_f32 v102, v120, v121
v_add_f32 v122, v122, v123
v_add_f32 v102, v102, v122
v_add_f32 v103, v124, v125
v_add_f32 v126, v126, v127
v_add_f32 v103, v103, v126
s_nop 1
v_permlane32_swap_b32 v100, v101
v_permlane32_swap_b32 v102, v103
v_add_f32 v100, v100, v101
v_add_f32 v102, v102, v103
s_nop 1
v_permlane16_swap_b32 v100, v102
s_nop 0
v_add_f32 v100, v100, v102
v_add_f32 v100, 0x358637bd, v100
v_rcp_f32 v100, v100
s_nop 0
v_mov_b32 v102, v100
s_nop 1
v_permlane16_swap_b32 v100, v102
s_nop 0
v_mov_b32 v101, v100
v_mov_b32 v103, v102
s_nop 0
v_permlane32_swap_b32 v100, v101
v_permlane32_swap_b32 v102, v103
s_mov_b32 s63, 0
sent_131:
s_waitcnt vmcnt(0)
v_max_u32 v4, v188, v189
v_max3_u32 v4, v4, v190, v191
v_max3_u32 v4, v4, v192, v193
v_max3_u32 v4, v4, v194, v195
v_max3_u32 v4, v4, v196, v197
v_max3_u32 v4, v4, v198, v199
v_max3_u32 v4, v4, v200, v201
v_max3_u32 v4, v4, v202, v203
v_cmp_eq_u32 vcc, -1, v4
s_cbranch_vccz sentd_132
buffer_load_dwordx4 v[188:191], v18, s[32:35], s58 offen offset:0 sc1
buffer_load_dwordx4 v[192:195], v18, s[32:35], s58 offen offset:1024 sc1
buffer_load_dwordx4 v[196:199], v18, s[32:35], s59 offen offset:0 sc1
buffer_load_dwordx4 v[200:203], v18, s[32:35], s59 offen offset:1024 sc1
s_add_u32 s63, s63, 1
s_cmp_lt_u32 s63, 0x80000
s_cbranch_scc1 sent_131
s_waitcnt vmcnt(0)
sentd_132:
v_mfma_f32_16x16x32_bf16 v[156:159], v[188:191], v[60:63], 0
v_mfma_f32_16x16x32_bf16 v[160:163], v[192:195], v[60:63], 0
v_mfma_f32_16x16x32_bf16 v[156:159], v[196:199], v[220:223], v[156:159]
v_mfma_f32_16x16x32_bf16 v[160:163], v[200:203], v[220:223], v[160:163]
v_mfma_f32_16x16x32_bf16 v[164:167], v[188:191], v[68:71], 0
v_mfma_f32_16x16x32_bf16 v[168:171], v[192:195], v[68:71], 0
v_mfma_f32_16x16x32_bf16 v[164:167], v[196:199], v[228:231], v[164:167]
v_mfma_f32_16x16x32_bf16 v[168:171], v[200:203], v[228:231], v[168:171]
s_nop 1
s_cmp_eq_u32 s46, 0
s_cbranch_scc1 slow_133
.p2align 3
v_pk_mul_f32 v[156:157], v[156:157], v[100:101] op_sel:[0,0] op_sel_hi:[1,0]
v_pk_mul_f32 v[158:159], v[158:159], v[100:101] op_sel:[0,0] op_sel_hi:[1,0]
v_pk_mul_f32 v[160:161], v[160:161], v[100:101] op_sel:[0,0] op_sel_hi:[1,0]
v_pk_mul_f32 v[162:163], v[162:163], v[100:101] op_sel:[0,0] op_sel_hi:[1,0]
v_cvt_pk_bf16_f32 v156, v156, v157
v_mfma_f32_16x16x32_bf16 v[172:175], v[188:191], v[76:79], 0
v_cvt_pk_bf16_f32 v157, v158, v159
v_mfma_f32_16x16x32_bf16 v[176:179], v[192:195], v[76:79], 0
v_cvt_pk_bf16_f32 v158, v160, v161
v_mfma_f32_16x16x32_bf16 v[172:175], v[196:199], v[236:239], v[172:175]
v_cvt_pk_bf16_f32 v159, v162, v163
v_mfma_f32_16x16x32_bf16 v[176:179], v[200:203], v[236:239], v[176:179]
buffer_store_dwordx4 v[156:159], v18, s[32:35], s80 offen
v_pk_mul_f32 v[164:165], v[164:165], v[100:101] op_sel:[0,1] op_sel_hi:[1,1]
v_pk_mul_f32 v[166:167], v[166:167], v[100:101] op_sel:[0,1] op_sel_hi:[1,1]
v_pk_mul_f32 v[168:169], v[168:169], v[100:101] op_sel:[0,1] op_sel_hi:[1,1]
v_pk_mul_f32 v[170:171], v[170:171], v[100:101] op_sel:[0,1] op_sel_hi:[1,1]
v_cvt_pk_bf16_f32 v164, v164, v165
v_mfma_f32_16x16x32_bf16 v[180:183], v[188:191], v[84:87], 0
v_cvt_pk_bf16_f32 v165, v166, v167
v_mfma_f32_16x16x32_bf16 v[184:187], v[192:195], v[84:87], 0
v_cvt_pk_bf16_f32 v166, v168, v169
v_mfma_f32_16x16x32_bf16 v[180:183], v[196:199], v[244:247], v[180:183]
v_cvt_pk_bf16_f32 v167, v170, v171
v_mfma_f32_16x16x32_bf16 v[184:187], v[200:203], v[244:247], v[184:187]
buffer_store_dwordx4 v[164:167], v18, s[32:35], s81 offen
v_pk_mul_f32 v[172:173], v[172:173], v[102:103] op_sel:[0,0] op_sel_hi:[1,0]
v_pk_mul_f32 v[174:175], v[174:175], v[102:103] op_sel:[0,0] op_sel_hi:[1,0]
v_pk_mul_f32 v[176:177], v[176:177], v[102:103] op_sel:[0,0] op_sel_hi:[1,0]
v_pk_mul_f32 v[178:179], v[178:179], v[102:103] op_sel:[0,0] op_sel_hi:[1,0]
v_cvt_pk_bf16_f32 v172, v172, v173
v_cvt_pk_bf16_f32 v173, v174, v175
v_cvt_pk_bf16_f32 v174, v176, v177
v_cvt_pk_bf16_f32 v175, v178, v179
buffer_store_dwordx4 v[172:175], v18, s[32:35], s82 offen
v_pk_mul_f32 v[180:181], v[180:181], v[102:103] op_sel:[0,1] op_sel_hi:[1,1]
v_pk_mul_f32 v[182:183], v[182:183], v[102:103] op_sel:[0,1] op_sel_hi:[1,1]
v_pk_mul_f32 v[184:185], v[184:185], v[102:103] op_sel:[0,1] op_sel_hi:[1,1]
v_pk_mul_f32 v[186:187], v[186:187], v[102:103] op_sel:[0,1] op_sel_hi:[1,1]
v_cvt_pk_bf16_f32 v180, v180, v181
v_cvt_pk_bf16_f32 v181, v182, v183
v_cvt_pk_bf16_f32 v182, v184, v185
v_cvt_pk_bf16_f32 v183, v186, v187
buffer_store_dwordx4 v[180:183], v18, s[32:35], s83 offen
back_134:
s_barrier
v_and_b32 v36, 31, v0
v_lshlrev_b32 v36, 2, v36
s_lshl_b32 s62, s45, 2
v_mov_b32 v4, s62
v_mov_b32 v5, 4
s_mov_b64 exec, 1
s_waitcnt vmcnt(0)
s_cmp_eq_u32 s46, 0
s_cbranch_scc1 slow_135
buffer_store_dword v5, v4, s[32:35], s84 offen
back_136:
s_mov_b64 exec, -1
v_lshrrev_b32 v4, 2, v2
v_and_b32 v5, 3, v0
v_lshl_add_u32 v6, v3, 3, v4
v_lshlrev_b32 v6, 7, v6
v_lshl_add_u32 v6, v5, 3, v6
v_lshrrev_b32 v7, 1, v4
v_and_b32 v8, 1, v3
v_lshl_add_u32 v7, v8, 1, v7
v_lshl_add_u32 v10, v7, 5, v6
v_xor_b32 v11, 32, v10
v_xor_b32 v12, 64, v10
v_xor_b32 v13, 96, v10
v_add_u32 v14, 0x10000, v10
v_add_u32 v15, 0x10000, v11
v_add_u32 v16, 0x10000, v12
v_add_u32 v17, 0x10000, v13
ds_read_b64_tr_b16 v[220:221], v10 offset:0
ds_read_b64_tr_b16 v[222:223], v10 offset:512
ds_read_b64_tr_b16 v[224:225], v11 offset:0
ds_read_b64_tr_b16 v[226:227], v11 offset:512
ds_read_b64_tr_b16 v[228:229], v12 offset:0
ds_read_b64_tr_b16 v[230:231], v12 offset:512
ds_read_b64_tr_b16 v[232:233], v13 offset:0
ds_read_b64_tr_b16 v[234:235], v13 offset:512
ds_read_b64_tr_b16 v[236:237], v10 offset:4096
ds_read_b64_tr_b16 v[238:239], v10 offset:4608
ds_read_b64_tr_b16 v[240:241], v11 offset:4096
ds_read_b64_tr_b16 v[242:243], v11 offset:4608
ds_read_b64_tr_b16 v[244:245], v12 offset:4096
ds_read_b64_tr_b16 v[246:247], v12 offset:4608
ds_read_b64_tr_b16 v[248:249], v13 offset:4096
ds_read_b64_tr_b16 v[250:251], v13 offset:4608
s_lshl_b32 s48, s41, 3
s_lshl_b32 s49, s40, 1
s_add_u32 s48, s48, s49
s_lshl_b32 s48, s48, 15
s_add_u32 s48, s48, 4194304
v_add_u32 v38, s48, v18
v_add_u32 v39, 32768, v38
s_lshl_b32 s57, s75, 11
s_add_u32 s87, s87, 262144
v_lshlrev_b32 v60, 16, v20
v_and_b32 v61, 0xffff0000, v20
v_lshlrev_b32 v62, 16, v21
v_and_b32 v63, 0xffff0000, v21
v_lshlrev_b32 v64, 16, v22
v_and_b32 v65, 0xffff0000, v22
v_lshlrev_b32 v66, 16, v23
v_and_b32 v67, 0xffff0000, v23
v_lshlrev_b32 v68, 16, v24
v_and_b32 v69, 0xffff0000, v24
v_lshlrev_b32 v70, 16, v25
v_and_b32 v71, 0xffff0000, v25
v_lshlrev_b32 v72, 16, v26
v_and_b32 v73, 0xffff0000, v26
v_lshlrev_b32 v74, 16, v27
v_and_b32 v75, 0xffff0000, v27
v_lshlrev_b32 v76, 16, v28
v_and_b32 v77, 0xffff0000, v28
v_lshlrev_b32 v78, 16, v29
v_and_b32 v79, 0xffff0000, v29
v_lshlrev_b32 v80, 16, v30
v_and_b32 v81, 0xffff0000, v30
v_lshlrev_b32 v82, 16, v31
v_and_b32 v83, 0xffff0000, v31
v_lshlrev_b32 v84, 16, v32
v_and_b32 v85, 0xffff0000, v32
v_lshlrev_b32 v86, 16, v33
v_and_b32 v87, 0xffff0000, v33
v_lshlrev_b32 v88, 16, v34
v_and_b32 v89, 0xffff0000, v34
v_lshlrev_b32 v90, 16, v35
v_and_b32 v91, 0xffff0000, v35
s_lshl_b32 s48, s40, 12
s_add_u32 s48, s48, 139264
v_lshrrev_b32 v4, 1, v2
v_lshrrev_b32 v5, 1, v3
v_xor_b32 v4, v4, v5
v_lshlrev_b32 v4, 4, v4
v_and_b32 v5, 1, v3
v_lshl_add_u32 v4, v5, 3, v4
v_lshl_add_u32 v4, v2, 7, v4
v_add_u32 v42, s48, v4
v_xor_b32 v43, 32, v42
v_xor_b32 v44, 64, v42
v_xor_b32 v45, 96, v42
v_add_u32 v46, s48, v18
s_lshl_b32 s48, s41, 7
s_lshl_b32 s49, s40, 5
s_add_u32 s48, s48, s49
s_lshl_b32 s48, s48, 11
s_lshl_b32 s49, s78, 7
s_add_u32 s48, s48, s49
s_add_u32 s49, s48, 32768
v_lshrrev_b32 v4, 3, v0
v_and_b32 v5, 7, v0
v_lshrrev_b32 v6, 1, v4
v_xor_b32 v5, v5, v6
v_lshlrev_b32 v4, 11, v4
v_lshl_add_u32 v40, v5, 4, v4
v_xor_b32 v41, 64, v40
v_add_u32 v41, 16384, v41
buffer_load_dword v37, v36, s[32:35], s84 offen sc1
s_mov_b32 s63, 0
s_waitcnt vmcnt(0)
poll_137:
v_cmp_gt_u32 vcc, 4, v37
s_cbranch_vccz polled_138
buffer_load_dword v37, v36, s[32:35], s84 offen sc1
s_add_u32 s63, s63, 1
s_cmp_lt_u32 s63, 0x80000
s_waitcnt vmcnt(0)
s_cbranch_scc1 poll_137
polled_138:
buffer_load_dwordx4 v[156:159], v38, s[32:35], s57 offen sc1
buffer_load_dwordx4 v[160:163], v39, s[32:35], s57 offen sc1
buffer_load_dwordx4 v[164:167], v38, s[32:35], s57 offen offset:1024 sc1
buffer_load_dwordx4 v[168:171], v39, s[32:35], s57 offen offset:1024 sc1
s_add_u32 s57, s57, 2048
s_and_b32 s57, s57, 0x7fff
buffer_load_dwordx4 v[172:175], v38, s[32:35], s57 offen sc1
buffer_load_dwordx4 v[176:179], v39, s[32:35], s57 offen sc1
buffer_load_dwordx4 v[180:183], v38, s[32:35], s57 offen offset:1024 sc1
buffer_load_dwordx4 v[184:187], v39, s[32:35], s57 offen offset:1024 sc1
s_add_u32 s57, s57, 2048
s_and_b32 s57, s57, 0x7fff
s_waitcnt vmcnt(6) lgkmcnt(8)
v_mfma_f32_16x16x32_bf16 v[60:63], v[220:223], v[156:159], v[60:63]
buffer_load_dwordx4 v[188:191], v38, s[32:35], s57 offen sc1
v_mfma_f32_16x16x32_bf16 v[76:79], v[220:223], v[160:163], v[76:79]
ds_read_b64_tr_b16 v[100:101], v10 offset:8192
ds_read_b64_tr_b16 v[102:103], v10 offset:8704
v_mfma_f32_16x16x32_bf16 v[64:67], v[224:227], v[156:159], v[64:67]
ds_read_b64_tr_b16 v[104:105], v11 offset:8192
ds_read_b64_tr_b16 v[106:107], v11 offset:8704
v_mfma_f32_16x16x32_bf16 v[80:83], v[224:227], v[160:163], v[80:83]
buffer_load_dwordx4 v[192:195], v39, s[32:35], s57 offen sc1
v_mfma_f32_16x16x32_bf16 v[68:71], v[228:231], v[156:159], v[68:71]
ds_read_b64_tr_b16 v[108:109], v12 offset:8192
ds_read_b64_tr_b16 v[110:111], v12 offset:8704
v_mfma_f32_16x16x32_bf16 v[84:87], v[228:231], v[160:163], v[84:87]
ds_read_b64_tr_b16 v[112:113], v13 offset:8192
ds_read_b64_tr_b16 v[114:115], v13 offset:8704
v_mfma_f32_16x16x32_bf16 v[72:75], v[232:235], v[156:159], v[72:75]
v_mfma_f32_16x16x32_bf16 v[88:91], v[232:235], v[160:163], v[88:91]
s_waitcnt vmcnt(6) lgkmcnt(8)
v_mfma_f32_16x16x32_bf16 v[60:63], v[236:239], v[164:167], v[60:63]
buffer_load_dwordx4 v[196:199], v38, s[32:35], s57 offen offset:1024 sc1
v_mfma_f32_16x16x32_bf16 v[76:79], v[236:239], v[168:171], v[76:79]
ds_read_b64_tr_b16 v[220:221], v10 offset:12288
ds_read_b64_tr_b16 v[222:223], v10 offset:12800
v_mfma_f32_16x16x32_bf16 v[64:67], v[240:243], v[164:167], v[64:67]
ds_read_b64_tr_b16 v[224:225], v11 offset:12288
ds_read_b64_tr_b16 v[226:227], v11 offset:12800
v_mfma_f32_16x16x32_bf16 v[80:83], v[240:243], v[168:171], v[80:83]
buffer_load_dwordx4 v[200:203], v39, s[32:35], s57 offen offset:1024 sc1
v_mfma_f32_16x16x32_bf16 v[68:71], v[244:247], v[164:167], v[68:71]
ds_read_b64_tr_b16 v[228:229], v12 offset:12288
ds_read_b64_tr_b16 v[230:231], v12 offset:12800
v_mfma_f32_16x16x32_bf16 v[84:87], v[244:247], v[168:171], v[84:87]
ds_read_b64_tr_b16 v[232:233], v13 offset:12288
ds_read_b64_tr_b16 v[234:235], v13 offset:12800
v_mfma_f32_16x16x32_bf16 v[72:75], v[248:251], v[164:167], v[72:75]
s_add_u32 s57, s57, 2048
s_and_b32 s57, s57, 0x7fff
v_mfma_f32_16x16x32_bf16 v[88:91], v[248:251], v[168:171], v[88:91]
s_waitcnt vmcnt(6) lgkmcnt(8)
v_mfma_f32_16x16x32_bf16 v[60:63], v[100:103], v[172:175], v[60:63]
buffer_load_dwordx4 v[204:207], v38, s[32:35], s57 offen sc1
v_mfma_f32_16x16x32_bf16 v[76:79], v[100:103], v[176:179], v[76:79]
ds_read_b64_tr_b16 v[236:237], v10 offset:16384
ds_read_b64_tr_b16 v[238:239], v10 offset:16896
v_mfma_f32_16x16x32_bf16 v[64:67], v[104:107], v[172:175], v[64:67]
ds_read_b64_tr_b16 v[240:241], v11 offset:16384
ds_read_b64_tr_b16 v[242:243], v11 offset:16896
v_mfma_f32_16x16x32_bf16 v[80:83], v[104:107], v[176:179], v[80:83]
buffer_load_dwordx4 v[208:211], v39, s[32:35], s57 offen sc1
v_mfma_f32_16x16x32_bf16 v[68:71], v[108:111], v[172:175], v[68:71]
ds_read_b64_tr_b16 v[244:245], v12 offset:16384
ds_read_b64_tr_b16 v[246:247], v12 offset:16896
v_mfma_f32_16x16x32_bf16 v[84:87], v[108:111], v[176:179], v[84:87]
ds_read_b64_tr_b16 v[248:249], v13 offset:16384
ds_read_b64_tr_b16 v[250:251], v13 offset:16896
v_mfma_f32_16x16x32_bf16 v[72:75], v[112:115], v[172:175], v[72:75]
v_mfma_f32_16x16x32_bf16 v[88:91], v[112:115], v[176:179], v[88:91]
s_waitcnt vmcnt(6) lgkmcnt(8)
v_mfma_f32_16x16x32_bf16 v[60:63], v[220:223], v[180:183], v[60:63]
buffer_load_dwordx4 v[212:215], v38, s[32:35], s57 offen offset:1024 sc1
v_mfma_f32_16x16x32_bf16 v[76:79], v[220:223], v[184:187], v[76:79]
ds_read_b64_tr_b16 v[100:101], v10 offset:20480
ds_read_b64_tr_b16 v[102:103], v10 offset:20992
v_mfma_f32_16x16x32_bf16 v[64:67], v[224:227], v[180:183], v[64:67]
ds_read_b64_tr_b16 v[104:105], v11 offset:20480
ds_read_b64_tr_b16 v[106:107], v11 offset:20992
v_mfma_f32_16x16x32_bf16 v[80:83], v[224:227], v[184:187], v[80:83]
buffer_load_dwordx4 v[216:219], v39, s[32:35], s57 offen offset:1024 sc1
v_mfma_f32_16x16x32_bf16 v[68:71], v[228:231], v[180:183], v[68:71]
ds_read_b64_tr_b16 v[108:109], v12 offset:20480
ds_read_b64_tr_b16 v[110:111], v12 offset:20992
v_mfma_f32_16x16x32_bf16 v[84:87], v[228:231], v[184:187], v[84:87]
ds_read_b64_tr_b16 v[112:113], v13 offset:20480
ds_read_b64_tr_b16 v[114:115], v13 offset:20992
v_mfma_f32_16x16x32_bf16 v[72:75], v[232:235], v[180:183], v[72:75]
s_add_u32 s57, s57, 2048
s_and_b32 s57, s57, 0x7fff
v_mfma_f32_16x16x32_bf16 v[88:91], v[232:235], v[184:187], v[88:91]
s_waitcnt vmcnt(6) lgkmcnt(8)
v_mfma_f32_16x16x32_bf16 v[60:63], v[236:239], v[188:191], v[60:63]
buffer_load_dwordx4 v[156:159], v38, s[32:35], s57 offen sc1
v_mfma_f32_16x16x32_bf16 v[76:79], v[236:239], v[192:195], v[76:79]
ds_read_b64_tr_b16 v[220:221], v10 offset:24576
ds_read_b64_tr_b16 v[222:223], v10 offset:25088
v_mfma_f32_16x16x32_bf16 v[64:67], v[240:243], v[188:191], v[64:67]
ds_read_b64_tr_b16 v[224:225], v11 offset:24576
ds_read_b64_tr_b16 v[226:227], v11 offset:25088
v_mfma_f32_16x16x32_bf16 v[80:83], v[240:243], v[192:195], v[80:83]
buffer_load_dwordx4 v[160:163], v39, s[32:35], s57 offen sc1
v_mfma_f32_16x16x32_bf16 v[68:71], v[244:247], v[188:191], v[68:71]
ds_read_b64_tr_b16 v[228:229], v12 offset:24576
ds_read_b64_tr_b16 v[230:231], v12 offset:25088
v_mfma_f32_16x16x32_bf16 v[84:87], v[244:247], v[192:195], v[84:87]
ds_read_b64_tr_b16 v[232:233], v13 offset:24576
ds_read_b64_tr_b16 v[234:235], v13 offset:25088
v_mfma_f32_16x16x32_bf16 v[72:75], v[248:251], v[188:191], v[72:75]
v_mfma_f32_16x16x32_bf16 v[88:91], v[248:251], v[192:195], v[88:91]
s_waitcnt vmcnt(6) lgkmcnt(8)
v_mfma_f32_16x16x32_bf16 v[60:63], v[100:103], v[196:199], v[60:63]
buffer_load_dwordx4 v[164:167], v38, s[32:35], s57 offen offset:1024 sc1
v_mfma_f32_16x16x32_bf16 v[76:79], v[100:103], v[200:203], v[76:79]
ds_read_b64_tr_b16 v[236:237], v10 offset:28672
ds_read_b64_tr_b16 v[238:239], v10 offset:29184
v_mfma_f32_16x16x32_bf16 v[64:67], v[104:107], v[196:199], v[64:67]
ds_read_b64_tr_b16 v[240:241], v11 offset:28672
ds_read_b64_tr_b16 v[242:243], v11 offset:29184
v_mfma_f32_16x16x32_bf16 v[80:83], v[104:107], v[200:203], v[80:83]
buffer_load_dwordx4 v[168:171], v39, s[32:35], s57 offen offset:1024 sc1
v_mfma_f32_16x16x32_bf16 v[68:71], v[108:111], v[196:199], v[68:71]
ds_read_b64_tr_b16 v[244:245], v12 offset:28672
ds_read_b64_tr_b16 v[246:247], v12 offset:29184
v_mfma_f32_16x16x32_bf16 v[84:87], v[108:111], v[200:203], v[84:87]
ds_read_b64_tr_b16 v[248:249], v13 offset:28672
ds_read_b64_tr_b16 v[250:251], v13 offset:29184
v_mfma_f32_16x16x32_bf16 v[72:75], v[112:115], v[196:199], v[72:75]
s_add_u32 s57, s57, 2048
s_and_b32 s57, s57, 0x7fff
v_mfma_f32_16x16x32_bf16 v[88:91], v[112:115], v[200:203], v[88:91]
s_waitcnt vmcnt(6) lgkmcnt(8)
v_mfma_f32_16x16x32_bf16 v[60:63], v[220:223], v[204:207], v[60:63]
buffer_load_dwordx4 v[172:175], v38, s[32:35], s57 offen sc1
v_mfma_f32_16x16x32_bf16 v[76:79], v[220:223], v[208:211], v[76:79]
ds_read_b64_tr_b16 v[100:101], v10 offset:32768
ds_read_b64_tr_b16 v[102:103], v10 offset:33280
v_mfma_f32_16x16x32_bf16 v[64:67], v[224:227], v[204:207], v[64:67]
ds_read_b64_tr_b16 v[104:105], v11 offset:32768
ds_read_b64_tr_b16 v[106:107], v11 offset:33280
v_mfma_f32_16x16x32_bf16 v[80:83], v[224:227], v[208:211], v[80:83]
buffer_load_dwordx4 v[176:179], v39, s[32:35], s57 offen sc1
v_mfma_f32_16x16x32_bf16 v[68:71], v[228:231], v[204:207], v[68:71]
ds_read_b64_tr_b16 v[108:109], v12 offset:32768
ds_read_b64_tr_b16 v[110:111], v12 offset:33280
v_mfma_f32_16x16x32_bf16 v[84:87], v[228:231], v[208:211], v[84:87]
ds_read_b64_tr_b16 v[112:113], v13 offset:32768
ds_read_b64_tr_b16 v[114:115], v13 offset:33280
v_mfma_f32_16x16x32_bf16 v[72:75], v[232:235], v[204:207], v[72:75]
v_mfma_f32_16x16x32_bf16 v[88:91], v[232:235], v[208:211], v[88:91]
s_waitcnt vmcnt(6) lgkmcnt(8)
v_mfma_f32_16x16x32_bf16 v[60:63], v[236:239], v[212:215], v[60:63]
buffer_load_dwordx4 v[180:183], v38, s[32:35], s57 offen offset:1024 sc1
v_mfma_f32_16x16x32_bf16 v[76:79], v[236:239], v[216:219], v[76:79]
ds_read_b64_tr_b16 v[220:221], v10 offset:36864
ds_read_b64_tr_b16 v[222:223], v10 offset:37376
v_mfma_f32_16x16x32_bf16 v[64:67], v[240:243], v[212:215], v[64:67]
ds_read_b64_tr_b16 v[224:225], v11 offset:36864
ds_read_b64_tr_b16 v[226:227], v11 offset:37376
v_mfma_f32_16x16x32_bf16 v[80:83], v[240:243], v[216:219], v[80:83]
buffer_load_dwordx4 v[184:187], v39, s[32:35], s57 offen offset:1024 sc1
v_mfma_f32_16x16x32_bf16 v[68:71], v[244:247], v[212:215], v[68:71]
ds_read_b64_tr_b16 v[228:229], v12 offset:36864
ds_read_b64_tr_b16 v[230:231], v12 offset:37376
v_mfma_f32_16x16x32_bf16 v[84:87], v[244:247], v[216:219], v[84:87]
ds_read_b64_tr_b16 v[232:233], v13 offset:36864
ds_read_b64_tr_b16 v[234:235], v13 offset:37376
v_mfma_f32_16x16x32_bf16 v[72:75], v[248:251], v[212:215], v[72:75]
s_add_u32 s57, s57, 2048
s_and_b32 s57, s57, 0x7fff
v_mfma_f32_16x16x32_bf16 v[88:91], v[248:251], v[216:219], v[88:91]
s_waitcnt vmcnt(6) lgkmcnt(8)
v_mfma_f32_16x16x32_bf16 v[60:63], v[100:103], v[156:159], v[60:63]
buffer_load_dwordx4 v[188:191], v38, s[32:35], s57 offen sc1
v_mfma_f32_16x16x32_bf16 v[76:79], v[100:103], v[160:163], v[76:79]
ds_read_b64_tr_b16 v[236:237], v10 offset:40960
ds_read_b64_tr_b16 v[238:239], v10 offset:41472
v_mfma_f32_16x16x32_bf16 v[64:67], v[104:107], v[156:159], v[64:67]
ds_read_b64_tr_b16 v[240:241], v11 offset:40960
ds_read_b64_tr_b16 v[242:243], v11 offset:41472
v_mfma_f32_16x16x32_bf16 v[80:83], v[104:107], v[160:163], v[80:83]
buffer_load_dwordx4 v[192:195], v39, s[32:35], s57 offen sc1
v_mfma_f32_16x16x32_bf16 v[68:71], v[108:111], v[156:159], v[68:71]
ds_read_b64_tr_b16 v[244:245], v12 offset:40960
ds_read_b64_tr_b16 v[246:247], v12 offset:41472
v_mfma_f32_16x16x32_bf16 v[84:87], v[108:111], v[160:163], v[84:87]
ds_read_b64_tr_b16 v[248:249], v13 offset:40960
ds_read_b64_tr_b16 v[250:251], v13 offset:41472
v_mfma_f32_16x16x32_bf16 v[72:75], v[112:115], v[156:159], v[72:75]
v_mfma_f32_16x16x32_bf16 v[88:91], v[112:115], v[160:163], v[88:91]
s_waitcnt vmcnt(6) lgkmcnt(8)
v_mfma_f32_16x16x32_bf16 v[60:63], v[220:223], v[164:167], v[60:63]
buffer_load_dwordx4 v[196:199], v38, s[32:35], s57 offen offset:1024 sc1
v_mfma_f32_16x16x32_bf16 v[76:79], v[220:223], v[168:171], v[76:79]
ds_read_b64_tr_b16 v[100:101], v10 offset:45056
ds_read_b64_tr_b16 v[102:103], v10 offset:45568
v_mfma_f32_16x16x32_bf16 v[64:67], v[224:227], v[164:167], v[64:67]
ds_read_b64_tr_b16 v[104:105], v11 offset:45056
ds_read_b64_tr_b16 v[106:107], v11 offset:45568
v_mfma_f32_16x16x32_bf16 v[80:83], v[224:227], v[168:171], v[80:83]
buffer_load_dwordx4 v[200:203], v39, s[32:35], s57 offen offset:1024 sc1
v_mfma_f32_16x16x32_bf16 v[68:71], v[228:231], v[164:167], v[68:71]
ds_read_b64_tr_b16 v[108:109], v12 offset:45056
ds_read_b64_tr_b16 v[110:111], v12 offset:45568
v_mfma_f32_16x16x32_bf16 v[84:87], v[228:231], v[168:171], v[84:87]
ds_read_b64_tr_b16 v[112:113], v13 offset:45056
ds_read_b64_tr_b16 v[114:115], v13 offset:45568
v_mfma_f32_16x16x32_bf16 v[72:75], v[232:235], v[164:167], v[72:75]
s_add_u32 s57, s57, 2048
s_and_b32 s57, s57, 0x7fff
v_mfma_f32_16x16x32_bf16 v[88:91], v[232:235], v[168:171], v[88:91]
s_waitcnt vmcnt(6) lgkmcnt(8)
v_mfma_f32_16x16x32_bf16 v[60:63], v[236:239], v[172:175], v[60:63]
buffer_load_dwordx4 v[204:207], v38, s[32:35], s57 offen sc1
v_mfma_f32_16x16x32_bf16 v[76:79], v[236:239], v[176:179], v[76:79]
ds_read_b64_tr_b16 v[220:221], v10 offset:49152
ds_read_b64_tr_b16 v[222:223], v10 offset:49664
v_mfma_f32_16x16x32_bf16 v[64:67], v[240:243], v[172:175], v[64:67]
ds_read_b64_tr_b16 v[224:225], v11 offset:49152
ds_read_b64_tr_b16 v[226:227], v11 offset:49664
v_mfma_f32_16x16x32_bf16 v[80:83], v[240:243], v[176:179], v[80:83]
buffer_load_dwordx4 v[208:211], v39, s[32:35], s57 offen sc1
v_mfma_f32_16x16x32_bf16 v[68:71], v[244:247], v[172:175], v[68:71]
ds_read_b64_tr_b16 v[228:229], v12 offset:49152
ds_read_b64_tr_b16 v[230:231], v12 offset:49664
v_mfma_f32_16x16x32_bf16 v[84:87], v[244:247], v[176:179], v[84:87]
ds_read_b64_tr_b16 v[232:233], v13 offset:49152
ds_read_b64_tr_b16 v[234:235], v13 offset:49664
v_mfma_f32_16x16x32_bf16 v[72:75], v[248:251], v[172:175], v[72:75]
v_mfma_f32_16x16x32_bf16 v[88:91], v[248:251], v[176:179], v[88:91]
s_waitcnt vmcnt(6) lgkmcnt(8)
v_mfma_f32_16x16x32_bf16 v[60:63], v[100:103], v[180:183], v[60:63]
buffer_load_dwordx4 v[212:215], v38, s[32:35], s57 offen offset:1024 sc1
v_mfma_f32_16x16x32_bf16 v[76:79], v[100:103], v[184:187], v[76:79]
ds_read_b64_tr_b16 v[236:237], v10 offset:53248
ds_read_b64_tr_b16 v[238:239], v10 offset:53760
v_mfma_f32_16x16x32_bf16 v[64:67], v[104:107], v[180:183], v[64:67]
ds_read_b64_tr_b16 v[240:241], v11 offset:53248
ds_read_b64_tr_b16 v[242:243], v11 offset:53760
v_mfma_f32_16x16x32_bf16 v[80:83], v[104:107], v[184:187], v[80:83]
buffer_load_dwordx4 v[216:219], v39, s[32:35], s57 offen offset:1024 sc1
v_mfma_f32_16x16x32_bf16 v[68:71], v[108:111], v[180:183], v[68:71]
ds_read_b64_tr_b16 v[244:245], v12 offset:53248
ds_read_b64_tr_b16 v[246:247], v12 offset:53760
v_mfma_f32_16x16x32_bf16 v[84:87], v[108:111], v[184:187], v[84:87]
ds_read_b64_tr_b16 v[248:249], v13 offset:53248
ds_read_b64_tr_b16 v[250:251], v13 offset:53760
v_mfma_f32_16x16x32_bf16 v[72:75], v[112:115], v[180:183], v[72:75]
s_add_u32 s57, s57, 2048
s_and_b32 s57, s57, 0x7fff
v_mfma_f32_16x16x32_bf16 v[88:91], v[112:115], v[184:187], v[88:91]
s_waitcnt vmcnt(6) lgkmcnt(8)
v_mfma_f32_16x16x32_bf16 v[60:63], v[220:223], v[188:191], v[60:63]
buffer_load_dwordx4 v[156:159], v38, s[32:35], s57 offen sc1
v_mfma_f32_16x16x32_bf16 v[76:79], v[220:223], v[192:195], v[76:79]
ds_read_b64_tr_b16 v[100:101], v10 offset:57344
ds_read_b64_tr_b16 v[102:103], v10 offset:57856
v_mfma_f32_16x16x32_bf16 v[64:67], v[224:227], v[188:191], v[64:67]
ds_read_b64_tr_b16 v[104:105], v11 offset:57344
ds_read_b64_tr_b16 v[106:107], v11 offset:57856
v_mfma_f32_16x16x32_bf16 v[80:83], v[224:227], v[192:195], v[80:83]
buffer_load_dwordx4 v[160:163], v39, s[32:35], s57 offen sc1
v_mfma_f32_16x16x32_bf16 v[68:71], v[228:231], v[188:191], v[68:71]
ds_read_b64_tr_b16 v[108:109], v12 offset:57344
ds_read_b64_tr_b16 v[110:111], v12 offset:57856
v_mfma_f32_16x16x32_bf16 v[84:87], v[228:231], v[192:195], v[84:87]
ds_read_b64_tr_b16 v[112:113], v13 offset:57344
ds_read_b64_tr_b16 v[114:115], v13 offset:57856
v_mfma_f32_16x16x32_bf16 v[72:75], v[232:235], v[188:191], v[72:75]
v_mfma_f32_16x16x32_bf16 v[88:91], v[232:235], v[192:195], v[88:91]
s_waitcnt vmcnt(6) lgkmcnt(8)
v_mfma_f32_16x16x32_bf16 v[60:63], v[236:239], v[196:199], v[60:63]
buffer_load_dwordx4 v[164:167], v38, s[32:35], s57 offen offset:1024 sc1
v_mfma_f32_16x16x32_bf16 v[76:79], v[236:239], v[200:203], v[76:79]
ds_read_b64_tr_b16 v[220:221], v10 offset:61440
ds_read_b64_tr_b16 v[222:223], v10 offset:61952
v_mfma_f32_16x16x32_bf16 v[64:67], v[240:243], v[196:199], v[64:67]
ds_read_b64_tr_b16 v[224:225], v11 offset:61440
ds_read_b64_tr_b16 v[226:227], v11 offset:61952
v_mfma_f32_16x16x32_bf16 v[80:83], v[240:243], v[200:203], v[80:83]
buffer_load_dwordx4 v[168:171], v39, s[32:35], s57 offen offset:1024 sc1
v_mfma_f32_16x16x32_bf16 v[68:71], v[244:247], v[196:199], v[68:71]
ds_read_b64_tr_b16 v[228:229], v12 offset:61440
ds_read_b64_tr_b16 v[230:231], v12 offset:61952
v_mfma_f32_16x16x32_bf16 v[84:87], v[244:247], v[200:203], v[84:87]
ds_read_b64_tr_b16 v[232:233], v13 offset:61440
ds_read_b64_tr_b16 v[234:235], v13 offset:61952
v_mfma_f32_16x16x32_bf16 v[72:75], v[248:251], v[196:199], v[72:75]
s_add_u32 s57, s57, 2048
s_and_b32 s57, s57, 0x7fff
v_mfma_f32_16x16x32_bf16 v[88:91], v[248:251], v[200:203], v[88:91]
s_waitcnt vmcnt(6) lgkmcnt(8)
v_mfma_f32_16x16x32_bf16 v[60:63], v[100:103], v[204:207], v[60:63]
buffer_load_dwordx4 v[172:175], v38, s[32:35], s57 offen sc1
v_mfma_f32_16x16x32_bf16 v[76:79], v[100:103], v[208:211], v[76:79]
ds_read_b64_tr_b16 v[236:237], v14 offset:0
ds_read_b64_tr_b16 v[238:239], v14 offset:512
v_mfma_f32_16x16x32_bf16 v[64:67], v[104:107], v[204:207], v[64:67]
ds_read_b64_tr_b16 v[240:241], v15 offset:0
ds_read_b64_tr_b16 v[242:243], v15 offset:512
v_mfma_f32_16x16x32_bf16 v[80:83], v[104:107], v[208:211], v[80:83]
buffer_load_dwordx4 v[176:179], v39, s[32:35], s57 offen sc1
v_mfma_f32_16x16x32_bf16 v[68:71], v[108:111], v[204:207], v[68:71]
ds_read_b64_tr_b16 v[244:245], v16 offset:0
ds_read_b64_tr_b16 v[246:247], v16 offset:512
v_mfma_f32_16x16x32_bf16 v[84:87], v[108:111], v[208:211], v[84:87]
ds_read_b64_tr_b16 v[248:249], v17 offset:0
ds_read_b64_tr_b16 v[250:251], v17 offset:512
v_mfma_f32_16x16x32_bf16 v[72:75], v[112:115], v[204:207], v[72:75]
v_mfma_f32_16x16x32_bf16 v[88:91], v[112:115], v[208:211], v[88:91]
s_waitcnt vmcnt(6) lgkmcnt(8)
v_mfma_f32_16x16x32_bf16 v[60:63], v[220:223], v[212:215], v[60:63]
buffer_load_dwordx4 v[180:183], v38, s[32:35], s57 offen offset:1024 sc1
v_mfma_f32_16x16x32_bf16 v[76:79], v[220:223], v[216:219], v[76:79]
ds_read_b64_tr_b16 v[100:101], v14 offset:4096
ds_read_b64_tr_b16 v[102:103], v14 offset:4608
v_mfma_f32_16x16x32_bf16 v[64:67], v[224:227], v[212:215], v[64:67]
ds_read_b64_tr_b16 v[104:105], v15 offset:4096
ds_read_b64_tr_b16 v[106:107], v15 offset:4608
v_mfma_f32_16x16x32_bf16 v[80:83], v[224:227], v[216:219], v[80:83]
buffer_load_dwordx4 v[184:187], v39, s[32:35], s57 offen offset:1024 sc1
v_mfma_f32_16x16x32_bf16 v[68:71], v[228:231], v[212:215], v[68:71]
ds_read_b64_tr_b16 v[108:109], v16 offset:4096
ds_read_b64_tr_b16 v[110:111], v16 offset:4608
v_mfma_f32_16x16x32_bf16 v[84:87], v[228:231], v[216:219], v[84:87]
ds_read_b64_tr_b16 v[112:113], v17 offset:4096
ds_read_b64_tr_b16 v[114:115], v17 offset:4608
v_mfma_f32_16x16x32_bf16 v[72:75], v[232:235], v[212:215], v[72:75]
s_add_u32 s57, s57, 2048
s_and_b32 s57, s57, 0x7fff
v_mfma_f32_16x16x32_bf16 v[88:91], v[232:235], v[216:219], v[88:91]
s_waitcnt vmcnt(6) lgkmcnt(8)
v_mfma_f32_16x16x32_bf16 v[60:63], v[236:239], v[156:159], v[60:63]
buffer_load_dwordx4 v[188:191], v38, s[32:35], s57 offen sc1
v_mfma_f32_16x16x32_bf16 v[76:79], v[236:239], v[160:163], v[76:79]
ds_read_b64_tr_b16 v[220:221], v14 offset:8192
ds_read_b64_tr_b16 v[222:223], v14 offset:8704
v_mfma_f32_16x16x32_bf16 v[64:67], v[240:243], v[156:159], v[64:67]
ds_read_b64_tr_b16 v[224:225], v15 offset:8192
ds_read_b64_tr_b16 v[226:227], v15 offset:8704
v_mfma_f32_16x16x32_bf16 v[80:83], v[240:243], v[160:163], v[80:83]
buffer_load_dwordx4 v[192:195], v39, s[32:35], s57 offen sc1
v_mfma_f32_16x16x32_bf16 v[68:71], v[244:247], v[156:159], v[68:71]
ds_read_b64_tr_b16 v[228:229], v16 offset:8192
ds_read_b64_tr_b16 v[230:231], v16 offset:8704
v_mfma_f32_16x16x32_bf16 v[84:87], v[244:247], v[160:163], v[84:87]
ds_read_b64_tr_b16 v[232:233], v17 offset:8192
ds_read_b64_tr_b16 v[234:235], v17 offset:8704
v_mfma_f32_16x16x32_bf16 v[72:75], v[248:251], v[156:159], v[72:75]
v_mfma_f32_16x16x32_bf16 v[88:91], v[248:251], v[160:163], v[88:91]
s_waitcnt vmcnt(6) lgkmcnt(8)
v_mfma_f32_16x16x32_bf16 v[60:63], v[100:103], v[164:167], v[60:63]
buffer_load_dwordx4 v[196:199], v38, s[32:35], s57 offen offset:1024 sc1
v_mfma_f32_16x16x32_bf16 v[76:79], v[100:103], v[168:171], v[76:79]
ds_read_b64_tr_b16 v[236:237], v14 offset:12288
ds_read_b64_tr_b16 v[238:239], v14 offset:12800
v_mfma_f32_16x16x32_bf16 v[64:67], v[104:107], v[164:167], v[64:67]
ds_read_b64_tr_b16 v[240:241], v15 offset:12288
ds_read_b64_tr_b16 v[242:243], v15 offset:12800
v_mfma_f32_16x16x32_bf16 v[80:83], v[104:107], v[168:171], v[80:83]
buffer_load_dwordx4 v[200:203], v39, s[32:35], s57 offen offset:1024 sc1
v_mfma_f32_16x16x32_bf16 v[68:71], v[108:111], v[164:167], v[68:71]
ds_read_b64_tr_b16 v[244:245], v16 offset:12288
ds_read_b64_tr_b16 v[246:247], v16 offset:12800
v_mfma_f32_16x16x32_bf16 v[84:87], v[108:111], v[168:171], v[84:87]
ds_read_b64_tr_b16 v[248:249], v17 offset:12288
ds_read_b64_tr_b16 v[250:251], v17 offset:12800
v_mfma_f32_16x16x32_bf16 v[72:75], v[112:115], v[164:167], v[72:75]
s_add_u32 s57, s57, 2048
s_and_b32 s57, s57, 0x7fff
v_mfma_f32_16x16x32_bf16 v[88:91], v[112:115], v[168:171], v[88:91]
s_waitcnt vmcnt(6) lgkmcnt(8)
v_mfma_f32_16x16x32_bf16 v[60:63], v[220:223], v[172:175], v[60:63]
buffer_load_dwordx4 v[204:207], v38, s[32:35], s57 offen sc1
v_mfma_f32_16x16x32_bf16 v[76:79], v[220:223], v[176:179], v[76:79]
ds_read_b64_tr_b16 v[100:101], v14 offset:16384
ds_read_b64_tr_b16 v[102:103], v14 offset:16896
v_mfma_f32_16x16x32_bf16 v[64:67], v[224:227], v[172:175], v[64:67]
ds_read_b64_tr_b16 v[104:105], v15 offset:16384
ds_read_b64_tr_b16 v[106:107], v15 offset:16896
v_mfma_f32_16x16x32_bf16 v[80:83], v[224:227], v[176:179], v[80:83]
buffer_load_dwordx4 v[208:211], v39, s[32:35], s57 offen sc1
v_mfma_f32_16x16x32_bf16 v[68:71], v[228:231], v[172:175], v[68:71]
ds_read_b64_tr_b16 v[108:109], v16 offset:16384
ds_read_b64_tr_b16 v[110:111], v16 offset:16896
v_mfma_f32_16x16x32_bf16 v[84:87], v[228:231], v[176:179], v[84:87]
ds_read_b64_tr_b16 v[112:113], v17 offset:16384
ds_read_b64_tr_b16 v[114:115], v17 offset:16896
v_mfma_f32_16x16x32_bf16 v[72:75], v[232:235], v[172:175], v[72:75]
v_mfma_f32_16x16x32_bf16 v[88:91], v[232:235], v[176:179], v[88:91]
s_waitcnt vmcnt(6) lgkmcnt(8)
v_mfma_f32_16x16x32_bf16 v[60:63], v[236:239], v[180:183], v[60:63]
buffer_load_dwordx4 v[212:215], v38, s[32:35], s57 offen offset:1024 sc1
v_mfma_f32_16x16x32_bf16 v[76:79], v[236:239], v[184:187], v[76:79]
ds_read_b64_tr_b16 v[220:221], v14 offset:20480
ds_read_b64_tr_b16 v[222:223], v14 offset:20992
v_mfma_f32_16x16x32_bf16 v[64:67], v[240:243], v[180:183], v[64:67]
ds_read_b64_tr_b16 v[224:225], v15 offset:20480
ds_read_b64_tr_b16 v[226:227], v15 offset:20992
v_mfma_f32_16x16x32_bf16 v[80:83], v[240:243], v[184:187], v[80:83]
buffer_load_dwordx4 v[216:219], v39, s[32:35], s57 offen offset:1024 sc1
v_mfma_f32_16x16x32_bf16 v[68:71], v[244:247], v[180:183], v[68:71]
ds_read_b64_tr_b16 v[228:229], v16 offset:20480
ds_read_b64_tr_b16 v[230:231], v16 offset:20992
v_mfma_f32_16x16x32_bf16 v[84:87], v[244:247], v[184:187], v[84:87]
ds_read_b64_tr_b16 v[232:233], v17 offset:20480
ds_read_b64_tr_b16 v[234:235], v17 offset:20992
v_mfma_f32_16x16x32_bf16 v[72:75], v[248:251], v[180:183], v[72:75]
s_add_u32 s57, s57, 2048
s_and_b32 s57, s57, 0x7fff
v_mfma_f32_16x16x32_bf16 v[88:91], v[248:251], v[184:187], v[88:91]
s_waitcnt vmcnt(6) lgkmcnt(8)
v_mfma_f32_16x16x32_bf16 v[60:63], v[100:103], v[188:191], v[60:63]
buffer_load_dwordx4 v[156:159], v38, s[32:35], s57 offen sc1
v_mfma_f32_16x16x32_bf16 v[76:79], v[100:103], v[192:195], v[76:79]
ds_read_b64_tr_b16 v[236:237], v14 offset:24576
ds_read_b64_tr_b16 v[238:239], v14 offset:25088
v_mfma_f32_16x16x32_bf16 v[64:67], v[104:107], v[188:191], v[64:67]
ds_read_b64_tr_b16 v[240:241], v15 offset:24576
ds_read_b64_tr_b16 v[242:243], v15 offset:25088
v_mfma_f32_16x16x32_bf16 v[80:83], v[104:107], v[192:195], v[80:83]
buffer_load_dwordx4 v[160:163], v39, s[32:35], s57 offen sc1
v_mfma_f32_16x16x32_bf16 v[68:71], v[108:111], v[188:191], v[68:71]
ds_read_b64_tr_b16 v[244:245], v16 offset:24576
ds_read_b64_tr_b16 v[246:247], v16 offset:25088
v_mfma_f32_16x16x32_bf16 v[84:87], v[108:111], v[192:195], v[84:87]
ds_read_b64_tr_b16 v[248:249], v17 offset:24576
ds_read_b64_tr_b16 v[250:251], v17 offset:25088
v_mfma_f32_16x16x32_bf16 v[72:75], v[112:115], v[188:191], v[72:75]
v_mfma_f32_16x16x32_bf16 v[88:91], v[112:115], v[192:195], v[88:91]
s_waitcnt vmcnt(6) lgkmcnt(8)
v_mfma_f32_16x16x32_bf16 v[60:63], v[220:223], v[196:199], v[60:63]
buffer_load_dwordx4 v[164:167], v38, s[32:35], s57 offen offset:1024 sc1
v_mfma_f32_16x16x32_bf16 v[76:79], v[220:223], v[200:203], v[76:79]
ds_read_b64_tr_b16 v[100:101], v14 offset:28672
ds_read_b64_tr_b16 v[102:103], v14 offset:29184
v_mfma_f32_16x16x32_bf16 v[64:67], v[224:227], v[196:199], v[64:67]
ds_read_b64_tr_b16 v[104:105], v15 offset:28672
ds_read_b64_tr_b16 v[106:107], v15 offset:29184
v_mfma_f32_16x16x32_bf16 v[80:83], v[224:227], v[200:203], v[80:83]
buffer_load_dwordx4 v[168:171], v39, s[32:35], s57 offen offset:1024 sc1
v_mfma_f32_16x16x32_bf16 v[68:71], v[228:231], v[196:199], v[68:71]
ds_read_b64_tr_b16 v[108:109], v16 offset:28672
ds_read_b64_tr_b16 v[110:111], v16 offset:29184
v_mfma_f32_16x16x32_bf16 v[84:87], v[228:231], v[200:203], v[84:87]
ds_read_b64_tr_b16 v[112:113], v17 offset:28672
ds_read_b64_tr_b16 v[114:115], v17 offset:29184
v_mfma_f32_16x16x32_bf16 v[72:75], v[232:235], v[196:199], v[72:75]
s_add_u32 s57, s57, 2048
s_and_b32 s57, s57, 0x7fff
v_mfma_f32_16x16x32_bf16 v[88:91], v[232:235], v[200:203], v[88:91]
s_waitcnt vmcnt(6) lgkmcnt(8)
v_mfma_f32_16x16x32_bf16 v[60:63], v[236:239], v[204:207], v[60:63]
buffer_load_dwordx4 v[172:175], v38, s[32:35], s57 offen sc1
v_mfma_f32_16x16x32_bf16 v[76:79], v[236:239], v[208:211], v[76:79]
ds_read_b64_tr_b16 v[220:221], v14 offset:32768
ds_read_b64_tr_b16 v[222:223], v14 offset:33280
v_mfma_f32_16x16x32_bf16 v[64:67], v[240:243], v[204:207], v[64:67]
ds_read_b64_tr_b16 v[224:225], v15 offset:32768
ds_read_b64_tr_b16 v[226:227], v15 offset:33280
v_mfma_f32_16x16x32_bf16 v[80:83], v[240:243], v[208:211], v[80:83]
buffer_load_dwordx4 v[176:179], v39, s[32:35], s57 offen sc1
v_mfma_f32_16x16x32_bf16 v[68:71], v[244:247], v[204:207], v[68:71]
ds_read_b64_tr_b16 v[228:229], v16 offset:32768
ds_read_b64_tr_b16 v[230:231], v16 offset:33280
v_mfma_f32_16x16x32_bf16 v[84:87], v[244:247], v[208:211], v[84:87]
ds_read_b64_tr_b16 v[232:233], v17 offset:32768
ds_read_b64_tr_b16 v[234:235], v17 offset:33280
v_mfma_f32_16x16x32_bf16 v[72:75], v[248:251], v[204:207], v[72:75]
v_mfma_f32_16x16x32_bf16 v[88:91], v[248:251], v[208:211], v[88:91]
s_waitcnt vmcnt(6) lgkmcnt(8)
v_mfma_f32_16x16x32_bf16 v[60:63], v[100:103], v[212:215], v[60:63]
buffer_load_dwordx4 v[180:183], v38, s[32:35], s57 offen offset:1024 sc1
v_mfma_f32_16x16x32_bf16 v[76:79], v[100:103], v[216:219], v[76:79]
ds_read_b64_tr_b16 v[236:237], v14 offset:36864
ds_read_b64_tr_b16 v[238:239], v14 offset:37376
v_mfma_f32_16x16x32_bf16 v[64:67], v[104:107], v[212:215], v[64:67]
ds_read_b64_tr_b16 v[240:241], v15 offset:36864
ds_read_b64_tr_b16 v[242:243], v15 offset:37376
v_mfma_f32_16x16x32_bf16 v[80:83], v[104:107], v[216:219], v[80:83]
buffer_load_dwordx4 v[184:187], v39, s[32:35], s57 offen offset:1024 sc1
v_mfma_f32_16x16x32_bf16 v[68:71], v[108:111], v[212:215], v[68:71]
ds_read_b64_tr_b16 v[244:245], v16 offset:36864
ds_read_b64_tr_b16 v[246:247], v16 offset:37376
v_mfma_f32_16x16x32_bf16 v[84:87], v[108:111], v[216:219], v[84:87]
ds_read_b64_tr_b16 v[248:249], v17 offset:36864
ds_read_b64_tr_b16 v[250:251], v17 offset:37376
v_mfma_f32_16x16x32_bf16 v[72:75], v[112:115], v[212:215], v[72:75]
s_add_u32 s57, s57, 2048
s_and_b32 s57, s57, 0x7fff
v_mfma_f32_16x16x32_bf16 v[88:91], v[112:115], v[216:219], v[88:91]
s_waitcnt vmcnt(6) lgkmcnt(8)
v_mfma_f32_16x16x32_bf16 v[60:63], v[220:223], v[156:159], v[60:63]
buffer_load_dwordx4 v[188:191], v38, s[32:35], s57 offen sc1
v_mfma_f32_16x16x32_bf16 v[76:79], v[220:223], v[160:163], v[76:79]
ds_read_b64_tr_b16 v[100:101], v14 offset:40960
ds_read_b64_tr_b16 v[102:103], v14 offset:41472
v_mfma_f32_16x16x32_bf16 v[64:67], v[224:227], v[156:159], v[64:67]
ds_read_b64_tr_b16 v[104:105], v15 offset:40960
ds_read_b64_tr_b16 v[106:107], v15 offset:41472
v_mfma_f32_16x16x32_bf16 v[80:83], v[224:227], v[160:163], v[80:83]
buffer_load_dwordx4 v[192:195], v39, s[32:35], s57 offen sc1
v_mfma_f32_16x16x32_bf16 v[68:71], v[228:231], v[156:159], v[68:71]
ds_read_b64_tr_b16 v[108:109], v16 offset:40960
ds_read_b64_tr_b16 v[110:111], v16 offset:41472
v_mfma_f32_16x16x32_bf16 v[84:87], v[228:231], v[160:163], v[84:87]
ds_read_b64_tr_b16 v[112:113], v17 offset:40960
ds_read_b64_tr_b16 v[114:115], v17 offset:41472
v_mfma_f32_16x16x32_bf16 v[72:75], v[232:235], v[156:159], v[72:75]
v_mfma_f32_16x16x32_bf16 v[88:91], v[232:235], v[160:163], v[88:91]
s_waitcnt vmcnt(6) lgkmcnt(8)
v_mfma_f32_16x16x32_bf16 v[60:63], v[236:239], v[164:167], v[60:63]
buffer_load_dwordx4 v[196:199], v38, s[32:35], s57 offen offset:1024 sc1
v_mfma_f32_16x16x32_bf16 v[76:79], v[236:239], v[168:171], v[76:79]
ds_read_b64_tr_b16 v[220:221], v14 offset:45056
ds_read_b64_tr_b16 v[222:223], v14 offset:45568
v_mfma_f32_16x16x32_bf16 v[64:67], v[240:243], v[164:167], v[64:67]
ds_read_b64_tr_b16 v[224:225], v15 offset:45056
ds_read_b64_tr_b16 v[226:227], v15 offset:45568
v_mfma_f32_16x16x32_bf16 v[80:83], v[240:243], v[168:171], v[80:83]
buffer_load_dwordx4 v[200:203], v39, s[32:35], s57 offen offset:1024 sc1
v_mfma_f32_16x16x32_bf16 v[68:71], v[244:247], v[164:167], v[68:71]
ds_read_b64_tr_b16 v[228:229], v16 offset:45056
ds_read_b64_tr_b16 v[230:231], v16 offset:45568
v_mfma_f32_16x16x32_bf16 v[84:87], v[244:247], v[168:171], v[84:87]
ds_read_b64_tr_b16 v[232:233], v17 offset:45056
ds_read_b64_tr_b16 v[234:235], v17 offset:45568
v_mfma_f32_16x16x32_bf16 v[72:75], v[248:251], v[164:167], v[72:75]
s_add_u32 s57, s57, 2048
s_and_b32 s57, s57, 0x7fff
v_mfma_f32_16x16x32_bf16 v[88:91], v[248:251], v[168:171], v[88:91]
s_waitcnt vmcnt(6) lgkmcnt(8)
v_mfma_f32_16x16x32_bf16 v[60:63], v[100:103], v[172:175], v[60:63]
buffer_load_dwordx4 v[204:207], v38, s[32:35], s57 offen sc1
v_mfma_f32_16x16x32_bf16 v[76:79], v[100:103], v[176:179], v[76:79]
ds_read_b64_tr_b16 v[236:237], v14 offset:49152
ds_read_b64_tr_b16 v[238:239], v14 offset:49664
v_mfma_f32_16x16x32_bf16 v[64:67], v[104:107], v[172:175], v[64:67]
ds_read_b64_tr_b16 v[240:241], v15 offset:49152
ds_read_b64_tr_b16 v[242:243], v15 offset:49664
v_mfma_f32_16x16x32_bf16 v[80:83], v[104:107], v[176:179], v[80:83]
buffer_load_dwordx4 v[208:211], v39, s[32:35], s57 offen sc1
v_mfma_f32_16x16x32_bf16 v[68:71], v[108:111], v[172:175], v[68:71]
ds_read_b64_tr_b16 v[244:245], v16 offset:49152
ds_read_b64_tr_b16 v[246:247], v16 offset:49664
v_mfma_f32_16x16x32_bf16 v[84:87], v[108:111], v[176:179], v[84:87]
ds_read_b64_tr_b16 v[248:249], v17 offset:49152
ds_read_b64_tr_b16 v[250:251], v17 offset:49664
v_mfma_f32_16x16x32_bf16 v[72:75], v[112:115], v[172:175], v[72:75]
v_mfma_f32_16x16x32_bf16 v[88:91], v[112:115], v[176:179], v[88:91]
s_waitcnt vmcnt(6) lgkmcnt(8)
v_mfma_f32_16x16x32_bf16 v[60:63], v[220:223], v[180:183], v[60:63]
buffer_load_dwordx4 v[212:215], v38, s[32:35], s57 offen offset:1024 sc1
v_mfma_f32_16x16x32_bf16 v[76:79], v[220:223], v[184:187], v[76:79]
ds_read_b64_tr_b16 v[100:101], v14 offset:53248
ds_read_b64_tr_b16 v[102:103], v14 offset:53760
v_mfma_f32_16x16x32_bf16 v[64:67], v[224:227], v[180:183], v[64:67]
ds_read_b64_tr_b16 v[104:105], v15 offset:53248
ds_read_b64_tr_b16 v[106:107], v15 offset:53760
v_mfma_f32_16x16x32_bf16 v[80:83], v[224:227], v[184:187], v[80:83]
buffer_load_dwordx4 v[216:219], v39, s[32:35], s57 offen offset:1024 sc1
v_mfma_f32_16x16x32_bf16 v[68:71], v[228:231], v[180:183], v[68:71]
ds_read_b64_tr_b16 v[108:109], v16 offset:53248
ds_read_b64_tr_b16 v[110:111], v16 offset:53760
v_mfma_f32_16x16x32_bf16 v[84:87], v[228:231], v[184:187], v[84:87]
ds_read_b64_tr_b16 v[112:113], v17 offset:53248
ds_read_b64_tr_b16 v[114:115], v17 offset:53760
v_mfma_f32_16x16x32_bf16 v[72:75], v[232:235], v[180:183], v[72:75]
v_mfma_f32_16x16x32_bf16 v[88:91], v[232:235], v[184:187], v[88:91]
s_waitcnt vmcnt(6) lgkmcnt(8)
v_mfma_f32_16x16x32_bf16 v[60:63], v[236:239], v[188:191], v[60:63]
v_mfma_f32_16x16x32_bf16 v[76:79], v[236:239], v[192:195], v[76:79]
ds_read_b64_tr_b16 v[220:221], v14 offset:57344
ds_read_b64_tr_b16 v[222:223], v14 offset:57856
v_mfma_f32_16x16x32_bf16 v[64:67], v[240:243], v[188:191], v[64:67]
ds_read_b64_tr_b16 v[224:225], v15 offset:57344
ds_read_b64_tr_b16 v[226:227], v15 offset:57856
v_mfma_f32_16x16x32_bf16 v[80:83], v[240:243], v[192:195], v[80:83]
v_mfma_f32_16x16x32_bf16 v[68:71], v[244:247], v[188:191], v[68:71]
ds_read_b64_tr_b16 v[228:229], v16 offset:57344
ds_read_b64_tr_b16 v[230:231], v16 offset:57856
v_mfma_f32_16x16x32_bf16 v[84:87], v[244:247], v[192:195], v[84:87]
ds_read_b64_tr_b16 v[232:233], v17 offset:57344
ds_read_b64_tr_b16 v[234:235], v17 offset:57856
v_mfma_f32_16x16x32_bf16 v[72:75], v[248:251], v[188:191], v[72:75]
v_mfma_f32_16x16x32_bf16 v[88:91], v[248:251], v[192:195], v[88:91]
s_waitcnt vmcnt(4) lgkmcnt(8)
v_mfma_f32_16x16x32_bf16 v[60:63], v[100:103], v[196:199], v[60:63]
v_mfma_f32_16x16x32_bf16 v[76:79], v[100:103], v[200:203], v[76:79]
ds_read_b64_tr_b16 v[236:237], v14 offset:61440
ds_read_b64_tr_b16 v[238:239], v14 offset:61952
v_mfma_f32_16x16x32_bf16 v[64:67], v[104:107], v[196:199], v[64:67]
ds_read_b64_tr_b16 v[240:241], v15 offset:61440
ds_read_b64_tr_b16 v[242:243], v15 offset:61952
v_mfma_f32_16x16x32_bf16 v[80:83], v[104:107], v[200:203], v[80:83]
v_mfma_f32_16x16x32_bf16 v[68:71], v[108:111], v[196:199], v[68:71]
ds_read_b64_tr_b16 v[244:245], v16 offset:61440
ds_read_b64_tr_b16 v[246:247], v16 offset:61952
v_mfma_f32_16x16x32_bf16 v[84:87], v[108:111], v[200:203], v[84:87]
ds_read_b64_tr_b16 v[248:249], v17 offset:61440
ds_read_b64_tr_b16 v[250:251], v17 offset:61952
v_mfma_f32_16x16x32_bf16 v[72:75], v[112:115], v[196:199], v[72:75]
v_mfma_f32_16x16x32_bf16 v[88:91], v[112:115], v[200:203], v[88:91]
s_waitcnt vmcnt(2) lgkmcnt(8)
v_mfma_f32_16x16x32_bf16 v[60:63], v[220:223], v[204:207], v[60:63]
v_mfma_f32_16x16x32_bf16 v[76:79], v[220:223], v[208:211], v[76:79]
v_mfma_f32_16x16x32_bf16 v[64:67], v[224:227], v[204:207], v[64:67]
v_mfma_f32_16x16x32_bf16 v[80:83], v[224:227], v[208:211], v[80:83]
v_mfma_f32_16x16x32_bf16 v[68:71], v[228:231], v[204:207], v[68:71]
v_mfma_f32_16x16x32_bf16 v[84:87], v[228:231], v[208:211], v[84:87]
v_mfma_f32_16x16x32_bf16 v[72:75], v[232:235], v[204:207], v[72:75]
v_mfma_f32_16x16x32_bf16 v[88:91], v[232:235], v[208:211], v[88:91]
s_waitcnt vmcnt(0) lgkmcnt(0)
v_mfma_f32_16x16x32_bf16 v[60:63], v[236:239], v[212:215], v[60:63]
v_mfma_f32_16x16x32_bf16 v[64:67], v[240:243], v[212:215], v[64:67]
v_mfma_f32_16x16x32_bf16 v[68:71], v[244:247], v[212:215], v[68:71]
v_mfma_f32_16x16x32_bf16 v[72:75], v[248:251], v[212:215], v[72:75]
v_mfma_f32_16x16x32_bf16 v[76:79], v[236:239], v[216:219], v[76:79]
v_mfma_f32_16x16x32_bf16 v[80:83], v[240:243], v[216:219], v[80:83]
v_mfma_f32_16x16x32_bf16 v[84:87], v[244:247], v[216:219], v[84:87]
v_mfma_f32_16x16x32_bf16 v[88:91], v[248:251], v[216:219], v[88:91]
s_nop 0
v_cvt_pk_bf16_f32 v20, v60, v61
v_cvt_pk_bf16_f32 v21, v62, v63
v_cvt_pk_bf16_f32 v22, v64, v65
v_cvt_pk_bf16_f32 v23, v66, v67
ds_write_b64 v42, v[20:21] offset:0
ds_write_b64 v43, v[22:23] offset:0
v_cvt_pk_bf16_f32 v24, v68, v69
v_cvt_pk_bf16_f32 v25, v70, v71
v_cvt_pk_bf16_f32 v26, v72, v73
v_cvt_pk_bf16_f32 v27, v74, v75
ds_write_b64 v44, v[24:25] offset:0
ds_write_b64 v45, v[26:27] offset:0
v_cvt_pk_bf16_f32 v28, v76, v77
v_cvt_pk_bf16_f32 v29, v78, v79
v_cvt_pk_bf16_f32 v30, v80, v81
v_cvt_pk_bf16_f32 v31, v82, v83
ds_write_b64 v42, v[28:29] offset:2048
ds_write_b64 v43, v[30:31] offset:2048
v_cvt_pk_bf16_f32 v32, v84, v85
v_cvt_pk_bf16_f32 v33, v86, v87
v_cvt_pk_bf16_f32 v34, v88, v89
v_cvt_pk_bf16_f32 v35, v90, v91
ds_write_b64 v44, v[32:33] offset:2048
ds_write_b64 v45, v[34:35] offset:2048
ds_read_b128 v[20:23], v46 offset:0
ds_read_b128 v[24:27], v46 offset:1024
ds_read_b128 v[28:31], v46 offset:2048
ds_read_b128 v[32:35], v46 offset:3072
s_waitcnt lgkmcnt(3)
buffer_store_dwordx4 v[20:23], v40, s[24:27], s48 offen sc1
s_waitcnt lgkmcnt(2)
buffer_store_dwordx4 v[24:27], v41, s[24:27], s48 offen sc1
s_waitcnt lgkmcnt(1)
buffer_store_dwordx4 v[28:31], v40, s[24:27], s49 offen sc1
s_waitcnt lgkmcnt(0)
buffer_store_dwordx4 v[32:35], v41, s[24:27], s49 offen sc1
s_endpgm
L_code_end:
again_22:
s_mov_b32 s63, 0
retry_24:
buffer_load_dwordx4 v[80:83], v37, s[32:35], 0 offen offset:0 sc1
buffer_load_dwordx4 v[84:87], v37, s[32:35], 0 offen offset:1024 sc1
buffer_load_dwordx4 v[88:91], v37, s[32:35], 0 offen offset:2048 sc1
buffer_load_dwordx4 v[92:95], v37, s[32:35], 0 offen offset:3072 sc1
s_waitcnt vmcnt(0)
v_add_f32 v80, v80, v88
v_add_f32 v81, v81, v89
v_add_f32 v82, v82, v90
v_add_f32 v83, v83, v91
v_add_f32 v84, v84, v92
v_add_f32 v85, v85, v93
v_add_f32 v86, v86, v94
v_add_f32 v87, v87, v95
v_add_f32 v80, v80, v84
v_add_f32 v81, v81, v85
v_add_f32 v82, v82, v86
v_add_f32 v83, v83, v87
s_nop 1
v_permlane32_swap_b32 v80, v81
v_permlane32_swap_b32 v82, v83
v_add_f32 v80, v80, v81
v_add_f32 v82, v82, v83
s_nop 1
v_permlane16_swap_b32 v80, v82
s_nop 0
v_add_f32 v80, v80, v82
v_cmp_u_f32 vcc, v80, v80
s_cbranch_vccz summed_23
s_add_u32 s63, s63, 1
s_cmp_lt_u32 s63, 0x10000
s_cbranch_scc1 retry_24
s_branch summed_23
again_25:
s_mov_b32 s63, 0
retry_27:
buffer_load_dwordx4 v[64:67], v38, s[32:35], 0 offen offset:0 sc1
buffer_load_dwordx4 v[68:71], v38, s[32:35], 0 offen offset:1024 sc1
buffer_load_dwordx4 v[72:75], v38, s[32:35], 0 offen offset:2048 sc1
buffer_load_dwordx4 v[76:79], v38, s[32:35], 0 offen offset:3072 sc1
s_waitcnt vmcnt(0)
v_add_f32 v64, v64, v72
v_add_f32 v65, v65, v73
v_add_f32 v66, v66, v74
v_add_f32 v67, v67, v75
v_add_f32 v68, v68, v76
v_add_f32 v69, v69, v77
v_add_f32 v70, v70, v78
v_add_f32 v71, v71, v79
v_add_f32 v64, v64, v68
v_add_f32 v65, v65, v69
v_add_f32 v66, v66, v70
v_add_f32 v67, v67, v71
s_nop 1
v_permlane32_swap_b32 v64, v65
v_permlane32_swap_b32 v66, v67
v_add_f32 v64, v64, v65
v_add_f32 v66, v66, v67
s_nop 1
v_permlane16_swap_b32 v64, v66
s_nop 0
v_add_f32 v64, v64, v66
v_cmp_u_f32 vcc, v64, v64
s_cbranch_vccz summed_26
s_add_u32 s63, s63, 1
s_cmp_lt_u32 s63, 0x10000
s_cbranch_scc1 retry_27
s_branch summed_26
again_33:
s_mov_b32 s63, 0
retry_35:
buffer_load_dwordx4 v[80:83], v37, s[32:35], 0 offen offset:0 sc1
buffer_load_dwordx4 v[84:87], v37, s[32:35], 0 offen offset:1024 sc1
buffer_load_dwordx4 v[88:91], v37, s[32:35], 0 offen offset:2048 sc1
buffer_load_dwordx4 v[92:95], v37, s[32:35], 0 offen offset:3072 sc1
s_waitcnt vmcnt(0)
v_add_f32 v80, v80, v88
v_add_f32 v81, v81, v89
v_add_f32 v82, v82, v90
v_add_f32 v83, v83, v91
v_add_f32 v84, v84, v92
v_add_f32 v85, v85, v93
v_add_f32 v86, v86, v94
v_add_f32 v87, v87, v95
v_add_f32 v80, v80, v84
v_add_f32 v81, v81, v85
v_add_f32 v82, v82, v86
v_add_f32 v83, v83, v87
s_nop 1
v_permlane32_swap_b32 v80, v81
v_permlane32_swap_b32 v82, v83
v_add_f32 v80, v80, v81
v_add_f32 v82, v82, v83
s_nop 1
v_permlane16_swap_b32 v80, v82
s_nop 0
v_add_f32 v80, v80, v82
v_cmp_u_f32 vcc, v80, v80
s_cbranch_vccz summed_34
s_add_u32 s63, s63, 1
s_cmp_lt_u32 s63, 0x10000
s_cbranch_scc1 retry_35
s_branch summed_34
again_36:
s_mov_b32 s63, 0
retry_38:
buffer_load_dwordx4 v[64:67], v38, s[32:35], 0 offen offset:0 sc1
buffer_load_dwordx4 v[68:71], v38, s[32:35], 0 offen offset:1024 sc1
buffer_load_dwordx4 v[72:75], v38, s[32:35], 0 offen offset:2048 sc1
buffer_load_dwordx4 v[76:79], v38, s[32:35], 0 offen offset:3072 sc1
s_waitcnt vmcnt(0)
v_add_f32 v64, v64, v72
v_add_f32 v65, v65, v73
v_add_f32 v66, v66, v74
v_add_f32 v67, v67, v75
v_add_f32 v68, v68, v76
v_add_f32 v69, v69, v77
v_add_f32 v70, v70, v78
v_add_f32 v71, v71, v79
v_add_f32 v64, v64, v68
v_add_f32 v65, v65, v69
v_add_f32 v66, v66, v70
v_add_f32 v67, v67, v71
s_nop 1
v_permlane32_swap_b32 v64, v65
v_permlane32_swap_b32 v66, v67
v_add_f32 v64, v64, v65
v_add_f32 v66, v66, v67
s_nop 1
v_permlane16_swap_b32 v64, v66
s_nop 0
v_add_f32 v64, v64, v66
v_cmp_u_f32 vcc, v64, v64
s_cbranch_vccz summed_37
s_add_u32 s63, s63, 1
s_cmp_lt_u32 s63, 0x10000
s_cbranch_scc1 retry_38
s_branch summed_37
again_42:
s_mov_b32 s63, 0
retry_44:
buffer_load_dwordx4 v[80:83], v37, s[32:35], 0 offen offset:0 sc1
buffer_load_dwordx4 v[84:87], v37, s[32:35], 0 offen offset:1024 sc1
buffer_load_dwordx4 v[88:91], v37, s[32:35], 0 offen offset:2048 sc1
buffer_load_dwordx4 v[92:95], v37, s[32:35], 0 offen offset:3072 sc1
s_waitcnt vmcnt(0)
v_add_f32 v80, v80, v88
v_add_f32 v81, v81, v89
v_add_f32 v82, v82, v90
v_add_f32 v83, v83, v91
v_add_f32 v84, v84, v92
v_add_f32 v85, v85, v93
v_add_f32 v86, v86, v94
v_add_f32 v87, v87, v95
v_add_f32 v80, v80, v84
v_add_f32 v81, v81, v85
v_add_f32 v82, v82, v86
v_add_f32 v83, v83, v87
s_nop 1
v_permlane32_swap_b32 v80, v81
v_permlane32_swap_b32 v82, v83
v_add_f32 v80, v80, v81
v_add_f32 v82, v82, v83
s_nop 1
v_permlane16_swap_b32 v80, v82
s_nop 0
v_add_f32 v80, v80, v82
v_cmp_u_f32 vcc, v80, v80
s_cbranch_vccz summed_43
s_add_u32 s63, s63, 1
s_cmp_lt_u32 s63, 0x10000
s_cbranch_scc1 retry_44
s_branch summed_43
again_52:
s_mov_b32 s63, 0
retry_54:
buffer_load_dwordx4 v[80:83], v37, s[32:35], 0 offen offset:0 sc1
buffer_load_dwordx4 v[84:87], v37, s[32:35], 0 offen offset:1024 sc1
buffer_load_dwordx4 v[88:91], v37, s[32:35], 0 offen offset:2048 sc1
buffer_load_dwordx4 v[92:95], v37, s[32:35], 0 offen offset:3072 sc1
s_waitcnt vmcnt(0)
v_add_f32 v80, v80, v88
v_add_f32 v81, v81, v89
v_add_f32 v82, v82, v90
v_add_f32 v83, v83, v91
v_add_f32 v84, v84, v92
v_add_f32 v85, v85, v93
v_add_f32 v86, v86, v94
v_add_f32 v87, v87, v95
v_add_f32 v80, v80, v84
v_add_f32 v81, v81, v85
v_add_f32 v82, v82, v86
v_add_f32 v83, v83, v87
s_nop 1
v_permlane32_swap_b32 v80, v81
v_permlane32_swap_b32 v82, v83
v_add_f32 v80, v80, v81
v_add_f32 v82, v82, v83
s_nop 1
v_permlane16_swap_b32 v80, v82
s_nop 0
v_add_f32 v80, v80, v82
v_cmp_u_f32 vcc, v80, v80
s_cbranch_vccz summed_53
s_add_u32 s63, s63, 1
s_cmp_lt_u32 s63, 0x10000
s_cbranch_scc1 retry_54
s_branch summed_53
slow_73:
.p2align 3
v_pk_mul_f32 v[220:221], v[220:221], v[160:161] op_sel:[0,0] op_sel_hi:[1,0]
v_pk_mul_f32 v[222:223], v[222:223], v[160:161] op_sel:[0,0] op_sel_hi:[1,0]
v_pk_mul_f32 v[224:225], v[224:225], v[160:161] op_sel:[0,0] op_sel_hi:[1,0]
v_pk_mul_f32 v[226:227], v[226:227], v[160:161] op_sel:[0,0] op_sel_hi:[1,0]
v_cvt_pk_bf16_f32 v220, v220, v221
v_cvt_pk_bf16_f32 v221, v222, v223
v_cvt_pk_bf16_f32 v222, v224, v225
v_cvt_pk_bf16_f32 v223, v226, v227
buffer_store_dwordx4 v[220:223], v18, s[32:35], s80 offen sc1
v_pk_mul_f32 v[228:229], v[228:229], v[168:169] op_sel:[0,0] op_sel_hi:[1,0]
v_pk_mul_f32 v[230:231], v[230:231], v[168:169] op_sel:[0,0] op_sel_hi:[1,0]
v_pk_mul_f32 v[232:233], v[232:233], v[168:169] op_sel:[0,0] op_sel_hi:[1,0]
v_pk_mul_f32 v[234:235], v[234:235], v[168:169] op_sel:[0,0] op_sel_hi:[1,0]
v_cvt_pk_bf16_f32 v228, v228, v229
v_cvt_pk_bf16_f32 v229, v230, v231
v_cvt_pk_bf16_f32 v230, v232, v233
v_cvt_pk_bf16_f32 v231, v234, v235
buffer_store_dwordx4 v[228:231], v18, s[32:35], s81 offen sc1
v_pk_mul_f32 v[236:237], v[236:237], v[176:177] op_sel:[0,0] op_sel_hi:[1,0]
v_pk_mul_f32 v[238:239], v[238:239], v[176:177] op_sel:[0,0] op_sel_hi:[1,0]
v_pk_mul_f32 v[240:241], v[240:241], v[176:177] op_sel:[0,0] op_sel_hi:[1,0]
v_pk_mul_f32 v[242:243], v[242:243], v[176:177] op_sel:[0,0] op_sel_hi:[1,0]
v_cvt_pk_bf16_f32 v236, v236, v237
v_cvt_pk_bf16_f32 v237, v238, v239
v_cvt_pk_bf16_f32 v238, v240, v241
v_cvt_pk_bf16_f32 v239, v242, v243
buffer_store_dwordx4 v[236:239], v18, s[32:35], s82 offen sc1
v_pk_mul_f32 v[244:245], v[244:245], v[184:185] op_sel:[0,0] op_sel_hi:[1,0]
v_pk_mul_f32 v[246:247], v[246:247], v[184:185] op_sel:[0,0] op_sel_hi:[1,0]
v_pk_mul_f32 v[248:249], v[248:249], v[184:185] op_sel:[0,0] op_sel_hi:[1,0]
v_pk_mul_f32 v[250:251], v[250:251], v[184:185] op_sel:[0,0] op_sel_hi:[1,0]
v_cvt_pk_bf16_f32 v244, v244, v245
v_cvt_pk_bf16_f32 v245, v246, v247
v_cvt_pk_bf16_f32 v246, v248, v249
v_cvt_pk_bf16_f32 v247, v250, v251
buffer_store_dwordx4 v[244:247], v18, s[32:35], s83 offen sc1
s_branch back_74
slow_75:
buffer_store_dword v5, v4, s[32:35], s84 offen sc1
s_branch back_76
slow_79:
s_nop 0
v_cvt_pk_bf16_f32 v20, v60, v61
v_cvt_pk_bf16_f32 v21, v62, v63
v_cvt_pk_bf16_f32 v22, v64, v65
v_cvt_pk_bf16_f32 v23, v66, v67
buffer_store_dwordx4 v[20:23], v18, s[32:35], s85 offen offset:0 sc1
v_cvt_pk_bf16_f32 v24, v68, v69
v_cvt_pk_bf16_f32 v25, v70, v71
v_cvt_pk_bf16_f32 v26, v72, v73
v_cvt_pk_bf16_f32 v27, v74, v75
buffer_store_dwordx4 v[24:27], v18, s[32:35], s85 offen offset:1024 sc1
v_cvt_pk_bf16_f32 v28, v76, v77
v_cvt_pk_bf16_f32 v29, v78, v79
v_cvt_pk_bf16_f32 v30, v80, v81
v_cvt_pk_bf16_f32 v31, v82, v83
buffer_store_dwordx4 v[28:31], v18, s[32:35], s86 offen offset:0 sc1
v_cvt_pk_bf16_f32 v32, v84, v85
v_cvt_pk_bf16_f32 v33, v86, v87
v_cvt_pk_bf16_f32 v34, v88, v89
v_cvt_pk_bf16_f32 v35, v90, v91
buffer_store_dwordx4 v[32:35], v18, s[32:35], s86 offen offset:1024 sc1
s_barrier
v_dot2c_f32_bf16 v6, v20, v48
v_dot2c_f32_bf16 v8, v20, v20
v_dot2c_f32_bf16 v7, v28, v48
v_dot2c_f32_bf16 v9, v28, v28
v_dot2c_f32_bf16 v6, v21, v48
v_dot2c_f32_bf16 v8, v21, v21
v_dot2c_f32_bf16 v7, v29, v48
v_dot2c_f32_bf16 v9, v29, v29
v_dot2c_f32_bf16 v6, v22, v48
v_dot2c_f32_bf16 v8, v22, v22
v_dot2c_f32_bf16 v7, v30, v48
v_dot2c_f32_bf16 v9, v30, v30
v_dot2c_f32_bf16 v6, v23, v48
v_dot2c_f32_bf16 v8, v23, v23
v_dot2c_f32_bf16 v7, v31, v48
v_dot2c_f32_bf16 v9, v31, v31
v_dot2c_f32_bf16 v6, v24, v48
v_dot2c_f32_bf16 v8, v24, v24
v_dot2c_f32_bf16 v7, v32, v48
v_dot2c_f32_bf16 v9, v32, v32
v_dot2c_f32_bf16 v6, v25, v48
v_dot2c_f32_bf16 v8, v25, v25
v_dot2c_f32_bf16 v7, v33, v48
v_dot2c_f32_bf16 v9, v33, v33
v_dot2c_f32_bf16 v6, v26, v48
v_dot2c_f32_bf16 v8, v26, v26
v_dot2c_f32_bf16 v7, v34, v48
v_dot2c_f32_bf16 v9, v34, v34
v_dot2c_f32_bf16 v6, v27, v48
v_dot2c_f32_bf16 v8, v27, v27
v_dot2c_f32_bf16 v7, v35, v48
v_dot2c_f32_bf16 v9, v35, v35
s_mov_b64 exec, 1
s_waitcnt vmcnt(0)
buffer_store_dword v5, v4, s[32:35], s88 offen sc1
s_mov_b64 exec, -1
s_nop 1
v_permlane32_swap_b32 v6, v7
v_permlane32_swap_b32 v8, v9
v_add_f32 v6, v6, v7
v_add_f32 v8, v8, v9
s_nop 1
v_permlane16_swap_b32 v6, v8
s_nop 0
v_add_f32 v6, v6, v8
buffer_store_dword v6, v1, s[32:35], s87 offen sc1
s_branch back_80
slow_95:
.p2align 3
v_pk_mul_f32 v[156:157], v[156:157], v[100:101] op_sel:[0,0] op_sel_hi:[1,0]
v_pk_mul_f32 v[158:159], v[158:159], v[100:101] op_sel:[0,0] op_sel_hi:[1,0]
v_pk_mul_f32 v[160:161], v[160:161], v[100:101] op_sel:[0,0] op_sel_hi:[1,0]
v_pk_mul_f32 v[162:163], v[162:163], v[100:101] op_sel:[0,0] op_sel_hi:[1,0]
v_cvt_pk_bf16_f32 v156, v156, v157
v_mfma_f32_16x16x32_bf16 v[172:175], v[188:191], v[76:79], 0
v_cvt_pk_bf16_f32 v157, v158, v159
v_mfma_f32_16x16x32_bf16 v[176:179], v[192:195], v[76:79], 0
v_cvt_pk_bf16_f32 v158, v160, v161
v_mfma_f32_16x16x32_bf16 v[172:175], v[196:199], v[236:239], v[172:175]
v_cvt_pk_bf16_f32 v159, v162, v163
v_mfma_f32_16x16x32_bf16 v[176:179], v[200:203], v[236:239], v[176:179]
buffer_store_dwordx4 v[156:159], v18, s[32:35], s80 offen sc1
v_pk_mul_f32 v[164:165], v[164:165], v[100:101] op_sel:[0,1] op_sel_hi:[1,1]
v_pk_mul_f32 v[166:167], v[166:167], v[100:101] op_sel:[0,1] op_sel_hi:[1,1]
v_pk_mul_f32 v[168:169], v[168:169], v[100:101] op_sel:[0,1] op_sel_hi:[1,1]
v_pk_mul_f32 v[170:171], v[170:171], v[100:101] op_sel:[0,1] op_sel_hi:[1,1]
v_cvt_pk_bf16_f32 v164, v164, v165
v_mfma_f32_16x16x32_bf16 v[180:183], v[188:191], v[84:87], 0
v_cvt_pk_bf16_f32 v165, v166, v167
v_mfma_f32_16x16x32_bf16 v[184:187], v[192:195], v[84:87], 0
v_cvt_pk_bf16_f32 v166, v168, v169
v_mfma_f32_16x16x32_bf16 v[180:183], v[196:199], v[244:247], v[180:183]
v_cvt_pk_bf16_f32 v167, v170, v171
v_mfma_f32_16x16x32_bf16 v[184:187], v[200:203], v[244:247], v[184:187]
buffer_store_dwordx4 v[164:167], v18, s[32:35], s81 offen sc1
v_pk_mul_f32 v[172:173], v[172:173], v[102:103] op_sel:[0,0] op_sel_hi:[1,0]
v_pk_mul_f32 v[174:175], v[174:175], v[102:103] op_sel:[0,0] op_sel_hi:[1,0]
v_pk_mul_f32 v[176:177], v[176:177], v[102:103] op_sel:[0,0] op_sel_hi:[1,0]
v_pk_mul_f32 v[178:179], v[178:179], v[102:103] op_sel:[0,0] op_sel_hi:[1,0]
v_cvt_pk_bf16_f32 v172, v172, v173
v_cvt_pk_bf16_f32 v173, v174, v175
v_cvt_pk_bf16_f32 v174, v176, v177
v_cvt_pk_bf16_f32 v175, v178, v179
buffer_store_dwordx4 v[172:175], v18, s[32:35], s82 offen sc1
v_pk_mul_f32 v[180:181], v[180:181], v[102:103] op_sel:[0,1] op_sel_hi:[1,1]
v_pk_mul_f32 v[182:183], v[182:183], v[102:103] op_sel:[0,1] op_sel_hi:[1,1]
v_pk_mul_f32 v[184:185], v[184:185], v[102:103] op_sel:[0,1] op_sel_hi:[1,1]
v_pk_mul_f32 v[186:187], v[186:187], v[102:103] op_sel:[0,1] op_sel_hi:[1,1]
v_cvt_pk_bf16_f32 v180, v180, v181
v_cvt_pk_bf16_f32 v181, v182, v183
v_cvt_pk_bf16_f32 v182, v184, v185
v_cvt_pk_bf16_f32 v183, v186, v187
buffer_store_dwordx4 v[180:183], v18, s[32:35], s83 offen sc1
s_branch back_96
slow_97:
buffer_store_dword v5, v4, s[32:35], s84 offen sc1
s_branch back_98
slow_101:
s_nop 0
v_cvt_pk_bf16_f32 v20, v60, v61
v_cvt_pk_bf16_f32 v21, v62, v63
v_cvt_pk_bf16_f32 v22, v64, v65
v_cvt_pk_bf16_f32 v23, v66, v67
buffer_store_dwordx4 v[20:23], v18, s[32:35], s85 offen offset:0 sc1
v_cvt_pk_bf16_f32 v24, v68, v69
v_cvt_pk_bf16_f32 v25, v70, v71
v_cvt_pk_bf16_f32 v26, v72, v73
v_cvt_pk_bf16_f32 v27, v74, v75
buffer_store_dwordx4 v[24:27], v18, s[32:35], s85 offen offset:1024 sc1
v_cvt_pk_bf16_f32 v28, v76, v77
v_cvt_pk_bf16_f32 v29, v78, v79
v_cvt_pk_bf16_f32 v30, v80, v81
v_cvt_pk_bf16_f32 v31, v82, v83
buffer_store_dwordx4 v[28:31], v18, s[32:35], s86 offen offset:0 sc1
v_cvt_pk_bf16_f32 v32, v84, v85
v_cvt_pk_bf16_f32 v33, v86, v87
v_cvt_pk_bf16_f32 v34, v88, v89
v_cvt_pk_bf16_f32 v35, v90, v91
buffer_store_dwordx4 v[32:35], v18, s[32:35], s86 offen offset:1024 sc1
s_barrier
v_dot2c_f32_bf16 v6, v20, v48
v_dot2c_f32_bf16 v8, v20, v20
v_dot2c_f32_bf16 v7, v28, v48
v_dot2c_f32_bf16 v9, v28, v28
v_dot2c_f32_bf16 v6, v21, v48
v_dot2c_f32_bf16 v8, v21, v21
v_dot2c_f32_bf16 v7, v29, v48
v_dot2c_f32_bf16 v9, v29, v29
v_dot2c_f32_bf16 v6, v22, v48
v_dot2c_f32_bf16 v8, v22, v22
v_dot2c_f32_bf16 v7, v30, v48
v_dot2c_f32_bf16 v9, v30, v30
v_dot2c_f32_bf16 v6, v23, v48
v_dot2c_f32_bf16 v8, v23, v23
v_dot2c_f32_bf16 v7, v31, v48
v_dot2c_f32_bf16 v9, v31, v31
v_dot2c_f32_bf16 v6, v24, v48
v_dot2c_f32_bf16 v8, v24, v24
v_dot2c_f32_bf16 v7, v32, v48
v_dot2c_f32_bf16 v9, v32, v32
v_dot2c_f32_bf16 v6, v25, v48
v_dot2c_f32_bf16 v8, v25, v25
v_dot2c_f32_bf16 v7, v33, v48
v_dot2c_f32_bf16 v9, v33, v33
v_dot2c_f32_bf16 v6, v26, v48
v_dot2c_f32_bf16 v8, v26, v26
v_dot2c_f32_bf16 v7, v34, v48
v_dot2c_f32_bf16 v9, v34, v34
v_dot2c_f32_bf16 v6, v27, v48
v_dot2c_f32_bf16 v8, v27, v27
v_dot2c_f32_bf16 v7, v35, v48
v_dot2c_f32_bf16 v9, v35, v35
s_mov_b64 exec, 1
s_waitcnt vmcnt(0)
buffer_store_dword v5, v4, s[32:35], s88 offen sc1
s_mov_b64 exec, -1
s_nop 1
v_permlane32_swap_b32 v6, v7
v_permlane32_swap_b32 v8, v9
v_add_f32 v6, v6, v7
v_add_f32 v8, v8, v9
s_nop 1
v_permlane16_swap_b32 v6, v8
s_nop 0
v_add_f32 v6, v6, v8
buffer_store_dword v6, v1, s[32:35], s87 offen sc1
s_branch back_102
slow_113:
.p2align 3
v_pk_mul_f32 v[220:221], v[220:221], v[160:161] op_sel:[0,0] op_sel_hi:[1,0]
v_pk_mul_f32 v[222:223], v[222:223], v[160:161] op_sel:[0,0] op_sel_hi:[1,0]
v_pk_mul_f32 v[224:225], v[224:225], v[160:161] op_sel:[0,0] op_sel_hi:[1,0]
v_pk_mul_f32 v[226:227], v[226:227], v[160:161] op_sel:[0,0] op_sel_hi:[1,0]
v_cvt_pk_bf16_f32 v220, v220, v221
v_cvt_pk_bf16_f32 v221, v222, v223
v_cvt_pk_bf16_f32 v222, v224, v225
v_cvt_pk_bf16_f32 v223, v226, v227
buffer_store_dwordx4 v[220:223], v18, s[32:35], s80 offen sc1
v_pk_mul_f32 v[228:229], v[228:229], v[168:169] op_sel:[0,0] op_sel_hi:[1,0]
v_pk_mul_f32 v[230:231], v[230:231], v[168:169] op_sel:[0,0] op_sel_hi:[1,0]
v_pk_mul_f32 v[232:233], v[232:233], v[168:169] op_sel:[0,0] op_sel_hi:[1,0]
v_pk_mul_f32 v[234:235], v[234:235], v[168:169] op_sel:[0,0] op_sel_hi:[1,0]
v_cvt_pk_bf16_f32 v228, v228, v229
v_cvt_pk_bf16_f32 v229, v230, v231
v_cvt_pk_bf16_f32 v230, v232, v233
v_cvt_pk_bf16_f32 v231, v234, v235
buffer_store_dwordx4 v[228:231], v18, s[32:35], s81 offen sc1
v_pk_mul_f32 v[236:237], v[236:237], v[176:177] op_sel:[0,0] op_sel_hi:[1,0]
v_pk_mul_f32 v[238:239], v[238:239], v[176:177] op_sel:[0,0] op_sel_hi:[1,0]
v_pk_mul_f32 v[240:241], v[240:241], v[176:177] op_sel:[0,0] op_sel_hi:[1,0]
v_pk_mul_f32 v[242:243], v[242:243], v[176:177] op_sel:[0,0] op_sel_hi:[1,0]
v_cvt_pk_bf16_f32 v236, v236, v237
v_cvt_pk_bf16_f32 v237, v238, v239
v_cvt_pk_bf16_f32 v238, v240, v241
v_cvt_pk_bf16_f32 v239, v242, v243
buffer_store_dwordx4 v[236:239], v18, s[32:35], s82 offen sc1
v_pk_mul_f32 v[244:245], v[244:245], v[184:185] op_sel:[0,0] op_sel_hi:[1,0]
v_pk_mul_f32 v[246:247], v[246:247], v[184:185] op_sel:[0,0] op_sel_hi:[1,0]
v_pk_mul_f32 v[248:249], v[248:249], v[184:185] op_sel:[0,0] op_sel_hi:[1,0]
v_pk_mul_f32 v[250:251], v[250:251], v[184:185] op_sel:[0,0] op_sel_hi:[1,0]
v_cvt_pk_bf16_f32 v244, v244, v245
v_cvt_pk_bf16_f32 v245, v246, v247
v_cvt_pk_bf16_f32 v246, v248, v249
v_cvt_pk_bf16_f32 v247, v250, v251
buffer_store_dwordx4 v[244:247], v18, s[32:35], s83 offen sc1
s_branch back_114
slow_115:
buffer_store_dword v5, v4, s[32:35], s84 offen sc1
s_branch back_116
slow_119:
s_nop 0
v_cvt_pk_bf16_f32 v20, v60, v61
v_cvt_pk_bf16_f32 v21, v62, v63
v_cvt_pk_bf16_f32 v22, v64, v65
v_cvt_pk_bf16_f32 v23, v66, v67
buffer_store_dwordx4 v[20:23], v18, s[32:35], s85 offen offset:0 sc1
v_cvt_pk_bf16_f32 v24, v68, v69
v_cvt_pk_bf16_f32 v25, v70, v71
v_cvt_pk_bf16_f32 v26, v72, v73
v_cvt_pk_bf16_f32 v27, v74, v75
buffer_store_dwordx4 v[24:27], v18, s[32:35], s85 offen offset:1024 sc1
v_cvt_pk_bf16_f32 v28, v76, v77
v_cvt_pk_bf16_f32 v29, v78, v79
v_cvt_pk_bf16_f32 v30, v80, v81
v_cvt_pk_bf16_f32 v31, v82, v83
buffer_store_dwordx4 v[28:31], v18, s[32:35], s86 offen offset:0 sc1
v_cvt_pk_bf16_f32 v32, v84, v85
v_cvt_pk_bf16_f32 v33, v86, v87
v_cvt_pk_bf16_f32 v34, v88, v89
v_cvt_pk_bf16_f32 v35, v90, v91
buffer_store_dwordx4 v[32:35], v18, s[32:35], s86 offen offset:1024 sc1
s_barrier
v_dot2c_f32_bf16 v6, v20, v48
v_dot2c_f32_bf16 v8, v20, v20
v_dot2c_f32_bf16 v7, v28, v48
v_dot2c_f32_bf16 v9, v28, v28
v_dot2c_f32_bf16 v6, v21, v48
v_dot2c_f32_bf16 v8, v21, v21
v_dot2c_f32_bf16 v7, v29, v48
v_dot2c_f32_bf16 v9, v29, v29
v_dot2c_f32_bf16 v6, v22, v48
v_dot2c_f32_bf16 v8, v22, v22
v_dot2c_f32_bf16 v7, v30, v48
v_dot2c_f32_bf16 v9, v30, v30
v_dot2c_f32_bf16 v6, v23, v48
v_dot2c_f32_bf16 v8, v23, v23
v_dot2c_f32_bf16 v7, v31, v48
v_dot2c_f32_bf16 v9, v31, v31
v_dot2c_f32_bf16 v6, v24, v48
v_dot2c_f32_bf16 v8, v24, v24
v_dot2c_f32_bf16 v7, v32, v48
v_dot2c_f32_bf16 v9, v32, v32
v_dot2c_f32_bf16 v6, v25, v48
v_dot2c_f32_bf16 v8, v25, v25
v_dot2c_f32_bf16 v7, v33, v48
v_dot2c_f32_bf16 v9, v33, v33
v_dot2c_f32_bf16 v6, v26, v48
v_dot2c_f32_bf16 v8, v26, v26
v_dot2c_f32_bf16 v7, v34, v48
v_dot2c_f32_bf16 v9, v34, v34
v_dot2c_f32_bf16 v6, v27, v48
v_dot2c_f32_bf16 v8, v27, v27
v_dot2c_f32_bf16 v7, v35, v48
v_dot2c_f32_bf16 v9, v35, v35
s_mov_b64 exec, 1
s_waitcnt vmcnt(0)
buffer_store_dword v5, v4, s[32:35], s88 offen sc1
s_mov_b64 exec, -1
s_nop 1
v_permlane32_swap_b32 v6, v7
v_permlane32_swap_b32 v8, v9
v_add_f32 v6, v6, v7
v_add_f32 v8, v8, v9
s_nop 1
v_permlane16_swap_b32 v6, v8
s_nop 0
v_add_f32 v6, v6, v8
buffer_store_dword v6, v1, s[32:35], s87 offen sc1
s_branch back_120
slow_133:
.p2align 3
v_pk_mul_f32 v[156:157], v[156:157], v[100:101] op_sel:[0,0] op_sel_hi:[1,0]
v_pk_mul_f32 v[158:159], v[158:159], v[100:101] op_sel:[0,0] op_sel_hi:[1,0]
v_pk_mul_f32 v[160:161], v[160:161], v[100:101] op_sel:[0,0] op_sel_hi:[1,0]
v_pk_mul_f32 v[162:163], v[162:163], v[100:101] op_sel:[0,0] op_sel_hi:[1,0]
v_cvt_pk_bf16_f32 v156, v156, v157
v_mfma_f32_16x16x32_bf16 v[172:175], v[188:191], v[76:79], 0
v_cvt_pk_bf16_f32 v157, v158, v159
v_mfma_f32_16x16x32_bf16 v[176:179], v[192:195], v[76:79], 0
v_cvt_pk_bf16_f32 v158, v160, v161
v_mfma_f32_16x16x32_bf16 v[172:175], v[196:199], v[236:239], v[172:175]
v_cvt_pk_bf16_f32 v159, v162, v163
v_mfma_f32_16x16x32_bf16 v[176:179], v[200:203], v[236:239], v[176:179]
buffer_store_dwordx4 v[156:159], v18, s[32:35], s80 offen sc1
v_pk_mul_f32 v[164:165], v[164:165], v[100:101] op_sel:[0,1] op_sel_hi:[1,1]
v_pk_mul_f32 v[166:167], v[166:167], v[100:101] op_sel:[0,1] op_sel_hi:[1,1]
v_pk_mul_f32 v[168:169], v[168:169], v[100:101] op_sel:[0,1] op_sel_hi:[1,1]
v_pk_mul_f32 v[170:171], v[170:171], v[100:101] op_sel:[0,1] op_sel_hi:[1,1]
v_cvt_pk_bf16_f32 v164, v164, v165
v_mfma_f32_16x16x32_bf16 v[180:183], v[188:191], v[84:87], 0
v_cvt_pk_bf16_f32 v165, v166, v167
v_mfma_f32_16x16x32_bf16 v[184:187], v[192:195], v[84:87], 0
v_cvt_pk_bf16_f32 v166, v168, v169
v_mfma_f32_16x16x32_bf16 v[180:183], v[196:199], v[244:247], v[180:183]
v_cvt_pk_bf16_f32 v167, v170, v171
v_mfma_f32_16x16x32_bf16 v[184:187], v[200:203], v[244:247], v[184:187]
buffer_store_dwordx4 v[164:167], v18, s[32:35], s81 offen sc1
v_pk_mul_f32 v[172:173], v[172:173], v[102:103] op_sel:[0,0] op_sel_hi:[1,0]
v_pk_mul_f32 v[174:175], v[174:175], v[102:103] op_sel:[0,0] op_sel_hi:[1,0]
v_pk_mul_f32 v[176:177], v[176:177], v[102:103] op_sel:[0,0] op_sel_hi:[1,0]
v_pk_mul_f32 v[178:179], v[178:179], v[102:103] op_sel:[0,0] op_sel_hi:[1,0]
v_cvt_pk_bf16_f32 v172, v172, v173
v_cvt_pk_bf16_f32 v173, v174, v175
v_cvt_pk_bf16_f32 v174, v176, v177
v_cvt_pk_bf16_f32 v175, v178, v179
buffer_store_dwordx4 v[172:175], v18, s[32:35], s82 offen sc1
v_pk_mul_f32 v[180:181], v[180:181], v[102:103] op_sel:[0,1] op_sel_hi:[1,1]
v_pk_mul_f32 v[182:183], v[182:183], v[102:103] op_sel:[0,1] op_sel_hi:[1,1]
v_pk_mul_f32 v[184:185], v[184:185], v[102:103] op_sel:[0,1] op_sel_hi:[1,1]
v_pk_mul_f32 v[186:187], v[186:187], v[102:103] op_sel:[0,1] op_sel_hi:[1,1]
v_cvt_pk_bf16_f32 v180, v180, v181
v_cvt_pk_bf16_f32 v181, v182, v183
v_cvt_pk_bf16_f32 v182, v184, v185
v_cvt_pk_bf16_f32 v183, v186, v187
buffer_store_dwordx4 v[180:183], v18, s[32:35], s83 offen sc1
s_branch back_134
slow_135:
buffer_store_dword v5, v4, s[32:35], s84 offen sc1
s_branch back_136
s_endpgm
.section .rodata,"a"
.p2align 6
.amdhsa_kernel interleave_layers__sliding_local_dilated__linear_kernel_hedgehog__prompt_kernel
  .amdhsa_next_free_vgpr 256
  .amdhsa_next_free_sgpr 102
  .amdhsa_accum_offset 256
  .amdhsa_group_segment_fixed_size 0
  .amdhsa_kernarg_size 80
  .amdhsa_user_sgpr_count 2
  .amdhsa_user_sgpr_kernarg_segment_ptr 1
  .amdhsa_system_sgpr_workgroup_id_x 1
.end_amdhsa_kernel
```

```asm
; @launch grid=(256,1,1) block=(512,1,1) lds=163840
.amdgcn_target "amdgcn-amd-amdhsa--gfx950"
.text
.globl interleave_layers__sliding_local_dilated__linear_kernel_hedgehog__prompt_kernel
.p2align 8
.type interleave_layers__sliding_local_dilated__linear_kernel_hedgehog__prompt_kernel,@function
interleave_layers__sliding_local_dilated__linear_kernel_hedgehog__prompt_kernel:
s_cmp_ge_u32 s2, 256
s_cbranch_scc1 L_end
s_load_dwordx16 s[4:19], s[0:1], 0
s_load_dwordx4 s[20:23], s[0:1], 64
v_lshrrev_b32 v1, 6, v0
v_and_b32 v0, 63, v0
v_readfirstlane_b32 s40, v1
v_and_b32 v2, 15, v0
v_lshrrev_b32 v3, 4, v0
v_lshlrev_b32 v18, 4, v0
s_and_b32 s48, s2, 7
s_lshr_b32 s49, s2, 3
s_and_b32 s74, s49, 1
s_lshl_b32 s41, s48, 1
s_add_u32 s41, s41, s74
s_lshr_b32 s42, s49, 1
s_and_b32 s48, s2, 7
s_lshr_b32 s47, s42, 2
s_add_u32 s47, s47, s48
s_and_b32 s47, s47, 3
s_and_b32 s43, s40, 3
s_lshl_b32 s70, s43, 12
s_lshl_b32 s71, s43, 11
s_add_u32 s71, s71, 16384
s_cmp_lt_u32 s40, 4
s_cbranch_scc1 L_compute
v_lshrrev_b32 v4, 3, v0
v_and_b32 v5, 7, v0
s_lshl_b32 s48, s43, 4
v_add_u32 v6, s48, v4
s_lshl_b32 s48, s42, 7
s_mov_b32 s49, 6144
v_mul_u32_u24 v6, s49, v6
v_and_b32 v7, 2, v4
v_xor_b32 v7, v7, v5
v_lshl_add_u32 v26, v7, 4, v6
v_add_u32 v26, s48, v26
s_mul_i32 s49, s49, 8
s_sub_u32 s49, s49, 1024
v_xor_b32 v27, 64, v26
v_add_u32 v27, s49, v27
s_mov_b32 s53, 2048
s_mov_b32 s54, 393216
s_mov_b32 s57, 131072
s_lshl_b32 s48, s41, 7
s_lshl_b32 s49, s43, 5
s_add_u32 s48, s48, s49
v_add_u32 v6, s48, v4
v_lshlrev_b32 v6, 11, v6
v_lshrrev_b32 v7, 1, v4
v_xor_b32 v7, v7, v5
v_lshl_add_u32 v20, v7, 4, v6
v_xor_b32 v21, 64, v20
v_add_u32 v21, 15360, v21
v_add_u32 v22, 30720, v20
v_add_u32 v23, 30720, v21
s_add_u32 s69, s47, 0
s_and_b32 s69, s69, 3
s_add_u32 s69, s69, 0
s_mul_i32 s67, s69, 128
s_mul_i32 s68, s69, s54
s_waitcnt lgkmcnt(0)
s_mov_b32 s24, s4
s_and_b32 s25, s5, 0xffff
s_mov_b32 s26, 4194304
s_mov_b32 s27, 0x00020000
s_mov_b32 s28, s6
s_and_b32 s29, s7, 0xffff
s_mov_b32 s30, 6291456
s_mov_b32 s31, 0x00020000
s_add_u32 m0, s70, 0
s_nop 0
buffer_load_dwordx4 v20, s[24:27], s67 offen offset:0  lds
buffer_load_dwordx4 v21, s[24:27], s67 offen offset:1024  lds
buffer_load_dwordx4 v22, s[24:27], s67 offen offset:2048  lds
buffer_load_dwordx4 v23, s[24:27], s67 offen offset:3072  lds
s_add_u32 s60, s71, 0
s_add_u32 m0, s60, 0
s_mov_b32 s61, s68
buffer_load_dwordx4 v26, s[28:31], s61 offen lds
buffer_load_dwordx4 v27, s[28:31], s61 offen offset:1024 lds
s_add_u32 m0, s60, 8192
s_add_u32 s61, s61, s53
buffer_load_dwordx4 v26, s[28:31], s61 offen lds
buffer_load_dwordx4 v27, s[28:31], s61 offen offset:1024 lds
s_add_u32 m0, s60, 16384
s_add_u32 s61, s61, s53
buffer_load_dwordx4 v26, s[28:31], s61 offen lds
buffer_load_dwordx4 v27, s[28:31], s61 offen offset:1024 lds
s_lshr_b32 s48, s2, 2
s_and_b32 s48, s48, 1
s_lshl_b32 s48, s48, 1
s_add_u32 s48, s48, s74
s_and_b32 s49, s42, 3
s_xor_b32 s77, s48, s49
s_add_u32 s77, s77, 4
s_add_u32 s48, s47, 1
s_and_b32 s48, s48, 3
s_and_b32 s49, s77, 3
s_lshl_b32 s49, s49, 2
s_add_u32 s78, s48, s49
s_and_b32 s48, s2, 7
s_lshl_b32 s48, s48, 1
s_add_u32 s75, s78, s48
s_and_b32 s75, s75, 15
s_mov_b32 s46, 0
s_mov_b32 s32, s22
s_and_b32 s33, s23, 0xffff
s_mov_b32 s34, 268435456
s_mov_b32 s35, 0x00020000
s_mov_b32 s36, s8
s_and_b32 s37, s9, 0xffff
s_mov_b32 s38, 2097152
s_mov_b32 s39, 0x00020000
v_mov_b32 v56, -1
v_mov_b32 v57, -1
v_mov_b32 v58, -1
v_mov_b32 v59, -1
s_lshl_b32 s52, s41, 6
s_add_u32 s52, s52, s42
s_lshl_b32 s52, s52, 8
s_add_u32 s52, s52, 16777216
s_getreg_b32 s50, hwreg(HW_REG_XCC_ID)
s_and_b32 s50, s50, 7
s_lshl_b32 s50, s50, 3
s_lshl_b64 s[94:95], 1, s50
s_and_b32 s96, s2, 7
s_lshl_b32 s96, s96, 5
s_and_b32 s51, s42, 7
s_cmp_gt_u32 s51, 3
s_cselect_b32 s49, 1, 0
s_sub_u32 s49, s51, s49
s_lshl_b32 s49, s49, 1
s_add_u32 s49, s49, s74
s_lshl_b32 s49, s49, 2
s_add_u32 s49, s49, s43
s_lshr_b32 s50, s49, 4
s_lshl_b32 s50, s50, 11
s_and_b32 s49, s49, 15
s_mul_i32 s49, s49, 24576
s_add_u32 s49, s49, s50
s_and_b32 s50, s42, 8
s_or_b32 s50, s50, 3
s_and_b32 s48, s2, 7
s_lshr_b32 s76, s50, 2
s_add_u32 s76, s76, s48
s_and_b32 s76, s76, 3
s_lshl_b32 s50, s50, 7
s_add_u32 s49, s49, s50
s_and_b32 s51, s51, 3
s_cmp_eq_u32 s51, 3
s_cselect_b32 s49, 0x70000000, s49
v_mul_u32_u24 v4, 6144, v4
v_lshl_add_u32 v4, v5, 4, v4
v_lshrrev_b32 v5, 5, v0
v_lshlrev_b32 v5, 30, v5
v_add3_u32 v36, v4, v5, s49
s_mov_b32 s55, -1
s_mov_b32 s56, -1
v_lshrrev_b32 v4, 3, v0
v_and_b32 v5, 7, v0
s_lshr_b32 s48, s43, 1
s_lshl_b32 s48, s48, 5
s_and_b32 s49, s43, 1
s_lshl_b32 s49, s49, 3
s_add_u32 s48, s48, s49
v_lshrrev_b32 v6, 2, v4
v_lshlrev_b32 v6, 4, v6
v_and_b32 v7, 3, v4
v_add3_u32 v6, v6, v7, s48
s_lshl_b32 s48, s78, 7
s_mov_b32 s49, 2048
v_mul_u32_u24 v6, s49, v6
v_and_b32 v7, 2, v4
v_xor_b32 v7, v7, v5
v_lshl_add_u32 v28, v7, 4, v6
v_add_u32 v28, s48, v28
s_mul_i32 s49, s49, 4
s_sub_u32 s49, s49, 1024
v_xor_b32 v29, 64, v28
v_add_u32 v29, s49, v29
v_lshrrev_b32 v4, 3, v0
v_and_b32 v5, 7, v0
s_lshr_b32 s48, s43, 1
s_lshl_b32 s48, s48, 5
s_and_b32 s49, s43, 1
s_lshl_b32 s49, s49, 3
s_add_u32 s48, s48, s49
v_lshrrev_b32 v6, 2, v4
v_lshlrev_b32 v6, 4, v6
v_and_b32 v7, 3, v4
v_add3_u32 v6, v6, v7, s48
s_lshl_b32 s48, s42, 7
s_mov_b32 s49, 6144
s_cmp_ge_i32 s55, 0
s_cselect_b32 s48, 1024, s48
s_cselect_b32 s49, 384, s49
v_mul_u32_u24 v6, s49, v6
v_and_b32 v7, 2, v4
v_xor_b32 v7, v7, v5
v_lshl_add_u32 v60, v7, 4, v6
v_add_u32 v60, s48, v60
s_mul_i32 s49, s49, 4
s_sub_u32 s49, s49, 1024
v_xor_b32 v61, 64, v60
v_add_u32 v61, s49, v61
v_lshrrev_b32 v4, 3, v0
v_and_b32 v5, 7, v0
s_lshr_b32 s48, s43, 1
s_lshl_b32 s48, s48, 5
s_and_b32 s49, s43, 1
s_lshl_b32 s49, s49, 3
s_add_u32 s48, s48, s49
v_lshrrev_b32 v6, 2, v4
v_lshlrev_b32 v6, 4, v6
v_and_b32 v7, 3, v4
v_add3_u32 v6, v6, v7, s48
s_lshl_b32 s48, s78, 7
s_mov_b32 s49, 2048
s_cmp_ge_i32 s56, 0
s_cselect_b32 s48, 1024, s48
s_cselect_b32 s49, 128, s49
v_mul_u32_u24 v6, s49, v6
v_and_b32 v7, 2, v4
v_xor_b32 v7, v7, v5
v_lshl_add_u32 v24, v7, 4, v6
v_add_u32 v24, s48, v24
s_mul_i32 s49, s49, 4
s_sub_u32 s49, s49, 1024
v_xor_b32 v25, 64, v24
v_add_u32 v25, s49, v25
v_lshlrev_b32 v30, 2, v2
v_and_b32 v32, 7, v0
v_lshlrev_b32 v32, 5, v32
s_lshl_b32 s50, s41, 2
s_add_u32 s50, s50, s43
s_lshl_b32 s50, s50, 12
s_add_u32 s50, s50, 16777216
v_add_u32 v37, s50, v18
v_lshrrev_b32 v4, 5, v0
v_lshl_add_u32 v4, v4, 4, v2
s_lshl_b32 s48, s43, 5
v_add_u32 v4, s48, v4
v_lshlrev_b32 v49, 3, v4
v_add_u32 v49, 131072, v49
v_lshlrev_b32 v50, 2, v4
v_add_u32 v50, 132096, v50
s_lshl_b32 s79, s41, 2
s_add_u32 s79, s79, s43
s_lshl_b32 s79, s79, 7
s_add_u32 s79, s79, 18358272
s_lshl_b32 s48, s41, 3
s_lshl_b32 s49, s43, 1
s_add_u32 s48, s48, s49
s_lshl_b32 s80, s48, 15
s_lshl_b32 s49, s42, 11
s_add_u32 s81, s80, s49
s_add_u32 s81, s81, 4194304
s_add_u32 s82, s81, 32768
s_lshl_b32 s48, s43, 11
v_add_u32 v51, s48, v18
v_add_u32 v52, 0x10000, v51
v_add_u32 v14, 0x20000, v51
s_lshl_b32 s48, s2, 2
s_add_u32 s48, s48, s43
s_lshl_b32 s83, s48, 11
s_mul_i32 s87, s48, 6144
v_add_u32 v62, s83, v18
s_add_u32 s87, s87, 3072
v_add_u32 v63, s87, v18
s_lshr_b32 s48, s2, 4
s_and_b32 s49, s2, 7
s_add_u32 s48, s48, s49
s_mul_i32 s49, s48, 8193
s_lshr_b32 s49, s49, 16
s_mul_i32 s49, s49, 8
s_sub_u32 s88, s48, s49
s_mul_i32 s48, s42, 163840
s_add_u32 s48, s48, 9437184
s_lshl_b32 s49, s43, 4
s_add_u32 s49, s49, s41
s_lshl_b32 s50, s49, 11
s_add_u32 s86, s48, s50
s_lshl_b32 s50, s49, 9
s_add_u32 s89, s48, s50
s_add_u32 s89, s89, 131072
v_lshlrev_b32 v39, 3, v0
s_lshl_b32 s73, s42, 2
s_add_u32 s73, s73, 0
s_lshl_b32 s73, s73, 7
s_add_u32 s73, s73, 18366464
s_lshl_b32 s48, s41, 2
v_mov_b32 v12, s48
v_mov_b32 v13, 1
s_lshl_b32 s50, s43, 12
s_add_u32 s50, s50, s52
s_add_u32 s50, s50, 262144
v_min_u32 v8, 2, v3
v_lshlrev_b32 v8, 18, v8
v_lshl_add_u32 v8, v2, 4, v8
v_add_u32 v55, s50, v8
s_lshl_b32 s50, s42, 2
s_add_u32 s50, s50, s43
s_lshl_b32 s50, s50, 12
s_add_u32 s50, s50, 17825792
v_add_u32 v38, s50, v18
v_min_u32 v4, 2, v3
v_lshlrev_b32 v4, 8, v4
v_lshl_add_u32 v4, v2, 2, v4
s_and_b32 s48, s43, 1
s_lshl_b32 s48, s48, 7
s_lshr_b32 s49, s43, 1
s_lshl_b32 s49, s49, 6
s_add_u32 s48, s48, s49
s_add_u32 s48, s48, 133120
v_add_u32 v53, s48, v4
s_getpc_b64 s[98:99]
pc_1:
s_add_u32 s98, s98, c0_last - pc_1
s_addc_u32 s99, s99, 0
s_lshr_b32 s50, s2, 3
s_lshl_b32 s50, s50, 2
s_add_u32 s50, s50, s43
s_lshl_b32 s50, s50, 7
v_and_b32 v4, 1, v0
v_lshl_add_u32 v4, v4, 6, s50
v_min_u32 v54, L_code_end - c0_last, v4
s_add_u32 s69, s47, 0
s_and_b32 s69, s69, 3
s_add_u32 s69, s69, 4
s_mul_i32 s67, s69, 128
s_mul_i32 s68, s69, s54
s_add_u32 m0, s70, 40960
s_nop 0
buffer_load_dwordx4 v20, s[24:27], s67 offen offset:0  lds
buffer_load_dwordx4 v21, s[24:27], s67 offen offset:1024  lds
buffer_load_dwordx4 v22, s[24:27], s67 offen offset:2048  lds
buffer_load_dwordx4 v23, s[24:27], s67 offen offset:3072  lds
s_add_u32 s60, s71, 40960
s_add_u32 m0, s60, 0
s_mov_b32 s61, s68
buffer_load_dwordx4 v26, s[28:31], s61 offen lds
buffer_load_dwordx4 v27, s[28:31], s61 offen offset:1024 lds
s_add_u32 m0, s60, 8192
s_add_u32 s61, s61, s53
buffer_load_dwordx4 v26, s[28:31], s61 offen lds
buffer_load_dwordx4 v27, s[28:31], s61 offen offset:1024 lds
s_add_u32 m0, s60, 16384
s_add_u32 s61, s61, s53
buffer_load_dwordx4 v26, s[28:31], s61 offen lds
buffer_load_dwordx4 v27, s[28:31], s61 offen offset:1024 lds
s_waitcnt vmcnt(10)
s_barrier
s_cmp_lg_u32 s43, 3
s_cbranch_scc1 else_2
s_atomic_add_x2 s[94:95], s[20:21], s96
else_2:
s_add_u32 s49, s76, 0
s_and_b32 s49, s49, 3
s_add_u32 s49, s49, 8
s_mul_i32 s49, s49, 393216
buffer_load_dwordx4 v[40:43], v36, s[28:31], s49 offen
s_add_u32 s49, s76, 0
s_and_b32 s49, s49, 3
s_add_u32 s49, s49, 12
s_mul_i32 s49, s49, 393216
buffer_load_dwordx4 v[40:43], v36, s[28:31], s49 offen
s_add_u32 s69, s47, 0
s_and_b32 s69, s69, 3
s_add_u32 s69, s69, 8
s_mul_i32 s67, s69, 128
s_mul_i32 s68, s69, s54
s_add_u32 m0, s70, 81920
s_nop 0
buffer_load_dwordx4 v20, s[24:27], s67 offen offset:0  lds
buffer_load_dwordx4 v21, s[24:27], s67 offen offset:1024  lds
buffer_load_dwordx4 v22, s[24:27], s67 offen offset:2048  lds
buffer_load_dwordx4 v23, s[24:27], s67 offen offset:3072  lds
s_add_u32 s60, s71, 81920
s_add_u32 m0, s60, 0
s_mov_b32 s61, s68
buffer_load_dwordx4 v26, s[28:31], s61 offen lds
buffer_load_dwordx4 v27, s[28:31], s61 offen offset:1024 lds
s_add_u32 m0, s60, 8192
s_add_u32 s61, s61, s53
buffer_load_dwordx4 v26, s[28:31], s61 offen lds
buffer_load_dwordx4 v27, s[28:31], s61 offen offset:1024 lds
s_add_u32 m0, s60, 16384
s_add_u32 s61, s61, s53
buffer_load_dwordx4 v26, s[28:31], s61 offen lds
buffer_load_dwordx4 v27, s[28:31], s61 offen offset:1024 lds
s_add_u32 s49, s76, 1
s_and_b32 s49, s49, 3
s_add_u32 s49, s49, 0
s_mul_i32 s49, s49, 393216
buffer_load_dwordx4 v[40:43], v36, s[28:31], s49 offen
s_mov_b32 s64, 0
s_mov_b32 s65, 0
s_waitcnt vmcnt(11)
s_barrier
s_add_u32 s69, s47, 0
s_and_b32 s69, s69, 3
s_add_u32 s69, s69, 12
s_mul_i32 s67, s69, 128
s_mul_i32 s68, s69, s54
s_add_u32 m0, s70, s65
s_nop 0
buffer_load_dwordx4 v20, s[24:27], s67 offen offset:0  lds
buffer_load_dwordx4 v21, s[24:27], s67 offen offset:1024  lds
buffer_load_dwordx4 v22, s[24:27], s67 offen offset:2048  lds
buffer_load_dwordx4 v23, s[24:27], s67 offen offset:3072  lds
s_add_u32 s60, s71, s65
s_add_u32 m0, s60, 0
s_mov_b32 s61, s68
buffer_load_dwordx4 v26, s[28:31], s61 offen lds
buffer_load_dwordx4 v27, s[28:31], s61 offen offset:1024 lds
s_add_u32 m0, s60, 8192
s_add_u32 s61, s61, s53
buffer_load_dwordx4 v26, s[28:31], s61 offen lds
buffer_load_dwordx4 v27, s[28:31], s61 offen offset:1024 lds
s_add_u32 m0, s60, 16384
s_add_u32 s61, s61, s53
buffer_load_dwordx4 v26, s[28:31], s61 offen lds
buffer_load_dwordx4 v27, s[28:31], s61 offen offset:1024 lds
s_add_u32 s49, s76, 1
s_and_b32 s49, s49, 3
s_add_u32 s49, s49, 4
s_mul_i32 s49, s49, 393216
buffer_load_dwordx4 v[40:43], v36, s[28:31], s49 offen
s_add_u32 s65, s65, 40960
s_cmp_eq_u32 s65, 122880
s_cselect_b32 s65, 0, s65
s_add_u32 s64, s64, 1
s_waitcnt vmcnt(11)
s_barrier
s_add_u32 s69, s47, 1
s_and_b32 s69, s69, 3
s_add_u32 s69, s69, 0
s_mul_i32 s67, s69, 128
s_mul_i32 s68, s69, s54
s_add_u32 m0, s70, s65
s_nop 0
buffer_load_dwordx4 v20, s[24:27], s67 offen offset:0  lds
buffer_load_dwordx4 v21, s[24:27], s67 offen offset:1024  lds
buffer_load_dwordx4 v22, s[24:27], s67 offen offset:2048  lds
buffer_load_dwordx4 v23, s[24:27], s67 offen offset:3072  lds
s_add_u32 s60, s71, s65
s_add_u32 m0, s60, 0
s_mov_b32 s61, s68
buffer_load_dwordx4 v26, s[28:31], s61 offen lds
buffer_load_dwordx4 v27, s[28:31], s61 offen offset:1024 lds
s_add_u32 m0, s60, 8192
s_add_u32 s61, s61, s53
buffer_load_dwordx4 v26, s[28:31], s61 offen lds
buffer_load_dwordx4 v27, s[28:31], s61 offen offset:1024 lds
s_add_u32 m0, s60, 16384
s_add_u32 s61, s61, s53
buffer_load_dwordx4 v26, s[28:31], s61 offen lds
buffer_load_dwordx4 v27, s[28:31], s61 offen offset:1024 lds
s_add_u32 s49, s76, 1
s_and_b32 s49, s49, 3
s_add_u32 s49, s49, 8
s_mul_i32 s49, s49, 393216
buffer_load_dwordx4 v[40:43], v36, s[28:31], s49 offen
s_add_u32 s65, s65, 40960
s_cmp_eq_u32 s65, 122880
s_cselect_b32 s65, 0, s65
s_add_u32 s64, s64, 1
s_waitcnt vmcnt(11)
s_barrier
s_cmp_lg_u32 s88, 0
s_cbranch_scc1 else_4
buffer_load_dwordx4 v[108:111], v18, s[36:39], s83 offen offset:0
buffer_load_dwordx4 v[108:111], v18, s[36:39], s83 offen offset:1024
global_load_dwordx4 v[108:111], v63, s[12:13] offset:-3072
global_load_dwordx4 v[108:111], v63, s[12:13] offset:-2048
global_load_dwordx4 v[108:111], v63, s[12:13] offset:-1024
global_load_dwordx4 v[108:111], v63, s[12:13] offset:0
global_load_dwordx4 v[108:111], v63, s[12:13] offset:1024
global_load_dwordx4 v[108:111], v63, s[12:13] offset:2048
buffer_store_dwordx4 v[56:59], v18, s[32:35], s86 offen offset:0 sc1
buffer_store_dwordx4 v[56:59], v18, s[32:35], s86 offen offset:1024 sc1
buffer_store_dwordx2 v[56:57], v39, s[32:35], s89 offen sc1
buffer_store_dwordx4 v[56:59], v55, s[32:35], 0 offen sc1
else_4:
s_add_u32 s69, s47, 1
s_and_b32 s69, s69, 3
s_add_u32 s69, s69, 4
s_mul_i32 s67, s69, 128
s_mul_i32 s68, s69, s54
s_add_u32 m0, s70, s65
s_nop 0
buffer_load_dwordx4 v20, s[24:27], s67 offen offset:0  lds
buffer_load_dwordx4 v21, s[24:27], s67 offen offset:1024  lds
buffer_load_dwordx4 v22, s[24:27], s67 offen offset:2048  lds
buffer_load_dwordx4 v23, s[24:27], s67 offen offset:3072  lds
s_add_u32 s60, s71, s65
s_add_u32 m0, s60, 0
s_mov_b32 s61, s68
buffer_load_dwordx4 v26, s[28:31], s61 offen lds
buffer_load_dwordx4 v27, s[28:31], s61 offen offset:1024 lds
s_add_u32 m0, s60, 8192
s_add_u32 s61, s61, s53
buffer_load_dwordx4 v26, s[28:31], s61 offen lds
buffer_load_dwordx4 v27, s[28:31], s61 offen offset:1024 lds
s_add_u32 m0, s60, 16384
s_add_u32 s61, s61, s53
buffer_load_dwordx4 v26, s[28:31], s61 offen lds
buffer_load_dwordx4 v27, s[28:31], s61 offen offset:1024 lds
s_add_u32 s49, s76, 1
s_and_b32 s49, s49, 3
s_add_u32 s49, s49, 12
s_mul_i32 s49, s49, 393216
buffer_load_dwordx4 v[40:43], v36, s[28:31], s49 offen
s_add_u32 s65, s65, 40960
s_cmp_eq_u32 s65, 122880
s_cselect_b32 s65, 0, s65
s_add_u32 s64, s64, 1
s_waitcnt vmcnt(11)
s_barrier
s_cmp_lg_u32 s88, 1
s_cbranch_scc1 else_6
buffer_load_dwordx4 v[108:111], v18, s[36:39], s83 offen offset:0
buffer_load_dwordx4 v[108:111], v18, s[36:39], s83 offen offset:1024
global_load_dwordx4 v[108:111], v63, s[12:13] offset:-3072
global_load_dwordx4 v[108:111], v63, s[12:13] offset:-2048
global_load_dwordx4 v[108:111], v63, s[12:13] offset:-1024
global_load_dwordx4 v[108:111], v63, s[12:13] offset:0
global_load_dwordx4 v[108:111], v63, s[12:13] offset:1024
global_load_dwordx4 v[108:111], v63, s[12:13] offset:2048
buffer_store_dwordx4 v[56:59], v18, s[32:35], s86 offen offset:0 sc1
buffer_store_dwordx4 v[56:59], v18, s[32:35], s86 offen offset:1024 sc1
buffer_store_dwordx2 v[56:57], v39, s[32:35], s89 offen sc1
buffer_store_dwordx4 v[56:59], v55, s[32:35], 0 offen sc1
else_6:
s_add_u32 s69, s47, 1
s_and_b32 s69, s69, 3
s_add_u32 s69, s69, 8
s_mul_i32 s67, s69, 128
s_mul_i32 s68, s69, s54
s_add_u32 m0, s70, s65
s_nop 0
buffer_load_dwordx4 v20, s[24:27], s67 offen offset:0  lds
buffer_load_dwordx4 v21, s[24:27], s67 offen offset:1024  lds
buffer_load_dwordx4 v22, s[24:27], s67 offen offset:2048  lds
buffer_load_dwordx4 v23, s[24:27], s67 offen offset:3072  lds
s_add_u32 s60, s71, s65
s_add_u32 m0, s60, 0
s_mov_b32 s61, s68
buffer_load_dwordx4 v26, s[28:31], s61 offen lds
buffer_load_dwordx4 v27, s[28:31], s61 offen offset:1024 lds
s_add_u32 m0, s60, 8192
s_add_u32 s61, s61, s53
buffer_load_dwordx4 v26, s[28:31], s61 offen lds
buffer_load_dwordx4 v27, s[28:31], s61 offen offset:1024 lds
s_add_u32 m0, s60, 16384
s_add_u32 s61, s61, s53
buffer_load_dwordx4 v26, s[28:31], s61 offen lds
buffer_load_dwordx4 v27, s[28:31], s61 offen offset:1024 lds
s_add_u32 s49, s76, 2
s_and_b32 s49, s49, 3
s_add_u32 s49, s49, 0
s_mul_i32 s49, s49, 393216
buffer_load_dwordx4 v[40:43], v36, s[28:31], s49 offen
s_add_u32 s65, s65, 40960
s_cmp_eq_u32 s65, 122880
s_cselect_b32 s65, 0, s65
s_add_u32 s64, s64, 1
s_waitcnt vmcnt(11)
s_barrier
s_cmp_lg_u32 s88, 2
s_cbranch_scc1 else_8
buffer_load_dwordx4 v[108:111], v18, s[36:39], s83 offen offset:0
buffer_load_dwordx4 v[108:111], v18, s[36:39], s83 offen offset:1024
global_load_dwordx4 v[108:111], v63, s[12:13] offset:-3072
global_load_dwordx4 v[108:111], v63, s[12:13] offset:-2048
global_load_dwordx4 v[108:111], v63, s[12:13] offset:-1024
global_load_dwordx4 v[108:111], v63, s[12:13] offset:0
global_load_dwordx4 v[108:111], v63, s[12:13] offset:1024
global_load_dwordx4 v[108:111], v63, s[12:13] offset:2048
buffer_store_dwordx4 v[56:59], v18, s[32:35], s86 offen offset:0 sc1
buffer_store_dwordx4 v[56:59], v18, s[32:35], s86 offen offset:1024 sc1
buffer_store_dwordx2 v[56:57], v39, s[32:35], s89 offen sc1
buffer_store_dwordx4 v[56:59], v55, s[32:35], 0 offen sc1
else_8:
s_add_u32 s69, s47, 1
s_and_b32 s69, s69, 3
s_add_u32 s69, s69, 12
s_mul_i32 s67, s69, 128
s_mul_i32 s68, s69, s54
s_add_u32 m0, s70, s65
s_nop 0
buffer_load_dwordx4 v20, s[24:27], s67 offen offset:0  lds
buffer_load_dwordx4 v21, s[24:27], s67 offen offset:1024  lds
buffer_load_dwordx4 v22, s[24:27], s67 offen offset:2048  lds
buffer_load_dwordx4 v23, s[24:27], s67 offen offset:3072  lds
s_add_u32 s60, s71, s65
s_add_u32 m0, s60, 0
s_mov_b32 s61, s68
buffer_load_dwordx4 v26, s[28:31], s61 offen lds
buffer_load_dwordx4 v27, s[28:31], s61 offen offset:1024 lds
s_add_u32 m0, s60, 8192
s_add_u32 s61, s61, s53
buffer_load_dwordx4 v26, s[28:31], s61 offen lds
buffer_load_dwordx4 v27, s[28:31], s61 offen offset:1024 lds
s_add_u32 m0, s60, 16384
s_add_u32 s61, s61, s53
buffer_load_dwordx4 v26, s[28:31], s61 offen lds
buffer_load_dwordx4 v27, s[28:31], s61 offen offset:1024 lds
s_add_u32 s49, s76, 2
s_and_b32 s49, s49, 3
s_add_u32 s49, s49, 4
s_mul_i32 s49, s49, 393216
buffer_load_dwordx4 v[40:43], v36, s[28:31], s49 offen
s_add_u32 s65, s65, 40960
s_cmp_eq_u32 s65, 122880
s_cselect_b32 s65, 0, s65
s_add_u32 s64, s64, 1
s_waitcnt vmcnt(11)
s_barrier
s_cmp_lg_u32 s88, 3
s_cbranch_scc1 else_10
buffer_load_dwordx4 v[108:111], v18, s[36:39], s83 offen offset:0
buffer_load_dwordx4 v[108:111], v18, s[36:39], s83 offen offset:1024
global_load_dwordx4 v[108:111], v63, s[12:13] offset:-3072
global_load_dwordx4 v[108:111], v63, s[12:13] offset:-2048
global_load_dwordx4 v[108:111], v63, s[12:13] offset:-1024
global_load_dwordx4 v[108:111], v63, s[12:13] offset:0
global_load_dwordx4 v[108:111], v63, s[12:13] offset:1024
global_load_dwordx4 v[108:111], v63, s[12:13] offset:2048
buffer_store_dwordx4 v[56:59], v18, s[32:35], s86 offen offset:0 sc1
buffer_store_dwordx4 v[56:59], v18, s[32:35], s86 offen offset:1024 sc1
buffer_store_dwordx2 v[56:57], v39, s[32:35], s89 offen sc1
buffer_store_dwordx4 v[56:59], v55, s[32:35], 0 offen sc1
else_10:
s_add_u32 s69, s47, 2
s_and_b32 s69, s69, 3
s_add_u32 s69, s69, 0
s_mul_i32 s67, s69, 128
s_mul_i32 s68, s69, s54
s_add_u32 m0, s70, s65
s_nop 0
buffer_load_dwordx4 v20, s[24:27], s67 offen offset:0  lds
buffer_load_dwordx4 v21, s[24:27], s67 offen offset:1024  lds
buffer_load_dwordx4 v22, s[24:27], s67 offen offset:2048  lds
buffer_load_dwordx4 v23, s[24:27], s67 offen offset:3072  lds
s_add_u32 s60, s71, s65
s_add_u32 m0, s60, 0
s_mov_b32 s61, s68
buffer_load_dwordx4 v26, s[28:31], s61 offen lds
buffer_load_dwordx4 v27, s[28:31], s61 offen offset:1024 lds
s_add_u32 m0, s60, 8192
s_add_u32 s61, s61, s53
buffer_load_dwordx4 v26, s[28:31], s61 offen lds
buffer_load_dwordx4 v27, s[28:31], s61 offen offset:1024 lds
s_add_u32 m0, s60, 16384
s_add_u32 s61, s61, s53
buffer_load_dwordx4 v26, s[28:31], s61 offen lds
buffer_load_dwordx4 v27, s[28:31], s61 offen offset:1024 lds
s_add_u32 s49, s76, 2
s_and_b32 s49, s49, 3
s_add_u32 s49, s49, 8
s_mul_i32 s49, s49, 393216
buffer_load_dwordx4 v[40:43], v36, s[28:31], s49 offen
s_add_u32 s65, s65, 40960
s_cmp_eq_u32 s65, 122880
s_cselect_b32 s65, 0, s65
s_add_u32 s64, s64, 1
s_waitcnt vmcnt(11)
s_barrier
s_cmp_lg_u32 s88, 4
s_cbranch_scc1 else_12
buffer_load_dwordx4 v[108:111], v18, s[36:39], s83 offen offset:0
buffer_load_dwordx4 v[108:111], v18, s[36:39], s83 offen offset:1024
global_load_dwordx4 v[108:111], v63, s[12:13] offset:-3072
global_load_dwordx4 v[108:111], v63, s[12:13] offset:-2048
global_load_dwordx4 v[108:111], v63, s[12:13] offset:-1024
global_load_dwordx4 v[108:111], v63, s[12:13] offset:0
global_load_dwordx4 v[108:111], v63, s[12:13] offset:1024
global_load_dwordx4 v[108:111], v63, s[12:13] offset:2048
buffer_store_dwordx4 v[56:59], v18, s[32:35], s86 offen offset:0 sc1
buffer_store_dwordx4 v[56:59], v18, s[32:35], s86 offen offset:1024 sc1
buffer_store_dwordx2 v[56:57], v39, s[32:35], s89 offen sc1
buffer_store_dwordx4 v[56:59], v55, s[32:35], 0 offen sc1
else_12:
s_add_u32 s69, s47, 2
s_and_b32 s69, s69, 3
s_add_u32 s69, s69, 4
s_mul_i32 s67, s69, 128
s_mul_i32 s68, s69, s54
s_add_u32 m0, s70, s65
s_nop 0
buffer_load_dwordx4 v20, s[24:27], s67 offen offset:0  lds
buffer_load_dwordx4 v21, s[24:27], s67 offen offset:1024  lds
buffer_load_dwordx4 v22, s[24:27], s67 offen offset:2048  lds
buffer_load_dwordx4 v23, s[24:27], s67 offen offset:3072  lds
s_add_u32 s60, s71, s65
s_add_u32 m0, s60, 0
s_mov_b32 s61, s68
buffer_load_dwordx4 v26, s[28:31], s61 offen lds
buffer_load_dwordx4 v27, s[28:31], s61 offen offset:1024 lds
s_add_u32 m0, s60, 8192
s_add_u32 s61, s61, s53
buffer_load_dwordx4 v26, s[28:31], s61 offen lds
buffer_load_dwordx4 v27, s[28:31], s61 offen offset:1024 lds
s_add_u32 m0, s60, 16384
s_add_u32 s61, s61, s53
buffer_load_dwordx4 v26, s[28:31], s61 offen lds
buffer_load_dwordx4 v27, s[28:31], s61 offen offset:1024 lds
s_add_u32 s49, s76, 2
s_and_b32 s49, s49, 3
s_add_u32 s49, s49, 12
s_mul_i32 s49, s49, 393216
buffer_load_dwordx4 v[40:43], v36, s[28:31], s49 offen
s_add_u32 s65, s65, 40960
s_cmp_eq_u32 s65, 122880
s_cselect_b32 s65, 0, s65
s_add_u32 s64, s64, 1
s_waitcnt vmcnt(11)
s_barrier
s_cmp_lg_u32 s88, 5
s_cbranch_scc1 else_14
buffer_load_dwordx4 v[108:111], v18, s[36:39], s83 offen offset:0
buffer_load_dwordx4 v[108:111], v18, s[36:39], s83 offen offset:1024
global_load_dwordx4 v[108:111], v63, s[12:13] offset:-3072
global_load_dwordx4 v[108:111], v63, s[12:13] offset:-2048
global_load_dwordx4 v[108:111], v63, s[12:13] offset:-1024
global_load_dwordx4 v[108:111], v63, s[12:13] offset:0
global_load_dwordx4 v[108:111], v63, s[12:13] offset:1024
global_load_dwordx4 v[108:111], v63, s[12:13] offset:2048
buffer_store_dwordx4 v[56:59], v18, s[32:35], s86 offen offset:0 sc1
buffer_store_dwordx4 v[56:59], v18, s[32:35], s86 offen offset:1024 sc1
buffer_store_dwordx2 v[56:57], v39, s[32:35], s89 offen sc1
buffer_store_dwordx4 v[56:59], v55, s[32:35], 0 offen sc1
else_14:
s_add_u32 s69, s47, 2
s_and_b32 s69, s69, 3
s_add_u32 s69, s69, 8
s_mul_i32 s67, s69, 128
s_mul_i32 s68, s69, s54
s_add_u32 m0, s70, s65
s_nop 0
buffer_load_dwordx4 v20, s[24:27], s67 offen offset:0  lds
buffer_load_dwordx4 v21, s[24:27], s67 offen offset:1024  lds
buffer_load_dwordx4 v22, s[24:27], s67 offen offset:2048  lds
buffer_load_dwordx4 v23, s[24:27], s67 offen offset:3072  lds
s_add_u32 s60, s71, s65
s_add_u32 m0, s60, 0
s_mov_b32 s61, s68
buffer_load_dwordx4 v26, s[28:31], s61 offen lds
buffer_load_dwordx4 v27, s[28:31], s61 offen offset:1024 lds
s_add_u32 m0, s60, 8192
s_add_u32 s61, s61, s53
buffer_load_dwordx4 v26, s[28:31], s61 offen lds
buffer_load_dwordx4 v27, s[28:31], s61 offen offset:1024 lds
s_add_u32 m0, s60, 16384
s_add_u32 s61, s61, s53
buffer_load_dwordx4 v26, s[28:31], s61 offen lds
buffer_load_dwordx4 v27, s[28:31], s61 offen offset:1024 lds
s_add_u32 s49, s76, 3
s_and_b32 s49, s49, 3
s_add_u32 s49, s49, 0
s_mul_i32 s49, s49, 393216
buffer_load_dwordx4 v[40:43], v36, s[28:31], s49 offen
s_add_u32 s65, s65, 40960
s_cmp_eq_u32 s65, 122880
s_cselect_b32 s65, 0, s65
s_add_u32 s64, s64, 1
s_waitcnt vmcnt(11)
s_barrier
s_cmp_lg_u32 s88, 6
s_cbranch_scc1 else_16
buffer_load_dwordx4 v[108:111], v18, s[36:39], s83 offen offset:0
buffer_load_dwordx4 v[108:111], v18, s[36:39], s83 offen offset:1024
global_load_dwordx4 v[108:111], v63, s[12:13] offset:-3072
global_load_dwordx4 v[108:111], v63, s[12:13] offset:-2048
global_load_dwordx4 v[108:111], v63, s[12:13] offset:-1024
global_load_dwordx4 v[108:111], v63, s[12:13] offset:0
global_load_dwordx4 v[108:111], v63, s[12:13] offset:1024
global_load_dwordx4 v[108:111], v63, s[12:13] offset:2048
buffer_store_dwordx4 v[56:59], v18, s[32:35], s86 offen offset:0 sc1
buffer_store_dwordx4 v[56:59], v18, s[32:35], s86 offen offset:1024 sc1
buffer_store_dwordx2 v[56:57], v39, s[32:35], s89 offen sc1
buffer_store_dwordx4 v[56:59], v55, s[32:35], 0 offen sc1
else_16:
s_add_u32 s69, s47, 2
s_and_b32 s69, s69, 3
s_add_u32 s69, s69, 12
s_mul_i32 s67, s69, 128
s_mul_i32 s68, s69, s54
s_add_u32 m0, s70, s65
s_nop 0
buffer_load_dwordx4 v20, s[24:27], s67 offen offset:0  lds
buffer_load_dwordx4 v21, s[24:27], s67 offen offset:1024  lds
buffer_load_dwordx4 v22, s[24:27], s67 offen offset:2048  lds
buffer_load_dwordx4 v23, s[24:27], s67 offen offset:3072  lds
s_add_u32 s60, s71, s65
s_add_u32 m0, s60, 0
s_mov_b32 s61, s68
buffer_load_dwordx4 v26, s[28:31], s61 offen lds
buffer_load_dwordx4 v27, s[28:31], s61 offen offset:1024 lds
s_add_u32 m0, s60, 8192
s_add_u32 s61, s61, s53
buffer_load_dwordx4 v26, s[28:31], s61 offen lds
buffer_load_dwordx4 v27, s[28:31], s61 offen offset:1024 lds
s_add_u32 m0, s60, 16384
s_add_u32 s61, s61, s53
buffer_load_dwordx4 v26, s[28:31], s61 offen lds
buffer_load_dwordx4 v27, s[28:31], s61 offen offset:1024 lds
s_add_u32 s49, s76, 3
s_and_b32 s49, s49, 3
s_add_u32 s49, s49, 4
s_mul_i32 s49, s49, 393216
buffer_load_dwordx4 v[40:43], v36, s[28:31], s49 offen
s_add_u32 s65, s65, 40960
s_cmp_eq_u32 s65, 122880
s_cselect_b32 s65, 0, s65
s_add_u32 s64, s64, 1
s_waitcnt vmcnt(11)
s_barrier
s_cmp_lg_u32 s88, 7
s_cbranch_scc1 else_18
buffer_load_dwordx4 v[108:111], v18, s[36:39], s83 offen offset:0
buffer_load_dwordx4 v[108:111], v18, s[36:39], s83 offen offset:1024
global_load_dwordx4 v[108:111], v63, s[12:13] offset:-3072
global_load_dwordx4 v[108:111], v63, s[12:13] offset:-2048
global_load_dwordx4 v[108:111], v63, s[12:13] offset:-1024
global_load_dwordx4 v[108:111], v63, s[12:13] offset:0
global_load_dwordx4 v[108:111], v63, s[12:13] offset:1024
global_load_dwordx4 v[108:111], v63, s[12:13] offset:2048
buffer_store_dwordx4 v[56:59], v18, s[32:35], s86 offen offset:0 sc1
buffer_store_dwordx4 v[56:59], v18, s[32:35], s86 offen offset:1024 sc1
buffer_store_dwordx2 v[56:57], v39, s[32:35], s89 offen sc1
buffer_store_dwordx4 v[56:59], v55, s[32:35], 0 offen sc1
else_18:
s_add_u32 s69, s47, 3
s_and_b32 s69, s69, 3
s_add_u32 s69, s69, 0
s_mul_i32 s67, s69, 128
s_mul_i32 s68, s69, s54
s_add_u32 m0, s70, s65
s_nop 0
buffer_load_dwordx4 v20, s[24:27], s67 offen offset:0  lds
buffer_load_dwordx4 v21, s[24:27], s67 offen offset:1024  lds
buffer_load_dwordx4 v22, s[24:27], s67 offen offset:2048  lds
buffer_load_dwordx4 v23, s[24:27], s67 offen offset:3072  lds
s_add_u32 s60, s71, s65
s_add_u32 m0, s60, 0
s_mov_b32 s61, s68
buffer_load_dwordx4 v26, s[28:31], s61 offen lds
buffer_load_dwordx4 v27, s[28:31], s61 offen offset:1024 lds
s_add_u32 m0, s60, 8192
s_add_u32 s61, s61, s53
buffer_load_dwordx4 v26, s[28:31], s61 offen lds
buffer_load_dwordx4 v27, s[28:31], s61 offen offset:1024 lds
s_add_u32 m0, s60, 16384
s_add_u32 s61, s61, s53
buffer_load_dwordx4 v26, s[28:31], s61 offen lds
buffer_load_dwordx4 v27, s[28:31], s61 offen offset:1024 lds
s_add_u32 s49, s76, 3
s_and_b32 s49, s49, 3
s_add_u32 s49, s49, 8
s_mul_i32 s49, s49, 393216
buffer_load_dwordx4 v[40:43], v36, s[28:31], s49 offen
s_add_u32 s65, s65, 40960
s_cmp_eq_u32 s65, 122880
s_cselect_b32 s65, 0, s65
s_add_u32 s64, s64, 1
s_waitcnt vmcnt(11)
s_barrier
s_add_u32 s69, s47, 3
s_and_b32 s69, s69, 3
s_add_u32 s69, s69, 4
s_mul_i32 s67, s69, 128
s_mul_i32 s68, s69, s54
s_add_u32 m0, s70, s65
s_nop 0
buffer_load_dwordx4 v20, s[24:27], s67 offen offset:0  lds
buffer_load_dwordx4 v21, s[24:27], s67 offen offset:1024  lds
buffer_load_dwordx4 v22, s[24:27], s67 offen offset:2048  lds
buffer_load_dwordx4 v23, s[24:27], s67 offen offset:3072  lds
s_add_u32 s60, s71, s65
s_add_u32 m0, s60, 0
s_mov_b32 s61, s68
buffer_load_dwordx4 v26, s[28:31], s61 offen lds
buffer_load_dwordx4 v27, s[28:31], s61 offen offset:1024 lds
s_add_u32 m0, s60, 8192
s_add_u32 s61, s61, s53
buffer_load_dwordx4 v26, s[28:31], s61 offen lds
buffer_load_dwordx4 v27, s[28:31], s61 offen offset:1024 lds
s_add_u32 m0, s60, 16384
s_add_u32 s61, s61, s53
buffer_load_dwordx4 v26, s[28:31], s61 offen lds
buffer_load_dwordx4 v27, s[28:31], s61 offen offset:1024 lds
s_add_u32 s49, s76, 3
s_and_b32 s49, s49, 3
s_add_u32 s49, s49, 12
s_mul_i32 s49, s49, 393216
buffer_load_dwordx4 v[40:43], v36, s[28:31], s49 offen
s_add_u32 s65, s65, 40960
s_cmp_eq_u32 s65, 122880
s_cselect_b32 s65, 0, s65
s_add_u32 s64, s64, 1
s_waitcnt vmcnt(11)
s_barrier
global_load_dwordx2 v[34:35], v32, s[20:21] sc1
s_add_u32 s69, s47, 3
s_and_b32 s69, s69, 3
s_add_u32 s69, s69, 8
s_mul_i32 s67, s69, 128
s_mul_i32 s68, s69, s54
s_add_u32 m0, s70, s65
s_nop 0
buffer_load_dwordx4 v20, s[24:27], s67 offen offset:0  lds
buffer_load_dwordx4 v21, s[24:27], s67 offen offset:1024  lds
buffer_load_dwordx4 v22, s[24:27], s67 offen offset:2048  lds
buffer_load_dwordx4 v23, s[24:27], s67 offen offset:3072  lds
s_add_u32 s60, s71, s65
s_add_u32 m0, s60, 0
s_mov_b32 s61, s68
buffer_load_dwordx4 v26, s[28:31], s61 offen lds
buffer_load_dwordx4 v27, s[28:31], s61 offen offset:1024 lds
s_add_u32 m0, s60, 8192
s_add_u32 s61, s61, s53
buffer_load_dwordx4 v26, s[28:31], s61 offen lds
buffer_load_dwordx4 v27, s[28:31], s61 offen offset:1024 lds
s_add_u32 m0, s60, 16384
s_add_u32 s61, s61, s53
buffer_load_dwordx4 v26, s[28:31], s61 offen lds
buffer_load_dwordx4 v27, s[28:31], s61 offen offset:1024 lds
s_add_u32 s65, s65, 40960
s_cmp_eq_u32 s65, 122880
s_cselect_b32 s65, 0, s65
s_add_u32 s64, s64, 1
s_waitcnt vmcnt(10)
s_barrier
s_mov_b32 s63, 0
ipoll_20:
v_sad_u8 v4, v34, 0, 0
v_sad_u8 v4, v35, 0, v4
v_cmp_gt_u32 vcc, 32, v4
s_cbranch_vccz ipolled_21
global_load_dwordx2 v[34:35], v32, s[20:21] sc1
s_add_u32 s63, s63, 1
s_cmp_lt_u32 s63, 0x80000
s_waitcnt vmcnt(0)
s_cbranch_scc1 ipoll_20
ipolled_21:
s_add_u32 s69, s47, 3
s_and_b32 s69, s69, 3
s_add_u32 s69, s69, 12
s_mul_i32 s67, s69, 128
s_mul_i32 s68, s69, s54
s_add_u32 m0, s70, 0
s_nop 0
buffer_load_dwordx4 v20, s[24:27], s67 offen offset:0  lds
buffer_load_dwordx4 v21, s[24:27], s67 offen offset:1024  lds
buffer_load_dwordx4 v22, s[24:27], s67 offen offset:2048  lds
buffer_load_dwordx4 v23, s[24:27], s67 offen offset:3072  lds
s_add_u32 s60, s71, 0
s_add_u32 m0, s60, 0
s_mov_b32 s61, s68
buffer_load_dwordx4 v26, s[28:31], s61 offen lds
buffer_load_dwordx4 v27, s[28:31], s61 offen offset:1024 lds
s_add_u32 m0, s60, 8192
s_add_u32 s61, s61, s53
buffer_load_dwordx4 v26, s[28:31], s61 offen lds
buffer_load_dwordx4 v27, s[28:31], s61 offen offset:1024 lds
s_add_u32 m0, s60, 16384
s_add_u32 s61, s61, s53
buffer_load_dwordx4 v26, s[28:31], s61 offen lds
buffer_load_dwordx4 v27, s[28:31], s61 offen offset:1024 lds
s_waitcnt vmcnt(10)
s_barrier
s_setprio 0
buffer_load_dwordx4 v[80:83], v37, s[32:35], 0 offen offset:0 sc1
buffer_load_dwordx4 v[84:87], v37, s[32:35], 0 offen offset:1024 sc1
buffer_load_dwordx4 v[88:91], v37, s[32:35], 0 offen offset:2048 sc1
buffer_load_dwordx4 v[92:95], v37, s[32:35], 0 offen offset:3072 sc1
global_load_dword v48, v54, s[98:99]
buffer_load_dwordx4 v[64:67], v38, s[32:35], 0 offen offset:0 sc1
buffer_load_dwordx4 v[68:71], v38, s[32:35], 0 offen offset:1024 sc1
buffer_load_dwordx4 v[72:75], v38, s[32:35], 0 offen offset:2048 sc1
buffer_load_dwordx4 v[76:79], v38, s[32:35], 0 offen offset:3072 sc1
s_add_u32 s48, s75, 15
s_and_b32 s48, s48, 15
s_mul_i32 s48, s48, s57
s_add_u32 m0, s71, 106496
s_nop 0
buffer_load_dwordx4 v28, s[36:39], s48 offen lds
buffer_load_dwordx4 v29, s[36:39], s48 offen offset:1024 lds
s_waitcnt vmcnt(11)
s_barrier
s_add_u32 s48, s75, 5
s_and_b32 s48, s48, 15
s_mul_i32 s48, s48, s57
s_add_u32 m0, s71, 24576
s_nop 0
buffer_load_dwordx4 v28, s[36:39], s48 offen lds
buffer_load_dwordx4 v29, s[36:39], s48 offen offset:1024 lds
s_waitcnt vmcnt(4)
s_add_u32 s48, s75, 6
s_and_b32 s48, s48, 15
s_mul_i32 s48, s48, s57
s_add_u32 m0, s71, 32768
s_nop 0
buffer_load_dwordx4 v28, s[36:39], s48 offen lds
v_add_f32 v80, v80, v88
v_add_f32 v64, v64, v72
v_add_f32 v81, v81, v89
v_add_f32 v65, v65, v73
v_add_f32 v82, v82, v90
v_add_f32 v66, v66, v74
v_add_f32 v83, v83, v91
v_add_f32 v67, v67, v75
v_add_f32 v84, v84, v92
v_add_f32 v68, v68, v76
buffer_load_dwordx4 v29, s[36:39], s48 offen offset:1024 lds
v_add_f32 v85, v85, v93
v_add_f32 v69, v69, v77
v_add_f32 v86, v86, v94
v_add_f32 v70, v70, v78
v_add_f32 v87, v87, v95
v_add_f32 v71, v71, v79
v_add_f32 v80, v80, v84
v_add_f32 v64, v64, v68
v_add_f32 v81, v81, v85
v_add_f32 v65, v65, v69
s_add_u32 s48, s75, 7
s_and_b32 s48, s48, 15
s_mul_i32 s48, s48, s57
s_add_u32 m0, s71, 40960
s_nop 0
buffer_load_dwordx4 v28, s[36:39], s48 offen lds
v_add_f32 v82, v82, v86
v_add_f32 v66, v66, v70
v_add_f32 v83, v83, v87
v_add_f32 v67, v67, v71
s_nop 1
s_nop 1
v_permlane32_swap_b32 v80, v81
v_permlane32_swap_b32 v64, v65
v_permlane32_swap_b32 v82, v83
buffer_load_dwordx4 v29, s[36:39], s48 offen offset:1024 lds
v_permlane32_swap_b32 v66, v67
v_add_f32 v80, v80, v81
v_add_f32 v64, v64, v65
v_add_f32 v82, v82, v83
v_add_f32 v66, v66, v67
s_nop 1
s_nop 1
v_permlane16_swap_b32 v80, v82
v_permlane16_swap_b32 v64, v66
s_nop 0
s_add_u32 s48, s75, 8
s_and_b32 s48, s48, 15
s_mul_i32 s48, s48, s57
s_add_u32 m0, s71, 49152
s_nop 0
buffer_load_dwordx4 v28, s[36:39], s48 offen lds
s_nop 0
v_add_f32 v80, v80, v82
v_add_f32 v64, v64, v66
v_cmp_u_f32 vcc, v80, v80
s_cbranch_vccnz again_22
summed_23:
v_cmp_u_f32 vcc, v64, v64
s_cbranch_vccnz again_25
summed_26:
v_mul_f32 v44, 0x3a800000, v80
ds_write_b32 v53, v64
v_mov_b32 v45, v44
s_nop 1
v_permlane16_swap_b32 v44, v45
buffer_load_dwordx4 v29, s[36:39], s48 offen offset:1024 lds
s_nop 0
v_fma_f32 v45, -v44, v44, v45
v_max_f32 v45, 0, v45
v_add_f32 v45, 0x3727c5ac, v45
v_rsq_f32 v46, v45
v_sub_f32 v47, 0, v44
ds_write_b32 v50, v47 offset:512
ds_write_b64 v49, v[46:47]
ds_write_b32 v50, v46
s_cmp_lg_u32 s43, 2
s_cbranch_scc1 else_28
s_and_b32 s50, s2, 7
v_readlane_b32 s58, v34, s50
v_readlane_b32 s59, v35, s50
s_lshl_b64 s[48:49], s[94:95], 5
v_mov_b32 v4, 134656
s_nop 1
s_cmp_eq_u64 s[48:49], s[58:59]
s_cselect_b32 s48, 1, 0
v_mov_b32 v5, s48
ds_write_b32 v4, v5
else_28:
s_setprio 0
s_waitcnt lgkmcnt(0)
s_waitcnt vmcnt(63)
s_barrier
s_waitcnt vmcnt(4)
s_add_u32 s48, s75, 9
s_and_b32 s48, s48, 15
s_mul_i32 s48, s48, s57
s_add_u32 m0, s71, 57344
s_nop 0
buffer_load_dwordx4 v28, s[36:39], s48 offen lds
buffer_load_dwordx4 v29, s[36:39], s48 offen offset:1024 lds
s_waitcnt vmcnt(4)
s_add_u32 s48, s75, 10
s_and_b32 s48, s48, 15
s_mul_i32 s48, s48, s57
s_add_u32 m0, s71, 65536
s_nop 0
buffer_load_dwordx4 v28, s[36:39], s48 offen lds
buffer_load_dwordx4 v29, s[36:39], s48 offen offset:1024 lds
s_waitcnt vmcnt(4)
s_add_u32 s48, s75, 11
s_and_b32 s48, s48, 15
s_mul_i32 s48, s48, s57
s_add_u32 m0, s71, 73728
s_nop 0
buffer_load_dwordx4 v28, s[36:39], s48 offen lds
buffer_load_dwordx4 v29, s[36:39], s48 offen offset:1024 lds
s_waitcnt vmcnt(4)
s_add_u32 s48, s75, 12
s_and_b32 s48, s48, 15
s_mul_i32 s48, s48, s57
s_add_u32 m0, s71, 81920
s_nop 0
buffer_load_dwordx4 v28, s[36:39], s48 offen lds
buffer_load_dwordx4 v29, s[36:39], s48 offen offset:1024 lds
s_waitcnt vmcnt(4)
s_add_u32 s48, s75, 13
s_and_b32 s48, s48, 15
s_mul_i32 s48, s48, s57
s_add_u32 m0, s71, 90112
s_nop 0
buffer_load_dwordx4 v28, s[36:39], s48 offen lds
buffer_load_dwordx4 v29, s[36:39], s48 offen offset:1024 lds
s_waitcnt vmcnt(4)
s_add_u32 s48, s75, 14
s_and_b32 s48, s48, 15
s_mul_i32 s48, s48, s57
s_add_u32 m0, s71, 98304
s_nop 0
buffer_load_dwordx4 v28, s[36:39], s48 offen lds
buffer_load_dwordx4 v29, s[36:39], s48 offen offset:1024 lds
s_waitcnt vmcnt(4)
s_add_u32 s48, s75, 0
s_and_b32 s48, s48, 15
s_mul_i32 s48, s48, s57
s_add_u32 m0, s71, 4294950912
s_nop 0
buffer_load_dwordx4 v28, s[36:39], s48 offen lds
buffer_load_dwordx4 v29, s[36:39], s48 offen offset:1024 lds
s_waitcnt vmcnt(4)
s_add_u32 s48, s75, 1
s_and_b32 s48, s48, 15
s_mul_i32 s48, s48, s57
s_add_u32 m0, s71, 4294959104
s_nop 0
buffer_load_dwordx4 v28, s[36:39], s48 offen lds
buffer_load_dwordx4 v29, s[36:39], s48 offen offset:1024 lds
s_waitcnt vmcnt(4)
s_add_u32 s48, s75, 2
s_and_b32 s48, s48, 15
s_mul_i32 s48, s48, s57
s_add_u32 m0, s71, 0
s_nop 0
buffer_load_dwordx4 v28, s[36:39], s48 offen lds
buffer_load_dwordx4 v29, s[36:39], s48 offen offset:1024 lds
s_waitcnt vmcnt(4)
s_add_u32 s48, s75, 3
s_and_b32 s48, s48, 15
s_mul_i32 s48, s48, s57
s_add_u32 m0, s71, 8192
s_nop 0
buffer_load_dwordx4 v28, s[36:39], s48 offen lds
buffer_load_dwordx4 v29, s[36:39], s48 offen offset:1024 lds
s_waitcnt vmcnt(4)
s_add_u32 s48, s75, 4
s_and_b32 s48, s48, 15
s_mul_i32 s48, s48, s57
s_add_u32 m0, s71, 16384
s_nop 0
buffer_load_dwordx4 v28, s[36:39], s48 offen lds
buffer_load_dwordx4 v29, s[36:39], s48 offen offset:1024 lds
s_mov_b32 s28, s12
s_and_b32 s29, s13, 0xffff
s_mov_b32 s30, 6291456
s_mov_b32 s31, 0x00020000
v_mov_b32 v26, v60
v_mov_b32 v27, v61
v_mov_b32 v28, v24
v_mov_b32 v29, v25
s_cmp_ge_i32 s55, 0
s_cselect_b32 s53, 128, s53
s_cselect_b32 s54, 24576, s54
s_cmp_ge_i32 s56, 0
s_cselect_b32 s57, 8192, s57
s_and_b32 s48, s2, 7
s_add_u32 s47, s42, s48
s_and_b32 s47, s47, 7
s_mul_i32 s47, s47, 2
s_and_b32 s50, s42, 8
s_or_b32 s50, s50, 3
s_and_b32 s48, s2, 7
s_add_u32 s76, s50, s48
s_and_b32 s76, s76, 7
s_mul_i32 s76, s76, 2
s_add_u32 s69, s47, 0
s_and_b32 s69, s69, 15
s_mul_i32 s67, s69, 128
s_mul_i32 s68, s69, s54
s_waitcnt vmcnt(0) lgkmcnt(0)
s_barrier
s_add_u32 s60, s71, 122880
s_add_u32 m0, s60, 0
s_mov_b32 s61, s68
buffer_load_dwordx4 v26, s[28:31], s61 offen lds
buffer_load_dwordx4 v27, s[28:31], s61 offen offset:1024 lds
s_add_u32 m0, s60, 8192
s_add_u32 s61, s61, s53
buffer_load_dwordx4 v26, s[28:31], s61 offen lds
buffer_load_dwordx4 v27, s[28:31], s61 offen offset:1024 lds
s_add_u32 m0, s60, 16384
s_add_u32 s61, s61, s53
buffer_load_dwordx4 v26, s[28:31], s61 offen lds
buffer_load_dwordx4 v27, s[28:31], s61 offen offset:1024 lds
s_mov_b32 s36, s14
s_and_b32 s37, s15, 0xffff
s_mov_b32 s38, 65536
s_mov_b32 s39, 0x00020000
s_lshl_b32 s48, s42, 12
s_lshl_b32 s49, s43, 10
s_add_u32 s48, s48, s49
s_add_u32 m0, s49, 135168
s_nop 0
buffer_load_dwordx4 v18, s[36:39], s48 offen lds
ds_read_b128 v[232:235], v52 offset:57344
ds_read_b128 v[236:239], v52 offset:58368
ds_read_b128 v[152:155], v51 offset:40960
ds_read_b128 v[156:159], v51 offset:41984
ds_read_b128 v[160:163], v51 offset:49152
ds_read_b128 v[164:167], v51 offset:50176
ds_read_b128 v[168:171], v51 offset:57344
ds_read_b128 v[172:175], v51 offset:58368
ds_read_b128 v[176:179], v52 offset:0
ds_read_b128 v[180:183], v52 offset:1024
ds_read_b128 v[184:187], v52 offset:8192
ds_read_b128 v[188:191], v52 offset:9216
ds_read_b128 v[192:195], v52 offset:16384
ds_read_b128 v[196:199], v52 offset:17408
ds_read_b128 v[200:203], v52 offset:24576
ds_read_b128 v[204:207], v52 offset:25600
ds_read_b128 v[208:211], v52 offset:32768
ds_read_b128 v[212:215], v52 offset:33792
ds_read_b128 v[216:219], v52 offset:40960
ds_read_b128 v[220:223], v52 offset:41984
ds_read_b128 v[224:227], v52 offset:49152
ds_read_b128 v[228:231], v52 offset:50176
ds_read_b128 v[112:115], v51 offset:0
ds_read_b128 v[116:119], v51 offset:1024
ds_read_b128 v[120:123], v51 offset:8192
ds_read_b128 v[124:127], v51 offset:9216
ds_read_b128 v[128:131], v51 offset:16384
ds_read_b128 v[132:135], v51 offset:17408
ds_read_b128 v[136:139], v51 offset:24576
ds_read_b128 v[140:143], v51 offset:25600
ds_read_b128 v[144:147], v51 offset:32768
ds_read_b128 v[148:151], v51 offset:33792
s_add_u32 s48, s80, 0
v_add_u32 v20, s48, v18
v_mov_b32 v21, v20
v_add_u32 v22, 30720, v20
v_mov_b32 v23, v22
v_add_u32 v37, 262144, v37
s_lshl_b32 s50, s42, 2
s_add_u32 s50, s50, s43
s_lshl_b32 s50, s50, 12
s_add_u32 s50, s50, 18087936
v_add_u32 v38, s50, v18
v_min_u32 v4, 2, v3
v_lshlrev_b32 v4, 8, v4
v_lshl_add_u32 v4, v2, 2, v4
s_and_b32 s48, s43, 1
s_lshl_b32 s48, s48, 7
s_lshr_b32 s49, s43, 1
s_lshl_b32 s49, s49, 6
s_add_u32 s48, s48, s49
s_add_u32 s48, s48, 133888
v_add_u32 v53, s48, v4
s_getpc_b64 s[98:99]
pc_30:
s_add_u32 s98, s98, c1_last - pc_30
s_addc_u32 s99, s99, 0
s_lshr_b32 s50, s2, 3
s_lshl_b32 s50, s50, 2
s_add_u32 s50, s50, s43
s_lshl_b32 s50, s50, 7
v_and_b32 v4, 1, v0
v_lshl_add_u32 v4, v4, 6, s50
v_min_u32 v54, L_code_end - c1_last, v4
s_waitcnt vmcnt(0) lgkmcnt(0)
s_add_u32 s69, s47, 1
s_and_b32 s69, s69, 15
s_mul_i32 s67, s69, 2048
s_mul_i32 s68, s69, s54
s_barrier
s_add_u32 s60, s71, 40960
s_add_u32 m0, s60, 0
s_mov_b32 s61, s68
buffer_load_dwordx4 v26, s[28:31], s61 offen lds
buffer_load_dwordx4 v27, s[28:31], s61 offen offset:1024 lds
s_add_u32 m0, s60, 8192
s_add_u32 s61, s61, s53
buffer_load_dwordx4 v26, s[28:31], s61 offen lds
buffer_load_dwordx4 v27, s[28:31], s61 offen offset:1024 lds
s_add_u32 m0, s60, 16384
s_add_u32 s61, s61, s53
buffer_load_dwordx4 v26, s[28:31], s61 offen lds
buffer_load_dwordx4 v27, s[28:31], s61 offen offset:1024 lds
s_add_u32 s49, s76, 2
s_and_b32 s49, s49, 15
s_mul_i32 s49, s49, 393216
buffer_load_dwordx4 v[40:43], v36, s[28:31], s49 offen
s_add_u32 s49, s76, 3
s_and_b32 s49, s49, 15
s_mul_i32 s49, s49, 393216
buffer_load_dwordx4 v[40:43], v36, s[28:31], s49 offen
buffer_load_dword v5, v30, s[32:35], s79 offen sc1
s_mov_b32 s63, 0
s_waitcnt vmcnt(0)
poll_31:
v_cmp_gt_u32 vcc, 1, v5
s_cbranch_vccz polled_32
buffer_load_dword v5, v30, s[32:35], s79 offen sc1
s_add_u32 s63, s63, 1
s_cmp_lt_u32 s63, 0x80000
s_waitcnt vmcnt(0)
s_cbranch_scc1 poll_31
polled_32:
s_add_u32 s69, s47, 0
s_and_b32 s69, s69, 15
s_mul_i32 s67, s69, 2048
s_mul_i32 s68, s69, s54
s_add_u32 m0, s70, 0
s_nop 0
buffer_load_dwordx4 v20, s[32:35], s67 offen offset:0 sc1 lds
buffer_load_dwordx4 v21, s[32:35], s67 offen offset:1024 sc1 lds
buffer_load_dwordx4 v22, s[32:35], s67 offen offset:2048 sc1 lds
buffer_load_dwordx4 v23, s[32:35], s67 offen offset:3072 sc1 lds
s_add_u32 s69, s47, 1
s_and_b32 s69, s69, 15
s_mul_i32 s67, s69, 2048
s_mul_i32 s68, s69, s54
s_add_u32 m0, s70, 40960
s_nop 0
buffer_load_dwordx4 v20, s[32:35], s67 offen offset:0 sc1 lds
buffer_load_dwordx4 v21, s[32:35], s67 offen offset:1024 sc1 lds
buffer_load_dwordx4 v22, s[32:35], s67 offen offset:2048 sc1 lds
buffer_load_dwordx4 v23, s[32:35], s67 offen offset:3072 sc1 lds
s_waitcnt vmcnt(4) lgkmcnt(0)
s_barrier
s_add_u32 s69, s47, 2
s_and_b32 s69, s69, 15
s_mul_i32 s67, s69, 2048
s_mul_i32 s68, s69, s54
s_add_u32 m0, s70, 81920
s_nop 0
buffer_load_dwordx4 v20, s[32:35], s67 offen offset:0 sc1 lds
buffer_load_dwordx4 v21, s[32:35], s67 offen offset:1024 sc1 lds
buffer_load_dwordx4 v22, s[32:35], s67 offen offset:2048 sc1 lds
buffer_load_dwordx4 v23, s[32:35], s67 offen offset:3072 sc1 lds
s_add_u32 s60, s71, 81920
s_add_u32 m0, s60, 0
s_mov_b32 s61, s68
buffer_load_dwordx4 v26, s[28:31], s61 offen lds
buffer_load_dwordx4 v27, s[28:31], s61 offen offset:1024 lds
s_add_u32 m0, s60, 8192
s_add_u32 s61, s61, s53
buffer_load_dwordx4 v26, s[28:31], s61 offen lds
buffer_load_dwordx4 v27, s[28:31], s61 offen offset:1024 lds
s_add_u32 m0, s60, 16384
s_add_u32 s61, s61, s53
buffer_load_dwordx4 v26, s[28:31], s61 offen lds
buffer_load_dwordx4 v27, s[28:31], s61 offen offset:1024 lds
s_add_u32 s49, s76, 4
s_and_b32 s49, s49, 15
s_mul_i32 s49, s49, 393216
buffer_load_dwordx4 v[40:43], v36, s[28:31], s49 offen
s_mov_b32 s64, 0
s_mov_b32 s65, 0
h1_loop:
s_waitcnt vmcnt(11)
s_barrier
s_add_u32 s69, s69, 1
s_and_b32 s69, s69, 15
s_mul_i32 s67, s69, 2048
s_mul_i32 s68, s69, s54
s_add_u32 m0, s70, s65
s_nop 0
buffer_load_dwordx4 v20, s[32:35], s67 offen offset:0 sc1 lds
buffer_load_dwordx4 v21, s[32:35], s67 offen offset:1024 sc1 lds
buffer_load_dwordx4 v22, s[32:35], s67 offen offset:2048 sc1 lds
buffer_load_dwordx4 v23, s[32:35], s67 offen offset:3072 sc1 lds
s_add_u32 s60, s71, s65
s_add_u32 m0, s60, 0
s_mov_b32 s61, s68
buffer_load_dwordx4 v26, s[28:31], s61 offen lds
buffer_load_dwordx4 v27, s[28:31], s61 offen offset:1024 lds
s_add_u32 m0, s60, 8192
s_add_u32 s61, s61, s53
buffer_load_dwordx4 v26, s[28:31], s61 offen lds
buffer_load_dwordx4 v27, s[28:31], s61 offen offset:1024 lds
s_add_u32 m0, s60, 16384
s_add_u32 s61, s61, s53
buffer_load_dwordx4 v26, s[28:31], s61 offen lds
buffer_load_dwordx4 v27, s[28:31], s61 offen offset:1024 lds
s_add_u32 s48, s64, 5
s_min_u32 s48, s48, 15
s_add_u32 s49, s48, s76
s_and_b32 s49, s49, 15
s_mul_i32 s49, s49, 393216
buffer_load_dwordx4 v[40:43], v36, s[28:31], s49 offen
s_add_u32 s65, s65, 40960
s_cmp_eq_u32 s65, 122880
s_cselect_b32 s65, 0, s65
s_add_u32 s64, s64, 1
s_cmp_lt_u32 s64, 11
s_cbranch_scc1 h1_loop
s_waitcnt vmcnt(11)
s_barrier
s_add_u32 s69, s47, 14
s_and_b32 s69, s69, 15
s_mul_i32 s67, s69, 2048
s_mul_i32 s68, s69, s54
s_add_u32 m0, s70, s65
s_nop 0
buffer_load_dwordx4 v20, s[32:35], s67 offen offset:0 sc1 lds
buffer_load_dwordx4 v21, s[32:35], s67 offen offset:1024 sc1 lds
buffer_load_dwordx4 v22, s[32:35], s67 offen offset:2048 sc1 lds
buffer_load_dwordx4 v23, s[32:35], s67 offen offset:3072 sc1 lds
s_add_u32 s60, s71, s65
s_add_u32 m0, s60, 0
s_mov_b32 s61, s68
buffer_load_dwordx4 v26, s[28:31], s61 offen lds
buffer_load_dwordx4 v27, s[28:31], s61 offen offset:1024 lds
s_add_u32 m0, s60, 8192
s_add_u32 s61, s61, s53
buffer_load_dwordx4 v26, s[28:31], s61 offen lds
buffer_load_dwordx4 v27, s[28:31], s61 offen offset:1024 lds
s_add_u32 m0, s60, 16384
s_add_u32 s61, s61, s53
buffer_load_dwordx4 v26, s[28:31], s61 offen lds
buffer_load_dwordx4 v27, s[28:31], s61 offen offset:1024 lds
s_add_u32 s65, s65, 40960
s_cmp_eq_u32 s65, 122880
s_cselect_b32 s65, 0, s65
s_add_u32 s64, s64, 1
s_mov_b32 s36, s16
s_and_b32 s37, s17, 0xffff
s_mov_b32 s38, 2097152
s_mov_b32 s39, 0x00020000
s_waitcnt vmcnt(10)
s_barrier
s_add_u32 s69, s47, 15
s_and_b32 s69, s69, 15
s_mul_i32 s67, s69, 2048
s_mul_i32 s68, s69, s54
s_add_u32 m0, s70, 0
s_nop 0
buffer_load_dwordx4 v20, s[32:35], s67 offen offset:0 sc1 lds
buffer_load_dwordx4 v21, s[32:35], s67 offen offset:1024 sc1 lds
buffer_load_dwordx4 v22, s[32:35], s67 offen offset:2048 sc1 lds
buffer_load_dwordx4 v23, s[32:35], s67 offen offset:3072 sc1 lds
s_add_u32 s60, s71, 0
s_add_u32 m0, s60, 0
s_mov_b32 s61, s68
buffer_load_dwordx4 v26, s[28:31], s61 offen lds
buffer_load_dwordx4 v27, s[28:31], s61 offen offset:1024 lds
s_add_u32 m0, s60, 8192
s_add_u32 s61, s61, s53
buffer_load_dwordx4 v26, s[28:31], s61 offen lds
buffer_load_dwordx4 v27, s[28:31], s61 offen offset:1024 lds
s_add_u32 m0, s60, 16384
s_add_u32 s61, s61, s53
buffer_load_dwordx4 v26, s[28:31], s61 offen lds
buffer_load_dwordx4 v27, s[28:31], s61 offen offset:1024 lds
s_waitcnt vmcnt(10)
s_barrier
s_setprio 0
buffer_load_dwordx4 v[80:83], v37, s[32:35], 0 offen offset:0 sc1
buffer_load_dwordx4 v[84:87], v37, s[32:35], 0 offen offset:1024 sc1
buffer_load_dwordx4 v[88:91], v37, s[32:35], 0 offen offset:2048 sc1
buffer_load_dwordx4 v[92:95], v37, s[32:35], 0 offen offset:3072 sc1
global_load_dword v48, v54, s[98:99]
buffer_load_dwordx4 v[64:67], v38, s[32:35], 0 offen offset:0 sc1
buffer_load_dwordx4 v[68:71], v38, s[32:35], 0 offen offset:1024 sc1
buffer_load_dwordx4 v[72:75], v38, s[32:35], 0 offen offset:2048 sc1
buffer_load_dwordx4 v[76:79], v38, s[32:35], 0 offen offset:3072 sc1
s_add_u32 s48, s75, 15
s_and_b32 s48, s48, 15
s_mul_i32 s48, s48, s57
s_add_u32 m0, s71, 106496
s_nop 0
buffer_load_dwordx4 v28, s[36:39], s48 offen lds
buffer_load_dwordx4 v29, s[36:39], s48 offen offset:1024 lds
s_waitcnt vmcnt(11)
s_barrier
s_add_u32 s48, s75, 5
s_and_b32 s48, s48, 15
s_mul_i32 s48, s48, s57
s_add_u32 m0, s71, 24576
s_nop 0
buffer_load_dwordx4 v28, s[36:39], s48 offen lds
buffer_load_dwordx4 v29, s[36:39], s48 offen offset:1024 lds
s_waitcnt vmcnt(4)
s_add_u32 s48, s75, 6
s_and_b32 s48, s48, 15
s_mul_i32 s48, s48, s57
s_add_u32 m0, s71, 32768
s_nop 0
buffer_load_dwordx4 v28, s[36:39], s48 offen lds
v_add_f32 v80, v80, v88
v_add_f32 v64, v64, v72
v_add_f32 v81, v81, v89
v_add_f32 v65, v65, v73
v_add_f32 v82, v82, v90
v_add_f32 v66, v66, v74
v_add_f32 v83, v83, v91
v_add_f32 v67, v67, v75
v_add_f32 v84, v84, v92
v_add_f32 v68, v68, v76
buffer_load_dwordx4 v29, s[36:39], s48 offen offset:1024 lds
v_add_f32 v85, v85, v93
v_add_f32 v69, v69, v77
v_add_f32 v86, v86, v94
v_add_f32 v70, v70, v78
v_add_f32 v87, v87, v95
v_add_f32 v71, v71, v79
v_add_f32 v80, v80, v84
v_add_f32 v64, v64, v68
v_add_f32 v81, v81, v85
v_add_f32 v65, v65, v69
s_add_u32 s48, s75, 7
s_and_b32 s48, s48, 15
s_mul_i32 s48, s48, s57
s_add_u32 m0, s71, 40960
s_nop 0
buffer_load_dwordx4 v28, s[36:39], s48 offen lds
v_add_f32 v82, v82, v86
v_add_f32 v66, v66, v70
v_add_f32 v83, v83, v87
v_add_f32 v67, v67, v71
s_nop 1
s_nop 1
v_permlane32_swap_b32 v80, v81
v_permlane32_swap_b32 v64, v65
v_permlane32_swap_b32 v82, v83
buffer_load_dwordx4 v29, s[36:39], s48 offen offset:1024 lds
v_permlane32_swap_b32 v66, v67
v_add_f32 v80, v80, v81
v_add_f32 v64, v64, v65
v_add_f32 v82, v82, v83
v_add_f32 v66, v66, v67
s_nop 1
s_nop 1
v_permlane16_swap_b32 v80, v82
v_permlane16_swap_b32 v64, v66
s_nop 0
s_add_u32 s48, s75, 8
s_and_b32 s48, s48, 15
s_mul_i32 s48, s48, s57
s_add_u32 m0, s71, 49152
s_nop 0
buffer_load_dwordx4 v28, s[36:39], s48 offen lds
s_nop 0
v_add_f32 v80, v80, v82
v_add_f32 v64, v64, v66
v_cmp_u_f32 vcc, v80, v80
s_cbranch_vccnz again_33
summed_34:
v_cmp_u_f32 vcc, v64, v64
s_cbranch_vccnz again_36
summed_37:
v_mul_f32 v44, 0x3a800000, v80
ds_write_b32 v53, v64
v_mov_b32 v45, v44
s_nop 1
v_permlane16_swap_b32 v44, v45
buffer_load_dwordx4 v29, s[36:39], s48 offen offset:1024 lds
s_nop 0
v_fma_f32 v45, -v44, v44, v45
v_max_f32 v45, 0, v45
v_add_f32 v45, 0x3727c5ac, v45
v_rsq_f32 v46, v45
v_sub_f32 v47, 0, v44
ds_write_b32 v50, v47 offset:512
ds_write_b64 v49, v[46:47]
ds_write_b32 v50, v46
s_setprio 0
s_waitcnt lgkmcnt(0)
s_waitcnt vmcnt(63)
s_barrier
s_waitcnt vmcnt(4)
s_add_u32 s48, s75, 9
s_and_b32 s48, s48, 15
s_mul_i32 s48, s48, s57
s_add_u32 m0, s71, 57344
s_nop 0
buffer_load_dwordx4 v28, s[36:39], s48 offen lds
buffer_load_dwordx4 v29, s[36:39], s48 offen offset:1024 lds
s_waitcnt vmcnt(4)
s_add_u32 s48, s75, 10
s_and_b32 s48, s48, 15
s_mul_i32 s48, s48, s57
s_add_u32 m0, s71, 65536
s_nop 0
buffer_load_dwordx4 v28, s[36:39], s48 offen lds
buffer_load_dwordx4 v29, s[36:39], s48 offen offset:1024 lds
s_waitcnt vmcnt(4)
s_add_u32 s48, s75, 11
s_and_b32 s48, s48, 15
s_mul_i32 s48, s48, s57
s_add_u32 m0, s71, 73728
s_nop 0
buffer_load_dwordx4 v28, s[36:39], s48 offen lds
buffer_load_dwordx4 v29, s[36:39], s48 offen offset:1024 lds
s_waitcnt vmcnt(4)
s_add_u32 s48, s75, 12
s_and_b32 s48, s48, 15
s_mul_i32 s48, s48, s57
s_add_u32 m0, s71, 81920
s_nop 0
buffer_load_dwordx4 v28, s[36:39], s48 offen lds
buffer_load_dwordx4 v29, s[36:39], s48 offen offset:1024 lds
s_waitcnt vmcnt(4)
s_add_u32 s48, s75, 13
s_and_b32 s48, s48, 15
s_mul_i32 s48, s48, s57
s_add_u32 m0, s71, 90112
s_nop 0
buffer_load_dwordx4 v28, s[36:39], s48 offen lds
buffer_load_dwordx4 v29, s[36:39], s48 offen offset:1024 lds
s_waitcnt vmcnt(4)
s_add_u32 s48, s75, 14
s_and_b32 s48, s48, 15
s_mul_i32 s48, s48, s57
s_add_u32 m0, s71, 98304
s_nop 0
buffer_load_dwordx4 v28, s[36:39], s48 offen lds
buffer_load_dwordx4 v29, s[36:39], s48 offen offset:1024 lds
s_waitcnt vmcnt(4)
s_add_u32 s48, s75, 0
s_and_b32 s48, s48, 15
s_mul_i32 s48, s48, s57
s_add_u32 m0, s71, 4294950912
s_nop 0
buffer_load_dwordx4 v28, s[36:39], s48 offen lds
buffer_load_dwordx4 v29, s[36:39], s48 offen offset:1024 lds
s_waitcnt vmcnt(4)
s_add_u32 s48, s75, 1
s_and_b32 s48, s48, 15
s_mul_i32 s48, s48, s57
s_add_u32 m0, s71, 4294959104
s_nop 0
buffer_load_dwordx4 v28, s[36:39], s48 offen lds
buffer_load_dwordx4 v29, s[36:39], s48 offen offset:1024 lds
s_waitcnt vmcnt(4)
s_add_u32 s48, s75, 2
s_and_b32 s48, s48, 15
s_mul_i32 s48, s48, s57
s_add_u32 m0, s71, 0
s_nop 0
buffer_load_dwordx4 v28, s[36:39], s48 offen lds
buffer_load_dwordx4 v29, s[36:39], s48 offen offset:1024 lds
s_waitcnt vmcnt(4)
s_add_u32 s48, s75, 3
s_and_b32 s48, s48, 15
s_mul_i32 s48, s48, s57
s_add_u32 m0, s71, 8192
s_nop 0
buffer_load_dwordx4 v28, s[36:39], s48 offen lds
buffer_load_dwordx4 v29, s[36:39], s48 offen offset:1024 lds
s_waitcnt vmcnt(4)
s_add_u32 s48, s75, 4
s_and_b32 s48, s48, 15
s_mul_i32 s48, s48, s57
s_add_u32 m0, s71, 16384
s_nop 0
buffer_load_dwordx4 v28, s[36:39], s48 offen lds
buffer_load_dwordx4 v29, s[36:39], s48 offen offset:1024 lds
s_waitcnt vmcnt(4)
buffer_load_dwordx4 v[240:243], v18, s[32:35], s81 offen offset:0 sc1
buffer_load_dwordx4 v[240:243], v18, s[32:35], s81 offen offset:1024 sc1
s_waitcnt vmcnt(4)
buffer_load_dwordx4 v[240:243], v18, s[32:35], s82 offen offset:0 sc1
buffer_load_dwordx4 v[240:243], v18, s[32:35], s82 offen offset:1024 sc1
s_mov_b32 s28, s6
s_and_b32 s29, s7, 0xffff
s_mov_b32 s30, 6291456
s_mov_b32 s31, 0x00020000
s_and_b32 s48, s2, 7
s_lshl_b32 s48, s48, 1
s_add_u32 s47, s42, s48
s_and_b32 s47, s47, 15
s_and_b32 s50, s42, 8
s_or_b32 s50, s50, 3
s_and_b32 s48, s2, 7
s_lshl_b32 s48, s48, 1
s_add_u32 s76, s50, s48
s_and_b32 s76, s76, 15
s_add_u32 s69, s47, 0
s_and_b32 s69, s69, 15
s_mul_i32 s67, s69, 2048
s_mul_i32 s68, s69, s54
s_waitcnt vmcnt(0) lgkmcnt(0)
s_barrier
s_add_u32 s60, s71, 122880
s_add_u32 m0, s60, 0
s_mov_b32 s61, s68
buffer_load_dwordx4 v26, s[28:31], s61 offen lds
buffer_load_dwordx4 v27, s[28:31], s61 offen offset:1024 lds
s_add_u32 m0, s60, 8192
s_add_u32 s61, s61, s53
buffer_load_dwordx4 v26, s[28:31], s61 offen lds
buffer_load_dwordx4 v27, s[28:31], s61 offen offset:1024 lds
s_add_u32 m0, s60, 16384
s_add_u32 s61, s61, s53
buffer_load_dwordx4 v26, s[28:31], s61 offen lds
buffer_load_dwordx4 v27, s[28:31], s61 offen offset:1024 lds
v_add_u32 v37, 262144, v37
s_getpc_b64 s[98:99]
pc_39:
s_add_u32 s98, s98, c2_last - pc_39
s_addc_u32 s99, s99, 0
s_lshr_b32 s50, s2, 3
s_lshl_b32 s50, s50, 2
s_add_u32 s50, s50, s43
s_lshl_b32 s50, s50, 7
v_and_b32 v4, 1, v0
v_lshl_add_u32 v4, v4, 6, s50
v_min_u32 v54, L_code_end - c2_last, v4
s_waitcnt vmcnt(0) lgkmcnt(0)
s_add_u32 s69, s47, 1
s_and_b32 s69, s69, 15
s_mul_i32 s67, s69, 2048
s_mul_i32 s68, s69, s54
s_barrier
s_add_u32 s60, s71, 40960
s_add_u32 m0, s60, 0
s_mov_b32 s61, s68
buffer_load_dwordx4 v26, s[28:31], s61 offen lds
buffer_load_dwordx4 v27, s[28:31], s61 offen offset:1024 lds
s_add_u32 m0, s60, 8192
s_add_u32 s61, s61, s53
buffer_load_dwordx4 v26, s[28:31], s61 offen lds
buffer_load_dwordx4 v27, s[28:31], s61 offen offset:1024 lds
s_add_u32 m0, s60, 16384
s_add_u32 s61, s61, s53
buffer_load_dwordx4 v26, s[28:31], s61 offen lds
buffer_load_dwordx4 v27, s[28:31], s61 offen offset:1024 lds
s_add_u32 s49, s76, 2
s_and_b32 s49, s49, 15
s_mul_i32 s49, s49, 393216
buffer_load_dwordx4 v[40:43], v36, s[28:31], s49 offen
s_add_u32 s49, s76, 3
s_and_b32 s49, s49, 15
s_mul_i32 s49, s49, 393216
buffer_load_dwordx4 v[40:43], v36, s[28:31], s49 offen
buffer_load_dword v5, v30, s[32:35], s79 offen sc1
s_mov_b32 s63, 0
s_waitcnt vmcnt(0)
poll_40:
v_cmp_gt_u32 vcc, 2, v5
s_cbranch_vccz polled_41
buffer_load_dword v5, v30, s[32:35], s79 offen sc1
s_add_u32 s63, s63, 1
s_cmp_lt_u32 s63, 0x80000
s_waitcnt vmcnt(0)
s_cbranch_scc1 poll_40
polled_41:
s_add_u32 s69, s47, 0
s_and_b32 s69, s69, 15
s_mul_i32 s67, s69, 2048
s_mul_i32 s68, s69, s54
s_add_u32 m0, s70, 0
s_nop 0
buffer_load_dwordx4 v20, s[32:35], s67 offen offset:0 sc1 lds
buffer_load_dwordx4 v21, s[32:35], s67 offen offset:1024 sc1 lds
buffer_load_dwordx4 v22, s[32:35], s67 offen offset:2048 sc1 lds
buffer_load_dwordx4 v23, s[32:35], s67 offen offset:3072 sc1 lds
s_add_u32 s69, s47, 1
s_and_b32 s69, s69, 15
s_mul_i32 s67, s69, 2048
s_mul_i32 s68, s69, s54
s_add_u32 m0, s70, 40960
s_nop 0
buffer_load_dwordx4 v20, s[32:35], s67 offen offset:0 sc1 lds
buffer_load_dwordx4 v21, s[32:35], s67 offen offset:1024 sc1 lds
buffer_load_dwordx4 v22, s[32:35], s67 offen offset:2048 sc1 lds
buffer_load_dwordx4 v23, s[32:35], s67 offen offset:3072 sc1 lds
s_waitcnt vmcnt(4) lgkmcnt(0)
s_barrier
s_add_u32 s69, s47, 2
s_and_b32 s69, s69, 15
s_mul_i32 s67, s69, 2048
s_mul_i32 s68, s69, s54
s_add_u32 m0, s70, 81920
s_nop 0
buffer_load_dwordx4 v20, s[32:35], s67 offen offset:0 sc1 lds
buffer_load_dwordx4 v21, s[32:35], s67 offen offset:1024 sc1 lds
buffer_load_dwordx4 v22, s[32:35], s67 offen offset:2048 sc1 lds
buffer_load_dwordx4 v23, s[32:35], s67 offen offset:3072 sc1 lds
s_add_u32 s60, s71, 81920
s_add_u32 m0, s60, 0
s_mov_b32 s61, s68
buffer_load_dwordx4 v26, s[28:31], s61 offen lds
buffer_load_dwordx4 v27, s[28:31], s61 offen offset:1024 lds
s_add_u32 m0, s60, 8192
s_add_u32 s61, s61, s53
buffer_load_dwordx4 v26, s[28:31], s61 offen lds
buffer_load_dwordx4 v27, s[28:31], s61 offen offset:1024 lds
s_add_u32 m0, s60, 16384
s_add_u32 s61, s61, s53
buffer_load_dwordx4 v26, s[28:31], s61 offen lds
buffer_load_dwordx4 v27, s[28:31], s61 offen offset:1024 lds
s_add_u32 s49, s76, 4
s_and_b32 s49, s49, 15
s_mul_i32 s49, s49, 393216
buffer_load_dwordx4 v[40:43], v36, s[28:31], s49 offen
s_mov_b32 s64, 0
s_mov_b32 s65, 0
h2_loop:
s_waitcnt vmcnt(11)
s_barrier
s_add_u32 s69, s69, 1
s_and_b32 s69, s69, 15
s_mul_i32 s67, s69, 2048
s_mul_i32 s68, s69, s54
s_add_u32 m0, s70, s65
s_nop 0
buffer_load_dwordx4 v20, s[32:35], s67 offen offset:0 sc1 lds
buffer_load_dwordx4 v21, s[32:35], s67 offen offset:1024 sc1 lds
buffer_load_dwordx4 v22, s[32:35], s67 offen offset:2048 sc1 lds
buffer_load_dwordx4 v23, s[32:35], s67 offen offset:3072 sc1 lds
s_add_u32 s60, s71, s65
s_add_u32 m0, s60, 0
s_mov_b32 s61, s68
buffer_load_dwordx4 v26, s[28:31], s61 offen lds
buffer_load_dwordx4 v27, s[28:31], s61 offen offset:1024 lds
s_add_u32 m0, s60, 8192
s_add_u32 s61, s61, s53
buffer_load_dwordx4 v26, s[28:31], s61 offen lds
buffer_load_dwordx4 v27, s[28:31], s61 offen offset:1024 lds
s_add_u32 m0, s60, 16384
s_add_u32 s61, s61, s53
buffer_load_dwordx4 v26, s[28:31], s61 offen lds
buffer_load_dwordx4 v27, s[28:31], s61 offen offset:1024 lds
s_add_u32 s48, s64, 5
s_min_u32 s48, s48, 15
s_add_u32 s49, s48, s76
s_and_b32 s49, s49, 15
s_mul_i32 s49, s49, 393216
buffer_load_dwordx4 v[40:43], v36, s[28:31], s49 offen
s_add_u32 s65, s65, 40960
s_cmp_eq_u32 s65, 122880
s_cselect_b32 s65, 0, s65
s_add_u32 s64, s64, 1
s_cmp_lt_u32 s64, 11
s_cbranch_scc1 h2_loop
s_waitcnt vmcnt(11)
s_barrier
s_add_u32 s69, s47, 14
s_and_b32 s69, s69, 15
s_mul_i32 s67, s69, 2048
s_mul_i32 s68, s69, s54
s_add_u32 m0, s70, s65
s_nop 0
buffer_load_dwordx4 v20, s[32:35], s67 offen offset:0 sc1 lds
buffer_load_dwordx4 v21, s[32:35], s67 offen offset:1024 sc1 lds
buffer_load_dwordx4 v22, s[32:35], s67 offen offset:2048 sc1 lds
buffer_load_dwordx4 v23, s[32:35], s67 offen offset:3072 sc1 lds
s_add_u32 s60, s71, s65
s_add_u32 m0, s60, 0
s_mov_b32 s61, s68
buffer_load_dwordx4 v26, s[28:31], s61 offen lds
buffer_load_dwordx4 v27, s[28:31], s61 offen offset:1024 lds
s_add_u32 m0, s60, 8192
s_add_u32 s61, s61, s53
buffer_load_dwordx4 v26, s[28:31], s61 offen lds
buffer_load_dwordx4 v27, s[28:31], s61 offen offset:1024 lds
s_add_u32 m0, s60, 16384
s_add_u32 s61, s61, s53
buffer_load_dwordx4 v26, s[28:31], s61 offen lds
buffer_load_dwordx4 v27, s[28:31], s61 offen offset:1024 lds
s_add_u32 s65, s65, 40960
s_cmp_eq_u32 s65, 122880
s_cselect_b32 s65, 0, s65
s_add_u32 s64, s64, 1
s_mov_b32 s36, s12
s_and_b32 s37, s13, 0xffff
s_mov_b32 s38, 6291456
s_mov_b32 s39, 0x00020000
s_waitcnt vmcnt(10)
s_barrier
s_add_u32 s69, s47, 15
s_and_b32 s69, s69, 15
s_mul_i32 s67, s69, 2048
s_mul_i32 s68, s69, s54
s_add_u32 m0, s70, 0
s_nop 0
buffer_load_dwordx4 v20, s[32:35], s67 offen offset:0 sc1 lds
buffer_load_dwordx4 v21, s[32:35], s67 offen offset:1024 sc1 lds
buffer_load_dwordx4 v22, s[32:35], s67 offen offset:2048 sc1 lds
buffer_load_dwordx4 v23, s[32:35], s67 offen offset:3072 sc1 lds
s_add_u32 s60, s71, 0
s_add_u32 m0, s60, 0
s_mov_b32 s61, s68
buffer_load_dwordx4 v26, s[28:31], s61 offen lds
buffer_load_dwordx4 v27, s[28:31], s61 offen offset:1024 lds
s_add_u32 m0, s60, 8192
s_add_u32 s61, s61, s53
buffer_load_dwordx4 v26, s[28:31], s61 offen lds
buffer_load_dwordx4 v27, s[28:31], s61 offen offset:1024 lds
s_add_u32 m0, s60, 16384
s_add_u32 s61, s61, s53
buffer_load_dwordx4 v26, s[28:31], s61 offen lds
buffer_load_dwordx4 v27, s[28:31], s61 offen offset:1024 lds
s_waitcnt vmcnt(10)
s_barrier
s_setprio 0
buffer_load_dwordx4 v[80:83], v37, s[32:35], 0 offen offset:0 sc1
buffer_load_dwordx4 v[84:87], v37, s[32:35], 0 offen offset:1024 sc1
buffer_load_dwordx4 v[88:91], v37, s[32:35], 0 offen offset:2048 sc1
buffer_load_dwordx4 v[92:95], v37, s[32:35], 0 offen offset:3072 sc1
global_load_dword v48, v54, s[98:99]
s_add_u32 s69, s47, 0
s_and_b32 s69, s69, 15
s_mul_i32 s67, s69, 2048
s_mul_i32 s68, s69, s54
s_add_u32 s60, s71, 122880
s_add_u32 m0, s60, 0
s_mov_b32 s61, s68
buffer_load_dwordx4 v26, s[36:39], s61 offen lds
buffer_load_dwordx4 v27, s[36:39], s61 offen offset:1024 lds
s_add_u32 m0, s60, 8192
s_add_u32 s61, s61, s53
buffer_load_dwordx4 v26, s[36:39], s61 offen lds
buffer_load_dwordx4 v27, s[36:39], s61 offen offset:1024 lds
s_add_u32 m0, s60, 16384
s_add_u32 s61, s61, s53
buffer_load_dwordx4 v26, s[36:39], s61 offen lds
buffer_load_dwordx4 v27, s[36:39], s61 offen offset:1024 lds
s_waitcnt vmcnt(11)
s_barrier
s_waitcnt vmcnt(7)
buffer_store_dwordx4 v[56:59], v18, s[32:35], s86 offen offset:0 sc1
v_add_f32 v80, v80, v88
v_add_f32 v81, v81, v89
v_add_f32 v82, v82, v90
v_add_f32 v83, v83, v91
v_add_f32 v84, v84, v92
v_add_f32 v85, v85, v93
v_add_f32 v86, v86, v94
buffer_store_dwordx4 v[56:59], v18, s[32:35], s86 offen offset:1024 sc1
v_add_f32 v87, v87, v95
v_add_f32 v80, v80, v84
v_add_f32 v81, v81, v85
v_add_f32 v82, v82, v86
v_add_f32 v83, v83, v87
s_nop 1
buffer_load_dwordx4 v[240:243], v18, s[32:35], s81 offen offset:0 sc1
v_permlane32_swap_b32 v80, v81
v_permlane32_swap_b32 v82, v83
v_add_f32 v80, v80, v81
v_add_f32 v82, v82, v83
s_nop 1
v_permlane16_swap_b32 v80, v82
buffer_load_dwordx4 v[240:243], v18, s[32:35], s81 offen offset:1024 sc1
s_nop 0
v_add_f32 v80, v80, v82
v_cmp_u_f32 vcc, v80, v80
s_cbranch_vccnz again_42
summed_43:
v_mul_f32 v44, 0x3a800000, v80
buffer_load_dwordx4 v[240:243], v18, s[32:35], s82 offen offset:0 sc1
v_mov_b32 v45, v44
s_nop 1
v_permlane16_swap_b32 v44, v45
s_nop 0
v_fma_f32 v45, -v44, v44, v45
v_max_f32 v45, 0, v45
buffer_load_dwordx4 v[240:243], v18, s[32:35], s82 offen offset:1024 sc1
v_add_f32 v45, 0x3727c5ac, v45
v_rsq_f32 v46, v45
v_sub_f32 v47, 0, v44
ds_write_b32 v50, v47 offset:512
ds_write_b64 v49, v[46:47]
ds_write_b32 v50, v46
s_setprio 0
s_waitcnt lgkmcnt(0)
s_waitcnt vmcnt(63)
s_barrier
ds_write_b128 v52, v[232:235] offset:57344
ds_write_b128 v52, v[236:239] offset:58368
ds_write_b128 v51, v[152:155] offset:40960
ds_write_b128 v51, v[156:159] offset:41984
ds_write_b128 v51, v[160:163] offset:49152
ds_write_b128 v51, v[164:167] offset:50176
ds_write_b128 v51, v[168:171] offset:57344
ds_write_b128 v51, v[172:175] offset:58368
ds_write_b128 v52, v[176:179] offset:0
ds_write_b128 v52, v[180:183] offset:1024
ds_write_b128 v52, v[184:187] offset:8192
ds_write_b128 v52, v[188:191] offset:9216
ds_write_b128 v52, v[192:195] offset:16384
ds_write_b128 v52, v[196:199] offset:17408
ds_write_b128 v52, v[200:203] offset:24576
ds_write_b128 v52, v[204:207] offset:25600
ds_write_b128 v52, v[208:211] offset:32768
ds_write_b128 v52, v[212:215] offset:33792
ds_write_b128 v52, v[216:219] offset:40960
ds_write_b128 v52, v[220:223] offset:41984
ds_write_b128 v52, v[224:227] offset:49152
ds_write_b128 v52, v[228:231] offset:50176
ds_write_b128 v51, v[112:115] offset:0
ds_write_b128 v51, v[116:119] offset:1024
ds_write_b128 v51, v[120:123] offset:8192
ds_write_b128 v51, v[124:127] offset:9216
ds_write_b128 v51, v[128:131] offset:16384
ds_write_b128 v51, v[132:135] offset:17408
ds_write_b128 v51, v[136:139] offset:24576
ds_write_b128 v51, v[140:143] offset:25600
ds_write_b128 v51, v[144:147] offset:32768
ds_write_b128 v51, v[148:151] offset:33792
s_mov_b32 s28, s12
s_and_b32 s29, s13, 0xffff
s_mov_b32 s30, 6291456
s_mov_b32 s31, 0x00020000
s_add_u32 s69, s47, 0
s_and_b32 s69, s69, 15
s_mul_i32 s67, s69, 2048
s_mul_i32 s68, s69, s54
s_waitcnt vmcnt(0) lgkmcnt(0)
s_barrier
s_mov_b32 s36, s14
s_and_b32 s37, s15, 0xffff
s_mov_b32 s38, 65536
s_mov_b32 s39, 0x00020000
s_lshl_b32 s48, s42, 12
s_lshl_b32 s49, s43, 10
s_add_u32 s48, s48, s49
s_add_u32 m0, s49, 135168
s_nop 0
buffer_load_dwordx4 v18, s[36:39], s48 offen lds
v_add_u32 v37, 262144, v37
s_getpc_b64 s[98:99]
pc_45:
s_add_u32 s98, s98, c3_last - pc_45
s_addc_u32 s99, s99, 0
s_lshr_b32 s50, s2, 3
s_lshl_b32 s50, s50, 2
s_add_u32 s50, s50, s43
s_lshl_b32 s50, s50, 7
v_and_b32 v4, 1, v0
v_lshl_add_u32 v4, v4, 6, s50
v_min_u32 v54, L_code_end - c3_last, v4
s_lshl_b32 s83, s41, 2
s_add_u32 s83, s83, 0
s_lshl_b32 s83, s83, 7
s_add_u32 s83, s83, 18350080
s_cmp_lg_u32 s43, 0
s_cbranch_scc1 else_46
buffer_load_dword v5, v30, s[32:35], s83 offen sc1
s_mov_b32 s63, 0
s_waitcnt vmcnt(0)
poll_48:
v_cmp_gt_u32 vcc, 3, v5
s_cbranch_vccz polled_49
buffer_load_dword v5, v30, s[32:35], s83 offen sc1
s_add_u32 s63, s63, 1
s_cmp_lt_u32 s63, 0x80000
s_waitcnt vmcnt(0)
s_cbranch_scc1 poll_48
polled_49:
s_mov_b64 exec, 1
buffer_store_dword v13, v12, s[32:35], s73 offen sc1
s_mov_b64 exec, -1
else_46:
s_waitcnt vmcnt(0) lgkmcnt(0)
s_add_u32 s69, s47, 1
s_and_b32 s69, s69, 15
s_mul_i32 s67, s69, 2048
s_mul_i32 s68, s69, s54
s_barrier
s_add_u32 s60, s71, 40960
s_add_u32 m0, s60, 0
s_mov_b32 s61, s68
buffer_load_dwordx4 v26, s[28:31], s61 offen lds
buffer_load_dwordx4 v27, s[28:31], s61 offen offset:1024 lds
s_add_u32 m0, s60, 8192
s_add_u32 s61, s61, s53
buffer_load_dwordx4 v26, s[28:31], s61 offen lds
buffer_load_dwordx4 v27, s[28:31], s61 offen offset:1024 lds
s_add_u32 m0, s60, 16384
s_add_u32 s61, s61, s53
buffer_load_dwordx4 v26, s[28:31], s61 offen lds
buffer_load_dwordx4 v27, s[28:31], s61 offen offset:1024 lds
s_add_u32 s49, s76, 2
s_and_b32 s49, s49, 15
s_mul_i32 s49, s49, 393216
buffer_load_dwordx4 v[40:43], v36, s[28:31], s49 offen
s_add_u32 s49, s76, 3
s_and_b32 s49, s49, 15
s_mul_i32 s49, s49, 393216
buffer_load_dwordx4 v[40:43], v36, s[28:31], s49 offen
buffer_load_dword v5, v30, s[32:35], s79 offen sc1
s_mov_b32 s63, 0
s_waitcnt vmcnt(0)
poll_50:
v_cmp_gt_u32 vcc, 3, v5
s_cbranch_vccz polled_51
buffer_load_dword v5, v30, s[32:35], s79 offen sc1
s_add_u32 s63, s63, 1
s_cmp_lt_u32 s63, 0x80000
s_waitcnt vmcnt(0)
s_cbranch_scc1 poll_50
polled_51:
s_add_u32 s69, s47, 0
s_and_b32 s69, s69, 15
s_mul_i32 s67, s69, 2048
s_mul_i32 s68, s69, s54
s_add_u32 m0, s70, 0
s_nop 0
buffer_load_dwordx4 v20, s[32:35], s67 offen offset:0 sc1 lds
buffer_load_dwordx4 v21, s[32:35], s67 offen offset:1024 sc1 lds
buffer_load_dwordx4 v22, s[32:35], s67 offen offset:2048 sc1 lds
buffer_load_dwordx4 v23, s[32:35], s67 offen offset:3072 sc1 lds
s_add_u32 s69, s47, 1
s_and_b32 s69, s69, 15
s_mul_i32 s67, s69, 2048
s_mul_i32 s68, s69, s54
s_add_u32 m0, s70, 40960
s_nop 0
buffer_load_dwordx4 v20, s[32:35], s67 offen offset:0 sc1 lds
buffer_load_dwordx4 v21, s[32:35], s67 offen offset:1024 sc1 lds
buffer_load_dwordx4 v22, s[32:35], s67 offen offset:2048 sc1 lds
buffer_load_dwordx4 v23, s[32:35], s67 offen offset:3072 sc1 lds
s_waitcnt vmcnt(4) lgkmcnt(0)
s_barrier
s_add_u32 s69, s47, 2
s_and_b32 s69, s69, 15
s_mul_i32 s67, s69, 2048
s_mul_i32 s68, s69, s54
s_add_u32 m0, s70, 81920
s_nop 0
buffer_load_dwordx4 v20, s[32:35], s67 offen offset:0 sc1 lds
buffer_load_dwordx4 v21, s[32:35], s67 offen offset:1024 sc1 lds
buffer_load_dwordx4 v22, s[32:35], s67 offen offset:2048 sc1 lds
buffer_load_dwordx4 v23, s[32:35], s67 offen offset:3072 sc1 lds
s_add_u32 s60, s71, 81920
s_add_u32 m0, s60, 0
s_mov_b32 s61, s68
buffer_load_dwordx4 v26, s[28:31], s61 offen lds
buffer_load_dwordx4 v27, s[28:31], s61 offen offset:1024 lds
s_add_u32 m0, s60, 8192
s_add_u32 s61, s61, s53
buffer_load_dwordx4 v26, s[28:31], s61 offen lds
buffer_load_dwordx4 v27, s[28:31], s61 offen offset:1024 lds
s_add_u32 m0, s60, 16384
s_add_u32 s61, s61, s53
buffer_load_dwordx4 v26, s[28:31], s61 offen lds
buffer_load_dwordx4 v27, s[28:31], s61 offen offset:1024 lds
s_add_u32 s49, s76, 4
s_and_b32 s49, s49, 15
s_mul_i32 s49, s49, 393216
buffer_load_dwordx4 v[40:43], v36, s[28:31], s49 offen
s_mov_b32 s64, 0
s_mov_b32 s65, 0
h3_loop:
s_waitcnt vmcnt(11)
s_barrier
s_add_u32 s69, s69, 1
s_and_b32 s69, s69, 15
s_mul_i32 s67, s69, 2048
s_mul_i32 s68, s69, s54
s_add_u32 m0, s70, s65
s_nop 0
buffer_load_dwordx4 v20, s[32:35], s67 offen offset:0 sc1 lds
buffer_load_dwordx4 v21, s[32:35], s67 offen offset:1024 sc1 lds
buffer_load_dwordx4 v22, s[32:35], s67 offen offset:2048 sc1 lds
buffer_load_dwordx4 v23, s[32:35], s67 offen offset:3072 sc1 lds
s_add_u32 s60, s71, s65
s_add_u32 m0, s60, 0
s_mov_b32 s61, s68
buffer_load_dwordx4 v26, s[28:31], s61 offen lds
buffer_load_dwordx4 v27, s[28:31], s61 offen offset:1024 lds
s_add_u32 m0, s60, 8192
s_add_u32 s61, s61, s53
buffer_load_dwordx4 v26, s[28:31], s61 offen lds
buffer_load_dwordx4 v27, s[28:31], s61 offen offset:1024 lds
s_add_u32 m0, s60, 16384
s_add_u32 s61, s61, s53
buffer_load_dwordx4 v26, s[28:31], s61 offen lds
buffer_load_dwordx4 v27, s[28:31], s61 offen offset:1024 lds
s_add_u32 s48, s64, 5
s_min_u32 s48, s48, 15
s_add_u32 s49, s48, s76
s_and_b32 s49, s49, 15
s_mul_i32 s49, s49, 393216
buffer_load_dwordx4 v[40:43], v36, s[28:31], s49 offen
s_add_u32 s65, s65, 40960
s_cmp_eq_u32 s65, 122880
s_cselect_b32 s65, 0, s65
s_add_u32 s64, s64, 1
s_cmp_lt_u32 s64, 11
s_cbranch_scc1 h3_loop
s_waitcnt vmcnt(11)
s_barrier
s_add_u32 s69, s47, 14
s_and_b32 s69, s69, 15
s_mul_i32 s67, s69, 2048
s_mul_i32 s68, s69, s54
s_add_u32 m0, s70, s65
s_nop 0
buffer_load_dwordx4 v20, s[32:35], s67 offen offset:0 sc1 lds
buffer_load_dwordx4 v21, s[32:35], s67 offen offset:1024 sc1 lds
buffer_load_dwordx4 v22, s[32:35], s67 offen offset:2048 sc1 lds
buffer_load_dwordx4 v23, s[32:35], s67 offen offset:3072 sc1 lds
s_add_u32 s60, s71, s65
s_add_u32 m0, s60, 0
s_mov_b32 s61, s68
buffer_load_dwordx4 v26, s[28:31], s61 offen lds
buffer_load_dwordx4 v27, s[28:31], s61 offen offset:1024 lds
s_add_u32 m0, s60, 8192
s_add_u32 s61, s61, s53
buffer_load_dwordx4 v26, s[28:31], s61 offen lds
buffer_load_dwordx4 v27, s[28:31], s61 offen offset:1024 lds
s_add_u32 m0, s60, 16384
s_add_u32 s61, s61, s53
buffer_load_dwordx4 v26, s[28:31], s61 offen lds
buffer_load_dwordx4 v27, s[28:31], s61 offen offset:1024 lds
s_add_u32 s65, s65, 40960
s_cmp_eq_u32 s65, 122880
s_cselect_b32 s65, 0, s65
s_add_u32 s64, s64, 1
s_mov_b32 s36, s16
s_and_b32 s37, s17, 0xffff
s_mov_b32 s38, 2097152
s_mov_b32 s39, 0x00020000
s_waitcnt vmcnt(10)
s_barrier
s_add_u32 s69, s47, 15
s_and_b32 s69, s69, 15
s_mul_i32 s67, s69, 2048
s_mul_i32 s68, s69, s54
s_add_u32 m0, s70, 0
s_nop 0
buffer_load_dwordx4 v20, s[32:35], s67 offen offset:0 sc1 lds
buffer_load_dwordx4 v21, s[32:35], s67 offen offset:1024 sc1 lds
buffer_load_dwordx4 v22, s[32:35], s67 offen offset:2048 sc1 lds
buffer_load_dwordx4 v23, s[32:35], s67 offen offset:3072 sc1 lds
s_add_u32 s60, s71, 0
s_add_u32 m0, s60, 0
s_mov_b32 s61, s68
buffer_load_dwordx4 v26, s[28:31], s61 offen lds
buffer_load_dwordx4 v27, s[28:31], s61 offen offset:1024 lds
s_add_u32 m0, s60, 8192
s_add_u32 s61, s61, s53
buffer_load_dwordx4 v26, s[28:31], s61 offen lds
buffer_load_dwordx4 v27, s[28:31], s61 offen offset:1024 lds
s_add_u32 m0, s60, 16384
s_add_u32 s61, s61, s53
buffer_load_dwordx4 v26, s[28:31], s61 offen lds
buffer_load_dwordx4 v27, s[28:31], s61 offen offset:1024 lds
s_waitcnt vmcnt(10)
s_barrier
s_setprio 0
buffer_load_dword v33, v30, s[32:35], s73 offen sc1
buffer_load_dwordx4 v[80:83], v37, s[32:35], 0 offen offset:0 sc1
buffer_load_dwordx4 v[84:87], v37, s[32:35], 0 offen offset:1024 sc1
buffer_load_dwordx4 v[88:91], v37, s[32:35], 0 offen offset:2048 sc1
buffer_load_dwordx4 v[92:95], v37, s[32:35], 0 offen offset:3072 sc1
global_load_dword v48, v54, s[98:99]
s_add_u32 s48, s75, 15
s_and_b32 s48, s48, 15
s_mul_i32 s48, s48, s57
s_add_u32 m0, s71, 106496
s_nop 0
buffer_load_dwordx4 v28, s[36:39], s48 offen lds
buffer_load_dwordx4 v29, s[36:39], s48 offen offset:1024 lds
s_add_u32 s48, s75, 5
s_and_b32 s48, s48, 15
s_mul_i32 s48, s48, s57
s_add_u32 m0, s71, 24576
s_nop 0
buffer_load_dwordx4 v28, s[36:39], s48 offen lds
buffer_load_dwordx4 v29, s[36:39], s48 offen offset:1024 lds
s_add_u32 s48, s75, 6
s_and_b32 s48, s48, 15
s_mul_i32 s48, s48, s57
s_add_u32 m0, s71, 32768
s_nop 0
buffer_load_dwordx4 v28, s[36:39], s48 offen lds
buffer_load_dwordx4 v29, s[36:39], s48 offen offset:1024 lds
s_waitcnt vmcnt(12)
s_barrier
s_waitcnt vmcnt(7)
s_mov_b32 s63, 0
poll_55:
v_cmp_gt_u32 vcc, 1, v33
s_cbranch_vccz polled_56
buffer_load_dword v33, v30, s[32:35], s73 offen sc1
s_add_u32 s63, s63, 1
s_cmp_lt_u32 s63, 0x80000
s_waitcnt vmcnt(0)
s_cbranch_scc1 poll_55
polled_56:
s_add_u32 s48, s75, 7
s_and_b32 s48, s48, 15
s_mul_i32 s48, s48, s57
s_add_u32 m0, s71, 40960
s_nop 0
buffer_load_dwordx4 v28, s[36:39], s48 offen lds
v_add_f32 v80, v80, v88
v_add_f32 v81, v81, v89
v_add_f32 v82, v82, v90
v_add_f32 v83, v83, v91
v_add_f32 v84, v84, v92
buffer_load_dwordx4 v29, s[36:39], s48 offen offset:1024 lds
v_add_f32 v85, v85, v93
v_add_f32 v86, v86, v94
v_add_f32 v87, v87, v95
v_add_f32 v80, v80, v84
v_add_f32 v81, v81, v85
s_add_u32 s48, s75, 8
s_and_b32 s48, s48, 15
s_mul_i32 s48, s48, s57
s_add_u32 m0, s71, 49152
s_nop 0
buffer_load_dwordx4 v28, s[36:39], s48 offen lds
v_add_f32 v82, v82, v86
v_add_f32 v83, v83, v87
s_nop 1
v_permlane32_swap_b32 v80, v81
buffer_load_dwordx4 v29, s[36:39], s48 offen offset:1024 lds
v_permlane32_swap_b32 v82, v83
v_add_f32 v80, v80, v81
v_add_f32 v82, v82, v83
s_nop 1
v_permlane16_swap_b32 v80, v82
s_add_u32 s48, s75, 9
s_and_b32 s48, s48, 15
s_mul_i32 s48, s48, s57
s_add_u32 m0, s71, 57344
s_nop 0
buffer_load_dwordx4 v28, s[36:39], s48 offen lds
s_nop 0
v_add_f32 v80, v80, v82
v_cmp_u_f32 vcc, v80, v80
s_cbranch_vccnz again_52
summed_53:
buffer_load_dwordx4 v29, s[36:39], s48 offen offset:1024 lds
v_mul_f32 v44, 0x3a800000, v80
v_mov_b32 v45, v44
s_nop 1
v_permlane16_swap_b32 v44, v45
s_add_u32 s48, s75, 10
s_and_b32 s48, s48, 15
s_mul_i32 s48, s48, s57
s_add_u32 m0, s71, 65536
s_nop 0
buffer_load_dwordx4 v28, s[36:39], s48 offen lds
s_nop 0
v_fma_f32 v45, -v44, v44, v45
v_max_f32 v45, 0, v45
v_add_f32 v45, 0x3727c5ac, v45
v_rsq_f32 v46, v45
buffer_load_dwordx4 v29, s[36:39], s48 offen offset:1024 lds
v_sub_f32 v47, 0, v44
ds_write_b32 v50, v47 offset:512
ds_write_b64 v49, v[46:47]
ds_write_b32 v50, v46
s_setprio 0
s_waitcnt lgkmcnt(0)
s_waitcnt vmcnt(63)
s_barrier
s_waitcnt vmcnt(4)
s_add_u32 s48, s75, 11
s_and_b32 s48, s48, 15
s_mul_i32 s48, s48, s57
s_add_u32 m0, s71, 73728
s_nop 0
buffer_load_dwordx4 v28, s[36:39], s48 offen lds
buffer_load_dwordx4 v29, s[36:39], s48 offen offset:1024 lds
s_waitcnt vmcnt(4)
s_add_u32 s48, s75, 12
s_and_b32 s48, s48, 15
s_mul_i32 s48, s48, s57
s_add_u32 m0, s71, 81920
s_nop 0
buffer_load_dwordx4 v28, s[36:39], s48 offen lds
buffer_load_dwordx4 v29, s[36:39], s48 offen offset:1024 lds
s_waitcnt vmcnt(4)
s_add_u32 s48, s75, 13
s_and_b32 s48, s48, 15
s_mul_i32 s48, s48, s57
s_add_u32 m0, s71, 90112
s_nop 0
buffer_load_dwordx4 v28, s[36:39], s48 offen lds
buffer_load_dwordx4 v29, s[36:39], s48 offen offset:1024 lds
s_waitcnt vmcnt(4)
s_add_u32 s48, s75, 14
s_and_b32 s48, s48, 15
s_mul_i32 s48, s48, s57
s_add_u32 m0, s71, 98304
s_nop 0
buffer_load_dwordx4 v28, s[36:39], s48 offen lds
buffer_load_dwordx4 v29, s[36:39], s48 offen offset:1024 lds
s_waitcnt vmcnt(4)
s_add_u32 s48, s75, 0
s_and_b32 s48, s48, 15
s_mul_i32 s48, s48, s57
s_add_u32 m0, s71, 4294950912
s_nop 0
buffer_load_dwordx4 v28, s[36:39], s48 offen lds
buffer_load_dwordx4 v29, s[36:39], s48 offen offset:1024 lds
s_waitcnt vmcnt(4)
s_add_u32 s48, s75, 1
s_and_b32 s48, s48, 15
s_mul_i32 s48, s48, s57
s_add_u32 m0, s71, 4294959104
s_nop 0
buffer_load_dwordx4 v28, s[36:39], s48 offen lds
buffer_load_dwordx4 v29, s[36:39], s48 offen offset:1024 lds
s_waitcnt vmcnt(4)
s_add_u32 s48, s75, 2
s_and_b32 s48, s48, 15
s_mul_i32 s48, s48, s57
s_add_u32 m0, s71, 0
s_nop 0
buffer_load_dwordx4 v28, s[36:39], s48 offen lds
buffer_load_dwordx4 v29, s[36:39], s48 offen offset:1024 lds
s_waitcnt vmcnt(4)
s_add_u32 s48, s75, 3
s_and_b32 s48, s48, 15
s_mul_i32 s48, s48, s57
s_add_u32 m0, s71, 8192
s_nop 0
buffer_load_dwordx4 v28, s[36:39], s48 offen lds
buffer_load_dwordx4 v29, s[36:39], s48 offen offset:1024 lds
s_waitcnt vmcnt(4)
s_add_u32 s48, s75, 4
s_and_b32 s48, s48, 15
s_mul_i32 s48, s48, s57
s_add_u32 m0, s71, 16384
s_nop 0
buffer_load_dwordx4 v28, s[36:39], s48 offen lds
buffer_load_dwordx4 v29, s[36:39], s48 offen offset:1024 lds
s_waitcnt vmcnt(4)
buffer_load_dwordx4 v[240:243], v18, s[32:35], s81 offen offset:0 sc1
buffer_load_dwordx4 v[240:243], v18, s[32:35], s81 offen offset:1024 sc1
s_waitcnt vmcnt(4)
buffer_load_dwordx4 v[240:243], v18, s[32:35], s82 offen offset:0 sc1
buffer_load_dwordx4 v[240:243], v18, s[32:35], s82 offen offset:1024 sc1
s_waitcnt vmcnt(0) lgkmcnt(0)
s_barrier
L_end:
s_endpgm
L_compute:
s_lshr_b32 s48, s2, 2
s_and_b32 s48, s48, 1
s_lshl_b32 s48, s48, 1
s_add_u32 s48, s48, s74
s_and_b32 s49, s42, 3
s_xor_b32 s77, s48, s49
s_add_u32 s77, s77, 4
s_add_u32 s48, s47, 1
s_and_b32 s48, s48, 3
s_and_b32 s49, s77, 3
s_lshl_b32 s49, s49, 2
s_add_u32 s78, s48, s49
s_and_b32 s48, s2, 7
s_lshl_b32 s48, s48, 1
s_add_u32 s75, s78, s48
s_and_b32 s75, s75, 15
s_mov_b32 s46, 0
s_waitcnt lgkmcnt(0)
s_mov_b32 s32, s22
s_and_b32 s33, s23, 0xffff
s_mov_b32 s34, 268435456
s_mov_b32 s35, 0x00020000
s_mov_b32 s24, s18
s_and_b32 s25, s19, 0xffff
s_mov_b32 s26, 4194304
s_mov_b32 s27, 0x00020000
s_setprio 1
s_and_b32 s43, s40, 1
s_lshr_b32 s44, s40, 1
s_lshl_b32 s45, s42, 1
s_add_u32 s45, s45, s43
s_cmp_lg_u32 s40, 1
s_cbranch_scc1 else_57
s_getpc_b64 s[48:49]
L_pc:
s_sub_u32 s48, s48, L_pc - interleave_layers__sliding_local_dilated__linear_kernel_hedgehog__prompt_kernel
s_subb_u32 s49, s49, 0
s_lshr_b32 s50, s2, 3
s_lshl_b32 s50, s50, 12
v_lshl_add_u32 v8, v0, 6, s50
v_cmp_gt_u32 vcc, L_code_end - interleave_layers__sliding_local_dilated__linear_kernel_hedgehog__prompt_kernel, v8
s_and_saveexec_b64 s[50:51], vcc
s_cbranch_execz nopf_59
global_load_dword v254, v8, s[48:49]
nopf_59:
s_mov_b64 exec, -1
else_57:
s_lshl_b32 s48, s41, 3
s_lshl_b32 s49, s44, 2
s_add_u32 s48, s48, s49
s_lshl_b32 s48, s48, 5
s_add_u32 s48, s48, s45
s_lshl_b32 s48, s48, 10
s_add_u32 s80, s48, 4194304
s_add_u32 s81, s80, 32768
s_add_u32 s82, s80, 65536
s_add_u32 s83, s80, 98304
s_lshl_b32 s84, s41, 2
s_add_u32 s84, s84, s44
s_lshl_b32 s84, s84, 7
s_add_u32 s84, s84, 18350080
s_lshl_b32 s48, s41, 3
s_lshl_b32 s49, s40, 1
s_add_u32 s48, s48, s49
s_lshl_b32 s48, s48, 15
s_lshl_b32 s49, s78, 11
s_add_u32 s85, s48, s49
s_add_u32 s86, s85, 32768
s_lshl_b32 s50, s41, 2
s_add_u32 s50, s50, s40
s_lshl_b32 s50, s50, 4
s_add_u32 s50, s50, s42
s_lshl_b32 s50, s50, 8
s_add_u32 s87, s50, 16777216
s_lshl_b32 s88, s41, 2
s_add_u32 s88, s88, s40
s_lshl_b32 s88, s88, 7
s_add_u32 s88, s88, 18358272
v_lshrrev_b32 v4, 1, v3
v_lshl_add_u32 v4, v2, 2, v4
v_and_b32 v5, 1, v3
v_lshl_add_u32 v4, v5, 1, v4
v_lshlrev_b32 v1, 2, v4
s_lshl_b32 s48, s40, 2
s_add_u32 s48, s48, 134672
v_mov_b32 v10, s48
v_mov_b32 v11, 0
ds_write_b32 v10, v11
v_mov_b32 v140, -1
v_mov_b32 v141, -1
v_mov_b32 v142, -1
v_mov_b32 v143, -1
s_lshl_b32 s50, s42, 2
s_add_u32 s50, s50, s40
s_lshl_b32 s50, s50, 4
s_add_u32 s50, s50, s41
s_lshl_b32 s50, s50, 8
s_add_u32 s50, s50, 17825792
v_mov_b32 v4, s87
v_mov_b32 v5, s50
v_cmp_eq_u32 vcc, 0, v3
v_lshrrev_b32 v6, 1, v3
v_mul_u32_u24 v6, 262144, v6
v_add_u32 v5, v5, v6
v_cndmask_b32 v4, v5, v4, vcc
v_lshl_add_u32 v4, v2, 4, v4
buffer_store_dwordx4 v[140:143], v4, s[32:35], 0 offen sc1
s_lshl_b32 s48, s2, 2
s_add_u32 s49, s48, s40
s_lshl_b32 s48, s49, 10
s_add_u32 s48, s48, 8388608
buffer_store_dwordx4 v[140:143], v18, s[32:35], s48 offen sc1
s_and_b32 s48, s49, 7
s_cmp_lg_u32 s48, 0
s_cbranch_scc1 nofl_60
s_lshl_b32 s48, s49, 5
s_add_u32 s48, s48, 18350080
v_lshlrev_b32 v6, 2, v0
buffer_store_dword v11, v6, s[32:35], s48 offen sc1
nofl_60:
s_lshl_b32 s49, s44, 13
v_lshrrev_b32 v4, 1, v2
v_xor_b32 v4, v4, v3
v_lshlrev_b32 v4, 4, v4
v_lshl_add_u32 v10, v2, 7, v4
v_add_u32 v10, s49, v10
v_xor_b32 v11, 64, v10
s_lshl_b32 s48, s43, 1
v_lshrrev_b32 v4, 2, v2
v_and_b32 v5, 3, v0
v_lshl_add_u32 v6, v3, 3, v4
v_lshlrev_b32 v6, 7, v6
v_lshl_add_u32 v6, v5, 3, v6
v_lshrrev_b32 v7, 1, v4
v_and_b32 v8, 1, v3
v_lshl_add_u32 v7, v8, 1, v7
v_xor_b32 v7, s48, v7
v_lshl_add_u32 v12, v7, 5, v6
v_add_u32 v12, 16384, v12
v_xor_b32 v13, 32, v12
v_mov_b32 v14, v10
v_mov_b32 v15, v11
v_add_u32 v16, 0, v12
v_add_u32 v17, 0, v13
v_mov_b32 v156, 0
v_mov_b32 v157, 0
v_mov_b32 v158, 0
v_mov_b32 v159, 0
v_mov_b32 v160, 0
v_mov_b32 v161, 0
v_mov_b32 v162, 0
v_mov_b32 v163, 0
v_mov_b32 v164, 0
v_mov_b32 v165, 0
v_mov_b32 v166, 0
v_mov_b32 v167, 0
v_mov_b32 v168, 0
v_mov_b32 v169, 0
v_mov_b32 v170, 0
v_mov_b32 v171, 0
v_mov_b32 v172, 0
v_mov_b32 v173, 0
v_mov_b32 v174, 0
v_mov_b32 v175, 0
v_mov_b32 v176, 0
v_mov_b32 v177, 0
v_mov_b32 v178, 0
v_mov_b32 v179, 0
v_mov_b32 v180, 0
v_mov_b32 v181, 0
v_mov_b32 v182, 0
v_mov_b32 v183, 0
v_mov_b32 v184, 0
v_mov_b32 v185, 0
v_mov_b32 v186, 0
v_mov_b32 v187, 0
v_mov_b32 v188, 0
v_mov_b32 v189, 0
v_mov_b32 v190, 0
v_mov_b32 v191, 0
v_mov_b32 v192, 0
v_mov_b32 v193, 0
v_mov_b32 v194, 0
v_mov_b32 v195, 0
v_mov_b32 v196, 0
v_mov_b32 v197, 0
v_mov_b32 v198, 0
v_mov_b32 v199, 0
v_mov_b32 v200, 0
v_mov_b32 v201, 0
v_mov_b32 v202, 0
v_mov_b32 v203, 0
v_mov_b32 v204, 0
v_mov_b32 v205, 0
v_mov_b32 v206, 0
v_mov_b32 v207, 0
v_mov_b32 v208, 0
v_mov_b32 v209, 0
v_mov_b32 v210, 0
v_mov_b32 v211, 0
v_mov_b32 v212, 0
v_mov_b32 v213, 0
v_mov_b32 v214, 0
v_mov_b32 v215, 0
v_mov_b32 v216, 0
v_mov_b32 v217, 0
v_mov_b32 v218, 0
v_mov_b32 v219, 0
v_mov_b32 v220, 0
v_mov_b32 v221, 0
v_mov_b32 v222, 0
v_mov_b32 v223, 0
v_mov_b32 v224, 0
v_mov_b32 v225, 0
v_mov_b32 v226, 0
v_mov_b32 v227, 0
v_mov_b32 v228, 0
v_mov_b32 v229, 0
v_mov_b32 v230, 0
v_mov_b32 v231, 0
v_mov_b32 v232, 0
v_mov_b32 v233, 0
v_mov_b32 v234, 0
v_mov_b32 v235, 0
v_mov_b32 v236, 0
v_mov_b32 v237, 0
v_mov_b32 v238, 0
v_mov_b32 v239, 0
v_mov_b32 v240, 0
v_mov_b32 v241, 0
v_mov_b32 v242, 0
v_mov_b32 v243, 0
v_mov_b32 v244, 0
v_mov_b32 v245, 0
v_mov_b32 v246, 0
v_mov_b32 v247, 0
v_mov_b32 v248, 0
v_mov_b32 v249, 0
v_mov_b32 v250, 0
v_mov_b32 v251, 0
v_mov_b32 v48, 0x3f803f80
v_mov_b32 v49, 0x3f803f80
v_mov_b32 v50, 0x3f803f80
v_mov_b32 v51, 0x3f803f80
s_mov_b32 s48, 0xf149f2ca
v_mov_b32 v9, s48
v_lshlrev_b32 v4, 2, v3
v_sub_u32 v4, v2, v4
v_subrev_u32 v5, 0, v4
v_and_b32 v6, 0x80000001, v5
v_cmp_eq_u32 vcc, 0, v6
v_add_u32 v5, 1, v5
v_and_b32 v6, 0x80000001, v5
v_cndmask_b32 v40, v9, 0, vcc
v_cmp_eq_u32 vcc, 0x80000001, v6
s_nop 1
v_cndmask_b32 v36, v9, 0, vcc
v_subrev_u32 v5, 1, v4
v_and_b32 v6, 0x80000001, v5
v_cmp_eq_u32 vcc, 0, v6
v_add_u32 v5, 1, v5
v_and_b32 v6, 0x80000001, v5
v_cndmask_b32 v41, v9, 0, vcc
v_cmp_eq_u32 vcc, 0x80000001, v6
s_nop 1
v_cndmask_b32 v37, v9, 0, vcc
v_subrev_u32 v5, 2, v4
v_and_b32 v6, 0x80000001, v5
v_cmp_eq_u32 vcc, 0, v6
v_add_u32 v5, 1, v5
v_and_b32 v6, 0x80000001, v5
v_cndmask_b32 v42, v9, 0, vcc
v_cmp_eq_u32 vcc, 0x80000001, v6
s_nop 1
v_cndmask_b32 v38, v9, 0, vcc
v_subrev_u32 v5, 3, v4
v_and_b32 v6, 0x80000001, v5
v_cmp_eq_u32 vcc, 0, v6
v_add_u32 v5, 1, v5
v_and_b32 v6, 0x80000001, v5
v_cndmask_b32 v43, v9, 0, vcc
v_cmp_eq_u32 vcc, 0x80000001, v6
s_nop 1
v_cndmask_b32 v39, v9, 0, vcc
s_or_b32 s48, s41, s44
s_cmp_eq_u32 s48, 0
s_cselect_b64 vcc, -1, 0
v_cndmask_b32 v44, v36, v9, vcc
v_cndmask_b32 v45, v37, v9, vcc
v_cndmask_b32 v46, v38, v9, vcc
v_cndmask_b32 v47, v39, v9, vcc
v_and_b32 v4, 1, v2
v_lshlrev_b32 v4, 4, v4
v_mov_b32 v5, 0xffff
v_lshlrev_b32 v52, v4, v5
s_lshl_b32 s48, s43, 11
s_add_u32 s48, s48, 135168
v_add_u32 v53, s48, v18
v_lshl_add_u32 v55, v0, 3, s48
s_add_u32 s48, s41, s44
s_sub_u32 s48, s48, 1
s_lshl_b32 s49, s48, 1
s_add_u32 s49, s49, s43
s_lshl_b32 s49, s49, 11
s_mul_i32 s50, s42, 65536
s_add_u32 s49, s49, s50
s_add_u32 s49, s49, 8388608
s_cmp_lt_i32 s48, 0
s_cselect_b32 s49, 0xf0000000, s49
v_add_u32 v58, s49, v18
v_lshl_add_u32 v59, v0, 3, s49
s_lshl_b32 s48, s43, 2
s_add_u32 s48, s48, 134672
v_mov_b32 v19, s48
s_lshl_b32 s48, s43, 7
s_add_u32 s48, s48, 133120
v_lshl_add_u32 v7, v3, 4, s48
v_lshl_add_u32 v54, v2, 2, s48
s_lshl_b32 s49, s44, 6
v_add_u32 v8, s49, v2
v_lshlrev_b32 v8, 3, v8
v_add_u32 v8, 131072, v8
v_lshl_add_u32 v9, v3, 2, s49
v_lshlrev_b32 v9, 2, v9
v_add_u32 v9, 132096, v9
s_mov_b32 s64, 0
s_mov_b32 s65, 0
s_mov_b32 s66, 0x3e8293ee
s_lshl_b32 s50, s42, 2
s_add_u32 s50, s50, s40
s_lshl_b32 s50, s50, 4
s_add_u32 s50, s50, s41
s_lshl_b32 s50, s50, 8
s_add_u32 s52, s50, 17825792
v_lshrrev_b32 v4, 1, v2
v_lshrrev_b32 v5, 1, v3
v_xor_b32 v4, v4, v5
v_lshlrev_b32 v4, 4, v4
v_and_b32 v5, 1, v3
v_lshl_add_u32 v4, v5, 3, v4
v_lshl_add_u32 v4, v2, 7, v4
s_lshl_b32 s48, s40, 12
v_add_u32 v155, s48, v4
v_mov_b32 v152, 0
v_mov_b32 v153, 0
v_mov_b32 v56, 0
v_mov_b32 v57, 0
s_waitcnt vmcnt(0)
s_barrier
ds_read_b128 v[60:63], v14 offset:0
ds_read_b128 v[64:67], v14 offset:2048
ds_read_b128 v[68:71], v14 offset:4096
ds_read_b128 v[72:75], v14 offset:6144
ds_read_b64_tr_b16 v[84:85], v16 offset:8192
ds_read_b64_tr_b16 v[86:87], v16 offset:8704
ds_read_b64_tr_b16 v[88:89], v17 offset:8192
ds_read_b64_tr_b16 v[90:91], v17 offset:8704
ds_read_b64_tr_b16 v[92:93], v16 offset:16384
ds_read_b64_tr_b16 v[94:95], v16 offset:16896
ds_read_b64_tr_b16 v[96:97], v17 offset:16384
ds_read_b64_tr_b16 v[98:99], v17 offset:16896
ds_read_b64_tr_b16 v[76:77], v16 offset:0
ds_read_b64_tr_b16 v[78:79], v16 offset:512
ds_read_b64_tr_b16 v[80:81], v17 offset:0
ds_read_b64_tr_b16 v[82:83], v17 offset:512
s_waitcnt lgkmcnt(0)
c0_loop:
v_mfma_f32_16x16x32_bf16 v[212:215], v[84:87], v[72:75], v[212:215]
ds_read_b128 v[100:103], v15 offset:0
v_mfma_f32_16x16x32_bf16 v[204:207], v[84:87], v[68:71], v[204:207]
ds_read_b128 v[104:107], v15 offset:2048
v_mfma_f32_16x16x32_bf16 v[196:199], v[84:87], v[64:67], v[196:199]
ds_read_b128 v[108:111], v15 offset:4096
v_mfma_f32_16x16x32_bf16 v[188:191], v[84:87], v[60:63], v[188:191]
ds_read_b128 v[112:115], v15 offset:6144
v_mfma_f32_16x16x32_bf16 v[192:195], v[88:91], v[60:63], v[192:195]
ds_read_b64_tr_b16 v[124:125], v16 offset:12288
v_mfma_f32_16x16x32_bf16 v[200:203], v[88:91], v[64:67], v[200:203]
ds_read_b64_tr_b16 v[126:127], v16 offset:12800
v_mfma_f32_16x16x32_bf16 v[208:211], v[88:91], v[68:71], v[208:211]
ds_read_b64_tr_b16 v[128:129], v17 offset:12288
v_mfma_f32_16x16x32_bf16 v[216:219], v[88:91], v[72:75], v[216:219]
ds_read_b64_tr_b16 v[130:131], v17 offset:12800
v_mfma_f32_16x16x32_bf16 v[244:247], v[72:75], v[92:95], v[244:247]
ds_read_b64_tr_b16 v[132:133], v16 offset:20480
v_mfma_f32_16x16x32_bf16 v[248:251], v[72:75], v[96:99], v[248:251]
ds_read_b64_tr_b16 v[134:135], v16 offset:20992
v_mfma_f32_16x16x32_bf16 v[240:243], v[68:71], v[96:99], v[240:243]
ds_read_b64_tr_b16 v[136:137], v17 offset:20480
v_mfma_f32_16x16x32_bf16 v[236:239], v[68:71], v[92:95], v[236:239]
ds_read_b64_tr_b16 v[138:139], v17 offset:20992
v_mfma_f32_16x16x32_bf16 v[228:231], v[64:67], v[92:95], v[228:231]
ds_read_b64_tr_b16 v[116:117], v16 offset:4096
v_mfma_f32_16x16x32_bf16 v[232:235], v[64:67], v[96:99], v[232:235]
ds_read_b64_tr_b16 v[118:119], v16 offset:4608
v_mfma_f32_16x16x32_bf16 v[224:227], v[60:63], v[96:99], v[224:227]
ds_read_b64_tr_b16 v[120:121], v17 offset:4096
v_mfma_f32_16x16x32_bf16 v[220:223], v[60:63], v[92:95], v[220:223]
ds_read_b64_tr_b16 v[122:123], v17 offset:4608
v_mfma_f32_16x16x32_bf16 v[156:159], v[76:79], v[60:63], v[156:159]
s_cmp_eq_u32 s77, s64
s_cbranch_scc1 c0_hook
c0_hook_ret:
v_mfma_f32_16x16x32_bf16 v[164:167], v[76:79], v[64:67], v[164:167]
s_add_u32 s65, s65, 40960
s_cmp_eq_u32 s65, 122880
v_mfma_f32_16x16x32_bf16 v[172:175], v[76:79], v[68:71], v[172:175]
s_cselect_b32 s65, 0, s65
s_add_u32 s64, s64, 1
v_mfma_f32_16x16x32_bf16 v[180:183], v[76:79], v[72:75], v[180:183]
v_add_u32 v14, s65, v10
v_add_u32 v15, s65, v11
v_mfma_f32_16x16x32_bf16 v[184:187], v[80:83], v[72:75], v[184:187]
v_add_u32 v16, s65, v12
v_add_u32 v17, s65, v13
v_mfma_f32_16x16x32_bf16 v[176:179], v[80:83], v[68:71], v[176:179]
s_cmp_eq_u32 s64, 16
s_cbranch_scc1 c0_last
v_mfma_f32_16x16x32_bf16 v[168:171], v[80:83], v[64:67], v[168:171]
s_waitcnt lgkmcnt(0)
v_mfma_f32_16x16x32_bf16 v[160:163], v[80:83], v[60:63], v[160:163]
s_barrier
v_mfma_f32_16x16x32_bf16 v[212:215], v[124:127], v[112:115], v[212:215]
ds_read_b128 v[60:63], v14 offset:0
v_mfma_f32_16x16x32_bf16 v[204:207], v[124:127], v[108:111], v[204:207]
ds_read_b128 v[64:67], v14 offset:2048
v_mfma_f32_16x16x32_bf16 v[196:199], v[124:127], v[104:107], v[196:199]
ds_read_b128 v[68:71], v14 offset:4096
v_mfma_f32_16x16x32_bf16 v[188:191], v[124:127], v[100:103], v[188:191]
ds_read_b128 v[72:75], v14 offset:6144
v_mfma_f32_16x16x32_bf16 v[192:195], v[128:131], v[100:103], v[192:195]
ds_read_b64_tr_b16 v[84:85], v16 offset:8192
v_mfma_f32_16x16x32_bf16 v[200:203], v[128:131], v[104:107], v[200:203]
ds_read_b64_tr_b16 v[86:87], v16 offset:8704
v_mfma_f32_16x16x32_bf16 v[208:211], v[128:131], v[108:111], v[208:211]
ds_read_b64_tr_b16 v[88:89], v17 offset:8192
v_mfma_f32_16x16x32_bf16 v[216:219], v[128:131], v[112:115], v[216:219]
ds_read_b64_tr_b16 v[90:91], v17 offset:8704
v_mfma_f32_16x16x32_bf16 v[244:247], v[112:115], v[132:135], v[244:247]
ds_read_b64_tr_b16 v[92:93], v16 offset:16384
v_mfma_f32_16x16x32_bf16 v[248:251], v[112:115], v[136:139], v[248:251]
ds_read_b64_tr_b16 v[94:95], v16 offset:16896
v_mfma_f32_16x16x32_bf16 v[240:243], v[108:111], v[136:139], v[240:243]
ds_read_b64_tr_b16 v[96:97], v17 offset:16384
v_mfma_f32_16x16x32_bf16 v[236:239], v[108:111], v[132:135], v[236:239]
ds_read_b64_tr_b16 v[98:99], v17 offset:16896
v_mfma_f32_16x16x32_bf16 v[228:231], v[104:107], v[132:135], v[228:231]
ds_read_b64_tr_b16 v[76:77], v16 offset:0
v_mfma_f32_16x16x32_bf16 v[232:235], v[104:107], v[136:139], v[232:235]
ds_read_b64_tr_b16 v[78:79], v16 offset:512
v_mfma_f32_16x16x32_bf16 v[224:227], v[100:103], v[136:139], v[224:227]
ds_read_b64_tr_b16 v[80:81], v17 offset:0
v_mfma_f32_16x16x32_bf16 v[220:223], v[100:103], v[132:135], v[220:223]
ds_read_b64_tr_b16 v[82:83], v17 offset:512
v_mfma_f32_16x16x32_bf16 v[156:159], v[116:119], v[100:103], v[156:159]
v_mfma_f32_16x16x32_bf16 v[164:167], v[116:119], v[104:107], v[164:167]
v_mfma_f32_16x16x32_bf16 v[172:175], v[116:119], v[108:111], v[172:175]
v_mfma_f32_16x16x32_bf16 v[180:183], v[116:119], v[112:115], v[180:183]
v_mfma_f32_16x16x32_bf16 v[184:187], v[120:123], v[112:115], v[184:187]
v_mfma_f32_16x16x32_bf16 v[176:179], v[120:123], v[108:111], v[176:179]
v_mfma_f32_16x16x32_bf16 v[168:171], v[120:123], v[104:107], v[168:171]
s_waitcnt lgkmcnt(0)
v_mfma_f32_16x16x32_bf16 v[160:163], v[120:123], v[100:103], v[160:163]
s_branch c0_loop
c0_hook:
v_add_u32 v4, s65, v155
ds_read_b64 v[20:21], v4 offset:0
ds_read_b64 v[28:29], v4 offset:2048
v_xor_b32 v5, 32, v4
ds_read_b64 v[22:23], v5 offset:0
ds_read_b64 v[30:31], v5 offset:2048
v_xor_b32 v5, 64, v4
ds_read_b64 v[24:25], v5 offset:0
ds_read_b64 v[32:33], v5 offset:2048
v_xor_b32 v5, 96, v4
ds_read_b64 v[26:27], v5 offset:0
ds_read_b64 v[34:35], v5 offset:2048
s_waitcnt lgkmcnt(8)
s_cmp_lg_u32 s44, 0
s_cbranch_scc1 else_61
v_mfma_f32_16x16x32_bf16 v[140:143], v[48:51], v[76:79], 0
v_mfma_f32_16x16x32_bf16 v[144:147], v[48:51], v[84:87], 0
v_mfma_f32_16x16x32_bf16 v[148:151], v[48:51], v[92:95], 0
v_mfma_f32_16x16x32_bf16 v[140:143], v[48:51], v[116:119], v[140:143]
v_mfma_f32_16x16x32_bf16 v[144:147], v[48:51], v[124:127], v[144:147]
v_mfma_f32_16x16x32_bf16 v[148:151], v[48:51], v[132:135], v[148:151]
s_branch fi_62
else_61:
v_mfma_f32_16x16x32_bf16 v[140:143], v[48:51], v[80:83], 0
v_mfma_f32_16x16x32_bf16 v[144:147], v[48:51], v[88:91], 0
v_mfma_f32_16x16x32_bf16 v[148:151], v[48:51], v[96:99], 0
v_mfma_f32_16x16x32_bf16 v[140:143], v[48:51], v[120:123], v[140:143]
v_mfma_f32_16x16x32_bf16 v[144:147], v[48:51], v[128:131], v[144:147]
v_mfma_f32_16x16x32_bf16 v[148:151], v[48:51], v[136:139], v[148:151]
fi_62:
s_waitcnt lgkmcnt(0)
v_dot2c_f32_bf16 v152, v20, v48
v_dot2c_f32_bf16 v56, v20, v20
v_dot2c_f32_bf16 v153, v28, v48
v_dot2c_f32_bf16 v57, v28, v28
v_dot2c_f32_bf16 v152, v21, v48
v_dot2c_f32_bf16 v56, v21, v21
v_dot2c_f32_bf16 v153, v29, v48
v_dot2c_f32_bf16 v57, v29, v29
v_dot2c_f32_bf16 v152, v22, v48
v_dot2c_f32_bf16 v56, v22, v22
v_dot2c_f32_bf16 v153, v30, v48
v_dot2c_f32_bf16 v57, v30, v30
v_dot2c_f32_bf16 v152, v23, v48
v_dot2c_f32_bf16 v56, v23, v23
v_dot2c_f32_bf16 v153, v31, v48
v_dot2c_f32_bf16 v57, v31, v31
v_dot2c_f32_bf16 v152, v24, v48
v_dot2c_f32_bf16 v56, v24, v24
v_dot2c_f32_bf16 v153, v32, v48
v_dot2c_f32_bf16 v57, v32, v32
v_dot2c_f32_bf16 v152, v25, v48
v_dot2c_f32_bf16 v56, v25, v25
v_dot2c_f32_bf16 v153, v33, v48
v_dot2c_f32_bf16 v57, v33, v33
v_dot2c_f32_bf16 v152, v26, v48
v_dot2c_f32_bf16 v56, v26, v26
v_dot2c_f32_bf16 v153, v34, v48
v_dot2c_f32_bf16 v57, v34, v34
v_dot2c_f32_bf16 v152, v27, v48
v_dot2c_f32_bf16 v56, v27, v27
v_dot2c_f32_bf16 v153, v35, v48
v_dot2c_f32_bf16 v57, v35, v35
v_cmp_eq_u32 vcc, 0, v3
v_cmp_eq_u32 s[48:49], 1, v3
s_nop 1
v_cndmask_b32 v4, v148, v144, s[48:49]
v_cndmask_b32 v4, v4, v140, vcc
buffer_store_dword v4, v1, s[32:35], s52 offen sc1
s_nop 1
v_permlane32_swap_b32 v152, v153
v_permlane32_swap_b32 v56, v57
v_add_f32 v152, v152, v153
v_add_f32 v56, v56, v57
s_nop 1
v_permlane16_swap_b32 v152, v56
s_nop 0
v_add_f32 v152, v152, v56
buffer_store_dword v152, v1, s[32:35], s87 offen sc1
s_branch c0_hook_ret
c0_last:
v_mfma_f32_16x16x32_bf16 v[168:171], v[80:83], v[64:67], v[168:171]
s_waitcnt lgkmcnt(0)
v_mfma_f32_16x16x32_bf16 v[160:163], v[80:83], v[60:63], v[160:163]
v_mfma_f32_16x16x32_bf16 v[212:215], v[124:127], v[112:115], v[212:215]
v_mfma_f32_16x16x32_bf16 v[204:207], v[124:127], v[108:111], v[204:207]
v_mfma_f32_16x16x32_bf16 v[196:199], v[124:127], v[104:107], v[196:199]
v_mfma_f32_16x16x32_bf16 v[188:191], v[124:127], v[100:103], v[188:191]
v_mfma_f32_16x16x32_bf16 v[192:195], v[128:131], v[100:103], v[192:195]
v_mfma_f32_16x16x32_bf16 v[200:203], v[128:131], v[104:107], v[200:203]
v_mfma_f32_16x16x32_bf16 v[208:211], v[128:131], v[108:111], v[208:211]
v_mfma_f32_16x16x32_bf16 v[216:219], v[128:131], v[112:115], v[216:219]
s_barrier
v_mfma_f32_16x16x32_bf16 v[244:247], v[112:115], v[132:135], v[244:247]
ds_read_b128 v[140:143], v7 offset:0
ds_read_b128 v[144:147], v7 offset:64
v_mfma_f32_16x16x32_bf16 v[248:251], v[112:115], v[136:139], v[248:251]
ds_read_b128 v[148:151], v7 offset:256
ds_read_b128 v[152:155], v7 offset:320
v_mfma_f32_16x16x32_bf16 v[240:243], v[108:111], v[136:139], v[240:243]
ds_read_b64 v[92:93], v8 offset:0
ds_read_b64 v[94:95], v8 offset:128
v_mfma_f32_16x16x32_bf16 v[236:239], v[108:111], v[132:135], v[236:239]
ds_read_b64 v[96:97], v8 offset:256
ds_read_b64 v[98:99], v8 offset:384
v_mfma_f32_16x16x32_bf16 v[228:231], v[104:107], v[132:135], v[228:231]
ds_read2_b32 v[56:57], v54 offset0:128 offset1:144
ds_read_b128 v[60:63], v9 offset:0
v_mfma_f32_16x16x32_bf16 v[232:235], v[104:107], v[136:139], v[232:235]
ds_read_b128 v[64:67], v9 offset:64
v_mfma_f32_16x16x32_bf16 v[224:227], v[100:103], v[136:139], v[224:227]
ds_read_b128 v[68:71], v9 offset:128
v_mfma_f32_16x16x32_bf16 v[220:223], v[100:103], v[132:135], v[220:223]
ds_read_b128 v[72:75], v9 offset:192
v_mfma_f32_16x16x32_bf16 v[156:159], v[116:119], v[100:103], v[156:159]
ds_read_b128 v[76:79], v9 offset:512
v_mfma_f32_16x16x32_bf16 v[164:167], v[116:119], v[104:107], v[164:167]
ds_read_b128 v[80:83], v9 offset:576
v_mfma_f32_16x16x32_bf16 v[172:175], v[116:119], v[108:111], v[172:175]
ds_read_b128 v[84:87], v9 offset:640
v_mfma_f32_16x16x32_bf16 v[180:183], v[116:119], v[112:115], v[180:183]
ds_read_b128 v[88:91], v9 offset:704
v_mfma_f32_16x16x32_bf16 v[184:187], v[120:123], v[112:115], v[184:187]
v_mov_b32 v6, 134656
ds_read_b32 v6, v6
v_mfma_f32_16x16x32_bf16 v[176:179], v[120:123], v[108:111], v[176:179]
v_mfma_f32_16x16x32_bf16 v[168:171], v[120:123], v[104:107], v[168:171]
v_mfma_f32_16x16x32_bf16 v[160:163], v[120:123], v[100:103], v[160:163]
c0_epi:
s_waitcnt lgkmcnt(0)
v_readfirstlane_b32 s46, v6
.p2align 3
v_pk_fma_f32 v[212:213], v[148:149], v[98:99], v[212:213] op_sel:[0,1,0] op_sel_hi:[1,1,1]
v_pk_fma_f32 v[214:215], v[150:151], v[98:99], v[214:215] op_sel:[0,1,0] op_sel_hi:[1,1,1]
v_pk_fma_f32 v[216:217], v[152:153], v[98:99], v[216:217] op_sel:[0,1,0] op_sel_hi:[1,1,1]
v_pk_fma_f32 v[218:219], v[154:155], v[98:99], v[218:219] op_sel:[0,1,0] op_sel_hi:[1,1,1]
v_pk_mul_f32 v[212:213], v[212:213], v[98:99] op_sel:[0,0] op_sel_hi:[1,0]
v_pk_mul_f32 v[214:215], v[214:215], v[98:99] op_sel:[0,0] op_sel_hi:[1,0]
v_pk_mul_f32 v[216:217], v[216:217], v[98:99] op_sel:[0,0] op_sel_hi:[1,0]
v_pk_mul_f32 v[218:219], v[218:219], v[98:99] op_sel:[0,0] op_sel_hi:[1,0]
v_cvt_pk_bf16_f32 v212, v212, v213
v_cvt_pk_bf16_f32 v213, v214, v215
v_cvt_pk_bf16_f32 v214, v216, v217
v_cvt_pk_bf16_f32 v215, v218, v219
v_pk_fma_f32 v[244:245], v[88:89], v[56:57], v[244:245] op_sel:[0,0,0] op_sel_hi:[1,0,1]
v_pk_fma_f32 v[246:247], v[90:91], v[56:57], v[246:247] op_sel:[0,0,0] op_sel_hi:[1,0,1]
v_pk_mul_f32 v[244:245], v[244:245], v[72:73]
v_pk_mul_f32 v[246:247], v[246:247], v[74:75]
v_cvt_pk_bf16_f32 v108, v244, v245
v_cvt_pk_bf16_f32 v109, v246, v247
v_pk_fma_f32 v[248:249], v[88:89], v[56:57], v[248:249] op_sel:[0,1,0] op_sel_hi:[1,1,1]
v_pk_fma_f32 v[250:251], v[90:91], v[56:57], v[250:251] op_sel:[0,1,0] op_sel_hi:[1,1,1]
v_pk_mul_f32 v[248:249], v[248:249], v[72:73]
v_pk_mul_f32 v[250:251], v[250:251], v[74:75]
v_cvt_pk_bf16_f32 v118, v248, v249
v_cvt_pk_bf16_f32 v119, v250, v251
s_cmp_lg_u32 s44, 1
s_cbranch_scc1 else_63
buffer_store_dwordx4 v[212:215], v58, s[32:35], 0 offen sc1
buffer_store_dwordx2 v[108:109], v59, s[32:35], 0 offen offset:1024 sc1
buffer_store_dwordx2 v[118:119], v59, s[32:35], 0 offen offset:1536 sc1
s_branch fi_64
else_63:
ds_write_b128 v53, v[212:215]
ds_write_b64 v55, v[108:109] offset:1024
ds_write_b64 v55, v[118:119] offset:1536
v_mov_b32 v4, 1
ds_write_b32 v19, v4
fi_64:
v_mul_f32 v124, s66, v92
v_mul_f32 v125, s66, v94
v_mul_f32 v126, s66, v96
v_mul_f32 v127, s66, v98
.p2align 3
v_pk_fma_f32 v[156:157], v[140:141], v[92:93], v[156:157] op_sel:[0,1,0] op_sel_hi:[1,1,1]
v_pk_fma_f32 v[158:159], v[142:143], v[92:93], v[158:159] op_sel:[0,1,0] op_sel_hi:[1,1,1]
v_pk_fma_f32 v[160:161], v[144:145], v[92:93], v[160:161] op_sel:[0,1,0] op_sel_hi:[1,1,1]
v_pk_fma_f32 v[162:163], v[146:147], v[92:93], v[162:163] op_sel:[0,1,0] op_sel_hi:[1,1,1]
v_cvt_pk_bf16_f32 v156, v156, v157
v_cvt_pk_bf16_f32 v157, v158, v159
v_cvt_pk_bf16_f32 v158, v160, v161
v_cvt_pk_bf16_f32 v159, v162, v163
v_pk_fma_f32 v[164:165], v[140:141], v[94:95], v[164:165] op_sel:[0,1,0] op_sel_hi:[1,1,1]
v_pk_fma_f32 v[166:167], v[142:143], v[94:95], v[166:167] op_sel:[0,1,0] op_sel_hi:[1,1,1]
v_pk_fma_f32 v[168:169], v[144:145], v[94:95], v[168:169] op_sel:[0,1,0] op_sel_hi:[1,1,1]
v_pk_fma_f32 v[170:171], v[146:147], v[94:95], v[170:171] op_sel:[0,1,0] op_sel_hi:[1,1,1]
v_cvt_pk_bf16_f32 v164, v164, v165
v_cvt_pk_bf16_f32 v165, v166, v167
v_cvt_pk_bf16_f32 v166, v168, v169
v_cvt_pk_bf16_f32 v167, v170, v171
v_pk_fma_f32 v[172:173], v[140:141], v[96:97], v[172:173] op_sel:[0,1,0] op_sel_hi:[1,1,1]
v_pk_fma_f32 v[174:175], v[142:143], v[96:97], v[174:175] op_sel:[0,1,0] op_sel_hi:[1,1,1]
v_pk_fma_f32 v[176:177], v[144:145], v[96:97], v[176:177] op_sel:[0,1,0] op_sel_hi:[1,1,1]
v_pk_fma_f32 v[178:179], v[146:147], v[96:97], v[178:179] op_sel:[0,1,0] op_sel_hi:[1,1,1]
v_cvt_pk_bf16_f32 v172, v172, v173
v_cvt_pk_bf16_f32 v173, v174, v175
v_cvt_pk_bf16_f32 v174, v176, v177
v_cvt_pk_bf16_f32 v175, v178, v179
v_pk_fma_f32 v[180:181], v[140:141], v[98:99], v[180:181] op_sel:[0,1,0] op_sel_hi:[1,1,1]
v_pk_fma_f32 v[182:183], v[142:143], v[98:99], v[182:183] op_sel:[0,1,0] op_sel_hi:[1,1,1]
v_pk_fma_f32 v[184:185], v[144:145], v[98:99], v[184:185] op_sel:[0,1,0] op_sel_hi:[1,1,1]
v_pk_fma_f32 v[186:187], v[146:147], v[98:99], v[186:187] op_sel:[0,1,0] op_sel_hi:[1,1,1]
v_cvt_pk_bf16_f32 v180, v180, v181
v_cvt_pk_bf16_f32 v181, v182, v183
v_cvt_pk_bf16_f32 v182, v184, v185
v_cvt_pk_bf16_f32 v183, v186, v187
v_pk_fma_f32 v[188:189], v[148:149], v[92:93], v[188:189] op_sel:[0,1,0] op_sel_hi:[1,1,1]
v_pk_fma_f32 v[190:191], v[150:151], v[92:93], v[190:191] op_sel:[0,1,0] op_sel_hi:[1,1,1]
v_pk_fma_f32 v[192:193], v[152:153], v[92:93], v[192:193] op_sel:[0,1,0] op_sel_hi:[1,1,1]
v_pk_fma_f32 v[194:195], v[154:155], v[92:93], v[194:195] op_sel:[0,1,0] op_sel_hi:[1,1,1]
v_pk_mul_f32 v[188:189], v[188:189], v[92:93] op_sel:[0,0] op_sel_hi:[1,0]
v_pk_mul_f32 v[190:191], v[190:191], v[92:93] op_sel:[0,0] op_sel_hi:[1,0]
v_pk_mul_f32 v[192:193], v[192:193], v[92:93] op_sel:[0,0] op_sel_hi:[1,0]
v_pk_mul_f32 v[194:195], v[194:195], v[92:93] op_sel:[0,0] op_sel_hi:[1,0]
v_cvt_pk_bf16_f32 v188, v188, v189
v_cvt_pk_bf16_f32 v189, v190, v191
v_cvt_pk_bf16_f32 v190, v192, v193
v_cvt_pk_bf16_f32 v191, v194, v195
v_pk_fma_f32 v[196:197], v[148:149], v[94:95], v[196:197] op_sel:[0,1,0] op_sel_hi:[1,1,1]
v_pk_fma_f32 v[198:199], v[150:151], v[94:95], v[198:199] op_sel:[0,1,0] op_sel_hi:[1,1,1]
v_pk_fma_f32 v[200:201], v[152:153], v[94:95], v[200:201] op_sel:[0,1,0] op_sel_hi:[1,1,1]
v_pk_fma_f32 v[202:203], v[154:155], v[94:95], v[202:203] op_sel:[0,1,0] op_sel_hi:[1,1,1]
v_pk_mul_f32 v[196:197], v[196:197], v[94:95] op_sel:[0,0] op_sel_hi:[1,0]
v_pk_mul_f32 v[198:199], v[198:199], v[94:95] op_sel:[0,0] op_sel_hi:[1,0]
v_pk_mul_f32 v[200:201], v[200:201], v[94:95] op_sel:[0,0] op_sel_hi:[1,0]
v_pk_mul_f32 v[202:203], v[202:203], v[94:95] op_sel:[0,0] op_sel_hi:[1,0]
v_cvt_pk_bf16_f32 v196, v196, v197
v_cvt_pk_bf16_f32 v197, v198, v199
v_cvt_pk_bf16_f32 v198, v200, v201
v_cvt_pk_bf16_f32 v199, v202, v203
v_pk_fma_f32 v[204:205], v[148:149], v[96:97], v[204:205] op_sel:[0,1,0] op_sel_hi:[1,1,1]
v_pk_fma_f32 v[206:207], v[150:151], v[96:97], v[206:207] op_sel:[0,1,0] op_sel_hi:[1,1,1]
v_pk_fma_f32 v[208:209], v[152:153], v[96:97], v[208:209] op_sel:[0,1,0] op_sel_hi:[1,1,1]
v_pk_fma_f32 v[210:211], v[154:155], v[96:97], v[210:211] op_sel:[0,1,0] op_sel_hi:[1,1,1]
v_pk_mul_f32 v[204:205], v[204:205], v[96:97] op_sel:[0,0] op_sel_hi:[1,0]
v_pk_mul_f32 v[206:207], v[206:207], v[96:97] op_sel:[0,0] op_sel_hi:[1,0]
v_pk_mul_f32 v[208:209], v[208:209], v[96:97] op_sel:[0,0] op_sel_hi:[1,0]
v_pk_mul_f32 v[210:211], v[210:211], v[96:97] op_sel:[0,0] op_sel_hi:[1,0]
v_cvt_pk_bf16_f32 v204, v204, v205
v_cvt_pk_bf16_f32 v205, v206, v207
v_cvt_pk_bf16_f32 v206, v208, v209
v_cvt_pk_bf16_f32 v207, v210, v211
s_cmp_lg_u32 s44, 0
s_cbranch_scc1 else_65
buffer_load_dwordx4 v[120:123], v58, s[32:35], 0 offen sc1
buffer_load_dwordx2 v[100:101], v59, s[32:35], 0 offen offset:1024 sc1
buffer_load_dwordx2 v[110:111], v59, s[32:35], 0 offen offset:1536 sc1
else_65:
.p2align 3
v_mfma_f32_16x16x32_bf16 v[216:219], v[212:215], v[180:183], v[40:43]
v_pk_fma_f32 v[220:221], v[76:77], v[56:57], v[220:221] op_sel:[0,0,0] op_sel_hi:[1,0,1]
v_pk_fma_f32 v[222:223], v[78:79], v[56:57], v[222:223] op_sel:[0,0,0] op_sel_hi:[1,0,1]
v_pk_mul_f32 v[220:221], v[220:221], v[60:61]
v_pk_mul_f32 v[222:223], v[222:223], v[62:63]
v_cvt_pk_bf16_f32 v102, v220, v221
v_mfma_f32_16x16x32_bf16 v[192:195], v[188:191], v[156:159], v[40:43]
v_cvt_pk_bf16_f32 v103, v222, v223
v_pk_fma_f32 v[224:225], v[76:77], v[56:57], v[224:225] op_sel:[0,1,0] op_sel_hi:[1,1,1]
v_pk_fma_f32 v[226:227], v[78:79], v[56:57], v[226:227] op_sel:[0,1,0] op_sel_hi:[1,1,1]
v_pk_mul_f32 v[224:225], v[224:225], v[60:61]
v_pk_mul_f32 v[226:227], v[226:227], v[62:63]
v_cvt_pk_bf16_f32 v112, v224, v225
v_mfma_f32_16x16x32_bf16 v[168:171], v[188:191], v[164:167], v[36:39]
v_cvt_pk_bf16_f32 v113, v226, v227
v_pk_fma_f32 v[228:229], v[80:81], v[56:57], v[228:229] op_sel:[0,0,0] op_sel_hi:[1,0,1]
v_pk_fma_f32 v[230:231], v[82:83], v[56:57], v[230:231] op_sel:[0,0,0] op_sel_hi:[1,0,1]
v_pk_mul_f32 v[228:229], v[228:229], v[64:65]
v_pk_mul_f32 v[230:231], v[230:231], v[66:67]
v_cvt_pk_bf16_f32 v104, v228, v229
v_mfma_f32_16x16x32_bf16 v[200:203], v[196:199], v[164:167], v[40:43]
v_cvt_pk_bf16_f32 v105, v230, v231
v_pk_fma_f32 v[232:233], v[80:81], v[56:57], v[232:233] op_sel:[0,1,0] op_sel_hi:[1,1,1]
v_pk_fma_f32 v[234:235], v[82:83], v[56:57], v[234:235] op_sel:[0,1,0] op_sel_hi:[1,1,1]
v_pk_mul_f32 v[232:233], v[232:233], v[64:65]
v_pk_mul_f32 v[234:235], v[234:235], v[66:67]
v_cvt_pk_bf16_f32 v114, v232, v233
v_mfma_f32_16x16x32_bf16 v[176:179], v[196:199], v[172:175], v[36:39]
v_cvt_pk_bf16_f32 v115, v234, v235
v_pk_fma_f32 v[236:237], v[84:85], v[56:57], v[236:237] op_sel:[0,0,0] op_sel_hi:[1,0,1]
v_pk_fma_f32 v[238:239], v[86:87], v[56:57], v[238:239] op_sel:[0,0,0] op_sel_hi:[1,0,1]
v_pk_mul_f32 v[236:237], v[236:237], v[68:69]
v_pk_mul_f32 v[238:239], v[238:239], v[70:71]
v_cvt_pk_bf16_f32 v106, v236, v237
v_mfma_f32_16x16x32_bf16 v[208:211], v[204:207], v[172:175], v[40:43]
v_cvt_pk_bf16_f32 v107, v238, v239
v_pk_fma_f32 v[240:241], v[84:85], v[56:57], v[240:241] op_sel:[0,1,0] op_sel_hi:[1,1,1]
v_pk_fma_f32 v[242:243], v[86:87], v[56:57], v[242:243] op_sel:[0,1,0] op_sel_hi:[1,1,1]
v_pk_mul_f32 v[240:241], v[240:241], v[68:69]
v_pk_mul_f32 v[242:243], v[242:243], v[70:71]
v_cvt_pk_bf16_f32 v116, v240, v241
v_mfma_f32_16x16x32_bf16 v[184:187], v[204:207], v[180:183], v[36:39]
v_cvt_pk_bf16_f32 v117, v242, v243
v_max_f32 v166, v200, v201
v_max_f32 v167, v202, v203
v_max_f32 v164, v168, v169
v_max_f32 v165, v170, v171
v_max3_f32 v129, v164, v165, v166
v_max_f32 v129, v129, v167
s_cmp_lg_u32 s44, 0
s_cbranch_scc1 else_67
s_mov_b32 s63, 0
sent_69:
s_waitcnt vmcnt(0)
v_max_u32 v4, v120, v121
v_max3_u32 v4, v4, v122, v123
v_max3_u32 v4, v4, v100, v101
v_max3_u32 v4, v4, v110, v111
v_cmp_eq_u32 vcc, -1, v4
s_cbranch_vccz sentd_70
buffer_load_dwordx4 v[120:123], v58, s[32:35], 0 offen sc1
buffer_load_dwordx2 v[100:101], v59, s[32:35], 0 offen offset:1024 sc1
buffer_load_dwordx2 v[110:111], v59, s[32:35], 0 offen offset:1536 sc1
s_add_u32 s63, s63, 1
s_cmp_lt_u32 s63, 0x80000
s_cbranch_scc1 sent_69
s_waitcnt vmcnt(0)
sentd_70:
v_mov_b32 v132, -1
v_mov_b32 v133, -1
v_mov_b32 v134, -1
v_mov_b32 v135, -1
buffer_store_dwordx4 v[132:135], v58, s[32:35], 0 offen offset:0 sc1
buffer_store_dwordx4 v[132:135], v58, s[32:35], 0 offen offset:1024 sc1
s_branch fi_68
else_67:
s_mov_b32 s63, 0
px_71:
ds_read_b32 v4, v19
ds_read_b128 v[120:123], v53
ds_read_b64 v[100:101], v55 offset:1024
ds_read_b64 v[110:111], v55 offset:1536
s_add_u32 s63, s63, 1
s_cmp_lt_u32 s63, 0x400000
s_waitcnt lgkmcnt(0)
v_cmp_ne_u32 vcc, 1, v4
s_cbranch_vccz pxd_72
s_cbranch_scc1 px_71
pxd_72:
fi_68:
v_mfma_f32_16x16x32_bf16 v[160:163], v[120:123], v[156:159], v[44:47]
v_max_f32 v174, v208, v209
v_max_f32 v175, v210, v211
v_max_f32 v172, v176, v177
v_max_f32 v173, v178, v179
v_max3_f32 v130, v172, v173, v174
v_max_f32 v130, v130, v175
v_max_f32 v182, v216, v217
v_max_f32 v183, v218, v219
v_max_f32 v180, v184, v185
v_max_f32 v181, v186, v187
v_max3_f32 v131, v180, v181, v182
v_max_f32 v131, v131, v183
v_max_f32 v158, v192, v193
v_max_f32 v159, v194, v195
v_max_f32 v156, v160, v161
v_max_f32 v157, v162, v163
v_max3_f32 v128, v156, v157, v158
v_max_f32 v128, v128, v159
s_nop 1
v_permlane32_swap_b32 v128, v129
v_permlane32_swap_b32 v130, v131
v_max_f32 v128, v128, v129
v_max_f32 v130, v130, v131
s_nop 1
v_permlane16_swap_b32 v128, v130
s_nop 0
v_max_f32 v128, v128, v130
v_mov_b32 v130, v128
s_nop 1
v_permlane16_swap_b32 v128, v130
s_nop 0
v_mov_b32 v129, v128
v_mov_b32 v131, v130
s_nop 0
v_permlane32_swap_b32 v128, v129
v_permlane32_swap_b32 v130, v131
v_pk_mul_f32 v[128:129], v[128:129], v[124:125]
v_pk_mul_f32 v[130:131], v[130:131], v[126:127]
v_pk_fma_f32 v[156:157], v[156:157], v[124:125], v[128:129] op_sel:[0,0,0] op_sel_hi:[1,0,0] neg_lo:[0,0,1] neg_hi:[0,0,1]
v_pk_fma_f32 v[158:159], v[158:159], v[124:125], v[128:129] op_sel:[0,0,0] op_sel_hi:[1,0,0] neg_lo:[0,0,1] neg_hi:[0,0,1]
v_exp_f32 v156, v156
v_exp_f32 v157, v157
v_exp_f32 v158, v158
v_exp_f32 v159, v159
v_cvt_pk_bf16_f32 v156, v156, v156
v_cvt_pk_bf16_f32 v157, v157, v157
v_cvt_pk_bf16_f32 v158, v158, v158
v_cvt_pk_bf16_f32 v159, v159, v159
v_and_b32 v156, v52, v156
v_and_b32 v157, v52, v157
v_and_b32 v158, v52, v158
v_and_b32 v159, v52, v159
v_pk_fma_f32 v[164:165], v[164:165], v[124:125], v[128:129] op_sel:[0,1,1] op_sel_hi:[1,1,1] neg_lo:[0,0,1] neg_hi:[0,0,1]
v_pk_fma_f32 v[166:167], v[166:167], v[124:125], v[128:129] op_sel:[0,1,1] op_sel_hi:[1,1,1] neg_lo:[0,0,1] neg_hi:[0,0,1]
v_exp_f32 v164, v164
v_mfma_f32_16x16x32_bf16 v[160:163], v[48:51], v[156:159], 0
v_exp_f32 v165, v165
v_exp_f32 v166, v166
v_exp_f32 v167, v167
v_cvt_pk_bf16_f32 v164, v164, v164
v_mfma_f32_16x16x32_bf16 v[220:223], v[100:103], v[156:159], 0
v_cvt_pk_bf16_f32 v165, v165, v165
v_cvt_pk_bf16_f32 v166, v166, v166
v_cvt_pk_bf16_f32 v167, v167, v167
v_and_b32 v164, v52, v164
v_mfma_f32_16x16x32_bf16 v[224:227], v[110:113], v[156:159], 0
v_and_b32 v165, v52, v165
v_and_b32 v166, v52, v166
v_and_b32 v167, v52, v167
v_pk_fma_f32 v[172:173], v[172:173], v[126:127], v[130:131] op_sel:[0,0,0] op_sel_hi:[1,0,0] neg_lo:[0,0,1] neg_hi:[0,0,1]
v_pk_fma_f32 v[174:175], v[174:175], v[126:127], v[130:131] op_sel:[0,0,0] op_sel_hi:[1,0,0] neg_lo:[0,0,1] neg_hi:[0,0,1]
v_exp_f32 v172, v172
v_mfma_f32_16x16x32_bf16 v[168:171], v[48:51], v[164:167], 0
v_exp_f32 v173, v173
v_exp_f32 v174, v174
v_exp_f32 v175, v175
v_cvt_pk_bf16_f32 v172, v172, v172
v_mfma_f32_16x16x32_bf16 v[228:231], v[102:105], v[164:167], 0
v_cvt_pk_bf16_f32 v173, v173, v173
v_cvt_pk_bf16_f32 v174, v174, v174
v_cvt_pk_bf16_f32 v175, v175, v175
v_and_b32 v172, v52, v172
v_mfma_f32_16x16x32_bf16 v[232:235], v[112:115], v[164:167], 0
v_and_b32 v173, v52, v173
v_and_b32 v174, v52, v174
v_and_b32 v175, v52, v175
v_pk_fma_f32 v[180:181], v[180:181], v[126:127], v[130:131] op_sel:[0,1,1] op_sel_hi:[1,1,1] neg_lo:[0,0,1] neg_hi:[0,0,1]
v_pk_fma_f32 v[182:183], v[182:183], v[126:127], v[130:131] op_sel:[0,1,1] op_sel_hi:[1,1,1] neg_lo:[0,0,1] neg_hi:[0,0,1]
v_exp_f32 v180, v180
v_mfma_f32_16x16x32_bf16 v[176:179], v[48:51], v[172:175], 0
v_exp_f32 v181, v181
v_exp_f32 v182, v182
v_exp_f32 v183, v183
v_cvt_pk_bf16_f32 v180, v180, v180
v_mfma_f32_16x16x32_bf16 v[236:239], v[104:107], v[172:175], 0
v_cvt_pk_bf16_f32 v181, v181, v181
v_cvt_pk_bf16_f32 v182, v182, v182
v_cvt_pk_bf16_f32 v183, v183, v183
v_and_b32 v180, v52, v180
v_mfma_f32_16x16x32_bf16 v[240:243], v[114:117], v[172:175], 0
v_and_b32 v181, v52, v181
v_and_b32 v182, v52, v182
v_and_b32 v183, v52, v183
v_rcp_f32 v160, v160
v_rcp_f32 v168, v168
v_mfma_f32_16x16x32_bf16 v[184:187], v[48:51], v[180:183], 0
v_mfma_f32_16x16x32_bf16 v[244:247], v[106:109], v[180:183], 0
v_mfma_f32_16x16x32_bf16 v[248:251], v[116:119], v[180:183], 0
v_rcp_f32 v176, v176
s_nop 4
v_rcp_f32 v184, v184
s_cmp_eq_u32 s46, 0
s_cbranch_scc1 slow_73
.p2align 3
v_pk_mul_f32 v[220:221], v[220:221], v[160:161] op_sel:[0,0] op_sel_hi:[1,0]
v_pk_mul_f32 v[222:223], v[222:223], v[160:161] op_sel:[0,0] op_sel_hi:[1,0]
v_pk_mul_f32 v[224:225], v[224:225], v[160:161] op_sel:[0,0] op_sel_hi:[1,0]
v_pk_mul_f32 v[226:227], v[226:227], v[160:161] op_sel:[0,0] op_sel_hi:[1,0]
v_cvt_pk_bf16_f32 v220, v220, v221
v_cvt_pk_bf16_f32 v221, v222, v223
v_cvt_pk_bf16_f32 v222, v224, v225
v_cvt_pk_bf16_f32 v223, v226, v227
buffer_store_dwordx4 v[220:223], v18, s[32:35], s80 offen sc1
v_pk_mul_f32 v[228:229], v[228:229], v[168:169] op_sel:[0,0] op_sel_hi:[1,0]
v_pk_mul_f32 v[230:231], v[230:231], v[168:169] op_sel:[0,0] op_sel_hi:[1,0]
v_pk_mul_f32 v[232:233], v[232:233], v[168:169] op_sel:[0,0] op_sel_hi:[1,0]
v_pk_mul_f32 v[234:235], v[234:235], v[168:169] op_sel:[0,0] op_sel_hi:[1,0]
v_cvt_pk_bf16_f32 v228, v228, v229
v_cvt_pk_bf16_f32 v229, v230, v231
v_cvt_pk_bf16_f32 v230, v232, v233
v_cvt_pk_bf16_f32 v231, v234, v235
buffer_store_dwordx4 v[228:231], v18, s[32:35], s81 offen sc1
v_pk_mul_f32 v[236:237], v[236:237], v[176:177] op_sel:[0,0] op_sel_hi:[1,0]
v_pk_mul_f32 v[238:239], v[238:239], v[176:177] op_sel:[0,0] op_sel_hi:[1,0]
v_pk_mul_f32 v[240:241], v[240:241], v[176:177] op_sel:[0,0] op_sel_hi:[1,0]
v_pk_mul_f32 v[242:243], v[242:243], v[176:177] op_sel:[0,0] op_sel_hi:[1,0]
v_cvt_pk_bf16_f32 v236, v236, v237
v_cvt_pk_bf16_f32 v237, v238, v239
v_cvt_pk_bf16_f32 v238, v240, v241
v_cvt_pk_bf16_f32 v239, v242, v243
buffer_store_dwordx4 v[236:239], v18, s[32:35], s82 offen sc1
v_pk_mul_f32 v[244:245], v[244:245], v[184:185] op_sel:[0,0] op_sel_hi:[1,0]
v_pk_mul_f32 v[246:247], v[246:247], v[184:185] op_sel:[0,0] op_sel_hi:[1,0]
v_pk_mul_f32 v[248:249], v[248:249], v[184:185] op_sel:[0,0] op_sel_hi:[1,0]
v_pk_mul_f32 v[250:251], v[250:251], v[184:185] op_sel:[0,0] op_sel_hi:[1,0]
v_cvt_pk_bf16_f32 v244, v244, v245
v_cvt_pk_bf16_f32 v245, v246, v247
v_cvt_pk_bf16_f32 v246, v248, v249
v_cvt_pk_bf16_f32 v247, v250, v251
buffer_store_dwordx4 v[244:247], v18, s[32:35], s83 offen sc1
back_74:
s_barrier
v_and_b32 v36, 31, v0
v_lshlrev_b32 v36, 2, v36
s_lshl_b32 s62, s45, 2
v_mov_b32 v4, s62
v_mov_b32 v5, 1
s_mov_b64 exec, 1
s_waitcnt vmcnt(0)
s_cmp_eq_u32 s46, 0
s_cbranch_scc1 slow_75
buffer_store_dword v5, v4, s[32:35], s84 offen
back_76:
s_mov_b64 exec, -1
v_lshrrev_b32 v4, 2, v2
v_and_b32 v5, 3, v0
v_lshl_add_u32 v6, v3, 3, v4
v_lshlrev_b32 v6, 7, v6
v_lshl_add_u32 v6, v5, 3, v6
v_lshrrev_b32 v7, 1, v4
v_and_b32 v8, 1, v3
v_lshl_add_u32 v7, v8, 1, v7
v_lshl_add_u32 v10, v7, 5, v6
v_xor_b32 v11, 32, v10
v_xor_b32 v12, 64, v10
v_xor_b32 v13, 96, v10
v_add_u32 v14, 0x10000, v10
v_add_u32 v15, 0x10000, v11
v_add_u32 v16, 0x10000, v12
v_add_u32 v17, 0x10000, v13
ds_read_b64_tr_b16 v[220:221], v10 offset:0
ds_read_b64_tr_b16 v[222:223], v10 offset:512
ds_read_b64_tr_b16 v[224:225], v11 offset:0
ds_read_b64_tr_b16 v[226:227], v11 offset:512
ds_read_b64_tr_b16 v[228:229], v12 offset:0
ds_read_b64_tr_b16 v[230:231], v12 offset:512
ds_read_b64_tr_b16 v[232:233], v13 offset:0
ds_read_b64_tr_b16 v[234:235], v13 offset:512
ds_read_b64_tr_b16 v[236:237], v10 offset:4096
ds_read_b64_tr_b16 v[238:239], v10 offset:4608
ds_read_b64_tr_b16 v[240:241], v11 offset:4096
ds_read_b64_tr_b16 v[242:243], v11 offset:4608
ds_read_b64_tr_b16 v[244:245], v12 offset:4096
ds_read_b64_tr_b16 v[246:247], v12 offset:4608
ds_read_b64_tr_b16 v[248:249], v13 offset:4096
ds_read_b64_tr_b16 v[250:251], v13 offset:4608
s_lshl_b32 s48, s41, 3
s_lshl_b32 s49, s40, 1
s_add_u32 s48, s48, s49
s_lshl_b32 s48, s48, 15
s_add_u32 s48, s48, 4194304
v_add_u32 v38, s48, v18
v_add_u32 v39, 32768, v38
s_lshl_b32 s57, s75, 11
s_add_u32 s87, s87, 262144
v_lshlrev_b32 v60, 16, v20
v_and_b32 v61, 0xffff0000, v20
v_lshlrev_b32 v62, 16, v21
v_and_b32 v63, 0xffff0000, v21
v_lshlrev_b32 v64, 16, v22
v_and_b32 v65, 0xffff0000, v22
v_lshlrev_b32 v66, 16, v23
v_and_b32 v67, 0xffff0000, v23
v_lshlrev_b32 v68, 16, v24
v_and_b32 v69, 0xffff0000, v24
v_lshlrev_b32 v70, 16, v25
v_and_b32 v71, 0xffff0000, v25
v_lshlrev_b32 v72, 16, v26
v_and_b32 v73, 0xffff0000, v26
v_lshlrev_b32 v74, 16, v27
v_and_b32 v75, 0xffff0000, v27
v_lshlrev_b32 v76, 16, v28
v_and_b32 v77, 0xffff0000, v28
v_lshlrev_b32 v78, 16, v29
v_and_b32 v79, 0xffff0000, v29
v_lshlrev_b32 v80, 16, v30
v_and_b32 v81, 0xffff0000, v30
v_lshlrev_b32 v82, 16, v31
v_and_b32 v83, 0xffff0000, v31
v_lshlrev_b32 v84, 16, v32
v_and_b32 v85, 0xffff0000, v32
v_lshlrev_b32 v86, 16, v33
v_and_b32 v87, 0xffff0000, v33
v_lshlrev_b32 v88, 16, v34
v_and_b32 v89, 0xffff0000, v34
v_lshlrev_b32 v90, 16, v35
v_and_b32 v91, 0xffff0000, v35
v_mov_b32 v6, 0
v_mov_b32 v7, 0
v_mov_b32 v8, 0
v_mov_b32 v9, 0
s_lshl_b32 s62, s42, 2
v_mov_b32 v4, s62
v_mov_b32 v5, 1
buffer_load_dword v37, v36, s[32:35], s84 offen sc1
s_mov_b32 s63, 0
s_waitcnt vmcnt(0)
poll_77:
v_cmp_gt_u32 vcc, 1, v37
s_cbranch_vccz polled_78
buffer_load_dword v37, v36, s[32:35], s84 offen sc1
s_add_u32 s63, s63, 1
s_cmp_lt_u32 s63, 0x80000
s_waitcnt vmcnt(0)
s_cbranch_scc1 poll_77
polled_78:
buffer_load_dwordx4 v[156:159], v38, s[32:35], s57 offen sc1
buffer_load_dwordx4 v[160:163], v39, s[32:35], s57 offen sc1
buffer_load_dwordx4 v[164:167], v38, s[32:35], s57 offen offset:1024 sc1
buffer_load_dwordx4 v[168:171], v39, s[32:35], s57 offen offset:1024 sc1
s_add_u32 s57, s57, 2048
s_and_b32 s57, s57, 0x7fff
buffer_load_dwordx4 v[172:175], v38, s[32:35], s57 offen sc1
buffer_load_dwordx4 v[176:179], v39, s[32:35], s57 offen sc1
buffer_load_dwordx4 v[180:183], v38, s[32:35], s57 offen offset:1024 sc1
buffer_load_dwordx4 v[184:187], v39, s[32:35], s57 offen offset:1024 sc1
s_add_u32 s57, s57, 2048
s_and_b32 s57, s57, 0x7fff
s_waitcnt vmcnt(6) lgkmcnt(8)
v_mfma_f32_16x16x32_bf16 v[60:63], v[220:223], v[156:159], v[60:63]
buffer_load_dwordx4 v[188:191], v38, s[32:35], s57 offen sc1
v_mfma_f32_16x16x32_bf16 v[76:79], v[220:223], v[160:163], v[76:79]
ds_read_b64_tr_b16 v[100:101], v10 offset:8192
ds_read_b64_tr_b16 v[102:103], v10 offset:8704
v_mfma_f32_16x16x32_bf16 v[80:83], v[224:227], v[160:163], v[80:83]
ds_read_b64_tr_b16 v[104:105], v11 offset:8192
ds_read_b64_tr_b16 v[106:107], v11 offset:8704
v_mfma_f32_16x16x32_bf16 v[64:67], v[224:227], v[156:159], v[64:67]
buffer_load_dwordx4 v[192:195], v39, s[32:35], s57 offen sc1
v_mfma_f32_16x16x32_bf16 v[68:71], v[228:231], v[156:159], v[68:71]
ds_read_b64_tr_b16 v[108:109], v12 offset:8192
ds_read_b64_tr_b16 v[110:111], v12 offset:8704
v_mfma_f32_16x16x32_bf16 v[84:87], v[228:231], v[160:163], v[84:87]
ds_read_b64_tr_b16 v[112:113], v13 offset:8192
ds_read_b64_tr_b16 v[114:115], v13 offset:8704
v_mfma_f32_16x16x32_bf16 v[88:91], v[232:235], v[160:163], v[88:91]
v_mfma_f32_16x16x32_bf16 v[72:75], v[232:235], v[156:159], v[72:75]
s_waitcnt vmcnt(6) lgkmcnt(8)
v_mfma_f32_16x16x32_bf16 v[60:63], v[236:239], v[164:167], v[60:63]
buffer_load_dwordx4 v[196:199], v38, s[32:35], s57 offen offset:1024 sc1
v_mfma_f32_16x16x32_bf16 v[76:79], v[236:239], v[168:171], v[76:79]
ds_read_b64_tr_b16 v[220:221], v10 offset:12288
ds_read_b64_tr_b16 v[222:223], v10 offset:12800
v_mfma_f32_16x16x32_bf16 v[80:83], v[240:243], v[168:171], v[80:83]
ds_read_b64_tr_b16 v[224:225], v11 offset:12288
ds_read_b64_tr_b16 v[226:227], v11 offset:12800
v_mfma_f32_16x16x32_bf16 v[64:67], v[240:243], v[164:167], v[64:67]
buffer_load_dwordx4 v[200:203], v39, s[32:35], s57 offen offset:1024 sc1
v_mfma_f32_16x16x32_bf16 v[68:71], v[244:247], v[164:167], v[68:71]
ds_read_b64_tr_b16 v[228:229], v12 offset:12288
ds_read_b64_tr_b16 v[230:231], v12 offset:12800
v_mfma_f32_16x16x32_bf16 v[84:87], v[244:247], v[168:171], v[84:87]
ds_read_b64_tr_b16 v[232:233], v13 offset:12288
ds_read_b64_tr_b16 v[234:235], v13 offset:12800
v_mfma_f32_16x16x32_bf16 v[88:91], v[248:251], v[168:171], v[88:91]
s_add_u32 s57, s57, 2048
s_and_b32 s57, s57, 0x7fff
v_mfma_f32_16x16x32_bf16 v[72:75], v[248:251], v[164:167], v[72:75]
s_waitcnt vmcnt(6) lgkmcnt(8)
v_mfma_f32_16x16x32_bf16 v[60:63], v[100:103], v[172:175], v[60:63]
buffer_load_dwordx4 v[204:207], v38, s[32:35], s57 offen sc1
v_mfma_f32_16x16x32_bf16 v[76:79], v[100:103], v[176:179], v[76:79]
ds_read_b64_tr_b16 v[236:237], v10 offset:16384
ds_read_b64_tr_b16 v[238:239], v10 offset:16896
v_mfma_f32_16x16x32_bf16 v[80:83], v[104:107], v[176:179], v[80:83]
ds_read_b64_tr_b16 v[240:241], v11 offset:16384
ds_read_b64_tr_b16 v[242:243], v11 offset:16896
v_mfma_f32_16x16x32_bf16 v[64:67], v[104:107], v[172:175], v[64:67]
buffer_load_dwordx4 v[208:211], v39, s[32:35], s57 offen sc1
v_mfma_f32_16x16x32_bf16 v[68:71], v[108:111], v[172:175], v[68:71]
ds_read_b64_tr_b16 v[244:245], v12 offset:16384
ds_read_b64_tr_b16 v[246:247], v12 offset:16896
v_mfma_f32_16x16x32_bf16 v[84:87], v[108:111], v[176:179], v[84:87]
ds_read_b64_tr_b16 v[248:249], v13 offset:16384
ds_read_b64_tr_b16 v[250:251], v13 offset:16896
v_mfma_f32_16x16x32_bf16 v[88:91], v[112:115], v[176:179], v[88:91]
v_mfma_f32_16x16x32_bf16 v[72:75], v[112:115], v[172:175], v[72:75]
s_waitcnt vmcnt(6) lgkmcnt(8)
v_mfma_f32_16x16x32_bf16 v[60:63], v[220:223], v[180:183], v[60:63]
buffer_load_dwordx4 v[212:215], v38, s[32:35], s57 offen offset:1024 sc1
v_mfma_f32_16x16x32_bf16 v[76:79], v[220:223], v[184:187], v[76:79]
ds_read_b64_tr_b16 v[100:101], v10 offset:20480
ds_read_b64_tr_b16 v[102:103], v10 offset:20992
v_mfma_f32_16x16x32_bf16 v[80:83], v[224:227], v[184:187], v[80:83]
ds_read_b64_tr_b16 v[104:105], v11 offset:20480
ds_read_b64_tr_b16 v[106:107], v11 offset:20992
v_mfma_f32_16x16x32_bf16 v[64:67], v[224:227], v[180:183], v[64:67]
buffer_load_dwordx4 v[216:219], v39, s[32:35], s57 offen offset:1024 sc1
v_mfma_f32_16x16x32_bf16 v[68:71], v[228:231], v[180:183], v[68:71]
ds_read_b64_tr_b16 v[108:109], v12 offset:20480
ds_read_b64_tr_b16 v[110:111], v12 offset:20992
v_mfma_f32_16x16x32_bf16 v[84:87], v[228:231], v[184:187], v[84:87]
ds_read_b64_tr_b16 v[112:113], v13 offset:20480
ds_read_b64_tr_b16 v[114:115], v13 offset:20992
v_mfma_f32_16x16x32_bf16 v[88:91], v[232:235], v[184:187], v[88:91]
s_add_u32 s57, s57, 2048
s_and_b32 s57, s57, 0x7fff
v_mfma_f32_16x16x32_bf16 v[72:75], v[232:235], v[180:183], v[72:75]
s_waitcnt vmcnt(6) lgkmcnt(8)
v_mfma_f32_16x16x32_bf16 v[60:63], v[236:239], v[188:191], v[60:63]
buffer_load_dwordx4 v[156:159], v38, s[32:35], s57 offen sc1
v_mfma_f32_16x16x32_bf16 v[76:79], v[236:239], v[192:195], v[76:79]
ds_read_b64_tr_b16 v[220:221], v10 offset:24576
ds_read_b64_tr_b16 v[222:223], v10 offset:25088
v_mfma_f32_16x16x32_bf16 v[80:83], v[240:243], v[192:195], v[80:83]
ds_read_b64_tr_b16 v[224:225], v11 offset:24576
ds_read_b64_tr_b16 v[226:227], v11 offset:25088
v_mfma_f32_16x16x32_bf16 v[64:67], v[240:243], v[188:191], v[64:67]
buffer_load_dwordx4 v[160:163], v39, s[32:35], s57 offen sc1
v_mfma_f32_16x16x32_bf16 v[68:71], v[244:247], v[188:191], v[68:71]
ds_read_b64_tr_b16 v[228:229], v12 offset:24576
ds_read_b64_tr_b16 v[230:231], v12 offset:25088
v_mfma_f32_16x16x32_bf16 v[84:87], v[244:247], v[192:195], v[84:87]
ds_read_b64_tr_b16 v[232:233], v13 offset:24576
ds_read_b64_tr_b16 v[234:235], v13 offset:25088
v_mfma_f32_16x16x32_bf16 v[88:91], v[248:251], v[192:195], v[88:91]
v_mfma_f32_16x16x32_bf16 v[72:75], v[248:251], v[188:191], v[72:75]
s_waitcnt vmcnt(6) lgkmcnt(8)
v_mfma_f32_16x16x32_bf16 v[60:63], v[100:103], v[196:199], v[60:63]
buffer_load_dwordx4 v[164:167], v38, s[32:35], s57 offen offset:1024 sc1
v_mfma_f32_16x16x32_bf16 v[76:79], v[100:103], v[200:203], v[76:79]
ds_read_b64_tr_b16 v[236:237], v10 offset:28672
ds_read_b64_tr_b16 v[238:239], v10 offset:29184
v_mfma_f32_16x16x32_bf16 v[80:83], v[104:107], v[200:203], v[80:83]
ds_read_b64_tr_b16 v[240:241], v11 offset:28672
ds_read_b64_tr_b16 v[242:243], v11 offset:29184
v_mfma_f32_16x16x32_bf16 v[64:67], v[104:107], v[196:199], v[64:67]
buffer_load_dwordx4 v[168:171], v39, s[32:35], s57 offen offset:1024 sc1
v_mfma_f32_16x16x32_bf16 v[68:71], v[108:111], v[196:199], v[68:71]
ds_read_b64_tr_b16 v[244:245], v12 offset:28672
ds_read_b64_tr_b16 v[246:247], v12 offset:29184
v_mfma_f32_16x16x32_bf16 v[84:87], v[108:111], v[200:203], v[84:87]
ds_read_b64_tr_b16 v[248:249], v13 offset:28672
ds_read_b64_tr_b16 v[250:251], v13 offset:29184
v_mfma_f32_16x16x32_bf16 v[88:91], v[112:115], v[200:203], v[88:91]
s_add_u32 s57, s57, 2048
s_and_b32 s57, s57, 0x7fff
v_mfma_f32_16x16x32_bf16 v[72:75], v[112:115], v[196:199], v[72:75]
s_waitcnt vmcnt(6) lgkmcnt(8)
v_mfma_f32_16x16x32_bf16 v[60:63], v[220:223], v[204:207], v[60:63]
buffer_load_dwordx4 v[172:175], v38, s[32:35], s57 offen sc1
v_mfma_f32_16x16x32_bf16 v[76:79], v[220:223], v[208:211], v[76:79]
ds_read_b64_tr_b16 v[100:101], v10 offset:32768
ds_read_b64_tr_b16 v[102:103], v10 offset:33280
v_mfma_f32_16x16x32_bf16 v[80:83], v[224:227], v[208:211], v[80:83]
ds_read_b64_tr_b16 v[104:105], v11 offset:32768
ds_read_b64_tr_b16 v[106:107], v11 offset:33280
v_mfma_f32_16x16x32_bf16 v[64:67], v[224:227], v[204:207], v[64:67]
buffer_load_dwordx4 v[176:179], v39, s[32:35], s57 offen sc1
v_mfma_f32_16x16x32_bf16 v[68:71], v[228:231], v[204:207], v[68:71]
ds_read_b64_tr_b16 v[108:109], v12 offset:32768
ds_read_b64_tr_b16 v[110:111], v12 offset:33280
v_mfma_f32_16x16x32_bf16 v[84:87], v[228:231], v[208:211], v[84:87]
ds_read_b64_tr_b16 v[112:113], v13 offset:32768
ds_read_b64_tr_b16 v[114:115], v13 offset:33280
v_mfma_f32_16x16x32_bf16 v[88:91], v[232:235], v[208:211], v[88:91]
v_mfma_f32_16x16x32_bf16 v[72:75], v[232:235], v[204:207], v[72:75]
s_waitcnt vmcnt(6) lgkmcnt(8)
v_mfma_f32_16x16x32_bf16 v[60:63], v[236:239], v[212:215], v[60:63]
buffer_load_dwordx4 v[180:183], v38, s[32:35], s57 offen offset:1024 sc1
v_mfma_f32_16x16x32_bf16 v[76:79], v[236:239], v[216:219], v[76:79]
ds_read_b64_tr_b16 v[220:221], v10 offset:36864
ds_read_b64_tr_b16 v[222:223], v10 offset:37376
v_mfma_f32_16x16x32_bf16 v[80:83], v[240:243], v[216:219], v[80:83]
ds_read_b64_tr_b16 v[224:225], v11 offset:36864
ds_read_b64_tr_b16 v[226:227], v11 offset:37376
v_mfma_f32_16x16x32_bf16 v[64:67], v[240:243], v[212:215], v[64:67]
buffer_load_dwordx4 v[184:187], v39, s[32:35], s57 offen offset:1024 sc1
v_mfma_f32_16x16x32_bf16 v[68:71], v[244:247], v[212:215], v[68:71]
ds_read_b64_tr_b16 v[228:229], v12 offset:36864
ds_read_b64_tr_b16 v[230:231], v12 offset:37376
v_mfma_f32_16x16x32_bf16 v[84:87], v[244:247], v[216:219], v[84:87]
ds_read_b64_tr_b16 v[232:233], v13 offset:36864
ds_read_b64_tr_b16 v[234:235], v13 offset:37376
v_mfma_f32_16x16x32_bf16 v[88:91], v[248:251], v[216:219], v[88:91]
s_add_u32 s57, s57, 2048
s_and_b32 s57, s57, 0x7fff
v_mfma_f32_16x16x32_bf16 v[72:75], v[248:251], v[212:215], v[72:75]
s_waitcnt vmcnt(6) lgkmcnt(8)
v_mfma_f32_16x16x32_bf16 v[60:63], v[100:103], v[156:159], v[60:63]
buffer_load_dwordx4 v[188:191], v38, s[32:35], s57 offen sc1
v_mfma_f32_16x16x32_bf16 v[76:79], v[100:103], v[160:163], v[76:79]
ds_read_b64_tr_b16 v[236:237], v10 offset:40960
ds_read_b64_tr_b16 v[238:239], v10 offset:41472
v_mfma_f32_16x16x32_bf16 v[80:83], v[104:107], v[160:163], v[80:83]
ds_read_b64_tr_b16 v[240:241], v11 offset:40960
ds_read_b64_tr_b16 v[242:243], v11 offset:41472
v_mfma_f32_16x16x32_bf16 v[64:67], v[104:107], v[156:159], v[64:67]
buffer_load_dwordx4 v[192:195], v39, s[32:35], s57 offen sc1
v_mfma_f32_16x16x32_bf16 v[68:71], v[108:111], v[156:159], v[68:71]
ds_read_b64_tr_b16 v[244:245], v12 offset:40960
ds_read_b64_tr_b16 v[246:247], v12 offset:41472
v_mfma_f32_16x16x32_bf16 v[84:87], v[108:111], v[160:163], v[84:87]
ds_read_b64_tr_b16 v[248:249], v13 offset:40960
ds_read_b64_tr_b16 v[250:251], v13 offset:41472
v_mfma_f32_16x16x32_bf16 v[88:91], v[112:115], v[160:163], v[88:91]
v_mfma_f32_16x16x32_bf16 v[72:75], v[112:115], v[156:159], v[72:75]
s_waitcnt vmcnt(6) lgkmcnt(8)
v_mfma_f32_16x16x32_bf16 v[60:63], v[220:223], v[164:167], v[60:63]
buffer_load_dwordx4 v[196:199], v38, s[32:35], s57 offen offset:1024 sc1
v_mfma_f32_16x16x32_bf16 v[76:79], v[220:223], v[168:171], v[76:79]
ds_read_b64_tr_b16 v[100:101], v10 offset:45056
ds_read_b64_tr_b16 v[102:103], v10 offset:45568
v_mfma_f32_16x16x32_bf16 v[80:83], v[224:227], v[168:171], v[80:83]
ds_read_b64_tr_b16 v[104:105], v11 offset:45056
ds_read_b64_tr_b16 v[106:107], v11 offset:45568
v_mfma_f32_16x16x32_bf16 v[64:67], v[224:227], v[164:167], v[64:67]
buffer_load_dwordx4 v[200:203], v39, s[32:35], s57 offen offset:1024 sc1
v_mfma_f32_16x16x32_bf16 v[68:71], v[228:231], v[164:167], v[68:71]
ds_read_b64_tr_b16 v[108:109], v12 offset:45056
ds_read_b64_tr_b16 v[110:111], v12 offset:45568
v_mfma_f32_16x16x32_bf16 v[84:87], v[228:231], v[168:171], v[84:87]
ds_read_b64_tr_b16 v[112:113], v13 offset:45056
ds_read_b64_tr_b16 v[114:115], v13 offset:45568
v_mfma_f32_16x16x32_bf16 v[88:91], v[232:235], v[168:171], v[88:91]
s_add_u32 s57, s57, 2048
s_and_b32 s57, s57, 0x7fff
v_mfma_f32_16x16x32_bf16 v[72:75], v[232:235], v[164:167], v[72:75]
s_waitcnt vmcnt(6) lgkmcnt(8)
v_mfma_f32_16x16x32_bf16 v[60:63], v[236:239], v[172:175], v[60:63]
buffer_load_dwordx4 v[204:207], v38, s[32:35], s57 offen sc1
v_mfma_f32_16x16x32_bf16 v[76:79], v[236:239], v[176:179], v[76:79]
ds_read_b64_tr_b16 v[220:221], v10 offset:49152
ds_read_b64_tr_b16 v[222:223], v10 offset:49664
v_mfma_f32_16x16x32_bf16 v[80:83], v[240:243], v[176:179], v[80:83]
ds_read_b64_tr_b16 v[224:225], v11 offset:49152
ds_read_b64_tr_b16 v[226:227], v11 offset:49664
v_mfma_f32_16x16x32_bf16 v[64:67], v[240:243], v[172:175], v[64:67]
buffer_load_dwordx4 v[208:211], v39, s[32:35], s57 offen sc1
v_mfma_f32_16x16x32_bf16 v[68:71], v[244:247], v[172:175], v[68:71]
ds_read_b64_tr_b16 v[228:229], v12 offset:49152
ds_read_b64_tr_b16 v[230:231], v12 offset:49664
v_mfma_f32_16x16x32_bf16 v[84:87], v[244:247], v[176:179], v[84:87]
ds_read_b64_tr_b16 v[232:233], v13 offset:49152
ds_read_b64_tr_b16 v[234:235], v13 offset:49664
v_mfma_f32_16x16x32_bf16 v[88:91], v[248:251], v[176:179], v[88:91]
v_mfma_f32_16x16x32_bf16 v[72:75], v[248:251], v[172:175], v[72:75]
s_waitcnt vmcnt(6) lgkmcnt(8)
v_mfma_f32_16x16x32_bf16 v[60:63], v[100:103], v[180:183], v[60:63]
buffer_load_dwordx4 v[212:215], v38, s[32:35], s57 offen offset:1024 sc1
v_mfma_f32_16x16x32_bf16 v[76:79], v[100:103], v[184:187], v[76:79]
ds_read_b64_tr_b16 v[236:237], v10 offset:53248
ds_read_b64_tr_b16 v[238:239], v10 offset:53760
v_mfma_f32_16x16x32_bf16 v[80:83], v[104:107], v[184:187], v[80:83]
ds_read_b64_tr_b16 v[240:241], v11 offset:53248
ds_read_b64_tr_b16 v[242:243], v11 offset:53760
v_mfma_f32_16x16x32_bf16 v[64:67], v[104:107], v[180:183], v[64:67]
buffer_load_dwordx4 v[216:219], v39, s[32:35], s57 offen offset:1024 sc1
v_mfma_f32_16x16x32_bf16 v[68:71], v[108:111], v[180:183], v[68:71]
ds_read_b64_tr_b16 v[244:245], v12 offset:53248
ds_read_b64_tr_b16 v[246:247], v12 offset:53760
v_mfma_f32_16x16x32_bf16 v[84:87], v[108:111], v[184:187], v[84:87]
ds_read_b64_tr_b16 v[248:249], v13 offset:53248
ds_read_b64_tr_b16 v[250:251], v13 offset:53760
v_mfma_f32_16x16x32_bf16 v[88:91], v[112:115], v[184:187], v[88:91]
s_add_u32 s57, s57, 2048
s_and_b32 s57, s57, 0x7fff
v_mfma_f32_16x16x32_bf16 v[72:75], v[112:115], v[180:183], v[72:75]
s_waitcnt vmcnt(6) lgkmcnt(8)
v_mfma_f32_16x16x32_bf16 v[60:63], v[220:223], v[188:191], v[60:63]
buffer_load_dwordx4 v[156:159], v38, s[32:35], s57 offen sc1
v_mfma_f32_16x16x32_bf16 v[76:79], v[220:223], v[192:195], v[76:79]
ds_read_b64_tr_b16 v[100:101], v10 offset:57344
ds_read_b64_tr_b16 v[102:103], v10 offset:57856
v_mfma_f32_16x16x32_bf16 v[80:83], v[224:227], v[192:195], v[80:83]
ds_read_b64_tr_b16 v[104:105], v11 offset:57344
ds_read_b64_tr_b16 v[106:107], v11 offset:57856
v_mfma_f32_16x16x32_bf16 v[64:67], v[224:227], v[188:191], v[64:67]
buffer_load_dwordx4 v[160:163], v39, s[32:35], s57 offen sc1
v_mfma_f32_16x16x32_bf16 v[68:71], v[228:231], v[188:191], v[68:71]
ds_read_b64_tr_b16 v[108:109], v12 offset:57344
ds_read_b64_tr_b16 v[110:111], v12 offset:57856
v_mfma_f32_16x16x32_bf16 v[84:87], v[228:231], v[192:195], v[84:87]
ds_read_b64_tr_b16 v[112:113], v13 offset:57344
ds_read_b64_tr_b16 v[114:115], v13 offset:57856
v_mfma_f32_16x16x32_bf16 v[88:91], v[232:235], v[192:195], v[88:91]
v_mfma_f32_16x16x32_bf16 v[72:75], v[232:235], v[188:191], v[72:75]
s_waitcnt vmcnt(6) lgkmcnt(8)
v_mfma_f32_16x16x32_bf16 v[60:63], v[236:239], v[196:199], v[60:63]
buffer_load_dwordx4 v[164:167], v38, s[32:35], s57 offen offset:1024 sc1
v_mfma_f32_16x16x32_bf16 v[76:79], v[236:239], v[200:203], v[76:79]
ds_read_b64_tr_b16 v[220:221], v10 offset:61440
ds_read_b64_tr_b16 v[222:223], v10 offset:61952
v_mfma_f32_16x16x32_bf16 v[80:83], v[240:243], v[200:203], v[80:83]
ds_read_b64_tr_b16 v[224:225], v11 offset:61440
ds_read_b64_tr_b16 v[226:227], v11 offset:61952
v_mfma_f32_16x16x32_bf16 v[64:67], v[240:243], v[196:199], v[64:67]
buffer_load_dwordx4 v[168:171], v39, s[32:35], s57 offen offset:1024 sc1
v_mfma_f32_16x16x32_bf16 v[68:71], v[244:247], v[196:199], v[68:71]
ds_read_b64_tr_b16 v[228:229], v12 offset:61440
ds_read_b64_tr_b16 v[230:231], v12 offset:61952
v_mfma_f32_16x16x32_bf16 v[84:87], v[244:247], v[200:203], v[84:87]
ds_read_b64_tr_b16 v[232:233], v13 offset:61440
ds_read_b64_tr_b16 v[234:235], v13 offset:61952
v_mfma_f32_16x16x32_bf16 v[88:91], v[248:251], v[200:203], v[88:91]
s_add_u32 s57, s57, 2048
s_and_b32 s57, s57, 0x7fff
v_mfma_f32_16x16x32_bf16 v[72:75], v[248:251], v[196:199], v[72:75]
s_waitcnt vmcnt(6) lgkmcnt(8)
v_mfma_f32_16x16x32_bf16 v[60:63], v[100:103], v[204:207], v[60:63]
buffer_load_dwordx4 v[172:175], v38, s[32:35], s57 offen sc1
v_mfma_f32_16x16x32_bf16 v[76:79], v[100:103], v[208:211], v[76:79]
ds_read_b64_tr_b16 v[236:237], v14 offset:0
ds_read_b64_tr_b16 v[238:239], v14 offset:512
v_mfma_f32_16x16x32_bf16 v[80:83], v[104:107], v[208:211], v[80:83]
ds_read_b64_tr_b16 v[240:241], v15 offset:0
ds_read_b64_tr_b16 v[242:243], v15 offset:512
v_mfma_f32_16x16x32_bf16 v[64:67], v[104:107], v[204:207], v[64:67]
buffer_load_dwordx4 v[176:179], v39, s[32:35], s57 offen sc1
v_mfma_f32_16x16x32_bf16 v[68:71], v[108:111], v[204:207], v[68:71]
ds_read_b64_tr_b16 v[244:245], v16 offset:0
ds_read_b64_tr_b16 v[246:247], v16 offset:512
v_mfma_f32_16x16x32_bf16 v[84:87], v[108:111], v[208:211], v[84:87]
ds_read_b64_tr_b16 v[248:249], v17 offset:0
ds_read_b64_tr_b16 v[250:251], v17 offset:512
v_mfma_f32_16x16x32_bf16 v[88:91], v[112:115], v[208:211], v[88:91]
v_mfma_f32_16x16x32_bf16 v[72:75], v[112:115], v[204:207], v[72:75]
s_waitcnt vmcnt(6) lgkmcnt(8)
v_mfma_f32_16x16x32_bf16 v[60:63], v[220:223], v[212:215], v[60:63]
buffer_load_dwordx4 v[180:183], v38, s[32:35], s57 offen offset:1024 sc1
v_mfma_f32_16x16x32_bf16 v[76:79], v[220:223], v[216:219], v[76:79]
ds_read_b64_tr_b16 v[100:101], v14 offset:4096
ds_read_b64_tr_b16 v[102:103], v14 offset:4608
v_mfma_f32_16x16x32_bf16 v[80:83], v[224:227], v[216:219], v[80:83]
ds_read_b64_tr_b16 v[104:105], v15 offset:4096
ds_read_b64_tr_b16 v[106:107], v15 offset:4608
v_mfma_f32_16x16x32_bf16 v[64:67], v[224:227], v[212:215], v[64:67]
buffer_load_dwordx4 v[184:187], v39, s[32:35], s57 offen offset:1024 sc1
v_mfma_f32_16x16x32_bf16 v[68:71], v[228:231], v[212:215], v[68:71]
ds_read_b64_tr_b16 v[108:109], v16 offset:4096
ds_read_b64_tr_b16 v[110:111], v16 offset:4608
v_mfma_f32_16x16x32_bf16 v[84:87], v[228:231], v[216:219], v[84:87]
ds_read_b64_tr_b16 v[112:113], v17 offset:4096
ds_read_b64_tr_b16 v[114:115], v17 offset:4608
v_mfma_f32_16x16x32_bf16 v[88:91], v[232:235], v[216:219], v[88:91]
s_add_u32 s57, s57, 2048
s_and_b32 s57, s57, 0x7fff
v_mfma_f32_16x16x32_bf16 v[72:75], v[232:235], v[212:215], v[72:75]
s_waitcnt vmcnt(6) lgkmcnt(8)
v_mfma_f32_16x16x32_bf16 v[60:63], v[236:239], v[156:159], v[60:63]
buffer_load_dwordx4 v[188:191], v38, s[32:35], s57 offen sc1
v_mfma_f32_16x16x32_bf16 v[76:79], v[236:239], v[160:163], v[76:79]
ds_read_b64_tr_b16 v[220:221], v14 offset:8192
ds_read_b64_tr_b16 v[222:223], v14 offset:8704
v_mfma_f32_16x16x32_bf16 v[80:83], v[240:243], v[160:163], v[80:83]
ds_read_b64_tr_b16 v[224:225], v15 offset:8192
ds_read_b64_tr_b16 v[226:227], v15 offset:8704
v_mfma_f32_16x16x32_bf16 v[64:67], v[240:243], v[156:159], v[64:67]
buffer_load_dwordx4 v[192:195], v39, s[32:35], s57 offen sc1
v_mfma_f32_16x16x32_bf16 v[68:71], v[244:247], v[156:159], v[68:71]
ds_read_b64_tr_b16 v[228:229], v16 offset:8192
ds_read_b64_tr_b16 v[230:231], v16 offset:8704
v_mfma_f32_16x16x32_bf16 v[84:87], v[244:247], v[160:163], v[84:87]
ds_read_b64_tr_b16 v[232:233], v17 offset:8192
ds_read_b64_tr_b16 v[234:235], v17 offset:8704
v_mfma_f32_16x16x32_bf16 v[88:91], v[248:251], v[160:163], v[88:91]
v_mfma_f32_16x16x32_bf16 v[72:75], v[248:251], v[156:159], v[72:75]
s_waitcnt vmcnt(6) lgkmcnt(8)
v_mfma_f32_16x16x32_bf16 v[60:63], v[100:103], v[164:167], v[60:63]
buffer_load_dwordx4 v[196:199], v38, s[32:35], s57 offen offset:1024 sc1
v_mfma_f32_16x16x32_bf16 v[76:79], v[100:103], v[168:171], v[76:79]
ds_read_b64_tr_b16 v[236:237], v14 offset:12288
ds_read_b64_tr_b16 v[238:239], v14 offset:12800
v_mfma_f32_16x16x32_bf16 v[80:83], v[104:107], v[168:171], v[80:83]
ds_read_b64_tr_b16 v[240:241], v15 offset:12288
ds_read_b64_tr_b16 v[242:243], v15 offset:12800
v_mfma_f32_16x16x32_bf16 v[64:67], v[104:107], v[164:167], v[64:67]
buffer_load_dwordx4 v[200:203], v39, s[32:35], s57 offen offset:1024 sc1
v_mfma_f32_16x16x32_bf16 v[68:71], v[108:111], v[164:167], v[68:71]
ds_read_b64_tr_b16 v[244:245], v16 offset:12288
ds_read_b64_tr_b16 v[246:247], v16 offset:12800
v_mfma_f32_16x16x32_bf16 v[84:87], v[108:111], v[168:171], v[84:87]
ds_read_b64_tr_b16 v[248:249], v17 offset:12288
ds_read_b64_tr_b16 v[250:251], v17 offset:12800
v_mfma_f32_16x16x32_bf16 v[88:91], v[112:115], v[168:171], v[88:91]
s_add_u32 s57, s57, 2048
s_and_b32 s57, s57, 0x7fff
v_mfma_f32_16x16x32_bf16 v[72:75], v[112:115], v[164:167], v[72:75]
s_waitcnt vmcnt(6) lgkmcnt(8)
v_mfma_f32_16x16x32_bf16 v[60:63], v[220:223], v[172:175], v[60:63]
buffer_load_dwordx4 v[204:207], v38, s[32:35], s57 offen sc1
v_mfma_f32_16x16x32_bf16 v[76:79], v[220:223], v[176:179], v[76:79]
ds_read_b64_tr_b16 v[100:101], v14 offset:16384
ds_read_b64_tr_b16 v[102:103], v14 offset:16896
v_mfma_f32_16x16x32_bf16 v[80:83], v[224:227], v[176:179], v[80:83]
ds_read_b64_tr_b16 v[104:105], v15 offset:16384
ds_read_b64_tr_b16 v[106:107], v15 offset:16896
v_mfma_f32_16x16x32_bf16 v[64:67], v[224:227], v[172:175], v[64:67]
buffer_load_dwordx4 v[208:211], v39, s[32:35], s57 offen sc1
v_mfma_f32_16x16x32_bf16 v[68:71], v[228:231], v[172:175], v[68:71]
ds_read_b64_tr_b16 v[108:109], v16 offset:16384
ds_read_b64_tr_b16 v[110:111], v16 offset:16896
v_mfma_f32_16x16x32_bf16 v[84:87], v[228:231], v[176:179], v[84:87]
ds_read_b64_tr_b16 v[112:113], v17 offset:16384
ds_read_b64_tr_b16 v[114:115], v17 offset:16896
v_mfma_f32_16x16x32_bf16 v[88:91], v[232:235], v[176:179], v[88:91]
v_mfma_f32_16x16x32_bf16 v[72:75], v[232:235], v[172:175], v[72:75]
s_waitcnt vmcnt(6) lgkmcnt(8)
v_mfma_f32_16x16x32_bf16 v[60:63], v[236:239], v[180:183], v[60:63]
buffer_load_dwordx4 v[212:215], v38, s[32:35], s57 offen offset:1024 sc1
v_mfma_f32_16x16x32_bf16 v[76:79], v[236:239], v[184:187], v[76:79]
ds_read_b64_tr_b16 v[220:221], v14 offset:20480
ds_read_b64_tr_b16 v[222:223], v14 offset:20992
v_mfma_f32_16x16x32_bf16 v[80:83], v[240:243], v[184:187], v[80:83]
ds_read_b64_tr_b16 v[224:225], v15 offset:20480
ds_read_b64_tr_b16 v[226:227], v15 offset:20992
v_mfma_f32_16x16x32_bf16 v[64:67], v[240:243], v[180:183], v[64:67]
buffer_load_dwordx4 v[216:219], v39, s[32:35], s57 offen offset:1024 sc1
v_mfma_f32_16x16x32_bf16 v[68:71], v[244:247], v[180:183], v[68:71]
ds_read_b64_tr_b16 v[228:229], v16 offset:20480
ds_read_b64_tr_b16 v[230:231], v16 offset:20992
v_mfma_f32_16x16x32_bf16 v[84:87], v[244:247], v[184:187], v[84:87]
ds_read_b64_tr_b16 v[232:233], v17 offset:20480
ds_read_b64_tr_b16 v[234:235], v17 offset:20992
v_mfma_f32_16x16x32_bf16 v[88:91], v[248:251], v[184:187], v[88:91]
s_add_u32 s57, s57, 2048
s_and_b32 s57, s57, 0x7fff
v_mfma_f32_16x16x32_bf16 v[72:75], v[248:251], v[180:183], v[72:75]
s_waitcnt vmcnt(6) lgkmcnt(8)
v_mfma_f32_16x16x32_bf16 v[60:63], v[100:103], v[188:191], v[60:63]
buffer_load_dwordx4 v[156:159], v38, s[32:35], s57 offen sc1
v_mfma_f32_16x16x32_bf16 v[76:79], v[100:103], v[192:195], v[76:79]
ds_read_b64_tr_b16 v[236:237], v14 offset:24576
ds_read_b64_tr_b16 v[238:239], v14 offset:25088
v_mfma_f32_16x16x32_bf16 v[80:83], v[104:107], v[192:195], v[80:83]
ds_read_b64_tr_b16 v[240:241], v15 offset:24576
ds_read_b64_tr_b16 v[242:243], v15 offset:25088
v_mfma_f32_16x16x32_bf16 v[64:67], v[104:107], v[188:191], v[64:67]
buffer_load_dwordx4 v[160:163], v39, s[32:35], s57 offen sc1
v_mfma_f32_16x16x32_bf16 v[68:71], v[108:111], v[188:191], v[68:71]
ds_read_b64_tr_b16 v[244:245], v16 offset:24576
ds_read_b64_tr_b16 v[246:247], v16 offset:25088
v_mfma_f32_16x16x32_bf16 v[84:87], v[108:111], v[192:195], v[84:87]
ds_read_b64_tr_b16 v[248:249], v17 offset:24576
ds_read_b64_tr_b16 v[250:251], v17 offset:25088
v_mfma_f32_16x16x32_bf16 v[88:91], v[112:115], v[192:195], v[88:91]
v_mfma_f32_16x16x32_bf16 v[72:75], v[112:115], v[188:191], v[72:75]
s_waitcnt vmcnt(6) lgkmcnt(8)
v_mfma_f32_16x16x32_bf16 v[60:63], v[220:223], v[196:199], v[60:63]
buffer_load_dwordx4 v[164:167], v38, s[32:35], s57 offen offset:1024 sc1
v_mfma_f32_16x16x32_bf16 v[76:79], v[220:223], v[200:203], v[76:79]
ds_read_b64_tr_b16 v[100:101], v14 offset:28672
ds_read_b64_tr_b16 v[102:103], v14 offset:29184
v_mfma_f32_16x16x32_bf16 v[80:83], v[224:227], v[200:203], v[80:83]
ds_read_b64_tr_b16 v[104:105], v15 offset:28672
ds_read_b64_tr_b16 v[106:107], v15 offset:29184
v_mfma_f32_16x16x32_bf16 v[64:67], v[224:227], v[196:199], v[64:67]
buffer_load_dwordx4 v[168:171], v39, s[32:35], s57 offen offset:1024 sc1
v_mfma_f32_16x16x32_bf16 v[68:71], v[228:231], v[196:199], v[68:71]
ds_read_b64_tr_b16 v[108:109], v16 offset:28672
ds_read_b64_tr_b16 v[110:111], v16 offset:29184
v_mfma_f32_16x16x32_bf16 v[84:87], v[228:231], v[200:203], v[84:87]
ds_read_b64_tr_b16 v[112:113], v17 offset:28672
ds_read_b64_tr_b16 v[114:115], v17 offset:29184
v_mfma_f32_16x16x32_bf16 v[88:91], v[232:235], v[200:203], v[88:91]
s_add_u32 s57, s57, 2048
s_and_b32 s57, s57, 0x7fff
v_mfma_f32_16x16x32_bf16 v[72:75], v[232:235], v[196:199], v[72:75]
s_waitcnt vmcnt(6) lgkmcnt(8)
v_mfma_f32_16x16x32_bf16 v[60:63], v[236:239], v[204:207], v[60:63]
buffer_load_dwordx4 v[172:175], v38, s[32:35], s57 offen sc1
v_mfma_f32_16x16x32_bf16 v[76:79], v[236:239], v[208:211], v[76:79]
ds_read_b64_tr_b16 v[220:221], v14 offset:32768
ds_read_b64_tr_b16 v[222:223], v14 offset:33280
v_mfma_f32_16x16x32_bf16 v[80:83], v[240:243], v[208:211], v[80:83]
ds_read_b64_tr_b16 v[224:225], v15 offset:32768
ds_read_b64_tr_b16 v[226:227], v15 offset:33280
v_mfma_f32_16x16x32_bf16 v[64:67], v[240:243], v[204:207], v[64:67]
buffer_load_dwordx4 v[176:179], v39, s[32:35], s57 offen sc1
v_mfma_f32_16x16x32_bf16 v[68:71], v[244:247], v[204:207], v[68:71]
ds_read_b64_tr_b16 v[228:229], v16 offset:32768
ds_read_b64_tr_b16 v[230:231], v16 offset:33280
v_mfma_f32_16x16x32_bf16 v[84:87], v[244:247], v[208:211], v[84:87]
ds_read_b64_tr_b16 v[232:233], v17 offset:32768
ds_read_b64_tr_b16 v[234:235], v17 offset:33280
v_mfma_f32_16x16x32_bf16 v[88:91], v[248:251], v[208:211], v[88:91]
v_mfma_f32_16x16x32_bf16 v[72:75], v[248:251], v[204:207], v[72:75]
s_waitcnt vmcnt(6) lgkmcnt(8)
v_mfma_f32_16x16x32_bf16 v[60:63], v[100:103], v[212:215], v[60:63]
buffer_load_dwordx4 v[180:183], v38, s[32:35], s57 offen offset:1024 sc1
v_mfma_f32_16x16x32_bf16 v[76:79], v[100:103], v[216:219], v[76:79]
ds_read_b64_tr_b16 v[236:237], v14 offset:36864
ds_read_b64_tr_b16 v[238:239], v14 offset:37376
v_mfma_f32_16x16x32_bf16 v[80:83], v[104:107], v[216:219], v[80:83]
ds_read_b64_tr_b16 v[240:241], v15 offset:36864
ds_read_b64_tr_b16 v[242:243], v15 offset:37376
v_mfma_f32_16x16x32_bf16 v[64:67], v[104:107], v[212:215], v[64:67]
buffer_load_dwordx4 v[184:187], v39, s[32:35], s57 offen offset:1024 sc1
v_mfma_f32_16x16x32_bf16 v[68:71], v[108:111], v[212:215], v[68:71]
ds_read_b64_tr_b16 v[244:245], v16 offset:36864
ds_read_b64_tr_b16 v[246:247], v16 offset:37376
v_mfma_f32_16x16x32_bf16 v[84:87], v[108:111], v[216:219], v[84:87]
ds_read_b64_tr_b16 v[248:249], v17 offset:36864
ds_read_b64_tr_b16 v[250:251], v17 offset:37376
v_mfma_f32_16x16x32_bf16 v[88:91], v[112:115], v[216:219], v[88:91]
s_add_u32 s57, s57, 2048
s_and_b32 s57, s57, 0x7fff
v_mfma_f32_16x16x32_bf16 v[72:75], v[112:115], v[212:215], v[72:75]
s_waitcnt vmcnt(6) lgkmcnt(8)
v_mfma_f32_16x16x32_bf16 v[60:63], v[220:223], v[156:159], v[60:63]
buffer_load_dwordx4 v[188:191], v38, s[32:35], s57 offen sc1
v_mfma_f32_16x16x32_bf16 v[76:79], v[220:223], v[160:163], v[76:79]
ds_read_b64_tr_b16 v[100:101], v14 offset:40960
ds_read_b64_tr_b16 v[102:103], v14 offset:41472
v_mfma_f32_16x16x32_bf16 v[80:83], v[224:227], v[160:163], v[80:83]
ds_read_b64_tr_b16 v[104:105], v15 offset:40960
ds_read_b64_tr_b16 v[106:107], v15 offset:41472
v_mfma_f32_16x16x32_bf16 v[64:67], v[224:227], v[156:159], v[64:67]
buffer_load_dwordx4 v[192:195], v39, s[32:35], s57 offen sc1
v_mfma_f32_16x16x32_bf16 v[68:71], v[228:231], v[156:159], v[68:71]
ds_read_b64_tr_b16 v[108:109], v16 offset:40960
ds_read_b64_tr_b16 v[110:111], v16 offset:41472
v_mfma_f32_16x16x32_bf16 v[84:87], v[228:231], v[160:163], v[84:87]
ds_read_b64_tr_b16 v[112:113], v17 offset:40960
ds_read_b64_tr_b16 v[114:115], v17 offset:41472
v_mfma_f32_16x16x32_bf16 v[88:91], v[232:235], v[160:163], v[88:91]
v_mfma_f32_16x16x32_bf16 v[72:75], v[232:235], v[156:159], v[72:75]
s_waitcnt vmcnt(6) lgkmcnt(8)
v_mfma_f32_16x16x32_bf16 v[60:63], v[236:239], v[164:167], v[60:63]
buffer_load_dwordx4 v[196:199], v38, s[32:35], s57 offen offset:1024 sc1
v_mfma_f32_16x16x32_bf16 v[76:79], v[236:239], v[168:171], v[76:79]
ds_read_b64_tr_b16 v[220:221], v14 offset:45056
ds_read_b64_tr_b16 v[222:223], v14 offset:45568
v_mfma_f32_16x16x32_bf16 v[80:83], v[240:243], v[168:171], v[80:83]
ds_read_b64_tr_b16 v[224:225], v15 offset:45056
ds_read_b64_tr_b16 v[226:227], v15 offset:45568
v_mfma_f32_16x16x32_bf16 v[64:67], v[240:243], v[164:167], v[64:67]
buffer_load_dwordx4 v[200:203], v39, s[32:35], s57 offen offset:1024 sc1
v_mfma_f32_16x16x32_bf16 v[68:71], v[244:247], v[164:167], v[68:71]
ds_read_b64_tr_b16 v[228:229], v16 offset:45056
ds_read_b64_tr_b16 v[230:231], v16 offset:45568
v_mfma_f32_16x16x32_bf16 v[84:87], v[244:247], v[168:171], v[84:87]
ds_read_b64_tr_b16 v[232:233], v17 offset:45056
ds_read_b64_tr_b16 v[234:235], v17 offset:45568
v_mfma_f32_16x16x32_bf16 v[88:91], v[248:251], v[168:171], v[88:91]
s_add_u32 s57, s57, 2048
s_and_b32 s57, s57, 0x7fff
v_mfma_f32_16x16x32_bf16 v[72:75], v[248:251], v[164:167], v[72:75]
s_waitcnt vmcnt(6) lgkmcnt(8)
v_mfma_f32_16x16x32_bf16 v[60:63], v[100:103], v[172:175], v[60:63]
buffer_load_dwordx4 v[204:207], v38, s[32:35], s57 offen sc1
v_mfma_f32_16x16x32_bf16 v[76:79], v[100:103], v[176:179], v[76:79]
ds_read_b64_tr_b16 v[236:237], v14 offset:49152
ds_read_b64_tr_b16 v[238:239], v14 offset:49664
v_mfma_f32_16x16x32_bf16 v[80:83], v[104:107], v[176:179], v[80:83]
ds_read_b64_tr_b16 v[240:241], v15 offset:49152
ds_read_b64_tr_b16 v[242:243], v15 offset:49664
v_mfma_f32_16x16x32_bf16 v[64:67], v[104:107], v[172:175], v[64:67]
buffer_load_dwordx4 v[208:211], v39, s[32:35], s57 offen sc1
v_mfma_f32_16x16x32_bf16 v[68:71], v[108:111], v[172:175], v[68:71]
ds_read_b64_tr_b16 v[244:245], v16 offset:49152
ds_read_b64_tr_b16 v[246:247], v16 offset:49664
v_mfma_f32_16x16x32_bf16 v[84:87], v[108:111], v[176:179], v[84:87]
ds_read_b64_tr_b16 v[248:249], v17 offset:49152
ds_read_b64_tr_b16 v[250:251], v17 offset:49664
v_mfma_f32_16x16x32_bf16 v[88:91], v[112:115], v[176:179], v[88:91]
v_mfma_f32_16x16x32_bf16 v[72:75], v[112:115], v[172:175], v[72:75]
s_waitcnt vmcnt(6) lgkmcnt(8)
v_mfma_f32_16x16x32_bf16 v[60:63], v[220:223], v[180:183], v[60:63]
buffer_load_dwordx4 v[212:215], v38, s[32:35], s57 offen offset:1024 sc1
v_mfma_f32_16x16x32_bf16 v[76:79], v[220:223], v[184:187], v[76:79]
ds_read_b64_tr_b16 v[100:101], v14 offset:53248
ds_read_b64_tr_b16 v[102:103], v14 offset:53760
v_mfma_f32_16x16x32_bf16 v[80:83], v[224:227], v[184:187], v[80:83]
ds_read_b64_tr_b16 v[104:105], v15 offset:53248
ds_read_b64_tr_b16 v[106:107], v15 offset:53760
v_mfma_f32_16x16x32_bf16 v[64:67], v[224:227], v[180:183], v[64:67]
buffer_load_dwordx4 v[216:219], v39, s[32:35], s57 offen offset:1024 sc1
v_mfma_f32_16x16x32_bf16 v[68:71], v[228:231], v[180:183], v[68:71]
ds_read_b64_tr_b16 v[108:109], v16 offset:53248
ds_read_b64_tr_b16 v[110:111], v16 offset:53760
v_mfma_f32_16x16x32_bf16 v[84:87], v[228:231], v[184:187], v[84:87]
ds_read_b64_tr_b16 v[112:113], v17 offset:53248
ds_read_b64_tr_b16 v[114:115], v17 offset:53760
v_mfma_f32_16x16x32_bf16 v[88:91], v[232:235], v[184:187], v[88:91]
v_mfma_f32_16x16x32_bf16 v[72:75], v[232:235], v[180:183], v[72:75]
s_waitcnt vmcnt(6) lgkmcnt(8)
v_mfma_f32_16x16x32_bf16 v[60:63], v[236:239], v[188:191], v[60:63]
v_mfma_f32_16x16x32_bf16 v[76:79], v[236:239], v[192:195], v[76:79]
ds_read_b64_tr_b16 v[220:221], v14 offset:57344
ds_read_b64_tr_b16 v[222:223], v14 offset:57856
v_mfma_f32_16x16x32_bf16 v[80:83], v[240:243], v[192:195], v[80:83]
ds_read_b64_tr_b16 v[224:225], v15 offset:57344
ds_read_b64_tr_b16 v[226:227], v15 offset:57856
v_mfma_f32_16x16x32_bf16 v[64:67], v[240:243], v[188:191], v[64:67]
v_mfma_f32_16x16x32_bf16 v[68:71], v[244:247], v[188:191], v[68:71]
ds_read_b64_tr_b16 v[228:229], v16 offset:57344
ds_read_b64_tr_b16 v[230:231], v16 offset:57856
v_mfma_f32_16x16x32_bf16 v[84:87], v[244:247], v[192:195], v[84:87]
ds_read_b64_tr_b16 v[232:233], v17 offset:57344
ds_read_b64_tr_b16 v[234:235], v17 offset:57856
v_mfma_f32_16x16x32_bf16 v[88:91], v[248:251], v[192:195], v[88:91]
v_mfma_f32_16x16x32_bf16 v[72:75], v[248:251], v[188:191], v[72:75]
s_waitcnt vmcnt(4) lgkmcnt(8)
v_mfma_f32_16x16x32_bf16 v[60:63], v[100:103], v[196:199], v[60:63]
v_mfma_f32_16x16x32_bf16 v[76:79], v[100:103], v[200:203], v[76:79]
ds_read_b64_tr_b16 v[236:237], v14 offset:61440
ds_read_b64_tr_b16 v[238:239], v14 offset:61952
v_mfma_f32_16x16x32_bf16 v[80:83], v[104:107], v[200:203], v[80:83]
ds_read_b64_tr_b16 v[240:241], v15 offset:61440
ds_read_b64_tr_b16 v[242:243], v15 offset:61952
v_mfma_f32_16x16x32_bf16 v[64:67], v[104:107], v[196:199], v[64:67]
v_mfma_f32_16x16x32_bf16 v[68:71], v[108:111], v[196:199], v[68:71]
ds_read_b64_tr_b16 v[244:245], v16 offset:61440
ds_read_b64_tr_b16 v[246:247], v16 offset:61952
v_mfma_f32_16x16x32_bf16 v[84:87], v[108:111], v[200:203], v[84:87]
ds_read_b64_tr_b16 v[248:249], v17 offset:61440
ds_read_b64_tr_b16 v[250:251], v17 offset:61952
v_mfma_f32_16x16x32_bf16 v[88:91], v[112:115], v[200:203], v[88:91]
v_mfma_f32_16x16x32_bf16 v[72:75], v[112:115], v[196:199], v[72:75]
s_waitcnt vmcnt(2) lgkmcnt(8)
v_mfma_f32_16x16x32_bf16 v[60:63], v[220:223], v[204:207], v[60:63]
v_mfma_f32_16x16x32_bf16 v[76:79], v[220:223], v[208:211], v[76:79]
v_mfma_f32_16x16x32_bf16 v[80:83], v[224:227], v[208:211], v[80:83]
v_mfma_f32_16x16x32_bf16 v[64:67], v[224:227], v[204:207], v[64:67]
v_mfma_f32_16x16x32_bf16 v[68:71], v[228:231], v[204:207], v[68:71]
v_mfma_f32_16x16x32_bf16 v[84:87], v[228:231], v[208:211], v[84:87]
v_mfma_f32_16x16x32_bf16 v[88:91], v[232:235], v[208:211], v[88:91]
v_mfma_f32_16x16x32_bf16 v[72:75], v[232:235], v[204:207], v[72:75]
s_waitcnt vmcnt(0) lgkmcnt(0)
v_mfma_f32_16x16x32_bf16 v[60:63], v[236:239], v[212:215], v[60:63]
v_mfma_f32_16x16x32_bf16 v[64:67], v[240:243], v[212:215], v[64:67]
v_mfma_f32_16x16x32_bf16 v[68:71], v[244:247], v[212:215], v[68:71]
v_mfma_f32_16x16x32_bf16 v[72:75], v[248:251], v[212:215], v[72:75]
v_mfma_f32_16x16x32_bf16 v[76:79], v[236:239], v[216:219], v[76:79]
v_mfma_f32_16x16x32_bf16 v[80:83], v[240:243], v[216:219], v[80:83]
v_mfma_f32_16x16x32_bf16 v[84:87], v[244:247], v[216:219], v[84:87]
v_mfma_f32_16x16x32_bf16 v[88:91], v[248:251], v[216:219], v[88:91]
s_cmp_eq_u32 s46, 0
s_cbranch_scc1 slow_79
s_nop 0
v_cvt_pk_bf16_f32 v20, v60, v61
v_cvt_pk_bf16_f32 v21, v62, v63
v_cvt_pk_bf16_f32 v22, v64, v65
v_cvt_pk_bf16_f32 v23, v66, v67
buffer_store_dwordx4 v[20:23], v18, s[32:35], s85 offen offset:0 sc1
v_cvt_pk_bf16_f32 v24, v68, v69
v_cvt_pk_bf16_f32 v25, v70, v71
v_cvt_pk_bf16_f32 v26, v72, v73
v_cvt_pk_bf16_f32 v27, v74, v75
buffer_store_dwordx4 v[24:27], v18, s[32:35], s85 offen offset:1024 sc1
v_cvt_pk_bf16_f32 v28, v76, v77
v_cvt_pk_bf16_f32 v29, v78, v79
v_cvt_pk_bf16_f32 v30, v80, v81
v_cvt_pk_bf16_f32 v31, v82, v83
buffer_store_dwordx4 v[28:31], v18, s[32:35], s86 offen offset:0 sc1
v_cvt_pk_bf16_f32 v32, v84, v85
v_cvt_pk_bf16_f32 v33, v86, v87
v_cvt_pk_bf16_f32 v34, v88, v89
v_cvt_pk_bf16_f32 v35, v90, v91
buffer_store_dwordx4 v[32:35], v18, s[32:35], s86 offen offset:1024 sc1
s_barrier
v_dot2c_f32_bf16 v6, v20, v48
v_dot2c_f32_bf16 v8, v20, v20
v_dot2c_f32_bf16 v7, v28, v48
v_dot2c_f32_bf16 v9, v28, v28
v_dot2c_f32_bf16 v6, v21, v48
v_dot2c_f32_bf16 v8, v21, v21
v_dot2c_f32_bf16 v7, v29, v48
v_dot2c_f32_bf16 v9, v29, v29
v_dot2c_f32_bf16 v6, v22, v48
v_dot2c_f32_bf16 v8, v22, v22
v_dot2c_f32_bf16 v7, v30, v48
v_dot2c_f32_bf16 v9, v30, v30
v_dot2c_f32_bf16 v6, v23, v48
v_dot2c_f32_bf16 v8, v23, v23
v_dot2c_f32_bf16 v7, v31, v48
v_dot2c_f32_bf16 v9, v31, v31
v_dot2c_f32_bf16 v6, v24, v48
v_dot2c_f32_bf16 v8, v24, v24
v_dot2c_f32_bf16 v7, v32, v48
v_dot2c_f32_bf16 v9, v32, v32
v_dot2c_f32_bf16 v6, v25, v48
v_dot2c_f32_bf16 v8, v25, v25
v_dot2c_f32_bf16 v7, v33, v48
v_dot2c_f32_bf16 v9, v33, v33
v_dot2c_f32_bf16 v6, v26, v48
v_dot2c_f32_bf16 v8, v26, v26
v_dot2c_f32_bf16 v7, v34, v48
v_dot2c_f32_bf16 v9, v34, v34
v_dot2c_f32_bf16 v6, v27, v48
v_dot2c_f32_bf16 v8, v27, v27
v_dot2c_f32_bf16 v7, v35, v48
v_dot2c_f32_bf16 v9, v35, v35
s_mov_b64 exec, 1
s_waitcnt vmcnt(0)
buffer_store_dword v5, v4, s[32:35], s88 offen
s_mov_b64 exec, -1
s_nop 1
v_permlane32_swap_b32 v6, v7
v_permlane32_swap_b32 v8, v9
v_add_f32 v6, v6, v7
v_add_f32 v8, v8, v9
s_nop 1
v_permlane16_swap_b32 v6, v8
s_nop 0
v_add_f32 v6, v6, v8
buffer_store_dword v6, v1, s[32:35], s87 offen
back_80:
s_lshl_b32 s49, s44, 13
v_add_u32 v10, s49, v18
v_add_u32 v11, 1024, v10
s_lshl_b32 s48, s43, 1
v_lshrrev_b32 v4, 2, v2
v_and_b32 v5, 3, v0
v_lshl_add_u32 v6, v3, 3, v4
v_lshlrev_b32 v6, 7, v6
v_lshl_add_u32 v6, v5, 3, v6
v_lshrrev_b32 v7, 1, v4
v_and_b32 v8, 1, v3
v_lshl_add_u32 v7, v8, 1, v7
v_xor_b32 v7, s48, v7
v_lshl_add_u32 v12, v7, 5, v6
v_add_u32 v12, 16384, v12
v_xor_b32 v13, 32, v12
v_mov_b32 v14, v10
v_mov_b32 v15, v11
v_add_u32 v16, 122880, v12
v_add_u32 v17, 122880, v13
v_mov_b32 v156, 0
v_mov_b32 v157, 0
v_mov_b32 v158, 0
v_mov_b32 v159, 0
v_mov_b32 v160, 0
v_mov_b32 v161, 0
v_mov_b32 v162, 0
v_mov_b32 v163, 0
v_mov_b32 v164, 0
v_mov_b32 v165, 0
v_mov_b32 v166, 0
v_mov_b32 v167, 0
v_mov_b32 v168, 0
v_mov_b32 v169, 0
v_mov_b32 v170, 0
v_mov_b32 v171, 0
v_mov_b32 v172, 0
v_mov_b32 v173, 0
v_mov_b32 v174, 0
v_mov_b32 v175, 0
v_mov_b32 v176, 0
v_mov_b32 v177, 0
v_mov_b32 v178, 0
v_mov_b32 v179, 0
v_mov_b32 v180, 0
v_mov_b32 v181, 0
v_mov_b32 v182, 0
v_mov_b32 v183, 0
v_mov_b32 v184, 0
v_mov_b32 v185, 0
v_mov_b32 v186, 0
v_mov_b32 v187, 0
v_mov_b32 v188, 0
v_mov_b32 v189, 0
v_mov_b32 v190, 0
v_mov_b32 v191, 0
v_mov_b32 v192, 0
v_mov_b32 v193, 0
v_mov_b32 v194, 0
v_mov_b32 v195, 0
v_mov_b32 v196, 0
v_mov_b32 v197, 0
v_mov_b32 v198, 0
v_mov_b32 v199, 0
v_mov_b32 v200, 0
v_mov_b32 v201, 0
v_mov_b32 v202, 0
v_mov_b32 v203, 0
v_mov_b32 v204, 0
v_mov_b32 v205, 0
v_mov_b32 v206, 0
v_mov_b32 v207, 0
v_mov_b32 v208, 0
v_mov_b32 v209, 0
v_mov_b32 v210, 0
v_mov_b32 v211, 0
v_mov_b32 v212, 0
v_mov_b32 v213, 0
v_mov_b32 v214, 0
v_mov_b32 v215, 0
v_mov_b32 v216, 0
v_mov_b32 v217, 0
v_mov_b32 v218, 0
v_mov_b32 v219, 0
v_mov_b32 v220, 0
v_mov_b32 v221, 0
v_mov_b32 v222, 0
v_mov_b32 v223, 0
v_mov_b32 v224, 0
v_mov_b32 v225, 0
v_mov_b32 v226, 0
v_mov_b32 v227, 0
v_mov_b32 v228, 0
v_mov_b32 v229, 0
v_mov_b32 v230, 0
v_mov_b32 v231, 0
v_mov_b32 v232, 0
v_mov_b32 v233, 0
v_mov_b32 v234, 0
v_mov_b32 v235, 0
v_mov_b32 v236, 0
v_mov_b32 v237, 0
v_mov_b32 v238, 0
v_mov_b32 v239, 0
v_mov_b32 v240, 0
v_mov_b32 v241, 0
v_mov_b32 v242, 0
v_mov_b32 v243, 0
v_mov_b32 v244, 0
v_mov_b32 v245, 0
v_mov_b32 v246, 0
v_mov_b32 v247, 0
v_mov_b32 v248, 0
v_mov_b32 v249, 0
v_mov_b32 v250, 0
v_mov_b32 v251, 0
v_lshrrev_b32 v6, 2, v2
v_cmp_eq_u32 vcc, v6, v3
v_and_b32 v7, 1, v0
v_lshlrev_b32 v7, 4, v7
v_mov_b32 v8, 0x3f80
v_lshlrev_b32 v9, v7, v8
v_cndmask_b32 v7, 0, v9, vcc
v_and_b32 v6, 2, v0
v_cmp_eq_u32 vcc, 0, v6
v_mov_b32 v36, 0
v_mov_b32 v37, 0
v_mov_b32 v40, 0
v_mov_b32 v41, 0
v_cndmask_b32 v38, 0, v7, vcc
v_cndmask_b32 v39, v7, 0, vcc
v_lshrrev_b32 v8, 1, v2
v_cmp_eq_u32 vcc, 0, v8
s_nop 1
v_cndmask_b32 v44, 0, v9, vcc
v_cmp_eq_u32 vcc, 1, v8
s_nop 1
v_cndmask_b32 v45, 0, v9, vcc
v_cmp_eq_u32 vcc, 2, v8
s_nop 1
v_cndmask_b32 v46, 0, v9, vcc
v_cmp_eq_u32 vcc, 3, v8
s_nop 1
v_cndmask_b32 v47, 0, v9, vcc
v_lshrrev_b32 v4, 2, v2
v_lshl_add_u32 v4, v3, 2, v4
v_lshlrev_b32 v4, 6, v4
v_and_b32 v5, 3, v0
v_lshl_add_u32 v4, v5, 3, v4
s_lshl_b32 s48, s43, 11
s_add_u32 s48, s48, 135168
v_add_u32 v53, s48, v4
s_mul_i32 s48, s40, 3072
s_add_u32 s48, s48, 139264
v_add_u32 v42, s48, v18
s_xor_b32 s49, s40, 2
s_mul_i32 s48, s49, 3072
s_add_u32 s48, s48, 139264
v_add_u32 v43, s48, v18
s_lshl_b32 s49, s49, 2
s_add_u32 s49, s49, 134672
v_mov_b32 v19, s49
v_xor_b32 v52, 8, v19
v_lshrrev_b32 v4, 3, v0
v_and_b32 v5, 7, v0
v_lshlrev_b32 v4, 11, v4
v_lshl_add_u32 v55, v5, 4, v4
v_lshlrev_b32 v4, 6, v2
v_lshl_add_u32 v58, v3, 4, v4
v_lshlrev_b32 v4, 4, v2
v_lshl_add_u32 v59, v3, 3, v4
s_mul_i32 s51, s42, 163840
s_add_u32 s51, s51, 9437184
s_lshl_b32 s50, s43, 1
s_add_u32 s50, s50, s44
s_lshl_b32 s48, s50, 15
s_add_u32 s48, s48, s51
s_add_u32 s48, s48, 0
s_lshl_b32 s49, s41, 7
s_add_u32 s53, s48, s49
s_add_u32 s54, s53, 16384
s_lshl_b32 s56, s50, 10
s_add_u32 s56, s56, s51
s_add_u32 s56, s56, 147456
s_xor_b32 s57, s56, 1024
s_lshl_b32 s58, s50, 11
s_add_u32 s58, s58, s51
s_add_u32 s58, s58, 131072
s_xor_b32 s59, s58, 2048
s_add_u32 s79, s58, s49
s_lshl_b32 s50, s41, 11
s_add_u32 s55, s48, s50
s_lshl_b32 s48, s43, 7
s_add_u32 s48, s48, 133888
v_lshl_add_u32 v7, v3, 4, s48
v_lshl_add_u32 v54, v2, 2, s48
s_lshl_b32 s49, s44, 6
v_add_u32 v8, s49, v2
v_lshlrev_b32 v8, 3, v8
v_add_u32 v8, 131072, v8
v_lshl_add_u32 v9, v3, 2, s49
v_lshlrev_b32 v9, 2, v9
v_add_u32 v9, 132096, v9
s_mov_b32 s64, 0
s_mov_b32 s65, 0
s_mov_b32 s66, 0x3fb8aa3b
s_lshr_b32 s49, s42, 3
s_xor_b32 s77, s74, s49
s_add_u32 s77, s77, 4
s_lshl_b32 s50, s42, 2
s_add_u32 s50, s50, s40
s_lshl_b32 s50, s50, 4
s_add_u32 s50, s50, s41
s_lshl_b32 s50, s50, 8
s_add_u32 s52, s50, 18087936
s_barrier
ds_read_b128 v[60:63], v14 offset:0
ds_read_b128 v[64:67], v14 offset:2048
ds_read_b128 v[68:71], v14 offset:4096
ds_read_b128 v[72:75], v14 offset:6144
ds_read_b64_tr_b16 v[84:85], v16 offset:8192
ds_read_b64_tr_b16 v[86:87], v16 offset:8704
ds_read_b64_tr_b16 v[88:89], v17 offset:8192
ds_read_b64_tr_b16 v[90:91], v17 offset:8704
ds_read_b64_tr_b16 v[92:93], v16 offset:16384
ds_read_b64_tr_b16 v[94:95], v16 offset:16896
ds_read_b64_tr_b16 v[96:97], v17 offset:16384
ds_read_b64_tr_b16 v[98:99], v17 offset:16896
ds_read_b64_tr_b16 v[76:77], v16 offset:0
ds_read_b64_tr_b16 v[78:79], v16 offset:512
ds_read_b64_tr_b16 v[80:81], v17 offset:0
ds_read_b64_tr_b16 v[82:83], v17 offset:512
s_waitcnt lgkmcnt(0)
c1_loop:
v_mfma_f32_16x16x32_bf16 v[212:215], v[84:87], v[72:75], v[212:215]
ds_read_b128 v[100:103], v15 offset:0
v_mfma_f32_16x16x32_bf16 v[204:207], v[84:87], v[68:71], v[204:207]
ds_read_b128 v[104:107], v15 offset:2048
v_mfma_f32_16x16x32_bf16 v[196:199], v[84:87], v[64:67], v[196:199]
ds_read_b128 v[108:111], v15 offset:4096
v_mfma_f32_16x16x32_bf16 v[188:191], v[84:87], v[60:63], v[188:191]
ds_read_b128 v[112:115], v15 offset:6144
v_mfma_f32_16x16x32_bf16 v[192:195], v[88:91], v[60:63], v[192:195]
ds_read_b64_tr_b16 v[124:125], v16 offset:12288
v_mfma_f32_16x16x32_bf16 v[200:203], v[88:91], v[64:67], v[200:203]
ds_read_b64_tr_b16 v[126:127], v16 offset:12800
v_mfma_f32_16x16x32_bf16 v[208:211], v[88:91], v[68:71], v[208:211]
ds_read_b64_tr_b16 v[128:129], v17 offset:12288
v_mfma_f32_16x16x32_bf16 v[216:219], v[88:91], v[72:75], v[216:219]
ds_read_b64_tr_b16 v[130:131], v17 offset:12800
v_mfma_f32_16x16x32_bf16 v[244:247], v[72:75], v[92:95], v[244:247]
ds_read_b64_tr_b16 v[132:133], v16 offset:20480
v_mfma_f32_16x16x32_bf16 v[248:251], v[72:75], v[96:99], v[248:251]
ds_read_b64_tr_b16 v[134:135], v16 offset:20992
v_mfma_f32_16x16x32_bf16 v[240:243], v[68:71], v[96:99], v[240:243]
ds_read_b64_tr_b16 v[136:137], v17 offset:20480
v_mfma_f32_16x16x32_bf16 v[236:239], v[68:71], v[92:95], v[236:239]
ds_read_b64_tr_b16 v[138:139], v17 offset:20992
v_mfma_f32_16x16x32_bf16 v[228:231], v[64:67], v[92:95], v[228:231]
ds_read_b64_tr_b16 v[116:117], v16 offset:4096
v_mfma_f32_16x16x32_bf16 v[232:235], v[64:67], v[96:99], v[232:235]
ds_read_b64_tr_b16 v[118:119], v16 offset:4608
v_mfma_f32_16x16x32_bf16 v[224:227], v[60:63], v[96:99], v[224:227]
ds_read_b64_tr_b16 v[120:121], v17 offset:4096
v_mfma_f32_16x16x32_bf16 v[220:223], v[60:63], v[92:95], v[220:223]
ds_read_b64_tr_b16 v[122:123], v17 offset:4608
v_mfma_f32_16x16x32_bf16 v[156:159], v[76:79], v[60:63], v[156:159]
s_cmp_eq_u32 s77, s64
s_cbranch_scc1 c1_hook
c1_hook_ret:
v_mfma_f32_16x16x32_bf16 v[164:167], v[76:79], v[64:67], v[164:167]
s_add_u32 s65, s65, 40960
s_cmp_eq_u32 s65, 122880
v_mfma_f32_16x16x32_bf16 v[172:175], v[76:79], v[68:71], v[172:175]
s_cselect_b32 s65, 0, s65
s_add_u32 s64, s64, 1
v_mfma_f32_16x16x32_bf16 v[180:183], v[76:79], v[72:75], v[180:183]
v_add_u32 v14, s65, v10
v_add_u32 v15, s65, v11
v_mfma_f32_16x16x32_bf16 v[184:187], v[80:83], v[72:75], v[184:187]
v_add_u32 v16, s65, v12
v_add_u32 v17, s65, v13
v_mfma_f32_16x16x32_bf16 v[176:179], v[80:83], v[68:71], v[176:179]
s_cmp_eq_u32 s64, 16
s_cbranch_scc1 c1_last
v_mfma_f32_16x16x32_bf16 v[168:171], v[80:83], v[64:67], v[168:171]
s_waitcnt lgkmcnt(0)
v_mfma_f32_16x16x32_bf16 v[160:163], v[80:83], v[60:63], v[160:163]
s_barrier
v_mfma_f32_16x16x32_bf16 v[212:215], v[124:127], v[112:115], v[212:215]
ds_read_b128 v[60:63], v14 offset:0
v_mfma_f32_16x16x32_bf16 v[204:207], v[124:127], v[108:111], v[204:207]
ds_read_b128 v[64:67], v14 offset:2048
v_mfma_f32_16x16x32_bf16 v[196:199], v[124:127], v[104:107], v[196:199]
ds_read_b128 v[68:71], v14 offset:4096
v_mfma_f32_16x16x32_bf16 v[188:191], v[124:127], v[100:103], v[188:191]
ds_read_b128 v[72:75], v14 offset:6144
v_mfma_f32_16x16x32_bf16 v[192:195], v[128:131], v[100:103], v[192:195]
ds_read_b64_tr_b16 v[84:85], v16 offset:8192
v_mfma_f32_16x16x32_bf16 v[200:203], v[128:131], v[104:107], v[200:203]
ds_read_b64_tr_b16 v[86:87], v16 offset:8704
v_mfma_f32_16x16x32_bf16 v[208:211], v[128:131], v[108:111], v[208:211]
ds_read_b64_tr_b16 v[88:89], v17 offset:8192
v_mfma_f32_16x16x32_bf16 v[216:219], v[128:131], v[112:115], v[216:219]
ds_read_b64_tr_b16 v[90:91], v17 offset:8704
v_mfma_f32_16x16x32_bf16 v[244:247], v[112:115], v[132:135], v[244:247]
ds_read_b64_tr_b16 v[92:93], v16 offset:16384
v_mfma_f32_16x16x32_bf16 v[248:251], v[112:115], v[136:139], v[248:251]
ds_read_b64_tr_b16 v[94:95], v16 offset:16896
v_mfma_f32_16x16x32_bf16 v[240:243], v[108:111], v[136:139], v[240:243]
ds_read_b64_tr_b16 v[96:97], v17 offset:16384
v_mfma_f32_16x16x32_bf16 v[236:239], v[108:111], v[132:135], v[236:239]
ds_read_b64_tr_b16 v[98:99], v17 offset:16896
v_mfma_f32_16x16x32_bf16 v[228:231], v[104:107], v[132:135], v[228:231]
ds_read_b64_tr_b16 v[76:77], v16 offset:0
v_mfma_f32_16x16x32_bf16 v[232:235], v[104:107], v[136:139], v[232:235]
ds_read_b64_tr_b16 v[78:79], v16 offset:512
v_mfma_f32_16x16x32_bf16 v[224:227], v[100:103], v[136:139], v[224:227]
ds_read_b64_tr_b16 v[80:81], v17 offset:0
v_mfma_f32_16x16x32_bf16 v[220:223], v[100:103], v[132:135], v[220:223]
ds_read_b64_tr_b16 v[82:83], v17 offset:512
v_mfma_f32_16x16x32_bf16 v[156:159], v[116:119], v[100:103], v[156:159]
v_mfma_f32_16x16x32_bf16 v[164:167], v[116:119], v[104:107], v[164:167]
v_mfma_f32_16x16x32_bf16 v[172:175], v[116:119], v[108:111], v[172:175]
v_mfma_f32_16x16x32_bf16 v[180:183], v[116:119], v[112:115], v[180:183]
v_mfma_f32_16x16x32_bf16 v[184:187], v[120:123], v[112:115], v[184:187]
v_mfma_f32_16x16x32_bf16 v[176:179], v[120:123], v[108:111], v[176:179]
v_mfma_f32_16x16x32_bf16 v[168:171], v[120:123], v[104:107], v[168:171]
s_waitcnt lgkmcnt(0)
v_mfma_f32_16x16x32_bf16 v[160:163], v[120:123], v[100:103], v[160:163]
s_branch c1_loop
c1_hook:
s_waitcnt lgkmcnt(0)
s_cmp_lg_u32 s44, 0
s_cbranch_scc1 else_81
v_mfma_f32_16x16x32_bf16 v[140:143], v[48:51], v[76:79], 0
v_mfma_f32_16x16x32_bf16 v[144:147], v[48:51], v[84:87], 0
v_mfma_f32_16x16x32_bf16 v[148:151], v[48:51], v[92:95], 0
v_mfma_f32_16x16x32_bf16 v[140:143], v[48:51], v[116:119], v[140:143]
v_mfma_f32_16x16x32_bf16 v[144:147], v[48:51], v[124:127], v[144:147]
v_mfma_f32_16x16x32_bf16 v[148:151], v[48:51], v[132:135], v[148:151]
s_branch fi_82
else_81:
v_mfma_f32_16x16x32_bf16 v[140:143], v[48:51], v[80:83], 0
v_mfma_f32_16x16x32_bf16 v[144:147], v[48:51], v[88:91], 0
v_mfma_f32_16x16x32_bf16 v[148:151], v[48:51], v[96:99], 0
v_mfma_f32_16x16x32_bf16 v[140:143], v[48:51], v[120:123], v[140:143]
v_mfma_f32_16x16x32_bf16 v[144:147], v[48:51], v[128:131], v[144:147]
v_mfma_f32_16x16x32_bf16 v[148:151], v[48:51], v[136:139], v[148:151]
fi_82:
s_nop 4
v_cmp_eq_u32 vcc, 0, v3
v_cmp_eq_u32 s[48:49], 1, v3
s_nop 1
v_cndmask_b32 v4, v148, v144, s[48:49]
v_cndmask_b32 v4, v4, v140, vcc
buffer_store_dword v4, v1, s[32:35], s52 offen sc1
s_branch c1_hook_ret
c1_last:
v_mfma_f32_16x16x32_bf16 v[168:171], v[80:83], v[64:67], v[168:171]
s_waitcnt lgkmcnt(0)
v_mfma_f32_16x16x32_bf16 v[160:163], v[80:83], v[60:63], v[160:163]
v_mfma_f32_16x16x32_bf16 v[212:215], v[124:127], v[112:115], v[212:215]
v_mfma_f32_16x16x32_bf16 v[204:207], v[124:127], v[108:111], v[204:207]
v_mfma_f32_16x16x32_bf16 v[196:199], v[124:127], v[104:107], v[196:199]
v_mfma_f32_16x16x32_bf16 v[188:191], v[124:127], v[100:103], v[188:191]
v_mfma_f32_16x16x32_bf16 v[192:195], v[128:131], v[100:103], v[192:195]
v_mfma_f32_16x16x32_bf16 v[200:203], v[128:131], v[104:107], v[200:203]
v_mfma_f32_16x16x32_bf16 v[208:211], v[128:131], v[108:111], v[208:211]
v_mfma_f32_16x16x32_bf16 v[216:219], v[128:131], v[112:115], v[216:219]
s_barrier
v_mfma_f32_16x16x32_bf16 v[244:247], v[112:115], v[132:135], v[244:247]
ds_read_b128 v[140:143], v7 offset:0
ds_read_b128 v[144:147], v7 offset:64
v_mfma_f32_16x16x32_bf16 v[248:251], v[112:115], v[136:139], v[248:251]
ds_read_b128 v[148:151], v7 offset:256
ds_read_b128 v[152:155], v7 offset:320
v_mfma_f32_16x16x32_bf16 v[240:243], v[108:111], v[136:139], v[240:243]
ds_read_b64 v[92:93], v8 offset:0
ds_read_b64 v[94:95], v8 offset:128
v_mfma_f32_16x16x32_bf16 v[236:239], v[108:111], v[132:135], v[236:239]
ds_read_b64 v[96:97], v8 offset:256
ds_read_b64 v[98:99], v8 offset:384
v_mfma_f32_16x16x32_bf16 v[228:231], v[104:107], v[132:135], v[228:231]
ds_read2_b32 v[56:57], v54 offset0:128 offset1:144
ds_read_b128 v[60:63], v9 offset:0
v_mfma_f32_16x16x32_bf16 v[232:235], v[104:107], v[136:139], v[232:235]
ds_read_b128 v[64:67], v9 offset:64
ds_read_b128 v[68:71], v9 offset:128
v_mfma_f32_16x16x32_bf16 v[224:227], v[100:103], v[136:139], v[224:227]
ds_read_b128 v[72:75], v9 offset:192
ds_read_b128 v[76:79], v9 offset:512
v_mfma_f32_16x16x32_bf16 v[220:223], v[100:103], v[132:135], v[220:223]
ds_read_b128 v[80:83], v9 offset:576
ds_read_b128 v[84:87], v9 offset:640
v_mfma_f32_16x16x32_bf16 v[156:159], v[116:119], v[100:103], v[156:159]
ds_read_b128 v[88:91], v9 offset:704
v_mfma_f32_16x16x32_bf16 v[164:167], v[116:119], v[104:107], v[164:167]
ds_read_b64_tr_b16 v[10:11], v53 offset:0
v_mfma_f32_16x16x32_bf16 v[172:175], v[116:119], v[108:111], v[172:175]
ds_read_b64_tr_b16 v[12:13], v53 offset:1024
v_mfma_f32_16x16x32_bf16 v[180:183], v[116:119], v[112:115], v[180:183]
ds_read_b64_tr_b16 v[14:15], v53 offset:32
v_mfma_f32_16x16x32_bf16 v[184:187], v[120:123], v[112:115], v[184:187]
ds_read_b64_tr_b16 v[16:17], v53 offset:1056
v_mfma_f32_16x16x32_bf16 v[176:179], v[120:123], v[108:111], v[176:179]
v_mfma_f32_16x16x32_bf16 v[168:171], v[120:123], v[104:107], v[168:171]
v_mfma_f32_16x16x32_bf16 v[160:163], v[120:123], v[100:103], v[160:163]
c1_epi:
s_waitcnt lgkmcnt(0)
s_mul_i32 s48, s44, 0x80008000
v_xor_b32 v10, s48, v10
v_xor_b32 v11, s48, v11
v_xor_b32 v12, s48, v12
v_xor_b32 v13, s48, v13
v_xor_b32 v14, s48, v14
v_xor_b32 v15, s48, v15
v_xor_b32 v16, s48, v16
v_xor_b32 v17, s48, v17
v_mul_f32 v128, s66, v92
v_mul_f32 v129, s66, v94
v_mul_f32 v130, s66, v96
v_mul_f32 v131, s66, v98
.p2align 3
v_pk_fma_f32 v[220:221], v[76:77], v[56:57], v[220:221] op_sel:[0,0,0] op_sel_hi:[1,0,1]
v_pk_fma_f32 v[222:223], v[78:79], v[56:57], v[222:223] op_sel:[0,0,0] op_sel_hi:[1,0,1]
v_pk_mul_f32 v[220:221], v[220:221], v[60:61]
v_pk_mul_f32 v[222:223], v[222:223], v[62:63]
v_cvt_pk_bf16_f32 v112, v220, v221
v_cvt_pk_bf16_f32 v113, v222, v223
v_pk_fma_f32 v[228:229], v[80:81], v[56:57], v[228:229] op_sel:[0,0,0] op_sel_hi:[1,0,1]
v_pk_fma_f32 v[230:231], v[82:83], v[56:57], v[230:231] op_sel:[0,0,0] op_sel_hi:[1,0,1]
v_pk_mul_f32 v[228:229], v[228:229], v[64:65]
v_pk_mul_f32 v[230:231], v[230:231], v[66:67]
v_cvt_pk_bf16_f32 v114, v228, v229
v_cvt_pk_bf16_f32 v115, v230, v231
v_pk_fma_f32 v[236:237], v[84:85], v[56:57], v[236:237] op_sel:[0,0,0] op_sel_hi:[1,0,1]
v_pk_fma_f32 v[238:239], v[86:87], v[56:57], v[238:239] op_sel:[0,0,0] op_sel_hi:[1,0,1]
v_pk_mul_f32 v[236:237], v[236:237], v[68:69]
v_pk_mul_f32 v[238:239], v[238:239], v[70:71]
v_cvt_pk_bf16_f32 v116, v236, v237
v_cvt_pk_bf16_f32 v117, v238, v239
v_pk_fma_f32 v[244:245], v[88:89], v[56:57], v[244:245] op_sel:[0,0,0] op_sel_hi:[1,0,1]
v_pk_fma_f32 v[246:247], v[90:91], v[56:57], v[246:247] op_sel:[0,0,0] op_sel_hi:[1,0,1]
v_pk_mul_f32 v[244:245], v[244:245], v[72:73]
v_pk_mul_f32 v[246:247], v[246:247], v[74:75]
v_cvt_pk_bf16_f32 v118, v244, v245
v_cvt_pk_bf16_f32 v119, v246, v247
v_pk_fma_f32 v[224:225], v[76:77], v[56:57], v[224:225] op_sel:[0,1,0] op_sel_hi:[1,1,1]
v_pk_fma_f32 v[226:227], v[78:79], v[56:57], v[226:227] op_sel:[0,1,0] op_sel_hi:[1,1,1]
v_pk_mul_f32 v[224:225], v[224:225], v[60:61]
v_pk_mul_f32 v[226:227], v[226:227], v[62:63]
v_cvt_pk_bf16_f32 v120, v224, v225
v_cvt_pk_bf16_f32 v121, v226, v227
v_pk_fma_f32 v[232:233], v[80:81], v[56:57], v[232:233] op_sel:[0,1,0] op_sel_hi:[1,1,1]
v_pk_fma_f32 v[234:235], v[82:83], v[56:57], v[234:235] op_sel:[0,1,0] op_sel_hi:[1,1,1]
v_pk_mul_f32 v[232:233], v[232:233], v[64:65]
v_pk_mul_f32 v[234:235], v[234:235], v[66:67]
v_cvt_pk_bf16_f32 v122, v232, v233
v_cvt_pk_bf16_f32 v123, v234, v235
v_pk_fma_f32 v[240:241], v[84:85], v[56:57], v[240:241] op_sel:[0,1,0] op_sel_hi:[1,1,1]
v_pk_fma_f32 v[242:243], v[86:87], v[56:57], v[242:243] op_sel:[0,1,0] op_sel_hi:[1,1,1]
v_pk_mul_f32 v[240:241], v[240:241], v[68:69]
v_pk_mul_f32 v[242:243], v[242:243], v[70:71]
v_cvt_pk_bf16_f32 v124, v240, v241
v_cvt_pk_bf16_f32 v125, v242, v243
v_pk_fma_f32 v[248:249], v[88:89], v[56:57], v[248:249] op_sel:[0,1,0] op_sel_hi:[1,1,1]
v_pk_fma_f32 v[250:251], v[90:91], v[56:57], v[250:251] op_sel:[0,1,0] op_sel_hi:[1,1,1]
v_pk_mul_f32 v[248:249], v[248:249], v[72:73]
v_pk_mul_f32 v[250:251], v[250:251], v[74:75]
v_cvt_pk_bf16_f32 v126, v248, v249
v_cvt_pk_bf16_f32 v127, v250, v251
v_pk_fma_f32 v[188:189], v[148:149], v[92:93], v[188:189] op_sel:[0,1,0] op_sel_hi:[1,1,1]
v_pk_fma_f32 v[190:191], v[150:151], v[92:93], v[190:191] op_sel:[0,1,0] op_sel_hi:[1,1,1]
v_pk_fma_f32 v[192:193], v[152:153], v[92:93], v[192:193] op_sel:[0,1,0] op_sel_hi:[1,1,1]
v_pk_fma_f32 v[194:195], v[154:155], v[92:93], v[194:195] op_sel:[0,1,0] op_sel_hi:[1,1,1]
v_cvt_pk_bf16_f32 v188, v188, v189
v_cvt_pk_bf16_f32 v189, v190, v191
v_cvt_pk_bf16_f32 v190, v192, v193
v_cvt_pk_bf16_f32 v191, v194, v195
v_pk_fma_f32 v[196:197], v[148:149], v[94:95], v[196:197] op_sel:[0,1,0] op_sel_hi:[1,1,1]
v_pk_fma_f32 v[198:199], v[150:151], v[94:95], v[198:199] op_sel:[0,1,0] op_sel_hi:[1,1,1]
v_pk_fma_f32 v[200:201], v[152:153], v[94:95], v[200:201] op_sel:[0,1,0] op_sel_hi:[1,1,1]
v_pk_fma_f32 v[202:203], v[154:155], v[94:95], v[202:203] op_sel:[0,1,0] op_sel_hi:[1,1,1]
v_cvt_pk_bf16_f32 v196, v196, v197
v_mfma_f32_16x16x32_bf16 v[60:63], v[10:13], v[188:191], 0
v_cvt_pk_bf16_f32 v197, v198, v199
v_cvt_pk_bf16_f32 v198, v200, v201
v_mfma_f32_16x16x32_bf16 v[64:67], v[14:17], v[188:191], 0
v_cvt_pk_bf16_f32 v199, v202, v203
v_pk_fma_f32 v[204:205], v[148:149], v[96:97], v[204:205] op_sel:[0,1,0] op_sel_hi:[1,1,1]
v_pk_fma_f32 v[206:207], v[150:151], v[96:97], v[206:207] op_sel:[0,1,0] op_sel_hi:[1,1,1]
v_pk_fma_f32 v[208:209], v[152:153], v[96:97], v[208:209] op_sel:[0,1,0] op_sel_hi:[1,1,1]
v_pk_fma_f32 v[210:211], v[154:155], v[96:97], v[210:211] op_sel:[0,1,0] op_sel_hi:[1,1,1]
v_cvt_pk_bf16_f32 v204, v204, v205
v_mfma_f32_16x16x32_bf16 v[68:71], v[10:13], v[196:199], 0
v_cvt_pk_bf16_f32 v205, v206, v207
v_cvt_pk_bf16_f32 v206, v208, v209
v_mfma_f32_16x16x32_bf16 v[72:75], v[14:17], v[196:199], 0
v_cvt_pk_bf16_f32 v207, v210, v211
v_pk_fma_f32 v[212:213], v[148:149], v[98:99], v[212:213] op_sel:[0,1,0] op_sel_hi:[1,1,1]
v_pk_fma_f32 v[214:215], v[150:151], v[98:99], v[214:215] op_sel:[0,1,0] op_sel_hi:[1,1,1]
v_pk_fma_f32 v[216:217], v[152:153], v[98:99], v[216:217] op_sel:[0,1,0] op_sel_hi:[1,1,1]
v_pk_fma_f32 v[218:219], v[154:155], v[98:99], v[218:219] op_sel:[0,1,0] op_sel_hi:[1,1,1]
v_cvt_pk_bf16_f32 v212, v212, v213
v_mfma_f32_16x16x32_bf16 v[76:79], v[10:13], v[204:207], 0
v_cvt_pk_bf16_f32 v213, v214, v215
v_cvt_pk_bf16_f32 v214, v216, v217
v_mfma_f32_16x16x32_bf16 v[80:83], v[14:17], v[204:207], 0
v_cvt_pk_bf16_f32 v215, v218, v219
s_nop 1
v_mfma_f32_16x16x32_bf16 v[84:87], v[10:13], v[212:215], 0
v_mfma_f32_16x16x32_bf16 v[88:91], v[14:17], v[212:215], 0
v_max3_f32 v100, v60, v61, v62
v_min3_f32 v104, v60, v61, v62
v_max3_f32 v100, v100, v63, v64
v_min3_f32 v104, v104, v63, v64
v_max3_f32 v100, v100, v65, v66
v_min3_f32 v104, v104, v65, v66
v_max_f32 v100, v100, v67
v_min_f32 v104, v104, v67
v_max3_f32 v101, v68, v69, v70
v_min3_f32 v105, v68, v69, v70
v_max3_f32 v101, v101, v71, v72
v_min3_f32 v105, v105, v71, v72
v_max3_f32 v101, v101, v73, v74
v_min3_f32 v105, v105, v73, v74
v_max_f32 v101, v101, v75
v_min_f32 v105, v105, v75
v_max3_f32 v102, v76, v77, v78
v_min3_f32 v106, v76, v77, v78
v_max3_f32 v102, v102, v79, v80
v_min3_f32 v106, v106, v79, v80
v_max3_f32 v102, v102, v81, v82
v_min3_f32 v106, v106, v81, v82
v_max_f32 v102, v102, v83
v_min_f32 v106, v106, v83
v_max3_f32 v103, v84, v85, v86
v_min3_f32 v107, v84, v85, v86
v_max3_f32 v103, v103, v87, v88
v_min3_f32 v107, v107, v87, v88
v_max3_f32 v103, v103, v89, v90
v_min3_f32 v107, v107, v89, v90
v_max_f32 v103, v103, v91
v_min_f32 v107, v107, v91
s_nop 1
v_permlane32_swap_b32 v100, v101
v_permlane32_swap_b32 v102, v103
v_permlane32_swap_b32 v104, v105
v_permlane32_swap_b32 v106, v107
v_max_f32 v100, v100, v101
v_max_f32 v102, v102, v103
v_min_f32 v104, v104, v105
v_min_f32 v106, v106, v107
v_permlane16_swap_b32 v100, v102
s_nop 0
v_permlane16_swap_b32 v104, v106
v_max_f32 v100, v100, v102
v_min_f32 v104, v104, v106
v_mov_b32 v102, v100
v_mov_b32 v106, v104
s_nop 0
v_permlane16_swap_b32 v100, v102
v_permlane16_swap_b32 v104, v106
v_mov_b32 v101, v100
v_mov_b32 v103, v102
v_mov_b32 v105, v104
v_mov_b32 v107, v106
v_permlane32_swap_b32 v100, v101
v_permlane32_swap_b32 v102, v103
v_permlane32_swap_b32 v104, v105
v_permlane32_swap_b32 v106, v107
v_pk_mul_f32 v[100:101], v[100:101], v[128:129]
v_pk_mul_f32 v[102:103], v[102:103], v[130:131]
v_pk_mul_f32 v[104:105], v[104:105], v[128:129]
v_pk_mul_f32 v[106:107], v[106:107], v[130:131]
v_pk_fma_f32 v[220:221], v[60:61], v[128:129], v[104:105] op_sel:[0,0,0] op_sel_hi:[1,0,0] neg_lo:[1,0,0] neg_hi:[1,0,0]
v_pk_fma_f32 v[60:61], v[60:61], v[128:129], v[100:101] op_sel:[0,0,0] op_sel_hi:[1,0,0] neg_lo:[0,0,1] neg_hi:[0,0,1]
v_exp_f32 v220, v220
v_exp_f32 v60, v60
v_exp_f32 v221, v221
v_exp_f32 v61, v61
v_pk_fma_f32 v[222:223], v[62:63], v[128:129], v[104:105] op_sel:[0,0,0] op_sel_hi:[1,0,0] neg_lo:[1,0,0] neg_hi:[1,0,0]
v_pk_fma_f32 v[62:63], v[62:63], v[128:129], v[100:101] op_sel:[0,0,0] op_sel_hi:[1,0,0] neg_lo:[0,0,1] neg_hi:[0,0,1]
v_exp_f32 v222, v222
v_exp_f32 v62, v62
v_exp_f32 v223, v223
v_exp_f32 v63, v63
v_pk_fma_f32 v[224:225], v[64:65], v[128:129], v[104:105] op_sel:[0,0,0] op_sel_hi:[1,0,0] neg_lo:[1,0,0] neg_hi:[1,0,0]
v_pk_fma_f32 v[64:65], v[64:65], v[128:129], v[100:101] op_sel:[0,0,0] op_sel_hi:[1,0,0] neg_lo:[0,0,1] neg_hi:[0,0,1]
v_exp_f32 v224, v224
v_exp_f32 v64, v64
v_exp_f32 v225, v225
v_exp_f32 v65, v65
v_pk_fma_f32 v[226:227], v[66:67], v[128:129], v[104:105] op_sel:[0,0,0] op_sel_hi:[1,0,0] neg_lo:[1,0,0] neg_hi:[1,0,0]
v_pk_fma_f32 v[66:67], v[66:67], v[128:129], v[100:101] op_sel:[0,0,0] op_sel_hi:[1,0,0] neg_lo:[0,0,1] neg_hi:[0,0,1]
v_exp_f32 v226, v226
v_exp_f32 v66, v66
v_exp_f32 v227, v227
v_exp_f32 v67, v67
v_pk_fma_f32 v[228:229], v[68:69], v[128:129], v[104:105] op_sel:[0,1,1] op_sel_hi:[1,1,1] neg_lo:[1,0,0] neg_hi:[1,0,0]
v_pk_fma_f32 v[68:69], v[68:69], v[128:129], v[100:101] op_sel:[0,1,1] op_sel_hi:[1,1,1] neg_lo:[0,0,1] neg_hi:[0,0,1]
v_exp_f32 v228, v228
v_exp_f32 v68, v68
v_exp_f32 v229, v229
v_exp_f32 v69, v69
v_pk_fma_f32 v[230:231], v[70:71], v[128:129], v[104:105] op_sel:[0,1,1] op_sel_hi:[1,1,1] neg_lo:[1,0,0] neg_hi:[1,0,0]
v_pk_fma_f32 v[70:71], v[70:71], v[128:129], v[100:101] op_sel:[0,1,1] op_sel_hi:[1,1,1] neg_lo:[0,0,1] neg_hi:[0,0,1]
v_exp_f32 v230, v230
v_exp_f32 v70, v70
v_exp_f32 v231, v231
v_exp_f32 v71, v71
v_pk_fma_f32 v[232:233], v[72:73], v[128:129], v[104:105] op_sel:[0,1,1] op_sel_hi:[1,1,1] neg_lo:[1,0,0] neg_hi:[1,0,0]
v_pk_fma_f32 v[72:73], v[72:73], v[128:129], v[100:101] op_sel:[0,1,1] op_sel_hi:[1,1,1] neg_lo:[0,0,1] neg_hi:[0,0,1]
v_exp_f32 v232, v232
v_exp_f32 v72, v72
v_exp_f32 v233, v233
v_exp_f32 v73, v73
v_pk_fma_f32 v[234:235], v[74:75], v[128:129], v[104:105] op_sel:[0,1,1] op_sel_hi:[1,1,1] neg_lo:[1,0,0] neg_hi:[1,0,0]
v_pk_fma_f32 v[74:75], v[74:75], v[128:129], v[100:101] op_sel:[0,1,1] op_sel_hi:[1,1,1] neg_lo:[0,0,1] neg_hi:[0,0,1]
v_exp_f32 v234, v234
v_exp_f32 v74, v74
v_exp_f32 v235, v235
v_exp_f32 v75, v75
v_pk_fma_f32 v[236:237], v[76:77], v[130:131], v[106:107] op_sel:[0,0,0] op_sel_hi:[1,0,0] neg_lo:[1,0,0] neg_hi:[1,0,0]
v_pk_fma_f32 v[76:77], v[76:77], v[130:131], v[102:103] op_sel:[0,0,0] op_sel_hi:[1,0,0] neg_lo:[0,0,1] neg_hi:[0,0,1]
v_exp_f32 v236, v236
v_exp_f32 v76, v76
v_exp_f32 v237, v237
v_exp_f32 v77, v77
v_pk_fma_f32 v[238:239], v[78:79], v[130:131], v[106:107] op_sel:[0,0,0] op_sel_hi:[1,0,0] neg_lo:[1,0,0] neg_hi:[1,0,0]
v_pk_fma_f32 v[78:79], v[78:79], v[130:131], v[102:103] op_sel:[0,0,0] op_sel_hi:[1,0,0] neg_lo:[0,0,1] neg_hi:[0,0,1]
v_exp_f32 v238, v238
v_exp_f32 v78, v78
v_exp_f32 v239, v239
v_exp_f32 v79, v79
v_pk_fma_f32 v[240:241], v[80:81], v[130:131], v[106:107] op_sel:[0,0,0] op_sel_hi:[1,0,0] neg_lo:[1,0,0] neg_hi:[1,0,0]
v_pk_fma_f32 v[80:81], v[80:81], v[130:131], v[102:103] op_sel:[0,0,0] op_sel_hi:[1,0,0] neg_lo:[0,0,1] neg_hi:[0,0,1]
v_exp_f32 v240, v240
v_exp_f32 v80, v80
v_exp_f32 v241, v241
v_exp_f32 v81, v81
v_pk_fma_f32 v[242:243], v[82:83], v[130:131], v[106:107] op_sel:[0,0,0] op_sel_hi:[1,0,0] neg_lo:[1,0,0] neg_hi:[1,0,0]
v_pk_fma_f32 v[82:83], v[82:83], v[130:131], v[102:103] op_sel:[0,0,0] op_sel_hi:[1,0,0] neg_lo:[0,0,1] neg_hi:[0,0,1]
v_exp_f32 v242, v242
v_exp_f32 v82, v82
v_exp_f32 v243, v243
v_exp_f32 v83, v83
v_pk_fma_f32 v[244:245], v[84:85], v[130:131], v[106:107] op_sel:[0,1,1] op_sel_hi:[1,1,1] neg_lo:[1,0,0] neg_hi:[1,0,0]
v_pk_fma_f32 v[84:85], v[84:85], v[130:131], v[102:103] op_sel:[0,1,1] op_sel_hi:[1,1,1] neg_lo:[0,0,1] neg_hi:[0,0,1]
v_exp_f32 v244, v244
v_exp_f32 v84, v84
v_exp_f32 v245, v245
v_exp_f32 v85, v85
v_pk_fma_f32 v[246:247], v[86:87], v[130:131], v[106:107] op_sel:[0,1,1] op_sel_hi:[1,1,1] neg_lo:[1,0,0] neg_hi:[1,0,0]
v_pk_fma_f32 v[86:87], v[86:87], v[130:131], v[102:103] op_sel:[0,1,1] op_sel_hi:[1,1,1] neg_lo:[0,0,1] neg_hi:[0,0,1]
v_exp_f32 v246, v246
v_exp_f32 v86, v86
v_exp_f32 v247, v247
v_exp_f32 v87, v87
v_pk_fma_f32 v[248:249], v[88:89], v[130:131], v[106:107] op_sel:[0,1,1] op_sel_hi:[1,1,1] neg_lo:[1,0,0] neg_hi:[1,0,0]
v_pk_fma_f32 v[88:89], v[88:89], v[130:131], v[102:103] op_sel:[0,1,1] op_sel_hi:[1,1,1] neg_lo:[0,0,1] neg_hi:[0,0,1]
v_exp_f32 v248, v248
v_exp_f32 v88, v88
v_exp_f32 v249, v249
v_exp_f32 v89, v89
v_pk_fma_f32 v[250:251], v[90:91], v[130:131], v[106:107] op_sel:[0,1,1] op_sel_hi:[1,1,1] neg_lo:[1,0,0] neg_hi:[1,0,0]
v_pk_fma_f32 v[90:91], v[90:91], v[130:131], v[102:103] op_sel:[0,1,1] op_sel_hi:[1,1,1] neg_lo:[0,0,1] neg_hi:[0,0,1]
v_exp_f32 v250, v250
v_exp_f32 v90, v90
v_exp_f32 v251, v251
v_exp_f32 v91, v91
v_pk_add_f32 v[108:109], v[60:61], v[62:63]
v_pk_add_f32 v[110:111], v[220:221], v[222:223]
v_pk_add_f32 v[108:109], v[108:109], v[64:65]
v_pk_add_f32 v[110:111], v[110:111], v[224:225]
v_pk_add_f32 v[108:109], v[108:109], v[66:67]
v_pk_add_f32 v[110:111], v[110:111], v[226:227]
v_add_f32 v100, v108, v109
v_add_f32 v104, v110, v111
v_pk_add_f32 v[108:109], v[68:69], v[70:71]
v_pk_add_f32 v[110:111], v[228:229], v[230:231]
v_pk_add_f32 v[108:109], v[108:109], v[72:73]
v_pk_add_f32 v[110:111], v[110:111], v[232:233]
v_pk_add_f32 v[108:109], v[108:109], v[74:75]
v_pk_add_f32 v[110:111], v[110:111], v[234:235]
v_add_f32 v101, v108, v109
v_add_f32 v105, v110, v111
v_pk_add_f32 v[108:109], v[76:77], v[78:79]
v_pk_add_f32 v[110:111], v[236:237], v[238:239]
v_pk_add_f32 v[108:109], v[108:109], v[80:81]
v_pk_add_f32 v[110:111], v[110:111], v[240:241]
v_pk_add_f32 v[108:109], v[108:109], v[82:83]
v_pk_add_f32 v[110:111], v[110:111], v[242:243]
v_add_f32 v102, v108, v109
v_add_f32 v106, v110, v111
v_pk_add_f32 v[108:109], v[84:85], v[86:87]
v_pk_add_f32 v[110:111], v[244:245], v[246:247]
v_pk_add_f32 v[108:109], v[108:109], v[88:89]
v_pk_add_f32 v[110:111], v[110:111], v[248:249]
v_pk_add_f32 v[108:109], v[108:109], v[90:91]
v_pk_add_f32 v[110:111], v[110:111], v[250:251]
v_add_f32 v103, v108, v109
v_add_f32 v107, v110, v111
s_nop 1
v_permlane32_swap_b32 v100, v101
v_permlane32_swap_b32 v102, v103
v_permlane32_swap_b32 v104, v105
v_permlane32_swap_b32 v106, v107
v_add_f32 v100, v100, v101
v_add_f32 v102, v102, v103
v_add_f32 v104, v104, v105
v_add_f32 v106, v106, v107
v_permlane16_swap_b32 v100, v102
s_nop 0
v_permlane16_swap_b32 v104, v106
v_add_f32 v100, v100, v102
v_add_f32 v104, v104, v106
v_rcp_f32 v100, v100
v_rcp_f32 v104, v104
s_nop 0
v_mov_b32 v102, v100
v_mov_b32 v106, v104
s_nop 0
v_permlane16_swap_b32 v100, v102
v_permlane16_swap_b32 v104, v106
v_mov_b32 v101, v100
v_mov_b32 v103, v102
v_mov_b32 v105, v104
v_mov_b32 v107, v106
v_permlane32_swap_b32 v100, v101
v_permlane32_swap_b32 v102, v103
v_permlane32_swap_b32 v104, v105
v_permlane32_swap_b32 v106, v107
.p2align 3
v_pk_mul_f32 v[60:61], v[60:61], v[100:101] op_sel:[0,0] op_sel_hi:[1,0]
v_pk_mul_f32 v[62:63], v[62:63], v[100:101] op_sel:[0,0] op_sel_hi:[1,0]
v_pk_mul_f32 v[64:65], v[64:65], v[100:101] op_sel:[0,0] op_sel_hi:[1,0]
v_pk_mul_f32 v[66:67], v[66:67], v[100:101] op_sel:[0,0] op_sel_hi:[1,0]
v_pk_mul_f32 v[220:221], v[220:221], v[104:105] op_sel:[0,0] op_sel_hi:[1,0]
v_pk_mul_f32 v[222:223], v[222:223], v[104:105] op_sel:[0,0] op_sel_hi:[1,0]
v_pk_mul_f32 v[224:225], v[224:225], v[104:105] op_sel:[0,0] op_sel_hi:[1,0]
v_pk_mul_f32 v[226:227], v[226:227], v[104:105] op_sel:[0,0] op_sel_hi:[1,0]
v_cvt_pk_bf16_f32 v60, v60, v61
v_cvt_pk_bf16_f32 v61, v62, v63
v_cvt_pk_bf16_f32 v62, v64, v65
v_cvt_pk_bf16_f32 v63, v66, v67
v_cvt_pk_bf16_f32 v220, v220, v221
v_cvt_pk_bf16_f32 v221, v222, v223
v_cvt_pk_bf16_f32 v222, v224, v225
v_cvt_pk_bf16_f32 v223, v226, v227
v_pk_mul_f32 v[68:69], v[68:69], v[100:101] op_sel:[0,1] op_sel_hi:[1,1]
v_pk_mul_f32 v[70:71], v[70:71], v[100:101] op_sel:[0,1] op_sel_hi:[1,1]
v_pk_mul_f32 v[72:73], v[72:73], v[100:101] op_sel:[0,1] op_sel_hi:[1,1]
v_pk_mul_f32 v[74:75], v[74:75], v[100:101] op_sel:[0,1] op_sel_hi:[1,1]
v_pk_mul_f32 v[228:229], v[228:229], v[104:105] op_sel:[0,1] op_sel_hi:[1,1]
v_pk_mul_f32 v[230:231], v[230:231], v[104:105] op_sel:[0,1] op_sel_hi:[1,1]
v_pk_mul_f32 v[232:233], v[232:233], v[104:105] op_sel:[0,1] op_sel_hi:[1,1]
v_pk_mul_f32 v[234:235], v[234:235], v[104:105] op_sel:[0,1] op_sel_hi:[1,1]
v_cvt_pk_bf16_f32 v68, v68, v69
v_mfma_f32_16x16x32_bf16 v[204:207], v[60:63], v[38:41], 0
v_cvt_pk_bf16_f32 v69, v70, v71
v_cvt_pk_bf16_f32 v70, v72, v73
v_mfma_f32_16x16x32_bf16 v[208:211], v[60:63], v[36:39], 0
v_cvt_pk_bf16_f32 v71, v74, v75
v_cvt_pk_bf16_f32 v228, v228, v229
v_mfma_f32_16x16x32_bf16 v[212:215], v[220:223], v[38:41], 0
v_cvt_pk_bf16_f32 v229, v230, v231
v_cvt_pk_bf16_f32 v230, v232, v233
v_mfma_f32_16x16x32_bf16 v[216:219], v[220:223], v[36:39], 0
v_cvt_pk_bf16_f32 v231, v234, v235
v_pk_mul_f32 v[76:77], v[76:77], v[102:103] op_sel:[0,0] op_sel_hi:[1,0]
v_pk_mul_f32 v[78:79], v[78:79], v[102:103] op_sel:[0,0] op_sel_hi:[1,0]
v_pk_mul_f32 v[80:81], v[80:81], v[102:103] op_sel:[0,0] op_sel_hi:[1,0]
v_pk_mul_f32 v[82:83], v[82:83], v[102:103] op_sel:[0,0] op_sel_hi:[1,0]
v_pk_mul_f32 v[236:237], v[236:237], v[106:107] op_sel:[0,0] op_sel_hi:[1,0]
v_pk_mul_f32 v[238:239], v[238:239], v[106:107] op_sel:[0,0] op_sel_hi:[1,0]
v_pk_mul_f32 v[240:241], v[240:241], v[106:107] op_sel:[0,0] op_sel_hi:[1,0]
v_pk_mul_f32 v[242:243], v[242:243], v[106:107] op_sel:[0,0] op_sel_hi:[1,0]
v_cvt_pk_bf16_f32 v76, v76, v77
v_mfma_f32_16x16x32_bf16 v[188:191], v[68:71], v[38:41], 0
v_mfma_f32_16x16x32_bf16 v[192:195], v[68:71], v[36:39], 0
v_cvt_pk_bf16_f32 v77, v78, v79
v_mfma_f32_16x16x32_bf16 v[196:199], v[228:231], v[38:41], 0
v_cvt_pk_bf16_f32 v78, v80, v81
v_mfma_f32_16x16x32_bf16 v[200:203], v[228:231], v[36:39], 0
v_cvt_pk_bf16_f32 v64, v204, v205
v_cvt_pk_bf16_f32 v79, v82, v83
v_cvt_pk_bf16_f32 v65, v206, v207
v_cvt_pk_bf16_f32 v236, v236, v237
v_cvt_pk_bf16_f32 v72, v208, v209
v_cvt_pk_bf16_f32 v73, v210, v211
v_cvt_pk_bf16_f32 v237, v238, v239
v_cvt_pk_bf16_f32 v224, v212, v213
v_cvt_pk_bf16_f32 v238, v240, v241
v_cvt_pk_bf16_f32 v225, v214, v215
v_cvt_pk_bf16_f32 v232, v216, v217
v_cvt_pk_bf16_f32 v239, v242, v243
v_cvt_pk_bf16_f32 v233, v218, v219
v_pk_mul_f32 v[84:85], v[84:85], v[102:103] op_sel:[0,1] op_sel_hi:[1,1]
v_pk_mul_f32 v[86:87], v[86:87], v[102:103] op_sel:[0,1] op_sel_hi:[1,1]
v_pk_mul_f32 v[88:89], v[88:89], v[102:103] op_sel:[0,1] op_sel_hi:[1,1]
v_pk_mul_f32 v[90:91], v[90:91], v[102:103] op_sel:[0,1] op_sel_hi:[1,1]
v_pk_mul_f32 v[244:245], v[244:245], v[106:107] op_sel:[0,1] op_sel_hi:[1,1]
v_pk_mul_f32 v[246:247], v[246:247], v[106:107] op_sel:[0,1] op_sel_hi:[1,1]
v_pk_mul_f32 v[248:249], v[248:249], v[106:107] op_sel:[0,1] op_sel_hi:[1,1]
v_pk_mul_f32 v[250:251], v[250:251], v[106:107] op_sel:[0,1] op_sel_hi:[1,1]
v_cvt_pk_bf16_f32 v84, v84, v85
v_mfma_f32_16x16x32_bf16 v[204:207], v[76:79], v[38:41], 0
v_mfma_f32_16x16x32_bf16 v[208:211], v[76:79], v[36:39], 0
v_cvt_pk_bf16_f32 v85, v86, v87
v_mfma_f32_16x16x32_bf16 v[212:215], v[236:239], v[38:41], 0
v_cvt_pk_bf16_f32 v86, v88, v89
v_mfma_f32_16x16x32_bf16 v[216:219], v[236:239], v[36:39], 0
v_cvt_pk_bf16_f32 v66, v188, v189
v_cvt_pk_bf16_f32 v87, v90, v91
v_cvt_pk_bf16_f32 v67, v190, v191
v_cvt_pk_bf16_f32 v244, v244, v245
v_cvt_pk_bf16_f32 v74, v192, v193
v_cvt_pk_bf16_f32 v75, v194, v195
v_cvt_pk_bf16_f32 v245, v246, v247
v_cvt_pk_bf16_f32 v226, v196, v197
v_cvt_pk_bf16_f32 v246, v248, v249
v_cvt_pk_bf16_f32 v227, v198, v199
v_cvt_pk_bf16_f32 v234, v200, v201
v_cvt_pk_bf16_f32 v247, v250, v251
v_cvt_pk_bf16_f32 v235, v202, v203
v_mov_b32 v5, 2
v_cmp_eq_u32 s[50:51], s41, v2
v_mfma_f32_16x16x32_bf16 v[188:191], v[84:87], v[38:41], 0
v_mfma_f32_16x16x32_bf16 v[192:195], v[84:87], v[36:39], 0
v_mfma_f32_16x16x32_bf16 v[196:199], v[244:247], v[38:41], 0
v_mfma_f32_16x16x32_bf16 v[200:203], v[244:247], v[36:39], 0
v_mfma_f32_16x16x32_bf16 v[152:155], v[224:227], v[112:115], 0
v_cvt_pk_bf16_f32 v80, v204, v205
v_cvt_pk_bf16_f32 v81, v206, v207
v_mfma_f32_16x16x32_bf16 v[60:63], v[232:235], v[112:115], 0
v_cvt_pk_bf16_f32 v88, v208, v209
v_mfma_f32_16x16x32_bf16 v[68:71], v[224:227], v[120:123], 0
v_cvt_pk_bf16_f32 v89, v210, v211
v_mfma_f32_16x16x32_bf16 v[220:223], v[232:235], v[120:123], 0
v_cvt_pk_bf16_f32 v240, v212, v213
v_cvt_pk_bf16_f32 v241, v214, v215
v_mfma_f32_16x16x32_bf16 v[228:231], v[224:227], v[48:51], 0
v_cvt_pk_bf16_f32 v248, v216, v217
v_mfma_f32_16x16x32_bf16 v[76:79], v[232:235], v[48:51], 0
v_cvt_pk_bf16_f32 v249, v218, v219
v_mfma_f32_16x16x32_bf16 v[100:103], v[64:67], v[112:115], 0
v_cvt_pk_bf16_f32 v82, v188, v189
v_cvt_pk_bf16_f32 v83, v190, v191
v_mfma_f32_16x16x32_bf16 v[104:107], v[72:75], v[112:115], 0
v_cvt_pk_bf16_f32 v90, v192, v193
v_mfma_f32_16x16x32_bf16 v[108:111], v[64:67], v[120:123], 0
v_cvt_pk_bf16_f32 v91, v194, v195
v_mfma_f32_16x16x32_bf16 v[132:135], v[72:75], v[120:123], 0
v_cvt_pk_bf16_f32 v242, v196, v197
v_cvt_pk_bf16_f32 v243, v198, v199
v_mfma_f32_16x16x32_bf16 v[136:139], v[64:67], v[48:51], 0
v_cvt_pk_bf16_f32 v250, v200, v201
v_mfma_f32_16x16x32_bf16 v[148:151], v[72:75], v[48:51], 0
v_cvt_pk_bf16_f32 v251, v202, v203
s_nop 1
v_mfma_f32_16x16x32_bf16 v[152:155], v[240:243], v[116:119], v[152:155]
v_mfma_f32_16x16x32_bf16 v[60:63], v[248:251], v[116:119], v[60:63]
v_mfma_f32_16x16x32_bf16 v[68:71], v[240:243], v[124:127], v[68:71]
v_mfma_f32_16x16x32_bf16 v[220:223], v[248:251], v[124:127], v[220:223]
v_mfma_f32_16x16x32_bf16 v[228:231], v[240:243], v[48:51], v[228:231]
v_mfma_f32_16x16x32_bf16 v[76:79], v[248:251], v[48:51], v[76:79]
v_mfma_f32_16x16x32_bf16 v[100:103], v[80:83], v[116:119], v[100:103]
v_mfma_f32_16x16x32_bf16 v[104:107], v[88:91], v[116:119], v[104:107]
v_mfma_f32_16x16x32_bf16 v[108:111], v[80:83], v[124:127], v[108:111]
v_mfma_f32_16x16x32_bf16 v[132:135], v[88:91], v[124:127], v[132:135]
v_cvt_pk_bf16_f32 v152, v152, v153
v_cvt_pk_bf16_f32 v153, v154, v155
v_mfma_f32_16x16x32_bf16 v[136:139], v[80:83], v[48:51], v[136:139]
v_cvt_pk_bf16_f32 v154, v60, v61
v_cvt_pk_bf16_f32 v155, v62, v63
v_mfma_f32_16x16x32_bf16 v[148:151], v[88:91], v[48:51], v[148:151]
ds_write_b128 v42, v[152:155] offset:0
v_cvt_pk_bf16_f32 v68, v68, v69
v_cvt_pk_bf16_f32 v69, v70, v71
v_cvt_pk_bf16_f32 v70, v220, v221
v_cvt_pk_bf16_f32 v71, v222, v223
ds_write_b128 v42, v[68:71] offset:1024
v_cvt_pk_bf16_f32 v228, v228, v229
v_cvt_pk_bf16_f32 v229, v230, v231
v_cvt_pk_bf16_f32 v230, v76, v77
v_cvt_pk_bf16_f32 v231, v78, v79
ds_write_b128 v42, v[228:231] offset:2048
ds_write_b32 v52, v5
s_mov_b32 s63, 0
px_83:
ds_read_b32 v4, v19
ds_read_b128 v[188:191], v43 offset:0
ds_read_b128 v[192:195], v43 offset:1024
ds_read_b128 v[196:199], v43 offset:2048
s_add_u32 s63, s63, 1
s_cmp_lt_u32 s63, 0x400000
s_waitcnt lgkmcnt(0)
v_cmp_ne_u32 vcc, 2, v4
s_cbranch_vccz pxd_84
s_cbranch_scc1 px_83
pxd_84:
v_mfma_f32_16x16x32_bf16 v[100:103], v[38:41], v[188:191], v[100:103]
v_mfma_f32_16x16x32_bf16 v[104:107], v[36:39], v[188:191], v[104:107]
v_mfma_f32_16x16x32_bf16 v[108:111], v[38:41], v[192:195], v[108:111]
v_mfma_f32_16x16x32_bf16 v[132:135], v[36:39], v[192:195], v[132:135]
v_mfma_f32_16x16x32_bf16 v[136:139], v[38:41], v[196:199], v[136:139]
v_mfma_f32_16x16x32_bf16 v[148:151], v[36:39], v[196:199], v[148:151]
s_nop 2
v_cvt_pk_bf16_f32 v100, v100, v101
v_cvt_pk_bf16_f32 v101, v102, v103
v_cvt_pk_bf16_f32 v102, v104, v105
v_cvt_pk_bf16_f32 v103, v106, v107
buffer_store_dwordx4 v[100:103], v55, s[32:35], s53 offen sc1
v_cvt_pk_bf16_f32 v108, v108, v109
v_cvt_pk_bf16_f32 v109, v110, v111
v_cvt_pk_bf16_f32 v110, v132, v133
v_cvt_pk_bf16_f32 v111, v134, v135
buffer_store_dwordx4 v[108:111], v55, s[32:35], s54 offen sc1
v_cvt_pk_bf16_f32 v136, v136, v137
v_cvt_pk_bf16_f32 v137, v138, v139
v_cvt_pk_bf16_f32 v138, v148, v149
v_cvt_pk_bf16_f32 v139, v150, v151
s_mov_b64 exec, s[50:51]
buffer_store_dwordx4 v[136:139], v58, s[32:35], s56 offen sc1
s_mov_b64 exec, -1
s_mov_b32 s51, 0
.p2align 3
v_pk_fma_f32 v[156:157], v[140:141], v[92:93], v[156:157] op_sel:[0,1,0] op_sel_hi:[1,1,1]
v_pk_fma_f32 v[158:159], v[142:143], v[92:93], v[158:159] op_sel:[0,1,0] op_sel_hi:[1,1,1]
v_pk_fma_f32 v[160:161], v[144:145], v[92:93], v[160:161] op_sel:[0,1,0] op_sel_hi:[1,1,1]
v_pk_fma_f32 v[162:163], v[146:147], v[92:93], v[162:163] op_sel:[0,1,0] op_sel_hi:[1,1,1]
v_cvt_pk_bf16_f32 v156, v156, v157
v_cvt_pk_bf16_f32 v157, v158, v159
v_cvt_pk_bf16_f32 v158, v160, v161
v_cvt_pk_bf16_f32 v159, v162, v163
v_pk_fma_f32 v[164:165], v[140:141], v[94:95], v[164:165] op_sel:[0,1,0] op_sel_hi:[1,1,1]
v_pk_fma_f32 v[166:167], v[142:143], v[94:95], v[166:167] op_sel:[0,1,0] op_sel_hi:[1,1,1]
v_pk_fma_f32 v[168:169], v[144:145], v[94:95], v[168:169] op_sel:[0,1,0] op_sel_hi:[1,1,1]
v_pk_fma_f32 v[170:171], v[146:147], v[94:95], v[170:171] op_sel:[0,1,0] op_sel_hi:[1,1,1]
v_cvt_pk_bf16_f32 v164, v164, v165
v_mfma_f32_16x16x32_bf16 v[60:63], v[10:13], v[156:159], 0
v_cvt_pk_bf16_f32 v165, v166, v167
v_cvt_pk_bf16_f32 v166, v168, v169
v_mfma_f32_16x16x32_bf16 v[64:67], v[14:17], v[156:159], 0
v_cvt_pk_bf16_f32 v167, v170, v171
v_pk_fma_f32 v[172:173], v[140:141], v[96:97], v[172:173] op_sel:[0,1,0] op_sel_hi:[1,1,1]
v_pk_fma_f32 v[174:175], v[142:143], v[96:97], v[174:175] op_sel:[0,1,0] op_sel_hi:[1,1,1]
v_pk_fma_f32 v[176:177], v[144:145], v[96:97], v[176:177] op_sel:[0,1,0] op_sel_hi:[1,1,1]
v_pk_fma_f32 v[178:179], v[146:147], v[96:97], v[178:179] op_sel:[0,1,0] op_sel_hi:[1,1,1]
v_cvt_pk_bf16_f32 v172, v172, v173
v_mfma_f32_16x16x32_bf16 v[68:71], v[10:13], v[164:167], 0
v_cvt_pk_bf16_f32 v173, v174, v175
v_cvt_pk_bf16_f32 v174, v176, v177
v_mfma_f32_16x16x32_bf16 v[72:75], v[14:17], v[164:167], 0
v_cvt_pk_bf16_f32 v175, v178, v179
v_pk_fma_f32 v[180:181], v[140:141], v[98:99], v[180:181] op_sel:[0,1,0] op_sel_hi:[1,1,1]
v_pk_fma_f32 v[182:183], v[142:143], v[98:99], v[182:183] op_sel:[0,1,0] op_sel_hi:[1,1,1]
v_pk_fma_f32 v[184:185], v[144:145], v[98:99], v[184:185] op_sel:[0,1,0] op_sel_hi:[1,1,1]
v_pk_fma_f32 v[186:187], v[146:147], v[98:99], v[186:187] op_sel:[0,1,0] op_sel_hi:[1,1,1]
v_cvt_pk_bf16_f32 v180, v180, v181
v_mfma_f32_16x16x32_bf16 v[76:79], v[10:13], v[172:175], 0
v_cvt_pk_bf16_f32 v181, v182, v183
v_cvt_pk_bf16_f32 v182, v184, v185
v_mfma_f32_16x16x32_bf16 v[80:83], v[14:17], v[172:175], 0
v_cvt_pk_bf16_f32 v183, v186, v187
s_nop 1
v_mfma_f32_16x16x32_bf16 v[84:87], v[10:13], v[180:183], 0
v_mfma_f32_16x16x32_bf16 v[88:91], v[14:17], v[180:183], 0
v_max3_f32 v100, v60, v61, v62
v_min3_f32 v104, v60, v61, v62
v_max3_f32 v100, v100, v63, v64
v_min3_f32 v104, v104, v63, v64
v_max3_f32 v100, v100, v65, v66
v_min3_f32 v104, v104, v65, v66
v_max_f32 v100, v100, v67
v_min_f32 v104, v104, v67
v_max3_f32 v101, v68, v69, v70
v_min3_f32 v105, v68, v69, v70
v_max3_f32 v101, v101, v71, v72
v_min3_f32 v105, v105, v71, v72
v_max3_f32 v101, v101, v73, v74
v_min3_f32 v105, v105, v73, v74
v_max_f32 v101, v101, v75
v_min_f32 v105, v105, v75
v_max3_f32 v102, v76, v77, v78
v_min3_f32 v106, v76, v77, v78
v_max3_f32 v102, v102, v79, v80
v_min3_f32 v106, v106, v79, v80
v_max3_f32 v102, v102, v81, v82
v_min3_f32 v106, v106, v81, v82
v_max_f32 v102, v102, v83
v_min_f32 v106, v106, v83
v_max3_f32 v103, v84, v85, v86
v_min3_f32 v107, v84, v85, v86
v_max3_f32 v103, v103, v87, v88
v_min3_f32 v107, v107, v87, v88
v_max3_f32 v103, v103, v89, v90
v_min3_f32 v107, v107, v89, v90
v_max_f32 v103, v103, v91
v_min_f32 v107, v107, v91
s_nop 1
v_permlane32_swap_b32 v100, v101
v_permlane32_swap_b32 v102, v103
v_permlane32_swap_b32 v104, v105
v_permlane32_swap_b32 v106, v107
v_max_f32 v100, v100, v101
v_max_f32 v102, v102, v103
v_min_f32 v104, v104, v105
v_min_f32 v106, v106, v107
v_permlane16_swap_b32 v100, v102
s_nop 0
v_permlane16_swap_b32 v104, v106
v_max_f32 v100, v100, v102
v_min_f32 v104, v104, v106
v_mov_b32 v102, v100
v_mov_b32 v106, v104
s_nop 0
v_permlane16_swap_b32 v100, v102
v_permlane16_swap_b32 v104, v106
v_mov_b32 v101, v100
v_mov_b32 v103, v102
v_mov_b32 v105, v104
v_mov_b32 v107, v106
v_permlane32_swap_b32 v100, v101
v_permlane32_swap_b32 v102, v103
v_permlane32_swap_b32 v104, v105
v_permlane32_swap_b32 v106, v107
v_pk_mul_f32 v[100:101], v[100:101], v[128:129]
v_pk_mul_f32 v[102:103], v[102:103], v[130:131]
v_pk_mul_f32 v[104:105], v[104:105], v[128:129]
v_pk_mul_f32 v[106:107], v[106:107], v[130:131]
v_pk_fma_f32 v[220:221], v[60:61], v[128:129], v[104:105] op_sel:[0,0,0] op_sel_hi:[1,0,0] neg_lo:[1,0,0] neg_hi:[1,0,0]
v_pk_fma_f32 v[60:61], v[60:61], v[128:129], v[100:101] op_sel:[0,0,0] op_sel_hi:[1,0,0] neg_lo:[0,0,1] neg_hi:[0,0,1]
v_exp_f32 v220, v220
v_exp_f32 v60, v60
v_exp_f32 v221, v221
v_exp_f32 v61, v61
v_pk_fma_f32 v[222:223], v[62:63], v[128:129], v[104:105] op_sel:[0,0,0] op_sel_hi:[1,0,0] neg_lo:[1,0,0] neg_hi:[1,0,0]
v_pk_fma_f32 v[62:63], v[62:63], v[128:129], v[100:101] op_sel:[0,0,0] op_sel_hi:[1,0,0] neg_lo:[0,0,1] neg_hi:[0,0,1]
v_exp_f32 v222, v222
v_exp_f32 v62, v62
v_exp_f32 v223, v223
v_exp_f32 v63, v63
v_pk_fma_f32 v[224:225], v[64:65], v[128:129], v[104:105] op_sel:[0,0,0] op_sel_hi:[1,0,0] neg_lo:[1,0,0] neg_hi:[1,0,0]
v_pk_fma_f32 v[64:65], v[64:65], v[128:129], v[100:101] op_sel:[0,0,0] op_sel_hi:[1,0,0] neg_lo:[0,0,1] neg_hi:[0,0,1]
v_exp_f32 v224, v224
v_exp_f32 v64, v64
v_exp_f32 v225, v225
v_exp_f32 v65, v65
v_pk_fma_f32 v[226:227], v[66:67], v[128:129], v[104:105] op_sel:[0,0,0] op_sel_hi:[1,0,0] neg_lo:[1,0,0] neg_hi:[1,0,0]
v_pk_fma_f32 v[66:67], v[66:67], v[128:129], v[100:101] op_sel:[0,0,0] op_sel_hi:[1,0,0] neg_lo:[0,0,1] neg_hi:[0,0,1]
v_exp_f32 v226, v226
v_exp_f32 v66, v66
v_exp_f32 v227, v227
v_exp_f32 v67, v67
v_pk_fma_f32 v[228:229], v[68:69], v[128:129], v[104:105] op_sel:[0,1,1] op_sel_hi:[1,1,1] neg_lo:[1,0,0] neg_hi:[1,0,0]
v_pk_fma_f32 v[68:69], v[68:69], v[128:129], v[100:101] op_sel:[0,1,1] op_sel_hi:[1,1,1] neg_lo:[0,0,1] neg_hi:[0,0,1]
v_exp_f32 v228, v228
v_exp_f32 v68, v68
v_exp_f32 v229, v229
v_exp_f32 v69, v69
v_pk_fma_f32 v[230:231], v[70:71], v[128:129], v[104:105] op_sel:[0,1,1] op_sel_hi:[1,1,1] neg_lo:[1,0,0] neg_hi:[1,0,0]
v_pk_fma_f32 v[70:71], v[70:71], v[128:129], v[100:101] op_sel:[0,1,1] op_sel_hi:[1,1,1] neg_lo:[0,0,1] neg_hi:[0,0,1]
v_exp_f32 v230, v230
v_exp_f32 v70, v70
v_exp_f32 v231, v231
v_exp_f32 v71, v71
v_pk_fma_f32 v[232:233], v[72:73], v[128:129], v[104:105] op_sel:[0,1,1] op_sel_hi:[1,1,1] neg_lo:[1,0,0] neg_hi:[1,0,0]
v_pk_fma_f32 v[72:73], v[72:73], v[128:129], v[100:101] op_sel:[0,1,1] op_sel_hi:[1,1,1] neg_lo:[0,0,1] neg_hi:[0,0,1]
v_exp_f32 v232, v232
v_exp_f32 v72, v72
v_exp_f32 v233, v233
v_exp_f32 v73, v73
v_pk_fma_f32 v[234:235], v[74:75], v[128:129], v[104:105] op_sel:[0,1,1] op_sel_hi:[1,1,1] neg_lo:[1,0,0] neg_hi:[1,0,0]
v_pk_fma_f32 v[74:75], v[74:75], v[128:129], v[100:101] op_sel:[0,1,1] op_sel_hi:[1,1,1] neg_lo:[0,0,1] neg_hi:[0,0,1]
v_exp_f32 v234, v234
v_exp_f32 v74, v74
v_exp_f32 v235, v235
v_exp_f32 v75, v75
buffer_load_dwordx4 v[212:215], v18, s[32:35], s55 offen offset:0 sc1
buffer_load_dwordx4 v[216:219], v18, s[32:35], s55 offen offset:1024 sc1
v_pk_fma_f32 v[236:237], v[76:77], v[130:131], v[106:107] op_sel:[0,0,0] op_sel_hi:[1,0,0] neg_lo:[1,0,0] neg_hi:[1,0,0]
v_pk_fma_f32 v[76:77], v[76:77], v[130:131], v[102:103] op_sel:[0,0,0] op_sel_hi:[1,0,0] neg_lo:[0,0,1] neg_hi:[0,0,1]
v_exp_f32 v236, v236
v_exp_f32 v76, v76
v_exp_f32 v237, v237
v_exp_f32 v77, v77
v_pk_fma_f32 v[238:239], v[78:79], v[130:131], v[106:107] op_sel:[0,0,0] op_sel_hi:[1,0,0] neg_lo:[1,0,0] neg_hi:[1,0,0]
v_pk_fma_f32 v[78:79], v[78:79], v[130:131], v[102:103] op_sel:[0,0,0] op_sel_hi:[1,0,0] neg_lo:[0,0,1] neg_hi:[0,0,1]
v_exp_f32 v238, v238
v_exp_f32 v78, v78
v_exp_f32 v239, v239
v_exp_f32 v79, v79
v_pk_fma_f32 v[240:241], v[80:81], v[130:131], v[106:107] op_sel:[0,0,0] op_sel_hi:[1,0,0] neg_lo:[1,0,0] neg_hi:[1,0,0]
v_pk_fma_f32 v[80:81], v[80:81], v[130:131], v[102:103] op_sel:[0,0,0] op_sel_hi:[1,0,0] neg_lo:[0,0,1] neg_hi:[0,0,1]
v_exp_f32 v240, v240
v_exp_f32 v80, v80
v_exp_f32 v241, v241
v_exp_f32 v81, v81
v_pk_fma_f32 v[242:243], v[82:83], v[130:131], v[106:107] op_sel:[0,0,0] op_sel_hi:[1,0,0] neg_lo:[1,0,0] neg_hi:[1,0,0]
v_pk_fma_f32 v[82:83], v[82:83], v[130:131], v[102:103] op_sel:[0,0,0] op_sel_hi:[1,0,0] neg_lo:[0,0,1] neg_hi:[0,0,1]
v_exp_f32 v242, v242
v_exp_f32 v82, v82
v_exp_f32 v243, v243
v_exp_f32 v83, v83
v_pk_fma_f32 v[244:245], v[84:85], v[130:131], v[106:107] op_sel:[0,1,1] op_sel_hi:[1,1,1] neg_lo:[1,0,0] neg_hi:[1,0,0]
v_pk_fma_f32 v[84:85], v[84:85], v[130:131], v[102:103] op_sel:[0,1,1] op_sel_hi:[1,1,1] neg_lo:[0,0,1] neg_hi:[0,0,1]
v_exp_f32 v244, v244
v_exp_f32 v84, v84
v_exp_f32 v245, v245
v_exp_f32 v85, v85
v_pk_fma_f32 v[246:247], v[86:87], v[130:131], v[106:107] op_sel:[0,1,1] op_sel_hi:[1,1,1] neg_lo:[1,0,0] neg_hi:[1,0,0]
v_pk_fma_f32 v[86:87], v[86:87], v[130:131], v[102:103] op_sel:[0,1,1] op_sel_hi:[1,1,1] neg_lo:[0,0,1] neg_hi:[0,0,1]
v_exp_f32 v246, v246
v_exp_f32 v86, v86
v_exp_f32 v247, v247
v_exp_f32 v87, v87
v_pk_fma_f32 v[248:249], v[88:89], v[130:131], v[106:107] op_sel:[0,1,1] op_sel_hi:[1,1,1] neg_lo:[1,0,0] neg_hi:[1,0,0]
v_pk_fma_f32 v[88:89], v[88:89], v[130:131], v[102:103] op_sel:[0,1,1] op_sel_hi:[1,1,1] neg_lo:[0,0,1] neg_hi:[0,0,1]
v_exp_f32 v248, v248
v_exp_f32 v88, v88
v_exp_f32 v249, v249
v_exp_f32 v89, v89
v_pk_fma_f32 v[250:251], v[90:91], v[130:131], v[106:107] op_sel:[0,1,1] op_sel_hi:[1,1,1] neg_lo:[1,0,0] neg_hi:[1,0,0]
v_pk_fma_f32 v[90:91], v[90:91], v[130:131], v[102:103] op_sel:[0,1,1] op_sel_hi:[1,1,1] neg_lo:[0,0,1] neg_hi:[0,0,1]
v_exp_f32 v250, v250
v_exp_f32 v90, v90
v_exp_f32 v251, v251
v_exp_f32 v91, v91
v_pk_add_f32 v[108:109], v[60:61], v[62:63]
v_pk_add_f32 v[110:111], v[220:221], v[222:223]
v_pk_add_f32 v[108:109], v[108:109], v[64:65]
v_pk_add_f32 v[110:111], v[110:111], v[224:225]
v_pk_add_f32 v[108:109], v[108:109], v[66:67]
v_pk_add_f32 v[110:111], v[110:111], v[226:227]
v_add_f32 v100, v108, v109
v_add_f32 v104, v110, v111
v_pk_add_f32 v[108:109], v[68:69], v[70:71]
v_pk_add_f32 v[110:111], v[228:229], v[230:231]
v_pk_add_f32 v[108:109], v[108:109], v[72:73]
v_pk_add_f32 v[110:111], v[110:111], v[232:233]
v_pk_add_f32 v[108:109], v[108:109], v[74:75]
v_pk_add_f32 v[110:111], v[110:111], v[234:235]
v_add_f32 v101, v108, v109
v_add_f32 v105, v110, v111
v_pk_add_f32 v[108:109], v[76:77], v[78:79]
v_pk_add_f32 v[110:111], v[236:237], v[238:239]
v_pk_add_f32 v[108:109], v[108:109], v[80:81]
v_pk_add_f32 v[110:111], v[110:111], v[240:241]
v_pk_add_f32 v[108:109], v[108:109], v[82:83]
v_pk_add_f32 v[110:111], v[110:111], v[242:243]
v_add_f32 v102, v108, v109
v_add_f32 v106, v110, v111
v_pk_add_f32 v[108:109], v[84:85], v[86:87]
v_pk_add_f32 v[110:111], v[244:245], v[246:247]
v_pk_add_f32 v[108:109], v[108:109], v[88:89]
v_pk_add_f32 v[110:111], v[110:111], v[248:249]
v_pk_add_f32 v[108:109], v[108:109], v[90:91]
v_pk_add_f32 v[110:111], v[110:111], v[250:251]
v_add_f32 v103, v108, v109
v_add_f32 v107, v110, v111
s_cmp_eq_u32 s51, 1
s_cbranch_scc1 chk_85
s_waitcnt vmcnt(0)
v_max_u32 v4, v212, v213
v_max3_u32 v4, v4, v214, v215
v_max3_u32 v4, v4, v216, v217
v_max3_u32 v4, v4, v218, v219
v_cmp_eq_u32 vcc, -1, v4
s_cbranch_vccz red_86
buffer_load_dwordx4 v[212:215], v18, s[32:35], s55 offen offset:0 sc1
buffer_load_dwordx4 v[216:219], v18, s[32:35], s55 offen offset:1024 sc1
s_branch chk_85
red_86:
v_mfma_f32_16x16x32_bf16 v[132:135], v[44:47], v[212:215], 0
v_mfma_f32_16x16x32_bf16 v[132:135], v[44:47], v[216:219], v[132:135]
s_mov_b32 s51, 1
s_nop 6
v_add_f32_dpp v132, v132, v132 row_ror:8 row_mask:0xf bank_mask:0xf
v_add_f32_dpp v133, v133, v133 row_ror:8 row_mask:0xf bank_mask:0xf
v_add_f32_dpp v134, v134, v134 row_ror:8 row_mask:0xf bank_mask:0xf
v_add_f32_dpp v135, v135, v135 row_ror:8 row_mask:0xf bank_mask:0xf
v_cvt_pk_bf16_f32 v132, v132, v133
v_cvt_pk_bf16_f32 v133, v134, v135
s_mov_b64 exec, 0x00ff00ff
buffer_store_dwordx2 v[132:133], v59, s[32:35], s79 offen sc1
s_mov_b64 exec, -1
buffer_load_dwordx4 v[204:207], v58, s[32:35], s56 offen sc1
buffer_load_dwordx4 v[208:211], v58, s[32:35], s57 offen sc1
chk_85:
s_nop 1
v_permlane32_swap_b32 v100, v101
v_permlane32_swap_b32 v102, v103
v_permlane32_swap_b32 v104, v105
v_permlane32_swap_b32 v106, v107
v_add_f32 v100, v100, v101
v_add_f32 v102, v102, v103
v_add_f32 v104, v104, v105
v_add_f32 v106, v106, v107
v_permlane16_swap_b32 v100, v102
s_nop 0
v_permlane16_swap_b32 v104, v106
v_add_f32 v100, v100, v102
v_add_f32 v104, v104, v106
v_rcp_f32 v100, v100
v_rcp_f32 v104, v104
s_nop 0
v_mov_b32 v102, v100
v_mov_b32 v106, v104
s_nop 0
v_permlane16_swap_b32 v100, v102
v_permlane16_swap_b32 v104, v106
v_mov_b32 v101, v100
v_mov_b32 v103, v102
v_mov_b32 v105, v104
v_mov_b32 v107, v106
v_permlane32_swap_b32 v100, v101
v_permlane32_swap_b32 v102, v103
v_permlane32_swap_b32 v104, v105
v_permlane32_swap_b32 v106, v107
.p2align 3
v_pk_mul_f32 v[60:61], v[60:61], v[100:101] op_sel:[0,0] op_sel_hi:[1,0]
v_pk_mul_f32 v[62:63], v[62:63], v[100:101] op_sel:[0,0] op_sel_hi:[1,0]
v_pk_mul_f32 v[64:65], v[64:65], v[100:101] op_sel:[0,0] op_sel_hi:[1,0]
v_pk_mul_f32 v[66:67], v[66:67], v[100:101] op_sel:[0,0] op_sel_hi:[1,0]
v_pk_mul_f32 v[220:221], v[220:221], v[104:105] op_sel:[0,0] op_sel_hi:[1,0]
v_pk_mul_f32 v[222:223], v[222:223], v[104:105] op_sel:[0,0] op_sel_hi:[1,0]
v_pk_mul_f32 v[224:225], v[224:225], v[104:105] op_sel:[0,0] op_sel_hi:[1,0]
v_pk_mul_f32 v[226:227], v[226:227], v[104:105] op_sel:[0,0] op_sel_hi:[1,0]
v_cvt_pk_bf16_f32 v60, v60, v61
v_cvt_pk_bf16_f32 v61, v62, v63
v_cvt_pk_bf16_f32 v62, v64, v65
v_cvt_pk_bf16_f32 v63, v66, v67
v_cvt_pk_bf16_f32 v220, v220, v221
v_cvt_pk_bf16_f32 v221, v222, v223
v_cvt_pk_bf16_f32 v222, v224, v225
v_cvt_pk_bf16_f32 v223, v226, v227
v_pk_mul_f32 v[68:69], v[68:69], v[100:101] op_sel:[0,1] op_sel_hi:[1,1]
v_pk_mul_f32 v[70:71], v[70:71], v[100:101] op_sel:[0,1] op_sel_hi:[1,1]
v_pk_mul_f32 v[72:73], v[72:73], v[100:101] op_sel:[0,1] op_sel_hi:[1,1]
v_pk_mul_f32 v[74:75], v[74:75], v[100:101] op_sel:[0,1] op_sel_hi:[1,1]
v_pk_mul_f32 v[228:229], v[228:229], v[104:105] op_sel:[0,1] op_sel_hi:[1,1]
v_pk_mul_f32 v[230:231], v[230:231], v[104:105] op_sel:[0,1] op_sel_hi:[1,1]
v_pk_mul_f32 v[232:233], v[232:233], v[104:105] op_sel:[0,1] op_sel_hi:[1,1]
v_pk_mul_f32 v[234:235], v[234:235], v[104:105] op_sel:[0,1] op_sel_hi:[1,1]
v_cvt_pk_bf16_f32 v68, v68, v69
v_cvt_pk_bf16_f32 v69, v70, v71
v_cvt_pk_bf16_f32 v70, v72, v73
v_cvt_pk_bf16_f32 v71, v74, v75
v_cvt_pk_bf16_f32 v228, v228, v229
v_cvt_pk_bf16_f32 v229, v230, v231
v_cvt_pk_bf16_f32 v230, v232, v233
v_cvt_pk_bf16_f32 v231, v234, v235
v_pk_mul_f32 v[76:77], v[76:77], v[102:103] op_sel:[0,0] op_sel_hi:[1,0]
v_pk_mul_f32 v[78:79], v[78:79], v[102:103] op_sel:[0,0] op_sel_hi:[1,0]
v_pk_mul_f32 v[80:81], v[80:81], v[102:103] op_sel:[0,0] op_sel_hi:[1,0]
v_pk_mul_f32 v[82:83], v[82:83], v[102:103] op_sel:[0,0] op_sel_hi:[1,0]
v_pk_mul_f32 v[236:237], v[236:237], v[106:107] op_sel:[0,0] op_sel_hi:[1,0]
v_pk_mul_f32 v[238:239], v[238:239], v[106:107] op_sel:[0,0] op_sel_hi:[1,0]
v_pk_mul_f32 v[240:241], v[240:241], v[106:107] op_sel:[0,0] op_sel_hi:[1,0]
v_pk_mul_f32 v[242:243], v[242:243], v[106:107] op_sel:[0,0] op_sel_hi:[1,0]
v_cvt_pk_bf16_f32 v76, v76, v77
v_cvt_pk_bf16_f32 v77, v78, v79
v_cvt_pk_bf16_f32 v78, v80, v81
v_cvt_pk_bf16_f32 v79, v82, v83
v_cvt_pk_bf16_f32 v236, v236, v237
v_cvt_pk_bf16_f32 v237, v238, v239
v_cvt_pk_bf16_f32 v238, v240, v241
v_cvt_pk_bf16_f32 v239, v242, v243
v_pk_mul_f32 v[84:85], v[84:85], v[102:103] op_sel:[0,1] op_sel_hi:[1,1]
v_pk_mul_f32 v[86:87], v[86:87], v[102:103] op_sel:[0,1] op_sel_hi:[1,1]
v_pk_mul_f32 v[88:89], v[88:89], v[102:103] op_sel:[0,1] op_sel_hi:[1,1]
v_pk_mul_f32 v[90:91], v[90:91], v[102:103] op_sel:[0,1] op_sel_hi:[1,1]
v_pk_mul_f32 v[244:245], v[244:245], v[106:107] op_sel:[0,1] op_sel_hi:[1,1]
v_pk_mul_f32 v[246:247], v[246:247], v[106:107] op_sel:[0,1] op_sel_hi:[1,1]
v_pk_mul_f32 v[248:249], v[248:249], v[106:107] op_sel:[0,1] op_sel_hi:[1,1]
v_pk_mul_f32 v[250:251], v[250:251], v[106:107] op_sel:[0,1] op_sel_hi:[1,1]
v_cvt_pk_bf16_f32 v84, v84, v85
v_cvt_pk_bf16_f32 v85, v86, v87
v_cvt_pk_bf16_f32 v86, v88, v89
v_cvt_pk_bf16_f32 v87, v90, v91
v_cvt_pk_bf16_f32 v244, v244, v245
v_cvt_pk_bf16_f32 v245, v246, v247
v_cvt_pk_bf16_f32 v246, v248, v249
v_cvt_pk_bf16_f32 v247, v250, v251
s_cmp_lg_u32 s51, 0
s_cbranch_scc1 else_87
s_mov_b32 s63, 0
sent_89:
s_waitcnt vmcnt(0)
v_max_u32 v4, v212, v213
v_max3_u32 v4, v4, v214, v215
v_max3_u32 v4, v4, v216, v217
v_max3_u32 v4, v4, v218, v219
v_cmp_eq_u32 vcc, -1, v4
s_cbranch_vccz sentd_90
buffer_load_dwordx4 v[212:215], v18, s[32:35], s55 offen offset:0 sc1
buffer_load_dwordx4 v[216:219], v18, s[32:35], s55 offen offset:1024 sc1
s_add_u32 s63, s63, 1
s_cmp_lt_u32 s63, 0x80000
s_cbranch_scc1 sent_89
s_waitcnt vmcnt(0)
sentd_90:
v_mfma_f32_16x16x32_bf16 v[132:135], v[44:47], v[212:215], 0
v_mfma_f32_16x16x32_bf16 v[132:135], v[44:47], v[216:219], v[132:135]
s_mov_b32 s51, 1
s_nop 6
v_add_f32_dpp v132, v132, v132 row_ror:8 row_mask:0xf bank_mask:0xf
v_add_f32_dpp v133, v133, v133 row_ror:8 row_mask:0xf bank_mask:0xf
v_add_f32_dpp v134, v134, v134 row_ror:8 row_mask:0xf bank_mask:0xf
v_add_f32_dpp v135, v135, v135 row_ror:8 row_mask:0xf bank_mask:0xf
v_cvt_pk_bf16_f32 v132, v132, v133
v_cvt_pk_bf16_f32 v133, v134, v135
s_mov_b64 exec, 0x00ff00ff
buffer_store_dwordx2 v[132:133], v59, s[32:35], s79 offen sc1
s_mov_b64 exec, -1
buffer_load_dwordx4 v[204:207], v58, s[32:35], s56 offen sc1
buffer_load_dwordx4 v[208:211], v58, s[32:35], s57 offen sc1
else_87:
s_mov_b32 s63, 0
sent_91:
s_waitcnt vmcnt(0)
v_max_u32 v4, v204, v205
v_max3_u32 v4, v4, v206, v207
v_max3_u32 v4, v4, v208, v209
v_max3_u32 v4, v4, v210, v211
v_cmp_eq_u32 vcc, -1, v4
s_cbranch_vccz sentd_92
buffer_load_dwordx4 v[204:207], v58, s[32:35], s56 offen sc1
buffer_load_dwordx4 v[208:211], v58, s[32:35], s57 offen sc1
s_add_u32 s63, s63, 1
s_cmp_lt_u32 s63, 0x80000
s_cbranch_scc1 sent_91
s_waitcnt vmcnt(0)
sentd_92:
buffer_load_dwordx4 v[188:191], v18, s[32:35], s58 offen offset:0 sc1
buffer_load_dwordx4 v[192:195], v18, s[32:35], s58 offen offset:1024 sc1
buffer_load_dwordx4 v[196:199], v18, s[32:35], s59 offen offset:0 sc1
buffer_load_dwordx4 v[200:203], v18, s[32:35], s59 offen offset:1024 sc1
v_mfma_f32_16x16x32_bf16 v[112:115], v[204:207], v[60:63], 0
v_mfma_f32_16x16x32_bf16 v[116:119], v[204:207], v[68:71], 0
v_mfma_f32_16x16x32_bf16 v[120:123], v[204:207], v[76:79], 0
v_mfma_f32_16x16x32_bf16 v[124:127], v[204:207], v[84:87], 0
v_mfma_f32_16x16x32_bf16 v[112:115], v[208:211], v[220:223], v[112:115]
v_mfma_f32_16x16x32_bf16 v[116:119], v[208:211], v[228:231], v[116:119]
v_mfma_f32_16x16x32_bf16 v[120:123], v[208:211], v[236:239], v[120:123]
v_mfma_f32_16x16x32_bf16 v[124:127], v[208:211], v[244:247], v[124:127]
s_nop 4
v_add_f32 v100, v112, v113
v_add_f32 v114, v114, v115
v_add_f32 v100, v100, v114
v_add_f32 v101, v116, v117
v_add_f32 v118, v118, v119
v_add_f32 v101, v101, v118
v_add_f32 v102, v120, v121
v_add_f32 v122, v122, v123
v_add_f32 v102, v102, v122
v_add_f32 v103, v124, v125
v_add_f32 v126, v126, v127
v_add_f32 v103, v103, v126
s_nop 1
v_permlane32_swap_b32 v100, v101
v_permlane32_swap_b32 v102, v103
v_add_f32 v100, v100, v101
v_add_f32 v102, v102, v103
s_nop 1
v_permlane16_swap_b32 v100, v102
s_nop 0
v_add_f32 v100, v100, v102
v_add_f32 v100, 0x358637bd, v100
v_rcp_f32 v100, v100
s_nop 0
v_mov_b32 v102, v100
s_nop 1
v_permlane16_swap_b32 v100, v102
s_nop 0
v_mov_b32 v101, v100
v_mov_b32 v103, v102
s_nop 0
v_permlane32_swap_b32 v100, v101
v_permlane32_swap_b32 v102, v103
s_mov_b32 s63, 0
sent_93:
s_waitcnt vmcnt(0)
v_max_u32 v4, v188, v189
v_max3_u32 v4, v4, v190, v191
v_max3_u32 v4, v4, v192, v193
v_max3_u32 v4, v4, v194, v195
v_max3_u32 v4, v4, v196, v197
v_max3_u32 v4, v4, v198, v199
v_max3_u32 v4, v4, v200, v201
v_max3_u32 v4, v4, v202, v203
v_cmp_eq_u32 vcc, -1, v4
s_cbranch_vccz sentd_94
buffer_load_dwordx4 v[188:191], v18, s[32:35], s58 offen offset:0 sc1
buffer_load_dwordx4 v[192:195], v18, s[32:35], s58 offen offset:1024 sc1
buffer_load_dwordx4 v[196:199], v18, s[32:35], s59 offen offset:0 sc1
buffer_load_dwordx4 v[200:203], v18, s[32:35], s59 offen offset:1024 sc1
s_add_u32 s63, s63, 1
s_cmp_lt_u32 s63, 0x80000
s_cbranch_scc1 sent_93
s_waitcnt vmcnt(0)
sentd_94:
v_mfma_f32_16x16x32_bf16 v[156:159], v[188:191], v[60:63], 0
v_mfma_f32_16x16x32_bf16 v[160:163], v[192:195], v[60:63], 0
v_mfma_f32_16x16x32_bf16 v[156:159], v[196:199], v[220:223], v[156:159]
v_mfma_f32_16x16x32_bf16 v[160:163], v[200:203], v[220:223], v[160:163]
v_mfma_f32_16x16x32_bf16 v[164:167], v[188:191], v[68:71], 0
v_mfma_f32_16x16x32_bf16 v[168:171], v[192:195], v[68:71], 0
v_mfma_f32_16x16x32_bf16 v[164:167], v[196:199], v[228:231], v[164:167]
v_mfma_f32_16x16x32_bf16 v[168:171], v[200:203], v[228:231], v[168:171]
s_nop 1
s_cmp_eq_u32 s46, 0
s_cbranch_scc1 slow_95
.p2align 3
v_pk_mul_f32 v[156:157], v[156:157], v[100:101] op_sel:[0,0] op_sel_hi:[1,0]
v_pk_mul_f32 v[158:159], v[158:159], v[100:101] op_sel:[0,0] op_sel_hi:[1,0]
v_pk_mul_f32 v[160:161], v[160:161], v[100:101] op_sel:[0,0] op_sel_hi:[1,0]
v_pk_mul_f32 v[162:163], v[162:163], v[100:101] op_sel:[0,0] op_sel_hi:[1,0]
v_cvt_pk_bf16_f32 v156, v156, v157
v_mfma_f32_16x16x32_bf16 v[172:175], v[188:191], v[76:79], 0
v_cvt_pk_bf16_f32 v157, v158, v159
v_mfma_f32_16x16x32_bf16 v[176:179], v[192:195], v[76:79], 0
v_cvt_pk_bf16_f32 v158, v160, v161
v_mfma_f32_16x16x32_bf16 v[172:175], v[196:199], v[236:239], v[172:175]
v_cvt_pk_bf16_f32 v159, v162, v163
v_mfma_f32_16x16x32_bf16 v[176:179], v[200:203], v[236:239], v[176:179]
buffer_store_dwordx4 v[156:159], v18, s[32:35], s80 offen
v_pk_mul_f32 v[164:165], v[164:165], v[100:101] op_sel:[0,1] op_sel_hi:[1,1]
v_pk_mul_f32 v[166:167], v[166:167], v[100:101] op_sel:[0,1] op_sel_hi:[1,1]
v_pk_mul_f32 v[168:169], v[168:169], v[100:101] op_sel:[0,1] op_sel_hi:[1,1]
v_pk_mul_f32 v[170:171], v[170:171], v[100:101] op_sel:[0,1] op_sel_hi:[1,1]
v_cvt_pk_bf16_f32 v164, v164, v165
v_mfma_f32_16x16x32_bf16 v[180:183], v[188:191], v[84:87], 0
v_cvt_pk_bf16_f32 v165, v166, v167
v_mfma_f32_16x16x32_bf16 v[184:187], v[192:195], v[84:87], 0
v_cvt_pk_bf16_f32 v166, v168, v169
v_mfma_f32_16x16x32_bf16 v[180:183], v[196:199], v[244:247], v[180:183]
v_cvt_pk_bf16_f32 v167, v170, v171
v_mfma_f32_16x16x32_bf16 v[184:187], v[200:203], v[244:247], v[184:187]
buffer_store_dwordx4 v[164:167], v18, s[32:35], s81 offen
v_pk_mul_f32 v[172:173], v[172:173], v[102:103] op_sel:[0,0] op_sel_hi:[1,0]
v_pk_mul_f32 v[174:175], v[174:175], v[102:103] op_sel:[0,0] op_sel_hi:[1,0]
v_pk_mul_f32 v[176:177], v[176:177], v[102:103] op_sel:[0,0] op_sel_hi:[1,0]
v_pk_mul_f32 v[178:179], v[178:179], v[102:103] op_sel:[0,0] op_sel_hi:[1,0]
v_cvt_pk_bf16_f32 v172, v172, v173
v_cvt_pk_bf16_f32 v173, v174, v175
v_cvt_pk_bf16_f32 v174, v176, v177
v_cvt_pk_bf16_f32 v175, v178, v179
buffer_store_dwordx4 v[172:175], v18, s[32:35], s82 offen
v_pk_mul_f32 v[180:181], v[180:181], v[102:103] op_sel:[0,1] op_sel_hi:[1,1]
v_pk_mul_f32 v[182:183], v[182:183], v[102:103] op_sel:[0,1] op_sel_hi:[1,1]
v_pk_mul_f32 v[184:185], v[184:185], v[102:103] op_sel:[0,1] op_sel_hi:[1,1]
v_pk_mul_f32 v[186:187], v[186:187], v[102:103] op_sel:[0,1] op_sel_hi:[1,1]
v_cvt_pk_bf16_f32 v180, v180, v181
v_cvt_pk_bf16_f32 v181, v182, v183
v_cvt_pk_bf16_f32 v182, v184, v185
v_cvt_pk_bf16_f32 v183, v186, v187
buffer_store_dwordx4 v[180:183], v18, s[32:35], s83 offen
back_96:
s_barrier
v_and_b32 v36, 31, v0
v_lshlrev_b32 v36, 2, v36
s_lshl_b32 s62, s45, 2
v_mov_b32 v4, s62
v_mov_b32 v5, 2
s_mov_b64 exec, 1
s_waitcnt vmcnt(0)
s_cmp_eq_u32 s46, 0
s_cbranch_scc1 slow_97
buffer_store_dword v5, v4, s[32:35], s84 offen
back_98:
s_mov_b64 exec, -1
v_lshrrev_b32 v4, 2, v2
v_and_b32 v5, 3, v0
v_lshl_add_u32 v6, v3, 3, v4
v_lshlrev_b32 v6, 7, v6
v_lshl_add_u32 v6, v5, 3, v6
v_lshrrev_b32 v7, 1, v4
v_and_b32 v8, 1, v3
v_lshl_add_u32 v7, v8, 1, v7
v_lshl_add_u32 v10, v7, 5, v6
v_xor_b32 v11, 32, v10
v_xor_b32 v12, 64, v10
v_xor_b32 v13, 96, v10
v_add_u32 v14, 0x10000, v10
v_add_u32 v15, 0x10000, v11
v_add_u32 v16, 0x10000, v12
v_add_u32 v17, 0x10000, v13
ds_read_b64_tr_b16 v[220:221], v10 offset:0
ds_read_b64_tr_b16 v[222:223], v10 offset:512
ds_read_b64_tr_b16 v[224:225], v11 offset:0
ds_read_b64_tr_b16 v[226:227], v11 offset:512
ds_read_b64_tr_b16 v[228:229], v12 offset:0
ds_read_b64_tr_b16 v[230:231], v12 offset:512
ds_read_b64_tr_b16 v[232:233], v13 offset:0
ds_read_b64_tr_b16 v[234:235], v13 offset:512
ds_read_b64_tr_b16 v[236:237], v10 offset:4096
ds_read_b64_tr_b16 v[238:239], v10 offset:4608
ds_read_b64_tr_b16 v[240:241], v11 offset:4096
ds_read_b64_tr_b16 v[242:243], v11 offset:4608
ds_read_b64_tr_b16 v[244:245], v12 offset:4096
ds_read_b64_tr_b16 v[246:247], v12 offset:4608
ds_read_b64_tr_b16 v[248:249], v13 offset:4096
ds_read_b64_tr_b16 v[250:251], v13 offset:4608
s_lshl_b32 s48, s41, 3
s_lshl_b32 s49, s40, 1
s_add_u32 s48, s48, s49
s_lshl_b32 s48, s48, 15
s_add_u32 s48, s48, 4194304
v_add_u32 v38, s48, v18
v_add_u32 v39, 32768, v38
s_lshl_b32 s57, s75, 11
s_add_u32 s87, s87, 262144
v_lshlrev_b32 v60, 16, v20
v_and_b32 v61, 0xffff0000, v20
v_lshlrev_b32 v62, 16, v21
v_and_b32 v63, 0xffff0000, v21
v_lshlrev_b32 v64, 16, v22
v_and_b32 v65, 0xffff0000, v22
v_lshlrev_b32 v66, 16, v23
v_and_b32 v67, 0xffff0000, v23
v_lshlrev_b32 v68, 16, v24
v_and_b32 v69, 0xffff0000, v24
v_lshlrev_b32 v70, 16, v25
v_and_b32 v71, 0xffff0000, v25
v_lshlrev_b32 v72, 16, v26
v_and_b32 v73, 0xffff0000, v26
v_lshlrev_b32 v74, 16, v27
v_and_b32 v75, 0xffff0000, v27
v_lshlrev_b32 v76, 16, v28
v_and_b32 v77, 0xffff0000, v28
v_lshlrev_b32 v78, 16, v29
v_and_b32 v79, 0xffff0000, v29
v_lshlrev_b32 v80, 16, v30
v_and_b32 v81, 0xffff0000, v30
v_lshlrev_b32 v82, 16, v31
v_and_b32 v83, 0xffff0000, v31
v_lshlrev_b32 v84, 16, v32
v_and_b32 v85, 0xffff0000, v32
v_lshlrev_b32 v86, 16, v33
v_and_b32 v87, 0xffff0000, v33
v_lshlrev_b32 v88, 16, v34
v_and_b32 v89, 0xffff0000, v34
v_lshlrev_b32 v90, 16, v35
v_and_b32 v91, 0xffff0000, v35
v_mov_b32 v6, 0
v_mov_b32 v7, 0
v_mov_b32 v8, 0
v_mov_b32 v9, 0
s_lshl_b32 s62, s42, 2
v_mov_b32 v4, s62
v_mov_b32 v5, 2
buffer_load_dword v37, v36, s[32:35], s84 offen sc1
s_mov_b32 s63, 0
s_waitcnt vmcnt(0)
poll_99:
v_cmp_gt_u32 vcc, 2, v37
s_cbranch_vccz polled_100
buffer_load_dword v37, v36, s[32:35], s84 offen sc1
s_add_u32 s63, s63, 1
s_cmp_lt_u32 s63, 0x80000
s_waitcnt vmcnt(0)
s_cbranch_scc1 poll_99
polled_100:
buffer_load_dwordx4 v[156:159], v38, s[32:35], s57 offen sc1
buffer_load_dwordx4 v[160:163], v39, s[32:35], s57 offen sc1
buffer_load_dwordx4 v[164:167], v38, s[32:35], s57 offen offset:1024 sc1
buffer_load_dwordx4 v[168:171], v39, s[32:35], s57 offen offset:1024 sc1
s_add_u32 s57, s57, 2048
s_and_b32 s57, s57, 0x7fff
buffer_load_dwordx4 v[172:175], v38, s[32:35], s57 offen sc1
buffer_load_dwordx4 v[176:179], v39, s[32:35], s57 offen sc1
buffer_load_dwordx4 v[180:183], v38, s[32:35], s57 offen offset:1024 sc1
buffer_load_dwordx4 v[184:187], v39, s[32:35], s57 offen offset:1024 sc1
s_add_u32 s57, s57, 2048
s_and_b32 s57, s57, 0x7fff
s_waitcnt vmcnt(6) lgkmcnt(8)
v_mfma_f32_16x16x32_bf16 v[60:63], v[220:223], v[156:159], v[60:63]
buffer_load_dwordx4 v[188:191], v38, s[32:35], s57 offen sc1
v_mfma_f32_16x16x32_bf16 v[76:79], v[220:223], v[160:163], v[76:79]
ds_read_b64_tr_b16 v[100:101], v10 offset:8192
ds_read_b64_tr_b16 v[102:103], v10 offset:8704
v_mfma_f32_16x16x32_bf16 v[80:83], v[224:227], v[160:163], v[80:83]
ds_read_b64_tr_b16 v[104:105], v11 offset:8192
ds_read_b64_tr_b16 v[106:107], v11 offset:8704
v_mfma_f32_16x16x32_bf16 v[64:67], v[224:227], v[156:159], v[64:67]
buffer_load_dwordx4 v[192:195], v39, s[32:35], s57 offen sc1
v_mfma_f32_16x16x32_bf16 v[68:71], v[228:231], v[156:159], v[68:71]
ds_read_b64_tr_b16 v[108:109], v12 offset:8192
ds_read_b64_tr_b16 v[110:111], v12 offset:8704
v_mfma_f32_16x16x32_bf16 v[84:87], v[228:231], v[160:163], v[84:87]
ds_read_b64_tr_b16 v[112:113], v13 offset:8192
ds_read_b64_tr_b16 v[114:115], v13 offset:8704
v_mfma_f32_16x16x32_bf16 v[88:91], v[232:235], v[160:163], v[88:91]
v_mfma_f32_16x16x32_bf16 v[72:75], v[232:235], v[156:159], v[72:75]
s_waitcnt vmcnt(6) lgkmcnt(8)
v_mfma_f32_16x16x32_bf16 v[60:63], v[236:239], v[164:167], v[60:63]
buffer_load_dwordx4 v[196:199], v38, s[32:35], s57 offen offset:1024 sc1
v_mfma_f32_16x16x32_bf16 v[76:79], v[236:239], v[168:171], v[76:79]
ds_read_b64_tr_b16 v[220:221], v10 offset:12288
ds_read_b64_tr_b16 v[222:223], v10 offset:12800
v_mfma_f32_16x16x32_bf16 v[80:83], v[240:243], v[168:171], v[80:83]
ds_read_b64_tr_b16 v[224:225], v11 offset:12288
ds_read_b64_tr_b16 v[226:227], v11 offset:12800
v_mfma_f32_16x16x32_bf16 v[64:67], v[240:243], v[164:167], v[64:67]
buffer_load_dwordx4 v[200:203], v39, s[32:35], s57 offen offset:1024 sc1
v_mfma_f32_16x16x32_bf16 v[68:71], v[244:247], v[164:167], v[68:71]
ds_read_b64_tr_b16 v[228:229], v12 offset:12288
ds_read_b64_tr_b16 v[230:231], v12 offset:12800
v_mfma_f32_16x16x32_bf16 v[84:87], v[244:247], v[168:171], v[84:87]
ds_read_b64_tr_b16 v[232:233], v13 offset:12288
ds_read_b64_tr_b16 v[234:235], v13 offset:12800
v_mfma_f32_16x16x32_bf16 v[88:91], v[248:251], v[168:171], v[88:91]
s_add_u32 s57, s57, 2048
s_and_b32 s57, s57, 0x7fff
v_mfma_f32_16x16x32_bf16 v[72:75], v[248:251], v[164:167], v[72:75]
s_waitcnt vmcnt(6) lgkmcnt(8)
v_mfma_f32_16x16x32_bf16 v[60:63], v[100:103], v[172:175], v[60:63]
buffer_load_dwordx4 v[204:207], v38, s[32:35], s57 offen sc1
v_mfma_f32_16x16x32_bf16 v[76:79], v[100:103], v[176:179], v[76:79]
ds_read_b64_tr_b16 v[236:237], v10 offset:16384
ds_read_b64_tr_b16 v[238:239], v10 offset:16896
v_mfma_f32_16x16x32_bf16 v[80:83], v[104:107], v[176:179], v[80:83]
ds_read_b64_tr_b16 v[240:241], v11 offset:16384
ds_read_b64_tr_b16 v[242:243], v11 offset:16896
v_mfma_f32_16x16x32_bf16 v[64:67], v[104:107], v[172:175], v[64:67]
buffer_load_dwordx4 v[208:211], v39, s[32:35], s57 offen sc1
v_mfma_f32_16x16x32_bf16 v[68:71], v[108:111], v[172:175], v[68:71]
ds_read_b64_tr_b16 v[244:245], v12 offset:16384
ds_read_b64_tr_b16 v[246:247], v12 offset:16896
v_mfma_f32_16x16x32_bf16 v[84:87], v[108:111], v[176:179], v[84:87]
ds_read_b64_tr_b16 v[248:249], v13 offset:16384
ds_read_b64_tr_b16 v[250:251], v13 offset:16896
v_mfma_f32_16x16x32_bf16 v[88:91], v[112:115], v[176:179], v[88:91]
v_mfma_f32_16x16x32_bf16 v[72:75], v[112:115], v[172:175], v[72:75]
s_waitcnt vmcnt(6) lgkmcnt(8)
v_mfma_f32_16x16x32_bf16 v[60:63], v[220:223], v[180:183], v[60:63]
buffer_load_dwordx4 v[212:215], v38, s[32:35], s57 offen offset:1024 sc1
v_mfma_f32_16x16x32_bf16 v[76:79], v[220:223], v[184:187], v[76:79]
ds_read_b64_tr_b16 v[100:101], v10 offset:20480
ds_read_b64_tr_b16 v[102:103], v10 offset:20992
v_mfma_f32_16x16x32_bf16 v[80:83], v[224:227], v[184:187], v[80:83]
ds_read_b64_tr_b16 v[104:105], v11 offset:20480
ds_read_b64_tr_b16 v[106:107], v11 offset:20992
v_mfma_f32_16x16x32_bf16 v[64:67], v[224:227], v[180:183], v[64:67]
buffer_load_dwordx4 v[216:219], v39, s[32:35], s57 offen offset:1024 sc1
v_mfma_f32_16x16x32_bf16 v[68:71], v[228:231], v[180:183], v[68:71]
ds_read_b64_tr_b16 v[108:109], v12 offset:20480
ds_read_b64_tr_b16 v[110:111], v12 offset:20992
v_mfma_f32_16x16x32_bf16 v[84:87], v[228:231], v[184:187], v[84:87]
ds_read_b64_tr_b16 v[112:113], v13 offset:20480
ds_read_b64_tr_b16 v[114:115], v13 offset:20992
v_mfma_f32_16x16x32_bf16 v[88:91], v[232:235], v[184:187], v[88:91]
s_add_u32 s57, s57, 2048
s_and_b32 s57, s57, 0x7fff
v_mfma_f32_16x16x32_bf16 v[72:75], v[232:235], v[180:183], v[72:75]
s_waitcnt vmcnt(6) lgkmcnt(8)
v_mfma_f32_16x16x32_bf16 v[60:63], v[236:239], v[188:191], v[60:63]
buffer_load_dwordx4 v[156:159], v38, s[32:35], s57 offen sc1
v_mfma_f32_16x16x32_bf16 v[76:79], v[236:239], v[192:195], v[76:79]
ds_read_b64_tr_b16 v[220:221], v10 offset:24576
ds_read_b64_tr_b16 v[222:223], v10 offset:25088
v_mfma_f32_16x16x32_bf16 v[80:83], v[240:243], v[192:195], v[80:83]
ds_read_b64_tr_b16 v[224:225], v11 offset:24576
ds_read_b64_tr_b16 v[226:227], v11 offset:25088
v_mfma_f32_16x16x32_bf16 v[64:67], v[240:243], v[188:191], v[64:67]
buffer_load_dwordx4 v[160:163], v39, s[32:35], s57 offen sc1
v_mfma_f32_16x16x32_bf16 v[68:71], v[244:247], v[188:191], v[68:71]
ds_read_b64_tr_b16 v[228:229], v12 offset:24576
ds_read_b64_tr_b16 v[230:231], v12 offset:25088
v_mfma_f32_16x16x32_bf16 v[84:87], v[244:247], v[192:195], v[84:87]
ds_read_b64_tr_b16 v[232:233], v13 offset:24576
ds_read_b64_tr_b16 v[234:235], v13 offset:25088
v_mfma_f32_16x16x32_bf16 v[88:91], v[248:251], v[192:195], v[88:91]
v_mfma_f32_16x16x32_bf16 v[72:75], v[248:251], v[188:191], v[72:75]
s_waitcnt vmcnt(6) lgkmcnt(8)
v_mfma_f32_16x16x32_bf16 v[60:63], v[100:103], v[196:199], v[60:63]
buffer_load_dwordx4 v[164:167], v38, s[32:35], s57 offen offset:1024 sc1
v_mfma_f32_16x16x32_bf16 v[76:79], v[100:103], v[200:203], v[76:79]
ds_read_b64_tr_b16 v[236:237], v10 offset:28672
ds_read_b64_tr_b16 v[238:239], v10 offset:29184
v_mfma_f32_16x16x32_bf16 v[80:83], v[104:107], v[200:203], v[80:83]
ds_read_b64_tr_b16 v[240:241], v11 offset:28672
ds_read_b64_tr_b16 v[242:243], v11 offset:29184
v_mfma_f32_16x16x32_bf16 v[64:67], v[104:107], v[196:199], v[64:67]
buffer_load_dwordx4 v[168:171], v39, s[32:35], s57 offen offset:1024 sc1
v_mfma_f32_16x16x32_bf16 v[68:71], v[108:111], v[196:199], v[68:71]
ds_read_b64_tr_b16 v[244:245], v12 offset:28672
ds_read_b64_tr_b16 v[246:247], v12 offset:29184
v_mfma_f32_16x16x32_bf16 v[84:87], v[108:111], v[200:203], v[84:87]
ds_read_b64_tr_b16 v[248:249], v13 offset:28672
ds_read_b64_tr_b16 v[250:251], v13 offset:29184
v_mfma_f32_16x16x32_bf16 v[88:91], v[112:115], v[200:203], v[88:91]
s_add_u32 s57, s57, 2048
s_and_b32 s57, s57, 0x7fff
v_mfma_f32_16x16x32_bf16 v[72:75], v[112:115], v[196:199], v[72:75]
s_waitcnt vmcnt(6) lgkmcnt(8)
v_mfma_f32_16x16x32_bf16 v[60:63], v[220:223], v[204:207], v[60:63]
buffer_load_dwordx4 v[172:175], v38, s[32:35], s57 offen sc1
v_mfma_f32_16x16x32_bf16 v[76:79], v[220:223], v[208:211], v[76:79]
ds_read_b64_tr_b16 v[100:101], v10 offset:32768
ds_read_b64_tr_b16 v[102:103], v10 offset:33280
v_mfma_f32_16x16x32_bf16 v[80:83], v[224:227], v[208:211], v[80:83]
ds_read_b64_tr_b16 v[104:105], v11 offset:32768
ds_read_b64_tr_b16 v[106:107], v11 offset:33280
v_mfma_f32_16x16x32_bf16 v[64:67], v[224:227], v[204:207], v[64:67]
buffer_load_dwordx4 v[176:179], v39, s[32:35], s57 offen sc1
v_mfma_f32_16x16x32_bf16 v[68:71], v[228:231], v[204:207], v[68:71]
ds_read_b64_tr_b16 v[108:109], v12 offset:32768
ds_read_b64_tr_b16 v[110:111], v12 offset:33280
v_mfma_f32_16x16x32_bf16 v[84:87], v[228:231], v[208:211], v[84:87]
ds_read_b64_tr_b16 v[112:113], v13 offset:32768
ds_read_b64_tr_b16 v[114:115], v13 offset:33280
v_mfma_f32_16x16x32_bf16 v[88:91], v[232:235], v[208:211], v[88:91]
v_mfma_f32_16x16x32_bf16 v[72:75], v[232:235], v[204:207], v[72:75]
s_waitcnt vmcnt(6) lgkmcnt(8)
v_mfma_f32_16x16x32_bf16 v[60:63], v[236:239], v[212:215], v[60:63]
buffer_load_dwordx4 v[180:183], v38, s[32:35], s57 offen offset:1024 sc1
v_mfma_f32_16x16x32_bf16 v[76:79], v[236:239], v[216:219], v[76:79]
ds_read_b64_tr_b16 v[220:221], v10 offset:36864
ds_read_b64_tr_b16 v[222:223], v10 offset:37376
v_mfma_f32_16x16x32_bf16 v[80:83], v[240:243], v[216:219], v[80:83]
ds_read_b64_tr_b16 v[224:225], v11 offset:36864
ds_read_b64_tr_b16 v[226:227], v11 offset:37376
v_mfma_f32_16x16x32_bf16 v[64:67], v[240:243], v[212:215], v[64:67]
buffer_load_dwordx4 v[184:187], v39, s[32:35], s57 offen offset:1024 sc1
v_mfma_f32_16x16x32_bf16 v[68:71], v[244:247], v[212:215], v[68:71]
ds_read_b64_tr_b16 v[228:229], v12 offset:36864
ds_read_b64_tr_b16 v[230:231], v12 offset:37376
v_mfma_f32_16x16x32_bf16 v[84:87], v[244:247], v[216:219], v[84:87]
ds_read_b64_tr_b16 v[232:233], v13 offset:36864
ds_read_b64_tr_b16 v[234:235], v13 offset:37376
v_mfma_f32_16x16x32_bf16 v[88:91], v[248:251], v[216:219], v[88:91]
s_add_u32 s57, s57, 2048
s_and_b32 s57, s57, 0x7fff
v_mfma_f32_16x16x32_bf16 v[72:75], v[248:251], v[212:215], v[72:75]
s_waitcnt vmcnt(6) lgkmcnt(8)
v_mfma_f32_16x16x32_bf16 v[60:63], v[100:103], v[156:159], v[60:63]
buffer_load_dwordx4 v[188:191], v38, s[32:35], s57 offen sc1
v_mfma_f32_16x16x32_bf16 v[76:79], v[100:103], v[160:163], v[76:79]
ds_read_b64_tr_b16 v[236:237], v10 offset:40960
ds_read_b64_tr_b16 v[238:239], v10 offset:41472
v_mfma_f32_16x16x32_bf16 v[80:83], v[104:107], v[160:163], v[80:83]
ds_read_b64_tr_b16 v[240:241], v11 offset:40960
ds_read_b64_tr_b16 v[242:243], v11 offset:41472
v_mfma_f32_16x16x32_bf16 v[64:67], v[104:107], v[156:159], v[64:67]
buffer_load_dwordx4 v[192:195], v39, s[32:35], s57 offen sc1
v_mfma_f32_16x16x32_bf16 v[68:71], v[108:111], v[156:159], v[68:71]
ds_read_b64_tr_b16 v[244:245], v12 offset:40960
ds_read_b64_tr_b16 v[246:247], v12 offset:41472
v_mfma_f32_16x16x32_bf16 v[84:87], v[108:111], v[160:163], v[84:87]
ds_read_b64_tr_b16 v[248:249], v13 offset:40960
ds_read_b64_tr_b16 v[250:251], v13 offset:41472
v_mfma_f32_16x16x32_bf16 v[88:91], v[112:115], v[160:163], v[88:91]
v_mfma_f32_16x16x32_bf16 v[72:75], v[112:115], v[156:159], v[72:75]
s_waitcnt vmcnt(6) lgkmcnt(8)
v_mfma_f32_16x16x32_bf16 v[60:63], v[220:223], v[164:167], v[60:63]
buffer_load_dwordx4 v[196:199], v38, s[32:35], s57 offen offset:1024 sc1
v_mfma_f32_16x16x32_bf16 v[76:79], v[220:223], v[168:171], v[76:79]
ds_read_b64_tr_b16 v[100:101], v10 offset:45056
ds_read_b64_tr_b16 v[102:103], v10 offset:45568
v_mfma_f32_16x16x32_bf16 v[80:83], v[224:227], v[168:171], v[80:83]
ds_read_b64_tr_b16 v[104:105], v11 offset:45056
ds_read_b64_tr_b16 v[106:107], v11 offset:45568
v_mfma_f32_16x16x32_bf16 v[64:67], v[224:227], v[164:167], v[64:67]
buffer_load_dwordx4 v[200:203], v39, s[32:35], s57 offen offset:1024 sc1
v_mfma_f32_16x16x32_bf16 v[68:71], v[228:231], v[164:167], v[68:71]
ds_read_b64_tr_b16 v[108:109], v12 offset:45056
ds_read_b64_tr_b16 v[110:111], v12 offset:45568
v_mfma_f32_16x16x32_bf16 v[84:87], v[228:231], v[168:171], v[84:87]
ds_read_b64_tr_b16 v[112:113], v13 offset:45056
ds_read_b64_tr_b16 v[114:115], v13 offset:45568
v_mfma_f32_16x16x32_bf16 v[88:91], v[232:235], v[168:171], v[88:91]
s_add_u32 s57, s57, 2048
s_and_b32 s57, s57, 0x7fff
v_mfma_f32_16x16x32_bf16 v[72:75], v[232:235], v[164:167], v[72:75]
s_waitcnt vmcnt(6) lgkmcnt(8)
v_mfma_f32_16x16x32_bf16 v[60:63], v[236:239], v[172:175], v[60:63]
buffer_load_dwordx4 v[204:207], v38, s[32:35], s57 offen sc1
v_mfma_f32_16x16x32_bf16 v[76:79], v[236:239], v[176:179], v[76:79]
ds_read_b64_tr_b16 v[220:221], v10 offset:49152
ds_read_b64_tr_b16 v[222:223], v10 offset:49664
v_mfma_f32_16x16x32_bf16 v[80:83], v[240:243], v[176:179], v[80:83]
ds_read_b64_tr_b16 v[224:225], v11 offset:49152
ds_read_b64_tr_b16 v[226:227], v11 offset:49664
v_mfma_f32_16x16x32_bf16 v[64:67], v[240:243], v[172:175], v[64:67]
buffer_load_dwordx4 v[208:211], v39, s[32:35], s57 offen sc1
v_mfma_f32_16x16x32_bf16 v[68:71], v[244:247], v[172:175], v[68:71]
ds_read_b64_tr_b16 v[228:229], v12 offset:49152
ds_read_b64_tr_b16 v[230:231], v12 offset:49664
v_mfma_f32_16x16x32_bf16 v[84:87], v[244:247], v[176:179], v[84:87]
ds_read_b64_tr_b16 v[232:233], v13 offset:49152
ds_read_b64_tr_b16 v[234:235], v13 offset:49664
v_mfma_f32_16x16x32_bf16 v[88:91], v[248:251], v[176:179], v[88:91]
v_mfma_f32_16x16x32_bf16 v[72:75], v[248:251], v[172:175], v[72:75]
s_waitcnt vmcnt(6) lgkmcnt(8)
v_mfma_f32_16x16x32_bf16 v[60:63], v[100:103], v[180:183], v[60:63]
buffer_load_dwordx4 v[212:215], v38, s[32:35], s57 offen offset:1024 sc1
v_mfma_f32_16x16x32_bf16 v[76:79], v[100:103], v[184:187], v[76:79]
ds_read_b64_tr_b16 v[236:237], v10 offset:53248
ds_read_b64_tr_b16 v[238:239], v10 offset:53760
v_mfma_f32_16x16x32_bf16 v[80:83], v[104:107], v[184:187], v[80:83]
ds_read_b64_tr_b16 v[240:241], v11 offset:53248
ds_read_b64_tr_b16 v[242:243], v11 offset:53760
v_mfma_f32_16x16x32_bf16 v[64:67], v[104:107], v[180:183], v[64:67]
buffer_load_dwordx4 v[216:219], v39, s[32:35], s57 offen offset:1024 sc1
v_mfma_f32_16x16x32_bf16 v[68:71], v[108:111], v[180:183], v[68:71]
ds_read_b64_tr_b16 v[244:245], v12 offset:53248
ds_read_b64_tr_b16 v[246:247], v12 offset:53760
v_mfma_f32_16x16x32_bf16 v[84:87], v[108:111], v[184:187], v[84:87]
ds_read_b64_tr_b16 v[248:249], v13 offset:53248
ds_read_b64_tr_b16 v[250:251], v13 offset:53760
v_mfma_f32_16x16x32_bf16 v[88:91], v[112:115], v[184:187], v[88:91]
s_add_u32 s57, s57, 2048
s_and_b32 s57, s57, 0x7fff
v_mfma_f32_16x16x32_bf16 v[72:75], v[112:115], v[180:183], v[72:75]
s_waitcnt vmcnt(6) lgkmcnt(8)
v_mfma_f32_16x16x32_bf16 v[60:63], v[220:223], v[188:191], v[60:63]
buffer_load_dwordx4 v[156:159], v38, s[32:35], s57 offen sc1
v_mfma_f32_16x16x32_bf16 v[76:79], v[220:223], v[192:195], v[76:79]
ds_read_b64_tr_b16 v[100:101], v10 offset:57344
ds_read_b64_tr_b16 v[102:103], v10 offset:57856
v_mfma_f32_16x16x32_bf16 v[80:83], v[224:227], v[192:195], v[80:83]
ds_read_b64_tr_b16 v[104:105], v11 offset:57344
ds_read_b64_tr_b16 v[106:107], v11 offset:57856
v_mfma_f32_16x16x32_bf16 v[64:67], v[224:227], v[188:191], v[64:67]
buffer_load_dwordx4 v[160:163], v39, s[32:35], s57 offen sc1
v_mfma_f32_16x16x32_bf16 v[68:71], v[228:231], v[188:191], v[68:71]
ds_read_b64_tr_b16 v[108:109], v12 offset:57344
ds_read_b64_tr_b16 v[110:111], v12 offset:57856
v_mfma_f32_16x16x32_bf16 v[84:87], v[228:231], v[192:195], v[84:87]
ds_read_b64_tr_b16 v[112:113], v13 offset:57344
ds_read_b64_tr_b16 v[114:115], v13 offset:57856
v_mfma_f32_16x16x32_bf16 v[88:91], v[232:235], v[192:195], v[88:91]
v_mfma_f32_16x16x32_bf16 v[72:75], v[232:235], v[188:191], v[72:75]
s_waitcnt vmcnt(6) lgkmcnt(8)
v_mfma_f32_16x16x32_bf16 v[60:63], v[236:239], v[196:199], v[60:63]
buffer_load_dwordx4 v[164:167], v38, s[32:35], s57 offen offset:1024 sc1
v_mfma_f32_16x16x32_bf16 v[76:79], v[236:239], v[200:203], v[76:79]
ds_read_b64_tr_b16 v[220:221], v10 offset:61440
ds_read_b64_tr_b16 v[222:223], v10 offset:61952
v_mfma_f32_16x16x32_bf16 v[80:83], v[240:243], v[200:203], v[80:83]
ds_read_b64_tr_b16 v[224:225], v11 offset:61440
ds_read_b64_tr_b16 v[226:227], v11 offset:61952
v_mfma_f32_16x16x32_bf16 v[64:67], v[240:243], v[196:199], v[64:67]
buffer_load_dwordx4 v[168:171], v39, s[32:35], s57 offen offset:1024 sc1
v_mfma_f32_16x16x32_bf16 v[68:71], v[244:247], v[196:199], v[68:71]
ds_read_b64_tr_b16 v[228:229], v12 offset:61440
ds_read_b64_tr_b16 v[230:231], v12 offset:61952
v_mfma_f32_16x16x32_bf16 v[84:87], v[244:247], v[200:203], v[84:87]
ds_read_b64_tr_b16 v[232:233], v13 offset:61440
ds_read_b64_tr_b16 v[234:235], v13 offset:61952
v_mfma_f32_16x16x32_bf16 v[88:91], v[248:251], v[200:203], v[88:91]
s_add_u32 s57, s57, 2048
s_and_b32 s57, s57, 0x7fff
v_mfma_f32_16x16x32_bf16 v[72:75], v[248:251], v[196:199], v[72:75]
s_waitcnt vmcnt(6) lgkmcnt(8)
v_mfma_f32_16x16x32_bf16 v[60:63], v[100:103], v[204:207], v[60:63]
buffer_load_dwordx4 v[172:175], v38, s[32:35], s57 offen sc1
v_mfma_f32_16x16x32_bf16 v[76:79], v[100:103], v[208:211], v[76:79]
ds_read_b64_tr_b16 v[236:237], v14 offset:0
ds_read_b64_tr_b16 v[238:239], v14 offset:512
v_mfma_f32_16x16x32_bf16 v[80:83], v[104:107], v[208:211], v[80:83]
ds_read_b64_tr_b16 v[240:241], v15 offset:0
ds_read_b64_tr_b16 v[242:243], v15 offset:512
v_mfma_f32_16x16x32_bf16 v[64:67], v[104:107], v[204:207], v[64:67]
buffer_load_dwordx4 v[176:179], v39, s[32:35], s57 offen sc1
v_mfma_f32_16x16x32_bf16 v[68:71], v[108:111], v[204:207], v[68:71]
ds_read_b64_tr_b16 v[244:245], v16 offset:0
ds_read_b64_tr_b16 v[246:247], v16 offset:512
v_mfma_f32_16x16x32_bf16 v[84:87], v[108:111], v[208:211], v[84:87]
ds_read_b64_tr_b16 v[248:249], v17 offset:0
ds_read_b64_tr_b16 v[250:251], v17 offset:512
v_mfma_f32_16x16x32_bf16 v[88:91], v[112:115], v[208:211], v[88:91]
v_mfma_f32_16x16x32_bf16 v[72:75], v[112:115], v[204:207], v[72:75]
s_waitcnt vmcnt(6) lgkmcnt(8)
v_mfma_f32_16x16x32_bf16 v[60:63], v[220:223], v[212:215], v[60:63]
buffer_load_dwordx4 v[180:183], v38, s[32:35], s57 offen offset:1024 sc1
v_mfma_f32_16x16x32_bf16 v[76:79], v[220:223], v[216:219], v[76:79]
ds_read_b64_tr_b16 v[100:101], v14 offset:4096
ds_read_b64_tr_b16 v[102:103], v14 offset:4608
v_mfma_f32_16x16x32_bf16 v[80:83], v[224:227], v[216:219], v[80:83]
ds_read_b64_tr_b16 v[104:105], v15 offset:4096
ds_read_b64_tr_b16 v[106:107], v15 offset:4608
v_mfma_f32_16x16x32_bf16 v[64:67], v[224:227], v[212:215], v[64:67]
buffer_load_dwordx4 v[184:187], v39, s[32:35], s57 offen offset:1024 sc1
v_mfma_f32_16x16x32_bf16 v[68:71], v[228:231], v[212:215], v[68:71]
ds_read_b64_tr_b16 v[108:109], v16 offset:4096
ds_read_b64_tr_b16 v[110:111], v16 offset:4608
v_mfma_f32_16x16x32_bf16 v[84:87], v[228:231], v[216:219], v[84:87]
ds_read_b64_tr_b16 v[112:113], v17 offset:4096
ds_read_b64_tr_b16 v[114:115], v17 offset:4608
v_mfma_f32_16x16x32_bf16 v[88:91], v[232:235], v[216:219], v[88:91]
s_add_u32 s57, s57, 2048
s_and_b32 s57, s57, 0x7fff
v_mfma_f32_16x16x32_bf16 v[72:75], v[232:235], v[212:215], v[72:75]
s_waitcnt vmcnt(6) lgkmcnt(8)
v_mfma_f32_16x16x32_bf16 v[60:63], v[236:239], v[156:159], v[60:63]
buffer_load_dwordx4 v[188:191], v38, s[32:35], s57 offen sc1
v_mfma_f32_16x16x32_bf16 v[76:79], v[236:239], v[160:163], v[76:79]
ds_read_b64_tr_b16 v[220:221], v14 offset:8192
ds_read_b64_tr_b16 v[222:223], v14 offset:8704
v_mfma_f32_16x16x32_bf16 v[80:83], v[240:243], v[160:163], v[80:83]
ds_read_b64_tr_b16 v[224:225], v15 offset:8192
ds_read_b64_tr_b16 v[226:227], v15 offset:8704
v_mfma_f32_16x16x32_bf16 v[64:67], v[240:243], v[156:159], v[64:67]
buffer_load_dwordx4 v[192:195], v39, s[32:35], s57 offen sc1
v_mfma_f32_16x16x32_bf16 v[68:71], v[244:247], v[156:159], v[68:71]
ds_read_b64_tr_b16 v[228:229], v16 offset:8192
ds_read_b64_tr_b16 v[230:231], v16 offset:8704
v_mfma_f32_16x16x32_bf16 v[84:87], v[244:247], v[160:163], v[84:87]
ds_read_b64_tr_b16 v[232:233], v17 offset:8192
ds_read_b64_tr_b16 v[234:235], v17 offset:8704
v_mfma_f32_16x16x32_bf16 v[88:91], v[248:251], v[160:163], v[88:91]
v_mfma_f32_16x16x32_bf16 v[72:75], v[248:251], v[156:159], v[72:75]
s_waitcnt vmcnt(6) lgkmcnt(8)
v_mfma_f32_16x16x32_bf16 v[60:63], v[100:103], v[164:167], v[60:63]
buffer_load_dwordx4 v[196:199], v38, s[32:35], s57 offen offset:1024 sc1
v_mfma_f32_16x16x32_bf16 v[76:79], v[100:103], v[168:171], v[76:79]
ds_read_b64_tr_b16 v[236:237], v14 offset:12288
ds_read_b64_tr_b16 v[238:239], v14 offset:12800
v_mfma_f32_16x16x32_bf16 v[80:83], v[104:107], v[168:171], v[80:83]
ds_read_b64_tr_b16 v[240:241], v15 offset:12288
ds_read_b64_tr_b16 v[242:243], v15 offset:12800
v_mfma_f32_16x16x32_bf16 v[64:67], v[104:107], v[164:167], v[64:67]
buffer_load_dwordx4 v[200:203], v39, s[32:35], s57 offen offset:1024 sc1
v_mfma_f32_16x16x32_bf16 v[68:71], v[108:111], v[164:167], v[68:71]
ds_read_b64_tr_b16 v[244:245], v16 offset:12288
ds_read_b64_tr_b16 v[246:247], v16 offset:12800
v_mfma_f32_16x16x32_bf16 v[84:87], v[108:111], v[168:171], v[84:87]
ds_read_b64_tr_b16 v[248:249], v17 offset:12288
ds_read_b64_tr_b16 v[250:251], v17 offset:12800
v_mfma_f32_16x16x32_bf16 v[88:91], v[112:115], v[168:171], v[88:91]
s_add_u32 s57, s57, 2048
s_and_b32 s57, s57, 0x7fff
v_mfma_f32_16x16x32_bf16 v[72:75], v[112:115], v[164:167], v[72:75]
s_waitcnt vmcnt(6) lgkmcnt(8)
v_mfma_f32_16x16x32_bf16 v[60:63], v[220:223], v[172:175], v[60:63]
buffer_load_dwordx4 v[204:207], v38, s[32:35], s57 offen sc1
v_mfma_f32_16x16x32_bf16 v[76:79], v[220:223], v[176:179], v[76:79]
ds_read_b64_tr_b16 v[100:101], v14 offset:16384
ds_read_b64_tr_b16 v[102:103], v14 offset:16896
v_mfma_f32_16x16x32_bf16 v[80:83], v[224:227], v[176:179], v[80:83]
ds_read_b64_tr_b16 v[104:105], v15 offset:16384
ds_read_b64_tr_b16 v[106:107], v15 offset:16896
v_mfma_f32_16x16x32_bf16 v[64:67], v[224:227], v[172:175], v[64:67]
buffer_load_dwordx4 v[208:211], v39, s[32:35], s57 offen sc1
v_mfma_f32_16x16x32_bf16 v[68:71], v[228:231], v[172:175], v[68:71]
ds_read_b64_tr_b16 v[108:109], v16 offset:16384
ds_read_b64_tr_b16 v[110:111], v16 offset:16896
v_mfma_f32_16x16x32_bf16 v[84:87], v[228:231], v[176:179], v[84:87]
ds_read_b64_tr_b16 v[112:113], v17 offset:16384
ds_read_b64_tr_b16 v[114:115], v17 offset:16896
v_mfma_f32_16x16x32_bf16 v[88:91], v[232:235], v[176:179], v[88:91]
v_mfma_f32_16x16x32_bf16 v[72:75], v[232:235], v[172:175], v[72:75]
s_waitcnt vmcnt(6) lgkmcnt(8)
v_mfma_f32_16x16x32_bf16 v[60:63], v[236:239], v[180:183], v[60:63]
buffer_load_dwordx4 v[212:215], v38, s[32:35], s57 offen offset:1024 sc1
v_mfma_f32_16x16x32_bf16 v[76:79], v[236:239], v[184:187], v[76:79]
ds_read_b64_tr_b16 v[220:221], v14 offset:20480
ds_read_b64_tr_b16 v[222:223], v14 offset:20992
v_mfma_f32_16x16x32_bf16 v[80:83], v[240:243], v[184:187], v[80:83]
ds_read_b64_tr_b16 v[224:225], v15 offset:20480
ds_read_b64_tr_b16 v[226:227], v15 offset:20992
v_mfma_f32_16x16x32_bf16 v[64:67], v[240:243], v[180:183], v[64:67]
buffer_load_dwordx4 v[216:219], v39, s[32:35], s57 offen offset:1024 sc1
v_mfma_f32_16x16x32_bf16 v[68:71], v[244:247], v[180:183], v[68:71]
ds_read_b64_tr_b16 v[228:229], v16 offset:20480
ds_read_b64_tr_b16 v[230:231], v16 offset:20992
v_mfma_f32_16x16x32_bf16 v[84:87], v[244:247], v[184:187], v[84:87]
ds_read_b64_tr_b16 v[232:233], v17 offset:20480
ds_read_b64_tr_b16 v[234:235], v17 offset:20992
v_mfma_f32_16x16x32_bf16 v[88:91], v[248:251], v[184:187], v[88:91]
s_add_u32 s57, s57, 2048
s_and_b32 s57, s57, 0x7fff
v_mfma_f32_16x16x32_bf16 v[72:75], v[248:251], v[180:183], v[72:75]
s_waitcnt vmcnt(6) lgkmcnt(8)
v_mfma_f32_16x16x32_bf16 v[60:63], v[100:103], v[188:191], v[60:63]
buffer_load_dwordx4 v[156:159], v38, s[32:35], s57 offen sc1
v_mfma_f32_16x16x32_bf16 v[76:79], v[100:103], v[192:195], v[76:79]
ds_read_b64_tr_b16 v[236:237], v14 offset:24576
ds_read_b64_tr_b16 v[238:239], v14 offset:25088
v_mfma_f32_16x16x32_bf16 v[80:83], v[104:107], v[192:195], v[80:83]
ds_read_b64_tr_b16 v[240:241], v15 offset:24576
ds_read_b64_tr_b16 v[242:243], v15 offset:25088
v_mfma_f32_16x16x32_bf16 v[64:67], v[104:107], v[188:191], v[64:67]
buffer_load_dwordx4 v[160:163], v39, s[32:35], s57 offen sc1
v_mfma_f32_16x16x32_bf16 v[68:71], v[108:111], v[188:191], v[68:71]
ds_read_b64_tr_b16 v[244:245], v16 offset:24576
ds_read_b64_tr_b16 v[246:247], v16 offset:25088
v_mfma_f32_16x16x32_bf16 v[84:87], v[108:111], v[192:195], v[84:87]
ds_read_b64_tr_b16 v[248:249], v17 offset:24576
ds_read_b64_tr_b16 v[250:251], v17 offset:25088
v_mfma_f32_16x16x32_bf16 v[88:91], v[112:115], v[192:195], v[88:91]
v_mfma_f32_16x16x32_bf16 v[72:75], v[112:115], v[188:191], v[72:75]
s_waitcnt vmcnt(6) lgkmcnt(8)
v_mfma_f32_16x16x32_bf16 v[60:63], v[220:223], v[196:199], v[60:63]
buffer_load_dwordx4 v[164:167], v38, s[32:35], s57 offen offset:1024 sc1
v_mfma_f32_16x16x32_bf16 v[76:79], v[220:223], v[200:203], v[76:79]
ds_read_b64_tr_b16 v[100:101], v14 offset:28672
ds_read_b64_tr_b16 v[102:103], v14 offset:29184
v_mfma_f32_16x16x32_bf16 v[80:83], v[224:227], v[200:203], v[80:83]
ds_read_b64_tr_b16 v[104:105], v15 offset:28672
ds_read_b64_tr_b16 v[106:107], v15 offset:29184
v_mfma_f32_16x16x32_bf16 v[64:67], v[224:227], v[196:199], v[64:67]
buffer_load_dwordx4 v[168:171], v39, s[32:35], s57 offen offset:1024 sc1
v_mfma_f32_16x16x32_bf16 v[68:71], v[228:231], v[196:199], v[68:71]
ds_read_b64_tr_b16 v[108:109], v16 offset:28672
ds_read_b64_tr_b16 v[110:111], v16 offset:29184
v_mfma_f32_16x16x32_bf16 v[84:87], v[228:231], v[200:203], v[84:87]
ds_read_b64_tr_b16 v[112:113], v17 offset:28672
ds_read_b64_tr_b16 v[114:115], v17 offset:29184
v_mfma_f32_16x16x32_bf16 v[88:91], v[232:235], v[200:203], v[88:91]
s_add_u32 s57, s57, 2048
s_and_b32 s57, s57, 0x7fff
v_mfma_f32_16x16x32_bf16 v[72:75], v[232:235], v[196:199], v[72:75]
s_waitcnt vmcnt(6) lgkmcnt(8)
v_mfma_f32_16x16x32_bf16 v[60:63], v[236:239], v[204:207], v[60:63]
buffer_load_dwordx4 v[172:175], v38, s[32:35], s57 offen sc1
v_mfma_f32_16x16x32_bf16 v[76:79], v[236:239], v[208:211], v[76:79]
ds_read_b64_tr_b16 v[220:221], v14 offset:32768
ds_read_b64_tr_b16 v[222:223], v14 offset:33280
v_mfma_f32_16x16x32_bf16 v[80:83], v[240:243], v[208:211], v[80:83]
ds_read_b64_tr_b16 v[224:225], v15 offset:32768
ds_read_b64_tr_b16 v[226:227], v15 offset:33280
v_mfma_f32_16x16x32_bf16 v[64:67], v[240:243], v[204:207], v[64:67]
buffer_load_dwordx4 v[176:179], v39, s[32:35], s57 offen sc1
v_mfma_f32_16x16x32_bf16 v[68:71], v[244:247], v[204:207], v[68:71]
ds_read_b64_tr_b16 v[228:229], v16 offset:32768
ds_read_b64_tr_b16 v[230:231], v16 offset:33280
v_mfma_f32_16x16x32_bf16 v[84:87], v[244:247], v[208:211], v[84:87]
ds_read_b64_tr_b16 v[232:233], v17 offset:32768
ds_read_b64_tr_b16 v[234:235], v17 offset:33280
v_mfma_f32_16x16x32_bf16 v[88:91], v[248:251], v[208:211], v[88:91]
v_mfma_f32_16x16x32_bf16 v[72:75], v[248:251], v[204:207], v[72:75]
s_waitcnt vmcnt(6) lgkmcnt(8)
v_mfma_f32_16x16x32_bf16 v[60:63], v[100:103], v[212:215], v[60:63]
buffer_load_dwordx4 v[180:183], v38, s[32:35], s57 offen offset:1024 sc1
v_mfma_f32_16x16x32_bf16 v[76:79], v[100:103], v[216:219], v[76:79]
ds_read_b64_tr_b16 v[236:237], v14 offset:36864
ds_read_b64_tr_b16 v[238:239], v14 offset:37376
v_mfma_f32_16x16x32_bf16 v[80:83], v[104:107], v[216:219], v[80:83]
ds_read_b64_tr_b16 v[240:241], v15 offset:36864
ds_read_b64_tr_b16 v[242:243], v15 offset:37376
v_mfma_f32_16x16x32_bf16 v[64:67], v[104:107], v[212:215], v[64:67]
buffer_load_dwordx4 v[184:187], v39, s[32:35], s57 offen offset:1024 sc1
v_mfma_f32_16x16x32_bf16 v[68:71], v[108:111], v[212:215], v[68:71]
ds_read_b64_tr_b16 v[244:245], v16 offset:36864
ds_read_b64_tr_b16 v[246:247], v16 offset:37376
v_mfma_f32_16x16x32_bf16 v[84:87], v[108:111], v[216:219], v[84:87]
ds_read_b64_tr_b16 v[248:249], v17 offset:36864
ds_read_b64_tr_b16 v[250:251], v17 offset:37376
v_mfma_f32_16x16x32_bf16 v[88:91], v[112:115], v[216:219], v[88:91]
s_add_u32 s57, s57, 2048
s_and_b32 s57, s57, 0x7fff
v_mfma_f32_16x16x32_bf16 v[72:75], v[112:115], v[212:215], v[72:75]
s_waitcnt vmcnt(6) lgkmcnt(8)
v_mfma_f32_16x16x32_bf16 v[60:63], v[220:223], v[156:159], v[60:63]
buffer_load_dwordx4 v[188:191], v38, s[32:35], s57 offen sc1
v_mfma_f32_16x16x32_bf16 v[76:79], v[220:223], v[160:163], v[76:79]
ds_read_b64_tr_b16 v[100:101], v14 offset:40960
ds_read_b64_tr_b16 v[102:103], v14 offset:41472
v_mfma_f32_16x16x32_bf16 v[80:83], v[224:227], v[160:163], v[80:83]
ds_read_b64_tr_b16 v[104:105], v15 offset:40960
ds_read_b64_tr_b16 v[106:107], v15 offset:41472
v_mfma_f32_16x16x32_bf16 v[64:67], v[224:227], v[156:159], v[64:67]
buffer_load_dwordx4 v[192:195], v39, s[32:35], s57 offen sc1
v_mfma_f32_16x16x32_bf16 v[68:71], v[228:231], v[156:159], v[68:71]
ds_read_b64_tr_b16 v[108:109], v16 offset:40960
ds_read_b64_tr_b16 v[110:111], v16 offset:41472
v_mfma_f32_16x16x32_bf16 v[84:87], v[228:231], v[160:163], v[84:87]
ds_read_b64_tr_b16 v[112:113], v17 offset:40960
ds_read_b64_tr_b16 v[114:115], v17 offset:41472
v_mfma_f32_16x16x32_bf16 v[88:91], v[232:235], v[160:163], v[88:91]
v_mfma_f32_16x16x32_bf16 v[72:75], v[232:235], v[156:159], v[72:75]
s_waitcnt vmcnt(6) lgkmcnt(8)
v_mfma_f32_16x16x32_bf16 v[60:63], v[236:239], v[164:167], v[60:63]
buffer_load_dwordx4 v[196:199], v38, s[32:35], s57 offen offset:1024 sc1
v_mfma_f32_16x16x32_bf16 v[76:79], v[236:239], v[168:171], v[76:79]
ds_read_b64_tr_b16 v[220:221], v14 offset:45056
ds_read_b64_tr_b16 v[222:223], v14 offset:45568
v_mfma_f32_16x16x32_bf16 v[80:83], v[240:243], v[168:171], v[80:83]
ds_read_b64_tr_b16 v[224:225], v15 offset:45056
ds_read_b64_tr_b16 v[226:227], v15 offset:45568
v_mfma_f32_16x16x32_bf16 v[64:67], v[240:243], v[164:167], v[64:67]
buffer_load_dwordx4 v[200:203], v39, s[32:35], s57 offen offset:1024 sc1
v_mfma_f32_16x16x32_bf16 v[68:71], v[244:247], v[164:167], v[68:71]
ds_read_b64_tr_b16 v[228:229], v16 offset:45056
ds_read_b64_tr_b16 v[230:231], v16 offset:45568
v_mfma_f32_16x16x32_bf16 v[84:87], v[244:247], v[168:171], v[84:87]
ds_read_b64_tr_b16 v[232:233], v17 offset:45056
ds_read_b64_tr_b16 v[234:235], v17 offset:45568
v_mfma_f32_16x16x32_bf16 v[88:91], v[248:251], v[168:171], v[88:91]
s_add_u32 s57, s57, 2048
s_and_b32 s57, s57, 0x7fff
v_mfma_f32_16x16x32_bf16 v[72:75], v[248:251], v[164:167], v[72:75]
s_waitcnt vmcnt(6) lgkmcnt(8)
v_mfma_f32_16x16x32_bf16 v[60:63], v[100:103], v[172:175], v[60:63]
buffer_load_dwordx4 v[204:207], v38, s[32:35], s57 offen sc1
v_mfma_f32_16x16x32_bf16 v[76:79], v[100:103], v[176:179], v[76:79]
ds_read_b64_tr_b16 v[236:237], v14 offset:49152
ds_read_b64_tr_b16 v[238:239], v14 offset:49664
v_mfma_f32_16x16x32_bf16 v[80:83], v[104:107], v[176:179], v[80:83]
ds_read_b64_tr_b16 v[240:241], v15 offset:49152
ds_read_b64_tr_b16 v[242:243], v15 offset:49664
v_mfma_f32_16x16x32_bf16 v[64:67], v[104:107], v[172:175], v[64:67]
buffer_load_dwordx4 v[208:211], v39, s[32:35], s57 offen sc1
v_mfma_f32_16x16x32_bf16 v[68:71], v[108:111], v[172:175], v[68:71]
ds_read_b64_tr_b16 v[244:245], v16 offset:49152
ds_read_b64_tr_b16 v[246:247], v16 offset:49664
v_mfma_f32_16x16x32_bf16 v[84:87], v[108:111], v[176:179], v[84:87]
ds_read_b64_tr_b16 v[248:249], v17 offset:49152
ds_read_b64_tr_b16 v[250:251], v17 offset:49664
v_mfma_f32_16x16x32_bf16 v[88:91], v[112:115], v[176:179], v[88:91]
v_mfma_f32_16x16x32_bf16 v[72:75], v[112:115], v[172:175], v[72:75]
s_waitcnt vmcnt(6) lgkmcnt(8)
v_mfma_f32_16x16x32_bf16 v[60:63], v[220:223], v[180:183], v[60:63]
buffer_load_dwordx4 v[212:215], v38, s[32:35], s57 offen offset:1024 sc1
v_mfma_f32_16x16x32_bf16 v[76:79], v[220:223], v[184:187], v[76:79]
ds_read_b64_tr_b16 v[100:101], v14 offset:53248
ds_read_b64_tr_b16 v[102:103], v14 offset:53760
v_mfma_f32_16x16x32_bf16 v[80:83], v[224:227], v[184:187], v[80:83]
ds_read_b64_tr_b16 v[104:105], v15 offset:53248
ds_read_b64_tr_b16 v[106:107], v15 offset:53760
v_mfma_f32_16x16x32_bf16 v[64:67], v[224:227], v[180:183], v[64:67]
buffer_load_dwordx4 v[216:219], v39, s[32:35], s57 offen offset:1024 sc1
v_mfma_f32_16x16x32_bf16 v[68:71], v[228:231], v[180:183], v[68:71]
ds_read_b64_tr_b16 v[108:109], v16 offset:53248
ds_read_b64_tr_b16 v[110:111], v16 offset:53760
v_mfma_f32_16x16x32_bf16 v[84:87], v[228:231], v[184:187], v[84:87]
ds_read_b64_tr_b16 v[112:113], v17 offset:53248
ds_read_b64_tr_b16 v[114:115], v17 offset:53760
v_mfma_f32_16x16x32_bf16 v[88:91], v[232:235], v[184:187], v[88:91]
v_mfma_f32_16x16x32_bf16 v[72:75], v[232:235], v[180:183], v[72:75]
s_waitcnt vmcnt(6) lgkmcnt(8)
v_mfma_f32_16x16x32_bf16 v[60:63], v[236:239], v[188:191], v[60:63]
v_mfma_f32_16x16x32_bf16 v[76:79], v[236:239], v[192:195], v[76:79]
ds_read_b64_tr_b16 v[220:221], v14 offset:57344
ds_read_b64_tr_b16 v[222:223], v14 offset:57856
v_mfma_f32_16x16x32_bf16 v[80:83], v[240:243], v[192:195], v[80:83]
ds_read_b64_tr_b16 v[224:225], v15 offset:57344
ds_read_b64_tr_b16 v[226:227], v15 offset:57856
v_mfma_f32_16x16x32_bf16 v[64:67], v[240:243], v[188:191], v[64:67]
v_mfma_f32_16x16x32_bf16 v[68:71], v[244:247], v[188:191], v[68:71]
ds_read_b64_tr_b16 v[228:229], v16 offset:57344
ds_read_b64_tr_b16 v[230:231], v16 offset:57856
v_mfma_f32_16x16x32_bf16 v[84:87], v[244:247], v[192:195], v[84:87]
ds_read_b64_tr_b16 v[232:233], v17 offset:57344
ds_read_b64_tr_b16 v[234:235], v17 offset:57856
v_mfma_f32_16x16x32_bf16 v[88:91], v[248:251], v[192:195], v[88:91]
v_mfma_f32_16x16x32_bf16 v[72:75], v[248:251], v[188:191], v[72:75]
s_waitcnt vmcnt(4) lgkmcnt(8)
v_mfma_f32_16x16x32_bf16 v[60:63], v[100:103], v[196:199], v[60:63]
v_mfma_f32_16x16x32_bf16 v[76:79], v[100:103], v[200:203], v[76:79]
ds_read_b64_tr_b16 v[236:237], v14 offset:61440
ds_read_b64_tr_b16 v[238:239], v14 offset:61952
v_mfma_f32_16x16x32_bf16 v[80:83], v[104:107], v[200:203], v[80:83]
ds_read_b64_tr_b16 v[240:241], v15 offset:61440
ds_read_b64_tr_b16 v[242:243], v15 offset:61952
v_mfma_f32_16x16x32_bf16 v[64:67], v[104:107], v[196:199], v[64:67]
v_mfma_f32_16x16x32_bf16 v[68:71], v[108:111], v[196:199], v[68:71]
ds_read_b64_tr_b16 v[244:245], v16 offset:61440
ds_read_b64_tr_b16 v[246:247], v16 offset:61952
v_mfma_f32_16x16x32_bf16 v[84:87], v[108:111], v[200:203], v[84:87]
ds_read_b64_tr_b16 v[248:249], v17 offset:61440
ds_read_b64_tr_b16 v[250:251], v17 offset:61952
v_mfma_f32_16x16x32_bf16 v[88:91], v[112:115], v[200:203], v[88:91]
v_mfma_f32_16x16x32_bf16 v[72:75], v[112:115], v[196:199], v[72:75]
s_waitcnt vmcnt(2) lgkmcnt(8)
v_mfma_f32_16x16x32_bf16 v[60:63], v[220:223], v[204:207], v[60:63]
v_mfma_f32_16x16x32_bf16 v[76:79], v[220:223], v[208:211], v[76:79]
v_mfma_f32_16x16x32_bf16 v[80:83], v[224:227], v[208:211], v[80:83]
v_mfma_f32_16x16x32_bf16 v[64:67], v[224:227], v[204:207], v[64:67]
v_mfma_f32_16x16x32_bf16 v[68:71], v[228:231], v[204:207], v[68:71]
v_mfma_f32_16x16x32_bf16 v[84:87], v[228:231], v[208:211], v[84:87]
v_mfma_f32_16x16x32_bf16 v[88:91], v[232:235], v[208:211], v[88:91]
v_mfma_f32_16x16x32_bf16 v[72:75], v[232:235], v[204:207], v[72:75]
s_waitcnt vmcnt(0) lgkmcnt(0)
v_mfma_f32_16x16x32_bf16 v[60:63], v[236:239], v[212:215], v[60:63]
v_mfma_f32_16x16x32_bf16 v[64:67], v[240:243], v[212:215], v[64:67]
v_mfma_f32_16x16x32_bf16 v[68:71], v[244:247], v[212:215], v[68:71]
v_mfma_f32_16x16x32_bf16 v[72:75], v[248:251], v[212:215], v[72:75]
v_mfma_f32_16x16x32_bf16 v[76:79], v[236:239], v[216:219], v[76:79]
v_mfma_f32_16x16x32_bf16 v[80:83], v[240:243], v[216:219], v[80:83]
v_mfma_f32_16x16x32_bf16 v[84:87], v[244:247], v[216:219], v[84:87]
v_mfma_f32_16x16x32_bf16 v[88:91], v[248:251], v[216:219], v[88:91]
s_cmp_eq_u32 s46, 0
s_cbranch_scc1 slow_101
s_nop 0
v_cvt_pk_bf16_f32 v20, v60, v61
v_cvt_pk_bf16_f32 v21, v62, v63
v_cvt_pk_bf16_f32 v22, v64, v65
v_cvt_pk_bf16_f32 v23, v66, v67
buffer_store_dwordx4 v[20:23], v18, s[32:35], s85 offen offset:0
v_cvt_pk_bf16_f32 v24, v68, v69
v_cvt_pk_bf16_f32 v25, v70, v71
v_cvt_pk_bf16_f32 v26, v72, v73
v_cvt_pk_bf16_f32 v27, v74, v75
buffer_store_dwordx4 v[24:27], v18, s[32:35], s85 offen offset:1024
v_cvt_pk_bf16_f32 v28, v76, v77
v_cvt_pk_bf16_f32 v29, v78, v79
v_cvt_pk_bf16_f32 v30, v80, v81
v_cvt_pk_bf16_f32 v31, v82, v83
buffer_store_dwordx4 v[28:31], v18, s[32:35], s86 offen offset:0
v_cvt_pk_bf16_f32 v32, v84, v85
v_cvt_pk_bf16_f32 v33, v86, v87
v_cvt_pk_bf16_f32 v34, v88, v89
v_cvt_pk_bf16_f32 v35, v90, v91
buffer_store_dwordx4 v[32:35], v18, s[32:35], s86 offen offset:1024
s_barrier
v_dot2c_f32_bf16 v6, v20, v48
v_dot2c_f32_bf16 v8, v20, v20
v_dot2c_f32_bf16 v7, v28, v48
v_dot2c_f32_bf16 v9, v28, v28
v_dot2c_f32_bf16 v6, v21, v48
v_dot2c_f32_bf16 v8, v21, v21
v_dot2c_f32_bf16 v7, v29, v48
v_dot2c_f32_bf16 v9, v29, v29
v_dot2c_f32_bf16 v6, v22, v48
v_dot2c_f32_bf16 v8, v22, v22
v_dot2c_f32_bf16 v7, v30, v48
v_dot2c_f32_bf16 v9, v30, v30
v_dot2c_f32_bf16 v6, v23, v48
v_dot2c_f32_bf16 v8, v23, v23
v_dot2c_f32_bf16 v7, v31, v48
v_dot2c_f32_bf16 v9, v31, v31
v_dot2c_f32_bf16 v6, v24, v48
v_dot2c_f32_bf16 v8, v24, v24
v_dot2c_f32_bf16 v7, v32, v48
v_dot2c_f32_bf16 v9, v32, v32
v_dot2c_f32_bf16 v6, v25, v48
v_dot2c_f32_bf16 v8, v25, v25
v_dot2c_f32_bf16 v7, v33, v48
v_dot2c_f32_bf16 v9, v33, v33
v_dot2c_f32_bf16 v6, v26, v48
v_dot2c_f32_bf16 v8, v26, v26
v_dot2c_f32_bf16 v7, v34, v48
v_dot2c_f32_bf16 v9, v34, v34
v_dot2c_f32_bf16 v6, v27, v48
v_dot2c_f32_bf16 v8, v27, v27
v_dot2c_f32_bf16 v7, v35, v48
v_dot2c_f32_bf16 v9, v35, v35
s_mov_b64 exec, 1
s_waitcnt vmcnt(0)
buffer_store_dword v5, v4, s[32:35], s88 offen
s_mov_b64 exec, -1
s_nop 1
v_permlane32_swap_b32 v6, v7
v_permlane32_swap_b32 v8, v9
v_add_f32 v6, v6, v7
v_add_f32 v8, v8, v9
s_nop 1
v_permlane16_swap_b32 v6, v8
s_nop 0
v_add_f32 v6, v6, v8
buffer_store_dword v6, v1, s[32:35], s87 offen
back_102:
s_lshl_b32 s49, s44, 13
v_add_u32 v10, s49, v18
v_add_u32 v11, 1024, v10
s_lshl_b32 s48, s43, 1
v_lshrrev_b32 v4, 2, v2
v_and_b32 v5, 3, v0
v_lshl_add_u32 v6, v3, 3, v4
v_lshlrev_b32 v6, 7, v6
v_lshl_add_u32 v6, v5, 3, v6
v_lshrrev_b32 v7, 1, v4
v_and_b32 v8, 1, v3
v_lshl_add_u32 v7, v8, 1, v7
v_xor_b32 v7, s48, v7
v_lshl_add_u32 v12, v7, 5, v6
v_add_u32 v12, 16384, v12
v_xor_b32 v13, 32, v12
v_mov_b32 v14, v10
v_mov_b32 v15, v11
v_add_u32 v16, 122880, v12
v_add_u32 v17, 122880, v13
v_mov_b32 v156, 0
v_mov_b32 v157, 0
v_mov_b32 v158, 0
v_mov_b32 v159, 0
v_mov_b32 v160, 0
v_mov_b32 v161, 0
v_mov_b32 v162, 0
v_mov_b32 v163, 0
v_mov_b32 v164, 0
v_mov_b32 v165, 0
v_mov_b32 v166, 0
v_mov_b32 v167, 0
v_mov_b32 v168, 0
v_mov_b32 v169, 0
v_mov_b32 v170, 0
v_mov_b32 v171, 0
v_mov_b32 v172, 0
v_mov_b32 v173, 0
v_mov_b32 v174, 0
v_mov_b32 v175, 0
v_mov_b32 v176, 0
v_mov_b32 v177, 0
v_mov_b32 v178, 0
v_mov_b32 v179, 0
v_mov_b32 v180, 0
v_mov_b32 v181, 0
v_mov_b32 v182, 0
v_mov_b32 v183, 0
v_mov_b32 v184, 0
v_mov_b32 v185, 0
v_mov_b32 v186, 0
v_mov_b32 v187, 0
v_mov_b32 v188, 0
v_mov_b32 v189, 0
v_mov_b32 v190, 0
v_mov_b32 v191, 0
v_mov_b32 v192, 0
v_mov_b32 v193, 0
v_mov_b32 v194, 0
v_mov_b32 v195, 0
v_mov_b32 v196, 0
v_mov_b32 v197, 0
v_mov_b32 v198, 0
v_mov_b32 v199, 0
v_mov_b32 v200, 0
v_mov_b32 v201, 0
v_mov_b32 v202, 0
v_mov_b32 v203, 0
v_mov_b32 v204, 0
v_mov_b32 v205, 0
v_mov_b32 v206, 0
v_mov_b32 v207, 0
v_mov_b32 v208, 0
v_mov_b32 v209, 0
v_mov_b32 v210, 0
v_mov_b32 v211, 0
v_mov_b32 v212, 0
v_mov_b32 v213, 0
v_mov_b32 v214, 0
v_mov_b32 v215, 0
v_mov_b32 v216, 0
v_mov_b32 v217, 0
v_mov_b32 v218, 0
v_mov_b32 v219, 0
v_mov_b32 v220, 0
v_mov_b32 v221, 0
v_mov_b32 v222, 0
v_mov_b32 v223, 0
v_mov_b32 v224, 0
v_mov_b32 v225, 0
v_mov_b32 v226, 0
v_mov_b32 v227, 0
v_mov_b32 v228, 0
v_mov_b32 v229, 0
v_mov_b32 v230, 0
v_mov_b32 v231, 0
v_mov_b32 v232, 0
v_mov_b32 v233, 0
v_mov_b32 v234, 0
v_mov_b32 v235, 0
v_mov_b32 v236, 0
v_mov_b32 v237, 0
v_mov_b32 v238, 0
v_mov_b32 v239, 0
v_mov_b32 v240, 0
v_mov_b32 v241, 0
v_mov_b32 v242, 0
v_mov_b32 v243, 0
v_mov_b32 v244, 0
v_mov_b32 v245, 0
v_mov_b32 v246, 0
v_mov_b32 v247, 0
v_mov_b32 v248, 0
v_mov_b32 v249, 0
v_mov_b32 v250, 0
v_mov_b32 v251, 0
s_mov_b32 s48, 0xf149f2ca
v_mov_b32 v9, s48
v_lshlrev_b32 v4, 2, v3
v_sub_u32 v4, v2, v4
v_subrev_u32 v5, 0, v4
v_and_b32 v6, 0x80000001, v5
v_cmp_eq_u32 vcc, 0, v6
v_add_u32 v5, 1, v5
v_and_b32 v6, 0x80000001, v5
v_cndmask_b32 v40, v9, 0, vcc
v_cmp_eq_u32 vcc, 0x80000001, v6
s_nop 1
v_cndmask_b32 v36, v9, 0, vcc
v_subrev_u32 v5, 1, v4
v_and_b32 v6, 0x80000001, v5
v_cmp_eq_u32 vcc, 0, v6
v_add_u32 v5, 1, v5
v_and_b32 v6, 0x80000001, v5
v_cndmask_b32 v41, v9, 0, vcc
v_cmp_eq_u32 vcc, 0x80000001, v6
s_nop 1
v_cndmask_b32 v37, v9, 0, vcc
v_subrev_u32 v5, 2, v4
v_and_b32 v6, 0x80000001, v5
v_cmp_eq_u32 vcc, 0, v6
v_add_u32 v5, 1, v5
v_and_b32 v6, 0x80000001, v5
v_cndmask_b32 v42, v9, 0, vcc
v_cmp_eq_u32 vcc, 0x80000001, v6
s_nop 1
v_cndmask_b32 v38, v9, 0, vcc
v_subrev_u32 v5, 3, v4
v_and_b32 v6, 0x80000001, v5
v_cmp_eq_u32 vcc, 0, v6
v_add_u32 v5, 1, v5
v_and_b32 v6, 0x80000001, v5
v_cndmask_b32 v43, v9, 0, vcc
v_cmp_eq_u32 vcc, 0x80000001, v6
s_nop 1
v_cndmask_b32 v39, v9, 0, vcc
s_or_b32 s48, s41, s44
s_cmp_eq_u32 s48, 0
s_cselect_b64 vcc, -1, 0
v_cndmask_b32 v44, v36, v9, vcc
v_cndmask_b32 v45, v37, v9, vcc
v_cndmask_b32 v46, v38, v9, vcc
v_cndmask_b32 v47, v39, v9, vcc
v_and_b32 v4, 1, v2
v_lshlrev_b32 v4, 4, v4
v_mov_b32 v5, 0xffff
v_lshlrev_b32 v52, v4, v5
s_lshl_b32 s48, s43, 11
s_add_u32 s48, s48, 135168
v_add_u32 v53, s48, v18
v_lshl_add_u32 v55, v0, 3, s48
s_add_u32 s48, s41, s44
s_sub_u32 s48, s48, 1
s_lshl_b32 s49, s48, 1
s_add_u32 s49, s49, s43
s_lshl_b32 s49, s49, 11
s_mul_i32 s50, s42, 65536
s_add_u32 s49, s49, s50
s_add_u32 s49, s49, 8388608
s_cmp_lt_i32 s48, 0
s_cselect_b32 s49, 0xf0000000, s49
v_add_u32 v58, s49, v18
v_lshl_add_u32 v59, v0, 3, s49
s_lshl_b32 s48, s43, 2
s_add_u32 s48, s48, 134672
v_mov_b32 v19, s48
s_lshl_b32 s48, s43, 7
s_add_u32 s48, s48, 133120
v_lshl_add_u32 v7, v3, 4, s48
v_lshl_add_u32 v54, v2, 2, s48
s_lshl_b32 s49, s44, 6
v_add_u32 v8, s49, v2
v_lshlrev_b32 v8, 3, v8
v_add_u32 v8, 131072, v8
v_lshl_add_u32 v9, v3, 2, s49
v_lshlrev_b32 v9, 2, v9
v_add_u32 v9, 132096, v9
s_mov_b32 s64, 0
s_mov_b32 s65, 0
s_mov_b32 s66, 0x3e8293ee
s_barrier
ds_read_b128 v[60:63], v14 offset:0
ds_read_b128 v[64:67], v14 offset:2048
ds_read_b128 v[68:71], v14 offset:4096
ds_read_b128 v[72:75], v14 offset:6144
ds_read_b64_tr_b16 v[84:85], v16 offset:8192
ds_read_b64_tr_b16 v[86:87], v16 offset:8704
ds_read_b64_tr_b16 v[88:89], v17 offset:8192
ds_read_b64_tr_b16 v[90:91], v17 offset:8704
ds_read_b64_tr_b16 v[92:93], v16 offset:16384
ds_read_b64_tr_b16 v[94:95], v16 offset:16896
ds_read_b64_tr_b16 v[96:97], v17 offset:16384
ds_read_b64_tr_b16 v[98:99], v17 offset:16896
ds_read_b64_tr_b16 v[76:77], v16 offset:0
ds_read_b64_tr_b16 v[78:79], v16 offset:512
ds_read_b64_tr_b16 v[80:81], v17 offset:0
ds_read_b64_tr_b16 v[82:83], v17 offset:512
s_waitcnt lgkmcnt(0)
c2_loop:
v_mfma_f32_16x16x32_bf16 v[212:215], v[84:87], v[72:75], v[212:215]
ds_read_b128 v[100:103], v15 offset:0
v_mfma_f32_16x16x32_bf16 v[204:207], v[84:87], v[68:71], v[204:207]
ds_read_b128 v[104:107], v15 offset:2048
v_mfma_f32_16x16x32_bf16 v[196:199], v[84:87], v[64:67], v[196:199]
ds_read_b128 v[108:111], v15 offset:4096
v_mfma_f32_16x16x32_bf16 v[188:191], v[84:87], v[60:63], v[188:191]
ds_read_b128 v[112:115], v15 offset:6144
v_mfma_f32_16x16x32_bf16 v[192:195], v[88:91], v[60:63], v[192:195]
ds_read_b64_tr_b16 v[124:125], v16 offset:12288
v_mfma_f32_16x16x32_bf16 v[200:203], v[88:91], v[64:67], v[200:203]
ds_read_b64_tr_b16 v[126:127], v16 offset:12800
v_mfma_f32_16x16x32_bf16 v[208:211], v[88:91], v[68:71], v[208:211]
ds_read_b64_tr_b16 v[128:129], v17 offset:12288
v_mfma_f32_16x16x32_bf16 v[216:219], v[88:91], v[72:75], v[216:219]
ds_read_b64_tr_b16 v[130:131], v17 offset:12800
v_mfma_f32_16x16x32_bf16 v[244:247], v[72:75], v[92:95], v[244:247]
ds_read_b64_tr_b16 v[132:133], v16 offset:20480
v_mfma_f32_16x16x32_bf16 v[248:251], v[72:75], v[96:99], v[248:251]
ds_read_b64_tr_b16 v[134:135], v16 offset:20992
v_mfma_f32_16x16x32_bf16 v[240:243], v[68:71], v[96:99], v[240:243]
ds_read_b64_tr_b16 v[136:137], v17 offset:20480
v_mfma_f32_16x16x32_bf16 v[236:239], v[68:71], v[92:95], v[236:239]
ds_read_b64_tr_b16 v[138:139], v17 offset:20992
v_mfma_f32_16x16x32_bf16 v[228:231], v[64:67], v[92:95], v[228:231]
ds_read_b64_tr_b16 v[116:117], v16 offset:4096
v_mfma_f32_16x16x32_bf16 v[232:235], v[64:67], v[96:99], v[232:235]
ds_read_b64_tr_b16 v[118:119], v16 offset:4608
v_mfma_f32_16x16x32_bf16 v[224:227], v[60:63], v[96:99], v[224:227]
ds_read_b64_tr_b16 v[120:121], v17 offset:4096
v_mfma_f32_16x16x32_bf16 v[220:223], v[60:63], v[92:95], v[220:223]
ds_read_b64_tr_b16 v[122:123], v17 offset:4608
v_mfma_f32_16x16x32_bf16 v[156:159], v[76:79], v[60:63], v[156:159]
s_add_u32 s65, s65, 40960
s_cmp_eq_u32 s65, 122880
v_mfma_f32_16x16x32_bf16 v[164:167], v[76:79], v[64:67], v[164:167]
s_cselect_b32 s65, 0, s65
s_add_u32 s64, s64, 1
v_mfma_f32_16x16x32_bf16 v[172:175], v[76:79], v[68:71], v[172:175]
v_add_u32 v14, s65, v10
v_add_u32 v15, s65, v11
v_mfma_f32_16x16x32_bf16 v[180:183], v[76:79], v[72:75], v[180:183]
v_add_u32 v16, s65, v12
v_add_u32 v17, s65, v13
v_mfma_f32_16x16x32_bf16 v[184:187], v[80:83], v[72:75], v[184:187]
v_mfma_f32_16x16x32_bf16 v[176:179], v[80:83], v[68:71], v[176:179]
s_cmp_eq_u32 s64, 16
s_cbranch_scc1 c2_last
v_mfma_f32_16x16x32_bf16 v[168:171], v[80:83], v[64:67], v[168:171]
s_waitcnt lgkmcnt(0)
v_mfma_f32_16x16x32_bf16 v[160:163], v[80:83], v[60:63], v[160:163]
s_barrier
v_mfma_f32_16x16x32_bf16 v[212:215], v[124:127], v[112:115], v[212:215]
ds_read_b128 v[60:63], v14 offset:0
v_mfma_f32_16x16x32_bf16 v[204:207], v[124:127], v[108:111], v[204:207]
ds_read_b128 v[64:67], v14 offset:2048
v_mfma_f32_16x16x32_bf16 v[196:199], v[124:127], v[104:107], v[196:199]
ds_read_b128 v[68:71], v14 offset:4096
v_mfma_f32_16x16x32_bf16 v[188:191], v[124:127], v[100:103], v[188:191]
ds_read_b128 v[72:75], v14 offset:6144
v_mfma_f32_16x16x32_bf16 v[192:195], v[128:131], v[100:103], v[192:195]
ds_read_b64_tr_b16 v[84:85], v16 offset:8192
v_mfma_f32_16x16x32_bf16 v[200:203], v[128:131], v[104:107], v[200:203]
ds_read_b64_tr_b16 v[86:87], v16 offset:8704
v_mfma_f32_16x16x32_bf16 v[208:211], v[128:131], v[108:111], v[208:211]
ds_read_b64_tr_b16 v[88:89], v17 offset:8192
v_mfma_f32_16x16x32_bf16 v[216:219], v[128:131], v[112:115], v[216:219]
ds_read_b64_tr_b16 v[90:91], v17 offset:8704
v_mfma_f32_16x16x32_bf16 v[244:247], v[112:115], v[132:135], v[244:247]
ds_read_b64_tr_b16 v[92:93], v16 offset:16384
v_mfma_f32_16x16x32_bf16 v[248:251], v[112:115], v[136:139], v[248:251]
ds_read_b64_tr_b16 v[94:95], v16 offset:16896
v_mfma_f32_16x16x32_bf16 v[240:243], v[108:111], v[136:139], v[240:243]
ds_read_b64_tr_b16 v[96:97], v17 offset:16384
v_mfma_f32_16x16x32_bf16 v[236:239], v[108:111], v[132:135], v[236:239]
ds_read_b64_tr_b16 v[98:99], v17 offset:16896
v_mfma_f32_16x16x32_bf16 v[228:231], v[104:107], v[132:135], v[228:231]
ds_read_b64_tr_b16 v[76:77], v16 offset:0
v_mfma_f32_16x16x32_bf16 v[232:235], v[104:107], v[136:139], v[232:235]
ds_read_b64_tr_b16 v[78:79], v16 offset:512
v_mfma_f32_16x16x32_bf16 v[224:227], v[100:103], v[136:139], v[224:227]
ds_read_b64_tr_b16 v[80:81], v17 offset:0
v_mfma_f32_16x16x32_bf16 v[220:223], v[100:103], v[132:135], v[220:223]
ds_read_b64_tr_b16 v[82:83], v17 offset:512
v_mfma_f32_16x16x32_bf16 v[156:159], v[116:119], v[100:103], v[156:159]
v_mfma_f32_16x16x32_bf16 v[164:167], v[116:119], v[104:107], v[164:167]
v_mfma_f32_16x16x32_bf16 v[172:175], v[116:119], v[108:111], v[172:175]
v_mfma_f32_16x16x32_bf16 v[180:183], v[116:119], v[112:115], v[180:183]
v_mfma_f32_16x16x32_bf16 v[184:187], v[120:123], v[112:115], v[184:187]
v_mfma_f32_16x16x32_bf16 v[176:179], v[120:123], v[108:111], v[176:179]
v_mfma_f32_16x16x32_bf16 v[168:171], v[120:123], v[104:107], v[168:171]
s_waitcnt lgkmcnt(0)
v_mfma_f32_16x16x32_bf16 v[160:163], v[120:123], v[100:103], v[160:163]
s_branch c2_loop
c2_last:
v_mfma_f32_16x16x32_bf16 v[168:171], v[80:83], v[64:67], v[168:171]
s_waitcnt lgkmcnt(0)
v_mfma_f32_16x16x32_bf16 v[160:163], v[80:83], v[60:63], v[160:163]
v_mfma_f32_16x16x32_bf16 v[212:215], v[124:127], v[112:115], v[212:215]
v_mfma_f32_16x16x32_bf16 v[204:207], v[124:127], v[108:111], v[204:207]
v_mfma_f32_16x16x32_bf16 v[196:199], v[124:127], v[104:107], v[196:199]
v_mfma_f32_16x16x32_bf16 v[188:191], v[124:127], v[100:103], v[188:191]
v_mfma_f32_16x16x32_bf16 v[192:195], v[128:131], v[100:103], v[192:195]
v_mfma_f32_16x16x32_bf16 v[200:203], v[128:131], v[104:107], v[200:203]
v_mfma_f32_16x16x32_bf16 v[208:211], v[128:131], v[108:111], v[208:211]
v_mfma_f32_16x16x32_bf16 v[216:219], v[128:131], v[112:115], v[216:219]
s_barrier
v_mfma_f32_16x16x32_bf16 v[244:247], v[112:115], v[132:135], v[244:247]
ds_read_b128 v[140:143], v7 offset:0
ds_read_b128 v[144:147], v7 offset:64
v_mfma_f32_16x16x32_bf16 v[248:251], v[112:115], v[136:139], v[248:251]
ds_read_b128 v[148:151], v7 offset:256
ds_read_b128 v[152:155], v7 offset:320
v_mfma_f32_16x16x32_bf16 v[240:243], v[108:111], v[136:139], v[240:243]
ds_read_b64 v[92:93], v8 offset:0
ds_read_b64 v[94:95], v8 offset:128
v_mfma_f32_16x16x32_bf16 v[236:239], v[108:111], v[132:135], v[236:239]
ds_read_b64 v[96:97], v8 offset:256
ds_read_b64 v[98:99], v8 offset:384
v_mfma_f32_16x16x32_bf16 v[228:231], v[104:107], v[132:135], v[228:231]
ds_read2_b32 v[56:57], v54 offset0:128 offset1:144
v_mfma_f32_16x16x32_bf16 v[232:235], v[104:107], v[136:139], v[232:235]
ds_read_b128 v[60:63], v9 offset:0
v_mfma_f32_16x16x32_bf16 v[224:227], v[100:103], v[136:139], v[224:227]
ds_read_b128 v[64:67], v9 offset:64
v_mfma_f32_16x16x32_bf16 v[220:223], v[100:103], v[132:135], v[220:223]
ds_read_b128 v[68:71], v9 offset:128
v_mfma_f32_16x16x32_bf16 v[156:159], v[116:119], v[100:103], v[156:159]
ds_read_b128 v[72:75], v9 offset:192
v_mfma_f32_16x16x32_bf16 v[164:167], v[116:119], v[104:107], v[164:167]
ds_read_b128 v[76:79], v9 offset:512
v_mfma_f32_16x16x32_bf16 v[172:175], v[116:119], v[108:111], v[172:175]
ds_read_b128 v[80:83], v9 offset:576
v_mfma_f32_16x16x32_bf16 v[180:183], v[116:119], v[112:115], v[180:183]
ds_read_b128 v[84:87], v9 offset:640
v_mfma_f32_16x16x32_bf16 v[184:187], v[120:123], v[112:115], v[184:187]
ds_read_b128 v[88:91], v9 offset:704
v_mfma_f32_16x16x32_bf16 v[176:179], v[120:123], v[108:111], v[176:179]
v_mfma_f32_16x16x32_bf16 v[168:171], v[120:123], v[104:107], v[168:171]
v_mfma_f32_16x16x32_bf16 v[160:163], v[120:123], v[100:103], v[160:163]
c2_epi:
s_waitcnt lgkmcnt(0)
.p2align 3
v_pk_fma_f32 v[212:213], v[148:149], v[98:99], v[212:213] op_sel:[0,1,0] op_sel_hi:[1,1,1]
v_pk_fma_f32 v[214:215], v[150:151], v[98:99], v[214:215] op_sel:[0,1,0] op_sel_hi:[1,1,1]
v_pk_fma_f32 v[216:217], v[152:153], v[98:99], v[216:217] op_sel:[0,1,0] op_sel_hi:[1,1,1]
v_pk_fma_f32 v[218:219], v[154:155], v[98:99], v[218:219] op_sel:[0,1,0] op_sel_hi:[1,1,1]
v_pk_mul_f32 v[212:213], v[212:213], v[98:99] op_sel:[0,0] op_sel_hi:[1,0]
v_pk_mul_f32 v[214:215], v[214:215], v[98:99] op_sel:[0,0] op_sel_hi:[1,0]
v_pk_mul_f32 v[216:217], v[216:217], v[98:99] op_sel:[0,0] op_sel_hi:[1,0]
v_pk_mul_f32 v[218:219], v[218:219], v[98:99] op_sel:[0,0] op_sel_hi:[1,0]
v_cvt_pk_bf16_f32 v212, v212, v213
v_cvt_pk_bf16_f32 v213, v214, v215
v_cvt_pk_bf16_f32 v214, v216, v217
v_cvt_pk_bf16_f32 v215, v218, v219
v_pk_fma_f32 v[244:245], v[88:89], v[56:57], v[244:245] op_sel:[0,0,0] op_sel_hi:[1,0,1]
v_pk_fma_f32 v[246:247], v[90:91], v[56:57], v[246:247] op_sel:[0,0,0] op_sel_hi:[1,0,1]
v_pk_mul_f32 v[244:245], v[244:245], v[72:73]
v_pk_mul_f32 v[246:247], v[246:247], v[74:75]
v_cvt_pk_bf16_f32 v108, v244, v245
v_cvt_pk_bf16_f32 v109, v246, v247
v_pk_fma_f32 v[248:249], v[88:89], v[56:57], v[248:249] op_sel:[0,1,0] op_sel_hi:[1,1,1]
v_pk_fma_f32 v[250:251], v[90:91], v[56:57], v[250:251] op_sel:[0,1,0] op_sel_hi:[1,1,1]
v_pk_mul_f32 v[248:249], v[248:249], v[72:73]
v_pk_mul_f32 v[250:251], v[250:251], v[74:75]
v_cvt_pk_bf16_f32 v118, v248, v249
v_cvt_pk_bf16_f32 v119, v250, v251
s_cmp_lg_u32 s44, 1
s_cbranch_scc1 else_103
buffer_store_dwordx4 v[212:215], v58, s[32:35], 0 offen sc1
buffer_store_dwordx2 v[108:109], v59, s[32:35], 0 offen offset:1024 sc1
buffer_store_dwordx2 v[118:119], v59, s[32:35], 0 offen offset:1536 sc1
s_branch fi_104
else_103:
ds_write_b128 v53, v[212:215]
ds_write_b64 v55, v[108:109] offset:1024
ds_write_b64 v55, v[118:119] offset:1536
v_mov_b32 v4, 3
ds_write_b32 v19, v4
fi_104:
v_mul_f32 v124, s66, v92
v_mul_f32 v125, s66, v94
v_mul_f32 v126, s66, v96
v_mul_f32 v127, s66, v98
.p2align 3
v_pk_fma_f32 v[156:157], v[140:141], v[92:93], v[156:157] op_sel:[0,1,0] op_sel_hi:[1,1,1]
v_pk_fma_f32 v[158:159], v[142:143], v[92:93], v[158:159] op_sel:[0,1,0] op_sel_hi:[1,1,1]
v_pk_fma_f32 v[160:161], v[144:145], v[92:93], v[160:161] op_sel:[0,1,0] op_sel_hi:[1,1,1]
v_pk_fma_f32 v[162:163], v[146:147], v[92:93], v[162:163] op_sel:[0,1,0] op_sel_hi:[1,1,1]
v_cvt_pk_bf16_f32 v156, v156, v157
v_cvt_pk_bf16_f32 v157, v158, v159
v_cvt_pk_bf16_f32 v158, v160, v161
v_cvt_pk_bf16_f32 v159, v162, v163
v_pk_fma_f32 v[164:165], v[140:141], v[94:95], v[164:165] op_sel:[0,1,0] op_sel_hi:[1,1,1]
v_pk_fma_f32 v[166:167], v[142:143], v[94:95], v[166:167] op_sel:[0,1,0] op_sel_hi:[1,1,1]
v_pk_fma_f32 v[168:169], v[144:145], v[94:95], v[168:169] op_sel:[0,1,0] op_sel_hi:[1,1,1]
v_pk_fma_f32 v[170:171], v[146:147], v[94:95], v[170:171] op_sel:[0,1,0] op_sel_hi:[1,1,1]
v_cvt_pk_bf16_f32 v164, v164, v165
v_cvt_pk_bf16_f32 v165, v166, v167
v_cvt_pk_bf16_f32 v166, v168, v169
v_cvt_pk_bf16_f32 v167, v170, v171
v_pk_fma_f32 v[172:173], v[140:141], v[96:97], v[172:173] op_sel:[0,1,0] op_sel_hi:[1,1,1]
v_pk_fma_f32 v[174:175], v[142:143], v[96:97], v[174:175] op_sel:[0,1,0] op_sel_hi:[1,1,1]
v_pk_fma_f32 v[176:177], v[144:145], v[96:97], v[176:177] op_sel:[0,1,0] op_sel_hi:[1,1,1]
v_pk_fma_f32 v[178:179], v[146:147], v[96:97], v[178:179] op_sel:[0,1,0] op_sel_hi:[1,1,1]
v_cvt_pk_bf16_f32 v172, v172, v173
v_cvt_pk_bf16_f32 v173, v174, v175
v_cvt_pk_bf16_f32 v174, v176, v177
v_cvt_pk_bf16_f32 v175, v178, v179
v_pk_fma_f32 v[180:181], v[140:141], v[98:99], v[180:181] op_sel:[0,1,0] op_sel_hi:[1,1,1]
v_pk_fma_f32 v[182:183], v[142:143], v[98:99], v[182:183] op_sel:[0,1,0] op_sel_hi:[1,1,1]
v_pk_fma_f32 v[184:185], v[144:145], v[98:99], v[184:185] op_sel:[0,1,0] op_sel_hi:[1,1,1]
v_pk_fma_f32 v[186:187], v[146:147], v[98:99], v[186:187] op_sel:[0,1,0] op_sel_hi:[1,1,1]
v_cvt_pk_bf16_f32 v180, v180, v181
v_cvt_pk_bf16_f32 v181, v182, v183
v_cvt_pk_bf16_f32 v182, v184, v185
v_cvt_pk_bf16_f32 v183, v186, v187
v_pk_fma_f32 v[188:189], v[148:149], v[92:93], v[188:189] op_sel:[0,1,0] op_sel_hi:[1,1,1]
v_pk_fma_f32 v[190:191], v[150:151], v[92:93], v[190:191] op_sel:[0,1,0] op_sel_hi:[1,1,1]
v_pk_fma_f32 v[192:193], v[152:153], v[92:93], v[192:193] op_sel:[0,1,0] op_sel_hi:[1,1,1]
v_pk_fma_f32 v[194:195], v[154:155], v[92:93], v[194:195] op_sel:[0,1,0] op_sel_hi:[1,1,1]
v_pk_mul_f32 v[188:189], v[188:189], v[92:93] op_sel:[0,0] op_sel_hi:[1,0]
v_pk_mul_f32 v[190:191], v[190:191], v[92:93] op_sel:[0,0] op_sel_hi:[1,0]
v_pk_mul_f32 v[192:193], v[192:193], v[92:93] op_sel:[0,0] op_sel_hi:[1,0]
v_pk_mul_f32 v[194:195], v[194:195], v[92:93] op_sel:[0,0] op_sel_hi:[1,0]
v_cvt_pk_bf16_f32 v188, v188, v189
v_cvt_pk_bf16_f32 v189, v190, v191
v_cvt_pk_bf16_f32 v190, v192, v193
v_cvt_pk_bf16_f32 v191, v194, v195
v_pk_fma_f32 v[196:197], v[148:149], v[94:95], v[196:197] op_sel:[0,1,0] op_sel_hi:[1,1,1]
v_pk_fma_f32 v[198:199], v[150:151], v[94:95], v[198:199] op_sel:[0,1,0] op_sel_hi:[1,1,1]
v_pk_fma_f32 v[200:201], v[152:153], v[94:95], v[200:201] op_sel:[0,1,0] op_sel_hi:[1,1,1]
v_pk_fma_f32 v[202:203], v[154:155], v[94:95], v[202:203] op_sel:[0,1,0] op_sel_hi:[1,1,1]
v_pk_mul_f32 v[196:197], v[196:197], v[94:95] op_sel:[0,0] op_sel_hi:[1,0]
v_pk_mul_f32 v[198:199], v[198:199], v[94:95] op_sel:[0,0] op_sel_hi:[1,0]
v_pk_mul_f32 v[200:201], v[200:201], v[94:95] op_sel:[0,0] op_sel_hi:[1,0]
v_pk_mul_f32 v[202:203], v[202:203], v[94:95] op_sel:[0,0] op_sel_hi:[1,0]
v_cvt_pk_bf16_f32 v196, v196, v197
v_cvt_pk_bf16_f32 v197, v198, v199
v_cvt_pk_bf16_f32 v198, v200, v201
v_cvt_pk_bf16_f32 v199, v202, v203
v_pk_fma_f32 v[204:205], v[148:149], v[96:97], v[204:205] op_sel:[0,1,0] op_sel_hi:[1,1,1]
v_pk_fma_f32 v[206:207], v[150:151], v[96:97], v[206:207] op_sel:[0,1,0] op_sel_hi:[1,1,1]
v_pk_fma_f32 v[208:209], v[152:153], v[96:97], v[208:209] op_sel:[0,1,0] op_sel_hi:[1,1,1]
v_pk_fma_f32 v[210:211], v[154:155], v[96:97], v[210:211] op_sel:[0,1,0] op_sel_hi:[1,1,1]
v_pk_mul_f32 v[204:205], v[204:205], v[96:97] op_sel:[0,0] op_sel_hi:[1,0]
v_pk_mul_f32 v[206:207], v[206:207], v[96:97] op_sel:[0,0] op_sel_hi:[1,0]
v_pk_mul_f32 v[208:209], v[208:209], v[96:97] op_sel:[0,0] op_sel_hi:[1,0]
v_pk_mul_f32 v[210:211], v[210:211], v[96:97] op_sel:[0,0] op_sel_hi:[1,0]
v_cvt_pk_bf16_f32 v204, v204, v205
v_cvt_pk_bf16_f32 v205, v206, v207
v_cvt_pk_bf16_f32 v206, v208, v209
v_cvt_pk_bf16_f32 v207, v210, v211
s_cmp_lg_u32 s44, 0
s_cbranch_scc1 else_105
buffer_load_dwordx4 v[120:123], v58, s[32:35], 0 offen sc1
buffer_load_dwordx2 v[100:101], v59, s[32:35], 0 offen offset:1024 sc1
buffer_load_dwordx2 v[110:111], v59, s[32:35], 0 offen offset:1536 sc1
else_105:
.p2align 3
v_mfma_f32_16x16x32_bf16 v[216:219], v[212:215], v[180:183], v[40:43]
v_pk_fma_f32 v[220:221], v[76:77], v[56:57], v[220:221] op_sel:[0,0,0] op_sel_hi:[1,0,1]
v_pk_fma_f32 v[222:223], v[78:79], v[56:57], v[222:223] op_sel:[0,0,0] op_sel_hi:[1,0,1]
v_pk_mul_f32 v[220:221], v[220:221], v[60:61]
v_pk_mul_f32 v[222:223], v[222:223], v[62:63]
v_cvt_pk_bf16_f32 v102, v220, v221
v_mfma_f32_16x16x32_bf16 v[192:195], v[188:191], v[156:159], v[40:43]
v_cvt_pk_bf16_f32 v103, v222, v223
v_pk_fma_f32 v[224:225], v[76:77], v[56:57], v[224:225] op_sel:[0,1,0] op_sel_hi:[1,1,1]
v_pk_fma_f32 v[226:227], v[78:79], v[56:57], v[226:227] op_sel:[0,1,0] op_sel_hi:[1,1,1]
v_pk_mul_f32 v[224:225], v[224:225], v[60:61]
v_pk_mul_f32 v[226:227], v[226:227], v[62:63]
v_cvt_pk_bf16_f32 v112, v224, v225
v_mfma_f32_16x16x32_bf16 v[168:171], v[188:191], v[164:167], v[36:39]
v_cvt_pk_bf16_f32 v113, v226, v227
v_pk_fma_f32 v[228:229], v[80:81], v[56:57], v[228:229] op_sel:[0,0,0] op_sel_hi:[1,0,1]
v_pk_fma_f32 v[230:231], v[82:83], v[56:57], v[230:231] op_sel:[0,0,0] op_sel_hi:[1,0,1]
v_pk_mul_f32 v[228:229], v[228:229], v[64:65]
v_pk_mul_f32 v[230:231], v[230:231], v[66:67]
v_cvt_pk_bf16_f32 v104, v228, v229
v_mfma_f32_16x16x32_bf16 v[200:203], v[196:199], v[164:167], v[40:43]
v_cvt_pk_bf16_f32 v105, v230, v231
v_pk_fma_f32 v[232:233], v[80:81], v[56:57], v[232:233] op_sel:[0,1,0] op_sel_hi:[1,1,1]
v_pk_fma_f32 v[234:235], v[82:83], v[56:57], v[234:235] op_sel:[0,1,0] op_sel_hi:[1,1,1]
v_pk_mul_f32 v[232:233], v[232:233], v[64:65]
v_pk_mul_f32 v[234:235], v[234:235], v[66:67]
v_cvt_pk_bf16_f32 v114, v232, v233
v_mfma_f32_16x16x32_bf16 v[176:179], v[196:199], v[172:175], v[36:39]
v_cvt_pk_bf16_f32 v115, v234, v235
v_pk_fma_f32 v[236:237], v[84:85], v[56:57], v[236:237] op_sel:[0,0,0] op_sel_hi:[1,0,1]
v_pk_fma_f32 v[238:239], v[86:87], v[56:57], v[238:239] op_sel:[0,0,0] op_sel_hi:[1,0,1]
v_pk_mul_f32 v[236:237], v[236:237], v[68:69]
v_pk_mul_f32 v[238:239], v[238:239], v[70:71]
v_cvt_pk_bf16_f32 v106, v236, v237
v_mfma_f32_16x16x32_bf16 v[208:211], v[204:207], v[172:175], v[40:43]
v_cvt_pk_bf16_f32 v107, v238, v239
v_pk_fma_f32 v[240:241], v[84:85], v[56:57], v[240:241] op_sel:[0,1,0] op_sel_hi:[1,1,1]
v_pk_fma_f32 v[242:243], v[86:87], v[56:57], v[242:243] op_sel:[0,1,0] op_sel_hi:[1,1,1]
v_pk_mul_f32 v[240:241], v[240:241], v[68:69]
v_pk_mul_f32 v[242:243], v[242:243], v[70:71]
v_cvt_pk_bf16_f32 v116, v240, v241
v_mfma_f32_16x16x32_bf16 v[184:187], v[204:207], v[180:183], v[36:39]
v_cvt_pk_bf16_f32 v117, v242, v243
v_max_f32 v166, v200, v201
v_max_f32 v167, v202, v203
v_max_f32 v164, v168, v169
v_max_f32 v165, v170, v171
v_max3_f32 v129, v164, v165, v166
v_max_f32 v129, v129, v167
s_cmp_lg_u32 s44, 0
s_cbranch_scc1 else_107
s_mov_b32 s63, 0
sent_109:
s_waitcnt vmcnt(0)
v_max_u32 v4, v120, v121
v_max3_u32 v4, v4, v122, v123
v_max3_u32 v4, v4, v100, v101
v_max3_u32 v4, v4, v110, v111
v_cmp_eq_u32 vcc, -1, v4
s_cbranch_vccz sentd_110
buffer_load_dwordx4 v[120:123], v58, s[32:35], 0 offen sc1
buffer_load_dwordx2 v[100:101], v59, s[32:35], 0 offen offset:1024 sc1
buffer_load_dwordx2 v[110:111], v59, s[32:35], 0 offen offset:1536 sc1
s_add_u32 s63, s63, 1
s_cmp_lt_u32 s63, 0x80000
s_cbranch_scc1 sent_109
s_waitcnt vmcnt(0)
sentd_110:
s_branch fi_108
else_107:
s_mov_b32 s63, 0
px_111:
ds_read_b32 v4, v19
ds_read_b128 v[120:123], v53
ds_read_b64 v[100:101], v55 offset:1024
ds_read_b64 v[110:111], v55 offset:1536
s_add_u32 s63, s63, 1
s_cmp_lt_u32 s63, 0x400000
s_waitcnt lgkmcnt(0)
v_cmp_ne_u32 vcc, 3, v4
s_cbranch_vccz pxd_112
s_cbranch_scc1 px_111
pxd_112:
fi_108:
v_mfma_f32_16x16x32_bf16 v[160:163], v[120:123], v[156:159], v[44:47]
v_max_f32 v174, v208, v209
v_max_f32 v175, v210, v211
v_max_f32 v172, v176, v177
v_max_f32 v173, v178, v179
v_max3_f32 v130, v172, v173, v174
v_max_f32 v130, v130, v175
v_max_f32 v182, v216, v217
v_max_f32 v183, v218, v219
v_max_f32 v180, v184, v185
v_max_f32 v181, v186, v187
v_max3_f32 v131, v180, v181, v182
v_max_f32 v131, v131, v183
v_max_f32 v158, v192, v193
v_max_f32 v159, v194, v195
v_max_f32 v156, v160, v161
v_max_f32 v157, v162, v163
v_max3_f32 v128, v156, v157, v158
v_max_f32 v128, v128, v159
s_nop 1
v_permlane32_swap_b32 v128, v129
v_permlane32_swap_b32 v130, v131
v_max_f32 v128, v128, v129
v_max_f32 v130, v130, v131
s_nop 1
v_permlane16_swap_b32 v128, v130
s_nop 0
v_max_f32 v128, v128, v130
v_mov_b32 v130, v128
s_nop 1
v_permlane16_swap_b32 v128, v130
s_nop 0
v_mov_b32 v129, v128
v_mov_b32 v131, v130
s_nop 0
v_permlane32_swap_b32 v128, v129
v_permlane32_swap_b32 v130, v131
v_pk_mul_f32 v[128:129], v[128:129], v[124:125]
v_pk_mul_f32 v[130:131], v[130:131], v[126:127]
v_pk_fma_f32 v[156:157], v[156:157], v[124:125], v[128:129] op_sel:[0,0,0] op_sel_hi:[1,0,0] neg_lo:[0,0,1] neg_hi:[0,0,1]
v_pk_fma_f32 v[158:159], v[158:159], v[124:125], v[128:129] op_sel:[0,0,0] op_sel_hi:[1,0,0] neg_lo:[0,0,1] neg_hi:[0,0,1]
v_exp_f32 v156, v156
v_exp_f32 v157, v157
v_exp_f32 v158, v158
v_exp_f32 v159, v159
v_cvt_pk_bf16_f32 v156, v156, v156
v_cvt_pk_bf16_f32 v157, v157, v157
v_cvt_pk_bf16_f32 v158, v158, v158
v_cvt_pk_bf16_f32 v159, v159, v159
v_and_b32 v156, v52, v156
v_and_b32 v157, v52, v157
v_and_b32 v158, v52, v158
v_and_b32 v159, v52, v159
v_pk_fma_f32 v[164:165], v[164:165], v[124:125], v[128:129] op_sel:[0,1,1] op_sel_hi:[1,1,1] neg_lo:[0,0,1] neg_hi:[0,0,1]
v_pk_fma_f32 v[166:167], v[166:167], v[124:125], v[128:129] op_sel:[0,1,1] op_sel_hi:[1,1,1] neg_lo:[0,0,1] neg_hi:[0,0,1]
v_exp_f32 v164, v164
v_mfma_f32_16x16x32_bf16 v[160:163], v[48:51], v[156:159], 0
v_exp_f32 v165, v165
v_exp_f32 v166, v166
v_exp_f32 v167, v167
v_cvt_pk_bf16_f32 v164, v164, v164
v_mfma_f32_16x16x32_bf16 v[220:223], v[100:103], v[156:159], 0
v_cvt_pk_bf16_f32 v165, v165, v165
v_cvt_pk_bf16_f32 v166, v166, v166
v_cvt_pk_bf16_f32 v167, v167, v167
v_and_b32 v164, v52, v164
v_mfma_f32_16x16x32_bf16 v[224:227], v[110:113], v[156:159], 0
v_and_b32 v165, v52, v165
v_and_b32 v166, v52, v166
v_and_b32 v167, v52, v167
v_pk_fma_f32 v[172:173], v[172:173], v[126:127], v[130:131] op_sel:[0,0,0] op_sel_hi:[1,0,0] neg_lo:[0,0,1] neg_hi:[0,0,1]
v_pk_fma_f32 v[174:175], v[174:175], v[126:127], v[130:131] op_sel:[0,0,0] op_sel_hi:[1,0,0] neg_lo:[0,0,1] neg_hi:[0,0,1]
v_exp_f32 v172, v172
v_mfma_f32_16x16x32_bf16 v[168:171], v[48:51], v[164:167], 0
v_exp_f32 v173, v173
v_exp_f32 v174, v174
v_exp_f32 v175, v175
v_cvt_pk_bf16_f32 v172, v172, v172
v_mfma_f32_16x16x32_bf16 v[228:231], v[102:105], v[164:167], 0
v_cvt_pk_bf16_f32 v173, v173, v173
v_cvt_pk_bf16_f32 v174, v174, v174
v_cvt_pk_bf16_f32 v175, v175, v175
v_and_b32 v172, v52, v172
v_mfma_f32_16x16x32_bf16 v[232:235], v[112:115], v[164:167], 0
v_and_b32 v173, v52, v173
v_and_b32 v174, v52, v174
v_and_b32 v175, v52, v175
v_pk_fma_f32 v[180:181], v[180:181], v[126:127], v[130:131] op_sel:[0,1,1] op_sel_hi:[1,1,1] neg_lo:[0,0,1] neg_hi:[0,0,1]
v_pk_fma_f32 v[182:183], v[182:183], v[126:127], v[130:131] op_sel:[0,1,1] op_sel_hi:[1,1,1] neg_lo:[0,0,1] neg_hi:[0,0,1]
v_exp_f32 v180, v180
v_mfma_f32_16x16x32_bf16 v[176:179], v[48:51], v[172:175], 0
v_exp_f32 v181, v181
v_exp_f32 v182, v182
v_exp_f32 v183, v183
v_cvt_pk_bf16_f32 v180, v180, v180
v_mfma_f32_16x16x32_bf16 v[236:239], v[104:107], v[172:175], 0
v_cvt_pk_bf16_f32 v181, v181, v181
v_cvt_pk_bf16_f32 v182, v182, v182
v_cvt_pk_bf16_f32 v183, v183, v183
v_and_b32 v180, v52, v180
v_mfma_f32_16x16x32_bf16 v[240:243], v[114:117], v[172:175], 0
v_and_b32 v181, v52, v181
v_and_b32 v182, v52, v182
v_and_b32 v183, v52, v183
v_rcp_f32 v160, v160
v_rcp_f32 v168, v168
v_mfma_f32_16x16x32_bf16 v[184:187], v[48:51], v[180:183], 0
v_mfma_f32_16x16x32_bf16 v[244:247], v[106:109], v[180:183], 0
v_mfma_f32_16x16x32_bf16 v[248:251], v[116:119], v[180:183], 0
v_rcp_f32 v176, v176
s_nop 4
v_rcp_f32 v184, v184
s_cmp_eq_u32 s46, 0
s_cbranch_scc1 slow_113
.p2align 3
v_pk_mul_f32 v[220:221], v[220:221], v[160:161] op_sel:[0,0] op_sel_hi:[1,0]
v_pk_mul_f32 v[222:223], v[222:223], v[160:161] op_sel:[0,0] op_sel_hi:[1,0]
v_pk_mul_f32 v[224:225], v[224:225], v[160:161] op_sel:[0,0] op_sel_hi:[1,0]
v_pk_mul_f32 v[226:227], v[226:227], v[160:161] op_sel:[0,0] op_sel_hi:[1,0]
v_cvt_pk_bf16_f32 v220, v220, v221
v_cvt_pk_bf16_f32 v221, v222, v223
v_cvt_pk_bf16_f32 v222, v224, v225
v_cvt_pk_bf16_f32 v223, v226, v227
buffer_store_dwordx4 v[220:223], v18, s[32:35], s80 offen
v_pk_mul_f32 v[228:229], v[228:229], v[168:169] op_sel:[0,0] op_sel_hi:[1,0]
v_pk_mul_f32 v[230:231], v[230:231], v[168:169] op_sel:[0,0] op_sel_hi:[1,0]
v_pk_mul_f32 v[232:233], v[232:233], v[168:169] op_sel:[0,0] op_sel_hi:[1,0]
v_pk_mul_f32 v[234:235], v[234:235], v[168:169] op_sel:[0,0] op_sel_hi:[1,0]
v_cvt_pk_bf16_f32 v228, v228, v229
v_cvt_pk_bf16_f32 v229, v230, v231
v_cvt_pk_bf16_f32 v230, v232, v233
v_cvt_pk_bf16_f32 v231, v234, v235
buffer_store_dwordx4 v[228:231], v18, s[32:35], s81 offen
v_pk_mul_f32 v[236:237], v[236:237], v[176:177] op_sel:[0,0] op_sel_hi:[1,0]
v_pk_mul_f32 v[238:239], v[238:239], v[176:177] op_sel:[0,0] op_sel_hi:[1,0]
v_pk_mul_f32 v[240:241], v[240:241], v[176:177] op_sel:[0,0] op_sel_hi:[1,0]
v_pk_mul_f32 v[242:243], v[242:243], v[176:177] op_sel:[0,0] op_sel_hi:[1,0]
v_cvt_pk_bf16_f32 v236, v236, v237
v_cvt_pk_bf16_f32 v237, v238, v239
v_cvt_pk_bf16_f32 v238, v240, v241
v_cvt_pk_bf16_f32 v239, v242, v243
buffer_store_dwordx4 v[236:239], v18, s[32:35], s82 offen
v_pk_mul_f32 v[244:245], v[244:245], v[184:185] op_sel:[0,0] op_sel_hi:[1,0]
v_pk_mul_f32 v[246:247], v[246:247], v[184:185] op_sel:[0,0] op_sel_hi:[1,0]
v_pk_mul_f32 v[248:249], v[248:249], v[184:185] op_sel:[0,0] op_sel_hi:[1,0]
v_pk_mul_f32 v[250:251], v[250:251], v[184:185] op_sel:[0,0] op_sel_hi:[1,0]
v_cvt_pk_bf16_f32 v244, v244, v245
v_cvt_pk_bf16_f32 v245, v246, v247
v_cvt_pk_bf16_f32 v246, v248, v249
v_cvt_pk_bf16_f32 v247, v250, v251
buffer_store_dwordx4 v[244:247], v18, s[32:35], s83 offen
back_114:
s_barrier
v_and_b32 v36, 31, v0
v_lshlrev_b32 v36, 2, v36
s_lshl_b32 s62, s45, 2
v_mov_b32 v4, s62
v_mov_b32 v5, 3
s_mov_b64 exec, 1
s_waitcnt vmcnt(0)
s_cmp_eq_u32 s46, 0
s_cbranch_scc1 slow_115
buffer_store_dword v5, v4, s[32:35], s84 offen
back_116:
s_mov_b64 exec, -1
v_lshrrev_b32 v4, 2, v2
v_and_b32 v5, 3, v0
v_lshl_add_u32 v6, v3, 3, v4
v_lshlrev_b32 v6, 7, v6
v_lshl_add_u32 v6, v5, 3, v6
v_lshrrev_b32 v7, 1, v4
v_and_b32 v8, 1, v3
v_lshl_add_u32 v7, v8, 1, v7
v_lshl_add_u32 v10, v7, 5, v6
v_xor_b32 v11, 32, v10
v_xor_b32 v12, 64, v10
v_xor_b32 v13, 96, v10
v_add_u32 v14, 0x10000, v10
v_add_u32 v15, 0x10000, v11
v_add_u32 v16, 0x10000, v12
v_add_u32 v17, 0x10000, v13
ds_read_b64_tr_b16 v[220:221], v10 offset:0
ds_read_b64_tr_b16 v[222:223], v10 offset:512
ds_read_b64_tr_b16 v[224:225], v11 offset:0
ds_read_b64_tr_b16 v[226:227], v11 offset:512
ds_read_b64_tr_b16 v[228:229], v12 offset:0
ds_read_b64_tr_b16 v[230:231], v12 offset:512
ds_read_b64_tr_b16 v[232:233], v13 offset:0
ds_read_b64_tr_b16 v[234:235], v13 offset:512
ds_read_b64_tr_b16 v[236:237], v10 offset:4096
ds_read_b64_tr_b16 v[238:239], v10 offset:4608
ds_read_b64_tr_b16 v[240:241], v11 offset:4096
ds_read_b64_tr_b16 v[242:243], v11 offset:4608
ds_read_b64_tr_b16 v[244:245], v12 offset:4096
ds_read_b64_tr_b16 v[246:247], v12 offset:4608
ds_read_b64_tr_b16 v[248:249], v13 offset:4096
ds_read_b64_tr_b16 v[250:251], v13 offset:4608
s_lshl_b32 s48, s41, 3
s_lshl_b32 s49, s40, 1
s_add_u32 s48, s48, s49
s_lshl_b32 s48, s48, 15
s_add_u32 s48, s48, 4194304
v_add_u32 v38, s48, v18
v_add_u32 v39, 32768, v38
s_lshl_b32 s57, s75, 11
s_add_u32 s87, s87, 262144
v_lshlrev_b32 v60, 16, v20
v_and_b32 v61, 0xffff0000, v20
v_lshlrev_b32 v62, 16, v21
v_and_b32 v63, 0xffff0000, v21
v_lshlrev_b32 v64, 16, v22
v_and_b32 v65, 0xffff0000, v22
v_lshlrev_b32 v66, 16, v23
v_and_b32 v67, 0xffff0000, v23
v_lshlrev_b32 v68, 16, v24
v_and_b32 v69, 0xffff0000, v24
v_lshlrev_b32 v70, 16, v25
v_and_b32 v71, 0xffff0000, v25
v_lshlrev_b32 v72, 16, v26
v_and_b32 v73, 0xffff0000, v26
v_lshlrev_b32 v74, 16, v27
v_and_b32 v75, 0xffff0000, v27
v_lshlrev_b32 v76, 16, v28
v_and_b32 v77, 0xffff0000, v28
v_lshlrev_b32 v78, 16, v29
v_and_b32 v79, 0xffff0000, v29
v_lshlrev_b32 v80, 16, v30
v_and_b32 v81, 0xffff0000, v30
v_lshlrev_b32 v82, 16, v31
v_and_b32 v83, 0xffff0000, v31
v_lshlrev_b32 v84, 16, v32
v_and_b32 v85, 0xffff0000, v32
v_lshlrev_b32 v86, 16, v33
v_and_b32 v87, 0xffff0000, v33
v_lshlrev_b32 v88, 16, v34
v_and_b32 v89, 0xffff0000, v34
v_lshlrev_b32 v90, 16, v35
v_and_b32 v91, 0xffff0000, v35
v_mov_b32 v6, 0
v_mov_b32 v7, 0
v_mov_b32 v8, 0
v_mov_b32 v9, 0
s_lshl_b32 s62, s42, 2
v_mov_b32 v4, s62
v_mov_b32 v5, 3
buffer_load_dword v37, v36, s[32:35], s84 offen sc1
s_mov_b32 s63, 0
s_waitcnt vmcnt(0)
poll_117:
v_cmp_gt_u32 vcc, 3, v37
s_cbranch_vccz polled_118
buffer_load_dword v37, v36, s[32:35], s84 offen sc1
s_add_u32 s63, s63, 1
s_cmp_lt_u32 s63, 0x80000
s_waitcnt vmcnt(0)
s_cbranch_scc1 poll_117
polled_118:
buffer_load_dwordx4 v[156:159], v38, s[32:35], s57 offen sc1
buffer_load_dwordx4 v[160:163], v39, s[32:35], s57 offen sc1
buffer_load_dwordx4 v[164:167], v38, s[32:35], s57 offen offset:1024 sc1
buffer_load_dwordx4 v[168:171], v39, s[32:35], s57 offen offset:1024 sc1
s_add_u32 s57, s57, 2048
s_and_b32 s57, s57, 0x7fff
buffer_load_dwordx4 v[172:175], v38, s[32:35], s57 offen sc1
buffer_load_dwordx4 v[176:179], v39, s[32:35], s57 offen sc1
buffer_load_dwordx4 v[180:183], v38, s[32:35], s57 offen offset:1024 sc1
buffer_load_dwordx4 v[184:187], v39, s[32:35], s57 offen offset:1024 sc1
s_add_u32 s57, s57, 2048
s_and_b32 s57, s57, 0x7fff
s_waitcnt vmcnt(6) lgkmcnt(8)
v_mfma_f32_16x16x32_bf16 v[60:63], v[220:223], v[156:159], v[60:63]
buffer_load_dwordx4 v[188:191], v38, s[32:35], s57 offen sc1
v_mfma_f32_16x16x32_bf16 v[76:79], v[220:223], v[160:163], v[76:79]
ds_read_b64_tr_b16 v[100:101], v10 offset:8192
ds_read_b64_tr_b16 v[102:103], v10 offset:8704
v_mfma_f32_16x16x32_bf16 v[80:83], v[224:227], v[160:163], v[80:83]
ds_read_b64_tr_b16 v[104:105], v11 offset:8192
ds_read_b64_tr_b16 v[106:107], v11 offset:8704
v_mfma_f32_16x16x32_bf16 v[64:67], v[224:227], v[156:159], v[64:67]
buffer_load_dwordx4 v[192:195], v39, s[32:35], s57 offen sc1
v_mfma_f32_16x16x32_bf16 v[68:71], v[228:231], v[156:159], v[68:71]
ds_read_b64_tr_b16 v[108:109], v12 offset:8192
ds_read_b64_tr_b16 v[110:111], v12 offset:8704
v_mfma_f32_16x16x32_bf16 v[84:87], v[228:231], v[160:163], v[84:87]
ds_read_b64_tr_b16 v[112:113], v13 offset:8192
ds_read_b64_tr_b16 v[114:115], v13 offset:8704
v_mfma_f32_16x16x32_bf16 v[88:91], v[232:235], v[160:163], v[88:91]
v_mfma_f32_16x16x32_bf16 v[72:75], v[232:235], v[156:159], v[72:75]
s_waitcnt vmcnt(6) lgkmcnt(8)
v_mfma_f32_16x16x32_bf16 v[60:63], v[236:239], v[164:167], v[60:63]
buffer_load_dwordx4 v[196:199], v38, s[32:35], s57 offen offset:1024 sc1
v_mfma_f32_16x16x32_bf16 v[76:79], v[236:239], v[168:171], v[76:79]
ds_read_b64_tr_b16 v[220:221], v10 offset:12288
ds_read_b64_tr_b16 v[222:223], v10 offset:12800
v_mfma_f32_16x16x32_bf16 v[80:83], v[240:243], v[168:171], v[80:83]
ds_read_b64_tr_b16 v[224:225], v11 offset:12288
ds_read_b64_tr_b16 v[226:227], v11 offset:12800
v_mfma_f32_16x16x32_bf16 v[64:67], v[240:243], v[164:167], v[64:67]
buffer_load_dwordx4 v[200:203], v39, s[32:35], s57 offen offset:1024 sc1
v_mfma_f32_16x16x32_bf16 v[68:71], v[244:247], v[164:167], v[68:71]
ds_read_b64_tr_b16 v[228:229], v12 offset:12288
ds_read_b64_tr_b16 v[230:231], v12 offset:12800
v_mfma_f32_16x16x32_bf16 v[84:87], v[244:247], v[168:171], v[84:87]
ds_read_b64_tr_b16 v[232:233], v13 offset:12288
ds_read_b64_tr_b16 v[234:235], v13 offset:12800
v_mfma_f32_16x16x32_bf16 v[88:91], v[248:251], v[168:171], v[88:91]
s_add_u32 s57, s57, 2048
s_and_b32 s57, s57, 0x7fff
v_mfma_f32_16x16x32_bf16 v[72:75], v[248:251], v[164:167], v[72:75]
s_waitcnt vmcnt(6) lgkmcnt(8)
v_mfma_f32_16x16x32_bf16 v[60:63], v[100:103], v[172:175], v[60:63]
buffer_load_dwordx4 v[204:207], v38, s[32:35], s57 offen sc1
v_mfma_f32_16x16x32_bf16 v[76:79], v[100:103], v[176:179], v[76:79]
ds_read_b64_tr_b16 v[236:237], v10 offset:16384
ds_read_b64_tr_b16 v[238:239], v10 offset:16896
v_mfma_f32_16x16x32_bf16 v[80:83], v[104:107], v[176:179], v[80:83]
ds_read_b64_tr_b16 v[240:241], v11 offset:16384
ds_read_b64_tr_b16 v[242:243], v11 offset:16896
v_mfma_f32_16x16x32_bf16 v[64:67], v[104:107], v[172:175], v[64:67]
buffer_load_dwordx4 v[208:211], v39, s[32:35], s57 offen sc1
v_mfma_f32_16x16x32_bf16 v[68:71], v[108:111], v[172:175], v[68:71]
ds_read_b64_tr_b16 v[244:245], v12 offset:16384
ds_read_b64_tr_b16 v[246:247], v12 offset:16896
v_mfma_f32_16x16x32_bf16 v[84:87], v[108:111], v[176:179], v[84:87]
ds_read_b64_tr_b16 v[248:249], v13 offset:16384
ds_read_b64_tr_b16 v[250:251], v13 offset:16896
v_mfma_f32_16x16x32_bf16 v[88:91], v[112:115], v[176:179], v[88:91]
v_mfma_f32_16x16x32_bf16 v[72:75], v[112:115], v[172:175], v[72:75]
s_waitcnt vmcnt(6) lgkmcnt(8)
v_mfma_f32_16x16x32_bf16 v[60:63], v[220:223], v[180:183], v[60:63]
buffer_load_dwordx4 v[212:215], v38, s[32:35], s57 offen offset:1024 sc1
v_mfma_f32_16x16x32_bf16 v[76:79], v[220:223], v[184:187], v[76:79]
ds_read_b64_tr_b16 v[100:101], v10 offset:20480
ds_read_b64_tr_b16 v[102:103], v10 offset:20992
v_mfma_f32_16x16x32_bf16 v[80:83], v[224:227], v[184:187], v[80:83]
ds_read_b64_tr_b16 v[104:105], v11 offset:20480
ds_read_b64_tr_b16 v[106:107], v11 offset:20992
v_mfma_f32_16x16x32_bf16 v[64:67], v[224:227], v[180:183], v[64:67]
buffer_load_dwordx4 v[216:219], v39, s[32:35], s57 offen offset:1024 sc1
v_mfma_f32_16x16x32_bf16 v[68:71], v[228:231], v[180:183], v[68:71]
ds_read_b64_tr_b16 v[108:109], v12 offset:20480
ds_read_b64_tr_b16 v[110:111], v12 offset:20992
v_mfma_f32_16x16x32_bf16 v[84:87], v[228:231], v[184:187], v[84:87]
ds_read_b64_tr_b16 v[112:113], v13 offset:20480
ds_read_b64_tr_b16 v[114:115], v13 offset:20992
v_mfma_f32_16x16x32_bf16 v[88:91], v[232:235], v[184:187], v[88:91]
s_add_u32 s57, s57, 2048
s_and_b32 s57, s57, 0x7fff
v_mfma_f32_16x16x32_bf16 v[72:75], v[232:235], v[180:183], v[72:75]
s_waitcnt vmcnt(6) lgkmcnt(8)
v_mfma_f32_16x16x32_bf16 v[60:63], v[236:239], v[188:191], v[60:63]
buffer_load_dwordx4 v[156:159], v38, s[32:35], s57 offen sc1
v_mfma_f32_16x16x32_bf16 v[76:79], v[236:239], v[192:195], v[76:79]
ds_read_b64_tr_b16 v[220:221], v10 offset:24576
ds_read_b64_tr_b16 v[222:223], v10 offset:25088
v_mfma_f32_16x16x32_bf16 v[80:83], v[240:243], v[192:195], v[80:83]
ds_read_b64_tr_b16 v[224:225], v11 offset:24576
ds_read_b64_tr_b16 v[226:227], v11 offset:25088
v_mfma_f32_16x16x32_bf16 v[64:67], v[240:243], v[188:191], v[64:67]
buffer_load_dwordx4 v[160:163], v39, s[32:35], s57 offen sc1
v_mfma_f32_16x16x32_bf16 v[68:71], v[244:247], v[188:191], v[68:71]
ds_read_b64_tr_b16 v[228:229], v12 offset:24576
ds_read_b64_tr_b16 v[230:231], v12 offset:25088
v_mfma_f32_16x16x32_bf16 v[84:87], v[244:247], v[192:195], v[84:87]
ds_read_b64_tr_b16 v[232:233], v13 offset:24576
ds_read_b64_tr_b16 v[234:235], v13 offset:25088
v_mfma_f32_16x16x32_bf16 v[88:91], v[248:251], v[192:195], v[88:91]
v_mfma_f32_16x16x32_bf16 v[72:75], v[248:251], v[188:191], v[72:75]
s_waitcnt vmcnt(6) lgkmcnt(8)
v_mfma_f32_16x16x32_bf16 v[60:63], v[100:103], v[196:199], v[60:63]
buffer_load_dwordx4 v[164:167], v38, s[32:35], s57 offen offset:1024 sc1
v_mfma_f32_16x16x32_bf16 v[76:79], v[100:103], v[200:203], v[76:79]
ds_read_b64_tr_b16 v[236:237], v10 offset:28672
ds_read_b64_tr_b16 v[238:239], v10 offset:29184
v_mfma_f32_16x16x32_bf16 v[80:83], v[104:107], v[200:203], v[80:83]
ds_read_b64_tr_b16 v[240:241], v11 offset:28672
ds_read_b64_tr_b16 v[242:243], v11 offset:29184
v_mfma_f32_16x16x32_bf16 v[64:67], v[104:107], v[196:199], v[64:67]
buffer_load_dwordx4 v[168:171], v39, s[32:35], s57 offen offset:1024 sc1
v_mfma_f32_16x16x32_bf16 v[68:71], v[108:111], v[196:199], v[68:71]
ds_read_b64_tr_b16 v[244:245], v12 offset:28672
ds_read_b64_tr_b16 v[246:247], v12 offset:29184
v_mfma_f32_16x16x32_bf16 v[84:87], v[108:111], v[200:203], v[84:87]
ds_read_b64_tr_b16 v[248:249], v13 offset:28672
ds_read_b64_tr_b16 v[250:251], v13 offset:29184
v_mfma_f32_16x16x32_bf16 v[88:91], v[112:115], v[200:203], v[88:91]
s_add_u32 s57, s57, 2048
s_and_b32 s57, s57, 0x7fff
v_mfma_f32_16x16x32_bf16 v[72:75], v[112:115], v[196:199], v[72:75]
s_waitcnt vmcnt(6) lgkmcnt(8)
v_mfma_f32_16x16x32_bf16 v[60:63], v[220:223], v[204:207], v[60:63]
buffer_load_dwordx4 v[172:175], v38, s[32:35], s57 offen sc1
v_mfma_f32_16x16x32_bf16 v[76:79], v[220:223], v[208:211], v[76:79]
ds_read_b64_tr_b16 v[100:101], v10 offset:32768
ds_read_b64_tr_b16 v[102:103], v10 offset:33280
v_mfma_f32_16x16x32_bf16 v[80:83], v[224:227], v[208:211], v[80:83]
ds_read_b64_tr_b16 v[104:105], v11 offset:32768
ds_read_b64_tr_b16 v[106:107], v11 offset:33280
v_mfma_f32_16x16x32_bf16 v[64:67], v[224:227], v[204:207], v[64:67]
buffer_load_dwordx4 v[176:179], v39, s[32:35], s57 offen sc1
v_mfma_f32_16x16x32_bf16 v[68:71], v[228:231], v[204:207], v[68:71]
ds_read_b64_tr_b16 v[108:109], v12 offset:32768
ds_read_b64_tr_b16 v[110:111], v12 offset:33280
v_mfma_f32_16x16x32_bf16 v[84:87], v[228:231], v[208:211], v[84:87]
ds_read_b64_tr_b16 v[112:113], v13 offset:32768
ds_read_b64_tr_b16 v[114:115], v13 offset:33280
v_mfma_f32_16x16x32_bf16 v[88:91], v[232:235], v[208:211], v[88:91]
v_mfma_f32_16x16x32_bf16 v[72:75], v[232:235], v[204:207], v[72:75]
s_waitcnt vmcnt(6) lgkmcnt(8)
v_mfma_f32_16x16x32_bf16 v[60:63], v[236:239], v[212:215], v[60:63]
buffer_load_dwordx4 v[180:183], v38, s[32:35], s57 offen offset:1024 sc1
v_mfma_f32_16x16x32_bf16 v[76:79], v[236:239], v[216:219], v[76:79]
ds_read_b64_tr_b16 v[220:221], v10 offset:36864
ds_read_b64_tr_b16 v[222:223], v10 offset:37376
v_mfma_f32_16x16x32_bf16 v[80:83], v[240:243], v[216:219], v[80:83]
ds_read_b64_tr_b16 v[224:225], v11 offset:36864
ds_read_b64_tr_b16 v[226:227], v11 offset:37376
v_mfma_f32_16x16x32_bf16 v[64:67], v[240:243], v[212:215], v[64:67]
buffer_load_dwordx4 v[184:187], v39, s[32:35], s57 offen offset:1024 sc1
v_mfma_f32_16x16x32_bf16 v[68:71], v[244:247], v[212:215], v[68:71]
ds_read_b64_tr_b16 v[228:229], v12 offset:36864
ds_read_b64_tr_b16 v[230:231], v12 offset:37376
v_mfma_f32_16x16x32_bf16 v[84:87], v[244:247], v[216:219], v[84:87]
ds_read_b64_tr_b16 v[232:233], v13 offset:36864
ds_read_b64_tr_b16 v[234:235], v13 offset:37376
v_mfma_f32_16x16x32_bf16 v[88:91], v[248:251], v[216:219], v[88:91]
s_add_u32 s57, s57, 2048
s_and_b32 s57, s57, 0x7fff
v_mfma_f32_16x16x32_bf16 v[72:75], v[248:251], v[212:215], v[72:75]
s_waitcnt vmcnt(6) lgkmcnt(8)
v_mfma_f32_16x16x32_bf16 v[60:63], v[100:103], v[156:159], v[60:63]
buffer_load_dwordx4 v[188:191], v38, s[32:35], s57 offen sc1
v_mfma_f32_16x16x32_bf16 v[76:79], v[100:103], v[160:163], v[76:79]
ds_read_b64_tr_b16 v[236:237], v10 offset:40960
ds_read_b64_tr_b16 v[238:239], v10 offset:41472
v_mfma_f32_16x16x32_bf16 v[80:83], v[104:107], v[160:163], v[80:83]
ds_read_b64_tr_b16 v[240:241], v11 offset:40960
ds_read_b64_tr_b16 v[242:243], v11 offset:41472
v_mfma_f32_16x16x32_bf16 v[64:67], v[104:107], v[156:159], v[64:67]
buffer_load_dwordx4 v[192:195], v39, s[32:35], s57 offen sc1
v_mfma_f32_16x16x32_bf16 v[68:71], v[108:111], v[156:159], v[68:71]
ds_read_b64_tr_b16 v[244:245], v12 offset:40960
ds_read_b64_tr_b16 v[246:247], v12 offset:41472
v_mfma_f32_16x16x32_bf16 v[84:87], v[108:111], v[160:163], v[84:87]
ds_read_b64_tr_b16 v[248:249], v13 offset:40960
ds_read_b64_tr_b16 v[250:251], v13 offset:41472
v_mfma_f32_16x16x32_bf16 v[88:91], v[112:115], v[160:163], v[88:91]
v_mfma_f32_16x16x32_bf16 v[72:75], v[112:115], v[156:159], v[72:75]
s_waitcnt vmcnt(6) lgkmcnt(8)
v_mfma_f32_16x16x32_bf16 v[60:63], v[220:223], v[164:167], v[60:63]
buffer_load_dwordx4 v[196:199], v38, s[32:35], s57 offen offset:1024 sc1
v_mfma_f32_16x16x32_bf16 v[76:79], v[220:223], v[168:171], v[76:79]
ds_read_b64_tr_b16 v[100:101], v10 offset:45056
ds_read_b64_tr_b16 v[102:103], v10 offset:45568
v_mfma_f32_16x16x32_bf16 v[80:83], v[224:227], v[168:171], v[80:83]
ds_read_b64_tr_b16 v[104:105], v11 offset:45056
ds_read_b64_tr_b16 v[106:107], v11 offset:45568
v_mfma_f32_16x16x32_bf16 v[64:67], v[224:227], v[164:167], v[64:67]
buffer_load_dwordx4 v[200:203], v39, s[32:35], s57 offen offset:1024 sc1
v_mfma_f32_16x16x32_bf16 v[68:71], v[228:231], v[164:167], v[68:71]
ds_read_b64_tr_b16 v[108:109], v12 offset:45056
ds_read_b64_tr_b16 v[110:111], v12 offset:45568
v_mfma_f32_16x16x32_bf16 v[84:87], v[228:231], v[168:171], v[84:87]
ds_read_b64_tr_b16 v[112:113], v13 offset:45056
ds_read_b64_tr_b16 v[114:115], v13 offset:45568
v_mfma_f32_16x16x32_bf16 v[88:91], v[232:235], v[168:171], v[88:91]
s_add_u32 s57, s57, 2048
s_and_b32 s57, s57, 0x7fff
v_mfma_f32_16x16x32_bf16 v[72:75], v[232:235], v[164:167], v[72:75]
s_waitcnt vmcnt(6) lgkmcnt(8)
v_mfma_f32_16x16x32_bf16 v[60:63], v[236:239], v[172:175], v[60:63]
buffer_load_dwordx4 v[204:207], v38, s[32:35], s57 offen sc1
v_mfma_f32_16x16x32_bf16 v[76:79], v[236:239], v[176:179], v[76:79]
ds_read_b64_tr_b16 v[220:221], v10 offset:49152
ds_read_b64_tr_b16 v[222:223], v10 offset:49664
v_mfma_f32_16x16x32_bf16 v[80:83], v[240:243], v[176:179], v[80:83]
ds_read_b64_tr_b16 v[224:225], v11 offset:49152
ds_read_b64_tr_b16 v[226:227], v11 offset:49664
v_mfma_f32_16x16x32_bf16 v[64:67], v[240:243], v[172:175], v[64:67]
buffer_load_dwordx4 v[208:211], v39, s[32:35], s57 offen sc1
v_mfma_f32_16x16x32_bf16 v[68:71], v[244:247], v[172:175], v[68:71]
ds_read_b64_tr_b16 v[228:229], v12 offset:49152
ds_read_b64_tr_b16 v[230:231], v12 offset:49664
v_mfma_f32_16x16x32_bf16 v[84:87], v[244:247], v[176:179], v[84:87]
ds_read_b64_tr_b16 v[232:233], v13 offset:49152
ds_read_b64_tr_b16 v[234:235], v13 offset:49664
v_mfma_f32_16x16x32_bf16 v[88:91], v[248:251], v[176:179], v[88:91]
v_mfma_f32_16x16x32_bf16 v[72:75], v[248:251], v[172:175], v[72:75]
s_waitcnt vmcnt(6) lgkmcnt(8)
v_mfma_f32_16x16x32_bf16 v[60:63], v[100:103], v[180:183], v[60:63]
buffer_load_dwordx4 v[212:215], v38, s[32:35], s57 offen offset:1024 sc1
v_mfma_f32_16x16x32_bf16 v[76:79], v[100:103], v[184:187], v[76:79]
ds_read_b64_tr_b16 v[236:237], v10 offset:53248
ds_read_b64_tr_b16 v[238:239], v10 offset:53760
v_mfma_f32_16x16x32_bf16 v[80:83], v[104:107], v[184:187], v[80:83]
ds_read_b64_tr_b16 v[240:241], v11 offset:53248
ds_read_b64_tr_b16 v[242:243], v11 offset:53760
v_mfma_f32_16x16x32_bf16 v[64:67], v[104:107], v[180:183], v[64:67]
buffer_load_dwordx4 v[216:219], v39, s[32:35], s57 offen offset:1024 sc1
v_mfma_f32_16x16x32_bf16 v[68:71], v[108:111], v[180:183], v[68:71]
ds_read_b64_tr_b16 v[244:245], v12 offset:53248
ds_read_b64_tr_b16 v[246:247], v12 offset:53760
v_mfma_f32_16x16x32_bf16 v[84:87], v[108:111], v[184:187], v[84:87]
ds_read_b64_tr_b16 v[248:249], v13 offset:53248
ds_read_b64_tr_b16 v[250:251], v13 offset:53760
v_mfma_f32_16x16x32_bf16 v[88:91], v[112:115], v[184:187], v[88:91]
s_add_u32 s57, s57, 2048
s_and_b32 s57, s57, 0x7fff
v_mfma_f32_16x16x32_bf16 v[72:75], v[112:115], v[180:183], v[72:75]
s_waitcnt vmcnt(6) lgkmcnt(8)
v_mfma_f32_16x16x32_bf16 v[60:63], v[220:223], v[188:191], v[60:63]
buffer_load_dwordx4 v[156:159], v38, s[32:35], s57 offen sc1
v_mfma_f32_16x16x32_bf16 v[76:79], v[220:223], v[192:195], v[76:79]
ds_read_b64_tr_b16 v[100:101], v10 offset:57344
ds_read_b64_tr_b16 v[102:103], v10 offset:57856
v_mfma_f32_16x16x32_bf16 v[80:83], v[224:227], v[192:195], v[80:83]
ds_read_b64_tr_b16 v[104:105], v11 offset:57344
ds_read_b64_tr_b16 v[106:107], v11 offset:57856
v_mfma_f32_16x16x32_bf16 v[64:67], v[224:227], v[188:191], v[64:67]
buffer_load_dwordx4 v[160:163], v39, s[32:35], s57 offen sc1
v_mfma_f32_16x16x32_bf16 v[68:71], v[228:231], v[188:191], v[68:71]
ds_read_b64_tr_b16 v[108:109], v12 offset:57344
ds_read_b64_tr_b16 v[110:111], v12 offset:57856
v_mfma_f32_16x16x32_bf16 v[84:87], v[228:231], v[192:195], v[84:87]
ds_read_b64_tr_b16 v[112:113], v13 offset:57344
ds_read_b64_tr_b16 v[114:115], v13 offset:57856
v_mfma_f32_16x16x32_bf16 v[88:91], v[232:235], v[192:195], v[88:91]
v_mfma_f32_16x16x32_bf16 v[72:75], v[232:235], v[188:191], v[72:75]
s_waitcnt vmcnt(6) lgkmcnt(8)
v_mfma_f32_16x16x32_bf16 v[60:63], v[236:239], v[196:199], v[60:63]
buffer_load_dwordx4 v[164:167], v38, s[32:35], s57 offen offset:1024 sc1
v_mfma_f32_16x16x32_bf16 v[76:79], v[236:239], v[200:203], v[76:79]
ds_read_b64_tr_b16 v[220:221], v10 offset:61440
ds_read_b64_tr_b16 v[222:223], v10 offset:61952
v_mfma_f32_16x16x32_bf16 v[80:83], v[240:243], v[200:203], v[80:83]
ds_read_b64_tr_b16 v[224:225], v11 offset:61440
ds_read_b64_tr_b16 v[226:227], v11 offset:61952
v_mfma_f32_16x16x32_bf16 v[64:67], v[240:243], v[196:199], v[64:67]
buffer_load_dwordx4 v[168:171], v39, s[32:35], s57 offen offset:1024 sc1
v_mfma_f32_16x16x32_bf16 v[68:71], v[244:247], v[196:199], v[68:71]
ds_read_b64_tr_b16 v[228:229], v12 offset:61440
ds_read_b64_tr_b16 v[230:231], v12 offset:61952
v_mfma_f32_16x16x32_bf16 v[84:87], v[244:247], v[200:203], v[84:87]
ds_read_b64_tr_b16 v[232:233], v13 offset:61440
ds_read_b64_tr_b16 v[234:235], v13 offset:61952
v_mfma_f32_16x16x32_bf16 v[88:91], v[248:251], v[200:203], v[88:91]
s_add_u32 s57, s57, 2048
s_and_b32 s57, s57, 0x7fff
v_mfma_f32_16x16x32_bf16 v[72:75], v[248:251], v[196:199], v[72:75]
s_waitcnt vmcnt(6) lgkmcnt(8)
v_mfma_f32_16x16x32_bf16 v[60:63], v[100:103], v[204:207], v[60:63]
buffer_load_dwordx4 v[172:175], v38, s[32:35], s57 offen sc1
v_mfma_f32_16x16x32_bf16 v[76:79], v[100:103], v[208:211], v[76:79]
ds_read_b64_tr_b16 v[236:237], v14 offset:0
ds_read_b64_tr_b16 v[238:239], v14 offset:512
v_mfma_f32_16x16x32_bf16 v[80:83], v[104:107], v[208:211], v[80:83]
ds_read_b64_tr_b16 v[240:241], v15 offset:0
ds_read_b64_tr_b16 v[242:243], v15 offset:512
v_mfma_f32_16x16x32_bf16 v[64:67], v[104:107], v[204:207], v[64:67]
buffer_load_dwordx4 v[176:179], v39, s[32:35], s57 offen sc1
v_mfma_f32_16x16x32_bf16 v[68:71], v[108:111], v[204:207], v[68:71]
ds_read_b64_tr_b16 v[244:245], v16 offset:0
ds_read_b64_tr_b16 v[246:247], v16 offset:512
v_mfma_f32_16x16x32_bf16 v[84:87], v[108:111], v[208:211], v[84:87]
ds_read_b64_tr_b16 v[248:249], v17 offset:0
ds_read_b64_tr_b16 v[250:251], v17 offset:512
v_mfma_f32_16x16x32_bf16 v[88:91], v[112:115], v[208:211], v[88:91]
v_mfma_f32_16x16x32_bf16 v[72:75], v[112:115], v[204:207], v[72:75]
s_waitcnt vmcnt(6) lgkmcnt(8)
v_mfma_f32_16x16x32_bf16 v[60:63], v[220:223], v[212:215], v[60:63]
buffer_load_dwordx4 v[180:183], v38, s[32:35], s57 offen offset:1024 sc1
v_mfma_f32_16x16x32_bf16 v[76:79], v[220:223], v[216:219], v[76:79]
ds_read_b64_tr_b16 v[100:101], v14 offset:4096
ds_read_b64_tr_b16 v[102:103], v14 offset:4608
v_mfma_f32_16x16x32_bf16 v[80:83], v[224:227], v[216:219], v[80:83]
ds_read_b64_tr_b16 v[104:105], v15 offset:4096
ds_read_b64_tr_b16 v[106:107], v15 offset:4608
v_mfma_f32_16x16x32_bf16 v[64:67], v[224:227], v[212:215], v[64:67]
buffer_load_dwordx4 v[184:187], v39, s[32:35], s57 offen offset:1024 sc1
v_mfma_f32_16x16x32_bf16 v[68:71], v[228:231], v[212:215], v[68:71]
ds_read_b64_tr_b16 v[108:109], v16 offset:4096
ds_read_b64_tr_b16 v[110:111], v16 offset:4608
v_mfma_f32_16x16x32_bf16 v[84:87], v[228:231], v[216:219], v[84:87]
ds_read_b64_tr_b16 v[112:113], v17 offset:4096
ds_read_b64_tr_b16 v[114:115], v17 offset:4608
v_mfma_f32_16x16x32_bf16 v[88:91], v[232:235], v[216:219], v[88:91]
s_add_u32 s57, s57, 2048
s_and_b32 s57, s57, 0x7fff
v_mfma_f32_16x16x32_bf16 v[72:75], v[232:235], v[212:215], v[72:75]
s_waitcnt vmcnt(6) lgkmcnt(8)
v_mfma_f32_16x16x32_bf16 v[60:63], v[236:239], v[156:159], v[60:63]
buffer_load_dwordx4 v[188:191], v38, s[32:35], s57 offen sc1
v_mfma_f32_16x16x32_bf16 v[76:79], v[236:239], v[160:163], v[76:79]
ds_read_b64_tr_b16 v[220:221], v14 offset:8192
ds_read_b64_tr_b16 v[222:223], v14 offset:8704
v_mfma_f32_16x16x32_bf16 v[80:83], v[240:243], v[160:163], v[80:83]
ds_read_b64_tr_b16 v[224:225], v15 offset:8192
ds_read_b64_tr_b16 v[226:227], v15 offset:8704
v_mfma_f32_16x16x32_bf16 v[64:67], v[240:243], v[156:159], v[64:67]
buffer_load_dwordx4 v[192:195], v39, s[32:35], s57 offen sc1
v_mfma_f32_16x16x32_bf16 v[68:71], v[244:247], v[156:159], v[68:71]
ds_read_b64_tr_b16 v[228:229], v16 offset:8192
ds_read_b64_tr_b16 v[230:231], v16 offset:8704
v_mfma_f32_16x16x32_bf16 v[84:87], v[244:247], v[160:163], v[84:87]
ds_read_b64_tr_b16 v[232:233], v17 offset:8192
ds_read_b64_tr_b16 v[234:235], v17 offset:8704
v_mfma_f32_16x16x32_bf16 v[88:91], v[248:251], v[160:163], v[88:91]
v_mfma_f32_16x16x32_bf16 v[72:75], v[248:251], v[156:159], v[72:75]
s_waitcnt vmcnt(6) lgkmcnt(8)
v_mfma_f32_16x16x32_bf16 v[60:63], v[100:103], v[164:167], v[60:63]
buffer_load_dwordx4 v[196:199], v38, s[32:35], s57 offen offset:1024 sc1
v_mfma_f32_16x16x32_bf16 v[76:79], v[100:103], v[168:171], v[76:79]
ds_read_b64_tr_b16 v[236:237], v14 offset:12288
ds_read_b64_tr_b16 v[238:239], v14 offset:12800
v_mfma_f32_16x16x32_bf16 v[80:83], v[104:107], v[168:171], v[80:83]
ds_read_b64_tr_b16 v[240:241], v15 offset:12288
ds_read_b64_tr_b16 v[242:243], v15 offset:12800
v_mfma_f32_16x16x32_bf16 v[64:67], v[104:107], v[164:167], v[64:67]
buffer_load_dwordx4 v[200:203], v39, s[32:35], s57 offen offset:1024 sc1
v_mfma_f32_16x16x32_bf16 v[68:71], v[108:111], v[164:167], v[68:71]
ds_read_b64_tr_b16 v[244:245], v16 offset:12288
ds_read_b64_tr_b16 v[246:247], v16 offset:12800
v_mfma_f32_16x16x32_bf16 v[84:87], v[108:111], v[168:171], v[84:87]
ds_read_b64_tr_b16 v[248:249], v17 offset:12288
ds_read_b64_tr_b16 v[250:251], v17 offset:12800
v_mfma_f32_16x16x32_bf16 v[88:91], v[112:115], v[168:171], v[88:91]
s_add_u32 s57, s57, 2048
s_and_b32 s57, s57, 0x7fff
v_mfma_f32_16x16x32_bf16 v[72:75], v[112:115], v[164:167], v[72:75]
s_waitcnt vmcnt(6) lgkmcnt(8)
v_mfma_f32_16x16x32_bf16 v[60:63], v[220:223], v[172:175], v[60:63]
buffer_load_dwordx4 v[204:207], v38, s[32:35], s57 offen sc1
v_mfma_f32_16x16x32_bf16 v[76:79], v[220:223], v[176:179], v[76:79]
ds_read_b64_tr_b16 v[100:101], v14 offset:16384
ds_read_b64_tr_b16 v[102:103], v14 offset:16896
v_mfma_f32_16x16x32_bf16 v[80:83], v[224:227], v[176:179], v[80:83]
ds_read_b64_tr_b16 v[104:105], v15 offset:16384
ds_read_b64_tr_b16 v[106:107], v15 offset:16896
v_mfma_f32_16x16x32_bf16 v[64:67], v[224:227], v[172:175], v[64:67]
buffer_load_dwordx4 v[208:211], v39, s[32:35], s57 offen sc1
v_mfma_f32_16x16x32_bf16 v[68:71], v[228:231], v[172:175], v[68:71]
ds_read_b64_tr_b16 v[108:109], v16 offset:16384
ds_read_b64_tr_b16 v[110:111], v16 offset:16896
v_mfma_f32_16x16x32_bf16 v[84:87], v[228:231], v[176:179], v[84:87]
ds_read_b64_tr_b16 v[112:113], v17 offset:16384
ds_read_b64_tr_b16 v[114:115], v17 offset:16896
v_mfma_f32_16x16x32_bf16 v[88:91], v[232:235], v[176:179], v[88:91]
v_mfma_f32_16x16x32_bf16 v[72:75], v[232:235], v[172:175], v[72:75]
s_waitcnt vmcnt(6) lgkmcnt(8)
v_mfma_f32_16x16x32_bf16 v[60:63], v[236:239], v[180:183], v[60:63]
buffer_load_dwordx4 v[212:215], v38, s[32:35], s57 offen offset:1024 sc1
v_mfma_f32_16x16x32_bf16 v[76:79], v[236:239], v[184:187], v[76:79]
ds_read_b64_tr_b16 v[220:221], v14 offset:20480
ds_read_b64_tr_b16 v[222:223], v14 offset:20992
v_mfma_f32_16x16x32_bf16 v[80:83], v[240:243], v[184:187], v[80:83]
ds_read_b64_tr_b16 v[224:225], v15 offset:20480
ds_read_b64_tr_b16 v[226:227], v15 offset:20992
v_mfma_f32_16x16x32_bf16 v[64:67], v[240:243], v[180:183], v[64:67]
buffer_load_dwordx4 v[216:219], v39, s[32:35], s57 offen offset:1024 sc1
v_mfma_f32_16x16x32_bf16 v[68:71], v[244:247], v[180:183], v[68:71]
ds_read_b64_tr_b16 v[228:229], v16 offset:20480
ds_read_b64_tr_b16 v[230:231], v16 offset:20992
v_mfma_f32_16x16x32_bf16 v[84:87], v[244:247], v[184:187], v[84:87]
ds_read_b64_tr_b16 v[232:233], v17 offset:20480
ds_read_b64_tr_b16 v[234:235], v17 offset:20992
v_mfma_f32_16x16x32_bf16 v[88:91], v[248:251], v[184:187], v[88:91]
s_add_u32 s57, s57, 2048
s_and_b32 s57, s57, 0x7fff
v_mfma_f32_16x16x32_bf16 v[72:75], v[248:251], v[180:183], v[72:75]
s_waitcnt vmcnt(6) lgkmcnt(8)
v_mfma_f32_16x16x32_bf16 v[60:63], v[100:103], v[188:191], v[60:63]
buffer_load_dwordx4 v[156:159], v38, s[32:35], s57 offen sc1
v_mfma_f32_16x16x32_bf16 v[76:79], v[100:103], v[192:195], v[76:79]
ds_read_b64_tr_b16 v[236:237], v14 offset:24576
ds_read_b64_tr_b16 v[238:239], v14 offset:25088
v_mfma_f32_16x16x32_bf16 v[80:83], v[104:107], v[192:195], v[80:83]
ds_read_b64_tr_b16 v[240:241], v15 offset:24576
ds_read_b64_tr_b16 v[242:243], v15 offset:25088
v_mfma_f32_16x16x32_bf16 v[64:67], v[104:107], v[188:191], v[64:67]
buffer_load_dwordx4 v[160:163], v39, s[32:35], s57 offen sc1
v_mfma_f32_16x16x32_bf16 v[68:71], v[108:111], v[188:191], v[68:71]
ds_read_b64_tr_b16 v[244:245], v16 offset:24576
ds_read_b64_tr_b16 v[246:247], v16 offset:25088
v_mfma_f32_16x16x32_bf16 v[84:87], v[108:111], v[192:195], v[84:87]
ds_read_b64_tr_b16 v[248:249], v17 offset:24576
ds_read_b64_tr_b16 v[250:251], v17 offset:25088
v_mfma_f32_16x16x32_bf16 v[88:91], v[112:115], v[192:195], v[88:91]
v_mfma_f32_16x16x32_bf16 v[72:75], v[112:115], v[188:191], v[72:75]
s_waitcnt vmcnt(6) lgkmcnt(8)
v_mfma_f32_16x16x32_bf16 v[60:63], v[220:223], v[196:199], v[60:63]
buffer_load_dwordx4 v[164:167], v38, s[32:35], s57 offen offset:1024 sc1
v_mfma_f32_16x16x32_bf16 v[76:79], v[220:223], v[200:203], v[76:79]
ds_read_b64_tr_b16 v[100:101], v14 offset:28672
ds_read_b64_tr_b16 v[102:103], v14 offset:29184
v_mfma_f32_16x16x32_bf16 v[80:83], v[224:227], v[200:203], v[80:83]
ds_read_b64_tr_b16 v[104:105], v15 offset:28672
ds_read_b64_tr_b16 v[106:107], v15 offset:29184
v_mfma_f32_16x16x32_bf16 v[64:67], v[224:227], v[196:199], v[64:67]
buffer_load_dwordx4 v[168:171], v39, s[32:35], s57 offen offset:1024 sc1
v_mfma_f32_16x16x32_bf16 v[68:71], v[228:231], v[196:199], v[68:71]
ds_read_b64_tr_b16 v[108:109], v16 offset:28672
ds_read_b64_tr_b16 v[110:111], v16 offset:29184
v_mfma_f32_16x16x32_bf16 v[84:87], v[228:231], v[200:203], v[84:87]
ds_read_b64_tr_b16 v[112:113], v17 offset:28672
ds_read_b64_tr_b16 v[114:115], v17 offset:29184
v_mfma_f32_16x16x32_bf16 v[88:91], v[232:235], v[200:203], v[88:91]
s_add_u32 s57, s57, 2048
s_and_b32 s57, s57, 0x7fff
v_mfma_f32_16x16x32_bf16 v[72:75], v[232:235], v[196:199], v[72:75]
s_waitcnt vmcnt(6) lgkmcnt(8)
v_mfma_f32_16x16x32_bf16 v[60:63], v[236:239], v[204:207], v[60:63]
buffer_load_dwordx4 v[172:175], v38, s[32:35], s57 offen sc1
v_mfma_f32_16x16x32_bf16 v[76:79], v[236:239], v[208:211], v[76:79]
ds_read_b64_tr_b16 v[220:221], v14 offset:32768
ds_read_b64_tr_b16 v[222:223], v14 offset:33280
v_mfma_f32_16x16x32_bf16 v[80:83], v[240:243], v[208:211], v[80:83]
ds_read_b64_tr_b16 v[224:225], v15 offset:32768
ds_read_b64_tr_b16 v[226:227], v15 offset:33280
v_mfma_f32_16x16x32_bf16 v[64:67], v[240:243], v[204:207], v[64:67]
buffer_load_dwordx4 v[176:179], v39, s[32:35], s57 offen sc1
v_mfma_f32_16x16x32_bf16 v[68:71], v[244:247], v[204:207], v[68:71]
ds_read_b64_tr_b16 v[228:229], v16 offset:32768
ds_read_b64_tr_b16 v[230:231], v16 offset:33280
v_mfma_f32_16x16x32_bf16 v[84:87], v[244:247], v[208:211], v[84:87]
ds_read_b64_tr_b16 v[232:233], v17 offset:32768
ds_read_b64_tr_b16 v[234:235], v17 offset:33280
v_mfma_f32_16x16x32_bf16 v[88:91], v[248:251], v[208:211], v[88:91]
v_mfma_f32_16x16x32_bf16 v[72:75], v[248:251], v[204:207], v[72:75]
s_waitcnt vmcnt(6) lgkmcnt(8)
v_mfma_f32_16x16x32_bf16 v[60:63], v[100:103], v[212:215], v[60:63]
buffer_load_dwordx4 v[180:183], v38, s[32:35], s57 offen offset:1024 sc1
v_mfma_f32_16x16x32_bf16 v[76:79], v[100:103], v[216:219], v[76:79]
ds_read_b64_tr_b16 v[236:237], v14 offset:36864
ds_read_b64_tr_b16 v[238:239], v14 offset:37376
v_mfma_f32_16x16x32_bf16 v[80:83], v[104:107], v[216:219], v[80:83]
ds_read_b64_tr_b16 v[240:241], v15 offset:36864
ds_read_b64_tr_b16 v[242:243], v15 offset:37376
v_mfma_f32_16x16x32_bf16 v[64:67], v[104:107], v[212:215], v[64:67]
buffer_load_dwordx4 v[184:187], v39, s[32:35], s57 offen offset:1024 sc1
v_mfma_f32_16x16x32_bf16 v[68:71], v[108:111], v[212:215], v[68:71]
ds_read_b64_tr_b16 v[244:245], v16 offset:36864
ds_read_b64_tr_b16 v[246:247], v16 offset:37376
v_mfma_f32_16x16x32_bf16 v[84:87], v[108:111], v[216:219], v[84:87]
ds_read_b64_tr_b16 v[248:249], v17 offset:36864
ds_read_b64_tr_b16 v[250:251], v17 offset:37376
v_mfma_f32_16x16x32_bf16 v[88:91], v[112:115], v[216:219], v[88:91]
s_add_u32 s57, s57, 2048
s_and_b32 s57, s57, 0x7fff
v_mfma_f32_16x16x32_bf16 v[72:75], v[112:115], v[212:215], v[72:75]
s_waitcnt vmcnt(6) lgkmcnt(8)
v_mfma_f32_16x16x32_bf16 v[60:63], v[220:223], v[156:159], v[60:63]
buffer_load_dwordx4 v[188:191], v38, s[32:35], s57 offen sc1
v_mfma_f32_16x16x32_bf16 v[76:79], v[220:223], v[160:163], v[76:79]
ds_read_b64_tr_b16 v[100:101], v14 offset:40960
ds_read_b64_tr_b16 v[102:103], v14 offset:41472
v_mfma_f32_16x16x32_bf16 v[80:83], v[224:227], v[160:163], v[80:83]
ds_read_b64_tr_b16 v[104:105], v15 offset:40960
ds_read_b64_tr_b16 v[106:107], v15 offset:41472
v_mfma_f32_16x16x32_bf16 v[64:67], v[224:227], v[156:159], v[64:67]
buffer_load_dwordx4 v[192:195], v39, s[32:35], s57 offen sc1
v_mfma_f32_16x16x32_bf16 v[68:71], v[228:231], v[156:159], v[68:71]
ds_read_b64_tr_b16 v[108:109], v16 offset:40960
ds_read_b64_tr_b16 v[110:111], v16 offset:41472
v_mfma_f32_16x16x32_bf16 v[84:87], v[228:231], v[160:163], v[84:87]
ds_read_b64_tr_b16 v[112:113], v17 offset:40960
ds_read_b64_tr_b16 v[114:115], v17 offset:41472
v_mfma_f32_16x16x32_bf16 v[88:91], v[232:235], v[160:163], v[88:91]
v_mfma_f32_16x16x32_bf16 v[72:75], v[232:235], v[156:159], v[72:75]
s_waitcnt vmcnt(6) lgkmcnt(8)
v_mfma_f32_16x16x32_bf16 v[60:63], v[236:239], v[164:167], v[60:63]
buffer_load_dwordx4 v[196:199], v38, s[32:35], s57 offen offset:1024 sc1
v_mfma_f32_16x16x32_bf16 v[76:79], v[236:239], v[168:171], v[76:79]
ds_read_b64_tr_b16 v[220:221], v14 offset:45056
ds_read_b64_tr_b16 v[222:223], v14 offset:45568
v_mfma_f32_16x16x32_bf16 v[80:83], v[240:243], v[168:171], v[80:83]
ds_read_b64_tr_b16 v[224:225], v15 offset:45056
ds_read_b64_tr_b16 v[226:227], v15 offset:45568
v_mfma_f32_16x16x32_bf16 v[64:67], v[240:243], v[164:167], v[64:67]
buffer_load_dwordx4 v[200:203], v39, s[32:35], s57 offen offset:1024 sc1
v_mfma_f32_16x16x32_bf16 v[68:71], v[244:247], v[164:167], v[68:71]
ds_read_b64_tr_b16 v[228:229], v16 offset:45056
ds_read_b64_tr_b16 v[230:231], v16 offset:45568
v_mfma_f32_16x16x32_bf16 v[84:87], v[244:247], v[168:171], v[84:87]
ds_read_b64_tr_b16 v[232:233], v17 offset:45056
ds_read_b64_tr_b16 v[234:235], v17 offset:45568
v_mfma_f32_16x16x32_bf16 v[88:91], v[248:251], v[168:171], v[88:91]
s_add_u32 s57, s57, 2048
s_and_b32 s57, s57, 0x7fff
v_mfma_f32_16x16x32_bf16 v[72:75], v[248:251], v[164:167], v[72:75]
s_waitcnt vmcnt(6) lgkmcnt(8)
v_mfma_f32_16x16x32_bf16 v[60:63], v[100:103], v[172:175], v[60:63]
buffer_load_dwordx4 v[204:207], v38, s[32:35], s57 offen sc1
v_mfma_f32_16x16x32_bf16 v[76:79], v[100:103], v[176:179], v[76:79]
ds_read_b64_tr_b16 v[236:237], v14 offset:49152
ds_read_b64_tr_b16 v[238:239], v14 offset:49664
v_mfma_f32_16x16x32_bf16 v[80:83], v[104:107], v[176:179], v[80:83]
ds_read_b64_tr_b16 v[240:241], v15 offset:49152
ds_read_b64_tr_b16 v[242:243], v15 offset:49664
v_mfma_f32_16x16x32_bf16 v[64:67], v[104:107], v[172:175], v[64:67]
buffer_load_dwordx4 v[208:211], v39, s[32:35], s57 offen sc1
v_mfma_f32_16x16x32_bf16 v[68:71], v[108:111], v[172:175], v[68:71]
ds_read_b64_tr_b16 v[244:245], v16 offset:49152
ds_read_b64_tr_b16 v[246:247], v16 offset:49664
v_mfma_f32_16x16x32_bf16 v[84:87], v[108:111], v[176:179], v[84:87]
ds_read_b64_tr_b16 v[248:249], v17 offset:49152
ds_read_b64_tr_b16 v[250:251], v17 offset:49664
v_mfma_f32_16x16x32_bf16 v[88:91], v[112:115], v[176:179], v[88:91]
v_mfma_f32_16x16x32_bf16 v[72:75], v[112:115], v[172:175], v[72:75]
s_waitcnt vmcnt(6) lgkmcnt(8)
v_mfma_f32_16x16x32_bf16 v[60:63], v[220:223], v[180:183], v[60:63]
buffer_load_dwordx4 v[212:215], v38, s[32:35], s57 offen offset:1024 sc1
v_mfma_f32_16x16x32_bf16 v[76:79], v[220:223], v[184:187], v[76:79]
ds_read_b64_tr_b16 v[100:101], v14 offset:53248
ds_read_b64_tr_b16 v[102:103], v14 offset:53760
v_mfma_f32_16x16x32_bf16 v[80:83], v[224:227], v[184:187], v[80:83]
ds_read_b64_tr_b16 v[104:105], v15 offset:53248
ds_read_b64_tr_b16 v[106:107], v15 offset:53760
v_mfma_f32_16x16x32_bf16 v[64:67], v[224:227], v[180:183], v[64:67]
buffer_load_dwordx4 v[216:219], v39, s[32:35], s57 offen offset:1024 sc1
v_mfma_f32_16x16x32_bf16 v[68:71], v[228:231], v[180:183], v[68:71]
ds_read_b64_tr_b16 v[108:109], v16 offset:53248
ds_read_b64_tr_b16 v[110:111], v16 offset:53760
v_mfma_f32_16x16x32_bf16 v[84:87], v[228:231], v[184:187], v[84:87]
ds_read_b64_tr_b16 v[112:113], v17 offset:53248
ds_read_b64_tr_b16 v[114:115], v17 offset:53760
v_mfma_f32_16x16x32_bf16 v[88:91], v[232:235], v[184:187], v[88:91]
v_mfma_f32_16x16x32_bf16 v[72:75], v[232:235], v[180:183], v[72:75]
s_waitcnt vmcnt(6) lgkmcnt(8)
v_mfma_f32_16x16x32_bf16 v[60:63], v[236:239], v[188:191], v[60:63]
v_mfma_f32_16x16x32_bf16 v[76:79], v[236:239], v[192:195], v[76:79]
ds_read_b64_tr_b16 v[220:221], v14 offset:57344
ds_read_b64_tr_b16 v[222:223], v14 offset:57856
v_mfma_f32_16x16x32_bf16 v[80:83], v[240:243], v[192:195], v[80:83]
ds_read_b64_tr_b16 v[224:225], v15 offset:57344
ds_read_b64_tr_b16 v[226:227], v15 offset:57856
v_mfma_f32_16x16x32_bf16 v[64:67], v[240:243], v[188:191], v[64:67]
v_mfma_f32_16x16x32_bf16 v[68:71], v[244:247], v[188:191], v[68:71]
ds_read_b64_tr_b16 v[228:229], v16 offset:57344
ds_read_b64_tr_b16 v[230:231], v16 offset:57856
v_mfma_f32_16x16x32_bf16 v[84:87], v[244:247], v[192:195], v[84:87]
ds_read_b64_tr_b16 v[232:233], v17 offset:57344
ds_read_b64_tr_b16 v[234:235], v17 offset:57856
v_mfma_f32_16x16x32_bf16 v[88:91], v[248:251], v[192:195], v[88:91]
v_mfma_f32_16x16x32_bf16 v[72:75], v[248:251], v[188:191], v[72:75]
s_waitcnt vmcnt(4) lgkmcnt(8)
v_mfma_f32_16x16x32_bf16 v[60:63], v[100:103], v[196:199], v[60:63]
v_mfma_f32_16x16x32_bf16 v[76:79], v[100:103], v[200:203], v[76:79]
ds_read_b64_tr_b16 v[236:237], v14 offset:61440
ds_read_b64_tr_b16 v[238:239], v14 offset:61952
v_mfma_f32_16x16x32_bf16 v[80:83], v[104:107], v[200:203], v[80:83]
ds_read_b64_tr_b16 v[240:241], v15 offset:61440
ds_read_b64_tr_b16 v[242:243], v15 offset:61952
v_mfma_f32_16x16x32_bf16 v[64:67], v[104:107], v[196:199], v[64:67]
v_mfma_f32_16x16x32_bf16 v[68:71], v[108:111], v[196:199], v[68:71]
ds_read_b64_tr_b16 v[244:245], v16 offset:61440
ds_read_b64_tr_b16 v[246:247], v16 offset:61952
v_mfma_f32_16x16x32_bf16 v[84:87], v[108:111], v[200:203], v[84:87]
ds_read_b64_tr_b16 v[248:249], v17 offset:61440
ds_read_b64_tr_b16 v[250:251], v17 offset:61952
v_mfma_f32_16x16x32_bf16 v[88:91], v[112:115], v[200:203], v[88:91]
v_mfma_f32_16x16x32_bf16 v[72:75], v[112:115], v[196:199], v[72:75]
s_waitcnt vmcnt(2) lgkmcnt(8)
v_mfma_f32_16x16x32_bf16 v[60:63], v[220:223], v[204:207], v[60:63]
v_mfma_f32_16x16x32_bf16 v[76:79], v[220:223], v[208:211], v[76:79]
v_mfma_f32_16x16x32_bf16 v[80:83], v[224:227], v[208:211], v[80:83]
v_mfma_f32_16x16x32_bf16 v[64:67], v[224:227], v[204:207], v[64:67]
v_mfma_f32_16x16x32_bf16 v[68:71], v[228:231], v[204:207], v[68:71]
v_mfma_f32_16x16x32_bf16 v[84:87], v[228:231], v[208:211], v[84:87]
v_mfma_f32_16x16x32_bf16 v[88:91], v[232:235], v[208:211], v[88:91]
v_mfma_f32_16x16x32_bf16 v[72:75], v[232:235], v[204:207], v[72:75]
s_waitcnt vmcnt(0) lgkmcnt(0)
v_mfma_f32_16x16x32_bf16 v[60:63], v[236:239], v[212:215], v[60:63]
v_mfma_f32_16x16x32_bf16 v[64:67], v[240:243], v[212:215], v[64:67]
v_mfma_f32_16x16x32_bf16 v[68:71], v[244:247], v[212:215], v[68:71]
v_mfma_f32_16x16x32_bf16 v[72:75], v[248:251], v[212:215], v[72:75]
v_mfma_f32_16x16x32_bf16 v[76:79], v[236:239], v[216:219], v[76:79]
v_mfma_f32_16x16x32_bf16 v[80:83], v[240:243], v[216:219], v[80:83]
v_mfma_f32_16x16x32_bf16 v[84:87], v[244:247], v[216:219], v[84:87]
v_mfma_f32_16x16x32_bf16 v[88:91], v[248:251], v[216:219], v[88:91]
s_cmp_eq_u32 s46, 0
s_cbranch_scc1 slow_119
s_nop 0
v_cvt_pk_bf16_f32 v20, v60, v61
v_cvt_pk_bf16_f32 v21, v62, v63
v_cvt_pk_bf16_f32 v22, v64, v65
v_cvt_pk_bf16_f32 v23, v66, v67
buffer_store_dwordx4 v[20:23], v18, s[32:35], s85 offen offset:0
v_cvt_pk_bf16_f32 v24, v68, v69
v_cvt_pk_bf16_f32 v25, v70, v71
v_cvt_pk_bf16_f32 v26, v72, v73
v_cvt_pk_bf16_f32 v27, v74, v75
buffer_store_dwordx4 v[24:27], v18, s[32:35], s85 offen offset:1024
v_cvt_pk_bf16_f32 v28, v76, v77
v_cvt_pk_bf16_f32 v29, v78, v79
v_cvt_pk_bf16_f32 v30, v80, v81
v_cvt_pk_bf16_f32 v31, v82, v83
buffer_store_dwordx4 v[28:31], v18, s[32:35], s86 offen offset:0
v_cvt_pk_bf16_f32 v32, v84, v85
v_cvt_pk_bf16_f32 v33, v86, v87
v_cvt_pk_bf16_f32 v34, v88, v89
v_cvt_pk_bf16_f32 v35, v90, v91
buffer_store_dwordx4 v[32:35], v18, s[32:35], s86 offen offset:1024
s_barrier
v_dot2c_f32_bf16 v6, v20, v48
v_dot2c_f32_bf16 v8, v20, v20
v_dot2c_f32_bf16 v7, v28, v48
v_dot2c_f32_bf16 v9, v28, v28
v_dot2c_f32_bf16 v6, v21, v48
v_dot2c_f32_bf16 v8, v21, v21
v_dot2c_f32_bf16 v7, v29, v48
v_dot2c_f32_bf16 v9, v29, v29
v_dot2c_f32_bf16 v6, v22, v48
v_dot2c_f32_bf16 v8, v22, v22
v_dot2c_f32_bf16 v7, v30, v48
v_dot2c_f32_bf16 v9, v30, v30
v_dot2c_f32_bf16 v6, v23, v48
v_dot2c_f32_bf16 v8, v23, v23
v_dot2c_f32_bf16 v7, v31, v48
v_dot2c_f32_bf16 v9, v31, v31
v_dot2c_f32_bf16 v6, v24, v48
v_dot2c_f32_bf16 v8, v24, v24
v_dot2c_f32_bf16 v7, v32, v48
v_dot2c_f32_bf16 v9, v32, v32
v_dot2c_f32_bf16 v6, v25, v48
v_dot2c_f32_bf16 v8, v25, v25
v_dot2c_f32_bf16 v7, v33, v48
v_dot2c_f32_bf16 v9, v33, v33
v_dot2c_f32_bf16 v6, v26, v48
v_dot2c_f32_bf16 v8, v26, v26
v_dot2c_f32_bf16 v7, v34, v48
v_dot2c_f32_bf16 v9, v34, v34
v_dot2c_f32_bf16 v6, v27, v48
v_dot2c_f32_bf16 v8, v27, v27
v_dot2c_f32_bf16 v7, v35, v48
v_dot2c_f32_bf16 v9, v35, v35
s_mov_b64 exec, 1
s_waitcnt vmcnt(0)
buffer_store_dword v5, v4, s[32:35], s88 offen
s_mov_b64 exec, -1
s_nop 1
v_permlane32_swap_b32 v6, v7
v_permlane32_swap_b32 v8, v9
v_add_f32 v6, v6, v7
v_add_f32 v8, v8, v9
s_nop 1
v_permlane16_swap_b32 v6, v8
s_nop 0
v_add_f32 v6, v6, v8
buffer_store_dword v6, v1, s[32:35], s87 offen
back_120:
s_lshl_b32 s49, s44, 13
v_add_u32 v10, s49, v18
v_add_u32 v11, 1024, v10
s_lshl_b32 s48, s43, 1
v_lshrrev_b32 v4, 2, v2
v_and_b32 v5, 3, v0
v_lshl_add_u32 v6, v3, 3, v4
v_lshlrev_b32 v6, 7, v6
v_lshl_add_u32 v6, v5, 3, v6
v_lshrrev_b32 v7, 1, v4
v_and_b32 v8, 1, v3
v_lshl_add_u32 v7, v8, 1, v7
v_xor_b32 v7, s48, v7
v_lshl_add_u32 v12, v7, 5, v6
v_add_u32 v12, 16384, v12
v_xor_b32 v13, 32, v12
v_mov_b32 v14, v10
v_mov_b32 v15, v11
v_add_u32 v16, 122880, v12
v_add_u32 v17, 122880, v13
v_mov_b32 v156, 0
v_mov_b32 v157, 0
v_mov_b32 v158, 0
v_mov_b32 v159, 0
v_mov_b32 v160, 0
v_mov_b32 v161, 0
v_mov_b32 v162, 0
v_mov_b32 v163, 0
v_mov_b32 v164, 0
v_mov_b32 v165, 0
v_mov_b32 v166, 0
v_mov_b32 v167, 0
v_mov_b32 v168, 0
v_mov_b32 v169, 0
v_mov_b32 v170, 0
v_mov_b32 v171, 0
v_mov_b32 v172, 0
v_mov_b32 v173, 0
v_mov_b32 v174, 0
v_mov_b32 v175, 0
v_mov_b32 v176, 0
v_mov_b32 v177, 0
v_mov_b32 v178, 0
v_mov_b32 v179, 0
v_mov_b32 v180, 0
v_mov_b32 v181, 0
v_mov_b32 v182, 0
v_mov_b32 v183, 0
v_mov_b32 v184, 0
v_mov_b32 v185, 0
v_mov_b32 v186, 0
v_mov_b32 v187, 0
v_mov_b32 v188, 0
v_mov_b32 v189, 0
v_mov_b32 v190, 0
v_mov_b32 v191, 0
v_mov_b32 v192, 0
v_mov_b32 v193, 0
v_mov_b32 v194, 0
v_mov_b32 v195, 0
v_mov_b32 v196, 0
v_mov_b32 v197, 0
v_mov_b32 v198, 0
v_mov_b32 v199, 0
v_mov_b32 v200, 0
v_mov_b32 v201, 0
v_mov_b32 v202, 0
v_mov_b32 v203, 0
v_mov_b32 v204, 0
v_mov_b32 v205, 0
v_mov_b32 v206, 0
v_mov_b32 v207, 0
v_mov_b32 v208, 0
v_mov_b32 v209, 0
v_mov_b32 v210, 0
v_mov_b32 v211, 0
v_mov_b32 v212, 0
v_mov_b32 v213, 0
v_mov_b32 v214, 0
v_mov_b32 v215, 0
v_mov_b32 v216, 0
v_mov_b32 v217, 0
v_mov_b32 v218, 0
v_mov_b32 v219, 0
v_mov_b32 v220, 0
v_mov_b32 v221, 0
v_mov_b32 v222, 0
v_mov_b32 v223, 0
v_mov_b32 v224, 0
v_mov_b32 v225, 0
v_mov_b32 v226, 0
v_mov_b32 v227, 0
v_mov_b32 v228, 0
v_mov_b32 v229, 0
v_mov_b32 v230, 0
v_mov_b32 v231, 0
v_mov_b32 v232, 0
v_mov_b32 v233, 0
v_mov_b32 v234, 0
v_mov_b32 v235, 0
v_mov_b32 v236, 0
v_mov_b32 v237, 0
v_mov_b32 v238, 0
v_mov_b32 v239, 0
v_mov_b32 v240, 0
v_mov_b32 v241, 0
v_mov_b32 v242, 0
v_mov_b32 v243, 0
v_mov_b32 v244, 0
v_mov_b32 v245, 0
v_mov_b32 v246, 0
v_mov_b32 v247, 0
v_mov_b32 v248, 0
v_mov_b32 v249, 0
v_mov_b32 v250, 0
v_mov_b32 v251, 0
v_lshrrev_b32 v6, 2, v2
v_cmp_eq_u32 vcc, v6, v3
v_and_b32 v7, 1, v0
v_lshlrev_b32 v7, 4, v7
v_mov_b32 v8, 0x3f80
v_lshlrev_b32 v9, v7, v8
v_cndmask_b32 v7, 0, v9, vcc
v_and_b32 v6, 2, v0
v_cmp_eq_u32 vcc, 0, v6
v_mov_b32 v36, 0
v_mov_b32 v37, 0
v_mov_b32 v40, 0
v_mov_b32 v41, 0
v_cndmask_b32 v38, 0, v7, vcc
v_cndmask_b32 v39, v7, 0, vcc
v_lshrrev_b32 v8, 1, v2
v_cmp_eq_u32 vcc, 0, v8
s_nop 1
v_cndmask_b32 v44, 0, v9, vcc
v_cmp_eq_u32 vcc, 1, v8
s_nop 1
v_cndmask_b32 v45, 0, v9, vcc
v_cmp_eq_u32 vcc, 2, v8
s_nop 1
v_cndmask_b32 v46, 0, v9, vcc
v_cmp_eq_u32 vcc, 3, v8
s_nop 1
v_cndmask_b32 v47, 0, v9, vcc
v_lshrrev_b32 v4, 2, v2
v_lshl_add_u32 v4, v3, 2, v4
v_lshlrev_b32 v4, 6, v4
v_and_b32 v5, 3, v0
v_lshl_add_u32 v4, v5, 3, v4
s_lshl_b32 s48, s43, 11
s_add_u32 s48, s48, 135168
v_add_u32 v53, s48, v4
s_mul_i32 s48, s40, 3072
s_add_u32 s48, s48, 139264
v_add_u32 v42, s48, v18
s_xor_b32 s49, s40, 2
s_mul_i32 s48, s49, 3072
s_add_u32 s48, s48, 139264
v_add_u32 v43, s48, v18
s_lshl_b32 s49, s49, 2
s_add_u32 s49, s49, 134672
v_mov_b32 v19, s49
v_xor_b32 v52, 8, v19
v_lshrrev_b32 v4, 3, v0
v_and_b32 v5, 7, v0
v_lshlrev_b32 v4, 11, v4
v_lshl_add_u32 v55, v5, 4, v4
v_lshlrev_b32 v4, 6, v2
v_lshl_add_u32 v58, v3, 4, v4
v_lshlrev_b32 v4, 4, v2
v_lshl_add_u32 v59, v3, 3, v4
s_mul_i32 s51, s42, 163840
s_add_u32 s51, s51, 9437184
s_lshl_b32 s50, s43, 1
s_add_u32 s50, s50, s44
s_lshl_b32 s48, s50, 15
s_add_u32 s48, s48, s51
s_add_u32 s48, s48, 0
s_lshl_b32 s49, s41, 7
s_add_u32 s53, s48, s49
s_add_u32 s54, s53, 16384
s_lshl_b32 s56, s50, 10
s_add_u32 s56, s56, s51
s_add_u32 s56, s56, 151552
s_xor_b32 s57, s56, 1024
s_lshl_b32 s58, s50, 11
s_add_u32 s58, s58, s51
s_add_u32 s58, s58, 139264
s_xor_b32 s59, s58, 2048
s_add_u32 s79, s58, s49
s_lshl_b32 s50, s41, 11
s_add_u32 s55, s48, s50
s_lshl_b32 s48, s43, 7
s_add_u32 s48, s48, 133888
v_lshl_add_u32 v7, v3, 4, s48
v_lshl_add_u32 v54, v2, 2, s48
s_lshl_b32 s49, s44, 6
v_add_u32 v8, s49, v2
v_lshlrev_b32 v8, 3, v8
v_add_u32 v8, 131072, v8
v_lshl_add_u32 v9, v3, 2, s49
v_lshlrev_b32 v9, 2, v9
v_add_u32 v9, 132096, v9
s_mov_b32 s64, 0
s_mov_b32 s65, 0
s_mov_b32 s66, 0x3fb8aa3b
s_barrier
ds_read_b128 v[60:63], v14 offset:0
ds_read_b128 v[64:67], v14 offset:2048
ds_read_b128 v[68:71], v14 offset:4096
ds_read_b128 v[72:75], v14 offset:6144
ds_read_b64_tr_b16 v[84:85], v16 offset:8192
ds_read_b64_tr_b16 v[86:87], v16 offset:8704
ds_read_b64_tr_b16 v[88:89], v17 offset:8192
ds_read_b64_tr_b16 v[90:91], v17 offset:8704
ds_read_b64_tr_b16 v[92:93], v16 offset:16384
ds_read_b64_tr_b16 v[94:95], v16 offset:16896
ds_read_b64_tr_b16 v[96:97], v17 offset:16384
ds_read_b64_tr_b16 v[98:99], v17 offset:16896
ds_read_b64_tr_b16 v[76:77], v16 offset:0
ds_read_b64_tr_b16 v[78:79], v16 offset:512
ds_read_b64_tr_b16 v[80:81], v17 offset:0
ds_read_b64_tr_b16 v[82:83], v17 offset:512
s_waitcnt lgkmcnt(0)
c3_loop:
v_mfma_f32_16x16x32_bf16 v[212:215], v[84:87], v[72:75], v[212:215]
ds_read_b128 v[100:103], v15 offset:0
v_mfma_f32_16x16x32_bf16 v[204:207], v[84:87], v[68:71], v[204:207]
ds_read_b128 v[104:107], v15 offset:2048
v_mfma_f32_16x16x32_bf16 v[196:199], v[84:87], v[64:67], v[196:199]
ds_read_b128 v[108:111], v15 offset:4096
v_mfma_f32_16x16x32_bf16 v[188:191], v[84:87], v[60:63], v[188:191]
ds_read_b128 v[112:115], v15 offset:6144
v_mfma_f32_16x16x32_bf16 v[192:195], v[88:91], v[60:63], v[192:195]
ds_read_b64_tr_b16 v[124:125], v16 offset:12288
v_mfma_f32_16x16x32_bf16 v[200:203], v[88:91], v[64:67], v[200:203]
ds_read_b64_tr_b16 v[126:127], v16 offset:12800
v_mfma_f32_16x16x32_bf16 v[208:211], v[88:91], v[68:71], v[208:211]
ds_read_b64_tr_b16 v[128:129], v17 offset:12288
v_mfma_f32_16x16x32_bf16 v[216:219], v[88:91], v[72:75], v[216:219]
ds_read_b64_tr_b16 v[130:131], v17 offset:12800
v_mfma_f32_16x16x32_bf16 v[244:247], v[72:75], v[92:95], v[244:247]
ds_read_b64_tr_b16 v[132:133], v16 offset:20480
v_mfma_f32_16x16x32_bf16 v[248:251], v[72:75], v[96:99], v[248:251]
ds_read_b64_tr_b16 v[134:135], v16 offset:20992
v_mfma_f32_16x16x32_bf16 v[240:243], v[68:71], v[96:99], v[240:243]
ds_read_b64_tr_b16 v[136:137], v17 offset:20480
v_mfma_f32_16x16x32_bf16 v[236:239], v[68:71], v[92:95], v[236:239]
ds_read_b64_tr_b16 v[138:139], v17 offset:20992
v_mfma_f32_16x16x32_bf16 v[228:231], v[64:67], v[92:95], v[228:231]
ds_read_b64_tr_b16 v[116:117], v16 offset:4096
v_mfma_f32_16x16x32_bf16 v[232:235], v[64:67], v[96:99], v[232:235]
ds_read_b64_tr_b16 v[118:119], v16 offset:4608
v_mfma_f32_16x16x32_bf16 v[224:227], v[60:63], v[96:99], v[224:227]
ds_read_b64_tr_b16 v[120:121], v17 offset:4096
v_mfma_f32_16x16x32_bf16 v[220:223], v[60:63], v[92:95], v[220:223]
ds_read_b64_tr_b16 v[122:123], v17 offset:4608
v_mfma_f32_16x16x32_bf16 v[156:159], v[76:79], v[60:63], v[156:159]
s_add_u32 s65, s65, 40960
s_cmp_eq_u32 s65, 122880
v_mfma_f32_16x16x32_bf16 v[164:167], v[76:79], v[64:67], v[164:167]
s_cselect_b32 s65, 0, s65
s_add_u32 s64, s64, 1
v_mfma_f32_16x16x32_bf16 v[172:175], v[76:79], v[68:71], v[172:175]
v_add_u32 v14, s65, v10
v_add_u32 v15, s65, v11
v_mfma_f32_16x16x32_bf16 v[180:183], v[76:79], v[72:75], v[180:183]
v_add_u32 v16, s65, v12
v_add_u32 v17, s65, v13
v_mfma_f32_16x16x32_bf16 v[184:187], v[80:83], v[72:75], v[184:187]
v_mfma_f32_16x16x32_bf16 v[176:179], v[80:83], v[68:71], v[176:179]
s_cmp_eq_u32 s64, 16
s_cbranch_scc1 c3_last
v_mfma_f32_16x16x32_bf16 v[168:171], v[80:83], v[64:67], v[168:171]
s_waitcnt lgkmcnt(0)
v_mfma_f32_16x16x32_bf16 v[160:163], v[80:83], v[60:63], v[160:163]
s_barrier
v_mfma_f32_16x16x32_bf16 v[212:215], v[124:127], v[112:115], v[212:215]
ds_read_b128 v[60:63], v14 offset:0
v_mfma_f32_16x16x32_bf16 v[204:207], v[124:127], v[108:111], v[204:207]
ds_read_b128 v[64:67], v14 offset:2048
v_mfma_f32_16x16x32_bf16 v[196:199], v[124:127], v[104:107], v[196:199]
ds_read_b128 v[68:71], v14 offset:4096
v_mfma_f32_16x16x32_bf16 v[188:191], v[124:127], v[100:103], v[188:191]
ds_read_b128 v[72:75], v14 offset:6144
v_mfma_f32_16x16x32_bf16 v[192:195], v[128:131], v[100:103], v[192:195]
ds_read_b64_tr_b16 v[84:85], v16 offset:8192
v_mfma_f32_16x16x32_bf16 v[200:203], v[128:131], v[104:107], v[200:203]
ds_read_b64_tr_b16 v[86:87], v16 offset:8704
v_mfma_f32_16x16x32_bf16 v[208:211], v[128:131], v[108:111], v[208:211]
ds_read_b64_tr_b16 v[88:89], v17 offset:8192
v_mfma_f32_16x16x32_bf16 v[216:219], v[128:131], v[112:115], v[216:219]
ds_read_b64_tr_b16 v[90:91], v17 offset:8704
v_mfma_f32_16x16x32_bf16 v[244:247], v[112:115], v[132:135], v[244:247]
ds_read_b64_tr_b16 v[92:93], v16 offset:16384
v_mfma_f32_16x16x32_bf16 v[248:251], v[112:115], v[136:139], v[248:251]
ds_read_b64_tr_b16 v[94:95], v16 offset:16896
v_mfma_f32_16x16x32_bf16 v[240:243], v[108:111], v[136:139], v[240:243]
ds_read_b64_tr_b16 v[96:97], v17 offset:16384
v_mfma_f32_16x16x32_bf16 v[236:239], v[108:111], v[132:135], v[236:239]
ds_read_b64_tr_b16 v[98:99], v17 offset:16896
v_mfma_f32_16x16x32_bf16 v[228:231], v[104:107], v[132:135], v[228:231]
ds_read_b64_tr_b16 v[76:77], v16 offset:0
v_mfma_f32_16x16x32_bf16 v[232:235], v[104:107], v[136:139], v[232:235]
ds_read_b64_tr_b16 v[78:79], v16 offset:512
v_mfma_f32_16x16x32_bf16 v[224:227], v[100:103], v[136:139], v[224:227]
ds_read_b64_tr_b16 v[80:81], v17 offset:0
v_mfma_f32_16x16x32_bf16 v[220:223], v[100:103], v[132:135], v[220:223]
ds_read_b64_tr_b16 v[82:83], v17 offset:512
v_mfma_f32_16x16x32_bf16 v[156:159], v[116:119], v[100:103], v[156:159]
v_mfma_f32_16x16x32_bf16 v[164:167], v[116:119], v[104:107], v[164:167]
v_mfma_f32_16x16x32_bf16 v[172:175], v[116:119], v[108:111], v[172:175]
v_mfma_f32_16x16x32_bf16 v[180:183], v[116:119], v[112:115], v[180:183]
v_mfma_f32_16x16x32_bf16 v[184:187], v[120:123], v[112:115], v[184:187]
v_mfma_f32_16x16x32_bf16 v[176:179], v[120:123], v[108:111], v[176:179]
v_mfma_f32_16x16x32_bf16 v[168:171], v[120:123], v[104:107], v[168:171]
s_waitcnt lgkmcnt(0)
v_mfma_f32_16x16x32_bf16 v[160:163], v[120:123], v[100:103], v[160:163]
s_branch c3_loop
c3_last:
v_mfma_f32_16x16x32_bf16 v[168:171], v[80:83], v[64:67], v[168:171]
s_waitcnt lgkmcnt(0)
v_mfma_f32_16x16x32_bf16 v[160:163], v[80:83], v[60:63], v[160:163]
v_mfma_f32_16x16x32_bf16 v[212:215], v[124:127], v[112:115], v[212:215]
v_mfma_f32_16x16x32_bf16 v[204:207], v[124:127], v[108:111], v[204:207]
v_mfma_f32_16x16x32_bf16 v[196:199], v[124:127], v[104:107], v[196:199]
v_mfma_f32_16x16x32_bf16 v[188:191], v[124:127], v[100:103], v[188:191]
v_mfma_f32_16x16x32_bf16 v[192:195], v[128:131], v[100:103], v[192:195]
v_mfma_f32_16x16x32_bf16 v[200:203], v[128:131], v[104:107], v[200:203]
v_mfma_f32_16x16x32_bf16 v[208:211], v[128:131], v[108:111], v[208:211]
v_mfma_f32_16x16x32_bf16 v[216:219], v[128:131], v[112:115], v[216:219]
s_barrier
v_mfma_f32_16x16x32_bf16 v[244:247], v[112:115], v[132:135], v[244:247]
ds_read_b128 v[140:143], v7 offset:0
ds_read_b128 v[144:147], v7 offset:64
v_mfma_f32_16x16x32_bf16 v[248:251], v[112:115], v[136:139], v[248:251]
ds_read_b128 v[148:151], v7 offset:256
ds_read_b128 v[152:155], v7 offset:320
v_mfma_f32_16x16x32_bf16 v[240:243], v[108:111], v[136:139], v[240:243]
ds_read_b64 v[92:93], v8 offset:0
ds_read_b64 v[94:95], v8 offset:128
v_mfma_f32_16x16x32_bf16 v[236:239], v[108:111], v[132:135], v[236:239]
ds_read_b64 v[96:97], v8 offset:256
ds_read_b64 v[98:99], v8 offset:384
v_mfma_f32_16x16x32_bf16 v[228:231], v[104:107], v[132:135], v[228:231]
ds_read2_b32 v[56:57], v54 offset0:128 offset1:144
ds_read_b128 v[60:63], v9 offset:0
v_mfma_f32_16x16x32_bf16 v[232:235], v[104:107], v[136:139], v[232:235]
ds_read_b128 v[64:67], v9 offset:64
ds_read_b128 v[68:71], v9 offset:128
v_mfma_f32_16x16x32_bf16 v[224:227], v[100:103], v[136:139], v[224:227]
ds_read_b128 v[72:75], v9 offset:192
ds_read_b128 v[76:79], v9 offset:512
v_mfma_f32_16x16x32_bf16 v[220:223], v[100:103], v[132:135], v[220:223]
ds_read_b128 v[80:83], v9 offset:576
ds_read_b128 v[84:87], v9 offset:640
v_mfma_f32_16x16x32_bf16 v[156:159], v[116:119], v[100:103], v[156:159]
ds_read_b128 v[88:91], v9 offset:704
v_mfma_f32_16x16x32_bf16 v[164:167], v[116:119], v[104:107], v[164:167]
ds_read_b64_tr_b16 v[10:11], v53 offset:0
v_mfma_f32_16x16x32_bf16 v[172:175], v[116:119], v[108:111], v[172:175]
ds_read_b64_tr_b16 v[12:13], v53 offset:1024
v_mfma_f32_16x16x32_bf16 v[180:183], v[116:119], v[112:115], v[180:183]
ds_read_b64_tr_b16 v[14:15], v53 offset:32
v_mfma_f32_16x16x32_bf16 v[184:187], v[120:123], v[112:115], v[184:187]
ds_read_b64_tr_b16 v[16:17], v53 offset:1056
v_mfma_f32_16x16x32_bf16 v[176:179], v[120:123], v[108:111], v[176:179]
v_mfma_f32_16x16x32_bf16 v[168:171], v[120:123], v[104:107], v[168:171]
v_mfma_f32_16x16x32_bf16 v[160:163], v[120:123], v[100:103], v[160:163]
c3_epi:
s_waitcnt lgkmcnt(0)
s_mul_i32 s48, s44, 0x80008000
v_xor_b32 v10, s48, v10
v_xor_b32 v11, s48, v11
v_xor_b32 v12, s48, v12
v_xor_b32 v13, s48, v13
v_xor_b32 v14, s48, v14
v_xor_b32 v15, s48, v15
v_xor_b32 v16, s48, v16
v_xor_b32 v17, s48, v17
v_mul_f32 v128, s66, v92
v_mul_f32 v129, s66, v94
v_mul_f32 v130, s66, v96
v_mul_f32 v131, s66, v98
.p2align 3
v_pk_fma_f32 v[220:221], v[76:77], v[56:57], v[220:221] op_sel:[0,0,0] op_sel_hi:[1,0,1]
v_pk_fma_f32 v[222:223], v[78:79], v[56:57], v[222:223] op_sel:[0,0,0] op_sel_hi:[1,0,1]
v_pk_mul_f32 v[220:221], v[220:221], v[60:61]
v_pk_mul_f32 v[222:223], v[222:223], v[62:63]
v_cvt_pk_bf16_f32 v112, v220, v221
v_cvt_pk_bf16_f32 v113, v222, v223
v_pk_fma_f32 v[228:229], v[80:81], v[56:57], v[228:229] op_sel:[0,0,0] op_sel_hi:[1,0,1]
v_pk_fma_f32 v[230:231], v[82:83], v[56:57], v[230:231] op_sel:[0,0,0] op_sel_hi:[1,0,1]
v_pk_mul_f32 v[228:229], v[228:229], v[64:65]
v_pk_mul_f32 v[230:231], v[230:231], v[66:67]
v_cvt_pk_bf16_f32 v114, v228, v229
v_cvt_pk_bf16_f32 v115, v230, v231
v_pk_fma_f32 v[236:237], v[84:85], v[56:57], v[236:237] op_sel:[0,0,0] op_sel_hi:[1,0,1]
v_pk_fma_f32 v[238:239], v[86:87], v[56:57], v[238:239] op_sel:[0,0,0] op_sel_hi:[1,0,1]
v_pk_mul_f32 v[236:237], v[236:237], v[68:69]
v_pk_mul_f32 v[238:239], v[238:239], v[70:71]
v_cvt_pk_bf16_f32 v116, v236, v237
v_cvt_pk_bf16_f32 v117, v238, v239
v_pk_fma_f32 v[244:245], v[88:89], v[56:57], v[244:245] op_sel:[0,0,0] op_sel_hi:[1,0,1]
v_pk_fma_f32 v[246:247], v[90:91], v[56:57], v[246:247] op_sel:[0,0,0] op_sel_hi:[1,0,1]
v_pk_mul_f32 v[244:245], v[244:245], v[72:73]
v_pk_mul_f32 v[246:247], v[246:247], v[74:75]
v_cvt_pk_bf16_f32 v118, v244, v245
v_cvt_pk_bf16_f32 v119, v246, v247
v_pk_fma_f32 v[224:225], v[76:77], v[56:57], v[224:225] op_sel:[0,1,0] op_sel_hi:[1,1,1]
v_pk_fma_f32 v[226:227], v[78:79], v[56:57], v[226:227] op_sel:[0,1,0] op_sel_hi:[1,1,1]
v_pk_mul_f32 v[224:225], v[224:225], v[60:61]
v_pk_mul_f32 v[226:227], v[226:227], v[62:63]
v_cvt_pk_bf16_f32 v120, v224, v225
v_cvt_pk_bf16_f32 v121, v226, v227
v_pk_fma_f32 v[232:233], v[80:81], v[56:57], v[232:233] op_sel:[0,1,0] op_sel_hi:[1,1,1]
v_pk_fma_f32 v[234:235], v[82:83], v[56:57], v[234:235] op_sel:[0,1,0] op_sel_hi:[1,1,1]
v_pk_mul_f32 v[232:233], v[232:233], v[64:65]
v_pk_mul_f32 v[234:235], v[234:235], v[66:67]
v_cvt_pk_bf16_f32 v122, v232, v233
v_cvt_pk_bf16_f32 v123, v234, v235
v_pk_fma_f32 v[240:241], v[84:85], v[56:57], v[240:241] op_sel:[0,1,0] op_sel_hi:[1,1,1]
v_pk_fma_f32 v[242:243], v[86:87], v[56:57], v[242:243] op_sel:[0,1,0] op_sel_hi:[1,1,1]
v_pk_mul_f32 v[240:241], v[240:241], v[68:69]
v_pk_mul_f32 v[242:243], v[242:243], v[70:71]
v_cvt_pk_bf16_f32 v124, v240, v241
v_cvt_pk_bf16_f32 v125, v242, v243
v_pk_fma_f32 v[248:249], v[88:89], v[56:57], v[248:249] op_sel:[0,1,0] op_sel_hi:[1,1,1]
v_pk_fma_f32 v[250:251], v[90:91], v[56:57], v[250:251] op_sel:[0,1,0] op_sel_hi:[1,1,1]
v_pk_mul_f32 v[248:249], v[248:249], v[72:73]
v_pk_mul_f32 v[250:251], v[250:251], v[74:75]
v_cvt_pk_bf16_f32 v126, v248, v249
v_cvt_pk_bf16_f32 v127, v250, v251
v_pk_fma_f32 v[188:189], v[148:149], v[92:93], v[188:189] op_sel:[0,1,0] op_sel_hi:[1,1,1]
v_pk_fma_f32 v[190:191], v[150:151], v[92:93], v[190:191] op_sel:[0,1,0] op_sel_hi:[1,1,1]
v_pk_fma_f32 v[192:193], v[152:153], v[92:93], v[192:193] op_sel:[0,1,0] op_sel_hi:[1,1,1]
v_pk_fma_f32 v[194:195], v[154:155], v[92:93], v[194:195] op_sel:[0,1,0] op_sel_hi:[1,1,1]
v_cvt_pk_bf16_f32 v188, v188, v189
v_cvt_pk_bf16_f32 v189, v190, v191
v_cvt_pk_bf16_f32 v190, v192, v193
v_cvt_pk_bf16_f32 v191, v194, v195
v_pk_fma_f32 v[196:197], v[148:149], v[94:95], v[196:197] op_sel:[0,1,0] op_sel_hi:[1,1,1]
v_pk_fma_f32 v[198:199], v[150:151], v[94:95], v[198:199] op_sel:[0,1,0] op_sel_hi:[1,1,1]
v_pk_fma_f32 v[200:201], v[152:153], v[94:95], v[200:201] op_sel:[0,1,0] op_sel_hi:[1,1,1]
v_pk_fma_f32 v[202:203], v[154:155], v[94:95], v[202:203] op_sel:[0,1,0] op_sel_hi:[1,1,1]
v_cvt_pk_bf16_f32 v196, v196, v197
v_mfma_f32_16x16x32_bf16 v[60:63], v[10:13], v[188:191], 0
v_cvt_pk_bf16_f32 v197, v198, v199
v_cvt_pk_bf16_f32 v198, v200, v201
v_mfma_f32_16x16x32_bf16 v[64:67], v[14:17], v[188:191], 0
v_cvt_pk_bf16_f32 v199, v202, v203
v_pk_fma_f32 v[204:205], v[148:149], v[96:97], v[204:205] op_sel:[0,1,0] op_sel_hi:[1,1,1]
v_pk_fma_f32 v[206:207], v[150:151], v[96:97], v[206:207] op_sel:[0,1,0] op_sel_hi:[1,1,1]
v_pk_fma_f32 v[208:209], v[152:153], v[96:97], v[208:209] op_sel:[0,1,0] op_sel_hi:[1,1,1]
v_pk_fma_f32 v[210:211], v[154:155], v[96:97], v[210:211] op_sel:[0,1,0] op_sel_hi:[1,1,1]
v_cvt_pk_bf16_f32 v204, v204, v205
v_mfma_f32_16x16x32_bf16 v[68:71], v[10:13], v[196:199], 0
v_cvt_pk_bf16_f32 v205, v206, v207
v_cvt_pk_bf16_f32 v206, v208, v209
v_mfma_f32_16x16x32_bf16 v[72:75], v[14:17], v[196:199], 0
v_cvt_pk_bf16_f32 v207, v210, v211
v_pk_fma_f32 v[212:213], v[148:149], v[98:99], v[212:213] op_sel:[0,1,0] op_sel_hi:[1,1,1]
v_pk_fma_f32 v[214:215], v[150:151], v[98:99], v[214:215] op_sel:[0,1,0] op_sel_hi:[1,1,1]
v_pk_fma_f32 v[216:217], v[152:153], v[98:99], v[216:217] op_sel:[0,1,0] op_sel_hi:[1,1,1]
v_pk_fma_f32 v[218:219], v[154:155], v[98:99], v[218:219] op_sel:[0,1,0] op_sel_hi:[1,1,1]
v_cvt_pk_bf16_f32 v212, v212, v213
v_mfma_f32_16x16x32_bf16 v[76:79], v[10:13], v[204:207], 0
v_cvt_pk_bf16_f32 v213, v214, v215
v_cvt_pk_bf16_f32 v214, v216, v217
v_mfma_f32_16x16x32_bf16 v[80:83], v[14:17], v[204:207], 0
v_cvt_pk_bf16_f32 v215, v218, v219
s_nop 1
v_mfma_f32_16x16x32_bf16 v[84:87], v[10:13], v[212:215], 0
v_mfma_f32_16x16x32_bf16 v[88:91], v[14:17], v[212:215], 0
v_max3_f32 v100, v60, v61, v62
v_min3_f32 v104, v60, v61, v62
v_max3_f32 v100, v100, v63, v64
v_min3_f32 v104, v104, v63, v64
v_max3_f32 v100, v100, v65, v66
v_min3_f32 v104, v104, v65, v66
v_max_f32 v100, v100, v67
v_min_f32 v104, v104, v67
v_max3_f32 v101, v68, v69, v70
v_min3_f32 v105, v68, v69, v70
v_max3_f32 v101, v101, v71, v72
v_min3_f32 v105, v105, v71, v72
v_max3_f32 v101, v101, v73, v74
v_min3_f32 v105, v105, v73, v74
v_max_f32 v101, v101, v75
v_min_f32 v105, v105, v75
v_max3_f32 v102, v76, v77, v78
v_min3_f32 v106, v76, v77, v78
v_max3_f32 v102, v102, v79, v80
v_min3_f32 v106, v106, v79, v80
v_max3_f32 v102, v102, v81, v82
v_min3_f32 v106, v106, v81, v82
v_max_f32 v102, v102, v83
v_min_f32 v106, v106, v83
v_max3_f32 v103, v84, v85, v86
v_min3_f32 v107, v84, v85, v86
v_max3_f32 v103, v103, v87, v88
v_min3_f32 v107, v107, v87, v88
v_max3_f32 v103, v103, v89, v90
v_min3_f32 v107, v107, v89, v90
v_max_f32 v103, v103, v91
v_min_f32 v107, v107, v91
s_nop 1
v_permlane32_swap_b32 v100, v101
v_permlane32_swap_b32 v102, v103
v_permlane32_swap_b32 v104, v105
v_permlane32_swap_b32 v106, v107
v_max_f32 v100, v100, v101
v_max_f32 v102, v102, v103
v_min_f32 v104, v104, v105
v_min_f32 v106, v106, v107
v_permlane16_swap_b32 v100, v102
s_nop 0
v_permlane16_swap_b32 v104, v106
v_max_f32 v100, v100, v102
v_min_f32 v104, v104, v106
v_mov_b32 v102, v100
v_mov_b32 v106, v104
s_nop 0
v_permlane16_swap_b32 v100, v102
v_permlane16_swap_b32 v104, v106
v_mov_b32 v101, v100
v_mov_b32 v103, v102
v_mov_b32 v105, v104
v_mov_b32 v107, v106
v_permlane32_swap_b32 v100, v101
v_permlane32_swap_b32 v102, v103
v_permlane32_swap_b32 v104, v105
v_permlane32_swap_b32 v106, v107
v_pk_mul_f32 v[100:101], v[100:101], v[128:129]
v_pk_mul_f32 v[102:103], v[102:103], v[130:131]
v_pk_mul_f32 v[104:105], v[104:105], v[128:129]
v_pk_mul_f32 v[106:107], v[106:107], v[130:131]
v_pk_fma_f32 v[220:221], v[60:61], v[128:129], v[104:105] op_sel:[0,0,0] op_sel_hi:[1,0,0] neg_lo:[1,0,0] neg_hi:[1,0,0]
v_pk_fma_f32 v[60:61], v[60:61], v[128:129], v[100:101] op_sel:[0,0,0] op_sel_hi:[1,0,0] neg_lo:[0,0,1] neg_hi:[0,0,1]
v_exp_f32 v220, v220
v_exp_f32 v60, v60
v_exp_f32 v221, v221
v_exp_f32 v61, v61
v_pk_fma_f32 v[222:223], v[62:63], v[128:129], v[104:105] op_sel:[0,0,0] op_sel_hi:[1,0,0] neg_lo:[1,0,0] neg_hi:[1,0,0]
v_pk_fma_f32 v[62:63], v[62:63], v[128:129], v[100:101] op_sel:[0,0,0] op_sel_hi:[1,0,0] neg_lo:[0,0,1] neg_hi:[0,0,1]
v_exp_f32 v222, v222
v_exp_f32 v62, v62
v_exp_f32 v223, v223
v_exp_f32 v63, v63
v_pk_fma_f32 v[224:225], v[64:65], v[128:129], v[104:105] op_sel:[0,0,0] op_sel_hi:[1,0,0] neg_lo:[1,0,0] neg_hi:[1,0,0]
v_pk_fma_f32 v[64:65], v[64:65], v[128:129], v[100:101] op_sel:[0,0,0] op_sel_hi:[1,0,0] neg_lo:[0,0,1] neg_hi:[0,0,1]
v_exp_f32 v224, v224
v_exp_f32 v64, v64
v_exp_f32 v225, v225
v_exp_f32 v65, v65
v_pk_fma_f32 v[226:227], v[66:67], v[128:129], v[104:105] op_sel:[0,0,0] op_sel_hi:[1,0,0] neg_lo:[1,0,0] neg_hi:[1,0,0]
v_pk_fma_f32 v[66:67], v[66:67], v[128:129], v[100:101] op_sel:[0,0,0] op_sel_hi:[1,0,0] neg_lo:[0,0,1] neg_hi:[0,0,1]
v_exp_f32 v226, v226
v_exp_f32 v66, v66
v_exp_f32 v227, v227
v_exp_f32 v67, v67
v_pk_fma_f32 v[228:229], v[68:69], v[128:129], v[104:105] op_sel:[0,1,1] op_sel_hi:[1,1,1] neg_lo:[1,0,0] neg_hi:[1,0,0]
v_pk_fma_f32 v[68:69], v[68:69], v[128:129], v[100:101] op_sel:[0,1,1] op_sel_hi:[1,1,1] neg_lo:[0,0,1] neg_hi:[0,0,1]
v_exp_f32 v228, v228
v_exp_f32 v68, v68
v_exp_f32 v229, v229
v_exp_f32 v69, v69
v_pk_fma_f32 v[230:231], v[70:71], v[128:129], v[104:105] op_sel:[0,1,1] op_sel_hi:[1,1,1] neg_lo:[1,0,0] neg_hi:[1,0,0]
v_pk_fma_f32 v[70:71], v[70:71], v[128:129], v[100:101] op_sel:[0,1,1] op_sel_hi:[1,1,1] neg_lo:[0,0,1] neg_hi:[0,0,1]
v_exp_f32 v230, v230
v_exp_f32 v70, v70
v_exp_f32 v231, v231
v_exp_f32 v71, v71
v_pk_fma_f32 v[232:233], v[72:73], v[128:129], v[104:105] op_sel:[0,1,1] op_sel_hi:[1,1,1] neg_lo:[1,0,0] neg_hi:[1,0,0]
v_pk_fma_f32 v[72:73], v[72:73], v[128:129], v[100:101] op_sel:[0,1,1] op_sel_hi:[1,1,1] neg_lo:[0,0,1] neg_hi:[0,0,1]
v_exp_f32 v232, v232
v_exp_f32 v72, v72
v_exp_f32 v233, v233
v_exp_f32 v73, v73
v_pk_fma_f32 v[234:235], v[74:75], v[128:129], v[104:105] op_sel:[0,1,1] op_sel_hi:[1,1,1] neg_lo:[1,0,0] neg_hi:[1,0,0]
v_pk_fma_f32 v[74:75], v[74:75], v[128:129], v[100:101] op_sel:[0,1,1] op_sel_hi:[1,1,1] neg_lo:[0,0,1] neg_hi:[0,0,1]
v_exp_f32 v234, v234
v_exp_f32 v74, v74
v_exp_f32 v235, v235
v_exp_f32 v75, v75
v_pk_fma_f32 v[236:237], v[76:77], v[130:131], v[106:107] op_sel:[0,0,0] op_sel_hi:[1,0,0] neg_lo:[1,0,0] neg_hi:[1,0,0]
v_pk_fma_f32 v[76:77], v[76:77], v[130:131], v[102:103] op_sel:[0,0,0] op_sel_hi:[1,0,0] neg_lo:[0,0,1] neg_hi:[0,0,1]
v_exp_f32 v236, v236
v_exp_f32 v76, v76
v_exp_f32 v237, v237
v_exp_f32 v77, v77
v_pk_fma_f32 v[238:239], v[78:79], v[130:131], v[106:107] op_sel:[0,0,0] op_sel_hi:[1,0,0] neg_lo:[1,0,0] neg_hi:[1,0,0]
v_pk_fma_f32 v[78:79], v[78:79], v[130:131], v[102:103] op_sel:[0,0,0] op_sel_hi:[1,0,0] neg_lo:[0,0,1] neg_hi:[0,0,1]
v_exp_f32 v238, v238
v_exp_f32 v78, v78
v_exp_f32 v239, v239
v_exp_f32 v79, v79
v_pk_fma_f32 v[240:241], v[80:81], v[130:131], v[106:107] op_sel:[0,0,0] op_sel_hi:[1,0,0] neg_lo:[1,0,0] neg_hi:[1,0,0]
v_pk_fma_f32 v[80:81], v[80:81], v[130:131], v[102:103] op_sel:[0,0,0] op_sel_hi:[1,0,0] neg_lo:[0,0,1] neg_hi:[0,0,1]
v_exp_f32 v240, v240
v_exp_f32 v80, v80
v_exp_f32 v241, v241
v_exp_f32 v81, v81
v_pk_fma_f32 v[242:243], v[82:83], v[130:131], v[106:107] op_sel:[0,0,0] op_sel_hi:[1,0,0] neg_lo:[1,0,0] neg_hi:[1,0,0]
v_pk_fma_f32 v[82:83], v[82:83], v[130:131], v[102:103] op_sel:[0,0,0] op_sel_hi:[1,0,0] neg_lo:[0,0,1] neg_hi:[0,0,1]
v_exp_f32 v242, v242
v_exp_f32 v82, v82
v_exp_f32 v243, v243
v_exp_f32 v83, v83
v_pk_fma_f32 v[244:245], v[84:85], v[130:131], v[106:107] op_sel:[0,1,1] op_sel_hi:[1,1,1] neg_lo:[1,0,0] neg_hi:[1,0,0]
v_pk_fma_f32 v[84:85], v[84:85], v[130:131], v[102:103] op_sel:[0,1,1] op_sel_hi:[1,1,1] neg_lo:[0,0,1] neg_hi:[0,0,1]
v_exp_f32 v244, v244
v_exp_f32 v84, v84
v_exp_f32 v245, v245
v_exp_f32 v85, v85
v_pk_fma_f32 v[246:247], v[86:87], v[130:131], v[106:107] op_sel:[0,1,1] op_sel_hi:[1,1,1] neg_lo:[1,0,0] neg_hi:[1,0,0]
v_pk_fma_f32 v[86:87], v[86:87], v[130:131], v[102:103] op_sel:[0,1,1] op_sel_hi:[1,1,1] neg_lo:[0,0,1] neg_hi:[0,0,1]
v_exp_f32 v246, v246
v_exp_f32 v86, v86
v_exp_f32 v247, v247
v_exp_f32 v87, v87
v_pk_fma_f32 v[248:249], v[88:89], v[130:131], v[106:107] op_sel:[0,1,1] op_sel_hi:[1,1,1] neg_lo:[1,0,0] neg_hi:[1,0,0]
v_pk_fma_f32 v[88:89], v[88:89], v[130:131], v[102:103] op_sel:[0,1,1] op_sel_hi:[1,1,1] neg_lo:[0,0,1] neg_hi:[0,0,1]
v_exp_f32 v248, v248
v_exp_f32 v88, v88
v_exp_f32 v249, v249
v_exp_f32 v89, v89
v_pk_fma_f32 v[250:251], v[90:91], v[130:131], v[106:107] op_sel:[0,1,1] op_sel_hi:[1,1,1] neg_lo:[1,0,0] neg_hi:[1,0,0]
v_pk_fma_f32 v[90:91], v[90:91], v[130:131], v[102:103] op_sel:[0,1,1] op_sel_hi:[1,1,1] neg_lo:[0,0,1] neg_hi:[0,0,1]
v_exp_f32 v250, v250
v_exp_f32 v90, v90
v_exp_f32 v251, v251
v_exp_f32 v91, v91
v_pk_add_f32 v[108:109], v[60:61], v[62:63]
v_pk_add_f32 v[110:111], v[220:221], v[222:223]
v_pk_add_f32 v[108:109], v[108:109], v[64:65]
v_pk_add_f32 v[110:111], v[110:111], v[224:225]
v_pk_add_f32 v[108:109], v[108:109], v[66:67]
v_pk_add_f32 v[110:111], v[110:111], v[226:227]
v_add_f32 v100, v108, v109
v_add_f32 v104, v110, v111
v_pk_add_f32 v[108:109], v[68:69], v[70:71]
v_pk_add_f32 v[110:111], v[228:229], v[230:231]
v_pk_add_f32 v[108:109], v[108:109], v[72:73]
v_pk_add_f32 v[110:111], v[110:111], v[232:233]
v_pk_add_f32 v[108:109], v[108:109], v[74:75]
v_pk_add_f32 v[110:111], v[110:111], v[234:235]
v_add_f32 v101, v108, v109
v_add_f32 v105, v110, v111
v_pk_add_f32 v[108:109], v[76:77], v[78:79]
v_pk_add_f32 v[110:111], v[236:237], v[238:239]
v_pk_add_f32 v[108:109], v[108:109], v[80:81]
v_pk_add_f32 v[110:111], v[110:111], v[240:241]
v_pk_add_f32 v[108:109], v[108:109], v[82:83]
v_pk_add_f32 v[110:111], v[110:111], v[242:243]
v_add_f32 v102, v108, v109
v_add_f32 v106, v110, v111
v_pk_add_f32 v[108:109], v[84:85], v[86:87]
v_pk_add_f32 v[110:111], v[244:245], v[246:247]
v_pk_add_f32 v[108:109], v[108:109], v[88:89]
v_pk_add_f32 v[110:111], v[110:111], v[248:249]
v_pk_add_f32 v[108:109], v[108:109], v[90:91]
v_pk_add_f32 v[110:111], v[110:111], v[250:251]
v_add_f32 v103, v108, v109
v_add_f32 v107, v110, v111
s_nop 1
v_permlane32_swap_b32 v100, v101
v_permlane32_swap_b32 v102, v103
v_permlane32_swap_b32 v104, v105
v_permlane32_swap_b32 v106, v107
v_add_f32 v100, v100, v101
v_add_f32 v102, v102, v103
v_add_f32 v104, v104, v105
v_add_f32 v106, v106, v107
v_permlane16_swap_b32 v100, v102
s_nop 0
v_permlane16_swap_b32 v104, v106
v_add_f32 v100, v100, v102
v_add_f32 v104, v104, v106
v_rcp_f32 v100, v100
v_rcp_f32 v104, v104
s_nop 0
v_mov_b32 v102, v100
v_mov_b32 v106, v104
s_nop 0
v_permlane16_swap_b32 v100, v102
v_permlane16_swap_b32 v104, v106
v_mov_b32 v101, v100
v_mov_b32 v103, v102
v_mov_b32 v105, v104
v_mov_b32 v107, v106
v_permlane32_swap_b32 v100, v101
v_permlane32_swap_b32 v102, v103
v_permlane32_swap_b32 v104, v105
v_permlane32_swap_b32 v106, v107
.p2align 3
v_pk_mul_f32 v[60:61], v[60:61], v[100:101] op_sel:[0,0] op_sel_hi:[1,0]
v_pk_mul_f32 v[62:63], v[62:63], v[100:101] op_sel:[0,0] op_sel_hi:[1,0]
v_pk_mul_f32 v[64:65], v[64:65], v[100:101] op_sel:[0,0] op_sel_hi:[1,0]
v_pk_mul_f32 v[66:67], v[66:67], v[100:101] op_sel:[0,0] op_sel_hi:[1,0]
v_pk_mul_f32 v[220:221], v[220:221], v[104:105] op_sel:[0,0] op_sel_hi:[1,0]
v_pk_mul_f32 v[222:223], v[222:223], v[104:105] op_sel:[0,0] op_sel_hi:[1,0]
v_pk_mul_f32 v[224:225], v[224:225], v[104:105] op_sel:[0,0] op_sel_hi:[1,0]
v_pk_mul_f32 v[226:227], v[226:227], v[104:105] op_sel:[0,0] op_sel_hi:[1,0]
v_cvt_pk_bf16_f32 v60, v60, v61
v_cvt_pk_bf16_f32 v61, v62, v63
v_cvt_pk_bf16_f32 v62, v64, v65
v_cvt_pk_bf16_f32 v63, v66, v67
v_cvt_pk_bf16_f32 v220, v220, v221
v_cvt_pk_bf16_f32 v221, v222, v223
v_cvt_pk_bf16_f32 v222, v224, v225
v_cvt_pk_bf16_f32 v223, v226, v227
v_pk_mul_f32 v[68:69], v[68:69], v[100:101] op_sel:[0,1] op_sel_hi:[1,1]
v_pk_mul_f32 v[70:71], v[70:71], v[100:101] op_sel:[0,1] op_sel_hi:[1,1]
v_pk_mul_f32 v[72:73], v[72:73], v[100:101] op_sel:[0,1] op_sel_hi:[1,1]
v_pk_mul_f32 v[74:75], v[74:75], v[100:101] op_sel:[0,1] op_sel_hi:[1,1]
v_pk_mul_f32 v[228:229], v[228:229], v[104:105] op_sel:[0,1] op_sel_hi:[1,1]
v_pk_mul_f32 v[230:231], v[230:231], v[104:105] op_sel:[0,1] op_sel_hi:[1,1]
v_pk_mul_f32 v[232:233], v[232:233], v[104:105] op_sel:[0,1] op_sel_hi:[1,1]
v_pk_mul_f32 v[234:235], v[234:235], v[104:105] op_sel:[0,1] op_sel_hi:[1,1]
v_cvt_pk_bf16_f32 v68, v68, v69
v_mfma_f32_16x16x32_bf16 v[204:207], v[60:63], v[38:41], 0
v_cvt_pk_bf16_f32 v69, v70, v71
v_cvt_pk_bf16_f32 v70, v72, v73
v_mfma_f32_16x16x32_bf16 v[208:211], v[60:63], v[36:39], 0
v_cvt_pk_bf16_f32 v71, v74, v75
v_cvt_pk_bf16_f32 v228, v228, v229
v_mfma_f32_16x16x32_bf16 v[212:215], v[220:223], v[38:41], 0
v_cvt_pk_bf16_f32 v229, v230, v231
v_cvt_pk_bf16_f32 v230, v232, v233
v_mfma_f32_16x16x32_bf16 v[216:219], v[220:223], v[36:39], 0
v_cvt_pk_bf16_f32 v231, v234, v235
v_pk_mul_f32 v[76:77], v[76:77], v[102:103] op_sel:[0,0] op_sel_hi:[1,0]
v_pk_mul_f32 v[78:79], v[78:79], v[102:103] op_sel:[0,0] op_sel_hi:[1,0]
v_pk_mul_f32 v[80:81], v[80:81], v[102:103] op_sel:[0,0] op_sel_hi:[1,0]
v_pk_mul_f32 v[82:83], v[82:83], v[102:103] op_sel:[0,0] op_sel_hi:[1,0]
v_pk_mul_f32 v[236:237], v[236:237], v[106:107] op_sel:[0,0] op_sel_hi:[1,0]
v_pk_mul_f32 v[238:239], v[238:239], v[106:107] op_sel:[0,0] op_sel_hi:[1,0]
v_pk_mul_f32 v[240:241], v[240:241], v[106:107] op_sel:[0,0] op_sel_hi:[1,0]
v_pk_mul_f32 v[242:243], v[242:243], v[106:107] op_sel:[0,0] op_sel_hi:[1,0]
v_cvt_pk_bf16_f32 v76, v76, v77
v_mfma_f32_16x16x32_bf16 v[188:191], v[68:71], v[38:41], 0
v_mfma_f32_16x16x32_bf16 v[192:195], v[68:71], v[36:39], 0
v_cvt_pk_bf16_f32 v77, v78, v79
v_mfma_f32_16x16x32_bf16 v[196:199], v[228:231], v[38:41], 0
v_cvt_pk_bf16_f32 v78, v80, v81
v_mfma_f32_16x16x32_bf16 v[200:203], v[228:231], v[36:39], 0
v_cvt_pk_bf16_f32 v64, v204, v205
v_cvt_pk_bf16_f32 v79, v82, v83
v_cvt_pk_bf16_f32 v65, v206, v207
v_cvt_pk_bf16_f32 v236, v236, v237
v_cvt_pk_bf16_f32 v72, v208, v209
v_cvt_pk_bf16_f32 v73, v210, v211
v_cvt_pk_bf16_f32 v237, v238, v239
v_cvt_pk_bf16_f32 v224, v212, v213
v_cvt_pk_bf16_f32 v238, v240, v241
v_cvt_pk_bf16_f32 v225, v214, v215
v_cvt_pk_bf16_f32 v232, v216, v217
v_cvt_pk_bf16_f32 v239, v242, v243
v_cvt_pk_bf16_f32 v233, v218, v219
v_pk_mul_f32 v[84:85], v[84:85], v[102:103] op_sel:[0,1] op_sel_hi:[1,1]
v_pk_mul_f32 v[86:87], v[86:87], v[102:103] op_sel:[0,1] op_sel_hi:[1,1]
v_pk_mul_f32 v[88:89], v[88:89], v[102:103] op_sel:[0,1] op_sel_hi:[1,1]
v_pk_mul_f32 v[90:91], v[90:91], v[102:103] op_sel:[0,1] op_sel_hi:[1,1]
v_pk_mul_f32 v[244:245], v[244:245], v[106:107] op_sel:[0,1] op_sel_hi:[1,1]
v_pk_mul_f32 v[246:247], v[246:247], v[106:107] op_sel:[0,1] op_sel_hi:[1,1]
v_pk_mul_f32 v[248:249], v[248:249], v[106:107] op_sel:[0,1] op_sel_hi:[1,1]
v_pk_mul_f32 v[250:251], v[250:251], v[106:107] op_sel:[0,1] op_sel_hi:[1,1]
v_cvt_pk_bf16_f32 v84, v84, v85
v_mfma_f32_16x16x32_bf16 v[204:207], v[76:79], v[38:41], 0
v_mfma_f32_16x16x32_bf16 v[208:211], v[76:79], v[36:39], 0
v_cvt_pk_bf16_f32 v85, v86, v87
v_mfma_f32_16x16x32_bf16 v[212:215], v[236:239], v[38:41], 0
v_cvt_pk_bf16_f32 v86, v88, v89
v_mfma_f32_16x16x32_bf16 v[216:219], v[236:239], v[36:39], 0
v_cvt_pk_bf16_f32 v66, v188, v189
v_cvt_pk_bf16_f32 v87, v90, v91
v_cvt_pk_bf16_f32 v67, v190, v191
v_cvt_pk_bf16_f32 v244, v244, v245
v_cvt_pk_bf16_f32 v74, v192, v193
v_cvt_pk_bf16_f32 v75, v194, v195
v_cvt_pk_bf16_f32 v245, v246, v247
v_cvt_pk_bf16_f32 v226, v196, v197
v_cvt_pk_bf16_f32 v246, v248, v249
v_cvt_pk_bf16_f32 v227, v198, v199
v_cvt_pk_bf16_f32 v234, v200, v201
v_cvt_pk_bf16_f32 v247, v250, v251
v_cvt_pk_bf16_f32 v235, v202, v203
v_mov_b32 v5, 4
v_cmp_eq_u32 s[50:51], s41, v2
v_mfma_f32_16x16x32_bf16 v[188:191], v[84:87], v[38:41], 0
v_mfma_f32_16x16x32_bf16 v[192:195], v[84:87], v[36:39], 0
v_mfma_f32_16x16x32_bf16 v[196:199], v[244:247], v[38:41], 0
v_mfma_f32_16x16x32_bf16 v[200:203], v[244:247], v[36:39], 0
v_mfma_f32_16x16x32_bf16 v[152:155], v[224:227], v[112:115], 0
v_cvt_pk_bf16_f32 v80, v204, v205
v_cvt_pk_bf16_f32 v81, v206, v207
v_mfma_f32_16x16x32_bf16 v[60:63], v[232:235], v[112:115], 0
v_cvt_pk_bf16_f32 v88, v208, v209
v_mfma_f32_16x16x32_bf16 v[68:71], v[224:227], v[120:123], 0
v_cvt_pk_bf16_f32 v89, v210, v211
v_mfma_f32_16x16x32_bf16 v[220:223], v[232:235], v[120:123], 0
v_cvt_pk_bf16_f32 v240, v212, v213
v_cvt_pk_bf16_f32 v241, v214, v215
v_mfma_f32_16x16x32_bf16 v[228:231], v[224:227], v[48:51], 0
v_cvt_pk_bf16_f32 v248, v216, v217
v_mfma_f32_16x16x32_bf16 v[76:79], v[232:235], v[48:51], 0
v_cvt_pk_bf16_f32 v249, v218, v219
v_mfma_f32_16x16x32_bf16 v[100:103], v[64:67], v[112:115], 0
v_cvt_pk_bf16_f32 v82, v188, v189
v_cvt_pk_bf16_f32 v83, v190, v191
v_mfma_f32_16x16x32_bf16 v[104:107], v[72:75], v[112:115], 0
v_cvt_pk_bf16_f32 v90, v192, v193
v_mfma_f32_16x16x32_bf16 v[108:111], v[64:67], v[120:123], 0
v_cvt_pk_bf16_f32 v91, v194, v195
v_mfma_f32_16x16x32_bf16 v[132:135], v[72:75], v[120:123], 0
v_cvt_pk_bf16_f32 v242, v196, v197
v_cvt_pk_bf16_f32 v243, v198, v199
v_mfma_f32_16x16x32_bf16 v[136:139], v[64:67], v[48:51], 0
v_cvt_pk_bf16_f32 v250, v200, v201
v_mfma_f32_16x16x32_bf16 v[148:151], v[72:75], v[48:51], 0
v_cvt_pk_bf16_f32 v251, v202, v203
s_nop 1
v_mfma_f32_16x16x32_bf16 v[152:155], v[240:243], v[116:119], v[152:155]
v_mfma_f32_16x16x32_bf16 v[60:63], v[248:251], v[116:119], v[60:63]
v_mfma_f32_16x16x32_bf16 v[68:71], v[240:243], v[124:127], v[68:71]
v_mfma_f32_16x16x32_bf16 v[220:223], v[248:251], v[124:127], v[220:223]
v_mfma_f32_16x16x32_bf16 v[228:231], v[240:243], v[48:51], v[228:231]
v_mfma_f32_16x16x32_bf16 v[76:79], v[248:251], v[48:51], v[76:79]
v_mfma_f32_16x16x32_bf16 v[100:103], v[80:83], v[116:119], v[100:103]
v_mfma_f32_16x16x32_bf16 v[104:107], v[88:91], v[116:119], v[104:107]
v_mfma_f32_16x16x32_bf16 v[108:111], v[80:83], v[124:127], v[108:111]
v_mfma_f32_16x16x32_bf16 v[132:135], v[88:91], v[124:127], v[132:135]
v_cvt_pk_bf16_f32 v152, v152, v153
v_cvt_pk_bf16_f32 v153, v154, v155
v_mfma_f32_16x16x32_bf16 v[136:139], v[80:83], v[48:51], v[136:139]
v_cvt_pk_bf16_f32 v154, v60, v61
v_cvt_pk_bf16_f32 v155, v62, v63
v_mfma_f32_16x16x32_bf16 v[148:151], v[88:91], v[48:51], v[148:151]
ds_write_b128 v42, v[152:155] offset:0
v_cvt_pk_bf16_f32 v68, v68, v69
v_cvt_pk_bf16_f32 v69, v70, v71
v_cvt_pk_bf16_f32 v70, v220, v221
v_cvt_pk_bf16_f32 v71, v222, v223
ds_write_b128 v42, v[68:71] offset:1024
v_cvt_pk_bf16_f32 v228, v228, v229
v_cvt_pk_bf16_f32 v229, v230, v231
v_cvt_pk_bf16_f32 v230, v76, v77
v_cvt_pk_bf16_f32 v231, v78, v79
ds_write_b128 v42, v[228:231] offset:2048
ds_write_b32 v52, v5
s_mov_b32 s63, 0
px_121:
ds_read_b32 v4, v19
ds_read_b128 v[188:191], v43 offset:0
ds_read_b128 v[192:195], v43 offset:1024
ds_read_b128 v[196:199], v43 offset:2048
s_add_u32 s63, s63, 1
s_cmp_lt_u32 s63, 0x400000
s_waitcnt lgkmcnt(0)
v_cmp_ne_u32 vcc, 4, v4
s_cbranch_vccz pxd_122
s_cbranch_scc1 px_121
pxd_122:
v_mfma_f32_16x16x32_bf16 v[100:103], v[38:41], v[188:191], v[100:103]
v_mfma_f32_16x16x32_bf16 v[104:107], v[36:39], v[188:191], v[104:107]
v_mfma_f32_16x16x32_bf16 v[108:111], v[38:41], v[192:195], v[108:111]
v_mfma_f32_16x16x32_bf16 v[132:135], v[36:39], v[192:195], v[132:135]
v_mfma_f32_16x16x32_bf16 v[136:139], v[38:41], v[196:199], v[136:139]
v_mfma_f32_16x16x32_bf16 v[148:151], v[36:39], v[196:199], v[148:151]
s_nop 2
v_cvt_pk_bf16_f32 v100, v100, v101
v_cvt_pk_bf16_f32 v101, v102, v103
v_cvt_pk_bf16_f32 v102, v104, v105
v_cvt_pk_bf16_f32 v103, v106, v107
buffer_store_dwordx4 v[100:103], v55, s[32:35], s53 offen sc1
v_cvt_pk_bf16_f32 v108, v108, v109
v_cvt_pk_bf16_f32 v109, v110, v111
v_cvt_pk_bf16_f32 v110, v132, v133
v_cvt_pk_bf16_f32 v111, v134, v135
buffer_store_dwordx4 v[108:111], v55, s[32:35], s54 offen sc1
v_cvt_pk_bf16_f32 v136, v136, v137
v_cvt_pk_bf16_f32 v137, v138, v139
v_cvt_pk_bf16_f32 v138, v148, v149
v_cvt_pk_bf16_f32 v139, v150, v151
s_mov_b64 exec, s[50:51]
buffer_store_dwordx4 v[136:139], v58, s[32:35], s56 offen sc1
s_mov_b64 exec, -1
s_mov_b32 s51, 0
.p2align 3
v_pk_fma_f32 v[156:157], v[140:141], v[92:93], v[156:157] op_sel:[0,1,0] op_sel_hi:[1,1,1]
v_pk_fma_f32 v[158:159], v[142:143], v[92:93], v[158:159] op_sel:[0,1,0] op_sel_hi:[1,1,1]
v_pk_fma_f32 v[160:161], v[144:145], v[92:93], v[160:161] op_sel:[0,1,0] op_sel_hi:[1,1,1]
v_pk_fma_f32 v[162:163], v[146:147], v[92:93], v[162:163] op_sel:[0,1,0] op_sel_hi:[1,1,1]
v_cvt_pk_bf16_f32 v156, v156, v157
v_cvt_pk_bf16_f32 v157, v158, v159
v_cvt_pk_bf16_f32 v158, v160, v161
v_cvt_pk_bf16_f32 v159, v162, v163
v_pk_fma_f32 v[164:165], v[140:141], v[94:95], v[164:165] op_sel:[0,1,0] op_sel_hi:[1,1,1]
v_pk_fma_f32 v[166:167], v[142:143], v[94:95], v[166:167] op_sel:[0,1,0] op_sel_hi:[1,1,1]
v_pk_fma_f32 v[168:169], v[144:145], v[94:95], v[168:169] op_sel:[0,1,0] op_sel_hi:[1,1,1]
v_pk_fma_f32 v[170:171], v[146:147], v[94:95], v[170:171] op_sel:[0,1,0] op_sel_hi:[1,1,1]
v_cvt_pk_bf16_f32 v164, v164, v165
v_mfma_f32_16x16x32_bf16 v[60:63], v[10:13], v[156:159], 0
v_cvt_pk_bf16_f32 v165, v166, v167
v_cvt_pk_bf16_f32 v166, v168, v169
v_mfma_f32_16x16x32_bf16 v[64:67], v[14:17], v[156:159], 0
v_cvt_pk_bf16_f32 v167, v170, v171
v_pk_fma_f32 v[172:173], v[140:141], v[96:97], v[172:173] op_sel:[0,1,0] op_sel_hi:[1,1,1]
v_pk_fma_f32 v[174:175], v[142:143], v[96:97], v[174:175] op_sel:[0,1,0] op_sel_hi:[1,1,1]
v_pk_fma_f32 v[176:177], v[144:145], v[96:97], v[176:177] op_sel:[0,1,0] op_sel_hi:[1,1,1]
v_pk_fma_f32 v[178:179], v[146:147], v[96:97], v[178:179] op_sel:[0,1,0] op_sel_hi:[1,1,1]
v_cvt_pk_bf16_f32 v172, v172, v173
v_mfma_f32_16x16x32_bf16 v[68:71], v[10:13], v[164:167], 0
v_cvt_pk_bf16_f32 v173, v174, v175
v_cvt_pk_bf16_f32 v174, v176, v177
v_mfma_f32_16x16x32_bf16 v[72:75], v[14:17], v[164:167], 0
v_cvt_pk_bf16_f32 v175, v178, v179
v_pk_fma_f32 v[180:181], v[140:141], v[98:99], v[180:181] op_sel:[0,1,0] op_sel_hi:[1,1,1]
v_pk_fma_f32 v[182:183], v[142:143], v[98:99], v[182:183] op_sel:[0,1,0] op_sel_hi:[1,1,1]
v_pk_fma_f32 v[184:185], v[144:145], v[98:99], v[184:185] op_sel:[0,1,0] op_sel_hi:[1,1,1]
v_pk_fma_f32 v[186:187], v[146:147], v[98:99], v[186:187] op_sel:[0,1,0] op_sel_hi:[1,1,1]
v_cvt_pk_bf16_f32 v180, v180, v181
v_mfma_f32_16x16x32_bf16 v[76:79], v[10:13], v[172:175], 0
v_cvt_pk_bf16_f32 v181, v182, v183
v_cvt_pk_bf16_f32 v182, v184, v185
v_mfma_f32_16x16x32_bf16 v[80:83], v[14:17], v[172:175], 0
v_cvt_pk_bf16_f32 v183, v186, v187
s_nop 1
v_mfma_f32_16x16x32_bf16 v[84:87], v[10:13], v[180:183], 0
v_mfma_f32_16x16x32_bf16 v[88:91], v[14:17], v[180:183], 0
v_max3_f32 v100, v60, v61, v62
v_min3_f32 v104, v60, v61, v62
v_max3_f32 v100, v100, v63, v64
v_min3_f32 v104, v104, v63, v64
v_max3_f32 v100, v100, v65, v66
v_min3_f32 v104, v104, v65, v66
v_max_f32 v100, v100, v67
v_min_f32 v104, v104, v67
v_max3_f32 v101, v68, v69, v70
v_min3_f32 v105, v68, v69, v70
v_max3_f32 v101, v101, v71, v72
v_min3_f32 v105, v105, v71, v72
v_max3_f32 v101, v101, v73, v74
v_min3_f32 v105, v105, v73, v74
v_max_f32 v101, v101, v75
v_min_f32 v105, v105, v75
v_max3_f32 v102, v76, v77, v78
v_min3_f32 v106, v76, v77, v78
v_max3_f32 v102, v102, v79, v80
v_min3_f32 v106, v106, v79, v80
v_max3_f32 v102, v102, v81, v82
v_min3_f32 v106, v106, v81, v82
v_max_f32 v102, v102, v83
v_min_f32 v106, v106, v83
v_max3_f32 v103, v84, v85, v86
v_min3_f32 v107, v84, v85, v86
v_max3_f32 v103, v103, v87, v88
v_min3_f32 v107, v107, v87, v88
v_max3_f32 v103, v103, v89, v90
v_min3_f32 v107, v107, v89, v90
v_max_f32 v103, v103, v91
v_min_f32 v107, v107, v91
s_nop 1
v_permlane32_swap_b32 v100, v101
v_permlane32_swap_b32 v102, v103
v_permlane32_swap_b32 v104, v105
v_permlane32_swap_b32 v106, v107
v_max_f32 v100, v100, v101
v_max_f32 v102, v102, v103
v_min_f32 v104, v104, v105
v_min_f32 v106, v106, v107
v_permlane16_swap_b32 v100, v102
s_nop 0
v_permlane16_swap_b32 v104, v106
v_max_f32 v100, v100, v102
v_min_f32 v104, v104, v106
v_mov_b32 v102, v100
v_mov_b32 v106, v104
s_nop 0
v_permlane16_swap_b32 v100, v102
v_permlane16_swap_b32 v104, v106
v_mov_b32 v101, v100
v_mov_b32 v103, v102
v_mov_b32 v105, v104
v_mov_b32 v107, v106
v_permlane32_swap_b32 v100, v101
v_permlane32_swap_b32 v102, v103
v_permlane32_swap_b32 v104, v105
v_permlane32_swap_b32 v106, v107
v_pk_mul_f32 v[100:101], v[100:101], v[128:129]
v_pk_mul_f32 v[102:103], v[102:103], v[130:131]
v_pk_mul_f32 v[104:105], v[104:105], v[128:129]
v_pk_mul_f32 v[106:107], v[106:107], v[130:131]
v_pk_fma_f32 v[220:221], v[60:61], v[128:129], v[104:105] op_sel:[0,0,0] op_sel_hi:[1,0,0] neg_lo:[1,0,0] neg_hi:[1,0,0]
v_pk_fma_f32 v[60:61], v[60:61], v[128:129], v[100:101] op_sel:[0,0,0] op_sel_hi:[1,0,0] neg_lo:[0,0,1] neg_hi:[0,0,1]
v_exp_f32 v220, v220
v_exp_f32 v60, v60
v_exp_f32 v221, v221
v_exp_f32 v61, v61
v_pk_fma_f32 v[222:223], v[62:63], v[128:129], v[104:105] op_sel:[0,0,0] op_sel_hi:[1,0,0] neg_lo:[1,0,0] neg_hi:[1,0,0]
v_pk_fma_f32 v[62:63], v[62:63], v[128:129], v[100:101] op_sel:[0,0,0] op_sel_hi:[1,0,0] neg_lo:[0,0,1] neg_hi:[0,0,1]
v_exp_f32 v222, v222
v_exp_f32 v62, v62
v_exp_f32 v223, v223
v_exp_f32 v63, v63
v_pk_fma_f32 v[224:225], v[64:65], v[128:129], v[104:105] op_sel:[0,0,0] op_sel_hi:[1,0,0] neg_lo:[1,0,0] neg_hi:[1,0,0]
v_pk_fma_f32 v[64:65], v[64:65], v[128:129], v[100:101] op_sel:[0,0,0] op_sel_hi:[1,0,0] neg_lo:[0,0,1] neg_hi:[0,0,1]
v_exp_f32 v224, v224
v_exp_f32 v64, v64
v_exp_f32 v225, v225
v_exp_f32 v65, v65
v_pk_fma_f32 v[226:227], v[66:67], v[128:129], v[104:105] op_sel:[0,0,0] op_sel_hi:[1,0,0] neg_lo:[1,0,0] neg_hi:[1,0,0]
v_pk_fma_f32 v[66:67], v[66:67], v[128:129], v[100:101] op_sel:[0,0,0] op_sel_hi:[1,0,0] neg_lo:[0,0,1] neg_hi:[0,0,1]
v_exp_f32 v226, v226
v_exp_f32 v66, v66
v_exp_f32 v227, v227
v_exp_f32 v67, v67
v_pk_fma_f32 v[228:229], v[68:69], v[128:129], v[104:105] op_sel:[0,1,1] op_sel_hi:[1,1,1] neg_lo:[1,0,0] neg_hi:[1,0,0]
v_pk_fma_f32 v[68:69], v[68:69], v[128:129], v[100:101] op_sel:[0,1,1] op_sel_hi:[1,1,1] neg_lo:[0,0,1] neg_hi:[0,0,1]
v_exp_f32 v228, v228
v_exp_f32 v68, v68
v_exp_f32 v229, v229
v_exp_f32 v69, v69
v_pk_fma_f32 v[230:231], v[70:71], v[128:129], v[104:105] op_sel:[0,1,1] op_sel_hi:[1,1,1] neg_lo:[1,0,0] neg_hi:[1,0,0]
v_pk_fma_f32 v[70:71], v[70:71], v[128:129], v[100:101] op_sel:[0,1,1] op_sel_hi:[1,1,1] neg_lo:[0,0,1] neg_hi:[0,0,1]
v_exp_f32 v230, v230
v_exp_f32 v70, v70
v_exp_f32 v231, v231
v_exp_f32 v71, v71
v_pk_fma_f32 v[232:233], v[72:73], v[128:129], v[104:105] op_sel:[0,1,1] op_sel_hi:[1,1,1] neg_lo:[1,0,0] neg_hi:[1,0,0]
v_pk_fma_f32 v[72:73], v[72:73], v[128:129], v[100:101] op_sel:[0,1,1] op_sel_hi:[1,1,1] neg_lo:[0,0,1] neg_hi:[0,0,1]
v_exp_f32 v232, v232
v_exp_f32 v72, v72
v_exp_f32 v233, v233
v_exp_f32 v73, v73
v_pk_fma_f32 v[234:235], v[74:75], v[128:129], v[104:105] op_sel:[0,1,1] op_sel_hi:[1,1,1] neg_lo:[1,0,0] neg_hi:[1,0,0]
v_pk_fma_f32 v[74:75], v[74:75], v[128:129], v[100:101] op_sel:[0,1,1] op_sel_hi:[1,1,1] neg_lo:[0,0,1] neg_hi:[0,0,1]
v_exp_f32 v234, v234
v_exp_f32 v74, v74
v_exp_f32 v235, v235
v_exp_f32 v75, v75
buffer_load_dwordx4 v[212:215], v18, s[32:35], s55 offen offset:0 sc1
buffer_load_dwordx4 v[216:219], v18, s[32:35], s55 offen offset:1024 sc1
v_pk_fma_f32 v[236:237], v[76:77], v[130:131], v[106:107] op_sel:[0,0,0] op_sel_hi:[1,0,0] neg_lo:[1,0,0] neg_hi:[1,0,0]
v_pk_fma_f32 v[76:77], v[76:77], v[130:131], v[102:103] op_sel:[0,0,0] op_sel_hi:[1,0,0] neg_lo:[0,0,1] neg_hi:[0,0,1]
v_exp_f32 v236, v236
v_exp_f32 v76, v76
v_exp_f32 v237, v237
v_exp_f32 v77, v77
v_pk_fma_f32 v[238:239], v[78:79], v[130:131], v[106:107] op_sel:[0,0,0] op_sel_hi:[1,0,0] neg_lo:[1,0,0] neg_hi:[1,0,0]
v_pk_fma_f32 v[78:79], v[78:79], v[130:131], v[102:103] op_sel:[0,0,0] op_sel_hi:[1,0,0] neg_lo:[0,0,1] neg_hi:[0,0,1]
v_exp_f32 v238, v238
v_exp_f32 v78, v78
v_exp_f32 v239, v239
v_exp_f32 v79, v79
v_pk_fma_f32 v[240:241], v[80:81], v[130:131], v[106:107] op_sel:[0,0,0] op_sel_hi:[1,0,0] neg_lo:[1,0,0] neg_hi:[1,0,0]
v_pk_fma_f32 v[80:81], v[80:81], v[130:131], v[102:103] op_sel:[0,0,0] op_sel_hi:[1,0,0] neg_lo:[0,0,1] neg_hi:[0,0,1]
v_exp_f32 v240, v240
v_exp_f32 v80, v80
v_exp_f32 v241, v241
v_exp_f32 v81, v81
v_pk_fma_f32 v[242:243], v[82:83], v[130:131], v[106:107] op_sel:[0,0,0] op_sel_hi:[1,0,0] neg_lo:[1,0,0] neg_hi:[1,0,0]
v_pk_fma_f32 v[82:83], v[82:83], v[130:131], v[102:103] op_sel:[0,0,0] op_sel_hi:[1,0,0] neg_lo:[0,0,1] neg_hi:[0,0,1]
v_exp_f32 v242, v242
v_exp_f32 v82, v82
v_exp_f32 v243, v243
v_exp_f32 v83, v83
v_pk_fma_f32 v[244:245], v[84:85], v[130:131], v[106:107] op_sel:[0,1,1] op_sel_hi:[1,1,1] neg_lo:[1,0,0] neg_hi:[1,0,0]
v_pk_fma_f32 v[84:85], v[84:85], v[130:131], v[102:103] op_sel:[0,1,1] op_sel_hi:[1,1,1] neg_lo:[0,0,1] neg_hi:[0,0,1]
v_exp_f32 v244, v244
v_exp_f32 v84, v84
v_exp_f32 v245, v245
v_exp_f32 v85, v85
v_pk_fma_f32 v[246:247], v[86:87], v[130:131], v[106:107] op_sel:[0,1,1] op_sel_hi:[1,1,1] neg_lo:[1,0,0] neg_hi:[1,0,0]
v_pk_fma_f32 v[86:87], v[86:87], v[130:131], v[102:103] op_sel:[0,1,1] op_sel_hi:[1,1,1] neg_lo:[0,0,1] neg_hi:[0,0,1]
v_exp_f32 v246, v246
v_exp_f32 v86, v86
v_exp_f32 v247, v247
v_exp_f32 v87, v87
v_pk_fma_f32 v[248:249], v[88:89], v[130:131], v[106:107] op_sel:[0,1,1] op_sel_hi:[1,1,1] neg_lo:[1,0,0] neg_hi:[1,0,0]
v_pk_fma_f32 v[88:89], v[88:89], v[130:131], v[102:103] op_sel:[0,1,1] op_sel_hi:[1,1,1] neg_lo:[0,0,1] neg_hi:[0,0,1]
v_exp_f32 v248, v248
v_exp_f32 v88, v88
v_exp_f32 v249, v249
v_exp_f32 v89, v89
v_pk_fma_f32 v[250:251], v[90:91], v[130:131], v[106:107] op_sel:[0,1,1] op_sel_hi:[1,1,1] neg_lo:[1,0,0] neg_hi:[1,0,0]
v_pk_fma_f32 v[90:91], v[90:91], v[130:131], v[102:103] op_sel:[0,1,1] op_sel_hi:[1,1,1] neg_lo:[0,0,1] neg_hi:[0,0,1]
v_exp_f32 v250, v250
v_exp_f32 v90, v90
v_exp_f32 v251, v251
v_exp_f32 v91, v91
v_pk_add_f32 v[108:109], v[60:61], v[62:63]
v_pk_add_f32 v[110:111], v[220:221], v[222:223]
v_pk_add_f32 v[108:109], v[108:109], v[64:65]
v_pk_add_f32 v[110:111], v[110:111], v[224:225]
v_pk_add_f32 v[108:109], v[108:109], v[66:67]
v_pk_add_f32 v[110:111], v[110:111], v[226:227]
v_add_f32 v100, v108, v109
v_add_f32 v104, v110, v111
v_pk_add_f32 v[108:109], v[68:69], v[70:71]
v_pk_add_f32 v[110:111], v[228:229], v[230:231]
v_pk_add_f32 v[108:109], v[108:109], v[72:73]
v_pk_add_f32 v[110:111], v[110:111], v[232:233]
v_pk_add_f32 v[108:109], v[108:109], v[74:75]
v_pk_add_f32 v[110:111], v[110:111], v[234:235]
v_add_f32 v101, v108, v109
v_add_f32 v105, v110, v111
v_pk_add_f32 v[108:109], v[76:77], v[78:79]
v_pk_add_f32 v[110:111], v[236:237], v[238:239]
v_pk_add_f32 v[108:109], v[108:109], v[80:81]
v_pk_add_f32 v[110:111], v[110:111], v[240:241]
v_pk_add_f32 v[108:109], v[108:109], v[82:83]
v_pk_add_f32 v[110:111], v[110:111], v[242:243]
v_add_f32 v102, v108, v109
v_add_f32 v106, v110, v111
v_pk_add_f32 v[108:109], v[84:85], v[86:87]
v_pk_add_f32 v[110:111], v[244:245], v[246:247]
v_pk_add_f32 v[108:109], v[108:109], v[88:89]
v_pk_add_f32 v[110:111], v[110:111], v[248:249]
v_pk_add_f32 v[108:109], v[108:109], v[90:91]
v_pk_add_f32 v[110:111], v[110:111], v[250:251]
v_add_f32 v103, v108, v109
v_add_f32 v107, v110, v111
s_cmp_eq_u32 s51, 1
s_cbranch_scc1 chk_123
s_waitcnt vmcnt(0)
v_max_u32 v4, v212, v213
v_max3_u32 v4, v4, v214, v215
v_max3_u32 v4, v4, v216, v217
v_max3_u32 v4, v4, v218, v219
v_cmp_eq_u32 vcc, -1, v4
s_cbranch_vccz red_124
buffer_load_dwordx4 v[212:215], v18, s[32:35], s55 offen offset:0 sc1
buffer_load_dwordx4 v[216:219], v18, s[32:35], s55 offen offset:1024 sc1
s_branch chk_123
red_124:
v_mfma_f32_16x16x32_bf16 v[132:135], v[44:47], v[212:215], 0
v_mfma_f32_16x16x32_bf16 v[132:135], v[44:47], v[216:219], v[132:135]
s_mov_b32 s51, 1
s_nop 6
v_add_f32_dpp v132, v132, v132 row_ror:8 row_mask:0xf bank_mask:0xf
v_add_f32_dpp v133, v133, v133 row_ror:8 row_mask:0xf bank_mask:0xf
v_add_f32_dpp v134, v134, v134 row_ror:8 row_mask:0xf bank_mask:0xf
v_add_f32_dpp v135, v135, v135 row_ror:8 row_mask:0xf bank_mask:0xf
v_cvt_pk_bf16_f32 v132, v132, v133
v_cvt_pk_bf16_f32 v133, v134, v135
s_mov_b64 exec, 0x00ff00ff
buffer_store_dwordx2 v[132:133], v59, s[32:35], s79 offen sc1
s_mov_b64 exec, -1
buffer_load_dwordx4 v[204:207], v58, s[32:35], s56 offen sc1
buffer_load_dwordx4 v[208:211], v58, s[32:35], s57 offen sc1
chk_123:
s_nop 1
v_permlane32_swap_b32 v100, v101
v_permlane32_swap_b32 v102, v103
v_permlane32_swap_b32 v104, v105
v_permlane32_swap_b32 v106, v107
v_add_f32 v100, v100, v101
v_add_f32 v102, v102, v103
v_add_f32 v104, v104, v105
v_add_f32 v106, v106, v107
v_permlane16_swap_b32 v100, v102
s_nop 0
v_permlane16_swap_b32 v104, v106
v_add_f32 v100, v100, v102
v_add_f32 v104, v104, v106
v_rcp_f32 v100, v100
v_rcp_f32 v104, v104
s_nop 0
v_mov_b32 v102, v100
v_mov_b32 v106, v104
s_nop 0
v_permlane16_swap_b32 v100, v102
v_permlane16_swap_b32 v104, v106
v_mov_b32 v101, v100
v_mov_b32 v103, v102
v_mov_b32 v105, v104
v_mov_b32 v107, v106
v_permlane32_swap_b32 v100, v101
v_permlane32_swap_b32 v102, v103
v_permlane32_swap_b32 v104, v105
v_permlane32_swap_b32 v106, v107
.p2align 3
v_pk_mul_f32 v[60:61], v[60:61], v[100:101] op_sel:[0,0] op_sel_hi:[1,0]
v_pk_mul_f32 v[62:63], v[62:63], v[100:101] op_sel:[0,0] op_sel_hi:[1,0]
v_pk_mul_f32 v[64:65], v[64:65], v[100:101] op_sel:[0,0] op_sel_hi:[1,0]
v_pk_mul_f32 v[66:67], v[66:67], v[100:101] op_sel:[0,0] op_sel_hi:[1,0]
v_pk_mul_f32 v[220:221], v[220:221], v[104:105] op_sel:[0,0] op_sel_hi:[1,0]
v_pk_mul_f32 v[222:223], v[222:223], v[104:105] op_sel:[0,0] op_sel_hi:[1,0]
v_pk_mul_f32 v[224:225], v[224:225], v[104:105] op_sel:[0,0] op_sel_hi:[1,0]
v_pk_mul_f32 v[226:227], v[226:227], v[104:105] op_sel:[0,0] op_sel_hi:[1,0]
v_cvt_pk_bf16_f32 v60, v60, v61
v_cvt_pk_bf16_f32 v61, v62, v63
v_cvt_pk_bf16_f32 v62, v64, v65
v_cvt_pk_bf16_f32 v63, v66, v67
v_cvt_pk_bf16_f32 v220, v220, v221
v_cvt_pk_bf16_f32 v221, v222, v223
v_cvt_pk_bf16_f32 v222, v224, v225
v_cvt_pk_bf16_f32 v223, v226, v227
v_pk_mul_f32 v[68:69], v[68:69], v[100:101] op_sel:[0,1] op_sel_hi:[1,1]
v_pk_mul_f32 v[70:71], v[70:71], v[100:101] op_sel:[0,1] op_sel_hi:[1,1]
v_pk_mul_f32 v[72:73], v[72:73], v[100:101] op_sel:[0,1] op_sel_hi:[1,1]
v_pk_mul_f32 v[74:75], v[74:75], v[100:101] op_sel:[0,1] op_sel_hi:[1,1]
v_pk_mul_f32 v[228:229], v[228:229], v[104:105] op_sel:[0,1] op_sel_hi:[1,1]
v_pk_mul_f32 v[230:231], v[230:231], v[104:105] op_sel:[0,1] op_sel_hi:[1,1]
v_pk_mul_f32 v[232:233], v[232:233], v[104:105] op_sel:[0,1] op_sel_hi:[1,1]
v_pk_mul_f32 v[234:235], v[234:235], v[104:105] op_sel:[0,1] op_sel_hi:[1,1]
v_cvt_pk_bf16_f32 v68, v68, v69
v_cvt_pk_bf16_f32 v69, v70, v71
v_cvt_pk_bf16_f32 v70, v72, v73
v_cvt_pk_bf16_f32 v71, v74, v75
v_cvt_pk_bf16_f32 v228, v228, v229
v_cvt_pk_bf16_f32 v229, v230, v231
v_cvt_pk_bf16_f32 v230, v232, v233
v_cvt_pk_bf16_f32 v231, v234, v235
v_pk_mul_f32 v[76:77], v[76:77], v[102:103] op_sel:[0,0] op_sel_hi:[1,0]
v_pk_mul_f32 v[78:79], v[78:79], v[102:103] op_sel:[0,0] op_sel_hi:[1,0]
v_pk_mul_f32 v[80:81], v[80:81], v[102:103] op_sel:[0,0] op_sel_hi:[1,0]
v_pk_mul_f32 v[82:83], v[82:83], v[102:103] op_sel:[0,0] op_sel_hi:[1,0]
v_pk_mul_f32 v[236:237], v[236:237], v[106:107] op_sel:[0,0] op_sel_hi:[1,0]
v_pk_mul_f32 v[238:239], v[238:239], v[106:107] op_sel:[0,0] op_sel_hi:[1,0]
v_pk_mul_f32 v[240:241], v[240:241], v[106:107] op_sel:[0,0] op_sel_hi:[1,0]
v_pk_mul_f32 v[242:243], v[242:243], v[106:107] op_sel:[0,0] op_sel_hi:[1,0]
v_cvt_pk_bf16_f32 v76, v76, v77
v_cvt_pk_bf16_f32 v77, v78, v79
v_cvt_pk_bf16_f32 v78, v80, v81
v_cvt_pk_bf16_f32 v79, v82, v83
v_cvt_pk_bf16_f32 v236, v236, v237
v_cvt_pk_bf16_f32 v237, v238, v239
v_cvt_pk_bf16_f32 v238, v240, v241
v_cvt_pk_bf16_f32 v239, v242, v243
v_pk_mul_f32 v[84:85], v[84:85], v[102:103] op_sel:[0,1] op_sel_hi:[1,1]
v_pk_mul_f32 v[86:87], v[86:87], v[102:103] op_sel:[0,1] op_sel_hi:[1,1]
v_pk_mul_f32 v[88:89], v[88:89], v[102:103] op_sel:[0,1] op_sel_hi:[1,1]
v_pk_mul_f32 v[90:91], v[90:91], v[102:103] op_sel:[0,1] op_sel_hi:[1,1]
v_pk_mul_f32 v[244:245], v[244:245], v[106:107] op_sel:[0,1] op_sel_hi:[1,1]
v_pk_mul_f32 v[246:247], v[246:247], v[106:107] op_sel:[0,1] op_sel_hi:[1,1]
v_pk_mul_f32 v[248:249], v[248:249], v[106:107] op_sel:[0,1] op_sel_hi:[1,1]
v_pk_mul_f32 v[250:251], v[250:251], v[106:107] op_sel:[0,1] op_sel_hi:[1,1]
v_cvt_pk_bf16_f32 v84, v84, v85
v_cvt_pk_bf16_f32 v85, v86, v87
v_cvt_pk_bf16_f32 v86, v88, v89
v_cvt_pk_bf16_f32 v87, v90, v91
v_cvt_pk_bf16_f32 v244, v244, v245
v_cvt_pk_bf16_f32 v245, v246, v247
v_cvt_pk_bf16_f32 v246, v248, v249
v_cvt_pk_bf16_f32 v247, v250, v251
s_cmp_lg_u32 s51, 0
s_cbranch_scc1 else_125
s_mov_b32 s63, 0
sent_127:
s_waitcnt vmcnt(0)
v_max_u32 v4, v212, v213
v_max3_u32 v4, v4, v214, v215
v_max3_u32 v4, v4, v216, v217
v_max3_u32 v4, v4, v218, v219
v_cmp_eq_u32 vcc, -1, v4
s_cbranch_vccz sentd_128
buffer_load_dwordx4 v[212:215], v18, s[32:35], s55 offen offset:0 sc1
buffer_load_dwordx4 v[216:219], v18, s[32:35], s55 offen offset:1024 sc1
s_add_u32 s63, s63, 1
s_cmp_lt_u32 s63, 0x80000
s_cbranch_scc1 sent_127
s_waitcnt vmcnt(0)
sentd_128:
v_mfma_f32_16x16x32_bf16 v[132:135], v[44:47], v[212:215], 0
v_mfma_f32_16x16x32_bf16 v[132:135], v[44:47], v[216:219], v[132:135]
s_mov_b32 s51, 1
s_nop 6
v_add_f32_dpp v132, v132, v132 row_ror:8 row_mask:0xf bank_mask:0xf
v_add_f32_dpp v133, v133, v133 row_ror:8 row_mask:0xf bank_mask:0xf
v_add_f32_dpp v134, v134, v134 row_ror:8 row_mask:0xf bank_mask:0xf
v_add_f32_dpp v135, v135, v135 row_ror:8 row_mask:0xf bank_mask:0xf
v_cvt_pk_bf16_f32 v132, v132, v133
v_cvt_pk_bf16_f32 v133, v134, v135
s_mov_b64 exec, 0x00ff00ff
buffer_store_dwordx2 v[132:133], v59, s[32:35], s79 offen sc1
s_mov_b64 exec, -1
buffer_load_dwordx4 v[204:207], v58, s[32:35], s56 offen sc1
buffer_load_dwordx4 v[208:211], v58, s[32:35], s57 offen sc1
else_125:
s_mov_b32 s63, 0
sent_129:
s_waitcnt vmcnt(0)
v_max_u32 v4, v204, v205
v_max3_u32 v4, v4, v206, v207
v_max3_u32 v4, v4, v208, v209
v_max3_u32 v4, v4, v210, v211
v_cmp_eq_u32 vcc, -1, v4
s_cbranch_vccz sentd_130
buffer_load_dwordx4 v[204:207], v58, s[32:35], s56 offen sc1
buffer_load_dwordx4 v[208:211], v58, s[32:35], s57 offen sc1
s_add_u32 s63, s63, 1
s_cmp_lt_u32 s63, 0x80000
s_cbranch_scc1 sent_129
s_waitcnt vmcnt(0)
sentd_130:
buffer_load_dwordx4 v[188:191], v18, s[32:35], s58 offen offset:0 sc1
buffer_load_dwordx4 v[192:195], v18, s[32:35], s58 offen offset:1024 sc1
buffer_load_dwordx4 v[196:199], v18, s[32:35], s59 offen offset:0 sc1
buffer_load_dwordx4 v[200:203], v18, s[32:35], s59 offen offset:1024 sc1
v_mfma_f32_16x16x32_bf16 v[112:115], v[204:207], v[60:63], 0
v_mfma_f32_16x16x32_bf16 v[116:119], v[204:207], v[68:71], 0
v_mfma_f32_16x16x32_bf16 v[120:123], v[204:207], v[76:79], 0
v_mfma_f32_16x16x32_bf16 v[124:127], v[204:207], v[84:87], 0
v_mfma_f32_16x16x32_bf16 v[112:115], v[208:211], v[220:223], v[112:115]
v_mfma_f32_16x16x32_bf16 v[116:119], v[208:211], v[228:231], v[116:119]
v_mfma_f32_16x16x32_bf16 v[120:123], v[208:211], v[236:239], v[120:123]
v_mfma_f32_16x16x32_bf16 v[124:127], v[208:211], v[244:247], v[124:127]
s_nop 4
v_add_f32 v100, v112, v113
v_add_f32 v114, v114, v115
v_add_f32 v100, v100, v114
v_add_f32 v101, v116, v117
v_add_f32 v118, v118, v119
v_add_f32 v101, v101, v118
v_add_f32 v102, v120, v121
v_add_f32 v122, v122, v123
v_add_f32 v102, v102, v122
v_add_f32 v103, v124, v125
v_add_f32 v126, v126, v127
v_add_f32 v103, v103, v126
s_nop 1
v_permlane32_swap_b32 v100, v101
v_permlane32_swap_b32 v102, v103
v_add_f32 v100, v100, v101
v_add_f32 v102, v102, v103
s_nop 1
v_permlane16_swap_b32 v100, v102
s_nop 0
v_add_f32 v100, v100, v102
v_add_f32 v100, 0x358637bd, v100
v_rcp_f32 v100, v100
s_nop 0
v_mov_b32 v102, v100
s_nop 1
v_permlane16_swap_b32 v100, v102
s_nop 0
v_mov_b32 v101, v100
v_mov_b32 v103, v102
s_nop 0
v_permlane32_swap_b32 v100, v101
v_permlane32_swap_b32 v102, v103
s_mov_b32 s63, 0
sent_131:
s_waitcnt vmcnt(0)
v_max_u32 v4, v188, v189
v_max3_u32 v4, v4, v190, v191
v_max3_u32 v4, v4, v192, v193
v_max3_u32 v4, v4, v194, v195
v_max3_u32 v4, v4, v196, v197
v_max3_u32 v4, v4, v198, v199
v_max3_u32 v4, v4, v200, v201
v_max3_u32 v4, v4, v202, v203
v_cmp_eq_u32 vcc, -1, v4
s_cbranch_vccz sentd_132
buffer_load_dwordx4 v[188:191], v18, s[32:35], s58 offen offset:0 sc1
buffer_load_dwordx4 v[192:195], v18, s[32:35], s58 offen offset:1024 sc1
buffer_load_dwordx4 v[196:199], v18, s[32:35], s59 offen offset:0 sc1
buffer_load_dwordx4 v[200:203], v18, s[32:35], s59 offen offset:1024 sc1
s_add_u32 s63, s63, 1
s_cmp_lt_u32 s63, 0x80000
s_cbranch_scc1 sent_131
s_waitcnt vmcnt(0)
sentd_132:
v_mfma_f32_16x16x32_bf16 v[156:159], v[188:191], v[60:63], 0
v_mfma_f32_16x16x32_bf16 v[160:163], v[192:195], v[60:63], 0
v_mfma_f32_16x16x32_bf16 v[156:159], v[196:199], v[220:223], v[156:159]
v_mfma_f32_16x16x32_bf16 v[160:163], v[200:203], v[220:223], v[160:163]
v_mfma_f32_16x16x32_bf16 v[164:167], v[188:191], v[68:71], 0
v_mfma_f32_16x16x32_bf16 v[168:171], v[192:195], v[68:71], 0
v_mfma_f32_16x16x32_bf16 v[164:167], v[196:199], v[228:231], v[164:167]
v_mfma_f32_16x16x32_bf16 v[168:171], v[200:203], v[228:231], v[168:171]
s_nop 1
s_cmp_eq_u32 s46, 0
s_cbranch_scc1 slow_133
.p2align 3
v_pk_mul_f32 v[156:157], v[156:157], v[100:101] op_sel:[0,0] op_sel_hi:[1,0]
v_pk_mul_f32 v[158:159], v[158:159], v[100:101] op_sel:[0,0] op_sel_hi:[1,0]
v_pk_mul_f32 v[160:161], v[160:161], v[100:101] op_sel:[0,0] op_sel_hi:[1,0]
v_pk_mul_f32 v[162:163], v[162:163], v[100:101] op_sel:[0,0] op_sel_hi:[1,0]
v_cvt_pk_bf16_f32 v156, v156, v157
v_mfma_f32_16x16x32_bf16 v[172:175], v[188:191], v[76:79], 0
v_cvt_pk_bf16_f32 v157, v158, v159
v_mfma_f32_16x16x32_bf16 v[176:179], v[192:195], v[76:79], 0
v_cvt_pk_bf16_f32 v158, v160, v161
v_mfma_f32_16x16x32_bf16 v[172:175], v[196:199], v[236:239], v[172:175]
v_cvt_pk_bf16_f32 v159, v162, v163
v_mfma_f32_16x16x32_bf16 v[176:179], v[200:203], v[236:239], v[176:179]
buffer_store_dwordx4 v[156:159], v18, s[32:35], s80 offen
v_pk_mul_f32 v[164:165], v[164:165], v[100:101] op_sel:[0,1] op_sel_hi:[1,1]
v_pk_mul_f32 v[166:167], v[166:167], v[100:101] op_sel:[0,1] op_sel_hi:[1,1]
v_pk_mul_f32 v[168:169], v[168:169], v[100:101] op_sel:[0,1] op_sel_hi:[1,1]
v_pk_mul_f32 v[170:171], v[170:171], v[100:101] op_sel:[0,1] op_sel_hi:[1,1]
v_cvt_pk_bf16_f32 v164, v164, v165
v_mfma_f32_16x16x32_bf16 v[180:183], v[188:191], v[84:87], 0
v_cvt_pk_bf16_f32 v165, v166, v167
v_mfma_f32_16x16x32_bf16 v[184:187], v[192:195], v[84:87], 0
v_cvt_pk_bf16_f32 v166, v168, v169
v_mfma_f32_16x16x32_bf16 v[180:183], v[196:199], v[244:247], v[180:183]
v_cvt_pk_bf16_f32 v167, v170, v171
v_mfma_f32_16x16x32_bf16 v[184:187], v[200:203], v[244:247], v[184:187]
buffer_store_dwordx4 v[164:167], v18, s[32:35], s81 offen
v_pk_mul_f32 v[172:173], v[172:173], v[102:103] op_sel:[0,0] op_sel_hi:[1,0]
v_pk_mul_f32 v[174:175], v[174:175], v[102:103] op_sel:[0,0] op_sel_hi:[1,0]
v_pk_mul_f32 v[176:177], v[176:177], v[102:103] op_sel:[0,0] op_sel_hi:[1,0]
v_pk_mul_f32 v[178:179], v[178:179], v[102:103] op_sel:[0,0] op_sel_hi:[1,0]
v_cvt_pk_bf16_f32 v172, v172, v173
v_cvt_pk_bf16_f32 v173, v174, v175
v_cvt_pk_bf16_f32 v174, v176, v177
v_cvt_pk_bf16_f32 v175, v178, v179
buffer_store_dwordx4 v[172:175], v18, s[32:35], s82 offen
v_pk_mul_f32 v[180:181], v[180:181], v[102:103] op_sel:[0,1] op_sel_hi:[1,1]
v_pk_mul_f32 v[182:183], v[182:183], v[102:103] op_sel:[0,1] op_sel_hi:[1,1]
v_pk_mul_f32 v[184:185], v[184:185], v[102:103] op_sel:[0,1] op_sel_hi:[1,1]
v_pk_mul_f32 v[186:187], v[186:187], v[102:103] op_sel:[0,1] op_sel_hi:[1,1]
v_cvt_pk_bf16_f32 v180, v180, v181
v_cvt_pk_bf16_f32 v181, v182, v183
v_cvt_pk_bf16_f32 v182, v184, v185
v_cvt_pk_bf16_f32 v183, v186, v187
buffer_store_dwordx4 v[180:183], v18, s[32:35], s83 offen
back_134:
s_barrier
v_and_b32 v36, 31, v0
v_lshlrev_b32 v36, 2, v36
s_lshl_b32 s62, s45, 2
v_mov_b32 v4, s62
v_mov_b32 v5, 4
s_mov_b64 exec, 1
s_waitcnt vmcnt(0)
s_cmp_eq_u32 s46, 0
s_cbranch_scc1 slow_135
buffer_store_dword v5, v4, s[32:35], s84 offen
back_136:
s_mov_b64 exec, -1
v_lshrrev_b32 v4, 2, v2
v_and_b32 v5, 3, v0
v_lshl_add_u32 v6, v3, 3, v4
v_lshlrev_b32 v6, 7, v6
v_lshl_add_u32 v6, v5, 3, v6
v_lshrrev_b32 v7, 1, v4
v_and_b32 v8, 1, v3
v_lshl_add_u32 v7, v8, 1, v7
v_lshl_add_u32 v10, v7, 5, v6
v_xor_b32 v11, 32, v10
v_xor_b32 v12, 64, v10
v_xor_b32 v13, 96, v10
v_add_u32 v14, 0x10000, v10
v_add_u32 v15, 0x10000, v11
v_add_u32 v16, 0x10000, v12
v_add_u32 v17, 0x10000, v13
ds_read_b64_tr_b16 v[220:221], v10 offset:0
ds_read_b64_tr_b16 v[222:223], v10 offset:512
ds_read_b64_tr_b16 v[224:225], v11 offset:0
ds_read_b64_tr_b16 v[226:227], v11 offset:512
ds_read_b64_tr_b16 v[228:229], v12 offset:0
ds_read_b64_tr_b16 v[230:231], v12 offset:512
ds_read_b64_tr_b16 v[232:233], v13 offset:0
ds_read_b64_tr_b16 v[234:235], v13 offset:512
ds_read_b64_tr_b16 v[236:237], v10 offset:4096
ds_read_b64_tr_b16 v[238:239], v10 offset:4608
ds_read_b64_tr_b16 v[240:241], v11 offset:4096
ds_read_b64_tr_b16 v[242:243], v11 offset:4608
ds_read_b64_tr_b16 v[244:245], v12 offset:4096
ds_read_b64_tr_b16 v[246:247], v12 offset:4608
ds_read_b64_tr_b16 v[248:249], v13 offset:4096
ds_read_b64_tr_b16 v[250:251], v13 offset:4608
s_lshl_b32 s48, s41, 3
s_lshl_b32 s49, s40, 1
s_add_u32 s48, s48, s49
s_lshl_b32 s48, s48, 15
s_add_u32 s48, s48, 4194304
v_add_u32 v38, s48, v18
v_add_u32 v39, 32768, v38
s_lshl_b32 s57, s75, 11
s_add_u32 s87, s87, 262144
v_lshlrev_b32 v60, 16, v20
v_and_b32 v61, 0xffff0000, v20
v_lshlrev_b32 v62, 16, v21
v_and_b32 v63, 0xffff0000, v21
v_lshlrev_b32 v64, 16, v22
v_and_b32 v65, 0xffff0000, v22
v_lshlrev_b32 v66, 16, v23
v_and_b32 v67, 0xffff0000, v23
v_lshlrev_b32 v68, 16, v24
v_and_b32 v69, 0xffff0000, v24
v_lshlrev_b32 v70, 16, v25
v_and_b32 v71, 0xffff0000, v25
v_lshlrev_b32 v72, 16, v26
v_and_b32 v73, 0xffff0000, v26
v_lshlrev_b32 v74, 16, v27
v_and_b32 v75, 0xffff0000, v27
v_lshlrev_b32 v76, 16, v28
v_and_b32 v77, 0xffff0000, v28
v_lshlrev_b32 v78, 16, v29
v_and_b32 v79, 0xffff0000, v29
v_lshlrev_b32 v80, 16, v30
v_and_b32 v81, 0xffff0000, v30
v_lshlrev_b32 v82, 16, v31
v_and_b32 v83, 0xffff0000, v31
v_lshlrev_b32 v84, 16, v32
v_and_b32 v85, 0xffff0000, v32
v_lshlrev_b32 v86, 16, v33
v_and_b32 v87, 0xffff0000, v33
v_lshlrev_b32 v88, 16, v34
v_and_b32 v89, 0xffff0000, v34
v_lshlrev_b32 v90, 16, v35
v_and_b32 v91, 0xffff0000, v35
s_lshl_b32 s48, s40, 12
s_add_u32 s48, s48, 139264
v_lshrrev_b32 v4, 1, v2
v_lshrrev_b32 v5, 1, v3
v_xor_b32 v4, v4, v5
v_lshlrev_b32 v4, 4, v4
v_and_b32 v5, 1, v3
v_lshl_add_u32 v4, v5, 3, v4
v_lshl_add_u32 v4, v2, 7, v4
v_add_u32 v42, s48, v4
v_xor_b32 v43, 32, v42
v_xor_b32 v44, 64, v42
v_xor_b32 v45, 96, v42
v_add_u32 v46, s48, v18
s_lshl_b32 s48, s41, 7
s_lshl_b32 s49, s40, 5
s_add_u32 s48, s48, s49
s_lshl_b32 s48, s48, 11
s_lshl_b32 s49, s78, 7
s_add_u32 s48, s48, s49
s_add_u32 s49, s48, 32768
v_lshrrev_b32 v4, 3, v0
v_and_b32 v5, 7, v0
v_lshrrev_b32 v6, 1, v4
v_xor_b32 v5, v5, v6
v_lshlrev_b32 v4, 11, v4
v_lshl_add_u32 v40, v5, 4, v4
v_xor_b32 v41, 64, v40
v_add_u32 v41, 16384, v41
buffer_load_dword v37, v36, s[32:35], s84 offen sc1
s_mov_b32 s63, 0
s_waitcnt vmcnt(0)
poll_137:
v_cmp_gt_u32 vcc, 4, v37
s_cbranch_vccz polled_138
buffer_load_dword v37, v36, s[32:35], s84 offen sc1
s_add_u32 s63, s63, 1
s_cmp_lt_u32 s63, 0x80000
s_waitcnt vmcnt(0)
s_cbranch_scc1 poll_137
polled_138:
buffer_load_dwordx4 v[156:159], v38, s[32:35], s57 offen sc1
buffer_load_dwordx4 v[160:163], v39, s[32:35], s57 offen sc1
buffer_load_dwordx4 v[164:167], v38, s[32:35], s57 offen offset:1024 sc1
buffer_load_dwordx4 v[168:171], v39, s[32:35], s57 offen offset:1024 sc1
s_add_u32 s57, s57, 2048
s_and_b32 s57, s57, 0x7fff
buffer_load_dwordx4 v[172:175], v38, s[32:35], s57 offen sc1
buffer_load_dwordx4 v[176:179], v39, s[32:35], s57 offen sc1
buffer_load_dwordx4 v[180:183], v38, s[32:35], s57 offen offset:1024 sc1
buffer_load_dwordx4 v[184:187], v39, s[32:35], s57 offen offset:1024 sc1
s_add_u32 s57, s57, 2048
s_and_b32 s57, s57, 0x7fff
s_waitcnt vmcnt(6) lgkmcnt(8)
v_mfma_f32_16x16x32_bf16 v[60:63], v[220:223], v[156:159], v[60:63]
buffer_load_dwordx4 v[188:191], v38, s[32:35], s57 offen sc1
v_mfma_f32_16x16x32_bf16 v[76:79], v[220:223], v[160:163], v[76:79]
ds_read_b64_tr_b16 v[100:101], v10 offset:8192
ds_read_b64_tr_b16 v[102:103], v10 offset:8704
v_mfma_f32_16x16x32_bf16 v[80:83], v[224:227], v[160:163], v[80:83]
ds_read_b64_tr_b16 v[104:105], v11 offset:8192
ds_read_b64_tr_b16 v[106:107], v11 offset:8704
v_mfma_f32_16x16x32_bf16 v[64:67], v[224:227], v[156:159], v[64:67]
buffer_load_dwordx4 v[192:195], v39, s[32:35], s57 offen sc1
v_mfma_f32_16x16x32_bf16 v[68:71], v[228:231], v[156:159], v[68:71]
ds_read_b64_tr_b16 v[108:109], v12 offset:8192
ds_read_b64_tr_b16 v[110:111], v12 offset:8704
v_mfma_f32_16x16x32_bf16 v[84:87], v[228:231], v[160:163], v[84:87]
ds_read_b64_tr_b16 v[112:113], v13 offset:8192
ds_read_b64_tr_b16 v[114:115], v13 offset:8704
v_mfma_f32_16x16x32_bf16 v[88:91], v[232:235], v[160:163], v[88:91]
v_mfma_f32_16x16x32_bf16 v[72:75], v[232:235], v[156:159], v[72:75]
s_waitcnt vmcnt(6) lgkmcnt(8)
v_mfma_f32_16x16x32_bf16 v[60:63], v[236:239], v[164:167], v[60:63]
buffer_load_dwordx4 v[196:199], v38, s[32:35], s57 offen offset:1024 sc1
v_mfma_f32_16x16x32_bf16 v[76:79], v[236:239], v[168:171], v[76:79]
ds_read_b64_tr_b16 v[220:221], v10 offset:12288
ds_read_b64_tr_b16 v[222:223], v10 offset:12800
v_mfma_f32_16x16x32_bf16 v[80:83], v[240:243], v[168:171], v[80:83]
ds_read_b64_tr_b16 v[224:225], v11 offset:12288
ds_read_b64_tr_b16 v[226:227], v11 offset:12800
v_mfma_f32_16x16x32_bf16 v[64:67], v[240:243], v[164:167], v[64:67]
buffer_load_dwordx4 v[200:203], v39, s[32:35], s57 offen offset:1024 sc1
v_mfma_f32_16x16x32_bf16 v[68:71], v[244:247], v[164:167], v[68:71]
ds_read_b64_tr_b16 v[228:229], v12 offset:12288
ds_read_b64_tr_b16 v[230:231], v12 offset:12800
v_mfma_f32_16x16x32_bf16 v[84:87], v[244:247], v[168:171], v[84:87]
ds_read_b64_tr_b16 v[232:233], v13 offset:12288
ds_read_b64_tr_b16 v[234:235], v13 offset:12800
v_mfma_f32_16x16x32_bf16 v[88:91], v[248:251], v[168:171], v[88:91]
s_add_u32 s57, s57, 2048
s_and_b32 s57, s57, 0x7fff
v_mfma_f32_16x16x32_bf16 v[72:75], v[248:251], v[164:167], v[72:75]
s_waitcnt vmcnt(6) lgkmcnt(8)
v_mfma_f32_16x16x32_bf16 v[60:63], v[100:103], v[172:175], v[60:63]
buffer_load_dwordx4 v[204:207], v38, s[32:35], s57 offen sc1
v_mfma_f32_16x16x32_bf16 v[76:79], v[100:103], v[176:179], v[76:79]
ds_read_b64_tr_b16 v[236:237], v10 offset:16384
ds_read_b64_tr_b16 v[238:239], v10 offset:16896
v_mfma_f32_16x16x32_bf16 v[80:83], v[104:107], v[176:179], v[80:83]
ds_read_b64_tr_b16 v[240:241], v11 offset:16384
ds_read_b64_tr_b16 v[242:243], v11 offset:16896
v_mfma_f32_16x16x32_bf16 v[64:67], v[104:107], v[172:175], v[64:67]
buffer_load_dwordx4 v[208:211], v39, s[32:35], s57 offen sc1
v_mfma_f32_16x16x32_bf16 v[68:71], v[108:111], v[172:175], v[68:71]
ds_read_b64_tr_b16 v[244:245], v12 offset:16384
ds_read_b64_tr_b16 v[246:247], v12 offset:16896
v_mfma_f32_16x16x32_bf16 v[84:87], v[108:111], v[176:179], v[84:87]
ds_read_b64_tr_b16 v[248:249], v13 offset:16384
ds_read_b64_tr_b16 v[250:251], v13 offset:16896
v_mfma_f32_16x16x32_bf16 v[88:91], v[112:115], v[176:179], v[88:91]
v_mfma_f32_16x16x32_bf16 v[72:75], v[112:115], v[172:175], v[72:75]
s_waitcnt vmcnt(6) lgkmcnt(8)
v_mfma_f32_16x16x32_bf16 v[60:63], v[220:223], v[180:183], v[60:63]
buffer_load_dwordx4 v[212:215], v38, s[32:35], s57 offen offset:1024 sc1
v_mfma_f32_16x16x32_bf16 v[76:79], v[220:223], v[184:187], v[76:79]
ds_read_b64_tr_b16 v[100:101], v10 offset:20480
ds_read_b64_tr_b16 v[102:103], v10 offset:20992
v_mfma_f32_16x16x32_bf16 v[80:83], v[224:227], v[184:187], v[80:83]
ds_read_b64_tr_b16 v[104:105], v11 offset:20480
ds_read_b64_tr_b16 v[106:107], v11 offset:20992
v_mfma_f32_16x16x32_bf16 v[64:67], v[224:227], v[180:183], v[64:67]
buffer_load_dwordx4 v[216:219], v39, s[32:35], s57 offen offset:1024 sc1
v_mfma_f32_16x16x32_bf16 v[68:71], v[228:231], v[180:183], v[68:71]
ds_read_b64_tr_b16 v[108:109], v12 offset:20480
ds_read_b64_tr_b16 v[110:111], v12 offset:20992
v_mfma_f32_16x16x32_bf16 v[84:87], v[228:231], v[184:187], v[84:87]
ds_read_b64_tr_b16 v[112:113], v13 offset:20480
ds_read_b64_tr_b16 v[114:115], v13 offset:20992
v_mfma_f32_16x16x32_bf16 v[88:91], v[232:235], v[184:187], v[88:91]
s_add_u32 s57, s57, 2048
s_and_b32 s57, s57, 0x7fff
v_mfma_f32_16x16x32_bf16 v[72:75], v[232:235], v[180:183], v[72:75]
s_waitcnt vmcnt(6) lgkmcnt(8)
v_mfma_f32_16x16x32_bf16 v[60:63], v[236:239], v[188:191], v[60:63]
buffer_load_dwordx4 v[156:159], v38, s[32:35], s57 offen sc1
v_mfma_f32_16x16x32_bf16 v[76:79], v[236:239], v[192:195], v[76:79]
ds_read_b64_tr_b16 v[220:221], v10 offset:24576
ds_read_b64_tr_b16 v[222:223], v10 offset:25088
v_mfma_f32_16x16x32_bf16 v[80:83], v[240:243], v[192:195], v[80:83]
ds_read_b64_tr_b16 v[224:225], v11 offset:24576
ds_read_b64_tr_b16 v[226:227], v11 offset:25088
v_mfma_f32_16x16x32_bf16 v[64:67], v[240:243], v[188:191], v[64:67]
buffer_load_dwordx4 v[160:163], v39, s[32:35], s57 offen sc1
v_mfma_f32_16x16x32_bf16 v[68:71], v[244:247], v[188:191], v[68:71]
ds_read_b64_tr_b16 v[228:229], v12 offset:24576
ds_read_b64_tr_b16 v[230:231], v12 offset:25088
v_mfma_f32_16x16x32_bf16 v[84:87], v[244:247], v[192:195], v[84:87]
ds_read_b64_tr_b16 v[232:233], v13 offset:24576
ds_read_b64_tr_b16 v[234:235], v13 offset:25088
v_mfma_f32_16x16x32_bf16 v[88:91], v[248:251], v[192:195], v[88:91]
v_mfma_f32_16x16x32_bf16 v[72:75], v[248:251], v[188:191], v[72:75]
s_waitcnt vmcnt(6) lgkmcnt(8)
v_mfma_f32_16x16x32_bf16 v[60:63], v[100:103], v[196:199], v[60:63]
buffer_load_dwordx4 v[164:167], v38, s[32:35], s57 offen offset:1024 sc1
v_mfma_f32_16x16x32_bf16 v[76:79], v[100:103], v[200:203], v[76:79]
ds_read_b64_tr_b16 v[236:237], v10 offset:28672
ds_read_b64_tr_b16 v[238:239], v10 offset:29184
v_mfma_f32_16x16x32_bf16 v[80:83], v[104:107], v[200:203], v[80:83]
ds_read_b64_tr_b16 v[240:241], v11 offset:28672
ds_read_b64_tr_b16 v[242:243], v11 offset:29184
v_mfma_f32_16x16x32_bf16 v[64:67], v[104:107], v[196:199], v[64:67]
buffer_load_dwordx4 v[168:171], v39, s[32:35], s57 offen offset:1024 sc1
v_mfma_f32_16x16x32_bf16 v[68:71], v[108:111], v[196:199], v[68:71]
ds_read_b64_tr_b16 v[244:245], v12 offset:28672
ds_read_b64_tr_b16 v[246:247], v12 offset:29184
v_mfma_f32_16x16x32_bf16 v[84:87], v[108:111], v[200:203], v[84:87]
ds_read_b64_tr_b16 v[248:249], v13 offset:28672
ds_read_b64_tr_b16 v[250:251], v13 offset:29184
v_mfma_f32_16x16x32_bf16 v[88:91], v[112:115], v[200:203], v[88:91]
s_add_u32 s57, s57, 2048
s_and_b32 s57, s57, 0x7fff
v_mfma_f32_16x16x32_bf16 v[72:75], v[112:115], v[196:199], v[72:75]
s_waitcnt vmcnt(6) lgkmcnt(8)
v_mfma_f32_16x16x32_bf16 v[60:63], v[220:223], v[204:207], v[60:63]
buffer_load_dwordx4 v[172:175], v38, s[32:35], s57 offen sc1
v_mfma_f32_16x16x32_bf16 v[76:79], v[220:223], v[208:211], v[76:79]
ds_read_b64_tr_b16 v[100:101], v10 offset:32768
ds_read_b64_tr_b16 v[102:103], v10 offset:33280
v_mfma_f32_16x16x32_bf16 v[80:83], v[224:227], v[208:211], v[80:83]
ds_read_b64_tr_b16 v[104:105], v11 offset:32768
ds_read_b64_tr_b16 v[106:107], v11 offset:33280
v_mfma_f32_16x16x32_bf16 v[64:67], v[224:227], v[204:207], v[64:67]
buffer_load_dwordx4 v[176:179], v39, s[32:35], s57 offen sc1
v_mfma_f32_16x16x32_bf16 v[68:71], v[228:231], v[204:207], v[68:71]
ds_read_b64_tr_b16 v[108:109], v12 offset:32768
ds_read_b64_tr_b16 v[110:111], v12 offset:33280
v_mfma_f32_16x16x32_bf16 v[84:87], v[228:231], v[208:211], v[84:87]
ds_read_b64_tr_b16 v[112:113], v13 offset:32768
ds_read_b64_tr_b16 v[114:115], v13 offset:33280
v_mfma_f32_16x16x32_bf16 v[88:91], v[232:235], v[208:211], v[88:91]
v_mfma_f32_16x16x32_bf16 v[72:75], v[232:235], v[204:207], v[72:75]
s_waitcnt vmcnt(6) lgkmcnt(8)
v_mfma_f32_16x16x32_bf16 v[60:63], v[236:239], v[212:215], v[60:63]
buffer_load_dwordx4 v[180:183], v38, s[32:35], s57 offen offset:1024 sc1
v_mfma_f32_16x16x32_bf16 v[76:79], v[236:239], v[216:219], v[76:79]
ds_read_b64_tr_b16 v[220:221], v10 offset:36864
ds_read_b64_tr_b16 v[222:223], v10 offset:37376
v_mfma_f32_16x16x32_bf16 v[80:83], v[240:243], v[216:219], v[80:83]
ds_read_b64_tr_b16 v[224:225], v11 offset:36864
ds_read_b64_tr_b16 v[226:227], v11 offset:37376
v_mfma_f32_16x16x32_bf16 v[64:67], v[240:243], v[212:215], v[64:67]
buffer_load_dwordx4 v[184:187], v39, s[32:35], s57 offen offset:1024 sc1
v_mfma_f32_16x16x32_bf16 v[68:71], v[244:247], v[212:215], v[68:71]
ds_read_b64_tr_b16 v[228:229], v12 offset:36864
ds_read_b64_tr_b16 v[230:231], v12 offset:37376
v_mfma_f32_16x16x32_bf16 v[84:87], v[244:247], v[216:219], v[84:87]
ds_read_b64_tr_b16 v[232:233], v13 offset:36864
ds_read_b64_tr_b16 v[234:235], v13 offset:37376
v_mfma_f32_16x16x32_bf16 v[88:91], v[248:251], v[216:219], v[88:91]
s_add_u32 s57, s57, 2048
s_and_b32 s57, s57, 0x7fff
v_mfma_f32_16x16x32_bf16 v[72:75], v[248:251], v[212:215], v[72:75]
s_waitcnt vmcnt(6) lgkmcnt(8)
v_mfma_f32_16x16x32_bf16 v[60:63], v[100:103], v[156:159], v[60:63]
buffer_load_dwordx4 v[188:191], v38, s[32:35], s57 offen sc1
v_mfma_f32_16x16x32_bf16 v[76:79], v[100:103], v[160:163], v[76:79]
ds_read_b64_tr_b16 v[236:237], v10 offset:40960
ds_read_b64_tr_b16 v[238:239], v10 offset:41472
v_mfma_f32_16x16x32_bf16 v[80:83], v[104:107], v[160:163], v[80:83]
ds_read_b64_tr_b16 v[240:241], v11 offset:40960
ds_read_b64_tr_b16 v[242:243], v11 offset:41472
v_mfma_f32_16x16x32_bf16 v[64:67], v[104:107], v[156:159], v[64:67]
buffer_load_dwordx4 v[192:195], v39, s[32:35], s57 offen sc1
v_mfma_f32_16x16x32_bf16 v[68:71], v[108:111], v[156:159], v[68:71]
ds_read_b64_tr_b16 v[244:245], v12 offset:40960
ds_read_b64_tr_b16 v[246:247], v12 offset:41472
v_mfma_f32_16x16x32_bf16 v[84:87], v[108:111], v[160:163], v[84:87]
ds_read_b64_tr_b16 v[248:249], v13 offset:40960
ds_read_b64_tr_b16 v[250:251], v13 offset:41472
v_mfma_f32_16x16x32_bf16 v[88:91], v[112:115], v[160:163], v[88:91]
v_mfma_f32_16x16x32_bf16 v[72:75], v[112:115], v[156:159], v[72:75]
s_waitcnt vmcnt(6) lgkmcnt(8)
v_mfma_f32_16x16x32_bf16 v[60:63], v[220:223], v[164:167], v[60:63]
buffer_load_dwordx4 v[196:199], v38, s[32:35], s57 offen offset:1024 sc1
v_mfma_f32_16x16x32_bf16 v[76:79], v[220:223], v[168:171], v[76:79]
ds_read_b64_tr_b16 v[100:101], v10 offset:45056
ds_read_b64_tr_b16 v[102:103], v10 offset:45568
v_mfma_f32_16x16x32_bf16 v[80:83], v[224:227], v[168:171], v[80:83]
ds_read_b64_tr_b16 v[104:105], v11 offset:45056
ds_read_b64_tr_b16 v[106:107], v11 offset:45568
v_mfma_f32_16x16x32_bf16 v[64:67], v[224:227], v[164:167], v[64:67]
buffer_load_dwordx4 v[200:203], v39, s[32:35], s57 offen offset:1024 sc1
v_mfma_f32_16x16x32_bf16 v[68:71], v[228:231], v[164:167], v[68:71]
ds_read_b64_tr_b16 v[108:109], v12 offset:45056
ds_read_b64_tr_b16 v[110:111], v12 offset:45568
v_mfma_f32_16x16x32_bf16 v[84:87], v[228:231], v[168:171], v[84:87]
ds_read_b64_tr_b16 v[112:113], v13 offset:45056
ds_read_b64_tr_b16 v[114:115], v13 offset:45568
v_mfma_f32_16x16x32_bf16 v[88:91], v[232:235], v[168:171], v[88:91]
s_add_u32 s57, s57, 2048
s_and_b32 s57, s57, 0x7fff
v_mfma_f32_16x16x32_bf16 v[72:75], v[232:235], v[164:167], v[72:75]
s_waitcnt vmcnt(6) lgkmcnt(8)
v_mfma_f32_16x16x32_bf16 v[60:63], v[236:239], v[172:175], v[60:63]
buffer_load_dwordx4 v[204:207], v38, s[32:35], s57 offen sc1
v_mfma_f32_16x16x32_bf16 v[76:79], v[236:239], v[176:179], v[76:79]
ds_read_b64_tr_b16 v[220:221], v10 offset:49152
ds_read_b64_tr_b16 v[222:223], v10 offset:49664
v_mfma_f32_16x16x32_bf16 v[80:83], v[240:243], v[176:179], v[80:83]
ds_read_b64_tr_b16 v[224:225], v11 offset:49152
ds_read_b64_tr_b16 v[226:227], v11 offset:49664
v_mfma_f32_16x16x32_bf16 v[64:67], v[240:243], v[172:175], v[64:67]
buffer_load_dwordx4 v[208:211], v39, s[32:35], s57 offen sc1
v_mfma_f32_16x16x32_bf16 v[68:71], v[244:247], v[172:175], v[68:71]
ds_read_b64_tr_b16 v[228:229], v12 offset:49152
ds_read_b64_tr_b16 v[230:231], v12 offset:49664
v_mfma_f32_16x16x32_bf16 v[84:87], v[244:247], v[176:179], v[84:87]
ds_read_b64_tr_b16 v[232:233], v13 offset:49152
ds_read_b64_tr_b16 v[234:235], v13 offset:49664
v_mfma_f32_16x16x32_bf16 v[88:91], v[248:251], v[176:179], v[88:91]
v_mfma_f32_16x16x32_bf16 v[72:75], v[248:251], v[172:175], v[72:75]
s_waitcnt vmcnt(6) lgkmcnt(8)
v_mfma_f32_16x16x32_bf16 v[60:63], v[100:103], v[180:183], v[60:63]
buffer_load_dwordx4 v[212:215], v38, s[32:35], s57 offen offset:1024 sc1
v_mfma_f32_16x16x32_bf16 v[76:79], v[100:103], v[184:187], v[76:79]
ds_read_b64_tr_b16 v[236:237], v10 offset:53248
ds_read_b64_tr_b16 v[238:239], v10 offset:53760
v_mfma_f32_16x16x32_bf16 v[80:83], v[104:107], v[184:187], v[80:83]
ds_read_b64_tr_b16 v[240:241], v11 offset:53248
ds_read_b64_tr_b16 v[242:243], v11 offset:53760
v_mfma_f32_16x16x32_bf16 v[64:67], v[104:107], v[180:183], v[64:67]
buffer_load_dwordx4 v[216:219], v39, s[32:35], s57 offen offset:1024 sc1
v_mfma_f32_16x16x32_bf16 v[68:71], v[108:111], v[180:183], v[68:71]
ds_read_b64_tr_b16 v[244:245], v12 offset:53248
ds_read_b64_tr_b16 v[246:247], v12 offset:53760
v_mfma_f32_16x16x32_bf16 v[84:87], v[108:111], v[184:187], v[84:87]
ds_read_b64_tr_b16 v[248:249], v13 offset:53248
ds_read_b64_tr_b16 v[250:251], v13 offset:53760
v_mfma_f32_16x16x32_bf16 v[88:91], v[112:115], v[184:187], v[88:91]
s_add_u32 s57, s57, 2048
s_and_b32 s57, s57, 0x7fff
v_mfma_f32_16x16x32_bf16 v[72:75], v[112:115], v[180:183], v[72:75]
s_waitcnt vmcnt(6) lgkmcnt(8)
v_mfma_f32_16x16x32_bf16 v[60:63], v[220:223], v[188:191], v[60:63]
buffer_load_dwordx4 v[156:159], v38, s[32:35], s57 offen sc1
v_mfma_f32_16x16x32_bf16 v[76:79], v[220:223], v[192:195], v[76:79]
ds_read_b64_tr_b16 v[100:101], v10 offset:57344
ds_read_b64_tr_b16 v[102:103], v10 offset:57856
v_mfma_f32_16x16x32_bf16 v[80:83], v[224:227], v[192:195], v[80:83]
ds_read_b64_tr_b16 v[104:105], v11 offset:57344
ds_read_b64_tr_b16 v[106:107], v11 offset:57856
v_mfma_f32_16x16x32_bf16 v[64:67], v[224:227], v[188:191], v[64:67]
buffer_load_dwordx4 v[160:163], v39, s[32:35], s57 offen sc1
v_mfma_f32_16x16x32_bf16 v[68:71], v[228:231], v[188:191], v[68:71]
ds_read_b64_tr_b16 v[108:109], v12 offset:57344
ds_read_b64_tr_b16 v[110:111], v12 offset:57856
v_mfma_f32_16x16x32_bf16 v[84:87], v[228:231], v[192:195], v[84:87]
ds_read_b64_tr_b16 v[112:113], v13 offset:57344
ds_read_b64_tr_b16 v[114:115], v13 offset:57856
v_mfma_f32_16x16x32_bf16 v[88:91], v[232:235], v[192:195], v[88:91]
v_mfma_f32_16x16x32_bf16 v[72:75], v[232:235], v[188:191], v[72:75]
s_waitcnt vmcnt(6) lgkmcnt(8)
v_mfma_f32_16x16x32_bf16 v[60:63], v[236:239], v[196:199], v[60:63]
buffer_load_dwordx4 v[164:167], v38, s[32:35], s57 offen offset:1024 sc1
v_mfma_f32_16x16x32_bf16 v[76:79], v[236:239], v[200:203], v[76:79]
ds_read_b64_tr_b16 v[220:221], v10 offset:61440
ds_read_b64_tr_b16 v[222:223], v10 offset:61952
v_mfma_f32_16x16x32_bf16 v[80:83], v[240:243], v[200:203], v[80:83]
ds_read_b64_tr_b16 v[224:225], v11 offset:61440
ds_read_b64_tr_b16 v[226:227], v11 offset:61952
v_mfma_f32_16x16x32_bf16 v[64:67], v[240:243], v[196:199], v[64:67]
buffer_load_dwordx4 v[168:171], v39, s[32:35], s57 offen offset:1024 sc1
v_mfma_f32_16x16x32_bf16 v[68:71], v[244:247], v[196:199], v[68:71]
ds_read_b64_tr_b16 v[228:229], v12 offset:61440
ds_read_b64_tr_b16 v[230:231], v12 offset:61952
v_mfma_f32_16x16x32_bf16 v[84:87], v[244:247], v[200:203], v[84:87]
ds_read_b64_tr_b16 v[232:233], v13 offset:61440
ds_read_b64_tr_b16 v[234:235], v13 offset:61952
v_mfma_f32_16x16x32_bf16 v[88:91], v[248:251], v[200:203], v[88:91]
s_add_u32 s57, s57, 2048
s_and_b32 s57, s57, 0x7fff
v_mfma_f32_16x16x32_bf16 v[72:75], v[248:251], v[196:199], v[72:75]
s_waitcnt vmcnt(6) lgkmcnt(8)
v_mfma_f32_16x16x32_bf16 v[60:63], v[100:103], v[204:207], v[60:63]
buffer_load_dwordx4 v[172:175], v38, s[32:35], s57 offen sc1
v_mfma_f32_16x16x32_bf16 v[76:79], v[100:103], v[208:211], v[76:79]
ds_read_b64_tr_b16 v[236:237], v14 offset:0
ds_read_b64_tr_b16 v[238:239], v14 offset:512
v_mfma_f32_16x16x32_bf16 v[80:83], v[104:107], v[208:211], v[80:83]
ds_read_b64_tr_b16 v[240:241], v15 offset:0
ds_read_b64_tr_b16 v[242:243], v15 offset:512
v_mfma_f32_16x16x32_bf16 v[64:67], v[104:107], v[204:207], v[64:67]
buffer_load_dwordx4 v[176:179], v39, s[32:35], s57 offen sc1
v_mfma_f32_16x16x32_bf16 v[68:71], v[108:111], v[204:207], v[68:71]
ds_read_b64_tr_b16 v[244:245], v16 offset:0
ds_read_b64_tr_b16 v[246:247], v16 offset:512
v_mfma_f32_16x16x32_bf16 v[84:87], v[108:111], v[208:211], v[84:87]
ds_read_b64_tr_b16 v[248:249], v17 offset:0
ds_read_b64_tr_b16 v[250:251], v17 offset:512
v_mfma_f32_16x16x32_bf16 v[88:91], v[112:115], v[208:211], v[88:91]
v_mfma_f32_16x16x32_bf16 v[72:75], v[112:115], v[204:207], v[72:75]
s_waitcnt vmcnt(6) lgkmcnt(8)
v_mfma_f32_16x16x32_bf16 v[60:63], v[220:223], v[212:215], v[60:63]
buffer_load_dwordx4 v[180:183], v38, s[32:35], s57 offen offset:1024 sc1
v_mfma_f32_16x16x32_bf16 v[76:79], v[220:223], v[216:219], v[76:79]
ds_read_b64_tr_b16 v[100:101], v14 offset:4096
ds_read_b64_tr_b16 v[102:103], v14 offset:4608
v_mfma_f32_16x16x32_bf16 v[80:83], v[224:227], v[216:219], v[80:83]
ds_read_b64_tr_b16 v[104:105], v15 offset:4096
ds_read_b64_tr_b16 v[106:107], v15 offset:4608
v_mfma_f32_16x16x32_bf16 v[64:67], v[224:227], v[212:215], v[64:67]
buffer_load_dwordx4 v[184:187], v39, s[32:35], s57 offen offset:1024 sc1
v_mfma_f32_16x16x32_bf16 v[68:71], v[228:231], v[212:215], v[68:71]
ds_read_b64_tr_b16 v[108:109], v16 offset:4096
ds_read_b64_tr_b16 v[110:111], v16 offset:4608
v_mfma_f32_16x16x32_bf16 v[84:87], v[228:231], v[216:219], v[84:87]
ds_read_b64_tr_b16 v[112:113], v17 offset:4096
ds_read_b64_tr_b16 v[114:115], v17 offset:4608
v_mfma_f32_16x16x32_bf16 v[88:91], v[232:235], v[216:219], v[88:91]
s_add_u32 s57, s57, 2048
s_and_b32 s57, s57, 0x7fff
v_mfma_f32_16x16x32_bf16 v[72:75], v[232:235], v[212:215], v[72:75]
s_waitcnt vmcnt(6) lgkmcnt(8)
v_mfma_f32_16x16x32_bf16 v[60:63], v[236:239], v[156:159], v[60:63]
buffer_load_dwordx4 v[188:191], v38, s[32:35], s57 offen sc1
v_mfma_f32_16x16x32_bf16 v[76:79], v[236:239], v[160:163], v[76:79]
ds_read_b64_tr_b16 v[220:221], v14 offset:8192
ds_read_b64_tr_b16 v[222:223], v14 offset:8704
v_mfma_f32_16x16x32_bf16 v[80:83], v[240:243], v[160:163], v[80:83]
ds_read_b64_tr_b16 v[224:225], v15 offset:8192
ds_read_b64_tr_b16 v[226:227], v15 offset:8704
v_mfma_f32_16x16x32_bf16 v[64:67], v[240:243], v[156:159], v[64:67]
buffer_load_dwordx4 v[192:195], v39, s[32:35], s57 offen sc1
v_mfma_f32_16x16x32_bf16 v[68:71], v[244:247], v[156:159], v[68:71]
ds_read_b64_tr_b16 v[228:229], v16 offset:8192
ds_read_b64_tr_b16 v[230:231], v16 offset:8704
v_mfma_f32_16x16x32_bf16 v[84:87], v[244:247], v[160:163], v[84:87]
ds_read_b64_tr_b16 v[232:233], v17 offset:8192
ds_read_b64_tr_b16 v[234:235], v17 offset:8704
v_mfma_f32_16x16x32_bf16 v[88:91], v[248:251], v[160:163], v[88:91]
v_mfma_f32_16x16x32_bf16 v[72:75], v[248:251], v[156:159], v[72:75]
s_waitcnt vmcnt(6) lgkmcnt(8)
v_mfma_f32_16x16x32_bf16 v[60:63], v[100:103], v[164:167], v[60:63]
buffer_load_dwordx4 v[196:199], v38, s[32:35], s57 offen offset:1024 sc1
v_mfma_f32_16x16x32_bf16 v[76:79], v[100:103], v[168:171], v[76:79]
ds_read_b64_tr_b16 v[236:237], v14 offset:12288
ds_read_b64_tr_b16 v[238:239], v14 offset:12800
v_mfma_f32_16x16x32_bf16 v[80:83], v[104:107], v[168:171], v[80:83]
ds_read_b64_tr_b16 v[240:241], v15 offset:12288
ds_read_b64_tr_b16 v[242:243], v15 offset:12800
v_mfma_f32_16x16x32_bf16 v[64:67], v[104:107], v[164:167], v[64:67]
buffer_load_dwordx4 v[200:203], v39, s[32:35], s57 offen offset:1024 sc1
v_mfma_f32_16x16x32_bf16 v[68:71], v[108:111], v[164:167], v[68:71]
ds_read_b64_tr_b16 v[244:245], v16 offset:12288
ds_read_b64_tr_b16 v[246:247], v16 offset:12800
v_mfma_f32_16x16x32_bf16 v[84:87], v[108:111], v[168:171], v[84:87]
ds_read_b64_tr_b16 v[248:249], v17 offset:12288
ds_read_b64_tr_b16 v[250:251], v17 offset:12800
v_mfma_f32_16x16x32_bf16 v[88:91], v[112:115], v[168:171], v[88:91]
s_add_u32 s57, s57, 2048
s_and_b32 s57, s57, 0x7fff
v_mfma_f32_16x16x32_bf16 v[72:75], v[112:115], v[164:167], v[72:75]
s_waitcnt vmcnt(6) lgkmcnt(8)
v_mfma_f32_16x16x32_bf16 v[60:63], v[220:223], v[172:175], v[60:63]
buffer_load_dwordx4 v[204:207], v38, s[32:35], s57 offen sc1
v_mfma_f32_16x16x32_bf16 v[76:79], v[220:223], v[176:179], v[76:79]
ds_read_b64_tr_b16 v[100:101], v14 offset:16384
ds_read_b64_tr_b16 v[102:103], v14 offset:16896
v_mfma_f32_16x16x32_bf16 v[80:83], v[224:227], v[176:179], v[80:83]
ds_read_b64_tr_b16 v[104:105], v15 offset:16384
ds_read_b64_tr_b16 v[106:107], v15 offset:16896
v_mfma_f32_16x16x32_bf16 v[64:67], v[224:227], v[172:175], v[64:67]
buffer_load_dwordx4 v[208:211], v39, s[32:35], s57 offen sc1
v_mfma_f32_16x16x32_bf16 v[68:71], v[228:231], v[172:175], v[68:71]
ds_read_b64_tr_b16 v[108:109], v16 offset:16384
ds_read_b64_tr_b16 v[110:111], v16 offset:16896
v_mfma_f32_16x16x32_bf16 v[84:87], v[228:231], v[176:179], v[84:87]
ds_read_b64_tr_b16 v[112:113], v17 offset:16384
ds_read_b64_tr_b16 v[114:115], v17 offset:16896
v_mfma_f32_16x16x32_bf16 v[88:91], v[232:235], v[176:179], v[88:91]
v_mfma_f32_16x16x32_bf16 v[72:75], v[232:235], v[172:175], v[72:75]
s_waitcnt vmcnt(6) lgkmcnt(8)
v_mfma_f32_16x16x32_bf16 v[60:63], v[236:239], v[180:183], v[60:63]
buffer_load_dwordx4 v[212:215], v38, s[32:35], s57 offen offset:1024 sc1
v_mfma_f32_16x16x32_bf16 v[76:79], v[236:239], v[184:187], v[76:79]
ds_read_b64_tr_b16 v[220:221], v14 offset:20480
ds_read_b64_tr_b16 v[222:223], v14 offset:20992
v_mfma_f32_16x16x32_bf16 v[80:83], v[240:243], v[184:187], v[80:83]
ds_read_b64_tr_b16 v[224:225], v15 offset:20480
ds_read_b64_tr_b16 v[226:227], v15 offset:20992
v_mfma_f32_16x16x32_bf16 v[64:67], v[240:243], v[180:183], v[64:67]
buffer_load_dwordx4 v[216:219], v39, s[32:35], s57 offen offset:1024 sc1
v_mfma_f32_16x16x32_bf16 v[68:71], v[244:247], v[180:183], v[68:71]
ds_read_b64_tr_b16 v[228:229], v16 offset:20480
ds_read_b64_tr_b16 v[230:231], v16 offset:20992
v_mfma_f32_16x16x32_bf16 v[84:87], v[244:247], v[184:187], v[84:87]
ds_read_b64_tr_b16 v[232:233], v17 offset:20480
ds_read_b64_tr_b16 v[234:235], v17 offset:20992
v_mfma_f32_16x16x32_bf16 v[88:91], v[248:251], v[184:187], v[88:91]
s_add_u32 s57, s57, 2048
s_and_b32 s57, s57, 0x7fff
v_mfma_f32_16x16x32_bf16 v[72:75], v[248:251], v[180:183], v[72:75]
s_waitcnt vmcnt(6) lgkmcnt(8)
v_mfma_f32_16x16x32_bf16 v[60:63], v[100:103], v[188:191], v[60:63]
buffer_load_dwordx4 v[156:159], v38, s[32:35], s57 offen sc1
v_mfma_f32_16x16x32_bf16 v[76:79], v[100:103], v[192:195], v[76:79]
ds_read_b64_tr_b16 v[236:237], v14 offset:24576
ds_read_b64_tr_b16 v[238:239], v14 offset:25088
v_mfma_f32_16x16x32_bf16 v[80:83], v[104:107], v[192:195], v[80:83]
ds_read_b64_tr_b16 v[240:241], v15 offset:24576
ds_read_b64_tr_b16 v[242:243], v15 offset:25088
v_mfma_f32_16x16x32_bf16 v[64:67], v[104:107], v[188:191], v[64:67]
buffer_load_dwordx4 v[160:163], v39, s[32:35], s57 offen sc1
v_mfma_f32_16x16x32_bf16 v[68:71], v[108:111], v[188:191], v[68:71]
ds_read_b64_tr_b16 v[244:245], v16 offset:24576
ds_read_b64_tr_b16 v[246:247], v16 offset:25088
v_mfma_f32_16x16x32_bf16 v[84:87], v[108:111], v[192:195], v[84:87]
ds_read_b64_tr_b16 v[248:249], v17 offset:24576
ds_read_b64_tr_b16 v[250:251], v17 offset:25088
v_mfma_f32_16x16x32_bf16 v[88:91], v[112:115], v[192:195], v[88:91]
v_mfma_f32_16x16x32_bf16 v[72:75], v[112:115], v[188:191], v[72:75]
s_waitcnt vmcnt(6) lgkmcnt(8)
v_mfma_f32_16x16x32_bf16 v[60:63], v[220:223], v[196:199], v[60:63]
buffer_load_dwordx4 v[164:167], v38, s[32:35], s57 offen offset:1024 sc1
v_mfma_f32_16x16x32_bf16 v[76:79], v[220:223], v[200:203], v[76:79]
ds_read_b64_tr_b16 v[100:101], v14 offset:28672
ds_read_b64_tr_b16 v[102:103], v14 offset:29184
v_mfma_f32_16x16x32_bf16 v[80:83], v[224:227], v[200:203], v[80:83]
ds_read_b64_tr_b16 v[104:105], v15 offset:28672
ds_read_b64_tr_b16 v[106:107], v15 offset:29184
v_mfma_f32_16x16x32_bf16 v[64:67], v[224:227], v[196:199], v[64:67]
buffer_load_dwordx4 v[168:171], v39, s[32:35], s57 offen offset:1024 sc1
v_mfma_f32_16x16x32_bf16 v[68:71], v[228:231], v[196:199], v[68:71]
ds_read_b64_tr_b16 v[108:109], v16 offset:28672
ds_read_b64_tr_b16 v[110:111], v16 offset:29184
v_mfma_f32_16x16x32_bf16 v[84:87], v[228:231], v[200:203], v[84:87]
ds_read_b64_tr_b16 v[112:113], v17 offset:28672
ds_read_b64_tr_b16 v[114:115], v17 offset:29184
v_mfma_f32_16x16x32_bf16 v[88:91], v[232:235], v[200:203], v[88:91]
s_add_u32 s57, s57, 2048
s_and_b32 s57, s57, 0x7fff
v_mfma_f32_16x16x32_bf16 v[72:75], v[232:235], v[196:199], v[72:75]
s_waitcnt vmcnt(6) lgkmcnt(8)
v_mfma_f32_16x16x32_bf16 v[60:63], v[236:239], v[204:207], v[60:63]
buffer_load_dwordx4 v[172:175], v38, s[32:35], s57 offen sc1
v_mfma_f32_16x16x32_bf16 v[76:79], v[236:239], v[208:211], v[76:79]
ds_read_b64_tr_b16 v[220:221], v14 offset:32768
ds_read_b64_tr_b16 v[222:223], v14 offset:33280
v_mfma_f32_16x16x32_bf16 v[80:83], v[240:243], v[208:211], v[80:83]
ds_read_b64_tr_b16 v[224:225], v15 offset:32768
ds_read_b64_tr_b16 v[226:227], v15 offset:33280
v_mfma_f32_16x16x32_bf16 v[64:67], v[240:243], v[204:207], v[64:67]
buffer_load_dwordx4 v[176:179], v39, s[32:35], s57 offen sc1
v_mfma_f32_16x16x32_bf16 v[68:71], v[244:247], v[204:207], v[68:71]
ds_read_b64_tr_b16 v[228:229], v16 offset:32768
ds_read_b64_tr_b16 v[230:231], v16 offset:33280
v_mfma_f32_16x16x32_bf16 v[84:87], v[244:247], v[208:211], v[84:87]
ds_read_b64_tr_b16 v[232:233], v17 offset:32768
ds_read_b64_tr_b16 v[234:235], v17 offset:33280
v_mfma_f32_16x16x32_bf16 v[88:91], v[248:251], v[208:211], v[88:91]
v_mfma_f32_16x16x32_bf16 v[72:75], v[248:251], v[204:207], v[72:75]
s_waitcnt vmcnt(6) lgkmcnt(8)
v_mfma_f32_16x16x32_bf16 v[60:63], v[100:103], v[212:215], v[60:63]
buffer_load_dwordx4 v[180:183], v38, s[32:35], s57 offen offset:1024 sc1
v_mfma_f32_16x16x32_bf16 v[76:79], v[100:103], v[216:219], v[76:79]
ds_read_b64_tr_b16 v[236:237], v14 offset:36864
ds_read_b64_tr_b16 v[238:239], v14 offset:37376
v_mfma_f32_16x16x32_bf16 v[80:83], v[104:107], v[216:219], v[80:83]
ds_read_b64_tr_b16 v[240:241], v15 offset:36864
ds_read_b64_tr_b16 v[242:243], v15 offset:37376
v_mfma_f32_16x16x32_bf16 v[64:67], v[104:107], v[212:215], v[64:67]
buffer_load_dwordx4 v[184:187], v39, s[32:35], s57 offen offset:1024 sc1
v_mfma_f32_16x16x32_bf16 v[68:71], v[108:111], v[212:215], v[68:71]
ds_read_b64_tr_b16 v[244:245], v16 offset:36864
ds_read_b64_tr_b16 v[246:247], v16 offset:37376
v_mfma_f32_16x16x32_bf16 v[84:87], v[108:111], v[216:219], v[84:87]
ds_read_b64_tr_b16 v[248:249], v17 offset:36864
ds_read_b64_tr_b16 v[250:251], v17 offset:37376
v_mfma_f32_16x16x32_bf16 v[88:91], v[112:115], v[216:219], v[88:91]
s_add_u32 s57, s57, 2048
s_and_b32 s57, s57, 0x7fff
v_mfma_f32_16x16x32_bf16 v[72:75], v[112:115], v[212:215], v[72:75]
s_waitcnt vmcnt(6) lgkmcnt(8)
v_mfma_f32_16x16x32_bf16 v[60:63], v[220:223], v[156:159], v[60:63]
buffer_load_dwordx4 v[188:191], v38, s[32:35], s57 offen sc1
v_mfma_f32_16x16x32_bf16 v[76:79], v[220:223], v[160:163], v[76:79]
ds_read_b64_tr_b16 v[100:101], v14 offset:40960
ds_read_b64_tr_b16 v[102:103], v14 offset:41472
v_mfma_f32_16x16x32_bf16 v[80:83], v[224:227], v[160:163], v[80:83]
ds_read_b64_tr_b16 v[104:105], v15 offset:40960
ds_read_b64_tr_b16 v[106:107], v15 offset:41472
v_mfma_f32_16x16x32_bf16 v[64:67], v[224:227], v[156:159], v[64:67]
buffer_load_dwordx4 v[192:195], v39, s[32:35], s57 offen sc1
v_mfma_f32_16x16x32_bf16 v[68:71], v[228:231], v[156:159], v[68:71]
ds_read_b64_tr_b16 v[108:109], v16 offset:40960
ds_read_b64_tr_b16 v[110:111], v16 offset:41472
v_mfma_f32_16x16x32_bf16 v[84:87], v[228:231], v[160:163], v[84:87]
ds_read_b64_tr_b16 v[112:113], v17 offset:40960
ds_read_b64_tr_b16 v[114:115], v17 offset:41472
v_mfma_f32_16x16x32_bf16 v[88:91], v[232:235], v[160:163], v[88:91]
v_mfma_f32_16x16x32_bf16 v[72:75], v[232:235], v[156:159], v[72:75]
s_waitcnt vmcnt(6) lgkmcnt(8)
v_mfma_f32_16x16x32_bf16 v[60:63], v[236:239], v[164:167], v[60:63]
buffer_load_dwordx4 v[196:199], v38, s[32:35], s57 offen offset:1024 sc1
v_mfma_f32_16x16x32_bf16 v[76:79], v[236:239], v[168:171], v[76:79]
ds_read_b64_tr_b16 v[220:221], v14 offset:45056
ds_read_b64_tr_b16 v[222:223], v14 offset:45568
v_mfma_f32_16x16x32_bf16 v[80:83], v[240:243], v[168:171], v[80:83]
ds_read_b64_tr_b16 v[224:225], v15 offset:45056
ds_read_b64_tr_b16 v[226:227], v15 offset:45568
v_mfma_f32_16x16x32_bf16 v[64:67], v[240:243], v[164:167], v[64:67]
buffer_load_dwordx4 v[200:203], v39, s[32:35], s57 offen offset:1024 sc1
v_mfma_f32_16x16x32_bf16 v[68:71], v[244:247], v[164:167], v[68:71]
ds_read_b64_tr_b16 v[228:229], v16 offset:45056
ds_read_b64_tr_b16 v[230:231], v16 offset:45568
v_mfma_f32_16x16x32_bf16 v[84:87], v[244:247], v[168:171], v[84:87]
ds_read_b64_tr_b16 v[232:233], v17 offset:45056
ds_read_b64_tr_b16 v[234:235], v17 offset:45568
v_mfma_f32_16x16x32_bf16 v[88:91], v[248:251], v[168:171], v[88:91]
s_add_u32 s57, s57, 2048
s_and_b32 s57, s57, 0x7fff
v_mfma_f32_16x16x32_bf16 v[72:75], v[248:251], v[164:167], v[72:75]
s_waitcnt vmcnt(6) lgkmcnt(8)
v_mfma_f32_16x16x32_bf16 v[60:63], v[100:103], v[172:175], v[60:63]
buffer_load_dwordx4 v[204:207], v38, s[32:35], s57 offen sc1
v_mfma_f32_16x16x32_bf16 v[76:79], v[100:103], v[176:179], v[76:79]
ds_read_b64_tr_b16 v[236:237], v14 offset:49152
ds_read_b64_tr_b16 v[238:239], v14 offset:49664
v_mfma_f32_16x16x32_bf16 v[80:83], v[104:107], v[176:179], v[80:83]
ds_read_b64_tr_b16 v[240:241], v15 offset:49152
ds_read_b64_tr_b16 v[242:243], v15 offset:49664
v_mfma_f32_16x16x32_bf16 v[64:67], v[104:107], v[172:175], v[64:67]
buffer_load_dwordx4 v[208:211], v39, s[32:35], s57 offen sc1
v_mfma_f32_16x16x32_bf16 v[68:71], v[108:111], v[172:175], v[68:71]
ds_read_b64_tr_b16 v[244:245], v16 offset:49152
ds_read_b64_tr_b16 v[246:247], v16 offset:49664
v_mfma_f32_16x16x32_bf16 v[84:87], v[108:111], v[176:179], v[84:87]
ds_read_b64_tr_b16 v[248:249], v17 offset:49152
ds_read_b64_tr_b16 v[250:251], v17 offset:49664
v_mfma_f32_16x16x32_bf16 v[88:91], v[112:115], v[176:179], v[88:91]
v_mfma_f32_16x16x32_bf16 v[72:75], v[112:115], v[172:175], v[72:75]
s_waitcnt vmcnt(6) lgkmcnt(8)
v_mfma_f32_16x16x32_bf16 v[60:63], v[220:223], v[180:183], v[60:63]
buffer_load_dwordx4 v[212:215], v38, s[32:35], s57 offen offset:1024 sc1
v_mfma_f32_16x16x32_bf16 v[76:79], v[220:223], v[184:187], v[76:79]
ds_read_b64_tr_b16 v[100:101], v14 offset:53248
ds_read_b64_tr_b16 v[102:103], v14 offset:53760
v_mfma_f32_16x16x32_bf16 v[80:83], v[224:227], v[184:187], v[80:83]
ds_read_b64_tr_b16 v[104:105], v15 offset:53248
ds_read_b64_tr_b16 v[106:107], v15 offset:53760
v_mfma_f32_16x16x32_bf16 v[64:67], v[224:227], v[180:183], v[64:67]
buffer_load_dwordx4 v[216:219], v39, s[32:35], s57 offen offset:1024 sc1
v_mfma_f32_16x16x32_bf16 v[68:71], v[228:231], v[180:183], v[68:71]
ds_read_b64_tr_b16 v[108:109], v16 offset:53248
ds_read_b64_tr_b16 v[110:111], v16 offset:53760
v_mfma_f32_16x16x32_bf16 v[84:87], v[228:231], v[184:187], v[84:87]
ds_read_b64_tr_b16 v[112:113], v17 offset:53248
ds_read_b64_tr_b16 v[114:115], v17 offset:53760
v_mfma_f32_16x16x32_bf16 v[88:91], v[232:235], v[184:187], v[88:91]
v_mfma_f32_16x16x32_bf16 v[72:75], v[232:235], v[180:183], v[72:75]
s_waitcnt vmcnt(6) lgkmcnt(8)
v_mfma_f32_16x16x32_bf16 v[60:63], v[236:239], v[188:191], v[60:63]
v_mfma_f32_16x16x32_bf16 v[76:79], v[236:239], v[192:195], v[76:79]
ds_read_b64_tr_b16 v[220:221], v14 offset:57344
ds_read_b64_tr_b16 v[222:223], v14 offset:57856
v_mfma_f32_16x16x32_bf16 v[80:83], v[240:243], v[192:195], v[80:83]
ds_read_b64_tr_b16 v[224:225], v15 offset:57344
ds_read_b64_tr_b16 v[226:227], v15 offset:57856
v_mfma_f32_16x16x32_bf16 v[64:67], v[240:243], v[188:191], v[64:67]
v_mfma_f32_16x16x32_bf16 v[68:71], v[244:247], v[188:191], v[68:71]
ds_read_b64_tr_b16 v[228:229], v16 offset:57344
ds_read_b64_tr_b16 v[230:231], v16 offset:57856
v_mfma_f32_16x16x32_bf16 v[84:87], v[244:247], v[192:195], v[84:87]
ds_read_b64_tr_b16 v[232:233], v17 offset:57344
ds_read_b64_tr_b16 v[234:235], v17 offset:57856
v_mfma_f32_16x16x32_bf16 v[88:91], v[248:251], v[192:195], v[88:91]
v_mfma_f32_16x16x32_bf16 v[72:75], v[248:251], v[188:191], v[72:75]
s_waitcnt vmcnt(4) lgkmcnt(8)
v_mfma_f32_16x16x32_bf16 v[60:63], v[100:103], v[196:199], v[60:63]
v_mfma_f32_16x16x32_bf16 v[76:79], v[100:103], v[200:203], v[76:79]
ds_read_b64_tr_b16 v[236:237], v14 offset:61440
ds_read_b64_tr_b16 v[238:239], v14 offset:61952
v_mfma_f32_16x16x32_bf16 v[80:83], v[104:107], v[200:203], v[80:83]
ds_read_b64_tr_b16 v[240:241], v15 offset:61440
ds_read_b64_tr_b16 v[242:243], v15 offset:61952
v_mfma_f32_16x16x32_bf16 v[64:67], v[104:107], v[196:199], v[64:67]
v_mfma_f32_16x16x32_bf16 v[68:71], v[108:111], v[196:199], v[68:71]
ds_read_b64_tr_b16 v[244:245], v16 offset:61440
ds_read_b64_tr_b16 v[246:247], v16 offset:61952
v_mfma_f32_16x16x32_bf16 v[84:87], v[108:111], v[200:203], v[84:87]
ds_read_b64_tr_b16 v[248:249], v17 offset:61440
ds_read_b64_tr_b16 v[250:251], v17 offset:61952
v_mfma_f32_16x16x32_bf16 v[88:91], v[112:115], v[200:203], v[88:91]
v_mfma_f32_16x16x32_bf16 v[72:75], v[112:115], v[196:199], v[72:75]
s_waitcnt vmcnt(2) lgkmcnt(8)
v_mfma_f32_16x16x32_bf16 v[60:63], v[220:223], v[204:207], v[60:63]
v_mfma_f32_16x16x32_bf16 v[76:79], v[220:223], v[208:211], v[76:79]
v_mfma_f32_16x16x32_bf16 v[80:83], v[224:227], v[208:211], v[80:83]
v_mfma_f32_16x16x32_bf16 v[64:67], v[224:227], v[204:207], v[64:67]
v_mfma_f32_16x16x32_bf16 v[68:71], v[228:231], v[204:207], v[68:71]
v_mfma_f32_16x16x32_bf16 v[84:87], v[228:231], v[208:211], v[84:87]
v_mfma_f32_16x16x32_bf16 v[88:91], v[232:235], v[208:211], v[88:91]
v_mfma_f32_16x16x32_bf16 v[72:75], v[232:235], v[204:207], v[72:75]
s_waitcnt vmcnt(0) lgkmcnt(0)
v_mfma_f32_16x16x32_bf16 v[60:63], v[236:239], v[212:215], v[60:63]
v_mfma_f32_16x16x32_bf16 v[64:67], v[240:243], v[212:215], v[64:67]
v_mfma_f32_16x16x32_bf16 v[68:71], v[244:247], v[212:215], v[68:71]
v_mfma_f32_16x16x32_bf16 v[72:75], v[248:251], v[212:215], v[72:75]
v_mfma_f32_16x16x32_bf16 v[76:79], v[236:239], v[216:219], v[76:79]
v_mfma_f32_16x16x32_bf16 v[80:83], v[240:243], v[216:219], v[80:83]
v_mfma_f32_16x16x32_bf16 v[84:87], v[244:247], v[216:219], v[84:87]
v_mfma_f32_16x16x32_bf16 v[88:91], v[248:251], v[216:219], v[88:91]
s_nop 0
v_cvt_pk_bf16_f32 v20, v60, v61
v_cvt_pk_bf16_f32 v21, v62, v63
v_cvt_pk_bf16_f32 v22, v64, v65
v_cvt_pk_bf16_f32 v23, v66, v67
ds_write_b64 v42, v[20:21] offset:0
ds_write_b64 v43, v[22:23] offset:0
v_cvt_pk_bf16_f32 v24, v68, v69
v_cvt_pk_bf16_f32 v25, v70, v71
v_cvt_pk_bf16_f32 v26, v72, v73
v_cvt_pk_bf16_f32 v27, v74, v75
ds_write_b64 v44, v[24:25] offset:0
ds_write_b64 v45, v[26:27] offset:0
v_cvt_pk_bf16_f32 v28, v76, v77
v_cvt_pk_bf16_f32 v29, v78, v79
v_cvt_pk_bf16_f32 v30, v80, v81
v_cvt_pk_bf16_f32 v31, v82, v83
ds_write_b64 v42, v[28:29] offset:2048
ds_write_b64 v43, v[30:31] offset:2048
v_cvt_pk_bf16_f32 v32, v84, v85
v_cvt_pk_bf16_f32 v33, v86, v87
v_cvt_pk_bf16_f32 v34, v88, v89
v_cvt_pk_bf16_f32 v35, v90, v91
ds_write_b64 v44, v[32:33] offset:2048
ds_write_b64 v45, v[34:35] offset:2048
ds_read_b128 v[20:23], v46 offset:0
ds_read_b128 v[24:27], v46 offset:1024
ds_read_b128 v[28:31], v46 offset:2048
ds_read_b128 v[32:35], v46 offset:3072
s_waitcnt lgkmcnt(3)
buffer_store_dwordx4 v[20:23], v40, s[24:27], s48 offen sc1
s_waitcnt lgkmcnt(2)
buffer_store_dwordx4 v[24:27], v41, s[24:27], s48 offen sc1
s_waitcnt lgkmcnt(1)
buffer_store_dwordx4 v[28:31], v40, s[24:27], s49 offen sc1
s_waitcnt lgkmcnt(0)
buffer_store_dwordx4 v[32:35], v41, s[24:27], s49 offen sc1
s_endpgm
L_code_end:
again_22:
s_mov_b32 s63, 0
retry_24:
buffer_load_dwordx4 v[80:83], v37, s[32:35], 0 offen offset:0 sc1
buffer_load_dwordx4 v[84:87], v37, s[32:35], 0 offen offset:1024 sc1
buffer_load_dwordx4 v[88:91], v37, s[32:35], 0 offen offset:2048 sc1
buffer_load_dwordx4 v[92:95], v37, s[32:35], 0 offen offset:3072 sc1
s_waitcnt vmcnt(0)
v_add_f32 v80, v80, v88
v_add_f32 v81, v81, v89
v_add_f32 v82, v82, v90
v_add_f32 v83, v83, v91
v_add_f32 v84, v84, v92
v_add_f32 v85, v85, v93
v_add_f32 v86, v86, v94
v_add_f32 v87, v87, v95
v_add_f32 v80, v80, v84
v_add_f32 v81, v81, v85
v_add_f32 v82, v82, v86
v_add_f32 v83, v83, v87
s_nop 1
v_permlane32_swap_b32 v80, v81
v_permlane32_swap_b32 v82, v83
v_add_f32 v80, v80, v81
v_add_f32 v82, v82, v83
s_nop 1
v_permlane16_swap_b32 v80, v82
s_nop 0
v_add_f32 v80, v80, v82
v_cmp_u_f32 vcc, v80, v80
s_cbranch_vccz summed_23
s_add_u32 s63, s63, 1
s_cmp_lt_u32 s63, 0x10000
s_cbranch_scc1 retry_24
s_branch summed_23
again_25:
s_mov_b32 s63, 0
retry_27:
buffer_load_dwordx4 v[64:67], v38, s[32:35], 0 offen offset:0 sc1
buffer_load_dwordx4 v[68:71], v38, s[32:35], 0 offen offset:1024 sc1
buffer_load_dwordx4 v[72:75], v38, s[32:35], 0 offen offset:2048 sc1
buffer_load_dwordx4 v[76:79], v38, s[32:35], 0 offen offset:3072 sc1
s_waitcnt vmcnt(0)
v_add_f32 v64, v64, v72
v_add_f32 v65, v65, v73
v_add_f32 v66, v66, v74
v_add_f32 v67, v67, v75
v_add_f32 v68, v68, v76
v_add_f32 v69, v69, v77
v_add_f32 v70, v70, v78
v_add_f32 v71, v71, v79
v_add_f32 v64, v64, v68
v_add_f32 v65, v65, v69
v_add_f32 v66, v66, v70
v_add_f32 v67, v67, v71
s_nop 1
v_permlane32_swap_b32 v64, v65
v_permlane32_swap_b32 v66, v67
v_add_f32 v64, v64, v65
v_add_f32 v66, v66, v67
s_nop 1
v_permlane16_swap_b32 v64, v66
s_nop 0
v_add_f32 v64, v64, v66
v_cmp_u_f32 vcc, v64, v64
s_cbranch_vccz summed_26
s_add_u32 s63, s63, 1
s_cmp_lt_u32 s63, 0x10000
s_cbranch_scc1 retry_27
s_branch summed_26
again_33:
s_mov_b32 s63, 0
retry_35:
buffer_load_dwordx4 v[80:83], v37, s[32:35], 0 offen offset:0 sc1
buffer_load_dwordx4 v[84:87], v37, s[32:35], 0 offen offset:1024 sc1
buffer_load_dwordx4 v[88:91], v37, s[32:35], 0 offen offset:2048 sc1
buffer_load_dwordx4 v[92:95], v37, s[32:35], 0 offen offset:3072 sc1
s_waitcnt vmcnt(0)
v_add_f32 v80, v80, v88
v_add_f32 v81, v81, v89
v_add_f32 v82, v82, v90
v_add_f32 v83, v83, v91
v_add_f32 v84, v84, v92
v_add_f32 v85, v85, v93
v_add_f32 v86, v86, v94
v_add_f32 v87, v87, v95
v_add_f32 v80, v80, v84
v_add_f32 v81, v81, v85
v_add_f32 v82, v82, v86
v_add_f32 v83, v83, v87
s_nop 1
v_permlane32_swap_b32 v80, v81
v_permlane32_swap_b32 v82, v83
v_add_f32 v80, v80, v81
v_add_f32 v82, v82, v83
s_nop 1
v_permlane16_swap_b32 v80, v82
s_nop 0
v_add_f32 v80, v80, v82
v_cmp_u_f32 vcc, v80, v80
s_cbranch_vccz summed_34
s_add_u32 s63, s63, 1
s_cmp_lt_u32 s63, 0x10000
s_cbranch_scc1 retry_35
s_branch summed_34
again_36:
s_mov_b32 s63, 0
retry_38:
buffer_load_dwordx4 v[64:67], v38, s[32:35], 0 offen offset:0 sc1
buffer_load_dwordx4 v[68:71], v38, s[32:35], 0 offen offset:1024 sc1
buffer_load_dwordx4 v[72:75], v38, s[32:35], 0 offen offset:2048 sc1
buffer_load_dwordx4 v[76:79], v38, s[32:35], 0 offen offset:3072 sc1
s_waitcnt vmcnt(0)
v_add_f32 v64, v64, v72
v_add_f32 v65, v65, v73
v_add_f32 v66, v66, v74
v_add_f32 v67, v67, v75
v_add_f32 v68, v68, v76
v_add_f32 v69, v69, v77
v_add_f32 v70, v70, v78
v_add_f32 v71, v71, v79
v_add_f32 v64, v64, v68
v_add_f32 v65, v65, v69
v_add_f32 v66, v66, v70
v_add_f32 v67, v67, v71
s_nop 1
v_permlane32_swap_b32 v64, v65
v_permlane32_swap_b32 v66, v67
v_add_f32 v64, v64, v65
v_add_f32 v66, v66, v67
s_nop 1
v_permlane16_swap_b32 v64, v66
s_nop 0
v_add_f32 v64, v64, v66
v_cmp_u_f32 vcc, v64, v64
s_cbranch_vccz summed_37
s_add_u32 s63, s63, 1
s_cmp_lt_u32 s63, 0x10000
s_cbranch_scc1 retry_38
s_branch summed_37
again_42:
s_mov_b32 s63, 0
retry_44:
buffer_load_dwordx4 v[80:83], v37, s[32:35], 0 offen offset:0 sc1
buffer_load_dwordx4 v[84:87], v37, s[32:35], 0 offen offset:1024 sc1
buffer_load_dwordx4 v[88:91], v37, s[32:35], 0 offen offset:2048 sc1
buffer_load_dwordx4 v[92:95], v37, s[32:35], 0 offen offset:3072 sc1
s_waitcnt vmcnt(0)
v_add_f32 v80, v80, v88
v_add_f32 v81, v81, v89
v_add_f32 v82, v82, v90
v_add_f32 v83, v83, v91
v_add_f32 v84, v84, v92
v_add_f32 v85, v85, v93
v_add_f32 v86, v86, v94
v_add_f32 v87, v87, v95
v_add_f32 v80, v80, v84
v_add_f32 v81, v81, v85
v_add_f32 v82, v82, v86
v_add_f32 v83, v83, v87
s_nop 1
v_permlane32_swap_b32 v80, v81
v_permlane32_swap_b32 v82, v83
v_add_f32 v80, v80, v81
v_add_f32 v82, v82, v83
s_nop 1
v_permlane16_swap_b32 v80, v82
s_nop 0
v_add_f32 v80, v80, v82
v_cmp_u_f32 vcc, v80, v80
s_cbranch_vccz summed_43
s_add_u32 s63, s63, 1
s_cmp_lt_u32 s63, 0x10000
s_cbranch_scc1 retry_44
s_branch summed_43
again_52:
s_mov_b32 s63, 0
retry_54:
buffer_load_dwordx4 v[80:83], v37, s[32:35], 0 offen offset:0 sc1
buffer_load_dwordx4 v[84:87], v37, s[32:35], 0 offen offset:1024 sc1
buffer_load_dwordx4 v[88:91], v37, s[32:35], 0 offen offset:2048 sc1
buffer_load_dwordx4 v[92:95], v37, s[32:35], 0 offen offset:3072 sc1
s_waitcnt vmcnt(0)
v_add_f32 v80, v80, v88
v_add_f32 v81, v81, v89
v_add_f32 v82, v82, v90
v_add_f32 v83, v83, v91
v_add_f32 v84, v84, v92
v_add_f32 v85, v85, v93
v_add_f32 v86, v86, v94
v_add_f32 v87, v87, v95
v_add_f32 v80, v80, v84
v_add_f32 v81, v81, v85
v_add_f32 v82, v82, v86
v_add_f32 v83, v83, v87
s_nop 1
v_permlane32_swap_b32 v80, v81
v_permlane32_swap_b32 v82, v83
v_add_f32 v80, v80, v81
v_add_f32 v82, v82, v83
s_nop 1
v_permlane16_swap_b32 v80, v82
s_nop 0
v_add_f32 v80, v80, v82
v_cmp_u_f32 vcc, v80, v80
s_cbranch_vccz summed_53
s_add_u32 s63, s63, 1
s_cmp_lt_u32 s63, 0x10000
s_cbranch_scc1 retry_54
s_branch summed_53
slow_73:
.p2align 3
v_pk_mul_f32 v[220:221], v[220:221], v[160:161] op_sel:[0,0] op_sel_hi:[1,0]
v_pk_mul_f32 v[222:223], v[222:223], v[160:161] op_sel:[0,0] op_sel_hi:[1,0]
v_pk_mul_f32 v[224:225], v[224:225], v[160:161] op_sel:[0,0] op_sel_hi:[1,0]
v_pk_mul_f32 v[226:227], v[226:227], v[160:161] op_sel:[0,0] op_sel_hi:[1,0]
v_cvt_pk_bf16_f32 v220, v220, v221
v_cvt_pk_bf16_f32 v221, v222, v223
v_cvt_pk_bf16_f32 v222, v224, v225
v_cvt_pk_bf16_f32 v223, v226, v227
buffer_store_dwordx4 v[220:223], v18, s[32:35], s80 offen sc1
v_pk_mul_f32 v[228:229], v[228:229], v[168:169] op_sel:[0,0] op_sel_hi:[1,0]
v_pk_mul_f32 v[230:231], v[230:231], v[168:169] op_sel:[0,0] op_sel_hi:[1,0]
v_pk_mul_f32 v[232:233], v[232:233], v[168:169] op_sel:[0,0] op_sel_hi:[1,0]
v_pk_mul_f32 v[234:235], v[234:235], v[168:169] op_sel:[0,0] op_sel_hi:[1,0]
v_cvt_pk_bf16_f32 v228, v228, v229
v_cvt_pk_bf16_f32 v229, v230, v231
v_cvt_pk_bf16_f32 v230, v232, v233
v_cvt_pk_bf16_f32 v231, v234, v235
buffer_store_dwordx4 v[228:231], v18, s[32:35], s81 offen sc1
v_pk_mul_f32 v[236:237], v[236:237], v[176:177] op_sel:[0,0] op_sel_hi:[1,0]
v_pk_mul_f32 v[238:239], v[238:239], v[176:177] op_sel:[0,0] op_sel_hi:[1,0]
v_pk_mul_f32 v[240:241], v[240:241], v[176:177] op_sel:[0,0] op_sel_hi:[1,0]
v_pk_mul_f32 v[242:243], v[242:243], v[176:177] op_sel:[0,0] op_sel_hi:[1,0]
v_cvt_pk_bf16_f32 v236, v236, v237
v_cvt_pk_bf16_f32 v237, v238, v239
v_cvt_pk_bf16_f32 v238, v240, v241
v_cvt_pk_bf16_f32 v239, v242, v243
buffer_store_dwordx4 v[236:239], v18, s[32:35], s82 offen sc1
v_pk_mul_f32 v[244:245], v[244:245], v[184:185] op_sel:[0,0] op_sel_hi:[1,0]
v_pk_mul_f32 v[246:247], v[246:247], v[184:185] op_sel:[0,0] op_sel_hi:[1,0]
v_pk_mul_f32 v[248:249], v[248:249], v[184:185] op_sel:[0,0] op_sel_hi:[1,0]
v_pk_mul_f32 v[250:251], v[250:251], v[184:185] op_sel:[0,0] op_sel_hi:[1,0]
v_cvt_pk_bf16_f32 v244, v244, v245
v_cvt_pk_bf16_f32 v245, v246, v247
v_cvt_pk_bf16_f32 v246, v248, v249
v_cvt_pk_bf16_f32 v247, v250, v251
buffer_store_dwordx4 v[244:247], v18, s[32:35], s83 offen sc1
s_branch back_74
slow_75:
buffer_store_dword v5, v4, s[32:35], s84 offen sc1
s_branch back_76
slow_79:
s_nop 0
v_cvt_pk_bf16_f32 v20, v60, v61
v_cvt_pk_bf16_f32 v21, v62, v63
v_cvt_pk_bf16_f32 v22, v64, v65
v_cvt_pk_bf16_f32 v23, v66, v67
buffer_store_dwordx4 v[20:23], v18, s[32:35], s85 offen offset:0 sc1
v_cvt_pk_bf16_f32 v24, v68, v69
v_cvt_pk_bf16_f32 v25, v70, v71
v_cvt_pk_bf16_f32 v26, v72, v73
v_cvt_pk_bf16_f32 v27, v74, v75
buffer_store_dwordx4 v[24:27], v18, s[32:35], s85 offen offset:1024 sc1
v_cvt_pk_bf16_f32 v28, v76, v77
v_cvt_pk_bf16_f32 v29, v78, v79
v_cvt_pk_bf16_f32 v30, v80, v81
v_cvt_pk_bf16_f32 v31, v82, v83
buffer_store_dwordx4 v[28:31], v18, s[32:35], s86 offen offset:0 sc1
v_cvt_pk_bf16_f32 v32, v84, v85
v_cvt_pk_bf16_f32 v33, v86, v87
v_cvt_pk_bf16_f32 v34, v88, v89
v_cvt_pk_bf16_f32 v35, v90, v91
buffer_store_dwordx4 v[32:35], v18, s[32:35], s86 offen offset:1024 sc1
s_barrier
v_dot2c_f32_bf16 v6, v20, v48
v_dot2c_f32_bf16 v8, v20, v20
v_dot2c_f32_bf16 v7, v28, v48
v_dot2c_f32_bf16 v9, v28, v28
v_dot2c_f32_bf16 v6, v21, v48
v_dot2c_f32_bf16 v8, v21, v21
v_dot2c_f32_bf16 v7, v29, v48
v_dot2c_f32_bf16 v9, v29, v29
v_dot2c_f32_bf16 v6, v22, v48
v_dot2c_f32_bf16 v8, v22, v22
v_dot2c_f32_bf16 v7, v30, v48
v_dot2c_f32_bf16 v9, v30, v30
v_dot2c_f32_bf16 v6, v23, v48
v_dot2c_f32_bf16 v8, v23, v23
v_dot2c_f32_bf16 v7, v31, v48
v_dot2c_f32_bf16 v9, v31, v31
v_dot2c_f32_bf16 v6, v24, v48
v_dot2c_f32_bf16 v8, v24, v24
v_dot2c_f32_bf16 v7, v32, v48
v_dot2c_f32_bf16 v9, v32, v32
v_dot2c_f32_bf16 v6, v25, v48
v_dot2c_f32_bf16 v8, v25, v25
v_dot2c_f32_bf16 v7, v33, v48
v_dot2c_f32_bf16 v9, v33, v33
v_dot2c_f32_bf16 v6, v26, v48
v_dot2c_f32_bf16 v8, v26, v26
v_dot2c_f32_bf16 v7, v34, v48
v_dot2c_f32_bf16 v9, v34, v34
v_dot2c_f32_bf16 v6, v27, v48
v_dot2c_f32_bf16 v8, v27, v27
v_dot2c_f32_bf16 v7, v35, v48
v_dot2c_f32_bf16 v9, v35, v35
s_mov_b64 exec, 1
s_waitcnt vmcnt(0)
buffer_store_dword v5, v4, s[32:35], s88 offen sc1
s_mov_b64 exec, -1
s_nop 1
v_permlane32_swap_b32 v6, v7
v_permlane32_swap_b32 v8, v9
v_add_f32 v6, v6, v7
v_add_f32 v8, v8, v9
s_nop 1
v_permlane16_swap_b32 v6, v8
s_nop 0
v_add_f32 v6, v6, v8
buffer_store_dword v6, v1, s[32:35], s87 offen sc1
s_branch back_80
slow_95:
.p2align 3
v_pk_mul_f32 v[156:157], v[156:157], v[100:101] op_sel:[0,0] op_sel_hi:[1,0]
v_pk_mul_f32 v[158:159], v[158:159], v[100:101] op_sel:[0,0] op_sel_hi:[1,0]
v_pk_mul_f32 v[160:161], v[160:161], v[100:101] op_sel:[0,0] op_sel_hi:[1,0]
v_pk_mul_f32 v[162:163], v[162:163], v[100:101] op_sel:[0,0] op_sel_hi:[1,0]
v_cvt_pk_bf16_f32 v156, v156, v157
v_mfma_f32_16x16x32_bf16 v[172:175], v[188:191], v[76:79], 0
v_cvt_pk_bf16_f32 v157, v158, v159
v_mfma_f32_16x16x32_bf16 v[176:179], v[192:195], v[76:79], 0
v_cvt_pk_bf16_f32 v158, v160, v161
v_mfma_f32_16x16x32_bf16 v[172:175], v[196:199], v[236:239], v[172:175]
v_cvt_pk_bf16_f32 v159, v162, v163
v_mfma_f32_16x16x32_bf16 v[176:179], v[200:203], v[236:239], v[176:179]
buffer_store_dwordx4 v[156:159], v18, s[32:35], s80 offen sc1
v_pk_mul_f32 v[164:165], v[164:165], v[100:101] op_sel:[0,1] op_sel_hi:[1,1]
v_pk_mul_f32 v[166:167], v[166:167], v[100:101] op_sel:[0,1] op_sel_hi:[1,1]
v_pk_mul_f32 v[168:169], v[168:169], v[100:101] op_sel:[0,1] op_sel_hi:[1,1]
v_pk_mul_f32 v[170:171], v[170:171], v[100:101] op_sel:[0,1] op_sel_hi:[1,1]
v_cvt_pk_bf16_f32 v164, v164, v165
v_mfma_f32_16x16x32_bf16 v[180:183], v[188:191], v[84:87], 0
v_cvt_pk_bf16_f32 v165, v166, v167
v_mfma_f32_16x16x32_bf16 v[184:187], v[192:195], v[84:87], 0
v_cvt_pk_bf16_f32 v166, v168, v169
v_mfma_f32_16x16x32_bf16 v[180:183], v[196:199], v[244:247], v[180:183]
v_cvt_pk_bf16_f32 v167, v170, v171
v_mfma_f32_16x16x32_bf16 v[184:187], v[200:203], v[244:247], v[184:187]
buffer_store_dwordx4 v[164:167], v18, s[32:35], s81 offen sc1
v_pk_mul_f32 v[172:173], v[172:173], v[102:103] op_sel:[0,0] op_sel_hi:[1,0]
v_pk_mul_f32 v[174:175], v[174:175], v[102:103] op_sel:[0,0] op_sel_hi:[1,0]
v_pk_mul_f32 v[176:177], v[176:177], v[102:103] op_sel:[0,0] op_sel_hi:[1,0]
v_pk_mul_f32 v[178:179], v[178:179], v[102:103] op_sel:[0,0] op_sel_hi:[1,0]
v_cvt_pk_bf16_f32 v172, v172, v173
v_cvt_pk_bf16_f32 v173, v174, v175
v_cvt_pk_bf16_f32 v174, v176, v177
v_cvt_pk_bf16_f32 v175, v178, v179
buffer_store_dwordx4 v[172:175], v18, s[32:35], s82 offen sc1
v_pk_mul_f32 v[180:181], v[180:181], v[102:103] op_sel:[0,1] op_sel_hi:[1,1]
v_pk_mul_f32 v[182:183], v[182:183], v[102:103] op_sel:[0,1] op_sel_hi:[1,1]
v_pk_mul_f32 v[184:185], v[184:185], v[102:103] op_sel:[0,1] op_sel_hi:[1,1]
v_pk_mul_f32 v[186:187], v[186:187], v[102:103] op_sel:[0,1] op_sel_hi:[1,1]
v_cvt_pk_bf16_f32 v180, v180, v181
v_cvt_pk_bf16_f32 v181, v182, v183
v_cvt_pk_bf16_f32 v182, v184, v185
v_cvt_pk_bf16_f32 v183, v186, v187
buffer_store_dwordx4 v[180:183], v18, s[32:35], s83 offen sc1
s_branch back_96
slow_97:
buffer_store_dword v5, v4, s[32:35], s84 offen sc1
s_branch back_98
slow_101:
s_nop 0
v_cvt_pk_bf16_f32 v20, v60, v61
v_cvt_pk_bf16_f32 v21, v62, v63
v_cvt_pk_bf16_f32 v22, v64, v65
v_cvt_pk_bf16_f32 v23, v66, v67
buffer_store_dwordx4 v[20:23], v18, s[32:35], s85 offen offset:0 sc1
v_cvt_pk_bf16_f32 v24, v68, v69
v_cvt_pk_bf16_f32 v25, v70, v71
v_cvt_pk_bf16_f32 v26, v72, v73
v_cvt_pk_bf16_f32 v27, v74, v75
buffer_store_dwordx4 v[24:27], v18, s[32:35], s85 offen offset:1024 sc1
v_cvt_pk_bf16_f32 v28, v76, v77
v_cvt_pk_bf16_f32 v29, v78, v79
v_cvt_pk_bf16_f32 v30, v80, v81
v_cvt_pk_bf16_f32 v31, v82, v83
buffer_store_dwordx4 v[28:31], v18, s[32:35], s86 offen offset:0 sc1
v_cvt_pk_bf16_f32 v32, v84, v85
v_cvt_pk_bf16_f32 v33, v86, v87
v_cvt_pk_bf16_f32 v34, v88, v89
v_cvt_pk_bf16_f32 v35, v90, v91
buffer_store_dwordx4 v[32:35], v18, s[32:35], s86 offen offset:1024 sc1
s_barrier
v_dot2c_f32_bf16 v6, v20, v48
v_dot2c_f32_bf16 v8, v20, v20
v_dot2c_f32_bf16 v7, v28, v48
v_dot2c_f32_bf16 v9, v28, v28
v_dot2c_f32_bf16 v6, v21, v48
v_dot2c_f32_bf16 v8, v21, v21
v_dot2c_f32_bf16 v7, v29, v48
v_dot2c_f32_bf16 v9, v29, v29
v_dot2c_f32_bf16 v6, v22, v48
v_dot2c_f32_bf16 v8, v22, v22
v_dot2c_f32_bf16 v7, v30, v48
v_dot2c_f32_bf16 v9, v30, v30
v_dot2c_f32_bf16 v6, v23, v48
v_dot2c_f32_bf16 v8, v23, v23
v_dot2c_f32_bf16 v7, v31, v48
v_dot2c_f32_bf16 v9, v31, v31
v_dot2c_f32_bf16 v6, v24, v48
v_dot2c_f32_bf16 v8, v24, v24
v_dot2c_f32_bf16 v7, v32, v48
v_dot2c_f32_bf16 v9, v32, v32
v_dot2c_f32_bf16 v6, v25, v48
v_dot2c_f32_bf16 v8, v25, v25
v_dot2c_f32_bf16 v7, v33, v48
v_dot2c_f32_bf16 v9, v33, v33
v_dot2c_f32_bf16 v6, v26, v48
v_dot2c_f32_bf16 v8, v26, v26
v_dot2c_f32_bf16 v7, v34, v48
v_dot2c_f32_bf16 v9, v34, v34
v_dot2c_f32_bf16 v6, v27, v48
v_dot2c_f32_bf16 v8, v27, v27
v_dot2c_f32_bf16 v7, v35, v48
v_dot2c_f32_bf16 v9, v35, v35
s_mov_b64 exec, 1
s_waitcnt vmcnt(0)
buffer_store_dword v5, v4, s[32:35], s88 offen sc1
s_mov_b64 exec, -1
s_nop 1
v_permlane32_swap_b32 v6, v7
v_permlane32_swap_b32 v8, v9
v_add_f32 v6, v6, v7
v_add_f32 v8, v8, v9
s_nop 1
v_permlane16_swap_b32 v6, v8
s_nop 0
v_add_f32 v6, v6, v8
buffer_store_dword v6, v1, s[32:35], s87 offen sc1
s_branch back_102
slow_113:
.p2align 3
v_pk_mul_f32 v[220:221], v[220:221], v[160:161] op_sel:[0,0] op_sel_hi:[1,0]
v_pk_mul_f32 v[222:223], v[222:223], v[160:161] op_sel:[0,0] op_sel_hi:[1,0]
v_pk_mul_f32 v[224:225], v[224:225], v[160:161] op_sel:[0,0] op_sel_hi:[1,0]
v_pk_mul_f32 v[226:227], v[226:227], v[160:161] op_sel:[0,0] op_sel_hi:[1,0]
v_cvt_pk_bf16_f32 v220, v220, v221
v_cvt_pk_bf16_f32 v221, v222, v223
v_cvt_pk_bf16_f32 v222, v224, v225
v_cvt_pk_bf16_f32 v223, v226, v227
buffer_store_dwordx4 v[220:223], v18, s[32:35], s80 offen sc1
v_pk_mul_f32 v[228:229], v[228:229], v[168:169] op_sel:[0,0] op_sel_hi:[1,0]
v_pk_mul_f32 v[230:231], v[230:231], v[168:169] op_sel:[0,0] op_sel_hi:[1,0]
v_pk_mul_f32 v[232:233], v[232:233], v[168:169] op_sel:[0,0] op_sel_hi:[1,0]
v_pk_mul_f32 v[234:235], v[234:235], v[168:169] op_sel:[0,0] op_sel_hi:[1,0]
v_cvt_pk_bf16_f32 v228, v228, v229
v_cvt_pk_bf16_f32 v229, v230, v231
v_cvt_pk_bf16_f32 v230, v232, v233
v_cvt_pk_bf16_f32 v231, v234, v235
buffer_store_dwordx4 v[228:231], v18, s[32:35], s81 offen sc1
v_pk_mul_f32 v[236:237], v[236:237], v[176:177] op_sel:[0,0] op_sel_hi:[1,0]
v_pk_mul_f32 v[238:239], v[238:239], v[176:177] op_sel:[0,0] op_sel_hi:[1,0]
v_pk_mul_f32 v[240:241], v[240:241], v[176:177] op_sel:[0,0] op_sel_hi:[1,0]
v_pk_mul_f32 v[242:243], v[242:243], v[176:177] op_sel:[0,0] op_sel_hi:[1,0]
v_cvt_pk_bf16_f32 v236, v236, v237
v_cvt_pk_bf16_f32 v237, v238, v239
v_cvt_pk_bf16_f32 v238, v240, v241
v_cvt_pk_bf16_f32 v239, v242, v243
buffer_store_dwordx4 v[236:239], v18, s[32:35], s82 offen sc1
v_pk_mul_f32 v[244:245], v[244:245], v[184:185] op_sel:[0,0] op_sel_hi:[1,0]
v_pk_mul_f32 v[246:247], v[246:247], v[184:185] op_sel:[0,0] op_sel_hi:[1,0]
v_pk_mul_f32 v[248:249], v[248:249], v[184:185] op_sel:[0,0] op_sel_hi:[1,0]
v_pk_mul_f32 v[250:251], v[250:251], v[184:185] op_sel:[0,0] op_sel_hi:[1,0]
v_cvt_pk_bf16_f32 v244, v244, v245
v_cvt_pk_bf16_f32 v245, v246, v247
v_cvt_pk_bf16_f32 v246, v248, v249
v_cvt_pk_bf16_f32 v247, v250, v251
buffer_store_dwordx4 v[244:247], v18, s[32:35], s83 offen sc1
s_branch back_114
slow_115:
buffer_store_dword v5, v4, s[32:35], s84 offen sc1
s_branch back_116
slow_119:
s_nop 0
v_cvt_pk_bf16_f32 v20, v60, v61
v_cvt_pk_bf16_f32 v21, v62, v63
v_cvt_pk_bf16_f32 v22, v64, v65
v_cvt_pk_bf16_f32 v23, v66, v67
buffer_store_dwordx4 v[20:23], v18, s[32:35], s85 offen offset:0 sc1
v_cvt_pk_bf16_f32 v24, v68, v69
v_cvt_pk_bf16_f32 v25, v70, v71
v_cvt_pk_bf16_f32 v26, v72, v73
v_cvt_pk_bf16_f32 v27, v74, v75
buffer_store_dwordx4 v[24:27], v18, s[32:35], s85 offen offset:1024 sc1
v_cvt_pk_bf16_f32 v28, v76, v77
v_cvt_pk_bf16_f32 v29, v78, v79
v_cvt_pk_bf16_f32 v30, v80, v81
v_cvt_pk_bf16_f32 v31, v82, v83
buffer_store_dwordx4 v[28:31], v18, s[32:35], s86 offen offset:0 sc1
v_cvt_pk_bf16_f32 v32, v84, v85
v_cvt_pk_bf16_f32 v33, v86, v87
v_cvt_pk_bf16_f32 v34, v88, v89
v_cvt_pk_bf16_f32 v35, v90, v91
buffer_store_dwordx4 v[32:35], v18, s[32:35], s86 offen offset:1024 sc1
s_barrier
v_dot2c_f32_bf16 v6, v20, v48
v_dot2c_f32_bf16 v8, v20, v20
v_dot2c_f32_bf16 v7, v28, v48
v_dot2c_f32_bf16 v9, v28, v28
v_dot2c_f32_bf16 v6, v21, v48
v_dot2c_f32_bf16 v8, v21, v21
v_dot2c_f32_bf16 v7, v29, v48
v_dot2c_f32_bf16 v9, v29, v29
v_dot2c_f32_bf16 v6, v22, v48
v_dot2c_f32_bf16 v8, v22, v22
v_dot2c_f32_bf16 v7, v30, v48
v_dot2c_f32_bf16 v9, v30, v30
v_dot2c_f32_bf16 v6, v23, v48
v_dot2c_f32_bf16 v8, v23, v23
v_dot2c_f32_bf16 v7, v31, v48
v_dot2c_f32_bf16 v9, v31, v31
v_dot2c_f32_bf16 v6, v24, v48
v_dot2c_f32_bf16 v8, v24, v24
v_dot2c_f32_bf16 v7, v32, v48
v_dot2c_f32_bf16 v9, v32, v32
v_dot2c_f32_bf16 v6, v25, v48
v_dot2c_f32_bf16 v8, v25, v25
v_dot2c_f32_bf16 v7, v33, v48
v_dot2c_f32_bf16 v9, v33, v33
v_dot2c_f32_bf16 v6, v26, v48
v_dot2c_f32_bf16 v8, v26, v26
v_dot2c_f32_bf16 v7, v34, v48
v_dot2c_f32_bf16 v9, v34, v34
v_dot2c_f32_bf16 v6, v27, v48
v_dot2c_f32_bf16 v8, v27, v27
v_dot2c_f32_bf16 v7, v35, v48
v_dot2c_f32_bf16 v9, v35, v35
s_mov_b64 exec, 1
s_waitcnt vmcnt(0)
buffer_store_dword v5, v4, s[32:35], s88 offen sc1
s_mov_b64 exec, -1
s_nop 1
v_permlane32_swap_b32 v6, v7
v_permlane32_swap_b32 v8, v9
v_add_f32 v6, v6, v7
v_add_f32 v8, v8, v9
s_nop 1
v_permlane16_swap_b32 v6, v8
s_nop 0
v_add_f32 v6, v6, v8
buffer_store_dword v6, v1, s[32:35], s87 offen sc1
s_branch back_120
slow_133:
.p2align 3
v_pk_mul_f32 v[156:157], v[156:157], v[100:101] op_sel:[0,0] op_sel_hi:[1,0]
v_pk_mul_f32 v[158:159], v[158:159], v[100:101] op_sel:[0,0] op_sel_hi:[1,0]
v_pk_mul_f32 v[160:161], v[160:161], v[100:101] op_sel:[0,0] op_sel_hi:[1,0]
v_pk_mul_f32 v[162:163], v[162:163], v[100:101] op_sel:[0,0] op_sel_hi:[1,0]
v_cvt_pk_bf16_f32 v156, v156, v157
v_mfma_f32_16x16x32_bf16 v[172:175], v[188:191], v[76:79], 0
v_cvt_pk_bf16_f32 v157, v158, v159
v_mfma_f32_16x16x32_bf16 v[176:179], v[192:195], v[76:79], 0
v_cvt_pk_bf16_f32 v158, v160, v161
v_mfma_f32_16x16x32_bf16 v[172:175], v[196:199], v[236:239], v[172:175]
v_cvt_pk_bf16_f32 v159, v162, v163
v_mfma_f32_16x16x32_bf16 v[176:179], v[200:203], v[236:239], v[176:179]
buffer_store_dwordx4 v[156:159], v18, s[32:35], s80 offen sc1
v_pk_mul_f32 v[164:165], v[164:165], v[100:101] op_sel:[0,1] op_sel_hi:[1,1]
v_pk_mul_f32 v[166:167], v[166:167], v[100:101] op_sel:[0,1] op_sel_hi:[1,1]
v_pk_mul_f32 v[168:169], v[168:169], v[100:101] op_sel:[0,1] op_sel_hi:[1,1]
v_pk_mul_f32 v[170:171], v[170:171], v[100:101] op_sel:[0,1] op_sel_hi:[1,1]
v_cvt_pk_bf16_f32 v164, v164, v165
v_mfma_f32_16x16x32_bf16 v[180:183], v[188:191], v[84:87], 0
v_cvt_pk_bf16_f32 v165, v166, v167
v_mfma_f32_16x16x32_bf16 v[184:187], v[192:195], v[84:87], 0
v_cvt_pk_bf16_f32 v166, v168, v169
v_mfma_f32_16x16x32_bf16 v[180:183], v[196:199], v[244:247], v[180:183]
v_cvt_pk_bf16_f32 v167, v170, v171
v_mfma_f32_16x16x32_bf16 v[184:187], v[200:203], v[244:247], v[184:187]
buffer_store_dwordx4 v[164:167], v18, s[32:35], s81 offen sc1
v_pk_mul_f32 v[172:173], v[172:173], v[102:103] op_sel:[0,0] op_sel_hi:[1,0]
v_pk_mul_f32 v[174:175], v[174:175], v[102:103] op_sel:[0,0] op_sel_hi:[1,0]
v_pk_mul_f32 v[176:177], v[176:177], v[102:103] op_sel:[0,0] op_sel_hi:[1,0]
v_pk_mul_f32 v[178:179], v[178:179], v[102:103] op_sel:[0,0] op_sel_hi:[1,0]
v_cvt_pk_bf16_f32 v172, v172, v173
v_cvt_pk_bf16_f32 v173, v174, v175
v_cvt_pk_bf16_f32 v174, v176, v177
v_cvt_pk_bf16_f32 v175, v178, v179
buffer_store_dwordx4 v[172:175], v18, s[32:35], s82 offen sc1
v_pk_mul_f32 v[180:181], v[180:181], v[102:103] op_sel:[0,1] op_sel_hi:[1,1]
v_pk_mul_f32 v[182:183], v[182:183], v[102:103] op_sel:[0,1] op_sel_hi:[1,1]
v_pk_mul_f32 v[184:185], v[184:185], v[102:103] op_sel:[0,1] op_sel_hi:[1,1]
v_pk_mul_f32 v[186:187], v[186:187], v[102:103] op_sel:[0,1] op_sel_hi:[1,1]
v_cvt_pk_bf16_f32 v180, v180, v181
v_cvt_pk_bf16_f32 v181, v182, v183
v_cvt_pk_bf16_f32 v182, v184, v185
v_cvt_pk_bf16_f32 v183, v186, v187
buffer_store_dwordx4 v[180:183], v18, s[32:35], s83 offen sc1
s_branch back_134
slow_135:
buffer_store_dword v5, v4, s[32:35], s84 offen sc1
s_branch back_136
s_endpgm
.section .rodata,"a"
.p2align 6
.amdhsa_kernel interleave_layers__sliding_local_dilated__linear_kernel_hedgehog__prompt_kernel
  .amdhsa_next_free_vgpr 256
  .amdhsa_next_free_sgpr 102
  .amdhsa_accum_offset 256
  .amdhsa_group_segment_fixed_size 0
  .amdhsa_kernarg_size 80
  .amdhsa_user_sgpr_count 2
  .amdhsa_user_sgpr_kernarg_segment_ptr 1
  .amdhsa_system_sgpr_workgroup_id_x 1
.end_amdhsa_kernel
```

```asm
; @launch grid=(256,1,1) block=(512,1,1) lds=163840
.amdgcn_target "amdgcn-amd-amdhsa--gfx950"
.text
.globl interleave_layers__sliding_local_dilated__linear_kernel_hedgehog__prompt_kernel
.p2align 8
.type interleave_layers__sliding_local_dilated__linear_kernel_hedgehog__prompt_kernel,@function
interleave_layers__sliding_local_dilated__linear_kernel_hedgehog__prompt_kernel:
s_cmp_ge_u32 s2, 256
s_cbranch_scc1 L_end
s_load_dwordx16 s[4:19], s[0:1], 0
s_load_dwordx4 s[20:23], s[0:1], 64
v_lshrrev_b32 v1, 6, v0
v_and_b32 v0, 63, v0
v_readfirstlane_b32 s40, v1
v_and_b32 v2, 15, v0
v_lshrrev_b32 v3, 4, v0
v_lshlrev_b32 v18, 4, v0
s_and_b32 s48, s2, 7
s_lshr_b32 s49, s2, 3
s_and_b32 s74, s49, 1
s_lshl_b32 s41, s48, 1
s_add_u32 s41, s41, s74
s_lshr_b32 s42, s49, 1
s_and_b32 s48, s2, 7
s_lshr_b32 s47, s42, 2
s_add_u32 s47, s47, s48
s_and_b32 s47, s47, 3
s_and_b32 s43, s40, 3
s_lshl_b32 s70, s43, 12
s_lshl_b32 s71, s43, 11
s_add_u32 s71, s71, 16384
s_cmp_lt_u32 s40, 4
s_cbranch_scc1 L_compute
v_lshrrev_b32 v4, 3, v0
v_and_b32 v5, 7, v0
s_lshl_b32 s48, s43, 4
v_add_u32 v6, s48, v4
s_lshl_b32 s48, s42, 7
s_mov_b32 s49, 6144
v_mul_u32_u24 v6, s49, v6
v_and_b32 v7, 2, v4
v_xor_b32 v7, v7, v5
v_lshl_add_u32 v26, v7, 4, v6
v_add_u32 v26, s48, v26
s_mul_i32 s49, s49, 8
s_sub_u32 s49, s49, 1024
v_xor_b32 v27, 64, v26
v_add_u32 v27, s49, v27
s_mov_b32 s53, 2048
s_mov_b32 s54, 393216
s_mov_b32 s57, 131072
s_lshl_b32 s48, s41, 7
s_lshl_b32 s49, s43, 5
s_add_u32 s48, s48, s49
v_add_u32 v6, s48, v4
v_lshlrev_b32 v6, 11, v6
v_lshrrev_b32 v7, 1, v4
v_xor_b32 v7, v7, v5
v_lshl_add_u32 v20, v7, 4, v6
v_xor_b32 v21, 64, v20
v_add_u32 v21, 15360, v21
v_add_u32 v22, 30720, v20
v_add_u32 v23, 30720, v21
s_add_u32 s69, s47, 0
s_and_b32 s69, s69, 3
s_add_u32 s69, s69, 0
s_mul_i32 s67, s69, 128
s_mul_i32 s68, s69, s54
s_waitcnt lgkmcnt(0)
s_mov_b32 s24, s4
s_and_b32 s25, s5, 0xffff
s_mov_b32 s26, 4194304
s_mov_b32 s27, 0x00020000
s_mov_b32 s28, s6
s_and_b32 s29, s7, 0xffff
s_mov_b32 s30, 6291456
s_mov_b32 s31, 0x00020000
s_add_u32 m0, s70, 0
s_nop 0
buffer_load_dwordx4 v20, s[24:27], s67 offen offset:0  lds
buffer_load_dwordx4 v21, s[24:27], s67 offen offset:1024  lds
buffer_load_dwordx4 v22, s[24:27], s67 offen offset:2048  lds
buffer_load_dwordx4 v23, s[24:27], s67 offen offset:3072  lds
s_add_u32 s60, s71, 0
s_add_u32 m0, s60, 0
s_mov_b32 s61, s68
buffer_load_dwordx4 v26, s[28:31], s61 offen lds
buffer_load_dwordx4 v27, s[28:31], s61 offen offset:1024 lds
s_add_u32 m0, s60, 8192
s_add_u32 s61, s61, s53
buffer_load_dwordx4 v26, s[28:31], s61 offen lds
buffer_load_dwordx4 v27, s[28:31], s61 offen offset:1024 lds
s_add_u32 m0, s60, 16384
s_add_u32 s61, s61, s53
buffer_load_dwordx4 v26, s[28:31], s61 offen lds
buffer_load_dwordx4 v27, s[28:31], s61 offen offset:1024 lds
s_lshr_b32 s48, s2, 2
s_and_b32 s48, s48, 1
s_lshl_b32 s48, s48, 1
s_add_u32 s48, s48, s74
s_and_b32 s49, s42, 3
s_xor_b32 s77, s48, s49
s_add_u32 s77, s77, 4
s_add_u32 s48, s47, 1
s_and_b32 s48, s48, 3
s_and_b32 s49, s77, 3
s_lshl_b32 s49, s49, 2
s_add_u32 s78, s48, s49
s_and_b32 s48, s2, 7
s_lshl_b32 s48, s48, 1
s_add_u32 s75, s78, s48
s_and_b32 s75, s75, 15
s_mov_b32 s46, 0
s_mov_b32 s32, s22
s_and_b32 s33, s23, 0xffff
s_mov_b32 s34, 268435456
s_mov_b32 s35, 0x00020000
s_mov_b32 s36, s8
s_and_b32 s37, s9, 0xffff
s_mov_b32 s38, 2097152
s_mov_b32 s39, 0x00020000
v_mov_b32 v56, -1
v_mov_b32 v57, -1
v_mov_b32 v58, -1
v_mov_b32 v59, -1
s_lshl_b32 s52, s41, 6
s_add_u32 s52, s52, s42
s_lshl_b32 s52, s52, 8
s_add_u32 s52, s52, 16777216
s_getreg_b32 s50, hwreg(HW_REG_XCC_ID)
s_and_b32 s50, s50, 7
s_lshl_b32 s50, s50, 3
s_lshl_b64 s[94:95], 1, s50
s_and_b32 s96, s2, 7
s_lshl_b32 s96, s96, 5
s_and_b32 s51, s42, 7
s_cmp_gt_u32 s51, 3
s_cselect_b32 s49, 1, 0
s_sub_u32 s49, s51, s49
s_lshl_b32 s49, s49, 1
s_add_u32 s49, s49, s74
s_lshl_b32 s49, s49, 2
s_add_u32 s49, s49, s43
s_lshr_b32 s50, s49, 4
s_lshl_b32 s50, s50, 11
s_and_b32 s49, s49, 15
s_mul_i32 s49, s49, 24576
s_add_u32 s49, s49, s50
s_and_b32 s50, s42, 8
s_or_b32 s50, s50, 3
s_and_b32 s48, s2, 7
s_lshr_b32 s76, s50, 2
s_add_u32 s76, s76, s48
s_and_b32 s76, s76, 3
s_lshl_b32 s50, s50, 7
s_add_u32 s49, s49, s50
s_and_b32 s51, s51, 3
s_cmp_eq_u32 s51, 3
s_cselect_b32 s49, 0x70000000, s49
v_mul_u32_u24 v4, 6144, v4
v_lshl_add_u32 v4, v5, 4, v4
v_lshrrev_b32 v5, 5, v0
v_lshlrev_b32 v5, 30, v5
v_add3_u32 v36, v4, v5, s49
s_mov_b32 s55, -1
s_mov_b32 s56, -1
v_lshrrev_b32 v4, 3, v0
v_and_b32 v5, 7, v0
s_lshr_b32 s48, s43, 1
s_lshl_b32 s48, s48, 5
s_and_b32 s49, s43, 1
s_lshl_b32 s49, s49, 3
s_add_u32 s48, s48, s49
v_lshrrev_b32 v6, 2, v4
v_lshlrev_b32 v6, 4, v6
v_and_b32 v7, 3, v4
v_add3_u32 v6, v6, v7, s48
s_lshl_b32 s48, s78, 7
s_mov_b32 s49, 2048
v_mul_u32_u24 v6, s49, v6
v_and_b32 v7, 2, v4
v_xor_b32 v7, v7, v5
v_lshl_add_u32 v28, v7, 4, v6
v_add_u32 v28, s48, v28
s_mul_i32 s49, s49, 4
s_sub_u32 s49, s49, 1024
v_xor_b32 v29, 64, v28
v_add_u32 v29, s49, v29
v_lshrrev_b32 v4, 3, v0
v_and_b32 v5, 7, v0
s_lshr_b32 s48, s43, 1
s_lshl_b32 s48, s48, 5
s_and_b32 s49, s43, 1
s_lshl_b32 s49, s49, 3
s_add_u32 s48, s48, s49
v_lshrrev_b32 v6, 2, v4
v_lshlrev_b32 v6, 4, v6
v_and_b32 v7, 3, v4
v_add3_u32 v6, v6, v7, s48
s_lshl_b32 s48, s42, 7
s_mov_b32 s49, 6144
s_cmp_ge_i32 s55, 0
s_cselect_b32 s48, 1024, s48
s_cselect_b32 s49, 384, s49
v_mul_u32_u24 v6, s49, v6
v_and_b32 v7, 2, v4
v_xor_b32 v7, v7, v5
v_lshl_add_u32 v60, v7, 4, v6
v_add_u32 v60, s48, v60
s_mul_i32 s49, s49, 4
s_sub_u32 s49, s49, 1024
v_xor_b32 v61, 64, v60
v_add_u32 v61, s49, v61
v_lshrrev_b32 v4, 3, v0
v_and_b32 v5, 7, v0
s_lshr_b32 s48, s43, 1
s_lshl_b32 s48, s48, 5
s_and_b32 s49, s43, 1
s_lshl_b32 s49, s49, 3
s_add_u32 s48, s48, s49
v_lshrrev_b32 v6, 2, v4
v_lshlrev_b32 v6, 4, v6
v_and_b32 v7, 3, v4
v_add3_u32 v6, v6, v7, s48
s_lshl_b32 s48, s78, 7
s_mov_b32 s49, 2048
s_cmp_ge_i32 s56, 0
s_cselect_b32 s48, 1024, s48
s_cselect_b32 s49, 128, s49
v_mul_u32_u24 v6, s49, v6
v_and_b32 v7, 2, v4
v_xor_b32 v7, v7, v5
v_lshl_add_u32 v24, v7, 4, v6
v_add_u32 v24, s48, v24
s_mul_i32 s49, s49, 4
s_sub_u32 s49, s49, 1024
v_xor_b32 v25, 64, v24
v_add_u32 v25, s49, v25
v_lshlrev_b32 v30, 2, v2
v_and_b32 v32, 7, v0
v_lshlrev_b32 v32, 5, v32
s_lshl_b32 s50, s41, 2
s_add_u32 s50, s50, s43
s_lshl_b32 s50, s50, 12
s_add_u32 s50, s50, 16777216
v_add_u32 v37, s50, v18
v_lshrrev_b32 v4, 5, v0
v_lshl_add_u32 v4, v4, 4, v2
s_lshl_b32 s48, s43, 5
v_add_u32 v4, s48, v4
v_lshlrev_b32 v49, 3, v4
v_add_u32 v49, 131072, v49
v_lshlrev_b32 v50, 2, v4
v_add_u32 v50, 132096, v50
s_lshl_b32 s79, s41, 2
s_add_u32 s79, s79, s43
s_lshl_b32 s79, s79, 7
s_add_u32 s79, s79, 18358272
s_lshl_b32 s48, s41, 3
s_lshl_b32 s49, s43, 1
s_add_u32 s48, s48, s49
s_lshl_b32 s80, s48, 15
s_lshl_b32 s49, s42, 11
s_add_u32 s81, s80, s49
s_add_u32 s81, s81, 4194304
s_add_u32 s82, s81, 32768
s_lshl_b32 s48, s43, 11
v_add_u32 v51, s48, v18
v_add_u32 v52, 0x10000, v51
v_add_u32 v14, 0x20000, v51
s_lshl_b32 s48, s2, 2
s_add_u32 s48, s48, s43
s_lshl_b32 s83, s48, 11
s_mul_i32 s87, s48, 6144
v_add_u32 v62, s83, v18
s_add_u32 s87, s87, 3072
v_add_u32 v63, s87, v18
s_lshr_b32 s48, s2, 4
s_and_b32 s49, s2, 7
s_add_u32 s48, s48, s49
s_mul_i32 s49, s48, 8193
s_lshr_b32 s49, s49, 16
s_mul_i32 s49, s49, 8
s_sub_u32 s88, s48, s49
s_lshr_b32 s48, s2, 3
s_lshl_b32 s48, s48, 2
s_add_u32 s48, s48, s43
s_lshl_b32 s48, s48, 14
s_add_u32 s48, s48, 384
v_lshrrev_b32 v4, 3, v0
v_and_b32 v5, 7, v0
v_lshlrev_b32 v4, 11, v4
v_lshl_add_u32 v4, v5, 4, v4
v_add_u32 v15, s48, v4
s_mul_i32 s48, s42, 163840
s_add_u32 s48, s48, 9437184
s_lshl_b32 s49, s43, 4
s_add_u32 s49, s49, s41
s_lshl_b32 s50, s49, 11
s_add_u32 s86, s48, s50
s_lshl_b32 s50, s49, 9
s_add_u32 s89, s48, s50
s_add_u32 s89, s89, 131072
v_lshlrev_b32 v39, 3, v0
s_lshl_b32 s73, s42, 2
s_add_u32 s73, s73, 0
s_lshl_b32 s73, s73, 7
s_add_u32 s73, s73, 18366464
s_lshl_b32 s48, s41, 2
v_mov_b32 v12, s48
v_mov_b32 v13, 1
s_lshl_b32 s50, s43, 12
s_add_u32 s50, s50, s52
s_add_u32 s50, s50, 262144
v_min_u32 v8, 2, v3
v_lshlrev_b32 v8, 18, v8
v_lshl_add_u32 v8, v2, 4, v8
v_add_u32 v55, s50, v8
s_lshl_b32 s50, s42, 2
s_add_u32 s50, s50, s43
s_lshl_b32 s50, s50, 12
s_add_u32 s50, s50, 17825792
v_add_u32 v38, s50, v18
v_min_u32 v4, 2, v3
v_lshlrev_b32 v4, 8, v4
v_lshl_add_u32 v4, v2, 2, v4
s_and_b32 s48, s43, 1
s_lshl_b32 s48, s48, 7
s_lshr_b32 s49, s43, 1
s_lshl_b32 s49, s49, 6
s_add_u32 s48, s48, s49
s_add_u32 s48, s48, 133120
v_add_u32 v53, s48, v4
s_getpc_b64 s[98:99]
pc_1:
s_add_u32 s98, s98, c0_last - pc_1
s_addc_u32 s99, s99, 0
s_lshr_b32 s50, s2, 3
s_lshl_b32 s50, s50, 2
s_add_u32 s50, s50, s43
s_lshl_b32 s50, s50, 7
v_and_b32 v4, 1, v0
v_lshl_add_u32 v4, v4, 6, s50
v_min_u32 v54, L_code_end - c0_last, v4
s_add_u32 s69, s47, 0
s_and_b32 s69, s69, 3
s_add_u32 s69, s69, 4
s_mul_i32 s67, s69, 128
s_mul_i32 s68, s69, s54
s_add_u32 m0, s70, 40960
s_nop 0
buffer_load_dwordx4 v20, s[24:27], s67 offen offset:0  lds
buffer_load_dwordx4 v21, s[24:27], s67 offen offset:1024  lds
buffer_load_dwordx4 v22, s[24:27], s67 offen offset:2048  lds
buffer_load_dwordx4 v23, s[24:27], s67 offen offset:3072  lds
s_add_u32 s60, s71, 40960
s_add_u32 m0, s60, 0
s_mov_b32 s61, s68
buffer_load_dwordx4 v26, s[28:31], s61 offen lds
buffer_load_dwordx4 v27, s[28:31], s61 offen offset:1024 lds
s_add_u32 m0, s60, 8192
s_add_u32 s61, s61, s53
buffer_load_dwordx4 v26, s[28:31], s61 offen lds
buffer_load_dwordx4 v27, s[28:31], s61 offen offset:1024 lds
s_add_u32 m0, s60, 16384
s_add_u32 s61, s61, s53
buffer_load_dwordx4 v26, s[28:31], s61 offen lds
buffer_load_dwordx4 v27, s[28:31], s61 offen offset:1024 lds
s_waitcnt vmcnt(10)
s_barrier
s_cmp_lg_u32 s43, 3
s_cbranch_scc1 else_2
s_atomic_add_x2 s[94:95], s[20:21], s96
else_2:
s_add_u32 s49, s76, 0
s_and_b32 s49, s49, 3
s_add_u32 s49, s49, 8
s_mul_i32 s49, s49, 393216
buffer_load_dwordx4 v[40:43], v36, s[28:31], s49 offen
s_add_u32 s49, s76, 0
s_and_b32 s49, s49, 3
s_add_u32 s49, s49, 12
s_mul_i32 s49, s49, 393216
buffer_load_dwordx4 v[40:43], v36, s[28:31], s49 offen
s_add_u32 s69, s47, 0
s_and_b32 s69, s69, 3
s_add_u32 s69, s69, 8
s_mul_i32 s67, s69, 128
s_mul_i32 s68, s69, s54
s_add_u32 m0, s70, 81920
s_nop 0
buffer_load_dwordx4 v20, s[24:27], s67 offen offset:0  lds
buffer_load_dwordx4 v21, s[24:27], s67 offen offset:1024  lds
buffer_load_dwordx4 v22, s[24:27], s67 offen offset:2048  lds
buffer_load_dwordx4 v23, s[24:27], s67 offen offset:3072  lds
s_add_u32 s60, s71, 81920
s_add_u32 m0, s60, 0
s_mov_b32 s61, s68
buffer_load_dwordx4 v26, s[28:31], s61 offen lds
buffer_load_dwordx4 v27, s[28:31], s61 offen offset:1024 lds
s_add_u32 m0, s60, 8192
s_add_u32 s61, s61, s53
buffer_load_dwordx4 v26, s[28:31], s61 offen lds
buffer_load_dwordx4 v27, s[28:31], s61 offen offset:1024 lds
s_add_u32 m0, s60, 16384
s_add_u32 s61, s61, s53
buffer_load_dwordx4 v26, s[28:31], s61 offen lds
buffer_load_dwordx4 v27, s[28:31], s61 offen offset:1024 lds
s_add_u32 s49, s76, 1
s_and_b32 s49, s49, 3
s_add_u32 s49, s49, 0
s_mul_i32 s49, s49, 393216
buffer_load_dwordx4 v[40:43], v36, s[28:31], s49 offen
s_mov_b32 s64, 0
s_mov_b32 s65, 0
s_waitcnt vmcnt(11)
s_barrier
s_add_u32 s69, s47, 0
s_and_b32 s69, s69, 3
s_add_u32 s69, s69, 12
s_mul_i32 s67, s69, 128
s_mul_i32 s68, s69, s54
s_add_u32 m0, s70, s65
s_nop 0
buffer_load_dwordx4 v20, s[24:27], s67 offen offset:0  lds
buffer_load_dwordx4 v21, s[24:27], s67 offen offset:1024  lds
buffer_load_dwordx4 v22, s[24:27], s67 offen offset:2048  lds
buffer_load_dwordx4 v23, s[24:27], s67 offen offset:3072  lds
s_add_u32 s60, s71, s65
s_add_u32 m0, s60, 0
s_mov_b32 s61, s68
buffer_load_dwordx4 v26, s[28:31], s61 offen lds
buffer_load_dwordx4 v27, s[28:31], s61 offen offset:1024 lds
s_add_u32 m0, s60, 8192
s_add_u32 s61, s61, s53
buffer_load_dwordx4 v26, s[28:31], s61 offen lds
buffer_load_dwordx4 v27, s[28:31], s61 offen offset:1024 lds
s_add_u32 m0, s60, 16384
s_add_u32 s61, s61, s53
buffer_load_dwordx4 v26, s[28:31], s61 offen lds
buffer_load_dwordx4 v27, s[28:31], s61 offen offset:1024 lds
s_add_u32 s49, s76, 1
s_and_b32 s49, s49, 3
s_add_u32 s49, s49, 4
s_mul_i32 s49, s49, 393216
buffer_load_dwordx4 v[40:43], v36, s[28:31], s49 offen
s_add_u32 s65, s65, 40960
s_cmp_eq_u32 s65, 122880
s_cselect_b32 s65, 0, s65
s_add_u32 s64, s64, 1
s_waitcnt vmcnt(11)
s_barrier
s_add_u32 s69, s47, 1
s_and_b32 s69, s69, 3
s_add_u32 s69, s69, 0
s_mul_i32 s67, s69, 128
s_mul_i32 s68, s69, s54
s_add_u32 m0, s70, s65
s_nop 0
buffer_load_dwordx4 v20, s[24:27], s67 offen offset:0  lds
buffer_load_dwordx4 v21, s[24:27], s67 offen offset:1024  lds
buffer_load_dwordx4 v22, s[24:27], s67 offen offset:2048  lds
buffer_load_dwordx4 v23, s[24:27], s67 offen offset:3072  lds
s_add_u32 s60, s71, s65
s_add_u32 m0, s60, 0
s_mov_b32 s61, s68
buffer_load_dwordx4 v26, s[28:31], s61 offen lds
buffer_load_dwordx4 v27, s[28:31], s61 offen offset:1024 lds
s_add_u32 m0, s60, 8192
s_add_u32 s61, s61, s53
buffer_load_dwordx4 v26, s[28:31], s61 offen lds
buffer_load_dwordx4 v27, s[28:31], s61 offen offset:1024 lds
s_add_u32 m0, s60, 16384
s_add_u32 s61, s61, s53
buffer_load_dwordx4 v26, s[28:31], s61 offen lds
buffer_load_dwordx4 v27, s[28:31], s61 offen offset:1024 lds
s_add_u32 s49, s76, 1
s_and_b32 s49, s49, 3
s_add_u32 s49, s49, 8
s_mul_i32 s49, s49, 393216
buffer_load_dwordx4 v[40:43], v36, s[28:31], s49 offen
s_add_u32 s65, s65, 40960
s_cmp_eq_u32 s65, 122880
s_cselect_b32 s65, 0, s65
s_add_u32 s64, s64, 1
s_waitcnt vmcnt(11)
s_barrier
s_cmp_lg_u32 s88, 0
s_cbranch_scc1 else_4
buffer_load_dwordx4 v[108:111], v18, s[36:39], s83 offen offset:0
buffer_load_dwordx4 v[108:111], v18, s[36:39], s83 offen offset:1024
global_load_dwordx4 v[108:111], v63, s[12:13] offset:-3072
global_load_dwordx4 v[108:111], v63, s[12:13] offset:-2048
global_load_dwordx4 v[108:111], v63, s[12:13] offset:-1024
global_load_dwordx4 v[108:111], v63, s[12:13] offset:0
global_load_dwordx4 v[108:111], v63, s[12:13] offset:1024
global_load_dwordx4 v[108:111], v63, s[12:13] offset:2048
buffer_store_dwordx4 v[56:59], v18, s[32:35], s86 offen offset:0 sc1
buffer_store_dwordx4 v[56:59], v18, s[32:35], s86 offen offset:1024 sc1
buffer_store_dwordx2 v[56:57], v39, s[32:35], s89 offen sc1
buffer_store_dwordx4 v[56:59], v55, s[32:35], 0 offen sc1
else_4:
s_add_u32 s69, s47, 1
s_and_b32 s69, s69, 3
s_add_u32 s69, s69, 4
s_mul_i32 s67, s69, 128
s_mul_i32 s68, s69, s54
s_add_u32 m0, s70, s65
s_nop 0
buffer_load_dwordx4 v20, s[24:27], s67 offen offset:0  lds
buffer_load_dwordx4 v21, s[24:27], s67 offen offset:1024  lds
buffer_load_dwordx4 v22, s[24:27], s67 offen offset:2048  lds
buffer_load_dwordx4 v23, s[24:27], s67 offen offset:3072  lds
s_add_u32 s60, s71, s65
s_add_u32 m0, s60, 0
s_mov_b32 s61, s68
buffer_load_dwordx4 v26, s[28:31], s61 offen lds
buffer_load_dwordx4 v27, s[28:31], s61 offen offset:1024 lds
s_add_u32 m0, s60, 8192
s_add_u32 s61, s61, s53
buffer_load_dwordx4 v26, s[28:31], s61 offen lds
buffer_load_dwordx4 v27, s[28:31], s61 offen offset:1024 lds
s_add_u32 m0, s60, 16384
s_add_u32 s61, s61, s53
buffer_load_dwordx4 v26, s[28:31], s61 offen lds
buffer_load_dwordx4 v27, s[28:31], s61 offen offset:1024 lds
s_add_u32 s49, s76, 1
s_and_b32 s49, s49, 3
s_add_u32 s49, s49, 12
s_mul_i32 s49, s49, 393216
buffer_load_dwordx4 v[40:43], v36, s[28:31], s49 offen
s_add_u32 s65, s65, 40960
s_cmp_eq_u32 s65, 122880
s_cselect_b32 s65, 0, s65
s_add_u32 s64, s64, 1
s_waitcnt vmcnt(11)
s_barrier
s_cmp_lg_u32 s88, 1
s_cbranch_scc1 else_6
buffer_load_dwordx4 v[108:111], v18, s[36:39], s83 offen offset:0
buffer_load_dwordx4 v[108:111], v18, s[36:39], s83 offen offset:1024
global_load_dwordx4 v[108:111], v63, s[12:13] offset:-3072
global_load_dwordx4 v[108:111], v63, s[12:13] offset:-2048
global_load_dwordx4 v[108:111], v63, s[12:13] offset:-1024
global_load_dwordx4 v[108:111], v63, s[12:13] offset:0
global_load_dwordx4 v[108:111], v63, s[12:13] offset:1024
global_load_dwordx4 v[108:111], v63, s[12:13] offset:2048
buffer_store_dwordx4 v[56:59], v18, s[32:35], s86 offen offset:0 sc1
buffer_store_dwordx4 v[56:59], v18, s[32:35], s86 offen offset:1024 sc1
buffer_store_dwordx2 v[56:57], v39, s[32:35], s89 offen sc1
buffer_store_dwordx4 v[56:59], v55, s[32:35], 0 offen sc1
else_6:
s_add_u32 s69, s47, 1
s_and_b32 s69, s69, 3
s_add_u32 s69, s69, 8
s_mul_i32 s67, s69, 128
s_mul_i32 s68, s69, s54
s_add_u32 m0, s70, s65
s_nop 0
buffer_load_dwordx4 v20, s[24:27], s67 offen offset:0  lds
buffer_load_dwordx4 v21, s[24:27], s67 offen offset:1024  lds
buffer_load_dwordx4 v22, s[24:27], s67 offen offset:2048  lds
buffer_load_dwordx4 v23, s[24:27], s67 offen offset:3072  lds
s_add_u32 s60, s71, s65
s_add_u32 m0, s60, 0
s_mov_b32 s61, s68
buffer_load_dwordx4 v26, s[28:31], s61 offen lds
buffer_load_dwordx4 v27, s[28:31], s61 offen offset:1024 lds
s_add_u32 m0, s60, 8192
s_add_u32 s61, s61, s53
buffer_load_dwordx4 v26, s[28:31], s61 offen lds
buffer_load_dwordx4 v27, s[28:31], s61 offen offset:1024 lds
s_add_u32 m0, s60, 16384
s_add_u32 s61, s61, s53
buffer_load_dwordx4 v26, s[28:31], s61 offen lds
buffer_load_dwordx4 v27, s[28:31], s61 offen offset:1024 lds
s_add_u32 s49, s76, 2
s_and_b32 s49, s49, 3
s_add_u32 s49, s49, 0
s_mul_i32 s49, s49, 393216
buffer_load_dwordx4 v[40:43], v36, s[28:31], s49 offen
s_add_u32 s65, s65, 40960
s_cmp_eq_u32 s65, 122880
s_cselect_b32 s65, 0, s65
s_add_u32 s64, s64, 1
s_waitcnt vmcnt(11)
s_barrier
s_cmp_lg_u32 s88, 2
s_cbranch_scc1 else_8
buffer_load_dwordx4 v[108:111], v18, s[36:39], s83 offen offset:0
buffer_load_dwordx4 v[108:111], v18, s[36:39], s83 offen offset:1024
global_load_dwordx4 v[108:111], v63, s[12:13] offset:-3072
global_load_dwordx4 v[108:111], v63, s[12:13] offset:-2048
global_load_dwordx4 v[108:111], v63, s[12:13] offset:-1024
global_load_dwordx4 v[108:111], v63, s[12:13] offset:0
global_load_dwordx4 v[108:111], v63, s[12:13] offset:1024
global_load_dwordx4 v[108:111], v63, s[12:13] offset:2048
buffer_store_dwordx4 v[56:59], v18, s[32:35], s86 offen offset:0 sc1
buffer_store_dwordx4 v[56:59], v18, s[32:35], s86 offen offset:1024 sc1
buffer_store_dwordx2 v[56:57], v39, s[32:35], s89 offen sc1
buffer_store_dwordx4 v[56:59], v55, s[32:35], 0 offen sc1
else_8:
s_add_u32 s69, s47, 1
s_and_b32 s69, s69, 3
s_add_u32 s69, s69, 12
s_mul_i32 s67, s69, 128
s_mul_i32 s68, s69, s54
s_add_u32 m0, s70, s65
s_nop 0
buffer_load_dwordx4 v20, s[24:27], s67 offen offset:0  lds
buffer_load_dwordx4 v21, s[24:27], s67 offen offset:1024  lds
buffer_load_dwordx4 v22, s[24:27], s67 offen offset:2048  lds
buffer_load_dwordx4 v23, s[24:27], s67 offen offset:3072  lds
s_add_u32 s60, s71, s65
s_add_u32 m0, s60, 0
s_mov_b32 s61, s68
buffer_load_dwordx4 v26, s[28:31], s61 offen lds
buffer_load_dwordx4 v27, s[28:31], s61 offen offset:1024 lds
s_add_u32 m0, s60, 8192
s_add_u32 s61, s61, s53
buffer_load_dwordx4 v26, s[28:31], s61 offen lds
buffer_load_dwordx4 v27, s[28:31], s61 offen offset:1024 lds
s_add_u32 m0, s60, 16384
s_add_u32 s61, s61, s53
buffer_load_dwordx4 v26, s[28:31], s61 offen lds
buffer_load_dwordx4 v27, s[28:31], s61 offen offset:1024 lds
s_add_u32 s49, s76, 2
s_and_b32 s49, s49, 3
s_add_u32 s49, s49, 4
s_mul_i32 s49, s49, 393216
buffer_load_dwordx4 v[40:43], v36, s[28:31], s49 offen
s_add_u32 s65, s65, 40960
s_cmp_eq_u32 s65, 122880
s_cselect_b32 s65, 0, s65
s_add_u32 s64, s64, 1
s_waitcnt vmcnt(11)
s_barrier
s_cmp_lg_u32 s88, 3
s_cbranch_scc1 else_10
buffer_load_dwordx4 v[108:111], v18, s[36:39], s83 offen offset:0
buffer_load_dwordx4 v[108:111], v18, s[36:39], s83 offen offset:1024
global_load_dwordx4 v[108:111], v63, s[12:13] offset:-3072
global_load_dwordx4 v[108:111], v63, s[12:13] offset:-2048
global_load_dwordx4 v[108:111], v63, s[12:13] offset:-1024
global_load_dwordx4 v[108:111], v63, s[12:13] offset:0
global_load_dwordx4 v[108:111], v63, s[12:13] offset:1024
global_load_dwordx4 v[108:111], v63, s[12:13] offset:2048
buffer_store_dwordx4 v[56:59], v18, s[32:35], s86 offen offset:0 sc1
buffer_store_dwordx4 v[56:59], v18, s[32:35], s86 offen offset:1024 sc1
buffer_store_dwordx2 v[56:57], v39, s[32:35], s89 offen sc1
buffer_store_dwordx4 v[56:59], v55, s[32:35], 0 offen sc1
else_10:
s_add_u32 s69, s47, 2
s_and_b32 s69, s69, 3
s_add_u32 s69, s69, 0
s_mul_i32 s67, s69, 128
s_mul_i32 s68, s69, s54
s_add_u32 m0, s70, s65
s_nop 0
buffer_load_dwordx4 v20, s[24:27], s67 offen offset:0  lds
buffer_load_dwordx4 v21, s[24:27], s67 offen offset:1024  lds
buffer_load_dwordx4 v22, s[24:27], s67 offen offset:2048  lds
buffer_load_dwordx4 v23, s[24:27], s67 offen offset:3072  lds
s_add_u32 s60, s71, s65
s_add_u32 m0, s60, 0
s_mov_b32 s61, s68
buffer_load_dwordx4 v26, s[28:31], s61 offen lds
buffer_load_dwordx4 v27, s[28:31], s61 offen offset:1024 lds
s_add_u32 m0, s60, 8192
s_add_u32 s61, s61, s53
buffer_load_dwordx4 v26, s[28:31], s61 offen lds
buffer_load_dwordx4 v27, s[28:31], s61 offen offset:1024 lds
s_add_u32 m0, s60, 16384
s_add_u32 s61, s61, s53
buffer_load_dwordx4 v26, s[28:31], s61 offen lds
buffer_load_dwordx4 v27, s[28:31], s61 offen offset:1024 lds
s_add_u32 s49, s76, 2
s_and_b32 s49, s49, 3
s_add_u32 s49, s49, 8
s_mul_i32 s49, s49, 393216
buffer_load_dwordx4 v[40:43], v36, s[28:31], s49 offen
s_add_u32 s65, s65, 40960
s_cmp_eq_u32 s65, 122880
s_cselect_b32 s65, 0, s65
s_add_u32 s64, s64, 1
s_waitcnt vmcnt(11)
s_barrier
s_cmp_lg_u32 s88, 4
s_cbranch_scc1 else_12
buffer_load_dwordx4 v[108:111], v18, s[36:39], s83 offen offset:0
buffer_load_dwordx4 v[108:111], v18, s[36:39], s83 offen offset:1024
global_load_dwordx4 v[108:111], v63, s[12:13] offset:-3072
global_load_dwordx4 v[108:111], v63, s[12:13] offset:-2048
global_load_dwordx4 v[108:111], v63, s[12:13] offset:-1024
global_load_dwordx4 v[108:111], v63, s[12:13] offset:0
global_load_dwordx4 v[108:111], v63, s[12:13] offset:1024
global_load_dwordx4 v[108:111], v63, s[12:13] offset:2048
buffer_store_dwordx4 v[56:59], v18, s[32:35], s86 offen offset:0 sc1
buffer_store_dwordx4 v[56:59], v18, s[32:35], s86 offen offset:1024 sc1
buffer_store_dwordx2 v[56:57], v39, s[32:35], s89 offen sc1
buffer_store_dwordx4 v[56:59], v55, s[32:35], 0 offen sc1
else_12:
s_add_u32 s69, s47, 2
s_and_b32 s69, s69, 3
s_add_u32 s69, s69, 4
s_mul_i32 s67, s69, 128
s_mul_i32 s68, s69, s54
s_add_u32 m0, s70, s65
s_nop 0
buffer_load_dwordx4 v20, s[24:27], s67 offen offset:0  lds
buffer_load_dwordx4 v21, s[24:27], s67 offen offset:1024  lds
buffer_load_dwordx4 v22, s[24:27], s67 offen offset:2048  lds
buffer_load_dwordx4 v23, s[24:27], s67 offen offset:3072  lds
s_add_u32 s60, s71, s65
s_add_u32 m0, s60, 0
s_mov_b32 s61, s68
buffer_load_dwordx4 v26, s[28:31], s61 offen lds
buffer_load_dwordx4 v27, s[28:31], s61 offen offset:1024 lds
s_add_u32 m0, s60, 8192
s_add_u32 s61, s61, s53
buffer_load_dwordx4 v26, s[28:31], s61 offen lds
buffer_load_dwordx4 v27, s[28:31], s61 offen offset:1024 lds
s_add_u32 m0, s60, 16384
s_add_u32 s61, s61, s53
buffer_load_dwordx4 v26, s[28:31], s61 offen lds
buffer_load_dwordx4 v27, s[28:31], s61 offen offset:1024 lds
s_add_u32 s49, s76, 2
s_and_b32 s49, s49, 3
s_add_u32 s49, s49, 12
s_mul_i32 s49, s49, 393216
buffer_load_dwordx4 v[40:43], v36, s[28:31], s49 offen
s_add_u32 s65, s65, 40960
s_cmp_eq_u32 s65, 122880
s_cselect_b32 s65, 0, s65
s_add_u32 s64, s64, 1
s_waitcnt vmcnt(11)
s_barrier
s_cmp_lg_u32 s88, 5
s_cbranch_scc1 else_14
buffer_load_dwordx4 v[108:111], v18, s[36:39], s83 offen offset:0
buffer_load_dwordx4 v[108:111], v18, s[36:39], s83 offen offset:1024
global_load_dwordx4 v[108:111], v63, s[12:13] offset:-3072
global_load_dwordx4 v[108:111], v63, s[12:13] offset:-2048
global_load_dwordx4 v[108:111], v63, s[12:13] offset:-1024
global_load_dwordx4 v[108:111], v63, s[12:13] offset:0
global_load_dwordx4 v[108:111], v63, s[12:13] offset:1024
global_load_dwordx4 v[108:111], v63, s[12:13] offset:2048
buffer_store_dwordx4 v[56:59], v18, s[32:35], s86 offen offset:0 sc1
buffer_store_dwordx4 v[56:59], v18, s[32:35], s86 offen offset:1024 sc1
buffer_store_dwordx2 v[56:57], v39, s[32:35], s89 offen sc1
buffer_store_dwordx4 v[56:59], v55, s[32:35], 0 offen sc1
else_14:
s_add_u32 s69, s47, 2
s_and_b32 s69, s69, 3
s_add_u32 s69, s69, 8
s_mul_i32 s67, s69, 128
s_mul_i32 s68, s69, s54
s_add_u32 m0, s70, s65
s_nop 0
buffer_load_dwordx4 v20, s[24:27], s67 offen offset:0  lds
buffer_load_dwordx4 v21, s[24:27], s67 offen offset:1024  lds
buffer_load_dwordx4 v22, s[24:27], s67 offen offset:2048  lds
buffer_load_dwordx4 v23, s[24:27], s67 offen offset:3072  lds
s_add_u32 s60, s71, s65
s_add_u32 m0, s60, 0
s_mov_b32 s61, s68
buffer_load_dwordx4 v26, s[28:31], s61 offen lds
buffer_load_dwordx4 v27, s[28:31], s61 offen offset:1024 lds
s_add_u32 m0, s60, 8192
s_add_u32 s61, s61, s53
buffer_load_dwordx4 v26, s[28:31], s61 offen lds
buffer_load_dwordx4 v27, s[28:31], s61 offen offset:1024 lds
s_add_u32 m0, s60, 16384
s_add_u32 s61, s61, s53
buffer_load_dwordx4 v26, s[28:31], s61 offen lds
buffer_load_dwordx4 v27, s[28:31], s61 offen offset:1024 lds
s_add_u32 s49, s76, 3
s_and_b32 s49, s49, 3
s_add_u32 s49, s49, 0
s_mul_i32 s49, s49, 393216
buffer_load_dwordx4 v[40:43], v36, s[28:31], s49 offen
s_add_u32 s65, s65, 40960
s_cmp_eq_u32 s65, 122880
s_cselect_b32 s65, 0, s65
s_add_u32 s64, s64, 1
s_waitcnt vmcnt(11)
s_barrier
s_cmp_lg_u32 s88, 6
s_cbranch_scc1 else_16
buffer_load_dwordx4 v[108:111], v18, s[36:39], s83 offen offset:0
buffer_load_dwordx4 v[108:111], v18, s[36:39], s83 offen offset:1024
global_load_dwordx4 v[108:111], v63, s[12:13] offset:-3072
global_load_dwordx4 v[108:111], v63, s[12:13] offset:-2048
global_load_dwordx4 v[108:111], v63, s[12:13] offset:-1024
global_load_dwordx4 v[108:111], v63, s[12:13] offset:0
global_load_dwordx4 v[108:111], v63, s[12:13] offset:1024
global_load_dwordx4 v[108:111], v63, s[12:13] offset:2048
buffer_store_dwordx4 v[56:59], v18, s[32:35], s86 offen offset:0 sc1
buffer_store_dwordx4 v[56:59], v18, s[32:35], s86 offen offset:1024 sc1
buffer_store_dwordx2 v[56:57], v39, s[32:35], s89 offen sc1
buffer_store_dwordx4 v[56:59], v55, s[32:35], 0 offen sc1
else_16:
s_add_u32 s69, s47, 2
s_and_b32 s69, s69, 3
s_add_u32 s69, s69, 12
s_mul_i32 s67, s69, 128
s_mul_i32 s68, s69, s54
s_add_u32 m0, s70, s65
s_nop 0
buffer_load_dwordx4 v20, s[24:27], s67 offen offset:0  lds
buffer_load_dwordx4 v21, s[24:27], s67 offen offset:1024  lds
buffer_load_dwordx4 v22, s[24:27], s67 offen offset:2048  lds
buffer_load_dwordx4 v23, s[24:27], s67 offen offset:3072  lds
s_add_u32 s60, s71, s65
s_add_u32 m0, s60, 0
s_mov_b32 s61, s68
buffer_load_dwordx4 v26, s[28:31], s61 offen lds
buffer_load_dwordx4 v27, s[28:31], s61 offen offset:1024 lds
s_add_u32 m0, s60, 8192
s_add_u32 s61, s61, s53
buffer_load_dwordx4 v26, s[28:31], s61 offen lds
buffer_load_dwordx4 v27, s[28:31], s61 offen offset:1024 lds
s_add_u32 m0, s60, 16384
s_add_u32 s61, s61, s53
buffer_load_dwordx4 v26, s[28:31], s61 offen lds
buffer_load_dwordx4 v27, s[28:31], s61 offen offset:1024 lds
s_add_u32 s49, s76, 3
s_and_b32 s49, s49, 3
s_add_u32 s49, s49, 4
s_mul_i32 s49, s49, 393216
buffer_load_dwordx4 v[40:43], v36, s[28:31], s49 offen
s_add_u32 s65, s65, 40960
s_cmp_eq_u32 s65, 122880
s_cselect_b32 s65, 0, s65
s_add_u32 s64, s64, 1
s_waitcnt vmcnt(11)
s_barrier
s_cmp_lg_u32 s88, 7
s_cbranch_scc1 else_18
buffer_load_dwordx4 v[108:111], v18, s[36:39], s83 offen offset:0
buffer_load_dwordx4 v[108:111], v18, s[36:39], s83 offen offset:1024
global_load_dwordx4 v[108:111], v63, s[12:13] offset:-3072
global_load_dwordx4 v[108:111], v63, s[12:13] offset:-2048
global_load_dwordx4 v[108:111], v63, s[12:13] offset:-1024
global_load_dwordx4 v[108:111], v63, s[12:13] offset:0
global_load_dwordx4 v[108:111], v63, s[12:13] offset:1024
global_load_dwordx4 v[108:111], v63, s[12:13] offset:2048
buffer_store_dwordx4 v[56:59], v18, s[32:35], s86 offen offset:0 sc1
buffer_store_dwordx4 v[56:59], v18, s[32:35], s86 offen offset:1024 sc1
buffer_store_dwordx2 v[56:57], v39, s[32:35], s89 offen sc1
buffer_store_dwordx4 v[56:59], v55, s[32:35], 0 offen sc1
else_18:
s_add_u32 s69, s47, 3
s_and_b32 s69, s69, 3
s_add_u32 s69, s69, 0
s_mul_i32 s67, s69, 128
s_mul_i32 s68, s69, s54
s_add_u32 m0, s70, s65
s_nop 0
buffer_load_dwordx4 v20, s[24:27], s67 offen offset:0  lds
buffer_load_dwordx4 v21, s[24:27], s67 offen offset:1024  lds
buffer_load_dwordx4 v22, s[24:27], s67 offen offset:2048  lds
buffer_load_dwordx4 v23, s[24:27], s67 offen offset:3072  lds
s_add_u32 s60, s71, s65
s_add_u32 m0, s60, 0
s_mov_b32 s61, s68
buffer_load_dwordx4 v26, s[28:31], s61 offen lds
buffer_load_dwordx4 v27, s[28:31], s61 offen offset:1024 lds
s_add_u32 m0, s60, 8192
s_add_u32 s61, s61, s53
buffer_load_dwordx4 v26, s[28:31], s61 offen lds
buffer_load_dwordx4 v27, s[28:31], s61 offen offset:1024 lds
s_add_u32 m0, s60, 16384
s_add_u32 s61, s61, s53
buffer_load_dwordx4 v26, s[28:31], s61 offen lds
buffer_load_dwordx4 v27, s[28:31], s61 offen offset:1024 lds
s_add_u32 s49, s76, 3
s_and_b32 s49, s49, 3
s_add_u32 s49, s49, 8
s_mul_i32 s49, s49, 393216
buffer_load_dwordx4 v[40:43], v36, s[28:31], s49 offen
s_add_u32 s65, s65, 40960
s_cmp_eq_u32 s65, 122880
s_cselect_b32 s65, 0, s65
s_add_u32 s64, s64, 1
s_waitcnt vmcnt(11)
s_barrier
s_add_u32 s69, s47, 3
s_and_b32 s69, s69, 3
s_add_u32 s69, s69, 4
s_mul_i32 s67, s69, 128
s_mul_i32 s68, s69, s54
s_add_u32 m0, s70, s65
s_nop 0
buffer_load_dwordx4 v20, s[24:27], s67 offen offset:0  lds
buffer_load_dwordx4 v21, s[24:27], s67 offen offset:1024  lds
buffer_load_dwordx4 v22, s[24:27], s67 offen offset:2048  lds
buffer_load_dwordx4 v23, s[24:27], s67 offen offset:3072  lds
s_add_u32 s60, s71, s65
s_add_u32 m0, s60, 0
s_mov_b32 s61, s68
buffer_load_dwordx4 v26, s[28:31], s61 offen lds
buffer_load_dwordx4 v27, s[28:31], s61 offen offset:1024 lds
s_add_u32 m0, s60, 8192
s_add_u32 s61, s61, s53
buffer_load_dwordx4 v26, s[28:31], s61 offen lds
buffer_load_dwordx4 v27, s[28:31], s61 offen offset:1024 lds
s_add_u32 m0, s60, 16384
s_add_u32 s61, s61, s53
buffer_load_dwordx4 v26, s[28:31], s61 offen lds
buffer_load_dwordx4 v27, s[28:31], s61 offen offset:1024 lds
s_add_u32 s49, s76, 3
s_and_b32 s49, s49, 3
s_add_u32 s49, s49, 12
s_mul_i32 s49, s49, 393216
buffer_load_dwordx4 v[40:43], v36, s[28:31], s49 offen
s_add_u32 s65, s65, 40960
s_cmp_eq_u32 s65, 122880
s_cselect_b32 s65, 0, s65
s_add_u32 s64, s64, 1
s_waitcnt vmcnt(11)
s_barrier
global_load_dwordx2 v[34:35], v32, s[20:21] sc1
s_add_u32 s69, s47, 3
s_and_b32 s69, s69, 3
s_add_u32 s69, s69, 8
s_mul_i32 s67, s69, 128
s_mul_i32 s68, s69, s54
s_add_u32 m0, s70, s65
s_nop 0
buffer_load_dwordx4 v20, s[24:27], s67 offen offset:0  lds
buffer_load_dwordx4 v21, s[24:27], s67 offen offset:1024  lds
buffer_load_dwordx4 v22, s[24:27], s67 offen offset:2048  lds
buffer_load_dwordx4 v23, s[24:27], s67 offen offset:3072  lds
s_add_u32 s60, s71, s65
s_add_u32 m0, s60, 0
s_mov_b32 s61, s68
buffer_load_dwordx4 v26, s[28:31], s61 offen lds
buffer_load_dwordx4 v27, s[28:31], s61 offen offset:1024 lds
s_add_u32 m0, s60, 8192
s_add_u32 s61, s61, s53
buffer_load_dwordx4 v26, s[28:31], s61 offen lds
buffer_load_dwordx4 v27, s[28:31], s61 offen offset:1024 lds
s_add_u32 m0, s60, 16384
s_add_u32 s61, s61, s53
buffer_load_dwordx4 v26, s[28:31], s61 offen lds
buffer_load_dwordx4 v27, s[28:31], s61 offen offset:1024 lds
s_add_u32 s65, s65, 40960
s_cmp_eq_u32 s65, 122880
s_cselect_b32 s65, 0, s65
s_add_u32 s64, s64, 1
s_waitcnt vmcnt(10)
s_barrier
s_mov_b32 s63, 0
ipoll_20:
v_sad_u8 v4, v34, 0, 0
v_sad_u8 v4, v35, 0, v4
v_cmp_gt_u32 vcc, 32, v4
s_cbranch_vccz ipolled_21
global_load_dwordx2 v[34:35], v32, s[20:21] sc1
s_add_u32 s63, s63, 1
s_cmp_lt_u32 s63, 0x80000
s_waitcnt vmcnt(0)
s_cbranch_scc1 ipoll_20
ipolled_21:
s_add_u32 s69, s47, 3
s_and_b32 s69, s69, 3
s_add_u32 s69, s69, 12
s_mul_i32 s67, s69, 128
s_mul_i32 s68, s69, s54
s_add_u32 m0, s70, 0
s_nop 0
buffer_load_dwordx4 v20, s[24:27], s67 offen offset:0  lds
buffer_load_dwordx4 v21, s[24:27], s67 offen offset:1024  lds
buffer_load_dwordx4 v22, s[24:27], s67 offen offset:2048  lds
buffer_load_dwordx4 v23, s[24:27], s67 offen offset:3072  lds
s_add_u32 s60, s71, 0
s_add_u32 m0, s60, 0
s_mov_b32 s61, s68
buffer_load_dwordx4 v26, s[28:31], s61 offen lds
buffer_load_dwordx4 v27, s[28:31], s61 offen offset:1024 lds
s_add_u32 m0, s60, 8192
s_add_u32 s61, s61, s53
buffer_load_dwordx4 v26, s[28:31], s61 offen lds
buffer_load_dwordx4 v27, s[28:31], s61 offen offset:1024 lds
s_add_u32 m0, s60, 16384
s_add_u32 s61, s61, s53
buffer_load_dwordx4 v26, s[28:31], s61 offen lds
buffer_load_dwordx4 v27, s[28:31], s61 offen offset:1024 lds
s_waitcnt vmcnt(10)
s_barrier
s_setprio 0
buffer_load_dwordx4 v[240:243], v15, s[36:39], 0 offen offset:0
buffer_load_dwordx4 v[240:243], v15, s[36:39], 0 offen offset:1024
buffer_load_dwordx4 v[80:83], v37, s[32:35], 0 offen offset:0 sc1
buffer_load_dwordx4 v[84:87], v37, s[32:35], 0 offen offset:1024 sc1
buffer_load_dwordx4 v[88:91], v37, s[32:35], 0 offen offset:2048 sc1
buffer_load_dwordx4 v[92:95], v37, s[32:35], 0 offen offset:3072 sc1
global_load_dword v48, v54, s[98:99]
buffer_load_dwordx4 v[64:67], v38, s[32:35], 0 offen offset:0 sc1
buffer_load_dwordx4 v[68:71], v38, s[32:35], 0 offen offset:1024 sc1
buffer_load_dwordx4 v[72:75], v38, s[32:35], 0 offen offset:2048 sc1
buffer_load_dwordx4 v[76:79], v38, s[32:35], 0 offen offset:3072 sc1
s_add_u32 s48, s75, 15
s_and_b32 s48, s48, 15
s_mul_i32 s48, s48, s57
s_add_u32 m0, s71, 106496
s_nop 0
buffer_load_dwordx4 v28, s[36:39], s48 offen lds
buffer_load_dwordx4 v29, s[36:39], s48 offen offset:1024 lds
s_waitcnt vmcnt(13)
s_barrier
s_add_u32 s48, s75, 5
s_and_b32 s48, s48, 15
s_mul_i32 s48, s48, s57
s_add_u32 m0, s71, 24576
s_nop 0
buffer_load_dwordx4 v28, s[36:39], s48 offen lds
buffer_load_dwordx4 v29, s[36:39], s48 offen offset:1024 lds
s_waitcnt vmcnt(4)
s_add_u32 s48, s75, 6
s_and_b32 s48, s48, 15
s_mul_i32 s48, s48, s57
s_add_u32 m0, s71, 32768
s_nop 0
buffer_load_dwordx4 v28, s[36:39], s48 offen lds
v_add_f32 v80, v80, v88
v_add_f32 v64, v64, v72
v_add_f32 v81, v81, v89
v_add_f32 v65, v65, v73
v_add_f32 v82, v82, v90
v_add_f32 v66, v66, v74
v_add_f32 v83, v83, v91
v_add_f32 v67, v67, v75
v_add_f32 v84, v84, v92
v_add_f32 v68, v68, v76
buffer_load_dwordx4 v29, s[36:39], s48 offen offset:1024 lds
v_add_f32 v85, v85, v93
v_add_f32 v69, v69, v77
v_add_f32 v86, v86, v94
v_add_f32 v70, v70, v78
v_add_f32 v87, v87, v95
v_add_f32 v71, v71, v79
v_add_f32 v80, v80, v84
v_add_f32 v64, v64, v68
v_add_f32 v81, v81, v85
v_add_f32 v65, v65, v69
s_add_u32 s48, s75, 7
s_and_b32 s48, s48, 15
s_mul_i32 s48, s48, s57
s_add_u32 m0, s71, 40960
s_nop 0
buffer_load_dwordx4 v28, s[36:39], s48 offen lds
v_add_f32 v82, v82, v86
v_add_f32 v66, v66, v70
v_add_f32 v83, v83, v87
v_add_f32 v67, v67, v71
s_nop 1
s_nop 1
v_permlane32_swap_b32 v80, v81
v_permlane32_swap_b32 v64, v65
v_permlane32_swap_b32 v82, v83
buffer_load_dwordx4 v29, s[36:39], s48 offen offset:1024 lds
v_permlane32_swap_b32 v66, v67
v_add_f32 v80, v80, v81
v_add_f32 v64, v64, v65
v_add_f32 v82, v82, v83
v_add_f32 v66, v66, v67
s_nop 1
s_nop 1
v_permlane16_swap_b32 v80, v82
v_permlane16_swap_b32 v64, v66
s_nop 0
s_add_u32 s48, s75, 8
s_and_b32 s48, s48, 15
s_mul_i32 s48, s48, s57
s_add_u32 m0, s71, 49152
s_nop 0
buffer_load_dwordx4 v28, s[36:39], s48 offen lds
s_nop 0
v_add_f32 v80, v80, v82
v_add_f32 v64, v64, v66
v_cmp_u_f32 vcc, v80, v80
s_cbranch_vccnz again_22
summed_23:
v_cmp_u_f32 vcc, v64, v64
s_cbranch_vccnz again_25
summed_26:
v_mul_f32 v44, 0x3a800000, v80
ds_write_b32 v53, v64
v_mov_b32 v45, v44
s_nop 1
v_permlane16_swap_b32 v44, v45
buffer_load_dwordx4 v29, s[36:39], s48 offen offset:1024 lds
s_nop 0
v_fma_f32 v45, -v44, v44, v45
v_max_f32 v45, 0, v45
v_add_f32 v45, 0x3727c5ac, v45
v_rsq_f32 v46, v45
v_sub_f32 v47, 0, v44
ds_write_b32 v50, v47 offset:512
ds_write_b64 v49, v[46:47]
ds_write_b32 v50, v46
s_cmp_lg_u32 s43, 2
s_cbranch_scc1 else_28
s_and_b32 s50, s2, 7
v_readlane_b32 s58, v34, s50
v_readlane_b32 s59, v35, s50
s_lshl_b64 s[48:49], s[94:95], 5
v_mov_b32 v4, 134656
s_nop 1
s_cmp_eq_u64 s[48:49], s[58:59]
s_cselect_b32 s48, 1, 0
v_mov_b32 v5, s48
ds_write_b32 v4, v5
else_28:
s_setprio 0
s_waitcnt lgkmcnt(0)
s_waitcnt vmcnt(63)
s_barrier
s_waitcnt vmcnt(5)
s_add_u32 s48, s75, 9
s_and_b32 s48, s48, 15
s_mul_i32 s48, s48, s57
s_add_u32 m0, s71, 57344
s_nop 0
buffer_load_dwordx4 v28, s[36:39], s48 offen lds
buffer_load_dwordx4 v29, s[36:39], s48 offen offset:1024 lds
s_waitcnt vmcnt(5)
s_add_u32 s48, s75, 10
s_and_b32 s48, s48, 15
s_mul_i32 s48, s48, s57
s_add_u32 m0, s71, 65536
s_nop 0
buffer_load_dwordx4 v28, s[36:39], s48 offen lds
buffer_load_dwordx4 v29, s[36:39], s48 offen offset:1024 lds
s_waitcnt vmcnt(5)
s_add_u32 s48, s75, 11
s_and_b32 s48, s48, 15
s_mul_i32 s48, s48, s57
s_add_u32 m0, s71, 73728
s_nop 0
buffer_load_dwordx4 v28, s[36:39], s48 offen lds
buffer_load_dwordx4 v29, s[36:39], s48 offen offset:1024 lds
s_waitcnt vmcnt(5)
s_add_u32 s48, s75, 12
s_and_b32 s48, s48, 15
s_mul_i32 s48, s48, s57
s_add_u32 m0, s71, 81920
s_nop 0
buffer_load_dwordx4 v28, s[36:39], s48 offen lds
buffer_load_dwordx4 v29, s[36:39], s48 offen offset:1024 lds
s_waitcnt vmcnt(5)
s_add_u32 s48, s75, 13
s_and_b32 s48, s48, 15
s_mul_i32 s48, s48, s57
s_add_u32 m0, s71, 90112
s_nop 0
buffer_load_dwordx4 v28, s[36:39], s48 offen lds
buffer_load_dwordx4 v29, s[36:39], s48 offen offset:1024 lds
s_waitcnt vmcnt(5)
s_add_u32 s48, s75, 14
s_and_b32 s48, s48, 15
s_mul_i32 s48, s48, s57
s_add_u32 m0, s71, 98304
s_nop 0
buffer_load_dwordx4 v28, s[36:39], s48 offen lds
buffer_load_dwordx4 v29, s[36:39], s48 offen offset:1024 lds
s_waitcnt vmcnt(5)
s_add_u32 s48, s75, 0
s_and_b32 s48, s48, 15
s_mul_i32 s48, s48, s57
s_add_u32 m0, s71, 4294950912
s_nop 0
buffer_load_dwordx4 v28, s[36:39], s48 offen lds
buffer_load_dwordx4 v29, s[36:39], s48 offen offset:1024 lds
s_waitcnt vmcnt(5)
s_add_u32 s48, s75, 1
s_and_b32 s48, s48, 15
s_mul_i32 s48, s48, s57
s_add_u32 m0, s71, 4294959104
s_nop 0
buffer_load_dwordx4 v28, s[36:39], s48 offen lds
buffer_load_dwordx4 v29, s[36:39], s48 offen offset:1024 lds
s_waitcnt vmcnt(5)
s_add_u32 s48, s75, 2
s_and_b32 s48, s48, 15
s_mul_i32 s48, s48, s57
s_add_u32 m0, s71, 0
s_nop 0
buffer_load_dwordx4 v28, s[36:39], s48 offen lds
buffer_load_dwordx4 v29, s[36:39], s48 offen offset:1024 lds
s_waitcnt vmcnt(5)
s_add_u32 s48, s75, 3
s_and_b32 s48, s48, 15
s_mul_i32 s48, s48, s57
s_add_u32 m0, s71, 8192
s_nop 0
buffer_load_dwordx4 v28, s[36:39], s48 offen lds
buffer_load_dwordx4 v29, s[36:39], s48 offen offset:1024 lds
s_waitcnt vmcnt(5)
s_add_u32 s48, s75, 4
s_and_b32 s48, s48, 15
s_mul_i32 s48, s48, s57
s_add_u32 m0, s71, 16384
s_nop 0
buffer_load_dwordx4 v28, s[36:39], s48 offen lds
buffer_load_dwordx4 v29, s[36:39], s48 offen offset:1024 lds
s_mov_b32 s28, s12
s_and_b32 s29, s13, 0xffff
s_mov_b32 s30, 6291456
s_mov_b32 s31, 0x00020000
v_mov_b32 v26, v60
v_mov_b32 v27, v61
v_mov_b32 v28, v24
v_mov_b32 v29, v25
s_cmp_ge_i32 s55, 0
s_cselect_b32 s53, 128, s53
s_cselect_b32 s54, 24576, s54
s_cmp_ge_i32 s56, 0
s_cselect_b32 s57, 8192, s57
s_and_b32 s48, s2, 7
s_add_u32 s47, s42, s48
s_and_b32 s47, s47, 7
s_mul_i32 s47, s47, 2
s_and_b32 s50, s42, 8
s_or_b32 s50, s50, 3
s_and_b32 s48, s2, 7
s_add_u32 s76, s50, s48
s_and_b32 s76, s76, 7
s_mul_i32 s76, s76, 2
s_add_u32 s69, s47, 0
s_and_b32 s69, s69, 15
s_mul_i32 s67, s69, 128
s_mul_i32 s68, s69, s54
s_waitcnt vmcnt(0) lgkmcnt(0)
s_barrier
s_add_u32 s60, s71, 122880
s_add_u32 m0, s60, 0
s_mov_b32 s61, s68
buffer_load_dwordx4 v26, s[28:31], s61 offen lds
buffer_load_dwordx4 v27, s[28:31], s61 offen offset:1024 lds
s_add_u32 m0, s60, 8192
s_add_u32 s61, s61, s53
buffer_load_dwordx4 v26, s[28:31], s61 offen lds
buffer_load_dwordx4 v27, s[28:31], s61 offen offset:1024 lds
s_add_u32 m0, s60, 16384
s_add_u32 s61, s61, s53
buffer_load_dwordx4 v26, s[28:31], s61 offen lds
buffer_load_dwordx4 v27, s[28:31], s61 offen offset:1024 lds
s_mov_b32 s36, s14
s_and_b32 s37, s15, 0xffff
s_mov_b32 s38, 65536
s_mov_b32 s39, 0x00020000
s_lshl_b32 s48, s42, 12
s_lshl_b32 s49, s43, 10
s_add_u32 s48, s48, s49
s_add_u32 m0, s49, 135168
s_nop 0
buffer_load_dwordx4 v18, s[36:39], s48 offen lds
ds_read_b128 v[232:235], v52 offset:57344
ds_read_b128 v[236:239], v52 offset:58368
ds_read_b128 v[152:155], v51 offset:40960
ds_read_b128 v[156:159], v51 offset:41984
ds_read_b128 v[160:163], v51 offset:49152
ds_read_b128 v[164:167], v51 offset:50176
ds_read_b128 v[168:171], v51 offset:57344
ds_read_b128 v[172:175], v51 offset:58368
ds_read_b128 v[176:179], v52 offset:0
ds_read_b128 v[180:183], v52 offset:1024
ds_read_b128 v[184:187], v52 offset:8192
ds_read_b128 v[188:191], v52 offset:9216
ds_read_b128 v[192:195], v52 offset:16384
ds_read_b128 v[196:199], v52 offset:17408
ds_read_b128 v[200:203], v52 offset:24576
ds_read_b128 v[204:207], v52 offset:25600
ds_read_b128 v[208:211], v52 offset:32768
ds_read_b128 v[212:215], v52 offset:33792
ds_read_b128 v[216:219], v52 offset:40960
ds_read_b128 v[220:223], v52 offset:41984
ds_read_b128 v[224:227], v52 offset:49152
ds_read_b128 v[228:231], v52 offset:50176
ds_read_b128 v[112:115], v51 offset:0
ds_read_b128 v[116:119], v51 offset:1024
ds_read_b128 v[120:123], v51 offset:8192
ds_read_b128 v[124:127], v51 offset:9216
ds_read_b128 v[128:131], v51 offset:16384
ds_read_b128 v[132:135], v51 offset:17408
ds_read_b128 v[136:139], v51 offset:24576
ds_read_b128 v[140:143], v51 offset:25600
ds_read_b128 v[144:147], v51 offset:32768
ds_read_b128 v[148:151], v51 offset:33792
s_add_u32 s48, s80, 0
v_add_u32 v20, s48, v18
v_mov_b32 v21, v20
v_add_u32 v22, 30720, v20
v_mov_b32 v23, v22
v_add_u32 v37, 262144, v37
s_lshl_b32 s50, s42, 2
s_add_u32 s50, s50, s43
s_lshl_b32 s50, s50, 12
s_add_u32 s50, s50, 18087936
v_add_u32 v38, s50, v18
v_min_u32 v4, 2, v3
v_lshlrev_b32 v4, 8, v4
v_lshl_add_u32 v4, v2, 2, v4
s_and_b32 s48, s43, 1
s_lshl_b32 s48, s48, 7
s_lshr_b32 s49, s43, 1
s_lshl_b32 s49, s49, 6
s_add_u32 s48, s48, s49
s_add_u32 s48, s48, 133888
v_add_u32 v53, s48, v4
s_getpc_b64 s[98:99]
pc_30:
s_add_u32 s98, s98, c1_last - pc_30
s_addc_u32 s99, s99, 0
s_lshr_b32 s50, s2, 3
s_lshl_b32 s50, s50, 2
s_add_u32 s50, s50, s43
s_lshl_b32 s50, s50, 7
v_and_b32 v4, 1, v0
v_lshl_add_u32 v4, v4, 6, s50
v_min_u32 v54, L_code_end - c1_last, v4
s_waitcnt vmcnt(0) lgkmcnt(0)
s_add_u32 s69, s47, 1
s_and_b32 s69, s69, 15
s_mul_i32 s67, s69, 2048
s_mul_i32 s68, s69, s54
s_barrier
s_add_u32 s60, s71, 40960
s_add_u32 m0, s60, 0
s_mov_b32 s61, s68
buffer_load_dwordx4 v26, s[28:31], s61 offen lds
buffer_load_dwordx4 v27, s[28:31], s61 offen offset:1024 lds
s_add_u32 m0, s60, 8192
s_add_u32 s61, s61, s53
buffer_load_dwordx4 v26, s[28:31], s61 offen lds
buffer_load_dwordx4 v27, s[28:31], s61 offen offset:1024 lds
s_add_u32 m0, s60, 16384
s_add_u32 s61, s61, s53
buffer_load_dwordx4 v26, s[28:31], s61 offen lds
buffer_load_dwordx4 v27, s[28:31], s61 offen offset:1024 lds
s_add_u32 s49, s76, 2
s_and_b32 s49, s49, 15
s_mul_i32 s49, s49, 393216
buffer_load_dwordx4 v[40:43], v36, s[28:31], s49 offen
s_add_u32 s49, s76, 3
s_and_b32 s49, s49, 15
s_mul_i32 s49, s49, 393216
buffer_load_dwordx4 v[40:43], v36, s[28:31], s49 offen
buffer_load_dword v5, v30, s[32:35], s79 offen sc1
s_add_u32 s69, s47, 0
s_and_b32 s69, s69, 15
s_mul_i32 s67, s69, 2048
s_mul_i32 s68, s69, s54
s_add_u32 m0, s70, 0
s_nop 0
s_mov_b32 s63, 0
s_waitcnt vmcnt(0)
poll_31:
v_cmp_gt_u32 vcc, 1, v5
s_cbranch_vccz polled_32
buffer_load_dword v5, v30, s[32:35], s79 offen sc1
s_add_u32 s63, s63, 1
s_cmp_lt_u32 s63, 0x80000
s_waitcnt vmcnt(0)
s_cbranch_scc1 poll_31
polled_32:
buffer_load_dwordx4 v20, s[32:35], s67 offen offset:0 sc1 lds
buffer_load_dwordx4 v21, s[32:35], s67 offen offset:1024 sc1 lds
buffer_load_dwordx4 v22, s[32:35], s67 offen offset:2048 sc1 lds
buffer_load_dwordx4 v23, s[32:35], s67 offen offset:3072 sc1 lds
s_add_u32 s69, s47, 1
s_and_b32 s69, s69, 15
s_mul_i32 s67, s69, 2048
s_mul_i32 s68, s69, s54
s_add_u32 m0, s70, 40960
s_nop 0
buffer_load_dwordx4 v20, s[32:35], s67 offen offset:0 sc1 lds
buffer_load_dwordx4 v21, s[32:35], s67 offen offset:1024 sc1 lds
buffer_load_dwordx4 v22, s[32:35], s67 offen offset:2048 sc1 lds
buffer_load_dwordx4 v23, s[32:35], s67 offen offset:3072 sc1 lds
s_waitcnt vmcnt(4) lgkmcnt(0)
s_barrier
s_add_u32 s69, s47, 2
s_and_b32 s69, s69, 15
s_mul_i32 s67, s69, 2048
s_mul_i32 s68, s69, s54
s_add_u32 m0, s70, 81920
s_nop 0
buffer_load_dwordx4 v20, s[32:35], s67 offen offset:0 sc1 lds
buffer_load_dwordx4 v21, s[32:35], s67 offen offset:1024 sc1 lds
buffer_load_dwordx4 v22, s[32:35], s67 offen offset:2048 sc1 lds
buffer_load_dwordx4 v23, s[32:35], s67 offen offset:3072 sc1 lds
s_add_u32 s60, s71, 81920
s_add_u32 m0, s60, 0
s_mov_b32 s61, s68
buffer_load_dwordx4 v26, s[28:31], s61 offen lds
buffer_load_dwordx4 v27, s[28:31], s61 offen offset:1024 lds
s_add_u32 m0, s60, 8192
s_add_u32 s61, s61, s53
buffer_load_dwordx4 v26, s[28:31], s61 offen lds
buffer_load_dwordx4 v27, s[28:31], s61 offen offset:1024 lds
s_add_u32 m0, s60, 16384
s_add_u32 s61, s61, s53
buffer_load_dwordx4 v26, s[28:31], s61 offen lds
buffer_load_dwordx4 v27, s[28:31], s61 offen offset:1024 lds
s_add_u32 s49, s76, 4
s_and_b32 s49, s49, 15
s_mul_i32 s49, s49, 393216
buffer_load_dwordx4 v[40:43], v36, s[28:31], s49 offen
s_mov_b32 s64, 0
s_mov_b32 s65, 0
h1_loop:
s_waitcnt vmcnt(11)
s_barrier
s_add_u32 s69, s69, 1
s_and_b32 s69, s69, 15
s_mul_i32 s67, s69, 2048
s_mul_i32 s68, s69, s54
s_add_u32 m0, s70, s65
s_nop 0
buffer_load_dwordx4 v20, s[32:35], s67 offen offset:0 sc1 lds
buffer_load_dwordx4 v21, s[32:35], s67 offen offset:1024 sc1 lds
buffer_load_dwordx4 v22, s[32:35], s67 offen offset:2048 sc1 lds
buffer_load_dwordx4 v23, s[32:35], s67 offen offset:3072 sc1 lds
s_add_u32 s60, s71, s65
s_add_u32 m0, s60, 0
s_mov_b32 s61, s68
buffer_load_dwordx4 v26, s[28:31], s61 offen lds
buffer_load_dwordx4 v27, s[28:31], s61 offen offset:1024 lds
s_add_u32 m0, s60, 8192
s_add_u32 s61, s61, s53
buffer_load_dwordx4 v26, s[28:31], s61 offen lds
buffer_load_dwordx4 v27, s[28:31], s61 offen offset:1024 lds
s_add_u32 m0, s60, 16384
s_add_u32 s61, s61, s53
buffer_load_dwordx4 v26, s[28:31], s61 offen lds
buffer_load_dwordx4 v27, s[28:31], s61 offen offset:1024 lds
s_add_u32 s48, s64, 5
s_min_u32 s48, s48, 15
s_add_u32 s49, s48, s76
s_and_b32 s49, s49, 15
s_mul_i32 s49, s49, 393216
buffer_load_dwordx4 v[40:43], v36, s[28:31], s49 offen
s_add_u32 s65, s65, 40960
s_cmp_eq_u32 s65, 122880
s_cselect_b32 s65, 0, s65
s_add_u32 s64, s64, 1
s_cmp_lt_u32 s64, 11
s_cbranch_scc1 h1_loop
s_waitcnt vmcnt(11)
s_barrier
s_add_u32 s69, s47, 14
s_and_b32 s69, s69, 15
s_mul_i32 s67, s69, 2048
s_mul_i32 s68, s69, s54
s_add_u32 m0, s70, s65
s_nop 0
buffer_load_dwordx4 v20, s[32:35], s67 offen offset:0 sc1 lds
buffer_load_dwordx4 v21, s[32:35], s67 offen offset:1024 sc1 lds
buffer_load_dwordx4 v22, s[32:35], s67 offen offset:2048 sc1 lds
buffer_load_dwordx4 v23, s[32:35], s67 offen offset:3072 sc1 lds
s_add_u32 s60, s71, s65
s_add_u32 m0, s60, 0
s_mov_b32 s61, s68
buffer_load_dwordx4 v26, s[28:31], s61 offen lds
buffer_load_dwordx4 v27, s[28:31], s61 offen offset:1024 lds
s_add_u32 m0, s60, 8192
s_add_u32 s61, s61, s53
buffer_load_dwordx4 v26, s[28:31], s61 offen lds
buffer_load_dwordx4 v27, s[28:31], s61 offen offset:1024 lds
s_add_u32 m0, s60, 16384
s_add_u32 s61, s61, s53
buffer_load_dwordx4 v26, s[28:31], s61 offen lds
buffer_load_dwordx4 v27, s[28:31], s61 offen offset:1024 lds
s_add_u32 s65, s65, 40960
s_cmp_eq_u32 s65, 122880
s_cselect_b32 s65, 0, s65
s_add_u32 s64, s64, 1
s_mov_b32 s36, s16
s_and_b32 s37, s17, 0xffff
s_mov_b32 s38, 2097152
s_mov_b32 s39, 0x00020000
s_waitcnt vmcnt(10)
s_barrier
s_add_u32 s69, s47, 15
s_and_b32 s69, s69, 15
s_mul_i32 s67, s69, 2048
s_mul_i32 s68, s69, s54
s_add_u32 m0, s70, 0
s_nop 0
buffer_load_dwordx4 v20, s[32:35], s67 offen offset:0 sc1 lds
buffer_load_dwordx4 v21, s[32:35], s67 offen offset:1024 sc1 lds
buffer_load_dwordx4 v22, s[32:35], s67 offen offset:2048 sc1 lds
buffer_load_dwordx4 v23, s[32:35], s67 offen offset:3072 sc1 lds
s_add_u32 s60, s71, 0
s_add_u32 m0, s60, 0
s_mov_b32 s61, s68
buffer_load_dwordx4 v26, s[28:31], s61 offen lds
buffer_load_dwordx4 v27, s[28:31], s61 offen offset:1024 lds
s_add_u32 m0, s60, 8192
s_add_u32 s61, s61, s53
buffer_load_dwordx4 v26, s[28:31], s61 offen lds
buffer_load_dwordx4 v27, s[28:31], s61 offen offset:1024 lds
s_add_u32 m0, s60, 16384
s_add_u32 s61, s61, s53
buffer_load_dwordx4 v26, s[28:31], s61 offen lds
buffer_load_dwordx4 v27, s[28:31], s61 offen offset:1024 lds
s_waitcnt vmcnt(10)
s_barrier
s_setprio 0
buffer_load_dwordx4 v[240:243], v15, s[36:39], 0 offen offset:0
buffer_load_dwordx4 v[240:243], v15, s[36:39], 0 offen offset:1024
buffer_load_dwordx4 v[80:83], v37, s[32:35], 0 offen offset:0 sc1
buffer_load_dwordx4 v[84:87], v37, s[32:35], 0 offen offset:1024 sc1
buffer_load_dwordx4 v[88:91], v37, s[32:35], 0 offen offset:2048 sc1
buffer_load_dwordx4 v[92:95], v37, s[32:35], 0 offen offset:3072 sc1
global_load_dword v48, v54, s[98:99]
buffer_load_dwordx4 v[64:67], v38, s[32:35], 0 offen offset:0 sc1
buffer_load_dwordx4 v[68:71], v38, s[32:35], 0 offen offset:1024 sc1
buffer_load_dwordx4 v[72:75], v38, s[32:35], 0 offen offset:2048 sc1
buffer_load_dwordx4 v[76:79], v38, s[32:35], 0 offen offset:3072 sc1
s_add_u32 s48, s75, 15
s_and_b32 s48, s48, 15
s_mul_i32 s48, s48, s57
s_add_u32 m0, s71, 106496
s_nop 0
buffer_load_dwordx4 v28, s[36:39], s48 offen lds
buffer_load_dwordx4 v29, s[36:39], s48 offen offset:1024 lds
s_waitcnt vmcnt(13)
s_barrier
s_add_u32 s48, s75, 5
s_and_b32 s48, s48, 15
s_mul_i32 s48, s48, s57
s_add_u32 m0, s71, 24576
s_nop 0
buffer_load_dwordx4 v28, s[36:39], s48 offen lds
buffer_load_dwordx4 v29, s[36:39], s48 offen offset:1024 lds
s_waitcnt vmcnt(4)
s_add_u32 s48, s75, 6
s_and_b32 s48, s48, 15
s_mul_i32 s48, s48, s57
s_add_u32 m0, s71, 32768
s_nop 0
buffer_load_dwordx4 v28, s[36:39], s48 offen lds
v_add_f32 v80, v80, v88
v_add_f32 v64, v64, v72
v_add_f32 v81, v81, v89
v_add_f32 v65, v65, v73
v_add_f32 v82, v82, v90
v_add_f32 v66, v66, v74
v_add_f32 v83, v83, v91
v_add_f32 v67, v67, v75
v_add_f32 v84, v84, v92
v_add_f32 v68, v68, v76
buffer_load_dwordx4 v29, s[36:39], s48 offen offset:1024 lds
v_add_f32 v85, v85, v93
v_add_f32 v69, v69, v77
v_add_f32 v86, v86, v94
v_add_f32 v70, v70, v78
v_add_f32 v87, v87, v95
v_add_f32 v71, v71, v79
v_add_f32 v80, v80, v84
v_add_f32 v64, v64, v68
v_add_f32 v81, v81, v85
v_add_f32 v65, v65, v69
s_add_u32 s48, s75, 7
s_and_b32 s48, s48, 15
s_mul_i32 s48, s48, s57
s_add_u32 m0, s71, 40960
s_nop 0
buffer_load_dwordx4 v28, s[36:39], s48 offen lds
v_add_f32 v82, v82, v86
v_add_f32 v66, v66, v70
v_add_f32 v83, v83, v87
v_add_f32 v67, v67, v71
s_nop 1
s_nop 1
v_permlane32_swap_b32 v80, v81
v_permlane32_swap_b32 v64, v65
v_permlane32_swap_b32 v82, v83
buffer_load_dwordx4 v29, s[36:39], s48 offen offset:1024 lds
v_permlane32_swap_b32 v66, v67
v_add_f32 v80, v80, v81
v_add_f32 v64, v64, v65
v_add_f32 v82, v82, v83
v_add_f32 v66, v66, v67
s_nop 1
s_nop 1
v_permlane16_swap_b32 v80, v82
v_permlane16_swap_b32 v64, v66
s_nop 0
s_add_u32 s48, s75, 8
s_and_b32 s48, s48, 15
s_mul_i32 s48, s48, s57
s_add_u32 m0, s71, 49152
s_nop 0
buffer_load_dwordx4 v28, s[36:39], s48 offen lds
s_nop 0
v_add_f32 v80, v80, v82
v_add_f32 v64, v64, v66
v_cmp_u_f32 vcc, v80, v80
s_cbranch_vccnz again_33
summed_34:
v_cmp_u_f32 vcc, v64, v64
s_cbranch_vccnz again_36
summed_37:
v_mul_f32 v44, 0x3a800000, v80
ds_write_b32 v53, v64
v_mov_b32 v45, v44
s_nop 1
v_permlane16_swap_b32 v44, v45
buffer_load_dwordx4 v29, s[36:39], s48 offen offset:1024 lds
s_nop 0
v_fma_f32 v45, -v44, v44, v45
v_max_f32 v45, 0, v45
v_add_f32 v45, 0x3727c5ac, v45
v_rsq_f32 v46, v45
v_sub_f32 v47, 0, v44
ds_write_b32 v50, v47 offset:512
ds_write_b64 v49, v[46:47]
ds_write_b32 v50, v46
s_setprio 0
s_waitcnt lgkmcnt(0)
s_waitcnt vmcnt(63)
s_barrier
s_waitcnt vmcnt(5)
s_add_u32 s48, s75, 9
s_and_b32 s48, s48, 15
s_mul_i32 s48, s48, s57
s_add_u32 m0, s71, 57344
s_nop 0
buffer_load_dwordx4 v28, s[36:39], s48 offen lds
buffer_load_dwordx4 v29, s[36:39], s48 offen offset:1024 lds
s_waitcnt vmcnt(5)
s_add_u32 s48, s75, 10
s_and_b32 s48, s48, 15
s_mul_i32 s48, s48, s57
s_add_u32 m0, s71, 65536
s_nop 0
buffer_load_dwordx4 v28, s[36:39], s48 offen lds
buffer_load_dwordx4 v29, s[36:39], s48 offen offset:1024 lds
s_waitcnt vmcnt(5)
s_add_u32 s48, s75, 11
s_and_b32 s48, s48, 15
s_mul_i32 s48, s48, s57
s_add_u32 m0, s71, 73728
s_nop 0
buffer_load_dwordx4 v28, s[36:39], s48 offen lds
buffer_load_dwordx4 v29, s[36:39], s48 offen offset:1024 lds
s_waitcnt vmcnt(5)
s_add_u32 s48, s75, 12
s_and_b32 s48, s48, 15
s_mul_i32 s48, s48, s57
s_add_u32 m0, s71, 81920
s_nop 0
buffer_load_dwordx4 v28, s[36:39], s48 offen lds
buffer_load_dwordx4 v29, s[36:39], s48 offen offset:1024 lds
s_waitcnt vmcnt(5)
s_add_u32 s48, s75, 13
s_and_b32 s48, s48, 15
s_mul_i32 s48, s48, s57
s_add_u32 m0, s71, 90112
s_nop 0
buffer_load_dwordx4 v28, s[36:39], s48 offen lds
buffer_load_dwordx4 v29, s[36:39], s48 offen offset:1024 lds
s_waitcnt vmcnt(5)
s_add_u32 s48, s75, 14
s_and_b32 s48, s48, 15
s_mul_i32 s48, s48, s57
s_add_u32 m0, s71, 98304
s_nop 0
buffer_load_dwordx4 v28, s[36:39], s48 offen lds
buffer_load_dwordx4 v29, s[36:39], s48 offen offset:1024 lds
s_waitcnt vmcnt(5)
s_add_u32 s48, s75, 0
s_and_b32 s48, s48, 15
s_mul_i32 s48, s48, s57
s_add_u32 m0, s71, 4294950912
s_nop 0
buffer_load_dwordx4 v28, s[36:39], s48 offen lds
buffer_load_dwordx4 v29, s[36:39], s48 offen offset:1024 lds
s_waitcnt vmcnt(5)
s_add_u32 s48, s75, 1
s_and_b32 s48, s48, 15
s_mul_i32 s48, s48, s57
s_add_u32 m0, s71, 4294959104
s_nop 0
buffer_load_dwordx4 v28, s[36:39], s48 offen lds
buffer_load_dwordx4 v29, s[36:39], s48 offen offset:1024 lds
s_waitcnt vmcnt(5)
s_add_u32 s48, s75, 2
s_and_b32 s48, s48, 15
s_mul_i32 s48, s48, s57
s_add_u32 m0, s71, 0
s_nop 0
buffer_load_dwordx4 v28, s[36:39], s48 offen lds
buffer_load_dwordx4 v29, s[36:39], s48 offen offset:1024 lds
s_waitcnt vmcnt(5)
s_add_u32 s48, s75, 3
s_and_b32 s48, s48, 15
s_mul_i32 s48, s48, s57
s_add_u32 m0, s71, 8192
s_nop 0
buffer_load_dwordx4 v28, s[36:39], s48 offen lds
buffer_load_dwordx4 v29, s[36:39], s48 offen offset:1024 lds
s_waitcnt vmcnt(5)
s_add_u32 s48, s75, 4
s_and_b32 s48, s48, 15
s_mul_i32 s48, s48, s57
s_add_u32 m0, s71, 16384
s_nop 0
buffer_load_dwordx4 v28, s[36:39], s48 offen lds
buffer_load_dwordx4 v29, s[36:39], s48 offen offset:1024 lds
s_waitcnt vmcnt(5)
buffer_load_dwordx4 v[240:243], v18, s[32:35], s81 offen offset:0 sc1
buffer_load_dwordx4 v[240:243], v18, s[32:35], s81 offen offset:1024 sc1
s_waitcnt vmcnt(5)
buffer_load_dwordx4 v[240:243], v18, s[32:35], s82 offen offset:0 sc1
buffer_load_dwordx4 v[240:243], v18, s[32:35], s82 offen offset:1024 sc1
s_mov_b32 s28, s6
s_and_b32 s29, s7, 0xffff
s_mov_b32 s30, 6291456
s_mov_b32 s31, 0x00020000
s_and_b32 s48, s2, 7
s_lshl_b32 s48, s48, 1
s_add_u32 s47, s42, s48
s_and_b32 s47, s47, 15
s_and_b32 s50, s42, 8
s_or_b32 s50, s50, 3
s_and_b32 s48, s2, 7
s_lshl_b32 s48, s48, 1
s_add_u32 s76, s50, s48
s_and_b32 s76, s76, 15
s_add_u32 s69, s47, 0
s_and_b32 s69, s69, 15
s_mul_i32 s67, s69, 2048
s_mul_i32 s68, s69, s54
s_waitcnt vmcnt(0) lgkmcnt(0)
s_barrier
s_add_u32 s60, s71, 122880
s_add_u32 m0, s60, 0
s_mov_b32 s61, s68
buffer_load_dwordx4 v26, s[28:31], s61 offen lds
buffer_load_dwordx4 v27, s[28:31], s61 offen offset:1024 lds
s_add_u32 m0, s60, 8192
s_add_u32 s61, s61, s53
buffer_load_dwordx4 v26, s[28:31], s61 offen lds
buffer_load_dwordx4 v27, s[28:31], s61 offen offset:1024 lds
s_add_u32 m0, s60, 16384
s_add_u32 s61, s61, s53
buffer_load_dwordx4 v26, s[28:31], s61 offen lds
buffer_load_dwordx4 v27, s[28:31], s61 offen offset:1024 lds
v_add_u32 v37, 262144, v37
s_getpc_b64 s[98:99]
pc_39:
s_add_u32 s98, s98, c2_last - pc_39
s_addc_u32 s99, s99, 0
s_lshr_b32 s50, s2, 3
s_lshl_b32 s50, s50, 2
s_add_u32 s50, s50, s43
s_lshl_b32 s50, s50, 7
v_and_b32 v4, 1, v0
v_lshl_add_u32 v4, v4, 6, s50
v_min_u32 v54, L_code_end - c2_last, v4
s_waitcnt vmcnt(0) lgkmcnt(0)
s_add_u32 s69, s47, 1
s_and_b32 s69, s69, 15
s_mul_i32 s67, s69, 2048
s_mul_i32 s68, s69, s54
s_barrier
s_add_u32 s60, s71, 40960
s_add_u32 m0, s60, 0
s_mov_b32 s61, s68
buffer_load_dwordx4 v26, s[28:31], s61 offen lds
buffer_load_dwordx4 v27, s[28:31], s61 offen offset:1024 lds
s_add_u32 m0, s60, 8192
s_add_u32 s61, s61, s53
buffer_load_dwordx4 v26, s[28:31], s61 offen lds
buffer_load_dwordx4 v27, s[28:31], s61 offen offset:1024 lds
s_add_u32 m0, s60, 16384
s_add_u32 s61, s61, s53
buffer_load_dwordx4 v26, s[28:31], s61 offen lds
buffer_load_dwordx4 v27, s[28:31], s61 offen offset:1024 lds
s_add_u32 s49, s76, 2
s_and_b32 s49, s49, 15
s_mul_i32 s49, s49, 393216
buffer_load_dwordx4 v[40:43], v36, s[28:31], s49 offen
s_add_u32 s49, s76, 3
s_and_b32 s49, s49, 15
s_mul_i32 s49, s49, 393216
buffer_load_dwordx4 v[40:43], v36, s[28:31], s49 offen
buffer_load_dword v5, v30, s[32:35], s79 offen sc1
s_add_u32 s69, s47, 0
s_and_b32 s69, s69, 15
s_mul_i32 s67, s69, 2048
s_mul_i32 s68, s69, s54
s_add_u32 m0, s70, 0
s_nop 0
s_mov_b32 s63, 0
s_waitcnt vmcnt(0)
poll_40:
v_cmp_gt_u32 vcc, 2, v5
s_cbranch_vccz polled_41
buffer_load_dword v5, v30, s[32:35], s79 offen sc1
s_add_u32 s63, s63, 1
s_cmp_lt_u32 s63, 0x80000
s_waitcnt vmcnt(0)
s_cbranch_scc1 poll_40
polled_41:
buffer_load_dwordx4 v20, s[32:35], s67 offen offset:0 sc1 lds
buffer_load_dwordx4 v21, s[32:35], s67 offen offset:1024 sc1 lds
buffer_load_dwordx4 v22, s[32:35], s67 offen offset:2048 sc1 lds
buffer_load_dwordx4 v23, s[32:35], s67 offen offset:3072 sc1 lds
s_add_u32 s69, s47, 1
s_and_b32 s69, s69, 15
s_mul_i32 s67, s69, 2048
s_mul_i32 s68, s69, s54
s_add_u32 m0, s70, 40960
s_nop 0
buffer_load_dwordx4 v20, s[32:35], s67 offen offset:0 sc1 lds
buffer_load_dwordx4 v21, s[32:35], s67 offen offset:1024 sc1 lds
buffer_load_dwordx4 v22, s[32:35], s67 offen offset:2048 sc1 lds
buffer_load_dwordx4 v23, s[32:35], s67 offen offset:3072 sc1 lds
s_waitcnt vmcnt(4) lgkmcnt(0)
s_barrier
s_add_u32 s69, s47, 2
s_and_b32 s69, s69, 15
s_mul_i32 s67, s69, 2048
s_mul_i32 s68, s69, s54
s_add_u32 m0, s70, 81920
s_nop 0
buffer_load_dwordx4 v20, s[32:35], s67 offen offset:0 sc1 lds
buffer_load_dwordx4 v21, s[32:35], s67 offen offset:1024 sc1 lds
buffer_load_dwordx4 v22, s[32:35], s67 offen offset:2048 sc1 lds
buffer_load_dwordx4 v23, s[32:35], s67 offen offset:3072 sc1 lds
s_add_u32 s60, s71, 81920
s_add_u32 m0, s60, 0
s_mov_b32 s61, s68
buffer_load_dwordx4 v26, s[28:31], s61 offen lds
buffer_load_dwordx4 v27, s[28:31], s61 offen offset:1024 lds
s_add_u32 m0, s60, 8192
s_add_u32 s61, s61, s53
buffer_load_dwordx4 v26, s[28:31], s61 offen lds
buffer_load_dwordx4 v27, s[28:31], s61 offen offset:1024 lds
s_add_u32 m0, s60, 16384
s_add_u32 s61, s61, s53
buffer_load_dwordx4 v26, s[28:31], s61 offen lds
buffer_load_dwordx4 v27, s[28:31], s61 offen offset:1024 lds
s_add_u32 s49, s76, 4
s_and_b32 s49, s49, 15
s_mul_i32 s49, s49, 393216
buffer_load_dwordx4 v[40:43], v36, s[28:31], s49 offen
s_mov_b32 s64, 0
s_mov_b32 s65, 0
h2_loop:
s_waitcnt vmcnt(11)
s_barrier
s_add_u32 s69, s69, 1
s_and_b32 s69, s69, 15
s_mul_i32 s67, s69, 2048
s_mul_i32 s68, s69, s54
s_add_u32 m0, s70, s65
s_nop 0
buffer_load_dwordx4 v20, s[32:35], s67 offen offset:0 sc1 lds
buffer_load_dwordx4 v21, s[32:35], s67 offen offset:1024 sc1 lds
buffer_load_dwordx4 v22, s[32:35], s67 offen offset:2048 sc1 lds
buffer_load_dwordx4 v23, s[32:35], s67 offen offset:3072 sc1 lds
s_add_u32 s60, s71, s65
s_add_u32 m0, s60, 0
s_mov_b32 s61, s68
buffer_load_dwordx4 v26, s[28:31], s61 offen lds
buffer_load_dwordx4 v27, s[28:31], s61 offen offset:1024 lds
s_add_u32 m0, s60, 8192
s_add_u32 s61, s61, s53
buffer_load_dwordx4 v26, s[28:31], s61 offen lds
buffer_load_dwordx4 v27, s[28:31], s61 offen offset:1024 lds
s_add_u32 m0, s60, 16384
s_add_u32 s61, s61, s53
buffer_load_dwordx4 v26, s[28:31], s61 offen lds
buffer_load_dwordx4 v27, s[28:31], s61 offen offset:1024 lds
s_add_u32 s48, s64, 5
s_min_u32 s48, s48, 15
s_add_u32 s49, s48, s76
s_and_b32 s49, s49, 15
s_mul_i32 s49, s49, 393216
buffer_load_dwordx4 v[40:43], v36, s[28:31], s49 offen
s_add_u32 s65, s65, 40960
s_cmp_eq_u32 s65, 122880
s_cselect_b32 s65, 0, s65
s_add_u32 s64, s64, 1
s_cmp_lt_u32 s64, 11
s_cbranch_scc1 h2_loop
s_waitcnt vmcnt(11)
s_barrier
s_add_u32 s69, s47, 14
s_and_b32 s69, s69, 15
s_mul_i32 s67, s69, 2048
s_mul_i32 s68, s69, s54
s_add_u32 m0, s70, s65
s_nop 0
buffer_load_dwordx4 v20, s[32:35], s67 offen offset:0 sc1 lds
buffer_load_dwordx4 v21, s[32:35], s67 offen offset:1024 sc1 lds
buffer_load_dwordx4 v22, s[32:35], s67 offen offset:2048 sc1 lds
buffer_load_dwordx4 v23, s[32:35], s67 offen offset:3072 sc1 lds
s_add_u32 s60, s71, s65
s_add_u32 m0, s60, 0
s_mov_b32 s61, s68
buffer_load_dwordx4 v26, s[28:31], s61 offen lds
buffer_load_dwordx4 v27, s[28:31], s61 offen offset:1024 lds
s_add_u32 m0, s60, 8192
s_add_u32 s61, s61, s53
buffer_load_dwordx4 v26, s[28:31], s61 offen lds
buffer_load_dwordx4 v27, s[28:31], s61 offen offset:1024 lds
s_add_u32 m0, s60, 16384
s_add_u32 s61, s61, s53
buffer_load_dwordx4 v26, s[28:31], s61 offen lds
buffer_load_dwordx4 v27, s[28:31], s61 offen offset:1024 lds
s_add_u32 s65, s65, 40960
s_cmp_eq_u32 s65, 122880
s_cselect_b32 s65, 0, s65
s_add_u32 s64, s64, 1
s_mov_b32 s36, s12
s_and_b32 s37, s13, 0xffff
s_mov_b32 s38, 6291456
s_mov_b32 s39, 0x00020000
s_waitcnt vmcnt(10)
s_barrier
s_add_u32 s69, s47, 15
s_and_b32 s69, s69, 15
s_mul_i32 s67, s69, 2048
s_mul_i32 s68, s69, s54
s_add_u32 m0, s70, 0
s_nop 0
buffer_load_dwordx4 v20, s[32:35], s67 offen offset:0 sc1 lds
buffer_load_dwordx4 v21, s[32:35], s67 offen offset:1024 sc1 lds
buffer_load_dwordx4 v22, s[32:35], s67 offen offset:2048 sc1 lds
buffer_load_dwordx4 v23, s[32:35], s67 offen offset:3072 sc1 lds
s_add_u32 s60, s71, 0
s_add_u32 m0, s60, 0
s_mov_b32 s61, s68
buffer_load_dwordx4 v26, s[28:31], s61 offen lds
buffer_load_dwordx4 v27, s[28:31], s61 offen offset:1024 lds
s_add_u32 m0, s60, 8192
s_add_u32 s61, s61, s53
buffer_load_dwordx4 v26, s[28:31], s61 offen lds
buffer_load_dwordx4 v27, s[28:31], s61 offen offset:1024 lds
s_add_u32 m0, s60, 16384
s_add_u32 s61, s61, s53
buffer_load_dwordx4 v26, s[28:31], s61 offen lds
buffer_load_dwordx4 v27, s[28:31], s61 offen offset:1024 lds
s_waitcnt vmcnt(10)
s_barrier
s_setprio 0
buffer_load_dwordx4 v[80:83], v37, s[32:35], 0 offen offset:0 sc1
buffer_load_dwordx4 v[84:87], v37, s[32:35], 0 offen offset:1024 sc1
buffer_load_dwordx4 v[88:91], v37, s[32:35], 0 offen offset:2048 sc1
buffer_load_dwordx4 v[92:95], v37, s[32:35], 0 offen offset:3072 sc1
global_load_dword v48, v54, s[98:99]
s_add_u32 s69, s47, 0
s_and_b32 s69, s69, 15
s_mul_i32 s67, s69, 2048
s_mul_i32 s68, s69, s54
s_add_u32 s60, s71, 122880
s_add_u32 m0, s60, 0
s_mov_b32 s61, s68
buffer_load_dwordx4 v26, s[36:39], s61 offen lds
buffer_load_dwordx4 v27, s[36:39], s61 offen offset:1024 lds
s_add_u32 m0, s60, 8192
s_add_u32 s61, s61, s53
buffer_load_dwordx4 v26, s[36:39], s61 offen lds
buffer_load_dwordx4 v27, s[36:39], s61 offen offset:1024 lds
s_add_u32 m0, s60, 16384
s_add_u32 s61, s61, s53
buffer_load_dwordx4 v26, s[36:39], s61 offen lds
buffer_load_dwordx4 v27, s[36:39], s61 offen offset:1024 lds
s_waitcnt vmcnt(11)
s_barrier
s_waitcnt vmcnt(7)
buffer_store_dwordx4 v[56:59], v18, s[32:35], s86 offen offset:0 sc1
v_add_f32 v80, v80, v88
v_add_f32 v81, v81, v89
v_add_f32 v82, v82, v90
v_add_f32 v83, v83, v91
v_add_f32 v84, v84, v92
v_add_f32 v85, v85, v93
v_add_f32 v86, v86, v94
buffer_store_dwordx4 v[56:59], v18, s[32:35], s86 offen offset:1024 sc1
v_add_f32 v87, v87, v95
v_add_f32 v80, v80, v84
v_add_f32 v81, v81, v85
v_add_f32 v82, v82, v86
v_add_f32 v83, v83, v87
s_nop 1
buffer_load_dwordx4 v[240:243], v18, s[32:35], s81 offen offset:0 sc1
v_permlane32_swap_b32 v80, v81
v_permlane32_swap_b32 v82, v83
v_add_f32 v80, v80, v81
v_add_f32 v82, v82, v83
s_nop 1
v_permlane16_swap_b32 v80, v82
buffer_load_dwordx4 v[240:243], v18, s[32:35], s81 offen offset:1024 sc1
s_nop 0
v_add_f32 v80, v80, v82
v_cmp_u_f32 vcc, v80, v80
s_cbranch_vccnz again_42
summed_43:
v_mul_f32 v44, 0x3a800000, v80
buffer_load_dwordx4 v[240:243], v18, s[32:35], s82 offen offset:0 sc1
v_mov_b32 v45, v44
s_nop 1
v_permlane16_swap_b32 v44, v45
s_nop 0
v_fma_f32 v45, -v44, v44, v45
v_max_f32 v45, 0, v45
buffer_load_dwordx4 v[240:243], v18, s[32:35], s82 offen offset:1024 sc1
v_add_f32 v45, 0x3727c5ac, v45
v_rsq_f32 v46, v45
v_sub_f32 v47, 0, v44
ds_write_b32 v50, v47 offset:512
ds_write_b64 v49, v[46:47]
ds_write_b32 v50, v46
s_setprio 0
s_waitcnt lgkmcnt(0)
s_waitcnt vmcnt(63)
s_barrier
ds_write_b128 v52, v[232:235] offset:57344
ds_write_b128 v52, v[236:239] offset:58368
ds_write_b128 v51, v[152:155] offset:40960
ds_write_b128 v51, v[156:159] offset:41984
ds_write_b128 v51, v[160:163] offset:49152
ds_write_b128 v51, v[164:167] offset:50176
ds_write_b128 v51, v[168:171] offset:57344
ds_write_b128 v51, v[172:175] offset:58368
ds_write_b128 v52, v[176:179] offset:0
ds_write_b128 v52, v[180:183] offset:1024
ds_write_b128 v52, v[184:187] offset:8192
ds_write_b128 v52, v[188:191] offset:9216
ds_write_b128 v52, v[192:195] offset:16384
ds_write_b128 v52, v[196:199] offset:17408
ds_write_b128 v52, v[200:203] offset:24576
ds_write_b128 v52, v[204:207] offset:25600
ds_write_b128 v52, v[208:211] offset:32768
ds_write_b128 v52, v[212:215] offset:33792
ds_write_b128 v52, v[216:219] offset:40960
ds_write_b128 v52, v[220:223] offset:41984
ds_write_b128 v52, v[224:227] offset:49152
ds_write_b128 v52, v[228:231] offset:50176
ds_write_b128 v51, v[112:115] offset:0
ds_write_b128 v51, v[116:119] offset:1024
ds_write_b128 v51, v[120:123] offset:8192
ds_write_b128 v51, v[124:127] offset:9216
ds_write_b128 v51, v[128:131] offset:16384
ds_write_b128 v51, v[132:135] offset:17408
ds_write_b128 v51, v[136:139] offset:24576
ds_write_b128 v51, v[140:143] offset:25600
ds_write_b128 v51, v[144:147] offset:32768
ds_write_b128 v51, v[148:151] offset:33792
s_mov_b32 s28, s12
s_and_b32 s29, s13, 0xffff
s_mov_b32 s30, 6291456
s_mov_b32 s31, 0x00020000
s_add_u32 s69, s47, 0
s_and_b32 s69, s69, 15
s_mul_i32 s67, s69, 2048
s_mul_i32 s68, s69, s54
s_waitcnt vmcnt(0) lgkmcnt(0)
s_barrier
s_mov_b32 s36, s14
s_and_b32 s37, s15, 0xffff
s_mov_b32 s38, 65536
s_mov_b32 s39, 0x00020000
s_lshl_b32 s48, s42, 12
s_lshl_b32 s49, s43, 10
s_add_u32 s48, s48, s49
s_add_u32 m0, s49, 135168
s_nop 0
buffer_load_dwordx4 v18, s[36:39], s48 offen lds
v_add_u32 v37, 262144, v37
s_getpc_b64 s[98:99]
pc_45:
s_add_u32 s98, s98, c3_last - pc_45
s_addc_u32 s99, s99, 0
s_lshr_b32 s50, s2, 3
s_lshl_b32 s50, s50, 2
s_add_u32 s50, s50, s43
s_lshl_b32 s50, s50, 7
v_and_b32 v4, 1, v0
v_lshl_add_u32 v4, v4, 6, s50
v_min_u32 v54, L_code_end - c3_last, v4
s_lshl_b32 s83, s41, 2
s_add_u32 s83, s83, 0
s_lshl_b32 s83, s83, 7
s_add_u32 s83, s83, 18350080
s_cmp_lg_u32 s43, 0
s_cbranch_scc1 else_46
buffer_load_dword v5, v30, s[32:35], s83 offen sc1
s_mov_b32 s63, 0
s_waitcnt vmcnt(0)
poll_48:
v_cmp_gt_u32 vcc, 3, v5
s_cbranch_vccz polled_49
buffer_load_dword v5, v30, s[32:35], s83 offen sc1
s_add_u32 s63, s63, 1
s_cmp_lt_u32 s63, 0x80000
s_waitcnt vmcnt(0)
s_cbranch_scc1 poll_48
polled_49:
s_mov_b64 exec, 1
buffer_store_dword v13, v12, s[32:35], s73 offen sc1
s_mov_b64 exec, -1
else_46:
s_waitcnt vmcnt(0) lgkmcnt(0)
s_add_u32 s69, s47, 1
s_and_b32 s69, s69, 15
s_mul_i32 s67, s69, 2048
s_mul_i32 s68, s69, s54
s_barrier
s_add_u32 s60, s71, 40960
s_add_u32 m0, s60, 0
s_mov_b32 s61, s68
buffer_load_dwordx4 v26, s[28:31], s61 offen lds
buffer_load_dwordx4 v27, s[28:31], s61 offen offset:1024 lds
s_add_u32 m0, s60, 8192
s_add_u32 s61, s61, s53
buffer_load_dwordx4 v26, s[28:31], s61 offen lds
buffer_load_dwordx4 v27, s[28:31], s61 offen offset:1024 lds
s_add_u32 m0, s60, 16384
s_add_u32 s61, s61, s53
buffer_load_dwordx4 v26, s[28:31], s61 offen lds
buffer_load_dwordx4 v27, s[28:31], s61 offen offset:1024 lds
s_add_u32 s49, s76, 2
s_and_b32 s49, s49, 15
s_mul_i32 s49, s49, 393216
buffer_load_dwordx4 v[40:43], v36, s[28:31], s49 offen
s_add_u32 s49, s76, 3
s_and_b32 s49, s49, 15
s_mul_i32 s49, s49, 393216
buffer_load_dwordx4 v[40:43], v36, s[28:31], s49 offen
buffer_load_dword v5, v30, s[32:35], s79 offen sc1
s_add_u32 s69, s47, 0
s_and_b32 s69, s69, 15
s_mul_i32 s67, s69, 2048
s_mul_i32 s68, s69, s54
s_add_u32 m0, s70, 0
s_nop 0
s_mov_b32 s63, 0
s_waitcnt vmcnt(0)
poll_50:
v_cmp_gt_u32 vcc, 3, v5
s_cbranch_vccz polled_51
buffer_load_dword v5, v30, s[32:35], s79 offen sc1
s_add_u32 s63, s63, 1
s_cmp_lt_u32 s63, 0x80000
s_waitcnt vmcnt(0)
s_cbranch_scc1 poll_50
polled_51:
buffer_load_dwordx4 v20, s[32:35], s67 offen offset:0 sc1 lds
buffer_load_dwordx4 v21, s[32:35], s67 offen offset:1024 sc1 lds
buffer_load_dwordx4 v22, s[32:35], s67 offen offset:2048 sc1 lds
buffer_load_dwordx4 v23, s[32:35], s67 offen offset:3072 sc1 lds
s_add_u32 s69, s47, 1
s_and_b32 s69, s69, 15
s_mul_i32 s67, s69, 2048
s_mul_i32 s68, s69, s54
s_add_u32 m0, s70, 40960
s_nop 0
buffer_load_dwordx4 v20, s[32:35], s67 offen offset:0 sc1 lds
buffer_load_dwordx4 v21, s[32:35], s67 offen offset:1024 sc1 lds
buffer_load_dwordx4 v22, s[32:35], s67 offen offset:2048 sc1 lds
buffer_load_dwordx4 v23, s[32:35], s67 offen offset:3072 sc1 lds
s_waitcnt vmcnt(4) lgkmcnt(0)
s_barrier
s_add_u32 s69, s47, 2
s_and_b32 s69, s69, 15
s_mul_i32 s67, s69, 2048
s_mul_i32 s68, s69, s54
s_add_u32 m0, s70, 81920
s_nop 0
buffer_load_dwordx4 v20, s[32:35], s67 offen offset:0 sc1 lds
buffer_load_dwordx4 v21, s[32:35], s67 offen offset:1024 sc1 lds
buffer_load_dwordx4 v22, s[32:35], s67 offen offset:2048 sc1 lds
buffer_load_dwordx4 v23, s[32:35], s67 offen offset:3072 sc1 lds
s_add_u32 s60, s71, 81920
s_add_u32 m0, s60, 0
s_mov_b32 s61, s68
buffer_load_dwordx4 v26, s[28:31], s61 offen lds
buffer_load_dwordx4 v27, s[28:31], s61 offen offset:1024 lds
s_add_u32 m0, s60, 8192
s_add_u32 s61, s61, s53
buffer_load_dwordx4 v26, s[28:31], s61 offen lds
buffer_load_dwordx4 v27, s[28:31], s61 offen offset:1024 lds
s_add_u32 m0, s60, 16384
s_add_u32 s61, s61, s53
buffer_load_dwordx4 v26, s[28:31], s61 offen lds
buffer_load_dwordx4 v27, s[28:31], s61 offen offset:1024 lds
s_add_u32 s49, s76, 4
s_and_b32 s49, s49, 15
s_mul_i32 s49, s49, 393216
buffer_load_dwordx4 v[40:43], v36, s[28:31], s49 offen
s_mov_b32 s64, 0
s_mov_b32 s65, 0
h3_loop:
s_waitcnt vmcnt(11)
s_barrier
s_add_u32 s69, s69, 1
s_and_b32 s69, s69, 15
s_mul_i32 s67, s69, 2048
s_mul_i32 s68, s69, s54
s_add_u32 m0, s70, s65
s_nop 0
buffer_load_dwordx4 v20, s[32:35], s67 offen offset:0 sc1 lds
buffer_load_dwordx4 v21, s[32:35], s67 offen offset:1024 sc1 lds
buffer_load_dwordx4 v22, s[32:35], s67 offen offset:2048 sc1 lds
buffer_load_dwordx4 v23, s[32:35], s67 offen offset:3072 sc1 lds
s_add_u32 s60, s71, s65
s_add_u32 m0, s60, 0
s_mov_b32 s61, s68
buffer_load_dwordx4 v26, s[28:31], s61 offen lds
buffer_load_dwordx4 v27, s[28:31], s61 offen offset:1024 lds
s_add_u32 m0, s60, 8192
s_add_u32 s61, s61, s53
buffer_load_dwordx4 v26, s[28:31], s61 offen lds
buffer_load_dwordx4 v27, s[28:31], s61 offen offset:1024 lds
s_add_u32 m0, s60, 16384
s_add_u32 s61, s61, s53
buffer_load_dwordx4 v26, s[28:31], s61 offen lds
buffer_load_dwordx4 v27, s[28:31], s61 offen offset:1024 lds
s_add_u32 s48, s64, 5
s_min_u32 s48, s48, 15
s_add_u32 s49, s48, s76
s_and_b32 s49, s49, 15
s_mul_i32 s49, s49, 393216
buffer_load_dwordx4 v[40:43], v36, s[28:31], s49 offen
s_add_u32 s65, s65, 40960
s_cmp_eq_u32 s65, 122880
s_cselect_b32 s65, 0, s65
s_add_u32 s64, s64, 1
s_cmp_lt_u32 s64, 11
s_cbranch_scc1 h3_loop
s_waitcnt vmcnt(11)
s_barrier
s_add_u32 s69, s47, 14
s_and_b32 s69, s69, 15
s_mul_i32 s67, s69, 2048
s_mul_i32 s68, s69, s54
s_add_u32 m0, s70, s65
s_nop 0
buffer_load_dwordx4 v20, s[32:35], s67 offen offset:0 sc1 lds
buffer_load_dwordx4 v21, s[32:35], s67 offen offset:1024 sc1 lds
buffer_load_dwordx4 v22, s[32:35], s67 offen offset:2048 sc1 lds
buffer_load_dwordx4 v23, s[32:35], s67 offen offset:3072 sc1 lds
s_add_u32 s60, s71, s65
s_add_u32 m0, s60, 0
s_mov_b32 s61, s68
buffer_load_dwordx4 v26, s[28:31], s61 offen lds
buffer_load_dwordx4 v27, s[28:31], s61 offen offset:1024 lds
s_add_u32 m0, s60, 8192
s_add_u32 s61, s61, s53
buffer_load_dwordx4 v26, s[28:31], s61 offen lds
buffer_load_dwordx4 v27, s[28:31], s61 offen offset:1024 lds
s_add_u32 m0, s60, 16384
s_add_u32 s61, s61, s53
buffer_load_dwordx4 v26, s[28:31], s61 offen lds
buffer_load_dwordx4 v27, s[28:31], s61 offen offset:1024 lds
s_add_u32 s65, s65, 40960
s_cmp_eq_u32 s65, 122880
s_cselect_b32 s65, 0, s65
s_add_u32 s64, s64, 1
s_mov_b32 s36, s16
s_and_b32 s37, s17, 0xffff
s_mov_b32 s38, 2097152
s_mov_b32 s39, 0x00020000
s_waitcnt vmcnt(10)
s_barrier
s_add_u32 s69, s47, 15
s_and_b32 s69, s69, 15
s_mul_i32 s67, s69, 2048
s_mul_i32 s68, s69, s54
s_add_u32 m0, s70, 0
s_nop 0
buffer_load_dwordx4 v20, s[32:35], s67 offen offset:0 sc1 lds
buffer_load_dwordx4 v21, s[32:35], s67 offen offset:1024 sc1 lds
buffer_load_dwordx4 v22, s[32:35], s67 offen offset:2048 sc1 lds
buffer_load_dwordx4 v23, s[32:35], s67 offen offset:3072 sc1 lds
s_add_u32 s60, s71, 0
s_add_u32 m0, s60, 0
s_mov_b32 s61, s68
buffer_load_dwordx4 v26, s[28:31], s61 offen lds
buffer_load_dwordx4 v27, s[28:31], s61 offen offset:1024 lds
s_add_u32 m0, s60, 8192
s_add_u32 s61, s61, s53
buffer_load_dwordx4 v26, s[28:31], s61 offen lds
buffer_load_dwordx4 v27, s[28:31], s61 offen offset:1024 lds
s_add_u32 m0, s60, 16384
s_add_u32 s61, s61, s53
buffer_load_dwordx4 v26, s[28:31], s61 offen lds
buffer_load_dwordx4 v27, s[28:31], s61 offen offset:1024 lds
s_waitcnt vmcnt(10)
s_barrier
s_setprio 0
buffer_load_dword v33, v30, s[32:35], s73 offen sc1
buffer_load_dwordx4 v[80:83], v37, s[32:35], 0 offen offset:0 sc1
buffer_load_dwordx4 v[84:87], v37, s[32:35], 0 offen offset:1024 sc1
buffer_load_dwordx4 v[88:91], v37, s[32:35], 0 offen offset:2048 sc1
buffer_load_dwordx4 v[92:95], v37, s[32:35], 0 offen offset:3072 sc1
global_load_dword v48, v54, s[98:99]
s_add_u32 s48, s75, 15
s_and_b32 s48, s48, 15
s_mul_i32 s48, s48, s57
s_add_u32 m0, s71, 106496
s_nop 0
buffer_load_dwordx4 v28, s[36:39], s48 offen lds
buffer_load_dwordx4 v29, s[36:39], s48 offen offset:1024 lds
s_add_u32 s48, s75, 5
s_and_b32 s48, s48, 15
s_mul_i32 s48, s48, s57
s_add_u32 m0, s71, 24576
s_nop 0
buffer_load_dwordx4 v28, s[36:39], s48 offen lds
buffer_load_dwordx4 v29, s[36:39], s48 offen offset:1024 lds
s_add_u32 s48, s75, 6
s_and_b32 s48, s48, 15
s_mul_i32 s48, s48, s57
s_add_u32 m0, s71, 32768
s_nop 0
buffer_load_dwordx4 v28, s[36:39], s48 offen lds
buffer_load_dwordx4 v29, s[36:39], s48 offen offset:1024 lds
s_waitcnt vmcnt(12)
s_barrier
s_waitcnt vmcnt(7)
s_mov_b32 s63, 0
poll_55:
v_cmp_gt_u32 vcc, 1, v33
s_cbranch_vccz polled_56
buffer_load_dword v33, v30, s[32:35], s73 offen sc1
s_add_u32 s63, s63, 1
s_cmp_lt_u32 s63, 0x80000
s_waitcnt vmcnt(0)
s_cbranch_scc1 poll_55
polled_56:
s_add_u32 s48, s75, 7
s_and_b32 s48, s48, 15
s_mul_i32 s48, s48, s57
s_add_u32 m0, s71, 40960
s_nop 0
buffer_load_dwordx4 v28, s[36:39], s48 offen lds
v_add_f32 v80, v80, v88
v_add_f32 v81, v81, v89
v_add_f32 v82, v82, v90
v_add_f32 v83, v83, v91
v_add_f32 v84, v84, v92
buffer_load_dwordx4 v29, s[36:39], s48 offen offset:1024 lds
v_add_f32 v85, v85, v93
v_add_f32 v86, v86, v94
v_add_f32 v87, v87, v95
v_add_f32 v80, v80, v84
v_add_f32 v81, v81, v85
s_add_u32 s48, s75, 8
s_and_b32 s48, s48, 15
s_mul_i32 s48, s48, s57
s_add_u32 m0, s71, 49152
s_nop 0
buffer_load_dwordx4 v28, s[36:39], s48 offen lds
v_add_f32 v82, v82, v86
v_add_f32 v83, v83, v87
s_nop 1
v_permlane32_swap_b32 v80, v81
buffer_load_dwordx4 v29, s[36:39], s48 offen offset:1024 lds
v_permlane32_swap_b32 v82, v83
v_add_f32 v80, v80, v81
v_add_f32 v82, v82, v83
s_nop 1
v_permlane16_swap_b32 v80, v82
s_add_u32 s48, s75, 9
s_and_b32 s48, s48, 15
s_mul_i32 s48, s48, s57
s_add_u32 m0, s71, 57344
s_nop 0
buffer_load_dwordx4 v28, s[36:39], s48 offen lds
s_nop 0
v_add_f32 v80, v80, v82
v_cmp_u_f32 vcc, v80, v80
s_cbranch_vccnz again_52
summed_53:
buffer_load_dwordx4 v29, s[36:39], s48 offen offset:1024 lds
v_mul_f32 v44, 0x3a800000, v80
v_mov_b32 v45, v44
s_nop 1
v_permlane16_swap_b32 v44, v45
s_add_u32 s48, s75, 10
s_and_b32 s48, s48, 15
s_mul_i32 s48, s48, s57
s_add_u32 m0, s71, 65536
s_nop 0
buffer_load_dwordx4 v28, s[36:39], s48 offen lds
s_nop 0
v_fma_f32 v45, -v44, v44, v45
v_max_f32 v45, 0, v45
v_add_f32 v45, 0x3727c5ac, v45
v_rsq_f32 v46, v45
buffer_load_dwordx4 v29, s[36:39], s48 offen offset:1024 lds
v_sub_f32 v47, 0, v44
ds_write_b32 v50, v47 offset:512
ds_write_b64 v49, v[46:47]
ds_write_b32 v50, v46
s_setprio 0
s_waitcnt lgkmcnt(0)
s_waitcnt vmcnt(63)
s_barrier
s_waitcnt vmcnt(5)
s_add_u32 s48, s75, 11
s_and_b32 s48, s48, 15
s_mul_i32 s48, s48, s57
s_add_u32 m0, s71, 73728
s_nop 0
buffer_load_dwordx4 v28, s[36:39], s48 offen lds
buffer_load_dwordx4 v29, s[36:39], s48 offen offset:1024 lds
s_waitcnt vmcnt(5)
s_add_u32 s48, s75, 12
s_and_b32 s48, s48, 15
s_mul_i32 s48, s48, s57
s_add_u32 m0, s71, 81920
s_nop 0
buffer_load_dwordx4 v28, s[36:39], s48 offen lds
buffer_load_dwordx4 v29, s[36:39], s48 offen offset:1024 lds
s_waitcnt vmcnt(5)
s_add_u32 s48, s75, 13
s_and_b32 s48, s48, 15
s_mul_i32 s48, s48, s57
s_add_u32 m0, s71, 90112
s_nop 0
buffer_load_dwordx4 v28, s[36:39], s48 offen lds
buffer_load_dwordx4 v29, s[36:39], s48 offen offset:1024 lds
s_waitcnt vmcnt(5)
s_add_u32 s48, s75, 14
s_and_b32 s48, s48, 15
s_mul_i32 s48, s48, s57
s_add_u32 m0, s71, 98304
s_nop 0
buffer_load_dwordx4 v28, s[36:39], s48 offen lds
buffer_load_dwordx4 v29, s[36:39], s48 offen offset:1024 lds
s_waitcnt vmcnt(5)
s_add_u32 s48, s75, 0
s_and_b32 s48, s48, 15
s_mul_i32 s48, s48, s57
s_add_u32 m0, s71, 4294950912
s_nop 0
buffer_load_dwordx4 v28, s[36:39], s48 offen lds
buffer_load_dwordx4 v29, s[36:39], s48 offen offset:1024 lds
s_waitcnt vmcnt(5)
s_add_u32 s48, s75, 1
s_and_b32 s48, s48, 15
s_mul_i32 s48, s48, s57
s_add_u32 m0, s71, 4294959104
s_nop 0
buffer_load_dwordx4 v28, s[36:39], s48 offen lds
buffer_load_dwordx4 v29, s[36:39], s48 offen offset:1024 lds
s_waitcnt vmcnt(5)
s_add_u32 s48, s75, 2
s_and_b32 s48, s48, 15
s_mul_i32 s48, s48, s57
s_add_u32 m0, s71, 0
s_nop 0
buffer_load_dwordx4 v28, s[36:39], s48 offen lds
buffer_load_dwordx4 v29, s[36:39], s48 offen offset:1024 lds
s_waitcnt vmcnt(5)
s_add_u32 s48, s75, 3
s_and_b32 s48, s48, 15
s_mul_i32 s48, s48, s57
s_add_u32 m0, s71, 8192
s_nop 0
buffer_load_dwordx4 v28, s[36:39], s48 offen lds
buffer_load_dwordx4 v29, s[36:39], s48 offen offset:1024 lds
s_waitcnt vmcnt(5)
s_add_u32 s48, s75, 4
s_and_b32 s48, s48, 15
s_mul_i32 s48, s48, s57
s_add_u32 m0, s71, 16384
s_nop 0
buffer_load_dwordx4 v28, s[36:39], s48 offen lds
buffer_load_dwordx4 v29, s[36:39], s48 offen offset:1024 lds
s_waitcnt vmcnt(5)
buffer_load_dwordx4 v[240:243], v18, s[32:35], s81 offen offset:0 sc1
buffer_load_dwordx4 v[240:243], v18, s[32:35], s81 offen offset:1024 sc1
s_waitcnt vmcnt(5)
buffer_load_dwordx4 v[240:243], v18, s[32:35], s82 offen offset:0 sc1
buffer_load_dwordx4 v[240:243], v18, s[32:35], s82 offen offset:1024 sc1
s_waitcnt vmcnt(0) lgkmcnt(0)
s_barrier
L_end:
s_endpgm
L_compute:
s_lshr_b32 s48, s2, 2
s_and_b32 s48, s48, 1
s_lshl_b32 s48, s48, 1
s_add_u32 s48, s48, s74
s_and_b32 s49, s42, 3
s_xor_b32 s77, s48, s49
s_add_u32 s77, s77, 4
s_add_u32 s48, s47, 1
s_and_b32 s48, s48, 3
s_and_b32 s49, s77, 3
s_lshl_b32 s49, s49, 2
s_add_u32 s78, s48, s49
s_and_b32 s48, s2, 7
s_lshl_b32 s48, s48, 1
s_add_u32 s75, s78, s48
s_and_b32 s75, s75, 15
s_mov_b32 s46, 0
s_waitcnt lgkmcnt(0)
s_mov_b32 s32, s22
s_and_b32 s33, s23, 0xffff
s_mov_b32 s34, 268435456
s_mov_b32 s35, 0x00020000
s_mov_b32 s24, s18
s_and_b32 s25, s19, 0xffff
s_mov_b32 s26, 4194304
s_mov_b32 s27, 0x00020000
s_setprio 1
s_and_b32 s43, s40, 1
s_lshr_b32 s44, s40, 1
s_lshl_b32 s45, s42, 1
s_add_u32 s45, s45, s43
s_cmp_lg_u32 s40, 1
s_cbranch_scc1 else_57
s_getpc_b64 s[48:49]
L_pc:
s_sub_u32 s48, s48, L_pc - interleave_layers__sliding_local_dilated__linear_kernel_hedgehog__prompt_kernel
s_subb_u32 s49, s49, 0
s_lshr_b32 s50, s2, 3
s_lshl_b32 s50, s50, 12
v_lshl_add_u32 v8, v0, 6, s50
v_cmp_gt_u32 vcc, L_code_end - interleave_layers__sliding_local_dilated__linear_kernel_hedgehog__prompt_kernel, v8
s_and_saveexec_b64 s[50:51], vcc
s_cbranch_execz nopf_59
global_load_dword v254, v8, s[48:49]
nopf_59:
s_mov_b64 exec, -1
else_57:
s_lshl_b32 s48, s41, 3
s_lshl_b32 s49, s44, 2
s_add_u32 s48, s48, s49
s_lshl_b32 s48, s48, 5
s_add_u32 s48, s48, s45
s_lshl_b32 s48, s48, 10
s_add_u32 s80, s48, 4194304
s_add_u32 s81, s80, 32768
s_add_u32 s82, s80, 65536
s_add_u32 s83, s80, 98304
s_lshl_b32 s84, s41, 2
s_add_u32 s84, s84, s44
s_lshl_b32 s84, s84, 7
s_add_u32 s84, s84, 18350080
s_lshl_b32 s48, s41, 3
s_lshl_b32 s49, s40, 1
s_add_u32 s48, s48, s49
s_lshl_b32 s48, s48, 15
s_lshl_b32 s49, s78, 11
s_add_u32 s85, s48, s49
s_add_u32 s86, s85, 32768
s_lshl_b32 s50, s41, 2
s_add_u32 s50, s50, s40
s_lshl_b32 s50, s50, 4
s_add_u32 s50, s50, s42
s_lshl_b32 s50, s50, 8
s_add_u32 s87, s50, 16777216
s_lshl_b32 s88, s41, 2
s_add_u32 s88, s88, s40
s_lshl_b32 s88, s88, 7
s_add_u32 s88, s88, 18358272
v_lshrrev_b32 v4, 1, v3
v_lshl_add_u32 v4, v2, 2, v4
v_and_b32 v5, 1, v3
v_lshl_add_u32 v4, v5, 1, v4
v_lshlrev_b32 v1, 2, v4
s_lshl_b32 s48, s40, 2
s_add_u32 s48, s48, 134672
v_mov_b32 v10, s48
v_mov_b32 v11, 0
ds_write_b32 v10, v11
v_mov_b32 v140, -1
v_mov_b32 v141, -1
v_mov_b32 v142, -1
v_mov_b32 v143, -1
s_lshl_b32 s50, s42, 2
s_add_u32 s50, s50, s40
s_lshl_b32 s50, s50, 4
s_add_u32 s50, s50, s41
s_lshl_b32 s50, s50, 8
s_add_u32 s50, s50, 17825792
v_mov_b32 v4, s87
v_mov_b32 v5, s50
v_cmp_eq_u32 vcc, 0, v3
v_lshrrev_b32 v6, 1, v3
v_mul_u32_u24 v6, 262144, v6
v_add_u32 v5, v5, v6
v_cndmask_b32 v4, v5, v4, vcc
v_lshl_add_u32 v4, v2, 4, v4
buffer_store_dwordx4 v[140:143], v4, s[32:35], 0 offen sc1
s_lshl_b32 s48, s2, 2
s_add_u32 s49, s48, s40
s_lshl_b32 s48, s49, 10
s_add_u32 s48, s48, 8388608
buffer_store_dwordx4 v[140:143], v18, s[32:35], s48 offen sc1
s_and_b32 s48, s49, 7
s_cmp_lg_u32 s48, 0
s_cbranch_scc1 nofl_60
s_lshl_b32 s48, s49, 5
s_add_u32 s48, s48, 18350080
v_lshlrev_b32 v6, 2, v0
buffer_store_dword v11, v6, s[32:35], s48 offen sc1
nofl_60:
s_lshl_b32 s49, s44, 13
v_lshrrev_b32 v4, 1, v2
v_xor_b32 v4, v4, v3
v_lshlrev_b32 v4, 4, v4
v_lshl_add_u32 v10, v2, 7, v4
v_add_u32 v10, s49, v10
v_xor_b32 v11, 64, v10
s_lshl_b32 s48, s43, 1
v_lshrrev_b32 v4, 2, v2
v_and_b32 v5, 3, v0
v_lshl_add_u32 v6, v3, 3, v4
v_lshlrev_b32 v6, 7, v6
v_lshl_add_u32 v6, v5, 3, v6
v_lshrrev_b32 v7, 1, v4
v_and_b32 v8, 1, v3
v_lshl_add_u32 v7, v8, 1, v7
v_xor_b32 v7, s48, v7
v_lshl_add_u32 v12, v7, 5, v6
v_add_u32 v12, 16384, v12
v_xor_b32 v13, 32, v12
v_mov_b32 v14, v10
v_mov_b32 v15, v11
v_add_u32 v16, 0, v12
v_add_u32 v17, 0, v13
v_mov_b32 v156, 0
v_mov_b32 v157, 0
v_mov_b32 v158, 0
v_mov_b32 v159, 0
v_mov_b32 v160, 0
v_mov_b32 v161, 0
v_mov_b32 v162, 0
v_mov_b32 v163, 0
v_mov_b32 v164, 0
v_mov_b32 v165, 0
v_mov_b32 v166, 0
v_mov_b32 v167, 0
v_mov_b32 v168, 0
v_mov_b32 v169, 0
v_mov_b32 v170, 0
v_mov_b32 v171, 0
v_mov_b32 v172, 0
v_mov_b32 v173, 0
v_mov_b32 v174, 0
v_mov_b32 v175, 0
v_mov_b32 v176, 0
v_mov_b32 v177, 0
v_mov_b32 v178, 0
v_mov_b32 v179, 0
v_mov_b32 v180, 0
v_mov_b32 v181, 0
v_mov_b32 v182, 0
v_mov_b32 v183, 0
v_mov_b32 v184, 0
v_mov_b32 v185, 0
v_mov_b32 v186, 0
v_mov_b32 v187, 0
v_mov_b32 v188, 0
v_mov_b32 v189, 0
v_mov_b32 v190, 0
v_mov_b32 v191, 0
v_mov_b32 v192, 0
v_mov_b32 v193, 0
v_mov_b32 v194, 0
v_mov_b32 v195, 0
v_mov_b32 v196, 0
v_mov_b32 v197, 0
v_mov_b32 v198, 0
v_mov_b32 v199, 0
v_mov_b32 v200, 0
v_mov_b32 v201, 0
v_mov_b32 v202, 0
v_mov_b32 v203, 0
v_mov_b32 v204, 0
v_mov_b32 v205, 0
v_mov_b32 v206, 0
v_mov_b32 v207, 0
v_mov_b32 v208, 0
v_mov_b32 v209, 0
v_mov_b32 v210, 0
v_mov_b32 v211, 0
v_mov_b32 v212, 0
v_mov_b32 v213, 0
v_mov_b32 v214, 0
v_mov_b32 v215, 0
v_mov_b32 v216, 0
v_mov_b32 v217, 0
v_mov_b32 v218, 0
v_mov_b32 v219, 0
v_mov_b32 v220, 0
v_mov_b32 v221, 0
v_mov_b32 v222, 0
v_mov_b32 v223, 0
v_mov_b32 v224, 0
v_mov_b32 v225, 0
v_mov_b32 v226, 0
v_mov_b32 v227, 0
v_mov_b32 v228, 0
v_mov_b32 v229, 0
v_mov_b32 v230, 0
v_mov_b32 v231, 0
v_mov_b32 v232, 0
v_mov_b32 v233, 0
v_mov_b32 v234, 0
v_mov_b32 v235, 0
v_mov_b32 v236, 0
v_mov_b32 v237, 0
v_mov_b32 v238, 0
v_mov_b32 v239, 0
v_mov_b32 v240, 0
v_mov_b32 v241, 0
v_mov_b32 v242, 0
v_mov_b32 v243, 0
v_mov_b32 v244, 0
v_mov_b32 v245, 0
v_mov_b32 v246, 0
v_mov_b32 v247, 0
v_mov_b32 v248, 0
v_mov_b32 v249, 0
v_mov_b32 v250, 0
v_mov_b32 v251, 0
v_mov_b32 v48, 0x3f803f80
v_mov_b32 v49, 0x3f803f80
v_mov_b32 v50, 0x3f803f80
v_mov_b32 v51, 0x3f803f80
s_mov_b32 s48, 0xf149f2ca
v_mov_b32 v9, s48
v_lshlrev_b32 v4, 2, v3
v_sub_u32 v4, v2, v4
v_subrev_u32 v5, 0, v4
v_and_b32 v6, 0x80000001, v5
v_cmp_eq_u32 vcc, 0, v6
v_add_u32 v5, 1, v5
v_and_b32 v6, 0x80000001, v5
v_cndmask_b32 v40, v9, 0, vcc
v_cmp_eq_u32 vcc, 0x80000001, v6
s_nop 1
v_cndmask_b32 v36, v9, 0, vcc
v_subrev_u32 v5, 1, v4
v_and_b32 v6, 0x80000001, v5
v_cmp_eq_u32 vcc, 0, v6
v_add_u32 v5, 1, v5
v_and_b32 v6, 0x80000001, v5
v_cndmask_b32 v41, v9, 0, vcc
v_cmp_eq_u32 vcc, 0x80000001, v6
s_nop 1
v_cndmask_b32 v37, v9, 0, vcc
v_subrev_u32 v5, 2, v4
v_and_b32 v6, 0x80000001, v5
v_cmp_eq_u32 vcc, 0, v6
v_add_u32 v5, 1, v5
v_and_b32 v6, 0x80000001, v5
v_cndmask_b32 v42, v9, 0, vcc
v_cmp_eq_u32 vcc, 0x80000001, v6
s_nop 1
v_cndmask_b32 v38, v9, 0, vcc
v_subrev_u32 v5, 3, v4
v_and_b32 v6, 0x80000001, v5
v_cmp_eq_u32 vcc, 0, v6
v_add_u32 v5, 1, v5
v_and_b32 v6, 0x80000001, v5
v_cndmask_b32 v43, v9, 0, vcc
v_cmp_eq_u32 vcc, 0x80000001, v6
s_nop 1
v_cndmask_b32 v39, v9, 0, vcc
s_or_b32 s48, s41, s44
s_cmp_eq_u32 s48, 0
s_cselect_b64 vcc, -1, 0
v_cndmask_b32 v44, v36, v9, vcc
v_cndmask_b32 v45, v37, v9, vcc
v_cndmask_b32 v46, v38, v9, vcc
v_cndmask_b32 v47, v39, v9, vcc
v_and_b32 v4, 1, v2
v_lshlrev_b32 v4, 4, v4
v_mov_b32 v5, 0xffff
v_lshlrev_b32 v52, v4, v5
s_lshl_b32 s48, s43, 11
s_add_u32 s48, s48, 135168
v_add_u32 v53, s48, v18
v_lshl_add_u32 v55, v0, 3, s48
s_add_u32 s48, s41, s44
s_sub_u32 s48, s48, 1
s_lshl_b32 s49, s48, 1
s_add_u32 s49, s49, s43
s_lshl_b32 s49, s49, 11
s_mul_i32 s50, s42, 65536
s_add_u32 s49, s49, s50
s_add_u32 s49, s49, 8388608
s_cmp_lt_i32 s48, 0
s_cselect_b32 s49, 0xf0000000, s49
v_add_u32 v58, s49, v18
v_lshl_add_u32 v59, v0, 3, s49
s_lshl_b32 s48, s43, 2
s_add_u32 s48, s48, 134672
v_mov_b32 v19, s48
s_lshl_b32 s48, s43, 7
s_add_u32 s48, s48, 133120
v_lshl_add_u32 v7, v3, 4, s48
v_lshl_add_u32 v54, v2, 2, s48
s_lshl_b32 s49, s44, 6
v_add_u32 v8, s49, v2
v_lshlrev_b32 v8, 3, v8
v_add_u32 v8, 131072, v8
v_lshl_add_u32 v9, v3, 2, s49
v_lshlrev_b32 v9, 2, v9
v_add_u32 v9, 132096, v9
s_mov_b32 s64, 0
s_mov_b32 s65, 0
s_mov_b32 s66, 0x3e8293ee
s_lshl_b32 s50, s42, 2
s_add_u32 s50, s50, s40
s_lshl_b32 s50, s50, 4
s_add_u32 s50, s50, s41
s_lshl_b32 s50, s50, 8
s_add_u32 s52, s50, 17825792
v_lshrrev_b32 v4, 1, v2
v_lshrrev_b32 v5, 1, v3
v_xor_b32 v4, v4, v5
v_lshlrev_b32 v4, 4, v4
v_and_b32 v5, 1, v3
v_lshl_add_u32 v4, v5, 3, v4
v_lshl_add_u32 v4, v2, 7, v4
s_lshl_b32 s48, s40, 12
v_add_u32 v155, s48, v4
v_mov_b32 v152, 0
v_mov_b32 v153, 0
v_mov_b32 v56, 0
v_mov_b32 v57, 0
s_waitcnt vmcnt(0)
s_lshl_b32 s79, 1, s77
s_or_b32 s79, s79, 0
s_barrier
ds_read_b128 v[60:63], v14 offset:0
ds_read_b128 v[64:67], v14 offset:2048
ds_read_b128 v[68:71], v14 offset:4096
ds_read_b128 v[72:75], v14 offset:6144
ds_read_b64_tr_b16 v[84:85], v16 offset:8192
ds_read_b64_tr_b16 v[86:87], v16 offset:8704
ds_read_b64_tr_b16 v[88:89], v17 offset:8192
ds_read_b64_tr_b16 v[90:91], v17 offset:8704
ds_read_b64_tr_b16 v[92:93], v16 offset:16384
ds_read_b64_tr_b16 v[94:95], v16 offset:16896
ds_read_b64_tr_b16 v[96:97], v17 offset:16384
ds_read_b64_tr_b16 v[98:99], v17 offset:16896
ds_read_b64_tr_b16 v[76:77], v16 offset:0
ds_read_b64_tr_b16 v[78:79], v16 offset:512
ds_read_b64_tr_b16 v[80:81], v17 offset:0
ds_read_b64_tr_b16 v[82:83], v17 offset:512
s_waitcnt lgkmcnt(0)
c0_loop:
v_mfma_f32_16x16x32_bf16 v[212:215], v[84:87], v[72:75], v[212:215]
ds_read_b128 v[100:103], v15 offset:0
v_mfma_f32_16x16x32_bf16 v[204:207], v[84:87], v[68:71], v[204:207]
ds_read_b128 v[104:107], v15 offset:2048
v_mfma_f32_16x16x32_bf16 v[196:199], v[84:87], v[64:67], v[196:199]
ds_read_b128 v[108:111], v15 offset:4096
v_mfma_f32_16x16x32_bf16 v[188:191], v[84:87], v[60:63], v[188:191]
ds_read_b128 v[112:115], v15 offset:6144
v_mfma_f32_16x16x32_bf16 v[192:195], v[88:91], v[60:63], v[192:195]
ds_read_b64_tr_b16 v[124:125], v16 offset:12288
v_mfma_f32_16x16x32_bf16 v[200:203], v[88:91], v[64:67], v[200:203]
ds_read_b64_tr_b16 v[126:127], v16 offset:12800
v_mfma_f32_16x16x32_bf16 v[208:211], v[88:91], v[68:71], v[208:211]
ds_read_b64_tr_b16 v[128:129], v17 offset:12288
v_mfma_f32_16x16x32_bf16 v[216:219], v[88:91], v[72:75], v[216:219]
ds_read_b64_tr_b16 v[130:131], v17 offset:12800
v_mfma_f32_16x16x32_bf16 v[244:247], v[72:75], v[92:95], v[244:247]
ds_read_b64_tr_b16 v[132:133], v16 offset:20480
v_mfma_f32_16x16x32_bf16 v[248:251], v[72:75], v[96:99], v[248:251]
ds_read_b64_tr_b16 v[134:135], v16 offset:20992
v_mfma_f32_16x16x32_bf16 v[240:243], v[68:71], v[96:99], v[240:243]
ds_read_b64_tr_b16 v[136:137], v17 offset:20480
v_mfma_f32_16x16x32_bf16 v[236:239], v[68:71], v[92:95], v[236:239]
ds_read_b64_tr_b16 v[138:139], v17 offset:20992
v_mfma_f32_16x16x32_bf16 v[228:231], v[64:67], v[92:95], v[228:231]
ds_read_b64_tr_b16 v[116:117], v16 offset:4096
v_mfma_f32_16x16x32_bf16 v[232:235], v[64:67], v[96:99], v[232:235]
ds_read_b64_tr_b16 v[118:119], v16 offset:4608
v_mfma_f32_16x16x32_bf16 v[224:227], v[60:63], v[96:99], v[224:227]
ds_read_b64_tr_b16 v[120:121], v17 offset:4096
v_mfma_f32_16x16x32_bf16 v[220:223], v[60:63], v[92:95], v[220:223]
ds_read_b64_tr_b16 v[122:123], v17 offset:4608
v_mfma_f32_16x16x32_bf16 v[156:159], v[76:79], v[60:63], v[156:159]
s_bitcmp1_b32 s79, s64
s_cbranch_scc1 c0_hook
c0_hook_ret:
v_mfma_f32_16x16x32_bf16 v[164:167], v[76:79], v[64:67], v[164:167]
s_add_u32 s65, s65, 40960
s_cmp_eq_u32 s65, 122880
v_mfma_f32_16x16x32_bf16 v[172:175], v[76:79], v[68:71], v[172:175]
s_cselect_b32 s65, 0, s65
s_add_u32 s64, s64, 1
v_mfma_f32_16x16x32_bf16 v[180:183], v[76:79], v[72:75], v[180:183]
v_add_u32 v14, s65, v10
v_add_u32 v15, s65, v11
v_mfma_f32_16x16x32_bf16 v[184:187], v[80:83], v[72:75], v[184:187]
v_add_u32 v16, s65, v12
v_add_u32 v17, s65, v13
v_mfma_f32_16x16x32_bf16 v[176:179], v[80:83], v[68:71], v[176:179]
s_cmp_eq_u32 s64, 16
s_cbranch_scc1 c0_last
v_mfma_f32_16x16x32_bf16 v[168:171], v[80:83], v[64:67], v[168:171]
s_waitcnt lgkmcnt(0)
v_mfma_f32_16x16x32_bf16 v[160:163], v[80:83], v[60:63], v[160:163]
s_barrier
v_mfma_f32_16x16x32_bf16 v[212:215], v[124:127], v[112:115], v[212:215]
ds_read_b128 v[60:63], v14 offset:0
v_mfma_f32_16x16x32_bf16 v[204:207], v[124:127], v[108:111], v[204:207]
ds_read_b128 v[64:67], v14 offset:2048
v_mfma_f32_16x16x32_bf16 v[196:199], v[124:127], v[104:107], v[196:199]
ds_read_b128 v[68:71], v14 offset:4096
v_mfma_f32_16x16x32_bf16 v[188:191], v[124:127], v[100:103], v[188:191]
ds_read_b128 v[72:75], v14 offset:6144
v_mfma_f32_16x16x32_bf16 v[192:195], v[128:131], v[100:103], v[192:195]
ds_read_b64_tr_b16 v[84:85], v16 offset:8192
v_mfma_f32_16x16x32_bf16 v[200:203], v[128:131], v[104:107], v[200:203]
ds_read_b64_tr_b16 v[86:87], v16 offset:8704
v_mfma_f32_16x16x32_bf16 v[208:211], v[128:131], v[108:111], v[208:211]
ds_read_b64_tr_b16 v[88:89], v17 offset:8192
v_mfma_f32_16x16x32_bf16 v[216:219], v[128:131], v[112:115], v[216:219]
ds_read_b64_tr_b16 v[90:91], v17 offset:8704
v_mfma_f32_16x16x32_bf16 v[244:247], v[112:115], v[132:135], v[244:247]
ds_read_b64_tr_b16 v[92:93], v16 offset:16384
v_mfma_f32_16x16x32_bf16 v[248:251], v[112:115], v[136:139], v[248:251]
ds_read_b64_tr_b16 v[94:95], v16 offset:16896
v_mfma_f32_16x16x32_bf16 v[240:243], v[108:111], v[136:139], v[240:243]
ds_read_b64_tr_b16 v[96:97], v17 offset:16384
v_mfma_f32_16x16x32_bf16 v[236:239], v[108:111], v[132:135], v[236:239]
ds_read_b64_tr_b16 v[98:99], v17 offset:16896
v_mfma_f32_16x16x32_bf16 v[228:231], v[104:107], v[132:135], v[228:231]
ds_read_b64_tr_b16 v[76:77], v16 offset:0
v_mfma_f32_16x16x32_bf16 v[232:235], v[104:107], v[136:139], v[232:235]
ds_read_b64_tr_b16 v[78:79], v16 offset:512
v_mfma_f32_16x16x32_bf16 v[224:227], v[100:103], v[136:139], v[224:227]
ds_read_b64_tr_b16 v[80:81], v17 offset:0
v_mfma_f32_16x16x32_bf16 v[220:223], v[100:103], v[132:135], v[220:223]
ds_read_b64_tr_b16 v[82:83], v17 offset:512
v_mfma_f32_16x16x32_bf16 v[156:159], v[116:119], v[100:103], v[156:159]
v_mfma_f32_16x16x32_bf16 v[164:167], v[116:119], v[104:107], v[164:167]
v_mfma_f32_16x16x32_bf16 v[172:175], v[116:119], v[108:111], v[172:175]
v_mfma_f32_16x16x32_bf16 v[180:183], v[116:119], v[112:115], v[180:183]
v_mfma_f32_16x16x32_bf16 v[184:187], v[120:123], v[112:115], v[184:187]
v_mfma_f32_16x16x32_bf16 v[176:179], v[120:123], v[108:111], v[176:179]
v_mfma_f32_16x16x32_bf16 v[168:171], v[120:123], v[104:107], v[168:171]
s_waitcnt lgkmcnt(0)
v_mfma_f32_16x16x32_bf16 v[160:163], v[120:123], v[100:103], v[160:163]
s_branch c0_loop
c0_hook:
v_add_u32 v4, s65, v155
ds_read_b64 v[20:21], v4 offset:0
ds_read_b64 v[28:29], v4 offset:2048
v_xor_b32 v5, 32, v4
ds_read_b64 v[22:23], v5 offset:0
ds_read_b64 v[30:31], v5 offset:2048
v_xor_b32 v5, 64, v4
ds_read_b64 v[24:25], v5 offset:0
ds_read_b64 v[32:33], v5 offset:2048
v_xor_b32 v5, 96, v4
ds_read_b64 v[26:27], v5 offset:0
ds_read_b64 v[34:35], v5 offset:2048
s_waitcnt lgkmcnt(8)
s_cmp_lg_u32 s44, 0
s_cbranch_scc1 else_61
v_mfma_f32_16x16x32_bf16 v[140:143], v[48:51], v[76:79], 0
v_mfma_f32_16x16x32_bf16 v[144:147], v[48:51], v[84:87], 0
v_mfma_f32_16x16x32_bf16 v[148:151], v[48:51], v[92:95], 0
v_mfma_f32_16x16x32_bf16 v[140:143], v[48:51], v[116:119], v[140:143]
v_mfma_f32_16x16x32_bf16 v[144:147], v[48:51], v[124:127], v[144:147]
v_mfma_f32_16x16x32_bf16 v[148:151], v[48:51], v[132:135], v[148:151]
s_branch fi_62
else_61:
v_mfma_f32_16x16x32_bf16 v[140:143], v[48:51], v[80:83], 0
v_mfma_f32_16x16x32_bf16 v[144:147], v[48:51], v[88:91], 0
v_mfma_f32_16x16x32_bf16 v[148:151], v[48:51], v[96:99], 0
v_mfma_f32_16x16x32_bf16 v[140:143], v[48:51], v[120:123], v[140:143]
v_mfma_f32_16x16x32_bf16 v[144:147], v[48:51], v[128:131], v[144:147]
v_mfma_f32_16x16x32_bf16 v[148:151], v[48:51], v[136:139], v[148:151]
fi_62:
s_waitcnt lgkmcnt(0)
v_dot2c_f32_bf16 v152, v20, v48
v_dot2c_f32_bf16 v56, v20, v20
v_dot2c_f32_bf16 v153, v28, v48
v_dot2c_f32_bf16 v57, v28, v28
v_dot2c_f32_bf16 v152, v21, v48
v_dot2c_f32_bf16 v56, v21, v21
v_dot2c_f32_bf16 v153, v29, v48
v_dot2c_f32_bf16 v57, v29, v29
v_dot2c_f32_bf16 v152, v22, v48
v_dot2c_f32_bf16 v56, v22, v22
v_dot2c_f32_bf16 v153, v30, v48
v_dot2c_f32_bf16 v57, v30, v30
v_dot2c_f32_bf16 v152, v23, v48
v_dot2c_f32_bf16 v56, v23, v23
v_dot2c_f32_bf16 v153, v31, v48
v_dot2c_f32_bf16 v57, v31, v31
v_dot2c_f32_bf16 v152, v24, v48
v_dot2c_f32_bf16 v56, v24, v24
v_dot2c_f32_bf16 v153, v32, v48
v_dot2c_f32_bf16 v57, v32, v32
v_dot2c_f32_bf16 v152, v25, v48
v_dot2c_f32_bf16 v56, v25, v25
v_dot2c_f32_bf16 v153, v33, v48
v_dot2c_f32_bf16 v57, v33, v33
v_dot2c_f32_bf16 v152, v26, v48
v_dot2c_f32_bf16 v56, v26, v26
v_dot2c_f32_bf16 v153, v34, v48
v_dot2c_f32_bf16 v57, v34, v34
v_dot2c_f32_bf16 v152, v27, v48
v_dot2c_f32_bf16 v56, v27, v27
v_dot2c_f32_bf16 v153, v35, v48
v_dot2c_f32_bf16 v57, v35, v35
v_cmp_eq_u32 vcc, 0, v3
v_cmp_eq_u32 s[48:49], 1, v3
s_nop 1
v_cndmask_b32 v4, v148, v144, s[48:49]
v_cndmask_b32 v4, v4, v140, vcc
buffer_store_dword v4, v1, s[32:35], s52 offen sc1
s_nop 1
v_permlane32_swap_b32 v152, v153
v_permlane32_swap_b32 v56, v57
v_add_f32 v152, v152, v153
v_add_f32 v56, v56, v57
s_nop 1
v_permlane16_swap_b32 v152, v56
s_nop 0
v_add_f32 v152, v152, v56
buffer_store_dword v152, v1, s[32:35], s87 offen sc1
s_branch c0_hook_ret
c0_last:
v_mfma_f32_16x16x32_bf16 v[168:171], v[80:83], v[64:67], v[168:171]
s_waitcnt lgkmcnt(0)
v_mfma_f32_16x16x32_bf16 v[160:163], v[80:83], v[60:63], v[160:163]
v_mfma_f32_16x16x32_bf16 v[212:215], v[124:127], v[112:115], v[212:215]
v_mfma_f32_16x16x32_bf16 v[204:207], v[124:127], v[108:111], v[204:207]
v_mfma_f32_16x16x32_bf16 v[196:199], v[124:127], v[104:107], v[196:199]
v_mfma_f32_16x16x32_bf16 v[188:191], v[124:127], v[100:103], v[188:191]
v_mfma_f32_16x16x32_bf16 v[192:195], v[128:131], v[100:103], v[192:195]
v_mfma_f32_16x16x32_bf16 v[200:203], v[128:131], v[104:107], v[200:203]
v_mfma_f32_16x16x32_bf16 v[208:211], v[128:131], v[108:111], v[208:211]
v_mfma_f32_16x16x32_bf16 v[216:219], v[128:131], v[112:115], v[216:219]
s_barrier
v_mfma_f32_16x16x32_bf16 v[244:247], v[112:115], v[132:135], v[244:247]
ds_read_b128 v[140:143], v7 offset:0
ds_read_b128 v[144:147], v7 offset:64
v_mfma_f32_16x16x32_bf16 v[248:251], v[112:115], v[136:139], v[248:251]
ds_read_b128 v[148:151], v7 offset:256
ds_read_b128 v[152:155], v7 offset:320
v_mfma_f32_16x16x32_bf16 v[240:243], v[108:111], v[136:139], v[240:243]
ds_read_b64 v[92:93], v8 offset:0
ds_read_b64 v[94:95], v8 offset:128
v_mfma_f32_16x16x32_bf16 v[236:239], v[108:111], v[132:135], v[236:239]
ds_read_b64 v[96:97], v8 offset:256
ds_read_b64 v[98:99], v8 offset:384
v_mfma_f32_16x16x32_bf16 v[228:231], v[104:107], v[132:135], v[228:231]
ds_read2_b32 v[56:57], v54 offset0:128 offset1:144
ds_read_b128 v[60:63], v9 offset:0
v_mfma_f32_16x16x32_bf16 v[232:235], v[104:107], v[136:139], v[232:235]
ds_read_b128 v[64:67], v9 offset:64
v_mfma_f32_16x16x32_bf16 v[224:227], v[100:103], v[136:139], v[224:227]
ds_read_b128 v[68:71], v9 offset:128
v_mfma_f32_16x16x32_bf16 v[220:223], v[100:103], v[132:135], v[220:223]
ds_read_b128 v[72:75], v9 offset:192
v_mfma_f32_16x16x32_bf16 v[156:159], v[116:119], v[100:103], v[156:159]
ds_read_b128 v[76:79], v9 offset:512
v_mfma_f32_16x16x32_bf16 v[164:167], v[116:119], v[104:107], v[164:167]
ds_read_b128 v[80:83], v9 offset:576
v_mfma_f32_16x16x32_bf16 v[172:175], v[116:119], v[108:111], v[172:175]
ds_read_b128 v[84:87], v9 offset:640
v_mfma_f32_16x16x32_bf16 v[180:183], v[116:119], v[112:115], v[180:183]
ds_read_b128 v[88:91], v9 offset:704
v_mfma_f32_16x16x32_bf16 v[184:187], v[120:123], v[112:115], v[184:187]
v_mov_b32 v6, 134656
ds_read_b32 v6, v6
v_mfma_f32_16x16x32_bf16 v[176:179], v[120:123], v[108:111], v[176:179]
v_mfma_f32_16x16x32_bf16 v[168:171], v[120:123], v[104:107], v[168:171]
v_mfma_f32_16x16x32_bf16 v[160:163], v[120:123], v[100:103], v[160:163]
c0_epi:
s_waitcnt lgkmcnt(0)
v_readfirstlane_b32 s46, v6
.p2align 3
v_pk_fma_f32 v[212:213], v[148:149], v[98:99], v[212:213] op_sel:[0,1,0] op_sel_hi:[1,1,1]
v_pk_fma_f32 v[214:215], v[150:151], v[98:99], v[214:215] op_sel:[0,1,0] op_sel_hi:[1,1,1]
v_pk_fma_f32 v[216:217], v[152:153], v[98:99], v[216:217] op_sel:[0,1,0] op_sel_hi:[1,1,1]
v_pk_fma_f32 v[218:219], v[154:155], v[98:99], v[218:219] op_sel:[0,1,0] op_sel_hi:[1,1,1]
v_pk_mul_f32 v[212:213], v[212:213], v[98:99] op_sel:[0,0] op_sel_hi:[1,0]
v_pk_mul_f32 v[214:215], v[214:215], v[98:99] op_sel:[0,0] op_sel_hi:[1,0]
v_pk_mul_f32 v[216:217], v[216:217], v[98:99] op_sel:[0,0] op_sel_hi:[1,0]
v_pk_mul_f32 v[218:219], v[218:219], v[98:99] op_sel:[0,0] op_sel_hi:[1,0]
v_cvt_pk_bf16_f32 v212, v212, v213
v_cvt_pk_bf16_f32 v213, v214, v215
v_cvt_pk_bf16_f32 v214, v216, v217
v_cvt_pk_bf16_f32 v215, v218, v219
v_pk_fma_f32 v[244:245], v[88:89], v[56:57], v[244:245] op_sel:[0,0,0] op_sel_hi:[1,0,1]
v_pk_fma_f32 v[246:247], v[90:91], v[56:57], v[246:247] op_sel:[0,0,0] op_sel_hi:[1,0,1]
v_pk_mul_f32 v[244:245], v[244:245], v[72:73]
v_pk_mul_f32 v[246:247], v[246:247], v[74:75]
v_cvt_pk_bf16_f32 v108, v244, v245
v_cvt_pk_bf16_f32 v109, v246, v247
v_pk_fma_f32 v[248:249], v[88:89], v[56:57], v[248:249] op_sel:[0,1,0] op_sel_hi:[1,1,1]
v_pk_fma_f32 v[250:251], v[90:91], v[56:57], v[250:251] op_sel:[0,1,0] op_sel_hi:[1,1,1]
v_pk_mul_f32 v[248:249], v[248:249], v[72:73]
v_pk_mul_f32 v[250:251], v[250:251], v[74:75]
v_cvt_pk_bf16_f32 v118, v248, v249
v_cvt_pk_bf16_f32 v119, v250, v251
s_cmp_lg_u32 s44, 1
s_cbranch_scc1 else_63
buffer_store_dwordx4 v[212:215], v58, s[32:35], 0 offen sc1
buffer_store_dwordx2 v[108:109], v59, s[32:35], 0 offen offset:1024 sc1
buffer_store_dwordx2 v[118:119], v59, s[32:35], 0 offen offset:1536 sc1
s_branch fi_64
else_63:
ds_write_b128 v53, v[212:215]
ds_write_b64 v55, v[108:109] offset:1024
ds_write_b64 v55, v[118:119] offset:1536
v_mov_b32 v4, 1
ds_write_b32 v19, v4
fi_64:
.p2align 3
v_pk_fma_f32 v[188:189], v[148:149], v[92:93], v[188:189] op_sel:[0,1,0] op_sel_hi:[1,1,1]
v_pk_fma_f32 v[196:197], v[148:149], v[94:95], v[196:197] op_sel:[0,1,0] op_sel_hi:[1,1,1]
v_pk_fma_f32 v[204:205], v[148:149], v[96:97], v[204:205] op_sel:[0,1,0] op_sel_hi:[1,1,1]
v_pk_fma_f32 v[164:165], v[140:141], v[94:95], v[164:165] op_sel:[0,1,0] op_sel_hi:[1,1,1]
v_pk_fma_f32 v[172:173], v[140:141], v[96:97], v[172:173] op_sel:[0,1,0] op_sel_hi:[1,1,1]
v_pk_fma_f32 v[180:181], v[140:141], v[98:99], v[180:181] op_sel:[0,1,0] op_sel_hi:[1,1,1]
v_pk_fma_f32 v[190:191], v[150:151], v[92:93], v[190:191] op_sel:[0,1,0] op_sel_hi:[1,1,1]
v_pk_mul_f32 v[188:189], v[188:189], v[92:93] op_sel:[0,0] op_sel_hi:[1,0]
v_pk_fma_f32 v[198:199], v[150:151], v[94:95], v[198:199] op_sel:[0,1,0] op_sel_hi:[1,1,1]
v_pk_mul_f32 v[196:197], v[196:197], v[94:95] op_sel:[0,0] op_sel_hi:[1,0]
v_pk_fma_f32 v[206:207], v[150:151], v[96:97], v[206:207] op_sel:[0,1,0] op_sel_hi:[1,1,1]
v_pk_mul_f32 v[204:205], v[204:205], v[96:97] op_sel:[0,0] op_sel_hi:[1,0]
v_pk_fma_f32 v[166:167], v[142:143], v[94:95], v[166:167] op_sel:[0,1,0] op_sel_hi:[1,1,1]
v_cvt_pk_bf16_f32 v164, v164, v165
v_pk_fma_f32 v[174:175], v[142:143], v[96:97], v[174:175] op_sel:[0,1,0] op_sel_hi:[1,1,1]
v_cvt_pk_bf16_f32 v172, v172, v173
v_pk_fma_f32 v[182:183], v[142:143], v[98:99], v[182:183] op_sel:[0,1,0] op_sel_hi:[1,1,1]
v_cvt_pk_bf16_f32 v180, v180, v181
v_pk_fma_f32 v[192:193], v[152:153], v[92:93], v[192:193] op_sel:[0,1,0] op_sel_hi:[1,1,1]
v_pk_fma_f32 v[194:195], v[154:155], v[92:93], v[194:195] op_sel:[0,1,0] op_sel_hi:[1,1,1]
v_pk_mul_f32 v[190:191], v[190:191], v[92:93] op_sel:[0,0] op_sel_hi:[1,0]
v_cvt_pk_bf16_f32 v188, v188, v189
v_pk_fma_f32 v[200:201], v[152:153], v[94:95], v[200:201] op_sel:[0,1,0] op_sel_hi:[1,1,1]
v_pk_fma_f32 v[202:203], v[154:155], v[94:95], v[202:203] op_sel:[0,1,0] op_sel_hi:[1,1,1]
v_pk_mul_f32 v[198:199], v[198:199], v[94:95] op_sel:[0,0] op_sel_hi:[1,0]
v_cvt_pk_bf16_f32 v196, v196, v197
v_pk_fma_f32 v[208:209], v[152:153], v[96:97], v[208:209] op_sel:[0,1,0] op_sel_hi:[1,1,1]
v_pk_fma_f32 v[210:211], v[154:155], v[96:97], v[210:211] op_sel:[0,1,0] op_sel_hi:[1,1,1]
v_pk_mul_f32 v[206:207], v[206:207], v[96:97] op_sel:[0,0] op_sel_hi:[1,0]
v_cvt_pk_bf16_f32 v204, v204, v205
v_pk_fma_f32 v[168:169], v[144:145], v[94:95], v[168:169] op_sel:[0,1,0] op_sel_hi:[1,1,1]
v_pk_fma_f32 v[170:171], v[146:147], v[94:95], v[170:171] op_sel:[0,1,0] op_sel_hi:[1,1,1]
v_cvt_pk_bf16_f32 v165, v166, v167
v_pk_fma_f32 v[176:177], v[144:145], v[96:97], v[176:177] op_sel:[0,1,0] op_sel_hi:[1,1,1]
v_pk_fma_f32 v[178:179], v[146:147], v[96:97], v[178:179] op_sel:[0,1,0] op_sel_hi:[1,1,1]
v_cvt_pk_bf16_f32 v173, v174, v175
v_pk_fma_f32 v[184:185], v[144:145], v[98:99], v[184:185] op_sel:[0,1,0] op_sel_hi:[1,1,1]
v_pk_fma_f32 v[186:187], v[146:147], v[98:99], v[186:187] op_sel:[0,1,0] op_sel_hi:[1,1,1]
v_cvt_pk_bf16_f32 v181, v182, v183
v_pk_mul_f32 v[192:193], v[192:193], v[92:93] op_sel:[0,0] op_sel_hi:[1,0]
v_pk_mul_f32 v[194:195], v[194:195], v[92:93] op_sel:[0,0] op_sel_hi:[1,0]
v_cvt_pk_bf16_f32 v189, v190, v191
v_pk_mul_f32 v[200:201], v[200:201], v[94:95] op_sel:[0,0] op_sel_hi:[1,0]
v_pk_mul_f32 v[202:203], v[202:203], v[94:95] op_sel:[0,0] op_sel_hi:[1,0]
v_cvt_pk_bf16_f32 v197, v198, v199
v_pk_mul_f32 v[208:209], v[208:209], v[96:97] op_sel:[0,0] op_sel_hi:[1,0]
v_pk_mul_f32 v[210:211], v[210:211], v[96:97] op_sel:[0,0] op_sel_hi:[1,0]
v_cvt_pk_bf16_f32 v205, v206, v207
v_cvt_pk_bf16_f32 v166, v168, v169
v_cvt_pk_bf16_f32 v167, v170, v171
v_cvt_pk_bf16_f32 v174, v176, v177
v_cvt_pk_bf16_f32 v175, v178, v179
v_cvt_pk_bf16_f32 v182, v184, v185
v_cvt_pk_bf16_f32 v183, v186, v187
v_cvt_pk_bf16_f32 v190, v192, v193
v_cvt_pk_bf16_f32 v191, v194, v195
v_mfma_f32_16x16x32_bf16 v[216:219], v[212:215], v[180:183], v[40:43]
v_cvt_pk_bf16_f32 v198, v200, v201
v_cvt_pk_bf16_f32 v199, v202, v203
v_mfma_f32_16x16x32_bf16 v[168:171], v[188:191], v[164:167], v[36:39]
v_cvt_pk_bf16_f32 v206, v208, v209
v_cvt_pk_bf16_f32 v207, v210, v211
v_mfma_f32_16x16x32_bf16 v[200:203], v[196:199], v[164:167], v[40:43]
v_mul_f32 v124, s66, v92
v_mul_f32 v125, s66, v94
v_mfma_f32_16x16x32_bf16 v[208:211], v[204:207], v[172:175], v[40:43]
v_mul_f32 v126, s66, v96
v_mul_f32 v127, s66, v98
v_mfma_f32_16x16x32_bf16 v[176:179], v[196:199], v[172:175], v[36:39]
v_max_f32 v164, v168, v169
v_max_f32 v165, v170, v171
v_mfma_f32_16x16x32_bf16 v[184:187], v[204:207], v[180:183], v[36:39]
v_max_f32 v166, v200, v201
v_max_f32 v182, v216, v217
v_max_f32 v174, v208, v209
v_max_f32 v167, v202, v203
v_max3_f32 v129, v164, v165, v166
v_pk_fma_f32 v[156:157], v[140:141], v[92:93], v[156:157] op_sel:[0,1,0] op_sel_hi:[1,1,1]
v_pk_fma_f32 v[158:159], v[142:143], v[92:93], v[158:159] op_sel:[0,1,0] op_sel_hi:[1,1,1]
v_cvt_pk_bf16_f32 v156, v156, v157
v_pk_fma_f32 v[160:161], v[144:145], v[92:93], v[160:161] op_sel:[0,1,0] op_sel_hi:[1,1,1]
v_pk_fma_f32 v[162:163], v[146:147], v[92:93], v[162:163] op_sel:[0,1,0] op_sel_hi:[1,1,1]
v_cvt_pk_bf16_f32 v157, v158, v159
v_cvt_pk_bf16_f32 v158, v160, v161
v_cvt_pk_bf16_f32 v159, v162, v163
v_pk_fma_f32 v[220:221], v[76:77], v[56:57], v[220:221] op_sel:[0,0,0] op_sel_hi:[1,0,1]
v_pk_fma_f32 v[222:223], v[78:79], v[56:57], v[222:223] op_sel:[0,0,0] op_sel_hi:[1,0,1]
v_mfma_f32_16x16x32_bf16 v[192:195], v[188:191], v[156:159], v[40:43]
v_max_f32 v172, v176, v177
v_max_f32 v173, v178, v179
v_max_f32 v180, v184, v185
v_max_f32 v181, v186, v187
v_max_f32_e64 v175, v210, v211
v_pk_fma_f32 v[224:225], v[76:77], v[56:57], v[224:225] op_sel:[0,1,0] op_sel_hi:[1,1,1]
v_pk_fma_f32 v[226:227], v[78:79], v[56:57], v[226:227] op_sel:[0,1,0] op_sel_hi:[1,1,1]
v_pk_fma_f32 v[228:229], v[80:81], v[56:57], v[228:229] op_sel:[0,0,0] op_sel_hi:[1,0,1]
v_pk_fma_f32 v[230:231], v[82:83], v[56:57], v[230:231] op_sel:[0,0,0] op_sel_hi:[1,0,1]
v_pk_fma_f32 v[232:233], v[80:81], v[56:57], v[232:233] op_sel:[0,1,0] op_sel_hi:[1,1,1]
v_pk_fma_f32 v[234:235], v[82:83], v[56:57], v[234:235] op_sel:[0,1,0] op_sel_hi:[1,1,1]
v_pk_fma_f32 v[236:237], v[84:85], v[56:57], v[236:237] op_sel:[0,0,0] op_sel_hi:[1,0,1]
v_pk_fma_f32 v[238:239], v[86:87], v[56:57], v[238:239] op_sel:[0,0,0] op_sel_hi:[1,0,1]
v_pk_fma_f32 v[240:241], v[84:85], v[56:57], v[240:241] op_sel:[0,1,0] op_sel_hi:[1,1,1]
v_pk_fma_f32 v[242:243], v[86:87], v[56:57], v[242:243] op_sel:[0,1,0] op_sel_hi:[1,1,1]
v_pk_mul_f32 v[220:221], v[220:221], v[60:61]
v_pk_mul_f32 v[222:223], v[222:223], v[62:63]
v_pk_mul_f32 v[224:225], v[224:225], v[60:61]
s_cmp_lg_u32 s44, 0
s_cbranch_scc1 else_65
buffer_load_dwordx4 v[120:123], v58, s[32:35], 0 offen sc1
buffer_load_dwordx2 v[100:101], v59, s[32:35], 0 offen offset:1024 sc1
buffer_load_dwordx2 v[110:111], v59, s[32:35], 0 offen offset:1536 sc1
else_65:
v_pk_mul_f32 v[226:227], v[226:227], v[62:63]
v_pk_mul_f32 v[228:229], v[228:229], v[64:65]
v_pk_mul_f32 v[230:231], v[230:231], v[66:67]
v_pk_mul_f32 v[232:233], v[232:233], v[64:65]
v_pk_mul_f32 v[234:235], v[234:235], v[66:67]
v_pk_mul_f32 v[236:237], v[236:237], v[68:69]
v_pk_mul_f32 v[238:239], v[238:239], v[70:71]
v_pk_mul_f32 v[240:241], v[240:241], v[68:69]
v_pk_mul_f32 v[242:243], v[242:243], v[70:71]
v_max3_f32 v130, v172, v173, v174
v_max_f32_e64 v183, v218, v219
v_max3_f32 v131, v180, v181, v182
v_cvt_pk_bf16_f32 v102, v220, v221
v_cvt_pk_bf16_f32 v103, v222, v223
v_cvt_pk_bf16_f32 v112, v224, v225
v_cvt_pk_bf16_f32 v113, v226, v227
v_cvt_pk_bf16_f32 v104, v228, v229
v_cvt_pk_bf16_f32 v105, v230, v231
v_cvt_pk_bf16_f32 v114, v232, v233
v_cvt_pk_bf16_f32 v115, v234, v235
v_cvt_pk_bf16_f32 v106, v236, v237
v_cvt_pk_bf16_f32 v107, v238, v239
v_cvt_pk_bf16_f32 v116, v240, v241
v_cvt_pk_bf16_f32 v117, v242, v243
v_max_f32 v129, v129, v167
v_max_f32 v130, v130, v175
v_max_f32 v131, v131, v183
s_cmp_lg_u32 s44, 0
s_cbranch_scc1 else_67
s_mov_b32 s63, 0
sent_69:
s_waitcnt vmcnt(0)
v_max_u32 v4, v120, v121
v_max3_u32 v4, v4, v122, v123
v_max3_u32 v4, v4, v100, v101
v_max3_u32 v4, v4, v110, v111
v_cmp_eq_u32 vcc, -1, v4
s_cbranch_vccz sentd_70
buffer_load_dwordx4 v[120:123], v58, s[32:35], 0 offen sc1
buffer_load_dwordx2 v[100:101], v59, s[32:35], 0 offen offset:1024 sc1
buffer_load_dwordx2 v[110:111], v59, s[32:35], 0 offen offset:1536 sc1
s_add_u32 s63, s63, 1
s_cmp_lt_u32 s63, 0x80000
s_cbranch_scc1 sent_69
s_waitcnt vmcnt(0)
sentd_70:
v_mov_b32 v132, -1
v_mov_b32 v133, -1
v_mov_b32 v134, -1
v_mov_b32 v135, -1
buffer_store_dwordx4 v[132:135], v58, s[32:35], 0 offen offset:0 sc1
buffer_store_dwordx4 v[132:135], v58, s[32:35], 0 offen offset:1024 sc1
s_branch fi_68
else_67:
s_mov_b32 s63, 0
px_71:
ds_read_b32 v4, v19
ds_read_b128 v[120:123], v53
ds_read_b64 v[100:101], v55 offset:1024
ds_read_b64 v[110:111], v55 offset:1536
s_add_u32 s63, s63, 1
s_cmp_lt_u32 s63, 0x400000
s_waitcnt lgkmcnt(0)
v_cmp_ne_u32 vcc, 1, v4
s_cbranch_vccz pxd_72
s_cbranch_scc1 px_71
pxd_72:
fi_68:
s_cmp_eq_u32 s46, 0
s_cbranch_scc1 slow_73
.p2align 3
v_mfma_f32_16x16x32_bf16 v[160:163], v[120:123], v[156:159], v[44:47]
v_max_f32 v158, v192, v193
v_max_f32 v159, v194, v195
v_permlane32_swap_b32 v130, v131
s_nop 0
v_max_f32 v130, v130, v131
s_nop 2
v_max_f32 v156, v160, v161
v_max_f32 v157, v162, v163
v_max3_f32 v128, v156, v157, v158
v_max_f32 v128, v128, v159
s_nop 1
v_permlane32_swap_b32 v128, v129
s_nop 0
v_max_f32 v128, v128, v129
s_nop 1
v_permlane16_swap_b32 v128, v130
s_nop 0
v_max_f32 v128, v128, v130
v_mov_b32 v130, v128
s_nop 1
v_permlane16_swap_b32 v128, v130
s_nop 0
v_mov_b32 v129, v128
v_mov_b32 v131, v130
s_nop 0
v_permlane32_swap_b32 v128, v129
v_permlane32_swap_b32 v130, v131
v_mul_f32 v128, v128, v124
v_mul_f32 v129, v129, v125
v_pk_fma_f32 v[156:157], v[156:157], v[124:125], v[128:129] op_sel:[0,0,0] op_sel_hi:[1,0,0] neg_lo:[0,0,1] neg_hi:[0,0,1]
v_pk_fma_f32 v[158:159], v[158:159], v[124:125], v[128:129] op_sel:[0,0,0] op_sel_hi:[1,0,0] neg_lo:[0,0,1] neg_hi:[0,0,1]
v_mul_f32 v130, v130, v126
v_mul_f32 v131, v131, v127
v_exp_f32 v156, v156
v_exp_f32 v157, v157
v_exp_f32 v158, v158
v_exp_f32 v159, v159
v_pk_fma_f32 v[164:165], v[164:165], v[124:125], v[128:129] op_sel:[0,1,1] op_sel_hi:[1,1,1] neg_lo:[0,0,1] neg_hi:[0,0,1]
v_pk_fma_f32 v[166:167], v[166:167], v[124:125], v[128:129] op_sel:[0,1,1] op_sel_hi:[1,1,1] neg_lo:[0,0,1] neg_hi:[0,0,1]
v_exp_f32 v164, v164
v_exp_f32 v165, v165
v_exp_f32 v166, v166
v_exp_f32 v167, v167
v_pk_fma_f32 v[172:173], v[172:173], v[126:127], v[130:131] op_sel:[0,0,0] op_sel_hi:[1,0,0] neg_lo:[0,0,1] neg_hi:[0,0,1]
v_pk_fma_f32 v[174:175], v[174:175], v[126:127], v[130:131] op_sel:[0,0,0] op_sel_hi:[1,0,0] neg_lo:[0,0,1] neg_hi:[0,0,1]
v_cvt_pk_bf16_f32 v156, v156, v156
v_cvt_pk_bf16_f32 v157, v157, v157
v_cvt_pk_bf16_f32 v158, v158, v158
v_cvt_pk_bf16_f32 v159, v159, v159
v_exp_f32 v172, v172
v_exp_f32 v173, v173
v_exp_f32 v174, v174
v_exp_f32 v175, v175
v_pk_fma_f32 v[180:181], v[180:181], v[126:127], v[130:131] op_sel:[0,1,1] op_sel_hi:[1,1,1] neg_lo:[0,0,1] neg_hi:[0,0,1]
v_pk_fma_f32 v[182:183], v[182:183], v[126:127], v[130:131] op_sel:[0,1,1] op_sel_hi:[1,1,1] neg_lo:[0,0,1] neg_hi:[0,0,1]
v_and_b32 v156, v52, v156
v_and_b32 v157, v52, v157
v_and_b32 v158, v52, v158
v_and_b32 v159, v52, v159
v_cvt_pk_bf16_f32 v164, v164, v164
v_cvt_pk_bf16_f32 v165, v165, v165
v_mfma_f32_16x16x32_bf16 v[160:163], v[48:51], v[156:159], 0
v_cvt_pk_bf16_f32 v166, v166, v166
v_cvt_pk_bf16_f32 v167, v167, v167
v_mfma_f32_16x16x32_bf16 v[220:223], v[100:103], v[156:159], 0
v_exp_f32 v180, v180
v_mfma_f32_16x16x32_bf16 v[224:227], v[110:113], v[156:159], 0
v_exp_f32 v181, v181
v_exp_f32 v182, v182
v_exp_f32 v183, v183
v_and_b32 v164, v52, v164
v_and_b32 v165, v52, v165
v_and_b32 v166, v52, v166
v_and_b32 v167, v52, v167
v_cvt_pk_bf16_f32 v172, v172, v172
v_cvt_pk_bf16_f32 v173, v173, v173
v_mfma_f32_16x16x32_bf16 v[168:171], v[48:51], v[164:167], 0
v_cvt_pk_bf16_f32 v174, v174, v174
v_cvt_pk_bf16_f32 v175, v175, v175
v_mfma_f32_16x16x32_bf16 v[228:231], v[102:105], v[164:167], 0
v_and_b32 v172, v52, v172
v_and_b32 v173, v52, v173
v_mfma_f32_16x16x32_bf16 v[232:235], v[112:115], v[164:167], 0
v_and_b32 v174, v52, v174
v_and_b32 v175, v52, v175
v_cvt_pk_bf16_f32 v180, v180, v180
v_cvt_pk_bf16_f32 v181, v181, v181
v_mfma_f32_16x16x32_bf16 v[176:179], v[48:51], v[172:175], 0
v_cvt_pk_bf16_f32 v182, v182, v182
v_cvt_pk_bf16_f32 v183, v183, v183
v_mfma_f32_16x16x32_bf16 v[236:239], v[104:107], v[172:175], 0
v_and_b32 v180, v52, v180
v_and_b32 v181, v52, v181
v_mfma_f32_16x16x32_bf16 v[240:243], v[114:117], v[172:175], 0
v_and_b32 v182, v52, v182
v_and_b32 v183, v52, v183
v_rcp_f32 v160, v160
v_rcp_f32 v168, v168
v_pk_mul_f32 v[220:221], v[220:221], v[160:161] op_sel:[0,0] op_sel_hi:[1,0]
v_pk_mul_f32 v[222:223], v[222:223], v[160:161] op_sel:[0,0] op_sel_hi:[1,0]
v_pk_mul_f32 v[228:229], v[228:229], v[168:169] op_sel:[0,0] op_sel_hi:[1,0]
v_pk_mul_f32 v[224:225], v[224:225], v[160:161] op_sel:[0,0] op_sel_hi:[1,0]
v_pk_mul_f32 v[226:227], v[226:227], v[160:161] op_sel:[0,0] op_sel_hi:[1,0]
v_pk_mul_f32 v[230:231], v[230:231], v[168:169] op_sel:[0,0] op_sel_hi:[1,0]
v_pk_mul_f32 v[232:233], v[232:233], v[168:169] op_sel:[0,0] op_sel_hi:[1,0]
v_pk_mul_f32 v[234:235], v[234:235], v[168:169] op_sel:[0,0] op_sel_hi:[1,0]
v_mfma_f32_16x16x32_bf16 v[184:187], v[48:51], v[180:183], 0
v_rcp_f32_e64 v176, v176
v_cvt_pk_bf16_f32 v220, v220, v221
v_cvt_pk_bf16_f32 v221, v222, v223
v_cvt_pk_bf16_f32 v228, v228, v229
v_pk_mul_f32 v[236:237], v[236:237], v[176:177] op_sel:[0,0] op_sel_hi:[1,0]
v_mfma_f32_16x16x32_bf16 v[244:247], v[106:109], v[180:183], 0
v_cvt_pk_bf16_f32 v222, v224, v225
v_cvt_pk_bf16_f32 v223, v226, v227
v_rcp_f32_e64 v184, v184
v_cvt_pk_bf16_f32 v229, v230, v231
v_pk_mul_f32 v[238:239], v[238:239], v[176:177] op_sel:[0,0] op_sel_hi:[1,0]
v_pk_mul_f32 v[240:241], v[240:241], v[176:177] op_sel:[0,0] op_sel_hi:[1,0]
v_pk_mul_f32 v[242:243], v[242:243], v[176:177] op_sel:[0,0] op_sel_hi:[1,0]
v_cvt_pk_bf16_f32 v236, v236, v237
v_pk_mul_f32 v[244:245], v[244:245], v[184:185] op_sel:[0,0] op_sel_hi:[1,0]
v_pk_mul_f32 v[246:247], v[246:247], v[184:185] op_sel:[0,0] op_sel_hi:[1,0]
v_mfma_f32_16x16x32_bf16 v[248:251], v[116:119], v[180:183], 0
buffer_store_dwordx4 v[220:223], v18, s[32:35], s80 offen sc1
v_cvt_pk_bf16_f32 v230, v232, v233
v_cvt_pk_bf16_f32 v231, v234, v235
v_cvt_pk_bf16_f32 v237, v238, v239
v_cvt_pk_bf16_f32 v244, v244, v245
buffer_store_dwordx4 v[228:231], v18, s[32:35], s81 offen sc1
v_cvt_pk_bf16_f32 v238, v240, v241
v_cvt_pk_bf16_f32 v239, v242, v243
v_pk_mul_f32 v[248:249], v[248:249], v[184:185] op_sel:[0,0] op_sel_hi:[1,0]
v_pk_mul_f32 v[250:251], v[250:251], v[184:185] op_sel:[0,0] op_sel_hi:[1,0]
v_cvt_pk_bf16_f32 v245, v246, v247
buffer_store_dwordx4 v[236:239], v18, s[32:35], s82 offen sc1
v_cvt_pk_bf16_f32 v246, v248, v249
v_cvt_pk_bf16_f32 v247, v250, v251
buffer_store_dwordx4 v[244:247], v18, s[32:35], s83 offen sc1
back_74:
s_barrier
v_and_b32 v36, 31, v0
v_lshlrev_b32 v36, 2, v36
s_lshl_b32 s62, s45, 2
v_mov_b32 v4, s62
v_mov_b32 v5, 1
s_mov_b64 exec, 1
s_waitcnt vmcnt(0)
s_cmp_eq_u32 s46, 0
s_cbranch_scc1 slow_75
buffer_store_dword v5, v4, s[32:35], s84 offen
back_76:
s_mov_b64 exec, -1
v_lshrrev_b32 v4, 2, v2
v_and_b32 v5, 3, v0
v_lshl_add_u32 v6, v3, 3, v4
v_lshlrev_b32 v6, 7, v6
v_lshl_add_u32 v6, v5, 3, v6
v_lshrrev_b32 v7, 1, v4
v_and_b32 v8, 1, v3
v_lshl_add_u32 v7, v8, 1, v7
v_lshl_add_u32 v10, v7, 5, v6
v_xor_b32 v11, 32, v10
v_xor_b32 v12, 64, v10
v_xor_b32 v13, 96, v10
v_add_u32 v14, 0x10000, v10
v_add_u32 v15, 0x10000, v11
v_add_u32 v16, 0x10000, v12
v_add_u32 v17, 0x10000, v13
ds_read_b64_tr_b16 v[220:221], v10 offset:0
ds_read_b64_tr_b16 v[222:223], v10 offset:512
ds_read_b64_tr_b16 v[224:225], v11 offset:0
ds_read_b64_tr_b16 v[226:227], v11 offset:512
ds_read_b64_tr_b16 v[228:229], v12 offset:0
ds_read_b64_tr_b16 v[230:231], v12 offset:512
ds_read_b64_tr_b16 v[232:233], v13 offset:0
ds_read_b64_tr_b16 v[234:235], v13 offset:512
ds_read_b64_tr_b16 v[236:237], v10 offset:4096
ds_read_b64_tr_b16 v[238:239], v10 offset:4608
ds_read_b64_tr_b16 v[240:241], v11 offset:4096
ds_read_b64_tr_b16 v[242:243], v11 offset:4608
ds_read_b64_tr_b16 v[244:245], v12 offset:4096
ds_read_b64_tr_b16 v[246:247], v12 offset:4608
ds_read_b64_tr_b16 v[248:249], v13 offset:4096
ds_read_b64_tr_b16 v[250:251], v13 offset:4608
s_lshl_b32 s48, s41, 3
s_lshl_b32 s49, s40, 1
s_add_u32 s48, s48, s49
s_lshl_b32 s48, s48, 15
s_add_u32 s48, s48, 4194304
v_add_u32 v38, s48, v18
v_add_u32 v39, 32768, v38
s_lshl_b32 s57, s75, 11
s_add_u32 s87, s87, 262144
v_lshlrev_b32 v60, 16, v20
v_and_b32 v61, 0xffff0000, v20
v_lshlrev_b32 v62, 16, v21
v_and_b32 v63, 0xffff0000, v21
v_lshlrev_b32 v64, 16, v22
v_and_b32 v65, 0xffff0000, v22
v_lshlrev_b32 v66, 16, v23
v_and_b32 v67, 0xffff0000, v23
v_lshlrev_b32 v68, 16, v24
v_and_b32 v69, 0xffff0000, v24
v_lshlrev_b32 v70, 16, v25
v_and_b32 v71, 0xffff0000, v25
v_lshlrev_b32 v72, 16, v26
v_and_b32 v73, 0xffff0000, v26
v_lshlrev_b32 v74, 16, v27
v_and_b32 v75, 0xffff0000, v27
v_lshlrev_b32 v76, 16, v28
v_and_b32 v77, 0xffff0000, v28
v_lshlrev_b32 v78, 16, v29
v_and_b32 v79, 0xffff0000, v29
v_lshlrev_b32 v80, 16, v30
v_and_b32 v81, 0xffff0000, v30
v_lshlrev_b32 v82, 16, v31
v_and_b32 v83, 0xffff0000, v31
v_lshlrev_b32 v84, 16, v32
v_and_b32 v85, 0xffff0000, v32
v_lshlrev_b32 v86, 16, v33
v_and_b32 v87, 0xffff0000, v33
v_lshlrev_b32 v88, 16, v34
v_and_b32 v89, 0xffff0000, v34
v_lshlrev_b32 v90, 16, v35
v_and_b32 v91, 0xffff0000, v35
v_mov_b32 v6, 0
v_mov_b32 v7, 0
v_mov_b32 v8, 0
v_mov_b32 v9, 0
s_lshl_b32 s62, s42, 2
v_mov_b32 v4, s62
v_mov_b32 v5, 1
buffer_load_dword v37, v36, s[32:35], s84 offen sc1
s_mov_b32 s63, 0
s_waitcnt vmcnt(0)
poll_77:
v_cmp_gt_u32 vcc, 1, v37
s_cbranch_vccz polled_78
buffer_load_dword v37, v36, s[32:35], s84 offen sc1
s_add_u32 s63, s63, 1
s_cmp_lt_u32 s63, 0x80000
s_waitcnt vmcnt(0)
s_cbranch_scc1 poll_77
polled_78:
buffer_load_dwordx4 v[156:159], v38, s[32:35], s57 offen sc1
buffer_load_dwordx4 v[160:163], v39, s[32:35], s57 offen sc1
buffer_load_dwordx4 v[164:167], v38, s[32:35], s57 offen offset:1024 sc1
buffer_load_dwordx4 v[168:171], v39, s[32:35], s57 offen offset:1024 sc1
s_add_u32 s57, s57, 2048
s_and_b32 s57, s57, 0x7fff
buffer_load_dwordx4 v[172:175], v38, s[32:35], s57 offen sc1
buffer_load_dwordx4 v[176:179], v39, s[32:35], s57 offen sc1
buffer_load_dwordx4 v[180:183], v38, s[32:35], s57 offen offset:1024 sc1
buffer_load_dwordx4 v[184:187], v39, s[32:35], s57 offen offset:1024 sc1
s_add_u32 s57, s57, 2048
s_and_b32 s57, s57, 0x7fff
s_waitcnt vmcnt(6) lgkmcnt(8)
v_mfma_f32_16x16x32_bf16 v[60:63], v[220:223], v[156:159], v[60:63]
buffer_load_dwordx4 v[188:191], v38, s[32:35], s57 offen sc1
v_mfma_f32_16x16x32_bf16 v[76:79], v[220:223], v[160:163], v[76:79]
ds_read_b64_tr_b16 v[100:101], v10 offset:8192
ds_read_b64_tr_b16 v[102:103], v10 offset:8704
v_mfma_f32_16x16x32_bf16 v[80:83], v[224:227], v[160:163], v[80:83]
ds_read_b64_tr_b16 v[104:105], v11 offset:8192
ds_read_b64_tr_b16 v[106:107], v11 offset:8704
v_mfma_f32_16x16x32_bf16 v[64:67], v[224:227], v[156:159], v[64:67]
buffer_load_dwordx4 v[192:195], v39, s[32:35], s57 offen sc1
v_mfma_f32_16x16x32_bf16 v[68:71], v[228:231], v[156:159], v[68:71]
ds_read_b64_tr_b16 v[108:109], v12 offset:8192
ds_read_b64_tr_b16 v[110:111], v12 offset:8704
v_mfma_f32_16x16x32_bf16 v[84:87], v[228:231], v[160:163], v[84:87]
ds_read_b64_tr_b16 v[112:113], v13 offset:8192
ds_read_b64_tr_b16 v[114:115], v13 offset:8704
v_mfma_f32_16x16x32_bf16 v[88:91], v[232:235], v[160:163], v[88:91]
v_mfma_f32_16x16x32_bf16 v[72:75], v[232:235], v[156:159], v[72:75]
s_waitcnt vmcnt(6) lgkmcnt(8)
v_mfma_f32_16x16x32_bf16 v[60:63], v[236:239], v[164:167], v[60:63]
buffer_load_dwordx4 v[196:199], v38, s[32:35], s57 offen offset:1024 sc1
v_mfma_f32_16x16x32_bf16 v[76:79], v[236:239], v[168:171], v[76:79]
ds_read_b64_tr_b16 v[220:221], v10 offset:12288
ds_read_b64_tr_b16 v[222:223], v10 offset:12800
v_mfma_f32_16x16x32_bf16 v[80:83], v[240:243], v[168:171], v[80:83]
ds_read_b64_tr_b16 v[224:225], v11 offset:12288
ds_read_b64_tr_b16 v[226:227], v11 offset:12800
v_mfma_f32_16x16x32_bf16 v[64:67], v[240:243], v[164:167], v[64:67]
buffer_load_dwordx4 v[200:203], v39, s[32:35], s57 offen offset:1024 sc1
v_mfma_f32_16x16x32_bf16 v[68:71], v[244:247], v[164:167], v[68:71]
ds_read_b64_tr_b16 v[228:229], v12 offset:12288
ds_read_b64_tr_b16 v[230:231], v12 offset:12800
v_mfma_f32_16x16x32_bf16 v[84:87], v[244:247], v[168:171], v[84:87]
ds_read_b64_tr_b16 v[232:233], v13 offset:12288
ds_read_b64_tr_b16 v[234:235], v13 offset:12800
v_mfma_f32_16x16x32_bf16 v[88:91], v[248:251], v[168:171], v[88:91]
s_add_u32 s57, s57, 2048
s_and_b32 s57, s57, 0x7fff
v_mfma_f32_16x16x32_bf16 v[72:75], v[248:251], v[164:167], v[72:75]
s_waitcnt vmcnt(6) lgkmcnt(8)
v_mfma_f32_16x16x32_bf16 v[60:63], v[100:103], v[172:175], v[60:63]
buffer_load_dwordx4 v[204:207], v38, s[32:35], s57 offen sc1
v_mfma_f32_16x16x32_bf16 v[76:79], v[100:103], v[176:179], v[76:79]
ds_read_b64_tr_b16 v[236:237], v10 offset:16384
ds_read_b64_tr_b16 v[238:239], v10 offset:16896
v_mfma_f32_16x16x32_bf16 v[80:83], v[104:107], v[176:179], v[80:83]
ds_read_b64_tr_b16 v[240:241], v11 offset:16384
ds_read_b64_tr_b16 v[242:243], v11 offset:16896
v_mfma_f32_16x16x32_bf16 v[64:67], v[104:107], v[172:175], v[64:67]
buffer_load_dwordx4 v[208:211], v39, s[32:35], s57 offen sc1
v_mfma_f32_16x16x32_bf16 v[68:71], v[108:111], v[172:175], v[68:71]
ds_read_b64_tr_b16 v[244:245], v12 offset:16384
ds_read_b64_tr_b16 v[246:247], v12 offset:16896
v_mfma_f32_16x16x32_bf16 v[84:87], v[108:111], v[176:179], v[84:87]
ds_read_b64_tr_b16 v[248:249], v13 offset:16384
ds_read_b64_tr_b16 v[250:251], v13 offset:16896
v_mfma_f32_16x16x32_bf16 v[88:91], v[112:115], v[176:179], v[88:91]
v_mfma_f32_16x16x32_bf16 v[72:75], v[112:115], v[172:175], v[72:75]
s_waitcnt vmcnt(6) lgkmcnt(8)
v_mfma_f32_16x16x32_bf16 v[60:63], v[220:223], v[180:183], v[60:63]
buffer_load_dwordx4 v[212:215], v38, s[32:35], s57 offen offset:1024 sc1
v_mfma_f32_16x16x32_bf16 v[76:79], v[220:223], v[184:187], v[76:79]
ds_read_b64_tr_b16 v[100:101], v10 offset:20480
ds_read_b64_tr_b16 v[102:103], v10 offset:20992
v_mfma_f32_16x16x32_bf16 v[80:83], v[224:227], v[184:187], v[80:83]
ds_read_b64_tr_b16 v[104:105], v11 offset:20480
ds_read_b64_tr_b16 v[106:107], v11 offset:20992
v_mfma_f32_16x16x32_bf16 v[64:67], v[224:227], v[180:183], v[64:67]
buffer_load_dwordx4 v[216:219], v39, s[32:35], s57 offen offset:1024 sc1
v_mfma_f32_16x16x32_bf16 v[68:71], v[228:231], v[180:183], v[68:71]
ds_read_b64_tr_b16 v[108:109], v12 offset:20480
ds_read_b64_tr_b16 v[110:111], v12 offset:20992
v_mfma_f32_16x16x32_bf16 v[84:87], v[228:231], v[184:187], v[84:87]
ds_read_b64_tr_b16 v[112:113], v13 offset:20480
ds_read_b64_tr_b16 v[114:115], v13 offset:20992
v_mfma_f32_16x16x32_bf16 v[88:91], v[232:235], v[184:187], v[88:91]
s_add_u32 s57, s57, 2048
s_and_b32 s57, s57, 0x7fff
v_mfma_f32_16x16x32_bf16 v[72:75], v[232:235], v[180:183], v[72:75]
s_waitcnt vmcnt(6) lgkmcnt(8)
v_mfma_f32_16x16x32_bf16 v[60:63], v[236:239], v[188:191], v[60:63]
buffer_load_dwordx4 v[156:159], v38, s[32:35], s57 offen sc1
v_mfma_f32_16x16x32_bf16 v[76:79], v[236:239], v[192:195], v[76:79]
ds_read_b64_tr_b16 v[220:221], v10 offset:24576
ds_read_b64_tr_b16 v[222:223], v10 offset:25088
v_mfma_f32_16x16x32_bf16 v[80:83], v[240:243], v[192:195], v[80:83]
ds_read_b64_tr_b16 v[224:225], v11 offset:24576
ds_read_b64_tr_b16 v[226:227], v11 offset:25088
v_mfma_f32_16x16x32_bf16 v[64:67], v[240:243], v[188:191], v[64:67]
buffer_load_dwordx4 v[160:163], v39, s[32:35], s57 offen sc1
v_mfma_f32_16x16x32_bf16 v[68:71], v[244:247], v[188:191], v[68:71]
ds_read_b64_tr_b16 v[228:229], v12 offset:24576
ds_read_b64_tr_b16 v[230:231], v12 offset:25088
v_mfma_f32_16x16x32_bf16 v[84:87], v[244:247], v[192:195], v[84:87]
ds_read_b64_tr_b16 v[232:233], v13 offset:24576
ds_read_b64_tr_b16 v[234:235], v13 offset:25088
v_mfma_f32_16x16x32_bf16 v[88:91], v[248:251], v[192:195], v[88:91]
v_mfma_f32_16x16x32_bf16 v[72:75], v[248:251], v[188:191], v[72:75]
s_waitcnt vmcnt(6) lgkmcnt(8)
v_mfma_f32_16x16x32_bf16 v[60:63], v[100:103], v[196:199], v[60:63]
buffer_load_dwordx4 v[164:167], v38, s[32:35], s57 offen offset:1024 sc1
v_mfma_f32_16x16x32_bf16 v[76:79], v[100:103], v[200:203], v[76:79]
ds_read_b64_tr_b16 v[236:237], v10 offset:28672
ds_read_b64_tr_b16 v[238:239], v10 offset:29184
v_mfma_f32_16x16x32_bf16 v[80:83], v[104:107], v[200:203], v[80:83]
ds_read_b64_tr_b16 v[240:241], v11 offset:28672
ds_read_b64_tr_b16 v[242:243], v11 offset:29184
v_mfma_f32_16x16x32_bf16 v[64:67], v[104:107], v[196:199], v[64:67]
buffer_load_dwordx4 v[168:171], v39, s[32:35], s57 offen offset:1024 sc1
v_mfma_f32_16x16x32_bf16 v[68:71], v[108:111], v[196:199], v[68:71]
ds_read_b64_tr_b16 v[244:245], v12 offset:28672
ds_read_b64_tr_b16 v[246:247], v12 offset:29184
v_mfma_f32_16x16x32_bf16 v[84:87], v[108:111], v[200:203], v[84:87]
ds_read_b64_tr_b16 v[248:249], v13 offset:28672
ds_read_b64_tr_b16 v[250:251], v13 offset:29184
v_mfma_f32_16x16x32_bf16 v[88:91], v[112:115], v[200:203], v[88:91]
s_add_u32 s57, s57, 2048
s_and_b32 s57, s57, 0x7fff
v_mfma_f32_16x16x32_bf16 v[72:75], v[112:115], v[196:199], v[72:75]
s_waitcnt vmcnt(6) lgkmcnt(8)
v_mfma_f32_16x16x32_bf16 v[60:63], v[220:223], v[204:207], v[60:63]
buffer_load_dwordx4 v[172:175], v38, s[32:35], s57 offen sc1
v_mfma_f32_16x16x32_bf16 v[76:79], v[220:223], v[208:211], v[76:79]
ds_read_b64_tr_b16 v[100:101], v10 offset:32768
ds_read_b64_tr_b16 v[102:103], v10 offset:33280
v_mfma_f32_16x16x32_bf16 v[80:83], v[224:227], v[208:211], v[80:83]
ds_read_b64_tr_b16 v[104:105], v11 offset:32768
ds_read_b64_tr_b16 v[106:107], v11 offset:33280
v_mfma_f32_16x16x32_bf16 v[64:67], v[224:227], v[204:207], v[64:67]
buffer_load_dwordx4 v[176:179], v39, s[32:35], s57 offen sc1
v_mfma_f32_16x16x32_bf16 v[68:71], v[228:231], v[204:207], v[68:71]
ds_read_b64_tr_b16 v[108:109], v12 offset:32768
ds_read_b64_tr_b16 v[110:111], v12 offset:33280
v_mfma_f32_16x16x32_bf16 v[84:87], v[228:231], v[208:211], v[84:87]
ds_read_b64_tr_b16 v[112:113], v13 offset:32768
ds_read_b64_tr_b16 v[114:115], v13 offset:33280
v_mfma_f32_16x16x32_bf16 v[88:91], v[232:235], v[208:211], v[88:91]
v_mfma_f32_16x16x32_bf16 v[72:75], v[232:235], v[204:207], v[72:75]
s_waitcnt vmcnt(6) lgkmcnt(8)
v_mfma_f32_16x16x32_bf16 v[60:63], v[236:239], v[212:215], v[60:63]
buffer_load_dwordx4 v[180:183], v38, s[32:35], s57 offen offset:1024 sc1
v_mfma_f32_16x16x32_bf16 v[76:79], v[236:239], v[216:219], v[76:79]
ds_read_b64_tr_b16 v[220:221], v10 offset:36864
ds_read_b64_tr_b16 v[222:223], v10 offset:37376
v_mfma_f32_16x16x32_bf16 v[80:83], v[240:243], v[216:219], v[80:83]
ds_read_b64_tr_b16 v[224:225], v11 offset:36864
ds_read_b64_tr_b16 v[226:227], v11 offset:37376
v_mfma_f32_16x16x32_bf16 v[64:67], v[240:243], v[212:215], v[64:67]
buffer_load_dwordx4 v[184:187], v39, s[32:35], s57 offen offset:1024 sc1
v_mfma_f32_16x16x32_bf16 v[68:71], v[244:247], v[212:215], v[68:71]
ds_read_b64_tr_b16 v[228:229], v12 offset:36864
ds_read_b64_tr_b16 v[230:231], v12 offset:37376
v_mfma_f32_16x16x32_bf16 v[84:87], v[244:247], v[216:219], v[84:87]
ds_read_b64_tr_b16 v[232:233], v13 offset:36864
ds_read_b64_tr_b16 v[234:235], v13 offset:37376
v_mfma_f32_16x16x32_bf16 v[88:91], v[248:251], v[216:219], v[88:91]
s_add_u32 s57, s57, 2048
s_and_b32 s57, s57, 0x7fff
v_mfma_f32_16x16x32_bf16 v[72:75], v[248:251], v[212:215], v[72:75]
s_waitcnt vmcnt(6) lgkmcnt(8)
v_mfma_f32_16x16x32_bf16 v[60:63], v[100:103], v[156:159], v[60:63]
buffer_load_dwordx4 v[188:191], v38, s[32:35], s57 offen sc1
v_mfma_f32_16x16x32_bf16 v[76:79], v[100:103], v[160:163], v[76:79]
ds_read_b64_tr_b16 v[236:237], v10 offset:40960
ds_read_b64_tr_b16 v[238:239], v10 offset:41472
v_mfma_f32_16x16x32_bf16 v[80:83], v[104:107], v[160:163], v[80:83]
ds_read_b64_tr_b16 v[240:241], v11 offset:40960
ds_read_b64_tr_b16 v[242:243], v11 offset:41472
v_mfma_f32_16x16x32_bf16 v[64:67], v[104:107], v[156:159], v[64:67]
buffer_load_dwordx4 v[192:195], v39, s[32:35], s57 offen sc1
v_mfma_f32_16x16x32_bf16 v[68:71], v[108:111], v[156:159], v[68:71]
ds_read_b64_tr_b16 v[244:245], v12 offset:40960
ds_read_b64_tr_b16 v[246:247], v12 offset:41472
v_mfma_f32_16x16x32_bf16 v[84:87], v[108:111], v[160:163], v[84:87]
ds_read_b64_tr_b16 v[248:249], v13 offset:40960
ds_read_b64_tr_b16 v[250:251], v13 offset:41472
v_mfma_f32_16x16x32_bf16 v[88:91], v[112:115], v[160:163], v[88:91]
v_mfma_f32_16x16x32_bf16 v[72:75], v[112:115], v[156:159], v[72:75]
s_waitcnt vmcnt(6) lgkmcnt(8)
v_mfma_f32_16x16x32_bf16 v[60:63], v[220:223], v[164:167], v[60:63]
buffer_load_dwordx4 v[196:199], v38, s[32:35], s57 offen offset:1024 sc1
v_mfma_f32_16x16x32_bf16 v[76:79], v[220:223], v[168:171], v[76:79]
ds_read_b64_tr_b16 v[100:101], v10 offset:45056
ds_read_b64_tr_b16 v[102:103], v10 offset:45568
v_mfma_f32_16x16x32_bf16 v[80:83], v[224:227], v[168:171], v[80:83]
ds_read_b64_tr_b16 v[104:105], v11 offset:45056
ds_read_b64_tr_b16 v[106:107], v11 offset:45568
v_mfma_f32_16x16x32_bf16 v[64:67], v[224:227], v[164:167], v[64:67]
buffer_load_dwordx4 v[200:203], v39, s[32:35], s57 offen offset:1024 sc1
v_mfma_f32_16x16x32_bf16 v[68:71], v[228:231], v[164:167], v[68:71]
ds_read_b64_tr_b16 v[108:109], v12 offset:45056
ds_read_b64_tr_b16 v[110:111], v12 offset:45568
v_mfma_f32_16x16x32_bf16 v[84:87], v[228:231], v[168:171], v[84:87]
ds_read_b64_tr_b16 v[112:113], v13 offset:45056
ds_read_b64_tr_b16 v[114:115], v13 offset:45568
v_mfma_f32_16x16x32_bf16 v[88:91], v[232:235], v[168:171], v[88:91]
s_add_u32 s57, s57, 2048
s_and_b32 s57, s57, 0x7fff
v_mfma_f32_16x16x32_bf16 v[72:75], v[232:235], v[164:167], v[72:75]
s_waitcnt vmcnt(6) lgkmcnt(8)
v_mfma_f32_16x16x32_bf16 v[60:63], v[236:239], v[172:175], v[60:63]
buffer_load_dwordx4 v[204:207], v38, s[32:35], s57 offen sc1
v_mfma_f32_16x16x32_bf16 v[76:79], v[236:239], v[176:179], v[76:79]
ds_read_b64_tr_b16 v[220:221], v10 offset:49152
ds_read_b64_tr_b16 v[222:223], v10 offset:49664
v_mfma_f32_16x16x32_bf16 v[80:83], v[240:243], v[176:179], v[80:83]
ds_read_b64_tr_b16 v[224:225], v11 offset:49152
ds_read_b64_tr_b16 v[226:227], v11 offset:49664
v_mfma_f32_16x16x32_bf16 v[64:67], v[240:243], v[172:175], v[64:67]
buffer_load_dwordx4 v[208:211], v39, s[32:35], s57 offen sc1
v_mfma_f32_16x16x32_bf16 v[68:71], v[244:247], v[172:175], v[68:71]
ds_read_b64_tr_b16 v[228:229], v12 offset:49152
ds_read_b64_tr_b16 v[230:231], v12 offset:49664
v_mfma_f32_16x16x32_bf16 v[84:87], v[244:247], v[176:179], v[84:87]
ds_read_b64_tr_b16 v[232:233], v13 offset:49152
ds_read_b64_tr_b16 v[234:235], v13 offset:49664
v_mfma_f32_16x16x32_bf16 v[88:91], v[248:251], v[176:179], v[88:91]
v_mfma_f32_16x16x32_bf16 v[72:75], v[248:251], v[172:175], v[72:75]
s_waitcnt vmcnt(6) lgkmcnt(8)
v_mfma_f32_16x16x32_bf16 v[60:63], v[100:103], v[180:183], v[60:63]
buffer_load_dwordx4 v[212:215], v38, s[32:35], s57 offen offset:1024 sc1
v_mfma_f32_16x16x32_bf16 v[76:79], v[100:103], v[184:187], v[76:79]
ds_read_b64_tr_b16 v[236:237], v10 offset:53248
ds_read_b64_tr_b16 v[238:239], v10 offset:53760
v_mfma_f32_16x16x32_bf16 v[80:83], v[104:107], v[184:187], v[80:83]
ds_read_b64_tr_b16 v[240:241], v11 offset:53248
ds_read_b64_tr_b16 v[242:243], v11 offset:53760
v_mfma_f32_16x16x32_bf16 v[64:67], v[104:107], v[180:183], v[64:67]
buffer_load_dwordx4 v[216:219], v39, s[32:35], s57 offen offset:1024 sc1
v_mfma_f32_16x16x32_bf16 v[68:71], v[108:111], v[180:183], v[68:71]
ds_read_b64_tr_b16 v[244:245], v12 offset:53248
ds_read_b64_tr_b16 v[246:247], v12 offset:53760
v_mfma_f32_16x16x32_bf16 v[84:87], v[108:111], v[184:187], v[84:87]
ds_read_b64_tr_b16 v[248:249], v13 offset:53248
ds_read_b64_tr_b16 v[250:251], v13 offset:53760
v_mfma_f32_16x16x32_bf16 v[88:91], v[112:115], v[184:187], v[88:91]
s_add_u32 s57, s57, 2048
s_and_b32 s57, s57, 0x7fff
v_mfma_f32_16x16x32_bf16 v[72:75], v[112:115], v[180:183], v[72:75]
s_waitcnt vmcnt(6) lgkmcnt(8)
v_mfma_f32_16x16x32_bf16 v[60:63], v[220:223], v[188:191], v[60:63]
buffer_load_dwordx4 v[156:159], v38, s[32:35], s57 offen sc1
v_mfma_f32_16x16x32_bf16 v[76:79], v[220:223], v[192:195], v[76:79]
ds_read_b64_tr_b16 v[100:101], v10 offset:57344
ds_read_b64_tr_b16 v[102:103], v10 offset:57856
v_mfma_f32_16x16x32_bf16 v[80:83], v[224:227], v[192:195], v[80:83]
ds_read_b64_tr_b16 v[104:105], v11 offset:57344
ds_read_b64_tr_b16 v[106:107], v11 offset:57856
v_mfma_f32_16x16x32_bf16 v[64:67], v[224:227], v[188:191], v[64:67]
buffer_load_dwordx4 v[160:163], v39, s[32:35], s57 offen sc1
v_mfma_f32_16x16x32_bf16 v[68:71], v[228:231], v[188:191], v[68:71]
ds_read_b64_tr_b16 v[108:109], v12 offset:57344
ds_read_b64_tr_b16 v[110:111], v12 offset:57856
v_mfma_f32_16x16x32_bf16 v[84:87], v[228:231], v[192:195], v[84:87]
ds_read_b64_tr_b16 v[112:113], v13 offset:57344
ds_read_b64_tr_b16 v[114:115], v13 offset:57856
v_mfma_f32_16x16x32_bf16 v[88:91], v[232:235], v[192:195], v[88:91]
v_mfma_f32_16x16x32_bf16 v[72:75], v[232:235], v[188:191], v[72:75]
s_waitcnt vmcnt(6) lgkmcnt(8)
v_mfma_f32_16x16x32_bf16 v[60:63], v[236:239], v[196:199], v[60:63]
buffer_load_dwordx4 v[164:167], v38, s[32:35], s57 offen offset:1024 sc1
v_mfma_f32_16x16x32_bf16 v[76:79], v[236:239], v[200:203], v[76:79]
ds_read_b64_tr_b16 v[220:221], v10 offset:61440
ds_read_b64_tr_b16 v[222:223], v10 offset:61952
v_mfma_f32_16x16x32_bf16 v[80:83], v[240:243], v[200:203], v[80:83]
ds_read_b64_tr_b16 v[224:225], v11 offset:61440
ds_read_b64_tr_b16 v[226:227], v11 offset:61952
v_mfma_f32_16x16x32_bf16 v[64:67], v[240:243], v[196:199], v[64:67]
buffer_load_dwordx4 v[168:171], v39, s[32:35], s57 offen offset:1024 sc1
v_mfma_f32_16x16x32_bf16 v[68:71], v[244:247], v[196:199], v[68:71]
ds_read_b64_tr_b16 v[228:229], v12 offset:61440
ds_read_b64_tr_b16 v[230:231], v12 offset:61952
v_mfma_f32_16x16x32_bf16 v[84:87], v[244:247], v[200:203], v[84:87]
ds_read_b64_tr_b16 v[232:233], v13 offset:61440
ds_read_b64_tr_b16 v[234:235], v13 offset:61952
v_mfma_f32_16x16x32_bf16 v[88:91], v[248:251], v[200:203], v[88:91]
s_add_u32 s57, s57, 2048
s_and_b32 s57, s57, 0x7fff
v_mfma_f32_16x16x32_bf16 v[72:75], v[248:251], v[196:199], v[72:75]
s_waitcnt vmcnt(6) lgkmcnt(8)
v_mfma_f32_16x16x32_bf16 v[60:63], v[100:103], v[204:207], v[60:63]
buffer_load_dwordx4 v[172:175], v38, s[32:35], s57 offen sc1
v_mfma_f32_16x16x32_bf16 v[76:79], v[100:103], v[208:211], v[76:79]
ds_read_b64_tr_b16 v[236:237], v14 offset:0
ds_read_b64_tr_b16 v[238:239], v14 offset:512
v_mfma_f32_16x16x32_bf16 v[80:83], v[104:107], v[208:211], v[80:83]
ds_read_b64_tr_b16 v[240:241], v15 offset:0
ds_read_b64_tr_b16 v[242:243], v15 offset:512
v_mfma_f32_16x16x32_bf16 v[64:67], v[104:107], v[204:207], v[64:67]
buffer_load_dwordx4 v[176:179], v39, s[32:35], s57 offen sc1
v_mfma_f32_16x16x32_bf16 v[68:71], v[108:111], v[204:207], v[68:71]
ds_read_b64_tr_b16 v[244:245], v16 offset:0
ds_read_b64_tr_b16 v[246:247], v16 offset:512
v_mfma_f32_16x16x32_bf16 v[84:87], v[108:111], v[208:211], v[84:87]
ds_read_b64_tr_b16 v[248:249], v17 offset:0
ds_read_b64_tr_b16 v[250:251], v17 offset:512
v_mfma_f32_16x16x32_bf16 v[88:91], v[112:115], v[208:211], v[88:91]
v_mfma_f32_16x16x32_bf16 v[72:75], v[112:115], v[204:207], v[72:75]
s_waitcnt vmcnt(6) lgkmcnt(8)
v_mfma_f32_16x16x32_bf16 v[60:63], v[220:223], v[212:215], v[60:63]
buffer_load_dwordx4 v[180:183], v38, s[32:35], s57 offen offset:1024 sc1
v_mfma_f32_16x16x32_bf16 v[76:79], v[220:223], v[216:219], v[76:79]
ds_read_b64_tr_b16 v[100:101], v14 offset:4096
ds_read_b64_tr_b16 v[102:103], v14 offset:4608
v_mfma_f32_16x16x32_bf16 v[80:83], v[224:227], v[216:219], v[80:83]
ds_read_b64_tr_b16 v[104:105], v15 offset:4096
ds_read_b64_tr_b16 v[106:107], v15 offset:4608
v_mfma_f32_16x16x32_bf16 v[64:67], v[224:227], v[212:215], v[64:67]
buffer_load_dwordx4 v[184:187], v39, s[32:35], s57 offen offset:1024 sc1
v_mfma_f32_16x16x32_bf16 v[68:71], v[228:231], v[212:215], v[68:71]
ds_read_b64_tr_b16 v[108:109], v16 offset:4096
ds_read_b64_tr_b16 v[110:111], v16 offset:4608
v_mfma_f32_16x16x32_bf16 v[84:87], v[228:231], v[216:219], v[84:87]
ds_read_b64_tr_b16 v[112:113], v17 offset:4096
ds_read_b64_tr_b16 v[114:115], v17 offset:4608
v_mfma_f32_16x16x32_bf16 v[88:91], v[232:235], v[216:219], v[88:91]
s_add_u32 s57, s57, 2048
s_and_b32 s57, s57, 0x7fff
v_mfma_f32_16x16x32_bf16 v[72:75], v[232:235], v[212:215], v[72:75]
s_waitcnt vmcnt(6) lgkmcnt(8)
v_mfma_f32_16x16x32_bf16 v[60:63], v[236:239], v[156:159], v[60:63]
buffer_load_dwordx4 v[188:191], v38, s[32:35], s57 offen sc1
v_mfma_f32_16x16x32_bf16 v[76:79], v[236:239], v[160:163], v[76:79]
ds_read_b64_tr_b16 v[220:221], v14 offset:8192
ds_read_b64_tr_b16 v[222:223], v14 offset:8704
v_mfma_f32_16x16x32_bf16 v[80:83], v[240:243], v[160:163], v[80:83]
ds_read_b64_tr_b16 v[224:225], v15 offset:8192
ds_read_b64_tr_b16 v[226:227], v15 offset:8704
v_mfma_f32_16x16x32_bf16 v[64:67], v[240:243], v[156:159], v[64:67]
buffer_load_dwordx4 v[192:195], v39, s[32:35], s57 offen sc1
v_mfma_f32_16x16x32_bf16 v[68:71], v[244:247], v[156:159], v[68:71]
ds_read_b64_tr_b16 v[228:229], v16 offset:8192
ds_read_b64_tr_b16 v[230:231], v16 offset:8704
v_mfma_f32_16x16x32_bf16 v[84:87], v[244:247], v[160:163], v[84:87]
ds_read_b64_tr_b16 v[232:233], v17 offset:8192
ds_read_b64_tr_b16 v[234:235], v17 offset:8704
v_mfma_f32_16x16x32_bf16 v[88:91], v[248:251], v[160:163], v[88:91]
v_mfma_f32_16x16x32_bf16 v[72:75], v[248:251], v[156:159], v[72:75]
s_waitcnt vmcnt(6) lgkmcnt(8)
v_mfma_f32_16x16x32_bf16 v[60:63], v[100:103], v[164:167], v[60:63]
buffer_load_dwordx4 v[196:199], v38, s[32:35], s57 offen offset:1024 sc1
v_mfma_f32_16x16x32_bf16 v[76:79], v[100:103], v[168:171], v[76:79]
ds_read_b64_tr_b16 v[236:237], v14 offset:12288
ds_read_b64_tr_b16 v[238:239], v14 offset:12800
v_mfma_f32_16x16x32_bf16 v[80:83], v[104:107], v[168:171], v[80:83]
ds_read_b64_tr_b16 v[240:241], v15 offset:12288
ds_read_b64_tr_b16 v[242:243], v15 offset:12800
v_mfma_f32_16x16x32_bf16 v[64:67], v[104:107], v[164:167], v[64:67]
buffer_load_dwordx4 v[200:203], v39, s[32:35], s57 offen offset:1024 sc1
v_mfma_f32_16x16x32_bf16 v[68:71], v[108:111], v[164:167], v[68:71]
ds_read_b64_tr_b16 v[244:245], v16 offset:12288
ds_read_b64_tr_b16 v[246:247], v16 offset:12800
v_mfma_f32_16x16x32_bf16 v[84:87], v[108:111], v[168:171], v[84:87]
ds_read_b64_tr_b16 v[248:249], v17 offset:12288
ds_read_b64_tr_b16 v[250:251], v17 offset:12800
v_mfma_f32_16x16x32_bf16 v[88:91], v[112:115], v[168:171], v[88:91]
s_add_u32 s57, s57, 2048
s_and_b32 s57, s57, 0x7fff
v_mfma_f32_16x16x32_bf16 v[72:75], v[112:115], v[164:167], v[72:75]
s_waitcnt vmcnt(6) lgkmcnt(8)
v_mfma_f32_16x16x32_bf16 v[60:63], v[220:223], v[172:175], v[60:63]
buffer_load_dwordx4 v[204:207], v38, s[32:35], s57 offen sc1
v_mfma_f32_16x16x32_bf16 v[76:79], v[220:223], v[176:179], v[76:79]
ds_read_b64_tr_b16 v[100:101], v14 offset:16384
ds_read_b64_tr_b16 v[102:103], v14 offset:16896
v_mfma_f32_16x16x32_bf16 v[80:83], v[224:227], v[176:179], v[80:83]
ds_read_b64_tr_b16 v[104:105], v15 offset:16384
ds_read_b64_tr_b16 v[106:107], v15 offset:16896
v_mfma_f32_16x16x32_bf16 v[64:67], v[224:227], v[172:175], v[64:67]
buffer_load_dwordx4 v[208:211], v39, s[32:35], s57 offen sc1
v_mfma_f32_16x16x32_bf16 v[68:71], v[228:231], v[172:175], v[68:71]
ds_read_b64_tr_b16 v[108:109], v16 offset:16384
ds_read_b64_tr_b16 v[110:111], v16 offset:16896
v_mfma_f32_16x16x32_bf16 v[84:87], v[228:231], v[176:179], v[84:87]
ds_read_b64_tr_b16 v[112:113], v17 offset:16384
ds_read_b64_tr_b16 v[114:115], v17 offset:16896
v_mfma_f32_16x16x32_bf16 v[88:91], v[232:235], v[176:179], v[88:91]
v_mfma_f32_16x16x32_bf16 v[72:75], v[232:235], v[172:175], v[72:75]
s_waitcnt vmcnt(6) lgkmcnt(8)
v_mfma_f32_16x16x32_bf16 v[60:63], v[236:239], v[180:183], v[60:63]
buffer_load_dwordx4 v[212:215], v38, s[32:35], s57 offen offset:1024 sc1
v_mfma_f32_16x16x32_bf16 v[76:79], v[236:239], v[184:187], v[76:79]
ds_read_b64_tr_b16 v[220:221], v14 offset:20480
ds_read_b64_tr_b16 v[222:223], v14 offset:20992
v_mfma_f32_16x16x32_bf16 v[80:83], v[240:243], v[184:187], v[80:83]
ds_read_b64_tr_b16 v[224:225], v15 offset:20480
ds_read_b64_tr_b16 v[226:227], v15 offset:20992
v_mfma_f32_16x16x32_bf16 v[64:67], v[240:243], v[180:183], v[64:67]
buffer_load_dwordx4 v[216:219], v39, s[32:35], s57 offen offset:1024 sc1
v_mfma_f32_16x16x32_bf16 v[68:71], v[244:247], v[180:183], v[68:71]
ds_read_b64_tr_b16 v[228:229], v16 offset:20480
ds_read_b64_tr_b16 v[230:231], v16 offset:20992
v_mfma_f32_16x16x32_bf16 v[84:87], v[244:247], v[184:187], v[84:87]
ds_read_b64_tr_b16 v[232:233], v17 offset:20480
ds_read_b64_tr_b16 v[234:235], v17 offset:20992
v_mfma_f32_16x16x32_bf16 v[88:91], v[248:251], v[184:187], v[88:91]
s_add_u32 s57, s57, 2048
s_and_b32 s57, s57, 0x7fff
v_mfma_f32_16x16x32_bf16 v[72:75], v[248:251], v[180:183], v[72:75]
s_waitcnt vmcnt(6) lgkmcnt(8)
v_mfma_f32_16x16x32_bf16 v[60:63], v[100:103], v[188:191], v[60:63]
buffer_load_dwordx4 v[156:159], v38, s[32:35], s57 offen sc1
v_mfma_f32_16x16x32_bf16 v[76:79], v[100:103], v[192:195], v[76:79]
ds_read_b64_tr_b16 v[236:237], v14 offset:24576
ds_read_b64_tr_b16 v[238:239], v14 offset:25088
v_mfma_f32_16x16x32_bf16 v[80:83], v[104:107], v[192:195], v[80:83]
ds_read_b64_tr_b16 v[240:241], v15 offset:24576
ds_read_b64_tr_b16 v[242:243], v15 offset:25088
v_mfma_f32_16x16x32_bf16 v[64:67], v[104:107], v[188:191], v[64:67]
buffer_load_dwordx4 v[160:163], v39, s[32:35], s57 offen sc1
v_mfma_f32_16x16x32_bf16 v[68:71], v[108:111], v[188:191], v[68:71]
ds_read_b64_tr_b16 v[244:245], v16 offset:24576
ds_read_b64_tr_b16 v[246:247], v16 offset:25088
v_mfma_f32_16x16x32_bf16 v[84:87], v[108:111], v[192:195], v[84:87]
ds_read_b64_tr_b16 v[248:249], v17 offset:24576
ds_read_b64_tr_b16 v[250:251], v17 offset:25088
v_mfma_f32_16x16x32_bf16 v[88:91], v[112:115], v[192:195], v[88:91]
v_mfma_f32_16x16x32_bf16 v[72:75], v[112:115], v[188:191], v[72:75]
s_waitcnt vmcnt(6) lgkmcnt(8)
v_mfma_f32_16x16x32_bf16 v[60:63], v[220:223], v[196:199], v[60:63]
buffer_load_dwordx4 v[164:167], v38, s[32:35], s57 offen offset:1024 sc1
v_mfma_f32_16x16x32_bf16 v[76:79], v[220:223], v[200:203], v[76:79]
ds_read_b64_tr_b16 v[100:101], v14 offset:28672
ds_read_b64_tr_b16 v[102:103], v14 offset:29184
v_mfma_f32_16x16x32_bf16 v[80:83], v[224:227], v[200:203], v[80:83]
ds_read_b64_tr_b16 v[104:105], v15 offset:28672
ds_read_b64_tr_b16 v[106:107], v15 offset:29184
v_mfma_f32_16x16x32_bf16 v[64:67], v[224:227], v[196:199], v[64:67]
buffer_load_dwordx4 v[168:171], v39, s[32:35], s57 offen offset:1024 sc1
v_mfma_f32_16x16x32_bf16 v[68:71], v[228:231], v[196:199], v[68:71]
ds_read_b64_tr_b16 v[108:109], v16 offset:28672
ds_read_b64_tr_b16 v[110:111], v16 offset:29184
v_mfma_f32_16x16x32_bf16 v[84:87], v[228:231], v[200:203], v[84:87]
ds_read_b64_tr_b16 v[112:113], v17 offset:28672
ds_read_b64_tr_b16 v[114:115], v17 offset:29184
v_mfma_f32_16x16x32_bf16 v[88:91], v[232:235], v[200:203], v[88:91]
s_add_u32 s57, s57, 2048
s_and_b32 s57, s57, 0x7fff
v_mfma_f32_16x16x32_bf16 v[72:75], v[232:235], v[196:199], v[72:75]
s_waitcnt vmcnt(6) lgkmcnt(8)
v_mfma_f32_16x16x32_bf16 v[60:63], v[236:239], v[204:207], v[60:63]
buffer_load_dwordx4 v[172:175], v38, s[32:35], s57 offen sc1
v_mfma_f32_16x16x32_bf16 v[76:79], v[236:239], v[208:211], v[76:79]
ds_read_b64_tr_b16 v[220:221], v14 offset:32768
ds_read_b64_tr_b16 v[222:223], v14 offset:33280
v_mfma_f32_16x16x32_bf16 v[80:83], v[240:243], v[208:211], v[80:83]
ds_read_b64_tr_b16 v[224:225], v15 offset:32768
ds_read_b64_tr_b16 v[226:227], v15 offset:33280
v_mfma_f32_16x16x32_bf16 v[64:67], v[240:243], v[204:207], v[64:67]
buffer_load_dwordx4 v[176:179], v39, s[32:35], s57 offen sc1
v_mfma_f32_16x16x32_bf16 v[68:71], v[244:247], v[204:207], v[68:71]
ds_read_b64_tr_b16 v[228:229], v16 offset:32768
ds_read_b64_tr_b16 v[230:231], v16 offset:33280
v_mfma_f32_16x16x32_bf16 v[84:87], v[244:247], v[208:211], v[84:87]
ds_read_b64_tr_b16 v[232:233], v17 offset:32768
ds_read_b64_tr_b16 v[234:235], v17 offset:33280
v_mfma_f32_16x16x32_bf16 v[88:91], v[248:251], v[208:211], v[88:91]
v_mfma_f32_16x16x32_bf16 v[72:75], v[248:251], v[204:207], v[72:75]
s_waitcnt vmcnt(6) lgkmcnt(8)
v_mfma_f32_16x16x32_bf16 v[60:63], v[100:103], v[212:215], v[60:63]
buffer_load_dwordx4 v[180:183], v38, s[32:35], s57 offen offset:1024 sc1
v_mfma_f32_16x16x32_bf16 v[76:79], v[100:103], v[216:219], v[76:79]
ds_read_b64_tr_b16 v[236:237], v14 offset:36864
ds_read_b64_tr_b16 v[238:239], v14 offset:37376
v_mfma_f32_16x16x32_bf16 v[80:83], v[104:107], v[216:219], v[80:83]
ds_read_b64_tr_b16 v[240:241], v15 offset:36864
ds_read_b64_tr_b16 v[242:243], v15 offset:37376
v_mfma_f32_16x16x32_bf16 v[64:67], v[104:107], v[212:215], v[64:67]
buffer_load_dwordx4 v[184:187], v39, s[32:35], s57 offen offset:1024 sc1
v_mfma_f32_16x16x32_bf16 v[68:71], v[108:111], v[212:215], v[68:71]
ds_read_b64_tr_b16 v[244:245], v16 offset:36864
ds_read_b64_tr_b16 v[246:247], v16 offset:37376
v_mfma_f32_16x16x32_bf16 v[84:87], v[108:111], v[216:219], v[84:87]
ds_read_b64_tr_b16 v[248:249], v17 offset:36864
ds_read_b64_tr_b16 v[250:251], v17 offset:37376
v_mfma_f32_16x16x32_bf16 v[88:91], v[112:115], v[216:219], v[88:91]
s_add_u32 s57, s57, 2048
s_and_b32 s57, s57, 0x7fff
v_mfma_f32_16x16x32_bf16 v[72:75], v[112:115], v[212:215], v[72:75]
s_waitcnt vmcnt(6) lgkmcnt(8)
v_mfma_f32_16x16x32_bf16 v[60:63], v[220:223], v[156:159], v[60:63]
buffer_load_dwordx4 v[188:191], v38, s[32:35], s57 offen sc1
v_mfma_f32_16x16x32_bf16 v[76:79], v[220:223], v[160:163], v[76:79]
ds_read_b64_tr_b16 v[100:101], v14 offset:40960
ds_read_b64_tr_b16 v[102:103], v14 offset:41472
v_mfma_f32_16x16x32_bf16 v[80:83], v[224:227], v[160:163], v[80:83]
ds_read_b64_tr_b16 v[104:105], v15 offset:40960
ds_read_b64_tr_b16 v[106:107], v15 offset:41472
v_mfma_f32_16x16x32_bf16 v[64:67], v[224:227], v[156:159], v[64:67]
buffer_load_dwordx4 v[192:195], v39, s[32:35], s57 offen sc1
v_mfma_f32_16x16x32_bf16 v[68:71], v[228:231], v[156:159], v[68:71]
ds_read_b64_tr_b16 v[108:109], v16 offset:40960
ds_read_b64_tr_b16 v[110:111], v16 offset:41472
v_mfma_f32_16x16x32_bf16 v[84:87], v[228:231], v[160:163], v[84:87]
ds_read_b64_tr_b16 v[112:113], v17 offset:40960
ds_read_b64_tr_b16 v[114:115], v17 offset:41472
v_mfma_f32_16x16x32_bf16 v[88:91], v[232:235], v[160:163], v[88:91]
v_mfma_f32_16x16x32_bf16 v[72:75], v[232:235], v[156:159], v[72:75]
s_waitcnt vmcnt(6) lgkmcnt(8)
v_mfma_f32_16x16x32_bf16 v[60:63], v[236:239], v[164:167], v[60:63]
buffer_load_dwordx4 v[196:199], v38, s[32:35], s57 offen offset:1024 sc1
v_mfma_f32_16x16x32_bf16 v[76:79], v[236:239], v[168:171], v[76:79]
ds_read_b64_tr_b16 v[220:221], v14 offset:45056
ds_read_b64_tr_b16 v[222:223], v14 offset:45568
v_mfma_f32_16x16x32_bf16 v[80:83], v[240:243], v[168:171], v[80:83]
ds_read_b64_tr_b16 v[224:225], v15 offset:45056
ds_read_b64_tr_b16 v[226:227], v15 offset:45568
v_mfma_f32_16x16x32_bf16 v[64:67], v[240:243], v[164:167], v[64:67]
buffer_load_dwordx4 v[200:203], v39, s[32:35], s57 offen offset:1024 sc1
v_mfma_f32_16x16x32_bf16 v[68:71], v[244:247], v[164:167], v[68:71]
ds_read_b64_tr_b16 v[228:229], v16 offset:45056
ds_read_b64_tr_b16 v[230:231], v16 offset:45568
v_mfma_f32_16x16x32_bf16 v[84:87], v[244:247], v[168:171], v[84:87]
ds_read_b64_tr_b16 v[232:233], v17 offset:45056
ds_read_b64_tr_b16 v[234:235], v17 offset:45568
v_mfma_f32_16x16x32_bf16 v[88:91], v[248:251], v[168:171], v[88:91]
s_add_u32 s57, s57, 2048
s_and_b32 s57, s57, 0x7fff
v_mfma_f32_16x16x32_bf16 v[72:75], v[248:251], v[164:167], v[72:75]
s_waitcnt vmcnt(6) lgkmcnt(8)
v_mfma_f32_16x16x32_bf16 v[60:63], v[100:103], v[172:175], v[60:63]
buffer_load_dwordx4 v[204:207], v38, s[32:35], s57 offen sc1
v_mfma_f32_16x16x32_bf16 v[76:79], v[100:103], v[176:179], v[76:79]
ds_read_b64_tr_b16 v[236:237], v14 offset:49152
ds_read_b64_tr_b16 v[238:239], v14 offset:49664
v_mfma_f32_16x16x32_bf16 v[80:83], v[104:107], v[176:179], v[80:83]
ds_read_b64_tr_b16 v[240:241], v15 offset:49152
ds_read_b64_tr_b16 v[242:243], v15 offset:49664
v_mfma_f32_16x16x32_bf16 v[64:67], v[104:107], v[172:175], v[64:67]
buffer_load_dwordx4 v[208:211], v39, s[32:35], s57 offen sc1
v_mfma_f32_16x16x32_bf16 v[68:71], v[108:111], v[172:175], v[68:71]
ds_read_b64_tr_b16 v[244:245], v16 offset:49152
ds_read_b64_tr_b16 v[246:247], v16 offset:49664
v_mfma_f32_16x16x32_bf16 v[84:87], v[108:111], v[176:179], v[84:87]
ds_read_b64_tr_b16 v[248:249], v17 offset:49152
ds_read_b64_tr_b16 v[250:251], v17 offset:49664
v_mfma_f32_16x16x32_bf16 v[88:91], v[112:115], v[176:179], v[88:91]
v_mfma_f32_16x16x32_bf16 v[72:75], v[112:115], v[172:175], v[72:75]
s_waitcnt vmcnt(6) lgkmcnt(8)
v_mfma_f32_16x16x32_bf16 v[60:63], v[220:223], v[180:183], v[60:63]
buffer_load_dwordx4 v[212:215], v38, s[32:35], s57 offen offset:1024 sc1
v_mfma_f32_16x16x32_bf16 v[76:79], v[220:223], v[184:187], v[76:79]
ds_read_b64_tr_b16 v[100:101], v14 offset:53248
ds_read_b64_tr_b16 v[102:103], v14 offset:53760
v_mfma_f32_16x16x32_bf16 v[80:83], v[224:227], v[184:187], v[80:83]
ds_read_b64_tr_b16 v[104:105], v15 offset:53248
ds_read_b64_tr_b16 v[106:107], v15 offset:53760
v_mfma_f32_16x16x32_bf16 v[64:67], v[224:227], v[180:183], v[64:67]
buffer_load_dwordx4 v[216:219], v39, s[32:35], s57 offen offset:1024 sc1
v_mfma_f32_16x16x32_bf16 v[68:71], v[228:231], v[180:183], v[68:71]
ds_read_b64_tr_b16 v[108:109], v16 offset:53248
ds_read_b64_tr_b16 v[110:111], v16 offset:53760
v_mfma_f32_16x16x32_bf16 v[84:87], v[228:231], v[184:187], v[84:87]
ds_read_b64_tr_b16 v[112:113], v17 offset:53248
ds_read_b64_tr_b16 v[114:115], v17 offset:53760
v_mfma_f32_16x16x32_bf16 v[88:91], v[232:235], v[184:187], v[88:91]
v_mfma_f32_16x16x32_bf16 v[72:75], v[232:235], v[180:183], v[72:75]
s_waitcnt vmcnt(6) lgkmcnt(8)
v_mfma_f32_16x16x32_bf16 v[60:63], v[236:239], v[188:191], v[60:63]
v_mfma_f32_16x16x32_bf16 v[76:79], v[236:239], v[192:195], v[76:79]
ds_read_b64_tr_b16 v[220:221], v14 offset:57344
ds_read_b64_tr_b16 v[222:223], v14 offset:57856
v_mfma_f32_16x16x32_bf16 v[80:83], v[240:243], v[192:195], v[80:83]
ds_read_b64_tr_b16 v[224:225], v15 offset:57344
ds_read_b64_tr_b16 v[226:227], v15 offset:57856
v_mfma_f32_16x16x32_bf16 v[64:67], v[240:243], v[188:191], v[64:67]
v_mfma_f32_16x16x32_bf16 v[68:71], v[244:247], v[188:191], v[68:71]
ds_read_b64_tr_b16 v[228:229], v16 offset:57344
ds_read_b64_tr_b16 v[230:231], v16 offset:57856
v_mfma_f32_16x16x32_bf16 v[84:87], v[244:247], v[192:195], v[84:87]
ds_read_b64_tr_b16 v[232:233], v17 offset:57344
ds_read_b64_tr_b16 v[234:235], v17 offset:57856
v_mfma_f32_16x16x32_bf16 v[88:91], v[248:251], v[192:195], v[88:91]
v_mfma_f32_16x16x32_bf16 v[72:75], v[248:251], v[188:191], v[72:75]
s_waitcnt vmcnt(4) lgkmcnt(8)
v_mfma_f32_16x16x32_bf16 v[60:63], v[100:103], v[196:199], v[60:63]
v_mfma_f32_16x16x32_bf16 v[76:79], v[100:103], v[200:203], v[76:79]
ds_read_b64_tr_b16 v[236:237], v14 offset:61440
ds_read_b64_tr_b16 v[238:239], v14 offset:61952
v_mfma_f32_16x16x32_bf16 v[80:83], v[104:107], v[200:203], v[80:83]
ds_read_b64_tr_b16 v[240:241], v15 offset:61440
ds_read_b64_tr_b16 v[242:243], v15 offset:61952
v_mfma_f32_16x16x32_bf16 v[64:67], v[104:107], v[196:199], v[64:67]
v_mfma_f32_16x16x32_bf16 v[68:71], v[108:111], v[196:199], v[68:71]
ds_read_b64_tr_b16 v[244:245], v16 offset:61440
ds_read_b64_tr_b16 v[246:247], v16 offset:61952
v_mfma_f32_16x16x32_bf16 v[84:87], v[108:111], v[200:203], v[84:87]
ds_read_b64_tr_b16 v[248:249], v17 offset:61440
ds_read_b64_tr_b16 v[250:251], v17 offset:61952
v_mfma_f32_16x16x32_bf16 v[88:91], v[112:115], v[200:203], v[88:91]
v_mfma_f32_16x16x32_bf16 v[72:75], v[112:115], v[196:199], v[72:75]
s_waitcnt vmcnt(2) lgkmcnt(8)
v_mfma_f32_16x16x32_bf16 v[60:63], v[220:223], v[204:207], v[60:63]
v_mfma_f32_16x16x32_bf16 v[76:79], v[220:223], v[208:211], v[76:79]
v_mfma_f32_16x16x32_bf16 v[80:83], v[224:227], v[208:211], v[80:83]
v_mfma_f32_16x16x32_bf16 v[64:67], v[224:227], v[204:207], v[64:67]
v_mfma_f32_16x16x32_bf16 v[68:71], v[228:231], v[204:207], v[68:71]
v_mfma_f32_16x16x32_bf16 v[84:87], v[228:231], v[208:211], v[84:87]
v_mfma_f32_16x16x32_bf16 v[88:91], v[232:235], v[208:211], v[88:91]
v_mfma_f32_16x16x32_bf16 v[72:75], v[232:235], v[204:207], v[72:75]
s_waitcnt vmcnt(0) lgkmcnt(0)
v_mfma_f32_16x16x32_bf16 v[60:63], v[236:239], v[212:215], v[60:63]
v_mfma_f32_16x16x32_bf16 v[64:67], v[240:243], v[212:215], v[64:67]
v_mfma_f32_16x16x32_bf16 v[68:71], v[244:247], v[212:215], v[68:71]
v_mfma_f32_16x16x32_bf16 v[72:75], v[248:251], v[212:215], v[72:75]
v_mfma_f32_16x16x32_bf16 v[76:79], v[236:239], v[216:219], v[76:79]
v_mfma_f32_16x16x32_bf16 v[80:83], v[240:243], v[216:219], v[80:83]
v_mfma_f32_16x16x32_bf16 v[84:87], v[244:247], v[216:219], v[84:87]
v_mfma_f32_16x16x32_bf16 v[88:91], v[248:251], v[216:219], v[88:91]
s_cmp_eq_u32 s46, 0
s_cbranch_scc1 slow_79
s_nop 0
v_cvt_pk_bf16_f32 v20, v60, v61
v_cvt_pk_bf16_f32 v21, v62, v63
v_cvt_pk_bf16_f32 v22, v64, v65
v_cvt_pk_bf16_f32 v23, v66, v67
buffer_store_dwordx4 v[20:23], v18, s[32:35], s85 offen offset:0 sc1
v_cvt_pk_bf16_f32 v24, v68, v69
v_cvt_pk_bf16_f32 v25, v70, v71
v_cvt_pk_bf16_f32 v26, v72, v73
v_cvt_pk_bf16_f32 v27, v74, v75
buffer_store_dwordx4 v[24:27], v18, s[32:35], s85 offen offset:1024 sc1
v_cvt_pk_bf16_f32 v28, v76, v77
v_cvt_pk_bf16_f32 v29, v78, v79
v_cvt_pk_bf16_f32 v30, v80, v81
v_cvt_pk_bf16_f32 v31, v82, v83
buffer_store_dwordx4 v[28:31], v18, s[32:35], s86 offen offset:0 sc1
v_cvt_pk_bf16_f32 v32, v84, v85
v_cvt_pk_bf16_f32 v33, v86, v87
v_cvt_pk_bf16_f32 v34, v88, v89
v_cvt_pk_bf16_f32 v35, v90, v91
buffer_store_dwordx4 v[32:35], v18, s[32:35], s86 offen offset:1024 sc1
s_barrier
v_dot2c_f32_bf16 v6, v20, v48
v_dot2c_f32_bf16 v8, v20, v20
v_dot2c_f32_bf16 v7, v28, v48
v_dot2c_f32_bf16 v9, v28, v28
v_dot2c_f32_bf16 v6, v21, v48
v_dot2c_f32_bf16 v8, v21, v21
v_dot2c_f32_bf16 v7, v29, v48
v_dot2c_f32_bf16 v9, v29, v29
v_dot2c_f32_bf16 v6, v22, v48
v_dot2c_f32_bf16 v8, v22, v22
v_dot2c_f32_bf16 v7, v30, v48
v_dot2c_f32_bf16 v9, v30, v30
v_dot2c_f32_bf16 v6, v23, v48
v_dot2c_f32_bf16 v8, v23, v23
v_dot2c_f32_bf16 v7, v31, v48
v_dot2c_f32_bf16 v9, v31, v31
v_dot2c_f32_bf16 v6, v24, v48
v_dot2c_f32_bf16 v8, v24, v24
v_dot2c_f32_bf16 v7, v32, v48
v_dot2c_f32_bf16 v9, v32, v32
v_dot2c_f32_bf16 v6, v25, v48
v_dot2c_f32_bf16 v8, v25, v25
v_dot2c_f32_bf16 v7, v33, v48
v_dot2c_f32_bf16 v9, v33, v33
v_dot2c_f32_bf16 v6, v26, v48
v_dot2c_f32_bf16 v8, v26, v26
v_dot2c_f32_bf16 v7, v34, v48
v_dot2c_f32_bf16 v9, v34, v34
v_dot2c_f32_bf16 v6, v27, v48
v_dot2c_f32_bf16 v8, v27, v27
v_dot2c_f32_bf16 v7, v35, v48
v_dot2c_f32_bf16 v9, v35, v35
s_mov_b64 exec, 1
s_waitcnt vmcnt(0)
buffer_store_dword v5, v4, s[32:35], s88 offen
s_mov_b64 exec, -1
s_nop 1
v_permlane32_swap_b32 v6, v7
v_permlane32_swap_b32 v8, v9
v_add_f32 v6, v6, v7
v_add_f32 v8, v8, v9
s_nop 1
v_permlane16_swap_b32 v6, v8
s_nop 0
v_add_f32 v6, v6, v8
buffer_store_dword v6, v1, s[32:35], s87 offen
back_80:
s_lshl_b32 s49, s44, 13
v_add_u32 v10, s49, v18
v_add_u32 v11, 1024, v10
s_lshl_b32 s48, s43, 1
v_lshrrev_b32 v4, 2, v2
v_and_b32 v5, 3, v0
v_lshl_add_u32 v6, v3, 3, v4
v_lshlrev_b32 v6, 7, v6
v_lshl_add_u32 v6, v5, 3, v6
v_lshrrev_b32 v7, 1, v4
v_and_b32 v8, 1, v3
v_lshl_add_u32 v7, v8, 1, v7
v_xor_b32 v7, s48, v7
v_lshl_add_u32 v12, v7, 5, v6
v_add_u32 v12, 16384, v12
v_xor_b32 v13, 32, v12
v_mov_b32 v14, v10
v_mov_b32 v15, v11
v_add_u32 v16, 122880, v12
v_add_u32 v17, 122880, v13
v_mov_b32 v156, 0
v_mov_b32 v157, 0
v_mov_b32 v158, 0
v_mov_b32 v159, 0
v_mov_b32 v160, 0
v_mov_b32 v161, 0
v_mov_b32 v162, 0
v_mov_b32 v163, 0
v_mov_b32 v164, 0
v_mov_b32 v165, 0
v_mov_b32 v166, 0
v_mov_b32 v167, 0
v_mov_b32 v168, 0
v_mov_b32 v169, 0
v_mov_b32 v170, 0
v_mov_b32 v171, 0
v_mov_b32 v172, 0
v_mov_b32 v173, 0
v_mov_b32 v174, 0
v_mov_b32 v175, 0
v_mov_b32 v176, 0
v_mov_b32 v177, 0
v_mov_b32 v178, 0
v_mov_b32 v179, 0
v_mov_b32 v180, 0
v_mov_b32 v181, 0
v_mov_b32 v182, 0
v_mov_b32 v183, 0
v_mov_b32 v184, 0
v_mov_b32 v185, 0
v_mov_b32 v186, 0
v_mov_b32 v187, 0
v_mov_b32 v188, 0
v_mov_b32 v189, 0
v_mov_b32 v190, 0
v_mov_b32 v191, 0
v_mov_b32 v192, 0
v_mov_b32 v193, 0
v_mov_b32 v194, 0
v_mov_b32 v195, 0
v_mov_b32 v196, 0
v_mov_b32 v197, 0
v_mov_b32 v198, 0
v_mov_b32 v199, 0
v_mov_b32 v200, 0
v_mov_b32 v201, 0
v_mov_b32 v202, 0
v_mov_b32 v203, 0
v_mov_b32 v204, 0
v_mov_b32 v205, 0
v_mov_b32 v206, 0
v_mov_b32 v207, 0
v_mov_b32 v208, 0
v_mov_b32 v209, 0
v_mov_b32 v210, 0
v_mov_b32 v211, 0
v_mov_b32 v212, 0
v_mov_b32 v213, 0
v_mov_b32 v214, 0
v_mov_b32 v215, 0
v_mov_b32 v216, 0
v_mov_b32 v217, 0
v_mov_b32 v218, 0
v_mov_b32 v219, 0
v_mov_b32 v220, 0
v_mov_b32 v221, 0
v_mov_b32 v222, 0
v_mov_b32 v223, 0
v_mov_b32 v224, 0
v_mov_b32 v225, 0
v_mov_b32 v226, 0
v_mov_b32 v227, 0
v_mov_b32 v228, 0
v_mov_b32 v229, 0
v_mov_b32 v230, 0
v_mov_b32 v231, 0
v_mov_b32 v232, 0
v_mov_b32 v233, 0
v_mov_b32 v234, 0
v_mov_b32 v235, 0
v_mov_b32 v236, 0
v_mov_b32 v237, 0
v_mov_b32 v238, 0
v_mov_b32 v239, 0
v_mov_b32 v240, 0
v_mov_b32 v241, 0
v_mov_b32 v242, 0
v_mov_b32 v243, 0
v_mov_b32 v244, 0
v_mov_b32 v245, 0
v_mov_b32 v246, 0
v_mov_b32 v247, 0
v_mov_b32 v248, 0
v_mov_b32 v249, 0
v_mov_b32 v250, 0
v_mov_b32 v251, 0
v_lshrrev_b32 v6, 2, v2
v_cmp_eq_u32 vcc, v6, v3
v_and_b32 v7, 1, v0
v_lshlrev_b32 v7, 4, v7
v_mov_b32 v8, 0x3f80
v_lshlrev_b32 v9, v7, v8
v_cndmask_b32 v7, 0, v9, vcc
v_and_b32 v6, 2, v0
v_cmp_eq_u32 vcc, 0, v6
v_mov_b32 v36, 0
v_mov_b32 v37, 0
v_mov_b32 v40, 0
v_mov_b32 v41, 0
v_cndmask_b32 v38, 0, v7, vcc
v_cndmask_b32 v39, v7, 0, vcc
v_lshrrev_b32 v8, 1, v2
v_cmp_eq_u32 vcc, 0, v8
s_nop 1
v_cndmask_b32 v44, 0, v9, vcc
v_cmp_eq_u32 vcc, 1, v8
s_nop 1
v_cndmask_b32 v45, 0, v9, vcc
v_cmp_eq_u32 vcc, 2, v8
s_nop 1
v_cndmask_b32 v46, 0, v9, vcc
v_cmp_eq_u32 vcc, 3, v8
s_nop 1
v_cndmask_b32 v47, 0, v9, vcc
v_lshrrev_b32 v4, 2, v2
v_lshl_add_u32 v4, v3, 2, v4
v_lshlrev_b32 v4, 6, v4
v_and_b32 v5, 3, v0
v_lshl_add_u32 v4, v5, 3, v4
s_lshl_b32 s48, s43, 11
s_add_u32 s48, s48, 135168
v_add_u32 v53, s48, v4
s_mul_i32 s48, s40, 3072
s_add_u32 s48, s48, 139264
v_add_u32 v42, s48, v18
s_xor_b32 s49, s40, 2
s_mul_i32 s48, s49, 3072
s_add_u32 s48, s48, 139264
v_add_u32 v43, s48, v18
s_lshl_b32 s49, s49, 2
s_add_u32 s49, s49, 134672
v_mov_b32 v19, s49
v_xor_b32 v52, 8, v19
v_lshrrev_b32 v4, 3, v0
v_and_b32 v5, 7, v0
v_lshlrev_b32 v4, 11, v4
v_lshl_add_u32 v55, v5, 4, v4
v_lshlrev_b32 v4, 6, v2
v_lshl_add_u32 v58, v3, 4, v4
v_lshlrev_b32 v4, 4, v2
v_lshl_add_u32 v59, v3, 3, v4
s_mul_i32 s51, s42, 163840
s_add_u32 s51, s51, 9437184
s_lshl_b32 s50, s43, 1
s_add_u32 s50, s50, s44
s_lshl_b32 s48, s50, 15
s_add_u32 s48, s48, s51
s_add_u32 s48, s48, 0
s_lshl_b32 s49, s41, 7
s_add_u32 s53, s48, s49
s_add_u32 s54, s53, 16384
s_lshl_b32 s56, s50, 10
s_add_u32 s56, s56, s51
s_add_u32 s56, s56, 147456
s_xor_b32 s57, s56, 1024
s_lshl_b32 s58, s50, 11
s_add_u32 s58, s58, s51
s_add_u32 s58, s58, 131072
s_xor_b32 s59, s58, 2048
s_add_u32 s79, s58, s49
s_lshl_b32 s50, s41, 11
s_add_u32 s55, s48, s50
s_lshl_b32 s48, s43, 7
s_add_u32 s48, s48, 133888
v_lshl_add_u32 v7, v3, 4, s48
v_lshl_add_u32 v54, v2, 2, s48
s_lshl_b32 s49, s44, 6
v_add_u32 v8, s49, v2
v_lshlrev_b32 v8, 3, v8
v_add_u32 v8, 131072, v8
v_lshl_add_u32 v9, v3, 2, s49
v_lshlrev_b32 v9, 2, v9
v_add_u32 v9, 132096, v9
s_mov_b32 s64, 0
s_mov_b32 s65, 0
s_mov_b32 s66, 0x3fb8aa3b
s_lshr_b32 s49, s42, 3
s_xor_b32 s77, s74, s49
s_add_u32 s77, s77, 4
s_lshl_b32 s50, s42, 2
s_add_u32 s50, s50, s40
s_lshl_b32 s50, s50, 4
s_add_u32 s50, s50, s41
s_lshl_b32 s50, s50, 8
s_add_u32 s52, s50, 18087936
s_barrier
ds_read_b128 v[60:63], v14 offset:0
ds_read_b128 v[64:67], v14 offset:2048
ds_read_b128 v[68:71], v14 offset:4096
ds_read_b128 v[72:75], v14 offset:6144
ds_read_b64_tr_b16 v[84:85], v16 offset:8192
ds_read_b64_tr_b16 v[86:87], v16 offset:8704
ds_read_b64_tr_b16 v[88:89], v17 offset:8192
ds_read_b64_tr_b16 v[90:91], v17 offset:8704
ds_read_b64_tr_b16 v[92:93], v16 offset:16384
ds_read_b64_tr_b16 v[94:95], v16 offset:16896
ds_read_b64_tr_b16 v[96:97], v17 offset:16384
ds_read_b64_tr_b16 v[98:99], v17 offset:16896
ds_read_b64_tr_b16 v[76:77], v16 offset:0
ds_read_b64_tr_b16 v[78:79], v16 offset:512
ds_read_b64_tr_b16 v[80:81], v17 offset:0
ds_read_b64_tr_b16 v[82:83], v17 offset:512
s_waitcnt lgkmcnt(0)
c1_loop:
v_mfma_f32_16x16x32_bf16 v[212:215], v[84:87], v[72:75], v[212:215]
ds_read_b128 v[100:103], v15 offset:0
v_mfma_f32_16x16x32_bf16 v[204:207], v[84:87], v[68:71], v[204:207]
ds_read_b128 v[104:107], v15 offset:2048
v_mfma_f32_16x16x32_bf16 v[196:199], v[84:87], v[64:67], v[196:199]
ds_read_b128 v[108:111], v15 offset:4096
v_mfma_f32_16x16x32_bf16 v[188:191], v[84:87], v[60:63], v[188:191]
ds_read_b128 v[112:115], v15 offset:6144
v_mfma_f32_16x16x32_bf16 v[192:195], v[88:91], v[60:63], v[192:195]
ds_read_b64_tr_b16 v[124:125], v16 offset:12288
v_mfma_f32_16x16x32_bf16 v[200:203], v[88:91], v[64:67], v[200:203]
ds_read_b64_tr_b16 v[126:127], v16 offset:12800
v_mfma_f32_16x16x32_bf16 v[208:211], v[88:91], v[68:71], v[208:211]
ds_read_b64_tr_b16 v[128:129], v17 offset:12288
v_mfma_f32_16x16x32_bf16 v[216:219], v[88:91], v[72:75], v[216:219]
ds_read_b64_tr_b16 v[130:131], v17 offset:12800
v_mfma_f32_16x16x32_bf16 v[244:247], v[72:75], v[92:95], v[244:247]
ds_read_b64_tr_b16 v[132:133], v16 offset:20480
v_mfma_f32_16x16x32_bf16 v[248:251], v[72:75], v[96:99], v[248:251]
ds_read_b64_tr_b16 v[134:135], v16 offset:20992
v_mfma_f32_16x16x32_bf16 v[240:243], v[68:71], v[96:99], v[240:243]
ds_read_b64_tr_b16 v[136:137], v17 offset:20480
v_mfma_f32_16x16x32_bf16 v[236:239], v[68:71], v[92:95], v[236:239]
ds_read_b64_tr_b16 v[138:139], v17 offset:20992
v_mfma_f32_16x16x32_bf16 v[228:231], v[64:67], v[92:95], v[228:231]
ds_read_b64_tr_b16 v[116:117], v16 offset:4096
v_mfma_f32_16x16x32_bf16 v[232:235], v[64:67], v[96:99], v[232:235]
ds_read_b64_tr_b16 v[118:119], v16 offset:4608
v_mfma_f32_16x16x32_bf16 v[224:227], v[60:63], v[96:99], v[224:227]
ds_read_b64_tr_b16 v[120:121], v17 offset:4096
v_mfma_f32_16x16x32_bf16 v[220:223], v[60:63], v[92:95], v[220:223]
ds_read_b64_tr_b16 v[122:123], v17 offset:4608
v_mfma_f32_16x16x32_bf16 v[156:159], v[76:79], v[60:63], v[156:159]
s_cmp_eq_u32 s77, s64
s_cbranch_scc1 c1_hook
c1_hook_ret:
v_mfma_f32_16x16x32_bf16 v[164:167], v[76:79], v[64:67], v[164:167]
s_add_u32 s65, s65, 40960
s_cmp_eq_u32 s65, 122880
v_mfma_f32_16x16x32_bf16 v[172:175], v[76:79], v[68:71], v[172:175]
s_cselect_b32 s65, 0, s65
s_add_u32 s64, s64, 1
v_mfma_f32_16x16x32_bf16 v[180:183], v[76:79], v[72:75], v[180:183]
v_add_u32 v14, s65, v10
v_add_u32 v15, s65, v11
v_mfma_f32_16x16x32_bf16 v[184:187], v[80:83], v[72:75], v[184:187]
v_add_u32 v16, s65, v12
v_add_u32 v17, s65, v13
v_mfma_f32_16x16x32_bf16 v[176:179], v[80:83], v[68:71], v[176:179]
s_cmp_eq_u32 s64, 16
s_cbranch_scc1 c1_last
v_mfma_f32_16x16x32_bf16 v[168:171], v[80:83], v[64:67], v[168:171]
s_waitcnt lgkmcnt(0)
v_mfma_f32_16x16x32_bf16 v[160:163], v[80:83], v[60:63], v[160:163]
s_barrier
v_mfma_f32_16x16x32_bf16 v[212:215], v[124:127], v[112:115], v[212:215]
ds_read_b128 v[60:63], v14 offset:0
v_mfma_f32_16x16x32_bf16 v[204:207], v[124:127], v[108:111], v[204:207]
ds_read_b128 v[64:67], v14 offset:2048
v_mfma_f32_16x16x32_bf16 v[196:199], v[124:127], v[104:107], v[196:199]
ds_read_b128 v[68:71], v14 offset:4096
v_mfma_f32_16x16x32_bf16 v[188:191], v[124:127], v[100:103], v[188:191]
ds_read_b128 v[72:75], v14 offset:6144
v_mfma_f32_16x16x32_bf16 v[192:195], v[128:131], v[100:103], v[192:195]
ds_read_b64_tr_b16 v[84:85], v16 offset:8192
v_mfma_f32_16x16x32_bf16 v[200:203], v[128:131], v[104:107], v[200:203]
ds_read_b64_tr_b16 v[86:87], v16 offset:8704
v_mfma_f32_16x16x32_bf16 v[208:211], v[128:131], v[108:111], v[208:211]
ds_read_b64_tr_b16 v[88:89], v17 offset:8192
v_mfma_f32_16x16x32_bf16 v[216:219], v[128:131], v[112:115], v[216:219]
ds_read_b64_tr_b16 v[90:91], v17 offset:8704
v_mfma_f32_16x16x32_bf16 v[244:247], v[112:115], v[132:135], v[244:247]
ds_read_b64_tr_b16 v[92:93], v16 offset:16384
v_mfma_f32_16x16x32_bf16 v[248:251], v[112:115], v[136:139], v[248:251]
ds_read_b64_tr_b16 v[94:95], v16 offset:16896
v_mfma_f32_16x16x32_bf16 v[240:243], v[108:111], v[136:139], v[240:243]
ds_read_b64_tr_b16 v[96:97], v17 offset:16384
v_mfma_f32_16x16x32_bf16 v[236:239], v[108:111], v[132:135], v[236:239]
ds_read_b64_tr_b16 v[98:99], v17 offset:16896
v_mfma_f32_16x16x32_bf16 v[228:231], v[104:107], v[132:135], v[228:231]
ds_read_b64_tr_b16 v[76:77], v16 offset:0
v_mfma_f32_16x16x32_bf16 v[232:235], v[104:107], v[136:139], v[232:235]
ds_read_b64_tr_b16 v[78:79], v16 offset:512
v_mfma_f32_16x16x32_bf16 v[224:227], v[100:103], v[136:139], v[224:227]
ds_read_b64_tr_b16 v[80:81], v17 offset:0
v_mfma_f32_16x16x32_bf16 v[220:223], v[100:103], v[132:135], v[220:223]
ds_read_b64_tr_b16 v[82:83], v17 offset:512
v_mfma_f32_16x16x32_bf16 v[156:159], v[116:119], v[100:103], v[156:159]
v_mfma_f32_16x16x32_bf16 v[164:167], v[116:119], v[104:107], v[164:167]
v_mfma_f32_16x16x32_bf16 v[172:175], v[116:119], v[108:111], v[172:175]
v_mfma_f32_16x16x32_bf16 v[180:183], v[116:119], v[112:115], v[180:183]
v_mfma_f32_16x16x32_bf16 v[184:187], v[120:123], v[112:115], v[184:187]
v_mfma_f32_16x16x32_bf16 v[176:179], v[120:123], v[108:111], v[176:179]
v_mfma_f32_16x16x32_bf16 v[168:171], v[120:123], v[104:107], v[168:171]
s_waitcnt lgkmcnt(0)
v_mfma_f32_16x16x32_bf16 v[160:163], v[120:123], v[100:103], v[160:163]
s_branch c1_loop
c1_hook:
s_waitcnt lgkmcnt(0)
s_cmp_lg_u32 s44, 0
s_cbranch_scc1 else_81
v_mfma_f32_16x16x32_bf16 v[140:143], v[48:51], v[76:79], 0
v_mfma_f32_16x16x32_bf16 v[144:147], v[48:51], v[84:87], 0
v_mfma_f32_16x16x32_bf16 v[148:151], v[48:51], v[92:95], 0
v_mfma_f32_16x16x32_bf16 v[140:143], v[48:51], v[116:119], v[140:143]
v_mfma_f32_16x16x32_bf16 v[144:147], v[48:51], v[124:127], v[144:147]
v_mfma_f32_16x16x32_bf16 v[148:151], v[48:51], v[132:135], v[148:151]
s_branch fi_82
else_81:
v_mfma_f32_16x16x32_bf16 v[140:143], v[48:51], v[80:83], 0
v_mfma_f32_16x16x32_bf16 v[144:147], v[48:51], v[88:91], 0
v_mfma_f32_16x16x32_bf16 v[148:151], v[48:51], v[96:99], 0
v_mfma_f32_16x16x32_bf16 v[140:143], v[48:51], v[120:123], v[140:143]
v_mfma_f32_16x16x32_bf16 v[144:147], v[48:51], v[128:131], v[144:147]
v_mfma_f32_16x16x32_bf16 v[148:151], v[48:51], v[136:139], v[148:151]
fi_82:
s_nop 4
v_cmp_eq_u32 vcc, 0, v3
v_cmp_eq_u32 s[48:49], 1, v3
s_nop 1
v_cndmask_b32 v4, v148, v144, s[48:49]
v_cndmask_b32 v4, v4, v140, vcc
buffer_store_dword v4, v1, s[32:35], s52 offen sc1
s_branch c1_hook_ret
c1_last:
v_mfma_f32_16x16x32_bf16 v[168:171], v[80:83], v[64:67], v[168:171]
s_waitcnt lgkmcnt(0)
v_mfma_f32_16x16x32_bf16 v[160:163], v[80:83], v[60:63], v[160:163]
v_mfma_f32_16x16x32_bf16 v[212:215], v[124:127], v[112:115], v[212:215]
ds_read_b64_tr_b16 v[10:11], v53 offset:0
ds_read_b64_tr_b16 v[12:13], v53 offset:1024
v_mfma_f32_16x16x32_bf16 v[204:207], v[124:127], v[108:111], v[204:207]
ds_read_b64_tr_b16 v[14:15], v53 offset:32
ds_read_b64_tr_b16 v[16:17], v53 offset:1056
v_mfma_f32_16x16x32_bf16 v[196:199], v[124:127], v[104:107], v[196:199]

s_mul_i32 s48, s44, 0x80008000
v_mfma_f32_16x16x32_bf16 v[188:191], v[124:127], v[100:103], v[188:191]

v_mfma_f32_16x16x32_bf16 v[192:195], v[128:131], v[100:103], v[192:195]

v_mfma_f32_16x16x32_bf16 v[200:203], v[128:131], v[104:107], v[200:203]

v_mfma_f32_16x16x32_bf16 v[208:211], v[128:131], v[108:111], v[208:211]

s_waitcnt lgkmcnt(0)
v_mfma_f32_16x16x32_bf16 v[216:219], v[128:131], v[112:115], v[216:219]
s_barrier
v_mfma_f32_16x16x32_bf16 v[244:247], v[112:115], v[132:135], v[244:247]
ds_read_b128 v[140:143], v7 offset:0
ds_read_b128 v[144:147], v7 offset:64
v_mfma_f32_16x16x32_bf16 v[248:251], v[112:115], v[136:139], v[248:251]
ds_read_b128 v[148:151], v7 offset:256
ds_read_b128 v[152:155], v7 offset:320
v_mfma_f32_16x16x32_bf16 v[240:243], v[108:111], v[136:139], v[240:243]
ds_read_b64 v[92:93], v8 offset:0
ds_read_b64 v[94:95], v8 offset:128
v_mfma_f32_16x16x32_bf16 v[236:239], v[108:111], v[132:135], v[236:239]
ds_read_b64 v[96:97], v8 offset:256
ds_read_b64 v[98:99], v8 offset:384
v_mfma_f32_16x16x32_bf16 v[228:231], v[104:107], v[132:135], v[228:231]
ds_read2_b32 v[56:57], v54 offset0:128 offset1:144
v_xor_b32 v10, s48, v10
v_mfma_f32_16x16x32_bf16 v[232:235], v[104:107], v[136:139], v[232:235]
ds_read_b128 v[60:63], v9 offset:0
v_xor_b32 v11, s48, v11
v_mfma_f32_16x16x32_bf16 v[224:227], v[100:103], v[136:139], v[224:227]
ds_read_b128 v[64:67], v9 offset:64
v_xor_b32 v12, s48, v12
v_mfma_f32_16x16x32_bf16 v[220:223], v[100:103], v[132:135], v[220:223]
ds_read_b128 v[68:71], v9 offset:128
v_xor_b32 v13, s48, v13
v_mfma_f32_16x16x32_bf16 v[156:159], v[116:119], v[100:103], v[156:159]
ds_read_b128 v[72:75], v9 offset:192
v_xor_b32 v14, s48, v14
v_mfma_f32_16x16x32_bf16 v[164:167], v[116:119], v[104:107], v[164:167]
ds_read_b128 v[76:79], v9 offset:512
v_xor_b32 v15, s48, v15
v_mfma_f32_16x16x32_bf16 v[172:175], v[116:119], v[108:111], v[172:175]
ds_read_b128 v[80:83], v9 offset:576
v_xor_b32 v16, s48, v16
v_mfma_f32_16x16x32_bf16 v[180:183], v[116:119], v[112:115], v[180:183]
ds_read_b128 v[84:87], v9 offset:640
v_xor_b32 v17, s48, v17
v_mfma_f32_16x16x32_bf16 v[184:187], v[120:123], v[112:115], v[184:187]
ds_read_b128 v[88:91], v9 offset:704
v_mfma_f32_16x16x32_bf16 v[176:179], v[120:123], v[108:111], v[176:179]
v_mfma_f32_16x16x32_bf16 v[168:171], v[120:123], v[104:107], v[168:171]
v_mfma_f32_16x16x32_bf16 v[160:163], v[120:123], v[100:103], v[160:163]
c1_epi:
s_waitcnt lgkmcnt(0)
.p2align 3
v_mul_f32 v129, s66, v94
v_mul_f32 v128, s66, v92
v_mul_f32 v131, s66, v98
v_mul_f32 v130, s66, v96
v_pk_fma_f32 v[190:191], v[150:151], v[92:93], v[190:191] op_sel:[0,1,0] op_sel_hi:[1,1,1]
v_pk_fma_f32 v[212:213], v[148:149], v[98:99], v[212:213] op_sel:[0,1,0] op_sel_hi:[1,1,1]
v_pk_fma_f32 v[214:215], v[150:151], v[98:99], v[214:215] op_sel:[0,1,0] op_sel_hi:[1,1,1]
v_pk_fma_f32 v[188:189], v[148:149], v[92:93], v[188:189] op_sel:[0,1,0] op_sel_hi:[1,1,1]
v_pk_fma_f32 v[218:219], v[154:155], v[98:99], v[218:219] op_sel:[0,1,0] op_sel_hi:[1,1,1]
v_cvt_pk_bf16_f32 v188, v188, v189
v_cvt_pk_bf16_f32 v189, v190, v191
v_pk_fma_f32 v[196:197], v[148:149], v[94:95], v[196:197] op_sel:[0,1,0] op_sel_hi:[1,1,1]
v_pk_fma_f32 v[200:201], v[152:153], v[94:95], v[200:201] op_sel:[0,1,0] op_sel_hi:[1,1,1]
v_pk_fma_f32 v[210:211], v[154:155], v[96:97], v[210:211] op_sel:[0,1,0] op_sel_hi:[1,1,1]
v_pk_fma_f32 v[240:241], v[84:85], v[56:57], v[240:241] op_sel:[0,1,0] op_sel_hi:[1,1,1]
v_pk_fma_f32 v[228:229], v[80:81], v[56:57], v[228:229] op_sel:[0,0,0] op_sel_hi:[1,0,1]
v_pk_fma_f32 v[226:227], v[78:79], v[56:57], v[226:227] op_sel:[0,1,0] op_sel_hi:[1,1,1]
v_pk_fma_f32 v[192:193], v[152:153], v[92:93], v[192:193] op_sel:[0,1,0] op_sel_hi:[1,1,1]
v_cvt_pk_bf16_f32 v190, v192, v193
v_pk_fma_f32 v[238:239], v[86:87], v[56:57], v[238:239] op_sel:[0,0,0] op_sel_hi:[1,0,1]
v_pk_fma_f32 v[234:235], v[82:83], v[56:57], v[234:235] op_sel:[0,1,0] op_sel_hi:[1,1,1]
v_pk_mul_f32 v[226:227], v[226:227], v[62:63]
v_pk_fma_f32 v[204:205], v[148:149], v[96:97], v[204:205] op_sel:[0,1,0] op_sel_hi:[1,1,1]
v_cvt_pk_bf16_f32 v204, v204, v205
v_pk_fma_f32 v[202:203], v[154:155], v[94:95], v[202:203] op_sel:[0,1,0] op_sel_hi:[1,1,1]
v_pk_fma_f32 v[224:225], v[76:77], v[56:57], v[224:225] op_sel:[0,1,0] op_sel_hi:[1,1,1]
v_pk_fma_f32 v[216:217], v[152:153], v[98:99], v[216:217] op_sel:[0,1,0] op_sel_hi:[1,1,1]
v_pk_fma_f32 v[244:245], v[88:89], v[56:57], v[244:245] op_sel:[0,0,0] op_sel_hi:[1,0,1]
v_pk_mul_f32 v[238:239], v[238:239], v[70:71]
v_pk_mul_f32 v[228:229], v[228:229], v[64:65]
v_pk_fma_f32 v[236:237], v[84:85], v[56:57], v[236:237] op_sel:[0,0,0] op_sel_hi:[1,0,1]
v_pk_fma_f32 v[220:221], v[76:77], v[56:57], v[220:221] op_sel:[0,0,0] op_sel_hi:[1,0,1]
v_pk_mul_f32 v[224:225], v[224:225], v[60:61]
v_cvt_pk_bf16_f32 v212, v212, v213
v_cvt_pk_bf16_f32 v213, v214, v215
v_cvt_pk_bf16_f32 v196, v196, v197
v_pk_mul_f32 v[240:241], v[240:241], v[68:69]
v_pk_fma_f32 v[198:199], v[150:151], v[94:95], v[198:199] op_sel:[0,1,0] op_sel_hi:[1,1,1]
v_cvt_pk_bf16_f32 v197, v198, v199
v_cvt_pk_bf16_f32 v198, v200, v201
v_cvt_pk_bf16_f32 v199, v202, v203
v_cvt_pk_bf16_f32 v215, v218, v219
v_pk_fma_f32 v[208:209], v[152:153], v[96:97], v[208:209] op_sel:[0,1,0] op_sel_hi:[1,1,1]
v_pk_fma_f32 v[246:247], v[90:91], v[56:57], v[246:247] op_sel:[0,0,0] op_sel_hi:[1,0,1]
v_pk_fma_f32 v[250:251], v[90:91], v[56:57], v[250:251] op_sel:[0,1,0] op_sel_hi:[1,1,1]
v_pk_mul_f32 v[250:251], v[250:251], v[74:75]
v_pk_fma_f32 v[206:207], v[150:151], v[96:97], v[206:207] op_sel:[0,1,0] op_sel_hi:[1,1,1]
v_cvt_pk_bf16_f32 v205, v206, v207
v_pk_fma_f32 v[242:243], v[86:87], v[56:57], v[242:243] op_sel:[0,1,0] op_sel_hi:[1,1,1]
v_cvt_pk_bf16_f32 v207, v210, v211
v_pk_mul_f32 v[236:237], v[236:237], v[68:69]
v_pk_fma_f32 v[230:231], v[82:83], v[56:57], v[230:231] op_sel:[0,0,0] op_sel_hi:[1,0,1]
v_pk_fma_f32 v[194:195], v[154:155], v[92:93], v[194:195] op_sel:[0,1,0] op_sel_hi:[1,1,1]
v_cvt_pk_bf16_f32 v191, v194, v195
v_pk_fma_f32 v[232:233], v[80:81], v[56:57], v[232:233] op_sel:[0,1,0] op_sel_hi:[1,1,1]
v_pk_mul_f32 v[232:233], v[232:233], v[64:65]
v_pk_mul_f32 v[230:231], v[230:231], v[66:67]
v_pk_fma_f32 v[248:249], v[88:89], v[56:57], v[248:249] op_sel:[0,1,0] op_sel_hi:[1,1,1]
v_pk_mul_f32 v[248:249], v[248:249], v[72:73]
v_pk_mul_f32 v[242:243], v[242:243], v[70:71]
v_mfma_f32_16x16x32_bf16 v[68:71], v[10:13], v[196:199], 0
v_cvt_pk_bf16_f32 v206, v208, v209
v_cvt_pk_bf16_f32 v214, v216, v217
v_cvt_pk_bf16_f32 v121, v226, v227
v_mfma_f32_16x16x32_bf16 v[80:83], v[14:17], v[204:207], 0
v_cvt_pk_bf16_f32 v120, v224, v225
v_cvt_pk_bf16_f32 v114, v228, v229
v_mfma_f32_16x16x32_bf16 v[84:87], v[10:13], v[212:215], 0
v_cvt_pk_bf16_f32 v116, v236, v237
v_min3_f32 v105, v68, v69, v70
v_mfma_f32_16x16x32_bf16 v[88:91], v[14:17], v[212:215], 0
v_max3_f32 v101, v68, v69, v70
v_cvt_pk_bf16_f32 v115, v230, v231
v_cvt_pk_bf16_f32 v122, v232, v233
v_cvt_pk_bf16_f32 v127, v250, v251
v_cvt_pk_bf16_f32 v124, v240, v241
v_pk_mul_f32 v[244:245], v[244:245], v[72:73]
v_pk_fma_f32 v[222:223], v[78:79], v[56:57], v[222:223] op_sel:[0,0,0] op_sel_hi:[1,0,1]
v_pk_mul_f32 v[222:223], v[222:223], v[62:63]
v_mfma_f32_16x16x32_bf16 v[76:79], v[10:13], v[204:207], 0
v_min3_f32 v107, v84, v85, v86
v_min3_f32 v107, v107, v87, v88
v_min3_f32 v107, v107, v89, v90
v_min_f32_e64 v107, v107, v91
v_max3_f32 v103, v84, v85, v86
v_pk_mul_f32 v[220:221], v[220:221], v[60:61]
v_mfma_f32_16x16x32_bf16 v[60:63], v[10:13], v[188:191], 0
v_max3_f32 v103, v103, v87, v88
v_min3_f32 v106, v76, v77, v78
v_min3_f32 v106, v106, v79, v80
v_min3_f32 v106, v106, v81, v82
v_min_f32 v106, v106, v83
v_pk_mul_f32 v[234:235], v[234:235], v[66:67]
v_mfma_f32_16x16x32_bf16 v[64:67], v[14:17], v[188:191], 0
v_permlane32_swap_b32 v106, v107
v_min3_f32 v104, v60, v61, v62
v_min_f32 v106, v106, v107
v_max3_f32 v103, v103, v89, v90
v_pk_mul_f32 v[246:247], v[246:247], v[74:75]
v_mfma_f32_16x16x32_bf16 v[72:75], v[14:17], v[196:199], 0
v_max_f32 v103, v103, v91
v_max3_f32 v102, v76, v77, v78
v_min3_f32 v104, v104, v63, v64
v_min3_f32 v104, v104, v65, v66
v_min_f32 v104, v104, v67
v_max3_f32 v102, v102, v79, v80
v_max3_f32 v102, v102, v81, v82
v_max_f32 v102, v102, v83
v_min3_f32 v105, v105, v71, v72
v_min3_f32 v105, v105, v73, v74
v_min_f32 v105, v105, v75
v_max3_f32 v101, v101, v71, v72
v_max3_f32 v101, v101, v73, v74
v_permlane32_swap_b32 v104, v105
v_permlane32_swap_b32 v102, v103
v_min_f32 v104, v104, v105
v_max_f32 v102, v102, v103
v_max_f32 v101, v101, v75
v_permlane16_swap_b32 v104, v106
v_max3_f32 v100, v60, v61, v62
v_min_f32 v104, v104, v106
v_mov_b32 v106, v104
v_max3_f32 v100, v100, v63, v64
v_max3_f32 v100, v100, v65, v66
v_max_f32 v100, v100, v67
v_permlane16_swap_b32 v104, v106
v_cvt_pk_bf16_f32 v112, v220, v221
v_permlane32_swap_b32 v100, v101
v_mov_b32 v105, v104
v_max_f32 v100, v100, v101
v_mov_b32 v107, v106
v_permlane32_swap_b32 v104, v105
v_permlane16_swap_b32 v100, v102
v_pk_mul_f32 v[104:105], v[104:105], v[128:129]
v_pk_fma_f32 v[226:227], v[66:67], v[128:129], v[104:105] op_sel:[0,0,0] op_sel_hi:[1,0,0] neg_lo:[1,0,0] neg_hi:[1,0,0]
v_pk_fma_f32 v[230:231], v[70:71], v[128:129], v[104:105] op_sel:[0,1,1] op_sel_hi:[1,1,1] neg_lo:[1,0,0] neg_hi:[1,0,0]
v_exp_f32 v226, v226
v_pk_fma_f32 v[224:225], v[64:65], v[128:129], v[104:105] op_sel:[0,0,0] op_sel_hi:[1,0,0] neg_lo:[1,0,0] neg_hi:[1,0,0]
v_exp_f32 v224, v224
v_pk_fma_f32 v[228:229], v[68:69], v[128:129], v[104:105] op_sel:[0,1,1] op_sel_hi:[1,1,1] neg_lo:[1,0,0] neg_hi:[1,0,0]
v_exp_f32 v231, v231
v_cvt_pk_bf16_f32 v113, v222, v223
v_pk_fma_f32 v[222:223], v[62:63], v[128:129], v[104:105] op_sel:[0,0,0] op_sel_hi:[1,0,0] neg_lo:[1,0,0] neg_hi:[1,0,0]
v_exp_f32 v222, v222
v_pk_fma_f32 v[220:221], v[60:61], v[128:129], v[104:105] op_sel:[0,0,0] op_sel_hi:[1,0,0] neg_lo:[1,0,0] neg_hi:[1,0,0]
v_exp_f32 v221, v221
v_exp_f32 v220, v220
v_max_f32 v100, v100, v102
v_exp_f32 v223, v223
v_mov_b32 v102, v100
v_pk_add_f32 v[110:111], v[220:221], v[222:223]
v_exp_f32 v225, v225
v_pk_fma_f32 v[232:233], v[72:73], v[128:129], v[104:105] op_sel:[0,1,1] op_sel_hi:[1,1,1] neg_lo:[1,0,0] neg_hi:[1,0,0]
v_exp_f32 v232, v232
v_exp_f32 v233, v233
v_pk_add_f32 v[110:111], v[110:111], v[224:225]
v_exp_f32 v229, v229
v_exp_f32 v228, v228
v_exp_f32 v227, v227
v_cvt_pk_bf16_f32 v123, v234, v235
v_pk_fma_f32 v[234:235], v[74:75], v[128:129], v[104:105] op_sel:[0,1,1] op_sel_hi:[1,1,1] neg_lo:[1,0,0] neg_hi:[1,0,0]
v_pk_add_f32 v[110:111], v[110:111], v[226:227]
v_add_f32 v104, v110, v111
v_cvt_pk_bf16_f32 v118, v244, v245
v_permlane32_swap_b32 v106, v107
v_permlane16_swap_b32 v100, v102
v_exp_f32 v234, v234
v_mov_b32 v101, v100
v_exp_f32 v235, v235
v_exp_f32_e64 v230, v230
v_cvt_pk_bf16_f32 v125, v242, v243
v_pk_add_f32 v[110:111], v[228:229], v[230:231]
v_pk_add_f32 v[110:111], v[110:111], v[232:233]
v_pk_add_f32 v[110:111], v[110:111], v[234:235]
v_cvt_pk_bf16_f32 v126, v248, v249
v_pk_mul_f32 v[106:107], v[106:107], v[130:131]
v_pk_fma_f32 v[236:237], v[76:77], v[130:131], v[106:107] op_sel:[0,0,0] op_sel_hi:[1,0,0] neg_lo:[1,0,0] neg_hi:[1,0,0]
v_exp_f32 v237, v237
v_exp_f32 v236, v236
v_pk_fma_f32 v[242:243], v[82:83], v[130:131], v[106:107] op_sel:[0,0,0] op_sel_hi:[1,0,0] neg_lo:[1,0,0] neg_hi:[1,0,0]
v_pk_fma_f32 v[250:251], v[90:91], v[130:131], v[106:107] op_sel:[0,1,1] op_sel_hi:[1,1,1] neg_lo:[1,0,0] neg_hi:[1,0,0]
v_add_f32 v105, v110, v111
v_exp_f32 v243, v243
v_cvt_pk_bf16_f32 v119, v246, v247
v_pk_fma_f32 v[246:247], v[86:87], v[130:131], v[106:107] op_sel:[0,1,1] op_sel_hi:[1,1,1] neg_lo:[1,0,0] neg_hi:[1,0,0]
v_exp_f32 v246, v246
v_cvt_pk_bf16_f32 v117, v238, v239
v_pk_fma_f32 v[238:239], v[78:79], v[130:131], v[106:107] op_sel:[0,0,0] op_sel_hi:[1,0,0] neg_lo:[1,0,0] neg_hi:[1,0,0]
v_exp_f32 v238, v238
v_exp_f32 v247, v247
v_pk_fma_f32 v[240:241], v[80:81], v[130:131], v[106:107] op_sel:[0,0,0] op_sel_hi:[1,0,0] neg_lo:[1,0,0] neg_hi:[1,0,0]
v_exp_f32 v240, v240
v_exp_f32 v241, v241
v_permlane32_swap_b32 v100, v101
v_exp_f32 v242, v242
v_pk_fma_f32 v[244:245], v[84:85], v[130:131], v[106:107] op_sel:[0,1,1] op_sel_hi:[1,1,1] neg_lo:[1,0,0] neg_hi:[1,0,0]
v_exp_f32 v244, v244
v_exp_f32_e64 v239, v239
v_pk_mul_f32 v[100:101], v[100:101], v[128:129]
v_pk_fma_f32 v[62:63], v[62:63], v[128:129], v[100:101] op_sel:[0,0,0] op_sel_hi:[1,0,0] neg_lo:[0,0,1] neg_hi:[0,0,1]
v_pk_add_f32 v[110:111], v[236:237], v[238:239]
v_pk_add_f32 v[110:111], v[110:111], v[240:241]
v_pk_add_f32 v[110:111], v[110:111], v[242:243]
v_pk_fma_f32 v[72:73], v[72:73], v[128:129], v[100:101] op_sel:[0,1,1] op_sel_hi:[1,1,1] neg_lo:[0,0,1] neg_hi:[0,0,1]
v_pk_fma_f32 v[66:67], v[66:67], v[128:129], v[100:101] op_sel:[0,0,0] op_sel_hi:[1,0,0] neg_lo:[0,0,1] neg_hi:[0,0,1]
v_exp_f32 v62, v62
v_pk_fma_f32 v[60:61], v[60:61], v[128:129], v[100:101] op_sel:[0,0,0] op_sel_hi:[1,0,0] neg_lo:[0,0,1] neg_hi:[0,0,1]
v_exp_f32 v60, v60
v_exp_f32 v245, v245
v_exp_f32 v73, v73
v_pk_fma_f32 v[248:249], v[88:89], v[130:131], v[106:107] op_sel:[0,1,1] op_sel_hi:[1,1,1] neg_lo:[1,0,0] neg_hi:[1,0,0]
v_add_f32 v106, v110, v111
v_exp_f32 v249, v249
v_pk_add_f32 v[110:111], v[244:245], v[246:247]
v_exp_f32 v248, v248
v_pk_fma_f32 v[64:65], v[64:65], v[128:129], v[100:101] op_sel:[0,0,0] op_sel_hi:[1,0,0] neg_lo:[0,0,1] neg_hi:[0,0,1]
v_exp_f32 v64, v64
v_pk_add_f32 v[110:111], v[110:111], v[248:249]
v_exp_f32 v65, v65
v_exp_f32 v61, v61
v_exp_f32 v66, v66
v_exp_f32 v251, v251
v_exp_f32 v63, v63
v_pk_fma_f32 v[74:75], v[74:75], v[128:129], v[100:101] op_sel:[0,1,1] op_sel_hi:[1,1,1] neg_lo:[0,0,1] neg_hi:[0,0,1]
v_pk_add_f32 v[108:109], v[60:61], v[62:63]
v_exp_f32 v67, v67
v_exp_f32 v250, v250
v_pk_fma_f32 v[68:69], v[68:69], v[128:129], v[100:101] op_sel:[0,1,1] op_sel_hi:[1,1,1] neg_lo:[0,0,1] neg_hi:[0,0,1]
v_pk_add_f32 v[110:111], v[110:111], v[250:251]
v_exp_f32 v68, v68
v_exp_f32 v69, v69
v_add_f32 v107, v110, v111
v_mov_b32 v103, v102
v_pk_fma_f32 v[70:71], v[70:71], v[128:129], v[100:101] op_sel:[0,1,1] op_sel_hi:[1,1,1] neg_lo:[0,0,1] neg_hi:[0,0,1]
v_exp_f32 v71, v71
v_exp_f32 v70, v70
v_permlane32_swap_b32 v106, v107
v_permlane32_swap_b32 v102, v103
v_pk_add_f32 v[108:109], v[108:109], v[64:65]
v_pk_add_f32 v[108:109], v[108:109], v[66:67]
v_add_f32 v100, v108, v109
v_pk_add_f32 v[108:109], v[68:69], v[70:71]
v_pk_mul_f32 v[102:103], v[102:103], v[130:131]
v_pk_fma_f32 v[78:79], v[78:79], v[130:131], v[102:103] op_sel:[0,0,0] op_sel_hi:[1,0,0] neg_lo:[0,0,1] neg_hi:[0,0,1]
v_exp_f32 v79, v79
v_exp_f32 v78, v78
v_exp_f32 v74, v74
v_exp_f32 v72, v72
v_pk_fma_f32 v[86:87], v[86:87], v[130:131], v[102:103] op_sel:[0,1,1] op_sel_hi:[1,1,1] neg_lo:[0,0,1] neg_hi:[0,0,1]
v_exp_f32 v87, v87
v_pk_fma_f32 v[76:77], v[76:77], v[130:131], v[102:103] op_sel:[0,0,0] op_sel_hi:[1,0,0] neg_lo:[0,0,1] neg_hi:[0,0,1]
v_exp_f32 v77, v77
v_add_f32 v106, v106, v107
v_pk_fma_f32 v[80:81], v[80:81], v[130:131], v[102:103] op_sel:[0,0,0] op_sel_hi:[1,0,0] neg_lo:[0,0,1] neg_hi:[0,0,1]
v_exp_f32 v81, v81
v_exp_f32 v80, v80
v_pk_add_f32 v[108:109], v[108:109], v[72:73]
v_permlane32_swap_b32 v104, v105
v_exp_f32 v75, v75
v_add_f32 v104, v104, v105
v_pk_fma_f32 v[82:83], v[82:83], v[130:131], v[102:103] op_sel:[0,0,0] op_sel_hi:[1,0,0] neg_lo:[0,0,1] neg_hi:[0,0,1]
v_exp_f32 v82, v82
v_exp_f32 v83, v83
v_permlane16_swap_b32 v104, v106
v_pk_add_f32 v[108:109], v[108:109], v[74:75]
v_add_f32 v101, v108, v109
v_exp_f32 v76, v76
v_add_f32 v104, v104, v106
v_rcp_f32 v104, v104
v_pk_fma_f32 v[84:85], v[84:85], v[130:131], v[102:103] op_sel:[0,1,1] op_sel_hi:[1,1,1] neg_lo:[0,0,1] neg_hi:[0,0,1]
v_exp_f32 v84, v84
v_exp_f32 v85, v85
v_mov_b32 v106, v104
v_pk_add_f32 v[108:109], v[76:77], v[78:79]
v_pk_add_f32 v[108:109], v[108:109], v[80:81]
v_pk_add_f32 v[108:109], v[108:109], v[82:83]
v_pk_fma_f32 v[88:89], v[88:89], v[130:131], v[102:103] op_sel:[0,1,1] op_sel_hi:[1,1,1] neg_lo:[0,0,1] neg_hi:[0,0,1]
v_exp_f32 v88, v88
v_exp_f32 v89, v89
v_exp_f32 v86, v86
v_pk_fma_f32 v[90:91], v[90:91], v[130:131], v[102:103] op_sel:[0,1,1] op_sel_hi:[1,1,1] neg_lo:[0,0,1] neg_hi:[0,0,1]
v_add_f32 v102, v108, v109
v_pk_add_f32 v[108:109], v[84:85], v[86:87]
v_pk_add_f32 v[108:109], v[108:109], v[88:89]
v_permlane16_swap_b32 v104, v106
v_exp_f32 v90, v90
v_exp_f32 v91, v91
v_permlane32_swap_b32 v100, v101
v_pk_add_f32 v[108:109], v[108:109], v[90:91]
v_add_f32 v103, v108, v109
v_add_f32 v100, v100, v101
v_mov_b32 v105, v104
v_permlane32_swap_b32 v102, v103
v_mov_b32 v107, v106
v_add_f32 v102, v102, v103
v_permlane32_swap_b32 v104, v105
v_permlane32_swap_b32 v106, v107
v_permlane16_swap_b32 v100, v102
v_pk_mul_f32 v[222:223], v[222:223], v[104:105] op_sel:[0,0] op_sel_hi:[1,0]
v_pk_mul_f32 v[226:227], v[226:227], v[104:105] op_sel:[0,0] op_sel_hi:[1,0]
v_pk_mul_f32 v[234:235], v[234:235], v[104:105] op_sel:[0,1] op_sel_hi:[1,1]
v_pk_mul_f32 v[232:233], v[232:233], v[104:105] op_sel:[0,1] op_sel_hi:[1,1]
v_pk_mul_f32 v[230:231], v[230:231], v[104:105] op_sel:[0,1] op_sel_hi:[1,1]
v_add_f32 v100, v100, v102
v_pk_mul_f32 v[228:229], v[228:229], v[104:105] op_sel:[0,1] op_sel_hi:[1,1]
v_cvt_pk_bf16_f32 v228, v228, v229
v_cvt_pk_bf16_f32 v229, v230, v231
v_cvt_pk_bf16_f32 v231, v234, v235
v_cvt_pk_bf16_f32 v230, v232, v233
v_pk_mul_f32 v[220:221], v[220:221], v[104:105] op_sel:[0,0] op_sel_hi:[1,0]
v_cvt_pk_bf16_f32 v220, v220, v221
v_pk_mul_f32 v[224:225], v[224:225], v[104:105] op_sel:[0,0] op_sel_hi:[1,0]
v_pk_mul_f32 v[236:237], v[236:237], v[106:107] op_sel:[0,0] op_sel_hi:[1,0]
v_pk_mul_f32 v[238:239], v[238:239], v[106:107] op_sel:[0,0] op_sel_hi:[1,0]
v_pk_mul_f32 v[240:241], v[240:241], v[106:107] op_sel:[0,0] op_sel_hi:[1,0]
v_pk_mul_f32 v[242:243], v[242:243], v[106:107] op_sel:[0,0] op_sel_hi:[1,0]
v_pk_mul_f32 v[248:249], v[248:249], v[106:107] op_sel:[0,1] op_sel_hi:[1,1]
v_rcp_f32 v100, v100
v_pk_mul_f32 v[244:245], v[244:245], v[106:107] op_sel:[0,1] op_sel_hi:[1,1]
v_mov_b32 v102, v100
v_pk_mul_f32 v[250:251], v[250:251], v[106:107] op_sel:[0,1] op_sel_hi:[1,1]
v_cvt_pk_bf16_f32 v221, v222, v223
v_pk_mul_f32 v[246:247], v[246:247], v[106:107] op_sel:[0,1] op_sel_hi:[1,1]
v_cvt_pk_bf16_f32 v222, v224, v225
v_mfma_f32_16x16x32_bf16 v[200:203], v[228:231], v[36:39], 0
v_cvt_pk_bf16_f32 v223, v226, v227
v_permlane16_swap_b32 v100, v102
v_mfma_f32_16x16x32_bf16 v[196:199], v[228:231], v[38:41], 0
v_mov_b32 v101, v100
v_cvt_pk_bf16_f32 v244, v244, v245
v_mfma_f32_16x16x32_bf16 v[212:215], v[220:223], v[38:41], 0
v_cvt_pk_bf16_f32 v245, v246, v247
v_cvt_pk_bf16_f32 v247, v250, v251
v_mfma_f32_16x16x32_bf16 v[216:219], v[220:223], v[36:39], 0
v_cvt_pk_bf16_f32 v234, v200, v201
v_cvt_pk_bf16_f32 v246, v248, v249
v_cvt_pk_bf16_f32 v226, v196, v197
v_cvt_pk_bf16_f32 v227, v198, v199
v_mfma_f32_16x16x32_bf16 v[196:199], v[244:247], v[38:41], 0
v_cvt_pk_bf16_f32 v225, v214, v215
v_cvt_pk_bf16_f32 v236, v236, v237
v_cvt_pk_bf16_f32 v237, v238, v239
v_cvt_pk_bf16_f32 v232, v216, v217
v_cvt_pk_bf16_f32 v233, v218, v219
v_cvt_pk_bf16_f32 v239, v242, v243
v_cvt_pk_bf16_f32 v238, v240, v241
v_cvt_pk_bf16_f32 v224, v212, v213
v_permlane32_swap_b32 v100, v101
v_mfma_f32_16x16x32_bf16 v[216:219], v[236:239], v[36:39], 0
v_mov_b32 v103, v102
v_cvt_pk_bf16_f32 v235, v202, v203
v_mfma_f32_16x16x32_bf16 v[212:215], v[236:239], v[38:41], 0
v_cvt_pk_bf16_f32 v243, v198, v199
v_permlane32_swap_b32 v102, v103
v_mfma_f32_16x16x32_bf16 v[200:203], v[244:247], v[36:39], 0
v_cvt_pk_bf16_f32 v242, v196, v197
v_mov_b32 v5, 2
v_mfma_f32_16x16x32_bf16 v[220:223], v[232:235], v[120:123], 0
v_cvt_pk_bf16_f32 v249, v218, v219
v_cvt_pk_bf16_f32 v248, v216, v217
v_cvt_pk_bf16_f32 v241, v214, v215
v_cvt_pk_bf16_f32 v240, v212, v213
v_cmp_eq_u32 s[50:51], s41, v2
v_pk_mul_f32 v[64:65], v[64:65], v[100:101] op_sel:[0,0] op_sel_hi:[1,0]
v_pk_mul_f32 v[74:75], v[74:75], v[100:101] op_sel:[0,1] op_sel_hi:[1,1]
v_pk_mul_f32 v[68:69], v[68:69], v[100:101] op_sel:[0,1] op_sel_hi:[1,1]
v_pk_mul_f32 v[72:73], v[72:73], v[100:101] op_sel:[0,1] op_sel_hi:[1,1]
v_pk_mul_f32 v[60:61], v[60:61], v[100:101] op_sel:[0,0] op_sel_hi:[1,0]
v_pk_mul_f32 v[62:63], v[62:63], v[100:101] op_sel:[0,0] op_sel_hi:[1,0]
v_pk_mul_f32 v[66:67], v[66:67], v[100:101] op_sel:[0,0] op_sel_hi:[1,0]
v_pk_mul_f32 v[76:77], v[76:77], v[102:103] op_sel:[0,0] op_sel_hi:[1,0]
v_pk_mul_f32 v[70:71], v[70:71], v[100:101] op_sel:[0,1] op_sel_hi:[1,1]
v_cvt_pk_bf16_f32 v60, v60, v61
v_pk_mul_f32 v[80:81], v[80:81], v[102:103] op_sel:[0,0] op_sel_hi:[1,0]
v_pk_mul_f32 v[78:79], v[78:79], v[102:103] op_sel:[0,0] op_sel_hi:[1,0]
v_pk_mul_f32 v[82:83], v[82:83], v[102:103] op_sel:[0,0] op_sel_hi:[1,0]
v_pk_mul_f32 v[86:87], v[86:87], v[102:103] op_sel:[0,1] op_sel_hi:[1,1]
v_cvt_pk_bf16_f32 v61, v62, v63
v_pk_mul_f32 v[84:85], v[84:85], v[102:103] op_sel:[0,1] op_sel_hi:[1,1]
v_cvt_pk_bf16_f32 v62, v64, v65
v_pk_mul_f32 v[88:89], v[88:89], v[102:103] op_sel:[0,1] op_sel_hi:[1,1]
v_cvt_pk_bf16_f32 v63, v66, v67
v_pk_mul_f32 v[90:91], v[90:91], v[102:103] op_sel:[0,1] op_sel_hi:[1,1]
v_cvt_pk_bf16_f32 v68, v68, v69
v_mfma_f32_16x16x32_bf16 v[208:211], v[60:63], v[36:39], 0
v_cvt_pk_bf16_f32 v69, v70, v71
v_cvt_pk_bf16_f32 v70, v72, v73
v_mfma_f32_16x16x32_bf16 v[204:207], v[60:63], v[38:41], 0
v_cvt_pk_bf16_f32 v71, v74, v75
v_cvt_pk_bf16_f32 v76, v76, v77
v_mfma_f32_16x16x32_bf16 v[60:63], v[232:235], v[112:115], 0
v_cvt_pk_bf16_f32 v250, v200, v201
v_cvt_pk_bf16_f32 v77, v78, v79
v_mfma_f32_16x16x32_bf16 v[192:195], v[68:71], v[36:39], 0
v_cvt_pk_bf16_f32 v78, v80, v81
v_cvt_pk_bf16_f32 v79, v82, v83
v_mfma_f32_16x16x32_bf16 v[188:191], v[68:71], v[38:41], 0
v_cvt_pk_bf16_f32 v65, v206, v207
v_cvt_pk_bf16_f32 v64, v204, v205
v_mfma_f32_16x16x32_bf16 v[68:71], v[224:227], v[120:123], 0
v_cvt_pk_bf16_f32 v251, v202, v203
v_cvt_pk_bf16_f32 v72, v208, v209
v_mfma_f32_16x16x32_bf16 v[152:155], v[224:227], v[112:115], 0
v_cvt_pk_bf16_f32 v73, v210, v211
v_cvt_pk_bf16_f32 v84, v84, v85
v_mfma_f32_16x16x32_bf16 v[60:63], v[248:251], v[116:119], v[60:63]
v_cvt_pk_bf16_f32 v85, v86, v87
v_cvt_pk_bf16_f32 v86, v88, v89
v_mfma_f32_16x16x32_bf16 v[228:231], v[224:227], v[48:51], 0
v_cvt_pk_bf16_f32 v67, v190, v191
v_cvt_pk_bf16_f32 v87, v90, v91
v_mfma_f32_16x16x32_bf16 v[220:223], v[248:251], v[124:127], v[220:223]
v_cvt_pk_bf16_f32 v66, v188, v189
v_cvt_pk_bf16_f32 v74, v192, v193
v_mfma_f32_16x16x32_bf16 v[152:155], v[240:243], v[116:119], v[152:155]
v_cvt_pk_bf16_f32 v75, v194, v195
v_mfma_f32_16x16x32_bf16 v[204:207], v[76:79], v[38:41], 0
v_mfma_f32_16x16x32_bf16 v[208:211], v[76:79], v[36:39], 0
v_mfma_f32_16x16x32_bf16 v[228:231], v[240:243], v[48:51], v[228:231]
v_mfma_f32_16x16x32_bf16 v[68:71], v[240:243], v[124:127], v[68:71]
v_mfma_f32_16x16x32_bf16 v[76:79], v[232:235], v[48:51], 0
s_nop 1
v_cvt_pk_bf16_f32 v152, v152, v153
v_mfma_f32_16x16x32_bf16 v[76:79], v[248:251], v[48:51], v[76:79]
v_cvt_pk_bf16_f32 v153, v154, v155
v_cvt_pk_bf16_f32 v154, v60, v61
v_mfma_f32_16x16x32_bf16 v[192:195], v[84:87], v[36:39], 0
v_cvt_pk_bf16_f32 v68, v68, v69
v_cvt_pk_bf16_f32 v155, v62, v63
v_mfma_f32_16x16x32_bf16 v[188:191], v[84:87], v[38:41], 0
ds_write_b128 v42, v[152:155] offset:0
v_mfma_f32_16x16x32_bf16 v[136:139], v[64:67], v[48:51], 0
v_cvt_pk_bf16_f32 v69, v70, v71
v_cvt_pk_bf16_f32 v228, v228, v229
v_mfma_f32_16x16x32_bf16 v[104:107], v[72:75], v[112:115], 0
v_cvt_pk_bf16_f32 v71, v222, v223
v_cvt_pk_bf16_f32 v229, v230, v231
v_mfma_f32_16x16x32_bf16 v[148:151], v[72:75], v[48:51], 0
v_cvt_pk_bf16_f32 v230, v76, v77
v_cvt_pk_bf16_f32 v70, v220, v221
v_mfma_f32_16x16x32_bf16 v[132:135], v[72:75], v[120:123], 0
ds_write_b128 v42, v[68:71] offset:1024
v_mfma_f32_16x16x32_bf16 v[108:111], v[64:67], v[120:123], 0
v_cvt_pk_bf16_f32 v231, v78, v79
ds_write_b128 v42, v[228:231] offset:2048
v_mfma_f32_16x16x32_bf16 v[100:103], v[64:67], v[112:115], 0
ds_write_b32 v52, v5
v_cvt_pk_bf16_f32 v88, v208, v209
v_cvt_pk_bf16_f32 v83, v190, v191
v_cvt_pk_bf16_f32 v91, v194, v195
v_cvt_pk_bf16_f32 v82, v188, v189
v_cvt_pk_bf16_f32 v80, v204, v205
v_cvt_pk_bf16_f32 v89, v210, v211
v_cvt_pk_bf16_f32 v81, v206, v207
v_cvt_pk_bf16_f32 v90, v192, v193
s_nop 0
v_mfma_f32_16x16x32_bf16 v[100:103], v[80:83], v[116:119], v[100:103]
v_mfma_f32_16x16x32_bf16 v[108:111], v[80:83], v[124:127], v[108:111]
v_mfma_f32_16x16x32_bf16 v[132:135], v[88:91], v[124:127], v[132:135]
v_mfma_f32_16x16x32_bf16 v[148:151], v[88:91], v[48:51], v[148:151]
v_mfma_f32_16x16x32_bf16 v[136:139], v[80:83], v[48:51], v[136:139]
v_mfma_f32_16x16x32_bf16 v[104:107], v[88:91], v[116:119], v[104:107]
s_mov_b32 s63, 0
px_83:
ds_read_b32 v4, v19
ds_read_b128 v[188:191], v43 offset:0
ds_read_b128 v[192:195], v43 offset:1024
ds_read_b128 v[196:199], v43 offset:2048
s_add_u32 s63, s63, 1
s_cmp_lt_u32 s63, 0x400000
s_waitcnt lgkmcnt(0)
v_cmp_ne_u32 vcc, 2, v4
s_cbranch_vccz pxd_84
s_cbranch_scc1 px_83
pxd_84:
v_mfma_f32_16x16x32_bf16 v[100:103], v[38:41], v[188:191], v[100:103]
v_mfma_f32_16x16x32_bf16 v[104:107], v[36:39], v[188:191], v[104:107]
v_mfma_f32_16x16x32_bf16 v[108:111], v[38:41], v[192:195], v[108:111]
v_mfma_f32_16x16x32_bf16 v[132:135], v[36:39], v[192:195], v[132:135]
v_mfma_f32_16x16x32_bf16 v[136:139], v[38:41], v[196:199], v[136:139]
v_mfma_f32_16x16x32_bf16 v[148:151], v[36:39], v[196:199], v[148:151]
s_nop 2
v_cvt_pk_bf16_f32 v100, v100, v101
v_cvt_pk_bf16_f32 v101, v102, v103
v_cvt_pk_bf16_f32 v102, v104, v105
v_cvt_pk_bf16_f32 v103, v106, v107
buffer_store_dwordx4 v[100:103], v55, s[32:35], s53 offen sc1
v_cvt_pk_bf16_f32 v108, v108, v109
v_cvt_pk_bf16_f32 v109, v110, v111
v_cvt_pk_bf16_f32 v110, v132, v133
v_cvt_pk_bf16_f32 v111, v134, v135
buffer_store_dwordx4 v[108:111], v55, s[32:35], s54 offen sc1
v_cvt_pk_bf16_f32 v136, v136, v137
v_cvt_pk_bf16_f32 v137, v138, v139
v_cvt_pk_bf16_f32 v138, v148, v149
v_cvt_pk_bf16_f32 v139, v150, v151
s_mov_b64 exec, s[50:51]
buffer_store_dwordx4 v[136:139], v58, s[32:35], s56 offen sc1
s_mov_b64 exec, -1
s_mov_b32 s51, 0
.p2align 3
v_pk_fma_f32 v[156:157], v[140:141], v[92:93], v[156:157] op_sel:[0,1,0] op_sel_hi:[1,1,1]
v_pk_fma_f32 v[164:165], v[140:141], v[94:95], v[164:165] op_sel:[0,1,0] op_sel_hi:[1,1,1]
v_pk_fma_f32 v[172:173], v[140:141], v[96:97], v[172:173] op_sel:[0,1,0] op_sel_hi:[1,1,1]
v_pk_fma_f32 v[180:181], v[140:141], v[98:99], v[180:181] op_sel:[0,1,0] op_sel_hi:[1,1,1]
v_pk_fma_f32 v[158:159], v[142:143], v[92:93], v[158:159] op_sel:[0,1,0] op_sel_hi:[1,1,1]
v_cvt_pk_bf16_f32 v156, v156, v157
v_pk_fma_f32 v[166:167], v[142:143], v[94:95], v[166:167] op_sel:[0,1,0] op_sel_hi:[1,1,1]
v_cvt_pk_bf16_f32 v164, v164, v165
v_pk_fma_f32 v[174:175], v[142:143], v[96:97], v[174:175] op_sel:[0,1,0] op_sel_hi:[1,1,1]
v_cvt_pk_bf16_f32 v172, v172, v173
v_pk_fma_f32 v[182:183], v[142:143], v[98:99], v[182:183] op_sel:[0,1,0] op_sel_hi:[1,1,1]
v_cvt_pk_bf16_f32 v180, v180, v181
v_pk_fma_f32 v[160:161], v[144:145], v[92:93], v[160:161] op_sel:[0,1,0] op_sel_hi:[1,1,1]
v_pk_fma_f32 v[162:163], v[146:147], v[92:93], v[162:163] op_sel:[0,1,0] op_sel_hi:[1,1,1]
v_cvt_pk_bf16_f32 v157, v158, v159
v_pk_fma_f32 v[168:169], v[144:145], v[94:95], v[168:169] op_sel:[0,1,0] op_sel_hi:[1,1,1]
v_pk_fma_f32 v[170:171], v[146:147], v[94:95], v[170:171] op_sel:[0,1,0] op_sel_hi:[1,1,1]
v_cvt_pk_bf16_f32 v165, v166, v167
v_pk_fma_f32 v[176:177], v[144:145], v[96:97], v[176:177] op_sel:[0,1,0] op_sel_hi:[1,1,1]
v_pk_fma_f32 v[178:179], v[146:147], v[96:97], v[178:179] op_sel:[0,1,0] op_sel_hi:[1,1,1]
v_cvt_pk_bf16_f32 v173, v174, v175
v_pk_fma_f32 v[184:185], v[144:145], v[98:99], v[184:185] op_sel:[0,1,0] op_sel_hi:[1,1,1]
v_pk_fma_f32 v[186:187], v[146:147], v[98:99], v[186:187] op_sel:[0,1,0] op_sel_hi:[1,1,1]
v_cvt_pk_bf16_f32 v181, v182, v183
v_cvt_pk_bf16_f32 v158, v160, v161
v_cvt_pk_bf16_f32 v159, v162, v163
v_cvt_pk_bf16_f32 v166, v168, v169
v_cvt_pk_bf16_f32 v167, v170, v171
v_mfma_f32_16x16x32_bf16 v[60:63], v[10:13], v[156:159], 0
v_cvt_pk_bf16_f32 v174, v176, v177
v_cvt_pk_bf16_f32 v175, v178, v179
v_mfma_f32_16x16x32_bf16 v[68:71], v[10:13], v[164:167], 0
v_cvt_pk_bf16_f32 v182, v184, v185
v_cvt_pk_bf16_f32 v183, v186, v187
v_mfma_f32_16x16x32_bf16 v[76:79], v[10:13], v[172:175], 0
s_nop 0
v_mfma_f32_16x16x32_bf16 v[84:87], v[10:13], v[180:183], 0
v_min3_f32 v104, v60, v61, v62
v_max3_f32 v100, v60, v61, v62
v_mfma_f32_16x16x32_bf16 v[64:67], v[14:17], v[156:159], 0
v_min3_f32 v105, v68, v69, v70
v_max3_f32 v101, v68, v69, v70
v_mfma_f32_16x16x32_bf16 v[72:75], v[14:17], v[164:167], 0
v_min3_f32 v106, v76, v77, v78
v_max3_f32 v102, v76, v77, v78
v_mfma_f32_16x16x32_bf16 v[80:83], v[14:17], v[172:175], 0
v_min3_f32 v107, v84, v85, v86
v_max3_f32 v103, v84, v85, v86
v_mfma_f32_16x16x32_bf16 v[88:91], v[14:17], v[180:183], 0
v_min3_f32 v104, v104, v63, v64
v_max3_f32 v100, v100, v63, v64
v_min3_f32 v105, v105, v71, v72
v_min3_f32 v104, v104, v65, v66
v_max3_f32 v101, v101, v71, v72
v_min3_f32 v106, v106, v79, v80
v_min3_f32 v105, v105, v73, v74
v_max3_f32 v102, v102, v79, v80
v_min3_f32 v107, v107, v87, v88
v_min3_f32 v106, v106, v81, v82
v_max3_f32 v103, v103, v87, v88
v_min3_f32 v107, v107, v89, v90
v_max3_f32 v100, v100, v65, v66
v_min_f32 v104, v104, v67
v_max3_f32 v101, v101, v73, v74
v_min_f32 v105, v105, v75
v_max3_f32 v102, v102, v81, v82
v_min_f32 v106, v106, v83
v_max3_f32 v103, v103, v89, v90
v_min_f32 v107, v107, v91
v_max_f32 v100, v100, v67
v_max_f32 v101, v101, v75
v_max_f32 v102, v102, v83
v_max_f32 v103, v103, v91
v_permlane32_swap_b32 v104, v105
v_permlane32_swap_b32 v106, v107
v_permlane32_swap_b32 v100, v101
v_permlane32_swap_b32 v102, v103
v_min_f32 v104, v104, v105
v_min_f32 v106, v106, v107
v_max_f32 v100, v100, v101
v_max_f32 v102, v102, v103
v_permlane16_swap_b32 v104, v106
s_nop 0
v_permlane16_swap_b32 v100, v102
v_min_f32 v104, v104, v106
v_max_f32 v100, v100, v102
v_mov_b32 v106, v104
v_mov_b32 v102, v100
s_nop 0
v_permlane16_swap_b32 v104, v106
v_permlane16_swap_b32 v100, v102
v_mov_b32 v105, v104
v_mov_b32 v101, v100
v_mov_b32 v103, v102
v_permlane32_swap_b32 v104, v105
v_mov_b32 v107, v106
v_permlane32_swap_b32_e64 v100, v101
v_pk_mul_f32 v[104:105], v[104:105], v[128:129]
v_pk_mul_f32 v[100:101], v[100:101], v[128:129]
v_pk_fma_f32 v[220:221], v[60:61], v[128:129], v[104:105] op_sel:[0,0,0] op_sel_hi:[1,0,0] neg_lo:[1,0,0] neg_hi:[1,0,0]
v_pk_fma_f32 v[222:223], v[62:63], v[128:129], v[104:105] op_sel:[0,0,0] op_sel_hi:[1,0,0] neg_lo:[1,0,0] neg_hi:[1,0,0]
v_pk_fma_f32 v[224:225], v[64:65], v[128:129], v[104:105] op_sel:[0,0,0] op_sel_hi:[1,0,0] neg_lo:[1,0,0] neg_hi:[1,0,0]
v_pk_fma_f32 v[226:227], v[66:67], v[128:129], v[104:105] op_sel:[0,0,0] op_sel_hi:[1,0,0] neg_lo:[1,0,0] neg_hi:[1,0,0]
v_pk_fma_f32 v[228:229], v[68:69], v[128:129], v[104:105] op_sel:[0,1,1] op_sel_hi:[1,1,1] neg_lo:[1,0,0] neg_hi:[1,0,0]
v_pk_fma_f32 v[230:231], v[70:71], v[128:129], v[104:105] op_sel:[0,1,1] op_sel_hi:[1,1,1] neg_lo:[1,0,0] neg_hi:[1,0,0]
v_pk_fma_f32 v[232:233], v[72:73], v[128:129], v[104:105] op_sel:[0,1,1] op_sel_hi:[1,1,1] neg_lo:[1,0,0] neg_hi:[1,0,0]
v_pk_fma_f32 v[234:235], v[74:75], v[128:129], v[104:105] op_sel:[0,1,1] op_sel_hi:[1,1,1] neg_lo:[1,0,0] neg_hi:[1,0,0]
v_permlane32_swap_b32 v102, v103
v_permlane32_swap_b32 v106, v107
v_pk_fma_f32 v[60:61], v[60:61], v[128:129], v[100:101] op_sel:[0,0,0] op_sel_hi:[1,0,0] neg_lo:[0,0,1] neg_hi:[0,0,1]
v_pk_fma_f32 v[62:63], v[62:63], v[128:129], v[100:101] op_sel:[0,0,0] op_sel_hi:[1,0,0] neg_lo:[0,0,1] neg_hi:[0,0,1]
v_pk_fma_f32 v[64:65], v[64:65], v[128:129], v[100:101] op_sel:[0,0,0] op_sel_hi:[1,0,0] neg_lo:[0,0,1] neg_hi:[0,0,1]
v_pk_fma_f32 v[66:67], v[66:67], v[128:129], v[100:101] op_sel:[0,0,0] op_sel_hi:[1,0,0] neg_lo:[0,0,1] neg_hi:[0,0,1]
v_pk_fma_f32 v[68:69], v[68:69], v[128:129], v[100:101] op_sel:[0,1,1] op_sel_hi:[1,1,1] neg_lo:[0,0,1] neg_hi:[0,0,1]
v_pk_fma_f32 v[70:71], v[70:71], v[128:129], v[100:101] op_sel:[0,1,1] op_sel_hi:[1,1,1] neg_lo:[0,0,1] neg_hi:[0,0,1]
v_pk_fma_f32 v[72:73], v[72:73], v[128:129], v[100:101] op_sel:[0,1,1] op_sel_hi:[1,1,1] neg_lo:[0,0,1] neg_hi:[0,0,1]
v_pk_fma_f32 v[74:75], v[74:75], v[128:129], v[100:101] op_sel:[0,1,1] op_sel_hi:[1,1,1] neg_lo:[0,0,1] neg_hi:[0,0,1]
v_exp_f32 v220, v220
v_exp_f32 v60, v60
v_exp_f32 v221, v221
v_exp_f32 v61, v61
v_exp_f32 v222, v222
v_exp_f32 v62, v62
v_exp_f32 v223, v223
v_exp_f32 v63, v63
v_exp_f32 v224, v224
v_exp_f32 v64, v64
v_exp_f32 v225, v225
v_exp_f32 v65, v65
v_exp_f32 v226, v226
v_exp_f32 v66, v66
v_exp_f32 v227, v227
v_exp_f32 v67, v67
v_exp_f32 v228, v228
v_exp_f32 v68, v68
v_exp_f32 v229, v229
v_exp_f32 v69, v69
v_exp_f32 v230, v230
v_exp_f32 v70, v70
v_exp_f32 v231, v231
v_exp_f32 v71, v71
v_exp_f32 v232, v232
v_exp_f32 v72, v72
v_exp_f32 v233, v233
v_exp_f32 v73, v73
v_exp_f32 v234, v234
v_exp_f32 v74, v74
v_exp_f32 v235, v235
v_exp_f32 v75, v75
v_pk_mul_f32 v[102:103], v[102:103], v[130:131]
v_pk_mul_f32 v[106:107], v[106:107], v[130:131]
buffer_load_dwordx4 v[212:215], v18, s[32:35], s55 offen offset:0 sc1
buffer_load_dwordx4 v[216:219], v18, s[32:35], s55 offen offset:1024 sc1
.p2align 3
v_pk_add_f32 v[108:109], v[60:61], v[62:63]
v_pk_add_f32 v[110:111], v[220:221], v[222:223]
v_pk_add_f32 v[108:109], v[108:109], v[64:65]
v_pk_add_f32 v[110:111], v[110:111], v[224:225]
v_pk_add_f32 v[108:109], v[108:109], v[66:67]
v_pk_add_f32 v[110:111], v[110:111], v[226:227]
v_add_f32 v100, v108, v109
v_add_f32 v104, v110, v111
v_pk_fma_f32 v[236:237], v[76:77], v[130:131], v[106:107] op_sel:[0,0,0] op_sel_hi:[1,0,0] neg_lo:[1,0,0] neg_hi:[1,0,0]
v_pk_fma_f32 v[238:239], v[78:79], v[130:131], v[106:107] op_sel:[0,0,0] op_sel_hi:[1,0,0] neg_lo:[1,0,0] neg_hi:[1,0,0]
v_pk_add_f32 v[108:109], v[68:69], v[70:71]
v_pk_add_f32 v[110:111], v[228:229], v[230:231]
v_pk_fma_f32 v[76:77], v[76:77], v[130:131], v[102:103] op_sel:[0,0,0] op_sel_hi:[1,0,0] neg_lo:[0,0,1] neg_hi:[0,0,1]
v_pk_fma_f32 v[78:79], v[78:79], v[130:131], v[102:103] op_sel:[0,0,0] op_sel_hi:[1,0,0] neg_lo:[0,0,1] neg_hi:[0,0,1]
v_pk_fma_f32 v[240:241], v[80:81], v[130:131], v[106:107] op_sel:[0,0,0] op_sel_hi:[1,0,0] neg_lo:[1,0,0] neg_hi:[1,0,0]
v_pk_add_f32 v[108:109], v[108:109], v[72:73]
v_pk_add_f32 v[110:111], v[110:111], v[232:233]
v_exp_f32 v236, v236
v_exp_f32 v76, v76
v_exp_f32 v237, v237
v_exp_f32 v77, v77
v_exp_f32 v238, v238
v_exp_f32 v78, v78
v_exp_f32 v239, v239
v_exp_f32 v79, v79
v_pk_fma_f32 v[80:81], v[80:81], v[130:131], v[102:103] op_sel:[0,0,0] op_sel_hi:[1,0,0] neg_lo:[0,0,1] neg_hi:[0,0,1]
v_pk_fma_f32 v[242:243], v[82:83], v[130:131], v[106:107] op_sel:[0,0,0] op_sel_hi:[1,0,0] neg_lo:[1,0,0] neg_hi:[1,0,0]
v_pk_add_f32 v[108:109], v[108:109], v[74:75]
v_pk_add_f32 v[110:111], v[110:111], v[234:235]
v_exp_f32 v240, v240
v_exp_f32 v80, v80
v_exp_f32 v241, v241
v_exp_f32 v81, v81
v_pk_fma_f32 v[82:83], v[82:83], v[130:131], v[102:103] op_sel:[0,0,0] op_sel_hi:[1,0,0] neg_lo:[0,0,1] neg_hi:[0,0,1]
v_add_f32 v101, v108, v109
v_add_f32 v105, v110, v111
v_exp_f32 v242, v242
v_exp_f32 v82, v82
v_exp_f32 v243, v243
v_exp_f32 v83, v83
v_pk_fma_f32 v[244:245], v[84:85], v[130:131], v[106:107] op_sel:[0,1,1] op_sel_hi:[1,1,1] neg_lo:[1,0,0] neg_hi:[1,0,0]
v_pk_fma_f32 v[246:247], v[86:87], v[130:131], v[106:107] op_sel:[0,1,1] op_sel_hi:[1,1,1] neg_lo:[1,0,0] neg_hi:[1,0,0]
v_pk_add_f32 v[108:109], v[76:77], v[78:79]
v_pk_add_f32 v[110:111], v[236:237], v[238:239]
v_pk_fma_f32 v[84:85], v[84:85], v[130:131], v[102:103] op_sel:[0,1,1] op_sel_hi:[1,1,1] neg_lo:[0,0,1] neg_hi:[0,0,1]
v_pk_fma_f32 v[86:87], v[86:87], v[130:131], v[102:103] op_sel:[0,1,1] op_sel_hi:[1,1,1] neg_lo:[0,0,1] neg_hi:[0,0,1]
v_pk_fma_f32 v[248:249], v[88:89], v[130:131], v[106:107] op_sel:[0,1,1] op_sel_hi:[1,1,1] neg_lo:[1,0,0] neg_hi:[1,0,0]
v_pk_fma_f32 v[250:251], v[90:91], v[130:131], v[106:107] op_sel:[0,1,1] op_sel_hi:[1,1,1] neg_lo:[1,0,0] neg_hi:[1,0,0]
v_pk_add_f32 v[108:109], v[108:109], v[80:81]
v_pk_add_f32 v[110:111], v[110:111], v[240:241]
v_exp_f32 v244, v244
v_exp_f32 v84, v84
v_exp_f32 v245, v245
v_exp_f32 v85, v85
v_exp_f32 v246, v246
v_exp_f32 v86, v86
v_exp_f32 v247, v247
v_exp_f32 v87, v87
v_pk_fma_f32 v[88:89], v[88:89], v[130:131], v[102:103] op_sel:[0,1,1] op_sel_hi:[1,1,1] neg_lo:[0,0,1] neg_hi:[0,0,1]
v_pk_fma_f32 v[90:91], v[90:91], v[130:131], v[102:103] op_sel:[0,1,1] op_sel_hi:[1,1,1] neg_lo:[0,0,1] neg_hi:[0,0,1]
v_pk_add_f32 v[108:109], v[108:109], v[82:83]
v_pk_add_f32 v[110:111], v[110:111], v[242:243]
v_exp_f32 v248, v248
v_exp_f32 v88, v88
v_exp_f32 v249, v249
v_exp_f32 v89, v89
v_add_f32 v102, v108, v109
v_add_f32 v106, v110, v111
v_exp_f32 v250, v250
v_exp_f32 v90, v90
v_exp_f32 v251, v251
v_exp_f32 v91, v91
v_pk_add_f32 v[108:109], v[84:85], v[86:87]
v_pk_add_f32 v[110:111], v[244:245], v[246:247]
v_pk_add_f32 v[108:109], v[108:109], v[88:89]
v_pk_add_f32 v[110:111], v[110:111], v[248:249]
v_pk_add_f32 v[108:109], v[108:109], v[90:91]
v_pk_add_f32 v[110:111], v[110:111], v[250:251]
v_add_f32 v103, v108, v109
v_add_f32 v107, v110, v111
s_cmp_eq_u32 s51, 1
s_cbranch_scc1 chk_85
s_waitcnt vmcnt(0)
v_max_u32 v4, v212, v213
v_max3_u32 v4, v4, v214, v215
v_max3_u32 v4, v4, v216, v217
v_max3_u32 v4, v4, v218, v219
v_cmp_eq_u32 vcc, -1, v4
s_cbranch_vccz red_86
buffer_load_dwordx4 v[212:215], v18, s[32:35], s55 offen offset:0 sc1
buffer_load_dwordx4 v[216:219], v18, s[32:35], s55 offen offset:1024 sc1
s_branch chk_85
red_86:
v_mfma_f32_16x16x32_bf16 v[132:135], v[44:47], v[212:215], 0
v_mfma_f32_16x16x32_bf16 v[132:135], v[44:47], v[216:219], v[132:135]
s_mov_b32 s51, 1
s_nop 6
v_add_f32_dpp v132, v132, v132 row_ror:8 row_mask:0xf bank_mask:0xf
v_add_f32_dpp v133, v133, v133 row_ror:8 row_mask:0xf bank_mask:0xf
v_add_f32_dpp v134, v134, v134 row_ror:8 row_mask:0xf bank_mask:0xf
v_add_f32_dpp v135, v135, v135 row_ror:8 row_mask:0xf bank_mask:0xf
v_cvt_pk_bf16_f32 v132, v132, v133
v_cvt_pk_bf16_f32 v133, v134, v135
s_mov_b64 exec, 0x00ff00ff
buffer_store_dwordx2 v[132:133], v59, s[32:35], s79 offen sc1
s_mov_b64 exec, -1
buffer_load_dwordx4 v[204:207], v58, s[32:35], s56 offen sc1
buffer_load_dwordx4 v[208:211], v58, s[32:35], s57 offen sc1
chk_85:
.p2align 3
v_permlane32_swap_b32 v100, v101
v_permlane32_swap_b32 v102, v103
v_permlane32_swap_b32 v104, v105
v_permlane32_swap_b32 v106, v107
v_add_f32 v100, v100, v101
v_add_f32 v102, v102, v103
v_add_f32 v104, v104, v105
v_add_f32 v106, v106, v107
v_permlane16_swap_b32 v100, v102
s_nop 0
v_permlane16_swap_b32 v104, v106
v_add_f32 v100, v100, v102
v_add_f32 v104, v104, v106
v_rcp_f32 v100, v100
v_rcp_f32 v104, v104
v_mov_b32 v102, v100
v_mov_b32 v106, v104
s_nop 0
v_permlane16_swap_b32 v100, v102
v_permlane16_swap_b32 v104, v106
v_mov_b32 v101, v100
v_mov_b32 v103, v102
v_mov_b32 v105, v104
v_mov_b32 v107, v106
v_permlane32_swap_b32 v100, v101
v_permlane32_swap_b32 v102, v103
v_permlane32_swap_b32 v104, v105
v_permlane32_swap_b32 v106, v107
v_pk_mul_f32 v[60:61], v[60:61], v[100:101] op_sel:[0,0] op_sel_hi:[1,0]
v_pk_mul_f32 v[220:221], v[220:221], v[104:105] op_sel:[0,0] op_sel_hi:[1,0]
v_pk_mul_f32 v[68:69], v[68:69], v[100:101] op_sel:[0,1] op_sel_hi:[1,1]
v_pk_mul_f32 v[228:229], v[228:229], v[104:105] op_sel:[0,1] op_sel_hi:[1,1]
v_pk_mul_f32 v[76:77], v[76:77], v[102:103] op_sel:[0,0] op_sel_hi:[1,0]
v_pk_mul_f32 v[236:237], v[236:237], v[106:107] op_sel:[0,0] op_sel_hi:[1,0]
v_pk_mul_f32 v[84:85], v[84:85], v[102:103] op_sel:[0,1] op_sel_hi:[1,1]
v_pk_mul_f32 v[244:245], v[244:245], v[106:107] op_sel:[0,1] op_sel_hi:[1,1]
v_pk_mul_f32 v[62:63], v[62:63], v[100:101] op_sel:[0,0] op_sel_hi:[1,0]
v_pk_mul_f32 v[222:223], v[222:223], v[104:105] op_sel:[0,0] op_sel_hi:[1,0]
v_cvt_pk_bf16_f32 v60, v60, v61
v_cvt_pk_bf16_f32 v220, v220, v221
v_pk_mul_f32 v[70:71], v[70:71], v[100:101] op_sel:[0,1] op_sel_hi:[1,1]
v_pk_mul_f32 v[230:231], v[230:231], v[104:105] op_sel:[0,1] op_sel_hi:[1,1]
v_cvt_pk_bf16_f32 v68, v68, v69
v_cvt_pk_bf16_f32 v228, v228, v229
v_pk_mul_f32 v[78:79], v[78:79], v[102:103] op_sel:[0,0] op_sel_hi:[1,0]
v_pk_mul_f32 v[238:239], v[238:239], v[106:107] op_sel:[0,0] op_sel_hi:[1,0]
v_cvt_pk_bf16_f32 v76, v76, v77
v_cvt_pk_bf16_f32 v236, v236, v237
v_pk_mul_f32 v[86:87], v[86:87], v[102:103] op_sel:[0,1] op_sel_hi:[1,1]
v_pk_mul_f32 v[246:247], v[246:247], v[106:107] op_sel:[0,1] op_sel_hi:[1,1]
v_cvt_pk_bf16_f32 v84, v84, v85
v_cvt_pk_bf16_f32 v244, v244, v245
v_pk_mul_f32 v[64:65], v[64:65], v[100:101] op_sel:[0,0] op_sel_hi:[1,0]
v_pk_mul_f32 v[66:67], v[66:67], v[100:101] op_sel:[0,0] op_sel_hi:[1,0]
v_pk_mul_f32 v[224:225], v[224:225], v[104:105] op_sel:[0,0] op_sel_hi:[1,0]
v_pk_mul_f32 v[226:227], v[226:227], v[104:105] op_sel:[0,0] op_sel_hi:[1,0]
v_cvt_pk_bf16_f32 v61, v62, v63
v_cvt_pk_bf16_f32 v221, v222, v223
v_pk_mul_f32 v[72:73], v[72:73], v[100:101] op_sel:[0,1] op_sel_hi:[1,1]
v_pk_mul_f32 v[74:75], v[74:75], v[100:101] op_sel:[0,1] op_sel_hi:[1,1]
v_pk_mul_f32 v[232:233], v[232:233], v[104:105] op_sel:[0,1] op_sel_hi:[1,1]
v_pk_mul_f32 v[234:235], v[234:235], v[104:105] op_sel:[0,1] op_sel_hi:[1,1]
v_cvt_pk_bf16_f32 v69, v70, v71
v_cvt_pk_bf16_f32 v229, v230, v231
v_pk_mul_f32 v[80:81], v[80:81], v[102:103] op_sel:[0,0] op_sel_hi:[1,0]
v_pk_mul_f32 v[82:83], v[82:83], v[102:103] op_sel:[0,0] op_sel_hi:[1,0]
v_pk_mul_f32 v[240:241], v[240:241], v[106:107] op_sel:[0,0] op_sel_hi:[1,0]
v_pk_mul_f32 v[242:243], v[242:243], v[106:107] op_sel:[0,0] op_sel_hi:[1,0]
v_cvt_pk_bf16_f32 v77, v78, v79
v_cvt_pk_bf16_f32 v237, v238, v239
v_pk_mul_f32 v[88:89], v[88:89], v[102:103] op_sel:[0,1] op_sel_hi:[1,1]
v_pk_mul_f32 v[90:91], v[90:91], v[102:103] op_sel:[0,1] op_sel_hi:[1,1]
v_pk_mul_f32 v[248:249], v[248:249], v[106:107] op_sel:[0,1] op_sel_hi:[1,1]
v_pk_mul_f32 v[250:251], v[250:251], v[106:107] op_sel:[0,1] op_sel_hi:[1,1]
v_cvt_pk_bf16_f32 v85, v86, v87
v_cvt_pk_bf16_f32 v245, v246, v247
v_cvt_pk_bf16_f32 v62, v64, v65
v_cvt_pk_bf16_f32 v63, v66, v67
v_cvt_pk_bf16_f32 v222, v224, v225
v_cvt_pk_bf16_f32 v223, v226, v227
v_cvt_pk_bf16_f32 v70, v72, v73
v_cvt_pk_bf16_f32 v71, v74, v75
v_cvt_pk_bf16_f32 v230, v232, v233
v_cvt_pk_bf16_f32 v231, v234, v235
v_cvt_pk_bf16_f32 v78, v80, v81
v_cvt_pk_bf16_f32 v79, v82, v83
v_cvt_pk_bf16_f32 v238, v240, v241
v_cvt_pk_bf16_f32 v239, v242, v243
v_cvt_pk_bf16_f32 v86, v88, v89
v_cvt_pk_bf16_f32 v87, v90, v91
v_cvt_pk_bf16_f32 v246, v248, v249
v_cvt_pk_bf16_f32 v247, v250, v251
s_cmp_lg_u32 s51, 0
s_cbranch_scc1 else_87
s_mov_b32 s63, 0
sent_89:
s_waitcnt vmcnt(0)
v_max_u32 v4, v212, v213
v_max3_u32 v4, v4, v214, v215
v_max3_u32 v4, v4, v216, v217
v_max3_u32 v4, v4, v218, v219
v_cmp_eq_u32 vcc, -1, v4
s_cbranch_vccz sentd_90
buffer_load_dwordx4 v[212:215], v18, s[32:35], s55 offen offset:0 sc1
buffer_load_dwordx4 v[216:219], v18, s[32:35], s55 offen offset:1024 sc1
s_add_u32 s63, s63, 1
s_cmp_lt_u32 s63, 0x80000
s_cbranch_scc1 sent_89
s_waitcnt vmcnt(0)
sentd_90:
v_mfma_f32_16x16x32_bf16 v[132:135], v[44:47], v[212:215], 0
v_mfma_f32_16x16x32_bf16 v[132:135], v[44:47], v[216:219], v[132:135]
s_mov_b32 s51, 1
s_nop 6
v_add_f32_dpp v132, v132, v132 row_ror:8 row_mask:0xf bank_mask:0xf
v_add_f32_dpp v133, v133, v133 row_ror:8 row_mask:0xf bank_mask:0xf
v_add_f32_dpp v134, v134, v134 row_ror:8 row_mask:0xf bank_mask:0xf
v_add_f32_dpp v135, v135, v135 row_ror:8 row_mask:0xf bank_mask:0xf
v_cvt_pk_bf16_f32 v132, v132, v133
v_cvt_pk_bf16_f32 v133, v134, v135
s_mov_b64 exec, 0x00ff00ff
buffer_store_dwordx2 v[132:133], v59, s[32:35], s79 offen sc1
s_mov_b64 exec, -1
buffer_load_dwordx4 v[204:207], v58, s[32:35], s56 offen sc1
buffer_load_dwordx4 v[208:211], v58, s[32:35], s57 offen sc1
else_87:
s_mov_b32 s63, 0
sent_91:
s_waitcnt vmcnt(0)
v_max_u32 v4, v204, v205
v_max3_u32 v4, v4, v206, v207
v_max3_u32 v4, v4, v208, v209
v_max3_u32 v4, v4, v210, v211
v_cmp_eq_u32 vcc, -1, v4
s_cbranch_vccz sentd_92
buffer_load_dwordx4 v[204:207], v58, s[32:35], s56 offen sc1
buffer_load_dwordx4 v[208:211], v58, s[32:35], s57 offen sc1
s_add_u32 s63, s63, 1
s_cmp_lt_u32 s63, 0x80000
s_cbranch_scc1 sent_91
s_waitcnt vmcnt(0)
sentd_92:
buffer_load_dwordx4 v[188:191], v18, s[32:35], s58 offen offset:0 sc1
buffer_load_dwordx4 v[192:195], v18, s[32:35], s58 offen offset:1024 sc1
buffer_load_dwordx4 v[196:199], v18, s[32:35], s59 offen offset:0 sc1
buffer_load_dwordx4 v[200:203], v18, s[32:35], s59 offen offset:1024 sc1
v_mfma_f32_16x16x32_bf16 v[112:115], v[204:207], v[60:63], 0
v_mfma_f32_16x16x32_bf16 v[116:119], v[204:207], v[68:71], 0
v_mfma_f32_16x16x32_bf16 v[120:123], v[204:207], v[76:79], 0
v_mfma_f32_16x16x32_bf16 v[124:127], v[204:207], v[84:87], 0
v_mfma_f32_16x16x32_bf16 v[112:115], v[208:211], v[220:223], v[112:115]
v_mfma_f32_16x16x32_bf16 v[116:119], v[208:211], v[228:231], v[116:119]
v_mfma_f32_16x16x32_bf16 v[120:123], v[208:211], v[236:239], v[120:123]
v_mfma_f32_16x16x32_bf16 v[124:127], v[208:211], v[244:247], v[124:127]
s_nop 4
v_add_f32 v100, v112, v113
v_add_f32 v114, v114, v115
v_add_f32 v100, v100, v114
v_add_f32 v101, v116, v117
v_add_f32 v118, v118, v119
v_add_f32 v101, v101, v118
v_add_f32 v102, v120, v121
v_add_f32 v122, v122, v123
v_add_f32 v102, v102, v122
v_add_f32 v103, v124, v125
v_add_f32 v126, v126, v127
v_add_f32 v103, v103, v126
s_nop 1
v_permlane32_swap_b32 v100, v101
v_permlane32_swap_b32 v102, v103
v_add_f32 v100, v100, v101
v_add_f32 v102, v102, v103
s_nop 1
v_permlane16_swap_b32 v100, v102
s_nop 0
v_add_f32 v100, v100, v102
v_add_f32 v100, 0x358637bd, v100
v_rcp_f32 v100, v100
s_nop 0
v_mov_b32 v102, v100
s_nop 1
v_permlane16_swap_b32 v100, v102
s_nop 0
v_mov_b32 v101, v100
v_mov_b32 v103, v102
s_nop 0
v_permlane32_swap_b32 v100, v101
v_permlane32_swap_b32 v102, v103
s_mov_b32 s63, 0
sent_93:
s_waitcnt vmcnt(0)
v_max_u32 v4, v188, v189
v_max3_u32 v4, v4, v190, v191
v_max3_u32 v4, v4, v192, v193
v_max3_u32 v4, v4, v194, v195
v_max3_u32 v4, v4, v196, v197
v_max3_u32 v4, v4, v198, v199
v_max3_u32 v4, v4, v200, v201
v_max3_u32 v4, v4, v202, v203
v_cmp_eq_u32 vcc, -1, v4
s_cbranch_vccz sentd_94
buffer_load_dwordx4 v[188:191], v18, s[32:35], s58 offen offset:0 sc1
buffer_load_dwordx4 v[192:195], v18, s[32:35], s58 offen offset:1024 sc1
buffer_load_dwordx4 v[196:199], v18, s[32:35], s59 offen offset:0 sc1
buffer_load_dwordx4 v[200:203], v18, s[32:35], s59 offen offset:1024 sc1
s_add_u32 s63, s63, 1
s_cmp_lt_u32 s63, 0x80000
s_cbranch_scc1 sent_93
s_waitcnt vmcnt(0)
sentd_94:
s_cmp_eq_u32 s46, 0
s_cbranch_scc1 slow_95
.p2align 3
v_mfma_f32_16x16x32_bf16 v[156:159], v[188:191], v[60:63], 0
v_mfma_f32_16x16x32_bf16 v[164:167], v[188:191], v[68:71], 0
v_mfma_f32_16x16x32_bf16 v[160:163], v[192:195], v[60:63], 0
v_mfma_f32_16x16x32_bf16 v[172:175], v[188:191], v[76:79], 0
v_mfma_f32_16x16x32_bf16 v[168:171], v[192:195], v[68:71], 0
v_mfma_f32_16x16x32_bf16 v[180:183], v[188:191], v[84:87], 0
v_mfma_f32_16x16x32_bf16 v[156:159], v[196:199], v[220:223], v[156:159]
v_mfma_f32_16x16x32_bf16 v[176:179], v[192:195], v[76:79], 0
v_mfma_f32_16x16x32_bf16 v[164:167], v[196:199], v[228:231], v[164:167]
v_mfma_f32_16x16x32_bf16 v[184:187], v[192:195], v[84:87], 0
v_mfma_f32_16x16x32_bf16 v[160:163], v[200:203], v[220:223], v[160:163]
v_mfma_f32_16x16x32_bf16 v[172:175], v[196:199], v[236:239], v[172:175]
v_mfma_f32_16x16x32_bf16 v[168:171], v[200:203], v[228:231], v[168:171]
v_mfma_f32_16x16x32_bf16 v[180:183], v[196:199], v[244:247], v[180:183]
v_mfma_f32_16x16x32_bf16 v[176:179], v[200:203], v[236:239], v[176:179]
v_mfma_f32_16x16x32_bf16 v[184:187], v[200:203], v[244:247], v[184:187]
v_pk_mul_f32 v[156:157], v[156:157], v[100:101] op_sel:[0,0] op_sel_hi:[1,0]
v_pk_mul_f32 v[158:159], v[158:159], v[100:101] op_sel:[0,0] op_sel_hi:[1,0]
v_cvt_pk_bf16_f32 v156, v156, v157
v_pk_mul_f32 v[164:165], v[164:165], v[100:101] op_sel:[0,1] op_sel_hi:[1,1]
v_pk_mul_f32 v[160:161], v[160:161], v[100:101] op_sel:[0,0] op_sel_hi:[1,0]
v_pk_mul_f32 v[162:163], v[162:163], v[100:101] op_sel:[0,0] op_sel_hi:[1,0]
v_cvt_pk_bf16_f32 v157, v158, v159
v_pk_mul_f32 v[166:167], v[166:167], v[100:101] op_sel:[0,1] op_sel_hi:[1,1]
v_cvt_pk_bf16_f32 v164, v164, v165
v_pk_mul_f32 v[172:173], v[172:173], v[102:103] op_sel:[0,0] op_sel_hi:[1,0]
v_cvt_pk_bf16_f32 v158, v160, v161
v_cvt_pk_bf16_f32 v159, v162, v163
v_pk_mul_f32 v[168:169], v[168:169], v[100:101] op_sel:[0,1] op_sel_hi:[1,1]
v_pk_mul_f32 v[170:171], v[170:171], v[100:101] op_sel:[0,1] op_sel_hi:[1,1]
v_cvt_pk_bf16_f32 v165, v166, v167
v_pk_mul_f32 v[174:175], v[174:175], v[102:103] op_sel:[0,0] op_sel_hi:[1,0]
v_cvt_pk_bf16_f32 v172, v172, v173
v_pk_mul_f32 v[180:181], v[180:181], v[102:103] op_sel:[0,1] op_sel_hi:[1,1]
buffer_store_dwordx4 v[156:159], v18, s[32:35], s80 offen
v_cvt_pk_bf16_f32 v166, v168, v169
v_cvt_pk_bf16_f32 v167, v170, v171
v_pk_mul_f32 v[176:177], v[176:177], v[102:103] op_sel:[0,0] op_sel_hi:[1,0]
v_pk_mul_f32 v[178:179], v[178:179], v[102:103] op_sel:[0,0] op_sel_hi:[1,0]
v_cvt_pk_bf16_f32 v173, v174, v175
v_pk_mul_f32 v[182:183], v[182:183], v[102:103] op_sel:[0,1] op_sel_hi:[1,1]
v_cvt_pk_bf16_f32 v180, v180, v181
buffer_store_dwordx4 v[164:167], v18, s[32:35], s81 offen
v_cvt_pk_bf16_f32 v174, v176, v177
v_cvt_pk_bf16_f32 v175, v178, v179
v_pk_mul_f32 v[184:185], v[184:185], v[102:103] op_sel:[0,1] op_sel_hi:[1,1]
v_pk_mul_f32 v[186:187], v[186:187], v[102:103] op_sel:[0,1] op_sel_hi:[1,1]
v_cvt_pk_bf16_f32 v181, v182, v183
buffer_store_dwordx4 v[172:175], v18, s[32:35], s82 offen
v_cvt_pk_bf16_f32 v182, v184, v185
v_cvt_pk_bf16_f32 v183, v186, v187
buffer_store_dwordx4 v[180:183], v18, s[32:35], s83 offen
back_96:
s_barrier
v_and_b32 v36, 31, v0
v_lshlrev_b32 v36, 2, v36
s_lshl_b32 s62, s45, 2
v_mov_b32 v4, s62
v_mov_b32 v5, 2
s_mov_b64 exec, 1
s_waitcnt vmcnt(0)
s_cmp_eq_u32 s46, 0
s_cbranch_scc1 slow_97
buffer_store_dword v5, v4, s[32:35], s84 offen
back_98:
s_mov_b64 exec, -1
v_lshrrev_b32 v4, 2, v2
v_and_b32 v5, 3, v0
v_lshl_add_u32 v6, v3, 3, v4
v_lshlrev_b32 v6, 7, v6
v_lshl_add_u32 v6, v5, 3, v6
v_lshrrev_b32 v7, 1, v4
v_and_b32 v8, 1, v3
v_lshl_add_u32 v7, v8, 1, v7
v_lshl_add_u32 v10, v7, 5, v6
v_xor_b32 v11, 32, v10
v_xor_b32 v12, 64, v10
v_xor_b32 v13, 96, v10
v_add_u32 v14, 0x10000, v10
v_add_u32 v15, 0x10000, v11
v_add_u32 v16, 0x10000, v12
v_add_u32 v17, 0x10000, v13
ds_read_b64_tr_b16 v[220:221], v10 offset:0
ds_read_b64_tr_b16 v[222:223], v10 offset:512
ds_read_b64_tr_b16 v[224:225], v11 offset:0
ds_read_b64_tr_b16 v[226:227], v11 offset:512
ds_read_b64_tr_b16 v[228:229], v12 offset:0
ds_read_b64_tr_b16 v[230:231], v12 offset:512
ds_read_b64_tr_b16 v[232:233], v13 offset:0
ds_read_b64_tr_b16 v[234:235], v13 offset:512
ds_read_b64_tr_b16 v[236:237], v10 offset:4096
ds_read_b64_tr_b16 v[238:239], v10 offset:4608
ds_read_b64_tr_b16 v[240:241], v11 offset:4096
ds_read_b64_tr_b16 v[242:243], v11 offset:4608
ds_read_b64_tr_b16 v[244:245], v12 offset:4096
ds_read_b64_tr_b16 v[246:247], v12 offset:4608
ds_read_b64_tr_b16 v[248:249], v13 offset:4096
ds_read_b64_tr_b16 v[250:251], v13 offset:4608
s_lshl_b32 s48, s41, 3
s_lshl_b32 s49, s40, 1
s_add_u32 s48, s48, s49
s_lshl_b32 s48, s48, 15
s_add_u32 s48, s48, 4194304
v_add_u32 v38, s48, v18
v_add_u32 v39, 32768, v38
s_lshl_b32 s57, s75, 11
s_add_u32 s87, s87, 262144
v_lshlrev_b32 v60, 16, v20
v_and_b32 v61, 0xffff0000, v20
v_lshlrev_b32 v62, 16, v21
v_and_b32 v63, 0xffff0000, v21
v_lshlrev_b32 v64, 16, v22
v_and_b32 v65, 0xffff0000, v22
v_lshlrev_b32 v66, 16, v23
v_and_b32 v67, 0xffff0000, v23
v_lshlrev_b32 v68, 16, v24
v_and_b32 v69, 0xffff0000, v24
v_lshlrev_b32 v70, 16, v25
v_and_b32 v71, 0xffff0000, v25
v_lshlrev_b32 v72, 16, v26
v_and_b32 v73, 0xffff0000, v26
v_lshlrev_b32 v74, 16, v27
v_and_b32 v75, 0xffff0000, v27
v_lshlrev_b32 v76, 16, v28
v_and_b32 v77, 0xffff0000, v28
v_lshlrev_b32 v78, 16, v29
v_and_b32 v79, 0xffff0000, v29
v_lshlrev_b32 v80, 16, v30
v_and_b32 v81, 0xffff0000, v30
v_lshlrev_b32 v82, 16, v31
v_and_b32 v83, 0xffff0000, v31
v_lshlrev_b32 v84, 16, v32
v_and_b32 v85, 0xffff0000, v32
v_lshlrev_b32 v86, 16, v33
v_and_b32 v87, 0xffff0000, v33
v_lshlrev_b32 v88, 16, v34
v_and_b32 v89, 0xffff0000, v34
v_lshlrev_b32 v90, 16, v35
v_and_b32 v91, 0xffff0000, v35
v_mov_b32 v6, 0
v_mov_b32 v7, 0
v_mov_b32 v8, 0
v_mov_b32 v9, 0
s_lshl_b32 s62, s42, 2
v_mov_b32 v4, s62
v_mov_b32 v5, 2
buffer_load_dword v37, v36, s[32:35], s84 offen sc1
s_mov_b32 s63, 0
s_waitcnt vmcnt(0)
poll_99:
v_cmp_gt_u32 vcc, 2, v37
s_cbranch_vccz polled_100
buffer_load_dword v37, v36, s[32:35], s84 offen sc1
s_add_u32 s63, s63, 1
s_cmp_lt_u32 s63, 0x80000
s_waitcnt vmcnt(0)
s_cbranch_scc1 poll_99
polled_100:
buffer_load_dwordx4 v[156:159], v38, s[32:35], s57 offen sc1
buffer_load_dwordx4 v[160:163], v39, s[32:35], s57 offen sc1
buffer_load_dwordx4 v[164:167], v38, s[32:35], s57 offen offset:1024 sc1
buffer_load_dwordx4 v[168:171], v39, s[32:35], s57 offen offset:1024 sc1
s_add_u32 s57, s57, 2048
s_and_b32 s57, s57, 0x7fff
buffer_load_dwordx4 v[172:175], v38, s[32:35], s57 offen sc1
buffer_load_dwordx4 v[176:179], v39, s[32:35], s57 offen sc1
buffer_load_dwordx4 v[180:183], v38, s[32:35], s57 offen offset:1024 sc1
buffer_load_dwordx4 v[184:187], v39, s[32:35], s57 offen offset:1024 sc1
s_add_u32 s57, s57, 2048
s_and_b32 s57, s57, 0x7fff
s_waitcnt vmcnt(6) lgkmcnt(8)
v_mfma_f32_16x16x32_bf16 v[60:63], v[220:223], v[156:159], v[60:63]
buffer_load_dwordx4 v[188:191], v38, s[32:35], s57 offen sc1
v_mfma_f32_16x16x32_bf16 v[76:79], v[220:223], v[160:163], v[76:79]
ds_read_b64_tr_b16 v[100:101], v10 offset:8192
ds_read_b64_tr_b16 v[102:103], v10 offset:8704
v_mfma_f32_16x16x32_bf16 v[80:83], v[224:227], v[160:163], v[80:83]
ds_read_b64_tr_b16 v[104:105], v11 offset:8192
ds_read_b64_tr_b16 v[106:107], v11 offset:8704
v_mfma_f32_16x16x32_bf16 v[64:67], v[224:227], v[156:159], v[64:67]
buffer_load_dwordx4 v[192:195], v39, s[32:35], s57 offen sc1
v_mfma_f32_16x16x32_bf16 v[68:71], v[228:231], v[156:159], v[68:71]
ds_read_b64_tr_b16 v[108:109], v12 offset:8192
ds_read_b64_tr_b16 v[110:111], v12 offset:8704
v_mfma_f32_16x16x32_bf16 v[84:87], v[228:231], v[160:163], v[84:87]
ds_read_b64_tr_b16 v[112:113], v13 offset:8192
ds_read_b64_tr_b16 v[114:115], v13 offset:8704
v_mfma_f32_16x16x32_bf16 v[88:91], v[232:235], v[160:163], v[88:91]
v_mfma_f32_16x16x32_bf16 v[72:75], v[232:235], v[156:159], v[72:75]
s_waitcnt vmcnt(6) lgkmcnt(8)
v_mfma_f32_16x16x32_bf16 v[60:63], v[236:239], v[164:167], v[60:63]
buffer_load_dwordx4 v[196:199], v38, s[32:35], s57 offen offset:1024 sc1
v_mfma_f32_16x16x32_bf16 v[76:79], v[236:239], v[168:171], v[76:79]
ds_read_b64_tr_b16 v[220:221], v10 offset:12288
ds_read_b64_tr_b16 v[222:223], v10 offset:12800
v_mfma_f32_16x16x32_bf16 v[80:83], v[240:243], v[168:171], v[80:83]
ds_read_b64_tr_b16 v[224:225], v11 offset:12288
ds_read_b64_tr_b16 v[226:227], v11 offset:12800
v_mfma_f32_16x16x32_bf16 v[64:67], v[240:243], v[164:167], v[64:67]
buffer_load_dwordx4 v[200:203], v39, s[32:35], s57 offen offset:1024 sc1
v_mfma_f32_16x16x32_bf16 v[68:71], v[244:247], v[164:167], v[68:71]
ds_read_b64_tr_b16 v[228:229], v12 offset:12288
ds_read_b64_tr_b16 v[230:231], v12 offset:12800
v_mfma_f32_16x16x32_bf16 v[84:87], v[244:247], v[168:171], v[84:87]
ds_read_b64_tr_b16 v[232:233], v13 offset:12288
ds_read_b64_tr_b16 v[234:235], v13 offset:12800
v_mfma_f32_16x16x32_bf16 v[88:91], v[248:251], v[168:171], v[88:91]
s_add_u32 s57, s57, 2048
s_and_b32 s57, s57, 0x7fff
v_mfma_f32_16x16x32_bf16 v[72:75], v[248:251], v[164:167], v[72:75]
s_waitcnt vmcnt(6) lgkmcnt(8)
v_mfma_f32_16x16x32_bf16 v[60:63], v[100:103], v[172:175], v[60:63]
buffer_load_dwordx4 v[204:207], v38, s[32:35], s57 offen sc1
v_mfma_f32_16x16x32_bf16 v[76:79], v[100:103], v[176:179], v[76:79]
ds_read_b64_tr_b16 v[236:237], v10 offset:16384
ds_read_b64_tr_b16 v[238:239], v10 offset:16896
v_mfma_f32_16x16x32_bf16 v[80:83], v[104:107], v[176:179], v[80:83]
ds_read_b64_tr_b16 v[240:241], v11 offset:16384
ds_read_b64_tr_b16 v[242:243], v11 offset:16896
v_mfma_f32_16x16x32_bf16 v[64:67], v[104:107], v[172:175], v[64:67]
buffer_load_dwordx4 v[208:211], v39, s[32:35], s57 offen sc1
v_mfma_f32_16x16x32_bf16 v[68:71], v[108:111], v[172:175], v[68:71]
ds_read_b64_tr_b16 v[244:245], v12 offset:16384
ds_read_b64_tr_b16 v[246:247], v12 offset:16896
v_mfma_f32_16x16x32_bf16 v[84:87], v[108:111], v[176:179], v[84:87]
ds_read_b64_tr_b16 v[248:249], v13 offset:16384
ds_read_b64_tr_b16 v[250:251], v13 offset:16896
v_mfma_f32_16x16x32_bf16 v[88:91], v[112:115], v[176:179], v[88:91]
v_mfma_f32_16x16x32_bf16 v[72:75], v[112:115], v[172:175], v[72:75]
s_waitcnt vmcnt(6) lgkmcnt(8)
v_mfma_f32_16x16x32_bf16 v[60:63], v[220:223], v[180:183], v[60:63]
buffer_load_dwordx4 v[212:215], v38, s[32:35], s57 offen offset:1024 sc1
v_mfma_f32_16x16x32_bf16 v[76:79], v[220:223], v[184:187], v[76:79]
ds_read_b64_tr_b16 v[100:101], v10 offset:20480
ds_read_b64_tr_b16 v[102:103], v10 offset:20992
v_mfma_f32_16x16x32_bf16 v[80:83], v[224:227], v[184:187], v[80:83]
ds_read_b64_tr_b16 v[104:105], v11 offset:20480
ds_read_b64_tr_b16 v[106:107], v11 offset:20992
v_mfma_f32_16x16x32_bf16 v[64:67], v[224:227], v[180:183], v[64:67]
buffer_load_dwordx4 v[216:219], v39, s[32:35], s57 offen offset:1024 sc1
v_mfma_f32_16x16x32_bf16 v[68:71], v[228:231], v[180:183], v[68:71]
ds_read_b64_tr_b16 v[108:109], v12 offset:20480
ds_read_b64_tr_b16 v[110:111], v12 offset:20992
v_mfma_f32_16x16x32_bf16 v[84:87], v[228:231], v[184:187], v[84:87]
ds_read_b64_tr_b16 v[112:113], v13 offset:20480
ds_read_b64_tr_b16 v[114:115], v13 offset:20992
v_mfma_f32_16x16x32_bf16 v[88:91], v[232:235], v[184:187], v[88:91]
s_add_u32 s57, s57, 2048
s_and_b32 s57, s57, 0x7fff
v_mfma_f32_16x16x32_bf16 v[72:75], v[232:235], v[180:183], v[72:75]
s_waitcnt vmcnt(6) lgkmcnt(8)
v_mfma_f32_16x16x32_bf16 v[60:63], v[236:239], v[188:191], v[60:63]
buffer_load_dwordx4 v[156:159], v38, s[32:35], s57 offen sc1
v_mfma_f32_16x16x32_bf16 v[76:79], v[236:239], v[192:195], v[76:79]
ds_read_b64_tr_b16 v[220:221], v10 offset:24576
ds_read_b64_tr_b16 v[222:223], v10 offset:25088
v_mfma_f32_16x16x32_bf16 v[80:83], v[240:243], v[192:195], v[80:83]
ds_read_b64_tr_b16 v[224:225], v11 offset:24576
ds_read_b64_tr_b16 v[226:227], v11 offset:25088
v_mfma_f32_16x16x32_bf16 v[64:67], v[240:243], v[188:191], v[64:67]
buffer_load_dwordx4 v[160:163], v39, s[32:35], s57 offen sc1
v_mfma_f32_16x16x32_bf16 v[68:71], v[244:247], v[188:191], v[68:71]
ds_read_b64_tr_b16 v[228:229], v12 offset:24576
ds_read_b64_tr_b16 v[230:231], v12 offset:25088
v_mfma_f32_16x16x32_bf16 v[84:87], v[244:247], v[192:195], v[84:87]
ds_read_b64_tr_b16 v[232:233], v13 offset:24576
ds_read_b64_tr_b16 v[234:235], v13 offset:25088
v_mfma_f32_16x16x32_bf16 v[88:91], v[248:251], v[192:195], v[88:91]
v_mfma_f32_16x16x32_bf16 v[72:75], v[248:251], v[188:191], v[72:75]
s_waitcnt vmcnt(6) lgkmcnt(8)
v_mfma_f32_16x16x32_bf16 v[60:63], v[100:103], v[196:199], v[60:63]
buffer_load_dwordx4 v[164:167], v38, s[32:35], s57 offen offset:1024 sc1
v_mfma_f32_16x16x32_bf16 v[76:79], v[100:103], v[200:203], v[76:79]
ds_read_b64_tr_b16 v[236:237], v10 offset:28672
ds_read_b64_tr_b16 v[238:239], v10 offset:29184
v_mfma_f32_16x16x32_bf16 v[80:83], v[104:107], v[200:203], v[80:83]
ds_read_b64_tr_b16 v[240:241], v11 offset:28672
ds_read_b64_tr_b16 v[242:243], v11 offset:29184
v_mfma_f32_16x16x32_bf16 v[64:67], v[104:107], v[196:199], v[64:67]
buffer_load_dwordx4 v[168:171], v39, s[32:35], s57 offen offset:1024 sc1
v_mfma_f32_16x16x32_bf16 v[68:71], v[108:111], v[196:199], v[68:71]
ds_read_b64_tr_b16 v[244:245], v12 offset:28672
ds_read_b64_tr_b16 v[246:247], v12 offset:29184
v_mfma_f32_16x16x32_bf16 v[84:87], v[108:111], v[200:203], v[84:87]
ds_read_b64_tr_b16 v[248:249], v13 offset:28672
ds_read_b64_tr_b16 v[250:251], v13 offset:29184
v_mfma_f32_16x16x32_bf16 v[88:91], v[112:115], v[200:203], v[88:91]
s_add_u32 s57, s57, 2048
s_and_b32 s57, s57, 0x7fff
v_mfma_f32_16x16x32_bf16 v[72:75], v[112:115], v[196:199], v[72:75]
s_waitcnt vmcnt(6) lgkmcnt(8)
v_mfma_f32_16x16x32_bf16 v[60:63], v[220:223], v[204:207], v[60:63]
buffer_load_dwordx4 v[172:175], v38, s[32:35], s57 offen sc1
v_mfma_f32_16x16x32_bf16 v[76:79], v[220:223], v[208:211], v[76:79]
ds_read_b64_tr_b16 v[100:101], v10 offset:32768
ds_read_b64_tr_b16 v[102:103], v10 offset:33280
v_mfma_f32_16x16x32_bf16 v[80:83], v[224:227], v[208:211], v[80:83]
ds_read_b64_tr_b16 v[104:105], v11 offset:32768
ds_read_b64_tr_b16 v[106:107], v11 offset:33280
v_mfma_f32_16x16x32_bf16 v[64:67], v[224:227], v[204:207], v[64:67]
buffer_load_dwordx4 v[176:179], v39, s[32:35], s57 offen sc1
v_mfma_f32_16x16x32_bf16 v[68:71], v[228:231], v[204:207], v[68:71]
ds_read_b64_tr_b16 v[108:109], v12 offset:32768
ds_read_b64_tr_b16 v[110:111], v12 offset:33280
v_mfma_f32_16x16x32_bf16 v[84:87], v[228:231], v[208:211], v[84:87]
ds_read_b64_tr_b16 v[112:113], v13 offset:32768
ds_read_b64_tr_b16 v[114:115], v13 offset:33280
v_mfma_f32_16x16x32_bf16 v[88:91], v[232:235], v[208:211], v[88:91]
v_mfma_f32_16x16x32_bf16 v[72:75], v[232:235], v[204:207], v[72:75]
s_waitcnt vmcnt(6) lgkmcnt(8)
v_mfma_f32_16x16x32_bf16 v[60:63], v[236:239], v[212:215], v[60:63]
buffer_load_dwordx4 v[180:183], v38, s[32:35], s57 offen offset:1024 sc1
v_mfma_f32_16x16x32_bf16 v[76:79], v[236:239], v[216:219], v[76:79]
ds_read_b64_tr_b16 v[220:221], v10 offset:36864
ds_read_b64_tr_b16 v[222:223], v10 offset:37376
v_mfma_f32_16x16x32_bf16 v[80:83], v[240:243], v[216:219], v[80:83]
ds_read_b64_tr_b16 v[224:225], v11 offset:36864
ds_read_b64_tr_b16 v[226:227], v11 offset:37376
v_mfma_f32_16x16x32_bf16 v[64:67], v[240:243], v[212:215], v[64:67]
buffer_load_dwordx4 v[184:187], v39, s[32:35], s57 offen offset:1024 sc1
v_mfma_f32_16x16x32_bf16 v[68:71], v[244:247], v[212:215], v[68:71]
ds_read_b64_tr_b16 v[228:229], v12 offset:36864
ds_read_b64_tr_b16 v[230:231], v12 offset:37376
v_mfma_f32_16x16x32_bf16 v[84:87], v[244:247], v[216:219], v[84:87]
ds_read_b64_tr_b16 v[232:233], v13 offset:36864
ds_read_b64_tr_b16 v[234:235], v13 offset:37376
v_mfma_f32_16x16x32_bf16 v[88:91], v[248:251], v[216:219], v[88:91]
s_add_u32 s57, s57, 2048
s_and_b32 s57, s57, 0x7fff
v_mfma_f32_16x16x32_bf16 v[72:75], v[248:251], v[212:215], v[72:75]
s_waitcnt vmcnt(6) lgkmcnt(8)
v_mfma_f32_16x16x32_bf16 v[60:63], v[100:103], v[156:159], v[60:63]
buffer_load_dwordx4 v[188:191], v38, s[32:35], s57 offen sc1
v_mfma_f32_16x16x32_bf16 v[76:79], v[100:103], v[160:163], v[76:79]
ds_read_b64_tr_b16 v[236:237], v10 offset:40960
ds_read_b64_tr_b16 v[238:239], v10 offset:41472
v_mfma_f32_16x16x32_bf16 v[80:83], v[104:107], v[160:163], v[80:83]
ds_read_b64_tr_b16 v[240:241], v11 offset:40960
ds_read_b64_tr_b16 v[242:243], v11 offset:41472
v_mfma_f32_16x16x32_bf16 v[64:67], v[104:107], v[156:159], v[64:67]
buffer_load_dwordx4 v[192:195], v39, s[32:35], s57 offen sc1
v_mfma_f32_16x16x32_bf16 v[68:71], v[108:111], v[156:159], v[68:71]
ds_read_b64_tr_b16 v[244:245], v12 offset:40960
ds_read_b64_tr_b16 v[246:247], v12 offset:41472
v_mfma_f32_16x16x32_bf16 v[84:87], v[108:111], v[160:163], v[84:87]
ds_read_b64_tr_b16 v[248:249], v13 offset:40960
ds_read_b64_tr_b16 v[250:251], v13 offset:41472
v_mfma_f32_16x16x32_bf16 v[88:91], v[112:115], v[160:163], v[88:91]
v_mfma_f32_16x16x32_bf16 v[72:75], v[112:115], v[156:159], v[72:75]
s_waitcnt vmcnt(6) lgkmcnt(8)
v_mfma_f32_16x16x32_bf16 v[60:63], v[220:223], v[164:167], v[60:63]
buffer_load_dwordx4 v[196:199], v38, s[32:35], s57 offen offset:1024 sc1
v_mfma_f32_16x16x32_bf16 v[76:79], v[220:223], v[168:171], v[76:79]
ds_read_b64_tr_b16 v[100:101], v10 offset:45056
ds_read_b64_tr_b16 v[102:103], v10 offset:45568
v_mfma_f32_16x16x32_bf16 v[80:83], v[224:227], v[168:171], v[80:83]
ds_read_b64_tr_b16 v[104:105], v11 offset:45056
ds_read_b64_tr_b16 v[106:107], v11 offset:45568
v_mfma_f32_16x16x32_bf16 v[64:67], v[224:227], v[164:167], v[64:67]
buffer_load_dwordx4 v[200:203], v39, s[32:35], s57 offen offset:1024 sc1
v_mfma_f32_16x16x32_bf16 v[68:71], v[228:231], v[164:167], v[68:71]
ds_read_b64_tr_b16 v[108:109], v12 offset:45056
ds_read_b64_tr_b16 v[110:111], v12 offset:45568
v_mfma_f32_16x16x32_bf16 v[84:87], v[228:231], v[168:171], v[84:87]
ds_read_b64_tr_b16 v[112:113], v13 offset:45056
ds_read_b64_tr_b16 v[114:115], v13 offset:45568
v_mfma_f32_16x16x32_bf16 v[88:91], v[232:235], v[168:171], v[88:91]
s_add_u32 s57, s57, 2048
s_and_b32 s57, s57, 0x7fff
v_mfma_f32_16x16x32_bf16 v[72:75], v[232:235], v[164:167], v[72:75]
s_waitcnt vmcnt(6) lgkmcnt(8)
v_mfma_f32_16x16x32_bf16 v[60:63], v[236:239], v[172:175], v[60:63]
buffer_load_dwordx4 v[204:207], v38, s[32:35], s57 offen sc1
v_mfma_f32_16x16x32_bf16 v[76:79], v[236:239], v[176:179], v[76:79]
ds_read_b64_tr_b16 v[220:221], v10 offset:49152
ds_read_b64_tr_b16 v[222:223], v10 offset:49664
v_mfma_f32_16x16x32_bf16 v[80:83], v[240:243], v[176:179], v[80:83]
ds_read_b64_tr_b16 v[224:225], v11 offset:49152
ds_read_b64_tr_b16 v[226:227], v11 offset:49664
v_mfma_f32_16x16x32_bf16 v[64:67], v[240:243], v[172:175], v[64:67]
buffer_load_dwordx4 v[208:211], v39, s[32:35], s57 offen sc1
v_mfma_f32_16x16x32_bf16 v[68:71], v[244:247], v[172:175], v[68:71]
ds_read_b64_tr_b16 v[228:229], v12 offset:49152
ds_read_b64_tr_b16 v[230:231], v12 offset:49664
v_mfma_f32_16x16x32_bf16 v[84:87], v[244:247], v[176:179], v[84:87]
ds_read_b64_tr_b16 v[232:233], v13 offset:49152
ds_read_b64_tr_b16 v[234:235], v13 offset:49664
v_mfma_f32_16x16x32_bf16 v[88:91], v[248:251], v[176:179], v[88:91]
v_mfma_f32_16x16x32_bf16 v[72:75], v[248:251], v[172:175], v[72:75]
s_waitcnt vmcnt(6) lgkmcnt(8)
v_mfma_f32_16x16x32_bf16 v[60:63], v[100:103], v[180:183], v[60:63]
buffer_load_dwordx4 v[212:215], v38, s[32:35], s57 offen offset:1024 sc1
v_mfma_f32_16x16x32_bf16 v[76:79], v[100:103], v[184:187], v[76:79]
ds_read_b64_tr_b16 v[236:237], v10 offset:53248
ds_read_b64_tr_b16 v[238:239], v10 offset:53760
v_mfma_f32_16x16x32_bf16 v[80:83], v[104:107], v[184:187], v[80:83]
ds_read_b64_tr_b16 v[240:241], v11 offset:53248
ds_read_b64_tr_b16 v[242:243], v11 offset:53760
v_mfma_f32_16x16x32_bf16 v[64:67], v[104:107], v[180:183], v[64:67]
buffer_load_dwordx4 v[216:219], v39, s[32:35], s57 offen offset:1024 sc1
v_mfma_f32_16x16x32_bf16 v[68:71], v[108:111], v[180:183], v[68:71]
ds_read_b64_tr_b16 v[244:245], v12 offset:53248
ds_read_b64_tr_b16 v[246:247], v12 offset:53760
v_mfma_f32_16x16x32_bf16 v[84:87], v[108:111], v[184:187], v[84:87]
ds_read_b64_tr_b16 v[248:249], v13 offset:53248
ds_read_b64_tr_b16 v[250:251], v13 offset:53760
v_mfma_f32_16x16x32_bf16 v[88:91], v[112:115], v[184:187], v[88:91]
s_add_u32 s57, s57, 2048
s_and_b32 s57, s57, 0x7fff
v_mfma_f32_16x16x32_bf16 v[72:75], v[112:115], v[180:183], v[72:75]
s_waitcnt vmcnt(6) lgkmcnt(8)
v_mfma_f32_16x16x32_bf16 v[60:63], v[220:223], v[188:191], v[60:63]
buffer_load_dwordx4 v[156:159], v38, s[32:35], s57 offen sc1
v_mfma_f32_16x16x32_bf16 v[76:79], v[220:223], v[192:195], v[76:79]
ds_read_b64_tr_b16 v[100:101], v10 offset:57344
ds_read_b64_tr_b16 v[102:103], v10 offset:57856
v_mfma_f32_16x16x32_bf16 v[80:83], v[224:227], v[192:195], v[80:83]
ds_read_b64_tr_b16 v[104:105], v11 offset:57344
ds_read_b64_tr_b16 v[106:107], v11 offset:57856
v_mfma_f32_16x16x32_bf16 v[64:67], v[224:227], v[188:191], v[64:67]
buffer_load_dwordx4 v[160:163], v39, s[32:35], s57 offen sc1
v_mfma_f32_16x16x32_bf16 v[68:71], v[228:231], v[188:191], v[68:71]
ds_read_b64_tr_b16 v[108:109], v12 offset:57344
ds_read_b64_tr_b16 v[110:111], v12 offset:57856
v_mfma_f32_16x16x32_bf16 v[84:87], v[228:231], v[192:195], v[84:87]
ds_read_b64_tr_b16 v[112:113], v13 offset:57344
ds_read_b64_tr_b16 v[114:115], v13 offset:57856
v_mfma_f32_16x16x32_bf16 v[88:91], v[232:235], v[192:195], v[88:91]
v_mfma_f32_16x16x32_bf16 v[72:75], v[232:235], v[188:191], v[72:75]
s_waitcnt vmcnt(6) lgkmcnt(8)
v_mfma_f32_16x16x32_bf16 v[60:63], v[236:239], v[196:199], v[60:63]
buffer_load_dwordx4 v[164:167], v38, s[32:35], s57 offen offset:1024 sc1
v_mfma_f32_16x16x32_bf16 v[76:79], v[236:239], v[200:203], v[76:79]
ds_read_b64_tr_b16 v[220:221], v10 offset:61440
ds_read_b64_tr_b16 v[222:223], v10 offset:61952
v_mfma_f32_16x16x32_bf16 v[80:83], v[240:243], v[200:203], v[80:83]
ds_read_b64_tr_b16 v[224:225], v11 offset:61440
ds_read_b64_tr_b16 v[226:227], v11 offset:61952
v_mfma_f32_16x16x32_bf16 v[64:67], v[240:243], v[196:199], v[64:67]
buffer_load_dwordx4 v[168:171], v39, s[32:35], s57 offen offset:1024 sc1
v_mfma_f32_16x16x32_bf16 v[68:71], v[244:247], v[196:199], v[68:71]
ds_read_b64_tr_b16 v[228:229], v12 offset:61440
ds_read_b64_tr_b16 v[230:231], v12 offset:61952
v_mfma_f32_16x16x32_bf16 v[84:87], v[244:247], v[200:203], v[84:87]
ds_read_b64_tr_b16 v[232:233], v13 offset:61440
ds_read_b64_tr_b16 v[234:235], v13 offset:61952
v_mfma_f32_16x16x32_bf16 v[88:91], v[248:251], v[200:203], v[88:91]
s_add_u32 s57, s57, 2048
s_and_b32 s57, s57, 0x7fff
v_mfma_f32_16x16x32_bf16 v[72:75], v[248:251], v[196:199], v[72:75]
s_waitcnt vmcnt(6) lgkmcnt(8)
v_mfma_f32_16x16x32_bf16 v[60:63], v[100:103], v[204:207], v[60:63]
buffer_load_dwordx4 v[172:175], v38, s[32:35], s57 offen sc1
v_mfma_f32_16x16x32_bf16 v[76:79], v[100:103], v[208:211], v[76:79]
ds_read_b64_tr_b16 v[236:237], v14 offset:0
ds_read_b64_tr_b16 v[238:239], v14 offset:512
v_mfma_f32_16x16x32_bf16 v[80:83], v[104:107], v[208:211], v[80:83]
ds_read_b64_tr_b16 v[240:241], v15 offset:0
ds_read_b64_tr_b16 v[242:243], v15 offset:512
v_mfma_f32_16x16x32_bf16 v[64:67], v[104:107], v[204:207], v[64:67]
buffer_load_dwordx4 v[176:179], v39, s[32:35], s57 offen sc1
v_mfma_f32_16x16x32_bf16 v[68:71], v[108:111], v[204:207], v[68:71]
ds_read_b64_tr_b16 v[244:245], v16 offset:0
ds_read_b64_tr_b16 v[246:247], v16 offset:512
v_mfma_f32_16x16x32_bf16 v[84:87], v[108:111], v[208:211], v[84:87]
ds_read_b64_tr_b16 v[248:249], v17 offset:0
ds_read_b64_tr_b16 v[250:251], v17 offset:512
v_mfma_f32_16x16x32_bf16 v[88:91], v[112:115], v[208:211], v[88:91]
v_mfma_f32_16x16x32_bf16 v[72:75], v[112:115], v[204:207], v[72:75]
s_waitcnt vmcnt(6) lgkmcnt(8)
v_mfma_f32_16x16x32_bf16 v[60:63], v[220:223], v[212:215], v[60:63]
buffer_load_dwordx4 v[180:183], v38, s[32:35], s57 offen offset:1024 sc1
v_mfma_f32_16x16x32_bf16 v[76:79], v[220:223], v[216:219], v[76:79]
ds_read_b64_tr_b16 v[100:101], v14 offset:4096
ds_read_b64_tr_b16 v[102:103], v14 offset:4608
v_mfma_f32_16x16x32_bf16 v[80:83], v[224:227], v[216:219], v[80:83]
ds_read_b64_tr_b16 v[104:105], v15 offset:4096
ds_read_b64_tr_b16 v[106:107], v15 offset:4608
v_mfma_f32_16x16x32_bf16 v[64:67], v[224:227], v[212:215], v[64:67]
buffer_load_dwordx4 v[184:187], v39, s[32:35], s57 offen offset:1024 sc1
v_mfma_f32_16x16x32_bf16 v[68:71], v[228:231], v[212:215], v[68:71]
ds_read_b64_tr_b16 v[108:109], v16 offset:4096
ds_read_b64_tr_b16 v[110:111], v16 offset:4608
v_mfma_f32_16x16x32_bf16 v[84:87], v[228:231], v[216:219], v[84:87]
ds_read_b64_tr_b16 v[112:113], v17 offset:4096
ds_read_b64_tr_b16 v[114:115], v17 offset:4608
v_mfma_f32_16x16x32_bf16 v[88:91], v[232:235], v[216:219], v[88:91]
s_add_u32 s57, s57, 2048
s_and_b32 s57, s57, 0x7fff
v_mfma_f32_16x16x32_bf16 v[72:75], v[232:235], v[212:215], v[72:75]
s_waitcnt vmcnt(6) lgkmcnt(8)
v_mfma_f32_16x16x32_bf16 v[60:63], v[236:239], v[156:159], v[60:63]
buffer_load_dwordx4 v[188:191], v38, s[32:35], s57 offen sc1
v_mfma_f32_16x16x32_bf16 v[76:79], v[236:239], v[160:163], v[76:79]
ds_read_b64_tr_b16 v[220:221], v14 offset:8192
ds_read_b64_tr_b16 v[222:223], v14 offset:8704
v_mfma_f32_16x16x32_bf16 v[80:83], v[240:243], v[160:163], v[80:83]
ds_read_b64_tr_b16 v[224:225], v15 offset:8192
ds_read_b64_tr_b16 v[226:227], v15 offset:8704
v_mfma_f32_16x16x32_bf16 v[64:67], v[240:243], v[156:159], v[64:67]
buffer_load_dwordx4 v[192:195], v39, s[32:35], s57 offen sc1
v_mfma_f32_16x16x32_bf16 v[68:71], v[244:247], v[156:159], v[68:71]
ds_read_b64_tr_b16 v[228:229], v16 offset:8192
ds_read_b64_tr_b16 v[230:231], v16 offset:8704
v_mfma_f32_16x16x32_bf16 v[84:87], v[244:247], v[160:163], v[84:87]
ds_read_b64_tr_b16 v[232:233], v17 offset:8192
ds_read_b64_tr_b16 v[234:235], v17 offset:8704
v_mfma_f32_16x16x32_bf16 v[88:91], v[248:251], v[160:163], v[88:91]
v_mfma_f32_16x16x32_bf16 v[72:75], v[248:251], v[156:159], v[72:75]
s_waitcnt vmcnt(6) lgkmcnt(8)
v_mfma_f32_16x16x32_bf16 v[60:63], v[100:103], v[164:167], v[60:63]
buffer_load_dwordx4 v[196:199], v38, s[32:35], s57 offen offset:1024 sc1
v_mfma_f32_16x16x32_bf16 v[76:79], v[100:103], v[168:171], v[76:79]
ds_read_b64_tr_b16 v[236:237], v14 offset:12288
ds_read_b64_tr_b16 v[238:239], v14 offset:12800
v_mfma_f32_16x16x32_bf16 v[80:83], v[104:107], v[168:171], v[80:83]
ds_read_b64_tr_b16 v[240:241], v15 offset:12288
ds_read_b64_tr_b16 v[242:243], v15 offset:12800
v_mfma_f32_16x16x32_bf16 v[64:67], v[104:107], v[164:167], v[64:67]
buffer_load_dwordx4 v[200:203], v39, s[32:35], s57 offen offset:1024 sc1
v_mfma_f32_16x16x32_bf16 v[68:71], v[108:111], v[164:167], v[68:71]
ds_read_b64_tr_b16 v[244:245], v16 offset:12288
ds_read_b64_tr_b16 v[246:247], v16 offset:12800
v_mfma_f32_16x16x32_bf16 v[84:87], v[108:111], v[168:171], v[84:87]
ds_read_b64_tr_b16 v[248:249], v17 offset:12288
ds_read_b64_tr_b16 v[250:251], v17 offset:12800
v_mfma_f32_16x16x32_bf16 v[88:91], v[112:115], v[168:171], v[88:91]
s_add_u32 s57, s57, 2048
s_and_b32 s57, s57, 0x7fff
v_mfma_f32_16x16x32_bf16 v[72:75], v[112:115], v[164:167], v[72:75]
s_waitcnt vmcnt(6) lgkmcnt(8)
v_mfma_f32_16x16x32_bf16 v[60:63], v[220:223], v[172:175], v[60:63]
buffer_load_dwordx4 v[204:207], v38, s[32:35], s57 offen sc1
v_mfma_f32_16x16x32_bf16 v[76:79], v[220:223], v[176:179], v[76:79]
ds_read_b64_tr_b16 v[100:101], v14 offset:16384
ds_read_b64_tr_b16 v[102:103], v14 offset:16896
v_mfma_f32_16x16x32_bf16 v[80:83], v[224:227], v[176:179], v[80:83]
ds_read_b64_tr_b16 v[104:105], v15 offset:16384
ds_read_b64_tr_b16 v[106:107], v15 offset:16896
v_mfma_f32_16x16x32_bf16 v[64:67], v[224:227], v[172:175], v[64:67]
buffer_load_dwordx4 v[208:211], v39, s[32:35], s57 offen sc1
v_mfma_f32_16x16x32_bf16 v[68:71], v[228:231], v[172:175], v[68:71]
ds_read_b64_tr_b16 v[108:109], v16 offset:16384
ds_read_b64_tr_b16 v[110:111], v16 offset:16896
v_mfma_f32_16x16x32_bf16 v[84:87], v[228:231], v[176:179], v[84:87]
ds_read_b64_tr_b16 v[112:113], v17 offset:16384
ds_read_b64_tr_b16 v[114:115], v17 offset:16896
v_mfma_f32_16x16x32_bf16 v[88:91], v[232:235], v[176:179], v[88:91]
v_mfma_f32_16x16x32_bf16 v[72:75], v[232:235], v[172:175], v[72:75]
s_waitcnt vmcnt(6) lgkmcnt(8)
v_mfma_f32_16x16x32_bf16 v[60:63], v[236:239], v[180:183], v[60:63]
buffer_load_dwordx4 v[212:215], v38, s[32:35], s57 offen offset:1024 sc1
v_mfma_f32_16x16x32_bf16 v[76:79], v[236:239], v[184:187], v[76:79]
ds_read_b64_tr_b16 v[220:221], v14 offset:20480
ds_read_b64_tr_b16 v[222:223], v14 offset:20992
v_mfma_f32_16x16x32_bf16 v[80:83], v[240:243], v[184:187], v[80:83]
ds_read_b64_tr_b16 v[224:225], v15 offset:20480
ds_read_b64_tr_b16 v[226:227], v15 offset:20992
v_mfma_f32_16x16x32_bf16 v[64:67], v[240:243], v[180:183], v[64:67]
buffer_load_dwordx4 v[216:219], v39, s[32:35], s57 offen offset:1024 sc1
v_mfma_f32_16x16x32_bf16 v[68:71], v[244:247], v[180:183], v[68:71]
ds_read_b64_tr_b16 v[228:229], v16 offset:20480
ds_read_b64_tr_b16 v[230:231], v16 offset:20992
v_mfma_f32_16x16x32_bf16 v[84:87], v[244:247], v[184:187], v[84:87]
ds_read_b64_tr_b16 v[232:233], v17 offset:20480
ds_read_b64_tr_b16 v[234:235], v17 offset:20992
v_mfma_f32_16x16x32_bf16 v[88:91], v[248:251], v[184:187], v[88:91]
s_add_u32 s57, s57, 2048
s_and_b32 s57, s57, 0x7fff
v_mfma_f32_16x16x32_bf16 v[72:75], v[248:251], v[180:183], v[72:75]
s_waitcnt vmcnt(6) lgkmcnt(8)
v_mfma_f32_16x16x32_bf16 v[60:63], v[100:103], v[188:191], v[60:63]
buffer_load_dwordx4 v[156:159], v38, s[32:35], s57 offen sc1
v_mfma_f32_16x16x32_bf16 v[76:79], v[100:103], v[192:195], v[76:79]
ds_read_b64_tr_b16 v[236:237], v14 offset:24576
ds_read_b64_tr_b16 v[238:239], v14 offset:25088
v_mfma_f32_16x16x32_bf16 v[80:83], v[104:107], v[192:195], v[80:83]
ds_read_b64_tr_b16 v[240:241], v15 offset:24576
ds_read_b64_tr_b16 v[242:243], v15 offset:25088
v_mfma_f32_16x16x32_bf16 v[64:67], v[104:107], v[188:191], v[64:67]
buffer_load_dwordx4 v[160:163], v39, s[32:35], s57 offen sc1
v_mfma_f32_16x16x32_bf16 v[68:71], v[108:111], v[188:191], v[68:71]
ds_read_b64_tr_b16 v[244:245], v16 offset:24576
ds_read_b64_tr_b16 v[246:247], v16 offset:25088
v_mfma_f32_16x16x32_bf16 v[84:87], v[108:111], v[192:195], v[84:87]
ds_read_b64_tr_b16 v[248:249], v17 offset:24576
ds_read_b64_tr_b16 v[250:251], v17 offset:25088
v_mfma_f32_16x16x32_bf16 v[88:91], v[112:115], v[192:195], v[88:91]
v_mfma_f32_16x16x32_bf16 v[72:75], v[112:115], v[188:191], v[72:75]
s_waitcnt vmcnt(6) lgkmcnt(8)
v_mfma_f32_16x16x32_bf16 v[60:63], v[220:223], v[196:199], v[60:63]
buffer_load_dwordx4 v[164:167], v38, s[32:35], s57 offen offset:1024 sc1
v_mfma_f32_16x16x32_bf16 v[76:79], v[220:223], v[200:203], v[76:79]
ds_read_b64_tr_b16 v[100:101], v14 offset:28672
ds_read_b64_tr_b16 v[102:103], v14 offset:29184
v_mfma_f32_16x16x32_bf16 v[80:83], v[224:227], v[200:203], v[80:83]
ds_read_b64_tr_b16 v[104:105], v15 offset:28672
ds_read_b64_tr_b16 v[106:107], v15 offset:29184
v_mfma_f32_16x16x32_bf16 v[64:67], v[224:227], v[196:199], v[64:67]
buffer_load_dwordx4 v[168:171], v39, s[32:35], s57 offen offset:1024 sc1
v_mfma_f32_16x16x32_bf16 v[68:71], v[228:231], v[196:199], v[68:71]
ds_read_b64_tr_b16 v[108:109], v16 offset:28672
ds_read_b64_tr_b16 v[110:111], v16 offset:29184
v_mfma_f32_16x16x32_bf16 v[84:87], v[228:231], v[200:203], v[84:87]
ds_read_b64_tr_b16 v[112:113], v17 offset:28672
ds_read_b64_tr_b16 v[114:115], v17 offset:29184
v_mfma_f32_16x16x32_bf16 v[88:91], v[232:235], v[200:203], v[88:91]
s_add_u32 s57, s57, 2048
s_and_b32 s57, s57, 0x7fff
v_mfma_f32_16x16x32_bf16 v[72:75], v[232:235], v[196:199], v[72:75]
s_waitcnt vmcnt(6) lgkmcnt(8)
v_mfma_f32_16x16x32_bf16 v[60:63], v[236:239], v[204:207], v[60:63]
buffer_load_dwordx4 v[172:175], v38, s[32:35], s57 offen sc1
v_mfma_f32_16x16x32_bf16 v[76:79], v[236:239], v[208:211], v[76:79]
ds_read_b64_tr_b16 v[220:221], v14 offset:32768
ds_read_b64_tr_b16 v[222:223], v14 offset:33280
v_mfma_f32_16x16x32_bf16 v[80:83], v[240:243], v[208:211], v[80:83]
ds_read_b64_tr_b16 v[224:225], v15 offset:32768
ds_read_b64_tr_b16 v[226:227], v15 offset:33280
v_mfma_f32_16x16x32_bf16 v[64:67], v[240:243], v[204:207], v[64:67]
buffer_load_dwordx4 v[176:179], v39, s[32:35], s57 offen sc1
v_mfma_f32_16x16x32_bf16 v[68:71], v[244:247], v[204:207], v[68:71]
ds_read_b64_tr_b16 v[228:229], v16 offset:32768
ds_read_b64_tr_b16 v[230:231], v16 offset:33280
v_mfma_f32_16x16x32_bf16 v[84:87], v[244:247], v[208:211], v[84:87]
ds_read_b64_tr_b16 v[232:233], v17 offset:32768
ds_read_b64_tr_b16 v[234:235], v17 offset:33280
v_mfma_f32_16x16x32_bf16 v[88:91], v[248:251], v[208:211], v[88:91]
v_mfma_f32_16x16x32_bf16 v[72:75], v[248:251], v[204:207], v[72:75]
s_waitcnt vmcnt(6) lgkmcnt(8)
v_mfma_f32_16x16x32_bf16 v[60:63], v[100:103], v[212:215], v[60:63]
buffer_load_dwordx4 v[180:183], v38, s[32:35], s57 offen offset:1024 sc1
v_mfma_f32_16x16x32_bf16 v[76:79], v[100:103], v[216:219], v[76:79]
ds_read_b64_tr_b16 v[236:237], v14 offset:36864
ds_read_b64_tr_b16 v[238:239], v14 offset:37376
v_mfma_f32_16x16x32_bf16 v[80:83], v[104:107], v[216:219], v[80:83]
ds_read_b64_tr_b16 v[240:241], v15 offset:36864
ds_read_b64_tr_b16 v[242:243], v15 offset:37376
v_mfma_f32_16x16x32_bf16 v[64:67], v[104:107], v[212:215], v[64:67]
buffer_load_dwordx4 v[184:187], v39, s[32:35], s57 offen offset:1024 sc1
v_mfma_f32_16x16x32_bf16 v[68:71], v[108:111], v[212:215], v[68:71]
ds_read_b64_tr_b16 v[244:245], v16 offset:36864
ds_read_b64_tr_b16 v[246:247], v16 offset:37376
v_mfma_f32_16x16x32_bf16 v[84:87], v[108:111], v[216:219], v[84:87]
ds_read_b64_tr_b16 v[248:249], v17 offset:36864
ds_read_b64_tr_b16 v[250:251], v17 offset:37376
v_mfma_f32_16x16x32_bf16 v[88:91], v[112:115], v[216:219], v[88:91]
s_add_u32 s57, s57, 2048
s_and_b32 s57, s57, 0x7fff
v_mfma_f32_16x16x32_bf16 v[72:75], v[112:115], v[212:215], v[72:75]
s_waitcnt vmcnt(6) lgkmcnt(8)
v_mfma_f32_16x16x32_bf16 v[60:63], v[220:223], v[156:159], v[60:63]
buffer_load_dwordx4 v[188:191], v38, s[32:35], s57 offen sc1
v_mfma_f32_16x16x32_bf16 v[76:79], v[220:223], v[160:163], v[76:79]
ds_read_b64_tr_b16 v[100:101], v14 offset:40960
ds_read_b64_tr_b16 v[102:103], v14 offset:41472
v_mfma_f32_16x16x32_bf16 v[80:83], v[224:227], v[160:163], v[80:83]
ds_read_b64_tr_b16 v[104:105], v15 offset:40960
ds_read_b64_tr_b16 v[106:107], v15 offset:41472
v_mfma_f32_16x16x32_bf16 v[64:67], v[224:227], v[156:159], v[64:67]
buffer_load_dwordx4 v[192:195], v39, s[32:35], s57 offen sc1
v_mfma_f32_16x16x32_bf16 v[68:71], v[228:231], v[156:159], v[68:71]
ds_read_b64_tr_b16 v[108:109], v16 offset:40960
ds_read_b64_tr_b16 v[110:111], v16 offset:41472
v_mfma_f32_16x16x32_bf16 v[84:87], v[228:231], v[160:163], v[84:87]
ds_read_b64_tr_b16 v[112:113], v17 offset:40960
ds_read_b64_tr_b16 v[114:115], v17 offset:41472
v_mfma_f32_16x16x32_bf16 v[88:91], v[232:235], v[160:163], v[88:91]
v_mfma_f32_16x16x32_bf16 v[72:75], v[232:235], v[156:159], v[72:75]
s_waitcnt vmcnt(6) lgkmcnt(8)
v_mfma_f32_16x16x32_bf16 v[60:63], v[236:239], v[164:167], v[60:63]
buffer_load_dwordx4 v[196:199], v38, s[32:35], s57 offen offset:1024 sc1
v_mfma_f32_16x16x32_bf16 v[76:79], v[236:239], v[168:171], v[76:79]
ds_read_b64_tr_b16 v[220:221], v14 offset:45056
ds_read_b64_tr_b16 v[222:223], v14 offset:45568
v_mfma_f32_16x16x32_bf16 v[80:83], v[240:243], v[168:171], v[80:83]
ds_read_b64_tr_b16 v[224:225], v15 offset:45056
ds_read_b64_tr_b16 v[226:227], v15 offset:45568
v_mfma_f32_16x16x32_bf16 v[64:67], v[240:243], v[164:167], v[64:67]
buffer_load_dwordx4 v[200:203], v39, s[32:35], s57 offen offset:1024 sc1
v_mfma_f32_16x16x32_bf16 v[68:71], v[244:247], v[164:167], v[68:71]
ds_read_b64_tr_b16 v[228:229], v16 offset:45056
ds_read_b64_tr_b16 v[230:231], v16 offset:45568
v_mfma_f32_16x16x32_bf16 v[84:87], v[244:247], v[168:171], v[84:87]
ds_read_b64_tr_b16 v[232:233], v17 offset:45056
ds_read_b64_tr_b16 v[234:235], v17 offset:45568
v_mfma_f32_16x16x32_bf16 v[88:91], v[248:251], v[168:171], v[88:91]
s_add_u32 s57, s57, 2048
s_and_b32 s57, s57, 0x7fff
v_mfma_f32_16x16x32_bf16 v[72:75], v[248:251], v[164:167], v[72:75]
s_waitcnt vmcnt(6) lgkmcnt(8)
v_mfma_f32_16x16x32_bf16 v[60:63], v[100:103], v[172:175], v[60:63]
buffer_load_dwordx4 v[204:207], v38, s[32:35], s57 offen sc1
v_mfma_f32_16x16x32_bf16 v[76:79], v[100:103], v[176:179], v[76:79]
ds_read_b64_tr_b16 v[236:237], v14 offset:49152
ds_read_b64_tr_b16 v[238:239], v14 offset:49664
v_mfma_f32_16x16x32_bf16 v[80:83], v[104:107], v[176:179], v[80:83]
ds_read_b64_tr_b16 v[240:241], v15 offset:49152
ds_read_b64_tr_b16 v[242:243], v15 offset:49664
v_mfma_f32_16x16x32_bf16 v[64:67], v[104:107], v[172:175], v[64:67]
buffer_load_dwordx4 v[208:211], v39, s[32:35], s57 offen sc1
v_mfma_f32_16x16x32_bf16 v[68:71], v[108:111], v[172:175], v[68:71]
ds_read_b64_tr_b16 v[244:245], v16 offset:49152
ds_read_b64_tr_b16 v[246:247], v16 offset:49664
v_mfma_f32_16x16x32_bf16 v[84:87], v[108:111], v[176:179], v[84:87]
ds_read_b64_tr_b16 v[248:249], v17 offset:49152
ds_read_b64_tr_b16 v[250:251], v17 offset:49664
v_mfma_f32_16x16x32_bf16 v[88:91], v[112:115], v[176:179], v[88:91]
v_mfma_f32_16x16x32_bf16 v[72:75], v[112:115], v[172:175], v[72:75]
s_waitcnt vmcnt(6) lgkmcnt(8)
v_mfma_f32_16x16x32_bf16 v[60:63], v[220:223], v[180:183], v[60:63]
buffer_load_dwordx4 v[212:215], v38, s[32:35], s57 offen offset:1024 sc1
v_mfma_f32_16x16x32_bf16 v[76:79], v[220:223], v[184:187], v[76:79]
ds_read_b64_tr_b16 v[100:101], v14 offset:53248
ds_read_b64_tr_b16 v[102:103], v14 offset:53760
v_mfma_f32_16x16x32_bf16 v[80:83], v[224:227], v[184:187], v[80:83]
ds_read_b64_tr_b16 v[104:105], v15 offset:53248
ds_read_b64_tr_b16 v[106:107], v15 offset:53760
v_mfma_f32_16x16x32_bf16 v[64:67], v[224:227], v[180:183], v[64:67]
buffer_load_dwordx4 v[216:219], v39, s[32:35], s57 offen offset:1024 sc1
v_mfma_f32_16x16x32_bf16 v[68:71], v[228:231], v[180:183], v[68:71]
ds_read_b64_tr_b16 v[108:109], v16 offset:53248
ds_read_b64_tr_b16 v[110:111], v16 offset:53760
v_mfma_f32_16x16x32_bf16 v[84:87], v[228:231], v[184:187], v[84:87]
ds_read_b64_tr_b16 v[112:113], v17 offset:53248
ds_read_b64_tr_b16 v[114:115], v17 offset:53760
v_mfma_f32_16x16x32_bf16 v[88:91], v[232:235], v[184:187], v[88:91]
v_mfma_f32_16x16x32_bf16 v[72:75], v[232:235], v[180:183], v[72:75]
s_waitcnt vmcnt(6) lgkmcnt(8)
v_mfma_f32_16x16x32_bf16 v[60:63], v[236:239], v[188:191], v[60:63]
v_mfma_f32_16x16x32_bf16 v[76:79], v[236:239], v[192:195], v[76:79]
ds_read_b64_tr_b16 v[220:221], v14 offset:57344
ds_read_b64_tr_b16 v[222:223], v14 offset:57856
v_mfma_f32_16x16x32_bf16 v[80:83], v[240:243], v[192:195], v[80:83]
ds_read_b64_tr_b16 v[224:225], v15 offset:57344
ds_read_b64_tr_b16 v[226:227], v15 offset:57856
v_mfma_f32_16x16x32_bf16 v[64:67], v[240:243], v[188:191], v[64:67]
v_mfma_f32_16x16x32_bf16 v[68:71], v[244:247], v[188:191], v[68:71]
ds_read_b64_tr_b16 v[228:229], v16 offset:57344
ds_read_b64_tr_b16 v[230:231], v16 offset:57856
v_mfma_f32_16x16x32_bf16 v[84:87], v[244:247], v[192:195], v[84:87]
ds_read_b64_tr_b16 v[232:233], v17 offset:57344
ds_read_b64_tr_b16 v[234:235], v17 offset:57856
v_mfma_f32_16x16x32_bf16 v[88:91], v[248:251], v[192:195], v[88:91]
v_mfma_f32_16x16x32_bf16 v[72:75], v[248:251], v[188:191], v[72:75]
s_waitcnt vmcnt(4) lgkmcnt(8)
v_mfma_f32_16x16x32_bf16 v[60:63], v[100:103], v[196:199], v[60:63]
v_mfma_f32_16x16x32_bf16 v[76:79], v[100:103], v[200:203], v[76:79]
ds_read_b64_tr_b16 v[236:237], v14 offset:61440
ds_read_b64_tr_b16 v[238:239], v14 offset:61952
v_mfma_f32_16x16x32_bf16 v[80:83], v[104:107], v[200:203], v[80:83]
ds_read_b64_tr_b16 v[240:241], v15 offset:61440
ds_read_b64_tr_b16 v[242:243], v15 offset:61952
v_mfma_f32_16x16x32_bf16 v[64:67], v[104:107], v[196:199], v[64:67]
v_mfma_f32_16x16x32_bf16 v[68:71], v[108:111], v[196:199], v[68:71]
ds_read_b64_tr_b16 v[244:245], v16 offset:61440
ds_read_b64_tr_b16 v[246:247], v16 offset:61952
v_mfma_f32_16x16x32_bf16 v[84:87], v[108:111], v[200:203], v[84:87]
ds_read_b64_tr_b16 v[248:249], v17 offset:61440
ds_read_b64_tr_b16 v[250:251], v17 offset:61952
v_mfma_f32_16x16x32_bf16 v[88:91], v[112:115], v[200:203], v[88:91]
v_mfma_f32_16x16x32_bf16 v[72:75], v[112:115], v[196:199], v[72:75]
s_waitcnt vmcnt(2) lgkmcnt(8)
v_mfma_f32_16x16x32_bf16 v[60:63], v[220:223], v[204:207], v[60:63]
v_mfma_f32_16x16x32_bf16 v[76:79], v[220:223], v[208:211], v[76:79]
v_mfma_f32_16x16x32_bf16 v[80:83], v[224:227], v[208:211], v[80:83]
v_mfma_f32_16x16x32_bf16 v[64:67], v[224:227], v[204:207], v[64:67]
v_mfma_f32_16x16x32_bf16 v[68:71], v[228:231], v[204:207], v[68:71]
v_mfma_f32_16x16x32_bf16 v[84:87], v[228:231], v[208:211], v[84:87]
v_mfma_f32_16x16x32_bf16 v[88:91], v[232:235], v[208:211], v[88:91]
v_mfma_f32_16x16x32_bf16 v[72:75], v[232:235], v[204:207], v[72:75]
s_waitcnt vmcnt(0) lgkmcnt(0)
v_mfma_f32_16x16x32_bf16 v[60:63], v[236:239], v[212:215], v[60:63]
v_mfma_f32_16x16x32_bf16 v[64:67], v[240:243], v[212:215], v[64:67]
v_mfma_f32_16x16x32_bf16 v[68:71], v[244:247], v[212:215], v[68:71]
v_mfma_f32_16x16x32_bf16 v[72:75], v[248:251], v[212:215], v[72:75]
v_mfma_f32_16x16x32_bf16 v[76:79], v[236:239], v[216:219], v[76:79]
v_mfma_f32_16x16x32_bf16 v[80:83], v[240:243], v[216:219], v[80:83]
v_mfma_f32_16x16x32_bf16 v[84:87], v[244:247], v[216:219], v[84:87]
v_mfma_f32_16x16x32_bf16 v[88:91], v[248:251], v[216:219], v[88:91]
s_cmp_eq_u32 s46, 0
s_cbranch_scc1 slow_101
s_nop 0
v_cvt_pk_bf16_f32 v20, v60, v61
v_cvt_pk_bf16_f32 v21, v62, v63
v_cvt_pk_bf16_f32 v22, v64, v65
v_cvt_pk_bf16_f32 v23, v66, v67
buffer_store_dwordx4 v[20:23], v18, s[32:35], s85 offen offset:0
v_cvt_pk_bf16_f32 v24, v68, v69
v_cvt_pk_bf16_f32 v25, v70, v71
v_cvt_pk_bf16_f32 v26, v72, v73
v_cvt_pk_bf16_f32 v27, v74, v75
buffer_store_dwordx4 v[24:27], v18, s[32:35], s85 offen offset:1024
v_cvt_pk_bf16_f32 v28, v76, v77
v_cvt_pk_bf16_f32 v29, v78, v79
v_cvt_pk_bf16_f32 v30, v80, v81
v_cvt_pk_bf16_f32 v31, v82, v83
buffer_store_dwordx4 v[28:31], v18, s[32:35], s86 offen offset:0
v_cvt_pk_bf16_f32 v32, v84, v85
v_cvt_pk_bf16_f32 v33, v86, v87
v_cvt_pk_bf16_f32 v34, v88, v89
v_cvt_pk_bf16_f32 v35, v90, v91
buffer_store_dwordx4 v[32:35], v18, s[32:35], s86 offen offset:1024
s_barrier
v_dot2c_f32_bf16 v6, v20, v48
v_dot2c_f32_bf16 v8, v20, v20
v_dot2c_f32_bf16 v7, v28, v48
v_dot2c_f32_bf16 v9, v28, v28
v_dot2c_f32_bf16 v6, v21, v48
v_dot2c_f32_bf16 v8, v21, v21
v_dot2c_f32_bf16 v7, v29, v48
v_dot2c_f32_bf16 v9, v29, v29
v_dot2c_f32_bf16 v6, v22, v48
v_dot2c_f32_bf16 v8, v22, v22
v_dot2c_f32_bf16 v7, v30, v48
v_dot2c_f32_bf16 v9, v30, v30
v_dot2c_f32_bf16 v6, v23, v48
v_dot2c_f32_bf16 v8, v23, v23
v_dot2c_f32_bf16 v7, v31, v48
v_dot2c_f32_bf16 v9, v31, v31
v_dot2c_f32_bf16 v6, v24, v48
v_dot2c_f32_bf16 v8, v24, v24
v_dot2c_f32_bf16 v7, v32, v48
v_dot2c_f32_bf16 v9, v32, v32
v_dot2c_f32_bf16 v6, v25, v48
v_dot2c_f32_bf16 v8, v25, v25
v_dot2c_f32_bf16 v7, v33, v48
v_dot2c_f32_bf16 v9, v33, v33
v_dot2c_f32_bf16 v6, v26, v48
v_dot2c_f32_bf16 v8, v26, v26
v_dot2c_f32_bf16 v7, v34, v48
v_dot2c_f32_bf16 v9, v34, v34
v_dot2c_f32_bf16 v6, v27, v48
v_dot2c_f32_bf16 v8, v27, v27
v_dot2c_f32_bf16 v7, v35, v48
v_dot2c_f32_bf16 v9, v35, v35
s_mov_b64 exec, 1
s_waitcnt vmcnt(0)
buffer_store_dword v5, v4, s[32:35], s88 offen
s_mov_b64 exec, -1
s_nop 1
v_permlane32_swap_b32 v6, v7
v_permlane32_swap_b32 v8, v9
v_add_f32 v6, v6, v7
v_add_f32 v8, v8, v9
s_nop 1
v_permlane16_swap_b32 v6, v8
s_nop 0
v_add_f32 v6, v6, v8
buffer_store_dword v6, v1, s[32:35], s87 offen
back_102:
s_lshl_b32 s49, s44, 13
v_add_u32 v10, s49, v18
v_add_u32 v11, 1024, v10
s_lshl_b32 s48, s43, 1
v_lshrrev_b32 v4, 2, v2
v_and_b32 v5, 3, v0
v_lshl_add_u32 v6, v3, 3, v4
v_lshlrev_b32 v6, 7, v6
v_lshl_add_u32 v6, v5, 3, v6
v_lshrrev_b32 v7, 1, v4
v_and_b32 v8, 1, v3
v_lshl_add_u32 v7, v8, 1, v7
v_xor_b32 v7, s48, v7
v_lshl_add_u32 v12, v7, 5, v6
v_add_u32 v12, 16384, v12
v_xor_b32 v13, 32, v12
v_mov_b32 v14, v10
v_mov_b32 v15, v11
v_add_u32 v16, 122880, v12
v_add_u32 v17, 122880, v13
v_mov_b32 v156, 0
v_mov_b32 v157, 0
v_mov_b32 v158, 0
v_mov_b32 v159, 0
v_mov_b32 v160, 0
v_mov_b32 v161, 0
v_mov_b32 v162, 0
v_mov_b32 v163, 0
v_mov_b32 v164, 0
v_mov_b32 v165, 0
v_mov_b32 v166, 0
v_mov_b32 v167, 0
v_mov_b32 v168, 0
v_mov_b32 v169, 0
v_mov_b32 v170, 0
v_mov_b32 v171, 0
v_mov_b32 v172, 0
v_mov_b32 v173, 0
v_mov_b32 v174, 0
v_mov_b32 v175, 0
v_mov_b32 v176, 0
v_mov_b32 v177, 0
v_mov_b32 v178, 0
v_mov_b32 v179, 0
v_mov_b32 v180, 0
v_mov_b32 v181, 0
v_mov_b32 v182, 0
v_mov_b32 v183, 0
v_mov_b32 v184, 0
v_mov_b32 v185, 0
v_mov_b32 v186, 0
v_mov_b32 v187, 0
v_mov_b32 v188, 0
v_mov_b32 v189, 0
v_mov_b32 v190, 0
v_mov_b32 v191, 0
v_mov_b32 v192, 0
v_mov_b32 v193, 0
v_mov_b32 v194, 0
v_mov_b32 v195, 0
v_mov_b32 v196, 0
v_mov_b32 v197, 0
v_mov_b32 v198, 0
v_mov_b32 v199, 0
v_mov_b32 v200, 0
v_mov_b32 v201, 0
v_mov_b32 v202, 0
v_mov_b32 v203, 0
v_mov_b32 v204, 0
v_mov_b32 v205, 0
v_mov_b32 v206, 0
v_mov_b32 v207, 0
v_mov_b32 v208, 0
v_mov_b32 v209, 0
v_mov_b32 v210, 0
v_mov_b32 v211, 0
v_mov_b32 v212, 0
v_mov_b32 v213, 0
v_mov_b32 v214, 0
v_mov_b32 v215, 0
v_mov_b32 v216, 0
v_mov_b32 v217, 0
v_mov_b32 v218, 0
v_mov_b32 v219, 0
v_mov_b32 v220, 0
v_mov_b32 v221, 0
v_mov_b32 v222, 0
v_mov_b32 v223, 0
v_mov_b32 v224, 0
v_mov_b32 v225, 0
v_mov_b32 v226, 0
v_mov_b32 v227, 0
v_mov_b32 v228, 0
v_mov_b32 v229, 0
v_mov_b32 v230, 0
v_mov_b32 v231, 0
v_mov_b32 v232, 0
v_mov_b32 v233, 0
v_mov_b32 v234, 0
v_mov_b32 v235, 0
v_mov_b32 v236, 0
v_mov_b32 v237, 0
v_mov_b32 v238, 0
v_mov_b32 v239, 0
v_mov_b32 v240, 0
v_mov_b32 v241, 0
v_mov_b32 v242, 0
v_mov_b32 v243, 0
v_mov_b32 v244, 0
v_mov_b32 v245, 0
v_mov_b32 v246, 0
v_mov_b32 v247, 0
v_mov_b32 v248, 0
v_mov_b32 v249, 0
v_mov_b32 v250, 0
v_mov_b32 v251, 0
s_mov_b32 s48, 0xf149f2ca
v_mov_b32 v9, s48
v_lshlrev_b32 v4, 2, v3
v_sub_u32 v4, v2, v4
v_subrev_u32 v5, 0, v4
v_and_b32 v6, 0x80000001, v5
v_cmp_eq_u32 vcc, 0, v6
v_add_u32 v5, 1, v5
v_and_b32 v6, 0x80000001, v5
v_cndmask_b32 v40, v9, 0, vcc
v_cmp_eq_u32 vcc, 0x80000001, v6
s_nop 1
v_cndmask_b32 v36, v9, 0, vcc
v_subrev_u32 v5, 1, v4
v_and_b32 v6, 0x80000001, v5
v_cmp_eq_u32 vcc, 0, v6
v_add_u32 v5, 1, v5
v_and_b32 v6, 0x80000001, v5
v_cndmask_b32 v41, v9, 0, vcc
v_cmp_eq_u32 vcc, 0x80000001, v6
s_nop 1
v_cndmask_b32 v37, v9, 0, vcc
v_subrev_u32 v5, 2, v4
v_and_b32 v6, 0x80000001, v5
v_cmp_eq_u32 vcc, 0, v6
v_add_u32 v5, 1, v5
v_and_b32 v6, 0x80000001, v5
v_cndmask_b32 v42, v9, 0, vcc
v_cmp_eq_u32 vcc, 0x80000001, v6
s_nop 1
v_cndmask_b32 v38, v9, 0, vcc
v_subrev_u32 v5, 3, v4
v_and_b32 v6, 0x80000001, v5
v_cmp_eq_u32 vcc, 0, v6
v_add_u32 v5, 1, v5
v_and_b32 v6, 0x80000001, v5
v_cndmask_b32 v43, v9, 0, vcc
v_cmp_eq_u32 vcc, 0x80000001, v6
s_nop 1
v_cndmask_b32 v39, v9, 0, vcc
s_or_b32 s48, s41, s44
s_cmp_eq_u32 s48, 0
s_cselect_b64 vcc, -1, 0
v_cndmask_b32 v44, v36, v9, vcc
v_cndmask_b32 v45, v37, v9, vcc
v_cndmask_b32 v46, v38, v9, vcc
v_cndmask_b32 v47, v39, v9, vcc
v_and_b32 v4, 1, v2
v_lshlrev_b32 v4, 4, v4
v_mov_b32 v5, 0xffff
v_lshlrev_b32 v52, v4, v5
s_lshl_b32 s48, s43, 11
s_add_u32 s48, s48, 135168
v_add_u32 v53, s48, v18
v_lshl_add_u32 v55, v0, 3, s48
s_add_u32 s48, s41, s44
s_sub_u32 s48, s48, 1
s_lshl_b32 s49, s48, 1
s_add_u32 s49, s49, s43
s_lshl_b32 s49, s49, 11
s_mul_i32 s50, s42, 65536
s_add_u32 s49, s49, s50
s_add_u32 s49, s49, 8388608
s_cmp_lt_i32 s48, 0
s_cselect_b32 s49, 0xf0000000, s49
v_add_u32 v58, s49, v18
v_lshl_add_u32 v59, v0, 3, s49
s_lshl_b32 s48, s43, 2
s_add_u32 s48, s48, 134672
v_mov_b32 v19, s48
s_lshl_b32 s48, s43, 7
s_add_u32 s48, s48, 133120
v_lshl_add_u32 v7, v3, 4, s48
v_lshl_add_u32 v54, v2, 2, s48
s_lshl_b32 s49, s44, 6
v_add_u32 v8, s49, v2
v_lshlrev_b32 v8, 3, v8
v_add_u32 v8, 131072, v8
v_lshl_add_u32 v9, v3, 2, s49
v_lshlrev_b32 v9, 2, v9
v_add_u32 v9, 132096, v9
s_mov_b32 s64, 0
s_mov_b32 s65, 0
s_mov_b32 s66, 0x3e8293ee
s_barrier
ds_read_b128 v[60:63], v14 offset:0
ds_read_b128 v[64:67], v14 offset:2048
ds_read_b128 v[68:71], v14 offset:4096
ds_read_b128 v[72:75], v14 offset:6144
ds_read_b64_tr_b16 v[84:85], v16 offset:8192
ds_read_b64_tr_b16 v[86:87], v16 offset:8704
ds_read_b64_tr_b16 v[88:89], v17 offset:8192
ds_read_b64_tr_b16 v[90:91], v17 offset:8704
ds_read_b64_tr_b16 v[92:93], v16 offset:16384
ds_read_b64_tr_b16 v[94:95], v16 offset:16896
ds_read_b64_tr_b16 v[96:97], v17 offset:16384
ds_read_b64_tr_b16 v[98:99], v17 offset:16896
ds_read_b64_tr_b16 v[76:77], v16 offset:0
ds_read_b64_tr_b16 v[78:79], v16 offset:512
ds_read_b64_tr_b16 v[80:81], v17 offset:0
ds_read_b64_tr_b16 v[82:83], v17 offset:512
s_waitcnt lgkmcnt(0)
c2_loop:
v_mfma_f32_16x16x32_bf16 v[212:215], v[84:87], v[72:75], v[212:215]
ds_read_b128 v[100:103], v15 offset:0
v_mfma_f32_16x16x32_bf16 v[204:207], v[84:87], v[68:71], v[204:207]
ds_read_b128 v[104:107], v15 offset:2048
v_mfma_f32_16x16x32_bf16 v[196:199], v[84:87], v[64:67], v[196:199]
ds_read_b128 v[108:111], v15 offset:4096
v_mfma_f32_16x16x32_bf16 v[188:191], v[84:87], v[60:63], v[188:191]
ds_read_b128 v[112:115], v15 offset:6144
v_mfma_f32_16x16x32_bf16 v[192:195], v[88:91], v[60:63], v[192:195]
ds_read_b64_tr_b16 v[124:125], v16 offset:12288
v_mfma_f32_16x16x32_bf16 v[200:203], v[88:91], v[64:67], v[200:203]
ds_read_b64_tr_b16 v[126:127], v16 offset:12800
v_mfma_f32_16x16x32_bf16 v[208:211], v[88:91], v[68:71], v[208:211]
ds_read_b64_tr_b16 v[128:129], v17 offset:12288
v_mfma_f32_16x16x32_bf16 v[216:219], v[88:91], v[72:75], v[216:219]
ds_read_b64_tr_b16 v[130:131], v17 offset:12800
v_mfma_f32_16x16x32_bf16 v[244:247], v[72:75], v[92:95], v[244:247]
ds_read_b64_tr_b16 v[132:133], v16 offset:20480
v_mfma_f32_16x16x32_bf16 v[248:251], v[72:75], v[96:99], v[248:251]
ds_read_b64_tr_b16 v[134:135], v16 offset:20992
v_mfma_f32_16x16x32_bf16 v[240:243], v[68:71], v[96:99], v[240:243]
ds_read_b64_tr_b16 v[136:137], v17 offset:20480
v_mfma_f32_16x16x32_bf16 v[236:239], v[68:71], v[92:95], v[236:239]
ds_read_b64_tr_b16 v[138:139], v17 offset:20992
v_mfma_f32_16x16x32_bf16 v[228:231], v[64:67], v[92:95], v[228:231]
ds_read_b64_tr_b16 v[116:117], v16 offset:4096
v_mfma_f32_16x16x32_bf16 v[232:235], v[64:67], v[96:99], v[232:235]
ds_read_b64_tr_b16 v[118:119], v16 offset:4608
v_mfma_f32_16x16x32_bf16 v[224:227], v[60:63], v[96:99], v[224:227]
ds_read_b64_tr_b16 v[120:121], v17 offset:4096
v_mfma_f32_16x16x32_bf16 v[220:223], v[60:63], v[92:95], v[220:223]
ds_read_b64_tr_b16 v[122:123], v17 offset:4608
v_mfma_f32_16x16x32_bf16 v[156:159], v[76:79], v[60:63], v[156:159]
s_add_u32 s65, s65, 40960
s_cmp_eq_u32 s65, 122880
v_mfma_f32_16x16x32_bf16 v[164:167], v[76:79], v[64:67], v[164:167]
s_cselect_b32 s65, 0, s65
s_add_u32 s64, s64, 1
v_mfma_f32_16x16x32_bf16 v[172:175], v[76:79], v[68:71], v[172:175]
v_add_u32 v14, s65, v10
v_add_u32 v15, s65, v11
v_mfma_f32_16x16x32_bf16 v[180:183], v[76:79], v[72:75], v[180:183]
v_add_u32 v16, s65, v12
v_add_u32 v17, s65, v13
v_mfma_f32_16x16x32_bf16 v[184:187], v[80:83], v[72:75], v[184:187]
v_mfma_f32_16x16x32_bf16 v[176:179], v[80:83], v[68:71], v[176:179]
s_cmp_eq_u32 s64, 16
s_cbranch_scc1 c2_last
v_mfma_f32_16x16x32_bf16 v[168:171], v[80:83], v[64:67], v[168:171]
s_waitcnt lgkmcnt(0)
v_mfma_f32_16x16x32_bf16 v[160:163], v[80:83], v[60:63], v[160:163]
s_barrier
v_mfma_f32_16x16x32_bf16 v[212:215], v[124:127], v[112:115], v[212:215]
ds_read_b128 v[60:63], v14 offset:0
v_mfma_f32_16x16x32_bf16 v[204:207], v[124:127], v[108:111], v[204:207]
ds_read_b128 v[64:67], v14 offset:2048
v_mfma_f32_16x16x32_bf16 v[196:199], v[124:127], v[104:107], v[196:199]
ds_read_b128 v[68:71], v14 offset:4096
v_mfma_f32_16x16x32_bf16 v[188:191], v[124:127], v[100:103], v[188:191]
ds_read_b128 v[72:75], v14 offset:6144
v_mfma_f32_16x16x32_bf16 v[192:195], v[128:131], v[100:103], v[192:195]
ds_read_b64_tr_b16 v[84:85], v16 offset:8192
v_mfma_f32_16x16x32_bf16 v[200:203], v[128:131], v[104:107], v[200:203]
ds_read_b64_tr_b16 v[86:87], v16 offset:8704
v_mfma_f32_16x16x32_bf16 v[208:211], v[128:131], v[108:111], v[208:211]
ds_read_b64_tr_b16 v[88:89], v17 offset:8192
v_mfma_f32_16x16x32_bf16 v[216:219], v[128:131], v[112:115], v[216:219]
ds_read_b64_tr_b16 v[90:91], v17 offset:8704
v_mfma_f32_16x16x32_bf16 v[244:247], v[112:115], v[132:135], v[244:247]
ds_read_b64_tr_b16 v[92:93], v16 offset:16384
v_mfma_f32_16x16x32_bf16 v[248:251], v[112:115], v[136:139], v[248:251]
ds_read_b64_tr_b16 v[94:95], v16 offset:16896
v_mfma_f32_16x16x32_bf16 v[240:243], v[108:111], v[136:139], v[240:243]
ds_read_b64_tr_b16 v[96:97], v17 offset:16384
v_mfma_f32_16x16x32_bf16 v[236:239], v[108:111], v[132:135], v[236:239]
ds_read_b64_tr_b16 v[98:99], v17 offset:16896
v_mfma_f32_16x16x32_bf16 v[228:231], v[104:107], v[132:135], v[228:231]
ds_read_b64_tr_b16 v[76:77], v16 offset:0
v_mfma_f32_16x16x32_bf16 v[232:235], v[104:107], v[136:139], v[232:235]
ds_read_b64_tr_b16 v[78:79], v16 offset:512
v_mfma_f32_16x16x32_bf16 v[224:227], v[100:103], v[136:139], v[224:227]
ds_read_b64_tr_b16 v[80:81], v17 offset:0
v_mfma_f32_16x16x32_bf16 v[220:223], v[100:103], v[132:135], v[220:223]
ds_read_b64_tr_b16 v[82:83], v17 offset:512
v_mfma_f32_16x16x32_bf16 v[156:159], v[116:119], v[100:103], v[156:159]
v_mfma_f32_16x16x32_bf16 v[164:167], v[116:119], v[104:107], v[164:167]
v_mfma_f32_16x16x32_bf16 v[172:175], v[116:119], v[108:111], v[172:175]
v_mfma_f32_16x16x32_bf16 v[180:183], v[116:119], v[112:115], v[180:183]
v_mfma_f32_16x16x32_bf16 v[184:187], v[120:123], v[112:115], v[184:187]
v_mfma_f32_16x16x32_bf16 v[176:179], v[120:123], v[108:111], v[176:179]
v_mfma_f32_16x16x32_bf16 v[168:171], v[120:123], v[104:107], v[168:171]
s_waitcnt lgkmcnt(0)
v_mfma_f32_16x16x32_bf16 v[160:163], v[120:123], v[100:103], v[160:163]
s_branch c2_loop
c2_last:
v_mfma_f32_16x16x32_bf16 v[168:171], v[80:83], v[64:67], v[168:171]
s_waitcnt lgkmcnt(0)
v_mfma_f32_16x16x32_bf16 v[160:163], v[80:83], v[60:63], v[160:163]
v_mfma_f32_16x16x32_bf16 v[212:215], v[124:127], v[112:115], v[212:215]
ds_read_b128 v[140:143], v7 offset:0
v_mfma_f32_16x16x32_bf16 v[204:207], v[124:127], v[108:111], v[204:207]
ds_read_b128 v[144:147], v7 offset:64
v_mfma_f32_16x16x32_bf16 v[196:199], v[124:127], v[104:107], v[196:199]
ds_read_b128 v[148:151], v7 offset:256
v_mfma_f32_16x16x32_bf16 v[188:191], v[124:127], v[100:103], v[188:191]
ds_read_b128 v[152:155], v7 offset:320
v_mfma_f32_16x16x32_bf16 v[192:195], v[128:131], v[100:103], v[192:195]
ds_read2_b32 v[56:57], v54 offset0:128 offset1:144
v_mfma_f32_16x16x32_bf16 v[200:203], v[128:131], v[104:107], v[200:203]
v_mfma_f32_16x16x32_bf16 v[208:211], v[128:131], v[108:111], v[208:211]
v_mfma_f32_16x16x32_bf16 v[216:219], v[128:131], v[112:115], v[216:219]
s_barrier
v_mfma_f32_16x16x32_bf16 v[244:247], v[112:115], v[132:135], v[244:247]
ds_read_b64 v[92:93], v8 offset:0
v_mfma_f32_16x16x32_bf16 v[248:251], v[112:115], v[136:139], v[248:251]
ds_read_b64 v[94:95], v8 offset:128
v_mfma_f32_16x16x32_bf16 v[240:243], v[108:111], v[136:139], v[240:243]
ds_read_b64 v[96:97], v8 offset:256
v_mfma_f32_16x16x32_bf16 v[236:239], v[108:111], v[132:135], v[236:239]
ds_read_b64 v[98:99], v8 offset:384
v_mfma_f32_16x16x32_bf16 v[228:231], v[104:107], v[132:135], v[228:231]
ds_read_b128 v[60:63], v9 offset:0
v_mfma_f32_16x16x32_bf16 v[232:235], v[104:107], v[136:139], v[232:235]
ds_read_b128 v[64:67], v9 offset:64
v_mfma_f32_16x16x32_bf16 v[224:227], v[100:103], v[136:139], v[224:227]
ds_read_b128 v[68:71], v9 offset:128
v_mfma_f32_16x16x32_bf16 v[220:223], v[100:103], v[132:135], v[220:223]
ds_read_b128 v[72:75], v9 offset:192
v_mfma_f32_16x16x32_bf16 v[156:159], v[116:119], v[100:103], v[156:159]
ds_read_b128 v[76:79], v9 offset:512
v_mfma_f32_16x16x32_bf16 v[164:167], v[116:119], v[104:107], v[164:167]
ds_read_b128 v[80:83], v9 offset:576
v_mfma_f32_16x16x32_bf16 v[172:175], v[116:119], v[108:111], v[172:175]
ds_read_b128 v[84:87], v9 offset:640
v_mfma_f32_16x16x32_bf16 v[180:183], v[116:119], v[112:115], v[180:183]
ds_read_b128 v[88:91], v9 offset:704
v_mfma_f32_16x16x32_bf16 v[184:187], v[120:123], v[112:115], v[184:187]
v_mfma_f32_16x16x32_bf16 v[176:179], v[120:123], v[108:111], v[176:179]
v_mfma_f32_16x16x32_bf16 v[168:171], v[120:123], v[104:107], v[168:171]
v_mfma_f32_16x16x32_bf16 v[160:163], v[120:123], v[100:103], v[160:163]
c2_epi:
s_waitcnt lgkmcnt(0)
.p2align 3
v_pk_fma_f32 v[212:213], v[148:149], v[98:99], v[212:213] op_sel:[0,1,0] op_sel_hi:[1,1,1]
v_pk_fma_f32 v[214:215], v[150:151], v[98:99], v[214:215] op_sel:[0,1,0] op_sel_hi:[1,1,1]
v_pk_fma_f32 v[216:217], v[152:153], v[98:99], v[216:217] op_sel:[0,1,0] op_sel_hi:[1,1,1]
v_pk_fma_f32 v[218:219], v[154:155], v[98:99], v[218:219] op_sel:[0,1,0] op_sel_hi:[1,1,1]
v_pk_mul_f32 v[212:213], v[212:213], v[98:99] op_sel:[0,0] op_sel_hi:[1,0]
v_pk_mul_f32 v[214:215], v[214:215], v[98:99] op_sel:[0,0] op_sel_hi:[1,0]
v_pk_mul_f32 v[216:217], v[216:217], v[98:99] op_sel:[0,0] op_sel_hi:[1,0]
v_pk_mul_f32 v[218:219], v[218:219], v[98:99] op_sel:[0,0] op_sel_hi:[1,0]
v_cvt_pk_bf16_f32 v212, v212, v213
v_cvt_pk_bf16_f32 v213, v214, v215
v_cvt_pk_bf16_f32 v214, v216, v217
v_cvt_pk_bf16_f32 v215, v218, v219
v_pk_fma_f32 v[244:245], v[88:89], v[56:57], v[244:245] op_sel:[0,0,0] op_sel_hi:[1,0,1]
v_pk_fma_f32 v[246:247], v[90:91], v[56:57], v[246:247] op_sel:[0,0,0] op_sel_hi:[1,0,1]
v_pk_mul_f32 v[244:245], v[244:245], v[72:73]
v_pk_mul_f32 v[246:247], v[246:247], v[74:75]
v_cvt_pk_bf16_f32 v108, v244, v245
v_cvt_pk_bf16_f32 v109, v246, v247
v_pk_fma_f32 v[248:249], v[88:89], v[56:57], v[248:249] op_sel:[0,1,0] op_sel_hi:[1,1,1]
v_pk_fma_f32 v[250:251], v[90:91], v[56:57], v[250:251] op_sel:[0,1,0] op_sel_hi:[1,1,1]
v_pk_mul_f32 v[248:249], v[248:249], v[72:73]
v_pk_mul_f32 v[250:251], v[250:251], v[74:75]
v_cvt_pk_bf16_f32 v118, v248, v249
v_cvt_pk_bf16_f32 v119, v250, v251
s_cmp_lg_u32 s44, 1
s_cbranch_scc1 else_103
buffer_store_dwordx4 v[212:215], v58, s[32:35], 0 offen sc1
buffer_store_dwordx2 v[108:109], v59, s[32:35], 0 offen offset:1024 sc1
buffer_store_dwordx2 v[118:119], v59, s[32:35], 0 offen offset:1536 sc1
s_branch fi_104
else_103:
ds_write_b128 v53, v[212:215]
ds_write_b64 v55, v[108:109] offset:1024
ds_write_b64 v55, v[118:119] offset:1536
v_mov_b32 v4, 3
ds_write_b32 v19, v4
fi_104:
.p2align 3
v_pk_fma_f32 v[188:189], v[148:149], v[92:93], v[188:189] op_sel:[0,1,0] op_sel_hi:[1,1,1]
v_pk_fma_f32 v[196:197], v[148:149], v[94:95], v[196:197] op_sel:[0,1,0] op_sel_hi:[1,1,1]
v_pk_fma_f32 v[204:205], v[148:149], v[96:97], v[204:205] op_sel:[0,1,0] op_sel_hi:[1,1,1]
v_pk_fma_f32 v[164:165], v[140:141], v[94:95], v[164:165] op_sel:[0,1,0] op_sel_hi:[1,1,1]
v_pk_fma_f32 v[172:173], v[140:141], v[96:97], v[172:173] op_sel:[0,1,0] op_sel_hi:[1,1,1]
v_pk_fma_f32 v[180:181], v[140:141], v[98:99], v[180:181] op_sel:[0,1,0] op_sel_hi:[1,1,1]
v_pk_fma_f32 v[190:191], v[150:151], v[92:93], v[190:191] op_sel:[0,1,0] op_sel_hi:[1,1,1]
v_pk_mul_f32 v[188:189], v[188:189], v[92:93] op_sel:[0,0] op_sel_hi:[1,0]
v_pk_fma_f32 v[198:199], v[150:151], v[94:95], v[198:199] op_sel:[0,1,0] op_sel_hi:[1,1,1]
v_pk_mul_f32 v[196:197], v[196:197], v[94:95] op_sel:[0,0] op_sel_hi:[1,0]
v_pk_fma_f32 v[206:207], v[150:151], v[96:97], v[206:207] op_sel:[0,1,0] op_sel_hi:[1,1,1]
v_pk_mul_f32 v[204:205], v[204:205], v[96:97] op_sel:[0,0] op_sel_hi:[1,0]
v_pk_fma_f32 v[166:167], v[142:143], v[94:95], v[166:167] op_sel:[0,1,0] op_sel_hi:[1,1,1]
v_cvt_pk_bf16_f32 v164, v164, v165
v_pk_fma_f32 v[174:175], v[142:143], v[96:97], v[174:175] op_sel:[0,1,0] op_sel_hi:[1,1,1]
v_cvt_pk_bf16_f32 v172, v172, v173
v_pk_fma_f32 v[182:183], v[142:143], v[98:99], v[182:183] op_sel:[0,1,0] op_sel_hi:[1,1,1]
v_cvt_pk_bf16_f32 v180, v180, v181
v_pk_fma_f32 v[192:193], v[152:153], v[92:93], v[192:193] op_sel:[0,1,0] op_sel_hi:[1,1,1]
v_pk_fma_f32 v[194:195], v[154:155], v[92:93], v[194:195] op_sel:[0,1,0] op_sel_hi:[1,1,1]
v_pk_mul_f32 v[190:191], v[190:191], v[92:93] op_sel:[0,0] op_sel_hi:[1,0]
v_cvt_pk_bf16_f32 v188, v188, v189
v_pk_fma_f32 v[200:201], v[152:153], v[94:95], v[200:201] op_sel:[0,1,0] op_sel_hi:[1,1,1]
v_pk_fma_f32 v[202:203], v[154:155], v[94:95], v[202:203] op_sel:[0,1,0] op_sel_hi:[1,1,1]
v_pk_mul_f32 v[198:199], v[198:199], v[94:95] op_sel:[0,0] op_sel_hi:[1,0]
v_cvt_pk_bf16_f32 v196, v196, v197
v_pk_fma_f32 v[208:209], v[152:153], v[96:97], v[208:209] op_sel:[0,1,0] op_sel_hi:[1,1,1]
v_pk_fma_f32 v[210:211], v[154:155], v[96:97], v[210:211] op_sel:[0,1,0] op_sel_hi:[1,1,1]
v_pk_mul_f32 v[206:207], v[206:207], v[96:97] op_sel:[0,0] op_sel_hi:[1,0]
v_cvt_pk_bf16_f32 v204, v204, v205
v_pk_fma_f32 v[168:169], v[144:145], v[94:95], v[168:169] op_sel:[0,1,0] op_sel_hi:[1,1,1]
v_pk_fma_f32 v[170:171], v[146:147], v[94:95], v[170:171] op_sel:[0,1,0] op_sel_hi:[1,1,1]
v_cvt_pk_bf16_f32 v165, v166, v167
v_pk_fma_f32 v[176:177], v[144:145], v[96:97], v[176:177] op_sel:[0,1,0] op_sel_hi:[1,1,1]
v_pk_fma_f32 v[178:179], v[146:147], v[96:97], v[178:179] op_sel:[0,1,0] op_sel_hi:[1,1,1]
v_cvt_pk_bf16_f32 v173, v174, v175
v_pk_fma_f32 v[184:185], v[144:145], v[98:99], v[184:185] op_sel:[0,1,0] op_sel_hi:[1,1,1]
v_pk_fma_f32 v[186:187], v[146:147], v[98:99], v[186:187] op_sel:[0,1,0] op_sel_hi:[1,1,1]
v_cvt_pk_bf16_f32 v181, v182, v183
v_pk_mul_f32 v[192:193], v[192:193], v[92:93] op_sel:[0,0] op_sel_hi:[1,0]
v_pk_mul_f32 v[194:195], v[194:195], v[92:93] op_sel:[0,0] op_sel_hi:[1,0]
v_cvt_pk_bf16_f32 v189, v190, v191
v_pk_mul_f32 v[200:201], v[200:201], v[94:95] op_sel:[0,0] op_sel_hi:[1,0]
v_pk_mul_f32 v[202:203], v[202:203], v[94:95] op_sel:[0,0] op_sel_hi:[1,0]
v_cvt_pk_bf16_f32 v197, v198, v199
v_pk_mul_f32 v[208:209], v[208:209], v[96:97] op_sel:[0,0] op_sel_hi:[1,0]
v_pk_mul_f32 v[210:211], v[210:211], v[96:97] op_sel:[0,0] op_sel_hi:[1,0]
v_cvt_pk_bf16_f32 v205, v206, v207
v_cvt_pk_bf16_f32 v166, v168, v169
v_cvt_pk_bf16_f32 v167, v170, v171
v_cvt_pk_bf16_f32 v174, v176, v177
v_cvt_pk_bf16_f32 v175, v178, v179
v_cvt_pk_bf16_f32 v182, v184, v185
v_cvt_pk_bf16_f32 v183, v186, v187
v_cvt_pk_bf16_f32 v190, v192, v193
v_cvt_pk_bf16_f32 v191, v194, v195
v_mfma_f32_16x16x32_bf16 v[216:219], v[212:215], v[180:183], v[40:43]
v_cvt_pk_bf16_f32 v198, v200, v201
v_cvt_pk_bf16_f32 v199, v202, v203
v_mfma_f32_16x16x32_bf16 v[168:171], v[188:191], v[164:167], v[36:39]
v_cvt_pk_bf16_f32 v206, v208, v209
v_cvt_pk_bf16_f32 v207, v210, v211
v_mfma_f32_16x16x32_bf16 v[200:203], v[196:199], v[164:167], v[40:43]
v_mul_f32 v124, s66, v92
v_mul_f32 v125, s66, v94
v_mfma_f32_16x16x32_bf16 v[208:211], v[204:207], v[172:175], v[40:43]
v_mul_f32 v126, s66, v96
v_mul_f32 v127, s66, v98
v_mfma_f32_16x16x32_bf16 v[176:179], v[196:199], v[172:175], v[36:39]
v_max_f32 v164, v168, v169
v_max_f32 v165, v170, v171
v_mfma_f32_16x16x32_bf16 v[184:187], v[204:207], v[180:183], v[36:39]
v_max_f32 v166, v200, v201
v_max_f32 v182, v216, v217
v_max_f32 v174, v208, v209
v_max_f32 v167, v202, v203
v_max3_f32 v129, v164, v165, v166
v_pk_fma_f32 v[156:157], v[140:141], v[92:93], v[156:157] op_sel:[0,1,0] op_sel_hi:[1,1,1]
v_pk_fma_f32 v[158:159], v[142:143], v[92:93], v[158:159] op_sel:[0,1,0] op_sel_hi:[1,1,1]
v_cvt_pk_bf16_f32 v156, v156, v157
v_pk_fma_f32 v[160:161], v[144:145], v[92:93], v[160:161] op_sel:[0,1,0] op_sel_hi:[1,1,1]
v_pk_fma_f32 v[162:163], v[146:147], v[92:93], v[162:163] op_sel:[0,1,0] op_sel_hi:[1,1,1]
v_cvt_pk_bf16_f32 v157, v158, v159
v_cvt_pk_bf16_f32 v158, v160, v161
v_cvt_pk_bf16_f32 v159, v162, v163
v_pk_fma_f32 v[220:221], v[76:77], v[56:57], v[220:221] op_sel:[0,0,0] op_sel_hi:[1,0,1]
v_pk_fma_f32 v[222:223], v[78:79], v[56:57], v[222:223] op_sel:[0,0,0] op_sel_hi:[1,0,1]
v_mfma_f32_16x16x32_bf16 v[192:195], v[188:191], v[156:159], v[40:43]
v_max_f32 v172, v176, v177
v_max_f32 v173, v178, v179
v_max_f32 v180, v184, v185
v_max_f32 v181, v186, v187
v_max_f32_e64 v175, v210, v211
v_pk_fma_f32 v[224:225], v[76:77], v[56:57], v[224:225] op_sel:[0,1,0] op_sel_hi:[1,1,1]
v_pk_fma_f32 v[226:227], v[78:79], v[56:57], v[226:227] op_sel:[0,1,0] op_sel_hi:[1,1,1]
v_pk_fma_f32 v[228:229], v[80:81], v[56:57], v[228:229] op_sel:[0,0,0] op_sel_hi:[1,0,1]
v_pk_fma_f32 v[230:231], v[82:83], v[56:57], v[230:231] op_sel:[0,0,0] op_sel_hi:[1,0,1]
v_pk_fma_f32 v[232:233], v[80:81], v[56:57], v[232:233] op_sel:[0,1,0] op_sel_hi:[1,1,1]
v_pk_fma_f32 v[234:235], v[82:83], v[56:57], v[234:235] op_sel:[0,1,0] op_sel_hi:[1,1,1]
v_pk_fma_f32 v[236:237], v[84:85], v[56:57], v[236:237] op_sel:[0,0,0] op_sel_hi:[1,0,1]
v_pk_fma_f32 v[238:239], v[86:87], v[56:57], v[238:239] op_sel:[0,0,0] op_sel_hi:[1,0,1]
v_pk_fma_f32 v[240:241], v[84:85], v[56:57], v[240:241] op_sel:[0,1,0] op_sel_hi:[1,1,1]
v_pk_fma_f32 v[242:243], v[86:87], v[56:57], v[242:243] op_sel:[0,1,0] op_sel_hi:[1,1,1]
v_pk_mul_f32 v[220:221], v[220:221], v[60:61]
v_pk_mul_f32 v[222:223], v[222:223], v[62:63]
v_pk_mul_f32 v[224:225], v[224:225], v[60:61]
s_cmp_lg_u32 s44, 0
s_cbranch_scc1 else_105
buffer_load_dwordx4 v[120:123], v58, s[32:35], 0 offen sc1
buffer_load_dwordx2 v[100:101], v59, s[32:35], 0 offen offset:1024 sc1
buffer_load_dwordx2 v[110:111], v59, s[32:35], 0 offen offset:1536 sc1
else_105:
v_pk_mul_f32 v[226:227], v[226:227], v[62:63]
v_pk_mul_f32 v[228:229], v[228:229], v[64:65]
v_pk_mul_f32 v[230:231], v[230:231], v[66:67]
v_pk_mul_f32 v[232:233], v[232:233], v[64:65]
v_pk_mul_f32 v[234:235], v[234:235], v[66:67]
v_pk_mul_f32 v[236:237], v[236:237], v[68:69]
v_pk_mul_f32 v[238:239], v[238:239], v[70:71]
v_pk_mul_f32 v[240:241], v[240:241], v[68:69]
v_pk_mul_f32 v[242:243], v[242:243], v[70:71]
v_max3_f32 v130, v172, v173, v174
v_max_f32_e64 v183, v218, v219
v_max3_f32 v131, v180, v181, v182
v_cvt_pk_bf16_f32 v102, v220, v221
v_cvt_pk_bf16_f32 v103, v222, v223
v_cvt_pk_bf16_f32 v112, v224, v225
v_cvt_pk_bf16_f32 v113, v226, v227
v_cvt_pk_bf16_f32 v104, v228, v229
v_cvt_pk_bf16_f32 v105, v230, v231
v_cvt_pk_bf16_f32 v114, v232, v233
v_cvt_pk_bf16_f32 v115, v234, v235
v_cvt_pk_bf16_f32 v106, v236, v237
v_cvt_pk_bf16_f32 v107, v238, v239
v_cvt_pk_bf16_f32 v116, v240, v241
v_cvt_pk_bf16_f32 v117, v242, v243
v_max_f32 v129, v129, v167
v_max_f32 v130, v130, v175
v_max_f32 v131, v131, v183
s_cmp_lg_u32 s44, 0
s_cbranch_scc1 else_107
s_mov_b32 s63, 0
sent_109:
s_waitcnt vmcnt(0)
v_max_u32 v4, v120, v121
v_max3_u32 v4, v4, v122, v123
v_max3_u32 v4, v4, v100, v101
v_max3_u32 v4, v4, v110, v111
v_cmp_eq_u32 vcc, -1, v4
s_cbranch_vccz sentd_110
buffer_load_dwordx4 v[120:123], v58, s[32:35], 0 offen sc1
buffer_load_dwordx2 v[100:101], v59, s[32:35], 0 offen offset:1024 sc1
buffer_load_dwordx2 v[110:111], v59, s[32:35], 0 offen offset:1536 sc1
s_add_u32 s63, s63, 1
s_cmp_lt_u32 s63, 0x80000
s_cbranch_scc1 sent_109
s_waitcnt vmcnt(0)
sentd_110:
s_branch fi_108
else_107:
s_mov_b32 s63, 0
px_111:
ds_read_b32 v4, v19
ds_read_b128 v[120:123], v53
ds_read_b64 v[100:101], v55 offset:1024
ds_read_b64 v[110:111], v55 offset:1536
s_add_u32 s63, s63, 1
s_cmp_lt_u32 s63, 0x400000
s_waitcnt lgkmcnt(0)
v_cmp_ne_u32 vcc, 3, v4
s_cbranch_vccz pxd_112
s_cbranch_scc1 px_111
pxd_112:
fi_108:
s_cmp_eq_u32 s46, 0
s_cbranch_scc1 slow_113
.p2align 3
v_mfma_f32_16x16x32_bf16 v[160:163], v[120:123], v[156:159], v[44:47]
v_max_f32 v158, v192, v193
v_max_f32 v159, v194, v195
v_permlane32_swap_b32 v130, v131
s_nop 0
v_max_f32 v130, v130, v131
s_nop 2
v_max_f32 v156, v160, v161
v_max_f32 v157, v162, v163
v_max3_f32 v128, v156, v157, v158
v_max_f32 v128, v128, v159
s_nop 1
v_permlane32_swap_b32 v128, v129
s_nop 0
v_max_f32 v128, v128, v129
s_nop 1
v_permlane16_swap_b32 v128, v130
s_nop 0
v_max_f32 v128, v128, v130
v_mov_b32 v130, v128
s_nop 1
v_permlane16_swap_b32 v128, v130
s_nop 0
v_mov_b32 v129, v128
v_mov_b32 v131, v130
s_nop 0
v_permlane32_swap_b32 v128, v129
v_permlane32_swap_b32 v130, v131
v_mul_f32 v128, v128, v124
v_mul_f32 v129, v129, v125
v_pk_fma_f32 v[156:157], v[156:157], v[124:125], v[128:129] op_sel:[0,0,0] op_sel_hi:[1,0,0] neg_lo:[0,0,1] neg_hi:[0,0,1]
v_pk_fma_f32 v[158:159], v[158:159], v[124:125], v[128:129] op_sel:[0,0,0] op_sel_hi:[1,0,0] neg_lo:[0,0,1] neg_hi:[0,0,1]
v_mul_f32 v130, v130, v126
v_mul_f32 v131, v131, v127
v_exp_f32 v156, v156
v_exp_f32 v157, v157
v_exp_f32 v158, v158
v_exp_f32 v159, v159
v_pk_fma_f32 v[164:165], v[164:165], v[124:125], v[128:129] op_sel:[0,1,1] op_sel_hi:[1,1,1] neg_lo:[0,0,1] neg_hi:[0,0,1]
v_pk_fma_f32 v[166:167], v[166:167], v[124:125], v[128:129] op_sel:[0,1,1] op_sel_hi:[1,1,1] neg_lo:[0,0,1] neg_hi:[0,0,1]
v_exp_f32 v164, v164
v_exp_f32 v165, v165
v_exp_f32 v166, v166
v_exp_f32 v167, v167
v_pk_fma_f32 v[172:173], v[172:173], v[126:127], v[130:131] op_sel:[0,0,0] op_sel_hi:[1,0,0] neg_lo:[0,0,1] neg_hi:[0,0,1]
v_pk_fma_f32 v[174:175], v[174:175], v[126:127], v[130:131] op_sel:[0,0,0] op_sel_hi:[1,0,0] neg_lo:[0,0,1] neg_hi:[0,0,1]
v_cvt_pk_bf16_f32 v156, v156, v156
v_cvt_pk_bf16_f32 v157, v157, v157
v_cvt_pk_bf16_f32 v158, v158, v158
v_cvt_pk_bf16_f32 v159, v159, v159
v_exp_f32 v172, v172
v_exp_f32 v173, v173
v_exp_f32 v174, v174
v_exp_f32 v175, v175
v_pk_fma_f32 v[180:181], v[180:181], v[126:127], v[130:131] op_sel:[0,1,1] op_sel_hi:[1,1,1] neg_lo:[0,0,1] neg_hi:[0,0,1]
v_pk_fma_f32 v[182:183], v[182:183], v[126:127], v[130:131] op_sel:[0,1,1] op_sel_hi:[1,1,1] neg_lo:[0,0,1] neg_hi:[0,0,1]
v_and_b32 v156, v52, v156
v_and_b32 v157, v52, v157
v_and_b32 v158, v52, v158
v_and_b32 v159, v52, v159
v_cvt_pk_bf16_f32 v164, v164, v164
v_cvt_pk_bf16_f32 v165, v165, v165
v_mfma_f32_16x16x32_bf16 v[160:163], v[48:51], v[156:159], 0
v_cvt_pk_bf16_f32 v166, v166, v166
v_cvt_pk_bf16_f32 v167, v167, v167
v_mfma_f32_16x16x32_bf16 v[220:223], v[100:103], v[156:159], 0
v_exp_f32 v180, v180
v_mfma_f32_16x16x32_bf16 v[224:227], v[110:113], v[156:159], 0
v_exp_f32 v181, v181
v_exp_f32 v182, v182
v_exp_f32 v183, v183
v_and_b32 v164, v52, v164
v_and_b32 v165, v52, v165
v_and_b32 v166, v52, v166
v_and_b32 v167, v52, v167
v_cvt_pk_bf16_f32 v172, v172, v172
v_cvt_pk_bf16_f32 v173, v173, v173
v_mfma_f32_16x16x32_bf16 v[168:171], v[48:51], v[164:167], 0
v_cvt_pk_bf16_f32 v174, v174, v174
v_cvt_pk_bf16_f32 v175, v175, v175
v_mfma_f32_16x16x32_bf16 v[228:231], v[102:105], v[164:167], 0
v_and_b32 v172, v52, v172
v_and_b32 v173, v52, v173
v_mfma_f32_16x16x32_bf16 v[232:235], v[112:115], v[164:167], 0
v_and_b32 v174, v52, v174
v_and_b32 v175, v52, v175
v_cvt_pk_bf16_f32 v180, v180, v180
v_cvt_pk_bf16_f32 v181, v181, v181
v_mfma_f32_16x16x32_bf16 v[176:179], v[48:51], v[172:175], 0
v_cvt_pk_bf16_f32 v182, v182, v182
v_cvt_pk_bf16_f32 v183, v183, v183
v_mfma_f32_16x16x32_bf16 v[236:239], v[104:107], v[172:175], 0
v_and_b32 v180, v52, v180
v_and_b32 v181, v52, v181
v_mfma_f32_16x16x32_bf16 v[240:243], v[114:117], v[172:175], 0
v_and_b32 v182, v52, v182
v_and_b32 v183, v52, v183
v_rcp_f32 v160, v160
v_rcp_f32 v168, v168
v_pk_mul_f32 v[220:221], v[220:221], v[160:161] op_sel:[0,0] op_sel_hi:[1,0]
v_pk_mul_f32 v[222:223], v[222:223], v[160:161] op_sel:[0,0] op_sel_hi:[1,0]
v_pk_mul_f32 v[228:229], v[228:229], v[168:169] op_sel:[0,0] op_sel_hi:[1,0]
v_pk_mul_f32 v[224:225], v[224:225], v[160:161] op_sel:[0,0] op_sel_hi:[1,0]
v_pk_mul_f32 v[226:227], v[226:227], v[160:161] op_sel:[0,0] op_sel_hi:[1,0]
v_pk_mul_f32 v[230:231], v[230:231], v[168:169] op_sel:[0,0] op_sel_hi:[1,0]
v_pk_mul_f32 v[232:233], v[232:233], v[168:169] op_sel:[0,0] op_sel_hi:[1,0]
v_pk_mul_f32 v[234:235], v[234:235], v[168:169] op_sel:[0,0] op_sel_hi:[1,0]
v_mfma_f32_16x16x32_bf16 v[184:187], v[48:51], v[180:183], 0
v_rcp_f32_e64 v176, v176
v_cvt_pk_bf16_f32 v220, v220, v221
v_cvt_pk_bf16_f32 v221, v222, v223
v_cvt_pk_bf16_f32 v228, v228, v229
v_pk_mul_f32 v[236:237], v[236:237], v[176:177] op_sel:[0,0] op_sel_hi:[1,0]
v_mfma_f32_16x16x32_bf16 v[244:247], v[106:109], v[180:183], 0
v_cvt_pk_bf16_f32 v222, v224, v225
v_cvt_pk_bf16_f32 v223, v226, v227
v_rcp_f32_e64 v184, v184
v_cvt_pk_bf16_f32 v229, v230, v231
v_pk_mul_f32 v[238:239], v[238:239], v[176:177] op_sel:[0,0] op_sel_hi:[1,0]
v_pk_mul_f32 v[240:241], v[240:241], v[176:177] op_sel:[0,0] op_sel_hi:[1,0]
v_pk_mul_f32 v[242:243], v[242:243], v[176:177] op_sel:[0,0] op_sel_hi:[1,0]
v_cvt_pk_bf16_f32 v236, v236, v237
v_pk_mul_f32 v[244:245], v[244:245], v[184:185] op_sel:[0,0] op_sel_hi:[1,0]
v_pk_mul_f32 v[246:247], v[246:247], v[184:185] op_sel:[0,0] op_sel_hi:[1,0]
v_mfma_f32_16x16x32_bf16 v[248:251], v[116:119], v[180:183], 0
buffer_store_dwordx4 v[220:223], v18, s[32:35], s80 offen
v_cvt_pk_bf16_f32 v230, v232, v233
v_cvt_pk_bf16_f32 v231, v234, v235
v_cvt_pk_bf16_f32 v237, v238, v239
v_cvt_pk_bf16_f32 v244, v244, v245
buffer_store_dwordx4 v[228:231], v18, s[32:35], s81 offen
v_cvt_pk_bf16_f32 v238, v240, v241
v_cvt_pk_bf16_f32 v239, v242, v243
v_pk_mul_f32 v[248:249], v[248:249], v[184:185] op_sel:[0,0] op_sel_hi:[1,0]
v_pk_mul_f32 v[250:251], v[250:251], v[184:185] op_sel:[0,0] op_sel_hi:[1,0]
v_cvt_pk_bf16_f32 v245, v246, v247
buffer_store_dwordx4 v[236:239], v18, s[32:35], s82 offen
v_cvt_pk_bf16_f32 v246, v248, v249
v_cvt_pk_bf16_f32 v247, v250, v251
buffer_store_dwordx4 v[244:247], v18, s[32:35], s83 offen
back_114:
s_barrier
v_and_b32 v36, 31, v0
v_lshlrev_b32 v36, 2, v36
s_lshl_b32 s62, s45, 2
v_mov_b32 v4, s62
v_mov_b32 v5, 3
s_mov_b64 exec, 1
s_waitcnt vmcnt(0)
s_cmp_eq_u32 s46, 0
s_cbranch_scc1 slow_115
buffer_store_dword v5, v4, s[32:35], s84 offen
back_116:
s_mov_b64 exec, -1
v_lshrrev_b32 v4, 2, v2
v_and_b32 v5, 3, v0
v_lshl_add_u32 v6, v3, 3, v4
v_lshlrev_b32 v6, 7, v6
v_lshl_add_u32 v6, v5, 3, v6
v_lshrrev_b32 v7, 1, v4
v_and_b32 v8, 1, v3
v_lshl_add_u32 v7, v8, 1, v7
v_lshl_add_u32 v10, v7, 5, v6
v_xor_b32 v11, 32, v10
v_xor_b32 v12, 64, v10
v_xor_b32 v13, 96, v10
v_add_u32 v14, 0x10000, v10
v_add_u32 v15, 0x10000, v11
v_add_u32 v16, 0x10000, v12
v_add_u32 v17, 0x10000, v13
ds_read_b64_tr_b16 v[220:221], v10 offset:0
ds_read_b64_tr_b16 v[222:223], v10 offset:512
ds_read_b64_tr_b16 v[224:225], v11 offset:0
ds_read_b64_tr_b16 v[226:227], v11 offset:512
ds_read_b64_tr_b16 v[228:229], v12 offset:0
ds_read_b64_tr_b16 v[230:231], v12 offset:512
ds_read_b64_tr_b16 v[232:233], v13 offset:0
ds_read_b64_tr_b16 v[234:235], v13 offset:512
ds_read_b64_tr_b16 v[236:237], v10 offset:4096
ds_read_b64_tr_b16 v[238:239], v10 offset:4608
ds_read_b64_tr_b16 v[240:241], v11 offset:4096
ds_read_b64_tr_b16 v[242:243], v11 offset:4608
ds_read_b64_tr_b16 v[244:245], v12 offset:4096
ds_read_b64_tr_b16 v[246:247], v12 offset:4608
ds_read_b64_tr_b16 v[248:249], v13 offset:4096
ds_read_b64_tr_b16 v[250:251], v13 offset:4608
s_lshl_b32 s48, s41, 3
s_lshl_b32 s49, s40, 1
s_add_u32 s48, s48, s49
s_lshl_b32 s48, s48, 15
s_add_u32 s48, s48, 4194304
v_add_u32 v38, s48, v18
v_add_u32 v39, 32768, v38
s_lshl_b32 s57, s75, 11
s_add_u32 s87, s87, 262144
v_lshlrev_b32 v60, 16, v20
v_and_b32 v61, 0xffff0000, v20
v_lshlrev_b32 v62, 16, v21
v_and_b32 v63, 0xffff0000, v21
v_lshlrev_b32 v64, 16, v22
v_and_b32 v65, 0xffff0000, v22
v_lshlrev_b32 v66, 16, v23
v_and_b32 v67, 0xffff0000, v23
v_lshlrev_b32 v68, 16, v24
v_and_b32 v69, 0xffff0000, v24
v_lshlrev_b32 v70, 16, v25
v_and_b32 v71, 0xffff0000, v25
v_lshlrev_b32 v72, 16, v26
v_and_b32 v73, 0xffff0000, v26
v_lshlrev_b32 v74, 16, v27
v_and_b32 v75, 0xffff0000, v27
v_lshlrev_b32 v76, 16, v28
v_and_b32 v77, 0xffff0000, v28
v_lshlrev_b32 v78, 16, v29
v_and_b32 v79, 0xffff0000, v29
v_lshlrev_b32 v80, 16, v30
v_and_b32 v81, 0xffff0000, v30
v_lshlrev_b32 v82, 16, v31
v_and_b32 v83, 0xffff0000, v31
v_lshlrev_b32 v84, 16, v32
v_and_b32 v85, 0xffff0000, v32
v_lshlrev_b32 v86, 16, v33
v_and_b32 v87, 0xffff0000, v33
v_lshlrev_b32 v88, 16, v34
v_and_b32 v89, 0xffff0000, v34
v_lshlrev_b32 v90, 16, v35
v_and_b32 v91, 0xffff0000, v35
v_mov_b32 v6, 0
v_mov_b32 v7, 0
v_mov_b32 v8, 0
v_mov_b32 v9, 0
s_lshl_b32 s62, s42, 2
v_mov_b32 v4, s62
v_mov_b32 v5, 3
buffer_load_dword v37, v36, s[32:35], s84 offen sc1
s_mov_b32 s63, 0
s_waitcnt vmcnt(0)
poll_117:
v_cmp_gt_u32 vcc, 3, v37
s_cbranch_vccz polled_118
buffer_load_dword v37, v36, s[32:35], s84 offen sc1
s_add_u32 s63, s63, 1
s_cmp_lt_u32 s63, 0x80000
s_waitcnt vmcnt(0)
s_cbranch_scc1 poll_117
polled_118:
buffer_load_dwordx4 v[156:159], v38, s[32:35], s57 offen sc1
buffer_load_dwordx4 v[160:163], v39, s[32:35], s57 offen sc1
buffer_load_dwordx4 v[164:167], v38, s[32:35], s57 offen offset:1024 sc1
buffer_load_dwordx4 v[168:171], v39, s[32:35], s57 offen offset:1024 sc1
s_add_u32 s57, s57, 2048
s_and_b32 s57, s57, 0x7fff
buffer_load_dwordx4 v[172:175], v38, s[32:35], s57 offen sc1
buffer_load_dwordx4 v[176:179], v39, s[32:35], s57 offen sc1
buffer_load_dwordx4 v[180:183], v38, s[32:35], s57 offen offset:1024 sc1
buffer_load_dwordx4 v[184:187], v39, s[32:35], s57 offen offset:1024 sc1
s_add_u32 s57, s57, 2048
s_and_b32 s57, s57, 0x7fff
s_waitcnt vmcnt(6) lgkmcnt(8)
v_mfma_f32_16x16x32_bf16 v[60:63], v[220:223], v[156:159], v[60:63]
buffer_load_dwordx4 v[188:191], v38, s[32:35], s57 offen sc1
v_mfma_f32_16x16x32_bf16 v[76:79], v[220:223], v[160:163], v[76:79]
ds_read_b64_tr_b16 v[100:101], v10 offset:8192
ds_read_b64_tr_b16 v[102:103], v10 offset:8704
v_mfma_f32_16x16x32_bf16 v[80:83], v[224:227], v[160:163], v[80:83]
ds_read_b64_tr_b16 v[104:105], v11 offset:8192
ds_read_b64_tr_b16 v[106:107], v11 offset:8704
v_mfma_f32_16x16x32_bf16 v[64:67], v[224:227], v[156:159], v[64:67]
buffer_load_dwordx4 v[192:195], v39, s[32:35], s57 offen sc1
v_mfma_f32_16x16x32_bf16 v[68:71], v[228:231], v[156:159], v[68:71]
ds_read_b64_tr_b16 v[108:109], v12 offset:8192
ds_read_b64_tr_b16 v[110:111], v12 offset:8704
v_mfma_f32_16x16x32_bf16 v[84:87], v[228:231], v[160:163], v[84:87]
ds_read_b64_tr_b16 v[112:113], v13 offset:8192
ds_read_b64_tr_b16 v[114:115], v13 offset:8704
v_mfma_f32_16x16x32_bf16 v[88:91], v[232:235], v[160:163], v[88:91]
v_mfma_f32_16x16x32_bf16 v[72:75], v[232:235], v[156:159], v[72:75]
s_waitcnt vmcnt(6) lgkmcnt(8)
v_mfma_f32_16x16x32_bf16 v[60:63], v[236:239], v[164:167], v[60:63]
buffer_load_dwordx4 v[196:199], v38, s[32:35], s57 offen offset:1024 sc1
v_mfma_f32_16x16x32_bf16 v[76:79], v[236:239], v[168:171], v[76:79]
ds_read_b64_tr_b16 v[220:221], v10 offset:12288
ds_read_b64_tr_b16 v[222:223], v10 offset:12800
v_mfma_f32_16x16x32_bf16 v[80:83], v[240:243], v[168:171], v[80:83]
ds_read_b64_tr_b16 v[224:225], v11 offset:12288
ds_read_b64_tr_b16 v[226:227], v11 offset:12800
v_mfma_f32_16x16x32_bf16 v[64:67], v[240:243], v[164:167], v[64:67]
buffer_load_dwordx4 v[200:203], v39, s[32:35], s57 offen offset:1024 sc1
v_mfma_f32_16x16x32_bf16 v[68:71], v[244:247], v[164:167], v[68:71]
ds_read_b64_tr_b16 v[228:229], v12 offset:12288
ds_read_b64_tr_b16 v[230:231], v12 offset:12800
v_mfma_f32_16x16x32_bf16 v[84:87], v[244:247], v[168:171], v[84:87]
ds_read_b64_tr_b16 v[232:233], v13 offset:12288
ds_read_b64_tr_b16 v[234:235], v13 offset:12800
v_mfma_f32_16x16x32_bf16 v[88:91], v[248:251], v[168:171], v[88:91]
s_add_u32 s57, s57, 2048
s_and_b32 s57, s57, 0x7fff
v_mfma_f32_16x16x32_bf16 v[72:75], v[248:251], v[164:167], v[72:75]
s_waitcnt vmcnt(6) lgkmcnt(8)
v_mfma_f32_16x16x32_bf16 v[60:63], v[100:103], v[172:175], v[60:63]
buffer_load_dwordx4 v[204:207], v38, s[32:35], s57 offen sc1
v_mfma_f32_16x16x32_bf16 v[76:79], v[100:103], v[176:179], v[76:79]
ds_read_b64_tr_b16 v[236:237], v10 offset:16384
ds_read_b64_tr_b16 v[238:239], v10 offset:16896
v_mfma_f32_16x16x32_bf16 v[80:83], v[104:107], v[176:179], v[80:83]
ds_read_b64_tr_b16 v[240:241], v11 offset:16384
ds_read_b64_tr_b16 v[242:243], v11 offset:16896
v_mfma_f32_16x16x32_bf16 v[64:67], v[104:107], v[172:175], v[64:67]
buffer_load_dwordx4 v[208:211], v39, s[32:35], s57 offen sc1
v_mfma_f32_16x16x32_bf16 v[68:71], v[108:111], v[172:175], v[68:71]
ds_read_b64_tr_b16 v[244:245], v12 offset:16384
ds_read_b64_tr_b16 v[246:247], v12 offset:16896
v_mfma_f32_16x16x32_bf16 v[84:87], v[108:111], v[176:179], v[84:87]
ds_read_b64_tr_b16 v[248:249], v13 offset:16384
ds_read_b64_tr_b16 v[250:251], v13 offset:16896
v_mfma_f32_16x16x32_bf16 v[88:91], v[112:115], v[176:179], v[88:91]
v_mfma_f32_16x16x32_bf16 v[72:75], v[112:115], v[172:175], v[72:75]
s_waitcnt vmcnt(6) lgkmcnt(8)
v_mfma_f32_16x16x32_bf16 v[60:63], v[220:223], v[180:183], v[60:63]
buffer_load_dwordx4 v[212:215], v38, s[32:35], s57 offen offset:1024 sc1
v_mfma_f32_16x16x32_bf16 v[76:79], v[220:223], v[184:187], v[76:79]
ds_read_b64_tr_b16 v[100:101], v10 offset:20480
ds_read_b64_tr_b16 v[102:103], v10 offset:20992
v_mfma_f32_16x16x32_bf16 v[80:83], v[224:227], v[184:187], v[80:83]
ds_read_b64_tr_b16 v[104:105], v11 offset:20480
ds_read_b64_tr_b16 v[106:107], v11 offset:20992
v_mfma_f32_16x16x32_bf16 v[64:67], v[224:227], v[180:183], v[64:67]
buffer_load_dwordx4 v[216:219], v39, s[32:35], s57 offen offset:1024 sc1
v_mfma_f32_16x16x32_bf16 v[68:71], v[228:231], v[180:183], v[68:71]
ds_read_b64_tr_b16 v[108:109], v12 offset:20480
ds_read_b64_tr_b16 v[110:111], v12 offset:20992
v_mfma_f32_16x16x32_bf16 v[84:87], v[228:231], v[184:187], v[84:87]
ds_read_b64_tr_b16 v[112:113], v13 offset:20480
ds_read_b64_tr_b16 v[114:115], v13 offset:20992
v_mfma_f32_16x16x32_bf16 v[88:91], v[232:235], v[184:187], v[88:91]
s_add_u32 s57, s57, 2048
s_and_b32 s57, s57, 0x7fff
v_mfma_f32_16x16x32_bf16 v[72:75], v[232:235], v[180:183], v[72:75]
s_waitcnt vmcnt(6) lgkmcnt(8)
v_mfma_f32_16x16x32_bf16 v[60:63], v[236:239], v[188:191], v[60:63]
buffer_load_dwordx4 v[156:159], v38, s[32:35], s57 offen sc1
v_mfma_f32_16x16x32_bf16 v[76:79], v[236:239], v[192:195], v[76:79]
ds_read_b64_tr_b16 v[220:221], v10 offset:24576
ds_read_b64_tr_b16 v[222:223], v10 offset:25088
v_mfma_f32_16x16x32_bf16 v[80:83], v[240:243], v[192:195], v[80:83]
ds_read_b64_tr_b16 v[224:225], v11 offset:24576
ds_read_b64_tr_b16 v[226:227], v11 offset:25088
v_mfma_f32_16x16x32_bf16 v[64:67], v[240:243], v[188:191], v[64:67]
buffer_load_dwordx4 v[160:163], v39, s[32:35], s57 offen sc1
v_mfma_f32_16x16x32_bf16 v[68:71], v[244:247], v[188:191], v[68:71]
ds_read_b64_tr_b16 v[228:229], v12 offset:24576
ds_read_b64_tr_b16 v[230:231], v12 offset:25088
v_mfma_f32_16x16x32_bf16 v[84:87], v[244:247], v[192:195], v[84:87]
ds_read_b64_tr_b16 v[232:233], v13 offset:24576
ds_read_b64_tr_b16 v[234:235], v13 offset:25088
v_mfma_f32_16x16x32_bf16 v[88:91], v[248:251], v[192:195], v[88:91]
v_mfma_f32_16x16x32_bf16 v[72:75], v[248:251], v[188:191], v[72:75]
s_waitcnt vmcnt(6) lgkmcnt(8)
v_mfma_f32_16x16x32_bf16 v[60:63], v[100:103], v[196:199], v[60:63]
buffer_load_dwordx4 v[164:167], v38, s[32:35], s57 offen offset:1024 sc1
v_mfma_f32_16x16x32_bf16 v[76:79], v[100:103], v[200:203], v[76:79]
ds_read_b64_tr_b16 v[236:237], v10 offset:28672
ds_read_b64_tr_b16 v[238:239], v10 offset:29184
v_mfma_f32_16x16x32_bf16 v[80:83], v[104:107], v[200:203], v[80:83]
ds_read_b64_tr_b16 v[240:241], v11 offset:28672
ds_read_b64_tr_b16 v[242:243], v11 offset:29184
v_mfma_f32_16x16x32_bf16 v[64:67], v[104:107], v[196:199], v[64:67]
buffer_load_dwordx4 v[168:171], v39, s[32:35], s57 offen offset:1024 sc1
v_mfma_f32_16x16x32_bf16 v[68:71], v[108:111], v[196:199], v[68:71]
ds_read_b64_tr_b16 v[244:245], v12 offset:28672
ds_read_b64_tr_b16 v[246:247], v12 offset:29184
v_mfma_f32_16x16x32_bf16 v[84:87], v[108:111], v[200:203], v[84:87]
ds_read_b64_tr_b16 v[248:249], v13 offset:28672
ds_read_b64_tr_b16 v[250:251], v13 offset:29184
v_mfma_f32_16x16x32_bf16 v[88:91], v[112:115], v[200:203], v[88:91]
s_add_u32 s57, s57, 2048
s_and_b32 s57, s57, 0x7fff
v_mfma_f32_16x16x32_bf16 v[72:75], v[112:115], v[196:199], v[72:75]
s_waitcnt vmcnt(6) lgkmcnt(8)
v_mfma_f32_16x16x32_bf16 v[60:63], v[220:223], v[204:207], v[60:63]
buffer_load_dwordx4 v[172:175], v38, s[32:35], s57 offen sc1
v_mfma_f32_16x16x32_bf16 v[76:79], v[220:223], v[208:211], v[76:79]
ds_read_b64_tr_b16 v[100:101], v10 offset:32768
ds_read_b64_tr_b16 v[102:103], v10 offset:33280
v_mfma_f32_16x16x32_bf16 v[80:83], v[224:227], v[208:211], v[80:83]
ds_read_b64_tr_b16 v[104:105], v11 offset:32768
ds_read_b64_tr_b16 v[106:107], v11 offset:33280
v_mfma_f32_16x16x32_bf16 v[64:67], v[224:227], v[204:207], v[64:67]
buffer_load_dwordx4 v[176:179], v39, s[32:35], s57 offen sc1
v_mfma_f32_16x16x32_bf16 v[68:71], v[228:231], v[204:207], v[68:71]
ds_read_b64_tr_b16 v[108:109], v12 offset:32768
ds_read_b64_tr_b16 v[110:111], v12 offset:33280
v_mfma_f32_16x16x32_bf16 v[84:87], v[228:231], v[208:211], v[84:87]
ds_read_b64_tr_b16 v[112:113], v13 offset:32768
ds_read_b64_tr_b16 v[114:115], v13 offset:33280
v_mfma_f32_16x16x32_bf16 v[88:91], v[232:235], v[208:211], v[88:91]
v_mfma_f32_16x16x32_bf16 v[72:75], v[232:235], v[204:207], v[72:75]
s_waitcnt vmcnt(6) lgkmcnt(8)
v_mfma_f32_16x16x32_bf16 v[60:63], v[236:239], v[212:215], v[60:63]
buffer_load_dwordx4 v[180:183], v38, s[32:35], s57 offen offset:1024 sc1
v_mfma_f32_16x16x32_bf16 v[76:79], v[236:239], v[216:219], v[76:79]
ds_read_b64_tr_b16 v[220:221], v10 offset:36864
ds_read_b64_tr_b16 v[222:223], v10 offset:37376
v_mfma_f32_16x16x32_bf16 v[80:83], v[240:243], v[216:219], v[80:83]
ds_read_b64_tr_b16 v[224:225], v11 offset:36864
ds_read_b64_tr_b16 v[226:227], v11 offset:37376
v_mfma_f32_16x16x32_bf16 v[64:67], v[240:243], v[212:215], v[64:67]
buffer_load_dwordx4 v[184:187], v39, s[32:35], s57 offen offset:1024 sc1
v_mfma_f32_16x16x32_bf16 v[68:71], v[244:247], v[212:215], v[68:71]
ds_read_b64_tr_b16 v[228:229], v12 offset:36864
ds_read_b64_tr_b16 v[230:231], v12 offset:37376
v_mfma_f32_16x16x32_bf16 v[84:87], v[244:247], v[216:219], v[84:87]
ds_read_b64_tr_b16 v[232:233], v13 offset:36864
ds_read_b64_tr_b16 v[234:235], v13 offset:37376
v_mfma_f32_16x16x32_bf16 v[88:91], v[248:251], v[216:219], v[88:91]
s_add_u32 s57, s57, 2048
s_and_b32 s57, s57, 0x7fff
v_mfma_f32_16x16x32_bf16 v[72:75], v[248:251], v[212:215], v[72:75]
s_waitcnt vmcnt(6) lgkmcnt(8)
v_mfma_f32_16x16x32_bf16 v[60:63], v[100:103], v[156:159], v[60:63]
buffer_load_dwordx4 v[188:191], v38, s[32:35], s57 offen sc1
v_mfma_f32_16x16x32_bf16 v[76:79], v[100:103], v[160:163], v[76:79]
ds_read_b64_tr_b16 v[236:237], v10 offset:40960
ds_read_b64_tr_b16 v[238:239], v10 offset:41472
v_mfma_f32_16x16x32_bf16 v[80:83], v[104:107], v[160:163], v[80:83]
ds_read_b64_tr_b16 v[240:241], v11 offset:40960
ds_read_b64_tr_b16 v[242:243], v11 offset:41472
v_mfma_f32_16x16x32_bf16 v[64:67], v[104:107], v[156:159], v[64:67]
buffer_load_dwordx4 v[192:195], v39, s[32:35], s57 offen sc1
v_mfma_f32_16x16x32_bf16 v[68:71], v[108:111], v[156:159], v[68:71]
ds_read_b64_tr_b16 v[244:245], v12 offset:40960
ds_read_b64_tr_b16 v[246:247], v12 offset:41472
v_mfma_f32_16x16x32_bf16 v[84:87], v[108:111], v[160:163], v[84:87]
ds_read_b64_tr_b16 v[248:249], v13 offset:40960
ds_read_b64_tr_b16 v[250:251], v13 offset:41472
v_mfma_f32_16x16x32_bf16 v[88:91], v[112:115], v[160:163], v[88:91]
v_mfma_f32_16x16x32_bf16 v[72:75], v[112:115], v[156:159], v[72:75]
s_waitcnt vmcnt(6) lgkmcnt(8)
v_mfma_f32_16x16x32_bf16 v[60:63], v[220:223], v[164:167], v[60:63]
buffer_load_dwordx4 v[196:199], v38, s[32:35], s57 offen offset:1024 sc1
v_mfma_f32_16x16x32_bf16 v[76:79], v[220:223], v[168:171], v[76:79]
ds_read_b64_tr_b16 v[100:101], v10 offset:45056
ds_read_b64_tr_b16 v[102:103], v10 offset:45568
v_mfma_f32_16x16x32_bf16 v[80:83], v[224:227], v[168:171], v[80:83]
ds_read_b64_tr_b16 v[104:105], v11 offset:45056
ds_read_b64_tr_b16 v[106:107], v11 offset:45568
v_mfma_f32_16x16x32_bf16 v[64:67], v[224:227], v[164:167], v[64:67]
buffer_load_dwordx4 v[200:203], v39, s[32:35], s57 offen offset:1024 sc1
v_mfma_f32_16x16x32_bf16 v[68:71], v[228:231], v[164:167], v[68:71]
ds_read_b64_tr_b16 v[108:109], v12 offset:45056
ds_read_b64_tr_b16 v[110:111], v12 offset:45568
v_mfma_f32_16x16x32_bf16 v[84:87], v[228:231], v[168:171], v[84:87]
ds_read_b64_tr_b16 v[112:113], v13 offset:45056
ds_read_b64_tr_b16 v[114:115], v13 offset:45568
v_mfma_f32_16x16x32_bf16 v[88:91], v[232:235], v[168:171], v[88:91]
s_add_u32 s57, s57, 2048
s_and_b32 s57, s57, 0x7fff
v_mfma_f32_16x16x32_bf16 v[72:75], v[232:235], v[164:167], v[72:75]
s_waitcnt vmcnt(6) lgkmcnt(8)
v_mfma_f32_16x16x32_bf16 v[60:63], v[236:239], v[172:175], v[60:63]
buffer_load_dwordx4 v[204:207], v38, s[32:35], s57 offen sc1
v_mfma_f32_16x16x32_bf16 v[76:79], v[236:239], v[176:179], v[76:79]
ds_read_b64_tr_b16 v[220:221], v10 offset:49152
ds_read_b64_tr_b16 v[222:223], v10 offset:49664
v_mfma_f32_16x16x32_bf16 v[80:83], v[240:243], v[176:179], v[80:83]
ds_read_b64_tr_b16 v[224:225], v11 offset:49152
ds_read_b64_tr_b16 v[226:227], v11 offset:49664
v_mfma_f32_16x16x32_bf16 v[64:67], v[240:243], v[172:175], v[64:67]
buffer_load_dwordx4 v[208:211], v39, s[32:35], s57 offen sc1
v_mfma_f32_16x16x32_bf16 v[68:71], v[244:247], v[172:175], v[68:71]
ds_read_b64_tr_b16 v[228:229], v12 offset:49152
ds_read_b64_tr_b16 v[230:231], v12 offset:49664
v_mfma_f32_16x16x32_bf16 v[84:87], v[244:247], v[176:179], v[84:87]
ds_read_b64_tr_b16 v[232:233], v13 offset:49152
ds_read_b64_tr_b16 v[234:235], v13 offset:49664
v_mfma_f32_16x16x32_bf16 v[88:91], v[248:251], v[176:179], v[88:91]
v_mfma_f32_16x16x32_bf16 v[72:75], v[248:251], v[172:175], v[72:75]
s_waitcnt vmcnt(6) lgkmcnt(8)
v_mfma_f32_16x16x32_bf16 v[60:63], v[100:103], v[180:183], v[60:63]
buffer_load_dwordx4 v[212:215], v38, s[32:35], s57 offen offset:1024 sc1
v_mfma_f32_16x16x32_bf16 v[76:79], v[100:103], v[184:187], v[76:79]
ds_read_b64_tr_b16 v[236:237], v10 offset:53248
ds_read_b64_tr_b16 v[238:239], v10 offset:53760
v_mfma_f32_16x16x32_bf16 v[80:83], v[104:107], v[184:187], v[80:83]
ds_read_b64_tr_b16 v[240:241], v11 offset:53248
ds_read_b64_tr_b16 v[242:243], v11 offset:53760
v_mfma_f32_16x16x32_bf16 v[64:67], v[104:107], v[180:183], v[64:67]
buffer_load_dwordx4 v[216:219], v39, s[32:35], s57 offen offset:1024 sc1
v_mfma_f32_16x16x32_bf16 v[68:71], v[108:111], v[180:183], v[68:71]
ds_read_b64_tr_b16 v[244:245], v12 offset:53248
ds_read_b64_tr_b16 v[246:247], v12 offset:53760
v_mfma_f32_16x16x32_bf16 v[84:87], v[108:111], v[184:187], v[84:87]
ds_read_b64_tr_b16 v[248:249], v13 offset:53248
ds_read_b64_tr_b16 v[250:251], v13 offset:53760
v_mfma_f32_16x16x32_bf16 v[88:91], v[112:115], v[184:187], v[88:91]
s_add_u32 s57, s57, 2048
s_and_b32 s57, s57, 0x7fff
v_mfma_f32_16x16x32_bf16 v[72:75], v[112:115], v[180:183], v[72:75]
s_waitcnt vmcnt(6) lgkmcnt(8)
v_mfma_f32_16x16x32_bf16 v[60:63], v[220:223], v[188:191], v[60:63]
buffer_load_dwordx4 v[156:159], v38, s[32:35], s57 offen sc1
v_mfma_f32_16x16x32_bf16 v[76:79], v[220:223], v[192:195], v[76:79]
ds_read_b64_tr_b16 v[100:101], v10 offset:57344
ds_read_b64_tr_b16 v[102:103], v10 offset:57856
v_mfma_f32_16x16x32_bf16 v[80:83], v[224:227], v[192:195], v[80:83]
ds_read_b64_tr_b16 v[104:105], v11 offset:57344
ds_read_b64_tr_b16 v[106:107], v11 offset:57856
v_mfma_f32_16x16x32_bf16 v[64:67], v[224:227], v[188:191], v[64:67]
buffer_load_dwordx4 v[160:163], v39, s[32:35], s57 offen sc1
v_mfma_f32_16x16x32_bf16 v[68:71], v[228:231], v[188:191], v[68:71]
ds_read_b64_tr_b16 v[108:109], v12 offset:57344
ds_read_b64_tr_b16 v[110:111], v12 offset:57856
v_mfma_f32_16x16x32_bf16 v[84:87], v[228:231], v[192:195], v[84:87]
ds_read_b64_tr_b16 v[112:113], v13 offset:57344
ds_read_b64_tr_b16 v[114:115], v13 offset:57856
v_mfma_f32_16x16x32_bf16 v[88:91], v[232:235], v[192:195], v[88:91]
v_mfma_f32_16x16x32_bf16 v[72:75], v[232:235], v[188:191], v[72:75]
s_waitcnt vmcnt(6) lgkmcnt(8)
v_mfma_f32_16x16x32_bf16 v[60:63], v[236:239], v[196:199], v[60:63]
buffer_load_dwordx4 v[164:167], v38, s[32:35], s57 offen offset:1024 sc1
v_mfma_f32_16x16x32_bf16 v[76:79], v[236:239], v[200:203], v[76:79]
ds_read_b64_tr_b16 v[220:221], v10 offset:61440
ds_read_b64_tr_b16 v[222:223], v10 offset:61952
v_mfma_f32_16x16x32_bf16 v[80:83], v[240:243], v[200:203], v[80:83]
ds_read_b64_tr_b16 v[224:225], v11 offset:61440
ds_read_b64_tr_b16 v[226:227], v11 offset:61952
v_mfma_f32_16x16x32_bf16 v[64:67], v[240:243], v[196:199], v[64:67]
buffer_load_dwordx4 v[168:171], v39, s[32:35], s57 offen offset:1024 sc1
v_mfma_f32_16x16x32_bf16 v[68:71], v[244:247], v[196:199], v[68:71]
ds_read_b64_tr_b16 v[228:229], v12 offset:61440
ds_read_b64_tr_b16 v[230:231], v12 offset:61952
v_mfma_f32_16x16x32_bf16 v[84:87], v[244:247], v[200:203], v[84:87]
ds_read_b64_tr_b16 v[232:233], v13 offset:61440
ds_read_b64_tr_b16 v[234:235], v13 offset:61952
v_mfma_f32_16x16x32_bf16 v[88:91], v[248:251], v[200:203], v[88:91]
s_add_u32 s57, s57, 2048
s_and_b32 s57, s57, 0x7fff
v_mfma_f32_16x16x32_bf16 v[72:75], v[248:251], v[196:199], v[72:75]
s_waitcnt vmcnt(6) lgkmcnt(8)
v_mfma_f32_16x16x32_bf16 v[60:63], v[100:103], v[204:207], v[60:63]
buffer_load_dwordx4 v[172:175], v38, s[32:35], s57 offen sc1
v_mfma_f32_16x16x32_bf16 v[76:79], v[100:103], v[208:211], v[76:79]
ds_read_b64_tr_b16 v[236:237], v14 offset:0
ds_read_b64_tr_b16 v[238:239], v14 offset:512
v_mfma_f32_16x16x32_bf16 v[80:83], v[104:107], v[208:211], v[80:83]
ds_read_b64_tr_b16 v[240:241], v15 offset:0
ds_read_b64_tr_b16 v[242:243], v15 offset:512
v_mfma_f32_16x16x32_bf16 v[64:67], v[104:107], v[204:207], v[64:67]
buffer_load_dwordx4 v[176:179], v39, s[32:35], s57 offen sc1
v_mfma_f32_16x16x32_bf16 v[68:71], v[108:111], v[204:207], v[68:71]
ds_read_b64_tr_b16 v[244:245], v16 offset:0
ds_read_b64_tr_b16 v[246:247], v16 offset:512
v_mfma_f32_16x16x32_bf16 v[84:87], v[108:111], v[208:211], v[84:87]
ds_read_b64_tr_b16 v[248:249], v17 offset:0
ds_read_b64_tr_b16 v[250:251], v17 offset:512
v_mfma_f32_16x16x32_bf16 v[88:91], v[112:115], v[208:211], v[88:91]
v_mfma_f32_16x16x32_bf16 v[72:75], v[112:115], v[204:207], v[72:75]
s_waitcnt vmcnt(6) lgkmcnt(8)
v_mfma_f32_16x16x32_bf16 v[60:63], v[220:223], v[212:215], v[60:63]
buffer_load_dwordx4 v[180:183], v38, s[32:35], s57 offen offset:1024 sc1
v_mfma_f32_16x16x32_bf16 v[76:79], v[220:223], v[216:219], v[76:79]
ds_read_b64_tr_b16 v[100:101], v14 offset:4096
ds_read_b64_tr_b16 v[102:103], v14 offset:4608
v_mfma_f32_16x16x32_bf16 v[80:83], v[224:227], v[216:219], v[80:83]
ds_read_b64_tr_b16 v[104:105], v15 offset:4096
ds_read_b64_tr_b16 v[106:107], v15 offset:4608
v_mfma_f32_16x16x32_bf16 v[64:67], v[224:227], v[212:215], v[64:67]
buffer_load_dwordx4 v[184:187], v39, s[32:35], s57 offen offset:1024 sc1
v_mfma_f32_16x16x32_bf16 v[68:71], v[228:231], v[212:215], v[68:71]
ds_read_b64_tr_b16 v[108:109], v16 offset:4096
ds_read_b64_tr_b16 v[110:111], v16 offset:4608
v_mfma_f32_16x16x32_bf16 v[84:87], v[228:231], v[216:219], v[84:87]
ds_read_b64_tr_b16 v[112:113], v17 offset:4096
ds_read_b64_tr_b16 v[114:115], v17 offset:4608
v_mfma_f32_16x16x32_bf16 v[88:91], v[232:235], v[216:219], v[88:91]
s_add_u32 s57, s57, 2048
s_and_b32 s57, s57, 0x7fff
v_mfma_f32_16x16x32_bf16 v[72:75], v[232:235], v[212:215], v[72:75]
s_waitcnt vmcnt(6) lgkmcnt(8)
v_mfma_f32_16x16x32_bf16 v[60:63], v[236:239], v[156:159], v[60:63]
buffer_load_dwordx4 v[188:191], v38, s[32:35], s57 offen sc1
v_mfma_f32_16x16x32_bf16 v[76:79], v[236:239], v[160:163], v[76:79]
ds_read_b64_tr_b16 v[220:221], v14 offset:8192
ds_read_b64_tr_b16 v[222:223], v14 offset:8704
v_mfma_f32_16x16x32_bf16 v[80:83], v[240:243], v[160:163], v[80:83]
ds_read_b64_tr_b16 v[224:225], v15 offset:8192
ds_read_b64_tr_b16 v[226:227], v15 offset:8704
v_mfma_f32_16x16x32_bf16 v[64:67], v[240:243], v[156:159], v[64:67]
buffer_load_dwordx4 v[192:195], v39, s[32:35], s57 offen sc1
v_mfma_f32_16x16x32_bf16 v[68:71], v[244:247], v[156:159], v[68:71]
ds_read_b64_tr_b16 v[228:229], v16 offset:8192
ds_read_b64_tr_b16 v[230:231], v16 offset:8704
v_mfma_f32_16x16x32_bf16 v[84:87], v[244:247], v[160:163], v[84:87]
ds_read_b64_tr_b16 v[232:233], v17 offset:8192
ds_read_b64_tr_b16 v[234:235], v17 offset:8704
v_mfma_f32_16x16x32_bf16 v[88:91], v[248:251], v[160:163], v[88:91]
v_mfma_f32_16x16x32_bf16 v[72:75], v[248:251], v[156:159], v[72:75]
s_waitcnt vmcnt(6) lgkmcnt(8)
v_mfma_f32_16x16x32_bf16 v[60:63], v[100:103], v[164:167], v[60:63]
buffer_load_dwordx4 v[196:199], v38, s[32:35], s57 offen offset:1024 sc1
v_mfma_f32_16x16x32_bf16 v[76:79], v[100:103], v[168:171], v[76:79]
ds_read_b64_tr_b16 v[236:237], v14 offset:12288
ds_read_b64_tr_b16 v[238:239], v14 offset:12800
v_mfma_f32_16x16x32_bf16 v[80:83], v[104:107], v[168:171], v[80:83]
ds_read_b64_tr_b16 v[240:241], v15 offset:12288
ds_read_b64_tr_b16 v[242:243], v15 offset:12800
v_mfma_f32_16x16x32_bf16 v[64:67], v[104:107], v[164:167], v[64:67]
buffer_load_dwordx4 v[200:203], v39, s[32:35], s57 offen offset:1024 sc1
v_mfma_f32_16x16x32_bf16 v[68:71], v[108:111], v[164:167], v[68:71]
ds_read_b64_tr_b16 v[244:245], v16 offset:12288
ds_read_b64_tr_b16 v[246:247], v16 offset:12800
v_mfma_f32_16x16x32_bf16 v[84:87], v[108:111], v[168:171], v[84:87]
ds_read_b64_tr_b16 v[248:249], v17 offset:12288
ds_read_b64_tr_b16 v[250:251], v17 offset:12800
v_mfma_f32_16x16x32_bf16 v[88:91], v[112:115], v[168:171], v[88:91]
s_add_u32 s57, s57, 2048
s_and_b32 s57, s57, 0x7fff
v_mfma_f32_16x16x32_bf16 v[72:75], v[112:115], v[164:167], v[72:75]
s_waitcnt vmcnt(6) lgkmcnt(8)
v_mfma_f32_16x16x32_bf16 v[60:63], v[220:223], v[172:175], v[60:63]
buffer_load_dwordx4 v[204:207], v38, s[32:35], s57 offen sc1
v_mfma_f32_16x16x32_bf16 v[76:79], v[220:223], v[176:179], v[76:79]
ds_read_b64_tr_b16 v[100:101], v14 offset:16384
ds_read_b64_tr_b16 v[102:103], v14 offset:16896
v_mfma_f32_16x16x32_bf16 v[80:83], v[224:227], v[176:179], v[80:83]
ds_read_b64_tr_b16 v[104:105], v15 offset:16384
ds_read_b64_tr_b16 v[106:107], v15 offset:16896
v_mfma_f32_16x16x32_bf16 v[64:67], v[224:227], v[172:175], v[64:67]
buffer_load_dwordx4 v[208:211], v39, s[32:35], s57 offen sc1
v_mfma_f32_16x16x32_bf16 v[68:71], v[228:231], v[172:175], v[68:71]
ds_read_b64_tr_b16 v[108:109], v16 offset:16384
ds_read_b64_tr_b16 v[110:111], v16 offset:16896
v_mfma_f32_16x16x32_bf16 v[84:87], v[228:231], v[176:179], v[84:87]
ds_read_b64_tr_b16 v[112:113], v17 offset:16384
ds_read_b64_tr_b16 v[114:115], v17 offset:16896
v_mfma_f32_16x16x32_bf16 v[88:91], v[232:235], v[176:179], v[88:91]
v_mfma_f32_16x16x32_bf16 v[72:75], v[232:235], v[172:175], v[72:75]
s_waitcnt vmcnt(6) lgkmcnt(8)
v_mfma_f32_16x16x32_bf16 v[60:63], v[236:239], v[180:183], v[60:63]
buffer_load_dwordx4 v[212:215], v38, s[32:35], s57 offen offset:1024 sc1
v_mfma_f32_16x16x32_bf16 v[76:79], v[236:239], v[184:187], v[76:79]
ds_read_b64_tr_b16 v[220:221], v14 offset:20480
ds_read_b64_tr_b16 v[222:223], v14 offset:20992
v_mfma_f32_16x16x32_bf16 v[80:83], v[240:243], v[184:187], v[80:83]
ds_read_b64_tr_b16 v[224:225], v15 offset:20480
ds_read_b64_tr_b16 v[226:227], v15 offset:20992
v_mfma_f32_16x16x32_bf16 v[64:67], v[240:243], v[180:183], v[64:67]
buffer_load_dwordx4 v[216:219], v39, s[32:35], s57 offen offset:1024 sc1
v_mfma_f32_16x16x32_bf16 v[68:71], v[244:247], v[180:183], v[68:71]
ds_read_b64_tr_b16 v[228:229], v16 offset:20480
ds_read_b64_tr_b16 v[230:231], v16 offset:20992
v_mfma_f32_16x16x32_bf16 v[84:87], v[244:247], v[184:187], v[84:87]
ds_read_b64_tr_b16 v[232:233], v17 offset:20480
ds_read_b64_tr_b16 v[234:235], v17 offset:20992
v_mfma_f32_16x16x32_bf16 v[88:91], v[248:251], v[184:187], v[88:91]
s_add_u32 s57, s57, 2048
s_and_b32 s57, s57, 0x7fff
v_mfma_f32_16x16x32_bf16 v[72:75], v[248:251], v[180:183], v[72:75]
s_waitcnt vmcnt(6) lgkmcnt(8)
v_mfma_f32_16x16x32_bf16 v[60:63], v[100:103], v[188:191], v[60:63]
buffer_load_dwordx4 v[156:159], v38, s[32:35], s57 offen sc1
v_mfma_f32_16x16x32_bf16 v[76:79], v[100:103], v[192:195], v[76:79]
ds_read_b64_tr_b16 v[236:237], v14 offset:24576
ds_read_b64_tr_b16 v[238:239], v14 offset:25088
v_mfma_f32_16x16x32_bf16 v[80:83], v[104:107], v[192:195], v[80:83]
ds_read_b64_tr_b16 v[240:241], v15 offset:24576
ds_read_b64_tr_b16 v[242:243], v15 offset:25088
v_mfma_f32_16x16x32_bf16 v[64:67], v[104:107], v[188:191], v[64:67]
buffer_load_dwordx4 v[160:163], v39, s[32:35], s57 offen sc1
v_mfma_f32_16x16x32_bf16 v[68:71], v[108:111], v[188:191], v[68:71]
ds_read_b64_tr_b16 v[244:245], v16 offset:24576
ds_read_b64_tr_b16 v[246:247], v16 offset:25088
v_mfma_f32_16x16x32_bf16 v[84:87], v[108:111], v[192:195], v[84:87]
ds_read_b64_tr_b16 v[248:249], v17 offset:24576
ds_read_b64_tr_b16 v[250:251], v17 offset:25088
v_mfma_f32_16x16x32_bf16 v[88:91], v[112:115], v[192:195], v[88:91]
v_mfma_f32_16x16x32_bf16 v[72:75], v[112:115], v[188:191], v[72:75]
s_waitcnt vmcnt(6) lgkmcnt(8)
v_mfma_f32_16x16x32_bf16 v[60:63], v[220:223], v[196:199], v[60:63]
buffer_load_dwordx4 v[164:167], v38, s[32:35], s57 offen offset:1024 sc1
v_mfma_f32_16x16x32_bf16 v[76:79], v[220:223], v[200:203], v[76:79]
ds_read_b64_tr_b16 v[100:101], v14 offset:28672
ds_read_b64_tr_b16 v[102:103], v14 offset:29184
v_mfma_f32_16x16x32_bf16 v[80:83], v[224:227], v[200:203], v[80:83]
ds_read_b64_tr_b16 v[104:105], v15 offset:28672
ds_read_b64_tr_b16 v[106:107], v15 offset:29184
v_mfma_f32_16x16x32_bf16 v[64:67], v[224:227], v[196:199], v[64:67]
buffer_load_dwordx4 v[168:171], v39, s[32:35], s57 offen offset:1024 sc1
v_mfma_f32_16x16x32_bf16 v[68:71], v[228:231], v[196:199], v[68:71]
ds_read_b64_tr_b16 v[108:109], v16 offset:28672
ds_read_b64_tr_b16 v[110:111], v16 offset:29184
v_mfma_f32_16x16x32_bf16 v[84:87], v[228:231], v[200:203], v[84:87]
ds_read_b64_tr_b16 v[112:113], v17 offset:28672
ds_read_b64_tr_b16 v[114:115], v17 offset:29184
v_mfma_f32_16x16x32_bf16 v[88:91], v[232:235], v[200:203], v[88:91]
s_add_u32 s57, s57, 2048
s_and_b32 s57, s57, 0x7fff
v_mfma_f32_16x16x32_bf16 v[72:75], v[232:235], v[196:199], v[72:75]
s_waitcnt vmcnt(6) lgkmcnt(8)
v_mfma_f32_16x16x32_bf16 v[60:63], v[236:239], v[204:207], v[60:63]
buffer_load_dwordx4 v[172:175], v38, s[32:35], s57 offen sc1
v_mfma_f32_16x16x32_bf16 v[76:79], v[236:239], v[208:211], v[76:79]
ds_read_b64_tr_b16 v[220:221], v14 offset:32768
ds_read_b64_tr_b16 v[222:223], v14 offset:33280
v_mfma_f32_16x16x32_bf16 v[80:83], v[240:243], v[208:211], v[80:83]
ds_read_b64_tr_b16 v[224:225], v15 offset:32768
ds_read_b64_tr_b16 v[226:227], v15 offset:33280
v_mfma_f32_16x16x32_bf16 v[64:67], v[240:243], v[204:207], v[64:67]
buffer_load_dwordx4 v[176:179], v39, s[32:35], s57 offen sc1
v_mfma_f32_16x16x32_bf16 v[68:71], v[244:247], v[204:207], v[68:71]
ds_read_b64_tr_b16 v[228:229], v16 offset:32768
ds_read_b64_tr_b16 v[230:231], v16 offset:33280
v_mfma_f32_16x16x32_bf16 v[84:87], v[244:247], v[208:211], v[84:87]
ds_read_b64_tr_b16 v[232:233], v17 offset:32768
ds_read_b64_tr_b16 v[234:235], v17 offset:33280
v_mfma_f32_16x16x32_bf16 v[88:91], v[248:251], v[208:211], v[88:91]
v_mfma_f32_16x16x32_bf16 v[72:75], v[248:251], v[204:207], v[72:75]
s_waitcnt vmcnt(6) lgkmcnt(8)
v_mfma_f32_16x16x32_bf16 v[60:63], v[100:103], v[212:215], v[60:63]
buffer_load_dwordx4 v[180:183], v38, s[32:35], s57 offen offset:1024 sc1
v_mfma_f32_16x16x32_bf16 v[76:79], v[100:103], v[216:219], v[76:79]
ds_read_b64_tr_b16 v[236:237], v14 offset:36864
ds_read_b64_tr_b16 v[238:239], v14 offset:37376
v_mfma_f32_16x16x32_bf16 v[80:83], v[104:107], v[216:219], v[80:83]
ds_read_b64_tr_b16 v[240:241], v15 offset:36864
ds_read_b64_tr_b16 v[242:243], v15 offset:37376
v_mfma_f32_16x16x32_bf16 v[64:67], v[104:107], v[212:215], v[64:67]
buffer_load_dwordx4 v[184:187], v39, s[32:35], s57 offen offset:1024 sc1
v_mfma_f32_16x16x32_bf16 v[68:71], v[108:111], v[212:215], v[68:71]
ds_read_b64_tr_b16 v[244:245], v16 offset:36864
ds_read_b64_tr_b16 v[246:247], v16 offset:37376
v_mfma_f32_16x16x32_bf16 v[84:87], v[108:111], v[216:219], v[84:87]
ds_read_b64_tr_b16 v[248:249], v17 offset:36864
ds_read_b64_tr_b16 v[250:251], v17 offset:37376
v_mfma_f32_16x16x32_bf16 v[88:91], v[112:115], v[216:219], v[88:91]
s_add_u32 s57, s57, 2048
s_and_b32 s57, s57, 0x7fff
v_mfma_f32_16x16x32_bf16 v[72:75], v[112:115], v[212:215], v[72:75]
s_waitcnt vmcnt(6) lgkmcnt(8)
v_mfma_f32_16x16x32_bf16 v[60:63], v[220:223], v[156:159], v[60:63]
buffer_load_dwordx4 v[188:191], v38, s[32:35], s57 offen sc1
v_mfma_f32_16x16x32_bf16 v[76:79], v[220:223], v[160:163], v[76:79]
ds_read_b64_tr_b16 v[100:101], v14 offset:40960
ds_read_b64_tr_b16 v[102:103], v14 offset:41472
v_mfma_f32_16x16x32_bf16 v[80:83], v[224:227], v[160:163], v[80:83]
ds_read_b64_tr_b16 v[104:105], v15 offset:40960
ds_read_b64_tr_b16 v[106:107], v15 offset:41472
v_mfma_f32_16x16x32_bf16 v[64:67], v[224:227], v[156:159], v[64:67]
buffer_load_dwordx4 v[192:195], v39, s[32:35], s57 offen sc1
v_mfma_f32_16x16x32_bf16 v[68:71], v[228:231], v[156:159], v[68:71]
ds_read_b64_tr_b16 v[108:109], v16 offset:40960
ds_read_b64_tr_b16 v[110:111], v16 offset:41472
v_mfma_f32_16x16x32_bf16 v[84:87], v[228:231], v[160:163], v[84:87]
ds_read_b64_tr_b16 v[112:113], v17 offset:40960
ds_read_b64_tr_b16 v[114:115], v17 offset:41472
v_mfma_f32_16x16x32_bf16 v[88:91], v[232:235], v[160:163], v[88:91]
v_mfma_f32_16x16x32_bf16 v[72:75], v[232:235], v[156:159], v[72:75]
s_waitcnt vmcnt(6) lgkmcnt(8)
v_mfma_f32_16x16x32_bf16 v[60:63], v[236:239], v[164:167], v[60:63]
buffer_load_dwordx4 v[196:199], v38, s[32:35], s57 offen offset:1024 sc1
v_mfma_f32_16x16x32_bf16 v[76:79], v[236:239], v[168:171], v[76:79]
ds_read_b64_tr_b16 v[220:221], v14 offset:45056
ds_read_b64_tr_b16 v[222:223], v14 offset:45568
v_mfma_f32_16x16x32_bf16 v[80:83], v[240:243], v[168:171], v[80:83]
ds_read_b64_tr_b16 v[224:225], v15 offset:45056
ds_read_b64_tr_b16 v[226:227], v15 offset:45568
v_mfma_f32_16x16x32_bf16 v[64:67], v[240:243], v[164:167], v[64:67]
buffer_load_dwordx4 v[200:203], v39, s[32:35], s57 offen offset:1024 sc1
v_mfma_f32_16x16x32_bf16 v[68:71], v[244:247], v[164:167], v[68:71]
ds_read_b64_tr_b16 v[228:229], v16 offset:45056
ds_read_b64_tr_b16 v[230:231], v16 offset:45568
v_mfma_f32_16x16x32_bf16 v[84:87], v[244:247], v[168:171], v[84:87]
ds_read_b64_tr_b16 v[232:233], v17 offset:45056
ds_read_b64_tr_b16 v[234:235], v17 offset:45568
v_mfma_f32_16x16x32_bf16 v[88:91], v[248:251], v[168:171], v[88:91]
s_add_u32 s57, s57, 2048
s_and_b32 s57, s57, 0x7fff
v_mfma_f32_16x16x32_bf16 v[72:75], v[248:251], v[164:167], v[72:75]
s_waitcnt vmcnt(6) lgkmcnt(8)
v_mfma_f32_16x16x32_bf16 v[60:63], v[100:103], v[172:175], v[60:63]
buffer_load_dwordx4 v[204:207], v38, s[32:35], s57 offen sc1
v_mfma_f32_16x16x32_bf16 v[76:79], v[100:103], v[176:179], v[76:79]
ds_read_b64_tr_b16 v[236:237], v14 offset:49152
ds_read_b64_tr_b16 v[238:239], v14 offset:49664
v_mfma_f32_16x16x32_bf16 v[80:83], v[104:107], v[176:179], v[80:83]
ds_read_b64_tr_b16 v[240:241], v15 offset:49152
ds_read_b64_tr_b16 v[242:243], v15 offset:49664
v_mfma_f32_16x16x32_bf16 v[64:67], v[104:107], v[172:175], v[64:67]
buffer_load_dwordx4 v[208:211], v39, s[32:35], s57 offen sc1
v_mfma_f32_16x16x32_bf16 v[68:71], v[108:111], v[172:175], v[68:71]
ds_read_b64_tr_b16 v[244:245], v16 offset:49152
ds_read_b64_tr_b16 v[246:247], v16 offset:49664
v_mfma_f32_16x16x32_bf16 v[84:87], v[108:111], v[176:179], v[84:87]
ds_read_b64_tr_b16 v[248:249], v17 offset:49152
ds_read_b64_tr_b16 v[250:251], v17 offset:49664
v_mfma_f32_16x16x32_bf16 v[88:91], v[112:115], v[176:179], v[88:91]
v_mfma_f32_16x16x32_bf16 v[72:75], v[112:115], v[172:175], v[72:75]
s_waitcnt vmcnt(6) lgkmcnt(8)
v_mfma_f32_16x16x32_bf16 v[60:63], v[220:223], v[180:183], v[60:63]
buffer_load_dwordx4 v[212:215], v38, s[32:35], s57 offen offset:1024 sc1
v_mfma_f32_16x16x32_bf16 v[76:79], v[220:223], v[184:187], v[76:79]
ds_read_b64_tr_b16 v[100:101], v14 offset:53248
ds_read_b64_tr_b16 v[102:103], v14 offset:53760
v_mfma_f32_16x16x32_bf16 v[80:83], v[224:227], v[184:187], v[80:83]
ds_read_b64_tr_b16 v[104:105], v15 offset:53248
ds_read_b64_tr_b16 v[106:107], v15 offset:53760
v_mfma_f32_16x16x32_bf16 v[64:67], v[224:227], v[180:183], v[64:67]
buffer_load_dwordx4 v[216:219], v39, s[32:35], s57 offen offset:1024 sc1
v_mfma_f32_16x16x32_bf16 v[68:71], v[228:231], v[180:183], v[68:71]
ds_read_b64_tr_b16 v[108:109], v16 offset:53248
ds_read_b64_tr_b16 v[110:111], v16 offset:53760
v_mfma_f32_16x16x32_bf16 v[84:87], v[228:231], v[184:187], v[84:87]
ds_read_b64_tr_b16 v[112:113], v17 offset:53248
ds_read_b64_tr_b16 v[114:115], v17 offset:53760
v_mfma_f32_16x16x32_bf16 v[88:91], v[232:235], v[184:187], v[88:91]
v_mfma_f32_16x16x32_bf16 v[72:75], v[232:235], v[180:183], v[72:75]
s_waitcnt vmcnt(6) lgkmcnt(8)
v_mfma_f32_16x16x32_bf16 v[60:63], v[236:239], v[188:191], v[60:63]
v_mfma_f32_16x16x32_bf16 v[76:79], v[236:239], v[192:195], v[76:79]
ds_read_b64_tr_b16 v[220:221], v14 offset:57344
ds_read_b64_tr_b16 v[222:223], v14 offset:57856
v_mfma_f32_16x16x32_bf16 v[80:83], v[240:243], v[192:195], v[80:83]
ds_read_b64_tr_b16 v[224:225], v15 offset:57344
ds_read_b64_tr_b16 v[226:227], v15 offset:57856
v_mfma_f32_16x16x32_bf16 v[64:67], v[240:243], v[188:191], v[64:67]
v_mfma_f32_16x16x32_bf16 v[68:71], v[244:247], v[188:191], v[68:71]
ds_read_b64_tr_b16 v[228:229], v16 offset:57344
ds_read_b64_tr_b16 v[230:231], v16 offset:57856
v_mfma_f32_16x16x32_bf16 v[84:87], v[244:247], v[192:195], v[84:87]
ds_read_b64_tr_b16 v[232:233], v17 offset:57344
ds_read_b64_tr_b16 v[234:235], v17 offset:57856
v_mfma_f32_16x16x32_bf16 v[88:91], v[248:251], v[192:195], v[88:91]
v_mfma_f32_16x16x32_bf16 v[72:75], v[248:251], v[188:191], v[72:75]
s_waitcnt vmcnt(4) lgkmcnt(8)
v_mfma_f32_16x16x32_bf16 v[60:63], v[100:103], v[196:199], v[60:63]
v_mfma_f32_16x16x32_bf16 v[76:79], v[100:103], v[200:203], v[76:79]
ds_read_b64_tr_b16 v[236:237], v14 offset:61440
ds_read_b64_tr_b16 v[238:239], v14 offset:61952
v_mfma_f32_16x16x32_bf16 v[80:83], v[104:107], v[200:203], v[80:83]
ds_read_b64_tr_b16 v[240:241], v15 offset:61440
ds_read_b64_tr_b16 v[242:243], v15 offset:61952
v_mfma_f32_16x16x32_bf16 v[64:67], v[104:107], v[196:199], v[64:67]
v_mfma_f32_16x16x32_bf16 v[68:71], v[108:111], v[196:199], v[68:71]
ds_read_b64_tr_b16 v[244:245], v16 offset:61440
ds_read_b64_tr_b16 v[246:247], v16 offset:61952
v_mfma_f32_16x16x32_bf16 v[84:87], v[108:111], v[200:203], v[84:87]
ds_read_b64_tr_b16 v[248:249], v17 offset:61440
ds_read_b64_tr_b16 v[250:251], v17 offset:61952
v_mfma_f32_16x16x32_bf16 v[88:91], v[112:115], v[200:203], v[88:91]
v_mfma_f32_16x16x32_bf16 v[72:75], v[112:115], v[196:199], v[72:75]
s_waitcnt vmcnt(2) lgkmcnt(8)
v_mfma_f32_16x16x32_bf16 v[60:63], v[220:223], v[204:207], v[60:63]
v_mfma_f32_16x16x32_bf16 v[76:79], v[220:223], v[208:211], v[76:79]
v_mfma_f32_16x16x32_bf16 v[80:83], v[224:227], v[208:211], v[80:83]
v_mfma_f32_16x16x32_bf16 v[64:67], v[224:227], v[204:207], v[64:67]
v_mfma_f32_16x16x32_bf16 v[68:71], v[228:231], v[204:207], v[68:71]
v_mfma_f32_16x16x32_bf16 v[84:87], v[228:231], v[208:211], v[84:87]
v_mfma_f32_16x16x32_bf16 v[88:91], v[232:235], v[208:211], v[88:91]
v_mfma_f32_16x16x32_bf16 v[72:75], v[232:235], v[204:207], v[72:75]
s_waitcnt vmcnt(0) lgkmcnt(0)
v_mfma_f32_16x16x32_bf16 v[60:63], v[236:239], v[212:215], v[60:63]
v_mfma_f32_16x16x32_bf16 v[64:67], v[240:243], v[212:215], v[64:67]
v_mfma_f32_16x16x32_bf16 v[68:71], v[244:247], v[212:215], v[68:71]
v_mfma_f32_16x16x32_bf16 v[72:75], v[248:251], v[212:215], v[72:75]
v_mfma_f32_16x16x32_bf16 v[76:79], v[236:239], v[216:219], v[76:79]
v_mfma_f32_16x16x32_bf16 v[80:83], v[240:243], v[216:219], v[80:83]
v_mfma_f32_16x16x32_bf16 v[84:87], v[244:247], v[216:219], v[84:87]
v_mfma_f32_16x16x32_bf16 v[88:91], v[248:251], v[216:219], v[88:91]
s_cmp_eq_u32 s46, 0
s_cbranch_scc1 slow_119
s_nop 0
v_cvt_pk_bf16_f32 v20, v60, v61
v_cvt_pk_bf16_f32 v21, v62, v63
v_cvt_pk_bf16_f32 v22, v64, v65
v_cvt_pk_bf16_f32 v23, v66, v67
buffer_store_dwordx4 v[20:23], v18, s[32:35], s85 offen offset:0
v_cvt_pk_bf16_f32 v24, v68, v69
v_cvt_pk_bf16_f32 v25, v70, v71
v_cvt_pk_bf16_f32 v26, v72, v73
v_cvt_pk_bf16_f32 v27, v74, v75
buffer_store_dwordx4 v[24:27], v18, s[32:35], s85 offen offset:1024
v_cvt_pk_bf16_f32 v28, v76, v77
v_cvt_pk_bf16_f32 v29, v78, v79
v_cvt_pk_bf16_f32 v30, v80, v81
v_cvt_pk_bf16_f32 v31, v82, v83
buffer_store_dwordx4 v[28:31], v18, s[32:35], s86 offen offset:0
v_cvt_pk_bf16_f32 v32, v84, v85
v_cvt_pk_bf16_f32 v33, v86, v87
v_cvt_pk_bf16_f32 v34, v88, v89
v_cvt_pk_bf16_f32 v35, v90, v91
buffer_store_dwordx4 v[32:35], v18, s[32:35], s86 offen offset:1024
s_barrier
v_dot2c_f32_bf16 v6, v20, v48
v_dot2c_f32_bf16 v8, v20, v20
v_dot2c_f32_bf16 v7, v28, v48
v_dot2c_f32_bf16 v9, v28, v28
v_dot2c_f32_bf16 v6, v21, v48
v_dot2c_f32_bf16 v8, v21, v21
v_dot2c_f32_bf16 v7, v29, v48
v_dot2c_f32_bf16 v9, v29, v29
v_dot2c_f32_bf16 v6, v22, v48
v_dot2c_f32_bf16 v8, v22, v22
v_dot2c_f32_bf16 v7, v30, v48
v_dot2c_f32_bf16 v9, v30, v30
v_dot2c_f32_bf16 v6, v23, v48
v_dot2c_f32_bf16 v8, v23, v23
v_dot2c_f32_bf16 v7, v31, v48
v_dot2c_f32_bf16 v9, v31, v31
v_dot2c_f32_bf16 v6, v24, v48
v_dot2c_f32_bf16 v8, v24, v24
v_dot2c_f32_bf16 v7, v32, v48
v_dot2c_f32_bf16 v9, v32, v32
v_dot2c_f32_bf16 v6, v25, v48
v_dot2c_f32_bf16 v8, v25, v25
v_dot2c_f32_bf16 v7, v33, v48
v_dot2c_f32_bf16 v9, v33, v33
v_dot2c_f32_bf16 v6, v26, v48
v_dot2c_f32_bf16 v8, v26, v26
v_dot2c_f32_bf16 v7, v34, v48
v_dot2c_f32_bf16 v9, v34, v34
v_dot2c_f32_bf16 v6, v27, v48
v_dot2c_f32_bf16 v8, v27, v27
v_dot2c_f32_bf16 v7, v35, v48
v_dot2c_f32_bf16 v9, v35, v35
s_mov_b64 exec, 1
s_waitcnt vmcnt(0)
buffer_store_dword v5, v4, s[32:35], s88 offen
s_mov_b64 exec, -1
s_nop 1
v_permlane32_swap_b32 v6, v7
v_permlane32_swap_b32 v8, v9
v_add_f32 v6, v6, v7
v_add_f32 v8, v8, v9
s_nop 1
v_permlane16_swap_b32 v6, v8
s_nop 0
v_add_f32 v6, v6, v8
buffer_store_dword v6, v1, s[32:35], s87 offen
back_120:
s_lshl_b32 s49, s44, 13
v_add_u32 v10, s49, v18
v_add_u32 v11, 1024, v10
s_lshl_b32 s48, s43, 1
v_lshrrev_b32 v4, 2, v2
v_and_b32 v5, 3, v0
v_lshl_add_u32 v6, v3, 3, v4
v_lshlrev_b32 v6, 7, v6
v_lshl_add_u32 v6, v5, 3, v6
v_lshrrev_b32 v7, 1, v4
v_and_b32 v8, 1, v3
v_lshl_add_u32 v7, v8, 1, v7
v_xor_b32 v7, s48, v7
v_lshl_add_u32 v12, v7, 5, v6
v_add_u32 v12, 16384, v12
v_xor_b32 v13, 32, v12
v_mov_b32 v14, v10
v_mov_b32 v15, v11
v_add_u32 v16, 122880, v12
v_add_u32 v17, 122880, v13
v_mov_b32 v156, 0
v_mov_b32 v157, 0
v_mov_b32 v158, 0
v_mov_b32 v159, 0
v_mov_b32 v160, 0
v_mov_b32 v161, 0
v_mov_b32 v162, 0
v_mov_b32 v163, 0
v_mov_b32 v164, 0
v_mov_b32 v165, 0
v_mov_b32 v166, 0
v_mov_b32 v167, 0
v_mov_b32 v168, 0
v_mov_b32 v169, 0
v_mov_b32 v170, 0
v_mov_b32 v171, 0
v_mov_b32 v172, 0
v_mov_b32 v173, 0
v_mov_b32 v174, 0
v_mov_b32 v175, 0
v_mov_b32 v176, 0
v_mov_b32 v177, 0
v_mov_b32 v178, 0
v_mov_b32 v179, 0
v_mov_b32 v180, 0
v_mov_b32 v181, 0
v_mov_b32 v182, 0
v_mov_b32 v183, 0
v_mov_b32 v184, 0
v_mov_b32 v185, 0
v_mov_b32 v186, 0
v_mov_b32 v187, 0
v_mov_b32 v188, 0
v_mov_b32 v189, 0
v_mov_b32 v190, 0
v_mov_b32 v191, 0
v_mov_b32 v192, 0
v_mov_b32 v193, 0
v_mov_b32 v194, 0
v_mov_b32 v195, 0
v_mov_b32 v196, 0
v_mov_b32 v197, 0
v_mov_b32 v198, 0
v_mov_b32 v199, 0
v_mov_b32 v200, 0
v_mov_b32 v201, 0
v_mov_b32 v202, 0
v_mov_b32 v203, 0
v_mov_b32 v204, 0
v_mov_b32 v205, 0
v_mov_b32 v206, 0
v_mov_b32 v207, 0
v_mov_b32 v208, 0
v_mov_b32 v209, 0
v_mov_b32 v210, 0
v_mov_b32 v211, 0
v_mov_b32 v212, 0
v_mov_b32 v213, 0
v_mov_b32 v214, 0
v_mov_b32 v215, 0
v_mov_b32 v216, 0
v_mov_b32 v217, 0
v_mov_b32 v218, 0
v_mov_b32 v219, 0
v_mov_b32 v220, 0
v_mov_b32 v221, 0
v_mov_b32 v222, 0
v_mov_b32 v223, 0
v_mov_b32 v224, 0
v_mov_b32 v225, 0
v_mov_b32 v226, 0
v_mov_b32 v227, 0
v_mov_b32 v228, 0
v_mov_b32 v229, 0
v_mov_b32 v230, 0
v_mov_b32 v231, 0
v_mov_b32 v232, 0
v_mov_b32 v233, 0
v_mov_b32 v234, 0
v_mov_b32 v235, 0
v_mov_b32 v236, 0
v_mov_b32 v237, 0
v_mov_b32 v238, 0
v_mov_b32 v239, 0
v_mov_b32 v240, 0
v_mov_b32 v241, 0
v_mov_b32 v242, 0
v_mov_b32 v243, 0
v_mov_b32 v244, 0
v_mov_b32 v245, 0
v_mov_b32 v246, 0
v_mov_b32 v247, 0
v_mov_b32 v248, 0
v_mov_b32 v249, 0
v_mov_b32 v250, 0
v_mov_b32 v251, 0
v_lshrrev_b32 v6, 2, v2
v_cmp_eq_u32 vcc, v6, v3
v_and_b32 v7, 1, v0
v_lshlrev_b32 v7, 4, v7
v_mov_b32 v8, 0x3f80
v_lshlrev_b32 v9, v7, v8
v_cndmask_b32 v7, 0, v9, vcc
v_and_b32 v6, 2, v0
v_cmp_eq_u32 vcc, 0, v6
v_mov_b32 v36, 0
v_mov_b32 v37, 0
v_mov_b32 v40, 0
v_mov_b32 v41, 0
v_cndmask_b32 v38, 0, v7, vcc
v_cndmask_b32 v39, v7, 0, vcc
v_lshrrev_b32 v8, 1, v2
v_cmp_eq_u32 vcc, 0, v8
s_nop 1
v_cndmask_b32 v44, 0, v9, vcc
v_cmp_eq_u32 vcc, 1, v8
s_nop 1
v_cndmask_b32 v45, 0, v9, vcc
v_cmp_eq_u32 vcc, 2, v8
s_nop 1
v_cndmask_b32 v46, 0, v9, vcc
v_cmp_eq_u32 vcc, 3, v8
s_nop 1
v_cndmask_b32 v47, 0, v9, vcc
v_lshrrev_b32 v4, 2, v2
v_lshl_add_u32 v4, v3, 2, v4
v_lshlrev_b32 v4, 6, v4
v_and_b32 v5, 3, v0
v_lshl_add_u32 v4, v5, 3, v4
s_lshl_b32 s48, s43, 11
s_add_u32 s48, s48, 135168
v_add_u32 v53, s48, v4
s_mul_i32 s48, s40, 3072
s_add_u32 s48, s48, 139264
v_add_u32 v42, s48, v18
s_xor_b32 s49, s40, 2
s_mul_i32 s48, s49, 3072
s_add_u32 s48, s48, 139264
v_add_u32 v43, s48, v18
s_lshl_b32 s49, s49, 2
s_add_u32 s49, s49, 134672
v_mov_b32 v19, s49
v_xor_b32 v52, 8, v19
v_lshrrev_b32 v4, 3, v0
v_and_b32 v5, 7, v0
v_lshlrev_b32 v4, 11, v4
v_lshl_add_u32 v55, v5, 4, v4
v_lshlrev_b32 v4, 6, v2
v_lshl_add_u32 v58, v3, 4, v4
v_lshlrev_b32 v4, 4, v2
v_lshl_add_u32 v59, v3, 3, v4
s_mul_i32 s51, s42, 163840
s_add_u32 s51, s51, 9437184
s_lshl_b32 s50, s43, 1
s_add_u32 s50, s50, s44
s_lshl_b32 s48, s50, 15
s_add_u32 s48, s48, s51
s_add_u32 s48, s48, 0
s_lshl_b32 s49, s41, 7
s_add_u32 s53, s48, s49
s_add_u32 s54, s53, 16384
s_lshl_b32 s56, s50, 10
s_add_u32 s56, s56, s51
s_add_u32 s56, s56, 151552
s_xor_b32 s57, s56, 1024
s_lshl_b32 s58, s50, 11
s_add_u32 s58, s58, s51
s_add_u32 s58, s58, 139264
s_xor_b32 s59, s58, 2048
s_add_u32 s79, s58, s49
s_lshl_b32 s50, s41, 11
s_add_u32 s55, s48, s50
s_lshl_b32 s48, s43, 7
s_add_u32 s48, s48, 133888
v_lshl_add_u32 v7, v3, 4, s48
v_lshl_add_u32 v54, v2, 2, s48
s_lshl_b32 s49, s44, 6
v_add_u32 v8, s49, v2
v_lshlrev_b32 v8, 3, v8
v_add_u32 v8, 131072, v8
v_lshl_add_u32 v9, v3, 2, s49
v_lshlrev_b32 v9, 2, v9
v_add_u32 v9, 132096, v9
s_mov_b32 s64, 0
s_mov_b32 s65, 0
s_mov_b32 s66, 0x3fb8aa3b
s_barrier
ds_read_b128 v[60:63], v14 offset:0
ds_read_b128 v[64:67], v14 offset:2048
ds_read_b128 v[68:71], v14 offset:4096
ds_read_b128 v[72:75], v14 offset:6144
ds_read_b64_tr_b16 v[84:85], v16 offset:8192
ds_read_b64_tr_b16 v[86:87], v16 offset:8704
ds_read_b64_tr_b16 v[88:89], v17 offset:8192
ds_read_b64_tr_b16 v[90:91], v17 offset:8704
ds_read_b64_tr_b16 v[92:93], v16 offset:16384
ds_read_b64_tr_b16 v[94:95], v16 offset:16896
ds_read_b64_tr_b16 v[96:97], v17 offset:16384
ds_read_b64_tr_b16 v[98:99], v17 offset:16896
ds_read_b64_tr_b16 v[76:77], v16 offset:0
ds_read_b64_tr_b16 v[78:79], v16 offset:512
ds_read_b64_tr_b16 v[80:81], v17 offset:0
ds_read_b64_tr_b16 v[82:83], v17 offset:512
s_waitcnt lgkmcnt(0)
c3_loop:
v_mfma_f32_16x16x32_bf16 v[212:215], v[84:87], v[72:75], v[212:215]
ds_read_b128 v[100:103], v15 offset:0
v_mfma_f32_16x16x32_bf16 v[204:207], v[84:87], v[68:71], v[204:207]
ds_read_b128 v[104:107], v15 offset:2048
v_mfma_f32_16x16x32_bf16 v[196:199], v[84:87], v[64:67], v[196:199]
ds_read_b128 v[108:111], v15 offset:4096
v_mfma_f32_16x16x32_bf16 v[188:191], v[84:87], v[60:63], v[188:191]
ds_read_b128 v[112:115], v15 offset:6144
v_mfma_f32_16x16x32_bf16 v[192:195], v[88:91], v[60:63], v[192:195]
ds_read_b64_tr_b16 v[124:125], v16 offset:12288
v_mfma_f32_16x16x32_bf16 v[200:203], v[88:91], v[64:67], v[200:203]
ds_read_b64_tr_b16 v[126:127], v16 offset:12800
v_mfma_f32_16x16x32_bf16 v[208:211], v[88:91], v[68:71], v[208:211]
ds_read_b64_tr_b16 v[128:129], v17 offset:12288
v_mfma_f32_16x16x32_bf16 v[216:219], v[88:91], v[72:75], v[216:219]
ds_read_b64_tr_b16 v[130:131], v17 offset:12800
v_mfma_f32_16x16x32_bf16 v[244:247], v[72:75], v[92:95], v[244:247]
ds_read_b64_tr_b16 v[132:133], v16 offset:20480
v_mfma_f32_16x16x32_bf16 v[248:251], v[72:75], v[96:99], v[248:251]
ds_read_b64_tr_b16 v[134:135], v16 offset:20992
v_mfma_f32_16x16x32_bf16 v[240:243], v[68:71], v[96:99], v[240:243]
ds_read_b64_tr_b16 v[136:137], v17 offset:20480
v_mfma_f32_16x16x32_bf16 v[236:239], v[68:71], v[92:95], v[236:239]
ds_read_b64_tr_b16 v[138:139], v17 offset:20992
v_mfma_f32_16x16x32_bf16 v[228:231], v[64:67], v[92:95], v[228:231]
ds_read_b64_tr_b16 v[116:117], v16 offset:4096
v_mfma_f32_16x16x32_bf16 v[232:235], v[64:67], v[96:99], v[232:235]
ds_read_b64_tr_b16 v[118:119], v16 offset:4608
v_mfma_f32_16x16x32_bf16 v[224:227], v[60:63], v[96:99], v[224:227]
ds_read_b64_tr_b16 v[120:121], v17 offset:4096
v_mfma_f32_16x16x32_bf16 v[220:223], v[60:63], v[92:95], v[220:223]
ds_read_b64_tr_b16 v[122:123], v17 offset:4608
v_mfma_f32_16x16x32_bf16 v[156:159], v[76:79], v[60:63], v[156:159]
s_add_u32 s65, s65, 40960
s_cmp_eq_u32 s65, 122880
v_mfma_f32_16x16x32_bf16 v[164:167], v[76:79], v[64:67], v[164:167]
s_cselect_b32 s65, 0, s65
s_add_u32 s64, s64, 1
v_mfma_f32_16x16x32_bf16 v[172:175], v[76:79], v[68:71], v[172:175]
v_add_u32 v14, s65, v10
v_add_u32 v15, s65, v11
v_mfma_f32_16x16x32_bf16 v[180:183], v[76:79], v[72:75], v[180:183]
v_add_u32 v16, s65, v12
v_add_u32 v17, s65, v13
v_mfma_f32_16x16x32_bf16 v[184:187], v[80:83], v[72:75], v[184:187]
v_mfma_f32_16x16x32_bf16 v[176:179], v[80:83], v[68:71], v[176:179]
s_cmp_eq_u32 s64, 16
s_cbranch_scc1 c3_last
v_mfma_f32_16x16x32_bf16 v[168:171], v[80:83], v[64:67], v[168:171]
s_waitcnt lgkmcnt(0)
v_mfma_f32_16x16x32_bf16 v[160:163], v[80:83], v[60:63], v[160:163]
s_barrier
v_mfma_f32_16x16x32_bf16 v[212:215], v[124:127], v[112:115], v[212:215]
ds_read_b128 v[60:63], v14 offset:0
v_mfma_f32_16x16x32_bf16 v[204:207], v[124:127], v[108:111], v[204:207]
ds_read_b128 v[64:67], v14 offset:2048
v_mfma_f32_16x16x32_bf16 v[196:199], v[124:127], v[104:107], v[196:199]
ds_read_b128 v[68:71], v14 offset:4096
v_mfma_f32_16x16x32_bf16 v[188:191], v[124:127], v[100:103], v[188:191]
ds_read_b128 v[72:75], v14 offset:6144
v_mfma_f32_16x16x32_bf16 v[192:195], v[128:131], v[100:103], v[192:195]
ds_read_b64_tr_b16 v[84:85], v16 offset:8192
v_mfma_f32_16x16x32_bf16 v[200:203], v[128:131], v[104:107], v[200:203]
ds_read_b64_tr_b16 v[86:87], v16 offset:8704
v_mfma_f32_16x16x32_bf16 v[208:211], v[128:131], v[108:111], v[208:211]
ds_read_b64_tr_b16 v[88:89], v17 offset:8192
v_mfma_f32_16x16x32_bf16 v[216:219], v[128:131], v[112:115], v[216:219]
ds_read_b64_tr_b16 v[90:91], v17 offset:8704
v_mfma_f32_16x16x32_bf16 v[244:247], v[112:115], v[132:135], v[244:247]
ds_read_b64_tr_b16 v[92:93], v16 offset:16384
v_mfma_f32_16x16x32_bf16 v[248:251], v[112:115], v[136:139], v[248:251]
ds_read_b64_tr_b16 v[94:95], v16 offset:16896
v_mfma_f32_16x16x32_bf16 v[240:243], v[108:111], v[136:139], v[240:243]
ds_read_b64_tr_b16 v[96:97], v17 offset:16384
v_mfma_f32_16x16x32_bf16 v[236:239], v[108:111], v[132:135], v[236:239]
ds_read_b64_tr_b16 v[98:99], v17 offset:16896
v_mfma_f32_16x16x32_bf16 v[228:231], v[104:107], v[132:135], v[228:231]
ds_read_b64_tr_b16 v[76:77], v16 offset:0
v_mfma_f32_16x16x32_bf16 v[232:235], v[104:107], v[136:139], v[232:235]
ds_read_b64_tr_b16 v[78:79], v16 offset:512
v_mfma_f32_16x16x32_bf16 v[224:227], v[100:103], v[136:139], v[224:227]
ds_read_b64_tr_b16 v[80:81], v17 offset:0
v_mfma_f32_16x16x32_bf16 v[220:223], v[100:103], v[132:135], v[220:223]
ds_read_b64_tr_b16 v[82:83], v17 offset:512
v_mfma_f32_16x16x32_bf16 v[156:159], v[116:119], v[100:103], v[156:159]
v_mfma_f32_16x16x32_bf16 v[164:167], v[116:119], v[104:107], v[164:167]
v_mfma_f32_16x16x32_bf16 v[172:175], v[116:119], v[108:111], v[172:175]
v_mfma_f32_16x16x32_bf16 v[180:183], v[116:119], v[112:115], v[180:183]
v_mfma_f32_16x16x32_bf16 v[184:187], v[120:123], v[112:115], v[184:187]
v_mfma_f32_16x16x32_bf16 v[176:179], v[120:123], v[108:111], v[176:179]
v_mfma_f32_16x16x32_bf16 v[168:171], v[120:123], v[104:107], v[168:171]
s_waitcnt lgkmcnt(0)
v_mfma_f32_16x16x32_bf16 v[160:163], v[120:123], v[100:103], v[160:163]
s_branch c3_loop
c3_last:
v_mfma_f32_16x16x32_bf16 v[168:171], v[80:83], v[64:67], v[168:171]
s_waitcnt lgkmcnt(0)
v_mfma_f32_16x16x32_bf16 v[160:163], v[80:83], v[60:63], v[160:163]
v_mfma_f32_16x16x32_bf16 v[212:215], v[124:127], v[112:115], v[212:215]
ds_read_b64_tr_b16 v[10:11], v53 offset:0
ds_read_b64_tr_b16 v[12:13], v53 offset:1024
v_mfma_f32_16x16x32_bf16 v[204:207], v[124:127], v[108:111], v[204:207]
ds_read_b64_tr_b16 v[14:15], v53 offset:32
ds_read_b64_tr_b16 v[16:17], v53 offset:1056
v_mfma_f32_16x16x32_bf16 v[196:199], v[124:127], v[104:107], v[196:199]
ds_read_b128 v[140:143], v7 offset:0
s_mul_i32 s48, s44, 0x80008000
v_mfma_f32_16x16x32_bf16 v[188:191], v[124:127], v[100:103], v[188:191]
ds_read_b128 v[144:147], v7 offset:64
v_mfma_f32_16x16x32_bf16 v[192:195], v[128:131], v[100:103], v[192:195]
ds_read_b128 v[148:151], v7 offset:256
v_mfma_f32_16x16x32_bf16 v[200:203], v[128:131], v[104:107], v[200:203]
ds_read_b128 v[152:155], v7 offset:320
v_mfma_f32_16x16x32_bf16 v[208:211], v[128:131], v[108:111], v[208:211]
ds_read2_b32 v[56:57], v54 offset0:128 offset1:144
s_waitcnt lgkmcnt(5)
v_mfma_f32_16x16x32_bf16 v[216:219], v[128:131], v[112:115], v[216:219]
s_barrier
v_mfma_f32_16x16x32_bf16 v[244:247], v[112:115], v[132:135], v[244:247]
ds_read_b64 v[92:93], v8 offset:0
v_xor_b32 v10, s48, v10
v_mfma_f32_16x16x32_bf16 v[248:251], v[112:115], v[136:139], v[248:251]
ds_read_b64 v[94:95], v8 offset:128
v_xor_b32 v11, s48, v11
v_mfma_f32_16x16x32_bf16 v[240:243], v[108:111], v[136:139], v[240:243]
ds_read_b64 v[96:97], v8 offset:256
v_xor_b32 v12, s48, v12
v_mfma_f32_16x16x32_bf16 v[236:239], v[108:111], v[132:135], v[236:239]
ds_read_b64 v[98:99], v8 offset:384
v_xor_b32 v13, s48, v13
v_mfma_f32_16x16x32_bf16 v[228:231], v[104:107], v[132:135], v[228:231]
ds_read_b128 v[60:63], v9 offset:0
v_xor_b32 v14, s48, v14
v_mfma_f32_16x16x32_bf16 v[232:235], v[104:107], v[136:139], v[232:235]
ds_read_b128 v[64:67], v9 offset:64
v_xor_b32 v15, s48, v15
v_mfma_f32_16x16x32_bf16 v[224:227], v[100:103], v[136:139], v[224:227]
ds_read_b128 v[68:71], v9 offset:128
v_xor_b32 v16, s48, v16
v_mfma_f32_16x16x32_bf16 v[220:223], v[100:103], v[132:135], v[220:223]
ds_read_b128 v[72:75], v9 offset:192
v_xor_b32 v17, s48, v17
v_mfma_f32_16x16x32_bf16 v[156:159], v[116:119], v[100:103], v[156:159]
ds_read_b128 v[76:79], v9 offset:512
v_mfma_f32_16x16x32_bf16 v[164:167], v[116:119], v[104:107], v[164:167]
ds_read_b128 v[80:83], v9 offset:576
v_mfma_f32_16x16x32_bf16 v[172:175], v[116:119], v[108:111], v[172:175]
ds_read_b128 v[84:87], v9 offset:640
v_mfma_f32_16x16x32_bf16 v[180:183], v[116:119], v[112:115], v[180:183]
ds_read_b128 v[88:91], v9 offset:704
v_mfma_f32_16x16x32_bf16 v[184:187], v[120:123], v[112:115], v[184:187]
v_mfma_f32_16x16x32_bf16 v[176:179], v[120:123], v[108:111], v[176:179]
v_mfma_f32_16x16x32_bf16 v[168:171], v[120:123], v[104:107], v[168:171]
v_mfma_f32_16x16x32_bf16 v[160:163], v[120:123], v[100:103], v[160:163]
c3_epi:
s_waitcnt lgkmcnt(0)
.p2align 3
v_mul_f32 v129, s66, v94
v_mul_f32 v128, s66, v92
v_mul_f32 v131, s66, v98
v_mul_f32 v130, s66, v96
v_pk_fma_f32 v[190:191], v[150:151], v[92:93], v[190:191] op_sel:[0,1,0] op_sel_hi:[1,1,1]
v_pk_fma_f32 v[212:213], v[148:149], v[98:99], v[212:213] op_sel:[0,1,0] op_sel_hi:[1,1,1]
v_pk_fma_f32 v[214:215], v[150:151], v[98:99], v[214:215] op_sel:[0,1,0] op_sel_hi:[1,1,1]
v_pk_fma_f32 v[188:189], v[148:149], v[92:93], v[188:189] op_sel:[0,1,0] op_sel_hi:[1,1,1]
v_pk_fma_f32 v[218:219], v[154:155], v[98:99], v[218:219] op_sel:[0,1,0] op_sel_hi:[1,1,1]
v_cvt_pk_bf16_f32 v188, v188, v189
v_cvt_pk_bf16_f32 v189, v190, v191
v_pk_fma_f32 v[196:197], v[148:149], v[94:95], v[196:197] op_sel:[0,1,0] op_sel_hi:[1,1,1]
v_pk_fma_f32 v[200:201], v[152:153], v[94:95], v[200:201] op_sel:[0,1,0] op_sel_hi:[1,1,1]
v_pk_fma_f32 v[210:211], v[154:155], v[96:97], v[210:211] op_sel:[0,1,0] op_sel_hi:[1,1,1]
v_pk_fma_f32 v[240:241], v[84:85], v[56:57], v[240:241] op_sel:[0,1,0] op_sel_hi:[1,1,1]
v_pk_fma_f32 v[228:229], v[80:81], v[56:57], v[228:229] op_sel:[0,0,0] op_sel_hi:[1,0,1]
v_pk_fma_f32 v[226:227], v[78:79], v[56:57], v[226:227] op_sel:[0,1,0] op_sel_hi:[1,1,1]
v_pk_fma_f32 v[192:193], v[152:153], v[92:93], v[192:193] op_sel:[0,1,0] op_sel_hi:[1,1,1]
v_cvt_pk_bf16_f32 v190, v192, v193
v_pk_fma_f32 v[238:239], v[86:87], v[56:57], v[238:239] op_sel:[0,0,0] op_sel_hi:[1,0,1]
v_pk_fma_f32 v[234:235], v[82:83], v[56:57], v[234:235] op_sel:[0,1,0] op_sel_hi:[1,1,1]
v_pk_mul_f32 v[226:227], v[226:227], v[62:63]
v_pk_fma_f32 v[204:205], v[148:149], v[96:97], v[204:205] op_sel:[0,1,0] op_sel_hi:[1,1,1]
v_cvt_pk_bf16_f32 v204, v204, v205
v_pk_fma_f32 v[202:203], v[154:155], v[94:95], v[202:203] op_sel:[0,1,0] op_sel_hi:[1,1,1]
v_pk_fma_f32 v[224:225], v[76:77], v[56:57], v[224:225] op_sel:[0,1,0] op_sel_hi:[1,1,1]
v_pk_fma_f32 v[216:217], v[152:153], v[98:99], v[216:217] op_sel:[0,1,0] op_sel_hi:[1,1,1]
v_pk_fma_f32 v[244:245], v[88:89], v[56:57], v[244:245] op_sel:[0,0,0] op_sel_hi:[1,0,1]
v_pk_mul_f32 v[238:239], v[238:239], v[70:71]
v_pk_mul_f32 v[228:229], v[228:229], v[64:65]
v_pk_fma_f32 v[236:237], v[84:85], v[56:57], v[236:237] op_sel:[0,0,0] op_sel_hi:[1,0,1]
v_pk_fma_f32 v[220:221], v[76:77], v[56:57], v[220:221] op_sel:[0,0,0] op_sel_hi:[1,0,1]
v_pk_mul_f32 v[224:225], v[224:225], v[60:61]
v_cvt_pk_bf16_f32 v212, v212, v213
v_cvt_pk_bf16_f32 v213, v214, v215
v_cvt_pk_bf16_f32 v196, v196, v197
v_pk_mul_f32 v[240:241], v[240:241], v[68:69]
v_pk_fma_f32 v[198:199], v[150:151], v[94:95], v[198:199] op_sel:[0,1,0] op_sel_hi:[1,1,1]
v_cvt_pk_bf16_f32 v197, v198, v199
v_cvt_pk_bf16_f32 v198, v200, v201
v_cvt_pk_bf16_f32 v199, v202, v203
v_cvt_pk_bf16_f32 v215, v218, v219
v_pk_fma_f32 v[208:209], v[152:153], v[96:97], v[208:209] op_sel:[0,1,0] op_sel_hi:[1,1,1]
v_pk_fma_f32 v[246:247], v[90:91], v[56:57], v[246:247] op_sel:[0,0,0] op_sel_hi:[1,0,1]
v_pk_fma_f32 v[250:251], v[90:91], v[56:57], v[250:251] op_sel:[0,1,0] op_sel_hi:[1,1,1]
v_pk_mul_f32 v[250:251], v[250:251], v[74:75]
v_pk_fma_f32 v[206:207], v[150:151], v[96:97], v[206:207] op_sel:[0,1,0] op_sel_hi:[1,1,1]
v_cvt_pk_bf16_f32 v205, v206, v207
v_pk_fma_f32 v[242:243], v[86:87], v[56:57], v[242:243] op_sel:[0,1,0] op_sel_hi:[1,1,1]
v_cvt_pk_bf16_f32 v207, v210, v211
v_pk_mul_f32 v[236:237], v[236:237], v[68:69]
v_pk_fma_f32 v[230:231], v[82:83], v[56:57], v[230:231] op_sel:[0,0,0] op_sel_hi:[1,0,1]
v_pk_fma_f32 v[194:195], v[154:155], v[92:93], v[194:195] op_sel:[0,1,0] op_sel_hi:[1,1,1]
v_cvt_pk_bf16_f32 v191, v194, v195
v_pk_fma_f32 v[232:233], v[80:81], v[56:57], v[232:233] op_sel:[0,1,0] op_sel_hi:[1,1,1]
v_pk_mul_f32 v[232:233], v[232:233], v[64:65]
v_pk_mul_f32 v[230:231], v[230:231], v[66:67]
v_pk_fma_f32 v[248:249], v[88:89], v[56:57], v[248:249] op_sel:[0,1,0] op_sel_hi:[1,1,1]
v_pk_mul_f32 v[248:249], v[248:249], v[72:73]
v_pk_mul_f32 v[242:243], v[242:243], v[70:71]
v_mfma_f32_16x16x32_bf16 v[68:71], v[10:13], v[196:199], 0
v_cvt_pk_bf16_f32 v206, v208, v209
v_cvt_pk_bf16_f32 v214, v216, v217
v_cvt_pk_bf16_f32 v121, v226, v227
v_mfma_f32_16x16x32_bf16 v[80:83], v[14:17], v[204:207], 0
v_cvt_pk_bf16_f32 v120, v224, v225
v_cvt_pk_bf16_f32 v114, v228, v229
v_mfma_f32_16x16x32_bf16 v[84:87], v[10:13], v[212:215], 0
v_cvt_pk_bf16_f32 v116, v236, v237
v_min3_f32 v105, v68, v69, v70
v_mfma_f32_16x16x32_bf16 v[88:91], v[14:17], v[212:215], 0
v_max3_f32 v101, v68, v69, v70
v_cvt_pk_bf16_f32 v115, v230, v231
v_cvt_pk_bf16_f32 v122, v232, v233
v_cvt_pk_bf16_f32 v127, v250, v251
v_cvt_pk_bf16_f32 v124, v240, v241
v_pk_mul_f32 v[244:245], v[244:245], v[72:73]
v_pk_fma_f32 v[222:223], v[78:79], v[56:57], v[222:223] op_sel:[0,0,0] op_sel_hi:[1,0,1]
v_pk_mul_f32 v[222:223], v[222:223], v[62:63]
v_mfma_f32_16x16x32_bf16 v[76:79], v[10:13], v[204:207], 0
v_min3_f32 v107, v84, v85, v86
v_min3_f32 v107, v107, v87, v88
v_min3_f32 v107, v107, v89, v90
v_min_f32_e64 v107, v107, v91
v_max3_f32 v103, v84, v85, v86
v_pk_mul_f32 v[220:221], v[220:221], v[60:61]
v_mfma_f32_16x16x32_bf16 v[60:63], v[10:13], v[188:191], 0
v_max3_f32 v103, v103, v87, v88
v_min3_f32 v106, v76, v77, v78
v_min3_f32 v106, v106, v79, v80
v_min3_f32 v106, v106, v81, v82
v_min_f32 v106, v106, v83
v_pk_mul_f32 v[234:235], v[234:235], v[66:67]
v_mfma_f32_16x16x32_bf16 v[64:67], v[14:17], v[188:191], 0
v_permlane32_swap_b32 v106, v107
v_min3_f32 v104, v60, v61, v62
v_min_f32 v106, v106, v107
v_max3_f32 v103, v103, v89, v90
v_pk_mul_f32 v[246:247], v[246:247], v[74:75]
v_mfma_f32_16x16x32_bf16 v[72:75], v[14:17], v[196:199], 0
v_max_f32 v103, v103, v91
v_max3_f32 v102, v76, v77, v78
v_min3_f32 v104, v104, v63, v64
v_min3_f32 v104, v104, v65, v66
v_min_f32 v104, v104, v67
v_max3_f32 v102, v102, v79, v80
v_max3_f32 v102, v102, v81, v82
v_max_f32 v102, v102, v83
v_min3_f32 v105, v105, v71, v72
v_min3_f32 v105, v105, v73, v74
v_min_f32 v105, v105, v75
v_max3_f32 v101, v101, v71, v72
v_max3_f32 v101, v101, v73, v74
v_permlane32_swap_b32 v104, v105
v_permlane32_swap_b32 v102, v103
v_min_f32 v104, v104, v105
v_max_f32 v102, v102, v103
v_max_f32 v101, v101, v75
v_permlane16_swap_b32 v104, v106
v_max3_f32 v100, v60, v61, v62
v_min_f32 v104, v104, v106
v_mov_b32 v106, v104
v_max3_f32 v100, v100, v63, v64
v_max3_f32 v100, v100, v65, v66
v_max_f32 v100, v100, v67
v_permlane16_swap_b32 v104, v106
v_cvt_pk_bf16_f32 v112, v220, v221
v_permlane32_swap_b32 v100, v101
v_mov_b32 v105, v104
v_max_f32 v100, v100, v101
v_mov_b32 v107, v106
v_permlane32_swap_b32 v104, v105
v_permlane16_swap_b32 v100, v102
v_pk_mul_f32 v[104:105], v[104:105], v[128:129]
v_pk_fma_f32 v[226:227], v[66:67], v[128:129], v[104:105] op_sel:[0,0,0] op_sel_hi:[1,0,0] neg_lo:[1,0,0] neg_hi:[1,0,0]
v_pk_fma_f32 v[230:231], v[70:71], v[128:129], v[104:105] op_sel:[0,1,1] op_sel_hi:[1,1,1] neg_lo:[1,0,0] neg_hi:[1,0,0]
v_exp_f32 v226, v226
v_pk_fma_f32 v[224:225], v[64:65], v[128:129], v[104:105] op_sel:[0,0,0] op_sel_hi:[1,0,0] neg_lo:[1,0,0] neg_hi:[1,0,0]
v_exp_f32 v224, v224
v_pk_fma_f32 v[228:229], v[68:69], v[128:129], v[104:105] op_sel:[0,1,1] op_sel_hi:[1,1,1] neg_lo:[1,0,0] neg_hi:[1,0,0]
v_exp_f32 v231, v231
v_cvt_pk_bf16_f32 v113, v222, v223
v_pk_fma_f32 v[222:223], v[62:63], v[128:129], v[104:105] op_sel:[0,0,0] op_sel_hi:[1,0,0] neg_lo:[1,0,0] neg_hi:[1,0,0]
v_exp_f32 v222, v222
v_pk_fma_f32 v[220:221], v[60:61], v[128:129], v[104:105] op_sel:[0,0,0] op_sel_hi:[1,0,0] neg_lo:[1,0,0] neg_hi:[1,0,0]
v_exp_f32 v221, v221
v_exp_f32 v220, v220
v_max_f32 v100, v100, v102
v_exp_f32 v223, v223
v_mov_b32 v102, v100
v_pk_add_f32 v[110:111], v[220:221], v[222:223]
v_exp_f32 v225, v225
v_pk_fma_f32 v[232:233], v[72:73], v[128:129], v[104:105] op_sel:[0,1,1] op_sel_hi:[1,1,1] neg_lo:[1,0,0] neg_hi:[1,0,0]
v_exp_f32 v232, v232
v_exp_f32 v233, v233
v_pk_add_f32 v[110:111], v[110:111], v[224:225]
v_exp_f32 v229, v229
v_exp_f32 v228, v228
v_exp_f32 v227, v227
v_cvt_pk_bf16_f32 v123, v234, v235
v_pk_fma_f32 v[234:235], v[74:75], v[128:129], v[104:105] op_sel:[0,1,1] op_sel_hi:[1,1,1] neg_lo:[1,0,0] neg_hi:[1,0,0]
v_pk_add_f32 v[110:111], v[110:111], v[226:227]
v_add_f32 v104, v110, v111
v_cvt_pk_bf16_f32 v118, v244, v245
v_permlane32_swap_b32 v106, v107
v_permlane16_swap_b32 v100, v102
v_exp_f32 v234, v234
v_mov_b32 v101, v100
v_exp_f32 v235, v235
v_exp_f32_e64 v230, v230
v_cvt_pk_bf16_f32 v125, v242, v243
v_pk_add_f32 v[110:111], v[228:229], v[230:231]
v_pk_add_f32 v[110:111], v[110:111], v[232:233]
v_pk_add_f32 v[110:111], v[110:111], v[234:235]
v_cvt_pk_bf16_f32 v126, v248, v249
v_pk_mul_f32 v[106:107], v[106:107], v[130:131]
v_pk_fma_f32 v[236:237], v[76:77], v[130:131], v[106:107] op_sel:[0,0,0] op_sel_hi:[1,0,0] neg_lo:[1,0,0] neg_hi:[1,0,0]
v_exp_f32 v237, v237
v_exp_f32 v236, v236
v_pk_fma_f32 v[242:243], v[82:83], v[130:131], v[106:107] op_sel:[0,0,0] op_sel_hi:[1,0,0] neg_lo:[1,0,0] neg_hi:[1,0,0]
v_pk_fma_f32 v[250:251], v[90:91], v[130:131], v[106:107] op_sel:[0,1,1] op_sel_hi:[1,1,1] neg_lo:[1,0,0] neg_hi:[1,0,0]
v_add_f32 v105, v110, v111
v_exp_f32 v243, v243
v_cvt_pk_bf16_f32 v119, v246, v247
v_pk_fma_f32 v[246:247], v[86:87], v[130:131], v[106:107] op_sel:[0,1,1] op_sel_hi:[1,1,1] neg_lo:[1,0,0] neg_hi:[1,0,0]
v_exp_f32 v246, v246
v_cvt_pk_bf16_f32 v117, v238, v239
v_pk_fma_f32 v[238:239], v[78:79], v[130:131], v[106:107] op_sel:[0,0,0] op_sel_hi:[1,0,0] neg_lo:[1,0,0] neg_hi:[1,0,0]
v_exp_f32 v238, v238
v_exp_f32 v247, v247
v_pk_fma_f32 v[240:241], v[80:81], v[130:131], v[106:107] op_sel:[0,0,0] op_sel_hi:[1,0,0] neg_lo:[1,0,0] neg_hi:[1,0,0]
v_exp_f32 v240, v240
v_exp_f32 v241, v241
v_permlane32_swap_b32 v100, v101
v_exp_f32 v242, v242
v_pk_fma_f32 v[244:245], v[84:85], v[130:131], v[106:107] op_sel:[0,1,1] op_sel_hi:[1,1,1] neg_lo:[1,0,0] neg_hi:[1,0,0]
v_exp_f32 v244, v244
v_exp_f32_e64 v239, v239
v_pk_mul_f32 v[100:101], v[100:101], v[128:129]
v_pk_fma_f32 v[62:63], v[62:63], v[128:129], v[100:101] op_sel:[0,0,0] op_sel_hi:[1,0,0] neg_lo:[0,0,1] neg_hi:[0,0,1]
v_pk_add_f32 v[110:111], v[236:237], v[238:239]
v_pk_add_f32 v[110:111], v[110:111], v[240:241]
v_pk_add_f32 v[110:111], v[110:111], v[242:243]
v_pk_fma_f32 v[72:73], v[72:73], v[128:129], v[100:101] op_sel:[0,1,1] op_sel_hi:[1,1,1] neg_lo:[0,0,1] neg_hi:[0,0,1]
v_pk_fma_f32 v[66:67], v[66:67], v[128:129], v[100:101] op_sel:[0,0,0] op_sel_hi:[1,0,0] neg_lo:[0,0,1] neg_hi:[0,0,1]
v_exp_f32 v62, v62
v_pk_fma_f32 v[60:61], v[60:61], v[128:129], v[100:101] op_sel:[0,0,0] op_sel_hi:[1,0,0] neg_lo:[0,0,1] neg_hi:[0,0,1]
v_exp_f32 v60, v60
v_exp_f32 v245, v245
v_exp_f32 v73, v73
v_pk_fma_f32 v[248:249], v[88:89], v[130:131], v[106:107] op_sel:[0,1,1] op_sel_hi:[1,1,1] neg_lo:[1,0,0] neg_hi:[1,0,0]
v_add_f32 v106, v110, v111
v_exp_f32 v249, v249
v_pk_add_f32 v[110:111], v[244:245], v[246:247]
v_exp_f32 v248, v248
v_pk_fma_f32 v[64:65], v[64:65], v[128:129], v[100:101] op_sel:[0,0,0] op_sel_hi:[1,0,0] neg_lo:[0,0,1] neg_hi:[0,0,1]
v_exp_f32 v64, v64
v_pk_add_f32 v[110:111], v[110:111], v[248:249]
v_exp_f32 v65, v65
v_exp_f32 v61, v61
v_exp_f32 v66, v66
v_exp_f32 v251, v251
v_exp_f32 v63, v63
v_pk_fma_f32 v[74:75], v[74:75], v[128:129], v[100:101] op_sel:[0,1,1] op_sel_hi:[1,1,1] neg_lo:[0,0,1] neg_hi:[0,0,1]
v_pk_add_f32 v[108:109], v[60:61], v[62:63]
v_exp_f32 v67, v67
v_exp_f32 v250, v250
v_pk_fma_f32 v[68:69], v[68:69], v[128:129], v[100:101] op_sel:[0,1,1] op_sel_hi:[1,1,1] neg_lo:[0,0,1] neg_hi:[0,0,1]
v_pk_add_f32 v[110:111], v[110:111], v[250:251]
v_exp_f32 v68, v68
v_exp_f32 v69, v69
v_add_f32 v107, v110, v111
v_mov_b32 v103, v102
v_pk_fma_f32 v[70:71], v[70:71], v[128:129], v[100:101] op_sel:[0,1,1] op_sel_hi:[1,1,1] neg_lo:[0,0,1] neg_hi:[0,0,1]
v_exp_f32 v71, v71
v_exp_f32 v70, v70
v_permlane32_swap_b32 v106, v107
v_permlane32_swap_b32 v102, v103
v_pk_add_f32 v[108:109], v[108:109], v[64:65]
v_pk_add_f32 v[108:109], v[108:109], v[66:67]
v_add_f32 v100, v108, v109
v_pk_add_f32 v[108:109], v[68:69], v[70:71]
v_pk_mul_f32 v[102:103], v[102:103], v[130:131]
v_pk_fma_f32 v[78:79], v[78:79], v[130:131], v[102:103] op_sel:[0,0,0] op_sel_hi:[1,0,0] neg_lo:[0,0,1] neg_hi:[0,0,1]
v_exp_f32 v79, v79
v_exp_f32 v78, v78
v_exp_f32 v74, v74
v_exp_f32 v72, v72
v_pk_fma_f32 v[86:87], v[86:87], v[130:131], v[102:103] op_sel:[0,1,1] op_sel_hi:[1,1,1] neg_lo:[0,0,1] neg_hi:[0,0,1]
v_exp_f32 v87, v87
v_pk_fma_f32 v[76:77], v[76:77], v[130:131], v[102:103] op_sel:[0,0,0] op_sel_hi:[1,0,0] neg_lo:[0,0,1] neg_hi:[0,0,1]
v_exp_f32 v77, v77
v_add_f32 v106, v106, v107
v_pk_fma_f32 v[80:81], v[80:81], v[130:131], v[102:103] op_sel:[0,0,0] op_sel_hi:[1,0,0] neg_lo:[0,0,1] neg_hi:[0,0,1]
v_exp_f32 v81, v81
v_exp_f32 v80, v80
v_pk_add_f32 v[108:109], v[108:109], v[72:73]
v_permlane32_swap_b32 v104, v105
v_exp_f32 v75, v75
v_add_f32 v104, v104, v105
v_pk_fma_f32 v[82:83], v[82:83], v[130:131], v[102:103] op_sel:[0,0,0] op_sel_hi:[1,0,0] neg_lo:[0,0,1] neg_hi:[0,0,1]
v_exp_f32 v82, v82
v_exp_f32 v83, v83
v_permlane16_swap_b32 v104, v106
v_pk_add_f32 v[108:109], v[108:109], v[74:75]
v_add_f32 v101, v108, v109
v_exp_f32 v76, v76
v_add_f32 v104, v104, v106
v_rcp_f32 v104, v104
v_pk_fma_f32 v[84:85], v[84:85], v[130:131], v[102:103] op_sel:[0,1,1] op_sel_hi:[1,1,1] neg_lo:[0,0,1] neg_hi:[0,0,1]
v_exp_f32 v84, v84
v_exp_f32 v85, v85
v_mov_b32 v106, v104
v_pk_add_f32 v[108:109], v[76:77], v[78:79]
v_pk_add_f32 v[108:109], v[108:109], v[80:81]
v_pk_add_f32 v[108:109], v[108:109], v[82:83]
v_pk_fma_f32 v[88:89], v[88:89], v[130:131], v[102:103] op_sel:[0,1,1] op_sel_hi:[1,1,1] neg_lo:[0,0,1] neg_hi:[0,0,1]
v_exp_f32 v88, v88
v_exp_f32 v89, v89
v_exp_f32 v86, v86
v_pk_fma_f32 v[90:91], v[90:91], v[130:131], v[102:103] op_sel:[0,1,1] op_sel_hi:[1,1,1] neg_lo:[0,0,1] neg_hi:[0,0,1]
v_add_f32 v102, v108, v109
v_pk_add_f32 v[108:109], v[84:85], v[86:87]
v_pk_add_f32 v[108:109], v[108:109], v[88:89]
v_permlane16_swap_b32 v104, v106
v_exp_f32 v90, v90
v_exp_f32 v91, v91
v_permlane32_swap_b32 v100, v101
v_pk_add_f32 v[108:109], v[108:109], v[90:91]
v_add_f32 v103, v108, v109
v_add_f32 v100, v100, v101
v_mov_b32 v105, v104
v_permlane32_swap_b32 v102, v103
v_mov_b32 v107, v106
v_add_f32 v102, v102, v103
v_permlane32_swap_b32 v104, v105
v_permlane32_swap_b32 v106, v107
v_permlane16_swap_b32 v100, v102
v_pk_mul_f32 v[222:223], v[222:223], v[104:105] op_sel:[0,0] op_sel_hi:[1,0]
v_pk_mul_f32 v[226:227], v[226:227], v[104:105] op_sel:[0,0] op_sel_hi:[1,0]
v_pk_mul_f32 v[234:235], v[234:235], v[104:105] op_sel:[0,1] op_sel_hi:[1,1]
v_pk_mul_f32 v[232:233], v[232:233], v[104:105] op_sel:[0,1] op_sel_hi:[1,1]
v_pk_mul_f32 v[230:231], v[230:231], v[104:105] op_sel:[0,1] op_sel_hi:[1,1]
v_add_f32 v100, v100, v102
v_pk_mul_f32 v[228:229], v[228:229], v[104:105] op_sel:[0,1] op_sel_hi:[1,1]
v_cvt_pk_bf16_f32 v228, v228, v229
v_cvt_pk_bf16_f32 v229, v230, v231
v_cvt_pk_bf16_f32 v231, v234, v235
v_cvt_pk_bf16_f32 v230, v232, v233
v_pk_mul_f32 v[220:221], v[220:221], v[104:105] op_sel:[0,0] op_sel_hi:[1,0]
v_cvt_pk_bf16_f32 v220, v220, v221
v_pk_mul_f32 v[224:225], v[224:225], v[104:105] op_sel:[0,0] op_sel_hi:[1,0]
v_pk_mul_f32 v[236:237], v[236:237], v[106:107] op_sel:[0,0] op_sel_hi:[1,0]
v_pk_mul_f32 v[238:239], v[238:239], v[106:107] op_sel:[0,0] op_sel_hi:[1,0]
v_pk_mul_f32 v[240:241], v[240:241], v[106:107] op_sel:[0,0] op_sel_hi:[1,0]
v_pk_mul_f32 v[242:243], v[242:243], v[106:107] op_sel:[0,0] op_sel_hi:[1,0]
v_pk_mul_f32 v[248:249], v[248:249], v[106:107] op_sel:[0,1] op_sel_hi:[1,1]
v_rcp_f32 v100, v100
v_pk_mul_f32 v[244:245], v[244:245], v[106:107] op_sel:[0,1] op_sel_hi:[1,1]
v_mov_b32 v102, v100
v_pk_mul_f32 v[250:251], v[250:251], v[106:107] op_sel:[0,1] op_sel_hi:[1,1]
v_cvt_pk_bf16_f32 v221, v222, v223
v_pk_mul_f32 v[246:247], v[246:247], v[106:107] op_sel:[0,1] op_sel_hi:[1,1]
v_cvt_pk_bf16_f32 v222, v224, v225
v_mfma_f32_16x16x32_bf16 v[200:203], v[228:231], v[36:39], 0
v_cvt_pk_bf16_f32 v223, v226, v227
v_permlane16_swap_b32 v100, v102
v_mfma_f32_16x16x32_bf16 v[196:199], v[228:231], v[38:41], 0
v_mov_b32 v101, v100
v_cvt_pk_bf16_f32 v244, v244, v245
v_mfma_f32_16x16x32_bf16 v[212:215], v[220:223], v[38:41], 0
v_cvt_pk_bf16_f32 v245, v246, v247
v_cvt_pk_bf16_f32 v247, v250, v251
v_mfma_f32_16x16x32_bf16 v[216:219], v[220:223], v[36:39], 0
v_cvt_pk_bf16_f32 v234, v200, v201
v_cvt_pk_bf16_f32 v246, v248, v249
v_cvt_pk_bf16_f32 v226, v196, v197
v_cvt_pk_bf16_f32 v227, v198, v199
v_mfma_f32_16x16x32_bf16 v[196:199], v[244:247], v[38:41], 0
v_cvt_pk_bf16_f32 v225, v214, v215
v_cvt_pk_bf16_f32 v236, v236, v237
v_cvt_pk_bf16_f32 v237, v238, v239
v_cvt_pk_bf16_f32 v232, v216, v217
v_cvt_pk_bf16_f32 v233, v218, v219
v_cvt_pk_bf16_f32 v239, v242, v243
v_cvt_pk_bf16_f32 v238, v240, v241
v_cvt_pk_bf16_f32 v224, v212, v213
v_permlane32_swap_b32 v100, v101
v_mfma_f32_16x16x32_bf16 v[216:219], v[236:239], v[36:39], 0
v_mov_b32 v103, v102
v_cvt_pk_bf16_f32 v235, v202, v203
v_mfma_f32_16x16x32_bf16 v[212:215], v[236:239], v[38:41], 0
v_cvt_pk_bf16_f32 v243, v198, v199
v_permlane32_swap_b32 v102, v103
v_mfma_f32_16x16x32_bf16 v[200:203], v[244:247], v[36:39], 0
v_cvt_pk_bf16_f32 v242, v196, v197
v_mov_b32 v5, 4
v_mfma_f32_16x16x32_bf16 v[220:223], v[232:235], v[120:123], 0
v_cvt_pk_bf16_f32 v249, v218, v219
v_cvt_pk_bf16_f32 v248, v216, v217
v_cvt_pk_bf16_f32 v241, v214, v215
v_cvt_pk_bf16_f32 v240, v212, v213
v_cmp_eq_u32 s[50:51], s41, v2
v_pk_mul_f32 v[64:65], v[64:65], v[100:101] op_sel:[0,0] op_sel_hi:[1,0]
v_pk_mul_f32 v[74:75], v[74:75], v[100:101] op_sel:[0,1] op_sel_hi:[1,1]
v_pk_mul_f32 v[68:69], v[68:69], v[100:101] op_sel:[0,1] op_sel_hi:[1,1]
v_pk_mul_f32 v[72:73], v[72:73], v[100:101] op_sel:[0,1] op_sel_hi:[1,1]
v_pk_mul_f32 v[60:61], v[60:61], v[100:101] op_sel:[0,0] op_sel_hi:[1,0]
v_pk_mul_f32 v[62:63], v[62:63], v[100:101] op_sel:[0,0] op_sel_hi:[1,0]
v_pk_mul_f32 v[66:67], v[66:67], v[100:101] op_sel:[0,0] op_sel_hi:[1,0]
v_pk_mul_f32 v[76:77], v[76:77], v[102:103] op_sel:[0,0] op_sel_hi:[1,0]
v_pk_mul_f32 v[70:71], v[70:71], v[100:101] op_sel:[0,1] op_sel_hi:[1,1]
v_cvt_pk_bf16_f32 v60, v60, v61
v_pk_mul_f32 v[80:81], v[80:81], v[102:103] op_sel:[0,0] op_sel_hi:[1,0]
v_pk_mul_f32 v[78:79], v[78:79], v[102:103] op_sel:[0,0] op_sel_hi:[1,0]
v_pk_mul_f32 v[82:83], v[82:83], v[102:103] op_sel:[0,0] op_sel_hi:[1,0]
v_pk_mul_f32 v[86:87], v[86:87], v[102:103] op_sel:[0,1] op_sel_hi:[1,1]
v_cvt_pk_bf16_f32 v61, v62, v63
v_pk_mul_f32 v[84:85], v[84:85], v[102:103] op_sel:[0,1] op_sel_hi:[1,1]
v_cvt_pk_bf16_f32 v62, v64, v65
v_pk_mul_f32 v[88:89], v[88:89], v[102:103] op_sel:[0,1] op_sel_hi:[1,1]
v_cvt_pk_bf16_f32 v63, v66, v67
v_pk_mul_f32 v[90:91], v[90:91], v[102:103] op_sel:[0,1] op_sel_hi:[1,1]
v_cvt_pk_bf16_f32 v68, v68, v69
v_mfma_f32_16x16x32_bf16 v[208:211], v[60:63], v[36:39], 0
v_cvt_pk_bf16_f32 v69, v70, v71
v_cvt_pk_bf16_f32 v70, v72, v73
v_mfma_f32_16x16x32_bf16 v[204:207], v[60:63], v[38:41], 0
v_cvt_pk_bf16_f32 v71, v74, v75
v_cvt_pk_bf16_f32 v76, v76, v77
v_mfma_f32_16x16x32_bf16 v[60:63], v[232:235], v[112:115], 0
v_cvt_pk_bf16_f32 v250, v200, v201
v_cvt_pk_bf16_f32 v77, v78, v79
v_mfma_f32_16x16x32_bf16 v[192:195], v[68:71], v[36:39], 0
v_cvt_pk_bf16_f32 v78, v80, v81
v_cvt_pk_bf16_f32 v79, v82, v83
v_mfma_f32_16x16x32_bf16 v[188:191], v[68:71], v[38:41], 0
v_cvt_pk_bf16_f32 v65, v206, v207
v_cvt_pk_bf16_f32 v64, v204, v205
v_mfma_f32_16x16x32_bf16 v[68:71], v[224:227], v[120:123], 0
v_cvt_pk_bf16_f32 v251, v202, v203
v_cvt_pk_bf16_f32 v72, v208, v209
v_mfma_f32_16x16x32_bf16 v[152:155], v[224:227], v[112:115], 0
v_cvt_pk_bf16_f32 v73, v210, v211
v_cvt_pk_bf16_f32 v84, v84, v85
v_mfma_f32_16x16x32_bf16 v[60:63], v[248:251], v[116:119], v[60:63]
v_cvt_pk_bf16_f32 v85, v86, v87
v_cvt_pk_bf16_f32 v86, v88, v89
v_mfma_f32_16x16x32_bf16 v[228:231], v[224:227], v[48:51], 0
v_cvt_pk_bf16_f32 v67, v190, v191
v_cvt_pk_bf16_f32 v87, v90, v91
v_mfma_f32_16x16x32_bf16 v[220:223], v[248:251], v[124:127], v[220:223]
v_cvt_pk_bf16_f32 v66, v188, v189
v_cvt_pk_bf16_f32 v74, v192, v193
v_mfma_f32_16x16x32_bf16 v[152:155], v[240:243], v[116:119], v[152:155]
v_cvt_pk_bf16_f32 v75, v194, v195
v_mfma_f32_16x16x32_bf16 v[204:207], v[76:79], v[38:41], 0
v_mfma_f32_16x16x32_bf16 v[208:211], v[76:79], v[36:39], 0
v_mfma_f32_16x16x32_bf16 v[228:231], v[240:243], v[48:51], v[228:231]
v_mfma_f32_16x16x32_bf16 v[68:71], v[240:243], v[124:127], v[68:71]
v_mfma_f32_16x16x32_bf16 v[76:79], v[232:235], v[48:51], 0
s_nop 1
v_cvt_pk_bf16_f32 v152, v152, v153
v_mfma_f32_16x16x32_bf16 v[76:79], v[248:251], v[48:51], v[76:79]
v_cvt_pk_bf16_f32 v153, v154, v155
v_cvt_pk_bf16_f32 v154, v60, v61
v_mfma_f32_16x16x32_bf16 v[192:195], v[84:87], v[36:39], 0
v_cvt_pk_bf16_f32 v68, v68, v69
v_cvt_pk_bf16_f32 v155, v62, v63
v_mfma_f32_16x16x32_bf16 v[188:191], v[84:87], v[38:41], 0
ds_write_b128 v42, v[152:155] offset:0
v_mfma_f32_16x16x32_bf16 v[136:139], v[64:67], v[48:51], 0
v_cvt_pk_bf16_f32 v69, v70, v71
v_cvt_pk_bf16_f32 v228, v228, v229
v_mfma_f32_16x16x32_bf16 v[104:107], v[72:75], v[112:115], 0
v_cvt_pk_bf16_f32 v71, v222, v223
v_cvt_pk_bf16_f32 v229, v230, v231
v_mfma_f32_16x16x32_bf16 v[148:151], v[72:75], v[48:51], 0
v_cvt_pk_bf16_f32 v230, v76, v77
v_cvt_pk_bf16_f32 v70, v220, v221
v_mfma_f32_16x16x32_bf16 v[132:135], v[72:75], v[120:123], 0
ds_write_b128 v42, v[68:71] offset:1024
v_mfma_f32_16x16x32_bf16 v[108:111], v[64:67], v[120:123], 0
v_cvt_pk_bf16_f32 v231, v78, v79
ds_write_b128 v42, v[228:231] offset:2048
v_mfma_f32_16x16x32_bf16 v[100:103], v[64:67], v[112:115], 0
ds_write_b32 v52, v5
v_cvt_pk_bf16_f32 v88, v208, v209
v_cvt_pk_bf16_f32 v83, v190, v191
v_cvt_pk_bf16_f32 v91, v194, v195
v_cvt_pk_bf16_f32 v82, v188, v189
v_cvt_pk_bf16_f32 v80, v204, v205
v_cvt_pk_bf16_f32 v89, v210, v211
v_cvt_pk_bf16_f32 v81, v206, v207
v_cvt_pk_bf16_f32 v90, v192, v193
s_nop 0
v_mfma_f32_16x16x32_bf16 v[100:103], v[80:83], v[116:119], v[100:103]
v_mfma_f32_16x16x32_bf16 v[108:111], v[80:83], v[124:127], v[108:111]
v_mfma_f32_16x16x32_bf16 v[132:135], v[88:91], v[124:127], v[132:135]
v_mfma_f32_16x16x32_bf16 v[148:151], v[88:91], v[48:51], v[148:151]
v_mfma_f32_16x16x32_bf16 v[136:139], v[80:83], v[48:51], v[136:139]
v_mfma_f32_16x16x32_bf16 v[104:107], v[88:91], v[116:119], v[104:107]
s_mov_b32 s63, 0
px_121:
ds_read_b32 v4, v19
ds_read_b128 v[188:191], v43 offset:0
ds_read_b128 v[192:195], v43 offset:1024
ds_read_b128 v[196:199], v43 offset:2048
s_add_u32 s63, s63, 1
s_cmp_lt_u32 s63, 0x400000
s_waitcnt lgkmcnt(0)
v_cmp_ne_u32 vcc, 4, v4
s_cbranch_vccz pxd_122
s_cbranch_scc1 px_121
pxd_122:
v_mfma_f32_16x16x32_bf16 v[100:103], v[38:41], v[188:191], v[100:103]
v_mfma_f32_16x16x32_bf16 v[104:107], v[36:39], v[188:191], v[104:107]
v_mfma_f32_16x16x32_bf16 v[108:111], v[38:41], v[192:195], v[108:111]
v_mfma_f32_16x16x32_bf16 v[132:135], v[36:39], v[192:195], v[132:135]
v_mfma_f32_16x16x32_bf16 v[136:139], v[38:41], v[196:199], v[136:139]
v_mfma_f32_16x16x32_bf16 v[148:151], v[36:39], v[196:199], v[148:151]
s_nop 2
v_cvt_pk_bf16_f32 v100, v100, v101
v_cvt_pk_bf16_f32 v101, v102, v103
v_cvt_pk_bf16_f32 v102, v104, v105
v_cvt_pk_bf16_f32 v103, v106, v107
buffer_store_dwordx4 v[100:103], v55, s[32:35], s53 offen sc1
v_cvt_pk_bf16_f32 v108, v108, v109
v_cvt_pk_bf16_f32 v109, v110, v111
v_cvt_pk_bf16_f32 v110, v132, v133
v_cvt_pk_bf16_f32 v111, v134, v135
buffer_store_dwordx4 v[108:111], v55, s[32:35], s54 offen sc1
v_cvt_pk_bf16_f32 v136, v136, v137
v_cvt_pk_bf16_f32 v137, v138, v139
v_cvt_pk_bf16_f32 v138, v148, v149
v_cvt_pk_bf16_f32 v139, v150, v151
s_mov_b64 exec, s[50:51]
buffer_store_dwordx4 v[136:139], v58, s[32:35], s56 offen sc1
s_mov_b64 exec, -1
s_mov_b32 s51, 0
.p2align 3
v_pk_fma_f32 v[156:157], v[140:141], v[92:93], v[156:157] op_sel:[0,1,0] op_sel_hi:[1,1,1]
v_pk_fma_f32 v[164:165], v[140:141], v[94:95], v[164:165] op_sel:[0,1,0] op_sel_hi:[1,1,1]
v_pk_fma_f32 v[172:173], v[140:141], v[96:97], v[172:173] op_sel:[0,1,0] op_sel_hi:[1,1,1]
v_pk_fma_f32 v[180:181], v[140:141], v[98:99], v[180:181] op_sel:[0,1,0] op_sel_hi:[1,1,1]
v_pk_fma_f32 v[158:159], v[142:143], v[92:93], v[158:159] op_sel:[0,1,0] op_sel_hi:[1,1,1]
v_cvt_pk_bf16_f32 v156, v156, v157
v_pk_fma_f32 v[166:167], v[142:143], v[94:95], v[166:167] op_sel:[0,1,0] op_sel_hi:[1,1,1]
v_cvt_pk_bf16_f32 v164, v164, v165
v_pk_fma_f32 v[174:175], v[142:143], v[96:97], v[174:175] op_sel:[0,1,0] op_sel_hi:[1,1,1]
v_cvt_pk_bf16_f32 v172, v172, v173
v_pk_fma_f32 v[182:183], v[142:143], v[98:99], v[182:183] op_sel:[0,1,0] op_sel_hi:[1,1,1]
v_cvt_pk_bf16_f32 v180, v180, v181
v_pk_fma_f32 v[160:161], v[144:145], v[92:93], v[160:161] op_sel:[0,1,0] op_sel_hi:[1,1,1]
v_pk_fma_f32 v[162:163], v[146:147], v[92:93], v[162:163] op_sel:[0,1,0] op_sel_hi:[1,1,1]
v_cvt_pk_bf16_f32 v157, v158, v159
v_pk_fma_f32 v[168:169], v[144:145], v[94:95], v[168:169] op_sel:[0,1,0] op_sel_hi:[1,1,1]
v_pk_fma_f32 v[170:171], v[146:147], v[94:95], v[170:171] op_sel:[0,1,0] op_sel_hi:[1,1,1]
v_cvt_pk_bf16_f32 v165, v166, v167
v_pk_fma_f32 v[176:177], v[144:145], v[96:97], v[176:177] op_sel:[0,1,0] op_sel_hi:[1,1,1]
v_pk_fma_f32 v[178:179], v[146:147], v[96:97], v[178:179] op_sel:[0,1,0] op_sel_hi:[1,1,1]
v_cvt_pk_bf16_f32 v173, v174, v175
v_pk_fma_f32 v[184:185], v[144:145], v[98:99], v[184:185] op_sel:[0,1,0] op_sel_hi:[1,1,1]
v_pk_fma_f32 v[186:187], v[146:147], v[98:99], v[186:187] op_sel:[0,1,0] op_sel_hi:[1,1,1]
v_cvt_pk_bf16_f32 v181, v182, v183
v_cvt_pk_bf16_f32 v158, v160, v161
v_cvt_pk_bf16_f32 v159, v162, v163
v_cvt_pk_bf16_f32 v166, v168, v169
v_cvt_pk_bf16_f32 v167, v170, v171
v_mfma_f32_16x16x32_bf16 v[60:63], v[10:13], v[156:159], 0
v_cvt_pk_bf16_f32 v174, v176, v177
v_cvt_pk_bf16_f32 v175, v178, v179
v_mfma_f32_16x16x32_bf16 v[68:71], v[10:13], v[164:167], 0
v_cvt_pk_bf16_f32 v182, v184, v185
v_cvt_pk_bf16_f32 v183, v186, v187
v_mfma_f32_16x16x32_bf16 v[76:79], v[10:13], v[172:175], 0
s_nop 0
v_mfma_f32_16x16x32_bf16 v[84:87], v[10:13], v[180:183], 0
v_min3_f32 v104, v60, v61, v62
v_max3_f32 v100, v60, v61, v62
v_mfma_f32_16x16x32_bf16 v[64:67], v[14:17], v[156:159], 0
v_min3_f32 v105, v68, v69, v70
v_max3_f32 v101, v68, v69, v70
v_mfma_f32_16x16x32_bf16 v[72:75], v[14:17], v[164:167], 0
v_min3_f32 v106, v76, v77, v78
v_max3_f32 v102, v76, v77, v78
v_mfma_f32_16x16x32_bf16 v[80:83], v[14:17], v[172:175], 0
v_min3_f32 v107, v84, v85, v86
v_max3_f32 v103, v84, v85, v86
v_mfma_f32_16x16x32_bf16 v[88:91], v[14:17], v[180:183], 0
v_min3_f32 v104, v104, v63, v64
v_max3_f32 v100, v100, v63, v64
v_min3_f32 v105, v105, v71, v72
v_min3_f32 v104, v104, v65, v66
v_max3_f32 v101, v101, v71, v72
v_min3_f32 v106, v106, v79, v80
v_min3_f32 v105, v105, v73, v74
v_max3_f32 v102, v102, v79, v80
v_min3_f32 v107, v107, v87, v88
v_min3_f32 v106, v106, v81, v82
v_max3_f32 v103, v103, v87, v88
v_min3_f32 v107, v107, v89, v90
v_max3_f32 v100, v100, v65, v66
v_min_f32 v104, v104, v67
v_max3_f32 v101, v101, v73, v74
v_min_f32 v105, v105, v75
v_max3_f32 v102, v102, v81, v82
v_min_f32 v106, v106, v83
v_max3_f32 v103, v103, v89, v90
v_min_f32 v107, v107, v91
v_max_f32 v100, v100, v67
v_max_f32 v101, v101, v75
v_max_f32 v102, v102, v83
v_max_f32 v103, v103, v91
v_permlane32_swap_b32 v104, v105
v_permlane32_swap_b32 v106, v107
v_permlane32_swap_b32 v100, v101
v_permlane32_swap_b32 v102, v103
v_min_f32 v104, v104, v105
v_min_f32 v106, v106, v107
v_max_f32 v100, v100, v101
v_max_f32 v102, v102, v103
v_permlane16_swap_b32 v104, v106
s_nop 0
v_permlane16_swap_b32 v100, v102
v_min_f32 v104, v104, v106
v_max_f32 v100, v100, v102
v_mov_b32 v106, v104
v_mov_b32 v102, v100
s_nop 0
v_permlane16_swap_b32 v104, v106
v_permlane16_swap_b32 v100, v102
v_mov_b32 v105, v104
v_mov_b32 v101, v100
v_mov_b32 v103, v102
v_permlane32_swap_b32 v104, v105
v_mov_b32 v107, v106
v_permlane32_swap_b32_e64 v100, v101
v_pk_mul_f32 v[104:105], v[104:105], v[128:129]
v_pk_mul_f32 v[100:101], v[100:101], v[128:129]
v_pk_fma_f32 v[220:221], v[60:61], v[128:129], v[104:105] op_sel:[0,0,0] op_sel_hi:[1,0,0] neg_lo:[1,0,0] neg_hi:[1,0,0]
v_pk_fma_f32 v[222:223], v[62:63], v[128:129], v[104:105] op_sel:[0,0,0] op_sel_hi:[1,0,0] neg_lo:[1,0,0] neg_hi:[1,0,0]
v_pk_fma_f32 v[224:225], v[64:65], v[128:129], v[104:105] op_sel:[0,0,0] op_sel_hi:[1,0,0] neg_lo:[1,0,0] neg_hi:[1,0,0]
v_pk_fma_f32 v[226:227], v[66:67], v[128:129], v[104:105] op_sel:[0,0,0] op_sel_hi:[1,0,0] neg_lo:[1,0,0] neg_hi:[1,0,0]
v_pk_fma_f32 v[228:229], v[68:69], v[128:129], v[104:105] op_sel:[0,1,1] op_sel_hi:[1,1,1] neg_lo:[1,0,0] neg_hi:[1,0,0]
v_pk_fma_f32 v[230:231], v[70:71], v[128:129], v[104:105] op_sel:[0,1,1] op_sel_hi:[1,1,1] neg_lo:[1,0,0] neg_hi:[1,0,0]
v_pk_fma_f32 v[232:233], v[72:73], v[128:129], v[104:105] op_sel:[0,1,1] op_sel_hi:[1,1,1] neg_lo:[1,0,0] neg_hi:[1,0,0]
v_pk_fma_f32 v[234:235], v[74:75], v[128:129], v[104:105] op_sel:[0,1,1] op_sel_hi:[1,1,1] neg_lo:[1,0,0] neg_hi:[1,0,0]
v_permlane32_swap_b32 v102, v103
v_permlane32_swap_b32 v106, v107
v_pk_fma_f32 v[60:61], v[60:61], v[128:129], v[100:101] op_sel:[0,0,0] op_sel_hi:[1,0,0] neg_lo:[0,0,1] neg_hi:[0,0,1]
v_pk_fma_f32 v[62:63], v[62:63], v[128:129], v[100:101] op_sel:[0,0,0] op_sel_hi:[1,0,0] neg_lo:[0,0,1] neg_hi:[0,0,1]
v_pk_fma_f32 v[64:65], v[64:65], v[128:129], v[100:101] op_sel:[0,0,0] op_sel_hi:[1,0,0] neg_lo:[0,0,1] neg_hi:[0,0,1]
v_pk_fma_f32 v[66:67], v[66:67], v[128:129], v[100:101] op_sel:[0,0,0] op_sel_hi:[1,0,0] neg_lo:[0,0,1] neg_hi:[0,0,1]
v_pk_fma_f32 v[68:69], v[68:69], v[128:129], v[100:101] op_sel:[0,1,1] op_sel_hi:[1,1,1] neg_lo:[0,0,1] neg_hi:[0,0,1]
v_pk_fma_f32 v[70:71], v[70:71], v[128:129], v[100:101] op_sel:[0,1,1] op_sel_hi:[1,1,1] neg_lo:[0,0,1] neg_hi:[0,0,1]
v_pk_fma_f32 v[72:73], v[72:73], v[128:129], v[100:101] op_sel:[0,1,1] op_sel_hi:[1,1,1] neg_lo:[0,0,1] neg_hi:[0,0,1]
v_pk_fma_f32 v[74:75], v[74:75], v[128:129], v[100:101] op_sel:[0,1,1] op_sel_hi:[1,1,1] neg_lo:[0,0,1] neg_hi:[0,0,1]
v_exp_f32 v220, v220
v_exp_f32 v60, v60
v_exp_f32 v221, v221
v_exp_f32 v61, v61
v_exp_f32 v222, v222
v_exp_f32 v62, v62
v_exp_f32 v223, v223
v_exp_f32 v63, v63
v_exp_f32 v224, v224
v_exp_f32 v64, v64
v_exp_f32 v225, v225
v_exp_f32 v65, v65
v_exp_f32 v226, v226
v_exp_f32 v66, v66
v_exp_f32 v227, v227
v_exp_f32 v67, v67
v_exp_f32 v228, v228
v_exp_f32 v68, v68
v_exp_f32 v229, v229
v_exp_f32 v69, v69
v_exp_f32 v230, v230
v_exp_f32 v70, v70
v_exp_f32 v231, v231
v_exp_f32 v71, v71
v_exp_f32 v232, v232
v_exp_f32 v72, v72
v_exp_f32 v233, v233
v_exp_f32 v73, v73
v_exp_f32 v234, v234
v_exp_f32 v74, v74
v_exp_f32 v235, v235
v_exp_f32 v75, v75
v_pk_mul_f32 v[102:103], v[102:103], v[130:131]
v_pk_mul_f32 v[106:107], v[106:107], v[130:131]
buffer_load_dwordx4 v[212:215], v18, s[32:35], s55 offen offset:0 sc1
buffer_load_dwordx4 v[216:219], v18, s[32:35], s55 offen offset:1024 sc1
.p2align 3
v_pk_add_f32 v[108:109], v[60:61], v[62:63]
v_pk_add_f32 v[110:111], v[220:221], v[222:223]
v_pk_add_f32 v[108:109], v[108:109], v[64:65]
v_pk_add_f32 v[110:111], v[110:111], v[224:225]
v_pk_add_f32 v[108:109], v[108:109], v[66:67]
v_pk_add_f32 v[110:111], v[110:111], v[226:227]
v_add_f32 v100, v108, v109
v_add_f32 v104, v110, v111
v_pk_fma_f32 v[236:237], v[76:77], v[130:131], v[106:107] op_sel:[0,0,0] op_sel_hi:[1,0,0] neg_lo:[1,0,0] neg_hi:[1,0,0]
v_pk_fma_f32 v[238:239], v[78:79], v[130:131], v[106:107] op_sel:[0,0,0] op_sel_hi:[1,0,0] neg_lo:[1,0,0] neg_hi:[1,0,0]
v_pk_add_f32 v[108:109], v[68:69], v[70:71]
v_pk_add_f32 v[110:111], v[228:229], v[230:231]
v_pk_fma_f32 v[76:77], v[76:77], v[130:131], v[102:103] op_sel:[0,0,0] op_sel_hi:[1,0,0] neg_lo:[0,0,1] neg_hi:[0,0,1]
v_pk_fma_f32 v[78:79], v[78:79], v[130:131], v[102:103] op_sel:[0,0,0] op_sel_hi:[1,0,0] neg_lo:[0,0,1] neg_hi:[0,0,1]
v_pk_fma_f32 v[240:241], v[80:81], v[130:131], v[106:107] op_sel:[0,0,0] op_sel_hi:[1,0,0] neg_lo:[1,0,0] neg_hi:[1,0,0]
v_pk_add_f32 v[108:109], v[108:109], v[72:73]
v_pk_add_f32 v[110:111], v[110:111], v[232:233]
v_exp_f32 v236, v236
v_exp_f32 v76, v76
v_exp_f32 v237, v237
v_exp_f32 v77, v77
v_exp_f32 v238, v238
v_exp_f32 v78, v78
v_exp_f32 v239, v239
v_exp_f32 v79, v79
v_pk_fma_f32 v[80:81], v[80:81], v[130:131], v[102:103] op_sel:[0,0,0] op_sel_hi:[1,0,0] neg_lo:[0,0,1] neg_hi:[0,0,1]
v_pk_fma_f32 v[242:243], v[82:83], v[130:131], v[106:107] op_sel:[0,0,0] op_sel_hi:[1,0,0] neg_lo:[1,0,0] neg_hi:[1,0,0]
v_pk_add_f32 v[108:109], v[108:109], v[74:75]
v_pk_add_f32 v[110:111], v[110:111], v[234:235]
v_exp_f32 v240, v240
v_exp_f32 v80, v80
v_exp_f32 v241, v241
v_exp_f32 v81, v81
v_pk_fma_f32 v[82:83], v[82:83], v[130:131], v[102:103] op_sel:[0,0,0] op_sel_hi:[1,0,0] neg_lo:[0,0,1] neg_hi:[0,0,1]
v_add_f32 v101, v108, v109
v_add_f32 v105, v110, v111
v_exp_f32 v242, v242
v_exp_f32 v82, v82
v_exp_f32 v243, v243
v_exp_f32 v83, v83
v_pk_fma_f32 v[244:245], v[84:85], v[130:131], v[106:107] op_sel:[0,1,1] op_sel_hi:[1,1,1] neg_lo:[1,0,0] neg_hi:[1,0,0]
v_pk_fma_f32 v[246:247], v[86:87], v[130:131], v[106:107] op_sel:[0,1,1] op_sel_hi:[1,1,1] neg_lo:[1,0,0] neg_hi:[1,0,0]
v_pk_add_f32 v[108:109], v[76:77], v[78:79]
v_pk_add_f32 v[110:111], v[236:237], v[238:239]
v_pk_fma_f32 v[84:85], v[84:85], v[130:131], v[102:103] op_sel:[0,1,1] op_sel_hi:[1,1,1] neg_lo:[0,0,1] neg_hi:[0,0,1]
v_pk_fma_f32 v[86:87], v[86:87], v[130:131], v[102:103] op_sel:[0,1,1] op_sel_hi:[1,1,1] neg_lo:[0,0,1] neg_hi:[0,0,1]
v_pk_fma_f32 v[248:249], v[88:89], v[130:131], v[106:107] op_sel:[0,1,1] op_sel_hi:[1,1,1] neg_lo:[1,0,0] neg_hi:[1,0,0]
v_pk_fma_f32 v[250:251], v[90:91], v[130:131], v[106:107] op_sel:[0,1,1] op_sel_hi:[1,1,1] neg_lo:[1,0,0] neg_hi:[1,0,0]
v_pk_add_f32 v[108:109], v[108:109], v[80:81]
v_pk_add_f32 v[110:111], v[110:111], v[240:241]
v_exp_f32 v244, v244
v_exp_f32 v84, v84
v_exp_f32 v245, v245
v_exp_f32 v85, v85
v_exp_f32 v246, v246
v_exp_f32 v86, v86
v_exp_f32 v247, v247
v_exp_f32 v87, v87
v_pk_fma_f32 v[88:89], v[88:89], v[130:131], v[102:103] op_sel:[0,1,1] op_sel_hi:[1,1,1] neg_lo:[0,0,1] neg_hi:[0,0,1]
v_pk_fma_f32 v[90:91], v[90:91], v[130:131], v[102:103] op_sel:[0,1,1] op_sel_hi:[1,1,1] neg_lo:[0,0,1] neg_hi:[0,0,1]
v_pk_add_f32 v[108:109], v[108:109], v[82:83]
v_pk_add_f32 v[110:111], v[110:111], v[242:243]
v_exp_f32 v248, v248
v_exp_f32 v88, v88
v_exp_f32 v249, v249
v_exp_f32 v89, v89
v_add_f32 v102, v108, v109
v_add_f32 v106, v110, v111
v_exp_f32 v250, v250
v_exp_f32 v90, v90
v_exp_f32 v251, v251
v_exp_f32 v91, v91
v_pk_add_f32 v[108:109], v[84:85], v[86:87]
v_pk_add_f32 v[110:111], v[244:245], v[246:247]
v_pk_add_f32 v[108:109], v[108:109], v[88:89]
v_pk_add_f32 v[110:111], v[110:111], v[248:249]
v_pk_add_f32 v[108:109], v[108:109], v[90:91]
v_pk_add_f32 v[110:111], v[110:111], v[250:251]
v_add_f32 v103, v108, v109
v_add_f32 v107, v110, v111
s_cmp_eq_u32 s51, 1
s_cbranch_scc1 chk_123
s_waitcnt vmcnt(0)
v_max_u32 v4, v212, v213
v_max3_u32 v4, v4, v214, v215
v_max3_u32 v4, v4, v216, v217
v_max3_u32 v4, v4, v218, v219
v_cmp_eq_u32 vcc, -1, v4
s_cbranch_vccz red_124
buffer_load_dwordx4 v[212:215], v18, s[32:35], s55 offen offset:0 sc1
buffer_load_dwordx4 v[216:219], v18, s[32:35], s55 offen offset:1024 sc1
s_branch chk_123
red_124:
v_mfma_f32_16x16x32_bf16 v[132:135], v[44:47], v[212:215], 0
v_mfma_f32_16x16x32_bf16 v[132:135], v[44:47], v[216:219], v[132:135]
s_mov_b32 s51, 1
s_nop 6
v_add_f32_dpp v132, v132, v132 row_ror:8 row_mask:0xf bank_mask:0xf
v_add_f32_dpp v133, v133, v133 row_ror:8 row_mask:0xf bank_mask:0xf
v_add_f32_dpp v134, v134, v134 row_ror:8 row_mask:0xf bank_mask:0xf
v_add_f32_dpp v135, v135, v135 row_ror:8 row_mask:0xf bank_mask:0xf
v_cvt_pk_bf16_f32 v132, v132, v133
v_cvt_pk_bf16_f32 v133, v134, v135
s_mov_b64 exec, 0x00ff00ff
buffer_store_dwordx2 v[132:133], v59, s[32:35], s79 offen sc1
s_mov_b64 exec, -1
buffer_load_dwordx4 v[204:207], v58, s[32:35], s56 offen sc1
buffer_load_dwordx4 v[208:211], v58, s[32:35], s57 offen sc1
chk_123:
.p2align 3
v_permlane32_swap_b32 v100, v101
v_permlane32_swap_b32 v102, v103
v_permlane32_swap_b32 v104, v105
v_permlane32_swap_b32 v106, v107
v_add_f32 v100, v100, v101
v_add_f32 v102, v102, v103
v_add_f32 v104, v104, v105
v_add_f32 v106, v106, v107
v_permlane16_swap_b32 v100, v102
s_nop 0
v_permlane16_swap_b32 v104, v106
v_add_f32 v100, v100, v102
v_add_f32 v104, v104, v106
v_rcp_f32 v100, v100
v_rcp_f32 v104, v104
v_mov_b32 v102, v100
v_mov_b32 v106, v104
s_nop 0
v_permlane16_swap_b32 v100, v102
v_permlane16_swap_b32 v104, v106
v_mov_b32 v101, v100
v_mov_b32 v103, v102
v_mov_b32 v105, v104
v_mov_b32 v107, v106
v_permlane32_swap_b32 v100, v101
v_permlane32_swap_b32 v102, v103
v_permlane32_swap_b32 v104, v105
v_permlane32_swap_b32 v106, v107
v_pk_mul_f32 v[60:61], v[60:61], v[100:101] op_sel:[0,0] op_sel_hi:[1,0]
v_pk_mul_f32 v[220:221], v[220:221], v[104:105] op_sel:[0,0] op_sel_hi:[1,0]
v_pk_mul_f32 v[68:69], v[68:69], v[100:101] op_sel:[0,1] op_sel_hi:[1,1]
v_pk_mul_f32 v[228:229], v[228:229], v[104:105] op_sel:[0,1] op_sel_hi:[1,1]
v_pk_mul_f32 v[76:77], v[76:77], v[102:103] op_sel:[0,0] op_sel_hi:[1,0]
v_pk_mul_f32 v[236:237], v[236:237], v[106:107] op_sel:[0,0] op_sel_hi:[1,0]
v_pk_mul_f32 v[84:85], v[84:85], v[102:103] op_sel:[0,1] op_sel_hi:[1,1]
v_pk_mul_f32 v[244:245], v[244:245], v[106:107] op_sel:[0,1] op_sel_hi:[1,1]
v_pk_mul_f32 v[62:63], v[62:63], v[100:101] op_sel:[0,0] op_sel_hi:[1,0]
v_pk_mul_f32 v[222:223], v[222:223], v[104:105] op_sel:[0,0] op_sel_hi:[1,0]
v_cvt_pk_bf16_f32 v60, v60, v61
v_cvt_pk_bf16_f32 v220, v220, v221
v_pk_mul_f32 v[70:71], v[70:71], v[100:101] op_sel:[0,1] op_sel_hi:[1,1]
v_pk_mul_f32 v[230:231], v[230:231], v[104:105] op_sel:[0,1] op_sel_hi:[1,1]
v_cvt_pk_bf16_f32 v68, v68, v69
v_cvt_pk_bf16_f32 v228, v228, v229
v_pk_mul_f32 v[78:79], v[78:79], v[102:103] op_sel:[0,0] op_sel_hi:[1,0]
v_pk_mul_f32 v[238:239], v[238:239], v[106:107] op_sel:[0,0] op_sel_hi:[1,0]
v_cvt_pk_bf16_f32 v76, v76, v77
v_cvt_pk_bf16_f32 v236, v236, v237
v_pk_mul_f32 v[86:87], v[86:87], v[102:103] op_sel:[0,1] op_sel_hi:[1,1]
v_pk_mul_f32 v[246:247], v[246:247], v[106:107] op_sel:[0,1] op_sel_hi:[1,1]
v_cvt_pk_bf16_f32 v84, v84, v85
v_cvt_pk_bf16_f32 v244, v244, v245
v_pk_mul_f32 v[64:65], v[64:65], v[100:101] op_sel:[0,0] op_sel_hi:[1,0]
v_pk_mul_f32 v[66:67], v[66:67], v[100:101] op_sel:[0,0] op_sel_hi:[1,0]
v_pk_mul_f32 v[224:225], v[224:225], v[104:105] op_sel:[0,0] op_sel_hi:[1,0]
v_pk_mul_f32 v[226:227], v[226:227], v[104:105] op_sel:[0,0] op_sel_hi:[1,0]
v_cvt_pk_bf16_f32 v61, v62, v63
v_cvt_pk_bf16_f32 v221, v222, v223
v_pk_mul_f32 v[72:73], v[72:73], v[100:101] op_sel:[0,1] op_sel_hi:[1,1]
v_pk_mul_f32 v[74:75], v[74:75], v[100:101] op_sel:[0,1] op_sel_hi:[1,1]
v_pk_mul_f32 v[232:233], v[232:233], v[104:105] op_sel:[0,1] op_sel_hi:[1,1]
v_pk_mul_f32 v[234:235], v[234:235], v[104:105] op_sel:[0,1] op_sel_hi:[1,1]
v_cvt_pk_bf16_f32 v69, v70, v71
v_cvt_pk_bf16_f32 v229, v230, v231
v_pk_mul_f32 v[80:81], v[80:81], v[102:103] op_sel:[0,0] op_sel_hi:[1,0]
v_pk_mul_f32 v[82:83], v[82:83], v[102:103] op_sel:[0,0] op_sel_hi:[1,0]
v_pk_mul_f32 v[240:241], v[240:241], v[106:107] op_sel:[0,0] op_sel_hi:[1,0]
v_pk_mul_f32 v[242:243], v[242:243], v[106:107] op_sel:[0,0] op_sel_hi:[1,0]
v_cvt_pk_bf16_f32 v77, v78, v79
v_cvt_pk_bf16_f32 v237, v238, v239
v_pk_mul_f32 v[88:89], v[88:89], v[102:103] op_sel:[0,1] op_sel_hi:[1,1]
v_pk_mul_f32 v[90:91], v[90:91], v[102:103] op_sel:[0,1] op_sel_hi:[1,1]
v_pk_mul_f32 v[248:249], v[248:249], v[106:107] op_sel:[0,1] op_sel_hi:[1,1]
v_pk_mul_f32 v[250:251], v[250:251], v[106:107] op_sel:[0,1] op_sel_hi:[1,1]
v_cvt_pk_bf16_f32 v85, v86, v87
v_cvt_pk_bf16_f32 v245, v246, v247
v_cvt_pk_bf16_f32 v62, v64, v65
v_cvt_pk_bf16_f32 v63, v66, v67
v_cvt_pk_bf16_f32 v222, v224, v225
v_cvt_pk_bf16_f32 v223, v226, v227
v_cvt_pk_bf16_f32 v70, v72, v73
v_cvt_pk_bf16_f32 v71, v74, v75
v_cvt_pk_bf16_f32 v230, v232, v233
v_cvt_pk_bf16_f32 v231, v234, v235
v_cvt_pk_bf16_f32 v78, v80, v81
v_cvt_pk_bf16_f32 v79, v82, v83
v_cvt_pk_bf16_f32 v238, v240, v241
v_cvt_pk_bf16_f32 v239, v242, v243
v_cvt_pk_bf16_f32 v86, v88, v89
v_cvt_pk_bf16_f32 v87, v90, v91
v_cvt_pk_bf16_f32 v246, v248, v249
v_cvt_pk_bf16_f32 v247, v250, v251
s_cmp_lg_u32 s51, 0
s_cbranch_scc1 else_125
s_mov_b32 s63, 0
sent_127:
s_waitcnt vmcnt(0)
v_max_u32 v4, v212, v213
v_max3_u32 v4, v4, v214, v215
v_max3_u32 v4, v4, v216, v217
v_max3_u32 v4, v4, v218, v219
v_cmp_eq_u32 vcc, -1, v4
s_cbranch_vccz sentd_128
buffer_load_dwordx4 v[212:215], v18, s[32:35], s55 offen offset:0 sc1
buffer_load_dwordx4 v[216:219], v18, s[32:35], s55 offen offset:1024 sc1
s_add_u32 s63, s63, 1
s_cmp_lt_u32 s63, 0x80000
s_cbranch_scc1 sent_127
s_waitcnt vmcnt(0)
sentd_128:
v_mfma_f32_16x16x32_bf16 v[132:135], v[44:47], v[212:215], 0
v_mfma_f32_16x16x32_bf16 v[132:135], v[44:47], v[216:219], v[132:135]
s_mov_b32 s51, 1
s_nop 6
v_add_f32_dpp v132, v132, v132 row_ror:8 row_mask:0xf bank_mask:0xf
v_add_f32_dpp v133, v133, v133 row_ror:8 row_mask:0xf bank_mask:0xf
v_add_f32_dpp v134, v134, v134 row_ror:8 row_mask:0xf bank_mask:0xf
v_add_f32_dpp v135, v135, v135 row_ror:8 row_mask:0xf bank_mask:0xf
v_cvt_pk_bf16_f32 v132, v132, v133
v_cvt_pk_bf16_f32 v133, v134, v135
s_mov_b64 exec, 0x00ff00ff
buffer_store_dwordx2 v[132:133], v59, s[32:35], s79 offen sc1
s_mov_b64 exec, -1
buffer_load_dwordx4 v[204:207], v58, s[32:35], s56 offen sc1
buffer_load_dwordx4 v[208:211], v58, s[32:35], s57 offen sc1
else_125:
s_mov_b32 s63, 0
sent_129:
s_waitcnt vmcnt(0)
v_max_u32 v4, v204, v205
v_max3_u32 v4, v4, v206, v207
v_max3_u32 v4, v4, v208, v209
v_max3_u32 v4, v4, v210, v211
v_cmp_eq_u32 vcc, -1, v4
s_cbranch_vccz sentd_130
buffer_load_dwordx4 v[204:207], v58, s[32:35], s56 offen sc1
buffer_load_dwordx4 v[208:211], v58, s[32:35], s57 offen sc1
s_add_u32 s63, s63, 1
s_cmp_lt_u32 s63, 0x80000
s_cbranch_scc1 sent_129
s_waitcnt vmcnt(0)
sentd_130:
buffer_load_dwordx4 v[188:191], v18, s[32:35], s58 offen offset:0 sc1
buffer_load_dwordx4 v[192:195], v18, s[32:35], s58 offen offset:1024 sc1
buffer_load_dwordx4 v[196:199], v18, s[32:35], s59 offen offset:0 sc1
buffer_load_dwordx4 v[200:203], v18, s[32:35], s59 offen offset:1024 sc1
v_mfma_f32_16x16x32_bf16 v[112:115], v[204:207], v[60:63], 0
v_mfma_f32_16x16x32_bf16 v[116:119], v[204:207], v[68:71], 0
v_mfma_f32_16x16x32_bf16 v[120:123], v[204:207], v[76:79], 0
v_mfma_f32_16x16x32_bf16 v[124:127], v[204:207], v[84:87], 0
v_mfma_f32_16x16x32_bf16 v[112:115], v[208:211], v[220:223], v[112:115]
v_mfma_f32_16x16x32_bf16 v[116:119], v[208:211], v[228:231], v[116:119]
v_mfma_f32_16x16x32_bf16 v[120:123], v[208:211], v[236:239], v[120:123]
v_mfma_f32_16x16x32_bf16 v[124:127], v[208:211], v[244:247], v[124:127]
s_nop 4
v_add_f32 v100, v112, v113
v_add_f32 v114, v114, v115
v_add_f32 v100, v100, v114
v_add_f32 v101, v116, v117
v_add_f32 v118, v118, v119
v_add_f32 v101, v101, v118
v_add_f32 v102, v120, v121
v_add_f32 v122, v122, v123
v_add_f32 v102, v102, v122
v_add_f32 v103, v124, v125
v_add_f32 v126, v126, v127
v_add_f32 v103, v103, v126
s_nop 1
v_permlane32_swap_b32 v100, v101
v_permlane32_swap_b32 v102, v103
v_add_f32 v100, v100, v101
v_add_f32 v102, v102, v103
s_nop 1
v_permlane16_swap_b32 v100, v102
s_nop 0
v_add_f32 v100, v100, v102
v_add_f32 v100, 0x358637bd, v100
v_rcp_f32 v100, v100
s_nop 0
v_mov_b32 v102, v100
s_nop 1
v_permlane16_swap_b32 v100, v102
s_nop 0
v_mov_b32 v101, v100
v_mov_b32 v103, v102
s_nop 0
v_permlane32_swap_b32 v100, v101
v_permlane32_swap_b32 v102, v103
s_mov_b32 s63, 0
sent_131:
s_waitcnt vmcnt(0)
v_max_u32 v4, v188, v189
v_max3_u32 v4, v4, v190, v191
v_max3_u32 v4, v4, v192, v193
v_max3_u32 v4, v4, v194, v195
v_max3_u32 v4, v4, v196, v197
v_max3_u32 v4, v4, v198, v199
v_max3_u32 v4, v4, v200, v201
v_max3_u32 v4, v4, v202, v203
v_cmp_eq_u32 vcc, -1, v4
s_cbranch_vccz sentd_132
buffer_load_dwordx4 v[188:191], v18, s[32:35], s58 offen offset:0 sc1
buffer_load_dwordx4 v[192:195], v18, s[32:35], s58 offen offset:1024 sc1
buffer_load_dwordx4 v[196:199], v18, s[32:35], s59 offen offset:0 sc1
buffer_load_dwordx4 v[200:203], v18, s[32:35], s59 offen offset:1024 sc1
s_add_u32 s63, s63, 1
s_cmp_lt_u32 s63, 0x80000
s_cbranch_scc1 sent_131
s_waitcnt vmcnt(0)
sentd_132:
s_cmp_eq_u32 s46, 0
s_cbranch_scc1 slow_133
.p2align 3
v_mfma_f32_16x16x32_bf16 v[156:159], v[188:191], v[60:63], 0
v_mfma_f32_16x16x32_bf16 v[164:167], v[188:191], v[68:71], 0
v_mfma_f32_16x16x32_bf16 v[160:163], v[192:195], v[60:63], 0
v_mfma_f32_16x16x32_bf16 v[172:175], v[188:191], v[76:79], 0
v_mfma_f32_16x16x32_bf16 v[168:171], v[192:195], v[68:71], 0
v_mfma_f32_16x16x32_bf16 v[180:183], v[188:191], v[84:87], 0
v_mfma_f32_16x16x32_bf16 v[156:159], v[196:199], v[220:223], v[156:159]
v_mfma_f32_16x16x32_bf16 v[176:179], v[192:195], v[76:79], 0
v_mfma_f32_16x16x32_bf16 v[164:167], v[196:199], v[228:231], v[164:167]
v_mfma_f32_16x16x32_bf16 v[184:187], v[192:195], v[84:87], 0
v_mfma_f32_16x16x32_bf16 v[160:163], v[200:203], v[220:223], v[160:163]
v_mfma_f32_16x16x32_bf16 v[172:175], v[196:199], v[236:239], v[172:175]
v_mfma_f32_16x16x32_bf16 v[168:171], v[200:203], v[228:231], v[168:171]
v_mfma_f32_16x16x32_bf16 v[180:183], v[196:199], v[244:247], v[180:183]
v_mfma_f32_16x16x32_bf16 v[176:179], v[200:203], v[236:239], v[176:179]
v_mfma_f32_16x16x32_bf16 v[184:187], v[200:203], v[244:247], v[184:187]
v_pk_mul_f32 v[156:157], v[156:157], v[100:101] op_sel:[0,0] op_sel_hi:[1,0]
v_pk_mul_f32 v[158:159], v[158:159], v[100:101] op_sel:[0,0] op_sel_hi:[1,0]
v_cvt_pk_bf16_f32 v156, v156, v157
v_pk_mul_f32 v[164:165], v[164:165], v[100:101] op_sel:[0,1] op_sel_hi:[1,1]
v_pk_mul_f32 v[160:161], v[160:161], v[100:101] op_sel:[0,0] op_sel_hi:[1,0]
v_pk_mul_f32 v[162:163], v[162:163], v[100:101] op_sel:[0,0] op_sel_hi:[1,0]
v_cvt_pk_bf16_f32 v157, v158, v159
v_pk_mul_f32 v[166:167], v[166:167], v[100:101] op_sel:[0,1] op_sel_hi:[1,1]
v_cvt_pk_bf16_f32 v164, v164, v165
v_pk_mul_f32 v[172:173], v[172:173], v[102:103] op_sel:[0,0] op_sel_hi:[1,0]
v_cvt_pk_bf16_f32 v158, v160, v161
v_cvt_pk_bf16_f32 v159, v162, v163
v_pk_mul_f32 v[168:169], v[168:169], v[100:101] op_sel:[0,1] op_sel_hi:[1,1]
v_pk_mul_f32 v[170:171], v[170:171], v[100:101] op_sel:[0,1] op_sel_hi:[1,1]
v_cvt_pk_bf16_f32 v165, v166, v167
v_pk_mul_f32 v[174:175], v[174:175], v[102:103] op_sel:[0,0] op_sel_hi:[1,0]
v_cvt_pk_bf16_f32 v172, v172, v173
v_pk_mul_f32 v[180:181], v[180:181], v[102:103] op_sel:[0,1] op_sel_hi:[1,1]
buffer_store_dwordx4 v[156:159], v18, s[32:35], s80 offen
v_cvt_pk_bf16_f32 v166, v168, v169
v_cvt_pk_bf16_f32 v167, v170, v171
v_pk_mul_f32 v[176:177], v[176:177], v[102:103] op_sel:[0,0] op_sel_hi:[1,0]
v_pk_mul_f32 v[178:179], v[178:179], v[102:103] op_sel:[0,0] op_sel_hi:[1,0]
v_cvt_pk_bf16_f32 v173, v174, v175
v_pk_mul_f32 v[182:183], v[182:183], v[102:103] op_sel:[0,1] op_sel_hi:[1,1]
v_cvt_pk_bf16_f32 v180, v180, v181
buffer_store_dwordx4 v[164:167], v18, s[32:35], s81 offen
v_cvt_pk_bf16_f32 v174, v176, v177
v_cvt_pk_bf16_f32 v175, v178, v179
v_pk_mul_f32 v[184:185], v[184:185], v[102:103] op_sel:[0,1] op_sel_hi:[1,1]
v_pk_mul_f32 v[186:187], v[186:187], v[102:103] op_sel:[0,1] op_sel_hi:[1,1]
v_cvt_pk_bf16_f32 v181, v182, v183
buffer_store_dwordx4 v[172:175], v18, s[32:35], s82 offen
v_cvt_pk_bf16_f32 v182, v184, v185
v_cvt_pk_bf16_f32 v183, v186, v187
buffer_store_dwordx4 v[180:183], v18, s[32:35], s83 offen
back_134:
s_barrier
v_and_b32 v36, 31, v0
v_lshlrev_b32 v36, 2, v36
s_lshl_b32 s62, s45, 2
v_mov_b32 v4, s62
v_mov_b32 v5, 4
s_mov_b64 exec, 1
s_waitcnt vmcnt(0)
s_cmp_eq_u32 s46, 0
s_cbranch_scc1 slow_135
buffer_store_dword v5, v4, s[32:35], s84 offen
back_136:
s_mov_b64 exec, -1
v_lshrrev_b32 v4, 2, v2
v_and_b32 v5, 3, v0
v_lshl_add_u32 v6, v3, 3, v4
v_lshlrev_b32 v6, 7, v6
v_lshl_add_u32 v6, v5, 3, v6
v_lshrrev_b32 v7, 1, v4
v_and_b32 v8, 1, v3
v_lshl_add_u32 v7, v8, 1, v7
v_lshl_add_u32 v10, v7, 5, v6
v_xor_b32 v11, 32, v10
v_xor_b32 v12, 64, v10
v_xor_b32 v13, 96, v10
v_add_u32 v14, 0x10000, v10
v_add_u32 v15, 0x10000, v11
v_add_u32 v16, 0x10000, v12
v_add_u32 v17, 0x10000, v13
ds_read_b64_tr_b16 v[220:221], v10 offset:0
ds_read_b64_tr_b16 v[222:223], v10 offset:512
ds_read_b64_tr_b16 v[224:225], v11 offset:0
ds_read_b64_tr_b16 v[226:227], v11 offset:512
ds_read_b64_tr_b16 v[228:229], v12 offset:0
ds_read_b64_tr_b16 v[230:231], v12 offset:512
ds_read_b64_tr_b16 v[232:233], v13 offset:0
ds_read_b64_tr_b16 v[234:235], v13 offset:512
ds_read_b64_tr_b16 v[236:237], v10 offset:4096
ds_read_b64_tr_b16 v[238:239], v10 offset:4608
ds_read_b64_tr_b16 v[240:241], v11 offset:4096
ds_read_b64_tr_b16 v[242:243], v11 offset:4608
ds_read_b64_tr_b16 v[244:245], v12 offset:4096
ds_read_b64_tr_b16 v[246:247], v12 offset:4608
ds_read_b64_tr_b16 v[248:249], v13 offset:4096
ds_read_b64_tr_b16 v[250:251], v13 offset:4608
s_lshl_b32 s48, s41, 3
s_lshl_b32 s49, s40, 1
s_add_u32 s48, s48, s49
s_lshl_b32 s48, s48, 15
s_add_u32 s48, s48, 4194304
v_add_u32 v38, s48, v18
v_add_u32 v39, 32768, v38
s_lshl_b32 s57, s75, 11
s_add_u32 s87, s87, 262144
v_lshlrev_b32 v60, 16, v20
v_and_b32 v61, 0xffff0000, v20
v_lshlrev_b32 v62, 16, v21
v_and_b32 v63, 0xffff0000, v21
v_lshlrev_b32 v64, 16, v22
v_and_b32 v65, 0xffff0000, v22
v_lshlrev_b32 v66, 16, v23
v_and_b32 v67, 0xffff0000, v23
v_lshlrev_b32 v68, 16, v24
v_and_b32 v69, 0xffff0000, v24
v_lshlrev_b32 v70, 16, v25
v_and_b32 v71, 0xffff0000, v25
v_lshlrev_b32 v72, 16, v26
v_and_b32 v73, 0xffff0000, v26
v_lshlrev_b32 v74, 16, v27
v_and_b32 v75, 0xffff0000, v27
v_lshlrev_b32 v76, 16, v28
v_and_b32 v77, 0xffff0000, v28
v_lshlrev_b32 v78, 16, v29
v_and_b32 v79, 0xffff0000, v29
v_lshlrev_b32 v80, 16, v30
v_and_b32 v81, 0xffff0000, v30
v_lshlrev_b32 v82, 16, v31
v_and_b32 v83, 0xffff0000, v31
v_lshlrev_b32 v84, 16, v32
v_and_b32 v85, 0xffff0000, v32
v_lshlrev_b32 v86, 16, v33
v_and_b32 v87, 0xffff0000, v33
v_lshlrev_b32 v88, 16, v34
v_and_b32 v89, 0xffff0000, v34
v_lshlrev_b32 v90, 16, v35
v_and_b32 v91, 0xffff0000, v35
s_lshl_b32 s48, s40, 12
s_add_u32 s48, s48, 139264
v_lshrrev_b32 v4, 1, v2
v_lshrrev_b32 v5, 1, v3
v_xor_b32 v4, v4, v5
v_lshlrev_b32 v4, 4, v4
v_and_b32 v5, 1, v3
v_lshl_add_u32 v4, v5, 3, v4
v_lshl_add_u32 v4, v2, 7, v4
v_add_u32 v42, s48, v4
v_xor_b32 v43, 32, v42
v_xor_b32 v44, 64, v42
v_xor_b32 v45, 96, v42
v_add_u32 v46, s48, v18
s_lshl_b32 s48, s41, 7
s_lshl_b32 s49, s40, 5
s_add_u32 s48, s48, s49
s_lshl_b32 s48, s48, 11
s_lshl_b32 s49, s78, 7
s_add_u32 s48, s48, s49
s_add_u32 s49, s48, 32768
v_lshrrev_b32 v4, 3, v0
v_and_b32 v5, 7, v0
v_lshrrev_b32 v6, 1, v4
v_xor_b32 v5, v5, v6
v_lshlrev_b32 v4, 11, v4
v_lshl_add_u32 v40, v5, 4, v4
v_xor_b32 v41, 64, v40
v_add_u32 v41, 16384, v41
buffer_load_dword v37, v36, s[32:35], s84 offen sc1
s_mov_b32 s63, 0
s_waitcnt vmcnt(0)
poll_137:
v_cmp_gt_u32 vcc, 4, v37
s_cbranch_vccz polled_138
buffer_load_dword v37, v36, s[32:35], s84 offen sc1
s_add_u32 s63, s63, 1
s_cmp_lt_u32 s63, 0x80000
s_waitcnt vmcnt(0)
s_cbranch_scc1 poll_137
polled_138:
buffer_load_dwordx4 v[156:159], v38, s[32:35], s57 offen sc1
buffer_load_dwordx4 v[160:163], v39, s[32:35], s57 offen sc1
buffer_load_dwordx4 v[164:167], v38, s[32:35], s57 offen offset:1024 sc1
buffer_load_dwordx4 v[168:171], v39, s[32:35], s57 offen offset:1024 sc1
s_add_u32 s57, s57, 2048
s_and_b32 s57, s57, 0x7fff
buffer_load_dwordx4 v[172:175], v38, s[32:35], s57 offen sc1
buffer_load_dwordx4 v[176:179], v39, s[32:35], s57 offen sc1
buffer_load_dwordx4 v[180:183], v38, s[32:35], s57 offen offset:1024 sc1
buffer_load_dwordx4 v[184:187], v39, s[32:35], s57 offen offset:1024 sc1
s_add_u32 s57, s57, 2048
s_and_b32 s57, s57, 0x7fff
s_waitcnt vmcnt(6) lgkmcnt(8)
v_mfma_f32_16x16x32_bf16 v[60:63], v[220:223], v[156:159], v[60:63]
buffer_load_dwordx4 v[188:191], v38, s[32:35], s57 offen sc1
v_mfma_f32_16x16x32_bf16 v[76:79], v[220:223], v[160:163], v[76:79]
ds_read_b64_tr_b16 v[100:101], v10 offset:8192
ds_read_b64_tr_b16 v[102:103], v10 offset:8704
v_mfma_f32_16x16x32_bf16 v[80:83], v[224:227], v[160:163], v[80:83]
ds_read_b64_tr_b16 v[104:105], v11 offset:8192
ds_read_b64_tr_b16 v[106:107], v11 offset:8704
v_mfma_f32_16x16x32_bf16 v[64:67], v[224:227], v[156:159], v[64:67]
buffer_load_dwordx4 v[192:195], v39, s[32:35], s57 offen sc1
v_mfma_f32_16x16x32_bf16 v[68:71], v[228:231], v[156:159], v[68:71]
ds_read_b64_tr_b16 v[108:109], v12 offset:8192
ds_read_b64_tr_b16 v[110:111], v12 offset:8704
v_mfma_f32_16x16x32_bf16 v[84:87], v[228:231], v[160:163], v[84:87]
ds_read_b64_tr_b16 v[112:113], v13 offset:8192
ds_read_b64_tr_b16 v[114:115], v13 offset:8704
v_mfma_f32_16x16x32_bf16 v[88:91], v[232:235], v[160:163], v[88:91]
v_mfma_f32_16x16x32_bf16 v[72:75], v[232:235], v[156:159], v[72:75]
s_waitcnt vmcnt(6) lgkmcnt(8)
v_mfma_f32_16x16x32_bf16 v[60:63], v[236:239], v[164:167], v[60:63]
buffer_load_dwordx4 v[196:199], v38, s[32:35], s57 offen offset:1024 sc1
v_mfma_f32_16x16x32_bf16 v[76:79], v[236:239], v[168:171], v[76:79]
ds_read_b64_tr_b16 v[220:221], v10 offset:12288
ds_read_b64_tr_b16 v[222:223], v10 offset:12800
v_mfma_f32_16x16x32_bf16 v[80:83], v[240:243], v[168:171], v[80:83]
ds_read_b64_tr_b16 v[224:225], v11 offset:12288
ds_read_b64_tr_b16 v[226:227], v11 offset:12800
v_mfma_f32_16x16x32_bf16 v[64:67], v[240:243], v[164:167], v[64:67]
buffer_load_dwordx4 v[200:203], v39, s[32:35], s57 offen offset:1024 sc1
v_mfma_f32_16x16x32_bf16 v[68:71], v[244:247], v[164:167], v[68:71]
ds_read_b64_tr_b16 v[228:229], v12 offset:12288
ds_read_b64_tr_b16 v[230:231], v12 offset:12800
v_mfma_f32_16x16x32_bf16 v[84:87], v[244:247], v[168:171], v[84:87]
ds_read_b64_tr_b16 v[232:233], v13 offset:12288
ds_read_b64_tr_b16 v[234:235], v13 offset:12800
v_mfma_f32_16x16x32_bf16 v[88:91], v[248:251], v[168:171], v[88:91]
s_add_u32 s57, s57, 2048
s_and_b32 s57, s57, 0x7fff
v_mfma_f32_16x16x32_bf16 v[72:75], v[248:251], v[164:167], v[72:75]
s_waitcnt vmcnt(6) lgkmcnt(8)
v_mfma_f32_16x16x32_bf16 v[60:63], v[100:103], v[172:175], v[60:63]
buffer_load_dwordx4 v[204:207], v38, s[32:35], s57 offen sc1
v_mfma_f32_16x16x32_bf16 v[76:79], v[100:103], v[176:179], v[76:79]
ds_read_b64_tr_b16 v[236:237], v10 offset:16384
ds_read_b64_tr_b16 v[238:239], v10 offset:16896
v_mfma_f32_16x16x32_bf16 v[80:83], v[104:107], v[176:179], v[80:83]
ds_read_b64_tr_b16 v[240:241], v11 offset:16384
ds_read_b64_tr_b16 v[242:243], v11 offset:16896
v_mfma_f32_16x16x32_bf16 v[64:67], v[104:107], v[172:175], v[64:67]
buffer_load_dwordx4 v[208:211], v39, s[32:35], s57 offen sc1
v_mfma_f32_16x16x32_bf16 v[68:71], v[108:111], v[172:175], v[68:71]
ds_read_b64_tr_b16 v[244:245], v12 offset:16384
ds_read_b64_tr_b16 v[246:247], v12 offset:16896
v_mfma_f32_16x16x32_bf16 v[84:87], v[108:111], v[176:179], v[84:87]
ds_read_b64_tr_b16 v[248:249], v13 offset:16384
ds_read_b64_tr_b16 v[250:251], v13 offset:16896
v_mfma_f32_16x16x32_bf16 v[88:91], v[112:115], v[176:179], v[88:91]
v_mfma_f32_16x16x32_bf16 v[72:75], v[112:115], v[172:175], v[72:75]
s_waitcnt vmcnt(6) lgkmcnt(8)
v_mfma_f32_16x16x32_bf16 v[60:63], v[220:223], v[180:183], v[60:63]
buffer_load_dwordx4 v[212:215], v38, s[32:35], s57 offen offset:1024 sc1
v_mfma_f32_16x16x32_bf16 v[76:79], v[220:223], v[184:187], v[76:79]
ds_read_b64_tr_b16 v[100:101], v10 offset:20480
ds_read_b64_tr_b16 v[102:103], v10 offset:20992
v_mfma_f32_16x16x32_bf16 v[80:83], v[224:227], v[184:187], v[80:83]
ds_read_b64_tr_b16 v[104:105], v11 offset:20480
ds_read_b64_tr_b16 v[106:107], v11 offset:20992
v_mfma_f32_16x16x32_bf16 v[64:67], v[224:227], v[180:183], v[64:67]
buffer_load_dwordx4 v[216:219], v39, s[32:35], s57 offen offset:1024 sc1
v_mfma_f32_16x16x32_bf16 v[68:71], v[228:231], v[180:183], v[68:71]
ds_read_b64_tr_b16 v[108:109], v12 offset:20480
ds_read_b64_tr_b16 v[110:111], v12 offset:20992
v_mfma_f32_16x16x32_bf16 v[84:87], v[228:231], v[184:187], v[84:87]
ds_read_b64_tr_b16 v[112:113], v13 offset:20480
ds_read_b64_tr_b16 v[114:115], v13 offset:20992
v_mfma_f32_16x16x32_bf16 v[88:91], v[232:235], v[184:187], v[88:91]
s_add_u32 s57, s57, 2048
s_and_b32 s57, s57, 0x7fff
v_mfma_f32_16x16x32_bf16 v[72:75], v[232:235], v[180:183], v[72:75]
s_waitcnt vmcnt(6) lgkmcnt(8)
v_mfma_f32_16x16x32_bf16 v[60:63], v[236:239], v[188:191], v[60:63]
buffer_load_dwordx4 v[156:159], v38, s[32:35], s57 offen sc1
v_mfma_f32_16x16x32_bf16 v[76:79], v[236:239], v[192:195], v[76:79]
ds_read_b64_tr_b16 v[220:221], v10 offset:24576
ds_read_b64_tr_b16 v[222:223], v10 offset:25088
v_mfma_f32_16x16x32_bf16 v[80:83], v[240:243], v[192:195], v[80:83]
ds_read_b64_tr_b16 v[224:225], v11 offset:24576
ds_read_b64_tr_b16 v[226:227], v11 offset:25088
v_mfma_f32_16x16x32_bf16 v[64:67], v[240:243], v[188:191], v[64:67]
buffer_load_dwordx4 v[160:163], v39, s[32:35], s57 offen sc1
v_mfma_f32_16x16x32_bf16 v[68:71], v[244:247], v[188:191], v[68:71]
ds_read_b64_tr_b16 v[228:229], v12 offset:24576
ds_read_b64_tr_b16 v[230:231], v12 offset:25088
v_mfma_f32_16x16x32_bf16 v[84:87], v[244:247], v[192:195], v[84:87]
ds_read_b64_tr_b16 v[232:233], v13 offset:24576
ds_read_b64_tr_b16 v[234:235], v13 offset:25088
v_mfma_f32_16x16x32_bf16 v[88:91], v[248:251], v[192:195], v[88:91]
v_mfma_f32_16x16x32_bf16 v[72:75], v[248:251], v[188:191], v[72:75]
s_waitcnt vmcnt(6) lgkmcnt(8)
v_mfma_f32_16x16x32_bf16 v[60:63], v[100:103], v[196:199], v[60:63]
buffer_load_dwordx4 v[164:167], v38, s[32:35], s57 offen offset:1024 sc1
v_mfma_f32_16x16x32_bf16 v[76:79], v[100:103], v[200:203], v[76:79]
ds_read_b64_tr_b16 v[236:237], v10 offset:28672
ds_read_b64_tr_b16 v[238:239], v10 offset:29184
v_mfma_f32_16x16x32_bf16 v[80:83], v[104:107], v[200:203], v[80:83]
ds_read_b64_tr_b16 v[240:241], v11 offset:28672
ds_read_b64_tr_b16 v[242:243], v11 offset:29184
v_mfma_f32_16x16x32_bf16 v[64:67], v[104:107], v[196:199], v[64:67]
buffer_load_dwordx4 v[168:171], v39, s[32:35], s57 offen offset:1024 sc1
v_mfma_f32_16x16x32_bf16 v[68:71], v[108:111], v[196:199], v[68:71]
ds_read_b64_tr_b16 v[244:245], v12 offset:28672
ds_read_b64_tr_b16 v[246:247], v12 offset:29184
v_mfma_f32_16x16x32_bf16 v[84:87], v[108:111], v[200:203], v[84:87]
ds_read_b64_tr_b16 v[248:249], v13 offset:28672
ds_read_b64_tr_b16 v[250:251], v13 offset:29184
v_mfma_f32_16x16x32_bf16 v[88:91], v[112:115], v[200:203], v[88:91]
s_add_u32 s57, s57, 2048
s_and_b32 s57, s57, 0x7fff
v_mfma_f32_16x16x32_bf16 v[72:75], v[112:115], v[196:199], v[72:75]
s_waitcnt vmcnt(6) lgkmcnt(8)
v_mfma_f32_16x16x32_bf16 v[60:63], v[220:223], v[204:207], v[60:63]
buffer_load_dwordx4 v[172:175], v38, s[32:35], s57 offen sc1
v_mfma_f32_16x16x32_bf16 v[76:79], v[220:223], v[208:211], v[76:79]
ds_read_b64_tr_b16 v[100:101], v10 offset:32768
ds_read_b64_tr_b16 v[102:103], v10 offset:33280
v_mfma_f32_16x16x32_bf16 v[80:83], v[224:227], v[208:211], v[80:83]
ds_read_b64_tr_b16 v[104:105], v11 offset:32768
ds_read_b64_tr_b16 v[106:107], v11 offset:33280
v_mfma_f32_16x16x32_bf16 v[64:67], v[224:227], v[204:207], v[64:67]
buffer_load_dwordx4 v[176:179], v39, s[32:35], s57 offen sc1
v_mfma_f32_16x16x32_bf16 v[68:71], v[228:231], v[204:207], v[68:71]
ds_read_b64_tr_b16 v[108:109], v12 offset:32768
ds_read_b64_tr_b16 v[110:111], v12 offset:33280
v_mfma_f32_16x16x32_bf16 v[84:87], v[228:231], v[208:211], v[84:87]
ds_read_b64_tr_b16 v[112:113], v13 offset:32768
ds_read_b64_tr_b16 v[114:115], v13 offset:33280
v_mfma_f32_16x16x32_bf16 v[88:91], v[232:235], v[208:211], v[88:91]
v_mfma_f32_16x16x32_bf16 v[72:75], v[232:235], v[204:207], v[72:75]
s_waitcnt vmcnt(6) lgkmcnt(8)
v_mfma_f32_16x16x32_bf16 v[60:63], v[236:239], v[212:215], v[60:63]
buffer_load_dwordx4 v[180:183], v38, s[32:35], s57 offen offset:1024 sc1
v_mfma_f32_16x16x32_bf16 v[76:79], v[236:239], v[216:219], v[76:79]
ds_read_b64_tr_b16 v[220:221], v10 offset:36864
ds_read_b64_tr_b16 v[222:223], v10 offset:37376
v_mfma_f32_16x16x32_bf16 v[80:83], v[240:243], v[216:219], v[80:83]
ds_read_b64_tr_b16 v[224:225], v11 offset:36864
ds_read_b64_tr_b16 v[226:227], v11 offset:37376
v_mfma_f32_16x16x32_bf16 v[64:67], v[240:243], v[212:215], v[64:67]
buffer_load_dwordx4 v[184:187], v39, s[32:35], s57 offen offset:1024 sc1
v_mfma_f32_16x16x32_bf16 v[68:71], v[244:247], v[212:215], v[68:71]
ds_read_b64_tr_b16 v[228:229], v12 offset:36864
ds_read_b64_tr_b16 v[230:231], v12 offset:37376
v_mfma_f32_16x16x32_bf16 v[84:87], v[244:247], v[216:219], v[84:87]
ds_read_b64_tr_b16 v[232:233], v13 offset:36864
ds_read_b64_tr_b16 v[234:235], v13 offset:37376
v_mfma_f32_16x16x32_bf16 v[88:91], v[248:251], v[216:219], v[88:91]
s_add_u32 s57, s57, 2048
s_and_b32 s57, s57, 0x7fff
v_mfma_f32_16x16x32_bf16 v[72:75], v[248:251], v[212:215], v[72:75]
s_waitcnt vmcnt(6) lgkmcnt(8)
v_mfma_f32_16x16x32_bf16 v[60:63], v[100:103], v[156:159], v[60:63]
buffer_load_dwordx4 v[188:191], v38, s[32:35], s57 offen sc1
v_mfma_f32_16x16x32_bf16 v[76:79], v[100:103], v[160:163], v[76:79]
ds_read_b64_tr_b16 v[236:237], v10 offset:40960
ds_read_b64_tr_b16 v[238:239], v10 offset:41472
v_mfma_f32_16x16x32_bf16 v[80:83], v[104:107], v[160:163], v[80:83]
ds_read_b64_tr_b16 v[240:241], v11 offset:40960
ds_read_b64_tr_b16 v[242:243], v11 offset:41472
v_mfma_f32_16x16x32_bf16 v[64:67], v[104:107], v[156:159], v[64:67]
buffer_load_dwordx4 v[192:195], v39, s[32:35], s57 offen sc1
v_mfma_f32_16x16x32_bf16 v[68:71], v[108:111], v[156:159], v[68:71]
ds_read_b64_tr_b16 v[244:245], v12 offset:40960
ds_read_b64_tr_b16 v[246:247], v12 offset:41472
v_mfma_f32_16x16x32_bf16 v[84:87], v[108:111], v[160:163], v[84:87]
ds_read_b64_tr_b16 v[248:249], v13 offset:40960
ds_read_b64_tr_b16 v[250:251], v13 offset:41472
v_mfma_f32_16x16x32_bf16 v[88:91], v[112:115], v[160:163], v[88:91]
v_mfma_f32_16x16x32_bf16 v[72:75], v[112:115], v[156:159], v[72:75]
s_waitcnt vmcnt(6) lgkmcnt(8)
v_mfma_f32_16x16x32_bf16 v[60:63], v[220:223], v[164:167], v[60:63]
buffer_load_dwordx4 v[196:199], v38, s[32:35], s57 offen offset:1024 sc1
v_mfma_f32_16x16x32_bf16 v[76:79], v[220:223], v[168:171], v[76:79]
ds_read_b64_tr_b16 v[100:101], v10 offset:45056
ds_read_b64_tr_b16 v[102:103], v10 offset:45568
v_mfma_f32_16x16x32_bf16 v[80:83], v[224:227], v[168:171], v[80:83]
ds_read_b64_tr_b16 v[104:105], v11 offset:45056
ds_read_b64_tr_b16 v[106:107], v11 offset:45568
v_mfma_f32_16x16x32_bf16 v[64:67], v[224:227], v[164:167], v[64:67]
buffer_load_dwordx4 v[200:203], v39, s[32:35], s57 offen offset:1024 sc1
v_mfma_f32_16x16x32_bf16 v[68:71], v[228:231], v[164:167], v[68:71]
ds_read_b64_tr_b16 v[108:109], v12 offset:45056
ds_read_b64_tr_b16 v[110:111], v12 offset:45568
v_mfma_f32_16x16x32_bf16 v[84:87], v[228:231], v[168:171], v[84:87]
ds_read_b64_tr_b16 v[112:113], v13 offset:45056
ds_read_b64_tr_b16 v[114:115], v13 offset:45568
v_mfma_f32_16x16x32_bf16 v[88:91], v[232:235], v[168:171], v[88:91]
s_add_u32 s57, s57, 2048
s_and_b32 s57, s57, 0x7fff
v_mfma_f32_16x16x32_bf16 v[72:75], v[232:235], v[164:167], v[72:75]
s_waitcnt vmcnt(6) lgkmcnt(8)
v_mfma_f32_16x16x32_bf16 v[60:63], v[236:239], v[172:175], v[60:63]
buffer_load_dwordx4 v[204:207], v38, s[32:35], s57 offen sc1
v_mfma_f32_16x16x32_bf16 v[76:79], v[236:239], v[176:179], v[76:79]
ds_read_b64_tr_b16 v[220:221], v10 offset:49152
ds_read_b64_tr_b16 v[222:223], v10 offset:49664
v_mfma_f32_16x16x32_bf16 v[80:83], v[240:243], v[176:179], v[80:83]
ds_read_b64_tr_b16 v[224:225], v11 offset:49152
ds_read_b64_tr_b16 v[226:227], v11 offset:49664
v_mfma_f32_16x16x32_bf16 v[64:67], v[240:243], v[172:175], v[64:67]
buffer_load_dwordx4 v[208:211], v39, s[32:35], s57 offen sc1
v_mfma_f32_16x16x32_bf16 v[68:71], v[244:247], v[172:175], v[68:71]
ds_read_b64_tr_b16 v[228:229], v12 offset:49152
ds_read_b64_tr_b16 v[230:231], v12 offset:49664
v_mfma_f32_16x16x32_bf16 v[84:87], v[244:247], v[176:179], v[84:87]
ds_read_b64_tr_b16 v[232:233], v13 offset:49152
ds_read_b64_tr_b16 v[234:235], v13 offset:49664
v_mfma_f32_16x16x32_bf16 v[88:91], v[248:251], v[176:179], v[88:91]
v_mfma_f32_16x16x32_bf16 v[72:75], v[248:251], v[172:175], v[72:75]
s_waitcnt vmcnt(6) lgkmcnt(8)
v_mfma_f32_16x16x32_bf16 v[60:63], v[100:103], v[180:183], v[60:63]
buffer_load_dwordx4 v[212:215], v38, s[32:35], s57 offen offset:1024 sc1
v_mfma_f32_16x16x32_bf16 v[76:79], v[100:103], v[184:187], v[76:79]
ds_read_b64_tr_b16 v[236:237], v10 offset:53248
ds_read_b64_tr_b16 v[238:239], v10 offset:53760
v_mfma_f32_16x16x32_bf16 v[80:83], v[104:107], v[184:187], v[80:83]
ds_read_b64_tr_b16 v[240:241], v11 offset:53248
ds_read_b64_tr_b16 v[242:243], v11 offset:53760
v_mfma_f32_16x16x32_bf16 v[64:67], v[104:107], v[180:183], v[64:67]
buffer_load_dwordx4 v[216:219], v39, s[32:35], s57 offen offset:1024 sc1
v_mfma_f32_16x16x32_bf16 v[68:71], v[108:111], v[180:183], v[68:71]
ds_read_b64_tr_b16 v[244:245], v12 offset:53248
ds_read_b64_tr_b16 v[246:247], v12 offset:53760
v_mfma_f32_16x16x32_bf16 v[84:87], v[108:111], v[184:187], v[84:87]
ds_read_b64_tr_b16 v[248:249], v13 offset:53248
ds_read_b64_tr_b16 v[250:251], v13 offset:53760
v_mfma_f32_16x16x32_bf16 v[88:91], v[112:115], v[184:187], v[88:91]
s_add_u32 s57, s57, 2048
s_and_b32 s57, s57, 0x7fff
v_mfma_f32_16x16x32_bf16 v[72:75], v[112:115], v[180:183], v[72:75]
s_waitcnt vmcnt(6) lgkmcnt(8)
v_mfma_f32_16x16x32_bf16 v[60:63], v[220:223], v[188:191], v[60:63]
buffer_load_dwordx4 v[156:159], v38, s[32:35], s57 offen sc1
v_mfma_f32_16x16x32_bf16 v[76:79], v[220:223], v[192:195], v[76:79]
ds_read_b64_tr_b16 v[100:101], v10 offset:57344
ds_read_b64_tr_b16 v[102:103], v10 offset:57856
v_mfma_f32_16x16x32_bf16 v[80:83], v[224:227], v[192:195], v[80:83]
ds_read_b64_tr_b16 v[104:105], v11 offset:57344
ds_read_b64_tr_b16 v[106:107], v11 offset:57856
v_mfma_f32_16x16x32_bf16 v[64:67], v[224:227], v[188:191], v[64:67]
buffer_load_dwordx4 v[160:163], v39, s[32:35], s57 offen sc1
v_mfma_f32_16x16x32_bf16 v[68:71], v[228:231], v[188:191], v[68:71]
ds_read_b64_tr_b16 v[108:109], v12 offset:57344
ds_read_b64_tr_b16 v[110:111], v12 offset:57856
v_mfma_f32_16x16x32_bf16 v[84:87], v[228:231], v[192:195], v[84:87]
ds_read_b64_tr_b16 v[112:113], v13 offset:57344
ds_read_b64_tr_b16 v[114:115], v13 offset:57856
v_mfma_f32_16x16x32_bf16 v[88:91], v[232:235], v[192:195], v[88:91]
v_mfma_f32_16x16x32_bf16 v[72:75], v[232:235], v[188:191], v[72:75]
s_waitcnt vmcnt(6) lgkmcnt(8)
v_mfma_f32_16x16x32_bf16 v[60:63], v[236:239], v[196:199], v[60:63]
buffer_load_dwordx4 v[164:167], v38, s[32:35], s57 offen offset:1024 sc1
v_mfma_f32_16x16x32_bf16 v[76:79], v[236:239], v[200:203], v[76:79]
ds_read_b64_tr_b16 v[220:221], v10 offset:61440
ds_read_b64_tr_b16 v[222:223], v10 offset:61952
v_mfma_f32_16x16x32_bf16 v[80:83], v[240:243], v[200:203], v[80:83]
ds_read_b64_tr_b16 v[224:225], v11 offset:61440
ds_read_b64_tr_b16 v[226:227], v11 offset:61952
v_mfma_f32_16x16x32_bf16 v[64:67], v[240:243], v[196:199], v[64:67]
buffer_load_dwordx4 v[168:171], v39, s[32:35], s57 offen offset:1024 sc1
v_mfma_f32_16x16x32_bf16 v[68:71], v[244:247], v[196:199], v[68:71]
ds_read_b64_tr_b16 v[228:229], v12 offset:61440
ds_read_b64_tr_b16 v[230:231], v12 offset:61952
v_mfma_f32_16x16x32_bf16 v[84:87], v[244:247], v[200:203], v[84:87]
ds_read_b64_tr_b16 v[232:233], v13 offset:61440
ds_read_b64_tr_b16 v[234:235], v13 offset:61952
v_mfma_f32_16x16x32_bf16 v[88:91], v[248:251], v[200:203], v[88:91]
s_add_u32 s57, s57, 2048
s_and_b32 s57, s57, 0x7fff
v_mfma_f32_16x16x32_bf16 v[72:75], v[248:251], v[196:199], v[72:75]
s_waitcnt vmcnt(6) lgkmcnt(8)
v_mfma_f32_16x16x32_bf16 v[60:63], v[100:103], v[204:207], v[60:63]
buffer_load_dwordx4 v[172:175], v38, s[32:35], s57 offen sc1
v_mfma_f32_16x16x32_bf16 v[76:79], v[100:103], v[208:211], v[76:79]
ds_read_b64_tr_b16 v[236:237], v14 offset:0
ds_read_b64_tr_b16 v[238:239], v14 offset:512
v_mfma_f32_16x16x32_bf16 v[80:83], v[104:107], v[208:211], v[80:83]
ds_read_b64_tr_b16 v[240:241], v15 offset:0
ds_read_b64_tr_b16 v[242:243], v15 offset:512
v_mfma_f32_16x16x32_bf16 v[64:67], v[104:107], v[204:207], v[64:67]
buffer_load_dwordx4 v[176:179], v39, s[32:35], s57 offen sc1
v_mfma_f32_16x16x32_bf16 v[68:71], v[108:111], v[204:207], v[68:71]
ds_read_b64_tr_b16 v[244:245], v16 offset:0
ds_read_b64_tr_b16 v[246:247], v16 offset:512
v_mfma_f32_16x16x32_bf16 v[84:87], v[108:111], v[208:211], v[84:87]
ds_read_b64_tr_b16 v[248:249], v17 offset:0
ds_read_b64_tr_b16 v[250:251], v17 offset:512
v_mfma_f32_16x16x32_bf16 v[88:91], v[112:115], v[208:211], v[88:91]
v_mfma_f32_16x16x32_bf16 v[72:75], v[112:115], v[204:207], v[72:75]
s_waitcnt vmcnt(6) lgkmcnt(8)
v_mfma_f32_16x16x32_bf16 v[60:63], v[220:223], v[212:215], v[60:63]
buffer_load_dwordx4 v[180:183], v38, s[32:35], s57 offen offset:1024 sc1
v_mfma_f32_16x16x32_bf16 v[76:79], v[220:223], v[216:219], v[76:79]
ds_read_b64_tr_b16 v[100:101], v14 offset:4096
ds_read_b64_tr_b16 v[102:103], v14 offset:4608
v_mfma_f32_16x16x32_bf16 v[80:83], v[224:227], v[216:219], v[80:83]
ds_read_b64_tr_b16 v[104:105], v15 offset:4096
ds_read_b64_tr_b16 v[106:107], v15 offset:4608
v_mfma_f32_16x16x32_bf16 v[64:67], v[224:227], v[212:215], v[64:67]
buffer_load_dwordx4 v[184:187], v39, s[32:35], s57 offen offset:1024 sc1
v_mfma_f32_16x16x32_bf16 v[68:71], v[228:231], v[212:215], v[68:71]
ds_read_b64_tr_b16 v[108:109], v16 offset:4096
ds_read_b64_tr_b16 v[110:111], v16 offset:4608
v_mfma_f32_16x16x32_bf16 v[84:87], v[228:231], v[216:219], v[84:87]
ds_read_b64_tr_b16 v[112:113], v17 offset:4096
ds_read_b64_tr_b16 v[114:115], v17 offset:4608
v_mfma_f32_16x16x32_bf16 v[88:91], v[232:235], v[216:219], v[88:91]
s_add_u32 s57, s57, 2048
s_and_b32 s57, s57, 0x7fff
v_mfma_f32_16x16x32_bf16 v[72:75], v[232:235], v[212:215], v[72:75]
s_waitcnt vmcnt(6) lgkmcnt(8)
v_mfma_f32_16x16x32_bf16 v[60:63], v[236:239], v[156:159], v[60:63]
buffer_load_dwordx4 v[188:191], v38, s[32:35], s57 offen sc1
v_mfma_f32_16x16x32_bf16 v[76:79], v[236:239], v[160:163], v[76:79]
ds_read_b64_tr_b16 v[220:221], v14 offset:8192
ds_read_b64_tr_b16 v[222:223], v14 offset:8704
v_mfma_f32_16x16x32_bf16 v[80:83], v[240:243], v[160:163], v[80:83]
ds_read_b64_tr_b16 v[224:225], v15 offset:8192
ds_read_b64_tr_b16 v[226:227], v15 offset:8704
v_mfma_f32_16x16x32_bf16 v[64:67], v[240:243], v[156:159], v[64:67]
buffer_load_dwordx4 v[192:195], v39, s[32:35], s57 offen sc1
v_mfma_f32_16x16x32_bf16 v[68:71], v[244:247], v[156:159], v[68:71]
ds_read_b64_tr_b16 v[228:229], v16 offset:8192
ds_read_b64_tr_b16 v[230:231], v16 offset:8704
v_mfma_f32_16x16x32_bf16 v[84:87], v[244:247], v[160:163], v[84:87]
ds_read_b64_tr_b16 v[232:233], v17 offset:8192
ds_read_b64_tr_b16 v[234:235], v17 offset:8704
v_mfma_f32_16x16x32_bf16 v[88:91], v[248:251], v[160:163], v[88:91]
v_mfma_f32_16x16x32_bf16 v[72:75], v[248:251], v[156:159], v[72:75]
s_waitcnt vmcnt(6) lgkmcnt(8)
v_mfma_f32_16x16x32_bf16 v[60:63], v[100:103], v[164:167], v[60:63]
buffer_load_dwordx4 v[196:199], v38, s[32:35], s57 offen offset:1024 sc1
v_mfma_f32_16x16x32_bf16 v[76:79], v[100:103], v[168:171], v[76:79]
ds_read_b64_tr_b16 v[236:237], v14 offset:12288
ds_read_b64_tr_b16 v[238:239], v14 offset:12800
v_mfma_f32_16x16x32_bf16 v[80:83], v[104:107], v[168:171], v[80:83]
ds_read_b64_tr_b16 v[240:241], v15 offset:12288
ds_read_b64_tr_b16 v[242:243], v15 offset:12800
v_mfma_f32_16x16x32_bf16 v[64:67], v[104:107], v[164:167], v[64:67]
buffer_load_dwordx4 v[200:203], v39, s[32:35], s57 offen offset:1024 sc1
v_mfma_f32_16x16x32_bf16 v[68:71], v[108:111], v[164:167], v[68:71]
ds_read_b64_tr_b16 v[244:245], v16 offset:12288
ds_read_b64_tr_b16 v[246:247], v16 offset:12800
v_mfma_f32_16x16x32_bf16 v[84:87], v[108:111], v[168:171], v[84:87]
ds_read_b64_tr_b16 v[248:249], v17 offset:12288
ds_read_b64_tr_b16 v[250:251], v17 offset:12800
v_mfma_f32_16x16x32_bf16 v[88:91], v[112:115], v[168:171], v[88:91]
s_add_u32 s57, s57, 2048
s_and_b32 s57, s57, 0x7fff
v_mfma_f32_16x16x32_bf16 v[72:75], v[112:115], v[164:167], v[72:75]
s_waitcnt vmcnt(6) lgkmcnt(8)
v_mfma_f32_16x16x32_bf16 v[60:63], v[220:223], v[172:175], v[60:63]
buffer_load_dwordx4 v[204:207], v38, s[32:35], s57 offen sc1
v_mfma_f32_16x16x32_bf16 v[76:79], v[220:223], v[176:179], v[76:79]
ds_read_b64_tr_b16 v[100:101], v14 offset:16384
ds_read_b64_tr_b16 v[102:103], v14 offset:16896
v_mfma_f32_16x16x32_bf16 v[80:83], v[224:227], v[176:179], v[80:83]
ds_read_b64_tr_b16 v[104:105], v15 offset:16384
ds_read_b64_tr_b16 v[106:107], v15 offset:16896
v_mfma_f32_16x16x32_bf16 v[64:67], v[224:227], v[172:175], v[64:67]
buffer_load_dwordx4 v[208:211], v39, s[32:35], s57 offen sc1
v_mfma_f32_16x16x32_bf16 v[68:71], v[228:231], v[172:175], v[68:71]
ds_read_b64_tr_b16 v[108:109], v16 offset:16384
ds_read_b64_tr_b16 v[110:111], v16 offset:16896
v_mfma_f32_16x16x32_bf16 v[84:87], v[228:231], v[176:179], v[84:87]
ds_read_b64_tr_b16 v[112:113], v17 offset:16384
ds_read_b64_tr_b16 v[114:115], v17 offset:16896
v_mfma_f32_16x16x32_bf16 v[88:91], v[232:235], v[176:179], v[88:91]
v_mfma_f32_16x16x32_bf16 v[72:75], v[232:235], v[172:175], v[72:75]
s_waitcnt vmcnt(6) lgkmcnt(8)
v_mfma_f32_16x16x32_bf16 v[60:63], v[236:239], v[180:183], v[60:63]
buffer_load_dwordx4 v[212:215], v38, s[32:35], s57 offen offset:1024 sc1
v_mfma_f32_16x16x32_bf16 v[76:79], v[236:239], v[184:187], v[76:79]
ds_read_b64_tr_b16 v[220:221], v14 offset:20480
ds_read_b64_tr_b16 v[222:223], v14 offset:20992
v_mfma_f32_16x16x32_bf16 v[80:83], v[240:243], v[184:187], v[80:83]
ds_read_b64_tr_b16 v[224:225], v15 offset:20480
ds_read_b64_tr_b16 v[226:227], v15 offset:20992
v_mfma_f32_16x16x32_bf16 v[64:67], v[240:243], v[180:183], v[64:67]
buffer_load_dwordx4 v[216:219], v39, s[32:35], s57 offen offset:1024 sc1
v_mfma_f32_16x16x32_bf16 v[68:71], v[244:247], v[180:183], v[68:71]
ds_read_b64_tr_b16 v[228:229], v16 offset:20480
ds_read_b64_tr_b16 v[230:231], v16 offset:20992
v_mfma_f32_16x16x32_bf16 v[84:87], v[244:247], v[184:187], v[84:87]
ds_read_b64_tr_b16 v[232:233], v17 offset:20480
ds_read_b64_tr_b16 v[234:235], v17 offset:20992
v_mfma_f32_16x16x32_bf16 v[88:91], v[248:251], v[184:187], v[88:91]
s_add_u32 s57, s57, 2048
s_and_b32 s57, s57, 0x7fff
v_mfma_f32_16x16x32_bf16 v[72:75], v[248:251], v[180:183], v[72:75]
s_waitcnt vmcnt(6) lgkmcnt(8)
v_mfma_f32_16x16x32_bf16 v[60:63], v[100:103], v[188:191], v[60:63]
buffer_load_dwordx4 v[156:159], v38, s[32:35], s57 offen sc1
v_mfma_f32_16x16x32_bf16 v[76:79], v[100:103], v[192:195], v[76:79]
ds_read_b64_tr_b16 v[236:237], v14 offset:24576
ds_read_b64_tr_b16 v[238:239], v14 offset:25088
v_mfma_f32_16x16x32_bf16 v[80:83], v[104:107], v[192:195], v[80:83]
ds_read_b64_tr_b16 v[240:241], v15 offset:24576
ds_read_b64_tr_b16 v[242:243], v15 offset:25088
v_mfma_f32_16x16x32_bf16 v[64:67], v[104:107], v[188:191], v[64:67]
buffer_load_dwordx4 v[160:163], v39, s[32:35], s57 offen sc1
v_mfma_f32_16x16x32_bf16 v[68:71], v[108:111], v[188:191], v[68:71]
ds_read_b64_tr_b16 v[244:245], v16 offset:24576
ds_read_b64_tr_b16 v[246:247], v16 offset:25088
v_mfma_f32_16x16x32_bf16 v[84:87], v[108:111], v[192:195], v[84:87]
ds_read_b64_tr_b16 v[248:249], v17 offset:24576
ds_read_b64_tr_b16 v[250:251], v17 offset:25088
v_mfma_f32_16x16x32_bf16 v[88:91], v[112:115], v[192:195], v[88:91]
v_mfma_f32_16x16x32_bf16 v[72:75], v[112:115], v[188:191], v[72:75]
s_waitcnt vmcnt(6) lgkmcnt(8)
v_mfma_f32_16x16x32_bf16 v[60:63], v[220:223], v[196:199], v[60:63]
buffer_load_dwordx4 v[164:167], v38, s[32:35], s57 offen offset:1024 sc1
v_mfma_f32_16x16x32_bf16 v[76:79], v[220:223], v[200:203], v[76:79]
ds_read_b64_tr_b16 v[100:101], v14 offset:28672
ds_read_b64_tr_b16 v[102:103], v14 offset:29184
v_mfma_f32_16x16x32_bf16 v[80:83], v[224:227], v[200:203], v[80:83]
ds_read_b64_tr_b16 v[104:105], v15 offset:28672
ds_read_b64_tr_b16 v[106:107], v15 offset:29184
v_mfma_f32_16x16x32_bf16 v[64:67], v[224:227], v[196:199], v[64:67]
buffer_load_dwordx4 v[168:171], v39, s[32:35], s57 offen offset:1024 sc1
v_mfma_f32_16x16x32_bf16 v[68:71], v[228:231], v[196:199], v[68:71]
ds_read_b64_tr_b16 v[108:109], v16 offset:28672
ds_read_b64_tr_b16 v[110:111], v16 offset:29184
v_mfma_f32_16x16x32_bf16 v[84:87], v[228:231], v[200:203], v[84:87]
ds_read_b64_tr_b16 v[112:113], v17 offset:28672
ds_read_b64_tr_b16 v[114:115], v17 offset:29184
v_mfma_f32_16x16x32_bf16 v[88:91], v[232:235], v[200:203], v[88:91]
s_add_u32 s57, s57, 2048
s_and_b32 s57, s57, 0x7fff
v_mfma_f32_16x16x32_bf16 v[72:75], v[232:235], v[196:199], v[72:75]
s_waitcnt vmcnt(6) lgkmcnt(8)
v_mfma_f32_16x16x32_bf16 v[60:63], v[236:239], v[204:207], v[60:63]
buffer_load_dwordx4 v[172:175], v38, s[32:35], s57 offen sc1
v_mfma_f32_16x16x32_bf16 v[76:79], v[236:239], v[208:211], v[76:79]
ds_read_b64_tr_b16 v[220:221], v14 offset:32768
ds_read_b64_tr_b16 v[222:223], v14 offset:33280
v_mfma_f32_16x16x32_bf16 v[80:83], v[240:243], v[208:211], v[80:83]
ds_read_b64_tr_b16 v[224:225], v15 offset:32768
ds_read_b64_tr_b16 v[226:227], v15 offset:33280
v_mfma_f32_16x16x32_bf16 v[64:67], v[240:243], v[204:207], v[64:67]
buffer_load_dwordx4 v[176:179], v39, s[32:35], s57 offen sc1
v_mfma_f32_16x16x32_bf16 v[68:71], v[244:247], v[204:207], v[68:71]
ds_read_b64_tr_b16 v[228:229], v16 offset:32768
ds_read_b64_tr_b16 v[230:231], v16 offset:33280
v_mfma_f32_16x16x32_bf16 v[84:87], v[244:247], v[208:211], v[84:87]
ds_read_b64_tr_b16 v[232:233], v17 offset:32768
ds_read_b64_tr_b16 v[234:235], v17 offset:33280
v_mfma_f32_16x16x32_bf16 v[88:91], v[248:251], v[208:211], v[88:91]
v_mfma_f32_16x16x32_bf16 v[72:75], v[248:251], v[204:207], v[72:75]
s_waitcnt vmcnt(6) lgkmcnt(8)
v_mfma_f32_16x16x32_bf16 v[60:63], v[100:103], v[212:215], v[60:63]
buffer_load_dwordx4 v[180:183], v38, s[32:35], s57 offen offset:1024 sc1
v_mfma_f32_16x16x32_bf16 v[76:79], v[100:103], v[216:219], v[76:79]
ds_read_b64_tr_b16 v[236:237], v14 offset:36864
ds_read_b64_tr_b16 v[238:239], v14 offset:37376
v_mfma_f32_16x16x32_bf16 v[80:83], v[104:107], v[216:219], v[80:83]
ds_read_b64_tr_b16 v[240:241], v15 offset:36864
ds_read_b64_tr_b16 v[242:243], v15 offset:37376
v_mfma_f32_16x16x32_bf16 v[64:67], v[104:107], v[212:215], v[64:67]
buffer_load_dwordx4 v[184:187], v39, s[32:35], s57 offen offset:1024 sc1
v_mfma_f32_16x16x32_bf16 v[68:71], v[108:111], v[212:215], v[68:71]
ds_read_b64_tr_b16 v[244:245], v16 offset:36864
ds_read_b64_tr_b16 v[246:247], v16 offset:37376
v_mfma_f32_16x16x32_bf16 v[84:87], v[108:111], v[216:219], v[84:87]
ds_read_b64_tr_b16 v[248:249], v17 offset:36864
ds_read_b64_tr_b16 v[250:251], v17 offset:37376
v_mfma_f32_16x16x32_bf16 v[88:91], v[112:115], v[216:219], v[88:91]
s_add_u32 s57, s57, 2048
s_and_b32 s57, s57, 0x7fff
v_mfma_f32_16x16x32_bf16 v[72:75], v[112:115], v[212:215], v[72:75]
s_waitcnt vmcnt(6) lgkmcnt(8)
v_mfma_f32_16x16x32_bf16 v[60:63], v[220:223], v[156:159], v[60:63]
buffer_load_dwordx4 v[188:191], v38, s[32:35], s57 offen sc1
v_mfma_f32_16x16x32_bf16 v[76:79], v[220:223], v[160:163], v[76:79]
ds_read_b64_tr_b16 v[100:101], v14 offset:40960
ds_read_b64_tr_b16 v[102:103], v14 offset:41472
v_mfma_f32_16x16x32_bf16 v[80:83], v[224:227], v[160:163], v[80:83]
ds_read_b64_tr_b16 v[104:105], v15 offset:40960
ds_read_b64_tr_b16 v[106:107], v15 offset:41472
v_mfma_f32_16x16x32_bf16 v[64:67], v[224:227], v[156:159], v[64:67]
buffer_load_dwordx4 v[192:195], v39, s[32:35], s57 offen sc1
v_mfma_f32_16x16x32_bf16 v[68:71], v[228:231], v[156:159], v[68:71]
ds_read_b64_tr_b16 v[108:109], v16 offset:40960
ds_read_b64_tr_b16 v[110:111], v16 offset:41472
v_mfma_f32_16x16x32_bf16 v[84:87], v[228:231], v[160:163], v[84:87]
ds_read_b64_tr_b16 v[112:113], v17 offset:40960
ds_read_b64_tr_b16 v[114:115], v17 offset:41472
v_mfma_f32_16x16x32_bf16 v[88:91], v[232:235], v[160:163], v[88:91]
v_mfma_f32_16x16x32_bf16 v[72:75], v[232:235], v[156:159], v[72:75]
s_waitcnt vmcnt(6) lgkmcnt(8)
v_mfma_f32_16x16x32_bf16 v[60:63], v[236:239], v[164:167], v[60:63]
buffer_load_dwordx4 v[196:199], v38, s[32:35], s57 offen offset:1024 sc1
v_mfma_f32_16x16x32_bf16 v[76:79], v[236:239], v[168:171], v[76:79]
ds_read_b64_tr_b16 v[220:221], v14 offset:45056
ds_read_b64_tr_b16 v[222:223], v14 offset:45568
v_mfma_f32_16x16x32_bf16 v[80:83], v[240:243], v[168:171], v[80:83]
ds_read_b64_tr_b16 v[224:225], v15 offset:45056
ds_read_b64_tr_b16 v[226:227], v15 offset:45568
v_mfma_f32_16x16x32_bf16 v[64:67], v[240:243], v[164:167], v[64:67]
buffer_load_dwordx4 v[200:203], v39, s[32:35], s57 offen offset:1024 sc1
v_mfma_f32_16x16x32_bf16 v[68:71], v[244:247], v[164:167], v[68:71]
ds_read_b64_tr_b16 v[228:229], v16 offset:45056
ds_read_b64_tr_b16 v[230:231], v16 offset:45568
v_mfma_f32_16x16x32_bf16 v[84:87], v[244:247], v[168:171], v[84:87]
ds_read_b64_tr_b16 v[232:233], v17 offset:45056
ds_read_b64_tr_b16 v[234:235], v17 offset:45568
v_mfma_f32_16x16x32_bf16 v[88:91], v[248:251], v[168:171], v[88:91]
s_add_u32 s57, s57, 2048
s_and_b32 s57, s57, 0x7fff
v_mfma_f32_16x16x32_bf16 v[72:75], v[248:251], v[164:167], v[72:75]
s_waitcnt vmcnt(6) lgkmcnt(8)
v_mfma_f32_16x16x32_bf16 v[60:63], v[100:103], v[172:175], v[60:63]
buffer_load_dwordx4 v[204:207], v38, s[32:35], s57 offen sc1
v_mfma_f32_16x16x32_bf16 v[76:79], v[100:103], v[176:179], v[76:79]
ds_read_b64_tr_b16 v[236:237], v14 offset:49152
ds_read_b64_tr_b16 v[238:239], v14 offset:49664
v_mfma_f32_16x16x32_bf16 v[80:83], v[104:107], v[176:179], v[80:83]
ds_read_b64_tr_b16 v[240:241], v15 offset:49152
ds_read_b64_tr_b16 v[242:243], v15 offset:49664
v_mfma_f32_16x16x32_bf16 v[64:67], v[104:107], v[172:175], v[64:67]
buffer_load_dwordx4 v[208:211], v39, s[32:35], s57 offen sc1
v_mfma_f32_16x16x32_bf16 v[68:71], v[108:111], v[172:175], v[68:71]
ds_read_b64_tr_b16 v[244:245], v16 offset:49152
ds_read_b64_tr_b16 v[246:247], v16 offset:49664
v_mfma_f32_16x16x32_bf16 v[84:87], v[108:111], v[176:179], v[84:87]
ds_read_b64_tr_b16 v[248:249], v17 offset:49152
ds_read_b64_tr_b16 v[250:251], v17 offset:49664
v_mfma_f32_16x16x32_bf16 v[88:91], v[112:115], v[176:179], v[88:91]
v_mfma_f32_16x16x32_bf16 v[72:75], v[112:115], v[172:175], v[72:75]
s_waitcnt vmcnt(6) lgkmcnt(8)
v_mfma_f32_16x16x32_bf16 v[60:63], v[220:223], v[180:183], v[60:63]
buffer_load_dwordx4 v[212:215], v38, s[32:35], s57 offen offset:1024 sc1
v_mfma_f32_16x16x32_bf16 v[76:79], v[220:223], v[184:187], v[76:79]
ds_read_b64_tr_b16 v[100:101], v14 offset:53248
ds_read_b64_tr_b16 v[102:103], v14 offset:53760
v_mfma_f32_16x16x32_bf16 v[80:83], v[224:227], v[184:187], v[80:83]
ds_read_b64_tr_b16 v[104:105], v15 offset:53248
ds_read_b64_tr_b16 v[106:107], v15 offset:53760
v_mfma_f32_16x16x32_bf16 v[64:67], v[224:227], v[180:183], v[64:67]
buffer_load_dwordx4 v[216:219], v39, s[32:35], s57 offen offset:1024 sc1
v_mfma_f32_16x16x32_bf16 v[68:71], v[228:231], v[180:183], v[68:71]
ds_read_b64_tr_b16 v[108:109], v16 offset:53248
ds_read_b64_tr_b16 v[110:111], v16 offset:53760
v_mfma_f32_16x16x32_bf16 v[84:87], v[228:231], v[184:187], v[84:87]
ds_read_b64_tr_b16 v[112:113], v17 offset:53248
ds_read_b64_tr_b16 v[114:115], v17 offset:53760
v_mfma_f32_16x16x32_bf16 v[88:91], v[232:235], v[184:187], v[88:91]
v_mfma_f32_16x16x32_bf16 v[72:75], v[232:235], v[180:183], v[72:75]
s_waitcnt vmcnt(6) lgkmcnt(8)
v_mfma_f32_16x16x32_bf16 v[60:63], v[236:239], v[188:191], v[60:63]
v_mfma_f32_16x16x32_bf16 v[76:79], v[236:239], v[192:195], v[76:79]
ds_read_b64_tr_b16 v[220:221], v14 offset:57344
ds_read_b64_tr_b16 v[222:223], v14 offset:57856
v_mfma_f32_16x16x32_bf16 v[80:83], v[240:243], v[192:195], v[80:83]
ds_read_b64_tr_b16 v[224:225], v15 offset:57344
ds_read_b64_tr_b16 v[226:227], v15 offset:57856
v_mfma_f32_16x16x32_bf16 v[64:67], v[240:243], v[188:191], v[64:67]
v_mfma_f32_16x16x32_bf16 v[68:71], v[244:247], v[188:191], v[68:71]
ds_read_b64_tr_b16 v[228:229], v16 offset:57344
ds_read_b64_tr_b16 v[230:231], v16 offset:57856
v_mfma_f32_16x16x32_bf16 v[84:87], v[244:247], v[192:195], v[84:87]
ds_read_b64_tr_b16 v[232:233], v17 offset:57344
ds_read_b64_tr_b16 v[234:235], v17 offset:57856
v_mfma_f32_16x16x32_bf16 v[88:91], v[248:251], v[192:195], v[88:91]
v_mfma_f32_16x16x32_bf16 v[72:75], v[248:251], v[188:191], v[72:75]
s_waitcnt vmcnt(4) lgkmcnt(8)
v_mfma_f32_16x16x32_bf16 v[60:63], v[100:103], v[196:199], v[60:63]
v_mfma_f32_16x16x32_bf16 v[76:79], v[100:103], v[200:203], v[76:79]
ds_read_b64_tr_b16 v[236:237], v14 offset:61440
ds_read_b64_tr_b16 v[238:239], v14 offset:61952
v_mfma_f32_16x16x32_bf16 v[80:83], v[104:107], v[200:203], v[80:83]
ds_read_b64_tr_b16 v[240:241], v15 offset:61440
ds_read_b64_tr_b16 v[242:243], v15 offset:61952
v_mfma_f32_16x16x32_bf16 v[64:67], v[104:107], v[196:199], v[64:67]
v_mfma_f32_16x16x32_bf16 v[68:71], v[108:111], v[196:199], v[68:71]
ds_read_b64_tr_b16 v[244:245], v16 offset:61440
ds_read_b64_tr_b16 v[246:247], v16 offset:61952
v_mfma_f32_16x16x32_bf16 v[84:87], v[108:111], v[200:203], v[84:87]
ds_read_b64_tr_b16 v[248:249], v17 offset:61440
ds_read_b64_tr_b16 v[250:251], v17 offset:61952
v_mfma_f32_16x16x32_bf16 v[88:91], v[112:115], v[200:203], v[88:91]
v_mfma_f32_16x16x32_bf16 v[72:75], v[112:115], v[196:199], v[72:75]
s_waitcnt vmcnt(2) lgkmcnt(8)
v_mfma_f32_16x16x32_bf16 v[60:63], v[220:223], v[204:207], v[60:63]
v_mfma_f32_16x16x32_bf16 v[76:79], v[220:223], v[208:211], v[76:79]
v_mfma_f32_16x16x32_bf16 v[80:83], v[224:227], v[208:211], v[80:83]
v_mfma_f32_16x16x32_bf16 v[64:67], v[224:227], v[204:207], v[64:67]
v_mfma_f32_16x16x32_bf16 v[68:71], v[228:231], v[204:207], v[68:71]
v_mfma_f32_16x16x32_bf16 v[84:87], v[228:231], v[208:211], v[84:87]
v_mfma_f32_16x16x32_bf16 v[88:91], v[232:235], v[208:211], v[88:91]
v_mfma_f32_16x16x32_bf16 v[72:75], v[232:235], v[204:207], v[72:75]
s_waitcnt vmcnt(0) lgkmcnt(0)
v_mfma_f32_16x16x32_bf16 v[60:63], v[236:239], v[212:215], v[60:63]
v_mfma_f32_16x16x32_bf16 v[64:67], v[240:243], v[212:215], v[64:67]
v_mfma_f32_16x16x32_bf16 v[68:71], v[244:247], v[212:215], v[68:71]
v_mfma_f32_16x16x32_bf16 v[72:75], v[248:251], v[212:215], v[72:75]
v_mfma_f32_16x16x32_bf16 v[76:79], v[236:239], v[216:219], v[76:79]
v_mfma_f32_16x16x32_bf16 v[80:83], v[240:243], v[216:219], v[80:83]
v_mfma_f32_16x16x32_bf16 v[84:87], v[244:247], v[216:219], v[84:87]
v_mfma_f32_16x16x32_bf16 v[88:91], v[248:251], v[216:219], v[88:91]
s_nop 0
v_cvt_pk_bf16_f32 v20, v60, v61
v_cvt_pk_bf16_f32 v21, v62, v63
v_cvt_pk_bf16_f32 v22, v64, v65
v_cvt_pk_bf16_f32 v23, v66, v67
ds_write_b64 v42, v[20:21] offset:0
ds_write_b64 v43, v[22:23] offset:0
v_cvt_pk_bf16_f32 v24, v68, v69
v_cvt_pk_bf16_f32 v25, v70, v71
v_cvt_pk_bf16_f32 v26, v72, v73
v_cvt_pk_bf16_f32 v27, v74, v75
ds_write_b64 v44, v[24:25] offset:0
ds_write_b64 v45, v[26:27] offset:0
v_cvt_pk_bf16_f32 v28, v76, v77
v_cvt_pk_bf16_f32 v29, v78, v79
v_cvt_pk_bf16_f32 v30, v80, v81
v_cvt_pk_bf16_f32 v31, v82, v83
ds_write_b64 v42, v[28:29] offset:2048
ds_write_b64 v43, v[30:31] offset:2048
v_cvt_pk_bf16_f32 v32, v84, v85
v_cvt_pk_bf16_f32 v33, v86, v87
v_cvt_pk_bf16_f32 v34, v88, v89
v_cvt_pk_bf16_f32 v35, v90, v91
ds_write_b64 v44, v[32:33] offset:2048
ds_write_b64 v45, v[34:35] offset:2048
ds_read_b128 v[20:23], v46 offset:0
ds_read_b128 v[24:27], v46 offset:1024
ds_read_b128 v[28:31], v46 offset:2048
ds_read_b128 v[32:35], v46 offset:3072
s_waitcnt lgkmcnt(3)
buffer_store_dwordx4 v[20:23], v40, s[24:27], s48 offen sc1
s_waitcnt lgkmcnt(2)
buffer_store_dwordx4 v[24:27], v41, s[24:27], s48 offen sc1
s_waitcnt lgkmcnt(1)
buffer_store_dwordx4 v[28:31], v40, s[24:27], s49 offen sc1
s_waitcnt lgkmcnt(0)
buffer_store_dwordx4 v[32:35], v41, s[24:27], s49 offen sc1
s_endpgm
L_code_end:
again_22:
s_mov_b32 s63, 0
retry_24:
buffer_load_dwordx4 v[80:83], v37, s[32:35], 0 offen offset:0 sc1
buffer_load_dwordx4 v[84:87], v37, s[32:35], 0 offen offset:1024 sc1
buffer_load_dwordx4 v[88:91], v37, s[32:35], 0 offen offset:2048 sc1
buffer_load_dwordx4 v[92:95], v37, s[32:35], 0 offen offset:3072 sc1
s_waitcnt vmcnt(0)
v_add_f32 v80, v80, v88
v_add_f32 v81, v81, v89
v_add_f32 v82, v82, v90
v_add_f32 v83, v83, v91
v_add_f32 v84, v84, v92
v_add_f32 v85, v85, v93
v_add_f32 v86, v86, v94
v_add_f32 v87, v87, v95
v_add_f32 v80, v80, v84
v_add_f32 v81, v81, v85
v_add_f32 v82, v82, v86
v_add_f32 v83, v83, v87
s_nop 1
v_permlane32_swap_b32 v80, v81
v_permlane32_swap_b32 v82, v83
v_add_f32 v80, v80, v81
v_add_f32 v82, v82, v83
s_nop 1
v_permlane16_swap_b32 v80, v82
s_nop 0
v_add_f32 v80, v80, v82
v_cmp_u_f32 vcc, v80, v80
s_cbranch_vccz summed_23
s_add_u32 s63, s63, 1
s_cmp_lt_u32 s63, 0x10000
s_cbranch_scc1 retry_24
s_branch summed_23
again_25:
s_mov_b32 s63, 0
retry_27:
buffer_load_dwordx4 v[64:67], v38, s[32:35], 0 offen offset:0 sc1
buffer_load_dwordx4 v[68:71], v38, s[32:35], 0 offen offset:1024 sc1
buffer_load_dwordx4 v[72:75], v38, s[32:35], 0 offen offset:2048 sc1
buffer_load_dwordx4 v[76:79], v38, s[32:35], 0 offen offset:3072 sc1
s_waitcnt vmcnt(0)
v_add_f32 v64, v64, v72
v_add_f32 v65, v65, v73
v_add_f32 v66, v66, v74
v_add_f32 v67, v67, v75
v_add_f32 v68, v68, v76
v_add_f32 v69, v69, v77
v_add_f32 v70, v70, v78
v_add_f32 v71, v71, v79
v_add_f32 v64, v64, v68
v_add_f32 v65, v65, v69
v_add_f32 v66, v66, v70
v_add_f32 v67, v67, v71
s_nop 1
v_permlane32_swap_b32 v64, v65
v_permlane32_swap_b32 v66, v67
v_add_f32 v64, v64, v65
v_add_f32 v66, v66, v67
s_nop 1
v_permlane16_swap_b32 v64, v66
s_nop 0
v_add_f32 v64, v64, v66
v_cmp_u_f32 vcc, v64, v64
s_cbranch_vccz summed_26
s_add_u32 s63, s63, 1
s_cmp_lt_u32 s63, 0x10000
s_cbranch_scc1 retry_27
s_branch summed_26
again_33:
s_mov_b32 s63, 0
retry_35:
buffer_load_dwordx4 v[80:83], v37, s[32:35], 0 offen offset:0 sc1
buffer_load_dwordx4 v[84:87], v37, s[32:35], 0 offen offset:1024 sc1
buffer_load_dwordx4 v[88:91], v37, s[32:35], 0 offen offset:2048 sc1
buffer_load_dwordx4 v[92:95], v37, s[32:35], 0 offen offset:3072 sc1
s_waitcnt vmcnt(0)
v_add_f32 v80, v80, v88
v_add_f32 v81, v81, v89
v_add_f32 v82, v82, v90
v_add_f32 v83, v83, v91
v_add_f32 v84, v84, v92
v_add_f32 v85, v85, v93
v_add_f32 v86, v86, v94
v_add_f32 v87, v87, v95
v_add_f32 v80, v80, v84
v_add_f32 v81, v81, v85
v_add_f32 v82, v82, v86
v_add_f32 v83, v83, v87
s_nop 1
v_permlane32_swap_b32 v80, v81
v_permlane32_swap_b32 v82, v83
v_add_f32 v80, v80, v81
v_add_f32 v82, v82, v83
s_nop 1
v_permlane16_swap_b32 v80, v82
s_nop 0
v_add_f32 v80, v80, v82
v_cmp_u_f32 vcc, v80, v80
s_cbranch_vccz summed_34
s_add_u32 s63, s63, 1
s_cmp_lt_u32 s63, 0x10000
s_cbranch_scc1 retry_35
s_branch summed_34
again_36:
s_mov_b32 s63, 0
retry_38:
buffer_load_dwordx4 v[64:67], v38, s[32:35], 0 offen offset:0 sc1
buffer_load_dwordx4 v[68:71], v38, s[32:35], 0 offen offset:1024 sc1
buffer_load_dwordx4 v[72:75], v38, s[32:35], 0 offen offset:2048 sc1
buffer_load_dwordx4 v[76:79], v38, s[32:35], 0 offen offset:3072 sc1
s_waitcnt vmcnt(0)
v_add_f32 v64, v64, v72
v_add_f32 v65, v65, v73
v_add_f32 v66, v66, v74
v_add_f32 v67, v67, v75
v_add_f32 v68, v68, v76
v_add_f32 v69, v69, v77
v_add_f32 v70, v70, v78
v_add_f32 v71, v71, v79
v_add_f32 v64, v64, v68
v_add_f32 v65, v65, v69
v_add_f32 v66, v66, v70
v_add_f32 v67, v67, v71
s_nop 1
v_permlane32_swap_b32 v64, v65
v_permlane32_swap_b32 v66, v67
v_add_f32 v64, v64, v65
v_add_f32 v66, v66, v67
s_nop 1
v_permlane16_swap_b32 v64, v66
s_nop 0
v_add_f32 v64, v64, v66
v_cmp_u_f32 vcc, v64, v64
s_cbranch_vccz summed_37
s_add_u32 s63, s63, 1
s_cmp_lt_u32 s63, 0x10000
s_cbranch_scc1 retry_38
s_branch summed_37
again_42:
s_mov_b32 s63, 0
retry_44:
buffer_load_dwordx4 v[80:83], v37, s[32:35], 0 offen offset:0 sc1
buffer_load_dwordx4 v[84:87], v37, s[32:35], 0 offen offset:1024 sc1
buffer_load_dwordx4 v[88:91], v37, s[32:35], 0 offen offset:2048 sc1
buffer_load_dwordx4 v[92:95], v37, s[32:35], 0 offen offset:3072 sc1
s_waitcnt vmcnt(0)
v_add_f32 v80, v80, v88
v_add_f32 v81, v81, v89
v_add_f32 v82, v82, v90
v_add_f32 v83, v83, v91
v_add_f32 v84, v84, v92
v_add_f32 v85, v85, v93
v_add_f32 v86, v86, v94
v_add_f32 v87, v87, v95
v_add_f32 v80, v80, v84
v_add_f32 v81, v81, v85
v_add_f32 v82, v82, v86
v_add_f32 v83, v83, v87
s_nop 1
v_permlane32_swap_b32 v80, v81
v_permlane32_swap_b32 v82, v83
v_add_f32 v80, v80, v81
v_add_f32 v82, v82, v83
s_nop 1
v_permlane16_swap_b32 v80, v82
s_nop 0
v_add_f32 v80, v80, v82
v_cmp_u_f32 vcc, v80, v80
s_cbranch_vccz summed_43
s_add_u32 s63, s63, 1
s_cmp_lt_u32 s63, 0x10000
s_cbranch_scc1 retry_44
s_branch summed_43
again_52:
s_mov_b32 s63, 0
retry_54:
buffer_load_dwordx4 v[80:83], v37, s[32:35], 0 offen offset:0 sc1
buffer_load_dwordx4 v[84:87], v37, s[32:35], 0 offen offset:1024 sc1
buffer_load_dwordx4 v[88:91], v37, s[32:35], 0 offen offset:2048 sc1
buffer_load_dwordx4 v[92:95], v37, s[32:35], 0 offen offset:3072 sc1
s_waitcnt vmcnt(0)
v_add_f32 v80, v80, v88
v_add_f32 v81, v81, v89
v_add_f32 v82, v82, v90
v_add_f32 v83, v83, v91
v_add_f32 v84, v84, v92
v_add_f32 v85, v85, v93
v_add_f32 v86, v86, v94
v_add_f32 v87, v87, v95
v_add_f32 v80, v80, v84
v_add_f32 v81, v81, v85
v_add_f32 v82, v82, v86
v_add_f32 v83, v83, v87
s_nop 1
v_permlane32_swap_b32 v80, v81
v_permlane32_swap_b32 v82, v83
v_add_f32 v80, v80, v81
v_add_f32 v82, v82, v83
s_nop 1
v_permlane16_swap_b32 v80, v82
s_nop 0
v_add_f32 v80, v80, v82
v_cmp_u_f32 vcc, v80, v80
s_cbranch_vccz summed_53
s_add_u32 s63, s63, 1
s_cmp_lt_u32 s63, 0x10000
s_cbranch_scc1 retry_54
s_branch summed_53
slow_73:
.p2align 3
v_mfma_f32_16x16x32_bf16 v[160:163], v[120:123], v[156:159], v[44:47]
v_max_f32 v158, v192, v193
v_max_f32 v159, v194, v195
v_permlane32_swap_b32 v130, v131
s_nop 0
v_max_f32 v130, v130, v131
s_nop 2
v_max_f32 v156, v160, v161
v_max_f32 v157, v162, v163
v_max3_f32 v128, v156, v157, v158
v_max_f32 v128, v128, v159
s_nop 1
v_permlane32_swap_b32 v128, v129
s_nop 0
v_max_f32 v128, v128, v129
s_nop 1
v_permlane16_swap_b32 v128, v130
s_nop 0
v_max_f32 v128, v128, v130
v_mov_b32 v130, v128
s_nop 1
v_permlane16_swap_b32 v128, v130
s_nop 0
v_mov_b32 v129, v128
v_mov_b32 v131, v130
s_nop 0
v_permlane32_swap_b32 v128, v129
v_permlane32_swap_b32 v130, v131
v_mul_f32 v128, v128, v124
v_mul_f32 v129, v129, v125
v_pk_fma_f32 v[156:157], v[156:157], v[124:125], v[128:129] op_sel:[0,0,0] op_sel_hi:[1,0,0] neg_lo:[0,0,1] neg_hi:[0,0,1]
v_pk_fma_f32 v[158:159], v[158:159], v[124:125], v[128:129] op_sel:[0,0,0] op_sel_hi:[1,0,0] neg_lo:[0,0,1] neg_hi:[0,0,1]
v_mul_f32 v130, v130, v126
v_mul_f32 v131, v131, v127
v_exp_f32 v156, v156
v_exp_f32 v157, v157
v_exp_f32 v158, v158
v_exp_f32 v159, v159
v_pk_fma_f32 v[164:165], v[164:165], v[124:125], v[128:129] op_sel:[0,1,1] op_sel_hi:[1,1,1] neg_lo:[0,0,1] neg_hi:[0,0,1]
v_pk_fma_f32 v[166:167], v[166:167], v[124:125], v[128:129] op_sel:[0,1,1] op_sel_hi:[1,1,1] neg_lo:[0,0,1] neg_hi:[0,0,1]
v_exp_f32 v164, v164
v_exp_f32 v165, v165
v_exp_f32 v166, v166
v_exp_f32 v167, v167
v_pk_fma_f32 v[172:173], v[172:173], v[126:127], v[130:131] op_sel:[0,0,0] op_sel_hi:[1,0,0] neg_lo:[0,0,1] neg_hi:[0,0,1]
v_pk_fma_f32 v[174:175], v[174:175], v[126:127], v[130:131] op_sel:[0,0,0] op_sel_hi:[1,0,0] neg_lo:[0,0,1] neg_hi:[0,0,1]
v_cvt_pk_bf16_f32 v156, v156, v156
v_cvt_pk_bf16_f32 v157, v157, v157
v_cvt_pk_bf16_f32 v158, v158, v158
v_cvt_pk_bf16_f32 v159, v159, v159
v_exp_f32 v172, v172
v_exp_f32 v173, v173
v_exp_f32 v174, v174
v_exp_f32 v175, v175
v_pk_fma_f32 v[180:181], v[180:181], v[126:127], v[130:131] op_sel:[0,1,1] op_sel_hi:[1,1,1] neg_lo:[0,0,1] neg_hi:[0,0,1]
v_pk_fma_f32 v[182:183], v[182:183], v[126:127], v[130:131] op_sel:[0,1,1] op_sel_hi:[1,1,1] neg_lo:[0,0,1] neg_hi:[0,0,1]
v_and_b32 v156, v52, v156
v_and_b32 v157, v52, v157
v_and_b32 v158, v52, v158
v_and_b32 v159, v52, v159
v_cvt_pk_bf16_f32 v164, v164, v164
v_cvt_pk_bf16_f32 v165, v165, v165
v_mfma_f32_16x16x32_bf16 v[160:163], v[48:51], v[156:159], 0
v_cvt_pk_bf16_f32 v166, v166, v166
v_cvt_pk_bf16_f32 v167, v167, v167
v_mfma_f32_16x16x32_bf16 v[220:223], v[100:103], v[156:159], 0
v_exp_f32 v180, v180
v_mfma_f32_16x16x32_bf16 v[224:227], v[110:113], v[156:159], 0
v_exp_f32 v181, v181
v_exp_f32 v182, v182
v_exp_f32 v183, v183
v_and_b32 v164, v52, v164
v_and_b32 v165, v52, v165
v_and_b32 v166, v52, v166
v_and_b32 v167, v52, v167
v_cvt_pk_bf16_f32 v172, v172, v172
v_cvt_pk_bf16_f32 v173, v173, v173
v_mfma_f32_16x16x32_bf16 v[168:171], v[48:51], v[164:167], 0
v_cvt_pk_bf16_f32 v174, v174, v174
v_cvt_pk_bf16_f32 v175, v175, v175
v_mfma_f32_16x16x32_bf16 v[228:231], v[102:105], v[164:167], 0
v_and_b32 v172, v52, v172
v_and_b32 v173, v52, v173
v_mfma_f32_16x16x32_bf16 v[232:235], v[112:115], v[164:167], 0
v_and_b32 v174, v52, v174
v_and_b32 v175, v52, v175
v_cvt_pk_bf16_f32 v180, v180, v180
v_cvt_pk_bf16_f32 v181, v181, v181
v_mfma_f32_16x16x32_bf16 v[176:179], v[48:51], v[172:175], 0
v_cvt_pk_bf16_f32 v182, v182, v182
v_cvt_pk_bf16_f32 v183, v183, v183
v_mfma_f32_16x16x32_bf16 v[236:239], v[104:107], v[172:175], 0
v_and_b32 v180, v52, v180
v_and_b32 v181, v52, v181
v_mfma_f32_16x16x32_bf16 v[240:243], v[114:117], v[172:175], 0
v_and_b32 v182, v52, v182
v_and_b32 v183, v52, v183
v_rcp_f32 v160, v160
v_rcp_f32 v168, v168
v_pk_mul_f32 v[220:221], v[220:221], v[160:161] op_sel:[0,0] op_sel_hi:[1,0]
v_pk_mul_f32 v[222:223], v[222:223], v[160:161] op_sel:[0,0] op_sel_hi:[1,0]
v_pk_mul_f32 v[228:229], v[228:229], v[168:169] op_sel:[0,0] op_sel_hi:[1,0]
v_pk_mul_f32 v[224:225], v[224:225], v[160:161] op_sel:[0,0] op_sel_hi:[1,0]
v_pk_mul_f32 v[226:227], v[226:227], v[160:161] op_sel:[0,0] op_sel_hi:[1,0]
v_pk_mul_f32 v[230:231], v[230:231], v[168:169] op_sel:[0,0] op_sel_hi:[1,0]
v_pk_mul_f32 v[232:233], v[232:233], v[168:169] op_sel:[0,0] op_sel_hi:[1,0]
v_pk_mul_f32 v[234:235], v[234:235], v[168:169] op_sel:[0,0] op_sel_hi:[1,0]
v_mfma_f32_16x16x32_bf16 v[184:187], v[48:51], v[180:183], 0
v_rcp_f32_e64 v176, v176
v_cvt_pk_bf16_f32 v220, v220, v221
v_cvt_pk_bf16_f32 v221, v222, v223
v_cvt_pk_bf16_f32 v228, v228, v229
v_pk_mul_f32 v[236:237], v[236:237], v[176:177] op_sel:[0,0] op_sel_hi:[1,0]
v_mfma_f32_16x16x32_bf16 v[244:247], v[106:109], v[180:183], 0
v_cvt_pk_bf16_f32 v222, v224, v225
v_cvt_pk_bf16_f32 v223, v226, v227
v_rcp_f32_e64 v184, v184
v_cvt_pk_bf16_f32 v229, v230, v231
v_pk_mul_f32 v[238:239], v[238:239], v[176:177] op_sel:[0,0] op_sel_hi:[1,0]
v_pk_mul_f32 v[240:241], v[240:241], v[176:177] op_sel:[0,0] op_sel_hi:[1,0]
v_pk_mul_f32 v[242:243], v[242:243], v[176:177] op_sel:[0,0] op_sel_hi:[1,0]
v_cvt_pk_bf16_f32 v236, v236, v237
v_pk_mul_f32 v[244:245], v[244:245], v[184:185] op_sel:[0,0] op_sel_hi:[1,0]
v_pk_mul_f32 v[246:247], v[246:247], v[184:185] op_sel:[0,0] op_sel_hi:[1,0]
v_mfma_f32_16x16x32_bf16 v[248:251], v[116:119], v[180:183], 0
buffer_store_dwordx4 v[220:223], v18, s[32:35], s80 offen sc1
v_cvt_pk_bf16_f32 v230, v232, v233
v_cvt_pk_bf16_f32 v231, v234, v235
v_cvt_pk_bf16_f32 v237, v238, v239
v_cvt_pk_bf16_f32 v244, v244, v245
buffer_store_dwordx4 v[228:231], v18, s[32:35], s81 offen sc1
v_cvt_pk_bf16_f32 v238, v240, v241
v_cvt_pk_bf16_f32 v239, v242, v243
v_pk_mul_f32 v[248:249], v[248:249], v[184:185] op_sel:[0,0] op_sel_hi:[1,0]
v_pk_mul_f32 v[250:251], v[250:251], v[184:185] op_sel:[0,0] op_sel_hi:[1,0]
v_cvt_pk_bf16_f32 v245, v246, v247
buffer_store_dwordx4 v[236:239], v18, s[32:35], s82 offen sc1
v_cvt_pk_bf16_f32 v246, v248, v249
v_cvt_pk_bf16_f32 v247, v250, v251
buffer_store_dwordx4 v[244:247], v18, s[32:35], s83 offen sc1
s_branch back_74
slow_75:
buffer_store_dword v5, v4, s[32:35], s84 offen sc1
s_branch back_76
slow_79:
s_nop 0
v_cvt_pk_bf16_f32 v20, v60, v61
v_cvt_pk_bf16_f32 v21, v62, v63
v_cvt_pk_bf16_f32 v22, v64, v65
v_cvt_pk_bf16_f32 v23, v66, v67
buffer_store_dwordx4 v[20:23], v18, s[32:35], s85 offen offset:0 sc1
v_cvt_pk_bf16_f32 v24, v68, v69
v_cvt_pk_bf16_f32 v25, v70, v71
v_cvt_pk_bf16_f32 v26, v72, v73
v_cvt_pk_bf16_f32 v27, v74, v75
buffer_store_dwordx4 v[24:27], v18, s[32:35], s85 offen offset:1024 sc1
v_cvt_pk_bf16_f32 v28, v76, v77
v_cvt_pk_bf16_f32 v29, v78, v79
v_cvt_pk_bf16_f32 v30, v80, v81
v_cvt_pk_bf16_f32 v31, v82, v83
buffer_store_dwordx4 v[28:31], v18, s[32:35], s86 offen offset:0 sc1
v_cvt_pk_bf16_f32 v32, v84, v85
v_cvt_pk_bf16_f32 v33, v86, v87
v_cvt_pk_bf16_f32 v34, v88, v89
v_cvt_pk_bf16_f32 v35, v90, v91
buffer_store_dwordx4 v[32:35], v18, s[32:35], s86 offen offset:1024 sc1
s_barrier
v_dot2c_f32_bf16 v6, v20, v48
v_dot2c_f32_bf16 v8, v20, v20
v_dot2c_f32_bf16 v7, v28, v48
v_dot2c_f32_bf16 v9, v28, v28
v_dot2c_f32_bf16 v6, v21, v48
v_dot2c_f32_bf16 v8, v21, v21
v_dot2c_f32_bf16 v7, v29, v48
v_dot2c_f32_bf16 v9, v29, v29
v_dot2c_f32_bf16 v6, v22, v48
v_dot2c_f32_bf16 v8, v22, v22
v_dot2c_f32_bf16 v7, v30, v48
v_dot2c_f32_bf16 v9, v30, v30
v_dot2c_f32_bf16 v6, v23, v48
v_dot2c_f32_bf16 v8, v23, v23
v_dot2c_f32_bf16 v7, v31, v48
v_dot2c_f32_bf16 v9, v31, v31
v_dot2c_f32_bf16 v6, v24, v48
v_dot2c_f32_bf16 v8, v24, v24
v_dot2c_f32_bf16 v7, v32, v48
v_dot2c_f32_bf16 v9, v32, v32
v_dot2c_f32_bf16 v6, v25, v48
v_dot2c_f32_bf16 v8, v25, v25
v_dot2c_f32_bf16 v7, v33, v48
v_dot2c_f32_bf16 v9, v33, v33
v_dot2c_f32_bf16 v6, v26, v48
v_dot2c_f32_bf16 v8, v26, v26
v_dot2c_f32_bf16 v7, v34, v48
v_dot2c_f32_bf16 v9, v34, v34
v_dot2c_f32_bf16 v6, v27, v48
v_dot2c_f32_bf16 v8, v27, v27
v_dot2c_f32_bf16 v7, v35, v48
v_dot2c_f32_bf16 v9, v35, v35
s_mov_b64 exec, 1
s_waitcnt vmcnt(0)
buffer_store_dword v5, v4, s[32:35], s88 offen sc1
s_mov_b64 exec, -1
s_nop 1
v_permlane32_swap_b32 v6, v7
v_permlane32_swap_b32 v8, v9
v_add_f32 v6, v6, v7
v_add_f32 v8, v8, v9
s_nop 1
v_permlane16_swap_b32 v6, v8
s_nop 0
v_add_f32 v6, v6, v8
buffer_store_dword v6, v1, s[32:35], s87 offen sc1
s_branch back_80
slow_95:
.p2align 3
v_mfma_f32_16x16x32_bf16 v[156:159], v[188:191], v[60:63], 0
v_mfma_f32_16x16x32_bf16 v[164:167], v[188:191], v[68:71], 0
v_mfma_f32_16x16x32_bf16 v[160:163], v[192:195], v[60:63], 0
v_mfma_f32_16x16x32_bf16 v[172:175], v[188:191], v[76:79], 0
v_mfma_f32_16x16x32_bf16 v[168:171], v[192:195], v[68:71], 0
v_mfma_f32_16x16x32_bf16 v[180:183], v[188:191], v[84:87], 0
v_mfma_f32_16x16x32_bf16 v[156:159], v[196:199], v[220:223], v[156:159]
v_mfma_f32_16x16x32_bf16 v[176:179], v[192:195], v[76:79], 0
v_mfma_f32_16x16x32_bf16 v[164:167], v[196:199], v[228:231], v[164:167]
v_mfma_f32_16x16x32_bf16 v[184:187], v[192:195], v[84:87], 0
v_mfma_f32_16x16x32_bf16 v[160:163], v[200:203], v[220:223], v[160:163]
v_mfma_f32_16x16x32_bf16 v[172:175], v[196:199], v[236:239], v[172:175]
v_mfma_f32_16x16x32_bf16 v[168:171], v[200:203], v[228:231], v[168:171]
v_mfma_f32_16x16x32_bf16 v[180:183], v[196:199], v[244:247], v[180:183]
v_mfma_f32_16x16x32_bf16 v[176:179], v[200:203], v[236:239], v[176:179]
v_mfma_f32_16x16x32_bf16 v[184:187], v[200:203], v[244:247], v[184:187]
v_pk_mul_f32 v[156:157], v[156:157], v[100:101] op_sel:[0,0] op_sel_hi:[1,0]
v_pk_mul_f32 v[158:159], v[158:159], v[100:101] op_sel:[0,0] op_sel_hi:[1,0]
v_cvt_pk_bf16_f32 v156, v156, v157
v_pk_mul_f32 v[164:165], v[164:165], v[100:101] op_sel:[0,1] op_sel_hi:[1,1]
v_pk_mul_f32 v[160:161], v[160:161], v[100:101] op_sel:[0,0] op_sel_hi:[1,0]
v_pk_mul_f32 v[162:163], v[162:163], v[100:101] op_sel:[0,0] op_sel_hi:[1,0]
v_cvt_pk_bf16_f32 v157, v158, v159
v_pk_mul_f32 v[166:167], v[166:167], v[100:101] op_sel:[0,1] op_sel_hi:[1,1]
v_cvt_pk_bf16_f32 v164, v164, v165
v_pk_mul_f32 v[172:173], v[172:173], v[102:103] op_sel:[0,0] op_sel_hi:[1,0]
v_cvt_pk_bf16_f32 v158, v160, v161
v_cvt_pk_bf16_f32 v159, v162, v163
v_pk_mul_f32 v[168:169], v[168:169], v[100:101] op_sel:[0,1] op_sel_hi:[1,1]
v_pk_mul_f32 v[170:171], v[170:171], v[100:101] op_sel:[0,1] op_sel_hi:[1,1]
v_cvt_pk_bf16_f32 v165, v166, v167
v_pk_mul_f32 v[174:175], v[174:175], v[102:103] op_sel:[0,0] op_sel_hi:[1,0]
v_cvt_pk_bf16_f32 v172, v172, v173
v_pk_mul_f32 v[180:181], v[180:181], v[102:103] op_sel:[0,1] op_sel_hi:[1,1]
buffer_store_dwordx4 v[156:159], v18, s[32:35], s80 offen sc1
v_cvt_pk_bf16_f32 v166, v168, v169
v_cvt_pk_bf16_f32 v167, v170, v171
v_pk_mul_f32 v[176:177], v[176:177], v[102:103] op_sel:[0,0] op_sel_hi:[1,0]
v_pk_mul_f32 v[178:179], v[178:179], v[102:103] op_sel:[0,0] op_sel_hi:[1,0]
v_cvt_pk_bf16_f32 v173, v174, v175
v_pk_mul_f32 v[182:183], v[182:183], v[102:103] op_sel:[0,1] op_sel_hi:[1,1]
v_cvt_pk_bf16_f32 v180, v180, v181
buffer_store_dwordx4 v[164:167], v18, s[32:35], s81 offen sc1
v_cvt_pk_bf16_f32 v174, v176, v177
v_cvt_pk_bf16_f32 v175, v178, v179
v_pk_mul_f32 v[184:185], v[184:185], v[102:103] op_sel:[0,1] op_sel_hi:[1,1]
v_pk_mul_f32 v[186:187], v[186:187], v[102:103] op_sel:[0,1] op_sel_hi:[1,1]
v_cvt_pk_bf16_f32 v181, v182, v183
buffer_store_dwordx4 v[172:175], v18, s[32:35], s82 offen sc1
v_cvt_pk_bf16_f32 v182, v184, v185
v_cvt_pk_bf16_f32 v183, v186, v187
buffer_store_dwordx4 v[180:183], v18, s[32:35], s83 offen sc1
s_branch back_96
slow_97:
buffer_store_dword v5, v4, s[32:35], s84 offen sc1
s_branch back_98
slow_101:
s_nop 0
v_cvt_pk_bf16_f32 v20, v60, v61
v_cvt_pk_bf16_f32 v21, v62, v63
v_cvt_pk_bf16_f32 v22, v64, v65
v_cvt_pk_bf16_f32 v23, v66, v67
buffer_store_dwordx4 v[20:23], v18, s[32:35], s85 offen offset:0 sc1
v_cvt_pk_bf16_f32 v24, v68, v69
v_cvt_pk_bf16_f32 v25, v70, v71
v_cvt_pk_bf16_f32 v26, v72, v73
v_cvt_pk_bf16_f32 v27, v74, v75
buffer_store_dwordx4 v[24:27], v18, s[32:35], s85 offen offset:1024 sc1
v_cvt_pk_bf16_f32 v28, v76, v77
v_cvt_pk_bf16_f32 v29, v78, v79
v_cvt_pk_bf16_f32 v30, v80, v81
v_cvt_pk_bf16_f32 v31, v82, v83
buffer_store_dwordx4 v[28:31], v18, s[32:35], s86 offen offset:0 sc1
v_cvt_pk_bf16_f32 v32, v84, v85
v_cvt_pk_bf16_f32 v33, v86, v87
v_cvt_pk_bf16_f32 v34, v88, v89
v_cvt_pk_bf16_f32 v35, v90, v91
buffer_store_dwordx4 v[32:35], v18, s[32:35], s86 offen offset:1024 sc1
s_barrier
v_dot2c_f32_bf16 v6, v20, v48
v_dot2c_f32_bf16 v8, v20, v20
v_dot2c_f32_bf16 v7, v28, v48
v_dot2c_f32_bf16 v9, v28, v28
v_dot2c_f32_bf16 v6, v21, v48
v_dot2c_f32_bf16 v8, v21, v21
v_dot2c_f32_bf16 v7, v29, v48
v_dot2c_f32_bf16 v9, v29, v29
v_dot2c_f32_bf16 v6, v22, v48
v_dot2c_f32_bf16 v8, v22, v22
v_dot2c_f32_bf16 v7, v30, v48
v_dot2c_f32_bf16 v9, v30, v30
v_dot2c_f32_bf16 v6, v23, v48
v_dot2c_f32_bf16 v8, v23, v23
v_dot2c_f32_bf16 v7, v31, v48
v_dot2c_f32_bf16 v9, v31, v31
v_dot2c_f32_bf16 v6, v24, v48
v_dot2c_f32_bf16 v8, v24, v24
v_dot2c_f32_bf16 v7, v32, v48
v_dot2c_f32_bf16 v9, v32, v32
v_dot2c_f32_bf16 v6, v25, v48
v_dot2c_f32_bf16 v8, v25, v25
v_dot2c_f32_bf16 v7, v33, v48
v_dot2c_f32_bf16 v9, v33, v33
v_dot2c_f32_bf16 v6, v26, v48
v_dot2c_f32_bf16 v8, v26, v26
v_dot2c_f32_bf16 v7, v34, v48
v_dot2c_f32_bf16 v9, v34, v34
v_dot2c_f32_bf16 v6, v27, v48
v_dot2c_f32_bf16 v8, v27, v27
v_dot2c_f32_bf16 v7, v35, v48
v_dot2c_f32_bf16 v9, v35, v35
s_mov_b64 exec, 1
s_waitcnt vmcnt(0)
buffer_store_dword v5, v4, s[32:35], s88 offen sc1
s_mov_b64 exec, -1
s_nop 1
v_permlane32_swap_b32 v6, v7
v_permlane32_swap_b32 v8, v9
v_add_f32 v6, v6, v7
v_add_f32 v8, v8, v9
s_nop 1
v_permlane16_swap_b32 v6, v8
s_nop 0
v_add_f32 v6, v6, v8
buffer_store_dword v6, v1, s[32:35], s87 offen sc1
s_branch back_102
slow_113:
.p2align 3
v_mfma_f32_16x16x32_bf16 v[160:163], v[120:123], v[156:159], v[44:47]
v_max_f32 v158, v192, v193
v_max_f32 v159, v194, v195
v_permlane32_swap_b32 v130, v131
s_nop 0
v_max_f32 v130, v130, v131
s_nop 2
v_max_f32 v156, v160, v161
v_max_f32 v157, v162, v163
v_max3_f32 v128, v156, v157, v158
v_max_f32 v128, v128, v159
s_nop 1
v_permlane32_swap_b32 v128, v129
s_nop 0
v_max_f32 v128, v128, v129
s_nop 1
v_permlane16_swap_b32 v128, v130
s_nop 0
v_max_f32 v128, v128, v130
v_mov_b32 v130, v128
s_nop 1
v_permlane16_swap_b32 v128, v130
s_nop 0
v_mov_b32 v129, v128
v_mov_b32 v131, v130
s_nop 0
v_permlane32_swap_b32 v128, v129
v_permlane32_swap_b32 v130, v131
v_mul_f32 v128, v128, v124
v_mul_f32 v129, v129, v125
v_pk_fma_f32 v[156:157], v[156:157], v[124:125], v[128:129] op_sel:[0,0,0] op_sel_hi:[1,0,0] neg_lo:[0,0,1] neg_hi:[0,0,1]
v_pk_fma_f32 v[158:159], v[158:159], v[124:125], v[128:129] op_sel:[0,0,0] op_sel_hi:[1,0,0] neg_lo:[0,0,1] neg_hi:[0,0,1]
v_mul_f32 v130, v130, v126
v_mul_f32 v131, v131, v127
v_exp_f32 v156, v156
v_exp_f32 v157, v157
v_exp_f32 v158, v158
v_exp_f32 v159, v159
v_pk_fma_f32 v[164:165], v[164:165], v[124:125], v[128:129] op_sel:[0,1,1] op_sel_hi:[1,1,1] neg_lo:[0,0,1] neg_hi:[0,0,1]
v_pk_fma_f32 v[166:167], v[166:167], v[124:125], v[128:129] op_sel:[0,1,1] op_sel_hi:[1,1,1] neg_lo:[0,0,1] neg_hi:[0,0,1]
v_exp_f32 v164, v164
v_exp_f32 v165, v165
v_exp_f32 v166, v166
v_exp_f32 v167, v167
v_pk_fma_f32 v[172:173], v[172:173], v[126:127], v[130:131] op_sel:[0,0,0] op_sel_hi:[1,0,0] neg_lo:[0,0,1] neg_hi:[0,0,1]
v_pk_fma_f32 v[174:175], v[174:175], v[126:127], v[130:131] op_sel:[0,0,0] op_sel_hi:[1,0,0] neg_lo:[0,0,1] neg_hi:[0,0,1]
v_cvt_pk_bf16_f32 v156, v156, v156
v_cvt_pk_bf16_f32 v157, v157, v157
v_cvt_pk_bf16_f32 v158, v158, v158
v_cvt_pk_bf16_f32 v159, v159, v159
v_exp_f32 v172, v172
v_exp_f32 v173, v173
v_exp_f32 v174, v174
v_exp_f32 v175, v175
v_pk_fma_f32 v[180:181], v[180:181], v[126:127], v[130:131] op_sel:[0,1,1] op_sel_hi:[1,1,1] neg_lo:[0,0,1] neg_hi:[0,0,1]
v_pk_fma_f32 v[182:183], v[182:183], v[126:127], v[130:131] op_sel:[0,1,1] op_sel_hi:[1,1,1] neg_lo:[0,0,1] neg_hi:[0,0,1]
v_and_b32 v156, v52, v156
v_and_b32 v157, v52, v157
v_and_b32 v158, v52, v158
v_and_b32 v159, v52, v159
v_cvt_pk_bf16_f32 v164, v164, v164
v_cvt_pk_bf16_f32 v165, v165, v165
v_mfma_f32_16x16x32_bf16 v[160:163], v[48:51], v[156:159], 0
v_cvt_pk_bf16_f32 v166, v166, v166
v_cvt_pk_bf16_f32 v167, v167, v167
v_mfma_f32_16x16x32_bf16 v[220:223], v[100:103], v[156:159], 0
v_exp_f32 v180, v180
v_mfma_f32_16x16x32_bf16 v[224:227], v[110:113], v[156:159], 0
v_exp_f32 v181, v181
v_exp_f32 v182, v182
v_exp_f32 v183, v183
v_and_b32 v164, v52, v164
v_and_b32 v165, v52, v165
v_and_b32 v166, v52, v166
v_and_b32 v167, v52, v167
v_cvt_pk_bf16_f32 v172, v172, v172
v_cvt_pk_bf16_f32 v173, v173, v173
v_mfma_f32_16x16x32_bf16 v[168:171], v[48:51], v[164:167], 0
v_cvt_pk_bf16_f32 v174, v174, v174
v_cvt_pk_bf16_f32 v175, v175, v175
v_mfma_f32_16x16x32_bf16 v[228:231], v[102:105], v[164:167], 0
v_and_b32 v172, v52, v172
v_and_b32 v173, v52, v173
v_mfma_f32_16x16x32_bf16 v[232:235], v[112:115], v[164:167], 0
v_and_b32 v174, v52, v174
v_and_b32 v175, v52, v175
v_cvt_pk_bf16_f32 v180, v180, v180
v_cvt_pk_bf16_f32 v181, v181, v181
v_mfma_f32_16x16x32_bf16 v[176:179], v[48:51], v[172:175], 0
v_cvt_pk_bf16_f32 v182, v182, v182
v_cvt_pk_bf16_f32 v183, v183, v183
v_mfma_f32_16x16x32_bf16 v[236:239], v[104:107], v[172:175], 0
v_and_b32 v180, v52, v180
v_and_b32 v181, v52, v181
v_mfma_f32_16x16x32_bf16 v[240:243], v[114:117], v[172:175], 0
v_and_b32 v182, v52, v182
v_and_b32 v183, v52, v183
v_rcp_f32 v160, v160
v_rcp_f32 v168, v168
v_pk_mul_f32 v[220:221], v[220:221], v[160:161] op_sel:[0,0] op_sel_hi:[1,0]
v_pk_mul_f32 v[222:223], v[222:223], v[160:161] op_sel:[0,0] op_sel_hi:[1,0]
v_pk_mul_f32 v[228:229], v[228:229], v[168:169] op_sel:[0,0] op_sel_hi:[1,0]
v_pk_mul_f32 v[224:225], v[224:225], v[160:161] op_sel:[0,0] op_sel_hi:[1,0]
v_pk_mul_f32 v[226:227], v[226:227], v[160:161] op_sel:[0,0] op_sel_hi:[1,0]
v_pk_mul_f32 v[230:231], v[230:231], v[168:169] op_sel:[0,0] op_sel_hi:[1,0]
v_pk_mul_f32 v[232:233], v[232:233], v[168:169] op_sel:[0,0] op_sel_hi:[1,0]
v_pk_mul_f32 v[234:235], v[234:235], v[168:169] op_sel:[0,0] op_sel_hi:[1,0]
v_mfma_f32_16x16x32_bf16 v[184:187], v[48:51], v[180:183], 0
v_rcp_f32_e64 v176, v176
v_cvt_pk_bf16_f32 v220, v220, v221
v_cvt_pk_bf16_f32 v221, v222, v223
v_cvt_pk_bf16_f32 v228, v228, v229
v_pk_mul_f32 v[236:237], v[236:237], v[176:177] op_sel:[0,0] op_sel_hi:[1,0]
v_mfma_f32_16x16x32_bf16 v[244:247], v[106:109], v[180:183], 0
v_cvt_pk_bf16_f32 v222, v224, v225
v_cvt_pk_bf16_f32 v223, v226, v227
v_rcp_f32_e64 v184, v184
v_cvt_pk_bf16_f32 v229, v230, v231
v_pk_mul_f32 v[238:239], v[238:239], v[176:177] op_sel:[0,0] op_sel_hi:[1,0]
v_pk_mul_f32 v[240:241], v[240:241], v[176:177] op_sel:[0,0] op_sel_hi:[1,0]
v_pk_mul_f32 v[242:243], v[242:243], v[176:177] op_sel:[0,0] op_sel_hi:[1,0]
v_cvt_pk_bf16_f32 v236, v236, v237
v_pk_mul_f32 v[244:245], v[244:245], v[184:185] op_sel:[0,0] op_sel_hi:[1,0]
v_pk_mul_f32 v[246:247], v[246:247], v[184:185] op_sel:[0,0] op_sel_hi:[1,0]
v_mfma_f32_16x16x32_bf16 v[248:251], v[116:119], v[180:183], 0
buffer_store_dwordx4 v[220:223], v18, s[32:35], s80 offen sc1
v_cvt_pk_bf16_f32 v230, v232, v233
v_cvt_pk_bf16_f32 v231, v234, v235
v_cvt_pk_bf16_f32 v237, v238, v239
v_cvt_pk_bf16_f32 v244, v244, v245
buffer_store_dwordx4 v[228:231], v18, s[32:35], s81 offen sc1
v_cvt_pk_bf16_f32 v238, v240, v241
v_cvt_pk_bf16_f32 v239, v242, v243
v_pk_mul_f32 v[248:249], v[248:249], v[184:185] op_sel:[0,0] op_sel_hi:[1,0]
v_pk_mul_f32 v[250:251], v[250:251], v[184:185] op_sel:[0,0] op_sel_hi:[1,0]
v_cvt_pk_bf16_f32 v245, v246, v247
buffer_store_dwordx4 v[236:239], v18, s[32:35], s82 offen sc1
v_cvt_pk_bf16_f32 v246, v248, v249
v_cvt_pk_bf16_f32 v247, v250, v251
buffer_store_dwordx4 v[244:247], v18, s[32:35], s83 offen sc1
s_branch back_114
slow_115:
buffer_store_dword v5, v4, s[32:35], s84 offen sc1
s_branch back_116
slow_119:
s_nop 0
v_cvt_pk_bf16_f32 v20, v60, v61
v_cvt_pk_bf16_f32 v21, v62, v63
v_cvt_pk_bf16_f32 v22, v64, v65
v_cvt_pk_bf16_f32 v23, v66, v67
buffer_store_dwordx4 v[20:23], v18, s[32:35], s85 offen offset:0 sc1
v_cvt_pk_bf16_f32 v24, v68, v69
v_cvt_pk_bf16_f32 v25, v70, v71
v_cvt_pk_bf16_f32 v26, v72, v73
v_cvt_pk_bf16_f32 v27, v74, v75
buffer_store_dwordx4 v[24:27], v18, s[32:35], s85 offen offset:1024 sc1
v_cvt_pk_bf16_f32 v28, v76, v77
v_cvt_pk_bf16_f32 v29, v78, v79
v_cvt_pk_bf16_f32 v30, v80, v81
v_cvt_pk_bf16_f32 v31, v82, v83
buffer_store_dwordx4 v[28:31], v18, s[32:35], s86 offen offset:0 sc1
v_cvt_pk_bf16_f32 v32, v84, v85
v_cvt_pk_bf16_f32 v33, v86, v87
v_cvt_pk_bf16_f32 v34, v88, v89
v_cvt_pk_bf16_f32 v35, v90, v91
buffer_store_dwordx4 v[32:35], v18, s[32:35], s86 offen offset:1024 sc1
s_barrier
v_dot2c_f32_bf16 v6, v20, v48
v_dot2c_f32_bf16 v8, v20, v20
v_dot2c_f32_bf16 v7, v28, v48
v_dot2c_f32_bf16 v9, v28, v28
v_dot2c_f32_bf16 v6, v21, v48
v_dot2c_f32_bf16 v8, v21, v21
v_dot2c_f32_bf16 v7, v29, v48
v_dot2c_f32_bf16 v9, v29, v29
v_dot2c_f32_bf16 v6, v22, v48
v_dot2c_f32_bf16 v8, v22, v22
v_dot2c_f32_bf16 v7, v30, v48
v_dot2c_f32_bf16 v9, v30, v30
v_dot2c_f32_bf16 v6, v23, v48
v_dot2c_f32_bf16 v8, v23, v23
v_dot2c_f32_bf16 v7, v31, v48
v_dot2c_f32_bf16 v9, v31, v31
v_dot2c_f32_bf16 v6, v24, v48
v_dot2c_f32_bf16 v8, v24, v24
v_dot2c_f32_bf16 v7, v32, v48
v_dot2c_f32_bf16 v9, v32, v32
v_dot2c_f32_bf16 v6, v25, v48
v_dot2c_f32_bf16 v8, v25, v25
v_dot2c_f32_bf16 v7, v33, v48
v_dot2c_f32_bf16 v9, v33, v33
v_dot2c_f32_bf16 v6, v26, v48
v_dot2c_f32_bf16 v8, v26, v26
v_dot2c_f32_bf16 v7, v34, v48
v_dot2c_f32_bf16 v9, v34, v34
v_dot2c_f32_bf16 v6, v27, v48
v_dot2c_f32_bf16 v8, v27, v27
v_dot2c_f32_bf16 v7, v35, v48
v_dot2c_f32_bf16 v9, v35, v35
s_mov_b64 exec, 1
s_waitcnt vmcnt(0)
buffer_store_dword v5, v4, s[32:35], s88 offen sc1
s_mov_b64 exec, -1
s_nop 1
v_permlane32_swap_b32 v6, v7
v_permlane32_swap_b32 v8, v9
v_add_f32 v6, v6, v7
v_add_f32 v8, v8, v9
s_nop 1
v_permlane16_swap_b32 v6, v8
s_nop 0
v_add_f32 v6, v6, v8
buffer_store_dword v6, v1, s[32:35], s87 offen sc1
s_branch back_120
slow_133:
.p2align 3
v_mfma_f32_16x16x32_bf16 v[156:159], v[188:191], v[60:63], 0
v_mfma_f32_16x16x32_bf16 v[164:167], v[188:191], v[68:71], 0
v_mfma_f32_16x16x32_bf16 v[160:163], v[192:195], v[60:63], 0
v_mfma_f32_16x16x32_bf16 v[172:175], v[188:191], v[76:79], 0
v_mfma_f32_16x16x32_bf16 v[168:171], v[192:195], v[68:71], 0
v_mfma_f32_16x16x32_bf16 v[180:183], v[188:191], v[84:87], 0
v_mfma_f32_16x16x32_bf16 v[156:159], v[196:199], v[220:223], v[156:159]
v_mfma_f32_16x16x32_bf16 v[176:179], v[192:195], v[76:79], 0
v_mfma_f32_16x16x32_bf16 v[164:167], v[196:199], v[228:231], v[164:167]
v_mfma_f32_16x16x32_bf16 v[184:187], v[192:195], v[84:87], 0
v_mfma_f32_16x16x32_bf16 v[160:163], v[200:203], v[220:223], v[160:163]
v_mfma_f32_16x16x32_bf16 v[172:175], v[196:199], v[236:239], v[172:175]
v_mfma_f32_16x16x32_bf16 v[168:171], v[200:203], v[228:231], v[168:171]
v_mfma_f32_16x16x32_bf16 v[180:183], v[196:199], v[244:247], v[180:183]
v_mfma_f32_16x16x32_bf16 v[176:179], v[200:203], v[236:239], v[176:179]
v_mfma_f32_16x16x32_bf16 v[184:187], v[200:203], v[244:247], v[184:187]
v_pk_mul_f32 v[156:157], v[156:157], v[100:101] op_sel:[0,0] op_sel_hi:[1,0]
v_pk_mul_f32 v[158:159], v[158:159], v[100:101] op_sel:[0,0] op_sel_hi:[1,0]
v_cvt_pk_bf16_f32 v156, v156, v157
v_pk_mul_f32 v[164:165], v[164:165], v[100:101] op_sel:[0,1] op_sel_hi:[1,1]
v_pk_mul_f32 v[160:161], v[160:161], v[100:101] op_sel:[0,0] op_sel_hi:[1,0]
v_pk_mul_f32 v[162:163], v[162:163], v[100:101] op_sel:[0,0] op_sel_hi:[1,0]
v_cvt_pk_bf16_f32 v157, v158, v159
v_pk_mul_f32 v[166:167], v[166:167], v[100:101] op_sel:[0,1] op_sel_hi:[1,1]
v_cvt_pk_bf16_f32 v164, v164, v165
v_pk_mul_f32 v[172:173], v[172:173], v[102:103] op_sel:[0,0] op_sel_hi:[1,0]
v_cvt_pk_bf16_f32 v158, v160, v161
v_cvt_pk_bf16_f32 v159, v162, v163
v_pk_mul_f32 v[168:169], v[168:169], v[100:101] op_sel:[0,1] op_sel_hi:[1,1]
v_pk_mul_f32 v[170:171], v[170:171], v[100:101] op_sel:[0,1] op_sel_hi:[1,1]
v_cvt_pk_bf16_f32 v165, v166, v167
v_pk_mul_f32 v[174:175], v[174:175], v[102:103] op_sel:[0,0] op_sel_hi:[1,0]
v_cvt_pk_bf16_f32 v172, v172, v173
v_pk_mul_f32 v[180:181], v[180:181], v[102:103] op_sel:[0,1] op_sel_hi:[1,1]
buffer_store_dwordx4 v[156:159], v18, s[32:35], s80 offen sc1
v_cvt_pk_bf16_f32 v166, v168, v169
v_cvt_pk_bf16_f32 v167, v170, v171
v_pk_mul_f32 v[176:177], v[176:177], v[102:103] op_sel:[0,0] op_sel_hi:[1,0]
v_pk_mul_f32 v[178:179], v[178:179], v[102:103] op_sel:[0,0] op_sel_hi:[1,0]
v_cvt_pk_bf16_f32 v173, v174, v175
v_pk_mul_f32 v[182:183], v[182:183], v[102:103] op_sel:[0,1] op_sel_hi:[1,1]
v_cvt_pk_bf16_f32 v180, v180, v181
buffer_store_dwordx4 v[164:167], v18, s[32:35], s81 offen sc1
v_cvt_pk_bf16_f32 v174, v176, v177
v_cvt_pk_bf16_f32 v175, v178, v179
v_pk_mul_f32 v[184:185], v[184:185], v[102:103] op_sel:[0,1] op_sel_hi:[1,1]
v_pk_mul_f32 v[186:187], v[186:187], v[102:103] op_sel:[0,1] op_sel_hi:[1,1]
v_cvt_pk_bf16_f32 v181, v182, v183
buffer_store_dwordx4 v[172:175], v18, s[32:35], s82 offen sc1
v_cvt_pk_bf16_f32 v182, v184, v185
v_cvt_pk_bf16_f32 v183, v186, v187
buffer_store_dwordx4 v[180:183], v18, s[32:35], s83 offen sc1
s_branch back_134
slow_135:
buffer_store_dword v5, v4, s[32:35], s84 offen sc1
s_branch back_136
s_endpgm
.section .rodata,"a"
.p2align 6
.amdhsa_kernel interleave_layers__sliding_local_dilated__linear_kernel_hedgehog__prompt_kernel
  .amdhsa_next_free_vgpr 256
  .amdhsa_next_free_sgpr 102
  .amdhsa_accum_offset 256
  .amdhsa_group_segment_fixed_size 0
  .amdhsa_kernarg_size 80
  .amdhsa_user_sgpr_count 2
  .amdhsa_user_sgpr_kernarg_segment_ptr 1
  .amdhsa_system_sgpr_workgroup_id_x 1
.end_amdhsa_kernel
```

```asm
; @launch grid=(256,1,1) block=(512,1,1) lds=163840
.amdgcn_target "amdgcn-amd-amdhsa--gfx950"
.text
.globl interleave_layers__sliding_local_dilated__linear_kernel_hedgehog__prompt_kernel
.p2align 8
.type interleave_layers__sliding_local_dilated__linear_kernel_hedgehog__prompt_kernel,@function
interleave_layers__sliding_local_dilated__linear_kernel_hedgehog__prompt_kernel:
s_cmp_ge_u32 s2, 256
s_cbranch_scc1 L_end
s_load_dwordx16 s[4:19], s[0:1], 0
s_load_dwordx4 s[20:23], s[0:1], 64
v_lshrrev_b32 v1, 6, v0
v_and_b32 v0, 63, v0
v_readfirstlane_b32 s40, v1
v_and_b32 v2, 15, v0
v_lshrrev_b32 v3, 4, v0
v_lshlrev_b32 v18, 4, v0
s_and_b32 s48, s2, 7
s_lshr_b32 s49, s2, 3
s_and_b32 s74, s49, 1
s_lshl_b32 s41, s48, 1
s_add_u32 s41, s41, s74
s_lshr_b32 s42, s49, 1
s_and_b32 s48, s2, 7
s_lshr_b32 s47, s42, 2
s_add_u32 s47, s47, s48
s_and_b32 s47, s47, 3
s_and_b32 s43, s40, 3
s_lshl_b32 s70, s43, 12
s_lshl_b32 s71, s43, 11
s_add_u32 s71, s71, 16384
s_cmp_lt_u32 s40, 4
s_cbranch_scc1 L_compute
v_lshrrev_b32 v4, 3, v0
v_and_b32 v5, 7, v0
s_lshl_b32 s48, s43, 4
v_add_u32 v6, s48, v4
s_lshl_b32 s48, s42, 7
s_mov_b32 s49, 6144
v_mul_u32_u24 v6, s49, v6
v_and_b32 v7, 2, v4
v_xor_b32 v7, v7, v5
v_lshl_add_u32 v26, v7, 4, v6
v_add_u32 v26, s48, v26
s_mul_i32 s49, s49, 8
s_sub_u32 s49, s49, 1024
v_xor_b32 v27, 64, v26
v_add_u32 v27, s49, v27
s_mov_b32 s53, 2048
s_mov_b32 s54, 393216
s_mov_b32 s57, 131072
s_lshl_b32 s48, s41, 7
s_lshl_b32 s49, s43, 5
s_add_u32 s48, s48, s49
v_add_u32 v6, s48, v4
v_lshlrev_b32 v6, 11, v6
v_lshrrev_b32 v7, 1, v4
v_xor_b32 v7, v7, v5
v_lshl_add_u32 v20, v7, 4, v6
v_xor_b32 v21, 64, v20
v_add_u32 v21, 15360, v21
v_add_u32 v22, 30720, v20
v_add_u32 v23, 30720, v21
s_add_u32 s69, s47, 0
s_and_b32 s69, s69, 3
s_add_u32 s69, s69, 0
s_mul_i32 s67, s69, 128
s_mul_i32 s68, s69, s54
s_waitcnt lgkmcnt(0)
s_mov_b32 s24, s4
s_and_b32 s25, s5, 0xffff
s_mov_b32 s26, 4194304
s_mov_b32 s27, 0x00020000
s_mov_b32 s28, s6
s_and_b32 s29, s7, 0xffff
s_mov_b32 s30, 6291456
s_mov_b32 s31, 0x00020000
s_add_u32 m0, s70, 0
s_nop 0
buffer_load_dwordx4 v20, s[24:27], s67 offen offset:0  lds
buffer_load_dwordx4 v21, s[24:27], s67 offen offset:1024  lds
buffer_load_dwordx4 v22, s[24:27], s67 offen offset:2048  lds
buffer_load_dwordx4 v23, s[24:27], s67 offen offset:3072  lds
s_add_u32 s60, s71, 0
s_add_u32 m0, s60, 0
s_mov_b32 s61, s68
buffer_load_dwordx4 v26, s[28:31], s61 offen lds
buffer_load_dwordx4 v27, s[28:31], s61 offen offset:1024 lds
s_add_u32 m0, s60, 8192
s_add_u32 s61, s61, s53
buffer_load_dwordx4 v26, s[28:31], s61 offen lds
buffer_load_dwordx4 v27, s[28:31], s61 offen offset:1024 lds
s_add_u32 m0, s60, 16384
s_add_u32 s61, s61, s53
buffer_load_dwordx4 v26, s[28:31], s61 offen lds
buffer_load_dwordx4 v27, s[28:31], s61 offen offset:1024 lds
s_lshr_b32 s48, s2, 2
s_and_b32 s48, s48, 1
s_lshl_b32 s48, s48, 1
s_add_u32 s48, s48, s74
s_and_b32 s49, s42, 3
s_xor_b32 s77, s48, s49
s_add_u32 s77, s77, 4
s_add_u32 s48, s47, 1
s_and_b32 s48, s48, 3
s_and_b32 s49, s77, 3
s_lshl_b32 s49, s49, 2
s_add_u32 s78, s48, s49
s_and_b32 s48, s2, 7
s_lshl_b32 s48, s48, 1
s_add_u32 s75, s78, s48
s_and_b32 s75, s75, 15
s_mov_b32 s46, 0
s_mov_b32 s32, s22
s_and_b32 s33, s23, 0xffff
s_mov_b32 s34, 268435456
s_mov_b32 s35, 0x00020000
s_mov_b32 s36, s8
s_and_b32 s37, s9, 0xffff
s_mov_b32 s38, 2097152
s_mov_b32 s39, 0x00020000
v_mov_b32 v56, -1
v_mov_b32 v57, -1
v_mov_b32 v58, -1
v_mov_b32 v59, -1
s_lshl_b32 s52, s41, 6
s_add_u32 s52, s52, s42
s_lshl_b32 s52, s52, 8
s_add_u32 s52, s52, 16777216
s_getreg_b32 s50, hwreg(HW_REG_XCC_ID)
s_and_b32 s50, s50, 7
s_lshl_b32 s50, s50, 3
s_lshl_b64 s[94:95], 1, s50
s_and_b32 s96, s2, 7
s_lshl_b32 s96, s96, 5
s_and_b32 s51, s42, 7
s_cmp_gt_u32 s51, 3
s_cselect_b32 s49, 1, 0
s_sub_u32 s49, s51, s49
s_lshl_b32 s49, s49, 1
s_add_u32 s49, s49, s74
s_lshl_b32 s49, s49, 2
s_add_u32 s49, s49, s43
s_lshr_b32 s50, s49, 4
s_lshl_b32 s50, s50, 11
s_and_b32 s49, s49, 15
s_mul_i32 s49, s49, 24576
s_add_u32 s49, s49, s50
s_and_b32 s50, s42, 8
s_or_b32 s50, s50, 3
s_and_b32 s48, s2, 7
s_lshr_b32 s76, s50, 2
s_add_u32 s76, s76, s48
s_and_b32 s76, s76, 3
s_lshl_b32 s50, s50, 7
s_add_u32 s49, s49, s50
s_and_b32 s51, s51, 3
s_cmp_eq_u32 s51, 3
s_cselect_b32 s49, 0x70000000, s49
v_mul_u32_u24 v4, 6144, v4
v_lshl_add_u32 v4, v5, 4, v4
v_lshrrev_b32 v5, 5, v0
v_lshlrev_b32 v5, 30, v5
v_add3_u32 v36, v4, v5, s49
s_mov_b32 s55, -1
s_mov_b32 s56, -1
v_lshrrev_b32 v4, 3, v0
v_and_b32 v5, 7, v0
s_lshr_b32 s48, s43, 1
s_lshl_b32 s48, s48, 5
s_and_b32 s49, s43, 1
s_lshl_b32 s49, s49, 3
s_add_u32 s48, s48, s49
v_lshrrev_b32 v6, 2, v4
v_lshlrev_b32 v6, 4, v6
v_and_b32 v7, 3, v4
v_add3_u32 v6, v6, v7, s48
s_lshl_b32 s48, s78, 7
s_mov_b32 s49, 2048
v_mul_u32_u24 v6, s49, v6
v_and_b32 v7, 2, v4
v_xor_b32 v7, v7, v5
v_lshl_add_u32 v28, v7, 4, v6
v_add_u32 v28, s48, v28
s_mul_i32 s49, s49, 4
s_sub_u32 s49, s49, 1024
v_xor_b32 v29, 64, v28
v_add_u32 v29, s49, v29
v_lshrrev_b32 v4, 3, v0
v_and_b32 v5, 7, v0
s_lshr_b32 s48, s43, 1
s_lshl_b32 s48, s48, 5
s_and_b32 s49, s43, 1
s_lshl_b32 s49, s49, 3
s_add_u32 s48, s48, s49
v_lshrrev_b32 v6, 2, v4
v_lshlrev_b32 v6, 4, v6
v_and_b32 v7, 3, v4
v_add3_u32 v6, v6, v7, s48
s_lshl_b32 s48, s42, 7
s_mov_b32 s49, 6144
s_cmp_ge_i32 s55, 0
s_cselect_b32 s48, 1024, s48
s_cselect_b32 s49, 384, s49
v_mul_u32_u24 v6, s49, v6
v_and_b32 v7, 2, v4
v_xor_b32 v7, v7, v5
v_lshl_add_u32 v60, v7, 4, v6
v_add_u32 v60, s48, v60
s_mul_i32 s49, s49, 4
s_sub_u32 s49, s49, 1024
v_xor_b32 v61, 64, v60
v_add_u32 v61, s49, v61
v_lshrrev_b32 v4, 3, v0
v_and_b32 v5, 7, v0
s_lshr_b32 s48, s43, 1
s_lshl_b32 s48, s48, 5
s_and_b32 s49, s43, 1
s_lshl_b32 s49, s49, 3
s_add_u32 s48, s48, s49
v_lshrrev_b32 v6, 2, v4
v_lshlrev_b32 v6, 4, v6
v_and_b32 v7, 3, v4
v_add3_u32 v6, v6, v7, s48
s_lshl_b32 s48, s78, 7
s_mov_b32 s49, 2048
s_cmp_ge_i32 s56, 0
s_cselect_b32 s48, 1024, s48
s_cselect_b32 s49, 128, s49
v_mul_u32_u24 v6, s49, v6
v_and_b32 v7, 2, v4
v_xor_b32 v7, v7, v5
v_lshl_add_u32 v24, v7, 4, v6
v_add_u32 v24, s48, v24
s_mul_i32 s49, s49, 4
s_sub_u32 s49, s49, 1024
v_xor_b32 v25, 64, v24
v_add_u32 v25, s49, v25
v_lshlrev_b32 v30, 2, v2
v_and_b32 v32, 7, v0
v_lshlrev_b32 v32, 5, v32
s_lshl_b32 s50, s41, 2
s_add_u32 s50, s50, s43
s_lshl_b32 s50, s50, 12
s_add_u32 s50, s50, 16777216
v_add_u32 v37, s50, v18
v_lshrrev_b32 v4, 5, v0
v_lshl_add_u32 v4, v4, 4, v2
s_lshl_b32 s48, s43, 5
v_add_u32 v4, s48, v4
v_lshlrev_b32 v49, 3, v4
v_add_u32 v49, 131072, v49
v_lshlrev_b32 v50, 2, v4
v_add_u32 v50, 132096, v50
s_lshl_b32 s79, s41, 2
s_add_u32 s79, s79, s43
s_lshl_b32 s79, s79, 7
s_add_u32 s79, s79, 18358272
s_lshl_b32 s48, s41, 3
s_lshl_b32 s49, s43, 1
s_add_u32 s48, s48, s49
s_lshl_b32 s80, s48, 15
s_lshl_b32 s49, s42, 11
s_add_u32 s81, s80, s49
s_add_u32 s81, s81, 4194304
s_add_u32 s82, s81, 32768
s_lshl_b32 s48, s43, 11
v_add_u32 v51, s48, v18
v_add_u32 v52, 0x10000, v51
v_add_u32 v14, 0x20000, v51
s_lshl_b32 s48, s2, 2
s_add_u32 s48, s48, s43
s_lshl_b32 s83, s48, 11
s_mul_i32 s87, s48, 6144
v_add_u32 v62, s83, v18
s_add_u32 s87, s87, 3072
v_add_u32 v63, s87, v18
s_lshr_b32 s48, s2, 4
s_and_b32 s49, s2, 7
s_add_u32 s48, s48, s49
s_mul_i32 s49, s48, 8193
s_lshr_b32 s49, s49, 16
s_mul_i32 s49, s49, 8
s_sub_u32 s88, s48, s49
s_lshr_b32 s48, s2, 3
s_lshl_b32 s48, s48, 2
s_add_u32 s48, s48, s43
s_lshl_b32 s48, s48, 14
s_add_u32 s48, s48, 384
v_lshrrev_b32 v4, 3, v0
v_and_b32 v5, 7, v0
v_lshlrev_b32 v4, 11, v4
v_lshl_add_u32 v4, v5, 4, v4
v_add_u32 v15, s48, v4
s_mul_i32 s48, s42, 163840
s_add_u32 s48, s48, 9437184
s_lshl_b32 s49, s43, 4
s_add_u32 s49, s49, s41
s_lshl_b32 s50, s49, 11
s_add_u32 s86, s48, s50
s_lshl_b32 s50, s49, 9
s_add_u32 s89, s48, s50
s_add_u32 s89, s89, 131072
v_lshlrev_b32 v39, 3, v0
s_lshl_b32 s73, s42, 2
s_add_u32 s73, s73, 0
s_lshl_b32 s73, s73, 7
s_add_u32 s73, s73, 18366464
v_mov_b32 v12, 0
s_lshl_b32 s50, s43, 12
s_add_u32 s50, s50, s52
s_add_u32 s50, s50, 262144
v_min_u32 v8, 2, v3
v_lshlrev_b32 v8, 18, v8
v_lshl_add_u32 v8, v2, 4, v8
v_add_u32 v55, s50, v8
s_lshl_b32 s50, s42, 2
s_add_u32 s50, s50, s43
s_lshl_b32 s50, s50, 12
s_add_u32 s50, s50, 17825792
v_add_u32 v38, s50, v18
v_min_u32 v4, 2, v3
v_lshlrev_b32 v4, 8, v4
v_lshl_add_u32 v4, v2, 2, v4
s_and_b32 s48, s43, 1
s_lshl_b32 s48, s48, 7
s_lshr_b32 s49, s43, 1
s_lshl_b32 s49, s49, 6
s_add_u32 s48, s48, s49
s_add_u32 s48, s48, 133120
v_add_u32 v53, s48, v4
s_getpc_b64 s[98:99]
pc_1:
s_add_u32 s98, s98, c0_last - pc_1
s_addc_u32 s99, s99, 0
s_lshr_b32 s50, s2, 3
s_lshl_b32 s50, s50, 2
s_add_u32 s50, s50, s43
s_lshl_b32 s50, s50, 7
v_and_b32 v4, 1, v0
v_lshl_add_u32 v4, v4, 6, s50
v_min_u32 v54, L_code_end - c0_last, v4
s_add_u32 s69, s47, 0
s_and_b32 s69, s69, 3
s_add_u32 s69, s69, 4
s_mul_i32 s67, s69, 128
s_mul_i32 s68, s69, s54
s_add_u32 m0, s70, 40960
s_nop 0
buffer_load_dwordx4 v20, s[24:27], s67 offen offset:0  lds
buffer_load_dwordx4 v21, s[24:27], s67 offen offset:1024  lds
buffer_load_dwordx4 v22, s[24:27], s67 offen offset:2048  lds
buffer_load_dwordx4 v23, s[24:27], s67 offen offset:3072  lds
s_add_u32 s60, s71, 40960
s_add_u32 m0, s60, 0
s_mov_b32 s61, s68
buffer_load_dwordx4 v26, s[28:31], s61 offen lds
buffer_load_dwordx4 v27, s[28:31], s61 offen offset:1024 lds
s_add_u32 m0, s60, 8192
s_add_u32 s61, s61, s53
buffer_load_dwordx4 v26, s[28:31], s61 offen lds
buffer_load_dwordx4 v27, s[28:31], s61 offen offset:1024 lds
s_add_u32 m0, s60, 16384
s_add_u32 s61, s61, s53
buffer_load_dwordx4 v26, s[28:31], s61 offen lds
buffer_load_dwordx4 v27, s[28:31], s61 offen offset:1024 lds
s_waitcnt vmcnt(10)
s_barrier
s_cmp_lg_u32 s43, 3
s_cbranch_scc1 else_2
s_atomic_add_x2 s[94:95], s[20:21], s96
else_2:
s_add_u32 s49, s76, 0
s_and_b32 s49, s49, 3
s_add_u32 s49, s49, 8
s_mul_i32 s49, s49, 393216
buffer_load_dwordx4 v[40:43], v36, s[28:31], s49 offen
s_add_u32 s49, s76, 0
s_and_b32 s49, s49, 3
s_add_u32 s49, s49, 12
s_mul_i32 s49, s49, 393216
buffer_load_dwordx4 v[40:43], v36, s[28:31], s49 offen
s_add_u32 s69, s47, 0
s_and_b32 s69, s69, 3
s_add_u32 s69, s69, 8
s_mul_i32 s67, s69, 128
s_mul_i32 s68, s69, s54
s_add_u32 m0, s70, 81920
s_nop 0
buffer_load_dwordx4 v20, s[24:27], s67 offen offset:0  lds
buffer_load_dwordx4 v21, s[24:27], s67 offen offset:1024  lds
buffer_load_dwordx4 v22, s[24:27], s67 offen offset:2048  lds
buffer_load_dwordx4 v23, s[24:27], s67 offen offset:3072  lds
s_add_u32 s60, s71, 81920
s_add_u32 m0, s60, 0
s_mov_b32 s61, s68
buffer_load_dwordx4 v26, s[28:31], s61 offen lds
buffer_load_dwordx4 v27, s[28:31], s61 offen offset:1024 lds
s_add_u32 m0, s60, 8192
s_add_u32 s61, s61, s53
buffer_load_dwordx4 v26, s[28:31], s61 offen lds
buffer_load_dwordx4 v27, s[28:31], s61 offen offset:1024 lds
s_add_u32 m0, s60, 16384
s_add_u32 s61, s61, s53
buffer_load_dwordx4 v26, s[28:31], s61 offen lds
buffer_load_dwordx4 v27, s[28:31], s61 offen offset:1024 lds
s_add_u32 s49, s76, 1
s_and_b32 s49, s49, 3
s_add_u32 s49, s49, 0
s_mul_i32 s49, s49, 393216
buffer_load_dwordx4 v[40:43], v36, s[28:31], s49 offen
s_mov_b32 s64, 0
s_mov_b32 s65, 0
s_waitcnt vmcnt(11)
s_barrier
s_add_u32 s69, s47, 0
s_and_b32 s69, s69, 3
s_add_u32 s69, s69, 12
s_mul_i32 s67, s69, 128
s_mul_i32 s68, s69, s54
s_add_u32 m0, s70, s65
s_nop 0
buffer_load_dwordx4 v20, s[24:27], s67 offen offset:0  lds
buffer_load_dwordx4 v21, s[24:27], s67 offen offset:1024  lds
buffer_load_dwordx4 v22, s[24:27], s67 offen offset:2048  lds
buffer_load_dwordx4 v23, s[24:27], s67 offen offset:3072  lds
s_add_u32 s60, s71, s65
s_add_u32 m0, s60, 0
s_mov_b32 s61, s68
buffer_load_dwordx4 v26, s[28:31], s61 offen lds
buffer_load_dwordx4 v27, s[28:31], s61 offen offset:1024 lds
s_add_u32 m0, s60, 8192
s_add_u32 s61, s61, s53
buffer_load_dwordx4 v26, s[28:31], s61 offen lds
buffer_load_dwordx4 v27, s[28:31], s61 offen offset:1024 lds
s_add_u32 m0, s60, 16384
s_add_u32 s61, s61, s53
buffer_load_dwordx4 v26, s[28:31], s61 offen lds
buffer_load_dwordx4 v27, s[28:31], s61 offen offset:1024 lds
s_add_u32 s49, s76, 1
s_and_b32 s49, s49, 3
s_add_u32 s49, s49, 4
s_mul_i32 s49, s49, 393216
buffer_load_dwordx4 v[40:43], v36, s[28:31], s49 offen
s_add_u32 s65, s65, 40960
s_cmp_eq_u32 s65, 122880
s_cselect_b32 s65, 0, s65
s_add_u32 s64, s64, 1
s_waitcnt vmcnt(11)
s_barrier
s_add_u32 s69, s47, 1
s_and_b32 s69, s69, 3
s_add_u32 s69, s69, 0
s_mul_i32 s67, s69, 128
s_mul_i32 s68, s69, s54
s_add_u32 m0, s70, s65
s_nop 0
buffer_load_dwordx4 v20, s[24:27], s67 offen offset:0  lds
buffer_load_dwordx4 v21, s[24:27], s67 offen offset:1024  lds
buffer_load_dwordx4 v22, s[24:27], s67 offen offset:2048  lds
buffer_load_dwordx4 v23, s[24:27], s67 offen offset:3072  lds
s_add_u32 s60, s71, s65
s_add_u32 m0, s60, 0
s_mov_b32 s61, s68
buffer_load_dwordx4 v26, s[28:31], s61 offen lds
buffer_load_dwordx4 v27, s[28:31], s61 offen offset:1024 lds
s_add_u32 m0, s60, 8192
s_add_u32 s61, s61, s53
buffer_load_dwordx4 v26, s[28:31], s61 offen lds
buffer_load_dwordx4 v27, s[28:31], s61 offen offset:1024 lds
s_add_u32 m0, s60, 16384
s_add_u32 s61, s61, s53
buffer_load_dwordx4 v26, s[28:31], s61 offen lds
buffer_load_dwordx4 v27, s[28:31], s61 offen offset:1024 lds
s_add_u32 s49, s76, 1
s_and_b32 s49, s49, 3
s_add_u32 s49, s49, 8
s_mul_i32 s49, s49, 393216
buffer_load_dwordx4 v[40:43], v36, s[28:31], s49 offen
s_add_u32 s65, s65, 40960
s_cmp_eq_u32 s65, 122880
s_cselect_b32 s65, 0, s65
s_add_u32 s64, s64, 1
s_waitcnt vmcnt(11)
s_barrier
s_cmp_lg_u32 s88, 0
s_cbranch_scc1 else_4
buffer_load_dwordx4 v[108:111], v18, s[36:39], s83 offen offset:0
buffer_load_dwordx4 v[108:111], v18, s[36:39], s83 offen offset:1024
global_load_dwordx4 v[108:111], v63, s[12:13] offset:-3072
global_load_dwordx4 v[108:111], v63, s[12:13] offset:-2048
global_load_dwordx4 v[108:111], v63, s[12:13] offset:-1024
global_load_dwordx4 v[108:111], v63, s[12:13] offset:0
global_load_dwordx4 v[108:111], v63, s[12:13] offset:1024
global_load_dwordx4 v[108:111], v63, s[12:13] offset:2048
buffer_store_dwordx4 v[56:59], v18, s[32:35], s86 offen offset:0 sc1
buffer_store_dwordx4 v[56:59], v18, s[32:35], s86 offen offset:1024 sc1
buffer_store_dwordx2 v[56:57], v39, s[32:35], s89 offen sc1
buffer_store_dwordx4 v[56:59], v55, s[32:35], 0 offen sc1
else_4:
s_add_u32 s69, s47, 1
s_and_b32 s69, s69, 3
s_add_u32 s69, s69, 4
s_mul_i32 s67, s69, 128
s_mul_i32 s68, s69, s54
s_add_u32 m0, s70, s65
s_nop 0
buffer_load_dwordx4 v20, s[24:27], s67 offen offset:0  lds
buffer_load_dwordx4 v21, s[24:27], s67 offen offset:1024  lds
buffer_load_dwordx4 v22, s[24:27], s67 offen offset:2048  lds
buffer_load_dwordx4 v23, s[24:27], s67 offen offset:3072  lds
s_add_u32 s60, s71, s65
s_add_u32 m0, s60, 0
s_mov_b32 s61, s68
buffer_load_dwordx4 v26, s[28:31], s61 offen lds
buffer_load_dwordx4 v27, s[28:31], s61 offen offset:1024 lds
s_add_u32 m0, s60, 8192
s_add_u32 s61, s61, s53
buffer_load_dwordx4 v26, s[28:31], s61 offen lds
buffer_load_dwordx4 v27, s[28:31], s61 offen offset:1024 lds
s_add_u32 m0, s60, 16384
s_add_u32 s61, s61, s53
buffer_load_dwordx4 v26, s[28:31], s61 offen lds
buffer_load_dwordx4 v27, s[28:31], s61 offen offset:1024 lds
s_add_u32 s49, s76, 1
s_and_b32 s49, s49, 3
s_add_u32 s49, s49, 12
s_mul_i32 s49, s49, 393216
buffer_load_dwordx4 v[40:43], v36, s[28:31], s49 offen
s_add_u32 s65, s65, 40960
s_cmp_eq_u32 s65, 122880
s_cselect_b32 s65, 0, s65
s_add_u32 s64, s64, 1
s_waitcnt vmcnt(11)
s_barrier
s_cmp_lg_u32 s88, 1
s_cbranch_scc1 else_6
buffer_load_dwordx4 v[108:111], v18, s[36:39], s83 offen offset:0
buffer_load_dwordx4 v[108:111], v18, s[36:39], s83 offen offset:1024
global_load_dwordx4 v[108:111], v63, s[12:13] offset:-3072
global_load_dwordx4 v[108:111], v63, s[12:13] offset:-2048
global_load_dwordx4 v[108:111], v63, s[12:13] offset:-1024
global_load_dwordx4 v[108:111], v63, s[12:13] offset:0
global_load_dwordx4 v[108:111], v63, s[12:13] offset:1024
global_load_dwordx4 v[108:111], v63, s[12:13] offset:2048
buffer_store_dwordx4 v[56:59], v18, s[32:35], s86 offen offset:0 sc1
buffer_store_dwordx4 v[56:59], v18, s[32:35], s86 offen offset:1024 sc1
buffer_store_dwordx2 v[56:57], v39, s[32:35], s89 offen sc1
buffer_store_dwordx4 v[56:59], v55, s[32:35], 0 offen sc1
else_6:
s_add_u32 s69, s47, 1
s_and_b32 s69, s69, 3
s_add_u32 s69, s69, 8
s_mul_i32 s67, s69, 128
s_mul_i32 s68, s69, s54
s_add_u32 m0, s70, s65
s_nop 0
buffer_load_dwordx4 v20, s[24:27], s67 offen offset:0  lds
buffer_load_dwordx4 v21, s[24:27], s67 offen offset:1024  lds
buffer_load_dwordx4 v22, s[24:27], s67 offen offset:2048  lds
buffer_load_dwordx4 v23, s[24:27], s67 offen offset:3072  lds
s_add_u32 s60, s71, s65
s_add_u32 m0, s60, 0
s_mov_b32 s61, s68
buffer_load_dwordx4 v26, s[28:31], s61 offen lds
buffer_load_dwordx4 v27, s[28:31], s61 offen offset:1024 lds
s_add_u32 m0, s60, 8192
s_add_u32 s61, s61, s53
buffer_load_dwordx4 v26, s[28:31], s61 offen lds
buffer_load_dwordx4 v27, s[28:31], s61 offen offset:1024 lds
s_add_u32 m0, s60, 16384
s_add_u32 s61, s61, s53
buffer_load_dwordx4 v26, s[28:31], s61 offen lds
buffer_load_dwordx4 v27, s[28:31], s61 offen offset:1024 lds
s_add_u32 s49, s76, 2
s_and_b32 s49, s49, 3
s_add_u32 s49, s49, 0
s_mul_i32 s49, s49, 393216
buffer_load_dwordx4 v[40:43], v36, s[28:31], s49 offen
s_add_u32 s65, s65, 40960
s_cmp_eq_u32 s65, 122880
s_cselect_b32 s65, 0, s65
s_add_u32 s64, s64, 1
s_waitcnt vmcnt(11)
s_barrier
s_cmp_lg_u32 s88, 2
s_cbranch_scc1 else_8
buffer_load_dwordx4 v[108:111], v18, s[36:39], s83 offen offset:0
buffer_load_dwordx4 v[108:111], v18, s[36:39], s83 offen offset:1024
global_load_dwordx4 v[108:111], v63, s[12:13] offset:-3072
global_load_dwordx4 v[108:111], v63, s[12:13] offset:-2048
global_load_dwordx4 v[108:111], v63, s[12:13] offset:-1024
global_load_dwordx4 v[108:111], v63, s[12:13] offset:0
global_load_dwordx4 v[108:111], v63, s[12:13] offset:1024
global_load_dwordx4 v[108:111], v63, s[12:13] offset:2048
buffer_store_dwordx4 v[56:59], v18, s[32:35], s86 offen offset:0 sc1
buffer_store_dwordx4 v[56:59], v18, s[32:35], s86 offen offset:1024 sc1
buffer_store_dwordx2 v[56:57], v39, s[32:35], s89 offen sc1
buffer_store_dwordx4 v[56:59], v55, s[32:35], 0 offen sc1
else_8:
s_add_u32 s69, s47, 1
s_and_b32 s69, s69, 3
s_add_u32 s69, s69, 12
s_mul_i32 s67, s69, 128
s_mul_i32 s68, s69, s54
s_add_u32 m0, s70, s65
s_nop 0
buffer_load_dwordx4 v20, s[24:27], s67 offen offset:0  lds
buffer_load_dwordx4 v21, s[24:27], s67 offen offset:1024  lds
buffer_load_dwordx4 v22, s[24:27], s67 offen offset:2048  lds
buffer_load_dwordx4 v23, s[24:27], s67 offen offset:3072  lds
s_add_u32 s60, s71, s65
s_add_u32 m0, s60, 0
s_mov_b32 s61, s68
buffer_load_dwordx4 v26, s[28:31], s61 offen lds
buffer_load_dwordx4 v27, s[28:31], s61 offen offset:1024 lds
s_add_u32 m0, s60, 8192
s_add_u32 s61, s61, s53
buffer_load_dwordx4 v26, s[28:31], s61 offen lds
buffer_load_dwordx4 v27, s[28:31], s61 offen offset:1024 lds
s_add_u32 m0, s60, 16384
s_add_u32 s61, s61, s53
buffer_load_dwordx4 v26, s[28:31], s61 offen lds
buffer_load_dwordx4 v27, s[28:31], s61 offen offset:1024 lds
s_add_u32 s49, s76, 2
s_and_b32 s49, s49, 3
s_add_u32 s49, s49, 4
s_mul_i32 s49, s49, 393216
buffer_load_dwordx4 v[40:43], v36, s[28:31], s49 offen
s_add_u32 s65, s65, 40960
s_cmp_eq_u32 s65, 122880
s_cselect_b32 s65, 0, s65
s_add_u32 s64, s64, 1
s_waitcnt vmcnt(11)
s_barrier
s_cmp_lg_u32 s88, 3
s_cbranch_scc1 else_10
buffer_load_dwordx4 v[108:111], v18, s[36:39], s83 offen offset:0
buffer_load_dwordx4 v[108:111], v18, s[36:39], s83 offen offset:1024
global_load_dwordx4 v[108:111], v63, s[12:13] offset:-3072
global_load_dwordx4 v[108:111], v63, s[12:13] offset:-2048
global_load_dwordx4 v[108:111], v63, s[12:13] offset:-1024
global_load_dwordx4 v[108:111], v63, s[12:13] offset:0
global_load_dwordx4 v[108:111], v63, s[12:13] offset:1024
global_load_dwordx4 v[108:111], v63, s[12:13] offset:2048
buffer_store_dwordx4 v[56:59], v18, s[32:35], s86 offen offset:0 sc1
buffer_store_dwordx4 v[56:59], v18, s[32:35], s86 offen offset:1024 sc1
buffer_store_dwordx2 v[56:57], v39, s[32:35], s89 offen sc1
buffer_store_dwordx4 v[56:59], v55, s[32:35], 0 offen sc1
else_10:
s_add_u32 s69, s47, 2
s_and_b32 s69, s69, 3
s_add_u32 s69, s69, 0
s_mul_i32 s67, s69, 128
s_mul_i32 s68, s69, s54
s_add_u32 m0, s70, s65
s_nop 0
buffer_load_dwordx4 v20, s[24:27], s67 offen offset:0  lds
buffer_load_dwordx4 v21, s[24:27], s67 offen offset:1024  lds
buffer_load_dwordx4 v22, s[24:27], s67 offen offset:2048  lds
buffer_load_dwordx4 v23, s[24:27], s67 offen offset:3072  lds
s_add_u32 s60, s71, s65
s_add_u32 m0, s60, 0
s_mov_b32 s61, s68
buffer_load_dwordx4 v26, s[28:31], s61 offen lds
buffer_load_dwordx4 v27, s[28:31], s61 offen offset:1024 lds
s_add_u32 m0, s60, 8192
s_add_u32 s61, s61, s53
buffer_load_dwordx4 v26, s[28:31], s61 offen lds
buffer_load_dwordx4 v27, s[28:31], s61 offen offset:1024 lds
s_add_u32 m0, s60, 16384
s_add_u32 s61, s61, s53
buffer_load_dwordx4 v26, s[28:31], s61 offen lds
buffer_load_dwordx4 v27, s[28:31], s61 offen offset:1024 lds
s_add_u32 s49, s76, 2
s_and_b32 s49, s49, 3
s_add_u32 s49, s49, 8
s_mul_i32 s49, s49, 393216
buffer_load_dwordx4 v[40:43], v36, s[28:31], s49 offen
s_add_u32 s65, s65, 40960
s_cmp_eq_u32 s65, 122880
s_cselect_b32 s65, 0, s65
s_add_u32 s64, s64, 1
s_waitcnt vmcnt(11)
s_barrier
s_cmp_lg_u32 s88, 4
s_cbranch_scc1 else_12
buffer_load_dwordx4 v[108:111], v18, s[36:39], s83 offen offset:0
buffer_load_dwordx4 v[108:111], v18, s[36:39], s83 offen offset:1024
global_load_dwordx4 v[108:111], v63, s[12:13] offset:-3072
global_load_dwordx4 v[108:111], v63, s[12:13] offset:-2048
global_load_dwordx4 v[108:111], v63, s[12:13] offset:-1024
global_load_dwordx4 v[108:111], v63, s[12:13] offset:0
global_load_dwordx4 v[108:111], v63, s[12:13] offset:1024
global_load_dwordx4 v[108:111], v63, s[12:13] offset:2048
buffer_store_dwordx4 v[56:59], v18, s[32:35], s86 offen offset:0 sc1
buffer_store_dwordx4 v[56:59], v18, s[32:35], s86 offen offset:1024 sc1
buffer_store_dwordx2 v[56:57], v39, s[32:35], s89 offen sc1
buffer_store_dwordx4 v[56:59], v55, s[32:35], 0 offen sc1
else_12:
s_add_u32 s69, s47, 2
s_and_b32 s69, s69, 3
s_add_u32 s69, s69, 4
s_mul_i32 s67, s69, 128
s_mul_i32 s68, s69, s54
s_add_u32 m0, s70, s65
s_nop 0
buffer_load_dwordx4 v20, s[24:27], s67 offen offset:0  lds
buffer_load_dwordx4 v21, s[24:27], s67 offen offset:1024  lds
buffer_load_dwordx4 v22, s[24:27], s67 offen offset:2048  lds
buffer_load_dwordx4 v23, s[24:27], s67 offen offset:3072  lds
s_add_u32 s60, s71, s65
s_add_u32 m0, s60, 0
s_mov_b32 s61, s68
buffer_load_dwordx4 v26, s[28:31], s61 offen lds
buffer_load_dwordx4 v27, s[28:31], s61 offen offset:1024 lds
s_add_u32 m0, s60, 8192
s_add_u32 s61, s61, s53
buffer_load_dwordx4 v26, s[28:31], s61 offen lds
buffer_load_dwordx4 v27, s[28:31], s61 offen offset:1024 lds
s_add_u32 m0, s60, 16384
s_add_u32 s61, s61, s53
buffer_load_dwordx4 v26, s[28:31], s61 offen lds
buffer_load_dwordx4 v27, s[28:31], s61 offen offset:1024 lds
s_add_u32 s49, s76, 2
s_and_b32 s49, s49, 3
s_add_u32 s49, s49, 12
s_mul_i32 s49, s49, 393216
buffer_load_dwordx4 v[40:43], v36, s[28:31], s49 offen
s_add_u32 s65, s65, 40960
s_cmp_eq_u32 s65, 122880
s_cselect_b32 s65, 0, s65
s_add_u32 s64, s64, 1
s_waitcnt vmcnt(11)
s_barrier
s_cmp_lg_u32 s88, 5
s_cbranch_scc1 else_14
buffer_load_dwordx4 v[108:111], v18, s[36:39], s83 offen offset:0
buffer_load_dwordx4 v[108:111], v18, s[36:39], s83 offen offset:1024
global_load_dwordx4 v[108:111], v63, s[12:13] offset:-3072
global_load_dwordx4 v[108:111], v63, s[12:13] offset:-2048
global_load_dwordx4 v[108:111], v63, s[12:13] offset:-1024
global_load_dwordx4 v[108:111], v63, s[12:13] offset:0
global_load_dwordx4 v[108:111], v63, s[12:13] offset:1024
global_load_dwordx4 v[108:111], v63, s[12:13] offset:2048
buffer_store_dwordx4 v[56:59], v18, s[32:35], s86 offen offset:0 sc1
buffer_store_dwordx4 v[56:59], v18, s[32:35], s86 offen offset:1024 sc1
buffer_store_dwordx2 v[56:57], v39, s[32:35], s89 offen sc1
buffer_store_dwordx4 v[56:59], v55, s[32:35], 0 offen sc1
else_14:
s_add_u32 s69, s47, 2
s_and_b32 s69, s69, 3
s_add_u32 s69, s69, 8
s_mul_i32 s67, s69, 128
s_mul_i32 s68, s69, s54
s_add_u32 m0, s70, s65
s_nop 0
buffer_load_dwordx4 v20, s[24:27], s67 offen offset:0  lds
buffer_load_dwordx4 v21, s[24:27], s67 offen offset:1024  lds
buffer_load_dwordx4 v22, s[24:27], s67 offen offset:2048  lds
buffer_load_dwordx4 v23, s[24:27], s67 offen offset:3072  lds
s_add_u32 s60, s71, s65
s_add_u32 m0, s60, 0
s_mov_b32 s61, s68
buffer_load_dwordx4 v26, s[28:31], s61 offen lds
buffer_load_dwordx4 v27, s[28:31], s61 offen offset:1024 lds
s_add_u32 m0, s60, 8192
s_add_u32 s61, s61, s53
buffer_load_dwordx4 v26, s[28:31], s61 offen lds
buffer_load_dwordx4 v27, s[28:31], s61 offen offset:1024 lds
s_add_u32 m0, s60, 16384
s_add_u32 s61, s61, s53
buffer_load_dwordx4 v26, s[28:31], s61 offen lds
buffer_load_dwordx4 v27, s[28:31], s61 offen offset:1024 lds
s_add_u32 s49, s76, 3
s_and_b32 s49, s49, 3
s_add_u32 s49, s49, 0
s_mul_i32 s49, s49, 393216
buffer_load_dwordx4 v[40:43], v36, s[28:31], s49 offen
s_add_u32 s65, s65, 40960
s_cmp_eq_u32 s65, 122880
s_cselect_b32 s65, 0, s65
s_add_u32 s64, s64, 1
s_waitcnt vmcnt(11)
s_barrier
s_cmp_lg_u32 s88, 6
s_cbranch_scc1 else_16
buffer_load_dwordx4 v[108:111], v18, s[36:39], s83 offen offset:0
buffer_load_dwordx4 v[108:111], v18, s[36:39], s83 offen offset:1024
global_load_dwordx4 v[108:111], v63, s[12:13] offset:-3072
global_load_dwordx4 v[108:111], v63, s[12:13] offset:-2048
global_load_dwordx4 v[108:111], v63, s[12:13] offset:-1024
global_load_dwordx4 v[108:111], v63, s[12:13] offset:0
global_load_dwordx4 v[108:111], v63, s[12:13] offset:1024
global_load_dwordx4 v[108:111], v63, s[12:13] offset:2048
buffer_store_dwordx4 v[56:59], v18, s[32:35], s86 offen offset:0 sc1
buffer_store_dwordx4 v[56:59], v18, s[32:35], s86 offen offset:1024 sc1
buffer_store_dwordx2 v[56:57], v39, s[32:35], s89 offen sc1
buffer_store_dwordx4 v[56:59], v55, s[32:35], 0 offen sc1
else_16:
s_add_u32 s69, s47, 2
s_and_b32 s69, s69, 3
s_add_u32 s69, s69, 12
s_mul_i32 s67, s69, 128
s_mul_i32 s68, s69, s54
s_add_u32 m0, s70, s65
s_nop 0
buffer_load_dwordx4 v20, s[24:27], s67 offen offset:0  lds
buffer_load_dwordx4 v21, s[24:27], s67 offen offset:1024  lds
buffer_load_dwordx4 v22, s[24:27], s67 offen offset:2048  lds
buffer_load_dwordx4 v23, s[24:27], s67 offen offset:3072  lds
s_add_u32 s60, s71, s65
s_add_u32 m0, s60, 0
s_mov_b32 s61, s68
buffer_load_dwordx4 v26, s[28:31], s61 offen lds
buffer_load_dwordx4 v27, s[28:31], s61 offen offset:1024 lds
s_add_u32 m0, s60, 8192
s_add_u32 s61, s61, s53
buffer_load_dwordx4 v26, s[28:31], s61 offen lds
buffer_load_dwordx4 v27, s[28:31], s61 offen offset:1024 lds
s_add_u32 m0, s60, 16384
s_add_u32 s61, s61, s53
buffer_load_dwordx4 v26, s[28:31], s61 offen lds
buffer_load_dwordx4 v27, s[28:31], s61 offen offset:1024 lds
s_add_u32 s49, s76, 3
s_and_b32 s49, s49, 3
s_add_u32 s49, s49, 4
s_mul_i32 s49, s49, 393216
buffer_load_dwordx4 v[40:43], v36, s[28:31], s49 offen
s_add_u32 s65, s65, 40960
s_cmp_eq_u32 s65, 122880
s_cselect_b32 s65, 0, s65
s_add_u32 s64, s64, 1
s_waitcnt vmcnt(11)
s_barrier
s_cmp_lg_u32 s88, 7
s_cbranch_scc1 else_18
buffer_load_dwordx4 v[108:111], v18, s[36:39], s83 offen offset:0
buffer_load_dwordx4 v[108:111], v18, s[36:39], s83 offen offset:1024
global_load_dwordx4 v[108:111], v63, s[12:13] offset:-3072
global_load_dwordx4 v[108:111], v63, s[12:13] offset:-2048
global_load_dwordx4 v[108:111], v63, s[12:13] offset:-1024
global_load_dwordx4 v[108:111], v63, s[12:13] offset:0
global_load_dwordx4 v[108:111], v63, s[12:13] offset:1024
global_load_dwordx4 v[108:111], v63, s[12:13] offset:2048
buffer_store_dwordx4 v[56:59], v18, s[32:35], s86 offen offset:0 sc1
buffer_store_dwordx4 v[56:59], v18, s[32:35], s86 offen offset:1024 sc1
buffer_store_dwordx2 v[56:57], v39, s[32:35], s89 offen sc1
buffer_store_dwordx4 v[56:59], v55, s[32:35], 0 offen sc1
else_18:
s_add_u32 s69, s47, 3
s_and_b32 s69, s69, 3
s_add_u32 s69, s69, 0
s_mul_i32 s67, s69, 128
s_mul_i32 s68, s69, s54
s_add_u32 m0, s70, s65
s_nop 0
buffer_load_dwordx4 v20, s[24:27], s67 offen offset:0  lds
buffer_load_dwordx4 v21, s[24:27], s67 offen offset:1024  lds
buffer_load_dwordx4 v22, s[24:27], s67 offen offset:2048  lds
buffer_load_dwordx4 v23, s[24:27], s67 offen offset:3072  lds
s_add_u32 s60, s71, s65
s_add_u32 m0, s60, 0
s_mov_b32 s61, s68
buffer_load_dwordx4 v26, s[28:31], s61 offen lds
buffer_load_dwordx4 v27, s[28:31], s61 offen offset:1024 lds
s_add_u32 m0, s60, 8192
s_add_u32 s61, s61, s53
buffer_load_dwordx4 v26, s[28:31], s61 offen lds
buffer_load_dwordx4 v27, s[28:31], s61 offen offset:1024 lds
s_add_u32 m0, s60, 16384
s_add_u32 s61, s61, s53
buffer_load_dwordx4 v26, s[28:31], s61 offen lds
buffer_load_dwordx4 v27, s[28:31], s61 offen offset:1024 lds
s_add_u32 s49, s76, 3
s_and_b32 s49, s49, 3
s_add_u32 s49, s49, 8
s_mul_i32 s49, s49, 393216
buffer_load_dwordx4 v[40:43], v36, s[28:31], s49 offen
s_add_u32 s65, s65, 40960
s_cmp_eq_u32 s65, 122880
s_cselect_b32 s65, 0, s65
s_add_u32 s64, s64, 1
s_waitcnt vmcnt(11)
s_barrier
s_add_u32 s69, s47, 3
s_and_b32 s69, s69, 3
s_add_u32 s69, s69, 4
s_mul_i32 s67, s69, 128
s_mul_i32 s68, s69, s54
s_add_u32 m0, s70, s65
s_nop 0
buffer_load_dwordx4 v20, s[24:27], s67 offen offset:0  lds
buffer_load_dwordx4 v21, s[24:27], s67 offen offset:1024  lds
buffer_load_dwordx4 v22, s[24:27], s67 offen offset:2048  lds
buffer_load_dwordx4 v23, s[24:27], s67 offen offset:3072  lds
s_add_u32 s60, s71, s65
s_add_u32 m0, s60, 0
s_mov_b32 s61, s68
buffer_load_dwordx4 v26, s[28:31], s61 offen lds
buffer_load_dwordx4 v27, s[28:31], s61 offen offset:1024 lds
s_add_u32 m0, s60, 8192
s_add_u32 s61, s61, s53
buffer_load_dwordx4 v26, s[28:31], s61 offen lds
buffer_load_dwordx4 v27, s[28:31], s61 offen offset:1024 lds
s_add_u32 m0, s60, 16384
s_add_u32 s61, s61, s53
buffer_load_dwordx4 v26, s[28:31], s61 offen lds
buffer_load_dwordx4 v27, s[28:31], s61 offen offset:1024 lds
s_add_u32 s49, s76, 3
s_and_b32 s49, s49, 3
s_add_u32 s49, s49, 12
s_mul_i32 s49, s49, 393216
buffer_load_dwordx4 v[40:43], v36, s[28:31], s49 offen
s_add_u32 s65, s65, 40960
s_cmp_eq_u32 s65, 122880
s_cselect_b32 s65, 0, s65
s_add_u32 s64, s64, 1
s_waitcnt vmcnt(11)
s_barrier
global_load_dwordx2 v[34:35], v32, s[20:21] sc1
s_add_u32 s69, s47, 3
s_and_b32 s69, s69, 3
s_add_u32 s69, s69, 8
s_mul_i32 s67, s69, 128
s_mul_i32 s68, s69, s54
s_add_u32 m0, s70, s65
s_nop 0
buffer_load_dwordx4 v20, s[24:27], s67 offen offset:0  lds
buffer_load_dwordx4 v21, s[24:27], s67 offen offset:1024  lds
buffer_load_dwordx4 v22, s[24:27], s67 offen offset:2048  lds
buffer_load_dwordx4 v23, s[24:27], s67 offen offset:3072  lds
s_add_u32 s60, s71, s65
s_add_u32 m0, s60, 0
s_mov_b32 s61, s68
buffer_load_dwordx4 v26, s[28:31], s61 offen lds
buffer_load_dwordx4 v27, s[28:31], s61 offen offset:1024 lds
s_add_u32 m0, s60, 8192
s_add_u32 s61, s61, s53
buffer_load_dwordx4 v26, s[28:31], s61 offen lds
buffer_load_dwordx4 v27, s[28:31], s61 offen offset:1024 lds
s_add_u32 m0, s60, 16384
s_add_u32 s61, s61, s53
buffer_load_dwordx4 v26, s[28:31], s61 offen lds
buffer_load_dwordx4 v27, s[28:31], s61 offen offset:1024 lds
s_add_u32 s65, s65, 40960
s_cmp_eq_u32 s65, 122880
s_cselect_b32 s65, 0, s65
s_add_u32 s64, s64, 1
s_waitcnt vmcnt(10)
s_barrier
s_mov_b32 s63, 0
ipoll_20:
v_sad_u8 v4, v34, 0, 0
v_sad_u8 v4, v35, 0, v4
v_cmp_gt_u32 vcc, 32, v4
s_cbranch_vccz ipolled_21
global_load_dwordx2 v[34:35], v32, s[20:21] sc1
s_add_u32 s63, s63, 1
s_cmp_lt_u32 s63, 0x80000
s_waitcnt vmcnt(0)
s_cbranch_scc1 ipoll_20
ipolled_21:
s_add_u32 s69, s47, 3
s_and_b32 s69, s69, 3
s_add_u32 s69, s69, 12
s_mul_i32 s67, s69, 128
s_mul_i32 s68, s69, s54
s_add_u32 m0, s70, 0
s_nop 0
buffer_load_dwordx4 v20, s[24:27], s67 offen offset:0  lds
buffer_load_dwordx4 v21, s[24:27], s67 offen offset:1024  lds
buffer_load_dwordx4 v22, s[24:27], s67 offen offset:2048  lds
buffer_load_dwordx4 v23, s[24:27], s67 offen offset:3072  lds
s_add_u32 s60, s71, 0
s_add_u32 m0, s60, 0
s_mov_b32 s61, s68
buffer_load_dwordx4 v26, s[28:31], s61 offen lds
buffer_load_dwordx4 v27, s[28:31], s61 offen offset:1024 lds
s_add_u32 m0, s60, 8192
s_add_u32 s61, s61, s53
buffer_load_dwordx4 v26, s[28:31], s61 offen lds
buffer_load_dwordx4 v27, s[28:31], s61 offen offset:1024 lds
s_add_u32 m0, s60, 16384
s_add_u32 s61, s61, s53
buffer_load_dwordx4 v26, s[28:31], s61 offen lds
buffer_load_dwordx4 v27, s[28:31], s61 offen offset:1024 lds
s_waitcnt vmcnt(10)
s_barrier
s_setprio 0
buffer_load_dwordx4 v[240:243], v15, s[36:39], 0 offen offset:0
buffer_load_dwordx4 v[240:243], v15, s[36:39], 0 offen offset:1024
buffer_load_dwordx4 v[80:83], v37, s[32:35], 0 offen offset:0 sc1
buffer_load_dwordx4 v[84:87], v37, s[32:35], 0 offen offset:1024 sc1
buffer_load_dwordx4 v[88:91], v37, s[32:35], 0 offen offset:2048 sc1
buffer_load_dwordx4 v[92:95], v37, s[32:35], 0 offen offset:3072 sc1
global_load_dword v48, v54, s[98:99]
buffer_load_dwordx4 v[64:67], v38, s[32:35], 0 offen offset:0 sc1
buffer_load_dwordx4 v[68:71], v38, s[32:35], 0 offen offset:1024 sc1
buffer_load_dwordx4 v[72:75], v38, s[32:35], 0 offen offset:2048 sc1
buffer_load_dwordx4 v[76:79], v38, s[32:35], 0 offen offset:3072 sc1
s_add_u32 s48, s75, 15
s_and_b32 s48, s48, 15
s_mul_i32 s48, s48, s57
s_add_u32 m0, s71, 106496
s_nop 0
buffer_load_dwordx4 v28, s[36:39], s48 offen lds
buffer_load_dwordx4 v29, s[36:39], s48 offen offset:1024 lds
s_waitcnt vmcnt(13)
s_barrier
s_add_u32 s48, s75, 5
s_and_b32 s48, s48, 15
s_mul_i32 s48, s48, s57
s_add_u32 m0, s71, 24576
s_nop 0
buffer_load_dwordx4 v28, s[36:39], s48 offen lds
buffer_load_dwordx4 v29, s[36:39], s48 offen offset:1024 lds
s_waitcnt vmcnt(4)
s_add_u32 s48, s75, 6
s_and_b32 s48, s48, 15
s_mul_i32 s48, s48, s57
s_add_u32 m0, s71, 32768
s_nop 0
buffer_load_dwordx4 v28, s[36:39], s48 offen lds
v_add_f32 v80, v80, v88
v_add_f32 v64, v64, v72
v_add_f32 v81, v81, v89
v_add_f32 v65, v65, v73
v_add_f32 v82, v82, v90
v_add_f32 v66, v66, v74
v_add_f32 v83, v83, v91
v_add_f32 v67, v67, v75
v_add_f32 v84, v84, v92
v_add_f32 v68, v68, v76
buffer_load_dwordx4 v29, s[36:39], s48 offen offset:1024 lds
v_add_f32 v85, v85, v93
v_add_f32 v69, v69, v77
v_add_f32 v86, v86, v94
v_add_f32 v70, v70, v78
v_add_f32 v87, v87, v95
v_add_f32 v71, v71, v79
v_add_f32 v80, v80, v84
v_add_f32 v64, v64, v68
v_add_f32 v81, v81, v85
v_add_f32 v65, v65, v69
s_add_u32 s48, s75, 7
s_and_b32 s48, s48, 15
s_mul_i32 s48, s48, s57
s_add_u32 m0, s71, 40960
s_nop 0
buffer_load_dwordx4 v28, s[36:39], s48 offen lds
v_add_f32 v82, v82, v86
v_add_f32 v66, v66, v70
v_add_f32 v83, v83, v87
v_add_f32 v67, v67, v71
s_nop 1
s_nop 1
v_permlane32_swap_b32 v80, v81
v_permlane32_swap_b32 v64, v65
v_permlane32_swap_b32 v82, v83
buffer_load_dwordx4 v29, s[36:39], s48 offen offset:1024 lds
v_permlane32_swap_b32 v66, v67
v_add_f32 v80, v80, v81
v_add_f32 v64, v64, v65
v_add_f32 v82, v82, v83
v_add_f32 v66, v66, v67
s_nop 1
s_nop 1
v_permlane16_swap_b32 v80, v82
v_permlane16_swap_b32 v64, v66
s_nop 0
s_add_u32 s48, s75, 8
s_and_b32 s48, s48, 15
s_mul_i32 s48, s48, s57
s_add_u32 m0, s71, 49152
s_nop 0
buffer_load_dwordx4 v28, s[36:39], s48 offen lds
s_nop 0
v_add_f32 v80, v80, v82
v_add_f32 v64, v64, v66
v_cmp_u_f32 vcc, v80, v80
s_cbranch_vccnz again_22
summed_23:
v_cmp_u_f32 vcc, v64, v64
s_cbranch_vccnz again_25
summed_26:
v_mul_f32 v44, 0x3a800000, v80
ds_write_b32 v53, v64
v_mov_b32 v45, v44
s_nop 1
v_permlane16_swap_b32 v44, v45
buffer_load_dwordx4 v29, s[36:39], s48 offen offset:1024 lds
s_nop 0
v_fma_f32 v45, -v44, v44, v45
v_max_f32 v45, 0, v45
v_add_f32 v45, 0x3727c5ac, v45
v_rsq_f32 v46, v45
v_sub_f32 v47, 0, v44
ds_write_b32 v50, v47 offset:512
ds_write_b64 v49, v[46:47]
ds_write_b32 v50, v46
s_cmp_lg_u32 s43, 2
s_cbranch_scc1 else_28
s_and_b32 s50, s2, 7
v_readlane_b32 s58, v34, s50
v_readlane_b32 s59, v35, s50
s_lshl_b64 s[48:49], s[94:95], 5
v_mov_b32 v4, 134656
s_nop 1
s_cmp_eq_u64 s[48:49], s[58:59]
s_cselect_b32 s48, 1, 0
v_mov_b32 v5, s48
ds_write_b32 v4, v5
else_28:
s_setprio 0
s_waitcnt lgkmcnt(0)
s_waitcnt vmcnt(63)
s_barrier
s_waitcnt vmcnt(5)
s_add_u32 s48, s75, 9
s_and_b32 s48, s48, 15
s_mul_i32 s48, s48, s57
s_add_u32 m0, s71, 57344
s_nop 0
buffer_load_dwordx4 v28, s[36:39], s48 offen lds
buffer_load_dwordx4 v29, s[36:39], s48 offen offset:1024 lds
s_waitcnt vmcnt(5)
s_add_u32 s48, s75, 10
s_and_b32 s48, s48, 15
s_mul_i32 s48, s48, s57
s_add_u32 m0, s71, 65536
s_nop 0
buffer_load_dwordx4 v28, s[36:39], s48 offen lds
buffer_load_dwordx4 v29, s[36:39], s48 offen offset:1024 lds
s_waitcnt vmcnt(5)
s_add_u32 s48, s75, 11
s_and_b32 s48, s48, 15
s_mul_i32 s48, s48, s57
s_add_u32 m0, s71, 73728
s_nop 0
buffer_load_dwordx4 v28, s[36:39], s48 offen lds
buffer_load_dwordx4 v29, s[36:39], s48 offen offset:1024 lds
s_waitcnt vmcnt(5)
s_add_u32 s48, s75, 12
s_and_b32 s48, s48, 15
s_mul_i32 s48, s48, s57
s_add_u32 m0, s71, 81920
s_nop 0
buffer_load_dwordx4 v28, s[36:39], s48 offen lds
buffer_load_dwordx4 v29, s[36:39], s48 offen offset:1024 lds
s_waitcnt vmcnt(5)
s_add_u32 s48, s75, 13
s_and_b32 s48, s48, 15
s_mul_i32 s48, s48, s57
s_add_u32 m0, s71, 90112
s_nop 0
buffer_load_dwordx4 v28, s[36:39], s48 offen lds
buffer_load_dwordx4 v29, s[36:39], s48 offen offset:1024 lds
s_waitcnt vmcnt(5)
s_add_u32 s48, s75, 14
s_and_b32 s48, s48, 15
s_mul_i32 s48, s48, s57
s_add_u32 m0, s71, 98304
s_nop 0
buffer_load_dwordx4 v28, s[36:39], s48 offen lds
buffer_load_dwordx4 v29, s[36:39], s48 offen offset:1024 lds
s_waitcnt vmcnt(5)
s_add_u32 s48, s75, 0
s_and_b32 s48, s48, 15
s_mul_i32 s48, s48, s57
s_add_u32 m0, s71, 4294950912
s_nop 0
buffer_load_dwordx4 v28, s[36:39], s48 offen lds
buffer_load_dwordx4 v29, s[36:39], s48 offen offset:1024 lds
s_waitcnt vmcnt(5)
s_add_u32 s48, s75, 1
s_and_b32 s48, s48, 15
s_mul_i32 s48, s48, s57
s_add_u32 m0, s71, 4294959104
s_nop 0
buffer_load_dwordx4 v28, s[36:39], s48 offen lds
buffer_load_dwordx4 v29, s[36:39], s48 offen offset:1024 lds
s_waitcnt vmcnt(5)
s_add_u32 s48, s75, 2
s_and_b32 s48, s48, 15
s_mul_i32 s48, s48, s57
s_add_u32 m0, s71, 0
s_nop 0
buffer_load_dwordx4 v28, s[36:39], s48 offen lds
buffer_load_dwordx4 v29, s[36:39], s48 offen offset:1024 lds
s_waitcnt vmcnt(5)
s_add_u32 s48, s75, 3
s_and_b32 s48, s48, 15
s_mul_i32 s48, s48, s57
s_add_u32 m0, s71, 8192
s_nop 0
buffer_load_dwordx4 v28, s[36:39], s48 offen lds
buffer_load_dwordx4 v29, s[36:39], s48 offen offset:1024 lds
s_waitcnt vmcnt(5)
s_add_u32 s48, s75, 4
s_and_b32 s48, s48, 15
s_mul_i32 s48, s48, s57
s_add_u32 m0, s71, 16384
s_nop 0
buffer_load_dwordx4 v28, s[36:39], s48 offen lds
buffer_load_dwordx4 v29, s[36:39], s48 offen offset:1024 lds
s_mov_b32 s28, s12
s_and_b32 s29, s13, 0xffff
s_mov_b32 s30, 6291456
s_mov_b32 s31, 0x00020000
v_mov_b32 v26, v60
v_mov_b32 v27, v61
v_mov_b32 v28, v24
v_mov_b32 v29, v25
s_cmp_ge_i32 s55, 0
s_cselect_b32 s53, 128, s53
s_cselect_b32 s54, 24576, s54
s_cmp_ge_i32 s56, 0
s_cselect_b32 s57, 8192, s57
s_and_b32 s48, s2, 7
s_add_u32 s47, s42, s48
s_and_b32 s47, s47, 7
s_mul_i32 s47, s47, 2
s_and_b32 s50, s42, 8
s_or_b32 s50, s50, 3
s_and_b32 s48, s2, 7
s_add_u32 s76, s50, s48
s_and_b32 s76, s76, 7
s_mul_i32 s76, s76, 2
s_add_u32 s69, s47, 0
s_and_b32 s69, s69, 15
s_mul_i32 s67, s69, 128
s_mul_i32 s68, s69, s54
s_waitcnt vmcnt(0) lgkmcnt(0)
s_barrier
s_add_u32 s60, s71, 122880
s_add_u32 m0, s60, 0
s_mov_b32 s61, s68
buffer_load_dwordx4 v26, s[28:31], s61 offen lds
buffer_load_dwordx4 v27, s[28:31], s61 offen offset:1024 lds
s_add_u32 m0, s60, 8192
s_add_u32 s61, s61, s53
buffer_load_dwordx4 v26, s[28:31], s61 offen lds
buffer_load_dwordx4 v27, s[28:31], s61 offen offset:1024 lds
s_add_u32 m0, s60, 16384
s_add_u32 s61, s61, s53
buffer_load_dwordx4 v26, s[28:31], s61 offen lds
buffer_load_dwordx4 v27, s[28:31], s61 offen offset:1024 lds
s_mov_b32 s36, s14
s_and_b32 s37, s15, 0xffff
s_mov_b32 s38, 65536
s_mov_b32 s39, 0x00020000
s_lshl_b32 s48, s42, 12
s_lshl_b32 s49, s43, 10
s_add_u32 s48, s48, s49
s_add_u32 m0, s49, 135168
s_nop 0
buffer_load_dwordx4 v18, s[36:39], s48 offen lds
ds_read_b128 v[232:235], v52 offset:57344
ds_read_b128 v[236:239], v52 offset:58368
ds_read_b128 v[152:155], v51 offset:40960
ds_read_b128 v[156:159], v51 offset:41984
ds_read_b128 v[160:163], v51 offset:49152
ds_read_b128 v[164:167], v51 offset:50176
ds_read_b128 v[168:171], v51 offset:57344
ds_read_b128 v[172:175], v51 offset:58368
ds_read_b128 v[176:179], v52 offset:0
ds_read_b128 v[180:183], v52 offset:1024
ds_read_b128 v[184:187], v52 offset:8192
ds_read_b128 v[188:191], v52 offset:9216
ds_read_b128 v[192:195], v52 offset:16384
ds_read_b128 v[196:199], v52 offset:17408
ds_read_b128 v[200:203], v52 offset:24576
ds_read_b128 v[204:207], v52 offset:25600
ds_read_b128 v[208:211], v52 offset:32768
ds_read_b128 v[212:215], v52 offset:33792
ds_read_b128 v[216:219], v52 offset:40960
ds_read_b128 v[220:223], v52 offset:41984
ds_read_b128 v[224:227], v52 offset:49152
ds_read_b128 v[228:231], v52 offset:50176
ds_read_b128 v[112:115], v51 offset:0
ds_read_b128 v[116:119], v51 offset:1024
ds_read_b128 v[120:123], v51 offset:8192
ds_read_b128 v[124:127], v51 offset:9216
ds_read_b128 v[128:131], v51 offset:16384
ds_read_b128 v[132:135], v51 offset:17408
ds_read_b128 v[136:139], v51 offset:24576
ds_read_b128 v[140:143], v51 offset:25600
ds_read_b128 v[144:147], v51 offset:32768
ds_read_b128 v[148:151], v51 offset:33792
s_add_u32 s48, s80, 0
v_add_u32 v20, s48, v18
v_mov_b32 v21, v20
v_add_u32 v22, 30720, v20
v_mov_b32 v23, v22
v_add_u32 v37, 262144, v37
s_lshl_b32 s50, s42, 2
s_add_u32 s50, s50, s43
s_lshl_b32 s50, s50, 12
s_add_u32 s50, s50, 18087936
v_add_u32 v38, s50, v18
v_min_u32 v4, 2, v3
v_lshlrev_b32 v4, 8, v4
v_lshl_add_u32 v4, v2, 2, v4
s_and_b32 s48, s43, 1
s_lshl_b32 s48, s48, 7
s_lshr_b32 s49, s43, 1
s_lshl_b32 s49, s49, 6
s_add_u32 s48, s48, s49
s_add_u32 s48, s48, 133888
v_add_u32 v53, s48, v4
s_getpc_b64 s[98:99]
pc_30:
s_add_u32 s98, s98, c1_last - pc_30
s_addc_u32 s99, s99, 0
s_lshr_b32 s50, s2, 3
s_lshl_b32 s50, s50, 2
s_add_u32 s50, s50, s43
s_lshl_b32 s50, s50, 7
v_and_b32 v4, 1, v0
v_lshl_add_u32 v4, v4, 6, s50
v_min_u32 v54, L_code_end - c1_last, v4
s_waitcnt vmcnt(0) lgkmcnt(0)
s_add_u32 s69, s47, 1
s_and_b32 s69, s69, 15
s_mul_i32 s67, s69, 2048
s_mul_i32 s68, s69, s54
s_barrier
s_add_u32 s60, s71, 40960
s_add_u32 m0, s60, 0
s_mov_b32 s61, s68
buffer_load_dwordx4 v26, s[28:31], s61 offen lds
buffer_load_dwordx4 v27, s[28:31], s61 offen offset:1024 lds
s_add_u32 m0, s60, 8192
s_add_u32 s61, s61, s53
buffer_load_dwordx4 v26, s[28:31], s61 offen lds
buffer_load_dwordx4 v27, s[28:31], s61 offen offset:1024 lds
s_add_u32 m0, s60, 16384
s_add_u32 s61, s61, s53
buffer_load_dwordx4 v26, s[28:31], s61 offen lds
buffer_load_dwordx4 v27, s[28:31], s61 offen offset:1024 lds
s_add_u32 s49, s76, 2
s_and_b32 s49, s49, 15
s_mul_i32 s49, s49, 393216
buffer_load_dwordx4 v[40:43], v36, s[28:31], s49 offen
s_add_u32 s49, s76, 3
s_and_b32 s49, s49, 15
s_mul_i32 s49, s49, 393216
buffer_load_dwordx4 v[40:43], v36, s[28:31], s49 offen
buffer_load_dword v5, v30, s[32:35], s79 offen sc1
s_add_u32 s69, s47, 0
s_and_b32 s69, s69, 15
s_mul_i32 s67, s69, 2048
s_mul_i32 s68, s69, s54
s_add_u32 m0, s70, 0
s_nop 0
s_mov_b32 s63, 0
s_waitcnt vmcnt(0)
poll_31:
v_cmp_gt_u32 vcc, 1, v5
s_cbranch_vccz polled_32
buffer_load_dword v5, v30, s[32:35], s79 offen sc1
s_add_u32 s63, s63, 1
s_cmp_lt_u32 s63, 0x80000
s_waitcnt vmcnt(0)
s_cbranch_scc1 poll_31
polled_32:
buffer_load_dwordx4 v20, s[32:35], s67 offen offset:0 sc1 lds
buffer_load_dwordx4 v21, s[32:35], s67 offen offset:1024 sc1 lds
buffer_load_dwordx4 v22, s[32:35], s67 offen offset:2048 sc1 lds
buffer_load_dwordx4 v23, s[32:35], s67 offen offset:3072 sc1 lds
s_add_u32 s69, s47, 1
s_and_b32 s69, s69, 15
s_mul_i32 s67, s69, 2048
s_mul_i32 s68, s69, s54
s_add_u32 m0, s70, 40960
s_nop 0
buffer_load_dwordx4 v20, s[32:35], s67 offen offset:0 sc1 lds
buffer_load_dwordx4 v21, s[32:35], s67 offen offset:1024 sc1 lds
buffer_load_dwordx4 v22, s[32:35], s67 offen offset:2048 sc1 lds
buffer_load_dwordx4 v23, s[32:35], s67 offen offset:3072 sc1 lds
s_waitcnt vmcnt(4) lgkmcnt(0)
s_barrier
s_add_u32 s69, s47, 2
s_and_b32 s69, s69, 15
s_mul_i32 s67, s69, 2048
s_mul_i32 s68, s69, s54
s_add_u32 m0, s70, 81920
s_nop 0
buffer_load_dwordx4 v20, s[32:35], s67 offen offset:0 sc1 lds
buffer_load_dwordx4 v21, s[32:35], s67 offen offset:1024 sc1 lds
buffer_load_dwordx4 v22, s[32:35], s67 offen offset:2048 sc1 lds
buffer_load_dwordx4 v23, s[32:35], s67 offen offset:3072 sc1 lds
s_add_u32 s60, s71, 81920
s_add_u32 m0, s60, 0
s_mov_b32 s61, s68
buffer_load_dwordx4 v26, s[28:31], s61 offen lds
buffer_load_dwordx4 v27, s[28:31], s61 offen offset:1024 lds
s_add_u32 m0, s60, 8192
s_add_u32 s61, s61, s53
buffer_load_dwordx4 v26, s[28:31], s61 offen lds
buffer_load_dwordx4 v27, s[28:31], s61 offen offset:1024 lds
s_add_u32 m0, s60, 16384
s_add_u32 s61, s61, s53
buffer_load_dwordx4 v26, s[28:31], s61 offen lds
buffer_load_dwordx4 v27, s[28:31], s61 offen offset:1024 lds
s_add_u32 s49, s76, 4
s_and_b32 s49, s49, 15
s_mul_i32 s49, s49, 393216
buffer_load_dwordx4 v[40:43], v36, s[28:31], s49 offen
s_mov_b32 s64, 0
s_mov_b32 s65, 0
h1_loop:
s_waitcnt vmcnt(11)
s_barrier
s_add_u32 s69, s69, 1
s_and_b32 s69, s69, 15
s_mul_i32 s67, s69, 2048
s_mul_i32 s68, s69, s54
s_add_u32 m0, s70, s65
s_nop 0
buffer_load_dwordx4 v20, s[32:35], s67 offen offset:0 sc1 lds
buffer_load_dwordx4 v21, s[32:35], s67 offen offset:1024 sc1 lds
buffer_load_dwordx4 v22, s[32:35], s67 offen offset:2048 sc1 lds
buffer_load_dwordx4 v23, s[32:35], s67 offen offset:3072 sc1 lds
s_add_u32 s60, s71, s65
s_add_u32 m0, s60, 0
s_mov_b32 s61, s68
buffer_load_dwordx4 v26, s[28:31], s61 offen lds
buffer_load_dwordx4 v27, s[28:31], s61 offen offset:1024 lds
s_add_u32 m0, s60, 8192
s_add_u32 s61, s61, s53
buffer_load_dwordx4 v26, s[28:31], s61 offen lds
buffer_load_dwordx4 v27, s[28:31], s61 offen offset:1024 lds
s_add_u32 m0, s60, 16384
s_add_u32 s61, s61, s53
buffer_load_dwordx4 v26, s[28:31], s61 offen lds
buffer_load_dwordx4 v27, s[28:31], s61 offen offset:1024 lds
s_add_u32 s48, s64, 5
s_min_u32 s48, s48, 15
s_add_u32 s49, s48, s76
s_and_b32 s49, s49, 15
s_mul_i32 s49, s49, 393216
buffer_load_dwordx4 v[40:43], v36, s[28:31], s49 offen
s_add_u32 s65, s65, 40960
s_cmp_eq_u32 s65, 122880
s_cselect_b32 s65, 0, s65
s_add_u32 s64, s64, 1
s_cmp_lt_u32 s64, 11
s_cbranch_scc1 h1_loop
s_waitcnt vmcnt(11)
s_barrier
s_add_u32 s69, s47, 14
s_and_b32 s69, s69, 15
s_mul_i32 s67, s69, 2048
s_mul_i32 s68, s69, s54
s_add_u32 m0, s70, s65
s_nop 0
buffer_load_dwordx4 v20, s[32:35], s67 offen offset:0 sc1 lds
buffer_load_dwordx4 v21, s[32:35], s67 offen offset:1024 sc1 lds
buffer_load_dwordx4 v22, s[32:35], s67 offen offset:2048 sc1 lds
buffer_load_dwordx4 v23, s[32:35], s67 offen offset:3072 sc1 lds
s_add_u32 s60, s71, s65
s_add_u32 m0, s60, 0
s_mov_b32 s61, s68
buffer_load_dwordx4 v26, s[28:31], s61 offen lds
buffer_load_dwordx4 v27, s[28:31], s61 offen offset:1024 lds
s_add_u32 m0, s60, 8192
s_add_u32 s61, s61, s53
buffer_load_dwordx4 v26, s[28:31], s61 offen lds
buffer_load_dwordx4 v27, s[28:31], s61 offen offset:1024 lds
s_add_u32 m0, s60, 16384
s_add_u32 s61, s61, s53
buffer_load_dwordx4 v26, s[28:31], s61 offen lds
buffer_load_dwordx4 v27, s[28:31], s61 offen offset:1024 lds
s_add_u32 s65, s65, 40960
s_cmp_eq_u32 s65, 122880
s_cselect_b32 s65, 0, s65
s_add_u32 s64, s64, 1
s_mov_b32 s36, s16
s_and_b32 s37, s17, 0xffff
s_mov_b32 s38, 2097152
s_mov_b32 s39, 0x00020000
s_waitcnt vmcnt(10)
s_barrier
s_add_u32 s69, s47, 15
s_and_b32 s69, s69, 15
s_mul_i32 s67, s69, 2048
s_mul_i32 s68, s69, s54
s_add_u32 m0, s70, 0
s_nop 0
buffer_load_dwordx4 v20, s[32:35], s67 offen offset:0 sc1 lds
buffer_load_dwordx4 v21, s[32:35], s67 offen offset:1024 sc1 lds
buffer_load_dwordx4 v22, s[32:35], s67 offen offset:2048 sc1 lds
buffer_load_dwordx4 v23, s[32:35], s67 offen offset:3072 sc1 lds
s_add_u32 s60, s71, 0
s_add_u32 m0, s60, 0
s_mov_b32 s61, s68
buffer_load_dwordx4 v26, s[28:31], s61 offen lds
buffer_load_dwordx4 v27, s[28:31], s61 offen offset:1024 lds
s_add_u32 m0, s60, 8192
s_add_u32 s61, s61, s53
buffer_load_dwordx4 v26, s[28:31], s61 offen lds
buffer_load_dwordx4 v27, s[28:31], s61 offen offset:1024 lds
s_add_u32 m0, s60, 16384
s_add_u32 s61, s61, s53
buffer_load_dwordx4 v26, s[28:31], s61 offen lds
buffer_load_dwordx4 v27, s[28:31], s61 offen offset:1024 lds
s_waitcnt vmcnt(10)
s_barrier
s_setprio 0
buffer_load_dwordx4 v[240:243], v15, s[36:39], 0 offen offset:0
buffer_load_dwordx4 v[240:243], v15, s[36:39], 0 offen offset:1024
buffer_load_dwordx4 v[80:83], v37, s[32:35], 0 offen offset:0 sc1
buffer_load_dwordx4 v[84:87], v37, s[32:35], 0 offen offset:1024 sc1
buffer_load_dwordx4 v[88:91], v37, s[32:35], 0 offen offset:2048 sc1
buffer_load_dwordx4 v[92:95], v37, s[32:35], 0 offen offset:3072 sc1
global_load_dword v48, v54, s[98:99]
buffer_load_dwordx4 v[64:67], v38, s[32:35], 0 offen offset:0 sc1
buffer_load_dwordx4 v[68:71], v38, s[32:35], 0 offen offset:1024 sc1
buffer_load_dwordx4 v[72:75], v38, s[32:35], 0 offen offset:2048 sc1
buffer_load_dwordx4 v[76:79], v38, s[32:35], 0 offen offset:3072 sc1
s_add_u32 s48, s75, 15
s_and_b32 s48, s48, 15
s_mul_i32 s48, s48, s57
s_add_u32 m0, s71, 106496
s_nop 0
buffer_load_dwordx4 v28, s[36:39], s48 offen lds
buffer_load_dwordx4 v29, s[36:39], s48 offen offset:1024 lds
s_waitcnt vmcnt(13)
s_barrier
s_add_u32 s48, s75, 5
s_and_b32 s48, s48, 15
s_mul_i32 s48, s48, s57
s_add_u32 m0, s71, 24576
s_nop 0
buffer_load_dwordx4 v28, s[36:39], s48 offen lds
buffer_load_dwordx4 v29, s[36:39], s48 offen offset:1024 lds
s_waitcnt vmcnt(4)
s_add_u32 s48, s75, 6
s_and_b32 s48, s48, 15
s_mul_i32 s48, s48, s57
s_add_u32 m0, s71, 32768
s_nop 0
buffer_load_dwordx4 v28, s[36:39], s48 offen lds
v_add_f32 v80, v80, v88
v_add_f32 v64, v64, v72
v_add_f32 v81, v81, v89
v_add_f32 v65, v65, v73
v_add_f32 v82, v82, v90
v_add_f32 v66, v66, v74
v_add_f32 v83, v83, v91
v_add_f32 v67, v67, v75
v_add_f32 v84, v84, v92
v_add_f32 v68, v68, v76
buffer_load_dwordx4 v29, s[36:39], s48 offen offset:1024 lds
v_add_f32 v85, v85, v93
v_add_f32 v69, v69, v77
v_add_f32 v86, v86, v94
v_add_f32 v70, v70, v78
v_add_f32 v87, v87, v95
v_add_f32 v71, v71, v79
v_add_f32 v80, v80, v84
v_add_f32 v64, v64, v68
v_add_f32 v81, v81, v85
v_add_f32 v65, v65, v69
s_add_u32 s48, s75, 7
s_and_b32 s48, s48, 15
s_mul_i32 s48, s48, s57
s_add_u32 m0, s71, 40960
s_nop 0
buffer_load_dwordx4 v28, s[36:39], s48 offen lds
v_add_f32 v82, v82, v86
v_add_f32 v66, v66, v70
v_add_f32 v83, v83, v87
v_add_f32 v67, v67, v71
s_nop 1
s_nop 1
v_permlane32_swap_b32 v80, v81
v_permlane32_swap_b32 v64, v65
v_permlane32_swap_b32 v82, v83
buffer_load_dwordx4 v29, s[36:39], s48 offen offset:1024 lds
v_permlane32_swap_b32 v66, v67
v_add_f32 v80, v80, v81
v_add_f32 v64, v64, v65
v_add_f32 v82, v82, v83
v_add_f32 v66, v66, v67
s_nop 1
s_nop 1
v_permlane16_swap_b32 v80, v82
v_permlane16_swap_b32 v64, v66
s_nop 0
s_add_u32 s48, s75, 8
s_and_b32 s48, s48, 15
s_mul_i32 s48, s48, s57
s_add_u32 m0, s71, 49152
s_nop 0
buffer_load_dwordx4 v28, s[36:39], s48 offen lds
s_nop 0
v_add_f32 v80, v80, v82
v_add_f32 v64, v64, v66
v_cmp_u_f32 vcc, v80, v80
s_cbranch_vccnz again_33
summed_34:
v_cmp_u_f32 vcc, v64, v64
s_cbranch_vccnz again_36
summed_37:
v_mul_f32 v44, 0x3a800000, v80
ds_write_b32 v53, v64
v_mov_b32 v45, v44
s_nop 1
v_permlane16_swap_b32 v44, v45
buffer_load_dwordx4 v29, s[36:39], s48 offen offset:1024 lds
s_nop 0
v_fma_f32 v45, -v44, v44, v45
v_max_f32 v45, 0, v45
v_add_f32 v45, 0x3727c5ac, v45
v_rsq_f32 v46, v45
v_sub_f32 v47, 0, v44
ds_write_b32 v50, v47 offset:512
ds_write_b64 v49, v[46:47]
ds_write_b32 v50, v46
s_setprio 0
s_waitcnt lgkmcnt(0)
s_waitcnt vmcnt(63)
s_barrier
s_waitcnt vmcnt(5)
s_add_u32 s48, s75, 9
s_and_b32 s48, s48, 15
s_mul_i32 s48, s48, s57
s_add_u32 m0, s71, 57344
s_nop 0
buffer_load_dwordx4 v28, s[36:39], s48 offen lds
buffer_load_dwordx4 v29, s[36:39], s48 offen offset:1024 lds
s_waitcnt vmcnt(5)
s_add_u32 s48, s75, 10
s_and_b32 s48, s48, 15
s_mul_i32 s48, s48, s57
s_add_u32 m0, s71, 65536
s_nop 0
buffer_load_dwordx4 v28, s[36:39], s48 offen lds
buffer_load_dwordx4 v29, s[36:39], s48 offen offset:1024 lds
s_waitcnt vmcnt(5)
s_add_u32 s48, s75, 11
s_and_b32 s48, s48, 15
s_mul_i32 s48, s48, s57
s_add_u32 m0, s71, 73728
s_nop 0
buffer_load_dwordx4 v28, s[36:39], s48 offen lds
buffer_load_dwordx4 v29, s[36:39], s48 offen offset:1024 lds
s_waitcnt vmcnt(5)
s_add_u32 s48, s75, 12
s_and_b32 s48, s48, 15
s_mul_i32 s48, s48, s57
s_add_u32 m0, s71, 81920
s_nop 0
buffer_load_dwordx4 v28, s[36:39], s48 offen lds
buffer_load_dwordx4 v29, s[36:39], s48 offen offset:1024 lds
s_waitcnt vmcnt(5)
s_add_u32 s48, s75, 13
s_and_b32 s48, s48, 15
s_mul_i32 s48, s48, s57
s_add_u32 m0, s71, 90112
s_nop 0
buffer_load_dwordx4 v28, s[36:39], s48 offen lds
buffer_load_dwordx4 v29, s[36:39], s48 offen offset:1024 lds
s_waitcnt vmcnt(5)
s_add_u32 s48, s75, 14
s_and_b32 s48, s48, 15
s_mul_i32 s48, s48, s57
s_add_u32 m0, s71, 98304
s_nop 0
buffer_load_dwordx4 v28, s[36:39], s48 offen lds
buffer_load_dwordx4 v29, s[36:39], s48 offen offset:1024 lds
s_waitcnt vmcnt(5)
s_add_u32 s48, s75, 0
s_and_b32 s48, s48, 15
s_mul_i32 s48, s48, s57
s_add_u32 m0, s71, 4294950912
s_nop 0
buffer_load_dwordx4 v28, s[36:39], s48 offen lds
buffer_load_dwordx4 v29, s[36:39], s48 offen offset:1024 lds
s_waitcnt vmcnt(5)
s_add_u32 s48, s75, 1
s_and_b32 s48, s48, 15
s_mul_i32 s48, s48, s57
s_add_u32 m0, s71, 4294959104
s_nop 0
buffer_load_dwordx4 v28, s[36:39], s48 offen lds
buffer_load_dwordx4 v29, s[36:39], s48 offen offset:1024 lds
s_waitcnt vmcnt(5)
s_add_u32 s48, s75, 2
s_and_b32 s48, s48, 15
s_mul_i32 s48, s48, s57
s_add_u32 m0, s71, 0
s_nop 0
buffer_load_dwordx4 v28, s[36:39], s48 offen lds
buffer_load_dwordx4 v29, s[36:39], s48 offen offset:1024 lds
s_waitcnt vmcnt(5)
s_add_u32 s48, s75, 3
s_and_b32 s48, s48, 15
s_mul_i32 s48, s48, s57
s_add_u32 m0, s71, 8192
s_nop 0
buffer_load_dwordx4 v28, s[36:39], s48 offen lds
buffer_load_dwordx4 v29, s[36:39], s48 offen offset:1024 lds
s_waitcnt vmcnt(5)
s_add_u32 s48, s75, 4
s_and_b32 s48, s48, 15
s_mul_i32 s48, s48, s57
s_add_u32 m0, s71, 16384
s_nop 0
buffer_load_dwordx4 v28, s[36:39], s48 offen lds
buffer_load_dwordx4 v29, s[36:39], s48 offen offset:1024 lds
s_waitcnt vmcnt(5)
buffer_load_dwordx4 v[240:243], v18, s[32:35], s81 offen offset:0 sc1
buffer_load_dwordx4 v[240:243], v18, s[32:35], s81 offen offset:1024 sc1
s_waitcnt vmcnt(5)
buffer_load_dwordx4 v[240:243], v18, s[32:35], s82 offen offset:0 sc1
buffer_load_dwordx4 v[240:243], v18, s[32:35], s82 offen offset:1024 sc1
s_mov_b32 s28, s6
s_and_b32 s29, s7, 0xffff
s_mov_b32 s30, 6291456
s_mov_b32 s31, 0x00020000
s_and_b32 s48, s2, 7
s_lshl_b32 s48, s48, 1
s_add_u32 s47, s42, s48
s_and_b32 s47, s47, 15
s_and_b32 s50, s42, 8
s_or_b32 s50, s50, 3
s_and_b32 s48, s2, 7
s_lshl_b32 s48, s48, 1
s_add_u32 s76, s50, s48
s_and_b32 s76, s76, 15
s_add_u32 s69, s47, 0
s_and_b32 s69, s69, 15
s_mul_i32 s67, s69, 2048
s_mul_i32 s68, s69, s54
s_waitcnt vmcnt(0) lgkmcnt(0)
s_barrier
s_add_u32 s60, s71, 122880
s_add_u32 m0, s60, 0
s_mov_b32 s61, s68
buffer_load_dwordx4 v26, s[28:31], s61 offen lds
buffer_load_dwordx4 v27, s[28:31], s61 offen offset:1024 lds
s_add_u32 m0, s60, 8192
s_add_u32 s61, s61, s53
buffer_load_dwordx4 v26, s[28:31], s61 offen lds
buffer_load_dwordx4 v27, s[28:31], s61 offen offset:1024 lds
s_add_u32 m0, s60, 16384
s_add_u32 s61, s61, s53
buffer_load_dwordx4 v26, s[28:31], s61 offen lds
buffer_load_dwordx4 v27, s[28:31], s61 offen offset:1024 lds
v_add_u32 v37, 262144, v37
s_getpc_b64 s[98:99]
pc_39:
s_add_u32 s98, s98, c2_last - pc_39
s_addc_u32 s99, s99, 0
s_lshr_b32 s50, s2, 3
s_lshl_b32 s50, s50, 2
s_add_u32 s50, s50, s43
s_lshl_b32 s50, s50, 7
v_and_b32 v4, 1, v0
v_lshl_add_u32 v4, v4, 6, s50
v_min_u32 v54, L_code_end - c2_last, v4
s_waitcnt vmcnt(0) lgkmcnt(0)
s_add_u32 s69, s47, 1
s_and_b32 s69, s69, 15
s_mul_i32 s67, s69, 2048
s_mul_i32 s68, s69, s54
s_barrier
s_add_u32 s60, s71, 40960
s_add_u32 m0, s60, 0
s_mov_b32 s61, s68
buffer_load_dwordx4 v26, s[28:31], s61 offen lds
buffer_load_dwordx4 v27, s[28:31], s61 offen offset:1024 lds
s_add_u32 m0, s60, 8192
s_add_u32 s61, s61, s53
buffer_load_dwordx4 v26, s[28:31], s61 offen lds
buffer_load_dwordx4 v27, s[28:31], s61 offen offset:1024 lds
s_add_u32 m0, s60, 16384
s_add_u32 s61, s61, s53
buffer_load_dwordx4 v26, s[28:31], s61 offen lds
buffer_load_dwordx4 v27, s[28:31], s61 offen offset:1024 lds
s_add_u32 s49, s76, 2
s_and_b32 s49, s49, 15
s_mul_i32 s49, s49, 393216
buffer_load_dwordx4 v[40:43], v36, s[28:31], s49 offen
s_add_u32 s49, s76, 3
s_and_b32 s49, s49, 15
s_mul_i32 s49, s49, 393216
buffer_load_dwordx4 v[40:43], v36, s[28:31], s49 offen
buffer_load_dword v5, v30, s[32:35], s79 offen sc1
s_add_u32 s69, s47, 0
s_and_b32 s69, s69, 15
s_mul_i32 s67, s69, 2048
s_mul_i32 s68, s69, s54
s_add_u32 m0, s70, 0
s_nop 0
s_mov_b32 s63, 0
s_waitcnt vmcnt(0)
poll_40:
v_cmp_gt_u32 vcc, 2, v5
s_cbranch_vccz polled_41
buffer_load_dword v5, v30, s[32:35], s79 offen sc1
s_add_u32 s63, s63, 1
s_cmp_lt_u32 s63, 0x80000
s_waitcnt vmcnt(0)
s_cbranch_scc1 poll_40
polled_41:
buffer_load_dwordx4 v20, s[32:35], s67 offen offset:0 sc1 lds
buffer_load_dwordx4 v21, s[32:35], s67 offen offset:1024 sc1 lds
buffer_load_dwordx4 v22, s[32:35], s67 offen offset:2048 sc1 lds
buffer_load_dwordx4 v23, s[32:35], s67 offen offset:3072 sc1 lds
s_add_u32 s69, s47, 1
s_and_b32 s69, s69, 15
s_mul_i32 s67, s69, 2048
s_mul_i32 s68, s69, s54
s_add_u32 m0, s70, 40960
s_nop 0
buffer_load_dwordx4 v20, s[32:35], s67 offen offset:0 sc1 lds
buffer_load_dwordx4 v21, s[32:35], s67 offen offset:1024 sc1 lds
buffer_load_dwordx4 v22, s[32:35], s67 offen offset:2048 sc1 lds
buffer_load_dwordx4 v23, s[32:35], s67 offen offset:3072 sc1 lds
s_waitcnt vmcnt(4) lgkmcnt(0)
s_barrier
s_add_u32 s69, s47, 2
s_and_b32 s69, s69, 15
s_mul_i32 s67, s69, 2048
s_mul_i32 s68, s69, s54
s_add_u32 m0, s70, 81920
s_nop 0
buffer_load_dwordx4 v20, s[32:35], s67 offen offset:0 sc1 lds
buffer_load_dwordx4 v21, s[32:35], s67 offen offset:1024 sc1 lds
buffer_load_dwordx4 v22, s[32:35], s67 offen offset:2048 sc1 lds
buffer_load_dwordx4 v23, s[32:35], s67 offen offset:3072 sc1 lds
s_add_u32 s60, s71, 81920
s_add_u32 m0, s60, 0
s_mov_b32 s61, s68
buffer_load_dwordx4 v26, s[28:31], s61 offen lds
buffer_load_dwordx4 v27, s[28:31], s61 offen offset:1024 lds
s_add_u32 m0, s60, 8192
s_add_u32 s61, s61, s53
buffer_load_dwordx4 v26, s[28:31], s61 offen lds
buffer_load_dwordx4 v27, s[28:31], s61 offen offset:1024 lds
s_add_u32 m0, s60, 16384
s_add_u32 s61, s61, s53
buffer_load_dwordx4 v26, s[28:31], s61 offen lds
buffer_load_dwordx4 v27, s[28:31], s61 offen offset:1024 lds
s_add_u32 s49, s76, 4
s_and_b32 s49, s49, 15
s_mul_i32 s49, s49, 393216
buffer_load_dwordx4 v[40:43], v36, s[28:31], s49 offen
s_mov_b32 s64, 0
s_mov_b32 s65, 0
h2_loop:
s_waitcnt vmcnt(11)
s_barrier
s_add_u32 s69, s69, 1
s_and_b32 s69, s69, 15
s_mul_i32 s67, s69, 2048
s_mul_i32 s68, s69, s54
s_add_u32 m0, s70, s65
s_nop 0
buffer_load_dwordx4 v20, s[32:35], s67 offen offset:0 sc1 lds
buffer_load_dwordx4 v21, s[32:35], s67 offen offset:1024 sc1 lds
buffer_load_dwordx4 v22, s[32:35], s67 offen offset:2048 sc1 lds
buffer_load_dwordx4 v23, s[32:35], s67 offen offset:3072 sc1 lds
s_add_u32 s60, s71, s65
s_add_u32 m0, s60, 0
s_mov_b32 s61, s68
buffer_load_dwordx4 v26, s[28:31], s61 offen lds
buffer_load_dwordx4 v27, s[28:31], s61 offen offset:1024 lds
s_add_u32 m0, s60, 8192
s_add_u32 s61, s61, s53
buffer_load_dwordx4 v26, s[28:31], s61 offen lds
buffer_load_dwordx4 v27, s[28:31], s61 offen offset:1024 lds
s_add_u32 m0, s60, 16384
s_add_u32 s61, s61, s53
buffer_load_dwordx4 v26, s[28:31], s61 offen lds
buffer_load_dwordx4 v27, s[28:31], s61 offen offset:1024 lds
s_add_u32 s48, s64, 5
s_min_u32 s48, s48, 15
s_add_u32 s49, s48, s76
s_and_b32 s49, s49, 15
s_mul_i32 s49, s49, 393216
buffer_load_dwordx4 v[40:43], v36, s[28:31], s49 offen
s_add_u32 s65, s65, 40960
s_cmp_eq_u32 s65, 122880
s_cselect_b32 s65, 0, s65
s_add_u32 s64, s64, 1
s_cmp_lt_u32 s64, 11
s_cbranch_scc1 h2_loop
s_waitcnt vmcnt(11)
s_barrier
s_add_u32 s69, s47, 14
s_and_b32 s69, s69, 15
s_mul_i32 s67, s69, 2048
s_mul_i32 s68, s69, s54
s_add_u32 m0, s70, s65
s_nop 0
buffer_load_dwordx4 v20, s[32:35], s67 offen offset:0 sc1 lds
buffer_load_dwordx4 v21, s[32:35], s67 offen offset:1024 sc1 lds
buffer_load_dwordx4 v22, s[32:35], s67 offen offset:2048 sc1 lds
buffer_load_dwordx4 v23, s[32:35], s67 offen offset:3072 sc1 lds
s_add_u32 s60, s71, s65
s_add_u32 m0, s60, 0
s_mov_b32 s61, s68
buffer_load_dwordx4 v26, s[28:31], s61 offen lds
buffer_load_dwordx4 v27, s[28:31], s61 offen offset:1024 lds
s_add_u32 m0, s60, 8192
s_add_u32 s61, s61, s53
buffer_load_dwordx4 v26, s[28:31], s61 offen lds
buffer_load_dwordx4 v27, s[28:31], s61 offen offset:1024 lds
s_add_u32 m0, s60, 16384
s_add_u32 s61, s61, s53
buffer_load_dwordx4 v26, s[28:31], s61 offen lds
buffer_load_dwordx4 v27, s[28:31], s61 offen offset:1024 lds
s_add_u32 s65, s65, 40960
s_cmp_eq_u32 s65, 122880
s_cselect_b32 s65, 0, s65
s_add_u32 s64, s64, 1
s_mov_b32 s36, s12
s_and_b32 s37, s13, 0xffff
s_mov_b32 s38, 6291456
s_mov_b32 s39, 0x00020000
s_waitcnt vmcnt(10)
s_barrier
s_add_u32 s69, s47, 15
s_and_b32 s69, s69, 15
s_mul_i32 s67, s69, 2048
s_mul_i32 s68, s69, s54
s_add_u32 m0, s70, 0
s_nop 0
buffer_load_dwordx4 v20, s[32:35], s67 offen offset:0 sc1 lds
buffer_load_dwordx4 v21, s[32:35], s67 offen offset:1024 sc1 lds
buffer_load_dwordx4 v22, s[32:35], s67 offen offset:2048 sc1 lds
buffer_load_dwordx4 v23, s[32:35], s67 offen offset:3072 sc1 lds
s_add_u32 s60, s71, 0
s_add_u32 m0, s60, 0
s_mov_b32 s61, s68
buffer_load_dwordx4 v26, s[28:31], s61 offen lds
buffer_load_dwordx4 v27, s[28:31], s61 offen offset:1024 lds
s_add_u32 m0, s60, 8192
s_add_u32 s61, s61, s53
buffer_load_dwordx4 v26, s[28:31], s61 offen lds
buffer_load_dwordx4 v27, s[28:31], s61 offen offset:1024 lds
s_add_u32 m0, s60, 16384
s_add_u32 s61, s61, s53
buffer_load_dwordx4 v26, s[28:31], s61 offen lds
buffer_load_dwordx4 v27, s[28:31], s61 offen offset:1024 lds
s_waitcnt vmcnt(10)
s_barrier
s_setprio 0
buffer_load_dwordx4 v[80:83], v37, s[32:35], 0 offen offset:0 sc1
buffer_load_dwordx4 v[84:87], v37, s[32:35], 0 offen offset:1024 sc1
buffer_load_dwordx4 v[88:91], v37, s[32:35], 0 offen offset:2048 sc1
buffer_load_dwordx4 v[92:95], v37, s[32:35], 0 offen offset:3072 sc1
global_load_dword v48, v54, s[98:99]
s_add_u32 s69, s47, 0
s_and_b32 s69, s69, 15
s_mul_i32 s67, s69, 2048
s_mul_i32 s68, s69, s54
s_add_u32 s60, s71, 122880
s_add_u32 m0, s60, 0
s_mov_b32 s61, s68
buffer_load_dwordx4 v26, s[36:39], s61 offen lds
buffer_load_dwordx4 v27, s[36:39], s61 offen offset:1024 lds
s_add_u32 m0, s60, 8192
s_add_u32 s61, s61, s53
buffer_load_dwordx4 v26, s[36:39], s61 offen lds
buffer_load_dwordx4 v27, s[36:39], s61 offen offset:1024 lds
s_add_u32 m0, s60, 16384
s_add_u32 s61, s61, s53
buffer_load_dwordx4 v26, s[36:39], s61 offen lds
buffer_load_dwordx4 v27, s[36:39], s61 offen offset:1024 lds
s_waitcnt vmcnt(11)
s_barrier
s_waitcnt vmcnt(7)
buffer_store_dwordx4 v[56:59], v18, s[32:35], s86 offen offset:0 sc1
v_add_f32 v80, v80, v88
v_add_f32 v81, v81, v89
v_add_f32 v82, v82, v90
v_add_f32 v83, v83, v91
v_add_f32 v84, v84, v92
v_add_f32 v85, v85, v93
v_add_f32 v86, v86, v94
buffer_store_dwordx4 v[56:59], v18, s[32:35], s86 offen offset:1024 sc1
v_add_f32 v87, v87, v95
v_add_f32 v80, v80, v84
v_add_f32 v81, v81, v85
v_add_f32 v82, v82, v86
v_add_f32 v83, v83, v87
s_nop 1
buffer_load_dwordx4 v[240:243], v18, s[32:35], s81 offen offset:0 sc1
v_permlane32_swap_b32 v80, v81
v_permlane32_swap_b32 v82, v83
v_add_f32 v80, v80, v81
v_add_f32 v82, v82, v83
s_nop 1
v_permlane16_swap_b32 v80, v82
buffer_load_dwordx4 v[240:243], v18, s[32:35], s81 offen offset:1024 sc1
s_nop 0
v_add_f32 v80, v80, v82
v_cmp_u_f32 vcc, v80, v80
s_cbranch_vccnz again_42
summed_43:
v_mul_f32 v44, 0x3a800000, v80
buffer_load_dwordx4 v[240:243], v18, s[32:35], s82 offen offset:0 sc1
v_mov_b32 v45, v44
s_nop 1
v_permlane16_swap_b32 v44, v45
s_nop 0
v_fma_f32 v45, -v44, v44, v45
v_max_f32 v45, 0, v45
buffer_load_dwordx4 v[240:243], v18, s[32:35], s82 offen offset:1024 sc1
v_add_f32 v45, 0x3727c5ac, v45
v_rsq_f32 v46, v45
v_sub_f32 v47, 0, v44
ds_write_b32 v50, v47 offset:512
ds_write_b64 v49, v[46:47]
ds_write_b32 v50, v46
s_setprio 0
s_waitcnt lgkmcnt(0)
s_waitcnt vmcnt(63)
s_barrier
ds_write_b128 v52, v[232:235] offset:57344
ds_write_b128 v52, v[236:239] offset:58368
ds_write_b128 v51, v[152:155] offset:40960
ds_write_b128 v51, v[156:159] offset:41984
ds_write_b128 v51, v[160:163] offset:49152
ds_write_b128 v51, v[164:167] offset:50176
ds_write_b128 v51, v[168:171] offset:57344
ds_write_b128 v51, v[172:175] offset:58368
ds_write_b128 v52, v[176:179] offset:0
ds_write_b128 v52, v[180:183] offset:1024
ds_write_b128 v52, v[184:187] offset:8192
ds_write_b128 v52, v[188:191] offset:9216
ds_write_b128 v52, v[192:195] offset:16384
ds_write_b128 v52, v[196:199] offset:17408
ds_write_b128 v52, v[200:203] offset:24576
ds_write_b128 v52, v[204:207] offset:25600
ds_write_b128 v52, v[208:211] offset:32768
ds_write_b128 v52, v[212:215] offset:33792
ds_write_b128 v52, v[216:219] offset:40960
ds_write_b128 v52, v[220:223] offset:41984
ds_write_b128 v52, v[224:227] offset:49152
ds_write_b128 v52, v[228:231] offset:50176
ds_write_b128 v51, v[112:115] offset:0
ds_write_b128 v51, v[116:119] offset:1024
ds_write_b128 v51, v[120:123] offset:8192
ds_write_b128 v51, v[124:127] offset:9216
ds_write_b128 v51, v[128:131] offset:16384
ds_write_b128 v51, v[132:135] offset:17408
ds_write_b128 v51, v[136:139] offset:24576
ds_write_b128 v51, v[140:143] offset:25600
ds_write_b128 v51, v[144:147] offset:32768
ds_write_b128 v51, v[148:151] offset:33792
s_mov_b32 s28, s12
s_and_b32 s29, s13, 0xffff
s_mov_b32 s30, 6291456
s_mov_b32 s31, 0x00020000
s_add_u32 s69, s47, 0
s_and_b32 s69, s69, 15
s_mul_i32 s67, s69, 2048
s_mul_i32 s68, s69, s54
s_waitcnt vmcnt(0) lgkmcnt(0)
s_barrier
s_mov_b32 s36, s14
s_and_b32 s37, s15, 0xffff
s_mov_b32 s38, 65536
s_mov_b32 s39, 0x00020000
s_lshl_b32 s48, s42, 12
s_lshl_b32 s49, s43, 10
s_add_u32 s48, s48, s49
s_add_u32 m0, s49, 135168
s_nop 0
buffer_load_dwordx4 v18, s[36:39], s48 offen lds
v_add_u32 v37, 262144, v37
s_getpc_b64 s[98:99]
pc_45:
s_add_u32 s98, s98, c3_last - pc_45
s_addc_u32 s99, s99, 0
s_lshr_b32 s50, s2, 3
s_lshl_b32 s50, s50, 2
s_add_u32 s50, s50, s43
s_lshl_b32 s50, s50, 7
v_and_b32 v4, 1, v0
v_lshl_add_u32 v4, v4, 6, s50
v_min_u32 v54, L_code_end - c3_last, v4
s_cmp_lg_u32 s43, 0
s_cbranch_scc1 else_46
s_mov_b32 s48, 1
s_atomic_add s48, s[22:23], s73
else_46:
s_waitcnt vmcnt(0) lgkmcnt(0)
s_add_u32 s69, s47, 1
s_and_b32 s69, s69, 15
s_mul_i32 s67, s69, 2048
s_mul_i32 s68, s69, s54
s_barrier
s_add_u32 s60, s71, 40960
s_add_u32 m0, s60, 0
s_mov_b32 s61, s68
buffer_load_dwordx4 v26, s[28:31], s61 offen lds
buffer_load_dwordx4 v27, s[28:31], s61 offen offset:1024 lds
s_add_u32 m0, s60, 8192
s_add_u32 s61, s61, s53
buffer_load_dwordx4 v26, s[28:31], s61 offen lds
buffer_load_dwordx4 v27, s[28:31], s61 offen offset:1024 lds
s_add_u32 m0, s60, 16384
s_add_u32 s61, s61, s53
buffer_load_dwordx4 v26, s[28:31], s61 offen lds
buffer_load_dwordx4 v27, s[28:31], s61 offen offset:1024 lds
s_add_u32 s49, s76, 2
s_and_b32 s49, s49, 15
s_mul_i32 s49, s49, 393216
buffer_load_dwordx4 v[40:43], v36, s[28:31], s49 offen
s_add_u32 s49, s76, 3
s_and_b32 s49, s49, 15
s_mul_i32 s49, s49, 393216
buffer_load_dwordx4 v[40:43], v36, s[28:31], s49 offen
buffer_load_dword v5, v30, s[32:35], s79 offen sc1
s_add_u32 s69, s47, 0
s_and_b32 s69, s69, 15
s_mul_i32 s67, s69, 2048
s_mul_i32 s68, s69, s54
s_add_u32 m0, s70, 0
s_nop 0
s_mov_b32 s63, 0
s_waitcnt vmcnt(0)
poll_48:
v_cmp_gt_u32 vcc, 3, v5
s_cbranch_vccz polled_49
buffer_load_dword v5, v30, s[32:35], s79 offen sc1
s_add_u32 s63, s63, 1
s_cmp_lt_u32 s63, 0x80000
s_waitcnt vmcnt(0)
s_cbranch_scc1 poll_48
polled_49:
buffer_load_dwordx4 v20, s[32:35], s67 offen offset:0 sc1 lds
buffer_load_dwordx4 v21, s[32:35], s67 offen offset:1024 sc1 lds
buffer_load_dwordx4 v22, s[32:35], s67 offen offset:2048 sc1 lds
buffer_load_dwordx4 v23, s[32:35], s67 offen offset:3072 sc1 lds
s_add_u32 s69, s47, 1
s_and_b32 s69, s69, 15
s_mul_i32 s67, s69, 2048
s_mul_i32 s68, s69, s54
s_add_u32 m0, s70, 40960
s_nop 0
buffer_load_dwordx4 v20, s[32:35], s67 offen offset:0 sc1 lds
buffer_load_dwordx4 v21, s[32:35], s67 offen offset:1024 sc1 lds
buffer_load_dwordx4 v22, s[32:35], s67 offen offset:2048 sc1 lds
buffer_load_dwordx4 v23, s[32:35], s67 offen offset:3072 sc1 lds
s_waitcnt vmcnt(4) lgkmcnt(0)
s_barrier
s_add_u32 s69, s47, 2
s_and_b32 s69, s69, 15
s_mul_i32 s67, s69, 2048
s_mul_i32 s68, s69, s54
s_add_u32 m0, s70, 81920
s_nop 0
buffer_load_dwordx4 v20, s[32:35], s67 offen offset:0 sc1 lds
buffer_load_dwordx4 v21, s[32:35], s67 offen offset:1024 sc1 lds
buffer_load_dwordx4 v22, s[32:35], s67 offen offset:2048 sc1 lds
buffer_load_dwordx4 v23, s[32:35], s67 offen offset:3072 sc1 lds
s_add_u32 s60, s71, 81920
s_add_u32 m0, s60, 0
s_mov_b32 s61, s68
buffer_load_dwordx4 v26, s[28:31], s61 offen lds
buffer_load_dwordx4 v27, s[28:31], s61 offen offset:1024 lds
s_add_u32 m0, s60, 8192
s_add_u32 s61, s61, s53
buffer_load_dwordx4 v26, s[28:31], s61 offen lds
buffer_load_dwordx4 v27, s[28:31], s61 offen offset:1024 lds
s_add_u32 m0, s60, 16384
s_add_u32 s61, s61, s53
buffer_load_dwordx4 v26, s[28:31], s61 offen lds
buffer_load_dwordx4 v27, s[28:31], s61 offen offset:1024 lds
s_add_u32 s49, s76, 4
s_and_b32 s49, s49, 15
s_mul_i32 s49, s49, 393216
buffer_load_dwordx4 v[40:43], v36, s[28:31], s49 offen
s_mov_b32 s64, 0
s_mov_b32 s65, 0
h3_loop:
s_waitcnt vmcnt(11)
s_barrier
s_add_u32 s69, s69, 1
s_and_b32 s69, s69, 15
s_mul_i32 s67, s69, 2048
s_mul_i32 s68, s69, s54
s_add_u32 m0, s70, s65
s_nop 0
buffer_load_dwordx4 v20, s[32:35], s67 offen offset:0 sc1 lds
buffer_load_dwordx4 v21, s[32:35], s67 offen offset:1024 sc1 lds
buffer_load_dwordx4 v22, s[32:35], s67 offen offset:2048 sc1 lds
buffer_load_dwordx4 v23, s[32:35], s67 offen offset:3072 sc1 lds
s_add_u32 s60, s71, s65
s_add_u32 m0, s60, 0
s_mov_b32 s61, s68
buffer_load_dwordx4 v26, s[28:31], s61 offen lds
buffer_load_dwordx4 v27, s[28:31], s61 offen offset:1024 lds
s_add_u32 m0, s60, 8192
s_add_u32 s61, s61, s53
buffer_load_dwordx4 v26, s[28:31], s61 offen lds
buffer_load_dwordx4 v27, s[28:31], s61 offen offset:1024 lds
s_add_u32 m0, s60, 16384
s_add_u32 s61, s61, s53
buffer_load_dwordx4 v26, s[28:31], s61 offen lds
buffer_load_dwordx4 v27, s[28:31], s61 offen offset:1024 lds
s_add_u32 s48, s64, 5
s_min_u32 s48, s48, 15
s_add_u32 s49, s48, s76
s_and_b32 s49, s49, 15
s_mul_i32 s49, s49, 393216
buffer_load_dwordx4 v[40:43], v36, s[28:31], s49 offen
s_add_u32 s65, s65, 40960
s_cmp_eq_u32 s65, 122880
s_cselect_b32 s65, 0, s65
s_add_u32 s64, s64, 1
s_cmp_lt_u32 s64, 11
s_cbranch_scc1 h3_loop
s_waitcnt vmcnt(11)
s_barrier
s_add_u32 s69, s47, 14
s_and_b32 s69, s69, 15
s_mul_i32 s67, s69, 2048
s_mul_i32 s68, s69, s54
s_add_u32 m0, s70, s65
s_nop 0
buffer_load_dwordx4 v20, s[32:35], s67 offen offset:0 sc1 lds
buffer_load_dwordx4 v21, s[32:35], s67 offen offset:1024 sc1 lds
buffer_load_dwordx4 v22, s[32:35], s67 offen offset:2048 sc1 lds
buffer_load_dwordx4 v23, s[32:35], s67 offen offset:3072 sc1 lds
s_add_u32 s60, s71, s65
s_add_u32 m0, s60, 0
s_mov_b32 s61, s68
buffer_load_dwordx4 v26, s[28:31], s61 offen lds
buffer_load_dwordx4 v27, s[28:31], s61 offen offset:1024 lds
s_add_u32 m0, s60, 8192
s_add_u32 s61, s61, s53
buffer_load_dwordx4 v26, s[28:31], s61 offen lds
buffer_load_dwordx4 v27, s[28:31], s61 offen offset:1024 lds
s_add_u32 m0, s60, 16384
s_add_u32 s61, s61, s53
buffer_load_dwordx4 v26, s[28:31], s61 offen lds
buffer_load_dwordx4 v27, s[28:31], s61 offen offset:1024 lds
s_add_u32 s65, s65, 40960
s_cmp_eq_u32 s65, 122880
s_cselect_b32 s65, 0, s65
s_add_u32 s64, s64, 1
s_mov_b32 s36, s16
s_and_b32 s37, s17, 0xffff
s_mov_b32 s38, 2097152
s_mov_b32 s39, 0x00020000
s_waitcnt vmcnt(10)
s_barrier
s_add_u32 s69, s47, 15
s_and_b32 s69, s69, 15
s_mul_i32 s67, s69, 2048
s_mul_i32 s68, s69, s54
s_add_u32 m0, s70, 0
s_nop 0
buffer_load_dwordx4 v20, s[32:35], s67 offen offset:0 sc1 lds
buffer_load_dwordx4 v21, s[32:35], s67 offen offset:1024 sc1 lds
buffer_load_dwordx4 v22, s[32:35], s67 offen offset:2048 sc1 lds
buffer_load_dwordx4 v23, s[32:35], s67 offen offset:3072 sc1 lds
s_add_u32 s60, s71, 0
s_add_u32 m0, s60, 0
s_mov_b32 s61, s68
buffer_load_dwordx4 v26, s[28:31], s61 offen lds
buffer_load_dwordx4 v27, s[28:31], s61 offen offset:1024 lds
s_add_u32 m0, s60, 8192
s_add_u32 s61, s61, s53
buffer_load_dwordx4 v26, s[28:31], s61 offen lds
buffer_load_dwordx4 v27, s[28:31], s61 offen offset:1024 lds
s_add_u32 m0, s60, 16384
s_add_u32 s61, s61, s53
buffer_load_dwordx4 v26, s[28:31], s61 offen lds
buffer_load_dwordx4 v27, s[28:31], s61 offen offset:1024 lds
s_waitcnt vmcnt(10)
s_barrier
s_setprio 0
buffer_load_dword v33, v12, s[32:35], s73 offen sc1
buffer_load_dwordx4 v[80:83], v37, s[32:35], 0 offen offset:0 sc1
buffer_load_dwordx4 v[84:87], v37, s[32:35], 0 offen offset:1024 sc1
buffer_load_dwordx4 v[88:91], v37, s[32:35], 0 offen offset:2048 sc1
buffer_load_dwordx4 v[92:95], v37, s[32:35], 0 offen offset:3072 sc1
global_load_dword v48, v54, s[98:99]
s_add_u32 s48, s75, 15
s_and_b32 s48, s48, 15
s_mul_i32 s48, s48, s57
s_add_u32 m0, s71, 106496
s_nop 0
buffer_load_dwordx4 v28, s[36:39], s48 offen lds
buffer_load_dwordx4 v29, s[36:39], s48 offen offset:1024 lds
s_add_u32 s48, s75, 5
s_and_b32 s48, s48, 15
s_mul_i32 s48, s48, s57
s_add_u32 m0, s71, 24576
s_nop 0
buffer_load_dwordx4 v28, s[36:39], s48 offen lds
buffer_load_dwordx4 v29, s[36:39], s48 offen offset:1024 lds
s_add_u32 s48, s75, 6
s_and_b32 s48, s48, 15
s_mul_i32 s48, s48, s57
s_add_u32 m0, s71, 32768
s_nop 0
buffer_load_dwordx4 v28, s[36:39], s48 offen lds
buffer_load_dwordx4 v29, s[36:39], s48 offen offset:1024 lds
s_waitcnt vmcnt(12)
s_barrier
s_waitcnt vmcnt(7)
s_mov_b32 s63, 0
poll_53:
v_cmp_gt_u32 vcc, 16, v33
s_cbranch_vccz polled_54
buffer_load_dword v33, v12, s[32:35], s73 offen sc1
s_add_u32 s63, s63, 1
s_cmp_lt_u32 s63, 0x80000
s_waitcnt vmcnt(0)
s_cbranch_scc1 poll_53
polled_54:
s_add_u32 s48, s75, 7
s_and_b32 s48, s48, 15
s_mul_i32 s48, s48, s57
s_add_u32 m0, s71, 40960
s_nop 0
buffer_load_dwordx4 v28, s[36:39], s48 offen lds
v_add_f32 v80, v80, v88
v_add_f32 v81, v81, v89
v_add_f32 v82, v82, v90
v_add_f32 v83, v83, v91
v_add_f32 v84, v84, v92
buffer_load_dwordx4 v29, s[36:39], s48 offen offset:1024 lds
v_add_f32 v85, v85, v93
v_add_f32 v86, v86, v94
v_add_f32 v87, v87, v95
v_add_f32 v80, v80, v84
v_add_f32 v81, v81, v85
s_add_u32 s48, s75, 8
s_and_b32 s48, s48, 15
s_mul_i32 s48, s48, s57
s_add_u32 m0, s71, 49152
s_nop 0
buffer_load_dwordx4 v28, s[36:39], s48 offen lds
v_add_f32 v82, v82, v86
v_add_f32 v83, v83, v87
s_nop 1
v_permlane32_swap_b32 v80, v81
buffer_load_dwordx4 v29, s[36:39], s48 offen offset:1024 lds
v_permlane32_swap_b32 v82, v83
v_add_f32 v80, v80, v81
v_add_f32 v82, v82, v83
s_nop 1
v_permlane16_swap_b32 v80, v82
s_add_u32 s48, s75, 9
s_and_b32 s48, s48, 15
s_mul_i32 s48, s48, s57
s_add_u32 m0, s71, 57344
s_nop 0
buffer_load_dwordx4 v28, s[36:39], s48 offen lds
s_nop 0
v_add_f32 v80, v80, v82
v_cmp_u_f32 vcc, v80, v80
s_cbranch_vccnz again_50
summed_51:
buffer_load_dwordx4 v29, s[36:39], s48 offen offset:1024 lds
v_mul_f32 v44, 0x3a800000, v80
v_mov_b32 v45, v44
s_nop 1
v_permlane16_swap_b32 v44, v45
s_add_u32 s48, s75, 10
s_and_b32 s48, s48, 15
s_mul_i32 s48, s48, s57
s_add_u32 m0, s71, 65536
s_nop 0
buffer_load_dwordx4 v28, s[36:39], s48 offen lds
s_nop 0
v_fma_f32 v45, -v44, v44, v45
v_max_f32 v45, 0, v45
v_add_f32 v45, 0x3727c5ac, v45
v_rsq_f32 v46, v45
buffer_load_dwordx4 v29, s[36:39], s48 offen offset:1024 lds
v_sub_f32 v47, 0, v44
ds_write_b32 v50, v47 offset:512
ds_write_b64 v49, v[46:47]
ds_write_b32 v50, v46
s_setprio 0
s_waitcnt lgkmcnt(0)
s_waitcnt vmcnt(63)
s_barrier
s_waitcnt vmcnt(5)
s_add_u32 s48, s75, 11
s_and_b32 s48, s48, 15
s_mul_i32 s48, s48, s57
s_add_u32 m0, s71, 73728
s_nop 0
buffer_load_dwordx4 v28, s[36:39], s48 offen lds
buffer_load_dwordx4 v29, s[36:39], s48 offen offset:1024 lds
s_waitcnt vmcnt(5)
s_add_u32 s48, s75, 12
s_and_b32 s48, s48, 15
s_mul_i32 s48, s48, s57
s_add_u32 m0, s71, 81920
s_nop 0
buffer_load_dwordx4 v28, s[36:39], s48 offen lds
buffer_load_dwordx4 v29, s[36:39], s48 offen offset:1024 lds
s_waitcnt vmcnt(5)
s_add_u32 s48, s75, 13
s_and_b32 s48, s48, 15
s_mul_i32 s48, s48, s57
s_add_u32 m0, s71, 90112
s_nop 0
buffer_load_dwordx4 v28, s[36:39], s48 offen lds
buffer_load_dwordx4 v29, s[36:39], s48 offen offset:1024 lds
s_waitcnt vmcnt(5)
s_add_u32 s48, s75, 14
s_and_b32 s48, s48, 15
s_mul_i32 s48, s48, s57
s_add_u32 m0, s71, 98304
s_nop 0
buffer_load_dwordx4 v28, s[36:39], s48 offen lds
buffer_load_dwordx4 v29, s[36:39], s48 offen offset:1024 lds
s_waitcnt vmcnt(5)
s_add_u32 s48, s75, 0
s_and_b32 s48, s48, 15
s_mul_i32 s48, s48, s57
s_add_u32 m0, s71, 4294950912
s_nop 0
buffer_load_dwordx4 v28, s[36:39], s48 offen lds
buffer_load_dwordx4 v29, s[36:39], s48 offen offset:1024 lds
s_waitcnt vmcnt(5)
s_add_u32 s48, s75, 1
s_and_b32 s48, s48, 15
s_mul_i32 s48, s48, s57
s_add_u32 m0, s71, 4294959104
s_nop 0
buffer_load_dwordx4 v28, s[36:39], s48 offen lds
buffer_load_dwordx4 v29, s[36:39], s48 offen offset:1024 lds
s_waitcnt vmcnt(5)
s_add_u32 s48, s75, 2
s_and_b32 s48, s48, 15
s_mul_i32 s48, s48, s57
s_add_u32 m0, s71, 0
s_nop 0
buffer_load_dwordx4 v28, s[36:39], s48 offen lds
buffer_load_dwordx4 v29, s[36:39], s48 offen offset:1024 lds
s_waitcnt vmcnt(5)
s_add_u32 s48, s75, 3
s_and_b32 s48, s48, 15
s_mul_i32 s48, s48, s57
s_add_u32 m0, s71, 8192
s_nop 0
buffer_load_dwordx4 v28, s[36:39], s48 offen lds
buffer_load_dwordx4 v29, s[36:39], s48 offen offset:1024 lds
s_waitcnt vmcnt(5)
s_add_u32 s48, s75, 4
s_and_b32 s48, s48, 15
s_mul_i32 s48, s48, s57
s_add_u32 m0, s71, 16384
s_nop 0
buffer_load_dwordx4 v28, s[36:39], s48 offen lds
buffer_load_dwordx4 v29, s[36:39], s48 offen offset:1024 lds
s_waitcnt vmcnt(5)
buffer_load_dwordx4 v[240:243], v18, s[32:35], s81 offen offset:0 sc1
buffer_load_dwordx4 v[240:243], v18, s[32:35], s81 offen offset:1024 sc1
s_waitcnt vmcnt(5)
buffer_load_dwordx4 v[240:243], v18, s[32:35], s82 offen offset:0 sc1
buffer_load_dwordx4 v[240:243], v18, s[32:35], s82 offen offset:1024 sc1
s_waitcnt vmcnt(0) lgkmcnt(0)
s_barrier
L_end:
s_endpgm
L_compute:
s_lshr_b32 s48, s2, 2
s_and_b32 s48, s48, 1
s_lshl_b32 s48, s48, 1
s_add_u32 s48, s48, s74
s_and_b32 s49, s42, 3
s_xor_b32 s77, s48, s49
s_add_u32 s77, s77, 4
s_add_u32 s48, s47, 1
s_and_b32 s48, s48, 3
s_and_b32 s49, s77, 3
s_lshl_b32 s49, s49, 2
s_add_u32 s78, s48, s49
s_and_b32 s48, s2, 7
s_lshl_b32 s48, s48, 1
s_add_u32 s75, s78, s48
s_and_b32 s75, s75, 15
s_mov_b32 s46, 0
s_waitcnt lgkmcnt(0)
s_mov_b32 s32, s22
s_and_b32 s33, s23, 0xffff
s_mov_b32 s34, 268435456
s_mov_b32 s35, 0x00020000
s_mov_b32 s24, s18
s_and_b32 s25, s19, 0xffff
s_mov_b32 s26, 4194304
s_mov_b32 s27, 0x00020000
s_setprio 1
s_and_b32 s43, s40, 1
s_lshr_b32 s44, s40, 1
s_lshl_b32 s45, s42, 1
s_add_u32 s45, s45, s43
s_cmp_lg_u32 s40, 1
s_cbranch_scc1 else_55
s_getpc_b64 s[48:49]
L_pc:
s_sub_u32 s48, s48, L_pc - interleave_layers__sliding_local_dilated__linear_kernel_hedgehog__prompt_kernel
s_subb_u32 s49, s49, 0
s_lshr_b32 s50, s2, 3
s_lshl_b32 s50, s50, 12
v_lshl_add_u32 v8, v0, 6, s50
v_cmp_gt_u32 vcc, L_code_end - interleave_layers__sliding_local_dilated__linear_kernel_hedgehog__prompt_kernel, v8
s_and_saveexec_b64 s[50:51], vcc
s_cbranch_execz nopf_57
global_load_dword v254, v8, s[48:49]
nopf_57:
s_mov_b64 exec, -1
else_55:
s_lshl_b32 s48, s41, 3
s_lshl_b32 s49, s44, 2
s_add_u32 s48, s48, s49
s_lshl_b32 s48, s48, 5
s_add_u32 s48, s48, s45
s_lshl_b32 s48, s48, 10
s_add_u32 s80, s48, 4194304
s_add_u32 s81, s80, 32768
s_add_u32 s82, s80, 65536
s_add_u32 s83, s80, 98304
s_lshl_b32 s84, s41, 2
s_add_u32 s84, s84, s44
s_lshl_b32 s84, s84, 7
s_add_u32 s84, s84, 18350080
s_lshl_b32 s48, s41, 3
s_lshl_b32 s49, s40, 1
s_add_u32 s48, s48, s49
s_lshl_b32 s48, s48, 15
s_lshl_b32 s49, s78, 11
s_add_u32 s85, s48, s49
s_add_u32 s86, s85, 32768
s_lshl_b32 s50, s41, 2
s_add_u32 s50, s50, s40
s_lshl_b32 s50, s50, 4
s_add_u32 s50, s50, s42
s_lshl_b32 s50, s50, 8
s_add_u32 s87, s50, 16777216
s_lshl_b32 s88, s41, 2
s_add_u32 s88, s88, s40
s_lshl_b32 s88, s88, 7
s_add_u32 s88, s88, 18358272
v_lshrrev_b32 v4, 1, v3
v_lshl_add_u32 v4, v2, 2, v4
v_and_b32 v5, 1, v3
v_lshl_add_u32 v4, v5, 1, v4
v_lshlrev_b32 v1, 2, v4
s_lshl_b32 s48, s40, 2
s_add_u32 s48, s48, 134672
v_mov_b32 v10, s48
v_mov_b32 v11, 0
ds_write_b32 v10, v11
v_mov_b32 v140, -1
v_mov_b32 v141, -1
v_mov_b32 v142, -1
v_mov_b32 v143, -1
s_lshl_b32 s50, s42, 2
s_add_u32 s50, s50, s40
s_lshl_b32 s50, s50, 4
s_add_u32 s50, s50, s41
s_lshl_b32 s50, s50, 8
s_add_u32 s50, s50, 17825792
v_mov_b32 v4, s87
v_mov_b32 v5, s50
v_cmp_eq_u32 vcc, 0, v3
v_lshrrev_b32 v6, 1, v3
v_mul_u32_u24 v6, 262144, v6
v_add_u32 v5, v5, v6
v_cndmask_b32 v4, v5, v4, vcc
v_lshl_add_u32 v4, v2, 4, v4
buffer_store_dwordx4 v[140:143], v4, s[32:35], 0 offen sc1
s_lshl_b32 s48, s2, 2
s_add_u32 s49, s48, s40
s_lshl_b32 s48, s49, 10
s_add_u32 s48, s48, 8388608
buffer_store_dwordx4 v[140:143], v18, s[32:35], s48 offen sc1
s_and_b32 s48, s49, 7
s_cmp_lg_u32 s48, 0
s_cbranch_scc1 nofl_58
s_lshl_b32 s48, s49, 5
s_add_u32 s48, s48, 18350080
v_lshlrev_b32 v6, 2, v0
buffer_store_dword v11, v6, s[32:35], s48 offen sc1
nofl_58:
s_lshl_b32 s49, s44, 13
v_lshrrev_b32 v4, 1, v2
v_xor_b32 v4, v4, v3
v_lshlrev_b32 v4, 4, v4
v_lshl_add_u32 v10, v2, 7, v4
v_add_u32 v10, s49, v10
v_xor_b32 v11, 64, v10
s_lshl_b32 s48, s43, 1
v_lshrrev_b32 v4, 2, v2
v_and_b32 v5, 3, v0
v_lshl_add_u32 v6, v3, 3, v4
v_lshlrev_b32 v6, 7, v6
v_lshl_add_u32 v6, v5, 3, v6
v_lshrrev_b32 v7, 1, v4
v_and_b32 v8, 1, v3
v_lshl_add_u32 v7, v8, 1, v7
v_xor_b32 v7, s48, v7
v_lshl_add_u32 v12, v7, 5, v6
v_add_u32 v12, 16384, v12
v_xor_b32 v13, 32, v12
v_mov_b32 v14, v10
v_mov_b32 v15, v11
v_add_u32 v16, 0, v12
v_add_u32 v17, 0, v13
v_mov_b32 v156, 0
v_mov_b32 v157, 0
v_mov_b32 v158, 0
v_mov_b32 v159, 0
v_mov_b32 v160, 0
v_mov_b32 v161, 0
v_mov_b32 v162, 0
v_mov_b32 v163, 0
v_mov_b32 v164, 0
v_mov_b32 v165, 0
v_mov_b32 v166, 0
v_mov_b32 v167, 0
v_mov_b32 v168, 0
v_mov_b32 v169, 0
v_mov_b32 v170, 0
v_mov_b32 v171, 0
v_mov_b32 v172, 0
v_mov_b32 v173, 0
v_mov_b32 v174, 0
v_mov_b32 v175, 0
v_mov_b32 v176, 0
v_mov_b32 v177, 0
v_mov_b32 v178, 0
v_mov_b32 v179, 0
v_mov_b32 v180, 0
v_mov_b32 v181, 0
v_mov_b32 v182, 0
v_mov_b32 v183, 0
v_mov_b32 v184, 0
v_mov_b32 v185, 0
v_mov_b32 v186, 0
v_mov_b32 v187, 0
v_mov_b32 v188, 0
v_mov_b32 v189, 0
v_mov_b32 v190, 0
v_mov_b32 v191, 0
v_mov_b32 v192, 0
v_mov_b32 v193, 0
v_mov_b32 v194, 0
v_mov_b32 v195, 0
v_mov_b32 v196, 0
v_mov_b32 v197, 0
v_mov_b32 v198, 0
v_mov_b32 v199, 0
v_mov_b32 v200, 0
v_mov_b32 v201, 0
v_mov_b32 v202, 0
v_mov_b32 v203, 0
v_mov_b32 v204, 0
v_mov_b32 v205, 0
v_mov_b32 v206, 0
v_mov_b32 v207, 0
v_mov_b32 v208, 0
v_mov_b32 v209, 0
v_mov_b32 v210, 0
v_mov_b32 v211, 0
v_mov_b32 v212, 0
v_mov_b32 v213, 0
v_mov_b32 v214, 0
v_mov_b32 v215, 0
v_mov_b32 v216, 0
v_mov_b32 v217, 0
v_mov_b32 v218, 0
v_mov_b32 v219, 0
v_mov_b32 v220, 0
v_mov_b32 v221, 0
v_mov_b32 v222, 0
v_mov_b32 v223, 0
v_mov_b32 v224, 0
v_mov_b32 v225, 0
v_mov_b32 v226, 0
v_mov_b32 v227, 0
v_mov_b32 v228, 0
v_mov_b32 v229, 0
v_mov_b32 v230, 0
v_mov_b32 v231, 0
v_mov_b32 v232, 0
v_mov_b32 v233, 0
v_mov_b32 v234, 0
v_mov_b32 v235, 0
v_mov_b32 v236, 0
v_mov_b32 v237, 0
v_mov_b32 v238, 0
v_mov_b32 v239, 0
v_mov_b32 v240, 0
v_mov_b32 v241, 0
v_mov_b32 v242, 0
v_mov_b32 v243, 0
v_mov_b32 v244, 0
v_mov_b32 v245, 0
v_mov_b32 v246, 0
v_mov_b32 v247, 0
v_mov_b32 v248, 0
v_mov_b32 v249, 0
v_mov_b32 v250, 0
v_mov_b32 v251, 0
v_mov_b32 v48, 0x3f803f80
v_mov_b32 v49, 0x3f803f80
v_mov_b32 v50, 0x3f803f80
v_mov_b32 v51, 0x3f803f80
s_mov_b32 s48, 0xf149f2ca
v_mov_b32 v9, s48
v_lshlrev_b32 v4, 2, v3
v_sub_u32 v4, v2, v4
v_subrev_u32 v5, 0, v4
v_and_b32 v6, 0x80000001, v5
v_cmp_eq_u32 vcc, 0, v6
v_add_u32 v5, 1, v5
v_and_b32 v6, 0x80000001, v5
v_cndmask_b32 v40, v9, 0, vcc
v_cmp_eq_u32 vcc, 0x80000001, v6
s_nop 1
v_cndmask_b32 v36, v9, 0, vcc
v_subrev_u32 v5, 1, v4
v_and_b32 v6, 0x80000001, v5
v_cmp_eq_u32 vcc, 0, v6
v_add_u32 v5, 1, v5
v_and_b32 v6, 0x80000001, v5
v_cndmask_b32 v41, v9, 0, vcc
v_cmp_eq_u32 vcc, 0x80000001, v6
s_nop 1
v_cndmask_b32 v37, v9, 0, vcc
v_subrev_u32 v5, 2, v4
v_and_b32 v6, 0x80000001, v5
v_cmp_eq_u32 vcc, 0, v6
v_add_u32 v5, 1, v5
v_and_b32 v6, 0x80000001, v5
v_cndmask_b32 v42, v9, 0, vcc
v_cmp_eq_u32 vcc, 0x80000001, v6
s_nop 1
v_cndmask_b32 v38, v9, 0, vcc
v_subrev_u32 v5, 3, v4
v_and_b32 v6, 0x80000001, v5
v_cmp_eq_u32 vcc, 0, v6
v_add_u32 v5, 1, v5
v_and_b32 v6, 0x80000001, v5
v_cndmask_b32 v43, v9, 0, vcc
v_cmp_eq_u32 vcc, 0x80000001, v6
s_nop 1
v_cndmask_b32 v39, v9, 0, vcc
s_or_b32 s48, s41, s44
s_cmp_eq_u32 s48, 0
s_cselect_b64 vcc, -1, 0
v_cndmask_b32 v44, v36, v9, vcc
v_cndmask_b32 v45, v37, v9, vcc
v_cndmask_b32 v46, v38, v9, vcc
v_cndmask_b32 v47, v39, v9, vcc
v_and_b32 v4, 1, v2
v_lshlrev_b32 v4, 4, v4
v_mov_b32 v5, 0xffff
v_lshlrev_b32 v52, v4, v5
s_lshl_b32 s48, s43, 11
s_add_u32 s48, s48, 135168
v_add_u32 v53, s48, v18
v_lshl_add_u32 v55, v0, 3, s48
s_add_u32 s48, s41, s44
s_sub_u32 s48, s48, 1
s_lshl_b32 s49, s48, 1
s_add_u32 s49, s49, s43
s_lshl_b32 s49, s49, 11
s_mul_i32 s50, s42, 65536
s_add_u32 s49, s49, s50
s_add_u32 s49, s49, 8388608
s_cmp_lt_i32 s48, 0
s_cselect_b32 s49, 0xf0000000, s49
v_add_u32 v58, s49, v18
v_lshl_add_u32 v59, v0, 3, s49
s_lshl_b32 s48, s43, 2
s_add_u32 s48, s48, 134672
v_mov_b32 v19, s48
s_lshl_b32 s48, s43, 7
s_add_u32 s48, s48, 133120
v_lshl_add_u32 v7, v3, 4, s48
v_lshl_add_u32 v54, v2, 2, s48
s_lshl_b32 s49, s44, 6
v_add_u32 v8, s49, v2
v_lshlrev_b32 v8, 3, v8
v_add_u32 v8, 131072, v8
v_lshl_add_u32 v9, v3, 2, s49
v_lshlrev_b32 v9, 2, v9
v_add_u32 v9, 132096, v9
s_mov_b32 s64, 0
s_mov_b32 s65, 0
s_mov_b32 s66, 0x3e8293ee
s_mov_b32 s61, 1
s_lshl_b32 s50, s42, 2
s_add_u32 s50, s50, s40
s_lshl_b32 s50, s50, 4
s_add_u32 s50, s50, s41
s_lshl_b32 s50, s50, 8
s_add_u32 s52, s50, 17825792
v_lshrrev_b32 v4, 1, v2
v_lshrrev_b32 v5, 1, v3
v_xor_b32 v4, v4, v5
v_lshlrev_b32 v4, 4, v4
v_and_b32 v5, 1, v3
v_lshl_add_u32 v4, v5, 3, v4
v_lshl_add_u32 v4, v2, 7, v4
s_lshl_b32 s48, s40, 12
v_add_u32 v155, s48, v4
v_mov_b32 v152, 0
v_mov_b32 v153, 0
v_mov_b32 v56, 0
v_mov_b32 v57, 0
s_waitcnt vmcnt(0)
s_lshl_b32 s79, 1, s77
s_or_b32 s79, s79, 0
s_barrier
ds_read_b128 v[60:63], v14 offset:0
ds_read_b128 v[64:67], v14 offset:2048
ds_read_b128 v[68:71], v14 offset:4096
ds_read_b128 v[72:75], v14 offset:6144
ds_read_b64_tr_b16 v[84:85], v16 offset:8192
ds_read_b64_tr_b16 v[86:87], v16 offset:8704
ds_read_b64_tr_b16 v[88:89], v17 offset:8192
ds_read_b64_tr_b16 v[90:91], v17 offset:8704
ds_read_b64_tr_b16 v[92:93], v16 offset:16384
ds_read_b64_tr_b16 v[94:95], v16 offset:16896
ds_read_b64_tr_b16 v[96:97], v17 offset:16384
ds_read_b64_tr_b16 v[98:99], v17 offset:16896
ds_read_b64_tr_b16 v[76:77], v16 offset:0
ds_read_b64_tr_b16 v[78:79], v16 offset:512
ds_read_b64_tr_b16 v[80:81], v17 offset:0
ds_read_b64_tr_b16 v[82:83], v17 offset:512
s_waitcnt lgkmcnt(0)
c0_loop:
v_mfma_f32_16x16x32_bf16 v[212:215], v[84:87], v[72:75], v[212:215]
ds_read_b128 v[100:103], v15 offset:0
v_mfma_f32_16x16x32_bf16 v[204:207], v[84:87], v[68:71], v[204:207]
ds_read_b128 v[104:107], v15 offset:2048
v_mfma_f32_16x16x32_bf16 v[196:199], v[84:87], v[64:67], v[196:199]
ds_read_b128 v[108:111], v15 offset:4096
v_mfma_f32_16x16x32_bf16 v[188:191], v[84:87], v[60:63], v[188:191]
ds_read_b128 v[112:115], v15 offset:6144
v_mfma_f32_16x16x32_bf16 v[192:195], v[88:91], v[60:63], v[192:195]
ds_read_b64_tr_b16 v[124:125], v16 offset:12288
v_mfma_f32_16x16x32_bf16 v[200:203], v[88:91], v[64:67], v[200:203]
ds_read_b64_tr_b16 v[126:127], v16 offset:12800
v_mfma_f32_16x16x32_bf16 v[208:211], v[88:91], v[68:71], v[208:211]
ds_read_b64_tr_b16 v[128:129], v17 offset:12288
v_mfma_f32_16x16x32_bf16 v[216:219], v[88:91], v[72:75], v[216:219]
ds_read_b64_tr_b16 v[130:131], v17 offset:12800
v_mfma_f32_16x16x32_bf16 v[244:247], v[72:75], v[92:95], v[244:247]
ds_read_b64_tr_b16 v[132:133], v16 offset:20480
v_mfma_f32_16x16x32_bf16 v[248:251], v[72:75], v[96:99], v[248:251]
ds_read_b64_tr_b16 v[134:135], v16 offset:20992
v_mfma_f32_16x16x32_bf16 v[240:243], v[68:71], v[96:99], v[240:243]
ds_read_b64_tr_b16 v[136:137], v17 offset:20480
v_mfma_f32_16x16x32_bf16 v[236:239], v[68:71], v[92:95], v[236:239]
ds_read_b64_tr_b16 v[138:139], v17 offset:20992
v_mfma_f32_16x16x32_bf16 v[228:231], v[64:67], v[92:95], v[228:231]
ds_read_b64_tr_b16 v[116:117], v16 offset:4096
v_mfma_f32_16x16x32_bf16 v[232:235], v[64:67], v[96:99], v[232:235]
ds_read_b64_tr_b16 v[118:119], v16 offset:4608
v_mfma_f32_16x16x32_bf16 v[224:227], v[60:63], v[96:99], v[224:227]
ds_read_b64_tr_b16 v[120:121], v17 offset:4096
v_mfma_f32_16x16x32_bf16 v[220:223], v[60:63], v[92:95], v[220:223]
ds_read_b64_tr_b16 v[122:123], v17 offset:4608
v_mfma_f32_16x16x32_bf16 v[156:159], v[76:79], v[60:63], v[156:159]
s_bitcmp1_b32 s79, s64
s_cbranch_scc1 c0_hook
c0_hook_ret:
v_mfma_f32_16x16x32_bf16 v[164:167], v[76:79], v[64:67], v[164:167]
s_add_u32 s65, s65, 40960
s_cmp_eq_u32 s65, 122880
v_mfma_f32_16x16x32_bf16 v[172:175], v[76:79], v[68:71], v[172:175]
s_cselect_b32 s65, 0, s65
s_add_u32 s64, s64, 1
v_mfma_f32_16x16x32_bf16 v[180:183], v[76:79], v[72:75], v[180:183]
v_add_u32 v14, s65, v10
v_add_u32 v15, s65, v11
v_mfma_f32_16x16x32_bf16 v[184:187], v[80:83], v[72:75], v[184:187]
v_add_u32 v16, s65, v12
v_add_u32 v17, s65, v13
v_mfma_f32_16x16x32_bf16 v[176:179], v[80:83], v[68:71], v[176:179]
s_cmp_eq_u32 s64, 16
s_cbranch_scc1 c0_last
v_mfma_f32_16x16x32_bf16 v[168:171], v[80:83], v[64:67], v[168:171]
s_waitcnt lgkmcnt(0)
v_mfma_f32_16x16x32_bf16 v[160:163], v[80:83], v[60:63], v[160:163]
s_barrier
v_mfma_f32_16x16x32_bf16 v[212:215], v[124:127], v[112:115], v[212:215]
ds_read_b128 v[60:63], v14 offset:0
v_mfma_f32_16x16x32_bf16 v[204:207], v[124:127], v[108:111], v[204:207]
ds_read_b128 v[64:67], v14 offset:2048
v_mfma_f32_16x16x32_bf16 v[196:199], v[124:127], v[104:107], v[196:199]
ds_read_b128 v[68:71], v14 offset:4096
v_mfma_f32_16x16x32_bf16 v[188:191], v[124:127], v[100:103], v[188:191]
ds_read_b128 v[72:75], v14 offset:6144
v_mfma_f32_16x16x32_bf16 v[192:195], v[128:131], v[100:103], v[192:195]
ds_read_b64_tr_b16 v[84:85], v16 offset:8192
v_mfma_f32_16x16x32_bf16 v[200:203], v[128:131], v[104:107], v[200:203]
ds_read_b64_tr_b16 v[86:87], v16 offset:8704
v_mfma_f32_16x16x32_bf16 v[208:211], v[128:131], v[108:111], v[208:211]
ds_read_b64_tr_b16 v[88:89], v17 offset:8192
v_mfma_f32_16x16x32_bf16 v[216:219], v[128:131], v[112:115], v[216:219]
ds_read_b64_tr_b16 v[90:91], v17 offset:8704
v_mfma_f32_16x16x32_bf16 v[244:247], v[112:115], v[132:135], v[244:247]
ds_read_b64_tr_b16 v[92:93], v16 offset:16384
v_mfma_f32_16x16x32_bf16 v[248:251], v[112:115], v[136:139], v[248:251]
ds_read_b64_tr_b16 v[94:95], v16 offset:16896
v_mfma_f32_16x16x32_bf16 v[240:243], v[108:111], v[136:139], v[240:243]
ds_read_b64_tr_b16 v[96:97], v17 offset:16384
v_mfma_f32_16x16x32_bf16 v[236:239], v[108:111], v[132:135], v[236:239]
ds_read_b64_tr_b16 v[98:99], v17 offset:16896
v_mfma_f32_16x16x32_bf16 v[228:231], v[104:107], v[132:135], v[228:231]
ds_read_b64_tr_b16 v[76:77], v16 offset:0
v_mfma_f32_16x16x32_bf16 v[232:235], v[104:107], v[136:139], v[232:235]
ds_read_b64_tr_b16 v[78:79], v16 offset:512
v_mfma_f32_16x16x32_bf16 v[224:227], v[100:103], v[136:139], v[224:227]
ds_read_b64_tr_b16 v[80:81], v17 offset:0
v_mfma_f32_16x16x32_bf16 v[220:223], v[100:103], v[132:135], v[220:223]
ds_read_b64_tr_b16 v[82:83], v17 offset:512
v_mfma_f32_16x16x32_bf16 v[156:159], v[116:119], v[100:103], v[156:159]
v_mfma_f32_16x16x32_bf16 v[164:167], v[116:119], v[104:107], v[164:167]
v_mfma_f32_16x16x32_bf16 v[172:175], v[116:119], v[108:111], v[172:175]
v_mfma_f32_16x16x32_bf16 v[180:183], v[116:119], v[112:115], v[180:183]
v_mfma_f32_16x16x32_bf16 v[184:187], v[120:123], v[112:115], v[184:187]
v_mfma_f32_16x16x32_bf16 v[176:179], v[120:123], v[108:111], v[176:179]
v_mfma_f32_16x16x32_bf16 v[168:171], v[120:123], v[104:107], v[168:171]
s_waitcnt lgkmcnt(0)
v_mfma_f32_16x16x32_bf16 v[160:163], v[120:123], v[100:103], v[160:163]
s_branch c0_loop
c0_hook:
v_add_u32 v4, s65, v155
ds_read_b64 v[20:21], v4 offset:0
ds_read_b64 v[28:29], v4 offset:2048
v_xor_b32 v5, 32, v4
ds_read_b64 v[22:23], v5 offset:0
ds_read_b64 v[30:31], v5 offset:2048
v_xor_b32 v5, 64, v4
ds_read_b64 v[24:25], v5 offset:0
ds_read_b64 v[32:33], v5 offset:2048
v_xor_b32 v5, 96, v4
ds_read_b64 v[26:27], v5 offset:0
ds_read_b64 v[34:35], v5 offset:2048
s_waitcnt lgkmcnt(8)
s_cmp_lg_u32 s44, 0
s_cbranch_scc1 else_59
v_mfma_f32_16x16x32_bf16 v[140:143], v[48:51], v[76:79], 0
v_mfma_f32_16x16x32_bf16 v[144:147], v[48:51], v[84:87], 0
v_mfma_f32_16x16x32_bf16 v[148:151], v[48:51], v[92:95], 0
v_mfma_f32_16x16x32_bf16 v[140:143], v[48:51], v[116:119], v[140:143]
v_mfma_f32_16x16x32_bf16 v[144:147], v[48:51], v[124:127], v[144:147]
v_mfma_f32_16x16x32_bf16 v[148:151], v[48:51], v[132:135], v[148:151]
s_branch fi_60
else_59:
v_mfma_f32_16x16x32_bf16 v[140:143], v[48:51], v[80:83], 0
v_mfma_f32_16x16x32_bf16 v[144:147], v[48:51], v[88:91], 0
v_mfma_f32_16x16x32_bf16 v[148:151], v[48:51], v[96:99], 0
v_mfma_f32_16x16x32_bf16 v[140:143], v[48:51], v[120:123], v[140:143]
v_mfma_f32_16x16x32_bf16 v[144:147], v[48:51], v[128:131], v[144:147]
v_mfma_f32_16x16x32_bf16 v[148:151], v[48:51], v[136:139], v[148:151]
fi_60:
s_waitcnt lgkmcnt(0)
v_dot2c_f32_bf16 v152, v20, v48
v_dot2c_f32_bf16 v56, v20, v20
v_dot2c_f32_bf16 v153, v28, v48
v_dot2c_f32_bf16 v57, v28, v28
v_dot2c_f32_bf16 v152, v21, v48
v_dot2c_f32_bf16 v56, v21, v21
v_dot2c_f32_bf16 v153, v29, v48
v_dot2c_f32_bf16 v57, v29, v29
v_dot2c_f32_bf16 v152, v22, v48
v_dot2c_f32_bf16 v56, v22, v22
v_dot2c_f32_bf16 v153, v30, v48
v_dot2c_f32_bf16 v57, v30, v30
v_dot2c_f32_bf16 v152, v23, v48
v_dot2c_f32_bf16 v56, v23, v23
v_dot2c_f32_bf16 v153, v31, v48
v_dot2c_f32_bf16 v57, v31, v31
v_dot2c_f32_bf16 v152, v24, v48
v_dot2c_f32_bf16 v56, v24, v24
v_dot2c_f32_bf16 v153, v32, v48
v_dot2c_f32_bf16 v57, v32, v32
v_dot2c_f32_bf16 v152, v25, v48
v_dot2c_f32_bf16 v56, v25, v25
v_dot2c_f32_bf16 v153, v33, v48
v_dot2c_f32_bf16 v57, v33, v33
v_dot2c_f32_bf16 v152, v26, v48
v_dot2c_f32_bf16 v56, v26, v26
v_dot2c_f32_bf16 v153, v34, v48
v_dot2c_f32_bf16 v57, v34, v34
v_dot2c_f32_bf16 v152, v27, v48
v_dot2c_f32_bf16 v56, v27, v27
v_dot2c_f32_bf16 v153, v35, v48
v_dot2c_f32_bf16 v57, v35, v35
v_cmp_eq_u32 vcc, 0, v3
v_cmp_eq_u32 s[48:49], 1, v3
s_nop 1
v_cndmask_b32 v4, v148, v144, s[48:49]
v_cndmask_b32 v4, v4, v140, vcc
buffer_store_dword v4, v1, s[32:35], s52 offen sc1
s_nop 1
v_permlane32_swap_b32 v152, v153
v_permlane32_swap_b32 v56, v57
v_add_f32 v152, v152, v153
v_add_f32 v56, v56, v57
s_nop 1
v_permlane16_swap_b32 v152, v56
s_nop 0
v_add_f32 v152, v152, v56
buffer_store_dword v152, v1, s[32:35], s87 offen sc1
s_branch c0_hook_ret
c0_last:
v_mfma_f32_16x16x32_bf16 v[168:171], v[80:83], v[64:67], v[168:171]
s_waitcnt lgkmcnt(0)
v_mfma_f32_16x16x32_bf16 v[160:163], v[80:83], v[60:63], v[160:163]
v_mfma_f32_16x16x32_bf16 v[212:215], v[124:127], v[112:115], v[212:215]
v_mfma_f32_16x16x32_bf16 v[204:207], v[124:127], v[108:111], v[204:207]
v_mfma_f32_16x16x32_bf16 v[196:199], v[124:127], v[104:107], v[196:199]
v_mfma_f32_16x16x32_bf16 v[188:191], v[124:127], v[100:103], v[188:191]
v_mfma_f32_16x16x32_bf16 v[192:195], v[128:131], v[100:103], v[192:195]
v_mfma_f32_16x16x32_bf16 v[200:203], v[128:131], v[104:107], v[200:203]
v_mfma_f32_16x16x32_bf16 v[208:211], v[128:131], v[108:111], v[208:211]
v_mfma_f32_16x16x32_bf16 v[216:219], v[128:131], v[112:115], v[216:219]
s_barrier
v_mfma_f32_16x16x32_bf16 v[244:247], v[112:115], v[132:135], v[244:247]
ds_read_b128 v[140:143], v7 offset:0
ds_read_b128 v[144:147], v7 offset:64
v_mfma_f32_16x16x32_bf16 v[248:251], v[112:115], v[136:139], v[248:251]
ds_read_b128 v[148:151], v7 offset:256
ds_read_b128 v[152:155], v7 offset:320
v_mfma_f32_16x16x32_bf16 v[240:243], v[108:111], v[136:139], v[240:243]
ds_read_b64 v[92:93], v8 offset:0
ds_read_b64 v[94:95], v8 offset:128
v_mfma_f32_16x16x32_bf16 v[236:239], v[108:111], v[132:135], v[236:239]
ds_read_b64 v[96:97], v8 offset:256
ds_read_b64 v[98:99], v8 offset:384
v_mfma_f32_16x16x32_bf16 v[228:231], v[104:107], v[132:135], v[228:231]
ds_read2_b32 v[56:57], v54 offset0:128 offset1:144
ds_read_b128 v[60:63], v9 offset:0
v_mfma_f32_16x16x32_bf16 v[232:235], v[104:107], v[136:139], v[232:235]
ds_read_b128 v[64:67], v9 offset:64
v_mfma_f32_16x16x32_bf16 v[224:227], v[100:103], v[136:139], v[224:227]
ds_read_b128 v[68:71], v9 offset:128
v_mfma_f32_16x16x32_bf16 v[220:223], v[100:103], v[132:135], v[220:223]
ds_read_b128 v[72:75], v9 offset:192
v_mfma_f32_16x16x32_bf16 v[156:159], v[116:119], v[100:103], v[156:159]
ds_read_b128 v[76:79], v9 offset:512
v_mfma_f32_16x16x32_bf16 v[164:167], v[116:119], v[104:107], v[164:167]
ds_read_b128 v[80:83], v9 offset:576
v_mfma_f32_16x16x32_bf16 v[172:175], v[116:119], v[108:111], v[172:175]
ds_read_b128 v[84:87], v9 offset:640
v_mfma_f32_16x16x32_bf16 v[180:183], v[116:119], v[112:115], v[180:183]
ds_read_b128 v[88:91], v9 offset:704
v_mfma_f32_16x16x32_bf16 v[184:187], v[120:123], v[112:115], v[184:187]
v_mov_b32 v6, 134656
ds_read_b32 v6, v6
v_mfma_f32_16x16x32_bf16 v[176:179], v[120:123], v[108:111], v[176:179]
v_mfma_f32_16x16x32_bf16 v[168:171], v[120:123], v[104:107], v[168:171]
v_mfma_f32_16x16x32_bf16 v[160:163], v[120:123], v[100:103], v[160:163]
c0_epi:
s_waitcnt lgkmcnt(0)
v_readfirstlane_b32 s46, v6
.p2align 3
v_pk_fma_f32 v[212:213], v[148:149], v[98:99], v[212:213] op_sel:[0,1,0] op_sel_hi:[1,1,1]
v_pk_fma_f32 v[214:215], v[150:151], v[98:99], v[214:215] op_sel:[0,1,0] op_sel_hi:[1,1,1]
v_pk_fma_f32 v[216:217], v[152:153], v[98:99], v[216:217] op_sel:[0,1,0] op_sel_hi:[1,1,1]
v_pk_fma_f32 v[218:219], v[154:155], v[98:99], v[218:219] op_sel:[0,1,0] op_sel_hi:[1,1,1]
v_pk_mul_f32 v[212:213], v[212:213], v[98:99] op_sel:[0,0] op_sel_hi:[1,0]
v_pk_mul_f32 v[214:215], v[214:215], v[98:99] op_sel:[0,0] op_sel_hi:[1,0]
v_pk_mul_f32 v[216:217], v[216:217], v[98:99] op_sel:[0,0] op_sel_hi:[1,0]
v_pk_mul_f32 v[218:219], v[218:219], v[98:99] op_sel:[0,0] op_sel_hi:[1,0]
v_cvt_pk_bf16_f32 v212, v212, v213
v_cvt_pk_bf16_f32 v213, v214, v215
v_cvt_pk_bf16_f32 v214, v216, v217
v_cvt_pk_bf16_f32 v215, v218, v219
v_pk_fma_f32 v[244:245], v[88:89], v[56:57], v[244:245] op_sel:[0,0,0] op_sel_hi:[1,0,1]
v_pk_fma_f32 v[246:247], v[90:91], v[56:57], v[246:247] op_sel:[0,0,0] op_sel_hi:[1,0,1]
v_pk_mul_f32 v[244:245], v[244:245], v[72:73]
v_pk_mul_f32 v[246:247], v[246:247], v[74:75]
v_cvt_pk_bf16_f32 v108, v244, v245
v_cvt_pk_bf16_f32 v109, v246, v247
v_pk_fma_f32 v[248:249], v[88:89], v[56:57], v[248:249] op_sel:[0,1,0] op_sel_hi:[1,1,1]
v_pk_fma_f32 v[250:251], v[90:91], v[56:57], v[250:251] op_sel:[0,1,0] op_sel_hi:[1,1,1]
v_pk_mul_f32 v[248:249], v[248:249], v[72:73]
v_pk_mul_f32 v[250:251], v[250:251], v[74:75]
v_cvt_pk_bf16_f32 v118, v248, v249
v_cvt_pk_bf16_f32 v119, v250, v251
s_cmp_lg_u32 s44, 1
s_cbranch_scc1 else_61
buffer_store_dwordx4 v[212:215], v58, s[32:35], 0 offen sc1
buffer_store_dwordx2 v[108:109], v59, s[32:35], 0 offen offset:1024 sc1
buffer_store_dwordx2 v[118:119], v59, s[32:35], 0 offen offset:1536 sc1
s_branch fi_62
else_61:
ds_write_b128 v53, v[212:215]
ds_write_b64 v55, v[108:109] offset:1024
ds_write_b64 v55, v[118:119] offset:1536
v_mov_b32 v4, 1
ds_write_b32 v19, v4
fi_62:
.p2align 3
v_pk_fma_f32 v[188:189], v[148:149], v[92:93], v[188:189] op_sel:[0,1,0] op_sel_hi:[1,1,1]
v_pk_fma_f32 v[196:197], v[148:149], v[94:95], v[196:197] op_sel:[0,1,0] op_sel_hi:[1,1,1]
v_pk_fma_f32 v[204:205], v[148:149], v[96:97], v[204:205] op_sel:[0,1,0] op_sel_hi:[1,1,1]
v_pk_fma_f32 v[164:165], v[140:141], v[94:95], v[164:165] op_sel:[0,1,0] op_sel_hi:[1,1,1]
v_pk_fma_f32 v[172:173], v[140:141], v[96:97], v[172:173] op_sel:[0,1,0] op_sel_hi:[1,1,1]
v_pk_fma_f32 v[180:181], v[140:141], v[98:99], v[180:181] op_sel:[0,1,0] op_sel_hi:[1,1,1]
v_pk_fma_f32 v[190:191], v[150:151], v[92:93], v[190:191] op_sel:[0,1,0] op_sel_hi:[1,1,1]
v_pk_mul_f32 v[188:189], v[188:189], v[92:93] op_sel:[0,0] op_sel_hi:[1,0]
v_pk_fma_f32 v[198:199], v[150:151], v[94:95], v[198:199] op_sel:[0,1,0] op_sel_hi:[1,1,1]
v_pk_mul_f32 v[196:197], v[196:197], v[94:95] op_sel:[0,0] op_sel_hi:[1,0]
v_pk_fma_f32 v[206:207], v[150:151], v[96:97], v[206:207] op_sel:[0,1,0] op_sel_hi:[1,1,1]
v_pk_mul_f32 v[204:205], v[204:205], v[96:97] op_sel:[0,0] op_sel_hi:[1,0]
v_pk_fma_f32 v[166:167], v[142:143], v[94:95], v[166:167] op_sel:[0,1,0] op_sel_hi:[1,1,1]
v_cvt_pk_bf16_f32 v164, v164, v165
v_pk_fma_f32 v[174:175], v[142:143], v[96:97], v[174:175] op_sel:[0,1,0] op_sel_hi:[1,1,1]
v_cvt_pk_bf16_f32 v172, v172, v173
v_pk_fma_f32 v[182:183], v[142:143], v[98:99], v[182:183] op_sel:[0,1,0] op_sel_hi:[1,1,1]
v_cvt_pk_bf16_f32 v180, v180, v181
v_pk_fma_f32 v[192:193], v[152:153], v[92:93], v[192:193] op_sel:[0,1,0] op_sel_hi:[1,1,1]
v_pk_fma_f32 v[194:195], v[154:155], v[92:93], v[194:195] op_sel:[0,1,0] op_sel_hi:[1,1,1]
v_pk_mul_f32 v[190:191], v[190:191], v[92:93] op_sel:[0,0] op_sel_hi:[1,0]
v_cvt_pk_bf16_f32 v188, v188, v189
v_pk_fma_f32 v[200:201], v[152:153], v[94:95], v[200:201] op_sel:[0,1,0] op_sel_hi:[1,1,1]
v_pk_fma_f32 v[202:203], v[154:155], v[94:95], v[202:203] op_sel:[0,1,0] op_sel_hi:[1,1,1]
v_pk_mul_f32 v[198:199], v[198:199], v[94:95] op_sel:[0,0] op_sel_hi:[1,0]
v_cvt_pk_bf16_f32 v196, v196, v197
v_pk_fma_f32 v[208:209], v[152:153], v[96:97], v[208:209] op_sel:[0,1,0] op_sel_hi:[1,1,1]
v_pk_fma_f32 v[210:211], v[154:155], v[96:97], v[210:211] op_sel:[0,1,0] op_sel_hi:[1,1,1]
v_pk_mul_f32 v[206:207], v[206:207], v[96:97] op_sel:[0,0] op_sel_hi:[1,0]
v_cvt_pk_bf16_f32 v204, v204, v205
v_pk_fma_f32 v[168:169], v[144:145], v[94:95], v[168:169] op_sel:[0,1,0] op_sel_hi:[1,1,1]
v_pk_fma_f32 v[170:171], v[146:147], v[94:95], v[170:171] op_sel:[0,1,0] op_sel_hi:[1,1,1]
v_cvt_pk_bf16_f32 v165, v166, v167
v_pk_fma_f32 v[176:177], v[144:145], v[96:97], v[176:177] op_sel:[0,1,0] op_sel_hi:[1,1,1]
v_pk_fma_f32 v[178:179], v[146:147], v[96:97], v[178:179] op_sel:[0,1,0] op_sel_hi:[1,1,1]
v_cvt_pk_bf16_f32 v173, v174, v175
v_pk_fma_f32 v[184:185], v[144:145], v[98:99], v[184:185] op_sel:[0,1,0] op_sel_hi:[1,1,1]
v_pk_fma_f32 v[186:187], v[146:147], v[98:99], v[186:187] op_sel:[0,1,0] op_sel_hi:[1,1,1]
v_cvt_pk_bf16_f32 v181, v182, v183
v_pk_mul_f32 v[192:193], v[192:193], v[92:93] op_sel:[0,0] op_sel_hi:[1,0]
v_pk_mul_f32 v[194:195], v[194:195], v[92:93] op_sel:[0,0] op_sel_hi:[1,0]
v_cvt_pk_bf16_f32 v189, v190, v191
v_pk_mul_f32 v[200:201], v[200:201], v[94:95] op_sel:[0,0] op_sel_hi:[1,0]
v_pk_mul_f32 v[202:203], v[202:203], v[94:95] op_sel:[0,0] op_sel_hi:[1,0]
v_cvt_pk_bf16_f32 v197, v198, v199
v_pk_mul_f32 v[208:209], v[208:209], v[96:97] op_sel:[0,0] op_sel_hi:[1,0]
v_pk_mul_f32 v[210:211], v[210:211], v[96:97] op_sel:[0,0] op_sel_hi:[1,0]
v_cvt_pk_bf16_f32 v205, v206, v207
v_cvt_pk_bf16_f32 v166, v168, v169
v_cvt_pk_bf16_f32 v167, v170, v171
v_cvt_pk_bf16_f32 v174, v176, v177
v_cvt_pk_bf16_f32 v175, v178, v179
v_cvt_pk_bf16_f32 v182, v184, v185
v_cvt_pk_bf16_f32 v183, v186, v187
v_cvt_pk_bf16_f32 v190, v192, v193
v_cvt_pk_bf16_f32 v191, v194, v195
v_mfma_f32_16x16x32_bf16 v[216:219], v[212:215], v[180:183], v[40:43]
v_cvt_pk_bf16_f32 v198, v200, v201
v_cvt_pk_bf16_f32 v199, v202, v203
v_mfma_f32_16x16x32_bf16 v[168:171], v[188:191], v[164:167], v[36:39]
v_cvt_pk_bf16_f32 v206, v208, v209
v_cvt_pk_bf16_f32 v207, v210, v211
v_mfma_f32_16x16x32_bf16 v[200:203], v[196:199], v[164:167], v[40:43]
v_mul_f32 v124, s66, v92
v_mul_f32 v125, s66, v94
v_mfma_f32_16x16x32_bf16 v[208:211], v[204:207], v[172:175], v[40:43]
v_mul_f32 v126, s66, v96
v_mul_f32 v127, s66, v98
v_mfma_f32_16x16x32_bf16 v[176:179], v[196:199], v[172:175], v[36:39]
v_max_f32 v164, v168, v169
v_max_f32 v165, v170, v171
v_mfma_f32_16x16x32_bf16 v[184:187], v[204:207], v[180:183], v[36:39]
v_max_f32 v166, v200, v201
v_max_f32 v182, v216, v217
v_max_f32 v174, v208, v209
v_max_f32 v167, v202, v203
v_max3_f32 v129, v164, v165, v166
v_pk_fma_f32 v[156:157], v[140:141], v[92:93], v[156:157] op_sel:[0,1,0] op_sel_hi:[1,1,1]
v_pk_fma_f32 v[158:159], v[142:143], v[92:93], v[158:159] op_sel:[0,1,0] op_sel_hi:[1,1,1]
v_cvt_pk_bf16_f32 v156, v156, v157
v_pk_fma_f32 v[160:161], v[144:145], v[92:93], v[160:161] op_sel:[0,1,0] op_sel_hi:[1,1,1]
v_pk_fma_f32 v[162:163], v[146:147], v[92:93], v[162:163] op_sel:[0,1,0] op_sel_hi:[1,1,1]
v_cvt_pk_bf16_f32 v157, v158, v159
v_cvt_pk_bf16_f32 v158, v160, v161
v_cvt_pk_bf16_f32 v159, v162, v163
v_pk_fma_f32 v[220:221], v[76:77], v[56:57], v[220:221] op_sel:[0,0,0] op_sel_hi:[1,0,1]
v_pk_fma_f32 v[222:223], v[78:79], v[56:57], v[222:223] op_sel:[0,0,0] op_sel_hi:[1,0,1]
v_mfma_f32_16x16x32_bf16 v[192:195], v[188:191], v[156:159], v[40:43]
v_max_f32 v172, v176, v177
v_max_f32 v173, v178, v179
v_max_f32 v180, v184, v185
v_max_f32 v181, v186, v187
v_max_f32_e64 v175, v210, v211
v_pk_fma_f32 v[224:225], v[76:77], v[56:57], v[224:225] op_sel:[0,1,0] op_sel_hi:[1,1,1]
v_pk_fma_f32 v[226:227], v[78:79], v[56:57], v[226:227] op_sel:[0,1,0] op_sel_hi:[1,1,1]
v_pk_fma_f32 v[228:229], v[80:81], v[56:57], v[228:229] op_sel:[0,0,0] op_sel_hi:[1,0,1]
v_pk_fma_f32 v[230:231], v[82:83], v[56:57], v[230:231] op_sel:[0,0,0] op_sel_hi:[1,0,1]
v_pk_fma_f32 v[232:233], v[80:81], v[56:57], v[232:233] op_sel:[0,1,0] op_sel_hi:[1,1,1]
v_pk_fma_f32 v[234:235], v[82:83], v[56:57], v[234:235] op_sel:[0,1,0] op_sel_hi:[1,1,1]
v_pk_fma_f32 v[236:237], v[84:85], v[56:57], v[236:237] op_sel:[0,0,0] op_sel_hi:[1,0,1]
v_pk_fma_f32 v[238:239], v[86:87], v[56:57], v[238:239] op_sel:[0,0,0] op_sel_hi:[1,0,1]
v_pk_fma_f32 v[240:241], v[84:85], v[56:57], v[240:241] op_sel:[0,1,0] op_sel_hi:[1,1,1]
v_pk_fma_f32 v[242:243], v[86:87], v[56:57], v[242:243] op_sel:[0,1,0] op_sel_hi:[1,1,1]
v_pk_mul_f32 v[220:221], v[220:221], v[60:61]
v_pk_mul_f32 v[222:223], v[222:223], v[62:63]
v_pk_mul_f32 v[224:225], v[224:225], v[60:61]
s_cmp_lg_u32 s44, 0
s_cbranch_scc1 else_63
buffer_load_dwordx4 v[120:123], v58, s[32:35], 0 offen sc1
buffer_load_dwordx2 v[100:101], v59, s[32:35], 0 offen offset:1024 sc1
buffer_load_dwordx2 v[110:111], v59, s[32:35], 0 offen offset:1536 sc1
else_63:
v_pk_mul_f32 v[226:227], v[226:227], v[62:63]
v_pk_mul_f32 v[228:229], v[228:229], v[64:65]
v_pk_mul_f32 v[230:231], v[230:231], v[66:67]
v_pk_mul_f32 v[232:233], v[232:233], v[64:65]
v_pk_mul_f32 v[234:235], v[234:235], v[66:67]
v_pk_mul_f32 v[236:237], v[236:237], v[68:69]
v_pk_mul_f32 v[238:239], v[238:239], v[70:71]
v_pk_mul_f32 v[240:241], v[240:241], v[68:69]
v_pk_mul_f32 v[242:243], v[242:243], v[70:71]
v_max3_f32 v130, v172, v173, v174
v_max_f32_e64 v183, v218, v219
v_max3_f32 v131, v180, v181, v182
v_cvt_pk_bf16_f32 v102, v220, v221
v_cvt_pk_bf16_f32 v103, v222, v223
v_cvt_pk_bf16_f32 v112, v224, v225
v_cvt_pk_bf16_f32 v113, v226, v227
v_cvt_pk_bf16_f32 v104, v228, v229
v_cvt_pk_bf16_f32 v105, v230, v231
v_cvt_pk_bf16_f32 v114, v232, v233
v_cvt_pk_bf16_f32 v115, v234, v235
v_cvt_pk_bf16_f32 v106, v236, v237
v_cvt_pk_bf16_f32 v107, v238, v239
v_cvt_pk_bf16_f32 v116, v240, v241
v_cvt_pk_bf16_f32 v117, v242, v243
v_max_f32 v129, v129, v167
v_max_f32 v130, v130, v175
v_max_f32 v131, v131, v183
s_cmp_lg_u32 s44, 0
s_cbranch_scc1 else_65
s_mov_b32 s63, 0
sent_67:
s_waitcnt vmcnt(0)
v_max_u32 v4, v120, v121
v_max3_u32 v4, v4, v122, v123
v_max3_u32 v4, v4, v100, v101
v_max3_u32 v4, v4, v110, v111
v_cmp_eq_u32 vcc, -1, v4
s_cbranch_vccz sentd_68
buffer_load_dwordx4 v[120:123], v58, s[32:35], 0 offen sc1
buffer_load_dwordx2 v[100:101], v59, s[32:35], 0 offen offset:1024 sc1
buffer_load_dwordx2 v[110:111], v59, s[32:35], 0 offen offset:1536 sc1
s_add_u32 s63, s63, 1
s_cmp_lt_u32 s63, 0x80000
s_cbranch_scc1 sent_67
s_waitcnt vmcnt(0)
sentd_68:
v_mov_b32 v132, -1
v_mov_b32 v133, -1
v_mov_b32 v134, -1
v_mov_b32 v135, -1
buffer_store_dwordx4 v[132:135], v58, s[32:35], 0 offen offset:0 sc1
buffer_store_dwordx4 v[132:135], v58, s[32:35], 0 offen offset:1024 sc1
s_branch fi_66
else_65:
s_mov_b32 s63, 0
px_69:
ds_read_b32 v4, v19
ds_read_b128 v[120:123], v53
ds_read_b64 v[100:101], v55 offset:1024
ds_read_b64 v[110:111], v55 offset:1536
s_add_u32 s63, s63, 1
s_cmp_lt_u32 s63, 0x400000
s_waitcnt lgkmcnt(0)
v_cmp_ne_u32 vcc, 1, v4
s_cbranch_vccz pxd_70
s_cbranch_scc1 px_69
pxd_70:
fi_66:
s_cmp_eq_u32 s46, 0
s_cbranch_scc1 slow_71
.p2align 3
v_mfma_f32_16x16x32_bf16 v[160:163], v[120:123], v[156:159], v[44:47]
v_max_f32 v158, v192, v193
v_max_f32 v159, v194, v195
v_permlane32_swap_b32 v130, v131
s_nop 0
v_max_f32 v130, v130, v131
s_nop 2
v_max_f32 v156, v160, v161
v_max_f32 v157, v162, v163
v_max3_f32 v128, v156, v157, v158
v_max_f32 v128, v128, v159
s_nop 1
v_permlane32_swap_b32 v128, v129
s_nop 0
v_max_f32 v128, v128, v129
s_nop 1
v_permlane16_swap_b32 v128, v130
s_nop 0
v_max_f32 v128, v128, v130
v_mov_b32 v130, v128
s_nop 1
v_permlane16_swap_b32 v128, v130
s_nop 0
v_mov_b32 v129, v128
v_mov_b32 v131, v130
s_nop 0
v_permlane32_swap_b32 v128, v129
v_permlane32_swap_b32 v130, v131
v_mul_f32 v128, v128, v124
v_mul_f32 v129, v129, v125
v_pk_fma_f32 v[156:157], v[156:157], v[124:125], v[128:129] op_sel:[0,0,0] op_sel_hi:[1,0,0] neg_lo:[0,0,1] neg_hi:[0,0,1]
v_pk_fma_f32 v[158:159], v[158:159], v[124:125], v[128:129] op_sel:[0,0,0] op_sel_hi:[1,0,0] neg_lo:[0,0,1] neg_hi:[0,0,1]
v_mul_f32 v130, v130, v126
v_mul_f32 v131, v131, v127
v_exp_f32 v156, v156
v_exp_f32 v157, v157
v_exp_f32 v158, v158
v_exp_f32 v159, v159
v_pk_fma_f32 v[164:165], v[164:165], v[124:125], v[128:129] op_sel:[0,1,1] op_sel_hi:[1,1,1] neg_lo:[0,0,1] neg_hi:[0,0,1]
v_pk_fma_f32 v[166:167], v[166:167], v[124:125], v[128:129] op_sel:[0,1,1] op_sel_hi:[1,1,1] neg_lo:[0,0,1] neg_hi:[0,0,1]
v_exp_f32 v164, v164
v_exp_f32 v165, v165
v_exp_f32 v166, v166
v_exp_f32 v167, v167
v_pk_fma_f32 v[172:173], v[172:173], v[126:127], v[130:131] op_sel:[0,0,0] op_sel_hi:[1,0,0] neg_lo:[0,0,1] neg_hi:[0,0,1]
v_pk_fma_f32 v[174:175], v[174:175], v[126:127], v[130:131] op_sel:[0,0,0] op_sel_hi:[1,0,0] neg_lo:[0,0,1] neg_hi:[0,0,1]
v_cvt_pk_bf16_f32 v156, v156, v156
v_cvt_pk_bf16_f32 v157, v157, v157
v_cvt_pk_bf16_f32 v158, v158, v158
v_cvt_pk_bf16_f32 v159, v159, v159
v_exp_f32 v172, v172
v_exp_f32 v173, v173
v_exp_f32 v174, v174
v_exp_f32 v175, v175
v_pk_fma_f32 v[180:181], v[180:181], v[126:127], v[130:131] op_sel:[0,1,1] op_sel_hi:[1,1,1] neg_lo:[0,0,1] neg_hi:[0,0,1]
v_pk_fma_f32 v[182:183], v[182:183], v[126:127], v[130:131] op_sel:[0,1,1] op_sel_hi:[1,1,1] neg_lo:[0,0,1] neg_hi:[0,0,1]
v_and_b32 v156, v52, v156
v_and_b32 v157, v52, v157
v_and_b32 v158, v52, v158
v_and_b32 v159, v52, v159
v_cvt_pk_bf16_f32 v164, v164, v164
v_cvt_pk_bf16_f32 v165, v165, v165
v_mfma_f32_16x16x32_bf16 v[160:163], v[48:51], v[156:159], 0
v_cvt_pk_bf16_f32 v166, v166, v166
v_cvt_pk_bf16_f32 v167, v167, v167
v_mfma_f32_16x16x32_bf16 v[220:223], v[100:103], v[156:159], 0
v_exp_f32 v180, v180
v_mfma_f32_16x16x32_bf16 v[224:227], v[110:113], v[156:159], 0
v_exp_f32 v181, v181
v_exp_f32 v182, v182
v_exp_f32 v183, v183
v_and_b32 v164, v52, v164
v_and_b32 v165, v52, v165
v_and_b32 v166, v52, v166
v_and_b32 v167, v52, v167
v_cvt_pk_bf16_f32 v172, v172, v172
v_cvt_pk_bf16_f32 v173, v173, v173
v_mfma_f32_16x16x32_bf16 v[168:171], v[48:51], v[164:167], 0
v_cvt_pk_bf16_f32 v174, v174, v174
v_cvt_pk_bf16_f32 v175, v175, v175
v_mfma_f32_16x16x32_bf16 v[228:231], v[102:105], v[164:167], 0
v_and_b32 v172, v52, v172
v_and_b32 v173, v52, v173
v_mfma_f32_16x16x32_bf16 v[232:235], v[112:115], v[164:167], 0
v_and_b32 v174, v52, v174
v_and_b32 v175, v52, v175
v_cvt_pk_bf16_f32 v180, v180, v180
v_cvt_pk_bf16_f32 v181, v181, v181
v_mfma_f32_16x16x32_bf16 v[176:179], v[48:51], v[172:175], 0
v_cvt_pk_bf16_f32 v182, v182, v182
v_cvt_pk_bf16_f32 v183, v183, v183
v_mfma_f32_16x16x32_bf16 v[236:239], v[104:107], v[172:175], 0
v_and_b32 v180, v52, v180
v_and_b32 v181, v52, v181
v_mfma_f32_16x16x32_bf16 v[240:243], v[114:117], v[172:175], 0
v_and_b32 v182, v52, v182
v_and_b32 v183, v52, v183
v_rcp_f32 v160, v160
v_rcp_f32 v168, v168
v_pk_mul_f32 v[220:221], v[220:221], v[160:161] op_sel:[0,0] op_sel_hi:[1,0]
v_pk_mul_f32 v[222:223], v[222:223], v[160:161] op_sel:[0,0] op_sel_hi:[1,0]
v_pk_mul_f32 v[228:229], v[228:229], v[168:169] op_sel:[0,0] op_sel_hi:[1,0]
v_pk_mul_f32 v[224:225], v[224:225], v[160:161] op_sel:[0,0] op_sel_hi:[1,0]
v_pk_mul_f32 v[226:227], v[226:227], v[160:161] op_sel:[0,0] op_sel_hi:[1,0]
v_pk_mul_f32 v[230:231], v[230:231], v[168:169] op_sel:[0,0] op_sel_hi:[1,0]
v_pk_mul_f32 v[232:233], v[232:233], v[168:169] op_sel:[0,0] op_sel_hi:[1,0]
v_pk_mul_f32 v[234:235], v[234:235], v[168:169] op_sel:[0,0] op_sel_hi:[1,0]
v_mfma_f32_16x16x32_bf16 v[184:187], v[48:51], v[180:183], 0
v_rcp_f32_e64 v176, v176
v_cvt_pk_bf16_f32 v220, v220, v221
v_cvt_pk_bf16_f32 v221, v222, v223
v_cvt_pk_bf16_f32 v228, v228, v229
v_pk_mul_f32 v[236:237], v[236:237], v[176:177] op_sel:[0,0] op_sel_hi:[1,0]
v_mfma_f32_16x16x32_bf16 v[244:247], v[106:109], v[180:183], 0
v_cvt_pk_bf16_f32 v222, v224, v225
v_cvt_pk_bf16_f32 v223, v226, v227
v_rcp_f32_e64 v184, v184
v_cvt_pk_bf16_f32 v229, v230, v231
v_pk_mul_f32 v[238:239], v[238:239], v[176:177] op_sel:[0,0] op_sel_hi:[1,0]
v_pk_mul_f32 v[240:241], v[240:241], v[176:177] op_sel:[0,0] op_sel_hi:[1,0]
v_pk_mul_f32 v[242:243], v[242:243], v[176:177] op_sel:[0,0] op_sel_hi:[1,0]
v_cvt_pk_bf16_f32 v236, v236, v237
v_pk_mul_f32 v[244:245], v[244:245], v[184:185] op_sel:[0,0] op_sel_hi:[1,0]
v_pk_mul_f32 v[246:247], v[246:247], v[184:185] op_sel:[0,0] op_sel_hi:[1,0]
v_mfma_f32_16x16x32_bf16 v[248:251], v[116:119], v[180:183], 0
buffer_store_dwordx4 v[220:223], v18, s[32:35], s80 offen sc1
v_cvt_pk_bf16_f32 v230, v232, v233
v_cvt_pk_bf16_f32 v231, v234, v235
v_cvt_pk_bf16_f32 v237, v238, v239
v_cvt_pk_bf16_f32 v244, v244, v245
buffer_store_dwordx4 v[228:231], v18, s[32:35], s81 offen sc1
v_cvt_pk_bf16_f32 v238, v240, v241
v_cvt_pk_bf16_f32 v239, v242, v243
v_pk_mul_f32 v[248:249], v[248:249], v[184:185] op_sel:[0,0] op_sel_hi:[1,0]
v_pk_mul_f32 v[250:251], v[250:251], v[184:185] op_sel:[0,0] op_sel_hi:[1,0]
v_cvt_pk_bf16_f32 v245, v246, v247
buffer_store_dwordx4 v[236:239], v18, s[32:35], s82 offen sc1
v_cvt_pk_bf16_f32 v246, v248, v249
v_cvt_pk_bf16_f32 v247, v250, v251
buffer_store_dwordx4 v[244:247], v18, s[32:35], s83 offen sc1
back_72:
s_barrier
v_and_b32 v36, 31, v0
v_lshlrev_b32 v36, 2, v36
s_lshl_b32 s62, s45, 2
v_mov_b32 v4, s62
v_mov_b32 v5, 1
s_mov_b64 exec, 1
s_waitcnt vmcnt(0)
s_cmp_eq_u32 s46, 0
s_cbranch_scc1 slow_73
buffer_store_dword v5, v4, s[32:35], s84 offen
back_74:
s_mov_b64 exec, -1
v_lshrrev_b32 v4, 2, v2
v_and_b32 v5, 3, v0
v_lshl_add_u32 v6, v3, 3, v4
v_lshlrev_b32 v6, 7, v6
v_lshl_add_u32 v6, v5, 3, v6
v_lshrrev_b32 v7, 1, v4
v_and_b32 v8, 1, v3
v_lshl_add_u32 v7, v8, 1, v7
v_lshl_add_u32 v10, v7, 5, v6
v_xor_b32 v11, 32, v10
v_xor_b32 v12, 64, v10
v_xor_b32 v13, 96, v10
v_add_u32 v14, 0x10000, v10
v_add_u32 v15, 0x10000, v11
v_add_u32 v16, 0x10000, v12
v_add_u32 v17, 0x10000, v13
ds_read_b64_tr_b16 v[220:221], v10 offset:0
ds_read_b64_tr_b16 v[222:223], v10 offset:512
ds_read_b64_tr_b16 v[224:225], v11 offset:0
ds_read_b64_tr_b16 v[226:227], v11 offset:512
ds_read_b64_tr_b16 v[228:229], v12 offset:0
ds_read_b64_tr_b16 v[230:231], v12 offset:512
ds_read_b64_tr_b16 v[232:233], v13 offset:0
ds_read_b64_tr_b16 v[234:235], v13 offset:512
ds_read_b64_tr_b16 v[236:237], v10 offset:4096
ds_read_b64_tr_b16 v[238:239], v10 offset:4608
ds_read_b64_tr_b16 v[240:241], v11 offset:4096
ds_read_b64_tr_b16 v[242:243], v11 offset:4608
ds_read_b64_tr_b16 v[244:245], v12 offset:4096
ds_read_b64_tr_b16 v[246:247], v12 offset:4608
ds_read_b64_tr_b16 v[248:249], v13 offset:4096
ds_read_b64_tr_b16 v[250:251], v13 offset:4608
s_lshl_b32 s48, s41, 3
s_lshl_b32 s49, s40, 1
s_add_u32 s48, s48, s49
s_lshl_b32 s48, s48, 15
s_add_u32 s48, s48, 4194304
v_add_u32 v38, s48, v18
v_add_u32 v39, 32768, v38
s_lshl_b32 s57, s75, 11
s_add_u32 s87, s87, 262144
v_lshlrev_b32 v60, 16, v20
v_and_b32 v61, 0xffff0000, v20
v_lshlrev_b32 v62, 16, v21
v_and_b32 v63, 0xffff0000, v21
v_lshlrev_b32 v64, 16, v22
v_and_b32 v65, 0xffff0000, v22
v_lshlrev_b32 v66, 16, v23
v_and_b32 v67, 0xffff0000, v23
v_lshlrev_b32 v68, 16, v24
v_and_b32 v69, 0xffff0000, v24
v_lshlrev_b32 v70, 16, v25
v_and_b32 v71, 0xffff0000, v25
v_lshlrev_b32 v72, 16, v26
v_and_b32 v73, 0xffff0000, v26
v_lshlrev_b32 v74, 16, v27
v_and_b32 v75, 0xffff0000, v27
v_lshlrev_b32 v76, 16, v28
v_and_b32 v77, 0xffff0000, v28
v_lshlrev_b32 v78, 16, v29
v_and_b32 v79, 0xffff0000, v29
v_lshlrev_b32 v80, 16, v30
v_and_b32 v81, 0xffff0000, v30
v_lshlrev_b32 v82, 16, v31
v_and_b32 v83, 0xffff0000, v31
v_lshlrev_b32 v84, 16, v32
v_and_b32 v85, 0xffff0000, v32
v_lshlrev_b32 v86, 16, v33
v_and_b32 v87, 0xffff0000, v33
v_lshlrev_b32 v88, 16, v34
v_and_b32 v89, 0xffff0000, v34
v_lshlrev_b32 v90, 16, v35
v_and_b32 v91, 0xffff0000, v35
v_mov_b32 v6, 0
v_mov_b32 v7, 0
v_mov_b32 v8, 0
v_mov_b32 v9, 0
s_lshl_b32 s62, s42, 2
v_mov_b32 v4, s62
v_mov_b32 v5, 1
buffer_load_dword v37, v36, s[32:35], s84 offen sc1
s_mov_b32 s63, 0
s_waitcnt vmcnt(0)
poll_75:
v_cmp_gt_u32 vcc, 1, v37
s_cbranch_vccz polled_76
buffer_load_dword v37, v36, s[32:35], s84 offen sc1
s_add_u32 s63, s63, 1
s_cmp_lt_u32 s63, 0x80000
s_waitcnt vmcnt(0)
s_cbranch_scc1 poll_75
polled_76:
s_getpc_b64 s[94:95]
pc_77:
s_add_u32 s94, s94, R_oloop_end - pc_77
s_addc_u32 s95, s95, 0
R_oloop:
buffer_load_dwordx4 v[156:159], v38, s[32:35], s57 offen sc1
buffer_load_dwordx4 v[160:163], v39, s[32:35], s57 offen sc1
buffer_load_dwordx4 v[164:167], v38, s[32:35], s57 offen offset:1024 sc1
buffer_load_dwordx4 v[168:171], v39, s[32:35], s57 offen offset:1024 sc1
s_add_u32 s57, s57, 2048
s_and_b32 s57, s57, 0x7fff
buffer_load_dwordx4 v[172:175], v38, s[32:35], s57 offen sc1
buffer_load_dwordx4 v[176:179], v39, s[32:35], s57 offen sc1
buffer_load_dwordx4 v[180:183], v38, s[32:35], s57 offen offset:1024 sc1
buffer_load_dwordx4 v[184:187], v39, s[32:35], s57 offen offset:1024 sc1
s_add_u32 s57, s57, 2048
s_and_b32 s57, s57, 0x7fff
buffer_load_dwordx4 v[188:191], v38, s[32:35], s57 offen sc1
buffer_load_dwordx4 v[192:195], v39, s[32:35], s57 offen sc1
s_waitcnt vmcnt(8) lgkmcnt(8)
v_mfma_f32_16x16x32_bf16 v[60:63], v[220:223], v[156:159], v[60:63]
buffer_load_dwordx4 v[196:199], v38, s[32:35], s57 offen offset:1024 sc1
v_mfma_f32_16x16x32_bf16 v[76:79], v[220:223], v[160:163], v[76:79]
ds_read_b64_tr_b16 v[100:101], v10 offset:8192
ds_read_b64_tr_b16 v[102:103], v10 offset:8704
v_mfma_f32_16x16x32_bf16 v[80:83], v[224:227], v[160:163], v[80:83]
ds_read_b64_tr_b16 v[104:105], v11 offset:8192
ds_read_b64_tr_b16 v[106:107], v11 offset:8704
v_mfma_f32_16x16x32_bf16 v[64:67], v[224:227], v[156:159], v[64:67]
buffer_load_dwordx4 v[200:203], v39, s[32:35], s57 offen offset:1024 sc1
v_mfma_f32_16x16x32_bf16 v[68:71], v[228:231], v[156:159], v[68:71]
ds_read_b64_tr_b16 v[108:109], v12 offset:8192
ds_read_b64_tr_b16 v[110:111], v12 offset:8704
v_mfma_f32_16x16x32_bf16 v[84:87], v[228:231], v[160:163], v[84:87]
ds_read_b64_tr_b16 v[112:113], v13 offset:8192
ds_read_b64_tr_b16 v[114:115], v13 offset:8704
v_mfma_f32_16x16x32_bf16 v[88:91], v[232:235], v[160:163], v[88:91]
s_add_u32 s57, s57, 2048
s_and_b32 s57, s57, 0x7fff
v_mfma_f32_16x16x32_bf16 v[72:75], v[232:235], v[156:159], v[72:75]
s_waitcnt vmcnt(8) lgkmcnt(8)
v_mfma_f32_16x16x32_bf16 v[60:63], v[236:239], v[164:167], v[60:63]
buffer_load_dwordx4 v[204:207], v38, s[32:35], s57 offen sc1
v_mfma_f32_16x16x32_bf16 v[76:79], v[236:239], v[168:171], v[76:79]
ds_read_b64_tr_b16 v[220:221], v10 offset:12288
ds_read_b64_tr_b16 v[222:223], v10 offset:12800
v_mfma_f32_16x16x32_bf16 v[80:83], v[240:243], v[168:171], v[80:83]
ds_read_b64_tr_b16 v[224:225], v11 offset:12288
ds_read_b64_tr_b16 v[226:227], v11 offset:12800
v_mfma_f32_16x16x32_bf16 v[64:67], v[240:243], v[164:167], v[64:67]
buffer_load_dwordx4 v[208:211], v39, s[32:35], s57 offen sc1
v_mfma_f32_16x16x32_bf16 v[68:71], v[244:247], v[164:167], v[68:71]
ds_read_b64_tr_b16 v[228:229], v12 offset:12288
ds_read_b64_tr_b16 v[230:231], v12 offset:12800
v_mfma_f32_16x16x32_bf16 v[84:87], v[244:247], v[168:171], v[84:87]
ds_read_b64_tr_b16 v[232:233], v13 offset:12288
ds_read_b64_tr_b16 v[234:235], v13 offset:12800
v_mfma_f32_16x16x32_bf16 v[88:91], v[248:251], v[168:171], v[88:91]
v_mfma_f32_16x16x32_bf16 v[72:75], v[248:251], v[164:167], v[72:75]
s_waitcnt vmcnt(8) lgkmcnt(8)
v_mfma_f32_16x16x32_bf16 v[60:63], v[100:103], v[172:175], v[60:63]
buffer_load_dwordx4 v[212:215], v38, s[32:35], s57 offen offset:1024 sc1
v_mfma_f32_16x16x32_bf16 v[76:79], v[100:103], v[176:179], v[76:79]
ds_read_b64_tr_b16 v[236:237], v10 offset:16384
ds_read_b64_tr_b16 v[238:239], v10 offset:16896
v_mfma_f32_16x16x32_bf16 v[80:83], v[104:107], v[176:179], v[80:83]
ds_read_b64_tr_b16 v[240:241], v11 offset:16384
ds_read_b64_tr_b16 v[242:243], v11 offset:16896
v_mfma_f32_16x16x32_bf16 v[64:67], v[104:107], v[172:175], v[64:67]
buffer_load_dwordx4 v[216:219], v39, s[32:35], s57 offen offset:1024 sc1
v_mfma_f32_16x16x32_bf16 v[68:71], v[108:111], v[172:175], v[68:71]
ds_read_b64_tr_b16 v[244:245], v12 offset:16384
ds_read_b64_tr_b16 v[246:247], v12 offset:16896
v_mfma_f32_16x16x32_bf16 v[84:87], v[108:111], v[176:179], v[84:87]
ds_read_b64_tr_b16 v[248:249], v13 offset:16384
ds_read_b64_tr_b16 v[250:251], v13 offset:16896
v_mfma_f32_16x16x32_bf16 v[88:91], v[112:115], v[176:179], v[88:91]
s_add_u32 s57, s57, 2048
s_and_b32 s57, s57, 0x7fff
v_mfma_f32_16x16x32_bf16 v[72:75], v[112:115], v[172:175], v[72:75]
s_waitcnt vmcnt(8) lgkmcnt(8)
v_mfma_f32_16x16x32_bf16 v[60:63], v[220:223], v[180:183], v[60:63]
buffer_load_dwordx4 v[156:159], v38, s[32:35], s57 offen sc1
v_mfma_f32_16x16x32_bf16 v[76:79], v[220:223], v[184:187], v[76:79]
ds_read_b64_tr_b16 v[100:101], v10 offset:20480
ds_read_b64_tr_b16 v[102:103], v10 offset:20992
v_mfma_f32_16x16x32_bf16 v[80:83], v[224:227], v[184:187], v[80:83]
ds_read_b64_tr_b16 v[104:105], v11 offset:20480
ds_read_b64_tr_b16 v[106:107], v11 offset:20992
v_mfma_f32_16x16x32_bf16 v[64:67], v[224:227], v[180:183], v[64:67]
buffer_load_dwordx4 v[160:163], v39, s[32:35], s57 offen sc1
v_mfma_f32_16x16x32_bf16 v[68:71], v[228:231], v[180:183], v[68:71]
ds_read_b64_tr_b16 v[108:109], v12 offset:20480
ds_read_b64_tr_b16 v[110:111], v12 offset:20992
v_mfma_f32_16x16x32_bf16 v[84:87], v[228:231], v[184:187], v[84:87]
ds_read_b64_tr_b16 v[112:113], v13 offset:20480
ds_read_b64_tr_b16 v[114:115], v13 offset:20992
v_mfma_f32_16x16x32_bf16 v[88:91], v[232:235], v[184:187], v[88:91]
v_mfma_f32_16x16x32_bf16 v[72:75], v[232:235], v[180:183], v[72:75]
s_waitcnt vmcnt(8) lgkmcnt(8)
v_mfma_f32_16x16x32_bf16 v[60:63], v[236:239], v[188:191], v[60:63]
buffer_load_dwordx4 v[164:167], v38, s[32:35], s57 offen offset:1024 sc1
v_mfma_f32_16x16x32_bf16 v[76:79], v[236:239], v[192:195], v[76:79]
ds_read_b64_tr_b16 v[220:221], v10 offset:24576
ds_read_b64_tr_b16 v[222:223], v10 offset:25088
v_mfma_f32_16x16x32_bf16 v[80:83], v[240:243], v[192:195], v[80:83]
ds_read_b64_tr_b16 v[224:225], v11 offset:24576
ds_read_b64_tr_b16 v[226:227], v11 offset:25088
v_mfma_f32_16x16x32_bf16 v[64:67], v[240:243], v[188:191], v[64:67]
buffer_load_dwordx4 v[168:171], v39, s[32:35], s57 offen offset:1024 sc1
v_mfma_f32_16x16x32_bf16 v[68:71], v[244:247], v[188:191], v[68:71]
ds_read_b64_tr_b16 v[228:229], v12 offset:24576
ds_read_b64_tr_b16 v[230:231], v12 offset:25088
v_mfma_f32_16x16x32_bf16 v[84:87], v[244:247], v[192:195], v[84:87]
ds_read_b64_tr_b16 v[232:233], v13 offset:24576
ds_read_b64_tr_b16 v[234:235], v13 offset:25088
v_mfma_f32_16x16x32_bf16 v[88:91], v[248:251], v[192:195], v[88:91]
s_add_u32 s57, s57, 2048
s_and_b32 s57, s57, 0x7fff
v_mfma_f32_16x16x32_bf16 v[72:75], v[248:251], v[188:191], v[72:75]
s_waitcnt vmcnt(8) lgkmcnt(8)
v_mfma_f32_16x16x32_bf16 v[60:63], v[100:103], v[196:199], v[60:63]
buffer_load_dwordx4 v[172:175], v38, s[32:35], s57 offen sc1
v_mfma_f32_16x16x32_bf16 v[76:79], v[100:103], v[200:203], v[76:79]
ds_read_b64_tr_b16 v[236:237], v10 offset:28672
ds_read_b64_tr_b16 v[238:239], v10 offset:29184
v_mfma_f32_16x16x32_bf16 v[80:83], v[104:107], v[200:203], v[80:83]
ds_read_b64_tr_b16 v[240:241], v11 offset:28672
ds_read_b64_tr_b16 v[242:243], v11 offset:29184
v_mfma_f32_16x16x32_bf16 v[64:67], v[104:107], v[196:199], v[64:67]
buffer_load_dwordx4 v[176:179], v39, s[32:35], s57 offen sc1
v_mfma_f32_16x16x32_bf16 v[68:71], v[108:111], v[196:199], v[68:71]
ds_read_b64_tr_b16 v[244:245], v12 offset:28672
ds_read_b64_tr_b16 v[246:247], v12 offset:29184
v_mfma_f32_16x16x32_bf16 v[84:87], v[108:111], v[200:203], v[84:87]
ds_read_b64_tr_b16 v[248:249], v13 offset:28672
ds_read_b64_tr_b16 v[250:251], v13 offset:29184
v_mfma_f32_16x16x32_bf16 v[88:91], v[112:115], v[200:203], v[88:91]
v_mfma_f32_16x16x32_bf16 v[72:75], v[112:115], v[196:199], v[72:75]
s_waitcnt vmcnt(8) lgkmcnt(8)
v_mfma_f32_16x16x32_bf16 v[60:63], v[220:223], v[204:207], v[60:63]
buffer_load_dwordx4 v[180:183], v38, s[32:35], s57 offen offset:1024 sc1
v_mfma_f32_16x16x32_bf16 v[76:79], v[220:223], v[208:211], v[76:79]
ds_read_b64_tr_b16 v[100:101], v10 offset:32768
ds_read_b64_tr_b16 v[102:103], v10 offset:33280
v_mfma_f32_16x16x32_bf16 v[80:83], v[224:227], v[208:211], v[80:83]
ds_read_b64_tr_b16 v[104:105], v11 offset:32768
ds_read_b64_tr_b16 v[106:107], v11 offset:33280
v_mfma_f32_16x16x32_bf16 v[64:67], v[224:227], v[204:207], v[64:67]
buffer_load_dwordx4 v[184:187], v39, s[32:35], s57 offen offset:1024 sc1
v_mfma_f32_16x16x32_bf16 v[68:71], v[228:231], v[204:207], v[68:71]
ds_read_b64_tr_b16 v[108:109], v12 offset:32768
ds_read_b64_tr_b16 v[110:111], v12 offset:33280
v_mfma_f32_16x16x32_bf16 v[84:87], v[228:231], v[208:211], v[84:87]
ds_read_b64_tr_b16 v[112:113], v13 offset:32768
ds_read_b64_tr_b16 v[114:115], v13 offset:33280
v_mfma_f32_16x16x32_bf16 v[88:91], v[232:235], v[208:211], v[88:91]
s_add_u32 s57, s57, 2048
s_and_b32 s57, s57, 0x7fff
v_mfma_f32_16x16x32_bf16 v[72:75], v[232:235], v[204:207], v[72:75]
s_waitcnt vmcnt(8) lgkmcnt(8)
v_mfma_f32_16x16x32_bf16 v[60:63], v[236:239], v[212:215], v[60:63]
buffer_load_dwordx4 v[188:191], v38, s[32:35], s57 offen sc1
v_mfma_f32_16x16x32_bf16 v[76:79], v[236:239], v[216:219], v[76:79]
ds_read_b64_tr_b16 v[220:221], v10 offset:36864
ds_read_b64_tr_b16 v[222:223], v10 offset:37376
v_mfma_f32_16x16x32_bf16 v[80:83], v[240:243], v[216:219], v[80:83]
ds_read_b64_tr_b16 v[224:225], v11 offset:36864
ds_read_b64_tr_b16 v[226:227], v11 offset:37376
v_mfma_f32_16x16x32_bf16 v[64:67], v[240:243], v[212:215], v[64:67]
buffer_load_dwordx4 v[192:195], v39, s[32:35], s57 offen sc1
v_mfma_f32_16x16x32_bf16 v[68:71], v[244:247], v[212:215], v[68:71]
ds_read_b64_tr_b16 v[228:229], v12 offset:36864
ds_read_b64_tr_b16 v[230:231], v12 offset:37376
v_mfma_f32_16x16x32_bf16 v[84:87], v[244:247], v[216:219], v[84:87]
ds_read_b64_tr_b16 v[232:233], v13 offset:36864
ds_read_b64_tr_b16 v[234:235], v13 offset:37376
v_mfma_f32_16x16x32_bf16 v[88:91], v[248:251], v[216:219], v[88:91]
v_mfma_f32_16x16x32_bf16 v[72:75], v[248:251], v[212:215], v[72:75]
s_waitcnt vmcnt(8) lgkmcnt(8)
v_mfma_f32_16x16x32_bf16 v[60:63], v[100:103], v[156:159], v[60:63]
buffer_load_dwordx4 v[196:199], v38, s[32:35], s57 offen offset:1024 sc1
v_mfma_f32_16x16x32_bf16 v[76:79], v[100:103], v[160:163], v[76:79]
ds_read_b64_tr_b16 v[236:237], v10 offset:40960
ds_read_b64_tr_b16 v[238:239], v10 offset:41472
v_mfma_f32_16x16x32_bf16 v[80:83], v[104:107], v[160:163], v[80:83]
ds_read_b64_tr_b16 v[240:241], v11 offset:40960
ds_read_b64_tr_b16 v[242:243], v11 offset:41472
v_mfma_f32_16x16x32_bf16 v[64:67], v[104:107], v[156:159], v[64:67]
buffer_load_dwordx4 v[200:203], v39, s[32:35], s57 offen offset:1024 sc1
v_mfma_f32_16x16x32_bf16 v[68:71], v[108:111], v[156:159], v[68:71]
ds_read_b64_tr_b16 v[244:245], v12 offset:40960
ds_read_b64_tr_b16 v[246:247], v12 offset:41472
v_mfma_f32_16x16x32_bf16 v[84:87], v[108:111], v[160:163], v[84:87]
ds_read_b64_tr_b16 v[248:249], v13 offset:40960
ds_read_b64_tr_b16 v[250:251], v13 offset:41472
v_mfma_f32_16x16x32_bf16 v[88:91], v[112:115], v[160:163], v[88:91]
s_add_u32 s57, s57, 2048
s_and_b32 s57, s57, 0x7fff
v_mfma_f32_16x16x32_bf16 v[72:75], v[112:115], v[156:159], v[72:75]
s_waitcnt vmcnt(8) lgkmcnt(8)
v_mfma_f32_16x16x32_bf16 v[60:63], v[220:223], v[164:167], v[60:63]
buffer_load_dwordx4 v[204:207], v38, s[32:35], s57 offen sc1
v_mfma_f32_16x16x32_bf16 v[76:79], v[220:223], v[168:171], v[76:79]
ds_read_b64_tr_b16 v[100:101], v10 offset:45056
ds_read_b64_tr_b16 v[102:103], v10 offset:45568
v_mfma_f32_16x16x32_bf16 v[80:83], v[224:227], v[168:171], v[80:83]
ds_read_b64_tr_b16 v[104:105], v11 offset:45056
ds_read_b64_tr_b16 v[106:107], v11 offset:45568
v_mfma_f32_16x16x32_bf16 v[64:67], v[224:227], v[164:167], v[64:67]
buffer_load_dwordx4 v[208:211], v39, s[32:35], s57 offen sc1
v_mfma_f32_16x16x32_bf16 v[68:71], v[228:231], v[164:167], v[68:71]
ds_read_b64_tr_b16 v[108:109], v12 offset:45056
ds_read_b64_tr_b16 v[110:111], v12 offset:45568
v_mfma_f32_16x16x32_bf16 v[84:87], v[228:231], v[168:171], v[84:87]
ds_read_b64_tr_b16 v[112:113], v13 offset:45056
ds_read_b64_tr_b16 v[114:115], v13 offset:45568
v_mfma_f32_16x16x32_bf16 v[88:91], v[232:235], v[168:171], v[88:91]
v_mfma_f32_16x16x32_bf16 v[72:75], v[232:235], v[164:167], v[72:75]
s_waitcnt vmcnt(8) lgkmcnt(8)
v_mfma_f32_16x16x32_bf16 v[60:63], v[236:239], v[172:175], v[60:63]
buffer_load_dwordx4 v[212:215], v38, s[32:35], s57 offen offset:1024 sc1
v_mfma_f32_16x16x32_bf16 v[76:79], v[236:239], v[176:179], v[76:79]
ds_read_b64_tr_b16 v[220:221], v10 offset:49152
ds_read_b64_tr_b16 v[222:223], v10 offset:49664
v_mfma_f32_16x16x32_bf16 v[80:83], v[240:243], v[176:179], v[80:83]
ds_read_b64_tr_b16 v[224:225], v11 offset:49152
ds_read_b64_tr_b16 v[226:227], v11 offset:49664
v_mfma_f32_16x16x32_bf16 v[64:67], v[240:243], v[172:175], v[64:67]
buffer_load_dwordx4 v[216:219], v39, s[32:35], s57 offen offset:1024 sc1
v_mfma_f32_16x16x32_bf16 v[68:71], v[244:247], v[172:175], v[68:71]
ds_read_b64_tr_b16 v[228:229], v12 offset:49152
ds_read_b64_tr_b16 v[230:231], v12 offset:49664
v_mfma_f32_16x16x32_bf16 v[84:87], v[244:247], v[176:179], v[84:87]
ds_read_b64_tr_b16 v[232:233], v13 offset:49152
ds_read_b64_tr_b16 v[234:235], v13 offset:49664
v_mfma_f32_16x16x32_bf16 v[88:91], v[248:251], v[176:179], v[88:91]
s_add_u32 s57, s57, 2048
s_and_b32 s57, s57, 0x7fff
v_mfma_f32_16x16x32_bf16 v[72:75], v[248:251], v[172:175], v[72:75]
s_waitcnt vmcnt(8) lgkmcnt(8)
v_mfma_f32_16x16x32_bf16 v[60:63], v[100:103], v[180:183], v[60:63]
buffer_load_dwordx4 v[156:159], v38, s[32:35], s57 offen sc1
v_mfma_f32_16x16x32_bf16 v[76:79], v[100:103], v[184:187], v[76:79]
ds_read_b64_tr_b16 v[236:237], v10 offset:53248
ds_read_b64_tr_b16 v[238:239], v10 offset:53760
v_mfma_f32_16x16x32_bf16 v[80:83], v[104:107], v[184:187], v[80:83]
ds_read_b64_tr_b16 v[240:241], v11 offset:53248
ds_read_b64_tr_b16 v[242:243], v11 offset:53760
v_mfma_f32_16x16x32_bf16 v[64:67], v[104:107], v[180:183], v[64:67]
buffer_load_dwordx4 v[160:163], v39, s[32:35], s57 offen sc1
v_mfma_f32_16x16x32_bf16 v[68:71], v[108:111], v[180:183], v[68:71]
ds_read_b64_tr_b16 v[244:245], v12 offset:53248
ds_read_b64_tr_b16 v[246:247], v12 offset:53760
v_mfma_f32_16x16x32_bf16 v[84:87], v[108:111], v[184:187], v[84:87]
ds_read_b64_tr_b16 v[248:249], v13 offset:53248
ds_read_b64_tr_b16 v[250:251], v13 offset:53760
v_mfma_f32_16x16x32_bf16 v[88:91], v[112:115], v[184:187], v[88:91]
v_mfma_f32_16x16x32_bf16 v[72:75], v[112:115], v[180:183], v[72:75]
s_waitcnt vmcnt(8) lgkmcnt(8)
v_mfma_f32_16x16x32_bf16 v[60:63], v[220:223], v[188:191], v[60:63]
buffer_load_dwordx4 v[164:167], v38, s[32:35], s57 offen offset:1024 sc1
v_mfma_f32_16x16x32_bf16 v[76:79], v[220:223], v[192:195], v[76:79]
ds_read_b64_tr_b16 v[100:101], v10 offset:57344
ds_read_b64_tr_b16 v[102:103], v10 offset:57856
v_mfma_f32_16x16x32_bf16 v[80:83], v[224:227], v[192:195], v[80:83]
ds_read_b64_tr_b16 v[104:105], v11 offset:57344
ds_read_b64_tr_b16 v[106:107], v11 offset:57856
v_mfma_f32_16x16x32_bf16 v[64:67], v[224:227], v[188:191], v[64:67]
buffer_load_dwordx4 v[168:171], v39, s[32:35], s57 offen offset:1024 sc1
v_mfma_f32_16x16x32_bf16 v[68:71], v[228:231], v[188:191], v[68:71]
ds_read_b64_tr_b16 v[108:109], v12 offset:57344
ds_read_b64_tr_b16 v[110:111], v12 offset:57856
v_mfma_f32_16x16x32_bf16 v[84:87], v[228:231], v[192:195], v[84:87]
ds_read_b64_tr_b16 v[112:113], v13 offset:57344
ds_read_b64_tr_b16 v[114:115], v13 offset:57856
v_mfma_f32_16x16x32_bf16 v[88:91], v[232:235], v[192:195], v[88:91]
s_add_u32 s57, s57, 2048
s_and_b32 s57, s57, 0x7fff
v_mfma_f32_16x16x32_bf16 v[72:75], v[232:235], v[188:191], v[72:75]
s_waitcnt vmcnt(8) lgkmcnt(8)
v_mfma_f32_16x16x32_bf16 v[60:63], v[236:239], v[196:199], v[60:63]
buffer_load_dwordx4 v[172:175], v38, s[32:35], s57 offen sc1
v_mfma_f32_16x16x32_bf16 v[76:79], v[236:239], v[200:203], v[76:79]
ds_read_b64_tr_b16 v[220:221], v10 offset:61440
ds_read_b64_tr_b16 v[222:223], v10 offset:61952
v_mfma_f32_16x16x32_bf16 v[80:83], v[240:243], v[200:203], v[80:83]
ds_read_b64_tr_b16 v[224:225], v11 offset:61440
ds_read_b64_tr_b16 v[226:227], v11 offset:61952
v_mfma_f32_16x16x32_bf16 v[64:67], v[240:243], v[196:199], v[64:67]
buffer_load_dwordx4 v[176:179], v39, s[32:35], s57 offen sc1
v_mfma_f32_16x16x32_bf16 v[68:71], v[244:247], v[196:199], v[68:71]
ds_read_b64_tr_b16 v[228:229], v12 offset:61440
ds_read_b64_tr_b16 v[230:231], v12 offset:61952
v_mfma_f32_16x16x32_bf16 v[84:87], v[244:247], v[200:203], v[84:87]
ds_read_b64_tr_b16 v[232:233], v13 offset:61440
ds_read_b64_tr_b16 v[234:235], v13 offset:61952
v_mfma_f32_16x16x32_bf16 v[88:91], v[248:251], v[200:203], v[88:91]
v_mfma_f32_16x16x32_bf16 v[72:75], v[248:251], v[196:199], v[72:75]
s_waitcnt vmcnt(8) lgkmcnt(8)
v_mfma_f32_16x16x32_bf16 v[60:63], v[100:103], v[204:207], v[60:63]
buffer_load_dwordx4 v[180:183], v38, s[32:35], s57 offen offset:1024 sc1
v_mfma_f32_16x16x32_bf16 v[76:79], v[100:103], v[208:211], v[76:79]
ds_read_b64_tr_b16 v[236:237], v14 offset:0
ds_read_b64_tr_b16 v[238:239], v14 offset:512
v_mfma_f32_16x16x32_bf16 v[80:83], v[104:107], v[208:211], v[80:83]
ds_read_b64_tr_b16 v[240:241], v15 offset:0
ds_read_b64_tr_b16 v[242:243], v15 offset:512
v_mfma_f32_16x16x32_bf16 v[64:67], v[104:107], v[204:207], v[64:67]
buffer_load_dwordx4 v[184:187], v39, s[32:35], s57 offen offset:1024 sc1
v_mfma_f32_16x16x32_bf16 v[68:71], v[108:111], v[204:207], v[68:71]
ds_read_b64_tr_b16 v[244:245], v16 offset:0
ds_read_b64_tr_b16 v[246:247], v16 offset:512
v_mfma_f32_16x16x32_bf16 v[84:87], v[108:111], v[208:211], v[84:87]
ds_read_b64_tr_b16 v[248:249], v17 offset:0
ds_read_b64_tr_b16 v[250:251], v17 offset:512
v_mfma_f32_16x16x32_bf16 v[88:91], v[112:115], v[208:211], v[88:91]
s_add_u32 s57, s57, 2048
s_and_b32 s57, s57, 0x7fff
v_mfma_f32_16x16x32_bf16 v[72:75], v[112:115], v[204:207], v[72:75]
s_waitcnt vmcnt(8) lgkmcnt(8)
v_mfma_f32_16x16x32_bf16 v[60:63], v[220:223], v[212:215], v[60:63]
buffer_load_dwordx4 v[188:191], v38, s[32:35], s57 offen sc1
v_mfma_f32_16x16x32_bf16 v[76:79], v[220:223], v[216:219], v[76:79]
ds_read_b64_tr_b16 v[100:101], v14 offset:4096
ds_read_b64_tr_b16 v[102:103], v14 offset:4608
v_mfma_f32_16x16x32_bf16 v[80:83], v[224:227], v[216:219], v[80:83]
ds_read_b64_tr_b16 v[104:105], v15 offset:4096
ds_read_b64_tr_b16 v[106:107], v15 offset:4608
v_mfma_f32_16x16x32_bf16 v[64:67], v[224:227], v[212:215], v[64:67]
buffer_load_dwordx4 v[192:195], v39, s[32:35], s57 offen sc1
v_mfma_f32_16x16x32_bf16 v[68:71], v[228:231], v[212:215], v[68:71]
ds_read_b64_tr_b16 v[108:109], v16 offset:4096
ds_read_b64_tr_b16 v[110:111], v16 offset:4608
v_mfma_f32_16x16x32_bf16 v[84:87], v[228:231], v[216:219], v[84:87]
ds_read_b64_tr_b16 v[112:113], v17 offset:4096
ds_read_b64_tr_b16 v[114:115], v17 offset:4608
v_mfma_f32_16x16x32_bf16 v[88:91], v[232:235], v[216:219], v[88:91]
v_mfma_f32_16x16x32_bf16 v[72:75], v[232:235], v[212:215], v[72:75]
s_waitcnt vmcnt(8) lgkmcnt(8)
v_mfma_f32_16x16x32_bf16 v[60:63], v[236:239], v[156:159], v[60:63]
buffer_load_dwordx4 v[196:199], v38, s[32:35], s57 offen offset:1024 sc1
v_mfma_f32_16x16x32_bf16 v[76:79], v[236:239], v[160:163], v[76:79]
ds_read_b64_tr_b16 v[220:221], v14 offset:8192
ds_read_b64_tr_b16 v[222:223], v14 offset:8704
v_mfma_f32_16x16x32_bf16 v[80:83], v[240:243], v[160:163], v[80:83]
ds_read_b64_tr_b16 v[224:225], v15 offset:8192
ds_read_b64_tr_b16 v[226:227], v15 offset:8704
v_mfma_f32_16x16x32_bf16 v[64:67], v[240:243], v[156:159], v[64:67]
buffer_load_dwordx4 v[200:203], v39, s[32:35], s57 offen offset:1024 sc1
v_mfma_f32_16x16x32_bf16 v[68:71], v[244:247], v[156:159], v[68:71]
ds_read_b64_tr_b16 v[228:229], v16 offset:8192
ds_read_b64_tr_b16 v[230:231], v16 offset:8704
v_mfma_f32_16x16x32_bf16 v[84:87], v[244:247], v[160:163], v[84:87]
ds_read_b64_tr_b16 v[232:233], v17 offset:8192
ds_read_b64_tr_b16 v[234:235], v17 offset:8704
v_mfma_f32_16x16x32_bf16 v[88:91], v[248:251], v[160:163], v[88:91]
s_add_u32 s57, s57, 2048
s_and_b32 s57, s57, 0x7fff
v_mfma_f32_16x16x32_bf16 v[72:75], v[248:251], v[156:159], v[72:75]
s_waitcnt vmcnt(8) lgkmcnt(8)
v_mfma_f32_16x16x32_bf16 v[60:63], v[100:103], v[164:167], v[60:63]
buffer_load_dwordx4 v[204:207], v38, s[32:35], s57 offen sc1
v_mfma_f32_16x16x32_bf16 v[76:79], v[100:103], v[168:171], v[76:79]
ds_read_b64_tr_b16 v[236:237], v14 offset:12288
ds_read_b64_tr_b16 v[238:239], v14 offset:12800
v_mfma_f32_16x16x32_bf16 v[80:83], v[104:107], v[168:171], v[80:83]
ds_read_b64_tr_b16 v[240:241], v15 offset:12288
ds_read_b64_tr_b16 v[242:243], v15 offset:12800
v_mfma_f32_16x16x32_bf16 v[64:67], v[104:107], v[164:167], v[64:67]
buffer_load_dwordx4 v[208:211], v39, s[32:35], s57 offen sc1
v_mfma_f32_16x16x32_bf16 v[68:71], v[108:111], v[164:167], v[68:71]
ds_read_b64_tr_b16 v[244:245], v16 offset:12288
ds_read_b64_tr_b16 v[246:247], v16 offset:12800
v_mfma_f32_16x16x32_bf16 v[84:87], v[108:111], v[168:171], v[84:87]
ds_read_b64_tr_b16 v[248:249], v17 offset:12288
ds_read_b64_tr_b16 v[250:251], v17 offset:12800
v_mfma_f32_16x16x32_bf16 v[88:91], v[112:115], v[168:171], v[88:91]
v_mfma_f32_16x16x32_bf16 v[72:75], v[112:115], v[164:167], v[72:75]
s_waitcnt vmcnt(8) lgkmcnt(8)
v_mfma_f32_16x16x32_bf16 v[60:63], v[220:223], v[172:175], v[60:63]
buffer_load_dwordx4 v[212:215], v38, s[32:35], s57 offen offset:1024 sc1
v_mfma_f32_16x16x32_bf16 v[76:79], v[220:223], v[176:179], v[76:79]
ds_read_b64_tr_b16 v[100:101], v14 offset:16384
ds_read_b64_tr_b16 v[102:103], v14 offset:16896
v_mfma_f32_16x16x32_bf16 v[80:83], v[224:227], v[176:179], v[80:83]
ds_read_b64_tr_b16 v[104:105], v15 offset:16384
ds_read_b64_tr_b16 v[106:107], v15 offset:16896
v_mfma_f32_16x16x32_bf16 v[64:67], v[224:227], v[172:175], v[64:67]
buffer_load_dwordx4 v[216:219], v39, s[32:35], s57 offen offset:1024 sc1
v_mfma_f32_16x16x32_bf16 v[68:71], v[228:231], v[172:175], v[68:71]
ds_read_b64_tr_b16 v[108:109], v16 offset:16384
ds_read_b64_tr_b16 v[110:111], v16 offset:16896
v_mfma_f32_16x16x32_bf16 v[84:87], v[228:231], v[176:179], v[84:87]
ds_read_b64_tr_b16 v[112:113], v17 offset:16384
ds_read_b64_tr_b16 v[114:115], v17 offset:16896
v_mfma_f32_16x16x32_bf16 v[88:91], v[232:235], v[176:179], v[88:91]
s_add_u32 s57, s57, 2048
s_and_b32 s57, s57, 0x7fff
v_mfma_f32_16x16x32_bf16 v[72:75], v[232:235], v[172:175], v[72:75]
s_waitcnt vmcnt(8) lgkmcnt(8)
v_mfma_f32_16x16x32_bf16 v[60:63], v[236:239], v[180:183], v[60:63]
buffer_load_dwordx4 v[156:159], v38, s[32:35], s57 offen sc1
v_mfma_f32_16x16x32_bf16 v[76:79], v[236:239], v[184:187], v[76:79]
ds_read_b64_tr_b16 v[220:221], v14 offset:20480
ds_read_b64_tr_b16 v[222:223], v14 offset:20992
v_mfma_f32_16x16x32_bf16 v[80:83], v[240:243], v[184:187], v[80:83]
ds_read_b64_tr_b16 v[224:225], v15 offset:20480
ds_read_b64_tr_b16 v[226:227], v15 offset:20992
v_mfma_f32_16x16x32_bf16 v[64:67], v[240:243], v[180:183], v[64:67]
buffer_load_dwordx4 v[160:163], v39, s[32:35], s57 offen sc1
v_mfma_f32_16x16x32_bf16 v[68:71], v[244:247], v[180:183], v[68:71]
ds_read_b64_tr_b16 v[228:229], v16 offset:20480
ds_read_b64_tr_b16 v[230:231], v16 offset:20992
v_mfma_f32_16x16x32_bf16 v[84:87], v[244:247], v[184:187], v[84:87]
ds_read_b64_tr_b16 v[232:233], v17 offset:20480
ds_read_b64_tr_b16 v[234:235], v17 offset:20992
v_mfma_f32_16x16x32_bf16 v[88:91], v[248:251], v[184:187], v[88:91]
v_mfma_f32_16x16x32_bf16 v[72:75], v[248:251], v[180:183], v[72:75]
s_waitcnt vmcnt(8) lgkmcnt(8)
v_mfma_f32_16x16x32_bf16 v[60:63], v[100:103], v[188:191], v[60:63]
buffer_load_dwordx4 v[164:167], v38, s[32:35], s57 offen offset:1024 sc1
v_mfma_f32_16x16x32_bf16 v[76:79], v[100:103], v[192:195], v[76:79]
ds_read_b64_tr_b16 v[236:237], v14 offset:24576
ds_read_b64_tr_b16 v[238:239], v14 offset:25088
v_mfma_f32_16x16x32_bf16 v[80:83], v[104:107], v[192:195], v[80:83]
ds_read_b64_tr_b16 v[240:241], v15 offset:24576
ds_read_b64_tr_b16 v[242:243], v15 offset:25088
v_mfma_f32_16x16x32_bf16 v[64:67], v[104:107], v[188:191], v[64:67]
buffer_load_dwordx4 v[168:171], v39, s[32:35], s57 offen offset:1024 sc1
v_mfma_f32_16x16x32_bf16 v[68:71], v[108:111], v[188:191], v[68:71]
ds_read_b64_tr_b16 v[244:245], v16 offset:24576
ds_read_b64_tr_b16 v[246:247], v16 offset:25088
v_mfma_f32_16x16x32_bf16 v[84:87], v[108:111], v[192:195], v[84:87]
ds_read_b64_tr_b16 v[248:249], v17 offset:24576
ds_read_b64_tr_b16 v[250:251], v17 offset:25088
v_mfma_f32_16x16x32_bf16 v[88:91], v[112:115], v[192:195], v[88:91]
s_add_u32 s57, s57, 2048
s_and_b32 s57, s57, 0x7fff
v_mfma_f32_16x16x32_bf16 v[72:75], v[112:115], v[188:191], v[72:75]
s_waitcnt vmcnt(8) lgkmcnt(8)
v_mfma_f32_16x16x32_bf16 v[60:63], v[220:223], v[196:199], v[60:63]
buffer_load_dwordx4 v[172:175], v38, s[32:35], s57 offen sc1
v_mfma_f32_16x16x32_bf16 v[76:79], v[220:223], v[200:203], v[76:79]
ds_read_b64_tr_b16 v[100:101], v14 offset:28672
ds_read_b64_tr_b16 v[102:103], v14 offset:29184
v_mfma_f32_16x16x32_bf16 v[80:83], v[224:227], v[200:203], v[80:83]
ds_read_b64_tr_b16 v[104:105], v15 offset:28672
ds_read_b64_tr_b16 v[106:107], v15 offset:29184
v_mfma_f32_16x16x32_bf16 v[64:67], v[224:227], v[196:199], v[64:67]
buffer_load_dwordx4 v[176:179], v39, s[32:35], s57 offen sc1
v_mfma_f32_16x16x32_bf16 v[68:71], v[228:231], v[196:199], v[68:71]
ds_read_b64_tr_b16 v[108:109], v16 offset:28672
ds_read_b64_tr_b16 v[110:111], v16 offset:29184
v_mfma_f32_16x16x32_bf16 v[84:87], v[228:231], v[200:203], v[84:87]
ds_read_b64_tr_b16 v[112:113], v17 offset:28672
ds_read_b64_tr_b16 v[114:115], v17 offset:29184
v_mfma_f32_16x16x32_bf16 v[88:91], v[232:235], v[200:203], v[88:91]
v_mfma_f32_16x16x32_bf16 v[72:75], v[232:235], v[196:199], v[72:75]
s_waitcnt vmcnt(8) lgkmcnt(8)
v_mfma_f32_16x16x32_bf16 v[60:63], v[236:239], v[204:207], v[60:63]
buffer_load_dwordx4 v[180:183], v38, s[32:35], s57 offen offset:1024 sc1
v_mfma_f32_16x16x32_bf16 v[76:79], v[236:239], v[208:211], v[76:79]
ds_read_b64_tr_b16 v[220:221], v14 offset:32768
ds_read_b64_tr_b16 v[222:223], v14 offset:33280
v_mfma_f32_16x16x32_bf16 v[80:83], v[240:243], v[208:211], v[80:83]
ds_read_b64_tr_b16 v[224:225], v15 offset:32768
ds_read_b64_tr_b16 v[226:227], v15 offset:33280
v_mfma_f32_16x16x32_bf16 v[64:67], v[240:243], v[204:207], v[64:67]
buffer_load_dwordx4 v[184:187], v39, s[32:35], s57 offen offset:1024 sc1
v_mfma_f32_16x16x32_bf16 v[68:71], v[244:247], v[204:207], v[68:71]
ds_read_b64_tr_b16 v[228:229], v16 offset:32768
ds_read_b64_tr_b16 v[230:231], v16 offset:33280
v_mfma_f32_16x16x32_bf16 v[84:87], v[244:247], v[208:211], v[84:87]
ds_read_b64_tr_b16 v[232:233], v17 offset:32768
ds_read_b64_tr_b16 v[234:235], v17 offset:33280
v_mfma_f32_16x16x32_bf16 v[88:91], v[248:251], v[208:211], v[88:91]
s_add_u32 s57, s57, 2048
s_and_b32 s57, s57, 0x7fff
v_mfma_f32_16x16x32_bf16 v[72:75], v[248:251], v[204:207], v[72:75]
s_waitcnt vmcnt(8) lgkmcnt(8)
v_mfma_f32_16x16x32_bf16 v[60:63], v[100:103], v[212:215], v[60:63]
buffer_load_dwordx4 v[188:191], v38, s[32:35], s57 offen sc1
v_mfma_f32_16x16x32_bf16 v[76:79], v[100:103], v[216:219], v[76:79]
ds_read_b64_tr_b16 v[236:237], v14 offset:36864
ds_read_b64_tr_b16 v[238:239], v14 offset:37376
v_mfma_f32_16x16x32_bf16 v[80:83], v[104:107], v[216:219], v[80:83]
ds_read_b64_tr_b16 v[240:241], v15 offset:36864
ds_read_b64_tr_b16 v[242:243], v15 offset:37376
v_mfma_f32_16x16x32_bf16 v[64:67], v[104:107], v[212:215], v[64:67]
buffer_load_dwordx4 v[192:195], v39, s[32:35], s57 offen sc1
v_mfma_f32_16x16x32_bf16 v[68:71], v[108:111], v[212:215], v[68:71]
ds_read_b64_tr_b16 v[244:245], v16 offset:36864
ds_read_b64_tr_b16 v[246:247], v16 offset:37376
v_mfma_f32_16x16x32_bf16 v[84:87], v[108:111], v[216:219], v[84:87]
ds_read_b64_tr_b16 v[248:249], v17 offset:36864
ds_read_b64_tr_b16 v[250:251], v17 offset:37376
v_mfma_f32_16x16x32_bf16 v[88:91], v[112:115], v[216:219], v[88:91]
v_mfma_f32_16x16x32_bf16 v[72:75], v[112:115], v[212:215], v[72:75]
s_waitcnt vmcnt(8) lgkmcnt(8)
v_mfma_f32_16x16x32_bf16 v[60:63], v[220:223], v[156:159], v[60:63]
buffer_load_dwordx4 v[196:199], v38, s[32:35], s57 offen offset:1024 sc1
v_mfma_f32_16x16x32_bf16 v[76:79], v[220:223], v[160:163], v[76:79]
ds_read_b64_tr_b16 v[100:101], v14 offset:40960
ds_read_b64_tr_b16 v[102:103], v14 offset:41472
v_mfma_f32_16x16x32_bf16 v[80:83], v[224:227], v[160:163], v[80:83]
ds_read_b64_tr_b16 v[104:105], v15 offset:40960
ds_read_b64_tr_b16 v[106:107], v15 offset:41472
v_mfma_f32_16x16x32_bf16 v[64:67], v[224:227], v[156:159], v[64:67]
buffer_load_dwordx4 v[200:203], v39, s[32:35], s57 offen offset:1024 sc1
v_mfma_f32_16x16x32_bf16 v[68:71], v[228:231], v[156:159], v[68:71]
ds_read_b64_tr_b16 v[108:109], v16 offset:40960
ds_read_b64_tr_b16 v[110:111], v16 offset:41472
v_mfma_f32_16x16x32_bf16 v[84:87], v[228:231], v[160:163], v[84:87]
ds_read_b64_tr_b16 v[112:113], v17 offset:40960
ds_read_b64_tr_b16 v[114:115], v17 offset:41472
v_mfma_f32_16x16x32_bf16 v[88:91], v[232:235], v[160:163], v[88:91]
s_add_u32 s57, s57, 2048
s_and_b32 s57, s57, 0x7fff
v_mfma_f32_16x16x32_bf16 v[72:75], v[232:235], v[156:159], v[72:75]
s_waitcnt vmcnt(8) lgkmcnt(8)
v_mfma_f32_16x16x32_bf16 v[60:63], v[236:239], v[164:167], v[60:63]
buffer_load_dwordx4 v[204:207], v38, s[32:35], s57 offen sc1
v_mfma_f32_16x16x32_bf16 v[76:79], v[236:239], v[168:171], v[76:79]
ds_read_b64_tr_b16 v[220:221], v14 offset:45056
ds_read_b64_tr_b16 v[222:223], v14 offset:45568
v_mfma_f32_16x16x32_bf16 v[80:83], v[240:243], v[168:171], v[80:83]
ds_read_b64_tr_b16 v[224:225], v15 offset:45056
ds_read_b64_tr_b16 v[226:227], v15 offset:45568
v_mfma_f32_16x16x32_bf16 v[64:67], v[240:243], v[164:167], v[64:67]
buffer_load_dwordx4 v[208:211], v39, s[32:35], s57 offen sc1
v_mfma_f32_16x16x32_bf16 v[68:71], v[244:247], v[164:167], v[68:71]
ds_read_b64_tr_b16 v[228:229], v16 offset:45056
ds_read_b64_tr_b16 v[230:231], v16 offset:45568
v_mfma_f32_16x16x32_bf16 v[84:87], v[244:247], v[168:171], v[84:87]
ds_read_b64_tr_b16 v[232:233], v17 offset:45056
ds_read_b64_tr_b16 v[234:235], v17 offset:45568
v_mfma_f32_16x16x32_bf16 v[88:91], v[248:251], v[168:171], v[88:91]
v_mfma_f32_16x16x32_bf16 v[72:75], v[248:251], v[164:167], v[72:75]
s_waitcnt vmcnt(8) lgkmcnt(8)
v_mfma_f32_16x16x32_bf16 v[60:63], v[100:103], v[172:175], v[60:63]
buffer_load_dwordx4 v[212:215], v38, s[32:35], s57 offen offset:1024 sc1
v_mfma_f32_16x16x32_bf16 v[76:79], v[100:103], v[176:179], v[76:79]
ds_read_b64_tr_b16 v[236:237], v14 offset:49152
ds_read_b64_tr_b16 v[238:239], v14 offset:49664
v_mfma_f32_16x16x32_bf16 v[80:83], v[104:107], v[176:179], v[80:83]
ds_read_b64_tr_b16 v[240:241], v15 offset:49152
ds_read_b64_tr_b16 v[242:243], v15 offset:49664
v_mfma_f32_16x16x32_bf16 v[64:67], v[104:107], v[172:175], v[64:67]
buffer_load_dwordx4 v[216:219], v39, s[32:35], s57 offen offset:1024 sc1
v_mfma_f32_16x16x32_bf16 v[68:71], v[108:111], v[172:175], v[68:71]
ds_read_b64_tr_b16 v[244:245], v16 offset:49152
ds_read_b64_tr_b16 v[246:247], v16 offset:49664
v_mfma_f32_16x16x32_bf16 v[84:87], v[108:111], v[176:179], v[84:87]
ds_read_b64_tr_b16 v[248:249], v17 offset:49152
ds_read_b64_tr_b16 v[250:251], v17 offset:49664
v_mfma_f32_16x16x32_bf16 v[88:91], v[112:115], v[176:179], v[88:91]
v_mfma_f32_16x16x32_bf16 v[72:75], v[112:115], v[172:175], v[72:75]
s_waitcnt vmcnt(8) lgkmcnt(8)
v_mfma_f32_16x16x32_bf16 v[60:63], v[220:223], v[180:183], v[60:63]
v_mfma_f32_16x16x32_bf16 v[76:79], v[220:223], v[184:187], v[76:79]
ds_read_b64_tr_b16 v[100:101], v14 offset:53248
ds_read_b64_tr_b16 v[102:103], v14 offset:53760
v_mfma_f32_16x16x32_bf16 v[80:83], v[224:227], v[184:187], v[80:83]
ds_read_b64_tr_b16 v[104:105], v15 offset:53248
ds_read_b64_tr_b16 v[106:107], v15 offset:53760
v_mfma_f32_16x16x32_bf16 v[64:67], v[224:227], v[180:183], v[64:67]
v_mfma_f32_16x16x32_bf16 v[68:71], v[228:231], v[180:183], v[68:71]
ds_read_b64_tr_b16 v[108:109], v16 offset:53248
ds_read_b64_tr_b16 v[110:111], v16 offset:53760
v_mfma_f32_16x16x32_bf16 v[84:87], v[228:231], v[184:187], v[84:87]
ds_read_b64_tr_b16 v[112:113], v17 offset:53248
ds_read_b64_tr_b16 v[114:115], v17 offset:53760
v_mfma_f32_16x16x32_bf16 v[88:91], v[232:235], v[184:187], v[88:91]
v_mfma_f32_16x16x32_bf16 v[72:75], v[232:235], v[180:183], v[72:75]
s_waitcnt vmcnt(6) lgkmcnt(8)
v_mfma_f32_16x16x32_bf16 v[60:63], v[236:239], v[188:191], v[60:63]
v_mfma_f32_16x16x32_bf16 v[76:79], v[236:239], v[192:195], v[76:79]
ds_read_b64_tr_b16 v[220:221], v14 offset:57344
ds_read_b64_tr_b16 v[222:223], v14 offset:57856
v_mfma_f32_16x16x32_bf16 v[80:83], v[240:243], v[192:195], v[80:83]
ds_read_b64_tr_b16 v[224:225], v15 offset:57344
ds_read_b64_tr_b16 v[226:227], v15 offset:57856
v_mfma_f32_16x16x32_bf16 v[64:67], v[240:243], v[188:191], v[64:67]
v_mfma_f32_16x16x32_bf16 v[68:71], v[244:247], v[188:191], v[68:71]
ds_read_b64_tr_b16 v[228:229], v16 offset:57344
ds_read_b64_tr_b16 v[230:231], v16 offset:57856
v_mfma_f32_16x16x32_bf16 v[84:87], v[244:247], v[192:195], v[84:87]
ds_read_b64_tr_b16 v[232:233], v17 offset:57344
ds_read_b64_tr_b16 v[234:235], v17 offset:57856
v_mfma_f32_16x16x32_bf16 v[88:91], v[248:251], v[192:195], v[88:91]
v_mfma_f32_16x16x32_bf16 v[72:75], v[248:251], v[188:191], v[72:75]
s_waitcnt vmcnt(4) lgkmcnt(8)
v_mfma_f32_16x16x32_bf16 v[60:63], v[100:103], v[196:199], v[60:63]
v_mfma_f32_16x16x32_bf16 v[76:79], v[100:103], v[200:203], v[76:79]
ds_read_b64_tr_b16 v[236:237], v14 offset:61440
ds_read_b64_tr_b16 v[238:239], v14 offset:61952
v_mfma_f32_16x16x32_bf16 v[80:83], v[104:107], v[200:203], v[80:83]
ds_read_b64_tr_b16 v[240:241], v15 offset:61440
ds_read_b64_tr_b16 v[242:243], v15 offset:61952
v_mfma_f32_16x16x32_bf16 v[64:67], v[104:107], v[196:199], v[64:67]
v_mfma_f32_16x16x32_bf16 v[68:71], v[108:111], v[196:199], v[68:71]
ds_read_b64_tr_b16 v[244:245], v16 offset:61440
ds_read_b64_tr_b16 v[246:247], v16 offset:61952
v_mfma_f32_16x16x32_bf16 v[84:87], v[108:111], v[200:203], v[84:87]
ds_read_b64_tr_b16 v[248:249], v17 offset:61440
ds_read_b64_tr_b16 v[250:251], v17 offset:61952
v_mfma_f32_16x16x32_bf16 v[88:91], v[112:115], v[200:203], v[88:91]
v_mfma_f32_16x16x32_bf16 v[72:75], v[112:115], v[196:199], v[72:75]
s_waitcnt vmcnt(2) lgkmcnt(8)
v_mfma_f32_16x16x32_bf16 v[60:63], v[220:223], v[204:207], v[60:63]
v_mfma_f32_16x16x32_bf16 v[76:79], v[220:223], v[208:211], v[76:79]
v_mfma_f32_16x16x32_bf16 v[80:83], v[224:227], v[208:211], v[80:83]
v_mfma_f32_16x16x32_bf16 v[64:67], v[224:227], v[204:207], v[64:67]
v_mfma_f32_16x16x32_bf16 v[68:71], v[228:231], v[204:207], v[68:71]
v_mfma_f32_16x16x32_bf16 v[84:87], v[228:231], v[208:211], v[84:87]
v_mfma_f32_16x16x32_bf16 v[88:91], v[232:235], v[208:211], v[88:91]
v_mfma_f32_16x16x32_bf16 v[72:75], v[232:235], v[204:207], v[72:75]
s_waitcnt vmcnt(0) lgkmcnt(0)
v_mfma_f32_16x16x32_bf16 v[60:63], v[236:239], v[212:215], v[60:63]
v_mfma_f32_16x16x32_bf16 v[64:67], v[240:243], v[212:215], v[64:67]
v_mfma_f32_16x16x32_bf16 v[68:71], v[244:247], v[212:215], v[68:71]
v_mfma_f32_16x16x32_bf16 v[72:75], v[248:251], v[212:215], v[72:75]
v_mfma_f32_16x16x32_bf16 v[76:79], v[236:239], v[216:219], v[76:79]
v_mfma_f32_16x16x32_bf16 v[80:83], v[240:243], v[216:219], v[80:83]
v_mfma_f32_16x16x32_bf16 v[84:87], v[244:247], v[216:219], v[84:87]
v_mfma_f32_16x16x32_bf16 v[88:91], v[248:251], v[216:219], v[88:91]
s_setpc_b64 s[94:95]
R_oloop_end:
s_cmp_eq_u32 s46, 0
s_cbranch_scc1 slow_78
s_nop 0
v_cvt_pk_bf16_f32 v20, v60, v61
v_cvt_pk_bf16_f32 v21, v62, v63
v_cvt_pk_bf16_f32 v22, v64, v65
v_cvt_pk_bf16_f32 v23, v66, v67
buffer_store_dwordx4 v[20:23], v18, s[32:35], s85 offen offset:0 sc1
v_cvt_pk_bf16_f32 v24, v68, v69
v_cvt_pk_bf16_f32 v25, v70, v71
v_cvt_pk_bf16_f32 v26, v72, v73
v_cvt_pk_bf16_f32 v27, v74, v75
buffer_store_dwordx4 v[24:27], v18, s[32:35], s85 offen offset:1024 sc1
v_cvt_pk_bf16_f32 v28, v76, v77
v_cvt_pk_bf16_f32 v29, v78, v79
v_cvt_pk_bf16_f32 v30, v80, v81
v_cvt_pk_bf16_f32 v31, v82, v83
buffer_store_dwordx4 v[28:31], v18, s[32:35], s86 offen offset:0 sc1
v_cvt_pk_bf16_f32 v32, v84, v85
v_cvt_pk_bf16_f32 v33, v86, v87
v_cvt_pk_bf16_f32 v34, v88, v89
v_cvt_pk_bf16_f32 v35, v90, v91
buffer_store_dwordx4 v[32:35], v18, s[32:35], s86 offen offset:1024 sc1
s_barrier
v_dot2c_f32_bf16 v6, v20, v48
v_dot2c_f32_bf16 v8, v20, v20
v_dot2c_f32_bf16 v7, v28, v48
v_dot2c_f32_bf16 v9, v28, v28
v_dot2c_f32_bf16 v6, v21, v48
v_dot2c_f32_bf16 v8, v21, v21
v_dot2c_f32_bf16 v7, v29, v48
v_dot2c_f32_bf16 v9, v29, v29
v_dot2c_f32_bf16 v6, v22, v48
v_dot2c_f32_bf16 v8, v22, v22
v_dot2c_f32_bf16 v7, v30, v48
v_dot2c_f32_bf16 v9, v30, v30
v_dot2c_f32_bf16 v6, v23, v48
v_dot2c_f32_bf16 v8, v23, v23
v_dot2c_f32_bf16 v7, v31, v48
v_dot2c_f32_bf16 v9, v31, v31
v_dot2c_f32_bf16 v6, v24, v48
v_dot2c_f32_bf16 v8, v24, v24
v_dot2c_f32_bf16 v7, v32, v48
v_dot2c_f32_bf16 v9, v32, v32
v_dot2c_f32_bf16 v6, v25, v48
v_dot2c_f32_bf16 v8, v25, v25
v_dot2c_f32_bf16 v7, v33, v48
v_dot2c_f32_bf16 v9, v33, v33
v_dot2c_f32_bf16 v6, v26, v48
v_dot2c_f32_bf16 v8, v26, v26
v_dot2c_f32_bf16 v7, v34, v48
v_dot2c_f32_bf16 v9, v34, v34
v_dot2c_f32_bf16 v6, v27, v48
v_dot2c_f32_bf16 v8, v27, v27
v_dot2c_f32_bf16 v7, v35, v48
v_dot2c_f32_bf16 v9, v35, v35
s_mov_b64 exec, 1
s_waitcnt vmcnt(0)
buffer_store_dword v5, v4, s[32:35], s88 offen
s_mov_b64 exec, -1
s_nop 1
v_permlane32_swap_b32 v6, v7
v_permlane32_swap_b32 v8, v9
v_add_f32 v6, v6, v7
v_add_f32 v8, v8, v9
s_nop 1
v_permlane16_swap_b32 v6, v8
s_nop 0
v_add_f32 v6, v6, v8
buffer_store_dword v6, v1, s[32:35], s87 offen
back_79:
s_lshl_b32 s49, s44, 13
v_add_u32 v10, s49, v18
v_add_u32 v11, 1024, v10
s_lshl_b32 s48, s43, 1
v_lshrrev_b32 v4, 2, v2
v_and_b32 v5, 3, v0
v_lshl_add_u32 v6, v3, 3, v4
v_lshlrev_b32 v6, 7, v6
v_lshl_add_u32 v6, v5, 3, v6
v_lshrrev_b32 v7, 1, v4
v_and_b32 v8, 1, v3
v_lshl_add_u32 v7, v8, 1, v7
v_xor_b32 v7, s48, v7
v_lshl_add_u32 v12, v7, 5, v6
v_add_u32 v12, 16384, v12
v_xor_b32 v13, 32, v12
v_mov_b32 v14, v10
v_mov_b32 v15, v11
v_add_u32 v16, 122880, v12
v_add_u32 v17, 122880, v13
v_mov_b32 v156, 0
v_mov_b32 v157, 0
v_mov_b32 v158, 0
v_mov_b32 v159, 0
v_mov_b32 v160, 0
v_mov_b32 v161, 0
v_mov_b32 v162, 0
v_mov_b32 v163, 0
v_mov_b32 v164, 0
v_mov_b32 v165, 0
v_mov_b32 v166, 0
v_mov_b32 v167, 0
v_mov_b32 v168, 0
v_mov_b32 v169, 0
v_mov_b32 v170, 0
v_mov_b32 v171, 0
v_mov_b32 v172, 0
v_mov_b32 v173, 0
v_mov_b32 v174, 0
v_mov_b32 v175, 0
v_mov_b32 v176, 0
v_mov_b32 v177, 0
v_mov_b32 v178, 0
v_mov_b32 v179, 0
v_mov_b32 v180, 0
v_mov_b32 v181, 0
v_mov_b32 v182, 0
v_mov_b32 v183, 0
v_mov_b32 v184, 0
v_mov_b32 v185, 0
v_mov_b32 v186, 0
v_mov_b32 v187, 0
v_mov_b32 v188, 0
v_mov_b32 v189, 0
v_mov_b32 v190, 0
v_mov_b32 v191, 0
v_mov_b32 v192, 0
v_mov_b32 v193, 0
v_mov_b32 v194, 0
v_mov_b32 v195, 0
v_mov_b32 v196, 0
v_mov_b32 v197, 0
v_mov_b32 v198, 0
v_mov_b32 v199, 0
v_mov_b32 v200, 0
v_mov_b32 v201, 0
v_mov_b32 v202, 0
v_mov_b32 v203, 0
v_mov_b32 v204, 0
v_mov_b32 v205, 0
v_mov_b32 v206, 0
v_mov_b32 v207, 0
v_mov_b32 v208, 0
v_mov_b32 v209, 0
v_mov_b32 v210, 0
v_mov_b32 v211, 0
v_mov_b32 v212, 0
v_mov_b32 v213, 0
v_mov_b32 v214, 0
v_mov_b32 v215, 0
v_mov_b32 v216, 0
v_mov_b32 v217, 0
v_mov_b32 v218, 0
v_mov_b32 v219, 0
v_mov_b32 v220, 0
v_mov_b32 v221, 0
v_mov_b32 v222, 0
v_mov_b32 v223, 0
v_mov_b32 v224, 0
v_mov_b32 v225, 0
v_mov_b32 v226, 0
v_mov_b32 v227, 0
v_mov_b32 v228, 0
v_mov_b32 v229, 0
v_mov_b32 v230, 0
v_mov_b32 v231, 0
v_mov_b32 v232, 0
v_mov_b32 v233, 0
v_mov_b32 v234, 0
v_mov_b32 v235, 0
v_mov_b32 v236, 0
v_mov_b32 v237, 0
v_mov_b32 v238, 0
v_mov_b32 v239, 0
v_mov_b32 v240, 0
v_mov_b32 v241, 0
v_mov_b32 v242, 0
v_mov_b32 v243, 0
v_mov_b32 v244, 0
v_mov_b32 v245, 0
v_mov_b32 v246, 0
v_mov_b32 v247, 0
v_mov_b32 v248, 0
v_mov_b32 v249, 0
v_mov_b32 v250, 0
v_mov_b32 v251, 0
v_lshrrev_b32 v6, 2, v2
v_cmp_eq_u32 vcc, v6, v3
v_and_b32 v7, 1, v0
v_lshlrev_b32 v7, 4, v7
v_mov_b32 v8, 0x3f80
v_lshlrev_b32 v9, v7, v8
v_cndmask_b32 v7, 0, v9, vcc
v_and_b32 v6, 2, v0
v_cmp_eq_u32 vcc, 0, v6
v_mov_b32 v36, 0
v_mov_b32 v37, 0
v_mov_b32 v40, 0
v_mov_b32 v41, 0
v_cndmask_b32 v38, 0, v7, vcc
v_cndmask_b32 v39, v7, 0, vcc
v_lshrrev_b32 v8, 1, v2
v_cmp_eq_u32 vcc, 0, v8
s_nop 1
v_cndmask_b32 v44, 0, v9, vcc
v_cmp_eq_u32 vcc, 1, v8
s_nop 1
v_cndmask_b32 v45, 0, v9, vcc
v_cmp_eq_u32 vcc, 2, v8
s_nop 1
v_cndmask_b32 v46, 0, v9, vcc
v_cmp_eq_u32 vcc, 3, v8
s_nop 1
v_cndmask_b32 v47, 0, v9, vcc
v_lshrrev_b32 v4, 2, v2
v_lshl_add_u32 v4, v3, 2, v4
v_lshlrev_b32 v4, 6, v4
v_and_b32 v5, 3, v0
v_lshl_add_u32 v4, v5, 3, v4
s_lshl_b32 s48, s43, 11
s_add_u32 s48, s48, 135168
v_add_u32 v53, s48, v4
s_mul_i32 s48, s40, 3072
s_add_u32 s48, s48, 139264
v_add_u32 v42, s48, v18
s_xor_b32 s49, s40, 2
s_mul_i32 s48, s49, 3072
s_add_u32 s48, s48, 139264
v_add_u32 v43, s48, v18
s_lshl_b32 s49, s49, 2
s_add_u32 s49, s49, 134672
v_mov_b32 v19, s49
v_xor_b32 v52, 8, v19
v_lshrrev_b32 v4, 3, v0
v_and_b32 v5, 7, v0
v_lshlrev_b32 v4, 11, v4
v_lshl_add_u32 v55, v5, 4, v4
v_lshlrev_b32 v4, 6, v2
v_lshl_add_u32 v58, v3, 4, v4
v_lshlrev_b32 v4, 4, v2
v_lshl_add_u32 v59, v3, 3, v4
s_mul_i32 s51, s42, 163840
s_add_u32 s51, s51, 9437184
s_lshl_b32 s50, s43, 1
s_add_u32 s50, s50, s44
s_lshl_b32 s48, s50, 15
s_add_u32 s48, s48, s51
s_add_u32 s48, s48, 0
s_lshl_b32 s49, s41, 7
s_add_u32 s53, s48, s49
s_add_u32 s54, s53, 16384
s_lshl_b32 s56, s50, 10
s_add_u32 s56, s56, s51
s_add_u32 s56, s56, 147456
s_xor_b32 s57, s56, 1024
s_lshl_b32 s58, s50, 11
s_add_u32 s58, s58, s51
s_add_u32 s58, s58, 131072
s_xor_b32 s59, s58, 2048
s_add_u32 s79, s58, s49
s_lshl_b32 s50, s41, 11
s_add_u32 s55, s48, s50
s_lshl_b32 s48, s43, 7
s_add_u32 s48, s48, 133888
v_lshl_add_u32 v7, v3, 4, s48
v_lshl_add_u32 v54, v2, 2, s48
s_lshl_b32 s49, s44, 6
v_add_u32 v8, s49, v2
v_lshlrev_b32 v8, 3, v8
v_add_u32 v8, 131072, v8
v_lshl_add_u32 v9, v3, 2, s49
v_lshlrev_b32 v9, 2, v9
v_add_u32 v9, 132096, v9
s_mov_b32 s64, 0
s_mov_b32 s65, 0
s_mov_b32 s66, 0x3fb8aa3b
s_mov_b32 s61, 2
s_lshr_b32 s49, s42, 3
s_xor_b32 s77, s74, s49
s_add_u32 s77, s77, 4
s_lshl_b32 s50, s42, 2
s_add_u32 s50, s50, s40
s_lshl_b32 s50, s50, 4
s_add_u32 s50, s50, s41
s_lshl_b32 s50, s50, 8
s_add_u32 s52, s50, 18087936
ds_read_b64_tr_b16 v[84:85], v16 offset:8192
ds_read_b64_tr_b16 v[86:87], v16 offset:8704
ds_read_b64_tr_b16 v[88:89], v17 offset:8192
ds_read_b64_tr_b16 v[90:91], v17 offset:8704
ds_read_b64_tr_b16 v[92:93], v16 offset:16384
ds_read_b64_tr_b16 v[94:95], v16 offset:16896
ds_read_b64_tr_b16 v[96:97], v17 offset:16384
ds_read_b64_tr_b16 v[98:99], v17 offset:16896
ds_read_b64_tr_b16 v[76:77], v16 offset:0
ds_read_b64_tr_b16 v[78:79], v16 offset:512
ds_read_b64_tr_b16 v[80:81], v17 offset:0
ds_read_b64_tr_b16 v[82:83], v17 offset:512
s_barrier
ds_read_b128 v[60:63], v14 offset:0
ds_read_b128 v[64:67], v14 offset:2048
ds_read_b128 v[68:71], v14 offset:4096
ds_read_b128 v[72:75], v14 offset:6144
s_waitcnt lgkmcnt(0)
c1_loop:
v_mfma_f32_16x16x32_bf16 v[212:215], v[84:87], v[72:75], v[212:215]
ds_read_b128 v[100:103], v15 offset:0
v_mfma_f32_16x16x32_bf16 v[204:207], v[84:87], v[68:71], v[204:207]
ds_read_b128 v[104:107], v15 offset:2048
v_mfma_f32_16x16x32_bf16 v[196:199], v[84:87], v[64:67], v[196:199]
ds_read_b128 v[108:111], v15 offset:4096
v_mfma_f32_16x16x32_bf16 v[188:191], v[84:87], v[60:63], v[188:191]
ds_read_b128 v[112:115], v15 offset:6144
v_mfma_f32_16x16x32_bf16 v[192:195], v[88:91], v[60:63], v[192:195]
ds_read_b64_tr_b16 v[124:125], v16 offset:12288
v_mfma_f32_16x16x32_bf16 v[200:203], v[88:91], v[64:67], v[200:203]
ds_read_b64_tr_b16 v[126:127], v16 offset:12800
v_mfma_f32_16x16x32_bf16 v[208:211], v[88:91], v[68:71], v[208:211]
ds_read_b64_tr_b16 v[128:129], v17 offset:12288
v_mfma_f32_16x16x32_bf16 v[216:219], v[88:91], v[72:75], v[216:219]
ds_read_b64_tr_b16 v[130:131], v17 offset:12800
v_mfma_f32_16x16x32_bf16 v[244:247], v[72:75], v[92:95], v[244:247]
ds_read_b64_tr_b16 v[132:133], v16 offset:20480
v_mfma_f32_16x16x32_bf16 v[248:251], v[72:75], v[96:99], v[248:251]
ds_read_b64_tr_b16 v[134:135], v16 offset:20992
v_mfma_f32_16x16x32_bf16 v[240:243], v[68:71], v[96:99], v[240:243]
ds_read_b64_tr_b16 v[136:137], v17 offset:20480
v_mfma_f32_16x16x32_bf16 v[236:239], v[68:71], v[92:95], v[236:239]
ds_read_b64_tr_b16 v[138:139], v17 offset:20992
v_mfma_f32_16x16x32_bf16 v[228:231], v[64:67], v[92:95], v[228:231]
ds_read_b64_tr_b16 v[116:117], v16 offset:4096
v_mfma_f32_16x16x32_bf16 v[232:235], v[64:67], v[96:99], v[232:235]
ds_read_b64_tr_b16 v[118:119], v16 offset:4608
v_mfma_f32_16x16x32_bf16 v[224:227], v[60:63], v[96:99], v[224:227]
ds_read_b64_tr_b16 v[120:121], v17 offset:4096
v_mfma_f32_16x16x32_bf16 v[220:223], v[60:63], v[92:95], v[220:223]
ds_read_b64_tr_b16 v[122:123], v17 offset:4608
v_mfma_f32_16x16x32_bf16 v[156:159], v[76:79], v[60:63], v[156:159]
s_cmp_eq_u32 s77, s64
s_cbranch_scc1 c1_hook
c1_hook_ret:
v_mfma_f32_16x16x32_bf16 v[164:167], v[76:79], v[64:67], v[164:167]
s_add_u32 s65, s65, 40960
s_cmp_eq_u32 s65, 122880
v_mfma_f32_16x16x32_bf16 v[172:175], v[76:79], v[68:71], v[172:175]
s_cselect_b32 s65, 0, s65
s_add_u32 s64, s64, 1
v_mfma_f32_16x16x32_bf16 v[180:183], v[76:79], v[72:75], v[180:183]
v_add_u32 v14, s65, v10
v_add_u32 v15, s65, v11
v_mfma_f32_16x16x32_bf16 v[184:187], v[80:83], v[72:75], v[184:187]
v_add_u32 v16, s65, v12
v_add_u32 v17, s65, v13
v_mfma_f32_16x16x32_bf16 v[176:179], v[80:83], v[68:71], v[176:179]
s_cmp_eq_u32 s64, 16
s_cbranch_scc1 c1_last
v_mfma_f32_16x16x32_bf16 v[168:171], v[80:83], v[64:67], v[168:171]
s_waitcnt lgkmcnt(0)
v_mfma_f32_16x16x32_bf16 v[160:163], v[80:83], v[60:63], v[160:163]
s_barrier
v_mfma_f32_16x16x32_bf16 v[212:215], v[124:127], v[112:115], v[212:215]
ds_read_b128 v[60:63], v14 offset:0
v_mfma_f32_16x16x32_bf16 v[204:207], v[124:127], v[108:111], v[204:207]
ds_read_b128 v[64:67], v14 offset:2048
v_mfma_f32_16x16x32_bf16 v[196:199], v[124:127], v[104:107], v[196:199]
ds_read_b128 v[68:71], v14 offset:4096
v_mfma_f32_16x16x32_bf16 v[188:191], v[124:127], v[100:103], v[188:191]
ds_read_b128 v[72:75], v14 offset:6144
v_mfma_f32_16x16x32_bf16 v[192:195], v[128:131], v[100:103], v[192:195]
ds_read_b64_tr_b16 v[84:85], v16 offset:8192
v_mfma_f32_16x16x32_bf16 v[200:203], v[128:131], v[104:107], v[200:203]
ds_read_b64_tr_b16 v[86:87], v16 offset:8704
v_mfma_f32_16x16x32_bf16 v[208:211], v[128:131], v[108:111], v[208:211]
ds_read_b64_tr_b16 v[88:89], v17 offset:8192
v_mfma_f32_16x16x32_bf16 v[216:219], v[128:131], v[112:115], v[216:219]
ds_read_b64_tr_b16 v[90:91], v17 offset:8704
v_mfma_f32_16x16x32_bf16 v[244:247], v[112:115], v[132:135], v[244:247]
ds_read_b64_tr_b16 v[92:93], v16 offset:16384
v_mfma_f32_16x16x32_bf16 v[248:251], v[112:115], v[136:139], v[248:251]
ds_read_b64_tr_b16 v[94:95], v16 offset:16896
v_mfma_f32_16x16x32_bf16 v[240:243], v[108:111], v[136:139], v[240:243]
ds_read_b64_tr_b16 v[96:97], v17 offset:16384
v_mfma_f32_16x16x32_bf16 v[236:239], v[108:111], v[132:135], v[236:239]
ds_read_b64_tr_b16 v[98:99], v17 offset:16896
v_mfma_f32_16x16x32_bf16 v[228:231], v[104:107], v[132:135], v[228:231]
ds_read_b64_tr_b16 v[76:77], v16 offset:0
v_mfma_f32_16x16x32_bf16 v[232:235], v[104:107], v[136:139], v[232:235]
ds_read_b64_tr_b16 v[78:79], v16 offset:512
v_mfma_f32_16x16x32_bf16 v[224:227], v[100:103], v[136:139], v[224:227]
ds_read_b64_tr_b16 v[80:81], v17 offset:0
v_mfma_f32_16x16x32_bf16 v[220:223], v[100:103], v[132:135], v[220:223]
ds_read_b64_tr_b16 v[82:83], v17 offset:512
v_mfma_f32_16x16x32_bf16 v[156:159], v[116:119], v[100:103], v[156:159]
v_mfma_f32_16x16x32_bf16 v[164:167], v[116:119], v[104:107], v[164:167]
v_mfma_f32_16x16x32_bf16 v[172:175], v[116:119], v[108:111], v[172:175]
v_mfma_f32_16x16x32_bf16 v[180:183], v[116:119], v[112:115], v[180:183]
v_mfma_f32_16x16x32_bf16 v[184:187], v[120:123], v[112:115], v[184:187]
v_mfma_f32_16x16x32_bf16 v[176:179], v[120:123], v[108:111], v[176:179]
v_mfma_f32_16x16x32_bf16 v[168:171], v[120:123], v[104:107], v[168:171]
s_waitcnt lgkmcnt(0)
v_mfma_f32_16x16x32_bf16 v[160:163], v[120:123], v[100:103], v[160:163]
s_branch c1_loop
c1_hook:
s_waitcnt lgkmcnt(0)
s_cmp_lg_u32 s44, 0
s_cbranch_scc1 else_80
v_mfma_f32_16x16x32_bf16 v[140:143], v[48:51], v[76:79], 0
v_mfma_f32_16x16x32_bf16 v[144:147], v[48:51], v[84:87], 0
v_mfma_f32_16x16x32_bf16 v[148:151], v[48:51], v[92:95], 0
v_mfma_f32_16x16x32_bf16 v[140:143], v[48:51], v[116:119], v[140:143]
v_mfma_f32_16x16x32_bf16 v[144:147], v[48:51], v[124:127], v[144:147]
v_mfma_f32_16x16x32_bf16 v[148:151], v[48:51], v[132:135], v[148:151]
s_branch fi_81
else_80:
v_mfma_f32_16x16x32_bf16 v[140:143], v[48:51], v[80:83], 0
v_mfma_f32_16x16x32_bf16 v[144:147], v[48:51], v[88:91], 0
v_mfma_f32_16x16x32_bf16 v[148:151], v[48:51], v[96:99], 0
v_mfma_f32_16x16x32_bf16 v[140:143], v[48:51], v[120:123], v[140:143]
v_mfma_f32_16x16x32_bf16 v[144:147], v[48:51], v[128:131], v[144:147]
v_mfma_f32_16x16x32_bf16 v[148:151], v[48:51], v[136:139], v[148:151]
fi_81:
s_nop 4
v_cmp_eq_u32 vcc, 0, v3
v_cmp_eq_u32 s[48:49], 1, v3
s_nop 1
v_cndmask_b32 v4, v148, v144, s[48:49]
v_cndmask_b32 v4, v4, v140, vcc
buffer_store_dword v4, v1, s[32:35], s52 offen sc1
s_branch c1_hook_ret
c1_last:
v_mfma_f32_16x16x32_bf16 v[168:171], v[80:83], v[64:67], v[168:171]
s_waitcnt lgkmcnt(0)
v_mfma_f32_16x16x32_bf16 v[160:163], v[80:83], v[60:63], v[160:163]
v_mfma_f32_16x16x32_bf16 v[212:215], v[124:127], v[112:115], v[212:215]
ds_read_b64_tr_b16 v[10:11], v53 offset:0
ds_read_b64_tr_b16 v[12:13], v53 offset:1024
v_mfma_f32_16x16x32_bf16 v[204:207], v[124:127], v[108:111], v[204:207]
ds_read_b64_tr_b16 v[14:15], v53 offset:32
ds_read_b64_tr_b16 v[16:17], v53 offset:1056
v_mfma_f32_16x16x32_bf16 v[196:199], v[124:127], v[104:107], v[196:199]

s_mul_i32 s48, s44, 0x80008000
v_mfma_f32_16x16x32_bf16 v[188:191], v[124:127], v[100:103], v[188:191]

v_mfma_f32_16x16x32_bf16 v[192:195], v[128:131], v[100:103], v[192:195]

v_mfma_f32_16x16x32_bf16 v[200:203], v[128:131], v[104:107], v[200:203]

v_mfma_f32_16x16x32_bf16 v[208:211], v[128:131], v[108:111], v[208:211]

s_waitcnt lgkmcnt(0)
v_mfma_f32_16x16x32_bf16 v[216:219], v[128:131], v[112:115], v[216:219]
s_barrier
v_mfma_f32_16x16x32_bf16 v[244:247], v[112:115], v[132:135], v[244:247]
ds_read_b128 v[140:143], v7 offset:0
ds_read_b128 v[144:147], v7 offset:64
v_mfma_f32_16x16x32_bf16 v[248:251], v[112:115], v[136:139], v[248:251]
ds_read_b128 v[148:151], v7 offset:256
ds_read_b128 v[152:155], v7 offset:320
v_mfma_f32_16x16x32_bf16 v[240:243], v[108:111], v[136:139], v[240:243]
ds_read_b64 v[92:93], v8 offset:0
ds_read_b64 v[94:95], v8 offset:128
v_mfma_f32_16x16x32_bf16 v[236:239], v[108:111], v[132:135], v[236:239]
ds_read_b64 v[96:97], v8 offset:256
ds_read_b64 v[98:99], v8 offset:384
v_mfma_f32_16x16x32_bf16 v[228:231], v[104:107], v[132:135], v[228:231]
ds_read2_b32 v[56:57], v54 offset0:128 offset1:144
v_xor_b32 v10, s48, v10
v_mfma_f32_16x16x32_bf16 v[232:235], v[104:107], v[136:139], v[232:235]
ds_read_b128 v[60:63], v9 offset:0
v_xor_b32 v11, s48, v11
v_mfma_f32_16x16x32_bf16 v[224:227], v[100:103], v[136:139], v[224:227]
ds_read_b128 v[64:67], v9 offset:64
v_xor_b32 v12, s48, v12
v_mfma_f32_16x16x32_bf16 v[220:223], v[100:103], v[132:135], v[220:223]
ds_read_b128 v[68:71], v9 offset:128
v_xor_b32 v13, s48, v13
v_mfma_f32_16x16x32_bf16 v[156:159], v[116:119], v[100:103], v[156:159]
ds_read_b128 v[72:75], v9 offset:192
v_xor_b32 v14, s48, v14
v_mfma_f32_16x16x32_bf16 v[164:167], v[116:119], v[104:107], v[164:167]
ds_read_b128 v[76:79], v9 offset:512
v_xor_b32 v15, s48, v15
v_mfma_f32_16x16x32_bf16 v[172:175], v[116:119], v[108:111], v[172:175]
ds_read_b128 v[80:83], v9 offset:576
v_xor_b32 v16, s48, v16
v_mfma_f32_16x16x32_bf16 v[180:183], v[116:119], v[112:115], v[180:183]
ds_read_b128 v[84:87], v9 offset:640
v_xor_b32 v17, s48, v17
v_mfma_f32_16x16x32_bf16 v[184:187], v[120:123], v[112:115], v[184:187]
ds_read_b128 v[88:91], v9 offset:704
v_mfma_f32_16x16x32_bf16 v[176:179], v[120:123], v[108:111], v[176:179]
v_mfma_f32_16x16x32_bf16 v[168:171], v[120:123], v[104:107], v[168:171]
v_mfma_f32_16x16x32_bf16 v[160:163], v[120:123], v[100:103], v[160:163]
c1_epi:
s_waitcnt lgkmcnt(0)
.p2align 3
v_mul_f32 v129, s66, v94
v_mul_f32 v128, s66, v92
v_mul_f32 v131, s66, v98
v_mul_f32 v130, s66, v96
v_pk_fma_f32 v[190:191], v[150:151], v[92:93], v[190:191] op_sel:[0,1,0] op_sel_hi:[1,1,1]
v_pk_fma_f32 v[212:213], v[148:149], v[98:99], v[212:213] op_sel:[0,1,0] op_sel_hi:[1,1,1]
v_pk_fma_f32 v[214:215], v[150:151], v[98:99], v[214:215] op_sel:[0,1,0] op_sel_hi:[1,1,1]
v_pk_fma_f32 v[188:189], v[148:149], v[92:93], v[188:189] op_sel:[0,1,0] op_sel_hi:[1,1,1]
v_pk_fma_f32 v[218:219], v[154:155], v[98:99], v[218:219] op_sel:[0,1,0] op_sel_hi:[1,1,1]
v_cvt_pk_bf16_f32 v188, v188, v189
v_cvt_pk_bf16_f32 v189, v190, v191
v_pk_fma_f32 v[196:197], v[148:149], v[94:95], v[196:197] op_sel:[0,1,0] op_sel_hi:[1,1,1]
v_pk_fma_f32 v[200:201], v[152:153], v[94:95], v[200:201] op_sel:[0,1,0] op_sel_hi:[1,1,1]
v_pk_fma_f32 v[210:211], v[154:155], v[96:97], v[210:211] op_sel:[0,1,0] op_sel_hi:[1,1,1]
v_pk_fma_f32 v[240:241], v[84:85], v[56:57], v[240:241] op_sel:[0,1,0] op_sel_hi:[1,1,1]
v_pk_fma_f32 v[228:229], v[80:81], v[56:57], v[228:229] op_sel:[0,0,0] op_sel_hi:[1,0,1]
v_pk_fma_f32 v[226:227], v[78:79], v[56:57], v[226:227] op_sel:[0,1,0] op_sel_hi:[1,1,1]
v_pk_fma_f32 v[192:193], v[152:153], v[92:93], v[192:193] op_sel:[0,1,0] op_sel_hi:[1,1,1]
v_cvt_pk_bf16_f32 v190, v192, v193
v_pk_fma_f32 v[238:239], v[86:87], v[56:57], v[238:239] op_sel:[0,0,0] op_sel_hi:[1,0,1]
v_pk_fma_f32 v[234:235], v[82:83], v[56:57], v[234:235] op_sel:[0,1,0] op_sel_hi:[1,1,1]
v_pk_mul_f32 v[226:227], v[226:227], v[62:63]
v_pk_fma_f32 v[204:205], v[148:149], v[96:97], v[204:205] op_sel:[0,1,0] op_sel_hi:[1,1,1]
v_cvt_pk_bf16_f32 v204, v204, v205
v_pk_fma_f32 v[202:203], v[154:155], v[94:95], v[202:203] op_sel:[0,1,0] op_sel_hi:[1,1,1]
v_pk_fma_f32 v[224:225], v[76:77], v[56:57], v[224:225] op_sel:[0,1,0] op_sel_hi:[1,1,1]
v_pk_fma_f32 v[216:217], v[152:153], v[98:99], v[216:217] op_sel:[0,1,0] op_sel_hi:[1,1,1]
v_pk_fma_f32 v[244:245], v[88:89], v[56:57], v[244:245] op_sel:[0,0,0] op_sel_hi:[1,0,1]
v_pk_mul_f32 v[238:239], v[238:239], v[70:71]
v_pk_mul_f32 v[228:229], v[228:229], v[64:65]
v_pk_fma_f32 v[236:237], v[84:85], v[56:57], v[236:237] op_sel:[0,0,0] op_sel_hi:[1,0,1]
v_pk_fma_f32 v[220:221], v[76:77], v[56:57], v[220:221] op_sel:[0,0,0] op_sel_hi:[1,0,1]
v_pk_mul_f32 v[224:225], v[224:225], v[60:61]
v_cvt_pk_bf16_f32 v212, v212, v213
v_cvt_pk_bf16_f32 v213, v214, v215
v_cvt_pk_bf16_f32 v196, v196, v197
v_pk_mul_f32 v[240:241], v[240:241], v[68:69]
v_pk_fma_f32 v[198:199], v[150:151], v[94:95], v[198:199] op_sel:[0,1,0] op_sel_hi:[1,1,1]
v_cvt_pk_bf16_f32 v197, v198, v199
v_cvt_pk_bf16_f32 v198, v200, v201
v_cvt_pk_bf16_f32 v199, v202, v203
v_cvt_pk_bf16_f32 v215, v218, v219
v_pk_fma_f32 v[208:209], v[152:153], v[96:97], v[208:209] op_sel:[0,1,0] op_sel_hi:[1,1,1]
v_pk_fma_f32 v[246:247], v[90:91], v[56:57], v[246:247] op_sel:[0,0,0] op_sel_hi:[1,0,1]
v_pk_fma_f32 v[250:251], v[90:91], v[56:57], v[250:251] op_sel:[0,1,0] op_sel_hi:[1,1,1]
v_pk_mul_f32 v[250:251], v[250:251], v[74:75]
v_pk_fma_f32 v[206:207], v[150:151], v[96:97], v[206:207] op_sel:[0,1,0] op_sel_hi:[1,1,1]
v_cvt_pk_bf16_f32 v205, v206, v207
v_pk_fma_f32 v[242:243], v[86:87], v[56:57], v[242:243] op_sel:[0,1,0] op_sel_hi:[1,1,1]
v_cvt_pk_bf16_f32 v207, v210, v211
v_pk_mul_f32 v[236:237], v[236:237], v[68:69]
v_pk_fma_f32 v[230:231], v[82:83], v[56:57], v[230:231] op_sel:[0,0,0] op_sel_hi:[1,0,1]
v_pk_fma_f32 v[194:195], v[154:155], v[92:93], v[194:195] op_sel:[0,1,0] op_sel_hi:[1,1,1]
v_cvt_pk_bf16_f32 v191, v194, v195
v_pk_fma_f32 v[232:233], v[80:81], v[56:57], v[232:233] op_sel:[0,1,0] op_sel_hi:[1,1,1]
v_pk_mul_f32 v[232:233], v[232:233], v[64:65]
v_pk_mul_f32 v[230:231], v[230:231], v[66:67]
v_pk_fma_f32 v[248:249], v[88:89], v[56:57], v[248:249] op_sel:[0,1,0] op_sel_hi:[1,1,1]
v_pk_mul_f32 v[248:249], v[248:249], v[72:73]
v_pk_mul_f32 v[242:243], v[242:243], v[70:71]
v_mfma_f32_16x16x32_bf16 v[68:71], v[10:13], v[196:199], 0
v_cvt_pk_bf16_f32 v206, v208, v209
v_cvt_pk_bf16_f32 v214, v216, v217
v_cvt_pk_bf16_f32 v121, v226, v227
v_mfma_f32_16x16x32_bf16 v[80:83], v[14:17], v[204:207], 0
v_cvt_pk_bf16_f32 v120, v224, v225
v_cvt_pk_bf16_f32 v114, v228, v229
v_mfma_f32_16x16x32_bf16 v[84:87], v[10:13], v[212:215], 0
v_cvt_pk_bf16_f32 v116, v236, v237
v_min3_f32 v105, v68, v69, v70
v_mfma_f32_16x16x32_bf16 v[88:91], v[14:17], v[212:215], 0
v_max3_f32 v101, v68, v69, v70
v_cvt_pk_bf16_f32 v115, v230, v231
v_cvt_pk_bf16_f32 v122, v232, v233
v_cvt_pk_bf16_f32 v127, v250, v251
v_cvt_pk_bf16_f32 v124, v240, v241
v_pk_mul_f32 v[244:245], v[244:245], v[72:73]
v_pk_fma_f32 v[222:223], v[78:79], v[56:57], v[222:223] op_sel:[0,0,0] op_sel_hi:[1,0,1]
v_pk_mul_f32 v[222:223], v[222:223], v[62:63]
v_mfma_f32_16x16x32_bf16 v[76:79], v[10:13], v[204:207], 0
v_min3_f32 v107, v84, v85, v86
v_min3_f32 v107, v107, v87, v88
v_min3_f32 v107, v107, v89, v90
v_min_f32_e64 v107, v107, v91
v_max3_f32 v103, v84, v85, v86
v_pk_mul_f32 v[220:221], v[220:221], v[60:61]
v_mfma_f32_16x16x32_bf16 v[60:63], v[10:13], v[188:191], 0
v_max3_f32 v103, v103, v87, v88
v_min3_f32 v106, v76, v77, v78
v_min3_f32 v106, v106, v79, v80
v_min3_f32 v106, v106, v81, v82
v_min_f32 v106, v106, v83
v_pk_mul_f32 v[234:235], v[234:235], v[66:67]
v_mfma_f32_16x16x32_bf16 v[64:67], v[14:17], v[188:191], 0
v_permlane32_swap_b32 v106, v107
v_min3_f32 v104, v60, v61, v62
v_min_f32 v106, v106, v107
v_max3_f32 v103, v103, v89, v90
v_pk_mul_f32 v[246:247], v[246:247], v[74:75]
v_mfma_f32_16x16x32_bf16 v[72:75], v[14:17], v[196:199], 0
v_max_f32 v103, v103, v91
v_max3_f32 v102, v76, v77, v78
v_min3_f32 v104, v104, v63, v64
v_min3_f32 v104, v104, v65, v66
v_min_f32 v104, v104, v67
v_max3_f32 v102, v102, v79, v80
v_max3_f32 v102, v102, v81, v82
v_max_f32 v102, v102, v83
v_min3_f32 v105, v105, v71, v72
v_min3_f32 v105, v105, v73, v74
v_min_f32 v105, v105, v75
v_max3_f32 v101, v101, v71, v72
v_max3_f32 v101, v101, v73, v74
v_permlane32_swap_b32 v104, v105
v_permlane32_swap_b32 v102, v103
v_min_f32 v104, v104, v105
v_max_f32 v102, v102, v103
v_max_f32 v101, v101, v75
v_permlane16_swap_b32 v104, v106
v_max3_f32 v100, v60, v61, v62
v_min_f32 v104, v104, v106
v_mov_b32 v106, v104
v_max3_f32 v100, v100, v63, v64
v_max3_f32 v100, v100, v65, v66
v_max_f32 v100, v100, v67
v_permlane16_swap_b32 v104, v106
v_cvt_pk_bf16_f32 v112, v220, v221
v_permlane32_swap_b32 v100, v101
v_mov_b32 v105, v104
v_max_f32 v100, v100, v101
v_mov_b32 v107, v106
v_permlane32_swap_b32 v104, v105
v_permlane16_swap_b32 v100, v102
v_pk_mul_f32 v[104:105], v[104:105], v[128:129]
v_pk_fma_f32 v[226:227], v[66:67], v[128:129], v[104:105] op_sel:[0,0,0] op_sel_hi:[1,0,0] neg_lo:[1,0,0] neg_hi:[1,0,0]
v_pk_fma_f32 v[230:231], v[70:71], v[128:129], v[104:105] op_sel:[0,1,1] op_sel_hi:[1,1,1] neg_lo:[1,0,0] neg_hi:[1,0,0]
v_exp_f32 v226, v226
v_pk_fma_f32 v[224:225], v[64:65], v[128:129], v[104:105] op_sel:[0,0,0] op_sel_hi:[1,0,0] neg_lo:[1,0,0] neg_hi:[1,0,0]
v_exp_f32 v224, v224
v_pk_fma_f32 v[228:229], v[68:69], v[128:129], v[104:105] op_sel:[0,1,1] op_sel_hi:[1,1,1] neg_lo:[1,0,0] neg_hi:[1,0,0]
v_exp_f32 v231, v231
v_cvt_pk_bf16_f32 v113, v222, v223
v_pk_fma_f32 v[222:223], v[62:63], v[128:129], v[104:105] op_sel:[0,0,0] op_sel_hi:[1,0,0] neg_lo:[1,0,0] neg_hi:[1,0,0]
v_exp_f32 v222, v222
v_pk_fma_f32 v[220:221], v[60:61], v[128:129], v[104:105] op_sel:[0,0,0] op_sel_hi:[1,0,0] neg_lo:[1,0,0] neg_hi:[1,0,0]
v_exp_f32 v221, v221
v_exp_f32 v220, v220
v_max_f32 v100, v100, v102
v_exp_f32 v223, v223
v_mov_b32 v102, v100
v_pk_add_f32 v[110:111], v[220:221], v[222:223]
v_exp_f32 v225, v225
v_pk_fma_f32 v[232:233], v[72:73], v[128:129], v[104:105] op_sel:[0,1,1] op_sel_hi:[1,1,1] neg_lo:[1,0,0] neg_hi:[1,0,0]
v_exp_f32 v232, v232
v_exp_f32 v233, v233
v_pk_add_f32 v[110:111], v[110:111], v[224:225]
v_exp_f32 v229, v229
v_exp_f32 v228, v228
v_exp_f32 v227, v227
v_cvt_pk_bf16_f32 v123, v234, v235
v_pk_fma_f32 v[234:235], v[74:75], v[128:129], v[104:105] op_sel:[0,1,1] op_sel_hi:[1,1,1] neg_lo:[1,0,0] neg_hi:[1,0,0]
v_pk_add_f32 v[110:111], v[110:111], v[226:227]
v_add_f32 v104, v110, v111
v_cvt_pk_bf16_f32 v118, v244, v245
v_permlane32_swap_b32 v106, v107
v_permlane16_swap_b32 v100, v102
v_exp_f32 v234, v234
v_mov_b32 v101, v100
v_exp_f32 v235, v235
v_exp_f32_e64 v230, v230
v_cvt_pk_bf16_f32 v125, v242, v243
v_pk_add_f32 v[110:111], v[228:229], v[230:231]
v_pk_add_f32 v[110:111], v[110:111], v[232:233]
v_pk_add_f32 v[110:111], v[110:111], v[234:235]
v_cvt_pk_bf16_f32 v126, v248, v249
v_pk_mul_f32 v[106:107], v[106:107], v[130:131]
v_pk_fma_f32 v[236:237], v[76:77], v[130:131], v[106:107] op_sel:[0,0,0] op_sel_hi:[1,0,0] neg_lo:[1,0,0] neg_hi:[1,0,0]
v_exp_f32 v237, v237
v_exp_f32 v236, v236
v_pk_fma_f32 v[242:243], v[82:83], v[130:131], v[106:107] op_sel:[0,0,0] op_sel_hi:[1,0,0] neg_lo:[1,0,0] neg_hi:[1,0,0]
v_pk_fma_f32 v[250:251], v[90:91], v[130:131], v[106:107] op_sel:[0,1,1] op_sel_hi:[1,1,1] neg_lo:[1,0,0] neg_hi:[1,0,0]
v_add_f32 v105, v110, v111
v_exp_f32 v243, v243
v_cvt_pk_bf16_f32 v119, v246, v247
v_pk_fma_f32 v[246:247], v[86:87], v[130:131], v[106:107] op_sel:[0,1,1] op_sel_hi:[1,1,1] neg_lo:[1,0,0] neg_hi:[1,0,0]
v_exp_f32 v246, v246
v_cvt_pk_bf16_f32 v117, v238, v239
v_pk_fma_f32 v[238:239], v[78:79], v[130:131], v[106:107] op_sel:[0,0,0] op_sel_hi:[1,0,0] neg_lo:[1,0,0] neg_hi:[1,0,0]
v_exp_f32 v238, v238
v_exp_f32 v247, v247
v_pk_fma_f32 v[240:241], v[80:81], v[130:131], v[106:107] op_sel:[0,0,0] op_sel_hi:[1,0,0] neg_lo:[1,0,0] neg_hi:[1,0,0]
v_exp_f32 v240, v240
v_exp_f32 v241, v241
v_permlane32_swap_b32 v100, v101
v_exp_f32 v242, v242
v_pk_fma_f32 v[244:245], v[84:85], v[130:131], v[106:107] op_sel:[0,1,1] op_sel_hi:[1,1,1] neg_lo:[1,0,0] neg_hi:[1,0,0]
v_exp_f32 v244, v244
v_exp_f32_e64 v239, v239
v_pk_mul_f32 v[100:101], v[100:101], v[128:129]
v_pk_fma_f32 v[62:63], v[62:63], v[128:129], v[100:101] op_sel:[0,0,0] op_sel_hi:[1,0,0] neg_lo:[0,0,1] neg_hi:[0,0,1]
v_pk_add_f32 v[110:111], v[236:237], v[238:239]
v_pk_add_f32 v[110:111], v[110:111], v[240:241]
v_pk_add_f32 v[110:111], v[110:111], v[242:243]
v_pk_fma_f32 v[72:73], v[72:73], v[128:129], v[100:101] op_sel:[0,1,1] op_sel_hi:[1,1,1] neg_lo:[0,0,1] neg_hi:[0,0,1]
v_pk_fma_f32 v[66:67], v[66:67], v[128:129], v[100:101] op_sel:[0,0,0] op_sel_hi:[1,0,0] neg_lo:[0,0,1] neg_hi:[0,0,1]
v_exp_f32 v62, v62
v_pk_fma_f32 v[60:61], v[60:61], v[128:129], v[100:101] op_sel:[0,0,0] op_sel_hi:[1,0,0] neg_lo:[0,0,1] neg_hi:[0,0,1]
v_exp_f32 v60, v60
v_exp_f32 v245, v245
v_exp_f32 v73, v73
v_pk_fma_f32 v[248:249], v[88:89], v[130:131], v[106:107] op_sel:[0,1,1] op_sel_hi:[1,1,1] neg_lo:[1,0,0] neg_hi:[1,0,0]
v_add_f32 v106, v110, v111
v_exp_f32 v249, v249
v_pk_add_f32 v[110:111], v[244:245], v[246:247]
v_exp_f32 v248, v248
v_pk_fma_f32 v[64:65], v[64:65], v[128:129], v[100:101] op_sel:[0,0,0] op_sel_hi:[1,0,0] neg_lo:[0,0,1] neg_hi:[0,0,1]
v_exp_f32 v64, v64
v_pk_add_f32 v[110:111], v[110:111], v[248:249]
v_exp_f32 v65, v65
v_exp_f32 v61, v61
v_exp_f32 v66, v66
v_exp_f32 v251, v251
v_exp_f32 v63, v63
v_pk_fma_f32 v[74:75], v[74:75], v[128:129], v[100:101] op_sel:[0,1,1] op_sel_hi:[1,1,1] neg_lo:[0,0,1] neg_hi:[0,0,1]
v_pk_add_f32 v[108:109], v[60:61], v[62:63]
v_exp_f32 v67, v67
v_exp_f32 v250, v250
v_pk_fma_f32 v[68:69], v[68:69], v[128:129], v[100:101] op_sel:[0,1,1] op_sel_hi:[1,1,1] neg_lo:[0,0,1] neg_hi:[0,0,1]
v_pk_add_f32 v[110:111], v[110:111], v[250:251]
v_exp_f32 v68, v68
v_exp_f32 v69, v69
v_add_f32 v107, v110, v111
v_mov_b32 v103, v102
v_pk_fma_f32 v[70:71], v[70:71], v[128:129], v[100:101] op_sel:[0,1,1] op_sel_hi:[1,1,1] neg_lo:[0,0,1] neg_hi:[0,0,1]
v_exp_f32 v71, v71
v_exp_f32 v70, v70
v_permlane32_swap_b32 v106, v107
v_permlane32_swap_b32 v102, v103
v_pk_add_f32 v[108:109], v[108:109], v[64:65]
v_pk_add_f32 v[108:109], v[108:109], v[66:67]
v_add_f32 v100, v108, v109
v_pk_add_f32 v[108:109], v[68:69], v[70:71]
v_pk_mul_f32 v[102:103], v[102:103], v[130:131]
v_pk_fma_f32 v[78:79], v[78:79], v[130:131], v[102:103] op_sel:[0,0,0] op_sel_hi:[1,0,0] neg_lo:[0,0,1] neg_hi:[0,0,1]
v_exp_f32 v79, v79
v_exp_f32 v78, v78
v_exp_f32 v74, v74
v_exp_f32 v72, v72
v_pk_fma_f32 v[86:87], v[86:87], v[130:131], v[102:103] op_sel:[0,1,1] op_sel_hi:[1,1,1] neg_lo:[0,0,1] neg_hi:[0,0,1]
v_exp_f32 v87, v87
v_pk_fma_f32 v[76:77], v[76:77], v[130:131], v[102:103] op_sel:[0,0,0] op_sel_hi:[1,0,0] neg_lo:[0,0,1] neg_hi:[0,0,1]
v_exp_f32 v77, v77
v_add_f32 v106, v106, v107
v_pk_fma_f32 v[80:81], v[80:81], v[130:131], v[102:103] op_sel:[0,0,0] op_sel_hi:[1,0,0] neg_lo:[0,0,1] neg_hi:[0,0,1]
v_exp_f32 v81, v81
v_exp_f32 v80, v80
v_pk_add_f32 v[108:109], v[108:109], v[72:73]
v_permlane32_swap_b32 v104, v105
v_exp_f32 v75, v75
v_add_f32 v104, v104, v105
v_pk_fma_f32 v[82:83], v[82:83], v[130:131], v[102:103] op_sel:[0,0,0] op_sel_hi:[1,0,0] neg_lo:[0,0,1] neg_hi:[0,0,1]
v_exp_f32 v82, v82
v_exp_f32 v83, v83
v_permlane16_swap_b32 v104, v106
v_pk_add_f32 v[108:109], v[108:109], v[74:75]
v_add_f32 v101, v108, v109
v_exp_f32 v76, v76
v_add_f32 v104, v104, v106
v_rcp_f32 v104, v104
v_pk_fma_f32 v[84:85], v[84:85], v[130:131], v[102:103] op_sel:[0,1,1] op_sel_hi:[1,1,1] neg_lo:[0,0,1] neg_hi:[0,0,1]
v_exp_f32 v84, v84
v_exp_f32 v85, v85
v_mov_b32 v106, v104
v_pk_add_f32 v[108:109], v[76:77], v[78:79]
v_pk_add_f32 v[108:109], v[108:109], v[80:81]
v_pk_add_f32 v[108:109], v[108:109], v[82:83]
v_pk_fma_f32 v[88:89], v[88:89], v[130:131], v[102:103] op_sel:[0,1,1] op_sel_hi:[1,1,1] neg_lo:[0,0,1] neg_hi:[0,0,1]
v_exp_f32 v88, v88
v_exp_f32 v89, v89
v_exp_f32 v86, v86
v_pk_fma_f32 v[90:91], v[90:91], v[130:131], v[102:103] op_sel:[0,1,1] op_sel_hi:[1,1,1] neg_lo:[0,0,1] neg_hi:[0,0,1]
v_add_f32 v102, v108, v109
v_pk_add_f32 v[108:109], v[84:85], v[86:87]
v_pk_add_f32 v[108:109], v[108:109], v[88:89]
v_permlane16_swap_b32 v104, v106
v_exp_f32 v90, v90
v_exp_f32 v91, v91
v_permlane32_swap_b32 v100, v101
v_pk_add_f32 v[108:109], v[108:109], v[90:91]
v_add_f32 v103, v108, v109
v_add_f32 v100, v100, v101
v_mov_b32 v105, v104
v_permlane32_swap_b32 v102, v103
v_mov_b32 v107, v106
v_add_f32 v102, v102, v103
v_permlane32_swap_b32 v104, v105
v_permlane32_swap_b32 v106, v107
v_permlane16_swap_b32 v100, v102
v_pk_mul_f32 v[222:223], v[222:223], v[104:105] op_sel:[0,0] op_sel_hi:[1,0]
v_pk_mul_f32 v[226:227], v[226:227], v[104:105] op_sel:[0,0] op_sel_hi:[1,0]
v_pk_mul_f32 v[234:235], v[234:235], v[104:105] op_sel:[0,1] op_sel_hi:[1,1]
v_pk_mul_f32 v[232:233], v[232:233], v[104:105] op_sel:[0,1] op_sel_hi:[1,1]
v_pk_mul_f32 v[230:231], v[230:231], v[104:105] op_sel:[0,1] op_sel_hi:[1,1]
v_add_f32 v100, v100, v102
v_pk_mul_f32 v[228:229], v[228:229], v[104:105] op_sel:[0,1] op_sel_hi:[1,1]
v_cvt_pk_bf16_f32 v228, v228, v229
v_cvt_pk_bf16_f32 v229, v230, v231
v_cvt_pk_bf16_f32 v231, v234, v235
v_cvt_pk_bf16_f32 v230, v232, v233
v_pk_mul_f32 v[220:221], v[220:221], v[104:105] op_sel:[0,0] op_sel_hi:[1,0]
v_cvt_pk_bf16_f32 v220, v220, v221
v_pk_mul_f32 v[224:225], v[224:225], v[104:105] op_sel:[0,0] op_sel_hi:[1,0]
v_pk_mul_f32 v[236:237], v[236:237], v[106:107] op_sel:[0,0] op_sel_hi:[1,0]
v_pk_mul_f32 v[238:239], v[238:239], v[106:107] op_sel:[0,0] op_sel_hi:[1,0]
v_pk_mul_f32 v[240:241], v[240:241], v[106:107] op_sel:[0,0] op_sel_hi:[1,0]
v_pk_mul_f32 v[242:243], v[242:243], v[106:107] op_sel:[0,0] op_sel_hi:[1,0]
v_pk_mul_f32 v[248:249], v[248:249], v[106:107] op_sel:[0,1] op_sel_hi:[1,1]
v_rcp_f32 v100, v100
v_pk_mul_f32 v[244:245], v[244:245], v[106:107] op_sel:[0,1] op_sel_hi:[1,1]
v_mov_b32 v102, v100
v_pk_mul_f32 v[250:251], v[250:251], v[106:107] op_sel:[0,1] op_sel_hi:[1,1]
v_cvt_pk_bf16_f32 v221, v222, v223
v_pk_mul_f32 v[246:247], v[246:247], v[106:107] op_sel:[0,1] op_sel_hi:[1,1]
v_cvt_pk_bf16_f32 v222, v224, v225
v_mfma_f32_16x16x32_bf16 v[200:203], v[228:231], v[36:39], 0
v_cvt_pk_bf16_f32 v223, v226, v227
v_permlane16_swap_b32 v100, v102
v_mfma_f32_16x16x32_bf16 v[196:199], v[228:231], v[38:41], 0
v_mov_b32 v101, v100
v_cvt_pk_bf16_f32 v244, v244, v245
v_mfma_f32_16x16x32_bf16 v[212:215], v[220:223], v[38:41], 0
v_cvt_pk_bf16_f32 v245, v246, v247
v_cvt_pk_bf16_f32 v247, v250, v251
v_mfma_f32_16x16x32_bf16 v[216:219], v[220:223], v[36:39], 0
v_cvt_pk_bf16_f32 v234, v200, v201
v_cvt_pk_bf16_f32 v246, v248, v249
v_cvt_pk_bf16_f32 v226, v196, v197
v_cvt_pk_bf16_f32 v227, v198, v199
v_mfma_f32_16x16x32_bf16 v[196:199], v[244:247], v[38:41], 0
v_cvt_pk_bf16_f32 v225, v214, v215
v_cvt_pk_bf16_f32 v236, v236, v237
v_cvt_pk_bf16_f32 v237, v238, v239
v_cvt_pk_bf16_f32 v232, v216, v217
v_cvt_pk_bf16_f32 v233, v218, v219
v_cvt_pk_bf16_f32 v239, v242, v243
v_cvt_pk_bf16_f32 v238, v240, v241
v_cvt_pk_bf16_f32 v224, v212, v213
v_permlane32_swap_b32 v100, v101
v_mfma_f32_16x16x32_bf16 v[216:219], v[236:239], v[36:39], 0
v_mov_b32 v103, v102
v_cvt_pk_bf16_f32 v235, v202, v203
v_mfma_f32_16x16x32_bf16 v[212:215], v[236:239], v[38:41], 0
v_cvt_pk_bf16_f32 v243, v198, v199
v_permlane32_swap_b32 v102, v103
v_mfma_f32_16x16x32_bf16 v[200:203], v[244:247], v[36:39], 0
v_cvt_pk_bf16_f32 v242, v196, v197
v_mov_b32 v5, s61
v_mfma_f32_16x16x32_bf16 v[220:223], v[232:235], v[120:123], 0
v_cvt_pk_bf16_f32 v249, v218, v219
v_cvt_pk_bf16_f32 v248, v216, v217
v_cvt_pk_bf16_f32 v241, v214, v215
v_cvt_pk_bf16_f32 v240, v212, v213
v_cmp_eq_u32 s[50:51], s41, v2
v_pk_mul_f32 v[64:65], v[64:65], v[100:101] op_sel:[0,0] op_sel_hi:[1,0]
v_pk_mul_f32 v[74:75], v[74:75], v[100:101] op_sel:[0,1] op_sel_hi:[1,1]
v_pk_mul_f32 v[68:69], v[68:69], v[100:101] op_sel:[0,1] op_sel_hi:[1,1]
v_pk_mul_f32 v[72:73], v[72:73], v[100:101] op_sel:[0,1] op_sel_hi:[1,1]
v_pk_mul_f32 v[60:61], v[60:61], v[100:101] op_sel:[0,0] op_sel_hi:[1,0]
v_pk_mul_f32 v[62:63], v[62:63], v[100:101] op_sel:[0,0] op_sel_hi:[1,0]
v_pk_mul_f32 v[66:67], v[66:67], v[100:101] op_sel:[0,0] op_sel_hi:[1,0]
v_pk_mul_f32 v[76:77], v[76:77], v[102:103] op_sel:[0,0] op_sel_hi:[1,0]
v_pk_mul_f32 v[70:71], v[70:71], v[100:101] op_sel:[0,1] op_sel_hi:[1,1]
v_cvt_pk_bf16_f32 v60, v60, v61
v_pk_mul_f32 v[80:81], v[80:81], v[102:103] op_sel:[0,0] op_sel_hi:[1,0]
v_pk_mul_f32 v[78:79], v[78:79], v[102:103] op_sel:[0,0] op_sel_hi:[1,0]
v_pk_mul_f32 v[82:83], v[82:83], v[102:103] op_sel:[0,0] op_sel_hi:[1,0]
v_pk_mul_f32 v[86:87], v[86:87], v[102:103] op_sel:[0,1] op_sel_hi:[1,1]
v_cvt_pk_bf16_f32 v61, v62, v63
v_pk_mul_f32 v[84:85], v[84:85], v[102:103] op_sel:[0,1] op_sel_hi:[1,1]
v_cvt_pk_bf16_f32 v62, v64, v65
v_pk_mul_f32 v[88:89], v[88:89], v[102:103] op_sel:[0,1] op_sel_hi:[1,1]
v_cvt_pk_bf16_f32 v63, v66, v67
v_pk_mul_f32 v[90:91], v[90:91], v[102:103] op_sel:[0,1] op_sel_hi:[1,1]
v_cvt_pk_bf16_f32 v68, v68, v69
v_mfma_f32_16x16x32_bf16 v[208:211], v[60:63], v[36:39], 0
v_cvt_pk_bf16_f32 v69, v70, v71
v_cvt_pk_bf16_f32 v70, v72, v73
v_mfma_f32_16x16x32_bf16 v[204:207], v[60:63], v[38:41], 0
v_cvt_pk_bf16_f32 v71, v74, v75
v_cvt_pk_bf16_f32 v76, v76, v77
v_mfma_f32_16x16x32_bf16 v[60:63], v[232:235], v[112:115], 0
v_cvt_pk_bf16_f32 v250, v200, v201
v_cvt_pk_bf16_f32 v77, v78, v79
v_mfma_f32_16x16x32_bf16 v[192:195], v[68:71], v[36:39], 0
v_cvt_pk_bf16_f32 v78, v80, v81
v_cvt_pk_bf16_f32 v79, v82, v83
v_mfma_f32_16x16x32_bf16 v[188:191], v[68:71], v[38:41], 0
v_cvt_pk_bf16_f32 v65, v206, v207
v_cvt_pk_bf16_f32 v64, v204, v205
v_mfma_f32_16x16x32_bf16 v[68:71], v[224:227], v[120:123], 0
v_cvt_pk_bf16_f32 v251, v202, v203
v_cvt_pk_bf16_f32 v72, v208, v209
v_mfma_f32_16x16x32_bf16 v[152:155], v[224:227], v[112:115], 0
v_cvt_pk_bf16_f32 v73, v210, v211
v_cvt_pk_bf16_f32 v84, v84, v85
v_mfma_f32_16x16x32_bf16 v[60:63], v[248:251], v[116:119], v[60:63]
v_cvt_pk_bf16_f32 v85, v86, v87
v_cvt_pk_bf16_f32 v86, v88, v89
v_mfma_f32_16x16x32_bf16 v[228:231], v[224:227], v[48:51], 0
v_cvt_pk_bf16_f32 v67, v190, v191
v_cvt_pk_bf16_f32 v87, v90, v91
v_mfma_f32_16x16x32_bf16 v[220:223], v[248:251], v[124:127], v[220:223]
v_cvt_pk_bf16_f32 v66, v188, v189
v_cvt_pk_bf16_f32 v74, v192, v193
v_mfma_f32_16x16x32_bf16 v[152:155], v[240:243], v[116:119], v[152:155]
v_cvt_pk_bf16_f32 v75, v194, v195
v_mfma_f32_16x16x32_bf16 v[204:207], v[76:79], v[38:41], 0
v_mfma_f32_16x16x32_bf16 v[208:211], v[76:79], v[36:39], 0
v_mfma_f32_16x16x32_bf16 v[228:231], v[240:243], v[48:51], v[228:231]
v_mfma_f32_16x16x32_bf16 v[68:71], v[240:243], v[124:127], v[68:71]
v_mfma_f32_16x16x32_bf16 v[76:79], v[232:235], v[48:51], 0
s_nop 1
v_cvt_pk_bf16_f32 v152, v152, v153
v_mfma_f32_16x16x32_bf16 v[76:79], v[248:251], v[48:51], v[76:79]
v_cvt_pk_bf16_f32 v153, v154, v155
v_cvt_pk_bf16_f32 v154, v60, v61
v_mfma_f32_16x16x32_bf16 v[192:195], v[84:87], v[36:39], 0
v_cvt_pk_bf16_f32 v68, v68, v69
v_cvt_pk_bf16_f32 v155, v62, v63
v_mfma_f32_16x16x32_bf16 v[188:191], v[84:87], v[38:41], 0
ds_write_b128 v42, v[152:155] offset:0
v_mfma_f32_16x16x32_bf16 v[136:139], v[64:67], v[48:51], 0
v_cvt_pk_bf16_f32 v69, v70, v71
v_cvt_pk_bf16_f32 v228, v228, v229
v_mfma_f32_16x16x32_bf16 v[104:107], v[72:75], v[112:115], 0
v_cvt_pk_bf16_f32 v71, v222, v223
v_cvt_pk_bf16_f32 v229, v230, v231
v_mfma_f32_16x16x32_bf16 v[148:151], v[72:75], v[48:51], 0
v_cvt_pk_bf16_f32 v230, v76, v77
v_cvt_pk_bf16_f32 v70, v220, v221
v_mfma_f32_16x16x32_bf16 v[132:135], v[72:75], v[120:123], 0
ds_write_b128 v42, v[68:71] offset:1024
v_mfma_f32_16x16x32_bf16 v[108:111], v[64:67], v[120:123], 0
v_cvt_pk_bf16_f32 v231, v78, v79
ds_write_b128 v42, v[228:231] offset:2048
v_mfma_f32_16x16x32_bf16 v[100:103], v[64:67], v[112:115], 0
ds_write_b32 v52, v5
v_cvt_pk_bf16_f32 v88, v208, v209
v_cvt_pk_bf16_f32 v83, v190, v191
v_cvt_pk_bf16_f32 v91, v194, v195
v_cvt_pk_bf16_f32 v82, v188, v189
v_cvt_pk_bf16_f32 v80, v204, v205
v_cvt_pk_bf16_f32 v89, v210, v211
v_cvt_pk_bf16_f32 v81, v206, v207
v_cvt_pk_bf16_f32 v90, v192, v193
s_nop 0
v_mfma_f32_16x16x32_bf16 v[100:103], v[80:83], v[116:119], v[100:103]
v_mfma_f32_16x16x32_bf16 v[108:111], v[80:83], v[124:127], v[108:111]
v_mfma_f32_16x16x32_bf16 v[132:135], v[88:91], v[124:127], v[132:135]
v_mfma_f32_16x16x32_bf16 v[148:151], v[88:91], v[48:51], v[148:151]
v_mfma_f32_16x16x32_bf16 v[136:139], v[80:83], v[48:51], v[136:139]
v_mfma_f32_16x16x32_bf16 v[104:107], v[88:91], v[116:119], v[104:107]
s_mov_b32 s63, 0
px_82:
ds_read_b32 v4, v19
ds_read_b128 v[188:191], v43 offset:0
ds_read_b128 v[192:195], v43 offset:1024
ds_read_b128 v[196:199], v43 offset:2048
s_add_u32 s63, s63, 1
s_cmp_lt_u32 s63, 0x400000
s_waitcnt lgkmcnt(0)
v_cmp_ne_u32 vcc, s61, v4
s_cbranch_vccz pxd_83
s_cbranch_scc1 px_82
pxd_83:
v_mfma_f32_16x16x32_bf16 v[100:103], v[38:41], v[188:191], v[100:103]
v_mfma_f32_16x16x32_bf16 v[104:107], v[36:39], v[188:191], v[104:107]
v_mfma_f32_16x16x32_bf16 v[108:111], v[38:41], v[192:195], v[108:111]
v_mfma_f32_16x16x32_bf16 v[132:135], v[36:39], v[192:195], v[132:135]
v_mfma_f32_16x16x32_bf16 v[136:139], v[38:41], v[196:199], v[136:139]
v_mfma_f32_16x16x32_bf16 v[148:151], v[36:39], v[196:199], v[148:151]
s_nop 2
v_cvt_pk_bf16_f32 v100, v100, v101
v_cvt_pk_bf16_f32 v101, v102, v103
v_cvt_pk_bf16_f32 v102, v104, v105
v_cvt_pk_bf16_f32 v103, v106, v107
buffer_store_dwordx4 v[100:103], v55, s[32:35], s53 offen sc1
v_cvt_pk_bf16_f32 v108, v108, v109
v_cvt_pk_bf16_f32 v109, v110, v111
v_cvt_pk_bf16_f32 v110, v132, v133
v_cvt_pk_bf16_f32 v111, v134, v135
buffer_store_dwordx4 v[108:111], v55, s[32:35], s54 offen sc1
v_cvt_pk_bf16_f32 v136, v136, v137
v_cvt_pk_bf16_f32 v137, v138, v139
v_cvt_pk_bf16_f32 v138, v148, v149
v_cvt_pk_bf16_f32 v139, v150, v151
s_mov_b64 exec, s[50:51]
buffer_store_dwordx4 v[136:139], v58, s[32:35], s56 offen sc1
s_mov_b64 exec, -1
s_mov_b32 s51, 0
.p2align 3
v_pk_fma_f32 v[156:157], v[140:141], v[92:93], v[156:157] op_sel:[0,1,0] op_sel_hi:[1,1,1]
v_pk_fma_f32 v[164:165], v[140:141], v[94:95], v[164:165] op_sel:[0,1,0] op_sel_hi:[1,1,1]
v_pk_fma_f32 v[172:173], v[140:141], v[96:97], v[172:173] op_sel:[0,1,0] op_sel_hi:[1,1,1]
v_pk_fma_f32 v[180:181], v[140:141], v[98:99], v[180:181] op_sel:[0,1,0] op_sel_hi:[1,1,1]
v_pk_fma_f32 v[158:159], v[142:143], v[92:93], v[158:159] op_sel:[0,1,0] op_sel_hi:[1,1,1]
v_cvt_pk_bf16_f32 v156, v156, v157
v_pk_fma_f32 v[166:167], v[142:143], v[94:95], v[166:167] op_sel:[0,1,0] op_sel_hi:[1,1,1]
v_cvt_pk_bf16_f32 v164, v164, v165
v_pk_fma_f32 v[174:175], v[142:143], v[96:97], v[174:175] op_sel:[0,1,0] op_sel_hi:[1,1,1]
v_cvt_pk_bf16_f32 v172, v172, v173
v_pk_fma_f32 v[182:183], v[142:143], v[98:99], v[182:183] op_sel:[0,1,0] op_sel_hi:[1,1,1]
v_cvt_pk_bf16_f32 v180, v180, v181
v_pk_fma_f32 v[160:161], v[144:145], v[92:93], v[160:161] op_sel:[0,1,0] op_sel_hi:[1,1,1]
v_pk_fma_f32 v[162:163], v[146:147], v[92:93], v[162:163] op_sel:[0,1,0] op_sel_hi:[1,1,1]
v_cvt_pk_bf16_f32 v157, v158, v159
v_pk_fma_f32 v[168:169], v[144:145], v[94:95], v[168:169] op_sel:[0,1,0] op_sel_hi:[1,1,1]
v_pk_fma_f32 v[170:171], v[146:147], v[94:95], v[170:171] op_sel:[0,1,0] op_sel_hi:[1,1,1]
v_cvt_pk_bf16_f32 v165, v166, v167
v_pk_fma_f32 v[176:177], v[144:145], v[96:97], v[176:177] op_sel:[0,1,0] op_sel_hi:[1,1,1]
v_pk_fma_f32 v[178:179], v[146:147], v[96:97], v[178:179] op_sel:[0,1,0] op_sel_hi:[1,1,1]
v_cvt_pk_bf16_f32 v173, v174, v175
v_pk_fma_f32 v[184:185], v[144:145], v[98:99], v[184:185] op_sel:[0,1,0] op_sel_hi:[1,1,1]
v_pk_fma_f32 v[186:187], v[146:147], v[98:99], v[186:187] op_sel:[0,1,0] op_sel_hi:[1,1,1]
v_cvt_pk_bf16_f32 v181, v182, v183
v_cvt_pk_bf16_f32 v158, v160, v161
v_cvt_pk_bf16_f32 v159, v162, v163
v_cvt_pk_bf16_f32 v166, v168, v169
v_cvt_pk_bf16_f32 v167, v170, v171
v_mfma_f32_16x16x32_bf16 v[60:63], v[10:13], v[156:159], 0
v_cvt_pk_bf16_f32 v174, v176, v177
v_cvt_pk_bf16_f32 v175, v178, v179
v_mfma_f32_16x16x32_bf16 v[68:71], v[10:13], v[164:167], 0
v_cvt_pk_bf16_f32 v182, v184, v185
v_cvt_pk_bf16_f32 v183, v186, v187
v_mfma_f32_16x16x32_bf16 v[76:79], v[10:13], v[172:175], 0
s_nop 0
v_mfma_f32_16x16x32_bf16 v[84:87], v[10:13], v[180:183], 0
v_min3_f32 v104, v60, v61, v62
v_max3_f32 v100, v60, v61, v62
v_mfma_f32_16x16x32_bf16 v[64:67], v[14:17], v[156:159], 0
v_min3_f32 v105, v68, v69, v70
v_max3_f32 v101, v68, v69, v70
v_mfma_f32_16x16x32_bf16 v[72:75], v[14:17], v[164:167], 0
v_min3_f32 v106, v76, v77, v78
v_max3_f32 v102, v76, v77, v78
v_mfma_f32_16x16x32_bf16 v[80:83], v[14:17], v[172:175], 0
v_min3_f32 v107, v84, v85, v86
v_max3_f32 v103, v84, v85, v86
v_mfma_f32_16x16x32_bf16 v[88:91], v[14:17], v[180:183], 0
v_min3_f32 v104, v104, v63, v64
v_max3_f32 v100, v100, v63, v64
v_min3_f32 v105, v105, v71, v72
v_min3_f32 v104, v104, v65, v66
v_max3_f32 v101, v101, v71, v72
v_min3_f32 v106, v106, v79, v80
v_min3_f32 v105, v105, v73, v74
v_max3_f32 v102, v102, v79, v80
v_min3_f32 v107, v107, v87, v88
v_min3_f32 v106, v106, v81, v82
v_max3_f32 v103, v103, v87, v88
v_min3_f32 v107, v107, v89, v90
v_max3_f32 v100, v100, v65, v66
v_min_f32 v104, v104, v67
v_max3_f32 v101, v101, v73, v74
v_min_f32 v105, v105, v75
v_max3_f32 v102, v102, v81, v82
v_min_f32 v106, v106, v83
v_max3_f32 v103, v103, v89, v90
v_min_f32 v107, v107, v91
v_max_f32 v100, v100, v67
v_max_f32 v101, v101, v75
v_max_f32 v102, v102, v83
v_max_f32 v103, v103, v91
v_permlane32_swap_b32 v104, v105
v_permlane32_swap_b32 v106, v107
v_permlane32_swap_b32 v100, v101
v_permlane32_swap_b32 v102, v103
v_min_f32 v104, v104, v105
v_min_f32 v106, v106, v107
v_max_f32 v100, v100, v101
v_max_f32 v102, v102, v103
v_permlane16_swap_b32 v104, v106
s_nop 0
v_permlane16_swap_b32 v100, v102
v_min_f32 v104, v104, v106
v_max_f32 v100, v100, v102
v_mov_b32 v106, v104
v_mov_b32 v102, v100
s_nop 0
v_permlane16_swap_b32 v104, v106
v_permlane16_swap_b32 v100, v102
v_mov_b32 v105, v104
v_mov_b32 v101, v100
v_mov_b32 v103, v102
v_permlane32_swap_b32 v104, v105
v_mov_b32 v107, v106
v_permlane32_swap_b32_e64 v100, v101
v_pk_mul_f32 v[104:105], v[104:105], v[128:129]
v_pk_mul_f32 v[100:101], v[100:101], v[128:129]
v_pk_fma_f32 v[220:221], v[60:61], v[128:129], v[104:105] op_sel:[0,0,0] op_sel_hi:[1,0,0] neg_lo:[1,0,0] neg_hi:[1,0,0]
v_pk_fma_f32 v[222:223], v[62:63], v[128:129], v[104:105] op_sel:[0,0,0] op_sel_hi:[1,0,0] neg_lo:[1,0,0] neg_hi:[1,0,0]
v_pk_fma_f32 v[224:225], v[64:65], v[128:129], v[104:105] op_sel:[0,0,0] op_sel_hi:[1,0,0] neg_lo:[1,0,0] neg_hi:[1,0,0]
v_pk_fma_f32 v[226:227], v[66:67], v[128:129], v[104:105] op_sel:[0,0,0] op_sel_hi:[1,0,0] neg_lo:[1,0,0] neg_hi:[1,0,0]
v_pk_fma_f32 v[228:229], v[68:69], v[128:129], v[104:105] op_sel:[0,1,1] op_sel_hi:[1,1,1] neg_lo:[1,0,0] neg_hi:[1,0,0]
v_pk_fma_f32 v[230:231], v[70:71], v[128:129], v[104:105] op_sel:[0,1,1] op_sel_hi:[1,1,1] neg_lo:[1,0,0] neg_hi:[1,0,0]
v_pk_fma_f32 v[232:233], v[72:73], v[128:129], v[104:105] op_sel:[0,1,1] op_sel_hi:[1,1,1] neg_lo:[1,0,0] neg_hi:[1,0,0]
v_pk_fma_f32 v[234:235], v[74:75], v[128:129], v[104:105] op_sel:[0,1,1] op_sel_hi:[1,1,1] neg_lo:[1,0,0] neg_hi:[1,0,0]
v_permlane32_swap_b32 v102, v103
v_permlane32_swap_b32 v106, v107
v_pk_fma_f32 v[60:61], v[60:61], v[128:129], v[100:101] op_sel:[0,0,0] op_sel_hi:[1,0,0] neg_lo:[0,0,1] neg_hi:[0,0,1]
v_pk_fma_f32 v[62:63], v[62:63], v[128:129], v[100:101] op_sel:[0,0,0] op_sel_hi:[1,0,0] neg_lo:[0,0,1] neg_hi:[0,0,1]
v_pk_fma_f32 v[64:65], v[64:65], v[128:129], v[100:101] op_sel:[0,0,0] op_sel_hi:[1,0,0] neg_lo:[0,0,1] neg_hi:[0,0,1]
v_pk_fma_f32 v[66:67], v[66:67], v[128:129], v[100:101] op_sel:[0,0,0] op_sel_hi:[1,0,0] neg_lo:[0,0,1] neg_hi:[0,0,1]
v_pk_fma_f32 v[68:69], v[68:69], v[128:129], v[100:101] op_sel:[0,1,1] op_sel_hi:[1,1,1] neg_lo:[0,0,1] neg_hi:[0,0,1]
v_pk_fma_f32 v[70:71], v[70:71], v[128:129], v[100:101] op_sel:[0,1,1] op_sel_hi:[1,1,1] neg_lo:[0,0,1] neg_hi:[0,0,1]
v_pk_fma_f32 v[72:73], v[72:73], v[128:129], v[100:101] op_sel:[0,1,1] op_sel_hi:[1,1,1] neg_lo:[0,0,1] neg_hi:[0,0,1]
v_pk_fma_f32 v[74:75], v[74:75], v[128:129], v[100:101] op_sel:[0,1,1] op_sel_hi:[1,1,1] neg_lo:[0,0,1] neg_hi:[0,0,1]
v_exp_f32 v220, v220
v_exp_f32 v60, v60
v_exp_f32 v221, v221
v_exp_f32 v61, v61
v_exp_f32 v222, v222
v_exp_f32 v62, v62
v_exp_f32 v223, v223
v_exp_f32 v63, v63
v_exp_f32 v224, v224
v_exp_f32 v64, v64
v_exp_f32 v225, v225
v_exp_f32 v65, v65
v_exp_f32 v226, v226
v_exp_f32 v66, v66
v_exp_f32 v227, v227
v_exp_f32 v67, v67
v_exp_f32 v228, v228
v_exp_f32 v68, v68
v_exp_f32 v229, v229
v_exp_f32 v69, v69
v_exp_f32 v230, v230
v_exp_f32 v70, v70
v_exp_f32 v231, v231
v_exp_f32 v71, v71
v_exp_f32 v232, v232
v_exp_f32 v72, v72
v_exp_f32 v233, v233
v_exp_f32 v73, v73
v_exp_f32 v234, v234
v_exp_f32 v74, v74
v_exp_f32 v235, v235
v_exp_f32 v75, v75
v_pk_mul_f32 v[102:103], v[102:103], v[130:131]
v_pk_mul_f32 v[106:107], v[106:107], v[130:131]
buffer_load_dwordx4 v[212:215], v18, s[32:35], s55 offen offset:0 sc1
buffer_load_dwordx4 v[216:219], v18, s[32:35], s55 offen offset:1024 sc1
.p2align 3
v_pk_add_f32 v[108:109], v[60:61], v[62:63]
v_pk_add_f32 v[110:111], v[220:221], v[222:223]
v_pk_add_f32 v[108:109], v[108:109], v[64:65]
v_pk_add_f32 v[110:111], v[110:111], v[224:225]
v_pk_add_f32 v[108:109], v[108:109], v[66:67]
v_pk_add_f32 v[110:111], v[110:111], v[226:227]
v_add_f32 v100, v108, v109
v_add_f32 v104, v110, v111
v_pk_fma_f32 v[236:237], v[76:77], v[130:131], v[106:107] op_sel:[0,0,0] op_sel_hi:[1,0,0] neg_lo:[1,0,0] neg_hi:[1,0,0]
v_pk_fma_f32 v[238:239], v[78:79], v[130:131], v[106:107] op_sel:[0,0,0] op_sel_hi:[1,0,0] neg_lo:[1,0,0] neg_hi:[1,0,0]
v_pk_add_f32 v[108:109], v[68:69], v[70:71]
v_pk_add_f32 v[110:111], v[228:229], v[230:231]
v_pk_fma_f32 v[76:77], v[76:77], v[130:131], v[102:103] op_sel:[0,0,0] op_sel_hi:[1,0,0] neg_lo:[0,0,1] neg_hi:[0,0,1]
v_pk_fma_f32 v[78:79], v[78:79], v[130:131], v[102:103] op_sel:[0,0,0] op_sel_hi:[1,0,0] neg_lo:[0,0,1] neg_hi:[0,0,1]
v_pk_fma_f32 v[240:241], v[80:81], v[130:131], v[106:107] op_sel:[0,0,0] op_sel_hi:[1,0,0] neg_lo:[1,0,0] neg_hi:[1,0,0]
v_pk_add_f32 v[108:109], v[108:109], v[72:73]
v_pk_add_f32 v[110:111], v[110:111], v[232:233]
v_exp_f32 v236, v236
v_exp_f32 v76, v76
v_exp_f32 v237, v237
v_exp_f32 v77, v77
v_exp_f32 v238, v238
v_exp_f32 v78, v78
v_exp_f32 v239, v239
v_exp_f32 v79, v79
v_pk_fma_f32 v[80:81], v[80:81], v[130:131], v[102:103] op_sel:[0,0,0] op_sel_hi:[1,0,0] neg_lo:[0,0,1] neg_hi:[0,0,1]
v_pk_fma_f32 v[242:243], v[82:83], v[130:131], v[106:107] op_sel:[0,0,0] op_sel_hi:[1,0,0] neg_lo:[1,0,0] neg_hi:[1,0,0]
v_pk_add_f32 v[108:109], v[108:109], v[74:75]
v_pk_add_f32 v[110:111], v[110:111], v[234:235]
v_exp_f32 v240, v240
v_exp_f32 v80, v80
v_exp_f32 v241, v241
v_exp_f32 v81, v81
v_pk_fma_f32 v[82:83], v[82:83], v[130:131], v[102:103] op_sel:[0,0,0] op_sel_hi:[1,0,0] neg_lo:[0,0,1] neg_hi:[0,0,1]
v_add_f32 v101, v108, v109
v_add_f32 v105, v110, v111
v_exp_f32 v242, v242
v_exp_f32 v82, v82
v_exp_f32 v243, v243
v_exp_f32 v83, v83
v_pk_fma_f32 v[244:245], v[84:85], v[130:131], v[106:107] op_sel:[0,1,1] op_sel_hi:[1,1,1] neg_lo:[1,0,0] neg_hi:[1,0,0]
v_pk_fma_f32 v[246:247], v[86:87], v[130:131], v[106:107] op_sel:[0,1,1] op_sel_hi:[1,1,1] neg_lo:[1,0,0] neg_hi:[1,0,0]
v_pk_add_f32 v[108:109], v[76:77], v[78:79]
v_pk_add_f32 v[110:111], v[236:237], v[238:239]
v_pk_fma_f32 v[84:85], v[84:85], v[130:131], v[102:103] op_sel:[0,1,1] op_sel_hi:[1,1,1] neg_lo:[0,0,1] neg_hi:[0,0,1]
v_pk_fma_f32 v[86:87], v[86:87], v[130:131], v[102:103] op_sel:[0,1,1] op_sel_hi:[1,1,1] neg_lo:[0,0,1] neg_hi:[0,0,1]
v_pk_fma_f32 v[248:249], v[88:89], v[130:131], v[106:107] op_sel:[0,1,1] op_sel_hi:[1,1,1] neg_lo:[1,0,0] neg_hi:[1,0,0]
v_pk_fma_f32 v[250:251], v[90:91], v[130:131], v[106:107] op_sel:[0,1,1] op_sel_hi:[1,1,1] neg_lo:[1,0,0] neg_hi:[1,0,0]
v_pk_add_f32 v[108:109], v[108:109], v[80:81]
v_pk_add_f32 v[110:111], v[110:111], v[240:241]
v_exp_f32 v244, v244
v_exp_f32 v84, v84
v_exp_f32 v245, v245
v_exp_f32 v85, v85
v_exp_f32 v246, v246
v_exp_f32 v86, v86
v_exp_f32 v247, v247
v_exp_f32 v87, v87
v_pk_fma_f32 v[88:89], v[88:89], v[130:131], v[102:103] op_sel:[0,1,1] op_sel_hi:[1,1,1] neg_lo:[0,0,1] neg_hi:[0,0,1]
v_pk_fma_f32 v[90:91], v[90:91], v[130:131], v[102:103] op_sel:[0,1,1] op_sel_hi:[1,1,1] neg_lo:[0,0,1] neg_hi:[0,0,1]
v_pk_add_f32 v[108:109], v[108:109], v[82:83]
v_pk_add_f32 v[110:111], v[110:111], v[242:243]
v_exp_f32 v248, v248
v_exp_f32 v88, v88
v_exp_f32 v249, v249
v_exp_f32 v89, v89
v_add_f32 v102, v108, v109
v_add_f32 v106, v110, v111
v_exp_f32 v250, v250
v_exp_f32 v90, v90
v_exp_f32 v251, v251
v_exp_f32 v91, v91
v_pk_add_f32 v[108:109], v[84:85], v[86:87]
v_pk_add_f32 v[110:111], v[244:245], v[246:247]
v_pk_add_f32 v[108:109], v[108:109], v[88:89]
v_pk_add_f32 v[110:111], v[110:111], v[248:249]
v_pk_add_f32 v[108:109], v[108:109], v[90:91]
v_pk_add_f32 v[110:111], v[110:111], v[250:251]
v_add_f32 v103, v108, v109
v_add_f32 v107, v110, v111
s_cmp_eq_u32 s51, 1
s_cbranch_scc1 chk_84
s_waitcnt vmcnt(0)
v_max_u32 v4, v212, v213
v_max3_u32 v4, v4, v214, v215
v_max3_u32 v4, v4, v216, v217
v_max3_u32 v4, v4, v218, v219
v_cmp_eq_u32 vcc, -1, v4
s_cbranch_vccz red_85
buffer_load_dwordx4 v[212:215], v18, s[32:35], s55 offen offset:0 sc1
buffer_load_dwordx4 v[216:219], v18, s[32:35], s55 offen offset:1024 sc1
s_branch chk_84
red_85:
v_mfma_f32_16x16x32_bf16 v[132:135], v[44:47], v[212:215], 0
v_mfma_f32_16x16x32_bf16 v[132:135], v[44:47], v[216:219], v[132:135]
s_mov_b32 s51, 1
s_nop 6
v_add_f32_dpp v132, v132, v132 row_ror:8 row_mask:0xf bank_mask:0xf
v_add_f32_dpp v133, v133, v133 row_ror:8 row_mask:0xf bank_mask:0xf
v_add_f32_dpp v134, v134, v134 row_ror:8 row_mask:0xf bank_mask:0xf
v_add_f32_dpp v135, v135, v135 row_ror:8 row_mask:0xf bank_mask:0xf
v_cvt_pk_bf16_f32 v132, v132, v133
v_cvt_pk_bf16_f32 v133, v134, v135
s_mov_b64 exec, 0x00ff00ff
buffer_store_dwordx2 v[132:133], v59, s[32:35], s79 offen sc1
s_mov_b64 exec, -1
buffer_load_dwordx4 v[204:207], v58, s[32:35], s56 offen sc1
buffer_load_dwordx4 v[208:211], v58, s[32:35], s57 offen sc1
chk_84:
.p2align 3
v_permlane32_swap_b32 v100, v101
v_permlane32_swap_b32 v102, v103
v_permlane32_swap_b32 v104, v105
v_permlane32_swap_b32 v106, v107
v_add_f32 v100, v100, v101
v_add_f32 v102, v102, v103
v_add_f32 v104, v104, v105
v_add_f32 v106, v106, v107
v_permlane16_swap_b32 v100, v102
s_nop 0
v_permlane16_swap_b32 v104, v106
v_add_f32 v100, v100, v102
v_add_f32 v104, v104, v106
v_rcp_f32 v100, v100
v_rcp_f32 v104, v104
v_mov_b32 v102, v100
v_mov_b32 v106, v104
s_nop 0
v_permlane16_swap_b32 v100, v102
v_permlane16_swap_b32 v104, v106
v_mov_b32 v101, v100
v_mov_b32 v103, v102
v_mov_b32 v105, v104
v_mov_b32 v107, v106
v_permlane32_swap_b32 v100, v101
v_permlane32_swap_b32 v102, v103
v_permlane32_swap_b32 v104, v105
v_permlane32_swap_b32 v106, v107
v_pk_mul_f32 v[60:61], v[60:61], v[100:101] op_sel:[0,0] op_sel_hi:[1,0]
v_pk_mul_f32 v[220:221], v[220:221], v[104:105] op_sel:[0,0] op_sel_hi:[1,0]
v_pk_mul_f32 v[68:69], v[68:69], v[100:101] op_sel:[0,1] op_sel_hi:[1,1]
v_pk_mul_f32 v[228:229], v[228:229], v[104:105] op_sel:[0,1] op_sel_hi:[1,1]
v_pk_mul_f32 v[76:77], v[76:77], v[102:103] op_sel:[0,0] op_sel_hi:[1,0]
v_pk_mul_f32 v[236:237], v[236:237], v[106:107] op_sel:[0,0] op_sel_hi:[1,0]
v_pk_mul_f32 v[84:85], v[84:85], v[102:103] op_sel:[0,1] op_sel_hi:[1,1]
v_pk_mul_f32 v[244:245], v[244:245], v[106:107] op_sel:[0,1] op_sel_hi:[1,1]
v_pk_mul_f32 v[62:63], v[62:63], v[100:101] op_sel:[0,0] op_sel_hi:[1,0]
v_pk_mul_f32 v[222:223], v[222:223], v[104:105] op_sel:[0,0] op_sel_hi:[1,0]
v_cvt_pk_bf16_f32 v60, v60, v61
v_cvt_pk_bf16_f32 v220, v220, v221
v_pk_mul_f32 v[70:71], v[70:71], v[100:101] op_sel:[0,1] op_sel_hi:[1,1]
v_pk_mul_f32 v[230:231], v[230:231], v[104:105] op_sel:[0,1] op_sel_hi:[1,1]
v_cvt_pk_bf16_f32 v68, v68, v69
v_cvt_pk_bf16_f32 v228, v228, v229
v_pk_mul_f32 v[78:79], v[78:79], v[102:103] op_sel:[0,0] op_sel_hi:[1,0]
v_pk_mul_f32 v[238:239], v[238:239], v[106:107] op_sel:[0,0] op_sel_hi:[1,0]
v_cvt_pk_bf16_f32 v76, v76, v77
v_cvt_pk_bf16_f32 v236, v236, v237
v_pk_mul_f32 v[86:87], v[86:87], v[102:103] op_sel:[0,1] op_sel_hi:[1,1]
v_pk_mul_f32 v[246:247], v[246:247], v[106:107] op_sel:[0,1] op_sel_hi:[1,1]
v_cvt_pk_bf16_f32 v84, v84, v85
v_cvt_pk_bf16_f32 v244, v244, v245
v_pk_mul_f32 v[64:65], v[64:65], v[100:101] op_sel:[0,0] op_sel_hi:[1,0]
v_pk_mul_f32 v[66:67], v[66:67], v[100:101] op_sel:[0,0] op_sel_hi:[1,0]
v_pk_mul_f32 v[224:225], v[224:225], v[104:105] op_sel:[0,0] op_sel_hi:[1,0]
v_pk_mul_f32 v[226:227], v[226:227], v[104:105] op_sel:[0,0] op_sel_hi:[1,0]
v_cvt_pk_bf16_f32 v61, v62, v63
v_cvt_pk_bf16_f32 v221, v222, v223
v_pk_mul_f32 v[72:73], v[72:73], v[100:101] op_sel:[0,1] op_sel_hi:[1,1]
v_pk_mul_f32 v[74:75], v[74:75], v[100:101] op_sel:[0,1] op_sel_hi:[1,1]
v_pk_mul_f32 v[232:233], v[232:233], v[104:105] op_sel:[0,1] op_sel_hi:[1,1]
v_pk_mul_f32 v[234:235], v[234:235], v[104:105] op_sel:[0,1] op_sel_hi:[1,1]
v_cvt_pk_bf16_f32 v69, v70, v71
v_cvt_pk_bf16_f32 v229, v230, v231
v_pk_mul_f32 v[80:81], v[80:81], v[102:103] op_sel:[0,0] op_sel_hi:[1,0]
v_pk_mul_f32 v[82:83], v[82:83], v[102:103] op_sel:[0,0] op_sel_hi:[1,0]
v_pk_mul_f32 v[240:241], v[240:241], v[106:107] op_sel:[0,0] op_sel_hi:[1,0]
v_pk_mul_f32 v[242:243], v[242:243], v[106:107] op_sel:[0,0] op_sel_hi:[1,0]
v_cvt_pk_bf16_f32 v77, v78, v79
v_cvt_pk_bf16_f32 v237, v238, v239
v_pk_mul_f32 v[88:89], v[88:89], v[102:103] op_sel:[0,1] op_sel_hi:[1,1]
v_pk_mul_f32 v[90:91], v[90:91], v[102:103] op_sel:[0,1] op_sel_hi:[1,1]
v_pk_mul_f32 v[248:249], v[248:249], v[106:107] op_sel:[0,1] op_sel_hi:[1,1]
v_pk_mul_f32 v[250:251], v[250:251], v[106:107] op_sel:[0,1] op_sel_hi:[1,1]
v_cvt_pk_bf16_f32 v85, v86, v87
v_cvt_pk_bf16_f32 v245, v246, v247
v_cvt_pk_bf16_f32 v62, v64, v65
v_cvt_pk_bf16_f32 v63, v66, v67
v_cvt_pk_bf16_f32 v222, v224, v225
v_cvt_pk_bf16_f32 v223, v226, v227
v_cvt_pk_bf16_f32 v70, v72, v73
v_cvt_pk_bf16_f32 v71, v74, v75
v_cvt_pk_bf16_f32 v230, v232, v233
v_cvt_pk_bf16_f32 v231, v234, v235
v_cvt_pk_bf16_f32 v78, v80, v81
v_cvt_pk_bf16_f32 v79, v82, v83
v_cvt_pk_bf16_f32 v238, v240, v241
v_cvt_pk_bf16_f32 v239, v242, v243
v_cvt_pk_bf16_f32 v86, v88, v89
v_cvt_pk_bf16_f32 v87, v90, v91
v_cvt_pk_bf16_f32 v246, v248, v249
v_cvt_pk_bf16_f32 v247, v250, v251
s_cmp_lg_u32 s51, 0
s_cbranch_scc1 else_86
s_mov_b32 s63, 0
sent_88:
s_waitcnt vmcnt(0)
v_max_u32 v4, v212, v213
v_max3_u32 v4, v4, v214, v215
v_max3_u32 v4, v4, v216, v217
v_max3_u32 v4, v4, v218, v219
v_cmp_eq_u32 vcc, -1, v4
s_cbranch_vccz sentd_89
buffer_load_dwordx4 v[212:215], v18, s[32:35], s55 offen offset:0 sc1
buffer_load_dwordx4 v[216:219], v18, s[32:35], s55 offen offset:1024 sc1
s_add_u32 s63, s63, 1
s_cmp_lt_u32 s63, 0x80000
s_cbranch_scc1 sent_88
s_waitcnt vmcnt(0)
sentd_89:
v_mfma_f32_16x16x32_bf16 v[132:135], v[44:47], v[212:215], 0
v_mfma_f32_16x16x32_bf16 v[132:135], v[44:47], v[216:219], v[132:135]
s_mov_b32 s51, 1
s_nop 6
v_add_f32_dpp v132, v132, v132 row_ror:8 row_mask:0xf bank_mask:0xf
v_add_f32_dpp v133, v133, v133 row_ror:8 row_mask:0xf bank_mask:0xf
v_add_f32_dpp v134, v134, v134 row_ror:8 row_mask:0xf bank_mask:0xf
v_add_f32_dpp v135, v135, v135 row_ror:8 row_mask:0xf bank_mask:0xf
v_cvt_pk_bf16_f32 v132, v132, v133
v_cvt_pk_bf16_f32 v133, v134, v135
s_mov_b64 exec, 0x00ff00ff
buffer_store_dwordx2 v[132:133], v59, s[32:35], s79 offen sc1
s_mov_b64 exec, -1
buffer_load_dwordx4 v[204:207], v58, s[32:35], s56 offen sc1
buffer_load_dwordx4 v[208:211], v58, s[32:35], s57 offen sc1
else_86:
s_mov_b32 s63, 0
sent_90:
s_waitcnt vmcnt(0)
v_max_u32 v4, v204, v205
v_max3_u32 v4, v4, v206, v207
v_max3_u32 v4, v4, v208, v209
v_max3_u32 v4, v4, v210, v211
v_cmp_eq_u32 vcc, -1, v4
s_cbranch_vccz sentd_91
buffer_load_dwordx4 v[204:207], v58, s[32:35], s56 offen sc1
buffer_load_dwordx4 v[208:211], v58, s[32:35], s57 offen sc1
s_add_u32 s63, s63, 1
s_cmp_lt_u32 s63, 0x80000
s_cbranch_scc1 sent_90
s_waitcnt vmcnt(0)
sentd_91:
buffer_load_dwordx4 v[188:191], v18, s[32:35], s58 offen offset:0 sc1
buffer_load_dwordx4 v[192:195], v18, s[32:35], s58 offen offset:1024 sc1
buffer_load_dwordx4 v[196:199], v18, s[32:35], s59 offen offset:0 sc1
buffer_load_dwordx4 v[200:203], v18, s[32:35], s59 offen offset:1024 sc1
v_mfma_f32_16x16x32_bf16 v[112:115], v[204:207], v[60:63], 0
v_mfma_f32_16x16x32_bf16 v[116:119], v[204:207], v[68:71], 0
v_mfma_f32_16x16x32_bf16 v[120:123], v[204:207], v[76:79], 0
v_mfma_f32_16x16x32_bf16 v[124:127], v[204:207], v[84:87], 0
v_mfma_f32_16x16x32_bf16 v[112:115], v[208:211], v[220:223], v[112:115]
v_mfma_f32_16x16x32_bf16 v[116:119], v[208:211], v[228:231], v[116:119]
v_mfma_f32_16x16x32_bf16 v[120:123], v[208:211], v[236:239], v[120:123]
v_mfma_f32_16x16x32_bf16 v[124:127], v[208:211], v[244:247], v[124:127]
s_nop 4
v_add_f32 v100, v112, v113
v_add_f32 v114, v114, v115
v_add_f32 v100, v100, v114
v_add_f32 v101, v116, v117
v_add_f32 v118, v118, v119
v_add_f32 v101, v101, v118
v_add_f32 v102, v120, v121
v_add_f32 v122, v122, v123
v_add_f32 v102, v102, v122
v_add_f32 v103, v124, v125
v_add_f32 v126, v126, v127
v_add_f32 v103, v103, v126
s_nop 1
v_permlane32_swap_b32 v100, v101
v_permlane32_swap_b32 v102, v103
v_add_f32 v100, v100, v101
v_add_f32 v102, v102, v103
s_nop 1
v_permlane16_swap_b32 v100, v102
s_nop 0
v_add_f32 v100, v100, v102
v_add_f32 v100, 0x358637bd, v100
v_rcp_f32 v100, v100
s_nop 0
v_mov_b32 v102, v100
s_nop 1
v_permlane16_swap_b32 v100, v102
s_nop 0
v_mov_b32 v101, v100
v_mov_b32 v103, v102
s_nop 0
v_permlane32_swap_b32 v100, v101
v_permlane32_swap_b32 v102, v103
s_mov_b32 s63, 0
sent_92:
s_waitcnt vmcnt(0)
v_max_u32 v4, v188, v189
v_max3_u32 v4, v4, v190, v191
v_max3_u32 v4, v4, v192, v193
v_max3_u32 v4, v4, v194, v195
v_max3_u32 v4, v4, v196, v197
v_max3_u32 v4, v4, v198, v199
v_max3_u32 v4, v4, v200, v201
v_max3_u32 v4, v4, v202, v203
v_cmp_eq_u32 vcc, -1, v4
s_cbranch_vccz sentd_93
buffer_load_dwordx4 v[188:191], v18, s[32:35], s58 offen offset:0 sc1
buffer_load_dwordx4 v[192:195], v18, s[32:35], s58 offen offset:1024 sc1
buffer_load_dwordx4 v[196:199], v18, s[32:35], s59 offen offset:0 sc1
buffer_load_dwordx4 v[200:203], v18, s[32:35], s59 offen offset:1024 sc1
s_add_u32 s63, s63, 1
s_cmp_lt_u32 s63, 0x80000
s_cbranch_scc1 sent_92
s_waitcnt vmcnt(0)
sentd_93:
s_cmp_eq_u32 s46, 0
s_cbranch_scc1 slow_94
.p2align 3
v_mfma_f32_16x16x32_bf16 v[156:159], v[188:191], v[60:63], 0
v_mfma_f32_16x16x32_bf16 v[164:167], v[188:191], v[68:71], 0
v_mfma_f32_16x16x32_bf16 v[160:163], v[192:195], v[60:63], 0
v_mfma_f32_16x16x32_bf16 v[172:175], v[188:191], v[76:79], 0
v_mfma_f32_16x16x32_bf16 v[168:171], v[192:195], v[68:71], 0
v_mfma_f32_16x16x32_bf16 v[180:183], v[188:191], v[84:87], 0
v_mfma_f32_16x16x32_bf16 v[156:159], v[196:199], v[220:223], v[156:159]
v_mfma_f32_16x16x32_bf16 v[176:179], v[192:195], v[76:79], 0
v_mfma_f32_16x16x32_bf16 v[164:167], v[196:199], v[228:231], v[164:167]
v_mfma_f32_16x16x32_bf16 v[184:187], v[192:195], v[84:87], 0
v_mfma_f32_16x16x32_bf16 v[160:163], v[200:203], v[220:223], v[160:163]
v_mfma_f32_16x16x32_bf16 v[172:175], v[196:199], v[236:239], v[172:175]
v_mfma_f32_16x16x32_bf16 v[168:171], v[200:203], v[228:231], v[168:171]
v_mfma_f32_16x16x32_bf16 v[180:183], v[196:199], v[244:247], v[180:183]
v_mfma_f32_16x16x32_bf16 v[176:179], v[200:203], v[236:239], v[176:179]
v_mfma_f32_16x16x32_bf16 v[184:187], v[200:203], v[244:247], v[184:187]
v_pk_mul_f32 v[156:157], v[156:157], v[100:101] op_sel:[0,0] op_sel_hi:[1,0]
v_pk_mul_f32 v[158:159], v[158:159], v[100:101] op_sel:[0,0] op_sel_hi:[1,0]
v_cvt_pk_bf16_f32 v156, v156, v157
v_pk_mul_f32 v[164:165], v[164:165], v[100:101] op_sel:[0,1] op_sel_hi:[1,1]
v_pk_mul_f32 v[160:161], v[160:161], v[100:101] op_sel:[0,0] op_sel_hi:[1,0]
v_pk_mul_f32 v[162:163], v[162:163], v[100:101] op_sel:[0,0] op_sel_hi:[1,0]
v_cvt_pk_bf16_f32 v157, v158, v159
v_pk_mul_f32 v[166:167], v[166:167], v[100:101] op_sel:[0,1] op_sel_hi:[1,1]
v_cvt_pk_bf16_f32 v164, v164, v165
v_pk_mul_f32 v[172:173], v[172:173], v[102:103] op_sel:[0,0] op_sel_hi:[1,0]
v_cvt_pk_bf16_f32 v158, v160, v161
v_cvt_pk_bf16_f32 v159, v162, v163
v_pk_mul_f32 v[168:169], v[168:169], v[100:101] op_sel:[0,1] op_sel_hi:[1,1]
v_pk_mul_f32 v[170:171], v[170:171], v[100:101] op_sel:[0,1] op_sel_hi:[1,1]
v_cvt_pk_bf16_f32 v165, v166, v167
v_pk_mul_f32 v[174:175], v[174:175], v[102:103] op_sel:[0,0] op_sel_hi:[1,0]
v_cvt_pk_bf16_f32 v172, v172, v173
v_pk_mul_f32 v[180:181], v[180:181], v[102:103] op_sel:[0,1] op_sel_hi:[1,1]
buffer_store_dwordx4 v[156:159], v18, s[32:35], s80 offen
v_cvt_pk_bf16_f32 v166, v168, v169
v_cvt_pk_bf16_f32 v167, v170, v171
v_pk_mul_f32 v[176:177], v[176:177], v[102:103] op_sel:[0,0] op_sel_hi:[1,0]
v_pk_mul_f32 v[178:179], v[178:179], v[102:103] op_sel:[0,0] op_sel_hi:[1,0]
v_cvt_pk_bf16_f32 v173, v174, v175
v_pk_mul_f32 v[182:183], v[182:183], v[102:103] op_sel:[0,1] op_sel_hi:[1,1]
v_cvt_pk_bf16_f32 v180, v180, v181
buffer_store_dwordx4 v[164:167], v18, s[32:35], s81 offen
v_cvt_pk_bf16_f32 v174, v176, v177
v_cvt_pk_bf16_f32 v175, v178, v179
v_pk_mul_f32 v[184:185], v[184:185], v[102:103] op_sel:[0,1] op_sel_hi:[1,1]
v_pk_mul_f32 v[186:187], v[186:187], v[102:103] op_sel:[0,1] op_sel_hi:[1,1]
v_cvt_pk_bf16_f32 v181, v182, v183
buffer_store_dwordx4 v[172:175], v18, s[32:35], s82 offen
v_cvt_pk_bf16_f32 v182, v184, v185
v_cvt_pk_bf16_f32 v183, v186, v187
buffer_store_dwordx4 v[180:183], v18, s[32:35], s83 offen
back_95:
s_barrier
v_and_b32 v36, 31, v0
v_lshlrev_b32 v36, 2, v36
s_lshl_b32 s62, s45, 2
v_mov_b32 v4, s62
v_mov_b32 v5, 2
s_mov_b64 exec, 1
s_waitcnt vmcnt(0)
s_cmp_eq_u32 s46, 0
s_cbranch_scc1 slow_96
buffer_store_dword v5, v4, s[32:35], s84 offen
back_97:
s_mov_b64 exec, -1
v_lshrrev_b32 v4, 2, v2
v_and_b32 v5, 3, v0
v_lshl_add_u32 v6, v3, 3, v4
v_lshlrev_b32 v6, 7, v6
v_lshl_add_u32 v6, v5, 3, v6
v_lshrrev_b32 v7, 1, v4
v_and_b32 v8, 1, v3
v_lshl_add_u32 v7, v8, 1, v7
v_lshl_add_u32 v10, v7, 5, v6
v_xor_b32 v11, 32, v10
v_xor_b32 v12, 64, v10
v_xor_b32 v13, 96, v10
v_add_u32 v14, 0x10000, v10
v_add_u32 v15, 0x10000, v11
v_add_u32 v16, 0x10000, v12
v_add_u32 v17, 0x10000, v13
ds_read_b64_tr_b16 v[220:221], v10 offset:0
ds_read_b64_tr_b16 v[222:223], v10 offset:512
ds_read_b64_tr_b16 v[224:225], v11 offset:0
ds_read_b64_tr_b16 v[226:227], v11 offset:512
ds_read_b64_tr_b16 v[228:229], v12 offset:0
ds_read_b64_tr_b16 v[230:231], v12 offset:512
ds_read_b64_tr_b16 v[232:233], v13 offset:0
ds_read_b64_tr_b16 v[234:235], v13 offset:512
ds_read_b64_tr_b16 v[236:237], v10 offset:4096
ds_read_b64_tr_b16 v[238:239], v10 offset:4608
ds_read_b64_tr_b16 v[240:241], v11 offset:4096
ds_read_b64_tr_b16 v[242:243], v11 offset:4608
ds_read_b64_tr_b16 v[244:245], v12 offset:4096
ds_read_b64_tr_b16 v[246:247], v12 offset:4608
ds_read_b64_tr_b16 v[248:249], v13 offset:4096
ds_read_b64_tr_b16 v[250:251], v13 offset:4608
s_lshl_b32 s48, s41, 3
s_lshl_b32 s49, s40, 1
s_add_u32 s48, s48, s49
s_lshl_b32 s48, s48, 15
s_add_u32 s48, s48, 4194304
v_add_u32 v38, s48, v18
v_add_u32 v39, 32768, v38
s_lshl_b32 s57, s75, 11
s_add_u32 s87, s87, 262144
v_lshlrev_b32 v60, 16, v20
v_and_b32 v61, 0xffff0000, v20
v_lshlrev_b32 v62, 16, v21
v_and_b32 v63, 0xffff0000, v21
v_lshlrev_b32 v64, 16, v22
v_and_b32 v65, 0xffff0000, v22
v_lshlrev_b32 v66, 16, v23
v_and_b32 v67, 0xffff0000, v23
v_lshlrev_b32 v68, 16, v24
v_and_b32 v69, 0xffff0000, v24
v_lshlrev_b32 v70, 16, v25
v_and_b32 v71, 0xffff0000, v25
v_lshlrev_b32 v72, 16, v26
v_and_b32 v73, 0xffff0000, v26
v_lshlrev_b32 v74, 16, v27
v_and_b32 v75, 0xffff0000, v27
v_lshlrev_b32 v76, 16, v28
v_and_b32 v77, 0xffff0000, v28
v_lshlrev_b32 v78, 16, v29
v_and_b32 v79, 0xffff0000, v29
v_lshlrev_b32 v80, 16, v30
v_and_b32 v81, 0xffff0000, v30
v_lshlrev_b32 v82, 16, v31
v_and_b32 v83, 0xffff0000, v31
v_lshlrev_b32 v84, 16, v32
v_and_b32 v85, 0xffff0000, v32
v_lshlrev_b32 v86, 16, v33
v_and_b32 v87, 0xffff0000, v33
v_lshlrev_b32 v88, 16, v34
v_and_b32 v89, 0xffff0000, v34
v_lshlrev_b32 v90, 16, v35
v_and_b32 v91, 0xffff0000, v35
v_mov_b32 v6, 0
v_mov_b32 v7, 0
v_mov_b32 v8, 0
v_mov_b32 v9, 0
s_lshl_b32 s62, s42, 2
v_mov_b32 v4, s62
v_mov_b32 v5, 2
buffer_load_dword v37, v36, s[32:35], s84 offen sc1
s_mov_b32 s63, 0
s_waitcnt vmcnt(0)
poll_98:
v_cmp_gt_u32 vcc, 2, v37
s_cbranch_vccz polled_99
buffer_load_dword v37, v36, s[32:35], s84 offen sc1
s_add_u32 s63, s63, 1
s_cmp_lt_u32 s63, 0x80000
s_waitcnt vmcnt(0)
s_cbranch_scc1 poll_98
polled_99:
s_call_b64 s[94:95], R_oloop
s_cmp_eq_u32 s46, 0
s_cbranch_scc1 slow_100
s_nop 0
v_cvt_pk_bf16_f32 v20, v60, v61
v_cvt_pk_bf16_f32 v21, v62, v63
v_cvt_pk_bf16_f32 v22, v64, v65
v_cvt_pk_bf16_f32 v23, v66, v67
buffer_store_dwordx4 v[20:23], v18, s[32:35], s85 offen offset:0
v_cvt_pk_bf16_f32 v24, v68, v69
v_cvt_pk_bf16_f32 v25, v70, v71
v_cvt_pk_bf16_f32 v26, v72, v73
v_cvt_pk_bf16_f32 v27, v74, v75
buffer_store_dwordx4 v[24:27], v18, s[32:35], s85 offen offset:1024
v_cvt_pk_bf16_f32 v28, v76, v77
v_cvt_pk_bf16_f32 v29, v78, v79
v_cvt_pk_bf16_f32 v30, v80, v81
v_cvt_pk_bf16_f32 v31, v82, v83
buffer_store_dwordx4 v[28:31], v18, s[32:35], s86 offen offset:0
v_cvt_pk_bf16_f32 v32, v84, v85
v_cvt_pk_bf16_f32 v33, v86, v87
v_cvt_pk_bf16_f32 v34, v88, v89
v_cvt_pk_bf16_f32 v35, v90, v91
buffer_store_dwordx4 v[32:35], v18, s[32:35], s86 offen offset:1024
s_barrier
v_dot2c_f32_bf16 v6, v20, v48
v_dot2c_f32_bf16 v8, v20, v20
v_dot2c_f32_bf16 v7, v28, v48
v_dot2c_f32_bf16 v9, v28, v28
v_dot2c_f32_bf16 v6, v21, v48
v_dot2c_f32_bf16 v8, v21, v21
v_dot2c_f32_bf16 v7, v29, v48
v_dot2c_f32_bf16 v9, v29, v29
v_dot2c_f32_bf16 v6, v22, v48
v_dot2c_f32_bf16 v8, v22, v22
v_dot2c_f32_bf16 v7, v30, v48
v_dot2c_f32_bf16 v9, v30, v30
v_dot2c_f32_bf16 v6, v23, v48
v_dot2c_f32_bf16 v8, v23, v23
v_dot2c_f32_bf16 v7, v31, v48
v_dot2c_f32_bf16 v9, v31, v31
v_dot2c_f32_bf16 v6, v24, v48
v_dot2c_f32_bf16 v8, v24, v24
v_dot2c_f32_bf16 v7, v32, v48
v_dot2c_f32_bf16 v9, v32, v32
v_dot2c_f32_bf16 v6, v25, v48
v_dot2c_f32_bf16 v8, v25, v25
v_dot2c_f32_bf16 v7, v33, v48
v_dot2c_f32_bf16 v9, v33, v33
v_dot2c_f32_bf16 v6, v26, v48
v_dot2c_f32_bf16 v8, v26, v26
v_dot2c_f32_bf16 v7, v34, v48
v_dot2c_f32_bf16 v9, v34, v34
v_dot2c_f32_bf16 v6, v27, v48
v_dot2c_f32_bf16 v8, v27, v27
v_dot2c_f32_bf16 v7, v35, v48
v_dot2c_f32_bf16 v9, v35, v35
s_mov_b64 exec, 1
s_waitcnt vmcnt(0)
buffer_store_dword v5, v4, s[32:35], s88 offen
s_mov_b64 exec, -1
s_nop 1
v_permlane32_swap_b32 v6, v7
v_permlane32_swap_b32 v8, v9
v_add_f32 v6, v6, v7
v_add_f32 v8, v8, v9
s_nop 1
v_permlane16_swap_b32 v6, v8
s_nop 0
v_add_f32 v6, v6, v8
buffer_store_dword v6, v1, s[32:35], s87 offen
back_101:
s_lshl_b32 s49, s44, 13
v_add_u32 v10, s49, v18
v_add_u32 v11, 1024, v10
s_lshl_b32 s48, s43, 1
v_lshrrev_b32 v4, 2, v2
v_and_b32 v5, 3, v0
v_lshl_add_u32 v6, v3, 3, v4
v_lshlrev_b32 v6, 7, v6
v_lshl_add_u32 v6, v5, 3, v6
v_lshrrev_b32 v7, 1, v4
v_and_b32 v8, 1, v3
v_lshl_add_u32 v7, v8, 1, v7
v_xor_b32 v7, s48, v7
v_lshl_add_u32 v12, v7, 5, v6
v_add_u32 v12, 16384, v12
v_xor_b32 v13, 32, v12
v_mov_b32 v14, v10
v_mov_b32 v15, v11
v_add_u32 v16, 122880, v12
v_add_u32 v17, 122880, v13
v_mov_b32 v156, 0
v_mov_b32 v157, 0
v_mov_b32 v158, 0
v_mov_b32 v159, 0
v_mov_b32 v160, 0
v_mov_b32 v161, 0
v_mov_b32 v162, 0
v_mov_b32 v163, 0
v_mov_b32 v164, 0
v_mov_b32 v165, 0
v_mov_b32 v166, 0
v_mov_b32 v167, 0
v_mov_b32 v168, 0
v_mov_b32 v169, 0
v_mov_b32 v170, 0
v_mov_b32 v171, 0
v_mov_b32 v172, 0
v_mov_b32 v173, 0
v_mov_b32 v174, 0
v_mov_b32 v175, 0
v_mov_b32 v176, 0
v_mov_b32 v177, 0
v_mov_b32 v178, 0
v_mov_b32 v179, 0
v_mov_b32 v180, 0
v_mov_b32 v181, 0
v_mov_b32 v182, 0
v_mov_b32 v183, 0
v_mov_b32 v184, 0
v_mov_b32 v185, 0
v_mov_b32 v186, 0
v_mov_b32 v187, 0
v_mov_b32 v188, 0
v_mov_b32 v189, 0
v_mov_b32 v190, 0
v_mov_b32 v191, 0
v_mov_b32 v192, 0
v_mov_b32 v193, 0
v_mov_b32 v194, 0
v_mov_b32 v195, 0
v_mov_b32 v196, 0
v_mov_b32 v197, 0
v_mov_b32 v198, 0
v_mov_b32 v199, 0
v_mov_b32 v200, 0
v_mov_b32 v201, 0
v_mov_b32 v202, 0
v_mov_b32 v203, 0
v_mov_b32 v204, 0
v_mov_b32 v205, 0
v_mov_b32 v206, 0
v_mov_b32 v207, 0
v_mov_b32 v208, 0
v_mov_b32 v209, 0
v_mov_b32 v210, 0
v_mov_b32 v211, 0
v_mov_b32 v212, 0
v_mov_b32 v213, 0
v_mov_b32 v214, 0
v_mov_b32 v215, 0
v_mov_b32 v216, 0
v_mov_b32 v217, 0
v_mov_b32 v218, 0
v_mov_b32 v219, 0
v_mov_b32 v220, 0
v_mov_b32 v221, 0
v_mov_b32 v222, 0
v_mov_b32 v223, 0
v_mov_b32 v224, 0
v_mov_b32 v225, 0
v_mov_b32 v226, 0
v_mov_b32 v227, 0
v_mov_b32 v228, 0
v_mov_b32 v229, 0
v_mov_b32 v230, 0
v_mov_b32 v231, 0
v_mov_b32 v232, 0
v_mov_b32 v233, 0
v_mov_b32 v234, 0
v_mov_b32 v235, 0
v_mov_b32 v236, 0
v_mov_b32 v237, 0
v_mov_b32 v238, 0
v_mov_b32 v239, 0
v_mov_b32 v240, 0
v_mov_b32 v241, 0
v_mov_b32 v242, 0
v_mov_b32 v243, 0
v_mov_b32 v244, 0
v_mov_b32 v245, 0
v_mov_b32 v246, 0
v_mov_b32 v247, 0
v_mov_b32 v248, 0
v_mov_b32 v249, 0
v_mov_b32 v250, 0
v_mov_b32 v251, 0
s_mov_b32 s48, 0xf149f2ca
v_mov_b32 v9, s48
v_lshlrev_b32 v4, 2, v3
v_sub_u32 v4, v2, v4
v_subrev_u32 v5, 0, v4
v_and_b32 v6, 0x80000001, v5
v_cmp_eq_u32 vcc, 0, v6
v_add_u32 v5, 1, v5
v_and_b32 v6, 0x80000001, v5
v_cndmask_b32 v40, v9, 0, vcc
v_cmp_eq_u32 vcc, 0x80000001, v6
s_nop 1
v_cndmask_b32 v36, v9, 0, vcc
v_subrev_u32 v5, 1, v4
v_and_b32 v6, 0x80000001, v5
v_cmp_eq_u32 vcc, 0, v6
v_add_u32 v5, 1, v5
v_and_b32 v6, 0x80000001, v5
v_cndmask_b32 v41, v9, 0, vcc
v_cmp_eq_u32 vcc, 0x80000001, v6
s_nop 1
v_cndmask_b32 v37, v9, 0, vcc
v_subrev_u32 v5, 2, v4
v_and_b32 v6, 0x80000001, v5
v_cmp_eq_u32 vcc, 0, v6
v_add_u32 v5, 1, v5
v_and_b32 v6, 0x80000001, v5
v_cndmask_b32 v42, v9, 0, vcc
v_cmp_eq_u32 vcc, 0x80000001, v6
s_nop 1
v_cndmask_b32 v38, v9, 0, vcc
v_subrev_u32 v5, 3, v4
v_and_b32 v6, 0x80000001, v5
v_cmp_eq_u32 vcc, 0, v6
v_add_u32 v5, 1, v5
v_and_b32 v6, 0x80000001, v5
v_cndmask_b32 v43, v9, 0, vcc
v_cmp_eq_u32 vcc, 0x80000001, v6
s_nop 1
v_cndmask_b32 v39, v9, 0, vcc
s_or_b32 s48, s41, s44
s_cmp_eq_u32 s48, 0
s_cselect_b64 vcc, -1, 0
v_cndmask_b32 v44, v36, v9, vcc
v_cndmask_b32 v45, v37, v9, vcc
v_cndmask_b32 v46, v38, v9, vcc
v_cndmask_b32 v47, v39, v9, vcc
v_and_b32 v4, 1, v2
v_lshlrev_b32 v4, 4, v4
v_mov_b32 v5, 0xffff
v_lshlrev_b32 v52, v4, v5
s_lshl_b32 s48, s43, 11
s_add_u32 s48, s48, 135168
v_add_u32 v53, s48, v18
v_lshl_add_u32 v55, v0, 3, s48
s_add_u32 s48, s41, s44
s_sub_u32 s48, s48, 1
s_lshl_b32 s49, s48, 1
s_add_u32 s49, s49, s43
s_lshl_b32 s49, s49, 11
s_mul_i32 s50, s42, 65536
s_add_u32 s49, s49, s50
s_add_u32 s49, s49, 8388608
s_cmp_lt_i32 s48, 0
s_cselect_b32 s49, 0xf0000000, s49
v_add_u32 v58, s49, v18
v_lshl_add_u32 v59, v0, 3, s49
s_lshl_b32 s48, s43, 2
s_add_u32 s48, s48, 134672
v_mov_b32 v19, s48
s_lshl_b32 s48, s43, 7
s_add_u32 s48, s48, 133120
v_lshl_add_u32 v7, v3, 4, s48
v_lshl_add_u32 v54, v2, 2, s48
s_lshl_b32 s49, s44, 6
v_add_u32 v8, s49, v2
v_lshlrev_b32 v8, 3, v8
v_add_u32 v8, 131072, v8
v_lshl_add_u32 v9, v3, 2, s49
v_lshlrev_b32 v9, 2, v9
v_add_u32 v9, 132096, v9
s_mov_b32 s64, 0
s_mov_b32 s65, 0
s_mov_b32 s66, 0x3e8293ee
s_mov_b32 s61, 3
ds_read_b64_tr_b16 v[84:85], v16 offset:8192
ds_read_b64_tr_b16 v[86:87], v16 offset:8704
ds_read_b64_tr_b16 v[88:89], v17 offset:8192
ds_read_b64_tr_b16 v[90:91], v17 offset:8704
ds_read_b64_tr_b16 v[92:93], v16 offset:16384
ds_read_b64_tr_b16 v[94:95], v16 offset:16896
ds_read_b64_tr_b16 v[96:97], v17 offset:16384
ds_read_b64_tr_b16 v[98:99], v17 offset:16896
ds_read_b64_tr_b16 v[76:77], v16 offset:0
ds_read_b64_tr_b16 v[78:79], v16 offset:512
ds_read_b64_tr_b16 v[80:81], v17 offset:0
ds_read_b64_tr_b16 v[82:83], v17 offset:512
s_barrier
ds_read_b128 v[60:63], v14 offset:0
ds_read_b128 v[64:67], v14 offset:2048
ds_read_b128 v[68:71], v14 offset:4096
ds_read_b128 v[72:75], v14 offset:6144
s_waitcnt lgkmcnt(0)
c2_loop:
v_mfma_f32_16x16x32_bf16 v[212:215], v[84:87], v[72:75], v[212:215]
ds_read_b128 v[100:103], v15 offset:0
v_mfma_f32_16x16x32_bf16 v[204:207], v[84:87], v[68:71], v[204:207]
ds_read_b128 v[104:107], v15 offset:2048
v_mfma_f32_16x16x32_bf16 v[196:199], v[84:87], v[64:67], v[196:199]
ds_read_b128 v[108:111], v15 offset:4096
v_mfma_f32_16x16x32_bf16 v[188:191], v[84:87], v[60:63], v[188:191]
ds_read_b128 v[112:115], v15 offset:6144
v_mfma_f32_16x16x32_bf16 v[192:195], v[88:91], v[60:63], v[192:195]
ds_read_b64_tr_b16 v[124:125], v16 offset:12288
v_mfma_f32_16x16x32_bf16 v[200:203], v[88:91], v[64:67], v[200:203]
ds_read_b64_tr_b16 v[126:127], v16 offset:12800
v_mfma_f32_16x16x32_bf16 v[208:211], v[88:91], v[68:71], v[208:211]
ds_read_b64_tr_b16 v[128:129], v17 offset:12288
v_mfma_f32_16x16x32_bf16 v[216:219], v[88:91], v[72:75], v[216:219]
ds_read_b64_tr_b16 v[130:131], v17 offset:12800
v_mfma_f32_16x16x32_bf16 v[244:247], v[72:75], v[92:95], v[244:247]
ds_read_b64_tr_b16 v[132:133], v16 offset:20480
v_mfma_f32_16x16x32_bf16 v[248:251], v[72:75], v[96:99], v[248:251]
ds_read_b64_tr_b16 v[134:135], v16 offset:20992
v_mfma_f32_16x16x32_bf16 v[240:243], v[68:71], v[96:99], v[240:243]
ds_read_b64_tr_b16 v[136:137], v17 offset:20480
v_mfma_f32_16x16x32_bf16 v[236:239], v[68:71], v[92:95], v[236:239]
ds_read_b64_tr_b16 v[138:139], v17 offset:20992
v_mfma_f32_16x16x32_bf16 v[228:231], v[64:67], v[92:95], v[228:231]
ds_read_b64_tr_b16 v[116:117], v16 offset:4096
v_mfma_f32_16x16x32_bf16 v[232:235], v[64:67], v[96:99], v[232:235]
ds_read_b64_tr_b16 v[118:119], v16 offset:4608
v_mfma_f32_16x16x32_bf16 v[224:227], v[60:63], v[96:99], v[224:227]
ds_read_b64_tr_b16 v[120:121], v17 offset:4096
v_mfma_f32_16x16x32_bf16 v[220:223], v[60:63], v[92:95], v[220:223]
ds_read_b64_tr_b16 v[122:123], v17 offset:4608
v_mfma_f32_16x16x32_bf16 v[156:159], v[76:79], v[60:63], v[156:159]
s_add_u32 s65, s65, 40960
s_cmp_eq_u32 s65, 122880
v_mfma_f32_16x16x32_bf16 v[164:167], v[76:79], v[64:67], v[164:167]
s_cselect_b32 s65, 0, s65
s_add_u32 s64, s64, 1
v_mfma_f32_16x16x32_bf16 v[172:175], v[76:79], v[68:71], v[172:175]
v_add_u32 v14, s65, v10
v_add_u32 v15, s65, v11
v_mfma_f32_16x16x32_bf16 v[180:183], v[76:79], v[72:75], v[180:183]
v_add_u32 v16, s65, v12
v_add_u32 v17, s65, v13
v_mfma_f32_16x16x32_bf16 v[184:187], v[80:83], v[72:75], v[184:187]
v_mfma_f32_16x16x32_bf16 v[176:179], v[80:83], v[68:71], v[176:179]
s_cmp_eq_u32 s64, 16
s_cbranch_scc1 c2_last
v_mfma_f32_16x16x32_bf16 v[168:171], v[80:83], v[64:67], v[168:171]
s_waitcnt lgkmcnt(0)
v_mfma_f32_16x16x32_bf16 v[160:163], v[80:83], v[60:63], v[160:163]
s_barrier
v_mfma_f32_16x16x32_bf16 v[212:215], v[124:127], v[112:115], v[212:215]
ds_read_b128 v[60:63], v14 offset:0
v_mfma_f32_16x16x32_bf16 v[204:207], v[124:127], v[108:111], v[204:207]
ds_read_b128 v[64:67], v14 offset:2048
v_mfma_f32_16x16x32_bf16 v[196:199], v[124:127], v[104:107], v[196:199]
ds_read_b128 v[68:71], v14 offset:4096
v_mfma_f32_16x16x32_bf16 v[188:191], v[124:127], v[100:103], v[188:191]
ds_read_b128 v[72:75], v14 offset:6144
v_mfma_f32_16x16x32_bf16 v[192:195], v[128:131], v[100:103], v[192:195]
ds_read_b64_tr_b16 v[84:85], v16 offset:8192
v_mfma_f32_16x16x32_bf16 v[200:203], v[128:131], v[104:107], v[200:203]
ds_read_b64_tr_b16 v[86:87], v16 offset:8704
v_mfma_f32_16x16x32_bf16 v[208:211], v[128:131], v[108:111], v[208:211]
ds_read_b64_tr_b16 v[88:89], v17 offset:8192
v_mfma_f32_16x16x32_bf16 v[216:219], v[128:131], v[112:115], v[216:219]
ds_read_b64_tr_b16 v[90:91], v17 offset:8704
v_mfma_f32_16x16x32_bf16 v[244:247], v[112:115], v[132:135], v[244:247]
ds_read_b64_tr_b16 v[92:93], v16 offset:16384
v_mfma_f32_16x16x32_bf16 v[248:251], v[112:115], v[136:139], v[248:251]
ds_read_b64_tr_b16 v[94:95], v16 offset:16896
v_mfma_f32_16x16x32_bf16 v[240:243], v[108:111], v[136:139], v[240:243]
ds_read_b64_tr_b16 v[96:97], v17 offset:16384
v_mfma_f32_16x16x32_bf16 v[236:239], v[108:111], v[132:135], v[236:239]
ds_read_b64_tr_b16 v[98:99], v17 offset:16896
v_mfma_f32_16x16x32_bf16 v[228:231], v[104:107], v[132:135], v[228:231]
ds_read_b64_tr_b16 v[76:77], v16 offset:0
v_mfma_f32_16x16x32_bf16 v[232:235], v[104:107], v[136:139], v[232:235]
ds_read_b64_tr_b16 v[78:79], v16 offset:512
v_mfma_f32_16x16x32_bf16 v[224:227], v[100:103], v[136:139], v[224:227]
ds_read_b64_tr_b16 v[80:81], v17 offset:0
v_mfma_f32_16x16x32_bf16 v[220:223], v[100:103], v[132:135], v[220:223]
ds_read_b64_tr_b16 v[82:83], v17 offset:512
v_mfma_f32_16x16x32_bf16 v[156:159], v[116:119], v[100:103], v[156:159]
v_mfma_f32_16x16x32_bf16 v[164:167], v[116:119], v[104:107], v[164:167]
v_mfma_f32_16x16x32_bf16 v[172:175], v[116:119], v[108:111], v[172:175]
v_mfma_f32_16x16x32_bf16 v[180:183], v[116:119], v[112:115], v[180:183]
v_mfma_f32_16x16x32_bf16 v[184:187], v[120:123], v[112:115], v[184:187]
v_mfma_f32_16x16x32_bf16 v[176:179], v[120:123], v[108:111], v[176:179]
v_mfma_f32_16x16x32_bf16 v[168:171], v[120:123], v[104:107], v[168:171]
s_waitcnt lgkmcnt(0)
v_mfma_f32_16x16x32_bf16 v[160:163], v[120:123], v[100:103], v[160:163]
s_branch c2_loop
c2_last:
v_mfma_f32_16x16x32_bf16 v[168:171], v[80:83], v[64:67], v[168:171]
s_waitcnt lgkmcnt(0)
v_mfma_f32_16x16x32_bf16 v[160:163], v[80:83], v[60:63], v[160:163]
v_mfma_f32_16x16x32_bf16 v[212:215], v[124:127], v[112:115], v[212:215]
ds_read_b128 v[140:143], v7 offset:0
v_mfma_f32_16x16x32_bf16 v[204:207], v[124:127], v[108:111], v[204:207]
ds_read_b128 v[144:147], v7 offset:64
v_mfma_f32_16x16x32_bf16 v[196:199], v[124:127], v[104:107], v[196:199]
ds_read_b128 v[148:151], v7 offset:256
v_mfma_f32_16x16x32_bf16 v[188:191], v[124:127], v[100:103], v[188:191]
ds_read_b128 v[152:155], v7 offset:320
v_mfma_f32_16x16x32_bf16 v[192:195], v[128:131], v[100:103], v[192:195]
ds_read2_b32 v[56:57], v54 offset0:128 offset1:144
v_mfma_f32_16x16x32_bf16 v[200:203], v[128:131], v[104:107], v[200:203]
v_mfma_f32_16x16x32_bf16 v[208:211], v[128:131], v[108:111], v[208:211]
v_mfma_f32_16x16x32_bf16 v[216:219], v[128:131], v[112:115], v[216:219]
s_barrier
v_mfma_f32_16x16x32_bf16 v[244:247], v[112:115], v[132:135], v[244:247]
ds_read_b64 v[92:93], v8 offset:0
v_mfma_f32_16x16x32_bf16 v[248:251], v[112:115], v[136:139], v[248:251]
ds_read_b64 v[94:95], v8 offset:128
v_mfma_f32_16x16x32_bf16 v[240:243], v[108:111], v[136:139], v[240:243]
ds_read_b64 v[96:97], v8 offset:256
v_mfma_f32_16x16x32_bf16 v[236:239], v[108:111], v[132:135], v[236:239]
ds_read_b64 v[98:99], v8 offset:384
v_mfma_f32_16x16x32_bf16 v[228:231], v[104:107], v[132:135], v[228:231]
ds_read_b128 v[60:63], v9 offset:0
v_mfma_f32_16x16x32_bf16 v[232:235], v[104:107], v[136:139], v[232:235]
ds_read_b128 v[64:67], v9 offset:64
v_mfma_f32_16x16x32_bf16 v[224:227], v[100:103], v[136:139], v[224:227]
ds_read_b128 v[68:71], v9 offset:128
v_mfma_f32_16x16x32_bf16 v[220:223], v[100:103], v[132:135], v[220:223]
ds_read_b128 v[72:75], v9 offset:192
v_mfma_f32_16x16x32_bf16 v[156:159], v[116:119], v[100:103], v[156:159]
ds_read_b128 v[76:79], v9 offset:512
v_mfma_f32_16x16x32_bf16 v[164:167], v[116:119], v[104:107], v[164:167]
ds_read_b128 v[80:83], v9 offset:576
v_mfma_f32_16x16x32_bf16 v[172:175], v[116:119], v[108:111], v[172:175]
ds_read_b128 v[84:87], v9 offset:640
v_mfma_f32_16x16x32_bf16 v[180:183], v[116:119], v[112:115], v[180:183]
ds_read_b128 v[88:91], v9 offset:704
v_mfma_f32_16x16x32_bf16 v[184:187], v[120:123], v[112:115], v[184:187]
v_mfma_f32_16x16x32_bf16 v[176:179], v[120:123], v[108:111], v[176:179]
v_mfma_f32_16x16x32_bf16 v[168:171], v[120:123], v[104:107], v[168:171]
v_mfma_f32_16x16x32_bf16 v[160:163], v[120:123], v[100:103], v[160:163]
c2_epi:
s_waitcnt lgkmcnt(0)
.p2align 3
v_pk_fma_f32 v[212:213], v[148:149], v[98:99], v[212:213] op_sel:[0,1,0] op_sel_hi:[1,1,1]
v_pk_fma_f32 v[214:215], v[150:151], v[98:99], v[214:215] op_sel:[0,1,0] op_sel_hi:[1,1,1]
v_pk_fma_f32 v[216:217], v[152:153], v[98:99], v[216:217] op_sel:[0,1,0] op_sel_hi:[1,1,1]
v_pk_fma_f32 v[218:219], v[154:155], v[98:99], v[218:219] op_sel:[0,1,0] op_sel_hi:[1,1,1]
v_pk_mul_f32 v[212:213], v[212:213], v[98:99] op_sel:[0,0] op_sel_hi:[1,0]
v_pk_mul_f32 v[214:215], v[214:215], v[98:99] op_sel:[0,0] op_sel_hi:[1,0]
v_pk_mul_f32 v[216:217], v[216:217], v[98:99] op_sel:[0,0] op_sel_hi:[1,0]
v_pk_mul_f32 v[218:219], v[218:219], v[98:99] op_sel:[0,0] op_sel_hi:[1,0]
v_cvt_pk_bf16_f32 v212, v212, v213
v_cvt_pk_bf16_f32 v213, v214, v215
v_cvt_pk_bf16_f32 v214, v216, v217
v_cvt_pk_bf16_f32 v215, v218, v219
v_pk_fma_f32 v[244:245], v[88:89], v[56:57], v[244:245] op_sel:[0,0,0] op_sel_hi:[1,0,1]
v_pk_fma_f32 v[246:247], v[90:91], v[56:57], v[246:247] op_sel:[0,0,0] op_sel_hi:[1,0,1]
v_pk_mul_f32 v[244:245], v[244:245], v[72:73]
v_pk_mul_f32 v[246:247], v[246:247], v[74:75]
v_cvt_pk_bf16_f32 v108, v244, v245
v_cvt_pk_bf16_f32 v109, v246, v247
v_pk_fma_f32 v[248:249], v[88:89], v[56:57], v[248:249] op_sel:[0,1,0] op_sel_hi:[1,1,1]
v_pk_fma_f32 v[250:251], v[90:91], v[56:57], v[250:251] op_sel:[0,1,0] op_sel_hi:[1,1,1]
v_pk_mul_f32 v[248:249], v[248:249], v[72:73]
v_pk_mul_f32 v[250:251], v[250:251], v[74:75]
v_cvt_pk_bf16_f32 v118, v248, v249
v_cvt_pk_bf16_f32 v119, v250, v251
s_cmp_lg_u32 s44, 1
s_cbranch_scc1 else_102
buffer_store_dwordx4 v[212:215], v58, s[32:35], 0 offen sc1
buffer_store_dwordx2 v[108:109], v59, s[32:35], 0 offen offset:1024 sc1
buffer_store_dwordx2 v[118:119], v59, s[32:35], 0 offen offset:1536 sc1
s_branch fi_103
else_102:
ds_write_b128 v53, v[212:215]
ds_write_b64 v55, v[108:109] offset:1024
ds_write_b64 v55, v[118:119] offset:1536
v_mov_b32 v4, 3
ds_write_b32 v19, v4
fi_103:
.p2align 3
v_pk_fma_f32 v[188:189], v[148:149], v[92:93], v[188:189] op_sel:[0,1,0] op_sel_hi:[1,1,1]
v_pk_fma_f32 v[196:197], v[148:149], v[94:95], v[196:197] op_sel:[0,1,0] op_sel_hi:[1,1,1]
v_pk_fma_f32 v[204:205], v[148:149], v[96:97], v[204:205] op_sel:[0,1,0] op_sel_hi:[1,1,1]
v_pk_fma_f32 v[164:165], v[140:141], v[94:95], v[164:165] op_sel:[0,1,0] op_sel_hi:[1,1,1]
v_pk_fma_f32 v[172:173], v[140:141], v[96:97], v[172:173] op_sel:[0,1,0] op_sel_hi:[1,1,1]
v_pk_fma_f32 v[180:181], v[140:141], v[98:99], v[180:181] op_sel:[0,1,0] op_sel_hi:[1,1,1]
v_pk_fma_f32 v[190:191], v[150:151], v[92:93], v[190:191] op_sel:[0,1,0] op_sel_hi:[1,1,1]
v_pk_mul_f32 v[188:189], v[188:189], v[92:93] op_sel:[0,0] op_sel_hi:[1,0]
v_pk_fma_f32 v[198:199], v[150:151], v[94:95], v[198:199] op_sel:[0,1,0] op_sel_hi:[1,1,1]
v_pk_mul_f32 v[196:197], v[196:197], v[94:95] op_sel:[0,0] op_sel_hi:[1,0]
v_pk_fma_f32 v[206:207], v[150:151], v[96:97], v[206:207] op_sel:[0,1,0] op_sel_hi:[1,1,1]
v_pk_mul_f32 v[204:205], v[204:205], v[96:97] op_sel:[0,0] op_sel_hi:[1,0]
v_pk_fma_f32 v[166:167], v[142:143], v[94:95], v[166:167] op_sel:[0,1,0] op_sel_hi:[1,1,1]
v_cvt_pk_bf16_f32 v164, v164, v165
v_pk_fma_f32 v[174:175], v[142:143], v[96:97], v[174:175] op_sel:[0,1,0] op_sel_hi:[1,1,1]
v_cvt_pk_bf16_f32 v172, v172, v173
v_pk_fma_f32 v[182:183], v[142:143], v[98:99], v[182:183] op_sel:[0,1,0] op_sel_hi:[1,1,1]
v_cvt_pk_bf16_f32 v180, v180, v181
v_pk_fma_f32 v[192:193], v[152:153], v[92:93], v[192:193] op_sel:[0,1,0] op_sel_hi:[1,1,1]
v_pk_fma_f32 v[194:195], v[154:155], v[92:93], v[194:195] op_sel:[0,1,0] op_sel_hi:[1,1,1]
v_pk_mul_f32 v[190:191], v[190:191], v[92:93] op_sel:[0,0] op_sel_hi:[1,0]
v_cvt_pk_bf16_f32 v188, v188, v189
v_pk_fma_f32 v[200:201], v[152:153], v[94:95], v[200:201] op_sel:[0,1,0] op_sel_hi:[1,1,1]
v_pk_fma_f32 v[202:203], v[154:155], v[94:95], v[202:203] op_sel:[0,1,0] op_sel_hi:[1,1,1]
v_pk_mul_f32 v[198:199], v[198:199], v[94:95] op_sel:[0,0] op_sel_hi:[1,0]
v_cvt_pk_bf16_f32 v196, v196, v197
v_pk_fma_f32 v[208:209], v[152:153], v[96:97], v[208:209] op_sel:[0,1,0] op_sel_hi:[1,1,1]
v_pk_fma_f32 v[210:211], v[154:155], v[96:97], v[210:211] op_sel:[0,1,0] op_sel_hi:[1,1,1]
v_pk_mul_f32 v[206:207], v[206:207], v[96:97] op_sel:[0,0] op_sel_hi:[1,0]
v_cvt_pk_bf16_f32 v204, v204, v205
v_pk_fma_f32 v[168:169], v[144:145], v[94:95], v[168:169] op_sel:[0,1,0] op_sel_hi:[1,1,1]
v_pk_fma_f32 v[170:171], v[146:147], v[94:95], v[170:171] op_sel:[0,1,0] op_sel_hi:[1,1,1]
v_cvt_pk_bf16_f32 v165, v166, v167
v_pk_fma_f32 v[176:177], v[144:145], v[96:97], v[176:177] op_sel:[0,1,0] op_sel_hi:[1,1,1]
v_pk_fma_f32 v[178:179], v[146:147], v[96:97], v[178:179] op_sel:[0,1,0] op_sel_hi:[1,1,1]
v_cvt_pk_bf16_f32 v173, v174, v175
v_pk_fma_f32 v[184:185], v[144:145], v[98:99], v[184:185] op_sel:[0,1,0] op_sel_hi:[1,1,1]
v_pk_fma_f32 v[186:187], v[146:147], v[98:99], v[186:187] op_sel:[0,1,0] op_sel_hi:[1,1,1]
v_cvt_pk_bf16_f32 v181, v182, v183
v_pk_mul_f32 v[192:193], v[192:193], v[92:93] op_sel:[0,0] op_sel_hi:[1,0]
v_pk_mul_f32 v[194:195], v[194:195], v[92:93] op_sel:[0,0] op_sel_hi:[1,0]
v_cvt_pk_bf16_f32 v189, v190, v191
v_pk_mul_f32 v[200:201], v[200:201], v[94:95] op_sel:[0,0] op_sel_hi:[1,0]
v_pk_mul_f32 v[202:203], v[202:203], v[94:95] op_sel:[0,0] op_sel_hi:[1,0]
v_cvt_pk_bf16_f32 v197, v198, v199
v_pk_mul_f32 v[208:209], v[208:209], v[96:97] op_sel:[0,0] op_sel_hi:[1,0]
v_pk_mul_f32 v[210:211], v[210:211], v[96:97] op_sel:[0,0] op_sel_hi:[1,0]
v_cvt_pk_bf16_f32 v205, v206, v207
v_cvt_pk_bf16_f32 v166, v168, v169
v_cvt_pk_bf16_f32 v167, v170, v171
v_cvt_pk_bf16_f32 v174, v176, v177
v_cvt_pk_bf16_f32 v175, v178, v179
v_cvt_pk_bf16_f32 v182, v184, v185
v_cvt_pk_bf16_f32 v183, v186, v187
v_cvt_pk_bf16_f32 v190, v192, v193
v_cvt_pk_bf16_f32 v191, v194, v195
v_mfma_f32_16x16x32_bf16 v[216:219], v[212:215], v[180:183], v[40:43]
v_cvt_pk_bf16_f32 v198, v200, v201
v_cvt_pk_bf16_f32 v199, v202, v203
v_mfma_f32_16x16x32_bf16 v[168:171], v[188:191], v[164:167], v[36:39]
v_cvt_pk_bf16_f32 v206, v208, v209
v_cvt_pk_bf16_f32 v207, v210, v211
v_mfma_f32_16x16x32_bf16 v[200:203], v[196:199], v[164:167], v[40:43]
v_mul_f32 v124, s66, v92
v_mul_f32 v125, s66, v94
v_mfma_f32_16x16x32_bf16 v[208:211], v[204:207], v[172:175], v[40:43]
v_mul_f32 v126, s66, v96
v_mul_f32 v127, s66, v98
v_mfma_f32_16x16x32_bf16 v[176:179], v[196:199], v[172:175], v[36:39]
v_max_f32 v164, v168, v169
v_max_f32 v165, v170, v171
v_mfma_f32_16x16x32_bf16 v[184:187], v[204:207], v[180:183], v[36:39]
v_max_f32 v166, v200, v201
v_max_f32 v182, v216, v217
v_max_f32 v174, v208, v209
v_max_f32 v167, v202, v203
v_max3_f32 v129, v164, v165, v166
v_pk_fma_f32 v[156:157], v[140:141], v[92:93], v[156:157] op_sel:[0,1,0] op_sel_hi:[1,1,1]
v_pk_fma_f32 v[158:159], v[142:143], v[92:93], v[158:159] op_sel:[0,1,0] op_sel_hi:[1,1,1]
v_cvt_pk_bf16_f32 v156, v156, v157
v_pk_fma_f32 v[160:161], v[144:145], v[92:93], v[160:161] op_sel:[0,1,0] op_sel_hi:[1,1,1]
v_pk_fma_f32 v[162:163], v[146:147], v[92:93], v[162:163] op_sel:[0,1,0] op_sel_hi:[1,1,1]
v_cvt_pk_bf16_f32 v157, v158, v159
v_cvt_pk_bf16_f32 v158, v160, v161
v_cvt_pk_bf16_f32 v159, v162, v163
v_pk_fma_f32 v[220:221], v[76:77], v[56:57], v[220:221] op_sel:[0,0,0] op_sel_hi:[1,0,1]
v_pk_fma_f32 v[222:223], v[78:79], v[56:57], v[222:223] op_sel:[0,0,0] op_sel_hi:[1,0,1]
v_mfma_f32_16x16x32_bf16 v[192:195], v[188:191], v[156:159], v[40:43]
v_max_f32 v172, v176, v177
v_max_f32 v173, v178, v179
v_max_f32 v180, v184, v185
v_max_f32 v181, v186, v187
v_max_f32_e64 v175, v210, v211
v_pk_fma_f32 v[224:225], v[76:77], v[56:57], v[224:225] op_sel:[0,1,0] op_sel_hi:[1,1,1]
v_pk_fma_f32 v[226:227], v[78:79], v[56:57], v[226:227] op_sel:[0,1,0] op_sel_hi:[1,1,1]
v_pk_fma_f32 v[228:229], v[80:81], v[56:57], v[228:229] op_sel:[0,0,0] op_sel_hi:[1,0,1]
v_pk_fma_f32 v[230:231], v[82:83], v[56:57], v[230:231] op_sel:[0,0,0] op_sel_hi:[1,0,1]
v_pk_fma_f32 v[232:233], v[80:81], v[56:57], v[232:233] op_sel:[0,1,0] op_sel_hi:[1,1,1]
v_pk_fma_f32 v[234:235], v[82:83], v[56:57], v[234:235] op_sel:[0,1,0] op_sel_hi:[1,1,1]
v_pk_fma_f32 v[236:237], v[84:85], v[56:57], v[236:237] op_sel:[0,0,0] op_sel_hi:[1,0,1]
v_pk_fma_f32 v[238:239], v[86:87], v[56:57], v[238:239] op_sel:[0,0,0] op_sel_hi:[1,0,1]
v_pk_fma_f32 v[240:241], v[84:85], v[56:57], v[240:241] op_sel:[0,1,0] op_sel_hi:[1,1,1]
v_pk_fma_f32 v[242:243], v[86:87], v[56:57], v[242:243] op_sel:[0,1,0] op_sel_hi:[1,1,1]
v_pk_mul_f32 v[220:221], v[220:221], v[60:61]
v_pk_mul_f32 v[222:223], v[222:223], v[62:63]
v_pk_mul_f32 v[224:225], v[224:225], v[60:61]
s_cmp_lg_u32 s44, 0
s_cbranch_scc1 else_104
buffer_load_dwordx4 v[120:123], v58, s[32:35], 0 offen sc1
buffer_load_dwordx2 v[100:101], v59, s[32:35], 0 offen offset:1024 sc1
buffer_load_dwordx2 v[110:111], v59, s[32:35], 0 offen offset:1536 sc1
else_104:
v_pk_mul_f32 v[226:227], v[226:227], v[62:63]
v_pk_mul_f32 v[228:229], v[228:229], v[64:65]
v_pk_mul_f32 v[230:231], v[230:231], v[66:67]
v_pk_mul_f32 v[232:233], v[232:233], v[64:65]
v_pk_mul_f32 v[234:235], v[234:235], v[66:67]
v_pk_mul_f32 v[236:237], v[236:237], v[68:69]
v_pk_mul_f32 v[238:239], v[238:239], v[70:71]
v_pk_mul_f32 v[240:241], v[240:241], v[68:69]
v_pk_mul_f32 v[242:243], v[242:243], v[70:71]
v_max3_f32 v130, v172, v173, v174
v_max_f32_e64 v183, v218, v219
v_max3_f32 v131, v180, v181, v182
v_cvt_pk_bf16_f32 v102, v220, v221
v_cvt_pk_bf16_f32 v103, v222, v223
v_cvt_pk_bf16_f32 v112, v224, v225
v_cvt_pk_bf16_f32 v113, v226, v227
v_cvt_pk_bf16_f32 v104, v228, v229
v_cvt_pk_bf16_f32 v105, v230, v231
v_cvt_pk_bf16_f32 v114, v232, v233
v_cvt_pk_bf16_f32 v115, v234, v235
v_cvt_pk_bf16_f32 v106, v236, v237
v_cvt_pk_bf16_f32 v107, v238, v239
v_cvt_pk_bf16_f32 v116, v240, v241
v_cvt_pk_bf16_f32 v117, v242, v243
v_max_f32 v129, v129, v167
v_max_f32 v130, v130, v175
v_max_f32 v131, v131, v183
s_cmp_lg_u32 s44, 0
s_cbranch_scc1 else_106
s_mov_b32 s63, 0
sent_108:
s_waitcnt vmcnt(0)
v_max_u32 v4, v120, v121
v_max3_u32 v4, v4, v122, v123
v_max3_u32 v4, v4, v100, v101
v_max3_u32 v4, v4, v110, v111
v_cmp_eq_u32 vcc, -1, v4
s_cbranch_vccz sentd_109
buffer_load_dwordx4 v[120:123], v58, s[32:35], 0 offen sc1
buffer_load_dwordx2 v[100:101], v59, s[32:35], 0 offen offset:1024 sc1
buffer_load_dwordx2 v[110:111], v59, s[32:35], 0 offen offset:1536 sc1
s_add_u32 s63, s63, 1
s_cmp_lt_u32 s63, 0x80000
s_cbranch_scc1 sent_108
s_waitcnt vmcnt(0)
sentd_109:
s_branch fi_107
else_106:
s_mov_b32 s63, 0
px_110:
ds_read_b32 v4, v19
ds_read_b128 v[120:123], v53
ds_read_b64 v[100:101], v55 offset:1024
ds_read_b64 v[110:111], v55 offset:1536
s_add_u32 s63, s63, 1
s_cmp_lt_u32 s63, 0x400000
s_waitcnt lgkmcnt(0)
v_cmp_ne_u32 vcc, 3, v4
s_cbranch_vccz pxd_111
s_cbranch_scc1 px_110
pxd_111:
fi_107:
s_cmp_eq_u32 s46, 0
s_cbranch_scc1 slow_112
.p2align 3
v_mfma_f32_16x16x32_bf16 v[160:163], v[120:123], v[156:159], v[44:47]
v_max_f32 v158, v192, v193
v_max_f32 v159, v194, v195
v_permlane32_swap_b32 v130, v131
s_nop 0
v_max_f32 v130, v130, v131
s_nop 2
v_max_f32 v156, v160, v161
v_max_f32 v157, v162, v163
v_max3_f32 v128, v156, v157, v158
v_max_f32 v128, v128, v159
s_nop 1
v_permlane32_swap_b32 v128, v129
s_nop 0
v_max_f32 v128, v128, v129
s_nop 1
v_permlane16_swap_b32 v128, v130
s_nop 0
v_max_f32 v128, v128, v130
v_mov_b32 v130, v128
s_nop 1
v_permlane16_swap_b32 v128, v130
s_nop 0
v_mov_b32 v129, v128
v_mov_b32 v131, v130
s_nop 0
v_permlane32_swap_b32 v128, v129
v_permlane32_swap_b32 v130, v131
v_mul_f32 v128, v128, v124
v_mul_f32 v129, v129, v125
v_pk_fma_f32 v[156:157], v[156:157], v[124:125], v[128:129] op_sel:[0,0,0] op_sel_hi:[1,0,0] neg_lo:[0,0,1] neg_hi:[0,0,1]
v_pk_fma_f32 v[158:159], v[158:159], v[124:125], v[128:129] op_sel:[0,0,0] op_sel_hi:[1,0,0] neg_lo:[0,0,1] neg_hi:[0,0,1]
v_mul_f32 v130, v130, v126
v_mul_f32 v131, v131, v127
v_exp_f32 v156, v156
v_exp_f32 v157, v157
v_exp_f32 v158, v158
v_exp_f32 v159, v159
v_pk_fma_f32 v[164:165], v[164:165], v[124:125], v[128:129] op_sel:[0,1,1] op_sel_hi:[1,1,1] neg_lo:[0,0,1] neg_hi:[0,0,1]
v_pk_fma_f32 v[166:167], v[166:167], v[124:125], v[128:129] op_sel:[0,1,1] op_sel_hi:[1,1,1] neg_lo:[0,0,1] neg_hi:[0,0,1]
v_exp_f32 v164, v164
v_exp_f32 v165, v165
v_exp_f32 v166, v166
v_exp_f32 v167, v167
v_pk_fma_f32 v[172:173], v[172:173], v[126:127], v[130:131] op_sel:[0,0,0] op_sel_hi:[1,0,0] neg_lo:[0,0,1] neg_hi:[0,0,1]
v_pk_fma_f32 v[174:175], v[174:175], v[126:127], v[130:131] op_sel:[0,0,0] op_sel_hi:[1,0,0] neg_lo:[0,0,1] neg_hi:[0,0,1]
v_cvt_pk_bf16_f32 v156, v156, v156
v_cvt_pk_bf16_f32 v157, v157, v157
v_cvt_pk_bf16_f32 v158, v158, v158
v_cvt_pk_bf16_f32 v159, v159, v159
v_exp_f32 v172, v172
v_exp_f32 v173, v173
v_exp_f32 v174, v174
v_exp_f32 v175, v175
v_pk_fma_f32 v[180:181], v[180:181], v[126:127], v[130:131] op_sel:[0,1,1] op_sel_hi:[1,1,1] neg_lo:[0,0,1] neg_hi:[0,0,1]
v_pk_fma_f32 v[182:183], v[182:183], v[126:127], v[130:131] op_sel:[0,1,1] op_sel_hi:[1,1,1] neg_lo:[0,0,1] neg_hi:[0,0,1]
v_and_b32 v156, v52, v156
v_and_b32 v157, v52, v157
v_and_b32 v158, v52, v158
v_and_b32 v159, v52, v159
v_cvt_pk_bf16_f32 v164, v164, v164
v_cvt_pk_bf16_f32 v165, v165, v165
v_mfma_f32_16x16x32_bf16 v[160:163], v[48:51], v[156:159], 0
v_cvt_pk_bf16_f32 v166, v166, v166
v_cvt_pk_bf16_f32 v167, v167, v167
v_mfma_f32_16x16x32_bf16 v[220:223], v[100:103], v[156:159], 0
v_exp_f32 v180, v180
v_mfma_f32_16x16x32_bf16 v[224:227], v[110:113], v[156:159], 0
v_exp_f32 v181, v181
v_exp_f32 v182, v182
v_exp_f32 v183, v183
v_and_b32 v164, v52, v164
v_and_b32 v165, v52, v165
v_and_b32 v166, v52, v166
v_and_b32 v167, v52, v167
v_cvt_pk_bf16_f32 v172, v172, v172
v_cvt_pk_bf16_f32 v173, v173, v173
v_mfma_f32_16x16x32_bf16 v[168:171], v[48:51], v[164:167], 0
v_cvt_pk_bf16_f32 v174, v174, v174
v_cvt_pk_bf16_f32 v175, v175, v175
v_mfma_f32_16x16x32_bf16 v[228:231], v[102:105], v[164:167], 0
v_and_b32 v172, v52, v172
v_and_b32 v173, v52, v173
v_mfma_f32_16x16x32_bf16 v[232:235], v[112:115], v[164:167], 0
v_and_b32 v174, v52, v174
v_and_b32 v175, v52, v175
v_cvt_pk_bf16_f32 v180, v180, v180
v_cvt_pk_bf16_f32 v181, v181, v181
v_mfma_f32_16x16x32_bf16 v[176:179], v[48:51], v[172:175], 0
v_cvt_pk_bf16_f32 v182, v182, v182
v_cvt_pk_bf16_f32 v183, v183, v183
v_mfma_f32_16x16x32_bf16 v[236:239], v[104:107], v[172:175], 0
v_and_b32 v180, v52, v180
v_and_b32 v181, v52, v181
v_mfma_f32_16x16x32_bf16 v[240:243], v[114:117], v[172:175], 0
v_and_b32 v182, v52, v182
v_and_b32 v183, v52, v183
v_rcp_f32 v160, v160
v_rcp_f32 v168, v168
v_pk_mul_f32 v[220:221], v[220:221], v[160:161] op_sel:[0,0] op_sel_hi:[1,0]
v_pk_mul_f32 v[222:223], v[222:223], v[160:161] op_sel:[0,0] op_sel_hi:[1,0]
v_pk_mul_f32 v[228:229], v[228:229], v[168:169] op_sel:[0,0] op_sel_hi:[1,0]
v_pk_mul_f32 v[224:225], v[224:225], v[160:161] op_sel:[0,0] op_sel_hi:[1,0]
v_pk_mul_f32 v[226:227], v[226:227], v[160:161] op_sel:[0,0] op_sel_hi:[1,0]
v_pk_mul_f32 v[230:231], v[230:231], v[168:169] op_sel:[0,0] op_sel_hi:[1,0]
v_pk_mul_f32 v[232:233], v[232:233], v[168:169] op_sel:[0,0] op_sel_hi:[1,0]
v_pk_mul_f32 v[234:235], v[234:235], v[168:169] op_sel:[0,0] op_sel_hi:[1,0]
v_mfma_f32_16x16x32_bf16 v[184:187], v[48:51], v[180:183], 0
v_rcp_f32_e64 v176, v176
v_cvt_pk_bf16_f32 v220, v220, v221
v_cvt_pk_bf16_f32 v221, v222, v223
v_cvt_pk_bf16_f32 v228, v228, v229
v_pk_mul_f32 v[236:237], v[236:237], v[176:177] op_sel:[0,0] op_sel_hi:[1,0]
v_mfma_f32_16x16x32_bf16 v[244:247], v[106:109], v[180:183], 0
v_cvt_pk_bf16_f32 v222, v224, v225
v_cvt_pk_bf16_f32 v223, v226, v227
v_rcp_f32_e64 v184, v184
v_cvt_pk_bf16_f32 v229, v230, v231
v_pk_mul_f32 v[238:239], v[238:239], v[176:177] op_sel:[0,0] op_sel_hi:[1,0]
v_pk_mul_f32 v[240:241], v[240:241], v[176:177] op_sel:[0,0] op_sel_hi:[1,0]
v_pk_mul_f32 v[242:243], v[242:243], v[176:177] op_sel:[0,0] op_sel_hi:[1,0]
v_cvt_pk_bf16_f32 v236, v236, v237
v_pk_mul_f32 v[244:245], v[244:245], v[184:185] op_sel:[0,0] op_sel_hi:[1,0]
v_pk_mul_f32 v[246:247], v[246:247], v[184:185] op_sel:[0,0] op_sel_hi:[1,0]
v_mfma_f32_16x16x32_bf16 v[248:251], v[116:119], v[180:183], 0
buffer_store_dwordx4 v[220:223], v18, s[32:35], s80 offen
v_cvt_pk_bf16_f32 v230, v232, v233
v_cvt_pk_bf16_f32 v231, v234, v235
v_cvt_pk_bf16_f32 v237, v238, v239
v_cvt_pk_bf16_f32 v244, v244, v245
buffer_store_dwordx4 v[228:231], v18, s[32:35], s81 offen
v_cvt_pk_bf16_f32 v238, v240, v241
v_cvt_pk_bf16_f32 v239, v242, v243
v_pk_mul_f32 v[248:249], v[248:249], v[184:185] op_sel:[0,0] op_sel_hi:[1,0]
v_pk_mul_f32 v[250:251], v[250:251], v[184:185] op_sel:[0,0] op_sel_hi:[1,0]
v_cvt_pk_bf16_f32 v245, v246, v247
buffer_store_dwordx4 v[236:239], v18, s[32:35], s82 offen
v_cvt_pk_bf16_f32 v246, v248, v249
v_cvt_pk_bf16_f32 v247, v250, v251
buffer_store_dwordx4 v[244:247], v18, s[32:35], s83 offen
back_113:
s_barrier
v_and_b32 v36, 31, v0
v_lshlrev_b32 v36, 2, v36
s_lshl_b32 s62, s45, 2
v_mov_b32 v4, s62
v_mov_b32 v5, 3
s_mov_b64 exec, 1
s_waitcnt vmcnt(0)
s_cmp_eq_u32 s46, 0
s_cbranch_scc1 slow_114
buffer_store_dword v5, v4, s[32:35], s84 offen
back_115:
s_mov_b64 exec, -1
v_lshrrev_b32 v4, 2, v2
v_and_b32 v5, 3, v0
v_lshl_add_u32 v6, v3, 3, v4
v_lshlrev_b32 v6, 7, v6
v_lshl_add_u32 v6, v5, 3, v6
v_lshrrev_b32 v7, 1, v4
v_and_b32 v8, 1, v3
v_lshl_add_u32 v7, v8, 1, v7
v_lshl_add_u32 v10, v7, 5, v6
v_xor_b32 v11, 32, v10
v_xor_b32 v12, 64, v10
v_xor_b32 v13, 96, v10
v_add_u32 v14, 0x10000, v10
v_add_u32 v15, 0x10000, v11
v_add_u32 v16, 0x10000, v12
v_add_u32 v17, 0x10000, v13
ds_read_b64_tr_b16 v[220:221], v10 offset:0
ds_read_b64_tr_b16 v[222:223], v10 offset:512
ds_read_b64_tr_b16 v[224:225], v11 offset:0
ds_read_b64_tr_b16 v[226:227], v11 offset:512
ds_read_b64_tr_b16 v[228:229], v12 offset:0
ds_read_b64_tr_b16 v[230:231], v12 offset:512
ds_read_b64_tr_b16 v[232:233], v13 offset:0
ds_read_b64_tr_b16 v[234:235], v13 offset:512
ds_read_b64_tr_b16 v[236:237], v10 offset:4096
ds_read_b64_tr_b16 v[238:239], v10 offset:4608
ds_read_b64_tr_b16 v[240:241], v11 offset:4096
ds_read_b64_tr_b16 v[242:243], v11 offset:4608
ds_read_b64_tr_b16 v[244:245], v12 offset:4096
ds_read_b64_tr_b16 v[246:247], v12 offset:4608
ds_read_b64_tr_b16 v[248:249], v13 offset:4096
ds_read_b64_tr_b16 v[250:251], v13 offset:4608
s_lshl_b32 s48, s41, 3
s_lshl_b32 s49, s40, 1
s_add_u32 s48, s48, s49
s_lshl_b32 s48, s48, 15
s_add_u32 s48, s48, 4194304
v_add_u32 v38, s48, v18
v_add_u32 v39, 32768, v38
s_lshl_b32 s57, s75, 11
s_add_u32 s87, s87, 262144
v_lshlrev_b32 v60, 16, v20
v_and_b32 v61, 0xffff0000, v20
v_lshlrev_b32 v62, 16, v21
v_and_b32 v63, 0xffff0000, v21
v_lshlrev_b32 v64, 16, v22
v_and_b32 v65, 0xffff0000, v22
v_lshlrev_b32 v66, 16, v23
v_and_b32 v67, 0xffff0000, v23
v_lshlrev_b32 v68, 16, v24
v_and_b32 v69, 0xffff0000, v24
v_lshlrev_b32 v70, 16, v25
v_and_b32 v71, 0xffff0000, v25
v_lshlrev_b32 v72, 16, v26
v_and_b32 v73, 0xffff0000, v26
v_lshlrev_b32 v74, 16, v27
v_and_b32 v75, 0xffff0000, v27
v_lshlrev_b32 v76, 16, v28
v_and_b32 v77, 0xffff0000, v28
v_lshlrev_b32 v78, 16, v29
v_and_b32 v79, 0xffff0000, v29
v_lshlrev_b32 v80, 16, v30
v_and_b32 v81, 0xffff0000, v30
v_lshlrev_b32 v82, 16, v31
v_and_b32 v83, 0xffff0000, v31
v_lshlrev_b32 v84, 16, v32
v_and_b32 v85, 0xffff0000, v32
v_lshlrev_b32 v86, 16, v33
v_and_b32 v87, 0xffff0000, v33
v_lshlrev_b32 v88, 16, v34
v_and_b32 v89, 0xffff0000, v34
v_lshlrev_b32 v90, 16, v35
v_and_b32 v91, 0xffff0000, v35
v_mov_b32 v6, 0
v_mov_b32 v7, 0
v_mov_b32 v8, 0
v_mov_b32 v9, 0
s_lshl_b32 s62, s42, 2
v_mov_b32 v4, s62
v_mov_b32 v5, 3
buffer_load_dword v37, v36, s[32:35], s84 offen sc1
s_mov_b32 s63, 0
s_waitcnt vmcnt(0)
poll_116:
v_cmp_gt_u32 vcc, 3, v37
s_cbranch_vccz polled_117
buffer_load_dword v37, v36, s[32:35], s84 offen sc1
s_add_u32 s63, s63, 1
s_cmp_lt_u32 s63, 0x80000
s_waitcnt vmcnt(0)
s_cbranch_scc1 poll_116
polled_117:
s_call_b64 s[94:95], R_oloop
s_cmp_eq_u32 s46, 0
s_cbranch_scc1 slow_118
s_nop 0
v_cvt_pk_bf16_f32 v20, v60, v61
v_cvt_pk_bf16_f32 v21, v62, v63
v_cvt_pk_bf16_f32 v22, v64, v65
v_cvt_pk_bf16_f32 v23, v66, v67
buffer_store_dwordx4 v[20:23], v18, s[32:35], s85 offen offset:0
v_cvt_pk_bf16_f32 v24, v68, v69
v_cvt_pk_bf16_f32 v25, v70, v71
v_cvt_pk_bf16_f32 v26, v72, v73
v_cvt_pk_bf16_f32 v27, v74, v75
buffer_store_dwordx4 v[24:27], v18, s[32:35], s85 offen offset:1024
v_cvt_pk_bf16_f32 v28, v76, v77
v_cvt_pk_bf16_f32 v29, v78, v79
v_cvt_pk_bf16_f32 v30, v80, v81
v_cvt_pk_bf16_f32 v31, v82, v83
buffer_store_dwordx4 v[28:31], v18, s[32:35], s86 offen offset:0
v_cvt_pk_bf16_f32 v32, v84, v85
v_cvt_pk_bf16_f32 v33, v86, v87
v_cvt_pk_bf16_f32 v34, v88, v89
v_cvt_pk_bf16_f32 v35, v90, v91
buffer_store_dwordx4 v[32:35], v18, s[32:35], s86 offen offset:1024
s_barrier
v_dot2c_f32_bf16 v6, v20, v48
v_dot2c_f32_bf16 v8, v20, v20
v_dot2c_f32_bf16 v7, v28, v48
v_dot2c_f32_bf16 v9, v28, v28
v_dot2c_f32_bf16 v6, v21, v48
v_dot2c_f32_bf16 v8, v21, v21
v_dot2c_f32_bf16 v7, v29, v48
v_dot2c_f32_bf16 v9, v29, v29
v_dot2c_f32_bf16 v6, v22, v48
v_dot2c_f32_bf16 v8, v22, v22
v_dot2c_f32_bf16 v7, v30, v48
v_dot2c_f32_bf16 v9, v30, v30
v_dot2c_f32_bf16 v6, v23, v48
v_dot2c_f32_bf16 v8, v23, v23
v_dot2c_f32_bf16 v7, v31, v48
v_dot2c_f32_bf16 v9, v31, v31
v_dot2c_f32_bf16 v6, v24, v48
v_dot2c_f32_bf16 v8, v24, v24
v_dot2c_f32_bf16 v7, v32, v48
v_dot2c_f32_bf16 v9, v32, v32
v_dot2c_f32_bf16 v6, v25, v48
v_dot2c_f32_bf16 v8, v25, v25
v_dot2c_f32_bf16 v7, v33, v48
v_dot2c_f32_bf16 v9, v33, v33
v_dot2c_f32_bf16 v6, v26, v48
v_dot2c_f32_bf16 v8, v26, v26
v_dot2c_f32_bf16 v7, v34, v48
v_dot2c_f32_bf16 v9, v34, v34
v_dot2c_f32_bf16 v6, v27, v48
v_dot2c_f32_bf16 v8, v27, v27
v_dot2c_f32_bf16 v7, v35, v48
v_dot2c_f32_bf16 v9, v35, v35
s_mov_b64 exec, 1
s_waitcnt vmcnt(0)
buffer_store_dword v5, v4, s[32:35], s88 offen
s_mov_b64 exec, -1
s_nop 1
v_permlane32_swap_b32 v6, v7
v_permlane32_swap_b32 v8, v9
v_add_f32 v6, v6, v7
v_add_f32 v8, v8, v9
s_nop 1
v_permlane16_swap_b32 v6, v8
s_nop 0
v_add_f32 v6, v6, v8
buffer_store_dword v6, v1, s[32:35], s87 offen
back_119:
s_lshl_b32 s49, s44, 13
v_add_u32 v10, s49, v18
v_add_u32 v11, 1024, v10
s_lshl_b32 s48, s43, 1
v_lshrrev_b32 v4, 2, v2
v_and_b32 v5, 3, v0
v_lshl_add_u32 v6, v3, 3, v4
v_lshlrev_b32 v6, 7, v6
v_lshl_add_u32 v6, v5, 3, v6
v_lshrrev_b32 v7, 1, v4
v_and_b32 v8, 1, v3
v_lshl_add_u32 v7, v8, 1, v7
v_xor_b32 v7, s48, v7
v_lshl_add_u32 v12, v7, 5, v6
v_add_u32 v12, 16384, v12
v_xor_b32 v13, 32, v12
v_mov_b32 v14, v10
v_mov_b32 v15, v11
v_add_u32 v16, 122880, v12
v_add_u32 v17, 122880, v13
v_mov_b32 v156, 0
v_mov_b32 v157, 0
v_mov_b32 v158, 0
v_mov_b32 v159, 0
v_mov_b32 v160, 0
v_mov_b32 v161, 0
v_mov_b32 v162, 0
v_mov_b32 v163, 0
v_mov_b32 v164, 0
v_mov_b32 v165, 0
v_mov_b32 v166, 0
v_mov_b32 v167, 0
v_mov_b32 v168, 0
v_mov_b32 v169, 0
v_mov_b32 v170, 0
v_mov_b32 v171, 0
v_mov_b32 v172, 0
v_mov_b32 v173, 0
v_mov_b32 v174, 0
v_mov_b32 v175, 0
v_mov_b32 v176, 0
v_mov_b32 v177, 0
v_mov_b32 v178, 0
v_mov_b32 v179, 0
v_mov_b32 v180, 0
v_mov_b32 v181, 0
v_mov_b32 v182, 0
v_mov_b32 v183, 0
v_mov_b32 v184, 0
v_mov_b32 v185, 0
v_mov_b32 v186, 0
v_mov_b32 v187, 0
v_mov_b32 v188, 0
v_mov_b32 v189, 0
v_mov_b32 v190, 0
v_mov_b32 v191, 0
v_mov_b32 v192, 0
v_mov_b32 v193, 0
v_mov_b32 v194, 0
v_mov_b32 v195, 0
v_mov_b32 v196, 0
v_mov_b32 v197, 0
v_mov_b32 v198, 0
v_mov_b32 v199, 0
v_mov_b32 v200, 0
v_mov_b32 v201, 0
v_mov_b32 v202, 0
v_mov_b32 v203, 0
v_mov_b32 v204, 0
v_mov_b32 v205, 0
v_mov_b32 v206, 0
v_mov_b32 v207, 0
v_mov_b32 v208, 0
v_mov_b32 v209, 0
v_mov_b32 v210, 0
v_mov_b32 v211, 0
v_mov_b32 v212, 0
v_mov_b32 v213, 0
v_mov_b32 v214, 0
v_mov_b32 v215, 0
v_mov_b32 v216, 0
v_mov_b32 v217, 0
v_mov_b32 v218, 0
v_mov_b32 v219, 0
v_mov_b32 v220, 0
v_mov_b32 v221, 0
v_mov_b32 v222, 0
v_mov_b32 v223, 0
v_mov_b32 v224, 0
v_mov_b32 v225, 0
v_mov_b32 v226, 0
v_mov_b32 v227, 0
v_mov_b32 v228, 0
v_mov_b32 v229, 0
v_mov_b32 v230, 0
v_mov_b32 v231, 0
v_mov_b32 v232, 0
v_mov_b32 v233, 0
v_mov_b32 v234, 0
v_mov_b32 v235, 0
v_mov_b32 v236, 0
v_mov_b32 v237, 0
v_mov_b32 v238, 0
v_mov_b32 v239, 0
v_mov_b32 v240, 0
v_mov_b32 v241, 0
v_mov_b32 v242, 0
v_mov_b32 v243, 0
v_mov_b32 v244, 0
v_mov_b32 v245, 0
v_mov_b32 v246, 0
v_mov_b32 v247, 0
v_mov_b32 v248, 0
v_mov_b32 v249, 0
v_mov_b32 v250, 0
v_mov_b32 v251, 0
v_lshrrev_b32 v6, 2, v2
v_cmp_eq_u32 vcc, v6, v3
v_and_b32 v7, 1, v0
v_lshlrev_b32 v7, 4, v7
v_mov_b32 v8, 0x3f80
v_lshlrev_b32 v9, v7, v8
v_cndmask_b32 v7, 0, v9, vcc
v_and_b32 v6, 2, v0
v_cmp_eq_u32 vcc, 0, v6
v_mov_b32 v36, 0
v_mov_b32 v37, 0
v_mov_b32 v40, 0
v_mov_b32 v41, 0
v_cndmask_b32 v38, 0, v7, vcc
v_cndmask_b32 v39, v7, 0, vcc
v_lshrrev_b32 v8, 1, v2
v_cmp_eq_u32 vcc, 0, v8
s_nop 1
v_cndmask_b32 v44, 0, v9, vcc
v_cmp_eq_u32 vcc, 1, v8
s_nop 1
v_cndmask_b32 v45, 0, v9, vcc
v_cmp_eq_u32 vcc, 2, v8
s_nop 1
v_cndmask_b32 v46, 0, v9, vcc
v_cmp_eq_u32 vcc, 3, v8
s_nop 1
v_cndmask_b32 v47, 0, v9, vcc
v_lshrrev_b32 v4, 2, v2
v_lshl_add_u32 v4, v3, 2, v4
v_lshlrev_b32 v4, 6, v4
v_and_b32 v5, 3, v0
v_lshl_add_u32 v4, v5, 3, v4
s_lshl_b32 s48, s43, 11
s_add_u32 s48, s48, 135168
v_add_u32 v53, s48, v4
s_mul_i32 s48, s40, 3072
s_add_u32 s48, s48, 139264
v_add_u32 v42, s48, v18
s_xor_b32 s49, s40, 2
s_mul_i32 s48, s49, 3072
s_add_u32 s48, s48, 139264
v_add_u32 v43, s48, v18
s_lshl_b32 s49, s49, 2
s_add_u32 s49, s49, 134672
v_mov_b32 v19, s49
v_xor_b32 v52, 8, v19
v_lshrrev_b32 v4, 3, v0
v_and_b32 v5, 7, v0
v_lshlrev_b32 v4, 11, v4
v_lshl_add_u32 v55, v5, 4, v4
v_lshlrev_b32 v4, 6, v2
v_lshl_add_u32 v58, v3, 4, v4
v_lshlrev_b32 v4, 4, v2
v_lshl_add_u32 v59, v3, 3, v4
s_mul_i32 s51, s42, 163840
s_add_u32 s51, s51, 9437184
s_lshl_b32 s50, s43, 1
s_add_u32 s50, s50, s44
s_lshl_b32 s48, s50, 15
s_add_u32 s48, s48, s51
s_add_u32 s48, s48, 0
s_lshl_b32 s49, s41, 7
s_add_u32 s53, s48, s49
s_add_u32 s54, s53, 16384
s_lshl_b32 s56, s50, 10
s_add_u32 s56, s56, s51
s_add_u32 s56, s56, 151552
s_xor_b32 s57, s56, 1024
s_lshl_b32 s58, s50, 11
s_add_u32 s58, s58, s51
s_add_u32 s58, s58, 139264
s_xor_b32 s59, s58, 2048
s_add_u32 s79, s58, s49
s_lshl_b32 s50, s41, 11
s_add_u32 s55, s48, s50
s_lshl_b32 s48, s43, 7
s_add_u32 s48, s48, 133888
v_lshl_add_u32 v7, v3, 4, s48
v_lshl_add_u32 v54, v2, 2, s48
s_lshl_b32 s49, s44, 6
v_add_u32 v8, s49, v2
v_lshlrev_b32 v8, 3, v8
v_add_u32 v8, 131072, v8
v_lshl_add_u32 v9, v3, 2, s49
v_lshlrev_b32 v9, 2, v9
v_add_u32 v9, 132096, v9
s_mov_b32 s64, 0
s_mov_b32 s65, 0
s_mov_b32 s66, 0x3fb8aa3b
s_mov_b32 s61, 4
ds_read_b64_tr_b16 v[84:85], v16 offset:8192
ds_read_b64_tr_b16 v[86:87], v16 offset:8704
ds_read_b64_tr_b16 v[88:89], v17 offset:8192
ds_read_b64_tr_b16 v[90:91], v17 offset:8704
ds_read_b64_tr_b16 v[92:93], v16 offset:16384
ds_read_b64_tr_b16 v[94:95], v16 offset:16896
ds_read_b64_tr_b16 v[96:97], v17 offset:16384
ds_read_b64_tr_b16 v[98:99], v17 offset:16896
ds_read_b64_tr_b16 v[76:77], v16 offset:0
ds_read_b64_tr_b16 v[78:79], v16 offset:512
ds_read_b64_tr_b16 v[80:81], v17 offset:0
ds_read_b64_tr_b16 v[82:83], v17 offset:512
s_barrier
ds_read_b128 v[60:63], v14 offset:0
ds_read_b128 v[64:67], v14 offset:2048
ds_read_b128 v[68:71], v14 offset:4096
ds_read_b128 v[72:75], v14 offset:6144
s_waitcnt lgkmcnt(0)
c3_loop:
v_mfma_f32_16x16x32_bf16 v[212:215], v[84:87], v[72:75], v[212:215]
ds_read_b128 v[100:103], v15 offset:0
v_mfma_f32_16x16x32_bf16 v[204:207], v[84:87], v[68:71], v[204:207]
ds_read_b128 v[104:107], v15 offset:2048
v_mfma_f32_16x16x32_bf16 v[196:199], v[84:87], v[64:67], v[196:199]
ds_read_b128 v[108:111], v15 offset:4096
v_mfma_f32_16x16x32_bf16 v[188:191], v[84:87], v[60:63], v[188:191]
ds_read_b128 v[112:115], v15 offset:6144
v_mfma_f32_16x16x32_bf16 v[192:195], v[88:91], v[60:63], v[192:195]
ds_read_b64_tr_b16 v[124:125], v16 offset:12288
v_mfma_f32_16x16x32_bf16 v[200:203], v[88:91], v[64:67], v[200:203]
ds_read_b64_tr_b16 v[126:127], v16 offset:12800
v_mfma_f32_16x16x32_bf16 v[208:211], v[88:91], v[68:71], v[208:211]
ds_read_b64_tr_b16 v[128:129], v17 offset:12288
v_mfma_f32_16x16x32_bf16 v[216:219], v[88:91], v[72:75], v[216:219]
ds_read_b64_tr_b16 v[130:131], v17 offset:12800
v_mfma_f32_16x16x32_bf16 v[244:247], v[72:75], v[92:95], v[244:247]
ds_read_b64_tr_b16 v[132:133], v16 offset:20480
v_mfma_f32_16x16x32_bf16 v[248:251], v[72:75], v[96:99], v[248:251]
ds_read_b64_tr_b16 v[134:135], v16 offset:20992
v_mfma_f32_16x16x32_bf16 v[240:243], v[68:71], v[96:99], v[240:243]
ds_read_b64_tr_b16 v[136:137], v17 offset:20480
v_mfma_f32_16x16x32_bf16 v[236:239], v[68:71], v[92:95], v[236:239]
ds_read_b64_tr_b16 v[138:139], v17 offset:20992
v_mfma_f32_16x16x32_bf16 v[228:231], v[64:67], v[92:95], v[228:231]
ds_read_b64_tr_b16 v[116:117], v16 offset:4096
v_mfma_f32_16x16x32_bf16 v[232:235], v[64:67], v[96:99], v[232:235]
ds_read_b64_tr_b16 v[118:119], v16 offset:4608
v_mfma_f32_16x16x32_bf16 v[224:227], v[60:63], v[96:99], v[224:227]
ds_read_b64_tr_b16 v[120:121], v17 offset:4096
v_mfma_f32_16x16x32_bf16 v[220:223], v[60:63], v[92:95], v[220:223]
ds_read_b64_tr_b16 v[122:123], v17 offset:4608
v_mfma_f32_16x16x32_bf16 v[156:159], v[76:79], v[60:63], v[156:159]
s_add_u32 s65, s65, 40960
s_cmp_eq_u32 s65, 122880
v_mfma_f32_16x16x32_bf16 v[164:167], v[76:79], v[64:67], v[164:167]
s_cselect_b32 s65, 0, s65
s_add_u32 s64, s64, 1
v_mfma_f32_16x16x32_bf16 v[172:175], v[76:79], v[68:71], v[172:175]
v_add_u32 v14, s65, v10
v_add_u32 v15, s65, v11
v_mfma_f32_16x16x32_bf16 v[180:183], v[76:79], v[72:75], v[180:183]
v_add_u32 v16, s65, v12
v_add_u32 v17, s65, v13
v_mfma_f32_16x16x32_bf16 v[184:187], v[80:83], v[72:75], v[184:187]
v_mfma_f32_16x16x32_bf16 v[176:179], v[80:83], v[68:71], v[176:179]
s_cmp_eq_u32 s64, 16
s_cbranch_scc1 c3_last
v_mfma_f32_16x16x32_bf16 v[168:171], v[80:83], v[64:67], v[168:171]
s_waitcnt lgkmcnt(0)
v_mfma_f32_16x16x32_bf16 v[160:163], v[80:83], v[60:63], v[160:163]
s_barrier
v_mfma_f32_16x16x32_bf16 v[212:215], v[124:127], v[112:115], v[212:215]
ds_read_b128 v[60:63], v14 offset:0
v_mfma_f32_16x16x32_bf16 v[204:207], v[124:127], v[108:111], v[204:207]
ds_read_b128 v[64:67], v14 offset:2048
v_mfma_f32_16x16x32_bf16 v[196:199], v[124:127], v[104:107], v[196:199]
ds_read_b128 v[68:71], v14 offset:4096
v_mfma_f32_16x16x32_bf16 v[188:191], v[124:127], v[100:103], v[188:191]
ds_read_b128 v[72:75], v14 offset:6144
v_mfma_f32_16x16x32_bf16 v[192:195], v[128:131], v[100:103], v[192:195]
ds_read_b64_tr_b16 v[84:85], v16 offset:8192
v_mfma_f32_16x16x32_bf16 v[200:203], v[128:131], v[104:107], v[200:203]
ds_read_b64_tr_b16 v[86:87], v16 offset:8704
v_mfma_f32_16x16x32_bf16 v[208:211], v[128:131], v[108:111], v[208:211]
ds_read_b64_tr_b16 v[88:89], v17 offset:8192
v_mfma_f32_16x16x32_bf16 v[216:219], v[128:131], v[112:115], v[216:219]
ds_read_b64_tr_b16 v[90:91], v17 offset:8704
v_mfma_f32_16x16x32_bf16 v[244:247], v[112:115], v[132:135], v[244:247]
ds_read_b64_tr_b16 v[92:93], v16 offset:16384
v_mfma_f32_16x16x32_bf16 v[248:251], v[112:115], v[136:139], v[248:251]
ds_read_b64_tr_b16 v[94:95], v16 offset:16896
v_mfma_f32_16x16x32_bf16 v[240:243], v[108:111], v[136:139], v[240:243]
ds_read_b64_tr_b16 v[96:97], v17 offset:16384
v_mfma_f32_16x16x32_bf16 v[236:239], v[108:111], v[132:135], v[236:239]
ds_read_b64_tr_b16 v[98:99], v17 offset:16896
v_mfma_f32_16x16x32_bf16 v[228:231], v[104:107], v[132:135], v[228:231]
ds_read_b64_tr_b16 v[76:77], v16 offset:0
v_mfma_f32_16x16x32_bf16 v[232:235], v[104:107], v[136:139], v[232:235]
ds_read_b64_tr_b16 v[78:79], v16 offset:512
v_mfma_f32_16x16x32_bf16 v[224:227], v[100:103], v[136:139], v[224:227]
ds_read_b64_tr_b16 v[80:81], v17 offset:0
v_mfma_f32_16x16x32_bf16 v[220:223], v[100:103], v[132:135], v[220:223]
ds_read_b64_tr_b16 v[82:83], v17 offset:512
v_mfma_f32_16x16x32_bf16 v[156:159], v[116:119], v[100:103], v[156:159]
v_mfma_f32_16x16x32_bf16 v[164:167], v[116:119], v[104:107], v[164:167]
v_mfma_f32_16x16x32_bf16 v[172:175], v[116:119], v[108:111], v[172:175]
v_mfma_f32_16x16x32_bf16 v[180:183], v[116:119], v[112:115], v[180:183]
v_mfma_f32_16x16x32_bf16 v[184:187], v[120:123], v[112:115], v[184:187]
v_mfma_f32_16x16x32_bf16 v[176:179], v[120:123], v[108:111], v[176:179]
v_mfma_f32_16x16x32_bf16 v[168:171], v[120:123], v[104:107], v[168:171]
s_waitcnt lgkmcnt(0)
v_mfma_f32_16x16x32_bf16 v[160:163], v[120:123], v[100:103], v[160:163]
s_branch c3_loop
c3_last:
v_mfma_f32_16x16x32_bf16 v[168:171], v[80:83], v[64:67], v[168:171]
s_waitcnt lgkmcnt(0)
v_mfma_f32_16x16x32_bf16 v[160:163], v[80:83], v[60:63], v[160:163]
v_mfma_f32_16x16x32_bf16 v[212:215], v[124:127], v[112:115], v[212:215]
ds_read_b64_tr_b16 v[10:11], v53 offset:0
ds_read_b64_tr_b16 v[12:13], v53 offset:1024
v_mfma_f32_16x16x32_bf16 v[204:207], v[124:127], v[108:111], v[204:207]
ds_read_b64_tr_b16 v[14:15], v53 offset:32
ds_read_b64_tr_b16 v[16:17], v53 offset:1056
v_mfma_f32_16x16x32_bf16 v[196:199], v[124:127], v[104:107], v[196:199]
ds_read_b128 v[140:143], v7 offset:0
s_mul_i32 s48, s44, 0x80008000
v_mfma_f32_16x16x32_bf16 v[188:191], v[124:127], v[100:103], v[188:191]
ds_read_b128 v[144:147], v7 offset:64
v_mfma_f32_16x16x32_bf16 v[192:195], v[128:131], v[100:103], v[192:195]
ds_read_b128 v[148:151], v7 offset:256
v_mfma_f32_16x16x32_bf16 v[200:203], v[128:131], v[104:107], v[200:203]
ds_read_b128 v[152:155], v7 offset:320
v_mfma_f32_16x16x32_bf16 v[208:211], v[128:131], v[108:111], v[208:211]
ds_read2_b32 v[56:57], v54 offset0:128 offset1:144
s_waitcnt lgkmcnt(5)
v_mfma_f32_16x16x32_bf16 v[216:219], v[128:131], v[112:115], v[216:219]
s_barrier
v_mfma_f32_16x16x32_bf16 v[244:247], v[112:115], v[132:135], v[244:247]
ds_read_b64 v[92:93], v8 offset:0
v_xor_b32 v10, s48, v10
v_mfma_f32_16x16x32_bf16 v[248:251], v[112:115], v[136:139], v[248:251]
ds_read_b64 v[94:95], v8 offset:128
v_xor_b32 v11, s48, v11
v_mfma_f32_16x16x32_bf16 v[240:243], v[108:111], v[136:139], v[240:243]
ds_read_b64 v[96:97], v8 offset:256
v_xor_b32 v12, s48, v12
v_mfma_f32_16x16x32_bf16 v[236:239], v[108:111], v[132:135], v[236:239]
ds_read_b64 v[98:99], v8 offset:384
v_xor_b32 v13, s48, v13
v_mfma_f32_16x16x32_bf16 v[228:231], v[104:107], v[132:135], v[228:231]
ds_read_b128 v[60:63], v9 offset:0
v_xor_b32 v14, s48, v14
v_mfma_f32_16x16x32_bf16 v[232:235], v[104:107], v[136:139], v[232:235]
ds_read_b128 v[64:67], v9 offset:64
v_xor_b32 v15, s48, v15
v_mfma_f32_16x16x32_bf16 v[224:227], v[100:103], v[136:139], v[224:227]
ds_read_b128 v[68:71], v9 offset:128
v_xor_b32 v16, s48, v16
v_mfma_f32_16x16x32_bf16 v[220:223], v[100:103], v[132:135], v[220:223]
ds_read_b128 v[72:75], v9 offset:192
v_xor_b32 v17, s48, v17
v_mfma_f32_16x16x32_bf16 v[156:159], v[116:119], v[100:103], v[156:159]
ds_read_b128 v[76:79], v9 offset:512
v_mfma_f32_16x16x32_bf16 v[164:167], v[116:119], v[104:107], v[164:167]
ds_read_b128 v[80:83], v9 offset:576
v_mfma_f32_16x16x32_bf16 v[172:175], v[116:119], v[108:111], v[172:175]
ds_read_b128 v[84:87], v9 offset:640
v_mfma_f32_16x16x32_bf16 v[180:183], v[116:119], v[112:115], v[180:183]
ds_read_b128 v[88:91], v9 offset:704
v_mfma_f32_16x16x32_bf16 v[184:187], v[120:123], v[112:115], v[184:187]
v_mfma_f32_16x16x32_bf16 v[176:179], v[120:123], v[108:111], v[176:179]
v_mfma_f32_16x16x32_bf16 v[168:171], v[120:123], v[104:107], v[168:171]
v_mfma_f32_16x16x32_bf16 v[160:163], v[120:123], v[100:103], v[160:163]
c3_epi:
s_waitcnt lgkmcnt(0)
.p2align 3
v_mul_f32 v129, s66, v94
v_mul_f32 v128, s66, v92
v_mul_f32 v131, s66, v98
v_mul_f32 v130, s66, v96
v_pk_fma_f32 v[190:191], v[150:151], v[92:93], v[190:191] op_sel:[0,1,0] op_sel_hi:[1,1,1]
v_pk_fma_f32 v[212:213], v[148:149], v[98:99], v[212:213] op_sel:[0,1,0] op_sel_hi:[1,1,1]
v_pk_fma_f32 v[214:215], v[150:151], v[98:99], v[214:215] op_sel:[0,1,0] op_sel_hi:[1,1,1]
v_pk_fma_f32 v[188:189], v[148:149], v[92:93], v[188:189] op_sel:[0,1,0] op_sel_hi:[1,1,1]
v_pk_fma_f32 v[218:219], v[154:155], v[98:99], v[218:219] op_sel:[0,1,0] op_sel_hi:[1,1,1]
v_cvt_pk_bf16_f32 v188, v188, v189
v_cvt_pk_bf16_f32 v189, v190, v191
v_pk_fma_f32 v[196:197], v[148:149], v[94:95], v[196:197] op_sel:[0,1,0] op_sel_hi:[1,1,1]
v_pk_fma_f32 v[200:201], v[152:153], v[94:95], v[200:201] op_sel:[0,1,0] op_sel_hi:[1,1,1]
v_pk_fma_f32 v[210:211], v[154:155], v[96:97], v[210:211] op_sel:[0,1,0] op_sel_hi:[1,1,1]
v_pk_fma_f32 v[240:241], v[84:85], v[56:57], v[240:241] op_sel:[0,1,0] op_sel_hi:[1,1,1]
v_pk_fma_f32 v[228:229], v[80:81], v[56:57], v[228:229] op_sel:[0,0,0] op_sel_hi:[1,0,1]
v_pk_fma_f32 v[226:227], v[78:79], v[56:57], v[226:227] op_sel:[0,1,0] op_sel_hi:[1,1,1]
v_pk_fma_f32 v[192:193], v[152:153], v[92:93], v[192:193] op_sel:[0,1,0] op_sel_hi:[1,1,1]
v_cvt_pk_bf16_f32 v190, v192, v193
v_pk_fma_f32 v[238:239], v[86:87], v[56:57], v[238:239] op_sel:[0,0,0] op_sel_hi:[1,0,1]
v_pk_fma_f32 v[234:235], v[82:83], v[56:57], v[234:235] op_sel:[0,1,0] op_sel_hi:[1,1,1]
v_pk_mul_f32 v[226:227], v[226:227], v[62:63]
v_pk_fma_f32 v[204:205], v[148:149], v[96:97], v[204:205] op_sel:[0,1,0] op_sel_hi:[1,1,1]
v_cvt_pk_bf16_f32 v204, v204, v205
v_pk_fma_f32 v[202:203], v[154:155], v[94:95], v[202:203] op_sel:[0,1,0] op_sel_hi:[1,1,1]
v_pk_fma_f32 v[224:225], v[76:77], v[56:57], v[224:225] op_sel:[0,1,0] op_sel_hi:[1,1,1]
v_pk_fma_f32 v[216:217], v[152:153], v[98:99], v[216:217] op_sel:[0,1,0] op_sel_hi:[1,1,1]
v_pk_fma_f32 v[244:245], v[88:89], v[56:57], v[244:245] op_sel:[0,0,0] op_sel_hi:[1,0,1]
v_pk_mul_f32 v[238:239], v[238:239], v[70:71]
v_pk_mul_f32 v[228:229], v[228:229], v[64:65]
v_pk_fma_f32 v[236:237], v[84:85], v[56:57], v[236:237] op_sel:[0,0,0] op_sel_hi:[1,0,1]
v_pk_fma_f32 v[220:221], v[76:77], v[56:57], v[220:221] op_sel:[0,0,0] op_sel_hi:[1,0,1]
v_pk_mul_f32 v[224:225], v[224:225], v[60:61]
v_cvt_pk_bf16_f32 v212, v212, v213
v_cvt_pk_bf16_f32 v213, v214, v215
v_cvt_pk_bf16_f32 v196, v196, v197
v_pk_mul_f32 v[240:241], v[240:241], v[68:69]
v_pk_fma_f32 v[198:199], v[150:151], v[94:95], v[198:199] op_sel:[0,1,0] op_sel_hi:[1,1,1]
v_cvt_pk_bf16_f32 v197, v198, v199
v_cvt_pk_bf16_f32 v198, v200, v201
v_cvt_pk_bf16_f32 v199, v202, v203
v_cvt_pk_bf16_f32 v215, v218, v219
v_pk_fma_f32 v[208:209], v[152:153], v[96:97], v[208:209] op_sel:[0,1,0] op_sel_hi:[1,1,1]
v_pk_fma_f32 v[246:247], v[90:91], v[56:57], v[246:247] op_sel:[0,0,0] op_sel_hi:[1,0,1]
v_pk_fma_f32 v[250:251], v[90:91], v[56:57], v[250:251] op_sel:[0,1,0] op_sel_hi:[1,1,1]
v_pk_mul_f32 v[250:251], v[250:251], v[74:75]
v_pk_fma_f32 v[206:207], v[150:151], v[96:97], v[206:207] op_sel:[0,1,0] op_sel_hi:[1,1,1]
v_cvt_pk_bf16_f32 v205, v206, v207
v_pk_fma_f32 v[242:243], v[86:87], v[56:57], v[242:243] op_sel:[0,1,0] op_sel_hi:[1,1,1]
v_cvt_pk_bf16_f32 v207, v210, v211
v_pk_mul_f32 v[236:237], v[236:237], v[68:69]
v_pk_fma_f32 v[230:231], v[82:83], v[56:57], v[230:231] op_sel:[0,0,0] op_sel_hi:[1,0,1]
v_pk_fma_f32 v[194:195], v[154:155], v[92:93], v[194:195] op_sel:[0,1,0] op_sel_hi:[1,1,1]
v_cvt_pk_bf16_f32 v191, v194, v195
v_pk_fma_f32 v[232:233], v[80:81], v[56:57], v[232:233] op_sel:[0,1,0] op_sel_hi:[1,1,1]
v_pk_mul_f32 v[232:233], v[232:233], v[64:65]
v_pk_mul_f32 v[230:231], v[230:231], v[66:67]
v_pk_fma_f32 v[248:249], v[88:89], v[56:57], v[248:249] op_sel:[0,1,0] op_sel_hi:[1,1,1]
v_pk_mul_f32 v[248:249], v[248:249], v[72:73]
v_pk_mul_f32 v[242:243], v[242:243], v[70:71]
v_mfma_f32_16x16x32_bf16 v[68:71], v[10:13], v[196:199], 0
v_cvt_pk_bf16_f32 v206, v208, v209
v_cvt_pk_bf16_f32 v214, v216, v217
v_cvt_pk_bf16_f32 v121, v226, v227
v_mfma_f32_16x16x32_bf16 v[80:83], v[14:17], v[204:207], 0
v_cvt_pk_bf16_f32 v120, v224, v225
v_cvt_pk_bf16_f32 v114, v228, v229
v_mfma_f32_16x16x32_bf16 v[84:87], v[10:13], v[212:215], 0
v_cvt_pk_bf16_f32 v116, v236, v237
v_min3_f32 v105, v68, v69, v70
v_mfma_f32_16x16x32_bf16 v[88:91], v[14:17], v[212:215], 0
v_max3_f32 v101, v68, v69, v70
v_cvt_pk_bf16_f32 v115, v230, v231
v_cvt_pk_bf16_f32 v122, v232, v233
v_cvt_pk_bf16_f32 v127, v250, v251
v_cvt_pk_bf16_f32 v124, v240, v241
v_pk_mul_f32 v[244:245], v[244:245], v[72:73]
v_pk_fma_f32 v[222:223], v[78:79], v[56:57], v[222:223] op_sel:[0,0,0] op_sel_hi:[1,0,1]
v_pk_mul_f32 v[222:223], v[222:223], v[62:63]
v_mfma_f32_16x16x32_bf16 v[76:79], v[10:13], v[204:207], 0
v_min3_f32 v107, v84, v85, v86
v_min3_f32 v107, v107, v87, v88
v_min3_f32 v107, v107, v89, v90
v_min_f32_e64 v107, v107, v91
v_max3_f32 v103, v84, v85, v86
v_pk_mul_f32 v[220:221], v[220:221], v[60:61]
v_mfma_f32_16x16x32_bf16 v[60:63], v[10:13], v[188:191], 0
v_max3_f32 v103, v103, v87, v88
v_min3_f32 v106, v76, v77, v78
v_min3_f32 v106, v106, v79, v80
v_min3_f32 v106, v106, v81, v82
v_min_f32 v106, v106, v83
v_pk_mul_f32 v[234:235], v[234:235], v[66:67]
v_mfma_f32_16x16x32_bf16 v[64:67], v[14:17], v[188:191], 0
v_permlane32_swap_b32 v106, v107
v_min3_f32 v104, v60, v61, v62
v_min_f32 v106, v106, v107
v_max3_f32 v103, v103, v89, v90
v_pk_mul_f32 v[246:247], v[246:247], v[74:75]
v_mfma_f32_16x16x32_bf16 v[72:75], v[14:17], v[196:199], 0
v_max_f32 v103, v103, v91
v_max3_f32 v102, v76, v77, v78
v_min3_f32 v104, v104, v63, v64
v_min3_f32 v104, v104, v65, v66
v_min_f32 v104, v104, v67
v_max3_f32 v102, v102, v79, v80
v_max3_f32 v102, v102, v81, v82
v_max_f32 v102, v102, v83
v_min3_f32 v105, v105, v71, v72
v_min3_f32 v105, v105, v73, v74
v_min_f32 v105, v105, v75
v_max3_f32 v101, v101, v71, v72
v_max3_f32 v101, v101, v73, v74
v_permlane32_swap_b32 v104, v105
v_permlane32_swap_b32 v102, v103
v_min_f32 v104, v104, v105
v_max_f32 v102, v102, v103
v_max_f32 v101, v101, v75
v_permlane16_swap_b32 v104, v106
v_max3_f32 v100, v60, v61, v62
v_min_f32 v104, v104, v106
v_mov_b32 v106, v104
v_max3_f32 v100, v100, v63, v64
v_max3_f32 v100, v100, v65, v66
v_max_f32 v100, v100, v67
v_permlane16_swap_b32 v104, v106
v_cvt_pk_bf16_f32 v112, v220, v221
v_permlane32_swap_b32 v100, v101
v_mov_b32 v105, v104
v_max_f32 v100, v100, v101
v_mov_b32 v107, v106
v_permlane32_swap_b32 v104, v105
v_permlane16_swap_b32 v100, v102
v_pk_mul_f32 v[104:105], v[104:105], v[128:129]
v_pk_fma_f32 v[226:227], v[66:67], v[128:129], v[104:105] op_sel:[0,0,0] op_sel_hi:[1,0,0] neg_lo:[1,0,0] neg_hi:[1,0,0]
v_pk_fma_f32 v[230:231], v[70:71], v[128:129], v[104:105] op_sel:[0,1,1] op_sel_hi:[1,1,1] neg_lo:[1,0,0] neg_hi:[1,0,0]
v_exp_f32 v226, v226
v_pk_fma_f32 v[224:225], v[64:65], v[128:129], v[104:105] op_sel:[0,0,0] op_sel_hi:[1,0,0] neg_lo:[1,0,0] neg_hi:[1,0,0]
v_exp_f32 v224, v224
v_pk_fma_f32 v[228:229], v[68:69], v[128:129], v[104:105] op_sel:[0,1,1] op_sel_hi:[1,1,1] neg_lo:[1,0,0] neg_hi:[1,0,0]
v_exp_f32 v231, v231
v_cvt_pk_bf16_f32 v113, v222, v223
v_pk_fma_f32 v[222:223], v[62:63], v[128:129], v[104:105] op_sel:[0,0,0] op_sel_hi:[1,0,0] neg_lo:[1,0,0] neg_hi:[1,0,0]
v_exp_f32 v222, v222
v_pk_fma_f32 v[220:221], v[60:61], v[128:129], v[104:105] op_sel:[0,0,0] op_sel_hi:[1,0,0] neg_lo:[1,0,0] neg_hi:[1,0,0]
v_exp_f32 v221, v221
v_exp_f32 v220, v220
v_max_f32 v100, v100, v102
v_exp_f32 v223, v223
v_mov_b32 v102, v100
v_pk_add_f32 v[110:111], v[220:221], v[222:223]
v_exp_f32 v225, v225
v_pk_fma_f32 v[232:233], v[72:73], v[128:129], v[104:105] op_sel:[0,1,1] op_sel_hi:[1,1,1] neg_lo:[1,0,0] neg_hi:[1,0,0]
v_exp_f32 v232, v232
v_exp_f32 v233, v233
v_pk_add_f32 v[110:111], v[110:111], v[224:225]
v_exp_f32 v229, v229
v_exp_f32 v228, v228
v_exp_f32 v227, v227
v_cvt_pk_bf16_f32 v123, v234, v235
v_pk_fma_f32 v[234:235], v[74:75], v[128:129], v[104:105] op_sel:[0,1,1] op_sel_hi:[1,1,1] neg_lo:[1,0,0] neg_hi:[1,0,0]
v_pk_add_f32 v[110:111], v[110:111], v[226:227]
v_add_f32 v104, v110, v111
v_cvt_pk_bf16_f32 v118, v244, v245
v_permlane32_swap_b32 v106, v107
v_permlane16_swap_b32 v100, v102
v_exp_f32 v234, v234
v_mov_b32 v101, v100
v_exp_f32 v235, v235
v_exp_f32_e64 v230, v230
v_cvt_pk_bf16_f32 v125, v242, v243
v_pk_add_f32 v[110:111], v[228:229], v[230:231]
v_pk_add_f32 v[110:111], v[110:111], v[232:233]
v_pk_add_f32 v[110:111], v[110:111], v[234:235]
v_cvt_pk_bf16_f32 v126, v248, v249
v_pk_mul_f32 v[106:107], v[106:107], v[130:131]
v_pk_fma_f32 v[236:237], v[76:77], v[130:131], v[106:107] op_sel:[0,0,0] op_sel_hi:[1,0,0] neg_lo:[1,0,0] neg_hi:[1,0,0]
v_exp_f32 v237, v237
v_exp_f32 v236, v236
v_pk_fma_f32 v[242:243], v[82:83], v[130:131], v[106:107] op_sel:[0,0,0] op_sel_hi:[1,0,0] neg_lo:[1,0,0] neg_hi:[1,0,0]
v_pk_fma_f32 v[250:251], v[90:91], v[130:131], v[106:107] op_sel:[0,1,1] op_sel_hi:[1,1,1] neg_lo:[1,0,0] neg_hi:[1,0,0]
v_add_f32 v105, v110, v111
v_exp_f32 v243, v243
v_cvt_pk_bf16_f32 v119, v246, v247
v_pk_fma_f32 v[246:247], v[86:87], v[130:131], v[106:107] op_sel:[0,1,1] op_sel_hi:[1,1,1] neg_lo:[1,0,0] neg_hi:[1,0,0]
v_exp_f32 v246, v246
v_cvt_pk_bf16_f32 v117, v238, v239
v_pk_fma_f32 v[238:239], v[78:79], v[130:131], v[106:107] op_sel:[0,0,0] op_sel_hi:[1,0,0] neg_lo:[1,0,0] neg_hi:[1,0,0]
v_exp_f32 v238, v238
v_exp_f32 v247, v247
v_pk_fma_f32 v[240:241], v[80:81], v[130:131], v[106:107] op_sel:[0,0,0] op_sel_hi:[1,0,0] neg_lo:[1,0,0] neg_hi:[1,0,0]
v_exp_f32 v240, v240
v_exp_f32 v241, v241
v_permlane32_swap_b32 v100, v101
v_exp_f32 v242, v242
v_pk_fma_f32 v[244:245], v[84:85], v[130:131], v[106:107] op_sel:[0,1,1] op_sel_hi:[1,1,1] neg_lo:[1,0,0] neg_hi:[1,0,0]
v_exp_f32 v244, v244
v_exp_f32_e64 v239, v239
v_pk_mul_f32 v[100:101], v[100:101], v[128:129]
v_pk_fma_f32 v[62:63], v[62:63], v[128:129], v[100:101] op_sel:[0,0,0] op_sel_hi:[1,0,0] neg_lo:[0,0,1] neg_hi:[0,0,1]
v_pk_add_f32 v[110:111], v[236:237], v[238:239]
v_pk_add_f32 v[110:111], v[110:111], v[240:241]
v_pk_add_f32 v[110:111], v[110:111], v[242:243]
v_pk_fma_f32 v[72:73], v[72:73], v[128:129], v[100:101] op_sel:[0,1,1] op_sel_hi:[1,1,1] neg_lo:[0,0,1] neg_hi:[0,0,1]
v_pk_fma_f32 v[66:67], v[66:67], v[128:129], v[100:101] op_sel:[0,0,0] op_sel_hi:[1,0,0] neg_lo:[0,0,1] neg_hi:[0,0,1]
v_exp_f32 v62, v62
v_pk_fma_f32 v[60:61], v[60:61], v[128:129], v[100:101] op_sel:[0,0,0] op_sel_hi:[1,0,0] neg_lo:[0,0,1] neg_hi:[0,0,1]
v_exp_f32 v60, v60
v_exp_f32 v245, v245
v_exp_f32 v73, v73
v_pk_fma_f32 v[248:249], v[88:89], v[130:131], v[106:107] op_sel:[0,1,1] op_sel_hi:[1,1,1] neg_lo:[1,0,0] neg_hi:[1,0,0]
v_add_f32 v106, v110, v111
v_exp_f32 v249, v249
v_pk_add_f32 v[110:111], v[244:245], v[246:247]
v_exp_f32 v248, v248
v_pk_fma_f32 v[64:65], v[64:65], v[128:129], v[100:101] op_sel:[0,0,0] op_sel_hi:[1,0,0] neg_lo:[0,0,1] neg_hi:[0,0,1]
v_exp_f32 v64, v64
v_pk_add_f32 v[110:111], v[110:111], v[248:249]
v_exp_f32 v65, v65
v_exp_f32 v61, v61
v_exp_f32 v66, v66
v_exp_f32 v251, v251
v_exp_f32 v63, v63
v_pk_fma_f32 v[74:75], v[74:75], v[128:129], v[100:101] op_sel:[0,1,1] op_sel_hi:[1,1,1] neg_lo:[0,0,1] neg_hi:[0,0,1]
v_pk_add_f32 v[108:109], v[60:61], v[62:63]
v_exp_f32 v67, v67
v_exp_f32 v250, v250
v_pk_fma_f32 v[68:69], v[68:69], v[128:129], v[100:101] op_sel:[0,1,1] op_sel_hi:[1,1,1] neg_lo:[0,0,1] neg_hi:[0,0,1]
v_pk_add_f32 v[110:111], v[110:111], v[250:251]
v_exp_f32 v68, v68
v_exp_f32 v69, v69
v_add_f32 v107, v110, v111
v_mov_b32 v103, v102
v_pk_fma_f32 v[70:71], v[70:71], v[128:129], v[100:101] op_sel:[0,1,1] op_sel_hi:[1,1,1] neg_lo:[0,0,1] neg_hi:[0,0,1]
v_exp_f32 v71, v71
v_exp_f32 v70, v70
v_permlane32_swap_b32 v106, v107
v_permlane32_swap_b32 v102, v103
v_pk_add_f32 v[108:109], v[108:109], v[64:65]
v_pk_add_f32 v[108:109], v[108:109], v[66:67]
v_add_f32 v100, v108, v109
v_pk_add_f32 v[108:109], v[68:69], v[70:71]
v_pk_mul_f32 v[102:103], v[102:103], v[130:131]
v_pk_fma_f32 v[78:79], v[78:79], v[130:131], v[102:103] op_sel:[0,0,0] op_sel_hi:[1,0,0] neg_lo:[0,0,1] neg_hi:[0,0,1]
v_exp_f32 v79, v79
v_exp_f32 v78, v78
v_exp_f32 v74, v74
v_exp_f32 v72, v72
v_pk_fma_f32 v[86:87], v[86:87], v[130:131], v[102:103] op_sel:[0,1,1] op_sel_hi:[1,1,1] neg_lo:[0,0,1] neg_hi:[0,0,1]
v_exp_f32 v87, v87
v_pk_fma_f32 v[76:77], v[76:77], v[130:131], v[102:103] op_sel:[0,0,0] op_sel_hi:[1,0,0] neg_lo:[0,0,1] neg_hi:[0,0,1]
v_exp_f32 v77, v77
v_add_f32 v106, v106, v107
v_pk_fma_f32 v[80:81], v[80:81], v[130:131], v[102:103] op_sel:[0,0,0] op_sel_hi:[1,0,0] neg_lo:[0,0,1] neg_hi:[0,0,1]
v_exp_f32 v81, v81
v_exp_f32 v80, v80
v_pk_add_f32 v[108:109], v[108:109], v[72:73]
v_permlane32_swap_b32 v104, v105
v_exp_f32 v75, v75
v_add_f32 v104, v104, v105
v_pk_fma_f32 v[82:83], v[82:83], v[130:131], v[102:103] op_sel:[0,0,0] op_sel_hi:[1,0,0] neg_lo:[0,0,1] neg_hi:[0,0,1]
v_exp_f32 v82, v82
v_exp_f32 v83, v83
v_permlane16_swap_b32 v104, v106
v_pk_add_f32 v[108:109], v[108:109], v[74:75]
v_add_f32 v101, v108, v109
v_exp_f32 v76, v76
v_add_f32 v104, v104, v106
v_rcp_f32 v104, v104
v_pk_fma_f32 v[84:85], v[84:85], v[130:131], v[102:103] op_sel:[0,1,1] op_sel_hi:[1,1,1] neg_lo:[0,0,1] neg_hi:[0,0,1]
v_exp_f32 v84, v84
v_exp_f32 v85, v85
v_mov_b32 v106, v104
v_pk_add_f32 v[108:109], v[76:77], v[78:79]
v_pk_add_f32 v[108:109], v[108:109], v[80:81]
v_pk_add_f32 v[108:109], v[108:109], v[82:83]
v_pk_fma_f32 v[88:89], v[88:89], v[130:131], v[102:103] op_sel:[0,1,1] op_sel_hi:[1,1,1] neg_lo:[0,0,1] neg_hi:[0,0,1]
v_exp_f32 v88, v88
v_exp_f32 v89, v89
v_exp_f32 v86, v86
v_pk_fma_f32 v[90:91], v[90:91], v[130:131], v[102:103] op_sel:[0,1,1] op_sel_hi:[1,1,1] neg_lo:[0,0,1] neg_hi:[0,0,1]
v_add_f32 v102, v108, v109
v_pk_add_f32 v[108:109], v[84:85], v[86:87]
v_pk_add_f32 v[108:109], v[108:109], v[88:89]
v_permlane16_swap_b32 v104, v106
v_exp_f32 v90, v90
v_exp_f32 v91, v91
v_permlane32_swap_b32 v100, v101
v_pk_add_f32 v[108:109], v[108:109], v[90:91]
v_add_f32 v103, v108, v109
v_add_f32 v100, v100, v101
v_mov_b32 v105, v104
v_permlane32_swap_b32 v102, v103
v_mov_b32 v107, v106
v_add_f32 v102, v102, v103
v_permlane32_swap_b32 v104, v105
v_permlane32_swap_b32 v106, v107
v_permlane16_swap_b32 v100, v102
v_pk_mul_f32 v[222:223], v[222:223], v[104:105] op_sel:[0,0] op_sel_hi:[1,0]
v_pk_mul_f32 v[226:227], v[226:227], v[104:105] op_sel:[0,0] op_sel_hi:[1,0]
v_pk_mul_f32 v[234:235], v[234:235], v[104:105] op_sel:[0,1] op_sel_hi:[1,1]
v_pk_mul_f32 v[232:233], v[232:233], v[104:105] op_sel:[0,1] op_sel_hi:[1,1]
v_pk_mul_f32 v[230:231], v[230:231], v[104:105] op_sel:[0,1] op_sel_hi:[1,1]
v_add_f32 v100, v100, v102
v_pk_mul_f32 v[228:229], v[228:229], v[104:105] op_sel:[0,1] op_sel_hi:[1,1]
v_cvt_pk_bf16_f32 v228, v228, v229
v_cvt_pk_bf16_f32 v229, v230, v231
v_cvt_pk_bf16_f32 v231, v234, v235
v_cvt_pk_bf16_f32 v230, v232, v233
v_pk_mul_f32 v[220:221], v[220:221], v[104:105] op_sel:[0,0] op_sel_hi:[1,0]
v_cvt_pk_bf16_f32 v220, v220, v221
v_pk_mul_f32 v[224:225], v[224:225], v[104:105] op_sel:[0,0] op_sel_hi:[1,0]
v_pk_mul_f32 v[236:237], v[236:237], v[106:107] op_sel:[0,0] op_sel_hi:[1,0]
v_pk_mul_f32 v[238:239], v[238:239], v[106:107] op_sel:[0,0] op_sel_hi:[1,0]
v_pk_mul_f32 v[240:241], v[240:241], v[106:107] op_sel:[0,0] op_sel_hi:[1,0]
v_pk_mul_f32 v[242:243], v[242:243], v[106:107] op_sel:[0,0] op_sel_hi:[1,0]
v_pk_mul_f32 v[248:249], v[248:249], v[106:107] op_sel:[0,1] op_sel_hi:[1,1]
v_rcp_f32 v100, v100
v_pk_mul_f32 v[244:245], v[244:245], v[106:107] op_sel:[0,1] op_sel_hi:[1,1]
v_mov_b32 v102, v100
v_pk_mul_f32 v[250:251], v[250:251], v[106:107] op_sel:[0,1] op_sel_hi:[1,1]
v_cvt_pk_bf16_f32 v221, v222, v223
v_pk_mul_f32 v[246:247], v[246:247], v[106:107] op_sel:[0,1] op_sel_hi:[1,1]
v_cvt_pk_bf16_f32 v222, v224, v225
v_mfma_f32_16x16x32_bf16 v[200:203], v[228:231], v[36:39], 0
v_cvt_pk_bf16_f32 v223, v226, v227
v_permlane16_swap_b32 v100, v102
v_mfma_f32_16x16x32_bf16 v[196:199], v[228:231], v[38:41], 0
v_mov_b32 v101, v100
v_cvt_pk_bf16_f32 v244, v244, v245
v_mfma_f32_16x16x32_bf16 v[212:215], v[220:223], v[38:41], 0
v_cvt_pk_bf16_f32 v245, v246, v247
v_cvt_pk_bf16_f32 v247, v250, v251
v_mfma_f32_16x16x32_bf16 v[216:219], v[220:223], v[36:39], 0
v_cvt_pk_bf16_f32 v234, v200, v201
v_cvt_pk_bf16_f32 v246, v248, v249
v_cvt_pk_bf16_f32 v226, v196, v197
v_cvt_pk_bf16_f32 v227, v198, v199
v_mfma_f32_16x16x32_bf16 v[196:199], v[244:247], v[38:41], 0
v_cvt_pk_bf16_f32 v225, v214, v215
v_cvt_pk_bf16_f32 v236, v236, v237
v_cvt_pk_bf16_f32 v237, v238, v239
v_cvt_pk_bf16_f32 v232, v216, v217
v_cvt_pk_bf16_f32 v233, v218, v219
v_cvt_pk_bf16_f32 v239, v242, v243
v_cvt_pk_bf16_f32 v238, v240, v241
v_cvt_pk_bf16_f32 v224, v212, v213
v_permlane32_swap_b32 v100, v101
v_mfma_f32_16x16x32_bf16 v[216:219], v[236:239], v[36:39], 0
v_mov_b32 v103, v102
v_cvt_pk_bf16_f32 v235, v202, v203
v_mfma_f32_16x16x32_bf16 v[212:215], v[236:239], v[38:41], 0
v_cvt_pk_bf16_f32 v243, v198, v199
v_permlane32_swap_b32 v102, v103
v_mfma_f32_16x16x32_bf16 v[200:203], v[244:247], v[36:39], 0
v_cvt_pk_bf16_f32 v242, v196, v197
v_mov_b32 v5, s61
v_mfma_f32_16x16x32_bf16 v[220:223], v[232:235], v[120:123], 0
v_cvt_pk_bf16_f32 v249, v218, v219
v_cvt_pk_bf16_f32 v248, v216, v217
v_cvt_pk_bf16_f32 v241, v214, v215
v_cvt_pk_bf16_f32 v240, v212, v213
v_cmp_eq_u32 s[50:51], s41, v2
v_pk_mul_f32 v[64:65], v[64:65], v[100:101] op_sel:[0,0] op_sel_hi:[1,0]
v_pk_mul_f32 v[74:75], v[74:75], v[100:101] op_sel:[0,1] op_sel_hi:[1,1]
v_pk_mul_f32 v[68:69], v[68:69], v[100:101] op_sel:[0,1] op_sel_hi:[1,1]
v_pk_mul_f32 v[72:73], v[72:73], v[100:101] op_sel:[0,1] op_sel_hi:[1,1]
v_pk_mul_f32 v[60:61], v[60:61], v[100:101] op_sel:[0,0] op_sel_hi:[1,0]
v_pk_mul_f32 v[62:63], v[62:63], v[100:101] op_sel:[0,0] op_sel_hi:[1,0]
v_pk_mul_f32 v[66:67], v[66:67], v[100:101] op_sel:[0,0] op_sel_hi:[1,0]
v_pk_mul_f32 v[76:77], v[76:77], v[102:103] op_sel:[0,0] op_sel_hi:[1,0]
v_pk_mul_f32 v[70:71], v[70:71], v[100:101] op_sel:[0,1] op_sel_hi:[1,1]
v_cvt_pk_bf16_f32 v60, v60, v61
v_pk_mul_f32 v[80:81], v[80:81], v[102:103] op_sel:[0,0] op_sel_hi:[1,0]
v_pk_mul_f32 v[78:79], v[78:79], v[102:103] op_sel:[0,0] op_sel_hi:[1,0]
v_pk_mul_f32 v[82:83], v[82:83], v[102:103] op_sel:[0,0] op_sel_hi:[1,0]
v_pk_mul_f32 v[86:87], v[86:87], v[102:103] op_sel:[0,1] op_sel_hi:[1,1]
v_cvt_pk_bf16_f32 v61, v62, v63
v_pk_mul_f32 v[84:85], v[84:85], v[102:103] op_sel:[0,1] op_sel_hi:[1,1]
v_cvt_pk_bf16_f32 v62, v64, v65
v_pk_mul_f32 v[88:89], v[88:89], v[102:103] op_sel:[0,1] op_sel_hi:[1,1]
v_cvt_pk_bf16_f32 v63, v66, v67
v_pk_mul_f32 v[90:91], v[90:91], v[102:103] op_sel:[0,1] op_sel_hi:[1,1]
v_cvt_pk_bf16_f32 v68, v68, v69
v_mfma_f32_16x16x32_bf16 v[208:211], v[60:63], v[36:39], 0
v_cvt_pk_bf16_f32 v69, v70, v71
v_cvt_pk_bf16_f32 v70, v72, v73
v_mfma_f32_16x16x32_bf16 v[204:207], v[60:63], v[38:41], 0
v_cvt_pk_bf16_f32 v71, v74, v75
v_cvt_pk_bf16_f32 v76, v76, v77
v_mfma_f32_16x16x32_bf16 v[60:63], v[232:235], v[112:115], 0
v_cvt_pk_bf16_f32 v250, v200, v201
v_cvt_pk_bf16_f32 v77, v78, v79
v_mfma_f32_16x16x32_bf16 v[192:195], v[68:71], v[36:39], 0
v_cvt_pk_bf16_f32 v78, v80, v81
v_cvt_pk_bf16_f32 v79, v82, v83
v_mfma_f32_16x16x32_bf16 v[188:191], v[68:71], v[38:41], 0
v_cvt_pk_bf16_f32 v65, v206, v207
v_cvt_pk_bf16_f32 v64, v204, v205
v_mfma_f32_16x16x32_bf16 v[68:71], v[224:227], v[120:123], 0
v_cvt_pk_bf16_f32 v251, v202, v203
v_cvt_pk_bf16_f32 v72, v208, v209
v_mfma_f32_16x16x32_bf16 v[152:155], v[224:227], v[112:115], 0
v_cvt_pk_bf16_f32 v73, v210, v211
v_cvt_pk_bf16_f32 v84, v84, v85
v_mfma_f32_16x16x32_bf16 v[60:63], v[248:251], v[116:119], v[60:63]
v_cvt_pk_bf16_f32 v85, v86, v87
v_cvt_pk_bf16_f32 v86, v88, v89
v_mfma_f32_16x16x32_bf16 v[228:231], v[224:227], v[48:51], 0
v_cvt_pk_bf16_f32 v67, v190, v191
v_cvt_pk_bf16_f32 v87, v90, v91
v_mfma_f32_16x16x32_bf16 v[220:223], v[248:251], v[124:127], v[220:223]
v_cvt_pk_bf16_f32 v66, v188, v189
v_cvt_pk_bf16_f32 v74, v192, v193
v_mfma_f32_16x16x32_bf16 v[152:155], v[240:243], v[116:119], v[152:155]
v_cvt_pk_bf16_f32 v75, v194, v195
v_mfma_f32_16x16x32_bf16 v[204:207], v[76:79], v[38:41], 0
v_mfma_f32_16x16x32_bf16 v[208:211], v[76:79], v[36:39], 0
v_mfma_f32_16x16x32_bf16 v[228:231], v[240:243], v[48:51], v[228:231]
v_mfma_f32_16x16x32_bf16 v[68:71], v[240:243], v[124:127], v[68:71]
v_mfma_f32_16x16x32_bf16 v[76:79], v[232:235], v[48:51], 0
s_nop 1
v_cvt_pk_bf16_f32 v152, v152, v153
v_mfma_f32_16x16x32_bf16 v[76:79], v[248:251], v[48:51], v[76:79]
v_cvt_pk_bf16_f32 v153, v154, v155
v_cvt_pk_bf16_f32 v154, v60, v61
v_mfma_f32_16x16x32_bf16 v[192:195], v[84:87], v[36:39], 0
v_cvt_pk_bf16_f32 v68, v68, v69
v_cvt_pk_bf16_f32 v155, v62, v63
v_mfma_f32_16x16x32_bf16 v[188:191], v[84:87], v[38:41], 0
ds_write_b128 v42, v[152:155] offset:0
v_mfma_f32_16x16x32_bf16 v[136:139], v[64:67], v[48:51], 0
v_cvt_pk_bf16_f32 v69, v70, v71
v_cvt_pk_bf16_f32 v228, v228, v229
v_mfma_f32_16x16x32_bf16 v[104:107], v[72:75], v[112:115], 0
v_cvt_pk_bf16_f32 v71, v222, v223
v_cvt_pk_bf16_f32 v229, v230, v231
v_mfma_f32_16x16x32_bf16 v[148:151], v[72:75], v[48:51], 0
v_cvt_pk_bf16_f32 v230, v76, v77
v_cvt_pk_bf16_f32 v70, v220, v221
v_mfma_f32_16x16x32_bf16 v[132:135], v[72:75], v[120:123], 0
ds_write_b128 v42, v[68:71] offset:1024
v_mfma_f32_16x16x32_bf16 v[108:111], v[64:67], v[120:123], 0
v_cvt_pk_bf16_f32 v231, v78, v79
ds_write_b128 v42, v[228:231] offset:2048
v_mfma_f32_16x16x32_bf16 v[100:103], v[64:67], v[112:115], 0
ds_write_b32 v52, v5
v_cvt_pk_bf16_f32 v88, v208, v209
v_cvt_pk_bf16_f32 v83, v190, v191
v_cvt_pk_bf16_f32 v91, v194, v195
v_cvt_pk_bf16_f32 v82, v188, v189
v_cvt_pk_bf16_f32 v80, v204, v205
v_cvt_pk_bf16_f32 v89, v210, v211
v_cvt_pk_bf16_f32 v81, v206, v207
v_cvt_pk_bf16_f32 v90, v192, v193
s_nop 0
v_mfma_f32_16x16x32_bf16 v[100:103], v[80:83], v[116:119], v[100:103]
v_mfma_f32_16x16x32_bf16 v[108:111], v[80:83], v[124:127], v[108:111]
v_mfma_f32_16x16x32_bf16 v[132:135], v[88:91], v[124:127], v[132:135]
v_mfma_f32_16x16x32_bf16 v[148:151], v[88:91], v[48:51], v[148:151]
v_mfma_f32_16x16x32_bf16 v[136:139], v[80:83], v[48:51], v[136:139]
v_mfma_f32_16x16x32_bf16 v[104:107], v[88:91], v[116:119], v[104:107]
s_mov_b32 s63, 0
px_120:
ds_read_b32 v4, v19
ds_read_b128 v[188:191], v43 offset:0
ds_read_b128 v[192:195], v43 offset:1024
ds_read_b128 v[196:199], v43 offset:2048
s_add_u32 s63, s63, 1
s_cmp_lt_u32 s63, 0x400000
s_waitcnt lgkmcnt(0)
v_cmp_ne_u32 vcc, s61, v4
s_cbranch_vccz pxd_121
s_cbranch_scc1 px_120
pxd_121:
v_mfma_f32_16x16x32_bf16 v[100:103], v[38:41], v[188:191], v[100:103]
v_mfma_f32_16x16x32_bf16 v[104:107], v[36:39], v[188:191], v[104:107]
v_mfma_f32_16x16x32_bf16 v[108:111], v[38:41], v[192:195], v[108:111]
v_mfma_f32_16x16x32_bf16 v[132:135], v[36:39], v[192:195], v[132:135]
v_mfma_f32_16x16x32_bf16 v[136:139], v[38:41], v[196:199], v[136:139]
v_mfma_f32_16x16x32_bf16 v[148:151], v[36:39], v[196:199], v[148:151]
s_nop 2
v_cvt_pk_bf16_f32 v100, v100, v101
v_cvt_pk_bf16_f32 v101, v102, v103
v_cvt_pk_bf16_f32 v102, v104, v105
v_cvt_pk_bf16_f32 v103, v106, v107
buffer_store_dwordx4 v[100:103], v55, s[32:35], s53 offen sc1
v_cvt_pk_bf16_f32 v108, v108, v109
v_cvt_pk_bf16_f32 v109, v110, v111
v_cvt_pk_bf16_f32 v110, v132, v133
v_cvt_pk_bf16_f32 v111, v134, v135
buffer_store_dwordx4 v[108:111], v55, s[32:35], s54 offen sc1
v_cvt_pk_bf16_f32 v136, v136, v137
v_cvt_pk_bf16_f32 v137, v138, v139
v_cvt_pk_bf16_f32 v138, v148, v149
v_cvt_pk_bf16_f32 v139, v150, v151
s_mov_b64 exec, s[50:51]
buffer_store_dwordx4 v[136:139], v58, s[32:35], s56 offen sc1
s_mov_b64 exec, -1
s_mov_b32 s51, 0
.p2align 3
v_pk_fma_f32 v[156:157], v[140:141], v[92:93], v[156:157] op_sel:[0,1,0] op_sel_hi:[1,1,1]
v_pk_fma_f32 v[164:165], v[140:141], v[94:95], v[164:165] op_sel:[0,1,0] op_sel_hi:[1,1,1]
v_pk_fma_f32 v[172:173], v[140:141], v[96:97], v[172:173] op_sel:[0,1,0] op_sel_hi:[1,1,1]
v_pk_fma_f32 v[180:181], v[140:141], v[98:99], v[180:181] op_sel:[0,1,0] op_sel_hi:[1,1,1]
v_pk_fma_f32 v[158:159], v[142:143], v[92:93], v[158:159] op_sel:[0,1,0] op_sel_hi:[1,1,1]
v_cvt_pk_bf16_f32 v156, v156, v157
v_pk_fma_f32 v[166:167], v[142:143], v[94:95], v[166:167] op_sel:[0,1,0] op_sel_hi:[1,1,1]
v_cvt_pk_bf16_f32 v164, v164, v165
v_pk_fma_f32 v[174:175], v[142:143], v[96:97], v[174:175] op_sel:[0,1,0] op_sel_hi:[1,1,1]
v_cvt_pk_bf16_f32 v172, v172, v173
v_pk_fma_f32 v[182:183], v[142:143], v[98:99], v[182:183] op_sel:[0,1,0] op_sel_hi:[1,1,1]
v_cvt_pk_bf16_f32 v180, v180, v181
v_pk_fma_f32 v[160:161], v[144:145], v[92:93], v[160:161] op_sel:[0,1,0] op_sel_hi:[1,1,1]
v_pk_fma_f32 v[162:163], v[146:147], v[92:93], v[162:163] op_sel:[0,1,0] op_sel_hi:[1,1,1]
v_cvt_pk_bf16_f32 v157, v158, v159
v_pk_fma_f32 v[168:169], v[144:145], v[94:95], v[168:169] op_sel:[0,1,0] op_sel_hi:[1,1,1]
v_pk_fma_f32 v[170:171], v[146:147], v[94:95], v[170:171] op_sel:[0,1,0] op_sel_hi:[1,1,1]
v_cvt_pk_bf16_f32 v165, v166, v167
v_pk_fma_f32 v[176:177], v[144:145], v[96:97], v[176:177] op_sel:[0,1,0] op_sel_hi:[1,1,1]
v_pk_fma_f32 v[178:179], v[146:147], v[96:97], v[178:179] op_sel:[0,1,0] op_sel_hi:[1,1,1]
v_cvt_pk_bf16_f32 v173, v174, v175
v_pk_fma_f32 v[184:185], v[144:145], v[98:99], v[184:185] op_sel:[0,1,0] op_sel_hi:[1,1,1]
v_pk_fma_f32 v[186:187], v[146:147], v[98:99], v[186:187] op_sel:[0,1,0] op_sel_hi:[1,1,1]
v_cvt_pk_bf16_f32 v181, v182, v183
v_cvt_pk_bf16_f32 v158, v160, v161
v_cvt_pk_bf16_f32 v159, v162, v163
v_cvt_pk_bf16_f32 v166, v168, v169
v_cvt_pk_bf16_f32 v167, v170, v171
v_mfma_f32_16x16x32_bf16 v[60:63], v[10:13], v[156:159], 0
v_cvt_pk_bf16_f32 v174, v176, v177
v_cvt_pk_bf16_f32 v175, v178, v179
v_mfma_f32_16x16x32_bf16 v[68:71], v[10:13], v[164:167], 0
v_cvt_pk_bf16_f32 v182, v184, v185
v_cvt_pk_bf16_f32 v183, v186, v187
v_mfma_f32_16x16x32_bf16 v[76:79], v[10:13], v[172:175], 0
s_nop 0
v_mfma_f32_16x16x32_bf16 v[84:87], v[10:13], v[180:183], 0
v_min3_f32 v104, v60, v61, v62
v_max3_f32 v100, v60, v61, v62
v_mfma_f32_16x16x32_bf16 v[64:67], v[14:17], v[156:159], 0
v_min3_f32 v105, v68, v69, v70
v_max3_f32 v101, v68, v69, v70
v_mfma_f32_16x16x32_bf16 v[72:75], v[14:17], v[164:167], 0
v_min3_f32 v106, v76, v77, v78
v_max3_f32 v102, v76, v77, v78
v_mfma_f32_16x16x32_bf16 v[80:83], v[14:17], v[172:175], 0
v_min3_f32 v107, v84, v85, v86
v_max3_f32 v103, v84, v85, v86
v_mfma_f32_16x16x32_bf16 v[88:91], v[14:17], v[180:183], 0
v_min3_f32 v104, v104, v63, v64
v_max3_f32 v100, v100, v63, v64
v_min3_f32 v105, v105, v71, v72
v_min3_f32 v104, v104, v65, v66
v_max3_f32 v101, v101, v71, v72
v_min3_f32 v106, v106, v79, v80
v_min3_f32 v105, v105, v73, v74
v_max3_f32 v102, v102, v79, v80
v_min3_f32 v107, v107, v87, v88
v_min3_f32 v106, v106, v81, v82
v_max3_f32 v103, v103, v87, v88
v_min3_f32 v107, v107, v89, v90
v_max3_f32 v100, v100, v65, v66
v_min_f32 v104, v104, v67
v_max3_f32 v101, v101, v73, v74
v_min_f32 v105, v105, v75
v_max3_f32 v102, v102, v81, v82
v_min_f32 v106, v106, v83
v_max3_f32 v103, v103, v89, v90
v_min_f32 v107, v107, v91
v_max_f32 v100, v100, v67
v_max_f32 v101, v101, v75
v_max_f32 v102, v102, v83
v_max_f32 v103, v103, v91
v_permlane32_swap_b32 v104, v105
v_permlane32_swap_b32 v106, v107
v_permlane32_swap_b32 v100, v101
v_permlane32_swap_b32 v102, v103
v_min_f32 v104, v104, v105
v_min_f32 v106, v106, v107
v_max_f32 v100, v100, v101
v_max_f32 v102, v102, v103
v_permlane16_swap_b32 v104, v106
s_nop 0
v_permlane16_swap_b32 v100, v102
v_min_f32 v104, v104, v106
v_max_f32 v100, v100, v102
v_mov_b32 v106, v104
v_mov_b32 v102, v100
s_nop 0
v_permlane16_swap_b32 v104, v106
v_permlane16_swap_b32 v100, v102
v_mov_b32 v105, v104
v_mov_b32 v101, v100
v_mov_b32 v103, v102
v_permlane32_swap_b32 v104, v105
v_mov_b32 v107, v106
v_permlane32_swap_b32_e64 v100, v101
v_pk_mul_f32 v[104:105], v[104:105], v[128:129]
v_pk_mul_f32 v[100:101], v[100:101], v[128:129]
v_pk_fma_f32 v[220:221], v[60:61], v[128:129], v[104:105] op_sel:[0,0,0] op_sel_hi:[1,0,0] neg_lo:[1,0,0] neg_hi:[1,0,0]
v_pk_fma_f32 v[222:223], v[62:63], v[128:129], v[104:105] op_sel:[0,0,0] op_sel_hi:[1,0,0] neg_lo:[1,0,0] neg_hi:[1,0,0]
v_pk_fma_f32 v[224:225], v[64:65], v[128:129], v[104:105] op_sel:[0,0,0] op_sel_hi:[1,0,0] neg_lo:[1,0,0] neg_hi:[1,0,0]
v_pk_fma_f32 v[226:227], v[66:67], v[128:129], v[104:105] op_sel:[0,0,0] op_sel_hi:[1,0,0] neg_lo:[1,0,0] neg_hi:[1,0,0]
v_pk_fma_f32 v[228:229], v[68:69], v[128:129], v[104:105] op_sel:[0,1,1] op_sel_hi:[1,1,1] neg_lo:[1,0,0] neg_hi:[1,0,0]
v_pk_fma_f32 v[230:231], v[70:71], v[128:129], v[104:105] op_sel:[0,1,1] op_sel_hi:[1,1,1] neg_lo:[1,0,0] neg_hi:[1,0,0]
v_pk_fma_f32 v[232:233], v[72:73], v[128:129], v[104:105] op_sel:[0,1,1] op_sel_hi:[1,1,1] neg_lo:[1,0,0] neg_hi:[1,0,0]
v_pk_fma_f32 v[234:235], v[74:75], v[128:129], v[104:105] op_sel:[0,1,1] op_sel_hi:[1,1,1] neg_lo:[1,0,0] neg_hi:[1,0,0]
v_permlane32_swap_b32 v102, v103
v_permlane32_swap_b32 v106, v107
v_pk_fma_f32 v[60:61], v[60:61], v[128:129], v[100:101] op_sel:[0,0,0] op_sel_hi:[1,0,0] neg_lo:[0,0,1] neg_hi:[0,0,1]
v_pk_fma_f32 v[62:63], v[62:63], v[128:129], v[100:101] op_sel:[0,0,0] op_sel_hi:[1,0,0] neg_lo:[0,0,1] neg_hi:[0,0,1]
v_pk_fma_f32 v[64:65], v[64:65], v[128:129], v[100:101] op_sel:[0,0,0] op_sel_hi:[1,0,0] neg_lo:[0,0,1] neg_hi:[0,0,1]
v_pk_fma_f32 v[66:67], v[66:67], v[128:129], v[100:101] op_sel:[0,0,0] op_sel_hi:[1,0,0] neg_lo:[0,0,1] neg_hi:[0,0,1]
v_pk_fma_f32 v[68:69], v[68:69], v[128:129], v[100:101] op_sel:[0,1,1] op_sel_hi:[1,1,1] neg_lo:[0,0,1] neg_hi:[0,0,1]
v_pk_fma_f32 v[70:71], v[70:71], v[128:129], v[100:101] op_sel:[0,1,1] op_sel_hi:[1,1,1] neg_lo:[0,0,1] neg_hi:[0,0,1]
v_pk_fma_f32 v[72:73], v[72:73], v[128:129], v[100:101] op_sel:[0,1,1] op_sel_hi:[1,1,1] neg_lo:[0,0,1] neg_hi:[0,0,1]
v_pk_fma_f32 v[74:75], v[74:75], v[128:129], v[100:101] op_sel:[0,1,1] op_sel_hi:[1,1,1] neg_lo:[0,0,1] neg_hi:[0,0,1]
v_exp_f32 v220, v220
v_exp_f32 v60, v60
v_exp_f32 v221, v221
v_exp_f32 v61, v61
v_exp_f32 v222, v222
v_exp_f32 v62, v62
v_exp_f32 v223, v223
v_exp_f32 v63, v63
v_exp_f32 v224, v224
v_exp_f32 v64, v64
v_exp_f32 v225, v225
v_exp_f32 v65, v65
v_exp_f32 v226, v226
v_exp_f32 v66, v66
v_exp_f32 v227, v227
v_exp_f32 v67, v67
v_exp_f32 v228, v228
v_exp_f32 v68, v68
v_exp_f32 v229, v229
v_exp_f32 v69, v69
v_exp_f32 v230, v230
v_exp_f32 v70, v70
v_exp_f32 v231, v231
v_exp_f32 v71, v71
v_exp_f32 v232, v232
v_exp_f32 v72, v72
v_exp_f32 v233, v233
v_exp_f32 v73, v73
v_exp_f32 v234, v234
v_exp_f32 v74, v74
v_exp_f32 v235, v235
v_exp_f32 v75, v75
v_pk_mul_f32 v[102:103], v[102:103], v[130:131]
v_pk_mul_f32 v[106:107], v[106:107], v[130:131]
buffer_load_dwordx4 v[212:215], v18, s[32:35], s55 offen offset:0 sc1
buffer_load_dwordx4 v[216:219], v18, s[32:35], s55 offen offset:1024 sc1
.p2align 3
v_pk_add_f32 v[108:109], v[60:61], v[62:63]
v_pk_add_f32 v[110:111], v[220:221], v[222:223]
v_pk_add_f32 v[108:109], v[108:109], v[64:65]
v_pk_add_f32 v[110:111], v[110:111], v[224:225]
v_pk_add_f32 v[108:109], v[108:109], v[66:67]
v_pk_add_f32 v[110:111], v[110:111], v[226:227]
v_add_f32 v100, v108, v109
v_add_f32 v104, v110, v111
v_pk_fma_f32 v[236:237], v[76:77], v[130:131], v[106:107] op_sel:[0,0,0] op_sel_hi:[1,0,0] neg_lo:[1,0,0] neg_hi:[1,0,0]
v_pk_fma_f32 v[238:239], v[78:79], v[130:131], v[106:107] op_sel:[0,0,0] op_sel_hi:[1,0,0] neg_lo:[1,0,0] neg_hi:[1,0,0]
v_pk_add_f32 v[108:109], v[68:69], v[70:71]
v_pk_add_f32 v[110:111], v[228:229], v[230:231]
v_pk_fma_f32 v[76:77], v[76:77], v[130:131], v[102:103] op_sel:[0,0,0] op_sel_hi:[1,0,0] neg_lo:[0,0,1] neg_hi:[0,0,1]
v_pk_fma_f32 v[78:79], v[78:79], v[130:131], v[102:103] op_sel:[0,0,0] op_sel_hi:[1,0,0] neg_lo:[0,0,1] neg_hi:[0,0,1]
v_pk_fma_f32 v[240:241], v[80:81], v[130:131], v[106:107] op_sel:[0,0,0] op_sel_hi:[1,0,0] neg_lo:[1,0,0] neg_hi:[1,0,0]
v_pk_add_f32 v[108:109], v[108:109], v[72:73]
v_pk_add_f32 v[110:111], v[110:111], v[232:233]
v_exp_f32 v236, v236
v_exp_f32 v76, v76
v_exp_f32 v237, v237
v_exp_f32 v77, v77
v_exp_f32 v238, v238
v_exp_f32 v78, v78
v_exp_f32 v239, v239
v_exp_f32 v79, v79
v_pk_fma_f32 v[80:81], v[80:81], v[130:131], v[102:103] op_sel:[0,0,0] op_sel_hi:[1,0,0] neg_lo:[0,0,1] neg_hi:[0,0,1]
v_pk_fma_f32 v[242:243], v[82:83], v[130:131], v[106:107] op_sel:[0,0,0] op_sel_hi:[1,0,0] neg_lo:[1,0,0] neg_hi:[1,0,0]
v_pk_add_f32 v[108:109], v[108:109], v[74:75]
v_pk_add_f32 v[110:111], v[110:111], v[234:235]
v_exp_f32 v240, v240
v_exp_f32 v80, v80
v_exp_f32 v241, v241
v_exp_f32 v81, v81
v_pk_fma_f32 v[82:83], v[82:83], v[130:131], v[102:103] op_sel:[0,0,0] op_sel_hi:[1,0,0] neg_lo:[0,0,1] neg_hi:[0,0,1]
v_add_f32 v101, v108, v109
v_add_f32 v105, v110, v111
v_exp_f32 v242, v242
v_exp_f32 v82, v82
v_exp_f32 v243, v243
v_exp_f32 v83, v83
v_pk_fma_f32 v[244:245], v[84:85], v[130:131], v[106:107] op_sel:[0,1,1] op_sel_hi:[1,1,1] neg_lo:[1,0,0] neg_hi:[1,0,0]
v_pk_fma_f32 v[246:247], v[86:87], v[130:131], v[106:107] op_sel:[0,1,1] op_sel_hi:[1,1,1] neg_lo:[1,0,0] neg_hi:[1,0,0]
v_pk_add_f32 v[108:109], v[76:77], v[78:79]
v_pk_add_f32 v[110:111], v[236:237], v[238:239]
v_pk_fma_f32 v[84:85], v[84:85], v[130:131], v[102:103] op_sel:[0,1,1] op_sel_hi:[1,1,1] neg_lo:[0,0,1] neg_hi:[0,0,1]
v_pk_fma_f32 v[86:87], v[86:87], v[130:131], v[102:103] op_sel:[0,1,1] op_sel_hi:[1,1,1] neg_lo:[0,0,1] neg_hi:[0,0,1]
v_pk_fma_f32 v[248:249], v[88:89], v[130:131], v[106:107] op_sel:[0,1,1] op_sel_hi:[1,1,1] neg_lo:[1,0,0] neg_hi:[1,0,0]
v_pk_fma_f32 v[250:251], v[90:91], v[130:131], v[106:107] op_sel:[0,1,1] op_sel_hi:[1,1,1] neg_lo:[1,0,0] neg_hi:[1,0,0]
v_pk_add_f32 v[108:109], v[108:109], v[80:81]
v_pk_add_f32 v[110:111], v[110:111], v[240:241]
v_exp_f32 v244, v244
v_exp_f32 v84, v84
v_exp_f32 v245, v245
v_exp_f32 v85, v85
v_exp_f32 v246, v246
v_exp_f32 v86, v86
v_exp_f32 v247, v247
v_exp_f32 v87, v87
v_pk_fma_f32 v[88:89], v[88:89], v[130:131], v[102:103] op_sel:[0,1,1] op_sel_hi:[1,1,1] neg_lo:[0,0,1] neg_hi:[0,0,1]
v_pk_fma_f32 v[90:91], v[90:91], v[130:131], v[102:103] op_sel:[0,1,1] op_sel_hi:[1,1,1] neg_lo:[0,0,1] neg_hi:[0,0,1]
v_pk_add_f32 v[108:109], v[108:109], v[82:83]
v_pk_add_f32 v[110:111], v[110:111], v[242:243]
v_exp_f32 v248, v248
v_exp_f32 v88, v88
v_exp_f32 v249, v249
v_exp_f32 v89, v89
v_add_f32 v102, v108, v109
v_add_f32 v106, v110, v111
v_exp_f32 v250, v250
v_exp_f32 v90, v90
v_exp_f32 v251, v251
v_exp_f32 v91, v91
v_pk_add_f32 v[108:109], v[84:85], v[86:87]
v_pk_add_f32 v[110:111], v[244:245], v[246:247]
v_pk_add_f32 v[108:109], v[108:109], v[88:89]
v_pk_add_f32 v[110:111], v[110:111], v[248:249]
v_pk_add_f32 v[108:109], v[108:109], v[90:91]
v_pk_add_f32 v[110:111], v[110:111], v[250:251]
v_add_f32 v103, v108, v109
v_add_f32 v107, v110, v111
s_cmp_eq_u32 s51, 1
s_cbranch_scc1 chk_122
s_waitcnt vmcnt(0)
v_max_u32 v4, v212, v213
v_max3_u32 v4, v4, v214, v215
v_max3_u32 v4, v4, v216, v217
v_max3_u32 v4, v4, v218, v219
v_cmp_eq_u32 vcc, -1, v4
s_cbranch_vccz red_123
buffer_load_dwordx4 v[212:215], v18, s[32:35], s55 offen offset:0 sc1
buffer_load_dwordx4 v[216:219], v18, s[32:35], s55 offen offset:1024 sc1
s_branch chk_122
red_123:
v_mfma_f32_16x16x32_bf16 v[132:135], v[44:47], v[212:215], 0
v_mfma_f32_16x16x32_bf16 v[132:135], v[44:47], v[216:219], v[132:135]
s_mov_b32 s51, 1
s_nop 6
v_add_f32_dpp v132, v132, v132 row_ror:8 row_mask:0xf bank_mask:0xf
v_add_f32_dpp v133, v133, v133 row_ror:8 row_mask:0xf bank_mask:0xf
v_add_f32_dpp v134, v134, v134 row_ror:8 row_mask:0xf bank_mask:0xf
v_add_f32_dpp v135, v135, v135 row_ror:8 row_mask:0xf bank_mask:0xf
v_cvt_pk_bf16_f32 v132, v132, v133
v_cvt_pk_bf16_f32 v133, v134, v135
s_mov_b64 exec, 0x00ff00ff
buffer_store_dwordx2 v[132:133], v59, s[32:35], s79 offen sc1
s_mov_b64 exec, -1
buffer_load_dwordx4 v[204:207], v58, s[32:35], s56 offen sc1
buffer_load_dwordx4 v[208:211], v58, s[32:35], s57 offen sc1
chk_122:
.p2align 3
v_permlane32_swap_b32 v100, v101
v_permlane32_swap_b32 v102, v103
v_permlane32_swap_b32 v104, v105
v_permlane32_swap_b32 v106, v107
v_add_f32 v100, v100, v101
v_add_f32 v102, v102, v103
v_add_f32 v104, v104, v105
v_add_f32 v106, v106, v107
v_permlane16_swap_b32 v100, v102
s_nop 0
v_permlane16_swap_b32 v104, v106
v_add_f32 v100, v100, v102
v_add_f32 v104, v104, v106
v_rcp_f32 v100, v100
v_rcp_f32 v104, v104
v_mov_b32 v102, v100
v_mov_b32 v106, v104
s_nop 0
v_permlane16_swap_b32 v100, v102
v_permlane16_swap_b32 v104, v106
v_mov_b32 v101, v100
v_mov_b32 v103, v102
v_mov_b32 v105, v104
v_mov_b32 v107, v106
v_permlane32_swap_b32 v100, v101
v_permlane32_swap_b32 v102, v103
v_permlane32_swap_b32 v104, v105
v_permlane32_swap_b32 v106, v107
v_pk_mul_f32 v[60:61], v[60:61], v[100:101] op_sel:[0,0] op_sel_hi:[1,0]
v_pk_mul_f32 v[220:221], v[220:221], v[104:105] op_sel:[0,0] op_sel_hi:[1,0]
v_pk_mul_f32 v[68:69], v[68:69], v[100:101] op_sel:[0,1] op_sel_hi:[1,1]
v_pk_mul_f32 v[228:229], v[228:229], v[104:105] op_sel:[0,1] op_sel_hi:[1,1]
v_pk_mul_f32 v[76:77], v[76:77], v[102:103] op_sel:[0,0] op_sel_hi:[1,0]
v_pk_mul_f32 v[236:237], v[236:237], v[106:107] op_sel:[0,0] op_sel_hi:[1,0]
v_pk_mul_f32 v[84:85], v[84:85], v[102:103] op_sel:[0,1] op_sel_hi:[1,1]
v_pk_mul_f32 v[244:245], v[244:245], v[106:107] op_sel:[0,1] op_sel_hi:[1,1]
v_pk_mul_f32 v[62:63], v[62:63], v[100:101] op_sel:[0,0] op_sel_hi:[1,0]
v_pk_mul_f32 v[222:223], v[222:223], v[104:105] op_sel:[0,0] op_sel_hi:[1,0]
v_cvt_pk_bf16_f32 v60, v60, v61
v_cvt_pk_bf16_f32 v220, v220, v221
v_pk_mul_f32 v[70:71], v[70:71], v[100:101] op_sel:[0,1] op_sel_hi:[1,1]
v_pk_mul_f32 v[230:231], v[230:231], v[104:105] op_sel:[0,1] op_sel_hi:[1,1]
v_cvt_pk_bf16_f32 v68, v68, v69
v_cvt_pk_bf16_f32 v228, v228, v229
v_pk_mul_f32 v[78:79], v[78:79], v[102:103] op_sel:[0,0] op_sel_hi:[1,0]
v_pk_mul_f32 v[238:239], v[238:239], v[106:107] op_sel:[0,0] op_sel_hi:[1,0]
v_cvt_pk_bf16_f32 v76, v76, v77
v_cvt_pk_bf16_f32 v236, v236, v237
v_pk_mul_f32 v[86:87], v[86:87], v[102:103] op_sel:[0,1] op_sel_hi:[1,1]
v_pk_mul_f32 v[246:247], v[246:247], v[106:107] op_sel:[0,1] op_sel_hi:[1,1]
v_cvt_pk_bf16_f32 v84, v84, v85
v_cvt_pk_bf16_f32 v244, v244, v245
v_pk_mul_f32 v[64:65], v[64:65], v[100:101] op_sel:[0,0] op_sel_hi:[1,0]
v_pk_mul_f32 v[66:67], v[66:67], v[100:101] op_sel:[0,0] op_sel_hi:[1,0]
v_pk_mul_f32 v[224:225], v[224:225], v[104:105] op_sel:[0,0] op_sel_hi:[1,0]
v_pk_mul_f32 v[226:227], v[226:227], v[104:105] op_sel:[0,0] op_sel_hi:[1,0]
v_cvt_pk_bf16_f32 v61, v62, v63
v_cvt_pk_bf16_f32 v221, v222, v223
v_pk_mul_f32 v[72:73], v[72:73], v[100:101] op_sel:[0,1] op_sel_hi:[1,1]
v_pk_mul_f32 v[74:75], v[74:75], v[100:101] op_sel:[0,1] op_sel_hi:[1,1]
v_pk_mul_f32 v[232:233], v[232:233], v[104:105] op_sel:[0,1] op_sel_hi:[1,1]
v_pk_mul_f32 v[234:235], v[234:235], v[104:105] op_sel:[0,1] op_sel_hi:[1,1]
v_cvt_pk_bf16_f32 v69, v70, v71
v_cvt_pk_bf16_f32 v229, v230, v231
v_pk_mul_f32 v[80:81], v[80:81], v[102:103] op_sel:[0,0] op_sel_hi:[1,0]
v_pk_mul_f32 v[82:83], v[82:83], v[102:103] op_sel:[0,0] op_sel_hi:[1,0]
v_pk_mul_f32 v[240:241], v[240:241], v[106:107] op_sel:[0,0] op_sel_hi:[1,0]
v_pk_mul_f32 v[242:243], v[242:243], v[106:107] op_sel:[0,0] op_sel_hi:[1,0]
v_cvt_pk_bf16_f32 v77, v78, v79
v_cvt_pk_bf16_f32 v237, v238, v239
v_pk_mul_f32 v[88:89], v[88:89], v[102:103] op_sel:[0,1] op_sel_hi:[1,1]
v_pk_mul_f32 v[90:91], v[90:91], v[102:103] op_sel:[0,1] op_sel_hi:[1,1]
v_pk_mul_f32 v[248:249], v[248:249], v[106:107] op_sel:[0,1] op_sel_hi:[1,1]
v_pk_mul_f32 v[250:251], v[250:251], v[106:107] op_sel:[0,1] op_sel_hi:[1,1]
v_cvt_pk_bf16_f32 v85, v86, v87
v_cvt_pk_bf16_f32 v245, v246, v247
v_cvt_pk_bf16_f32 v62, v64, v65
v_cvt_pk_bf16_f32 v63, v66, v67
v_cvt_pk_bf16_f32 v222, v224, v225
v_cvt_pk_bf16_f32 v223, v226, v227
v_cvt_pk_bf16_f32 v70, v72, v73
v_cvt_pk_bf16_f32 v71, v74, v75
v_cvt_pk_bf16_f32 v230, v232, v233
v_cvt_pk_bf16_f32 v231, v234, v235
v_cvt_pk_bf16_f32 v78, v80, v81
v_cvt_pk_bf16_f32 v79, v82, v83
v_cvt_pk_bf16_f32 v238, v240, v241
v_cvt_pk_bf16_f32 v239, v242, v243
v_cvt_pk_bf16_f32 v86, v88, v89
v_cvt_pk_bf16_f32 v87, v90, v91
v_cvt_pk_bf16_f32 v246, v248, v249
v_cvt_pk_bf16_f32 v247, v250, v251
s_cmp_lg_u32 s51, 0
s_cbranch_scc1 else_124
s_mov_b32 s63, 0
sent_126:
s_waitcnt vmcnt(0)
v_max_u32 v4, v212, v213
v_max3_u32 v4, v4, v214, v215
v_max3_u32 v4, v4, v216, v217
v_max3_u32 v4, v4, v218, v219
v_cmp_eq_u32 vcc, -1, v4
s_cbranch_vccz sentd_127
buffer_load_dwordx4 v[212:215], v18, s[32:35], s55 offen offset:0 sc1
buffer_load_dwordx4 v[216:219], v18, s[32:35], s55 offen offset:1024 sc1
s_add_u32 s63, s63, 1
s_cmp_lt_u32 s63, 0x80000
s_cbranch_scc1 sent_126
s_waitcnt vmcnt(0)
sentd_127:
v_mfma_f32_16x16x32_bf16 v[132:135], v[44:47], v[212:215], 0
v_mfma_f32_16x16x32_bf16 v[132:135], v[44:47], v[216:219], v[132:135]
s_mov_b32 s51, 1
s_nop 6
v_add_f32_dpp v132, v132, v132 row_ror:8 row_mask:0xf bank_mask:0xf
v_add_f32_dpp v133, v133, v133 row_ror:8 row_mask:0xf bank_mask:0xf
v_add_f32_dpp v134, v134, v134 row_ror:8 row_mask:0xf bank_mask:0xf
v_add_f32_dpp v135, v135, v135 row_ror:8 row_mask:0xf bank_mask:0xf
v_cvt_pk_bf16_f32 v132, v132, v133
v_cvt_pk_bf16_f32 v133, v134, v135
s_mov_b64 exec, 0x00ff00ff
buffer_store_dwordx2 v[132:133], v59, s[32:35], s79 offen sc1
s_mov_b64 exec, -1
buffer_load_dwordx4 v[204:207], v58, s[32:35], s56 offen sc1
buffer_load_dwordx4 v[208:211], v58, s[32:35], s57 offen sc1
else_124:
s_mov_b32 s63, 0
sent_128:
s_waitcnt vmcnt(0)
v_max_u32 v4, v204, v205
v_max3_u32 v4, v4, v206, v207
v_max3_u32 v4, v4, v208, v209
v_max3_u32 v4, v4, v210, v211
v_cmp_eq_u32 vcc, -1, v4
s_cbranch_vccz sentd_129
buffer_load_dwordx4 v[204:207], v58, s[32:35], s56 offen sc1
buffer_load_dwordx4 v[208:211], v58, s[32:35], s57 offen sc1
s_add_u32 s63, s63, 1
s_cmp_lt_u32 s63, 0x80000
s_cbranch_scc1 sent_128
s_waitcnt vmcnt(0)
sentd_129:
buffer_load_dwordx4 v[188:191], v18, s[32:35], s58 offen offset:0 sc1
buffer_load_dwordx4 v[192:195], v18, s[32:35], s58 offen offset:1024 sc1
buffer_load_dwordx4 v[196:199], v18, s[32:35], s59 offen offset:0 sc1
buffer_load_dwordx4 v[200:203], v18, s[32:35], s59 offen offset:1024 sc1
v_mfma_f32_16x16x32_bf16 v[112:115], v[204:207], v[60:63], 0
v_mfma_f32_16x16x32_bf16 v[116:119], v[204:207], v[68:71], 0
v_mfma_f32_16x16x32_bf16 v[120:123], v[204:207], v[76:79], 0
v_mfma_f32_16x16x32_bf16 v[124:127], v[204:207], v[84:87], 0
v_mfma_f32_16x16x32_bf16 v[112:115], v[208:211], v[220:223], v[112:115]
v_mfma_f32_16x16x32_bf16 v[116:119], v[208:211], v[228:231], v[116:119]
v_mfma_f32_16x16x32_bf16 v[120:123], v[208:211], v[236:239], v[120:123]
v_mfma_f32_16x16x32_bf16 v[124:127], v[208:211], v[244:247], v[124:127]
s_nop 4
v_add_f32 v100, v112, v113
v_add_f32 v114, v114, v115
v_add_f32 v100, v100, v114
v_add_f32 v101, v116, v117
v_add_f32 v118, v118, v119
v_add_f32 v101, v101, v118
v_add_f32 v102, v120, v121
v_add_f32 v122, v122, v123
v_add_f32 v102, v102, v122
v_add_f32 v103, v124, v125
v_add_f32 v126, v126, v127
v_add_f32 v103, v103, v126
s_nop 1
v_permlane32_swap_b32 v100, v101
v_permlane32_swap_b32 v102, v103
v_add_f32 v100, v100, v101
v_add_f32 v102, v102, v103
s_nop 1
v_permlane16_swap_b32 v100, v102
s_nop 0
v_add_f32 v100, v100, v102
v_add_f32 v100, 0x358637bd, v100
v_rcp_f32 v100, v100
s_nop 0
v_mov_b32 v102, v100
s_nop 1
v_permlane16_swap_b32 v100, v102
s_nop 0
v_mov_b32 v101, v100
v_mov_b32 v103, v102
s_nop 0
v_permlane32_swap_b32 v100, v101
v_permlane32_swap_b32 v102, v103
s_mov_b32 s63, 0
sent_130:
s_waitcnt vmcnt(0)
v_max_u32 v4, v188, v189
v_max3_u32 v4, v4, v190, v191
v_max3_u32 v4, v4, v192, v193
v_max3_u32 v4, v4, v194, v195
v_max3_u32 v4, v4, v196, v197
v_max3_u32 v4, v4, v198, v199
v_max3_u32 v4, v4, v200, v201
v_max3_u32 v4, v4, v202, v203
v_cmp_eq_u32 vcc, -1, v4
s_cbranch_vccz sentd_131
buffer_load_dwordx4 v[188:191], v18, s[32:35], s58 offen offset:0 sc1
buffer_load_dwordx4 v[192:195], v18, s[32:35], s58 offen offset:1024 sc1
buffer_load_dwordx4 v[196:199], v18, s[32:35], s59 offen offset:0 sc1
buffer_load_dwordx4 v[200:203], v18, s[32:35], s59 offen offset:1024 sc1
s_add_u32 s63, s63, 1
s_cmp_lt_u32 s63, 0x80000
s_cbranch_scc1 sent_130
s_waitcnt vmcnt(0)
sentd_131:
s_cmp_eq_u32 s46, 0
s_cbranch_scc1 slow_132
.p2align 3
v_mfma_f32_16x16x32_bf16 v[156:159], v[188:191], v[60:63], 0
v_mfma_f32_16x16x32_bf16 v[164:167], v[188:191], v[68:71], 0
v_mfma_f32_16x16x32_bf16 v[160:163], v[192:195], v[60:63], 0
v_mfma_f32_16x16x32_bf16 v[172:175], v[188:191], v[76:79], 0
v_mfma_f32_16x16x32_bf16 v[168:171], v[192:195], v[68:71], 0
v_mfma_f32_16x16x32_bf16 v[180:183], v[188:191], v[84:87], 0
v_mfma_f32_16x16x32_bf16 v[156:159], v[196:199], v[220:223], v[156:159]
v_mfma_f32_16x16x32_bf16 v[176:179], v[192:195], v[76:79], 0
v_mfma_f32_16x16x32_bf16 v[164:167], v[196:199], v[228:231], v[164:167]
v_mfma_f32_16x16x32_bf16 v[184:187], v[192:195], v[84:87], 0
v_mfma_f32_16x16x32_bf16 v[160:163], v[200:203], v[220:223], v[160:163]
v_mfma_f32_16x16x32_bf16 v[172:175], v[196:199], v[236:239], v[172:175]
v_mfma_f32_16x16x32_bf16 v[168:171], v[200:203], v[228:231], v[168:171]
v_mfma_f32_16x16x32_bf16 v[180:183], v[196:199], v[244:247], v[180:183]
v_mfma_f32_16x16x32_bf16 v[176:179], v[200:203], v[236:239], v[176:179]
v_mfma_f32_16x16x32_bf16 v[184:187], v[200:203], v[244:247], v[184:187]
v_pk_mul_f32 v[156:157], v[156:157], v[100:101] op_sel:[0,0] op_sel_hi:[1,0]
v_pk_mul_f32 v[158:159], v[158:159], v[100:101] op_sel:[0,0] op_sel_hi:[1,0]
v_cvt_pk_bf16_f32 v156, v156, v157
v_pk_mul_f32 v[164:165], v[164:165], v[100:101] op_sel:[0,1] op_sel_hi:[1,1]
v_pk_mul_f32 v[160:161], v[160:161], v[100:101] op_sel:[0,0] op_sel_hi:[1,0]
v_pk_mul_f32 v[162:163], v[162:163], v[100:101] op_sel:[0,0] op_sel_hi:[1,0]
v_cvt_pk_bf16_f32 v157, v158, v159
v_pk_mul_f32 v[166:167], v[166:167], v[100:101] op_sel:[0,1] op_sel_hi:[1,1]
v_cvt_pk_bf16_f32 v164, v164, v165
v_pk_mul_f32 v[172:173], v[172:173], v[102:103] op_sel:[0,0] op_sel_hi:[1,0]
v_cvt_pk_bf16_f32 v158, v160, v161
v_cvt_pk_bf16_f32 v159, v162, v163
v_pk_mul_f32 v[168:169], v[168:169], v[100:101] op_sel:[0,1] op_sel_hi:[1,1]
v_pk_mul_f32 v[170:171], v[170:171], v[100:101] op_sel:[0,1] op_sel_hi:[1,1]
v_cvt_pk_bf16_f32 v165, v166, v167
v_pk_mul_f32 v[174:175], v[174:175], v[102:103] op_sel:[0,0] op_sel_hi:[1,0]
v_cvt_pk_bf16_f32 v172, v172, v173
v_pk_mul_f32 v[180:181], v[180:181], v[102:103] op_sel:[0,1] op_sel_hi:[1,1]
buffer_store_dwordx4 v[156:159], v18, s[32:35], s80 offen
v_cvt_pk_bf16_f32 v166, v168, v169
v_cvt_pk_bf16_f32 v167, v170, v171
v_pk_mul_f32 v[176:177], v[176:177], v[102:103] op_sel:[0,0] op_sel_hi:[1,0]
v_pk_mul_f32 v[178:179], v[178:179], v[102:103] op_sel:[0,0] op_sel_hi:[1,0]
v_cvt_pk_bf16_f32 v173, v174, v175
v_pk_mul_f32 v[182:183], v[182:183], v[102:103] op_sel:[0,1] op_sel_hi:[1,1]
v_cvt_pk_bf16_f32 v180, v180, v181
buffer_store_dwordx4 v[164:167], v18, s[32:35], s81 offen
v_cvt_pk_bf16_f32 v174, v176, v177
v_cvt_pk_bf16_f32 v175, v178, v179
v_pk_mul_f32 v[184:185], v[184:185], v[102:103] op_sel:[0,1] op_sel_hi:[1,1]
v_pk_mul_f32 v[186:187], v[186:187], v[102:103] op_sel:[0,1] op_sel_hi:[1,1]
v_cvt_pk_bf16_f32 v181, v182, v183
buffer_store_dwordx4 v[172:175], v18, s[32:35], s82 offen
v_cvt_pk_bf16_f32 v182, v184, v185
v_cvt_pk_bf16_f32 v183, v186, v187
buffer_store_dwordx4 v[180:183], v18, s[32:35], s83 offen
back_133:
s_barrier
v_and_b32 v36, 31, v0
v_lshlrev_b32 v36, 2, v36
s_lshl_b32 s62, s45, 2
v_mov_b32 v4, s62
v_mov_b32 v5, 4
s_mov_b64 exec, 1
s_waitcnt vmcnt(0)
s_cmp_eq_u32 s46, 0
s_cbranch_scc1 slow_134
buffer_store_dword v5, v4, s[32:35], s84 offen
back_135:
s_mov_b64 exec, -1
v_lshrrev_b32 v4, 2, v2
v_and_b32 v5, 3, v0
v_lshl_add_u32 v6, v3, 3, v4
v_lshlrev_b32 v6, 7, v6
v_lshl_add_u32 v6, v5, 3, v6
v_lshrrev_b32 v7, 1, v4
v_and_b32 v8, 1, v3
v_lshl_add_u32 v7, v8, 1, v7
v_lshl_add_u32 v10, v7, 5, v6
v_xor_b32 v11, 32, v10
v_xor_b32 v12, 64, v10
v_xor_b32 v13, 96, v10
v_add_u32 v14, 0x10000, v10
v_add_u32 v15, 0x10000, v11
v_add_u32 v16, 0x10000, v12
v_add_u32 v17, 0x10000, v13
ds_read_b64_tr_b16 v[220:221], v10 offset:0
ds_read_b64_tr_b16 v[222:223], v10 offset:512
ds_read_b64_tr_b16 v[224:225], v11 offset:0
ds_read_b64_tr_b16 v[226:227], v11 offset:512
ds_read_b64_tr_b16 v[228:229], v12 offset:0
ds_read_b64_tr_b16 v[230:231], v12 offset:512
ds_read_b64_tr_b16 v[232:233], v13 offset:0
ds_read_b64_tr_b16 v[234:235], v13 offset:512
ds_read_b64_tr_b16 v[236:237], v10 offset:4096
ds_read_b64_tr_b16 v[238:239], v10 offset:4608
ds_read_b64_tr_b16 v[240:241], v11 offset:4096
ds_read_b64_tr_b16 v[242:243], v11 offset:4608
ds_read_b64_tr_b16 v[244:245], v12 offset:4096
ds_read_b64_tr_b16 v[246:247], v12 offset:4608
ds_read_b64_tr_b16 v[248:249], v13 offset:4096
ds_read_b64_tr_b16 v[250:251], v13 offset:4608
s_lshl_b32 s48, s41, 3
s_lshl_b32 s49, s40, 1
s_add_u32 s48, s48, s49
s_lshl_b32 s48, s48, 15
s_add_u32 s48, s48, 4194304
v_add_u32 v38, s48, v18
v_add_u32 v39, 32768, v38
s_lshl_b32 s57, s75, 11
s_add_u32 s87, s87, 262144
v_lshlrev_b32 v60, 16, v20
v_and_b32 v61, 0xffff0000, v20
v_lshlrev_b32 v62, 16, v21
v_and_b32 v63, 0xffff0000, v21
v_lshlrev_b32 v64, 16, v22
v_and_b32 v65, 0xffff0000, v22
v_lshlrev_b32 v66, 16, v23
v_and_b32 v67, 0xffff0000, v23
v_lshlrev_b32 v68, 16, v24
v_and_b32 v69, 0xffff0000, v24
v_lshlrev_b32 v70, 16, v25
v_and_b32 v71, 0xffff0000, v25
v_lshlrev_b32 v72, 16, v26
v_and_b32 v73, 0xffff0000, v26
v_lshlrev_b32 v74, 16, v27
v_and_b32 v75, 0xffff0000, v27
v_lshlrev_b32 v76, 16, v28
v_and_b32 v77, 0xffff0000, v28
v_lshlrev_b32 v78, 16, v29
v_and_b32 v79, 0xffff0000, v29
v_lshlrev_b32 v80, 16, v30
v_and_b32 v81, 0xffff0000, v30
v_lshlrev_b32 v82, 16, v31
v_and_b32 v83, 0xffff0000, v31
v_lshlrev_b32 v84, 16, v32
v_and_b32 v85, 0xffff0000, v32
v_lshlrev_b32 v86, 16, v33
v_and_b32 v87, 0xffff0000, v33
v_lshlrev_b32 v88, 16, v34
v_and_b32 v89, 0xffff0000, v34
v_lshlrev_b32 v90, 16, v35
v_and_b32 v91, 0xffff0000, v35
s_lshl_b32 s48, s40, 12
s_add_u32 s48, s48, 139264
v_lshrrev_b32 v4, 1, v2
v_lshrrev_b32 v5, 1, v3
v_xor_b32 v4, v4, v5
v_lshlrev_b32 v4, 4, v4
v_and_b32 v5, 1, v3
v_lshl_add_u32 v4, v5, 3, v4
v_lshl_add_u32 v4, v2, 7, v4
v_add_u32 v42, s48, v4
v_xor_b32 v43, 32, v42
v_xor_b32 v44, 64, v42
v_xor_b32 v45, 96, v42
v_add_u32 v46, s48, v18
s_lshl_b32 s48, s41, 7
s_lshl_b32 s49, s40, 5
s_add_u32 s48, s48, s49
s_lshl_b32 s48, s48, 11
s_lshl_b32 s49, s78, 7
s_add_u32 s48, s48, s49
s_add_u32 s49, s48, 32768
v_lshrrev_b32 v4, 3, v0
v_and_b32 v5, 7, v0
v_lshrrev_b32 v6, 1, v4
v_xor_b32 v5, v5, v6
v_lshlrev_b32 v4, 11, v4
v_lshl_add_u32 v40, v5, 4, v4
v_xor_b32 v41, 64, v40
v_add_u32 v41, 16384, v41
buffer_load_dword v37, v36, s[32:35], s84 offen sc1
s_mov_b32 s63, 0
s_waitcnt vmcnt(0)
poll_136:
v_cmp_gt_u32 vcc, 4, v37
s_cbranch_vccz polled_137
buffer_load_dword v37, v36, s[32:35], s84 offen sc1
s_add_u32 s63, s63, 1
s_cmp_lt_u32 s63, 0x80000
s_waitcnt vmcnt(0)
s_cbranch_scc1 poll_136
polled_137:
s_call_b64 s[94:95], R_oloop
s_nop 0
v_cvt_pk_bf16_f32 v20, v60, v61
v_cvt_pk_bf16_f32 v21, v62, v63
v_cvt_pk_bf16_f32 v22, v64, v65
v_cvt_pk_bf16_f32 v23, v66, v67
ds_write_b64 v42, v[20:21] offset:0
ds_write_b64 v43, v[22:23] offset:0
v_cvt_pk_bf16_f32 v24, v68, v69
v_cvt_pk_bf16_f32 v25, v70, v71
v_cvt_pk_bf16_f32 v26, v72, v73
v_cvt_pk_bf16_f32 v27, v74, v75
ds_write_b64 v44, v[24:25] offset:0
ds_write_b64 v45, v[26:27] offset:0
v_cvt_pk_bf16_f32 v28, v76, v77
v_cvt_pk_bf16_f32 v29, v78, v79
v_cvt_pk_bf16_f32 v30, v80, v81
v_cvt_pk_bf16_f32 v31, v82, v83
ds_write_b64 v42, v[28:29] offset:2048
ds_write_b64 v43, v[30:31] offset:2048
v_cvt_pk_bf16_f32 v32, v84, v85
v_cvt_pk_bf16_f32 v33, v86, v87
v_cvt_pk_bf16_f32 v34, v88, v89
v_cvt_pk_bf16_f32 v35, v90, v91
ds_write_b64 v44, v[32:33] offset:2048
ds_write_b64 v45, v[34:35] offset:2048
ds_read_b128 v[20:23], v46 offset:0
ds_read_b128 v[24:27], v46 offset:1024
ds_read_b128 v[28:31], v46 offset:2048
ds_read_b128 v[32:35], v46 offset:3072
s_waitcnt lgkmcnt(3)
buffer_store_dwordx4 v[20:23], v40, s[24:27], s48 offen sc1
s_waitcnt lgkmcnt(2)
buffer_store_dwordx4 v[24:27], v41, s[24:27], s48 offen sc1
s_waitcnt lgkmcnt(1)
buffer_store_dwordx4 v[28:31], v40, s[24:27], s49 offen sc1
s_waitcnt lgkmcnt(0)
buffer_store_dwordx4 v[32:35], v41, s[24:27], s49 offen sc1
s_endpgm
L_code_end:
again_22:
s_mov_b32 s63, 0
retry_24:
buffer_load_dwordx4 v[80:83], v37, s[32:35], 0 offen offset:0 sc1
buffer_load_dwordx4 v[84:87], v37, s[32:35], 0 offen offset:1024 sc1
buffer_load_dwordx4 v[88:91], v37, s[32:35], 0 offen offset:2048 sc1
buffer_load_dwordx4 v[92:95], v37, s[32:35], 0 offen offset:3072 sc1
s_waitcnt vmcnt(0)
v_add_f32 v80, v80, v88
v_add_f32 v81, v81, v89
v_add_f32 v82, v82, v90
v_add_f32 v83, v83, v91
v_add_f32 v84, v84, v92
v_add_f32 v85, v85, v93
v_add_f32 v86, v86, v94
v_add_f32 v87, v87, v95
v_add_f32 v80, v80, v84
v_add_f32 v81, v81, v85
v_add_f32 v82, v82, v86
v_add_f32 v83, v83, v87
s_nop 1
v_permlane32_swap_b32 v80, v81
v_permlane32_swap_b32 v82, v83
v_add_f32 v80, v80, v81
v_add_f32 v82, v82, v83
s_nop 1
v_permlane16_swap_b32 v80, v82
s_nop 0
v_add_f32 v80, v80, v82
v_cmp_u_f32 vcc, v80, v80
s_cbranch_vccz summed_23
s_add_u32 s63, s63, 1
s_cmp_lt_u32 s63, 0x10000
s_cbranch_scc1 retry_24
s_branch summed_23
again_25:
s_mov_b32 s63, 0
retry_27:
buffer_load_dwordx4 v[64:67], v38, s[32:35], 0 offen offset:0 sc1
buffer_load_dwordx4 v[68:71], v38, s[32:35], 0 offen offset:1024 sc1
buffer_load_dwordx4 v[72:75], v38, s[32:35], 0 offen offset:2048 sc1
buffer_load_dwordx4 v[76:79], v38, s[32:35], 0 offen offset:3072 sc1
s_waitcnt vmcnt(0)
v_add_f32 v64, v64, v72
v_add_f32 v65, v65, v73
v_add_f32 v66, v66, v74
v_add_f32 v67, v67, v75
v_add_f32 v68, v68, v76
v_add_f32 v69, v69, v77
v_add_f32 v70, v70, v78
v_add_f32 v71, v71, v79
v_add_f32 v64, v64, v68
v_add_f32 v65, v65, v69
v_add_f32 v66, v66, v70
v_add_f32 v67, v67, v71
s_nop 1
v_permlane32_swap_b32 v64, v65
v_permlane32_swap_b32 v66, v67
v_add_f32 v64, v64, v65
v_add_f32 v66, v66, v67
s_nop 1
v_permlane16_swap_b32 v64, v66
s_nop 0
v_add_f32 v64, v64, v66
v_cmp_u_f32 vcc, v64, v64
s_cbranch_vccz summed_26
s_add_u32 s63, s63, 1
s_cmp_lt_u32 s63, 0x10000
s_cbranch_scc1 retry_27
s_branch summed_26
again_33:
s_mov_b32 s63, 0
retry_35:
buffer_load_dwordx4 v[80:83], v37, s[32:35], 0 offen offset:0 sc1
buffer_load_dwordx4 v[84:87], v37, s[32:35], 0 offen offset:1024 sc1
buffer_load_dwordx4 v[88:91], v37, s[32:35], 0 offen offset:2048 sc1
buffer_load_dwordx4 v[92:95], v37, s[32:35], 0 offen offset:3072 sc1
s_waitcnt vmcnt(0)
v_add_f32 v80, v80, v88
v_add_f32 v81, v81, v89
v_add_f32 v82, v82, v90
v_add_f32 v83, v83, v91
v_add_f32 v84, v84, v92
v_add_f32 v85, v85, v93
v_add_f32 v86, v86, v94
v_add_f32 v87, v87, v95
v_add_f32 v80, v80, v84
v_add_f32 v81, v81, v85
v_add_f32 v82, v82, v86
v_add_f32 v83, v83, v87
s_nop 1
v_permlane32_swap_b32 v80, v81
v_permlane32_swap_b32 v82, v83
v_add_f32 v80, v80, v81
v_add_f32 v82, v82, v83
s_nop 1
v_permlane16_swap_b32 v80, v82
s_nop 0
v_add_f32 v80, v80, v82
v_cmp_u_f32 vcc, v80, v80
s_cbranch_vccz summed_34
s_add_u32 s63, s63, 1
s_cmp_lt_u32 s63, 0x10000
s_cbranch_scc1 retry_35
s_branch summed_34
again_36:
s_mov_b32 s63, 0
retry_38:
buffer_load_dwordx4 v[64:67], v38, s[32:35], 0 offen offset:0 sc1
buffer_load_dwordx4 v[68:71], v38, s[32:35], 0 offen offset:1024 sc1
buffer_load_dwordx4 v[72:75], v38, s[32:35], 0 offen offset:2048 sc1
buffer_load_dwordx4 v[76:79], v38, s[32:35], 0 offen offset:3072 sc1
s_waitcnt vmcnt(0)
v_add_f32 v64, v64, v72
v_add_f32 v65, v65, v73
v_add_f32 v66, v66, v74
v_add_f32 v67, v67, v75
v_add_f32 v68, v68, v76
v_add_f32 v69, v69, v77
v_add_f32 v70, v70, v78
v_add_f32 v71, v71, v79
v_add_f32 v64, v64, v68
v_add_f32 v65, v65, v69
v_add_f32 v66, v66, v70
v_add_f32 v67, v67, v71
s_nop 1
v_permlane32_swap_b32 v64, v65
v_permlane32_swap_b32 v66, v67
v_add_f32 v64, v64, v65
v_add_f32 v66, v66, v67
s_nop 1
v_permlane16_swap_b32 v64, v66
s_nop 0
v_add_f32 v64, v64, v66
v_cmp_u_f32 vcc, v64, v64
s_cbranch_vccz summed_37
s_add_u32 s63, s63, 1
s_cmp_lt_u32 s63, 0x10000
s_cbranch_scc1 retry_38
s_branch summed_37
again_42:
s_mov_b32 s63, 0
retry_44:
buffer_load_dwordx4 v[80:83], v37, s[32:35], 0 offen offset:0 sc1
buffer_load_dwordx4 v[84:87], v37, s[32:35], 0 offen offset:1024 sc1
buffer_load_dwordx4 v[88:91], v37, s[32:35], 0 offen offset:2048 sc1
buffer_load_dwordx4 v[92:95], v37, s[32:35], 0 offen offset:3072 sc1
s_waitcnt vmcnt(0)
v_add_f32 v80, v80, v88
v_add_f32 v81, v81, v89
v_add_f32 v82, v82, v90
v_add_f32 v83, v83, v91
v_add_f32 v84, v84, v92
v_add_f32 v85, v85, v93
v_add_f32 v86, v86, v94
v_add_f32 v87, v87, v95
v_add_f32 v80, v80, v84
v_add_f32 v81, v81, v85
v_add_f32 v82, v82, v86
v_add_f32 v83, v83, v87
s_nop 1
v_permlane32_swap_b32 v80, v81
v_permlane32_swap_b32 v82, v83
v_add_f32 v80, v80, v81
v_add_f32 v82, v82, v83
s_nop 1
v_permlane16_swap_b32 v80, v82
s_nop 0
v_add_f32 v80, v80, v82
v_cmp_u_f32 vcc, v80, v80
s_cbranch_vccz summed_43
s_add_u32 s63, s63, 1
s_cmp_lt_u32 s63, 0x10000
s_cbranch_scc1 retry_44
s_branch summed_43
again_50:
s_mov_b32 s63, 0
retry_52:
buffer_load_dwordx4 v[80:83], v37, s[32:35], 0 offen offset:0 sc1
buffer_load_dwordx4 v[84:87], v37, s[32:35], 0 offen offset:1024 sc1
buffer_load_dwordx4 v[88:91], v37, s[32:35], 0 offen offset:2048 sc1
buffer_load_dwordx4 v[92:95], v37, s[32:35], 0 offen offset:3072 sc1
s_waitcnt vmcnt(0)
v_add_f32 v80, v80, v88
v_add_f32 v81, v81, v89
v_add_f32 v82, v82, v90
v_add_f32 v83, v83, v91
v_add_f32 v84, v84, v92
v_add_f32 v85, v85, v93
v_add_f32 v86, v86, v94
v_add_f32 v87, v87, v95
v_add_f32 v80, v80, v84
v_add_f32 v81, v81, v85
v_add_f32 v82, v82, v86
v_add_f32 v83, v83, v87
s_nop 1
v_permlane32_swap_b32 v80, v81
v_permlane32_swap_b32 v82, v83
v_add_f32 v80, v80, v81
v_add_f32 v82, v82, v83
s_nop 1
v_permlane16_swap_b32 v80, v82
s_nop 0
v_add_f32 v80, v80, v82
v_cmp_u_f32 vcc, v80, v80
s_cbranch_vccz summed_51
s_add_u32 s63, s63, 1
s_cmp_lt_u32 s63, 0x10000
s_cbranch_scc1 retry_52
s_branch summed_51
slow_71:
.p2align 3
v_mfma_f32_16x16x32_bf16 v[160:163], v[120:123], v[156:159], v[44:47]
v_max_f32 v158, v192, v193
v_max_f32 v159, v194, v195
v_permlane32_swap_b32 v130, v131
s_nop 0
v_max_f32 v130, v130, v131
s_nop 2
v_max_f32 v156, v160, v161
v_max_f32 v157, v162, v163
v_max3_f32 v128, v156, v157, v158
v_max_f32 v128, v128, v159
s_nop 1
v_permlane32_swap_b32 v128, v129
s_nop 0
v_max_f32 v128, v128, v129
s_nop 1
v_permlane16_swap_b32 v128, v130
s_nop 0
v_max_f32 v128, v128, v130
v_mov_b32 v130, v128
s_nop 1
v_permlane16_swap_b32 v128, v130
s_nop 0
v_mov_b32 v129, v128
v_mov_b32 v131, v130
s_nop 0
v_permlane32_swap_b32 v128, v129
v_permlane32_swap_b32 v130, v131
v_mul_f32 v128, v128, v124
v_mul_f32 v129, v129, v125
v_pk_fma_f32 v[156:157], v[156:157], v[124:125], v[128:129] op_sel:[0,0,0] op_sel_hi:[1,0,0] neg_lo:[0,0,1] neg_hi:[0,0,1]
v_pk_fma_f32 v[158:159], v[158:159], v[124:125], v[128:129] op_sel:[0,0,0] op_sel_hi:[1,0,0] neg_lo:[0,0,1] neg_hi:[0,0,1]
v_mul_f32 v130, v130, v126
v_mul_f32 v131, v131, v127
v_exp_f32 v156, v156
v_exp_f32 v157, v157
v_exp_f32 v158, v158
v_exp_f32 v159, v159
v_pk_fma_f32 v[164:165], v[164:165], v[124:125], v[128:129] op_sel:[0,1,1] op_sel_hi:[1,1,1] neg_lo:[0,0,1] neg_hi:[0,0,1]
v_pk_fma_f32 v[166:167], v[166:167], v[124:125], v[128:129] op_sel:[0,1,1] op_sel_hi:[1,1,1] neg_lo:[0,0,1] neg_hi:[0,0,1]
v_exp_f32 v164, v164
v_exp_f32 v165, v165
v_exp_f32 v166, v166
v_exp_f32 v167, v167
v_pk_fma_f32 v[172:173], v[172:173], v[126:127], v[130:131] op_sel:[0,0,0] op_sel_hi:[1,0,0] neg_lo:[0,0,1] neg_hi:[0,0,1]
v_pk_fma_f32 v[174:175], v[174:175], v[126:127], v[130:131] op_sel:[0,0,0] op_sel_hi:[1,0,0] neg_lo:[0,0,1] neg_hi:[0,0,1]
v_cvt_pk_bf16_f32 v156, v156, v156
v_cvt_pk_bf16_f32 v157, v157, v157
v_cvt_pk_bf16_f32 v158, v158, v158
v_cvt_pk_bf16_f32 v159, v159, v159
v_exp_f32 v172, v172
v_exp_f32 v173, v173
v_exp_f32 v174, v174
v_exp_f32 v175, v175
v_pk_fma_f32 v[180:181], v[180:181], v[126:127], v[130:131] op_sel:[0,1,1] op_sel_hi:[1,1,1] neg_lo:[0,0,1] neg_hi:[0,0,1]
v_pk_fma_f32 v[182:183], v[182:183], v[126:127], v[130:131] op_sel:[0,1,1] op_sel_hi:[1,1,1] neg_lo:[0,0,1] neg_hi:[0,0,1]
v_and_b32 v156, v52, v156
v_and_b32 v157, v52, v157
v_and_b32 v158, v52, v158
v_and_b32 v159, v52, v159
v_cvt_pk_bf16_f32 v164, v164, v164
v_cvt_pk_bf16_f32 v165, v165, v165
v_mfma_f32_16x16x32_bf16 v[160:163], v[48:51], v[156:159], 0
v_cvt_pk_bf16_f32 v166, v166, v166
v_cvt_pk_bf16_f32 v167, v167, v167
v_mfma_f32_16x16x32_bf16 v[220:223], v[100:103], v[156:159], 0
v_exp_f32 v180, v180
v_mfma_f32_16x16x32_bf16 v[224:227], v[110:113], v[156:159], 0
v_exp_f32 v181, v181
v_exp_f32 v182, v182
v_exp_f32 v183, v183
v_and_b32 v164, v52, v164
v_and_b32 v165, v52, v165
v_and_b32 v166, v52, v166
v_and_b32 v167, v52, v167
v_cvt_pk_bf16_f32 v172, v172, v172
v_cvt_pk_bf16_f32 v173, v173, v173
v_mfma_f32_16x16x32_bf16 v[168:171], v[48:51], v[164:167], 0
v_cvt_pk_bf16_f32 v174, v174, v174
v_cvt_pk_bf16_f32 v175, v175, v175
v_mfma_f32_16x16x32_bf16 v[228:231], v[102:105], v[164:167], 0
v_and_b32 v172, v52, v172
v_and_b32 v173, v52, v173
v_mfma_f32_16x16x32_bf16 v[232:235], v[112:115], v[164:167], 0
v_and_b32 v174, v52, v174
v_and_b32 v175, v52, v175
v_cvt_pk_bf16_f32 v180, v180, v180
v_cvt_pk_bf16_f32 v181, v181, v181
v_mfma_f32_16x16x32_bf16 v[176:179], v[48:51], v[172:175], 0
v_cvt_pk_bf16_f32 v182, v182, v182
v_cvt_pk_bf16_f32 v183, v183, v183
v_mfma_f32_16x16x32_bf16 v[236:239], v[104:107], v[172:175], 0
v_and_b32 v180, v52, v180
v_and_b32 v181, v52, v181
v_mfma_f32_16x16x32_bf16 v[240:243], v[114:117], v[172:175], 0
v_and_b32 v182, v52, v182
v_and_b32 v183, v52, v183
v_rcp_f32 v160, v160
v_rcp_f32 v168, v168
v_pk_mul_f32 v[220:221], v[220:221], v[160:161] op_sel:[0,0] op_sel_hi:[1,0]
v_pk_mul_f32 v[222:223], v[222:223], v[160:161] op_sel:[0,0] op_sel_hi:[1,0]
v_pk_mul_f32 v[228:229], v[228:229], v[168:169] op_sel:[0,0] op_sel_hi:[1,0]
v_pk_mul_f32 v[224:225], v[224:225], v[160:161] op_sel:[0,0] op_sel_hi:[1,0]
v_pk_mul_f32 v[226:227], v[226:227], v[160:161] op_sel:[0,0] op_sel_hi:[1,0]
v_pk_mul_f32 v[230:231], v[230:231], v[168:169] op_sel:[0,0] op_sel_hi:[1,0]
v_pk_mul_f32 v[232:233], v[232:233], v[168:169] op_sel:[0,0] op_sel_hi:[1,0]
v_pk_mul_f32 v[234:235], v[234:235], v[168:169] op_sel:[0,0] op_sel_hi:[1,0]
v_mfma_f32_16x16x32_bf16 v[184:187], v[48:51], v[180:183], 0
v_rcp_f32_e64 v176, v176
v_cvt_pk_bf16_f32 v220, v220, v221
v_cvt_pk_bf16_f32 v221, v222, v223
v_cvt_pk_bf16_f32 v228, v228, v229
v_pk_mul_f32 v[236:237], v[236:237], v[176:177] op_sel:[0,0] op_sel_hi:[1,0]
v_mfma_f32_16x16x32_bf16 v[244:247], v[106:109], v[180:183], 0
v_cvt_pk_bf16_f32 v222, v224, v225
v_cvt_pk_bf16_f32 v223, v226, v227
v_rcp_f32_e64 v184, v184
v_cvt_pk_bf16_f32 v229, v230, v231
v_pk_mul_f32 v[238:239], v[238:239], v[176:177] op_sel:[0,0] op_sel_hi:[1,0]
v_pk_mul_f32 v[240:241], v[240:241], v[176:177] op_sel:[0,0] op_sel_hi:[1,0]
v_pk_mul_f32 v[242:243], v[242:243], v[176:177] op_sel:[0,0] op_sel_hi:[1,0]
v_cvt_pk_bf16_f32 v236, v236, v237
v_pk_mul_f32 v[244:245], v[244:245], v[184:185] op_sel:[0,0] op_sel_hi:[1,0]
v_pk_mul_f32 v[246:247], v[246:247], v[184:185] op_sel:[0,0] op_sel_hi:[1,0]
v_mfma_f32_16x16x32_bf16 v[248:251], v[116:119], v[180:183], 0
buffer_store_dwordx4 v[220:223], v18, s[32:35], s80 offen sc1
v_cvt_pk_bf16_f32 v230, v232, v233
v_cvt_pk_bf16_f32 v231, v234, v235
v_cvt_pk_bf16_f32 v237, v238, v239
v_cvt_pk_bf16_f32 v244, v244, v245
buffer_store_dwordx4 v[228:231], v18, s[32:35], s81 offen sc1
v_cvt_pk_bf16_f32 v238, v240, v241
v_cvt_pk_bf16_f32 v239, v242, v243
v_pk_mul_f32 v[248:249], v[248:249], v[184:185] op_sel:[0,0] op_sel_hi:[1,0]
v_pk_mul_f32 v[250:251], v[250:251], v[184:185] op_sel:[0,0] op_sel_hi:[1,0]
v_cvt_pk_bf16_f32 v245, v246, v247
buffer_store_dwordx4 v[236:239], v18, s[32:35], s82 offen sc1
v_cvt_pk_bf16_f32 v246, v248, v249
v_cvt_pk_bf16_f32 v247, v250, v251
buffer_store_dwordx4 v[244:247], v18, s[32:35], s83 offen sc1
s_branch back_72
slow_73:
buffer_store_dword v5, v4, s[32:35], s84 offen sc1
s_branch back_74
slow_78:
s_nop 0
v_cvt_pk_bf16_f32 v20, v60, v61
v_cvt_pk_bf16_f32 v21, v62, v63
v_cvt_pk_bf16_f32 v22, v64, v65
v_cvt_pk_bf16_f32 v23, v66, v67
buffer_store_dwordx4 v[20:23], v18, s[32:35], s85 offen offset:0 sc1
v_cvt_pk_bf16_f32 v24, v68, v69
v_cvt_pk_bf16_f32 v25, v70, v71
v_cvt_pk_bf16_f32 v26, v72, v73
v_cvt_pk_bf16_f32 v27, v74, v75
buffer_store_dwordx4 v[24:27], v18, s[32:35], s85 offen offset:1024 sc1
v_cvt_pk_bf16_f32 v28, v76, v77
v_cvt_pk_bf16_f32 v29, v78, v79
v_cvt_pk_bf16_f32 v30, v80, v81
v_cvt_pk_bf16_f32 v31, v82, v83
buffer_store_dwordx4 v[28:31], v18, s[32:35], s86 offen offset:0 sc1
v_cvt_pk_bf16_f32 v32, v84, v85
v_cvt_pk_bf16_f32 v33, v86, v87
v_cvt_pk_bf16_f32 v34, v88, v89
v_cvt_pk_bf16_f32 v35, v90, v91
buffer_store_dwordx4 v[32:35], v18, s[32:35], s86 offen offset:1024 sc1
s_barrier
v_dot2c_f32_bf16 v6, v20, v48
v_dot2c_f32_bf16 v8, v20, v20
v_dot2c_f32_bf16 v7, v28, v48
v_dot2c_f32_bf16 v9, v28, v28
v_dot2c_f32_bf16 v6, v21, v48
v_dot2c_f32_bf16 v8, v21, v21
v_dot2c_f32_bf16 v7, v29, v48
v_dot2c_f32_bf16 v9, v29, v29
v_dot2c_f32_bf16 v6, v22, v48
v_dot2c_f32_bf16 v8, v22, v22
v_dot2c_f32_bf16 v7, v30, v48
v_dot2c_f32_bf16 v9, v30, v30
v_dot2c_f32_bf16 v6, v23, v48
v_dot2c_f32_bf16 v8, v23, v23
v_dot2c_f32_bf16 v7, v31, v48
v_dot2c_f32_bf16 v9, v31, v31
v_dot2c_f32_bf16 v6, v24, v48
v_dot2c_f32_bf16 v8, v24, v24
v_dot2c_f32_bf16 v7, v32, v48
v_dot2c_f32_bf16 v9, v32, v32
v_dot2c_f32_bf16 v6, v25, v48
v_dot2c_f32_bf16 v8, v25, v25
v_dot2c_f32_bf16 v7, v33, v48
v_dot2c_f32_bf16 v9, v33, v33
v_dot2c_f32_bf16 v6, v26, v48
v_dot2c_f32_bf16 v8, v26, v26
v_dot2c_f32_bf16 v7, v34, v48
v_dot2c_f32_bf16 v9, v34, v34
v_dot2c_f32_bf16 v6, v27, v48
v_dot2c_f32_bf16 v8, v27, v27
v_dot2c_f32_bf16 v7, v35, v48
v_dot2c_f32_bf16 v9, v35, v35
s_mov_b64 exec, 1
s_waitcnt vmcnt(0)
buffer_store_dword v5, v4, s[32:35], s88 offen sc1
s_mov_b64 exec, -1
s_nop 1
v_permlane32_swap_b32 v6, v7
v_permlane32_swap_b32 v8, v9
v_add_f32 v6, v6, v7
v_add_f32 v8, v8, v9
s_nop 1
v_permlane16_swap_b32 v6, v8
s_nop 0
v_add_f32 v6, v6, v8
buffer_store_dword v6, v1, s[32:35], s87 offen sc1
s_branch back_79
slow_94:
.p2align 3
v_mfma_f32_16x16x32_bf16 v[156:159], v[188:191], v[60:63], 0
v_mfma_f32_16x16x32_bf16 v[164:167], v[188:191], v[68:71], 0
v_mfma_f32_16x16x32_bf16 v[160:163], v[192:195], v[60:63], 0
v_mfma_f32_16x16x32_bf16 v[172:175], v[188:191], v[76:79], 0
v_mfma_f32_16x16x32_bf16 v[168:171], v[192:195], v[68:71], 0
v_mfma_f32_16x16x32_bf16 v[180:183], v[188:191], v[84:87], 0
v_mfma_f32_16x16x32_bf16 v[156:159], v[196:199], v[220:223], v[156:159]
v_mfma_f32_16x16x32_bf16 v[176:179], v[192:195], v[76:79], 0
v_mfma_f32_16x16x32_bf16 v[164:167], v[196:199], v[228:231], v[164:167]
v_mfma_f32_16x16x32_bf16 v[184:187], v[192:195], v[84:87], 0
v_mfma_f32_16x16x32_bf16 v[160:163], v[200:203], v[220:223], v[160:163]
v_mfma_f32_16x16x32_bf16 v[172:175], v[196:199], v[236:239], v[172:175]
v_mfma_f32_16x16x32_bf16 v[168:171], v[200:203], v[228:231], v[168:171]
v_mfma_f32_16x16x32_bf16 v[180:183], v[196:199], v[244:247], v[180:183]
v_mfma_f32_16x16x32_bf16 v[176:179], v[200:203], v[236:239], v[176:179]
v_mfma_f32_16x16x32_bf16 v[184:187], v[200:203], v[244:247], v[184:187]
v_pk_mul_f32 v[156:157], v[156:157], v[100:101] op_sel:[0,0] op_sel_hi:[1,0]
v_pk_mul_f32 v[158:159], v[158:159], v[100:101] op_sel:[0,0] op_sel_hi:[1,0]
v_cvt_pk_bf16_f32 v156, v156, v157
v_pk_mul_f32 v[164:165], v[164:165], v[100:101] op_sel:[0,1] op_sel_hi:[1,1]
v_pk_mul_f32 v[160:161], v[160:161], v[100:101] op_sel:[0,0] op_sel_hi:[1,0]
v_pk_mul_f32 v[162:163], v[162:163], v[100:101] op_sel:[0,0] op_sel_hi:[1,0]
v_cvt_pk_bf16_f32 v157, v158, v159
v_pk_mul_f32 v[166:167], v[166:167], v[100:101] op_sel:[0,1] op_sel_hi:[1,1]
v_cvt_pk_bf16_f32 v164, v164, v165
v_pk_mul_f32 v[172:173], v[172:173], v[102:103] op_sel:[0,0] op_sel_hi:[1,0]
v_cvt_pk_bf16_f32 v158, v160, v161
v_cvt_pk_bf16_f32 v159, v162, v163
v_pk_mul_f32 v[168:169], v[168:169], v[100:101] op_sel:[0,1] op_sel_hi:[1,1]
v_pk_mul_f32 v[170:171], v[170:171], v[100:101] op_sel:[0,1] op_sel_hi:[1,1]
v_cvt_pk_bf16_f32 v165, v166, v167
v_pk_mul_f32 v[174:175], v[174:175], v[102:103] op_sel:[0,0] op_sel_hi:[1,0]
v_cvt_pk_bf16_f32 v172, v172, v173
v_pk_mul_f32 v[180:181], v[180:181], v[102:103] op_sel:[0,1] op_sel_hi:[1,1]
buffer_store_dwordx4 v[156:159], v18, s[32:35], s80 offen sc1
v_cvt_pk_bf16_f32 v166, v168, v169
v_cvt_pk_bf16_f32 v167, v170, v171
v_pk_mul_f32 v[176:177], v[176:177], v[102:103] op_sel:[0,0] op_sel_hi:[1,0]
v_pk_mul_f32 v[178:179], v[178:179], v[102:103] op_sel:[0,0] op_sel_hi:[1,0]
v_cvt_pk_bf16_f32 v173, v174, v175
v_pk_mul_f32 v[182:183], v[182:183], v[102:103] op_sel:[0,1] op_sel_hi:[1,1]
v_cvt_pk_bf16_f32 v180, v180, v181
buffer_store_dwordx4 v[164:167], v18, s[32:35], s81 offen sc1
v_cvt_pk_bf16_f32 v174, v176, v177
v_cvt_pk_bf16_f32 v175, v178, v179
v_pk_mul_f32 v[184:185], v[184:185], v[102:103] op_sel:[0,1] op_sel_hi:[1,1]
v_pk_mul_f32 v[186:187], v[186:187], v[102:103] op_sel:[0,1] op_sel_hi:[1,1]
v_cvt_pk_bf16_f32 v181, v182, v183
buffer_store_dwordx4 v[172:175], v18, s[32:35], s82 offen sc1
v_cvt_pk_bf16_f32 v182, v184, v185
v_cvt_pk_bf16_f32 v183, v186, v187
buffer_store_dwordx4 v[180:183], v18, s[32:35], s83 offen sc1
s_branch back_95
slow_96:
buffer_store_dword v5, v4, s[32:35], s84 offen sc1
s_branch back_97
slow_100:
s_nop 0
v_cvt_pk_bf16_f32 v20, v60, v61
v_cvt_pk_bf16_f32 v21, v62, v63
v_cvt_pk_bf16_f32 v22, v64, v65
v_cvt_pk_bf16_f32 v23, v66, v67
buffer_store_dwordx4 v[20:23], v18, s[32:35], s85 offen offset:0 sc1
v_cvt_pk_bf16_f32 v24, v68, v69
v_cvt_pk_bf16_f32 v25, v70, v71
v_cvt_pk_bf16_f32 v26, v72, v73
v_cvt_pk_bf16_f32 v27, v74, v75
buffer_store_dwordx4 v[24:27], v18, s[32:35], s85 offen offset:1024 sc1
v_cvt_pk_bf16_f32 v28, v76, v77
v_cvt_pk_bf16_f32 v29, v78, v79
v_cvt_pk_bf16_f32 v30, v80, v81
v_cvt_pk_bf16_f32 v31, v82, v83
buffer_store_dwordx4 v[28:31], v18, s[32:35], s86 offen offset:0 sc1
v_cvt_pk_bf16_f32 v32, v84, v85
v_cvt_pk_bf16_f32 v33, v86, v87
v_cvt_pk_bf16_f32 v34, v88, v89
v_cvt_pk_bf16_f32 v35, v90, v91
buffer_store_dwordx4 v[32:35], v18, s[32:35], s86 offen offset:1024 sc1
s_barrier
v_dot2c_f32_bf16 v6, v20, v48
v_dot2c_f32_bf16 v8, v20, v20
v_dot2c_f32_bf16 v7, v28, v48
v_dot2c_f32_bf16 v9, v28, v28
v_dot2c_f32_bf16 v6, v21, v48
v_dot2c_f32_bf16 v8, v21, v21
v_dot2c_f32_bf16 v7, v29, v48
v_dot2c_f32_bf16 v9, v29, v29
v_dot2c_f32_bf16 v6, v22, v48
v_dot2c_f32_bf16 v8, v22, v22
v_dot2c_f32_bf16 v7, v30, v48
v_dot2c_f32_bf16 v9, v30, v30
v_dot2c_f32_bf16 v6, v23, v48
v_dot2c_f32_bf16 v8, v23, v23
v_dot2c_f32_bf16 v7, v31, v48
v_dot2c_f32_bf16 v9, v31, v31
v_dot2c_f32_bf16 v6, v24, v48
v_dot2c_f32_bf16 v8, v24, v24
v_dot2c_f32_bf16 v7, v32, v48
v_dot2c_f32_bf16 v9, v32, v32
v_dot2c_f32_bf16 v6, v25, v48
v_dot2c_f32_bf16 v8, v25, v25
v_dot2c_f32_bf16 v7, v33, v48
v_dot2c_f32_bf16 v9, v33, v33
v_dot2c_f32_bf16 v6, v26, v48
v_dot2c_f32_bf16 v8, v26, v26
v_dot2c_f32_bf16 v7, v34, v48
v_dot2c_f32_bf16 v9, v34, v34
v_dot2c_f32_bf16 v6, v27, v48
v_dot2c_f32_bf16 v8, v27, v27
v_dot2c_f32_bf16 v7, v35, v48
v_dot2c_f32_bf16 v9, v35, v35
s_mov_b64 exec, 1
s_waitcnt vmcnt(0)
buffer_store_dword v5, v4, s[32:35], s88 offen sc1
s_mov_b64 exec, -1
s_nop 1
v_permlane32_swap_b32 v6, v7
v_permlane32_swap_b32 v8, v9
v_add_f32 v6, v6, v7
v_add_f32 v8, v8, v9
s_nop 1
v_permlane16_swap_b32 v6, v8
s_nop 0
v_add_f32 v6, v6, v8
buffer_store_dword v6, v1, s[32:35], s87 offen sc1
s_branch back_101
slow_112:
.p2align 3
v_mfma_f32_16x16x32_bf16 v[160:163], v[120:123], v[156:159], v[44:47]
v_max_f32 v158, v192, v193
v_max_f32 v159, v194, v195
v_permlane32_swap_b32 v130, v131
s_nop 0
v_max_f32 v130, v130, v131
s_nop 2
v_max_f32 v156, v160, v161
v_max_f32 v157, v162, v163
v_max3_f32 v128, v156, v157, v158
v_max_f32 v128, v128, v159
s_nop 1
v_permlane32_swap_b32 v128, v129
s_nop 0
v_max_f32 v128, v128, v129
s_nop 1
v_permlane16_swap_b32 v128, v130
s_nop 0
v_max_f32 v128, v128, v130
v_mov_b32 v130, v128
s_nop 1
v_permlane16_swap_b32 v128, v130
s_nop 0
v_mov_b32 v129, v128
v_mov_b32 v131, v130
s_nop 0
v_permlane32_swap_b32 v128, v129
v_permlane32_swap_b32 v130, v131
v_mul_f32 v128, v128, v124
v_mul_f32 v129, v129, v125
v_pk_fma_f32 v[156:157], v[156:157], v[124:125], v[128:129] op_sel:[0,0,0] op_sel_hi:[1,0,0] neg_lo:[0,0,1] neg_hi:[0,0,1]
v_pk_fma_f32 v[158:159], v[158:159], v[124:125], v[128:129] op_sel:[0,0,0] op_sel_hi:[1,0,0] neg_lo:[0,0,1] neg_hi:[0,0,1]
v_mul_f32 v130, v130, v126
v_mul_f32 v131, v131, v127
v_exp_f32 v156, v156
v_exp_f32 v157, v157
v_exp_f32 v158, v158
v_exp_f32 v159, v159
v_pk_fma_f32 v[164:165], v[164:165], v[124:125], v[128:129] op_sel:[0,1,1] op_sel_hi:[1,1,1] neg_lo:[0,0,1] neg_hi:[0,0,1]
v_pk_fma_f32 v[166:167], v[166:167], v[124:125], v[128:129] op_sel:[0,1,1] op_sel_hi:[1,1,1] neg_lo:[0,0,1] neg_hi:[0,0,1]
v_exp_f32 v164, v164
v_exp_f32 v165, v165
v_exp_f32 v166, v166
v_exp_f32 v167, v167
v_pk_fma_f32 v[172:173], v[172:173], v[126:127], v[130:131] op_sel:[0,0,0] op_sel_hi:[1,0,0] neg_lo:[0,0,1] neg_hi:[0,0,1]
v_pk_fma_f32 v[174:175], v[174:175], v[126:127], v[130:131] op_sel:[0,0,0] op_sel_hi:[1,0,0] neg_lo:[0,0,1] neg_hi:[0,0,1]
v_cvt_pk_bf16_f32 v156, v156, v156
v_cvt_pk_bf16_f32 v157, v157, v157
v_cvt_pk_bf16_f32 v158, v158, v158
v_cvt_pk_bf16_f32 v159, v159, v159
v_exp_f32 v172, v172
v_exp_f32 v173, v173
v_exp_f32 v174, v174
v_exp_f32 v175, v175
v_pk_fma_f32 v[180:181], v[180:181], v[126:127], v[130:131] op_sel:[0,1,1] op_sel_hi:[1,1,1] neg_lo:[0,0,1] neg_hi:[0,0,1]
v_pk_fma_f32 v[182:183], v[182:183], v[126:127], v[130:131] op_sel:[0,1,1] op_sel_hi:[1,1,1] neg_lo:[0,0,1] neg_hi:[0,0,1]
v_and_b32 v156, v52, v156
v_and_b32 v157, v52, v157
v_and_b32 v158, v52, v158
v_and_b32 v159, v52, v159
v_cvt_pk_bf16_f32 v164, v164, v164
v_cvt_pk_bf16_f32 v165, v165, v165
v_mfma_f32_16x16x32_bf16 v[160:163], v[48:51], v[156:159], 0
v_cvt_pk_bf16_f32 v166, v166, v166
v_cvt_pk_bf16_f32 v167, v167, v167
v_mfma_f32_16x16x32_bf16 v[220:223], v[100:103], v[156:159], 0
v_exp_f32 v180, v180
v_mfma_f32_16x16x32_bf16 v[224:227], v[110:113], v[156:159], 0
v_exp_f32 v181, v181
v_exp_f32 v182, v182
v_exp_f32 v183, v183
v_and_b32 v164, v52, v164
v_and_b32 v165, v52, v165
v_and_b32 v166, v52, v166
v_and_b32 v167, v52, v167
v_cvt_pk_bf16_f32 v172, v172, v172
v_cvt_pk_bf16_f32 v173, v173, v173
v_mfma_f32_16x16x32_bf16 v[168:171], v[48:51], v[164:167], 0
v_cvt_pk_bf16_f32 v174, v174, v174
v_cvt_pk_bf16_f32 v175, v175, v175
v_mfma_f32_16x16x32_bf16 v[228:231], v[102:105], v[164:167], 0
v_and_b32 v172, v52, v172
v_and_b32 v173, v52, v173
v_mfma_f32_16x16x32_bf16 v[232:235], v[112:115], v[164:167], 0
v_and_b32 v174, v52, v174
v_and_b32 v175, v52, v175
v_cvt_pk_bf16_f32 v180, v180, v180
v_cvt_pk_bf16_f32 v181, v181, v181
v_mfma_f32_16x16x32_bf16 v[176:179], v[48:51], v[172:175], 0
v_cvt_pk_bf16_f32 v182, v182, v182
v_cvt_pk_bf16_f32 v183, v183, v183
v_mfma_f32_16x16x32_bf16 v[236:239], v[104:107], v[172:175], 0
v_and_b32 v180, v52, v180
v_and_b32 v181, v52, v181
v_mfma_f32_16x16x32_bf16 v[240:243], v[114:117], v[172:175], 0
v_and_b32 v182, v52, v182
v_and_b32 v183, v52, v183
v_rcp_f32 v160, v160
v_rcp_f32 v168, v168
v_pk_mul_f32 v[220:221], v[220:221], v[160:161] op_sel:[0,0] op_sel_hi:[1,0]
v_pk_mul_f32 v[222:223], v[222:223], v[160:161] op_sel:[0,0] op_sel_hi:[1,0]
v_pk_mul_f32 v[228:229], v[228:229], v[168:169] op_sel:[0,0] op_sel_hi:[1,0]
v_pk_mul_f32 v[224:225], v[224:225], v[160:161] op_sel:[0,0] op_sel_hi:[1,0]
v_pk_mul_f32 v[226:227], v[226:227], v[160:161] op_sel:[0,0] op_sel_hi:[1,0]
v_pk_mul_f32 v[230:231], v[230:231], v[168:169] op_sel:[0,0] op_sel_hi:[1,0]
v_pk_mul_f32 v[232:233], v[232:233], v[168:169] op_sel:[0,0] op_sel_hi:[1,0]
v_pk_mul_f32 v[234:235], v[234:235], v[168:169] op_sel:[0,0] op_sel_hi:[1,0]
v_mfma_f32_16x16x32_bf16 v[184:187], v[48:51], v[180:183], 0
v_rcp_f32_e64 v176, v176
v_cvt_pk_bf16_f32 v220, v220, v221
v_cvt_pk_bf16_f32 v221, v222, v223
v_cvt_pk_bf16_f32 v228, v228, v229
v_pk_mul_f32 v[236:237], v[236:237], v[176:177] op_sel:[0,0] op_sel_hi:[1,0]
v_mfma_f32_16x16x32_bf16 v[244:247], v[106:109], v[180:183], 0
v_cvt_pk_bf16_f32 v222, v224, v225
v_cvt_pk_bf16_f32 v223, v226, v227
v_rcp_f32_e64 v184, v184
v_cvt_pk_bf16_f32 v229, v230, v231
v_pk_mul_f32 v[238:239], v[238:239], v[176:177] op_sel:[0,0] op_sel_hi:[1,0]
v_pk_mul_f32 v[240:241], v[240:241], v[176:177] op_sel:[0,0] op_sel_hi:[1,0]
v_pk_mul_f32 v[242:243], v[242:243], v[176:177] op_sel:[0,0] op_sel_hi:[1,0]
v_cvt_pk_bf16_f32 v236, v236, v237
v_pk_mul_f32 v[244:245], v[244:245], v[184:185] op_sel:[0,0] op_sel_hi:[1,0]
v_pk_mul_f32 v[246:247], v[246:247], v[184:185] op_sel:[0,0] op_sel_hi:[1,0]
v_mfma_f32_16x16x32_bf16 v[248:251], v[116:119], v[180:183], 0
buffer_store_dwordx4 v[220:223], v18, s[32:35], s80 offen sc1
v_cvt_pk_bf16_f32 v230, v232, v233
v_cvt_pk_bf16_f32 v231, v234, v235
v_cvt_pk_bf16_f32 v237, v238, v239
v_cvt_pk_bf16_f32 v244, v244, v245
buffer_store_dwordx4 v[228:231], v18, s[32:35], s81 offen sc1
v_cvt_pk_bf16_f32 v238, v240, v241
v_cvt_pk_bf16_f32 v239, v242, v243
v_pk_mul_f32 v[248:249], v[248:249], v[184:185] op_sel:[0,0] op_sel_hi:[1,0]
v_pk_mul_f32 v[250:251], v[250:251], v[184:185] op_sel:[0,0] op_sel_hi:[1,0]
v_cvt_pk_bf16_f32 v245, v246, v247
buffer_store_dwordx4 v[236:239], v18, s[32:35], s82 offen sc1
v_cvt_pk_bf16_f32 v246, v248, v249
v_cvt_pk_bf16_f32 v247, v250, v251
buffer_store_dwordx4 v[244:247], v18, s[32:35], s83 offen sc1
s_branch back_113
slow_114:
buffer_store_dword v5, v4, s[32:35], s84 offen sc1
s_branch back_115
slow_118:
s_nop 0
v_cvt_pk_bf16_f32 v20, v60, v61
v_cvt_pk_bf16_f32 v21, v62, v63
v_cvt_pk_bf16_f32 v22, v64, v65
v_cvt_pk_bf16_f32 v23, v66, v67
buffer_store_dwordx4 v[20:23], v18, s[32:35], s85 offen offset:0 sc1
v_cvt_pk_bf16_f32 v24, v68, v69
v_cvt_pk_bf16_f32 v25, v70, v71
v_cvt_pk_bf16_f32 v26, v72, v73
v_cvt_pk_bf16_f32 v27, v74, v75
buffer_store_dwordx4 v[24:27], v18, s[32:35], s85 offen offset:1024 sc1
v_cvt_pk_bf16_f32 v28, v76, v77
v_cvt_pk_bf16_f32 v29, v78, v79
v_cvt_pk_bf16_f32 v30, v80, v81
v_cvt_pk_bf16_f32 v31, v82, v83
buffer_store_dwordx4 v[28:31], v18, s[32:35], s86 offen offset:0 sc1
v_cvt_pk_bf16_f32 v32, v84, v85
v_cvt_pk_bf16_f32 v33, v86, v87
v_cvt_pk_bf16_f32 v34, v88, v89
v_cvt_pk_bf16_f32 v35, v90, v91
buffer_store_dwordx4 v[32:35], v18, s[32:35], s86 offen offset:1024 sc1
s_barrier
v_dot2c_f32_bf16 v6, v20, v48
v_dot2c_f32_bf16 v8, v20, v20
v_dot2c_f32_bf16 v7, v28, v48
v_dot2c_f32_bf16 v9, v28, v28
v_dot2c_f32_bf16 v6, v21, v48
v_dot2c_f32_bf16 v8, v21, v21
v_dot2c_f32_bf16 v7, v29, v48
v_dot2c_f32_bf16 v9, v29, v29
v_dot2c_f32_bf16 v6, v22, v48
v_dot2c_f32_bf16 v8, v22, v22
v_dot2c_f32_bf16 v7, v30, v48
v_dot2c_f32_bf16 v9, v30, v30
v_dot2c_f32_bf16 v6, v23, v48
v_dot2c_f32_bf16 v8, v23, v23
v_dot2c_f32_bf16 v7, v31, v48
v_dot2c_f32_bf16 v9, v31, v31
v_dot2c_f32_bf16 v6, v24, v48
v_dot2c_f32_bf16 v8, v24, v24
v_dot2c_f32_bf16 v7, v32, v48
v_dot2c_f32_bf16 v9, v32, v32
v_dot2c_f32_bf16 v6, v25, v48
v_dot2c_f32_bf16 v8, v25, v25
v_dot2c_f32_bf16 v7, v33, v48
v_dot2c_f32_bf16 v9, v33, v33
v_dot2c_f32_bf16 v6, v26, v48
v_dot2c_f32_bf16 v8, v26, v26
v_dot2c_f32_bf16 v7, v34, v48
v_dot2c_f32_bf16 v9, v34, v34
v_dot2c_f32_bf16 v6, v27, v48
v_dot2c_f32_bf16 v8, v27, v27
v_dot2c_f32_bf16 v7, v35, v48
v_dot2c_f32_bf16 v9, v35, v35
s_mov_b64 exec, 1
s_waitcnt vmcnt(0)
buffer_store_dword v5, v4, s[32:35], s88 offen sc1
s_mov_b64 exec, -1
s_nop 1
v_permlane32_swap_b32 v6, v7
v_permlane32_swap_b32 v8, v9
v_add_f32 v6, v6, v7
v_add_f32 v8, v8, v9
s_nop 1
v_permlane16_swap_b32 v6, v8
s_nop 0
v_add_f32 v6, v6, v8
buffer_store_dword v6, v1, s[32:35], s87 offen sc1
s_branch back_119
slow_132:
.p2align 3
v_mfma_f32_16x16x32_bf16 v[156:159], v[188:191], v[60:63], 0
v_mfma_f32_16x16x32_bf16 v[164:167], v[188:191], v[68:71], 0
v_mfma_f32_16x16x32_bf16 v[160:163], v[192:195], v[60:63], 0
v_mfma_f32_16x16x32_bf16 v[172:175], v[188:191], v[76:79], 0
v_mfma_f32_16x16x32_bf16 v[168:171], v[192:195], v[68:71], 0
v_mfma_f32_16x16x32_bf16 v[180:183], v[188:191], v[84:87], 0
v_mfma_f32_16x16x32_bf16 v[156:159], v[196:199], v[220:223], v[156:159]
v_mfma_f32_16x16x32_bf16 v[176:179], v[192:195], v[76:79], 0
v_mfma_f32_16x16x32_bf16 v[164:167], v[196:199], v[228:231], v[164:167]
v_mfma_f32_16x16x32_bf16 v[184:187], v[192:195], v[84:87], 0
v_mfma_f32_16x16x32_bf16 v[160:163], v[200:203], v[220:223], v[160:163]
v_mfma_f32_16x16x32_bf16 v[172:175], v[196:199], v[236:239], v[172:175]
v_mfma_f32_16x16x32_bf16 v[168:171], v[200:203], v[228:231], v[168:171]
v_mfma_f32_16x16x32_bf16 v[180:183], v[196:199], v[244:247], v[180:183]
v_mfma_f32_16x16x32_bf16 v[176:179], v[200:203], v[236:239], v[176:179]
v_mfma_f32_16x16x32_bf16 v[184:187], v[200:203], v[244:247], v[184:187]
v_pk_mul_f32 v[156:157], v[156:157], v[100:101] op_sel:[0,0] op_sel_hi:[1,0]
v_pk_mul_f32 v[158:159], v[158:159], v[100:101] op_sel:[0,0] op_sel_hi:[1,0]
v_cvt_pk_bf16_f32 v156, v156, v157
v_pk_mul_f32 v[164:165], v[164:165], v[100:101] op_sel:[0,1] op_sel_hi:[1,1]
v_pk_mul_f32 v[160:161], v[160:161], v[100:101] op_sel:[0,0] op_sel_hi:[1,0]
v_pk_mul_f32 v[162:163], v[162:163], v[100:101] op_sel:[0,0] op_sel_hi:[1,0]
v_cvt_pk_bf16_f32 v157, v158, v159
v_pk_mul_f32 v[166:167], v[166:167], v[100:101] op_sel:[0,1] op_sel_hi:[1,1]
v_cvt_pk_bf16_f32 v164, v164, v165
v_pk_mul_f32 v[172:173], v[172:173], v[102:103] op_sel:[0,0] op_sel_hi:[1,0]
v_cvt_pk_bf16_f32 v158, v160, v161
v_cvt_pk_bf16_f32 v159, v162, v163
v_pk_mul_f32 v[168:169], v[168:169], v[100:101] op_sel:[0,1] op_sel_hi:[1,1]
v_pk_mul_f32 v[170:171], v[170:171], v[100:101] op_sel:[0,1] op_sel_hi:[1,1]
v_cvt_pk_bf16_f32 v165, v166, v167
v_pk_mul_f32 v[174:175], v[174:175], v[102:103] op_sel:[0,0] op_sel_hi:[1,0]
v_cvt_pk_bf16_f32 v172, v172, v173
v_pk_mul_f32 v[180:181], v[180:181], v[102:103] op_sel:[0,1] op_sel_hi:[1,1]
buffer_store_dwordx4 v[156:159], v18, s[32:35], s80 offen sc1
v_cvt_pk_bf16_f32 v166, v168, v169
v_cvt_pk_bf16_f32 v167, v170, v171
v_pk_mul_f32 v[176:177], v[176:177], v[102:103] op_sel:[0,0] op_sel_hi:[1,0]
v_pk_mul_f32 v[178:179], v[178:179], v[102:103] op_sel:[0,0] op_sel_hi:[1,0]
v_cvt_pk_bf16_f32 v173, v174, v175
v_pk_mul_f32 v[182:183], v[182:183], v[102:103] op_sel:[0,1] op_sel_hi:[1,1]
v_cvt_pk_bf16_f32 v180, v180, v181
buffer_store_dwordx4 v[164:167], v18, s[32:35], s81 offen sc1
v_cvt_pk_bf16_f32 v174, v176, v177
v_cvt_pk_bf16_f32 v175, v178, v179
v_pk_mul_f32 v[184:185], v[184:185], v[102:103] op_sel:[0,1] op_sel_hi:[1,1]
v_pk_mul_f32 v[186:187], v[186:187], v[102:103] op_sel:[0,1] op_sel_hi:[1,1]
v_cvt_pk_bf16_f32 v181, v182, v183
buffer_store_dwordx4 v[172:175], v18, s[32:35], s82 offen sc1
v_cvt_pk_bf16_f32 v182, v184, v185
v_cvt_pk_bf16_f32 v183, v186, v187
buffer_store_dwordx4 v[180:183], v18, s[32:35], s83 offen sc1
s_branch back_133
slow_134:
buffer_store_dword v5, v4, s[32:35], s84 offen sc1
s_branch back_135
s_endpgm
.section .rodata,"a"
.p2align 6
.amdhsa_kernel interleave_layers__sliding_local_dilated__linear_kernel_hedgehog__prompt_kernel
  .amdhsa_next_free_vgpr 256
  .amdhsa_next_free_sgpr 102
  .amdhsa_accum_offset 256
  .amdhsa_group_segment_fixed_size 0
  .amdhsa_kernarg_size 80
  .amdhsa_user_sgpr_count 2
  .amdhsa_user_sgpr_kernarg_segment_ptr 1
  .amdhsa_system_sgpr_workgroup_id_x 1
.end_amdhsa_kernel
```

```asm
; @launch grid=(256,1,1) block=(512,1,1) lds=163840
.amdgcn_target "amdgcn-amd-amdhsa--gfx950"
.text
.globl interleave_layers__sliding_local_dilated__linear_kernel_hedgehog__prompt_kernel
.p2align 8
.type interleave_layers__sliding_local_dilated__linear_kernel_hedgehog__prompt_kernel,@function
interleave_layers__sliding_local_dilated__linear_kernel_hedgehog__prompt_kernel:
s_cmp_ge_u32 s2, 256
s_cbranch_scc1 L_end
s_load_dwordx16 s[4:19], s[0:1], 0
s_load_dwordx4 s[20:23], s[0:1], 64
v_lshrrev_b32 v1, 6, v0
v_and_b32 v0, 63, v0
v_readfirstlane_b32 s40, v1
v_and_b32 v2, 15, v0
v_lshrrev_b32 v3, 4, v0
v_lshlrev_b32 v18, 4, v0
s_and_b32 s48, s2, 7
s_lshr_b32 s49, s2, 3
s_and_b32 s74, s49, 1
s_lshl_b32 s41, s48, 1
s_add_u32 s41, s41, s74
s_lshr_b32 s42, s49, 1
s_and_b32 s48, s2, 7
s_lshr_b32 s47, s42, 2
s_add_u32 s47, s47, s48
s_and_b32 s47, s47, 3
s_and_b32 s43, s40, 3
s_lshl_b32 s70, s43, 12
s_lshl_b32 s71, s43, 11
s_add_u32 s71, s71, 16384
s_cmp_lt_u32 s40, 4
s_cbranch_scc1 L_compute
v_lshrrev_b32 v4, 3, v0
v_and_b32 v5, 7, v0
s_lshl_b32 s48, s43, 4
v_add_u32 v6, s48, v4
s_lshl_b32 s48, s42, 7
s_mov_b32 s49, 6144
v_mul_u32_u24 v6, s49, v6
v_and_b32 v7, 2, v4
v_xor_b32 v7, v7, v5
v_lshl_add_u32 v26, v7, 4, v6
v_add_u32 v26, s48, v26
s_mul_i32 s49, s49, 8
s_sub_u32 s49, s49, 1024
v_xor_b32 v27, 64, v26
v_add_u32 v27, s49, v27
s_mov_b32 s53, 2048
s_mov_b32 s54, 393216
s_mov_b32 s57, 131072
s_lshl_b32 s48, s41, 7
s_lshl_b32 s49, s43, 5
s_add_u32 s48, s48, s49
v_add_u32 v6, s48, v4
v_lshlrev_b32 v6, 11, v6
v_lshrrev_b32 v7, 1, v4
v_xor_b32 v7, v7, v5
v_lshl_add_u32 v20, v7, 4, v6
v_xor_b32 v21, 64, v20
v_add_u32 v21, 15360, v21
v_add_u32 v22, 30720, v20
v_add_u32 v23, 30720, v21
s_add_u32 s69, s47, 0
s_and_b32 s69, s69, 3
s_add_u32 s69, s69, 0
s_mul_i32 s67, s69, 128
s_mul_i32 s68, s69, s54
s_waitcnt lgkmcnt(0)
s_mov_b32 s24, s4
s_and_b32 s25, s5, 0xffff
s_mov_b32 s26, 4194304
s_mov_b32 s27, 0x00020000
s_mov_b32 s28, s6
s_and_b32 s29, s7, 0xffff
s_mov_b32 s30, 6291456
s_mov_b32 s31, 0x00020000
s_add_u32 m0, s70, 0
s_nop 0
buffer_load_dwordx4 v20, s[24:27], s67 offen offset:0  lds
buffer_load_dwordx4 v21, s[24:27], s67 offen offset:1024  lds
buffer_load_dwordx4 v22, s[24:27], s67 offen offset:2048  lds
buffer_load_dwordx4 v23, s[24:27], s67 offen offset:3072  lds
s_add_u32 s60, s71, 0
s_add_u32 m0, s60, 0
s_mov_b32 s61, s68
buffer_load_dwordx4 v26, s[28:31], s61 offen lds
buffer_load_dwordx4 v27, s[28:31], s61 offen offset:1024 lds
s_add_u32 m0, s60, 8192
s_add_u32 s61, s61, s53
buffer_load_dwordx4 v26, s[28:31], s61 offen lds
buffer_load_dwordx4 v27, s[28:31], s61 offen offset:1024 lds
s_add_u32 m0, s60, 16384
s_add_u32 s61, s61, s53
buffer_load_dwordx4 v26, s[28:31], s61 offen lds
buffer_load_dwordx4 v27, s[28:31], s61 offen offset:1024 lds
s_lshr_b32 s48, s2, 2
s_and_b32 s48, s48, 1
s_lshl_b32 s48, s48, 1
s_add_u32 s48, s48, s74
s_and_b32 s49, s42, 3
s_xor_b32 s77, s48, s49
s_add_u32 s77, s77, 4
s_add_u32 s48, s47, 1
s_and_b32 s48, s48, 3
s_and_b32 s49, s77, 3
s_lshl_b32 s49, s49, 2
s_add_u32 s78, s48, s49
s_and_b32 s48, s2, 7
s_lshl_b32 s48, s48, 1
s_add_u32 s75, s78, s48
s_and_b32 s75, s75, 15
s_mov_b32 s46, 0
s_mov_b32 s32, s22
s_and_b32 s33, s23, 0xffff
s_mov_b32 s34, 268435456
s_mov_b32 s35, 0x00020000
s_mov_b32 s36, s8
s_and_b32 s37, s9, 0xffff
s_mov_b32 s38, 2097152
s_mov_b32 s39, 0x00020000
v_mov_b32 v56, -1
v_mov_b32 v57, -1
v_mov_b32 v58, -1
v_mov_b32 v59, -1
s_lshl_b32 s52, s41, 6
s_add_u32 s52, s52, s42
s_lshl_b32 s52, s52, 8
s_add_u32 s52, s52, 16777216
s_getreg_b32 s50, hwreg(HW_REG_XCC_ID)
s_and_b32 s50, s50, 7
s_lshl_b32 s50, s50, 3
s_lshl_b64 s[94:95], 1, s50
s_and_b32 s96, s2, 7
s_lshl_b32 s96, s96, 5
s_and_b32 s51, s42, 7
s_cmp_gt_u32 s51, 3
s_cselect_b32 s49, 1, 0
s_sub_u32 s49, s51, s49
s_lshl_b32 s49, s49, 1
s_add_u32 s49, s49, s74
s_lshl_b32 s49, s49, 2
s_add_u32 s49, s49, s43
s_lshr_b32 s50, s49, 4
s_lshl_b32 s50, s50, 11
s_and_b32 s49, s49, 15
s_mul_i32 s49, s49, 24576
s_add_u32 s49, s49, s50
s_and_b32 s50, s42, 8
s_or_b32 s50, s50, 3
s_and_b32 s48, s2, 7
s_lshr_b32 s76, s50, 2
s_add_u32 s76, s76, s48
s_and_b32 s76, s76, 3
s_lshl_b32 s50, s50, 7
s_add_u32 s49, s49, s50
s_and_b32 s51, s51, 3
s_cmp_eq_u32 s51, 3
s_cselect_b32 s49, 0x70000000, s49
v_mul_u32_u24 v4, 6144, v4
v_lshl_add_u32 v4, v5, 4, v4
v_lshrrev_b32 v5, 5, v0
v_lshlrev_b32 v5, 30, v5
v_add3_u32 v36, v4, v5, s49
s_mov_b32 s55, -1
s_mov_b32 s56, -1
v_lshrrev_b32 v4, 3, v0
v_and_b32 v5, 7, v0
s_lshr_b32 s48, s43, 1
s_lshl_b32 s48, s48, 5
s_and_b32 s49, s43, 1
s_lshl_b32 s49, s49, 3
s_add_u32 s48, s48, s49
v_lshrrev_b32 v6, 2, v4
v_lshlrev_b32 v6, 4, v6
v_and_b32 v7, 3, v4
v_add3_u32 v6, v6, v7, s48
s_lshl_b32 s48, s78, 7
s_mov_b32 s49, 2048
v_mul_u32_u24 v6, s49, v6
v_and_b32 v7, 2, v4
v_xor_b32 v7, v7, v5
v_lshl_add_u32 v28, v7, 4, v6
v_add_u32 v28, s48, v28
s_mul_i32 s49, s49, 4
s_sub_u32 s49, s49, 1024
v_xor_b32 v29, 64, v28
v_add_u32 v29, s49, v29
v_lshrrev_b32 v4, 3, v0
v_and_b32 v5, 7, v0
s_lshr_b32 s48, s43, 1
s_lshl_b32 s48, s48, 5
s_and_b32 s49, s43, 1
s_lshl_b32 s49, s49, 3
s_add_u32 s48, s48, s49
v_lshrrev_b32 v6, 2, v4
v_lshlrev_b32 v6, 4, v6
v_and_b32 v7, 3, v4
v_add3_u32 v6, v6, v7, s48
s_lshl_b32 s48, s42, 7
s_mov_b32 s49, 6144
s_cmp_ge_i32 s55, 0
s_cselect_b32 s48, 1024, s48
s_cselect_b32 s49, 384, s49
v_mul_u32_u24 v6, s49, v6
v_and_b32 v7, 2, v4
v_xor_b32 v7, v7, v5
v_lshl_add_u32 v60, v7, 4, v6
v_add_u32 v60, s48, v60
s_mul_i32 s49, s49, 4
s_sub_u32 s49, s49, 1024
v_xor_b32 v61, 64, v60
v_add_u32 v61, s49, v61
v_lshrrev_b32 v4, 3, v0
v_and_b32 v5, 7, v0
s_lshr_b32 s48, s43, 1
s_lshl_b32 s48, s48, 5
s_and_b32 s49, s43, 1
s_lshl_b32 s49, s49, 3
s_add_u32 s48, s48, s49
v_lshrrev_b32 v6, 2, v4
v_lshlrev_b32 v6, 4, v6
v_and_b32 v7, 3, v4
v_add3_u32 v6, v6, v7, s48
s_lshl_b32 s48, s78, 7
s_mov_b32 s49, 2048
s_cmp_ge_i32 s56, 0
s_cselect_b32 s48, 1024, s48
s_cselect_b32 s49, 128, s49
v_mul_u32_u24 v6, s49, v6
v_and_b32 v7, 2, v4
v_xor_b32 v7, v7, v5
v_lshl_add_u32 v24, v7, 4, v6
v_add_u32 v24, s48, v24
s_mul_i32 s49, s49, 4
s_sub_u32 s49, s49, 1024
v_xor_b32 v25, 64, v24
v_add_u32 v25, s49, v25
v_lshlrev_b32 v30, 2, v2
v_and_b32 v32, 7, v0
v_lshlrev_b32 v32, 5, v32
s_lshl_b32 s50, s41, 2
s_add_u32 s50, s50, s43
s_lshl_b32 s50, s50, 12
s_add_u32 s50, s50, 16777216
v_add_u32 v37, s50, v18
v_lshrrev_b32 v4, 5, v0
v_lshl_add_u32 v4, v4, 4, v2
s_lshl_b32 s48, s43, 5
v_add_u32 v4, s48, v4
v_lshlrev_b32 v49, 3, v4
v_add_u32 v49, 131072, v49
v_lshlrev_b32 v50, 2, v4
v_add_u32 v50, 132096, v50
s_lshl_b32 s79, s41, 2
s_add_u32 s79, s79, s43
s_lshl_b32 s79, s79, 7
s_add_u32 s79, s79, 18358272
s_lshl_b32 s48, s41, 3
s_lshl_b32 s49, s43, 1
s_add_u32 s48, s48, s49
s_lshl_b32 s80, s48, 15
s_lshl_b32 s49, s42, 11
s_add_u32 s81, s80, s49
s_add_u32 s81, s81, 4194304
s_add_u32 s82, s81, 32768
s_lshl_b32 s48, s43, 11
v_add_u32 v51, s48, v18
v_add_u32 v52, 0x10000, v51
v_add_u32 v14, 0x20000, v51
s_lshl_b32 s48, s2, 2
s_add_u32 s48, s48, s43
s_lshl_b32 s83, s48, 11
s_mul_i32 s87, s48, 6144
v_add_u32 v62, s83, v18
s_add_u32 s87, s87, 3072
v_add_u32 v63, s87, v18
s_lshr_b32 s48, s2, 4
s_and_b32 s49, s2, 7
s_add_u32 s48, s48, s49
s_mul_i32 s49, s48, 8193
s_lshr_b32 s49, s49, 16
s_mul_i32 s49, s49, 8
s_sub_u32 s88, s48, s49
s_lshr_b32 s48, s2, 3
s_lshl_b32 s48, s48, 2
s_add_u32 s48, s48, s43
s_lshl_b32 s48, s48, 14
s_add_u32 s48, s48, 384
v_lshrrev_b32 v4, 3, v0
v_and_b32 v5, 7, v0
v_lshlrev_b32 v4, 11, v4
v_lshl_add_u32 v4, v5, 4, v4
v_add_u32 v15, s48, v4
s_mul_i32 s48, s42, 163840
s_add_u32 s48, s48, 9437184
s_lshl_b32 s49, s43, 4
s_add_u32 s49, s49, s41
s_lshl_b32 s50, s49, 11
s_add_u32 s86, s48, s50
s_lshl_b32 s50, s49, 9
s_add_u32 s89, s48, s50
s_add_u32 s89, s89, 131072
v_lshlrev_b32 v39, 3, v0
s_lshl_b32 s73, s42, 2
s_add_u32 s73, s73, 0
s_lshl_b32 s73, s73, 7
s_add_u32 s73, s73, 18366464
v_mov_b32 v12, 0
s_lshl_b32 s50, s43, 12
s_add_u32 s50, s50, s52
s_add_u32 s50, s50, 262144
v_min_u32 v8, 2, v3
v_lshlrev_b32 v8, 18, v8
v_lshl_add_u32 v8, v2, 4, v8
v_add_u32 v55, s50, v8
s_lshl_b32 s50, s42, 2
s_add_u32 s50, s50, s43
s_lshl_b32 s50, s50, 12
s_add_u32 s50, s50, 17825792
v_add_u32 v38, s50, v18
v_min_u32 v4, 2, v3
v_lshlrev_b32 v4, 8, v4
v_lshl_add_u32 v4, v2, 2, v4
s_and_b32 s48, s43, 1
s_lshl_b32 s48, s48, 7
s_lshr_b32 s49, s43, 1
s_lshl_b32 s49, s49, 6
s_add_u32 s48, s48, s49
s_add_u32 s48, s48, 133120
v_add_u32 v53, s48, v4
s_getpc_b64 s[98:99]
pc_1:
s_add_u32 s98, s98, c0_last - pc_1
s_addc_u32 s99, s99, 0
s_lshr_b32 s50, s2, 3
s_lshl_b32 s50, s50, 2
s_add_u32 s50, s50, s43
s_lshl_b32 s50, s50, 7
v_and_b32 v4, 1, v0
v_lshl_add_u32 v4, v4, 6, s50
v_min_u32 v54, L_code_end - c0_last, v4
s_add_u32 s69, s47, 0
s_and_b32 s69, s69, 3
s_add_u32 s69, s69, 4
s_mul_i32 s67, s69, 128
s_mul_i32 s68, s69, s54
s_add_u32 m0, s70, 40960
s_nop 0
buffer_load_dwordx4 v20, s[24:27], s67 offen offset:0  lds
buffer_load_dwordx4 v21, s[24:27], s67 offen offset:1024  lds
buffer_load_dwordx4 v22, s[24:27], s67 offen offset:2048  lds
buffer_load_dwordx4 v23, s[24:27], s67 offen offset:3072  lds
s_add_u32 s60, s71, 40960
s_add_u32 m0, s60, 0
s_mov_b32 s61, s68
buffer_load_dwordx4 v26, s[28:31], s61 offen lds
buffer_load_dwordx4 v27, s[28:31], s61 offen offset:1024 lds
s_add_u32 m0, s60, 8192
s_add_u32 s61, s61, s53
buffer_load_dwordx4 v26, s[28:31], s61 offen lds
buffer_load_dwordx4 v27, s[28:31], s61 offen offset:1024 lds
s_add_u32 m0, s60, 16384
s_add_u32 s61, s61, s53
buffer_load_dwordx4 v26, s[28:31], s61 offen lds
buffer_load_dwordx4 v27, s[28:31], s61 offen offset:1024 lds
s_waitcnt vmcnt(10)
s_barrier
s_cmp_lg_u32 s43, 3
s_cbranch_scc1 else_2
s_atomic_add_x2 s[94:95], s[20:21], s96
else_2:
s_add_u32 s49, s76, 0
s_and_b32 s49, s49, 3
s_add_u32 s49, s49, 8
s_mul_i32 s49, s49, 393216
buffer_load_dwordx4 v[40:43], v36, s[28:31], s49 offen
s_add_u32 s49, s76, 0
s_and_b32 s49, s49, 3
s_add_u32 s49, s49, 12
s_mul_i32 s49, s49, 393216
buffer_load_dwordx4 v[40:43], v36, s[28:31], s49 offen
s_add_u32 s69, s47, 0
s_and_b32 s69, s69, 3
s_add_u32 s69, s69, 8
s_mul_i32 s67, s69, 128
s_mul_i32 s68, s69, s54
s_add_u32 m0, s70, 81920
s_nop 0
buffer_load_dwordx4 v20, s[24:27], s67 offen offset:0  lds
buffer_load_dwordx4 v21, s[24:27], s67 offen offset:1024  lds
buffer_load_dwordx4 v22, s[24:27], s67 offen offset:2048  lds
buffer_load_dwordx4 v23, s[24:27], s67 offen offset:3072  lds
s_add_u32 s60, s71, 81920
s_add_u32 m0, s60, 0
s_mov_b32 s61, s68
buffer_load_dwordx4 v26, s[28:31], s61 offen lds
buffer_load_dwordx4 v27, s[28:31], s61 offen offset:1024 lds
s_add_u32 m0, s60, 8192
s_add_u32 s61, s61, s53
buffer_load_dwordx4 v26, s[28:31], s61 offen lds
buffer_load_dwordx4 v27, s[28:31], s61 offen offset:1024 lds
s_add_u32 m0, s60, 16384
s_add_u32 s61, s61, s53
buffer_load_dwordx4 v26, s[28:31], s61 offen lds
buffer_load_dwordx4 v27, s[28:31], s61 offen offset:1024 lds
s_add_u32 s49, s76, 1
s_and_b32 s49, s49, 3
s_add_u32 s49, s49, 0
s_mul_i32 s49, s49, 393216
buffer_load_dwordx4 v[40:43], v36, s[28:31], s49 offen
s_mov_b32 s64, 0
s_mov_b32 s65, 0
s_waitcnt vmcnt(11)
s_barrier
s_add_u32 s69, s47, 0
s_and_b32 s69, s69, 3
s_add_u32 s69, s69, 12
s_mul_i32 s67, s69, 128
s_mul_i32 s68, s69, s54
s_add_u32 m0, s70, s65
s_nop 0
buffer_load_dwordx4 v20, s[24:27], s67 offen offset:0  lds
buffer_load_dwordx4 v21, s[24:27], s67 offen offset:1024  lds
buffer_load_dwordx4 v22, s[24:27], s67 offen offset:2048  lds
buffer_load_dwordx4 v23, s[24:27], s67 offen offset:3072  lds
s_add_u32 s60, s71, s65
s_add_u32 m0, s60, 0
s_mov_b32 s61, s68
buffer_load_dwordx4 v26, s[28:31], s61 offen lds
buffer_load_dwordx4 v27, s[28:31], s61 offen offset:1024 lds
s_add_u32 m0, s60, 8192
s_add_u32 s61, s61, s53
buffer_load_dwordx4 v26, s[28:31], s61 offen lds
buffer_load_dwordx4 v27, s[28:31], s61 offen offset:1024 lds
s_add_u32 m0, s60, 16384
s_add_u32 s61, s61, s53
buffer_load_dwordx4 v26, s[28:31], s61 offen lds
buffer_load_dwordx4 v27, s[28:31], s61 offen offset:1024 lds
s_add_u32 s49, s76, 1
s_and_b32 s49, s49, 3
s_add_u32 s49, s49, 4
s_mul_i32 s49, s49, 393216
buffer_load_dwordx4 v[40:43], v36, s[28:31], s49 offen
s_add_u32 s65, s65, 40960
s_cmp_eq_u32 s65, 122880
s_cselect_b32 s65, 0, s65
s_add_u32 s64, s64, 1
s_waitcnt vmcnt(11)
s_barrier
s_add_u32 s69, s47, 1
s_and_b32 s69, s69, 3
s_add_u32 s69, s69, 0
s_mul_i32 s67, s69, 128
s_mul_i32 s68, s69, s54
s_add_u32 m0, s70, s65
s_nop 0
buffer_load_dwordx4 v20, s[24:27], s67 offen offset:0  lds
buffer_load_dwordx4 v21, s[24:27], s67 offen offset:1024  lds
buffer_load_dwordx4 v22, s[24:27], s67 offen offset:2048  lds
buffer_load_dwordx4 v23, s[24:27], s67 offen offset:3072  lds
s_add_u32 s60, s71, s65
s_add_u32 m0, s60, 0
s_mov_b32 s61, s68
buffer_load_dwordx4 v26, s[28:31], s61 offen lds
buffer_load_dwordx4 v27, s[28:31], s61 offen offset:1024 lds
s_add_u32 m0, s60, 8192
s_add_u32 s61, s61, s53
buffer_load_dwordx4 v26, s[28:31], s61 offen lds
buffer_load_dwordx4 v27, s[28:31], s61 offen offset:1024 lds
s_add_u32 m0, s60, 16384
s_add_u32 s61, s61, s53
buffer_load_dwordx4 v26, s[28:31], s61 offen lds
buffer_load_dwordx4 v27, s[28:31], s61 offen offset:1024 lds
s_add_u32 s49, s76, 1
s_and_b32 s49, s49, 3
s_add_u32 s49, s49, 8
s_mul_i32 s49, s49, 393216
buffer_load_dwordx4 v[40:43], v36, s[28:31], s49 offen
s_add_u32 s65, s65, 40960
s_cmp_eq_u32 s65, 122880
s_cselect_b32 s65, 0, s65
s_add_u32 s64, s64, 1
s_waitcnt vmcnt(11)
s_barrier
s_cmp_lg_u32 s88, 0
s_cbranch_scc1 else_4
buffer_load_dwordx4 v[108:111], v18, s[36:39], s83 offen offset:0
buffer_load_dwordx4 v[108:111], v18, s[36:39], s83 offen offset:1024
global_load_dwordx4 v[108:111], v63, s[12:13] offset:-3072
global_load_dwordx4 v[108:111], v63, s[12:13] offset:-2048
global_load_dwordx4 v[108:111], v63, s[12:13] offset:-1024
global_load_dwordx4 v[108:111], v63, s[12:13] offset:0
global_load_dwordx4 v[108:111], v63, s[12:13] offset:1024
global_load_dwordx4 v[108:111], v63, s[12:13] offset:2048
buffer_store_dwordx4 v[56:59], v18, s[32:35], s86 offen offset:0 sc1
buffer_store_dwordx4 v[56:59], v18, s[32:35], s86 offen offset:1024 sc1
buffer_store_dwordx2 v[56:57], v39, s[32:35], s89 offen sc1
buffer_store_dwordx4 v[56:59], v55, s[32:35], 0 offen sc1
else_4:
s_add_u32 s69, s47, 1
s_and_b32 s69, s69, 3
s_add_u32 s69, s69, 4
s_mul_i32 s67, s69, 128
s_mul_i32 s68, s69, s54
s_add_u32 m0, s70, s65
s_nop 0
buffer_load_dwordx4 v20, s[24:27], s67 offen offset:0  lds
buffer_load_dwordx4 v21, s[24:27], s67 offen offset:1024  lds
buffer_load_dwordx4 v22, s[24:27], s67 offen offset:2048  lds
buffer_load_dwordx4 v23, s[24:27], s67 offen offset:3072  lds
s_add_u32 s60, s71, s65
s_add_u32 m0, s60, 0
s_mov_b32 s61, s68
buffer_load_dwordx4 v26, s[28:31], s61 offen lds
buffer_load_dwordx4 v27, s[28:31], s61 offen offset:1024 lds
s_add_u32 m0, s60, 8192
s_add_u32 s61, s61, s53
buffer_load_dwordx4 v26, s[28:31], s61 offen lds
buffer_load_dwordx4 v27, s[28:31], s61 offen offset:1024 lds
s_add_u32 m0, s60, 16384
s_add_u32 s61, s61, s53
buffer_load_dwordx4 v26, s[28:31], s61 offen lds
buffer_load_dwordx4 v27, s[28:31], s61 offen offset:1024 lds
s_add_u32 s49, s76, 1
s_and_b32 s49, s49, 3
s_add_u32 s49, s49, 12
s_mul_i32 s49, s49, 393216
buffer_load_dwordx4 v[40:43], v36, s[28:31], s49 offen
s_add_u32 s65, s65, 40960
s_cmp_eq_u32 s65, 122880
s_cselect_b32 s65, 0, s65
s_add_u32 s64, s64, 1
s_waitcnt vmcnt(11)
s_barrier
s_cmp_lg_u32 s88, 1
s_cbranch_scc1 else_6
buffer_load_dwordx4 v[108:111], v18, s[36:39], s83 offen offset:0
buffer_load_dwordx4 v[108:111], v18, s[36:39], s83 offen offset:1024
global_load_dwordx4 v[108:111], v63, s[12:13] offset:-3072
global_load_dwordx4 v[108:111], v63, s[12:13] offset:-2048
global_load_dwordx4 v[108:111], v63, s[12:13] offset:-1024
global_load_dwordx4 v[108:111], v63, s[12:13] offset:0
global_load_dwordx4 v[108:111], v63, s[12:13] offset:1024
global_load_dwordx4 v[108:111], v63, s[12:13] offset:2048
buffer_store_dwordx4 v[56:59], v18, s[32:35], s86 offen offset:0 sc1
buffer_store_dwordx4 v[56:59], v18, s[32:35], s86 offen offset:1024 sc1
buffer_store_dwordx2 v[56:57], v39, s[32:35], s89 offen sc1
buffer_store_dwordx4 v[56:59], v55, s[32:35], 0 offen sc1
else_6:
s_add_u32 s69, s47, 1
s_and_b32 s69, s69, 3
s_add_u32 s69, s69, 8
s_mul_i32 s67, s69, 128
s_mul_i32 s68, s69, s54
s_add_u32 m0, s70, s65
s_nop 0
buffer_load_dwordx4 v20, s[24:27], s67 offen offset:0  lds
buffer_load_dwordx4 v21, s[24:27], s67 offen offset:1024  lds
buffer_load_dwordx4 v22, s[24:27], s67 offen offset:2048  lds
buffer_load_dwordx4 v23, s[24:27], s67 offen offset:3072  lds
s_add_u32 s60, s71, s65
s_add_u32 m0, s60, 0
s_mov_b32 s61, s68
buffer_load_dwordx4 v26, s[28:31], s61 offen lds
buffer_load_dwordx4 v27, s[28:31], s61 offen offset:1024 lds
s_add_u32 m0, s60, 8192
s_add_u32 s61, s61, s53
buffer_load_dwordx4 v26, s[28:31], s61 offen lds
buffer_load_dwordx4 v27, s[28:31], s61 offen offset:1024 lds
s_add_u32 m0, s60, 16384
s_add_u32 s61, s61, s53
buffer_load_dwordx4 v26, s[28:31], s61 offen lds
buffer_load_dwordx4 v27, s[28:31], s61 offen offset:1024 lds
s_add_u32 s49, s76, 2
s_and_b32 s49, s49, 3
s_add_u32 s49, s49, 0
s_mul_i32 s49, s49, 393216
buffer_load_dwordx4 v[40:43], v36, s[28:31], s49 offen
s_add_u32 s65, s65, 40960
s_cmp_eq_u32 s65, 122880
s_cselect_b32 s65, 0, s65
s_add_u32 s64, s64, 1
s_waitcnt vmcnt(11)
s_barrier
s_cmp_lg_u32 s88, 2
s_cbranch_scc1 else_8
buffer_load_dwordx4 v[108:111], v18, s[36:39], s83 offen offset:0
buffer_load_dwordx4 v[108:111], v18, s[36:39], s83 offen offset:1024
global_load_dwordx4 v[108:111], v63, s[12:13] offset:-3072
global_load_dwordx4 v[108:111], v63, s[12:13] offset:-2048
global_load_dwordx4 v[108:111], v63, s[12:13] offset:-1024
global_load_dwordx4 v[108:111], v63, s[12:13] offset:0
global_load_dwordx4 v[108:111], v63, s[12:13] offset:1024
global_load_dwordx4 v[108:111], v63, s[12:13] offset:2048
buffer_store_dwordx4 v[56:59], v18, s[32:35], s86 offen offset:0 sc1
buffer_store_dwordx4 v[56:59], v18, s[32:35], s86 offen offset:1024 sc1
buffer_store_dwordx2 v[56:57], v39, s[32:35], s89 offen sc1
buffer_store_dwordx4 v[56:59], v55, s[32:35], 0 offen sc1
else_8:
s_add_u32 s69, s47, 1
s_and_b32 s69, s69, 3
s_add_u32 s69, s69, 12
s_mul_i32 s67, s69, 128
s_mul_i32 s68, s69, s54
s_add_u32 m0, s70, s65
s_nop 0
buffer_load_dwordx4 v20, s[24:27], s67 offen offset:0  lds
buffer_load_dwordx4 v21, s[24:27], s67 offen offset:1024  lds
buffer_load_dwordx4 v22, s[24:27], s67 offen offset:2048  lds
buffer_load_dwordx4 v23, s[24:27], s67 offen offset:3072  lds
s_add_u32 s60, s71, s65
s_add_u32 m0, s60, 0
s_mov_b32 s61, s68
buffer_load_dwordx4 v26, s[28:31], s61 offen lds
buffer_load_dwordx4 v27, s[28:31], s61 offen offset:1024 lds
s_add_u32 m0, s60, 8192
s_add_u32 s61, s61, s53
buffer_load_dwordx4 v26, s[28:31], s61 offen lds
buffer_load_dwordx4 v27, s[28:31], s61 offen offset:1024 lds
s_add_u32 m0, s60, 16384
s_add_u32 s61, s61, s53
buffer_load_dwordx4 v26, s[28:31], s61 offen lds
buffer_load_dwordx4 v27, s[28:31], s61 offen offset:1024 lds
s_add_u32 s49, s76, 2
s_and_b32 s49, s49, 3
s_add_u32 s49, s49, 4
s_mul_i32 s49, s49, 393216
buffer_load_dwordx4 v[40:43], v36, s[28:31], s49 offen
s_add_u32 s65, s65, 40960
s_cmp_eq_u32 s65, 122880
s_cselect_b32 s65, 0, s65
s_add_u32 s64, s64, 1
s_waitcnt vmcnt(11)
s_barrier
s_cmp_lg_u32 s88, 3
s_cbranch_scc1 else_10
buffer_load_dwordx4 v[108:111], v18, s[36:39], s83 offen offset:0
buffer_load_dwordx4 v[108:111], v18, s[36:39], s83 offen offset:1024
global_load_dwordx4 v[108:111], v63, s[12:13] offset:-3072
global_load_dwordx4 v[108:111], v63, s[12:13] offset:-2048
global_load_dwordx4 v[108:111], v63, s[12:13] offset:-1024
global_load_dwordx4 v[108:111], v63, s[12:13] offset:0
global_load_dwordx4 v[108:111], v63, s[12:13] offset:1024
global_load_dwordx4 v[108:111], v63, s[12:13] offset:2048
buffer_store_dwordx4 v[56:59], v18, s[32:35], s86 offen offset:0 sc1
buffer_store_dwordx4 v[56:59], v18, s[32:35], s86 offen offset:1024 sc1
buffer_store_dwordx2 v[56:57], v39, s[32:35], s89 offen sc1
buffer_store_dwordx4 v[56:59], v55, s[32:35], 0 offen sc1
else_10:
s_add_u32 s69, s47, 2
s_and_b32 s69, s69, 3
s_add_u32 s69, s69, 0
s_mul_i32 s67, s69, 128
s_mul_i32 s68, s69, s54
s_add_u32 m0, s70, s65
s_nop 0
buffer_load_dwordx4 v20, s[24:27], s67 offen offset:0  lds
buffer_load_dwordx4 v21, s[24:27], s67 offen offset:1024  lds
buffer_load_dwordx4 v22, s[24:27], s67 offen offset:2048  lds
buffer_load_dwordx4 v23, s[24:27], s67 offen offset:3072  lds
s_add_u32 s60, s71, s65
s_add_u32 m0, s60, 0
s_mov_b32 s61, s68
buffer_load_dwordx4 v26, s[28:31], s61 offen lds
buffer_load_dwordx4 v27, s[28:31], s61 offen offset:1024 lds
s_add_u32 m0, s60, 8192
s_add_u32 s61, s61, s53
buffer_load_dwordx4 v26, s[28:31], s61 offen lds
buffer_load_dwordx4 v27, s[28:31], s61 offen offset:1024 lds
s_add_u32 m0, s60, 16384
s_add_u32 s61, s61, s53
buffer_load_dwordx4 v26, s[28:31], s61 offen lds
buffer_load_dwordx4 v27, s[28:31], s61 offen offset:1024 lds
s_add_u32 s49, s76, 2
s_and_b32 s49, s49, 3
s_add_u32 s49, s49, 8
s_mul_i32 s49, s49, 393216
buffer_load_dwordx4 v[40:43], v36, s[28:31], s49 offen
s_add_u32 s65, s65, 40960
s_cmp_eq_u32 s65, 122880
s_cselect_b32 s65, 0, s65
s_add_u32 s64, s64, 1
s_waitcnt vmcnt(11)
s_barrier
s_cmp_lg_u32 s88, 4
s_cbranch_scc1 else_12
buffer_load_dwordx4 v[108:111], v18, s[36:39], s83 offen offset:0
buffer_load_dwordx4 v[108:111], v18, s[36:39], s83 offen offset:1024
global_load_dwordx4 v[108:111], v63, s[12:13] offset:-3072
global_load_dwordx4 v[108:111], v63, s[12:13] offset:-2048
global_load_dwordx4 v[108:111], v63, s[12:13] offset:-1024
global_load_dwordx4 v[108:111], v63, s[12:13] offset:0
global_load_dwordx4 v[108:111], v63, s[12:13] offset:1024
global_load_dwordx4 v[108:111], v63, s[12:13] offset:2048
buffer_store_dwordx4 v[56:59], v18, s[32:35], s86 offen offset:0 sc1
buffer_store_dwordx4 v[56:59], v18, s[32:35], s86 offen offset:1024 sc1
buffer_store_dwordx2 v[56:57], v39, s[32:35], s89 offen sc1
buffer_store_dwordx4 v[56:59], v55, s[32:35], 0 offen sc1
else_12:
s_add_u32 s69, s47, 2
s_and_b32 s69, s69, 3
s_add_u32 s69, s69, 4
s_mul_i32 s67, s69, 128
s_mul_i32 s68, s69, s54
s_add_u32 m0, s70, s65
s_nop 0
buffer_load_dwordx4 v20, s[24:27], s67 offen offset:0  lds
buffer_load_dwordx4 v21, s[24:27], s67 offen offset:1024  lds
buffer_load_dwordx4 v22, s[24:27], s67 offen offset:2048  lds
buffer_load_dwordx4 v23, s[24:27], s67 offen offset:3072  lds
s_add_u32 s60, s71, s65
s_add_u32 m0, s60, 0
s_mov_b32 s61, s68
buffer_load_dwordx4 v26, s[28:31], s61 offen lds
buffer_load_dwordx4 v27, s[28:31], s61 offen offset:1024 lds
s_add_u32 m0, s60, 8192
s_add_u32 s61, s61, s53
buffer_load_dwordx4 v26, s[28:31], s61 offen lds
buffer_load_dwordx4 v27, s[28:31], s61 offen offset:1024 lds
s_add_u32 m0, s60, 16384
s_add_u32 s61, s61, s53
buffer_load_dwordx4 v26, s[28:31], s61 offen lds
buffer_load_dwordx4 v27, s[28:31], s61 offen offset:1024 lds
s_add_u32 s49, s76, 2
s_and_b32 s49, s49, 3
s_add_u32 s49, s49, 12
s_mul_i32 s49, s49, 393216
buffer_load_dwordx4 v[40:43], v36, s[28:31], s49 offen
s_add_u32 s65, s65, 40960
s_cmp_eq_u32 s65, 122880
s_cselect_b32 s65, 0, s65
s_add_u32 s64, s64, 1
s_waitcnt vmcnt(11)
s_barrier
s_cmp_lg_u32 s88, 5
s_cbranch_scc1 else_14
buffer_load_dwordx4 v[108:111], v18, s[36:39], s83 offen offset:0
buffer_load_dwordx4 v[108:111], v18, s[36:39], s83 offen offset:1024
global_load_dwordx4 v[108:111], v63, s[12:13] offset:-3072
global_load_dwordx4 v[108:111], v63, s[12:13] offset:-2048
global_load_dwordx4 v[108:111], v63, s[12:13] offset:-1024
global_load_dwordx4 v[108:111], v63, s[12:13] offset:0
global_load_dwordx4 v[108:111], v63, s[12:13] offset:1024
global_load_dwordx4 v[108:111], v63, s[12:13] offset:2048
buffer_store_dwordx4 v[56:59], v18, s[32:35], s86 offen offset:0 sc1
buffer_store_dwordx4 v[56:59], v18, s[32:35], s86 offen offset:1024 sc1
buffer_store_dwordx2 v[56:57], v39, s[32:35], s89 offen sc1
buffer_store_dwordx4 v[56:59], v55, s[32:35], 0 offen sc1
else_14:
s_add_u32 s69, s47, 2
s_and_b32 s69, s69, 3
s_add_u32 s69, s69, 8
s_mul_i32 s67, s69, 128
s_mul_i32 s68, s69, s54
s_add_u32 m0, s70, s65
s_nop 0
buffer_load_dwordx4 v20, s[24:27], s67 offen offset:0  lds
buffer_load_dwordx4 v21, s[24:27], s67 offen offset:1024  lds
buffer_load_dwordx4 v22, s[24:27], s67 offen offset:2048  lds
buffer_load_dwordx4 v23, s[24:27], s67 offen offset:3072  lds
s_add_u32 s60, s71, s65
s_add_u32 m0, s60, 0
s_mov_b32 s61, s68
buffer_load_dwordx4 v26, s[28:31], s61 offen lds
buffer_load_dwordx4 v27, s[28:31], s61 offen offset:1024 lds
s_add_u32 m0, s60, 8192
s_add_u32 s61, s61, s53
buffer_load_dwordx4 v26, s[28:31], s61 offen lds
buffer_load_dwordx4 v27, s[28:31], s61 offen offset:1024 lds
s_add_u32 m0, s60, 16384
s_add_u32 s61, s61, s53
buffer_load_dwordx4 v26, s[28:31], s61 offen lds
buffer_load_dwordx4 v27, s[28:31], s61 offen offset:1024 lds
s_add_u32 s49, s76, 3
s_and_b32 s49, s49, 3
s_add_u32 s49, s49, 0
s_mul_i32 s49, s49, 393216
buffer_load_dwordx4 v[40:43], v36, s[28:31], s49 offen
s_add_u32 s65, s65, 40960
s_cmp_eq_u32 s65, 122880
s_cselect_b32 s65, 0, s65
s_add_u32 s64, s64, 1
s_waitcnt vmcnt(11)
s_barrier
s_cmp_lg_u32 s88, 6
s_cbranch_scc1 else_16
buffer_load_dwordx4 v[108:111], v18, s[36:39], s83 offen offset:0
buffer_load_dwordx4 v[108:111], v18, s[36:39], s83 offen offset:1024
global_load_dwordx4 v[108:111], v63, s[12:13] offset:-3072
global_load_dwordx4 v[108:111], v63, s[12:13] offset:-2048
global_load_dwordx4 v[108:111], v63, s[12:13] offset:-1024
global_load_dwordx4 v[108:111], v63, s[12:13] offset:0
global_load_dwordx4 v[108:111], v63, s[12:13] offset:1024
global_load_dwordx4 v[108:111], v63, s[12:13] offset:2048
buffer_store_dwordx4 v[56:59], v18, s[32:35], s86 offen offset:0 sc1
buffer_store_dwordx4 v[56:59], v18, s[32:35], s86 offen offset:1024 sc1
buffer_store_dwordx2 v[56:57], v39, s[32:35], s89 offen sc1
buffer_store_dwordx4 v[56:59], v55, s[32:35], 0 offen sc1
else_16:
s_add_u32 s69, s47, 2
s_and_b32 s69, s69, 3
s_add_u32 s69, s69, 12
s_mul_i32 s67, s69, 128
s_mul_i32 s68, s69, s54
s_add_u32 m0, s70, s65
s_nop 0
buffer_load_dwordx4 v20, s[24:27], s67 offen offset:0  lds
buffer_load_dwordx4 v21, s[24:27], s67 offen offset:1024  lds
buffer_load_dwordx4 v22, s[24:27], s67 offen offset:2048  lds
buffer_load_dwordx4 v23, s[24:27], s67 offen offset:3072  lds
s_add_u32 s60, s71, s65
s_add_u32 m0, s60, 0
s_mov_b32 s61, s68
buffer_load_dwordx4 v26, s[28:31], s61 offen lds
buffer_load_dwordx4 v27, s[28:31], s61 offen offset:1024 lds
s_add_u32 m0, s60, 8192
s_add_u32 s61, s61, s53
buffer_load_dwordx4 v26, s[28:31], s61 offen lds
buffer_load_dwordx4 v27, s[28:31], s61 offen offset:1024 lds
s_add_u32 m0, s60, 16384
s_add_u32 s61, s61, s53
buffer_load_dwordx4 v26, s[28:31], s61 offen lds
buffer_load_dwordx4 v27, s[28:31], s61 offen offset:1024 lds
s_add_u32 s49, s76, 3
s_and_b32 s49, s49, 3
s_add_u32 s49, s49, 4
s_mul_i32 s49, s49, 393216
buffer_load_dwordx4 v[40:43], v36, s[28:31], s49 offen
s_add_u32 s65, s65, 40960
s_cmp_eq_u32 s65, 122880
s_cselect_b32 s65, 0, s65
s_add_u32 s64, s64, 1
s_waitcnt vmcnt(11)
s_barrier
s_cmp_lg_u32 s88, 7
s_cbranch_scc1 else_18
buffer_load_dwordx4 v[108:111], v18, s[36:39], s83 offen offset:0
buffer_load_dwordx4 v[108:111], v18, s[36:39], s83 offen offset:1024
global_load_dwordx4 v[108:111], v63, s[12:13] offset:-3072
global_load_dwordx4 v[108:111], v63, s[12:13] offset:-2048
global_load_dwordx4 v[108:111], v63, s[12:13] offset:-1024
global_load_dwordx4 v[108:111], v63, s[12:13] offset:0
global_load_dwordx4 v[108:111], v63, s[12:13] offset:1024
global_load_dwordx4 v[108:111], v63, s[12:13] offset:2048
buffer_store_dwordx4 v[56:59], v18, s[32:35], s86 offen offset:0 sc1
buffer_store_dwordx4 v[56:59], v18, s[32:35], s86 offen offset:1024 sc1
buffer_store_dwordx2 v[56:57], v39, s[32:35], s89 offen sc1
buffer_store_dwordx4 v[56:59], v55, s[32:35], 0 offen sc1
else_18:
s_add_u32 s69, s47, 3
s_and_b32 s69, s69, 3
s_add_u32 s69, s69, 0
s_mul_i32 s67, s69, 128
s_mul_i32 s68, s69, s54
s_add_u32 m0, s70, s65
s_nop 0
buffer_load_dwordx4 v20, s[24:27], s67 offen offset:0  lds
buffer_load_dwordx4 v21, s[24:27], s67 offen offset:1024  lds
buffer_load_dwordx4 v22, s[24:27], s67 offen offset:2048  lds
buffer_load_dwordx4 v23, s[24:27], s67 offen offset:3072  lds
s_add_u32 s60, s71, s65
s_add_u32 m0, s60, 0
s_mov_b32 s61, s68
buffer_load_dwordx4 v26, s[28:31], s61 offen lds
buffer_load_dwordx4 v27, s[28:31], s61 offen offset:1024 lds
s_add_u32 m0, s60, 8192
s_add_u32 s61, s61, s53
buffer_load_dwordx4 v26, s[28:31], s61 offen lds
buffer_load_dwordx4 v27, s[28:31], s61 offen offset:1024 lds
s_add_u32 m0, s60, 16384
s_add_u32 s61, s61, s53
buffer_load_dwordx4 v26, s[28:31], s61 offen lds
buffer_load_dwordx4 v27, s[28:31], s61 offen offset:1024 lds
s_add_u32 s49, s76, 3
s_and_b32 s49, s49, 3
s_add_u32 s49, s49, 8
s_mul_i32 s49, s49, 393216
buffer_load_dwordx4 v[40:43], v36, s[28:31], s49 offen
s_add_u32 s65, s65, 40960
s_cmp_eq_u32 s65, 122880
s_cselect_b32 s65, 0, s65
s_add_u32 s64, s64, 1
s_waitcnt vmcnt(11)
s_barrier
s_add_u32 s69, s47, 3
s_and_b32 s69, s69, 3
s_add_u32 s69, s69, 4
s_mul_i32 s67, s69, 128
s_mul_i32 s68, s69, s54
s_add_u32 m0, s70, s65
s_nop 0
buffer_load_dwordx4 v20, s[24:27], s67 offen offset:0  lds
buffer_load_dwordx4 v21, s[24:27], s67 offen offset:1024  lds
buffer_load_dwordx4 v22, s[24:27], s67 offen offset:2048  lds
buffer_load_dwordx4 v23, s[24:27], s67 offen offset:3072  lds
s_add_u32 s60, s71, s65
s_add_u32 m0, s60, 0
s_mov_b32 s61, s68
buffer_load_dwordx4 v26, s[28:31], s61 offen lds
buffer_load_dwordx4 v27, s[28:31], s61 offen offset:1024 lds
s_add_u32 m0, s60, 8192
s_add_u32 s61, s61, s53
buffer_load_dwordx4 v26, s[28:31], s61 offen lds
buffer_load_dwordx4 v27, s[28:31], s61 offen offset:1024 lds
s_add_u32 m0, s60, 16384
s_add_u32 s61, s61, s53
buffer_load_dwordx4 v26, s[28:31], s61 offen lds
buffer_load_dwordx4 v27, s[28:31], s61 offen offset:1024 lds
s_add_u32 s49, s76, 3
s_and_b32 s49, s49, 3
s_add_u32 s49, s49, 12
s_mul_i32 s49, s49, 393216
buffer_load_dwordx4 v[40:43], v36, s[28:31], s49 offen
s_add_u32 s65, s65, 40960
s_cmp_eq_u32 s65, 122880
s_cselect_b32 s65, 0, s65
s_add_u32 s64, s64, 1
s_waitcnt vmcnt(11)
s_barrier
global_load_dwordx2 v[34:35], v32, s[20:21] sc1
s_add_u32 s69, s47, 3
s_and_b32 s69, s69, 3
s_add_u32 s69, s69, 8
s_mul_i32 s67, s69, 128
s_mul_i32 s68, s69, s54
s_add_u32 m0, s70, s65
s_nop 0
buffer_load_dwordx4 v20, s[24:27], s67 offen offset:0  lds
buffer_load_dwordx4 v21, s[24:27], s67 offen offset:1024  lds
buffer_load_dwordx4 v22, s[24:27], s67 offen offset:2048  lds
buffer_load_dwordx4 v23, s[24:27], s67 offen offset:3072  lds
s_add_u32 s60, s71, s65
s_add_u32 m0, s60, 0
s_mov_b32 s61, s68
buffer_load_dwordx4 v26, s[28:31], s61 offen lds
buffer_load_dwordx4 v27, s[28:31], s61 offen offset:1024 lds
s_add_u32 m0, s60, 8192
s_add_u32 s61, s61, s53
buffer_load_dwordx4 v26, s[28:31], s61 offen lds
buffer_load_dwordx4 v27, s[28:31], s61 offen offset:1024 lds
s_add_u32 m0, s60, 16384
s_add_u32 s61, s61, s53
buffer_load_dwordx4 v26, s[28:31], s61 offen lds
buffer_load_dwordx4 v27, s[28:31], s61 offen offset:1024 lds
s_add_u32 s65, s65, 40960
s_cmp_eq_u32 s65, 122880
s_cselect_b32 s65, 0, s65
s_add_u32 s64, s64, 1
s_waitcnt vmcnt(10)
s_barrier
s_mov_b32 s63, 0
ipoll_20:
v_sad_u8 v4, v34, 0, 0
v_sad_u8 v4, v35, 0, v4
v_cmp_gt_u32 vcc, 32, v4
s_cbranch_vccz ipolled_21
global_load_dwordx2 v[34:35], v32, s[20:21] sc1
s_add_u32 s63, s63, 1
s_cmp_lt_u32 s63, 0x80000
s_waitcnt vmcnt(0)
s_cbranch_scc1 ipoll_20
ipolled_21:
s_add_u32 s69, s47, 3
s_and_b32 s69, s69, 3
s_add_u32 s69, s69, 12
s_mul_i32 s67, s69, 128
s_mul_i32 s68, s69, s54
s_add_u32 m0, s70, 0
s_nop 0
buffer_load_dwordx4 v20, s[24:27], s67 offen offset:0  lds
buffer_load_dwordx4 v21, s[24:27], s67 offen offset:1024  lds
buffer_load_dwordx4 v22, s[24:27], s67 offen offset:2048  lds
buffer_load_dwordx4 v23, s[24:27], s67 offen offset:3072  lds
s_add_u32 s60, s71, 0
s_add_u32 m0, s60, 0
s_mov_b32 s61, s68
buffer_load_dwordx4 v26, s[28:31], s61 offen lds
buffer_load_dwordx4 v27, s[28:31], s61 offen offset:1024 lds
s_add_u32 m0, s60, 8192
s_add_u32 s61, s61, s53
buffer_load_dwordx4 v26, s[28:31], s61 offen lds
buffer_load_dwordx4 v27, s[28:31], s61 offen offset:1024 lds
s_add_u32 m0, s60, 16384
s_add_u32 s61, s61, s53
buffer_load_dwordx4 v26, s[28:31], s61 offen lds
buffer_load_dwordx4 v27, s[28:31], s61 offen offset:1024 lds
s_waitcnt vmcnt(10)
s_barrier
s_setprio 0
buffer_load_dwordx4 v[240:243], v15, s[36:39], 0 offen offset:0
buffer_load_dwordx4 v[240:243], v15, s[36:39], 0 offen offset:1024
buffer_load_dwordx4 v[80:83], v37, s[32:35], 0 offen offset:0 sc1
buffer_load_dwordx4 v[84:87], v37, s[32:35], 0 offen offset:1024 sc1
buffer_load_dwordx4 v[88:91], v37, s[32:35], 0 offen offset:2048 sc1
buffer_load_dwordx4 v[92:95], v37, s[32:35], 0 offen offset:3072 sc1
global_load_dword v48, v54, s[98:99]
buffer_load_dwordx4 v[64:67], v38, s[32:35], 0 offen offset:0 sc1
buffer_load_dwordx4 v[68:71], v38, s[32:35], 0 offen offset:1024 sc1
buffer_load_dwordx4 v[72:75], v38, s[32:35], 0 offen offset:2048 sc1
buffer_load_dwordx4 v[76:79], v38, s[32:35], 0 offen offset:3072 sc1
s_add_u32 s48, s75, 15
s_and_b32 s48, s48, 15
s_mul_i32 s48, s48, s57
s_add_u32 m0, s71, 106496
s_nop 0
buffer_load_dwordx4 v28, s[36:39], s48 offen lds
buffer_load_dwordx4 v29, s[36:39], s48 offen offset:1024 lds
s_waitcnt vmcnt(13)
s_barrier
s_add_u32 s48, s75, 5
s_and_b32 s48, s48, 15
s_mul_i32 s48, s48, s57
s_add_u32 m0, s71, 24576
s_nop 0
buffer_load_dwordx4 v28, s[36:39], s48 offen lds
buffer_load_dwordx4 v29, s[36:39], s48 offen offset:1024 lds
s_waitcnt vmcnt(4)
s_add_u32 s48, s75, 6
s_and_b32 s48, s48, 15
s_mul_i32 s48, s48, s57
s_add_u32 m0, s71, 32768
s_nop 0
buffer_load_dwordx4 v28, s[36:39], s48 offen lds
v_add_f32 v80, v80, v88
v_add_f32 v64, v64, v72
v_add_f32 v81, v81, v89
v_add_f32 v65, v65, v73
v_add_f32 v82, v82, v90
v_add_f32 v66, v66, v74
v_add_f32 v83, v83, v91
v_add_f32 v67, v67, v75
v_add_f32 v84, v84, v92
v_add_f32 v68, v68, v76
buffer_load_dwordx4 v29, s[36:39], s48 offen offset:1024 lds
v_add_f32 v85, v85, v93
v_add_f32 v69, v69, v77
v_add_f32 v86, v86, v94
v_add_f32 v70, v70, v78
v_add_f32 v87, v87, v95
v_add_f32 v71, v71, v79
v_add_f32 v80, v80, v84
v_add_f32 v64, v64, v68
v_add_f32 v81, v81, v85
v_add_f32 v65, v65, v69
s_add_u32 s48, s75, 7
s_and_b32 s48, s48, 15
s_mul_i32 s48, s48, s57
s_add_u32 m0, s71, 40960
s_nop 0
buffer_load_dwordx4 v28, s[36:39], s48 offen lds
v_add_f32 v82, v82, v86
v_add_f32 v66, v66, v70
v_add_f32 v83, v83, v87
v_add_f32 v67, v67, v71
s_nop 1
s_nop 1
v_permlane32_swap_b32 v80, v81
v_permlane32_swap_b32 v64, v65
v_permlane32_swap_b32 v82, v83
buffer_load_dwordx4 v29, s[36:39], s48 offen offset:1024 lds
v_permlane32_swap_b32 v66, v67
v_add_f32 v80, v80, v81
v_add_f32 v64, v64, v65
v_add_f32 v82, v82, v83
v_add_f32 v66, v66, v67
s_nop 1
s_nop 1
v_permlane16_swap_b32 v80, v82
v_permlane16_swap_b32 v64, v66
s_nop 0
s_add_u32 s48, s75, 8
s_and_b32 s48, s48, 15
s_mul_i32 s48, s48, s57
s_add_u32 m0, s71, 49152
s_nop 0
buffer_load_dwordx4 v28, s[36:39], s48 offen lds
s_nop 0
v_add_f32 v80, v80, v82
v_add_f32 v64, v64, v66
v_cmp_u_f32 vcc, v80, v80
s_cbranch_vccnz again_22
summed_23:
v_cmp_u_f32 vcc, v64, v64
s_cbranch_vccnz again_25
summed_26:
v_mul_f32 v44, 0x3a800000, v80
ds_write_b32 v53, v64
v_mov_b32 v45, v44
s_nop 1
v_permlane16_swap_b32 v44, v45
buffer_load_dwordx4 v29, s[36:39], s48 offen offset:1024 lds
s_nop 0
v_fma_f32 v45, -v44, v44, v45
v_max_f32 v45, 0, v45
v_add_f32 v45, 0x3727c5ac, v45
v_rsq_f32 v46, v45
v_sub_f32 v47, 0, v44
ds_write_b32 v50, v47 offset:512
ds_write_b64 v49, v[46:47]
ds_write_b32 v50, v46
s_cmp_lg_u32 s43, 2
s_cbranch_scc1 else_28
s_and_b32 s50, s2, 7
v_readlane_b32 s58, v34, s50
v_readlane_b32 s59, v35, s50
s_lshl_b64 s[48:49], s[94:95], 5
v_mov_b32 v4, 134656
s_nop 1
s_cmp_eq_u64 s[48:49], s[58:59]
s_cselect_b32 s48, 1, 0
v_mov_b32 v5, s48
ds_write_b32 v4, v5
else_28:
s_setprio 0
s_waitcnt lgkmcnt(0)
s_waitcnt vmcnt(63)
s_barrier
s_waitcnt vmcnt(5)
s_add_u32 s48, s75, 9
s_and_b32 s48, s48, 15
s_mul_i32 s48, s48, s57
s_add_u32 m0, s71, 57344
s_nop 0
buffer_load_dwordx4 v28, s[36:39], s48 offen lds
buffer_load_dwordx4 v29, s[36:39], s48 offen offset:1024 lds
s_waitcnt vmcnt(5)
s_add_u32 s48, s75, 10
s_and_b32 s48, s48, 15
s_mul_i32 s48, s48, s57
s_add_u32 m0, s71, 65536
s_nop 0
buffer_load_dwordx4 v28, s[36:39], s48 offen lds
buffer_load_dwordx4 v29, s[36:39], s48 offen offset:1024 lds
s_waitcnt vmcnt(5)
s_add_u32 s48, s75, 11
s_and_b32 s48, s48, 15
s_mul_i32 s48, s48, s57
s_add_u32 m0, s71, 73728
s_nop 0
buffer_load_dwordx4 v28, s[36:39], s48 offen lds
buffer_load_dwordx4 v29, s[36:39], s48 offen offset:1024 lds
s_waitcnt vmcnt(5)
s_add_u32 s48, s75, 12
s_and_b32 s48, s48, 15
s_mul_i32 s48, s48, s57
s_add_u32 m0, s71, 81920
s_nop 0
buffer_load_dwordx4 v28, s[36:39], s48 offen lds
buffer_load_dwordx4 v29, s[36:39], s48 offen offset:1024 lds
s_waitcnt vmcnt(5)
s_add_u32 s48, s75, 13
s_and_b32 s48, s48, 15
s_mul_i32 s48, s48, s57
s_add_u32 m0, s71, 90112
s_nop 0
buffer_load_dwordx4 v28, s[36:39], s48 offen lds
buffer_load_dwordx4 v29, s[36:39], s48 offen offset:1024 lds
s_waitcnt vmcnt(5)
s_add_u32 s48, s75, 14
s_and_b32 s48, s48, 15
s_mul_i32 s48, s48, s57
s_add_u32 m0, s71, 98304
s_nop 0
buffer_load_dwordx4 v28, s[36:39], s48 offen lds
buffer_load_dwordx4 v29, s[36:39], s48 offen offset:1024 lds
s_waitcnt vmcnt(5)
s_add_u32 s48, s75, 0
s_and_b32 s48, s48, 15
s_mul_i32 s48, s48, s57
s_add_u32 m0, s71, 4294950912
s_nop 0
buffer_load_dwordx4 v28, s[36:39], s48 offen lds
buffer_load_dwordx4 v29, s[36:39], s48 offen offset:1024 lds
s_waitcnt vmcnt(5)
s_add_u32 s48, s75, 1
s_and_b32 s48, s48, 15
s_mul_i32 s48, s48, s57
s_add_u32 m0, s71, 4294959104
s_nop 0
buffer_load_dwordx4 v28, s[36:39], s48 offen lds
buffer_load_dwordx4 v29, s[36:39], s48 offen offset:1024 lds
s_waitcnt vmcnt(5)
s_add_u32 s48, s75, 2
s_and_b32 s48, s48, 15
s_mul_i32 s48, s48, s57
s_add_u32 m0, s71, 0
s_nop 0
buffer_load_dwordx4 v28, s[36:39], s48 offen lds
buffer_load_dwordx4 v29, s[36:39], s48 offen offset:1024 lds
s_waitcnt vmcnt(5)
s_add_u32 s48, s75, 3
s_and_b32 s48, s48, 15
s_mul_i32 s48, s48, s57
s_add_u32 m0, s71, 8192
s_nop 0
buffer_load_dwordx4 v28, s[36:39], s48 offen lds
buffer_load_dwordx4 v29, s[36:39], s48 offen offset:1024 lds
s_waitcnt vmcnt(5)
s_add_u32 s48, s75, 4
s_and_b32 s48, s48, 15
s_mul_i32 s48, s48, s57
s_add_u32 m0, s71, 16384
s_nop 0
buffer_load_dwordx4 v28, s[36:39], s48 offen lds
buffer_load_dwordx4 v29, s[36:39], s48 offen offset:1024 lds
s_mov_b32 s28, s12
s_and_b32 s29, s13, 0xffff
s_mov_b32 s30, 6291456
s_mov_b32 s31, 0x00020000
v_mov_b32 v26, v60
v_mov_b32 v27, v61
v_mov_b32 v28, v24
v_mov_b32 v29, v25
s_cmp_ge_i32 s55, 0
s_cselect_b32 s53, 128, s53
s_cselect_b32 s54, 24576, s54
s_cmp_ge_i32 s56, 0
s_cselect_b32 s57, 8192, s57
s_and_b32 s48, s2, 7
s_add_u32 s47, s42, s48
s_and_b32 s47, s47, 7
s_mul_i32 s47, s47, 2
s_and_b32 s50, s42, 8
s_or_b32 s50, s50, 3
s_and_b32 s48, s2, 7
s_add_u32 s76, s50, s48
s_and_b32 s76, s76, 7
s_mul_i32 s76, s76, 2
s_add_u32 s69, s47, 0
s_and_b32 s69, s69, 15
s_mul_i32 s67, s69, 128
s_mul_i32 s68, s69, s54
s_waitcnt vmcnt(0) lgkmcnt(0)
s_barrier
s_add_u32 s60, s71, 122880
s_add_u32 m0, s60, 0
s_mov_b32 s61, s68
buffer_load_dwordx4 v26, s[28:31], s61 offen lds
buffer_load_dwordx4 v27, s[28:31], s61 offen offset:1024 lds
s_add_u32 m0, s60, 8192
s_add_u32 s61, s61, s53
buffer_load_dwordx4 v26, s[28:31], s61 offen lds
buffer_load_dwordx4 v27, s[28:31], s61 offen offset:1024 lds
s_add_u32 m0, s60, 16384
s_add_u32 s61, s61, s53
buffer_load_dwordx4 v26, s[28:31], s61 offen lds
buffer_load_dwordx4 v27, s[28:31], s61 offen offset:1024 lds
s_mov_b32 s36, s14
s_and_b32 s37, s15, 0xffff
s_mov_b32 s38, 65536
s_mov_b32 s39, 0x00020000
s_lshl_b32 s48, s42, 12
s_lshl_b32 s49, s43, 10
s_add_u32 s48, s48, s49
s_add_u32 m0, s49, 135168
s_nop 0
buffer_load_dwordx4 v18, s[36:39], s48 offen lds
ds_read_b128 v[232:235], v52 offset:57344
ds_read_b128 v[236:239], v52 offset:58368
ds_read_b128 v[152:155], v51 offset:40960
ds_read_b128 v[156:159], v51 offset:41984
ds_read_b128 v[160:163], v51 offset:49152
ds_read_b128 v[164:167], v51 offset:50176
ds_read_b128 v[168:171], v51 offset:57344
ds_read_b128 v[172:175], v51 offset:58368
ds_read_b128 v[176:179], v52 offset:0
ds_read_b128 v[180:183], v52 offset:1024
ds_read_b128 v[184:187], v52 offset:8192
ds_read_b128 v[188:191], v52 offset:9216
ds_read_b128 v[192:195], v52 offset:16384
ds_read_b128 v[196:199], v52 offset:17408
ds_read_b128 v[200:203], v52 offset:24576
ds_read_b128 v[204:207], v52 offset:25600
ds_read_b128 v[208:211], v52 offset:32768
ds_read_b128 v[212:215], v52 offset:33792
ds_read_b128 v[216:219], v52 offset:40960
ds_read_b128 v[220:223], v52 offset:41984
ds_read_b128 v[224:227], v52 offset:49152
ds_read_b128 v[228:231], v52 offset:50176
ds_read_b128 v[112:115], v51 offset:0
ds_read_b128 v[116:119], v51 offset:1024
ds_read_b128 v[120:123], v51 offset:8192
ds_read_b128 v[124:127], v51 offset:9216
ds_read_b128 v[128:131], v51 offset:16384
ds_read_b128 v[132:135], v51 offset:17408
ds_read_b128 v[136:139], v51 offset:24576
ds_read_b128 v[140:143], v51 offset:25600
ds_read_b128 v[144:147], v51 offset:32768
ds_read_b128 v[148:151], v51 offset:33792
s_add_u32 s48, s80, 0
v_add_u32 v20, s48, v18
v_mov_b32 v21, v20
v_add_u32 v22, 30720, v20
v_mov_b32 v23, v22
v_add_u32 v37, 262144, v37
s_lshl_b32 s50, s42, 2
s_add_u32 s50, s50, s43
s_lshl_b32 s50, s50, 12
s_add_u32 s50, s50, 18087936
v_add_u32 v38, s50, v18
v_min_u32 v4, 2, v3
v_lshlrev_b32 v4, 8, v4
v_lshl_add_u32 v4, v2, 2, v4
s_and_b32 s48, s43, 1
s_lshl_b32 s48, s48, 7
s_lshr_b32 s49, s43, 1
s_lshl_b32 s49, s49, 6
s_add_u32 s48, s48, s49
s_add_u32 s48, s48, 133888
v_add_u32 v53, s48, v4
s_getpc_b64 s[98:99]
pc_30:
s_add_u32 s98, s98, c1_last - pc_30
s_addc_u32 s99, s99, 0
s_lshr_b32 s50, s2, 3
s_lshl_b32 s50, s50, 2
s_add_u32 s50, s50, s43
s_lshl_b32 s50, s50, 7
v_and_b32 v4, 1, v0
v_lshl_add_u32 v4, v4, 6, s50
v_min_u32 v54, L_code_end - c1_last, v4
s_waitcnt vmcnt(0) lgkmcnt(0)
s_add_u32 s69, s47, 1
s_and_b32 s69, s69, 15
s_mul_i32 s67, s69, 2048
s_mul_i32 s68, s69, s54
s_barrier
s_add_u32 s60, s71, 40960
s_add_u32 m0, s60, 0
s_mov_b32 s61, s68
buffer_load_dwordx4 v26, s[28:31], s61 offen lds
buffer_load_dwordx4 v27, s[28:31], s61 offen offset:1024 lds
s_add_u32 m0, s60, 8192
s_add_u32 s61, s61, s53
buffer_load_dwordx4 v26, s[28:31], s61 offen lds
buffer_load_dwordx4 v27, s[28:31], s61 offen offset:1024 lds
s_add_u32 m0, s60, 16384
s_add_u32 s61, s61, s53
buffer_load_dwordx4 v26, s[28:31], s61 offen lds
buffer_load_dwordx4 v27, s[28:31], s61 offen offset:1024 lds
s_add_u32 s49, s76, 2
s_and_b32 s49, s49, 15
s_mul_i32 s49, s49, 393216
buffer_load_dwordx4 v[40:43], v36, s[28:31], s49 offen
s_add_u32 s49, s76, 3
s_and_b32 s49, s49, 15
s_mul_i32 s49, s49, 393216
buffer_load_dwordx4 v[40:43], v36, s[28:31], s49 offen
buffer_load_dword v5, v30, s[32:35], s79 offen sc1
s_add_u32 s69, s47, 0
s_and_b32 s69, s69, 15
s_mul_i32 s67, s69, 2048
s_mul_i32 s68, s69, s54
s_add_u32 m0, s70, 0
s_nop 0
s_mov_b32 s63, 0
s_waitcnt vmcnt(0)
poll_31:
v_cmp_gt_u32 vcc, 1, v5
s_cbranch_vccz polled_32
buffer_load_dword v5, v30, s[32:35], s79 offen sc1
s_add_u32 s63, s63, 1
s_cmp_lt_u32 s63, 0x80000
s_waitcnt vmcnt(0)
s_cbranch_scc1 poll_31
polled_32:
buffer_load_dwordx4 v20, s[32:35], s67 offen offset:0 sc1 lds
buffer_load_dwordx4 v21, s[32:35], s67 offen offset:1024 sc1 lds
buffer_load_dwordx4 v22, s[32:35], s67 offen offset:2048 sc1 lds
buffer_load_dwordx4 v23, s[32:35], s67 offen offset:3072 sc1 lds
s_add_u32 s69, s47, 1
s_and_b32 s69, s69, 15
s_mul_i32 s67, s69, 2048
s_mul_i32 s68, s69, s54
s_add_u32 m0, s70, 40960
s_nop 0
buffer_load_dwordx4 v20, s[32:35], s67 offen offset:0 sc1 lds
buffer_load_dwordx4 v21, s[32:35], s67 offen offset:1024 sc1 lds
buffer_load_dwordx4 v22, s[32:35], s67 offen offset:2048 sc1 lds
buffer_load_dwordx4 v23, s[32:35], s67 offen offset:3072 sc1 lds
s_waitcnt vmcnt(4) lgkmcnt(0)
s_barrier
s_add_u32 s69, s47, 2
s_and_b32 s69, s69, 15
s_mul_i32 s67, s69, 2048
s_mul_i32 s68, s69, s54
s_add_u32 m0, s70, 81920
s_nop 0
buffer_load_dwordx4 v20, s[32:35], s67 offen offset:0 sc1 lds
buffer_load_dwordx4 v21, s[32:35], s67 offen offset:1024 sc1 lds
buffer_load_dwordx4 v22, s[32:35], s67 offen offset:2048 sc1 lds
buffer_load_dwordx4 v23, s[32:35], s67 offen offset:3072 sc1 lds
s_add_u32 s60, s71, 81920
s_add_u32 m0, s60, 0
s_mov_b32 s61, s68
buffer_load_dwordx4 v26, s[28:31], s61 offen lds
buffer_load_dwordx4 v27, s[28:31], s61 offen offset:1024 lds
s_add_u32 m0, s60, 8192
s_add_u32 s61, s61, s53
buffer_load_dwordx4 v26, s[28:31], s61 offen lds
buffer_load_dwordx4 v27, s[28:31], s61 offen offset:1024 lds
s_add_u32 m0, s60, 16384
s_add_u32 s61, s61, s53
buffer_load_dwordx4 v26, s[28:31], s61 offen lds
buffer_load_dwordx4 v27, s[28:31], s61 offen offset:1024 lds
s_add_u32 s49, s76, 4
s_and_b32 s49, s49, 15
s_mul_i32 s49, s49, 393216
buffer_load_dwordx4 v[40:43], v36, s[28:31], s49 offen
s_mov_b32 s64, 0
s_mov_b32 s65, 0
h1_loop:
s_waitcnt vmcnt(11)
s_barrier
s_add_u32 s69, s69, 1
s_and_b32 s69, s69, 15
s_mul_i32 s67, s69, 2048
s_mul_i32 s68, s69, s54
s_add_u32 m0, s70, s65
s_nop 0
buffer_load_dwordx4 v20, s[32:35], s67 offen offset:0 sc1 lds
buffer_load_dwordx4 v21, s[32:35], s67 offen offset:1024 sc1 lds
buffer_load_dwordx4 v22, s[32:35], s67 offen offset:2048 sc1 lds
buffer_load_dwordx4 v23, s[32:35], s67 offen offset:3072 sc1 lds
s_add_u32 s60, s71, s65
s_add_u32 m0, s60, 0
s_mov_b32 s61, s68
buffer_load_dwordx4 v26, s[28:31], s61 offen lds
buffer_load_dwordx4 v27, s[28:31], s61 offen offset:1024 lds
s_add_u32 m0, s60, 8192
s_add_u32 s61, s61, s53
buffer_load_dwordx4 v26, s[28:31], s61 offen lds
buffer_load_dwordx4 v27, s[28:31], s61 offen offset:1024 lds
s_add_u32 m0, s60, 16384
s_add_u32 s61, s61, s53
buffer_load_dwordx4 v26, s[28:31], s61 offen lds
buffer_load_dwordx4 v27, s[28:31], s61 offen offset:1024 lds
s_add_u32 s48, s64, 5
s_min_u32 s48, s48, 15
s_add_u32 s49, s48, s76
s_and_b32 s49, s49, 15
s_mul_i32 s49, s49, 393216
buffer_load_dwordx4 v[40:43], v36, s[28:31], s49 offen
s_add_u32 s65, s65, 40960
s_cmp_eq_u32 s65, 122880
s_cselect_b32 s65, 0, s65
s_add_u32 s64, s64, 1
s_cmp_lt_u32 s64, 11
s_cbranch_scc1 h1_loop
s_waitcnt vmcnt(11)
s_barrier
s_add_u32 s69, s47, 14
s_and_b32 s69, s69, 15
s_mul_i32 s67, s69, 2048
s_mul_i32 s68, s69, s54
s_add_u32 m0, s70, s65
s_nop 0
buffer_load_dwordx4 v20, s[32:35], s67 offen offset:0 sc1 lds
buffer_load_dwordx4 v21, s[32:35], s67 offen offset:1024 sc1 lds
buffer_load_dwordx4 v22, s[32:35], s67 offen offset:2048 sc1 lds
buffer_load_dwordx4 v23, s[32:35], s67 offen offset:3072 sc1 lds
s_add_u32 s60, s71, s65
s_add_u32 m0, s60, 0
s_mov_b32 s61, s68
buffer_load_dwordx4 v26, s[28:31], s61 offen lds
buffer_load_dwordx4 v27, s[28:31], s61 offen offset:1024 lds
s_add_u32 m0, s60, 8192
s_add_u32 s61, s61, s53
buffer_load_dwordx4 v26, s[28:31], s61 offen lds
buffer_load_dwordx4 v27, s[28:31], s61 offen offset:1024 lds
s_add_u32 m0, s60, 16384
s_add_u32 s61, s61, s53
buffer_load_dwordx4 v26, s[28:31], s61 offen lds
buffer_load_dwordx4 v27, s[28:31], s61 offen offset:1024 lds
s_add_u32 s65, s65, 40960
s_cmp_eq_u32 s65, 122880
s_cselect_b32 s65, 0, s65
s_add_u32 s64, s64, 1
s_mov_b32 s36, s16
s_and_b32 s37, s17, 0xffff
s_mov_b32 s38, 2097152
s_mov_b32 s39, 0x00020000
s_waitcnt vmcnt(10)
s_barrier
s_add_u32 s69, s47, 15
s_and_b32 s69, s69, 15
s_mul_i32 s67, s69, 2048
s_mul_i32 s68, s69, s54
s_add_u32 m0, s70, 0
s_nop 0
buffer_load_dwordx4 v20, s[32:35], s67 offen offset:0 sc1 lds
buffer_load_dwordx4 v21, s[32:35], s67 offen offset:1024 sc1 lds
buffer_load_dwordx4 v22, s[32:35], s67 offen offset:2048 sc1 lds
buffer_load_dwordx4 v23, s[32:35], s67 offen offset:3072 sc1 lds
s_add_u32 s60, s71, 0
s_add_u32 m0, s60, 0
s_mov_b32 s61, s68
buffer_load_dwordx4 v26, s[28:31], s61 offen lds
buffer_load_dwordx4 v27, s[28:31], s61 offen offset:1024 lds
s_add_u32 m0, s60, 8192
s_add_u32 s61, s61, s53
buffer_load_dwordx4 v26, s[28:31], s61 offen lds
buffer_load_dwordx4 v27, s[28:31], s61 offen offset:1024 lds
s_add_u32 m0, s60, 16384
s_add_u32 s61, s61, s53
buffer_load_dwordx4 v26, s[28:31], s61 offen lds
buffer_load_dwordx4 v27, s[28:31], s61 offen offset:1024 lds
s_waitcnt vmcnt(10)
s_barrier
s_setprio 0
buffer_load_dwordx4 v[240:243], v15, s[36:39], 0 offen offset:0
buffer_load_dwordx4 v[240:243], v15, s[36:39], 0 offen offset:1024
buffer_load_dwordx4 v[80:83], v37, s[32:35], 0 offen offset:0 sc1
buffer_load_dwordx4 v[84:87], v37, s[32:35], 0 offen offset:1024 sc1
buffer_load_dwordx4 v[88:91], v37, s[32:35], 0 offen offset:2048 sc1
buffer_load_dwordx4 v[92:95], v37, s[32:35], 0 offen offset:3072 sc1
global_load_dword v48, v54, s[98:99]
buffer_load_dwordx4 v[64:67], v38, s[32:35], 0 offen offset:0 sc1
buffer_load_dwordx4 v[68:71], v38, s[32:35], 0 offen offset:1024 sc1
buffer_load_dwordx4 v[72:75], v38, s[32:35], 0 offen offset:2048 sc1
buffer_load_dwordx4 v[76:79], v38, s[32:35], 0 offen offset:3072 sc1
s_add_u32 s48, s75, 15
s_and_b32 s48, s48, 15
s_mul_i32 s48, s48, s57
s_add_u32 m0, s71, 106496
s_nop 0
buffer_load_dwordx4 v28, s[36:39], s48 offen lds
buffer_load_dwordx4 v29, s[36:39], s48 offen offset:1024 lds
s_waitcnt vmcnt(13)
s_barrier
s_add_u32 s48, s75, 5
s_and_b32 s48, s48, 15
s_mul_i32 s48, s48, s57
s_add_u32 m0, s71, 24576
s_nop 0
buffer_load_dwordx4 v28, s[36:39], s48 offen lds
buffer_load_dwordx4 v29, s[36:39], s48 offen offset:1024 lds
s_waitcnt vmcnt(4)
s_add_u32 s48, s75, 6
s_and_b32 s48, s48, 15
s_mul_i32 s48, s48, s57
s_add_u32 m0, s71, 32768
s_nop 0
buffer_load_dwordx4 v28, s[36:39], s48 offen lds
v_add_f32 v80, v80, v88
v_add_f32 v64, v64, v72
v_add_f32 v81, v81, v89
v_add_f32 v65, v65, v73
v_add_f32 v82, v82, v90
v_add_f32 v66, v66, v74
v_add_f32 v83, v83, v91
v_add_f32 v67, v67, v75
v_add_f32 v84, v84, v92
v_add_f32 v68, v68, v76
buffer_load_dwordx4 v29, s[36:39], s48 offen offset:1024 lds
v_add_f32 v85, v85, v93
v_add_f32 v69, v69, v77
v_add_f32 v86, v86, v94
v_add_f32 v70, v70, v78
v_add_f32 v87, v87, v95
v_add_f32 v71, v71, v79
v_add_f32 v80, v80, v84
v_add_f32 v64, v64, v68
v_add_f32 v81, v81, v85
v_add_f32 v65, v65, v69
s_add_u32 s48, s75, 7
s_and_b32 s48, s48, 15
s_mul_i32 s48, s48, s57
s_add_u32 m0, s71, 40960
s_nop 0
buffer_load_dwordx4 v28, s[36:39], s48 offen lds
v_add_f32 v82, v82, v86
v_add_f32 v66, v66, v70
v_add_f32 v83, v83, v87
v_add_f32 v67, v67, v71
s_nop 1
s_nop 1
v_permlane32_swap_b32 v80, v81
v_permlane32_swap_b32 v64, v65
v_permlane32_swap_b32 v82, v83
buffer_load_dwordx4 v29, s[36:39], s48 offen offset:1024 lds
v_permlane32_swap_b32 v66, v67
v_add_f32 v80, v80, v81
v_add_f32 v64, v64, v65
v_add_f32 v82, v82, v83
v_add_f32 v66, v66, v67
s_nop 1
s_nop 1
v_permlane16_swap_b32 v80, v82
v_permlane16_swap_b32 v64, v66
s_nop 0
s_add_u32 s48, s75, 8
s_and_b32 s48, s48, 15
s_mul_i32 s48, s48, s57
s_add_u32 m0, s71, 49152
s_nop 0
buffer_load_dwordx4 v28, s[36:39], s48 offen lds
s_nop 0
v_add_f32 v80, v80, v82
v_add_f32 v64, v64, v66
v_cmp_u_f32 vcc, v80, v80
s_cbranch_vccnz again_33
summed_34:
v_cmp_u_f32 vcc, v64, v64
s_cbranch_vccnz again_36
summed_37:
v_mul_f32 v44, 0x3a800000, v80
ds_write_b32 v53, v64
v_mov_b32 v45, v44
s_nop 1
v_permlane16_swap_b32 v44, v45
buffer_load_dwordx4 v29, s[36:39], s48 offen offset:1024 lds
s_nop 0
v_fma_f32 v45, -v44, v44, v45
v_max_f32 v45, 0, v45
v_add_f32 v45, 0x3727c5ac, v45
v_rsq_f32 v46, v45
v_sub_f32 v47, 0, v44
ds_write_b32 v50, v47 offset:512
ds_write_b64 v49, v[46:47]
ds_write_b32 v50, v46
s_setprio 0
s_waitcnt lgkmcnt(0)
s_waitcnt vmcnt(63)
s_barrier
s_waitcnt vmcnt(5)
s_add_u32 s48, s75, 9
s_and_b32 s48, s48, 15
s_mul_i32 s48, s48, s57
s_add_u32 m0, s71, 57344
s_nop 0
buffer_load_dwordx4 v28, s[36:39], s48 offen lds
buffer_load_dwordx4 v29, s[36:39], s48 offen offset:1024 lds
s_waitcnt vmcnt(5)
s_add_u32 s48, s75, 10
s_and_b32 s48, s48, 15
s_mul_i32 s48, s48, s57
s_add_u32 m0, s71, 65536
s_nop 0
buffer_load_dwordx4 v28, s[36:39], s48 offen lds
buffer_load_dwordx4 v29, s[36:39], s48 offen offset:1024 lds
s_waitcnt vmcnt(5)
s_add_u32 s48, s75, 11
s_and_b32 s48, s48, 15
s_mul_i32 s48, s48, s57
s_add_u32 m0, s71, 73728
s_nop 0
buffer_load_dwordx4 v28, s[36:39], s48 offen lds
buffer_load_dwordx4 v29, s[36:39], s48 offen offset:1024 lds
s_waitcnt vmcnt(5)
s_add_u32 s48, s75, 12
s_and_b32 s48, s48, 15
s_mul_i32 s48, s48, s57
s_add_u32 m0, s71, 81920
s_nop 0
buffer_load_dwordx4 v28, s[36:39], s48 offen lds
buffer_load_dwordx4 v29, s[36:39], s48 offen offset:1024 lds
s_waitcnt vmcnt(5)
s_add_u32 s48, s75, 13
s_and_b32 s48, s48, 15
s_mul_i32 s48, s48, s57
s_add_u32 m0, s71, 90112
s_nop 0
buffer_load_dwordx4 v28, s[36:39], s48 offen lds
buffer_load_dwordx4 v29, s[36:39], s48 offen offset:1024 lds
s_waitcnt vmcnt(5)
s_add_u32 s48, s75, 14
s_and_b32 s48, s48, 15
s_mul_i32 s48, s48, s57
s_add_u32 m0, s71, 98304
s_nop 0
buffer_load_dwordx4 v28, s[36:39], s48 offen lds
buffer_load_dwordx4 v29, s[36:39], s48 offen offset:1024 lds
s_waitcnt vmcnt(5)
s_add_u32 s48, s75, 0
s_and_b32 s48, s48, 15
s_mul_i32 s48, s48, s57
s_add_u32 m0, s71, 4294950912
s_nop 0
buffer_load_dwordx4 v28, s[36:39], s48 offen lds
buffer_load_dwordx4 v29, s[36:39], s48 offen offset:1024 lds
s_waitcnt vmcnt(5)
s_add_u32 s48, s75, 1
s_and_b32 s48, s48, 15
s_mul_i32 s48, s48, s57
s_add_u32 m0, s71, 4294959104
s_nop 0
buffer_load_dwordx4 v28, s[36:39], s48 offen lds
buffer_load_dwordx4 v29, s[36:39], s48 offen offset:1024 lds
s_waitcnt vmcnt(5)
s_add_u32 s48, s75, 2
s_and_b32 s48, s48, 15
s_mul_i32 s48, s48, s57
s_add_u32 m0, s71, 0
s_nop 0
buffer_load_dwordx4 v28, s[36:39], s48 offen lds
buffer_load_dwordx4 v29, s[36:39], s48 offen offset:1024 lds
s_waitcnt vmcnt(5)
s_add_u32 s48, s75, 3
s_and_b32 s48, s48, 15
s_mul_i32 s48, s48, s57
s_add_u32 m0, s71, 8192
s_nop 0
buffer_load_dwordx4 v28, s[36:39], s48 offen lds
buffer_load_dwordx4 v29, s[36:39], s48 offen offset:1024 lds
s_waitcnt vmcnt(5)
s_add_u32 s48, s75, 4
s_and_b32 s48, s48, 15
s_mul_i32 s48, s48, s57
s_add_u32 m0, s71, 16384
s_nop 0
buffer_load_dwordx4 v28, s[36:39], s48 offen lds
buffer_load_dwordx4 v29, s[36:39], s48 offen offset:1024 lds
s_waitcnt vmcnt(5)
buffer_load_dwordx4 v[240:243], v18, s[32:35], s81 offen offset:0 sc1
buffer_load_dwordx4 v[240:243], v18, s[32:35], s81 offen offset:1024 sc1
s_waitcnt vmcnt(5)
buffer_load_dwordx4 v[240:243], v18, s[32:35], s82 offen offset:0 sc1
buffer_load_dwordx4 v[240:243], v18, s[32:35], s82 offen offset:1024 sc1
s_mov_b32 s28, s6
s_and_b32 s29, s7, 0xffff
s_mov_b32 s30, 6291456
s_mov_b32 s31, 0x00020000
s_and_b32 s48, s2, 7
s_lshl_b32 s48, s48, 1
s_add_u32 s47, s42, s48
s_and_b32 s47, s47, 15
s_and_b32 s50, s42, 8
s_or_b32 s50, s50, 3
s_and_b32 s48, s2, 7
s_lshl_b32 s48, s48, 1
s_add_u32 s76, s50, s48
s_and_b32 s76, s76, 15
s_add_u32 s69, s47, 0
s_and_b32 s69, s69, 15
s_mul_i32 s67, s69, 2048
s_mul_i32 s68, s69, s54
s_waitcnt vmcnt(0) lgkmcnt(0)
s_barrier
s_add_u32 s60, s71, 122880
s_add_u32 m0, s60, 0
s_mov_b32 s61, s68
buffer_load_dwordx4 v26, s[28:31], s61 offen lds
buffer_load_dwordx4 v27, s[28:31], s61 offen offset:1024 lds
s_add_u32 m0, s60, 8192
s_add_u32 s61, s61, s53
buffer_load_dwordx4 v26, s[28:31], s61 offen lds
buffer_load_dwordx4 v27, s[28:31], s61 offen offset:1024 lds
s_add_u32 m0, s60, 16384
s_add_u32 s61, s61, s53
buffer_load_dwordx4 v26, s[28:31], s61 offen lds
buffer_load_dwordx4 v27, s[28:31], s61 offen offset:1024 lds
v_add_u32 v37, 262144, v37
s_getpc_b64 s[98:99]
pc_39:
s_add_u32 s98, s98, c2_last - pc_39
s_addc_u32 s99, s99, 0
s_lshr_b32 s50, s2, 3
s_lshl_b32 s50, s50, 2
s_add_u32 s50, s50, s43
s_lshl_b32 s50, s50, 7
v_and_b32 v4, 1, v0
v_lshl_add_u32 v4, v4, 6, s50
v_min_u32 v54, L_code_end - c2_last, v4
s_waitcnt vmcnt(0) lgkmcnt(0)
s_add_u32 s69, s47, 1
s_and_b32 s69, s69, 15
s_mul_i32 s67, s69, 2048
s_mul_i32 s68, s69, s54
s_barrier
s_add_u32 s60, s71, 40960
s_add_u32 m0, s60, 0
s_mov_b32 s61, s68
buffer_load_dwordx4 v26, s[28:31], s61 offen lds
buffer_load_dwordx4 v27, s[28:31], s61 offen offset:1024 lds
s_add_u32 m0, s60, 8192
s_add_u32 s61, s61, s53
buffer_load_dwordx4 v26, s[28:31], s61 offen lds
buffer_load_dwordx4 v27, s[28:31], s61 offen offset:1024 lds
s_add_u32 m0, s60, 16384
s_add_u32 s61, s61, s53
buffer_load_dwordx4 v26, s[28:31], s61 offen lds
buffer_load_dwordx4 v27, s[28:31], s61 offen offset:1024 lds
s_add_u32 s49, s76, 2
s_and_b32 s49, s49, 15
s_mul_i32 s49, s49, 393216
buffer_load_dwordx4 v[40:43], v36, s[28:31], s49 offen
s_add_u32 s49, s76, 3
s_and_b32 s49, s49, 15
s_mul_i32 s49, s49, 393216
buffer_load_dwordx4 v[40:43], v36, s[28:31], s49 offen
buffer_load_dword v5, v30, s[32:35], s79 offen sc1
s_add_u32 s69, s47, 0
s_and_b32 s69, s69, 15
s_mul_i32 s67, s69, 2048
s_mul_i32 s68, s69, s54
s_add_u32 m0, s70, 0
s_nop 0
s_mov_b32 s63, 0
s_waitcnt vmcnt(0)
poll_40:
v_cmp_gt_u32 vcc, 2, v5
s_cbranch_vccz polled_41
buffer_load_dword v5, v30, s[32:35], s79 offen sc1
s_add_u32 s63, s63, 1
s_cmp_lt_u32 s63, 0x80000
s_waitcnt vmcnt(0)
s_cbranch_scc1 poll_40
polled_41:
buffer_load_dwordx4 v20, s[32:35], s67 offen offset:0 sc1 lds
buffer_load_dwordx4 v21, s[32:35], s67 offen offset:1024 sc1 lds
buffer_load_dwordx4 v22, s[32:35], s67 offen offset:2048 sc1 lds
buffer_load_dwordx4 v23, s[32:35], s67 offen offset:3072 sc1 lds
s_add_u32 s69, s47, 1
s_and_b32 s69, s69, 15
s_mul_i32 s67, s69, 2048
s_mul_i32 s68, s69, s54
s_add_u32 m0, s70, 40960
s_nop 0
buffer_load_dwordx4 v20, s[32:35], s67 offen offset:0 sc1 lds
buffer_load_dwordx4 v21, s[32:35], s67 offen offset:1024 sc1 lds
buffer_load_dwordx4 v22, s[32:35], s67 offen offset:2048 sc1 lds
buffer_load_dwordx4 v23, s[32:35], s67 offen offset:3072 sc1 lds
s_waitcnt vmcnt(4) lgkmcnt(0)
s_barrier
s_add_u32 s69, s47, 2
s_and_b32 s69, s69, 15
s_mul_i32 s67, s69, 2048
s_mul_i32 s68, s69, s54
s_add_u32 m0, s70, 81920
s_nop 0
buffer_load_dwordx4 v20, s[32:35], s67 offen offset:0 sc1 lds
buffer_load_dwordx4 v21, s[32:35], s67 offen offset:1024 sc1 lds
buffer_load_dwordx4 v22, s[32:35], s67 offen offset:2048 sc1 lds
buffer_load_dwordx4 v23, s[32:35], s67 offen offset:3072 sc1 lds
s_add_u32 s60, s71, 81920
s_add_u32 m0, s60, 0
s_mov_b32 s61, s68
buffer_load_dwordx4 v26, s[28:31], s61 offen lds
buffer_load_dwordx4 v27, s[28:31], s61 offen offset:1024 lds
s_add_u32 m0, s60, 8192
s_add_u32 s61, s61, s53
buffer_load_dwordx4 v26, s[28:31], s61 offen lds
buffer_load_dwordx4 v27, s[28:31], s61 offen offset:1024 lds
s_add_u32 m0, s60, 16384
s_add_u32 s61, s61, s53
buffer_load_dwordx4 v26, s[28:31], s61 offen lds
buffer_load_dwordx4 v27, s[28:31], s61 offen offset:1024 lds
s_add_u32 s49, s76, 4
s_and_b32 s49, s49, 15
s_mul_i32 s49, s49, 393216
buffer_load_dwordx4 v[40:43], v36, s[28:31], s49 offen
s_mov_b32 s64, 0
s_mov_b32 s65, 0
h2_loop:
s_waitcnt vmcnt(11)
s_barrier
s_add_u32 s69, s69, 1
s_and_b32 s69, s69, 15
s_mul_i32 s67, s69, 2048
s_mul_i32 s68, s69, s54
s_add_u32 m0, s70, s65
s_nop 0
buffer_load_dwordx4 v20, s[32:35], s67 offen offset:0 sc1 lds
buffer_load_dwordx4 v21, s[32:35], s67 offen offset:1024 sc1 lds
buffer_load_dwordx4 v22, s[32:35], s67 offen offset:2048 sc1 lds
buffer_load_dwordx4 v23, s[32:35], s67 offen offset:3072 sc1 lds
s_add_u32 s60, s71, s65
s_add_u32 m0, s60, 0
s_mov_b32 s61, s68
buffer_load_dwordx4 v26, s[28:31], s61 offen lds
buffer_load_dwordx4 v27, s[28:31], s61 offen offset:1024 lds
s_add_u32 m0, s60, 8192
s_add_u32 s61, s61, s53
buffer_load_dwordx4 v26, s[28:31], s61 offen lds
buffer_load_dwordx4 v27, s[28:31], s61 offen offset:1024 lds
s_add_u32 m0, s60, 16384
s_add_u32 s61, s61, s53
buffer_load_dwordx4 v26, s[28:31], s61 offen lds
buffer_load_dwordx4 v27, s[28:31], s61 offen offset:1024 lds
s_add_u32 s48, s64, 5
s_min_u32 s48, s48, 15
s_add_u32 s49, s48, s76
s_and_b32 s49, s49, 15
s_mul_i32 s49, s49, 393216
buffer_load_dwordx4 v[40:43], v36, s[28:31], s49 offen
s_add_u32 s65, s65, 40960
s_cmp_eq_u32 s65, 122880
s_cselect_b32 s65, 0, s65
s_add_u32 s64, s64, 1
s_cmp_lt_u32 s64, 11
s_cbranch_scc1 h2_loop
s_waitcnt vmcnt(11)
s_barrier
s_add_u32 s69, s47, 14
s_and_b32 s69, s69, 15
s_mul_i32 s67, s69, 2048
s_mul_i32 s68, s69, s54
s_add_u32 m0, s70, s65
s_nop 0
buffer_load_dwordx4 v20, s[32:35], s67 offen offset:0 sc1 lds
buffer_load_dwordx4 v21, s[32:35], s67 offen offset:1024 sc1 lds
buffer_load_dwordx4 v22, s[32:35], s67 offen offset:2048 sc1 lds
buffer_load_dwordx4 v23, s[32:35], s67 offen offset:3072 sc1 lds
s_add_u32 s60, s71, s65
s_add_u32 m0, s60, 0
s_mov_b32 s61, s68
buffer_load_dwordx4 v26, s[28:31], s61 offen lds
buffer_load_dwordx4 v27, s[28:31], s61 offen offset:1024 lds
s_add_u32 m0, s60, 8192
s_add_u32 s61, s61, s53
buffer_load_dwordx4 v26, s[28:31], s61 offen lds
buffer_load_dwordx4 v27, s[28:31], s61 offen offset:1024 lds
s_add_u32 m0, s60, 16384
s_add_u32 s61, s61, s53
buffer_load_dwordx4 v26, s[28:31], s61 offen lds
buffer_load_dwordx4 v27, s[28:31], s61 offen offset:1024 lds
s_add_u32 s65, s65, 40960
s_cmp_eq_u32 s65, 122880
s_cselect_b32 s65, 0, s65
s_add_u32 s64, s64, 1
s_mov_b32 s36, s12
s_and_b32 s37, s13, 0xffff
s_mov_b32 s38, 6291456
s_mov_b32 s39, 0x00020000
s_waitcnt vmcnt(10)
s_barrier
s_add_u32 s69, s47, 15
s_and_b32 s69, s69, 15
s_mul_i32 s67, s69, 2048
s_mul_i32 s68, s69, s54
s_add_u32 m0, s70, 0
s_nop 0
buffer_load_dwordx4 v20, s[32:35], s67 offen offset:0 sc1 lds
buffer_load_dwordx4 v21, s[32:35], s67 offen offset:1024 sc1 lds
buffer_load_dwordx4 v22, s[32:35], s67 offen offset:2048 sc1 lds
buffer_load_dwordx4 v23, s[32:35], s67 offen offset:3072 sc1 lds
s_add_u32 s60, s71, 0
s_add_u32 m0, s60, 0
s_mov_b32 s61, s68
buffer_load_dwordx4 v26, s[28:31], s61 offen lds
buffer_load_dwordx4 v27, s[28:31], s61 offen offset:1024 lds
s_add_u32 m0, s60, 8192
s_add_u32 s61, s61, s53
buffer_load_dwordx4 v26, s[28:31], s61 offen lds
buffer_load_dwordx4 v27, s[28:31], s61 offen offset:1024 lds
s_add_u32 m0, s60, 16384
s_add_u32 s61, s61, s53
buffer_load_dwordx4 v26, s[28:31], s61 offen lds
buffer_load_dwordx4 v27, s[28:31], s61 offen offset:1024 lds
s_waitcnt vmcnt(10)
s_barrier
s_setprio 0
buffer_load_dwordx4 v[80:83], v37, s[32:35], 0 offen offset:0 sc1
buffer_load_dwordx4 v[84:87], v37, s[32:35], 0 offen offset:1024 sc1
buffer_load_dwordx4 v[88:91], v37, s[32:35], 0 offen offset:2048 sc1
buffer_load_dwordx4 v[92:95], v37, s[32:35], 0 offen offset:3072 sc1
global_load_dword v48, v54, s[98:99]
s_add_u32 s69, s47, 0
s_and_b32 s69, s69, 15
s_mul_i32 s67, s69, 2048
s_mul_i32 s68, s69, s54
s_add_u32 s60, s71, 122880
s_add_u32 m0, s60, 0
s_mov_b32 s61, s68
buffer_load_dwordx4 v26, s[36:39], s61 offen lds
buffer_load_dwordx4 v27, s[36:39], s61 offen offset:1024 lds
s_add_u32 m0, s60, 8192
s_add_u32 s61, s61, s53
buffer_load_dwordx4 v26, s[36:39], s61 offen lds
buffer_load_dwordx4 v27, s[36:39], s61 offen offset:1024 lds
s_add_u32 m0, s60, 16384
s_add_u32 s61, s61, s53
buffer_load_dwordx4 v26, s[36:39], s61 offen lds
buffer_load_dwordx4 v27, s[36:39], s61 offen offset:1024 lds
s_waitcnt vmcnt(11)
s_barrier
s_waitcnt vmcnt(7)
buffer_store_dwordx4 v[56:59], v18, s[32:35], s86 offen offset:0 sc1
v_add_f32 v80, v80, v88
v_add_f32 v81, v81, v89
v_add_f32 v82, v82, v90
v_add_f32 v83, v83, v91
v_add_f32 v84, v84, v92
v_add_f32 v85, v85, v93
v_add_f32 v86, v86, v94
buffer_store_dwordx4 v[56:59], v18, s[32:35], s86 offen offset:1024 sc1
v_add_f32 v87, v87, v95
v_add_f32 v80, v80, v84
v_add_f32 v81, v81, v85
v_add_f32 v82, v82, v86
v_add_f32 v83, v83, v87
s_nop 1
buffer_load_dwordx4 v[240:243], v18, s[32:35], s81 offen offset:0 sc1
v_permlane32_swap_b32 v80, v81
v_permlane32_swap_b32 v82, v83
v_add_f32 v80, v80, v81
v_add_f32 v82, v82, v83
s_nop 1
v_permlane16_swap_b32 v80, v82
buffer_load_dwordx4 v[240:243], v18, s[32:35], s81 offen offset:1024 sc1
s_nop 0
v_add_f32 v80, v80, v82
v_cmp_u_f32 vcc, v80, v80
s_cbranch_vccnz again_42
summed_43:
v_mul_f32 v44, 0x3a800000, v80
buffer_load_dwordx4 v[240:243], v18, s[32:35], s82 offen offset:0 sc1
v_mov_b32 v45, v44
s_nop 1
v_permlane16_swap_b32 v44, v45
s_nop 0
v_fma_f32 v45, -v44, v44, v45
v_max_f32 v45, 0, v45
buffer_load_dwordx4 v[240:243], v18, s[32:35], s82 offen offset:1024 sc1
v_add_f32 v45, 0x3727c5ac, v45
v_rsq_f32 v46, v45
v_sub_f32 v47, 0, v44
ds_write_b32 v50, v47 offset:512
ds_write_b64 v49, v[46:47]
ds_write_b32 v50, v46
s_setprio 0
s_waitcnt lgkmcnt(0)
s_waitcnt vmcnt(63)
s_barrier
ds_write_b128 v52, v[232:235] offset:57344
ds_write_b128 v52, v[236:239] offset:58368
ds_write_b128 v51, v[152:155] offset:40960
ds_write_b128 v51, v[156:159] offset:41984
ds_write_b128 v51, v[160:163] offset:49152
ds_write_b128 v51, v[164:167] offset:50176
ds_write_b128 v51, v[168:171] offset:57344
ds_write_b128 v51, v[172:175] offset:58368
ds_write_b128 v52, v[176:179] offset:0
ds_write_b128 v52, v[180:183] offset:1024
ds_write_b128 v52, v[184:187] offset:8192
ds_write_b128 v52, v[188:191] offset:9216
ds_write_b128 v52, v[192:195] offset:16384
ds_write_b128 v52, v[196:199] offset:17408
ds_write_b128 v52, v[200:203] offset:24576
ds_write_b128 v52, v[204:207] offset:25600
ds_write_b128 v52, v[208:211] offset:32768
ds_write_b128 v52, v[212:215] offset:33792
ds_write_b128 v52, v[216:219] offset:40960
ds_write_b128 v52, v[220:223] offset:41984
ds_write_b128 v52, v[224:227] offset:49152
ds_write_b128 v52, v[228:231] offset:50176
ds_write_b128 v51, v[112:115] offset:0
ds_write_b128 v51, v[116:119] offset:1024
ds_write_b128 v51, v[120:123] offset:8192
ds_write_b128 v51, v[124:127] offset:9216
ds_write_b128 v51, v[128:131] offset:16384
ds_write_b128 v51, v[132:135] offset:17408
ds_write_b128 v51, v[136:139] offset:24576
ds_write_b128 v51, v[140:143] offset:25600
ds_write_b128 v51, v[144:147] offset:32768
ds_write_b128 v51, v[148:151] offset:33792
s_mov_b32 s28, s12
s_and_b32 s29, s13, 0xffff
s_mov_b32 s30, 6291456
s_mov_b32 s31, 0x00020000
s_add_u32 s69, s47, 0
s_and_b32 s69, s69, 15
s_mul_i32 s67, s69, 2048
s_mul_i32 s68, s69, s54
s_waitcnt vmcnt(0) lgkmcnt(0)
s_barrier
s_mov_b32 s36, s14
s_and_b32 s37, s15, 0xffff
s_mov_b32 s38, 65536
s_mov_b32 s39, 0x00020000
s_lshl_b32 s48, s42, 12
s_lshl_b32 s49, s43, 10
s_add_u32 s48, s48, s49
s_add_u32 m0, s49, 135168
s_nop 0
buffer_load_dwordx4 v18, s[36:39], s48 offen lds
v_add_u32 v37, 262144, v37
s_getpc_b64 s[98:99]
pc_45:
s_add_u32 s98, s98, c3_last - pc_45
s_addc_u32 s99, s99, 0
s_lshr_b32 s50, s2, 3
s_lshl_b32 s50, s50, 2
s_add_u32 s50, s50, s43
s_lshl_b32 s50, s50, 7
v_and_b32 v4, 1, v0
v_lshl_add_u32 v4, v4, 6, s50
v_min_u32 v54, L_code_end - c3_last, v4
s_cmp_lg_u32 s43, 0
s_cbranch_scc1 else_46
s_mov_b32 s48, 1
s_atomic_add s48, s[22:23], s73
else_46:
s_waitcnt vmcnt(0) lgkmcnt(0)
s_add_u32 s69, s47, 1
s_and_b32 s69, s69, 15
s_mul_i32 s67, s69, 2048
s_mul_i32 s68, s69, s54
s_barrier
s_add_u32 s60, s71, 40960
s_add_u32 m0, s60, 0
s_mov_b32 s61, s68
buffer_load_dwordx4 v26, s[28:31], s61 offen lds
buffer_load_dwordx4 v27, s[28:31], s61 offen offset:1024 lds
s_add_u32 m0, s60, 8192
s_add_u32 s61, s61, s53
buffer_load_dwordx4 v26, s[28:31], s61 offen lds
buffer_load_dwordx4 v27, s[28:31], s61 offen offset:1024 lds
s_add_u32 m0, s60, 16384
s_add_u32 s61, s61, s53
buffer_load_dwordx4 v26, s[28:31], s61 offen lds
buffer_load_dwordx4 v27, s[28:31], s61 offen offset:1024 lds
s_add_u32 s49, s76, 2
s_and_b32 s49, s49, 15
s_mul_i32 s49, s49, 393216
buffer_load_dwordx4 v[40:43], v36, s[28:31], s49 offen
s_add_u32 s49, s76, 3
s_and_b32 s49, s49, 15
s_mul_i32 s49, s49, 393216
buffer_load_dwordx4 v[40:43], v36, s[28:31], s49 offen
buffer_load_dword v5, v30, s[32:35], s79 offen sc1
s_add_u32 s69, s47, 0
s_and_b32 s69, s69, 15
s_mul_i32 s67, s69, 2048
s_mul_i32 s68, s69, s54
s_add_u32 m0, s70, 0
s_nop 0
s_mov_b32 s63, 0
s_waitcnt vmcnt(0)
poll_48:
v_cmp_gt_u32 vcc, 3, v5
s_cbranch_vccz polled_49
buffer_load_dword v5, v30, s[32:35], s79 offen sc1
s_add_u32 s63, s63, 1
s_cmp_lt_u32 s63, 0x80000
s_waitcnt vmcnt(0)
s_cbranch_scc1 poll_48
polled_49:
buffer_load_dwordx4 v20, s[32:35], s67 offen offset:0 sc1 lds
buffer_load_dwordx4 v21, s[32:35], s67 offen offset:1024 sc1 lds
buffer_load_dwordx4 v22, s[32:35], s67 offen offset:2048 sc1 lds
buffer_load_dwordx4 v23, s[32:35], s67 offen offset:3072 sc1 lds
s_add_u32 s69, s47, 1
s_and_b32 s69, s69, 15
s_mul_i32 s67, s69, 2048
s_mul_i32 s68, s69, s54
s_add_u32 m0, s70, 40960
s_nop 0
buffer_load_dwordx4 v20, s[32:35], s67 offen offset:0 sc1 lds
buffer_load_dwordx4 v21, s[32:35], s67 offen offset:1024 sc1 lds
buffer_load_dwordx4 v22, s[32:35], s67 offen offset:2048 sc1 lds
buffer_load_dwordx4 v23, s[32:35], s67 offen offset:3072 sc1 lds
s_waitcnt vmcnt(4) lgkmcnt(0)
s_barrier
s_add_u32 s69, s47, 2
s_and_b32 s69, s69, 15
s_mul_i32 s67, s69, 2048
s_mul_i32 s68, s69, s54
s_add_u32 m0, s70, 81920
s_nop 0
buffer_load_dwordx4 v20, s[32:35], s67 offen offset:0 sc1 lds
buffer_load_dwordx4 v21, s[32:35], s67 offen offset:1024 sc1 lds
buffer_load_dwordx4 v22, s[32:35], s67 offen offset:2048 sc1 lds
buffer_load_dwordx4 v23, s[32:35], s67 offen offset:3072 sc1 lds
s_add_u32 s60, s71, 81920
s_add_u32 m0, s60, 0
s_mov_b32 s61, s68
buffer_load_dwordx4 v26, s[28:31], s61 offen lds
buffer_load_dwordx4 v27, s[28:31], s61 offen offset:1024 lds
s_add_u32 m0, s60, 8192
s_add_u32 s61, s61, s53
buffer_load_dwordx4 v26, s[28:31], s61 offen lds
buffer_load_dwordx4 v27, s[28:31], s61 offen offset:1024 lds
s_add_u32 m0, s60, 16384
s_add_u32 s61, s61, s53
buffer_load_dwordx4 v26, s[28:31], s61 offen lds
buffer_load_dwordx4 v27, s[28:31], s61 offen offset:1024 lds
s_add_u32 s49, s76, 4
s_and_b32 s49, s49, 15
s_mul_i32 s49, s49, 393216
buffer_load_dwordx4 v[40:43], v36, s[28:31], s49 offen
s_mov_b32 s64, 0
s_mov_b32 s65, 0
h3_loop:
s_waitcnt vmcnt(11)
s_barrier
s_add_u32 s69, s69, 1
s_and_b32 s69, s69, 15
s_mul_i32 s67, s69, 2048
s_mul_i32 s68, s69, s54
s_add_u32 m0, s70, s65
s_nop 0
buffer_load_dwordx4 v20, s[32:35], s67 offen offset:0 sc1 lds
buffer_load_dwordx4 v21, s[32:35], s67 offen offset:1024 sc1 lds
buffer_load_dwordx4 v22, s[32:35], s67 offen offset:2048 sc1 lds
buffer_load_dwordx4 v23, s[32:35], s67 offen offset:3072 sc1 lds
s_add_u32 s60, s71, s65
s_add_u32 m0, s60, 0
s_mov_b32 s61, s68
buffer_load_dwordx4 v26, s[28:31], s61 offen lds
buffer_load_dwordx4 v27, s[28:31], s61 offen offset:1024 lds
s_add_u32 m0, s60, 8192
s_add_u32 s61, s61, s53
buffer_load_dwordx4 v26, s[28:31], s61 offen lds
buffer_load_dwordx4 v27, s[28:31], s61 offen offset:1024 lds
s_add_u32 m0, s60, 16384
s_add_u32 s61, s61, s53
buffer_load_dwordx4 v26, s[28:31], s61 offen lds
buffer_load_dwordx4 v27, s[28:31], s61 offen offset:1024 lds
s_add_u32 s48, s64, 5
s_min_u32 s48, s48, 15
s_add_u32 s49, s48, s76
s_and_b32 s49, s49, 15
s_mul_i32 s49, s49, 393216
buffer_load_dwordx4 v[40:43], v36, s[28:31], s49 offen
s_add_u32 s65, s65, 40960
s_cmp_eq_u32 s65, 122880
s_cselect_b32 s65, 0, s65
s_add_u32 s64, s64, 1
s_cmp_lt_u32 s64, 11
s_cbranch_scc1 h3_loop
s_waitcnt vmcnt(11)
s_barrier
s_add_u32 s69, s47, 14
s_and_b32 s69, s69, 15
s_mul_i32 s67, s69, 2048
s_mul_i32 s68, s69, s54
s_add_u32 m0, s70, s65
s_nop 0
buffer_load_dwordx4 v20, s[32:35], s67 offen offset:0 sc1 lds
buffer_load_dwordx4 v21, s[32:35], s67 offen offset:1024 sc1 lds
buffer_load_dwordx4 v22, s[32:35], s67 offen offset:2048 sc1 lds
buffer_load_dwordx4 v23, s[32:35], s67 offen offset:3072 sc1 lds
s_add_u32 s60, s71, s65
s_add_u32 m0, s60, 0
s_mov_b32 s61, s68
buffer_load_dwordx4 v26, s[28:31], s61 offen lds
buffer_load_dwordx4 v27, s[28:31], s61 offen offset:1024 lds
s_add_u32 m0, s60, 8192
s_add_u32 s61, s61, s53
buffer_load_dwordx4 v26, s[28:31], s61 offen lds
buffer_load_dwordx4 v27, s[28:31], s61 offen offset:1024 lds
s_add_u32 m0, s60, 16384
s_add_u32 s61, s61, s53
buffer_load_dwordx4 v26, s[28:31], s61 offen lds
buffer_load_dwordx4 v27, s[28:31], s61 offen offset:1024 lds
s_add_u32 s65, s65, 40960
s_cmp_eq_u32 s65, 122880
s_cselect_b32 s65, 0, s65
s_add_u32 s64, s64, 1
s_mov_b32 s36, s16
s_and_b32 s37, s17, 0xffff
s_mov_b32 s38, 2097152
s_mov_b32 s39, 0x00020000
s_waitcnt vmcnt(10)
s_barrier
s_add_u32 s69, s47, 15
s_and_b32 s69, s69, 15
s_mul_i32 s67, s69, 2048
s_mul_i32 s68, s69, s54
s_add_u32 m0, s70, 0
s_nop 0
buffer_load_dwordx4 v20, s[32:35], s67 offen offset:0 sc1 lds
buffer_load_dwordx4 v21, s[32:35], s67 offen offset:1024 sc1 lds
buffer_load_dwordx4 v22, s[32:35], s67 offen offset:2048 sc1 lds
buffer_load_dwordx4 v23, s[32:35], s67 offen offset:3072 sc1 lds
s_add_u32 s60, s71, 0
s_add_u32 m0, s60, 0
s_mov_b32 s61, s68
buffer_load_dwordx4 v26, s[28:31], s61 offen lds
buffer_load_dwordx4 v27, s[28:31], s61 offen offset:1024 lds
s_add_u32 m0, s60, 8192
s_add_u32 s61, s61, s53
buffer_load_dwordx4 v26, s[28:31], s61 offen lds
buffer_load_dwordx4 v27, s[28:31], s61 offen offset:1024 lds
s_add_u32 m0, s60, 16384
s_add_u32 s61, s61, s53
buffer_load_dwordx4 v26, s[28:31], s61 offen lds
buffer_load_dwordx4 v27, s[28:31], s61 offen offset:1024 lds
s_waitcnt vmcnt(10)
s_barrier
s_setprio 0
buffer_load_dword v33, v12, s[32:35], s73 offen sc1
buffer_load_dwordx4 v[80:83], v37, s[32:35], 0 offen offset:0 sc1
buffer_load_dwordx4 v[84:87], v37, s[32:35], 0 offen offset:1024 sc1
buffer_load_dwordx4 v[88:91], v37, s[32:35], 0 offen offset:2048 sc1
buffer_load_dwordx4 v[92:95], v37, s[32:35], 0 offen offset:3072 sc1
global_load_dword v48, v54, s[98:99]
s_add_u32 s48, s75, 15
s_and_b32 s48, s48, 15
s_mul_i32 s48, s48, s57
s_add_u32 m0, s71, 106496
s_nop 0
buffer_load_dwordx4 v28, s[36:39], s48 offen lds
buffer_load_dwordx4 v29, s[36:39], s48 offen offset:1024 lds
s_add_u32 s48, s75, 5
s_and_b32 s48, s48, 15
s_mul_i32 s48, s48, s57
s_add_u32 m0, s71, 24576
s_nop 0
buffer_load_dwordx4 v28, s[36:39], s48 offen lds
buffer_load_dwordx4 v29, s[36:39], s48 offen offset:1024 lds
s_add_u32 s48, s75, 6
s_and_b32 s48, s48, 15
s_mul_i32 s48, s48, s57
s_add_u32 m0, s71, 32768
s_nop 0
buffer_load_dwordx4 v28, s[36:39], s48 offen lds
buffer_load_dwordx4 v29, s[36:39], s48 offen offset:1024 lds
s_waitcnt vmcnt(12)
s_barrier
s_waitcnt vmcnt(7)
s_mov_b32 s63, 0
poll_53:
v_cmp_gt_u32 vcc, 16, v33
s_cbranch_vccz polled_54
buffer_load_dword v33, v12, s[32:35], s73 offen sc1
s_add_u32 s63, s63, 1
s_cmp_lt_u32 s63, 0x80000
s_waitcnt vmcnt(0)
s_cbranch_scc1 poll_53
polled_54:
s_add_u32 s48, s75, 7
s_and_b32 s48, s48, 15
s_mul_i32 s48, s48, s57
s_add_u32 m0, s71, 40960
s_nop 0
buffer_load_dwordx4 v28, s[36:39], s48 offen lds
v_add_f32 v80, v80, v88
v_add_f32 v81, v81, v89
v_add_f32 v82, v82, v90
v_add_f32 v83, v83, v91
v_add_f32 v84, v84, v92
buffer_load_dwordx4 v29, s[36:39], s48 offen offset:1024 lds
v_add_f32 v85, v85, v93
v_add_f32 v86, v86, v94
v_add_f32 v87, v87, v95
v_add_f32 v80, v80, v84
v_add_f32 v81, v81, v85
s_add_u32 s48, s75, 8
s_and_b32 s48, s48, 15
s_mul_i32 s48, s48, s57
s_add_u32 m0, s71, 49152
s_nop 0
buffer_load_dwordx4 v28, s[36:39], s48 offen lds
v_add_f32 v82, v82, v86
v_add_f32 v83, v83, v87
s_nop 1
v_permlane32_swap_b32 v80, v81
buffer_load_dwordx4 v29, s[36:39], s48 offen offset:1024 lds
v_permlane32_swap_b32 v82, v83
v_add_f32 v80, v80, v81
v_add_f32 v82, v82, v83
s_nop 1
v_permlane16_swap_b32 v80, v82
s_add_u32 s48, s75, 9
s_and_b32 s48, s48, 15
s_mul_i32 s48, s48, s57
s_add_u32 m0, s71, 57344
s_nop 0
buffer_load_dwordx4 v28, s[36:39], s48 offen lds
s_nop 0
v_add_f32 v80, v80, v82
v_cmp_u_f32 vcc, v80, v80
s_cbranch_vccnz again_50
summed_51:
buffer_load_dwordx4 v29, s[36:39], s48 offen offset:1024 lds
v_mul_f32 v44, 0x3a800000, v80
v_mov_b32 v45, v44
s_nop 1
v_permlane16_swap_b32 v44, v45
s_add_u32 s48, s75, 10
s_and_b32 s48, s48, 15
s_mul_i32 s48, s48, s57
s_add_u32 m0, s71, 65536
s_nop 0
buffer_load_dwordx4 v28, s[36:39], s48 offen lds
s_nop 0
v_fma_f32 v45, -v44, v44, v45
v_max_f32 v45, 0, v45
v_add_f32 v45, 0x3727c5ac, v45
v_rsq_f32 v46, v45
buffer_load_dwordx4 v29, s[36:39], s48 offen offset:1024 lds
v_sub_f32 v47, 0, v44
ds_write_b32 v50, v47 offset:512
ds_write_b64 v49, v[46:47]
ds_write_b32 v50, v46
s_setprio 0
s_waitcnt lgkmcnt(0)
s_waitcnt vmcnt(63)
s_barrier
s_waitcnt vmcnt(5)
s_add_u32 s48, s75, 11
s_and_b32 s48, s48, 15
s_mul_i32 s48, s48, s57
s_add_u32 m0, s71, 73728
s_nop 0
buffer_load_dwordx4 v28, s[36:39], s48 offen lds
buffer_load_dwordx4 v29, s[36:39], s48 offen offset:1024 lds
s_waitcnt vmcnt(5)
s_add_u32 s48, s75, 12
s_and_b32 s48, s48, 15
s_mul_i32 s48, s48, s57
s_add_u32 m0, s71, 81920
s_nop 0
buffer_load_dwordx4 v28, s[36:39], s48 offen lds
buffer_load_dwordx4 v29, s[36:39], s48 offen offset:1024 lds
s_waitcnt vmcnt(5)
s_add_u32 s48, s75, 13
s_and_b32 s48, s48, 15
s_mul_i32 s48, s48, s57
s_add_u32 m0, s71, 90112
s_nop 0
buffer_load_dwordx4 v28, s[36:39], s48 offen lds
buffer_load_dwordx4 v29, s[36:39], s48 offen offset:1024 lds
s_waitcnt vmcnt(5)
s_add_u32 s48, s75, 14
s_and_b32 s48, s48, 15
s_mul_i32 s48, s48, s57
s_add_u32 m0, s71, 98304
s_nop 0
buffer_load_dwordx4 v28, s[36:39], s48 offen lds
buffer_load_dwordx4 v29, s[36:39], s48 offen offset:1024 lds
s_waitcnt vmcnt(5)
s_add_u32 s48, s75, 0
s_and_b32 s48, s48, 15
s_mul_i32 s48, s48, s57
s_add_u32 m0, s71, 4294950912
s_nop 0
buffer_load_dwordx4 v28, s[36:39], s48 offen lds
buffer_load_dwordx4 v29, s[36:39], s48 offen offset:1024 lds
s_waitcnt vmcnt(5)
s_add_u32 s48, s75, 1
s_and_b32 s48, s48, 15
s_mul_i32 s48, s48, s57
s_add_u32 m0, s71, 4294959104
s_nop 0
buffer_load_dwordx4 v28, s[36:39], s48 offen lds
buffer_load_dwordx4 v29, s[36:39], s48 offen offset:1024 lds
s_waitcnt vmcnt(5)
s_add_u32 s48, s75, 2
s_and_b32 s48, s48, 15
s_mul_i32 s48, s48, s57
s_add_u32 m0, s71, 0
s_nop 0
buffer_load_dwordx4 v28, s[36:39], s48 offen lds
buffer_load_dwordx4 v29, s[36:39], s48 offen offset:1024 lds
s_waitcnt vmcnt(5)
s_add_u32 s48, s75, 3
s_and_b32 s48, s48, 15
s_mul_i32 s48, s48, s57
s_add_u32 m0, s71, 8192
s_nop 0
buffer_load_dwordx4 v28, s[36:39], s48 offen lds
buffer_load_dwordx4 v29, s[36:39], s48 offen offset:1024 lds
s_waitcnt vmcnt(5)
s_add_u32 s48, s75, 4
s_and_b32 s48, s48, 15
s_mul_i32 s48, s48, s57
s_add_u32 m0, s71, 16384
s_nop 0
buffer_load_dwordx4 v28, s[36:39], s48 offen lds
buffer_load_dwordx4 v29, s[36:39], s48 offen offset:1024 lds
s_waitcnt vmcnt(5)
buffer_load_dwordx4 v[240:243], v18, s[32:35], s81 offen offset:0 sc1
buffer_load_dwordx4 v[240:243], v18, s[32:35], s81 offen offset:1024 sc1
s_waitcnt vmcnt(5)
buffer_load_dwordx4 v[240:243], v18, s[32:35], s82 offen offset:0 sc1
buffer_load_dwordx4 v[240:243], v18, s[32:35], s82 offen offset:1024 sc1
s_waitcnt vmcnt(0) lgkmcnt(0)
s_barrier
L_end:
s_endpgm
L_compute:
s_lshr_b32 s48, s2, 2
s_and_b32 s48, s48, 1
s_lshl_b32 s48, s48, 1
s_add_u32 s48, s48, s74
s_and_b32 s49, s42, 3
s_xor_b32 s77, s48, s49
s_add_u32 s77, s77, 4
s_add_u32 s48, s47, 1
s_and_b32 s48, s48, 3
s_and_b32 s49, s77, 3
s_lshl_b32 s49, s49, 2
s_add_u32 s78, s48, s49
s_and_b32 s48, s2, 7
s_lshl_b32 s48, s48, 1
s_add_u32 s75, s78, s48
s_and_b32 s75, s75, 15
s_mov_b32 s46, 0
s_waitcnt lgkmcnt(0)
s_mov_b32 s32, s22
s_and_b32 s33, s23, 0xffff
s_mov_b32 s34, 268435456
s_mov_b32 s35, 0x00020000
s_mov_b32 s24, s18
s_and_b32 s25, s19, 0xffff
s_mov_b32 s26, 4194304
s_mov_b32 s27, 0x00020000
s_setprio 1
s_and_b32 s43, s40, 1
s_lshr_b32 s44, s40, 1
s_lshl_b32 s45, s42, 1
s_add_u32 s45, s45, s43
s_cmp_lg_u32 s40, 1
s_cbranch_scc1 else_55
s_getpc_b64 s[48:49]
L_pc:
s_sub_u32 s48, s48, L_pc - interleave_layers__sliding_local_dilated__linear_kernel_hedgehog__prompt_kernel
s_subb_u32 s49, s49, 0
s_lshr_b32 s50, s2, 3
s_lshl_b32 s50, s50, 12
v_lshl_add_u32 v8, v0, 6, s50
v_cmp_gt_u32 vcc, L_code_end - interleave_layers__sliding_local_dilated__linear_kernel_hedgehog__prompt_kernel, v8
s_and_saveexec_b64 s[50:51], vcc
s_cbranch_execz nopf_57
global_load_dword v254, v8, s[48:49]
nopf_57:
s_mov_b64 exec, -1
else_55:
s_lshl_b32 s48, s41, 3
s_lshl_b32 s49, s44, 2
s_add_u32 s48, s48, s49
s_lshl_b32 s48, s48, 5
s_add_u32 s48, s48, s45
s_lshl_b32 s48, s48, 10
s_add_u32 s80, s48, 4194304
s_add_u32 s81, s80, 32768
s_add_u32 s82, s80, 65536
s_add_u32 s83, s80, 98304
s_lshl_b32 s84, s41, 2
s_add_u32 s84, s84, s44
s_lshl_b32 s84, s84, 7
s_add_u32 s84, s84, 18350080
s_lshl_b32 s48, s41, 3
s_lshl_b32 s49, s40, 1
s_add_u32 s48, s48, s49
s_lshl_b32 s48, s48, 15
s_lshl_b32 s49, s78, 11
s_add_u32 s85, s48, s49
s_add_u32 s86, s85, 32768
s_lshl_b32 s50, s41, 2
s_add_u32 s50, s50, s40
s_lshl_b32 s50, s50, 4
s_add_u32 s50, s50, s42
s_lshl_b32 s50, s50, 8
s_add_u32 s87, s50, 16777216
s_lshl_b32 s88, s41, 2
s_add_u32 s88, s88, s40
s_lshl_b32 s88, s88, 7
s_add_u32 s88, s88, 18358272
v_lshrrev_b32 v4, 1, v3
v_lshl_add_u32 v4, v2, 2, v4
v_and_b32 v5, 1, v3
v_lshl_add_u32 v4, v5, 1, v4
v_lshlrev_b32 v1, 2, v4
s_lshl_b32 s48, s40, 2
s_add_u32 s48, s48, 134672
v_mov_b32 v10, s48
v_mov_b32 v11, 0
ds_write_b32 v10, v11
v_mov_b32 v140, -1
v_mov_b32 v141, -1
v_mov_b32 v142, -1
v_mov_b32 v143, -1
s_lshl_b32 s50, s42, 2
s_add_u32 s50, s50, s40
s_lshl_b32 s50, s50, 4
s_add_u32 s50, s50, s41
s_lshl_b32 s50, s50, 8
s_add_u32 s50, s50, 17825792
v_mov_b32 v4, s87
v_mov_b32 v5, s50
v_cmp_eq_u32 vcc, 0, v3
v_lshrrev_b32 v6, 1, v3
v_mul_u32_u24 v6, 262144, v6
v_add_u32 v5, v5, v6
v_cndmask_b32 v4, v5, v4, vcc
v_lshl_add_u32 v4, v2, 4, v4
buffer_store_dwordx4 v[140:143], v4, s[32:35], 0 offen sc1
s_lshl_b32 s48, s2, 2
s_add_u32 s49, s48, s40
s_lshl_b32 s48, s49, 10
s_add_u32 s48, s48, 8388608
buffer_store_dwordx4 v[140:143], v18, s[32:35], s48 offen sc1
s_and_b32 s48, s49, 7
s_cmp_lg_u32 s48, 0
s_cbranch_scc1 nofl_58
s_lshl_b32 s48, s49, 5
s_add_u32 s48, s48, 18350080
v_lshlrev_b32 v6, 2, v0
buffer_store_dword v11, v6, s[32:35], s48 offen sc1
nofl_58:
s_lshl_b32 s49, s44, 13
v_lshrrev_b32 v4, 1, v2
v_xor_b32 v4, v4, v3
v_lshlrev_b32 v4, 4, v4
v_lshl_add_u32 v10, v2, 7, v4
v_add_u32 v10, s49, v10
v_xor_b32 v11, 64, v10
s_lshl_b32 s48, s43, 1
v_lshrrev_b32 v4, 2, v2
v_and_b32 v5, 3, v0
v_lshl_add_u32 v6, v3, 3, v4
v_lshlrev_b32 v6, 7, v6
v_lshl_add_u32 v6, v5, 3, v6
v_lshrrev_b32 v7, 1, v4
v_and_b32 v8, 1, v3
v_lshl_add_u32 v7, v8, 1, v7
v_xor_b32 v7, s48, v7
v_lshl_add_u32 v12, v7, 5, v6
v_add_u32 v12, 16384, v12
v_xor_b32 v13, 32, v12
v_mov_b32 v14, v10
v_mov_b32 v15, v11
v_add_u32 v16, 0, v12
v_add_u32 v17, 0, v13
v_mov_b32 v156, 0
v_mov_b32 v157, 0
v_mov_b32 v158, 0
v_mov_b32 v159, 0
v_mov_b32 v160, 0
v_mov_b32 v161, 0
v_mov_b32 v162, 0
v_mov_b32 v163, 0
v_mov_b32 v164, 0
v_mov_b32 v165, 0
v_mov_b32 v166, 0
v_mov_b32 v167, 0
v_mov_b32 v168, 0
v_mov_b32 v169, 0
v_mov_b32 v170, 0
v_mov_b32 v171, 0
v_mov_b32 v172, 0
v_mov_b32 v173, 0
v_mov_b32 v174, 0
v_mov_b32 v175, 0
v_mov_b32 v176, 0
v_mov_b32 v177, 0
v_mov_b32 v178, 0
v_mov_b32 v179, 0
v_mov_b32 v180, 0
v_mov_b32 v181, 0
v_mov_b32 v182, 0
v_mov_b32 v183, 0
v_mov_b32 v184, 0
v_mov_b32 v185, 0
v_mov_b32 v186, 0
v_mov_b32 v187, 0
v_mov_b32 v188, 0
v_mov_b32 v189, 0
v_mov_b32 v190, 0
v_mov_b32 v191, 0
v_mov_b32 v192, 0
v_mov_b32 v193, 0
v_mov_b32 v194, 0
v_mov_b32 v195, 0
v_mov_b32 v196, 0
v_mov_b32 v197, 0
v_mov_b32 v198, 0
v_mov_b32 v199, 0
v_mov_b32 v200, 0
v_mov_b32 v201, 0
v_mov_b32 v202, 0
v_mov_b32 v203, 0
v_mov_b32 v204, 0
v_mov_b32 v205, 0
v_mov_b32 v206, 0
v_mov_b32 v207, 0
v_mov_b32 v208, 0
v_mov_b32 v209, 0
v_mov_b32 v210, 0
v_mov_b32 v211, 0
v_mov_b32 v212, 0
v_mov_b32 v213, 0
v_mov_b32 v214, 0
v_mov_b32 v215, 0
v_mov_b32 v216, 0
v_mov_b32 v217, 0
v_mov_b32 v218, 0
v_mov_b32 v219, 0
v_mov_b32 v220, 0
v_mov_b32 v221, 0
v_mov_b32 v222, 0
v_mov_b32 v223, 0
v_mov_b32 v224, 0
v_mov_b32 v225, 0
v_mov_b32 v226, 0
v_mov_b32 v227, 0
v_mov_b32 v228, 0
v_mov_b32 v229, 0
v_mov_b32 v230, 0
v_mov_b32 v231, 0
v_mov_b32 v232, 0
v_mov_b32 v233, 0
v_mov_b32 v234, 0
v_mov_b32 v235, 0
v_mov_b32 v236, 0
v_mov_b32 v237, 0
v_mov_b32 v238, 0
v_mov_b32 v239, 0
v_mov_b32 v240, 0
v_mov_b32 v241, 0
v_mov_b32 v242, 0
v_mov_b32 v243, 0
v_mov_b32 v244, 0
v_mov_b32 v245, 0
v_mov_b32 v246, 0
v_mov_b32 v247, 0
v_mov_b32 v248, 0
v_mov_b32 v249, 0
v_mov_b32 v250, 0
v_mov_b32 v251, 0
v_mov_b32 v48, 0x3f803f80
v_mov_b32 v49, 0x3f803f80
v_mov_b32 v50, 0x3f803f80
v_mov_b32 v51, 0x3f803f80
s_mov_b32 s48, 0xf149f2ca
v_mov_b32 v9, s48
v_lshlrev_b32 v4, 2, v3
v_sub_u32 v4, v2, v4
v_subrev_u32 v5, 0, v4
v_and_b32 v6, 0x80000001, v5
v_cmp_eq_u32 vcc, 0, v6
v_add_u32 v5, 1, v5
v_and_b32 v6, 0x80000001, v5
v_cndmask_b32 v40, v9, 0, vcc
v_cmp_eq_u32 vcc, 0x80000001, v6
s_nop 1
v_cndmask_b32 v36, v9, 0, vcc
v_subrev_u32 v5, 1, v4
v_and_b32 v6, 0x80000001, v5
v_cmp_eq_u32 vcc, 0, v6
v_add_u32 v5, 1, v5
v_and_b32 v6, 0x80000001, v5
v_cndmask_b32 v41, v9, 0, vcc
v_cmp_eq_u32 vcc, 0x80000001, v6
s_nop 1
v_cndmask_b32 v37, v9, 0, vcc
v_subrev_u32 v5, 2, v4
v_and_b32 v6, 0x80000001, v5
v_cmp_eq_u32 vcc, 0, v6
v_add_u32 v5, 1, v5
v_and_b32 v6, 0x80000001, v5
v_cndmask_b32 v42, v9, 0, vcc
v_cmp_eq_u32 vcc, 0x80000001, v6
s_nop 1
v_cndmask_b32 v38, v9, 0, vcc
v_subrev_u32 v5, 3, v4
v_and_b32 v6, 0x80000001, v5
v_cmp_eq_u32 vcc, 0, v6
v_add_u32 v5, 1, v5
v_and_b32 v6, 0x80000001, v5
v_cndmask_b32 v43, v9, 0, vcc
v_cmp_eq_u32 vcc, 0x80000001, v6
s_nop 1
v_cndmask_b32 v39, v9, 0, vcc
s_or_b32 s48, s41, s44
s_cmp_eq_u32 s48, 0
s_cselect_b64 vcc, -1, 0
v_cndmask_b32 v44, v36, v9, vcc
v_cndmask_b32 v45, v37, v9, vcc
v_cndmask_b32 v46, v38, v9, vcc
v_cndmask_b32 v47, v39, v9, vcc
v_and_b32 v4, 1, v2
v_lshlrev_b32 v4, 4, v4
v_mov_b32 v5, 0xffff
v_lshlrev_b32 v52, v4, v5
s_lshl_b32 s48, s43, 11
s_add_u32 s48, s48, 135168
v_add_u32 v53, s48, v18
v_lshl_add_u32 v55, v0, 3, s48
s_add_u32 s48, s41, s44
s_sub_u32 s48, s48, 1
s_lshl_b32 s49, s48, 1
s_add_u32 s49, s49, s43
s_lshl_b32 s49, s49, 11
s_mul_i32 s50, s42, 65536
s_add_u32 s49, s49, s50
s_add_u32 s49, s49, 8388608
s_cmp_lt_i32 s48, 0
s_cselect_b32 s49, 0xf0000000, s49
v_add_u32 v58, s49, v18
v_lshl_add_u32 v59, v0, 3, s49
s_lshl_b32 s48, s43, 2
s_add_u32 s48, s48, 134672
v_mov_b32 v19, s48
s_lshl_b32 s48, s43, 7
s_add_u32 s48, s48, 133120
v_lshl_add_u32 v7, v3, 4, s48
v_lshl_add_u32 v54, v2, 2, s48
s_lshl_b32 s49, s44, 6
v_add_u32 v8, s49, v2
v_lshlrev_b32 v8, 3, v8
v_add_u32 v8, 131072, v8
v_lshl_add_u32 v9, v3, 2, s49
v_lshlrev_b32 v9, 2, v9
v_add_u32 v9, 132096, v9
s_mov_b32 s64, 0
s_mov_b32 s65, 0
s_mov_b32 s66, 0x3e8293ee
s_mov_b32 s61, 1
s_lshl_b32 s50, s42, 2
s_add_u32 s50, s50, s40
s_lshl_b32 s50, s50, 4
s_add_u32 s50, s50, s41
s_lshl_b32 s50, s50, 8
s_add_u32 s52, s50, 17825792
v_lshrrev_b32 v4, 1, v2
v_lshrrev_b32 v5, 1, v3
v_xor_b32 v4, v4, v5
v_lshlrev_b32 v4, 4, v4
v_and_b32 v5, 1, v3
v_lshl_add_u32 v4, v5, 3, v4
v_lshl_add_u32 v4, v2, 7, v4
s_lshl_b32 s48, s40, 12
v_add_u32 v155, s48, v4
v_mov_b32 v152, 0
v_mov_b32 v153, 0
v_mov_b32 v56, 0
v_mov_b32 v57, 0
s_waitcnt vmcnt(0)
s_lshl_b32 s79, 1, s77
s_or_b32 s79, s79, 0
s_barrier
ds_read_b128 v[60:63], v14 offset:0
ds_read_b128 v[64:67], v14 offset:2048
ds_read_b128 v[68:71], v14 offset:4096
ds_read_b128 v[72:75], v14 offset:6144
ds_read_b64_tr_b16 v[84:85], v16 offset:8192
ds_read_b64_tr_b16 v[86:87], v16 offset:8704
ds_read_b64_tr_b16 v[88:89], v17 offset:8192
ds_read_b64_tr_b16 v[90:91], v17 offset:8704
ds_read_b64_tr_b16 v[92:93], v16 offset:16384
ds_read_b64_tr_b16 v[94:95], v16 offset:16896
ds_read_b64_tr_b16 v[96:97], v17 offset:16384
ds_read_b64_tr_b16 v[98:99], v17 offset:16896
ds_read_b64_tr_b16 v[76:77], v16 offset:0
ds_read_b64_tr_b16 v[78:79], v16 offset:512
ds_read_b64_tr_b16 v[80:81], v17 offset:0
ds_read_b64_tr_b16 v[82:83], v17 offset:512
s_waitcnt lgkmcnt(0)
c0_loop:
v_mfma_f32_16x16x32_bf16 v[212:215], v[84:87], v[72:75], v[212:215]
ds_read_b128 v[100:103], v15 offset:0
v_mfma_f32_16x16x32_bf16 v[204:207], v[84:87], v[68:71], v[204:207]
ds_read_b128 v[104:107], v15 offset:2048
v_mfma_f32_16x16x32_bf16 v[196:199], v[84:87], v[64:67], v[196:199]
ds_read_b128 v[108:111], v15 offset:4096
v_mfma_f32_16x16x32_bf16 v[188:191], v[84:87], v[60:63], v[188:191]
ds_read_b128 v[112:115], v15 offset:6144
v_mfma_f32_16x16x32_bf16 v[192:195], v[88:91], v[60:63], v[192:195]
ds_read_b64_tr_b16 v[124:125], v16 offset:12288
v_mfma_f32_16x16x32_bf16 v[200:203], v[88:91], v[64:67], v[200:203]
ds_read_b64_tr_b16 v[126:127], v16 offset:12800
v_mfma_f32_16x16x32_bf16 v[208:211], v[88:91], v[68:71], v[208:211]
ds_read_b64_tr_b16 v[128:129], v17 offset:12288
v_mfma_f32_16x16x32_bf16 v[216:219], v[88:91], v[72:75], v[216:219]
ds_read_b64_tr_b16 v[130:131], v17 offset:12800
v_mfma_f32_16x16x32_bf16 v[244:247], v[72:75], v[92:95], v[244:247]
ds_read_b64_tr_b16 v[132:133], v16 offset:20480
v_mfma_f32_16x16x32_bf16 v[248:251], v[72:75], v[96:99], v[248:251]
ds_read_b64_tr_b16 v[134:135], v16 offset:20992
v_mfma_f32_16x16x32_bf16 v[240:243], v[68:71], v[96:99], v[240:243]
ds_read_b64_tr_b16 v[136:137], v17 offset:20480
v_mfma_f32_16x16x32_bf16 v[236:239], v[68:71], v[92:95], v[236:239]
ds_read_b64_tr_b16 v[138:139], v17 offset:20992
v_mfma_f32_16x16x32_bf16 v[228:231], v[64:67], v[92:95], v[228:231]
ds_read_b64_tr_b16 v[116:117], v16 offset:4096
v_mfma_f32_16x16x32_bf16 v[232:235], v[64:67], v[96:99], v[232:235]
ds_read_b64_tr_b16 v[118:119], v16 offset:4608
v_mfma_f32_16x16x32_bf16 v[224:227], v[60:63], v[96:99], v[224:227]
ds_read_b64_tr_b16 v[120:121], v17 offset:4096
v_mfma_f32_16x16x32_bf16 v[220:223], v[60:63], v[92:95], v[220:223]
ds_read_b64_tr_b16 v[122:123], v17 offset:4608
v_mfma_f32_16x16x32_bf16 v[156:159], v[76:79], v[60:63], v[156:159]
s_bitcmp1_b32 s79, s64
s_cbranch_scc1 c0_hook
c0_hook_ret:
v_mfma_f32_16x16x32_bf16 v[164:167], v[76:79], v[64:67], v[164:167]
s_add_u32 s65, s65, 40960
s_cmp_eq_u32 s65, 122880
v_mfma_f32_16x16x32_bf16 v[172:175], v[76:79], v[68:71], v[172:175]
s_cselect_b32 s65, 0, s65
s_add_u32 s64, s64, 1
v_mfma_f32_16x16x32_bf16 v[180:183], v[76:79], v[72:75], v[180:183]
v_add_u32 v14, s65, v10
v_add_u32 v15, s65, v11
v_mfma_f32_16x16x32_bf16 v[184:187], v[80:83], v[72:75], v[184:187]
v_add_u32 v16, s65, v12
v_add_u32 v17, s65, v13
v_mfma_f32_16x16x32_bf16 v[176:179], v[80:83], v[68:71], v[176:179]
s_cmp_eq_u32 s64, 16
s_cbranch_scc1 c0_last
v_mfma_f32_16x16x32_bf16 v[168:171], v[80:83], v[64:67], v[168:171]
s_waitcnt lgkmcnt(0)
v_mfma_f32_16x16x32_bf16 v[160:163], v[80:83], v[60:63], v[160:163]
s_barrier
v_mfma_f32_16x16x32_bf16 v[212:215], v[124:127], v[112:115], v[212:215]
ds_read_b128 v[60:63], v14 offset:0
v_mfma_f32_16x16x32_bf16 v[204:207], v[124:127], v[108:111], v[204:207]
ds_read_b128 v[64:67], v14 offset:2048
v_mfma_f32_16x16x32_bf16 v[196:199], v[124:127], v[104:107], v[196:199]
ds_read_b128 v[68:71], v14 offset:4096
v_mfma_f32_16x16x32_bf16 v[188:191], v[124:127], v[100:103], v[188:191]
ds_read_b128 v[72:75], v14 offset:6144
v_mfma_f32_16x16x32_bf16 v[192:195], v[128:131], v[100:103], v[192:195]
ds_read_b64_tr_b16 v[84:85], v16 offset:8192
v_mfma_f32_16x16x32_bf16 v[200:203], v[128:131], v[104:107], v[200:203]
ds_read_b64_tr_b16 v[86:87], v16 offset:8704
v_mfma_f32_16x16x32_bf16 v[208:211], v[128:131], v[108:111], v[208:211]
ds_read_b64_tr_b16 v[88:89], v17 offset:8192
v_mfma_f32_16x16x32_bf16 v[216:219], v[128:131], v[112:115], v[216:219]
ds_read_b64_tr_b16 v[90:91], v17 offset:8704
v_mfma_f32_16x16x32_bf16 v[244:247], v[112:115], v[132:135], v[244:247]
ds_read_b64_tr_b16 v[92:93], v16 offset:16384
v_mfma_f32_16x16x32_bf16 v[248:251], v[112:115], v[136:139], v[248:251]
ds_read_b64_tr_b16 v[94:95], v16 offset:16896
v_mfma_f32_16x16x32_bf16 v[240:243], v[108:111], v[136:139], v[240:243]
ds_read_b64_tr_b16 v[96:97], v17 offset:16384
v_mfma_f32_16x16x32_bf16 v[236:239], v[108:111], v[132:135], v[236:239]
ds_read_b64_tr_b16 v[98:99], v17 offset:16896
v_mfma_f32_16x16x32_bf16 v[228:231], v[104:107], v[132:135], v[228:231]
ds_read_b64_tr_b16 v[76:77], v16 offset:0
v_mfma_f32_16x16x32_bf16 v[232:235], v[104:107], v[136:139], v[232:235]
ds_read_b64_tr_b16 v[78:79], v16 offset:512
v_mfma_f32_16x16x32_bf16 v[224:227], v[100:103], v[136:139], v[224:227]
ds_read_b64_tr_b16 v[80:81], v17 offset:0
v_mfma_f32_16x16x32_bf16 v[220:223], v[100:103], v[132:135], v[220:223]
ds_read_b64_tr_b16 v[82:83], v17 offset:512
v_mfma_f32_16x16x32_bf16 v[156:159], v[116:119], v[100:103], v[156:159]
v_mfma_f32_16x16x32_bf16 v[164:167], v[116:119], v[104:107], v[164:167]
v_mfma_f32_16x16x32_bf16 v[172:175], v[116:119], v[108:111], v[172:175]
v_mfma_f32_16x16x32_bf16 v[180:183], v[116:119], v[112:115], v[180:183]
v_mfma_f32_16x16x32_bf16 v[184:187], v[120:123], v[112:115], v[184:187]
v_mfma_f32_16x16x32_bf16 v[176:179], v[120:123], v[108:111], v[176:179]
v_mfma_f32_16x16x32_bf16 v[168:171], v[120:123], v[104:107], v[168:171]
s_waitcnt lgkmcnt(0)
v_mfma_f32_16x16x32_bf16 v[160:163], v[120:123], v[100:103], v[160:163]
s_branch c0_loop
c0_hook:
v_add_u32 v4, s65, v155
ds_read_b64 v[20:21], v4 offset:0
ds_read_b64 v[28:29], v4 offset:2048
v_xor_b32 v5, 32, v4
ds_read_b64 v[22:23], v5 offset:0
ds_read_b64 v[30:31], v5 offset:2048
v_xor_b32 v5, 64, v4
ds_read_b64 v[24:25], v5 offset:0
ds_read_b64 v[32:33], v5 offset:2048
v_xor_b32 v5, 96, v4
ds_read_b64 v[26:27], v5 offset:0
ds_read_b64 v[34:35], v5 offset:2048
s_waitcnt lgkmcnt(8)
s_cmp_lg_u32 s44, 0
s_cbranch_scc1 else_59
v_mfma_f32_16x16x32_bf16 v[140:143], v[48:51], v[76:79], 0
v_mfma_f32_16x16x32_bf16 v[144:147], v[48:51], v[84:87], 0
v_mfma_f32_16x16x32_bf16 v[148:151], v[48:51], v[92:95], 0
v_mfma_f32_16x16x32_bf16 v[140:143], v[48:51], v[116:119], v[140:143]
v_mfma_f32_16x16x32_bf16 v[144:147], v[48:51], v[124:127], v[144:147]
v_mfma_f32_16x16x32_bf16 v[148:151], v[48:51], v[132:135], v[148:151]
s_branch fi_60
else_59:
v_mfma_f32_16x16x32_bf16 v[140:143], v[48:51], v[80:83], 0
v_mfma_f32_16x16x32_bf16 v[144:147], v[48:51], v[88:91], 0
v_mfma_f32_16x16x32_bf16 v[148:151], v[48:51], v[96:99], 0
v_mfma_f32_16x16x32_bf16 v[140:143], v[48:51], v[120:123], v[140:143]
v_mfma_f32_16x16x32_bf16 v[144:147], v[48:51], v[128:131], v[144:147]
v_mfma_f32_16x16x32_bf16 v[148:151], v[48:51], v[136:139], v[148:151]
fi_60:
s_waitcnt lgkmcnt(0)
v_dot2c_f32_bf16 v152, v20, v48
v_dot2c_f32_bf16 v56, v20, v20
v_dot2c_f32_bf16 v153, v28, v48
v_dot2c_f32_bf16 v57, v28, v28
v_dot2c_f32_bf16 v152, v21, v48
v_dot2c_f32_bf16 v56, v21, v21
v_dot2c_f32_bf16 v153, v29, v48
v_dot2c_f32_bf16 v57, v29, v29
v_dot2c_f32_bf16 v152, v22, v48
v_dot2c_f32_bf16 v56, v22, v22
v_dot2c_f32_bf16 v153, v30, v48
v_dot2c_f32_bf16 v57, v30, v30
v_dot2c_f32_bf16 v152, v23, v48
v_dot2c_f32_bf16 v56, v23, v23
v_dot2c_f32_bf16 v153, v31, v48
v_dot2c_f32_bf16 v57, v31, v31
v_dot2c_f32_bf16 v152, v24, v48
v_dot2c_f32_bf16 v56, v24, v24
v_dot2c_f32_bf16 v153, v32, v48
v_dot2c_f32_bf16 v57, v32, v32
v_dot2c_f32_bf16 v152, v25, v48
v_dot2c_f32_bf16 v56, v25, v25
v_dot2c_f32_bf16 v153, v33, v48
v_dot2c_f32_bf16 v57, v33, v33
v_dot2c_f32_bf16 v152, v26, v48
v_dot2c_f32_bf16 v56, v26, v26
v_dot2c_f32_bf16 v153, v34, v48
v_dot2c_f32_bf16 v57, v34, v34
v_dot2c_f32_bf16 v152, v27, v48
v_dot2c_f32_bf16 v56, v27, v27
v_dot2c_f32_bf16 v153, v35, v48
v_dot2c_f32_bf16 v57, v35, v35
v_cmp_eq_u32 vcc, 0, v3
v_cmp_eq_u32 s[48:49], 1, v3
s_nop 1
v_cndmask_b32 v4, v148, v144, s[48:49]
v_cndmask_b32 v4, v4, v140, vcc
buffer_store_dword v4, v1, s[32:35], s52 offen sc1
s_nop 1
v_permlane32_swap_b32 v152, v153
v_permlane32_swap_b32 v56, v57
v_add_f32 v152, v152, v153
v_add_f32 v56, v56, v57
s_nop 1
v_permlane16_swap_b32 v152, v56
s_nop 0
v_add_f32 v152, v152, v56
buffer_store_dword v152, v1, s[32:35], s87 offen sc1
s_branch c0_hook_ret
c0_last:
v_mfma_f32_16x16x32_bf16 v[168:171], v[80:83], v[64:67], v[168:171]
s_waitcnt lgkmcnt(0)
v_mfma_f32_16x16x32_bf16 v[160:163], v[80:83], v[60:63], v[160:163]
v_mfma_f32_16x16x32_bf16 v[212:215], v[124:127], v[112:115], v[212:215]
v_mfma_f32_16x16x32_bf16 v[204:207], v[124:127], v[108:111], v[204:207]
v_mfma_f32_16x16x32_bf16 v[196:199], v[124:127], v[104:107], v[196:199]
v_mfma_f32_16x16x32_bf16 v[188:191], v[124:127], v[100:103], v[188:191]
v_mfma_f32_16x16x32_bf16 v[192:195], v[128:131], v[100:103], v[192:195]
v_mfma_f32_16x16x32_bf16 v[200:203], v[128:131], v[104:107], v[200:203]
v_mfma_f32_16x16x32_bf16 v[208:211], v[128:131], v[108:111], v[208:211]
v_mfma_f32_16x16x32_bf16 v[216:219], v[128:131], v[112:115], v[216:219]
s_barrier
v_mfma_f32_16x16x32_bf16 v[244:247], v[112:115], v[132:135], v[244:247]
ds_read_b128 v[140:143], v7 offset:0
ds_read_b128 v[144:147], v7 offset:64
v_mfma_f32_16x16x32_bf16 v[248:251], v[112:115], v[136:139], v[248:251]
ds_read_b128 v[148:151], v7 offset:256
ds_read_b128 v[152:155], v7 offset:320
v_mfma_f32_16x16x32_bf16 v[240:243], v[108:111], v[136:139], v[240:243]
ds_read_b64 v[92:93], v8 offset:0
ds_read_b64 v[94:95], v8 offset:128
v_mfma_f32_16x16x32_bf16 v[236:239], v[108:111], v[132:135], v[236:239]
ds_read_b64 v[96:97], v8 offset:256
ds_read_b64 v[98:99], v8 offset:384
v_mfma_f32_16x16x32_bf16 v[228:231], v[104:107], v[132:135], v[228:231]
ds_read2_b32 v[56:57], v54 offset0:128 offset1:144
ds_read_b128 v[60:63], v9 offset:0
v_mfma_f32_16x16x32_bf16 v[232:235], v[104:107], v[136:139], v[232:235]
ds_read_b128 v[64:67], v9 offset:64
v_mfma_f32_16x16x32_bf16 v[224:227], v[100:103], v[136:139], v[224:227]
ds_read_b128 v[68:71], v9 offset:128
v_mfma_f32_16x16x32_bf16 v[220:223], v[100:103], v[132:135], v[220:223]
ds_read_b128 v[72:75], v9 offset:192
v_mfma_f32_16x16x32_bf16 v[156:159], v[116:119], v[100:103], v[156:159]
ds_read_b128 v[76:79], v9 offset:512
v_mfma_f32_16x16x32_bf16 v[164:167], v[116:119], v[104:107], v[164:167]
ds_read_b128 v[80:83], v9 offset:576
v_mfma_f32_16x16x32_bf16 v[172:175], v[116:119], v[108:111], v[172:175]
ds_read_b128 v[84:87], v9 offset:640
v_mfma_f32_16x16x32_bf16 v[180:183], v[116:119], v[112:115], v[180:183]
ds_read_b128 v[88:91], v9 offset:704
v_mfma_f32_16x16x32_bf16 v[184:187], v[120:123], v[112:115], v[184:187]
v_mov_b32 v6, 134656
ds_read_b32 v6, v6
v_mfma_f32_16x16x32_bf16 v[176:179], v[120:123], v[108:111], v[176:179]
v_mfma_f32_16x16x32_bf16 v[168:171], v[120:123], v[104:107], v[168:171]
v_mfma_f32_16x16x32_bf16 v[160:163], v[120:123], v[100:103], v[160:163]
c0_epi:
s_waitcnt lgkmcnt(0)
v_readfirstlane_b32 s46, v6
.p2align 3
v_pk_fma_f32 v[212:213], v[148:149], v[98:99], v[212:213] op_sel:[0,1,0] op_sel_hi:[1,1,1]
v_pk_fma_f32 v[214:215], v[150:151], v[98:99], v[214:215] op_sel:[0,1,0] op_sel_hi:[1,1,1]
v_pk_fma_f32 v[216:217], v[152:153], v[98:99], v[216:217] op_sel:[0,1,0] op_sel_hi:[1,1,1]
v_pk_fma_f32 v[218:219], v[154:155], v[98:99], v[218:219] op_sel:[0,1,0] op_sel_hi:[1,1,1]
v_pk_mul_f32 v[212:213], v[212:213], v[98:99] op_sel:[0,0] op_sel_hi:[1,0]
v_pk_mul_f32 v[214:215], v[214:215], v[98:99] op_sel:[0,0] op_sel_hi:[1,0]
v_pk_mul_f32 v[216:217], v[216:217], v[98:99] op_sel:[0,0] op_sel_hi:[1,0]
v_pk_mul_f32 v[218:219], v[218:219], v[98:99] op_sel:[0,0] op_sel_hi:[1,0]
v_cvt_pk_bf16_f32 v212, v212, v213
v_cvt_pk_bf16_f32 v213, v214, v215
v_cvt_pk_bf16_f32 v214, v216, v217
v_cvt_pk_bf16_f32 v215, v218, v219
v_pk_fma_f32 v[244:245], v[88:89], v[56:57], v[244:245] op_sel:[0,0,0] op_sel_hi:[1,0,1]
v_pk_fma_f32 v[246:247], v[90:91], v[56:57], v[246:247] op_sel:[0,0,0] op_sel_hi:[1,0,1]
v_pk_mul_f32 v[244:245], v[244:245], v[72:73]
v_pk_mul_f32 v[246:247], v[246:247], v[74:75]
v_cvt_pk_bf16_f32 v108, v244, v245
v_cvt_pk_bf16_f32 v109, v246, v247
v_pk_fma_f32 v[248:249], v[88:89], v[56:57], v[248:249] op_sel:[0,1,0] op_sel_hi:[1,1,1]
v_pk_fma_f32 v[250:251], v[90:91], v[56:57], v[250:251] op_sel:[0,1,0] op_sel_hi:[1,1,1]
v_pk_mul_f32 v[248:249], v[248:249], v[72:73]
v_pk_mul_f32 v[250:251], v[250:251], v[74:75]
v_cvt_pk_bf16_f32 v118, v248, v249
v_cvt_pk_bf16_f32 v119, v250, v251
s_cmp_lg_u32 s44, 1
s_cbranch_scc1 else_61
buffer_store_dwordx4 v[212:215], v58, s[32:35], 0 offen sc1
buffer_store_dwordx2 v[108:109], v59, s[32:35], 0 offen offset:1024 sc1
buffer_store_dwordx2 v[118:119], v59, s[32:35], 0 offen offset:1536 sc1
s_branch fi_62
else_61:
ds_write_b128 v53, v[212:215]
ds_write_b64 v55, v[108:109] offset:1024
ds_write_b64 v55, v[118:119] offset:1536
v_mov_b32 v4, 1
ds_write_b32 v19, v4
fi_62:
.p2align 3
v_pk_fma_f32 v[188:189], v[148:149], v[92:93], v[188:189] op_sel:[0,1,0] op_sel_hi:[1,1,1]
v_pk_fma_f32 v[196:197], v[148:149], v[94:95], v[196:197] op_sel:[0,1,0] op_sel_hi:[1,1,1]
v_pk_fma_f32 v[204:205], v[148:149], v[96:97], v[204:205] op_sel:[0,1,0] op_sel_hi:[1,1,1]
v_pk_fma_f32 v[164:165], v[140:141], v[94:95], v[164:165] op_sel:[0,1,0] op_sel_hi:[1,1,1]
v_pk_fma_f32 v[172:173], v[140:141], v[96:97], v[172:173] op_sel:[0,1,0] op_sel_hi:[1,1,1]
v_pk_fma_f32 v[180:181], v[140:141], v[98:99], v[180:181] op_sel:[0,1,0] op_sel_hi:[1,1,1]
v_pk_fma_f32 v[190:191], v[150:151], v[92:93], v[190:191] op_sel:[0,1,0] op_sel_hi:[1,1,1]
v_pk_mul_f32 v[188:189], v[188:189], v[92:93] op_sel:[0,0] op_sel_hi:[1,0]
v_pk_fma_f32 v[198:199], v[150:151], v[94:95], v[198:199] op_sel:[0,1,0] op_sel_hi:[1,1,1]
v_pk_mul_f32 v[196:197], v[196:197], v[94:95] op_sel:[0,0] op_sel_hi:[1,0]
v_pk_fma_f32 v[206:207], v[150:151], v[96:97], v[206:207] op_sel:[0,1,0] op_sel_hi:[1,1,1]
v_pk_mul_f32 v[204:205], v[204:205], v[96:97] op_sel:[0,0] op_sel_hi:[1,0]
v_pk_fma_f32 v[166:167], v[142:143], v[94:95], v[166:167] op_sel:[0,1,0] op_sel_hi:[1,1,1]
v_cvt_pk_bf16_f32 v164, v164, v165
v_pk_fma_f32 v[174:175], v[142:143], v[96:97], v[174:175] op_sel:[0,1,0] op_sel_hi:[1,1,1]
v_cvt_pk_bf16_f32 v172, v172, v173
v_pk_fma_f32 v[182:183], v[142:143], v[98:99], v[182:183] op_sel:[0,1,0] op_sel_hi:[1,1,1]
v_cvt_pk_bf16_f32 v180, v180, v181
v_pk_fma_f32 v[192:193], v[152:153], v[92:93], v[192:193] op_sel:[0,1,0] op_sel_hi:[1,1,1]
v_pk_fma_f32 v[194:195], v[154:155], v[92:93], v[194:195] op_sel:[0,1,0] op_sel_hi:[1,1,1]
v_pk_mul_f32 v[190:191], v[190:191], v[92:93] op_sel:[0,0] op_sel_hi:[1,0]
v_cvt_pk_bf16_f32 v188, v188, v189
v_pk_fma_f32 v[200:201], v[152:153], v[94:95], v[200:201] op_sel:[0,1,0] op_sel_hi:[1,1,1]
v_pk_fma_f32 v[202:203], v[154:155], v[94:95], v[202:203] op_sel:[0,1,0] op_sel_hi:[1,1,1]
v_pk_mul_f32 v[198:199], v[198:199], v[94:95] op_sel:[0,0] op_sel_hi:[1,0]
v_cvt_pk_bf16_f32 v196, v196, v197
v_pk_fma_f32 v[208:209], v[152:153], v[96:97], v[208:209] op_sel:[0,1,0] op_sel_hi:[1,1,1]
v_pk_fma_f32 v[210:211], v[154:155], v[96:97], v[210:211] op_sel:[0,1,0] op_sel_hi:[1,1,1]
v_pk_mul_f32 v[206:207], v[206:207], v[96:97] op_sel:[0,0] op_sel_hi:[1,0]
v_cvt_pk_bf16_f32 v204, v204, v205
v_pk_fma_f32 v[168:169], v[144:145], v[94:95], v[168:169] op_sel:[0,1,0] op_sel_hi:[1,1,1]
v_pk_fma_f32 v[170:171], v[146:147], v[94:95], v[170:171] op_sel:[0,1,0] op_sel_hi:[1,1,1]
v_cvt_pk_bf16_f32 v165, v166, v167
v_pk_fma_f32 v[176:177], v[144:145], v[96:97], v[176:177] op_sel:[0,1,0] op_sel_hi:[1,1,1]
v_pk_fma_f32 v[178:179], v[146:147], v[96:97], v[178:179] op_sel:[0,1,0] op_sel_hi:[1,1,1]
v_cvt_pk_bf16_f32 v173, v174, v175
v_pk_fma_f32 v[184:185], v[144:145], v[98:99], v[184:185] op_sel:[0,1,0] op_sel_hi:[1,1,1]
v_pk_fma_f32 v[186:187], v[146:147], v[98:99], v[186:187] op_sel:[0,1,0] op_sel_hi:[1,1,1]
v_cvt_pk_bf16_f32 v181, v182, v183
v_pk_mul_f32 v[192:193], v[192:193], v[92:93] op_sel:[0,0] op_sel_hi:[1,0]
v_pk_mul_f32 v[194:195], v[194:195], v[92:93] op_sel:[0,0] op_sel_hi:[1,0]
v_cvt_pk_bf16_f32 v189, v190, v191
v_pk_mul_f32 v[200:201], v[200:201], v[94:95] op_sel:[0,0] op_sel_hi:[1,0]
v_pk_mul_f32 v[202:203], v[202:203], v[94:95] op_sel:[0,0] op_sel_hi:[1,0]
v_cvt_pk_bf16_f32 v197, v198, v199
v_pk_mul_f32 v[208:209], v[208:209], v[96:97] op_sel:[0,0] op_sel_hi:[1,0]
v_pk_mul_f32 v[210:211], v[210:211], v[96:97] op_sel:[0,0] op_sel_hi:[1,0]
v_cvt_pk_bf16_f32 v205, v206, v207
v_cvt_pk_bf16_f32 v166, v168, v169
v_cvt_pk_bf16_f32 v167, v170, v171
v_cvt_pk_bf16_f32 v174, v176, v177
v_cvt_pk_bf16_f32 v175, v178, v179
v_cvt_pk_bf16_f32 v182, v184, v185
v_cvt_pk_bf16_f32 v183, v186, v187
v_cvt_pk_bf16_f32 v190, v192, v193
v_cvt_pk_bf16_f32 v191, v194, v195
v_mfma_f32_16x16x32_bf16 v[216:219], v[212:215], v[180:183], v[40:43]
v_cvt_pk_bf16_f32 v198, v200, v201
v_cvt_pk_bf16_f32 v199, v202, v203
v_mfma_f32_16x16x32_bf16 v[168:171], v[188:191], v[164:167], v[36:39]
v_cvt_pk_bf16_f32 v206, v208, v209
v_cvt_pk_bf16_f32 v207, v210, v211
v_mfma_f32_16x16x32_bf16 v[200:203], v[196:199], v[164:167], v[40:43]
v_mul_f32 v124, s66, v92
v_mul_f32 v125, s66, v94
v_mfma_f32_16x16x32_bf16 v[208:211], v[204:207], v[172:175], v[40:43]
v_mul_f32 v126, s66, v96
v_mul_f32 v127, s66, v98
v_mfma_f32_16x16x32_bf16 v[176:179], v[196:199], v[172:175], v[36:39]
v_max_f32 v164, v168, v169
v_max_f32 v165, v170, v171
v_mfma_f32_16x16x32_bf16 v[184:187], v[204:207], v[180:183], v[36:39]
v_max_f32 v166, v200, v201
v_max_f32 v182, v216, v217
v_max_f32 v174, v208, v209
v_max_f32 v167, v202, v203
v_max3_f32 v129, v164, v165, v166
v_pk_fma_f32 v[156:157], v[140:141], v[92:93], v[156:157] op_sel:[0,1,0] op_sel_hi:[1,1,1]
v_pk_fma_f32 v[158:159], v[142:143], v[92:93], v[158:159] op_sel:[0,1,0] op_sel_hi:[1,1,1]
v_cvt_pk_bf16_f32 v156, v156, v157
v_pk_fma_f32 v[160:161], v[144:145], v[92:93], v[160:161] op_sel:[0,1,0] op_sel_hi:[1,1,1]
v_pk_fma_f32 v[162:163], v[146:147], v[92:93], v[162:163] op_sel:[0,1,0] op_sel_hi:[1,1,1]
v_cvt_pk_bf16_f32 v157, v158, v159
v_cvt_pk_bf16_f32 v158, v160, v161
v_cvt_pk_bf16_f32 v159, v162, v163
v_pk_fma_f32 v[220:221], v[76:77], v[56:57], v[220:221] op_sel:[0,0,0] op_sel_hi:[1,0,1]
v_pk_fma_f32 v[222:223], v[78:79], v[56:57], v[222:223] op_sel:[0,0,0] op_sel_hi:[1,0,1]
v_mfma_f32_16x16x32_bf16 v[192:195], v[188:191], v[156:159], v[40:43]
v_max_f32 v172, v176, v177
v_max_f32 v173, v178, v179
v_max_f32 v180, v184, v185
v_max_f32 v181, v186, v187
v_max_f32_e64 v175, v210, v211
v_pk_fma_f32 v[224:225], v[76:77], v[56:57], v[224:225] op_sel:[0,1,0] op_sel_hi:[1,1,1]
v_pk_fma_f32 v[226:227], v[78:79], v[56:57], v[226:227] op_sel:[0,1,0] op_sel_hi:[1,1,1]
v_pk_fma_f32 v[228:229], v[80:81], v[56:57], v[228:229] op_sel:[0,0,0] op_sel_hi:[1,0,1]
v_pk_fma_f32 v[230:231], v[82:83], v[56:57], v[230:231] op_sel:[0,0,0] op_sel_hi:[1,0,1]
v_pk_fma_f32 v[232:233], v[80:81], v[56:57], v[232:233] op_sel:[0,1,0] op_sel_hi:[1,1,1]
v_pk_fma_f32 v[234:235], v[82:83], v[56:57], v[234:235] op_sel:[0,1,0] op_sel_hi:[1,1,1]
v_pk_fma_f32 v[236:237], v[84:85], v[56:57], v[236:237] op_sel:[0,0,0] op_sel_hi:[1,0,1]
v_pk_fma_f32 v[238:239], v[86:87], v[56:57], v[238:239] op_sel:[0,0,0] op_sel_hi:[1,0,1]
v_pk_fma_f32 v[240:241], v[84:85], v[56:57], v[240:241] op_sel:[0,1,0] op_sel_hi:[1,1,1]
v_pk_fma_f32 v[242:243], v[86:87], v[56:57], v[242:243] op_sel:[0,1,0] op_sel_hi:[1,1,1]
v_pk_mul_f32 v[220:221], v[220:221], v[60:61]
v_pk_mul_f32 v[222:223], v[222:223], v[62:63]
v_pk_mul_f32 v[224:225], v[224:225], v[60:61]
s_cmp_lg_u32 s44, 0
s_cbranch_scc1 else_63
buffer_load_dwordx4 v[120:123], v58, s[32:35], 0 offen sc1
buffer_load_dwordx2 v[100:101], v59, s[32:35], 0 offen offset:1024 sc1
buffer_load_dwordx2 v[110:111], v59, s[32:35], 0 offen offset:1536 sc1
else_63:
v_pk_mul_f32 v[226:227], v[226:227], v[62:63]
v_pk_mul_f32 v[228:229], v[228:229], v[64:65]
v_pk_mul_f32 v[230:231], v[230:231], v[66:67]
v_pk_mul_f32 v[232:233], v[232:233], v[64:65]
v_pk_mul_f32 v[234:235], v[234:235], v[66:67]
v_pk_mul_f32 v[236:237], v[236:237], v[68:69]
v_pk_mul_f32 v[238:239], v[238:239], v[70:71]
v_pk_mul_f32 v[240:241], v[240:241], v[68:69]
v_pk_mul_f32 v[242:243], v[242:243], v[70:71]
v_max3_f32 v130, v172, v173, v174
v_max_f32_e64 v183, v218, v219
v_max3_f32 v131, v180, v181, v182
v_cvt_pk_bf16_f32 v102, v220, v221
v_cvt_pk_bf16_f32 v103, v222, v223
v_cvt_pk_bf16_f32 v112, v224, v225
v_cvt_pk_bf16_f32 v113, v226, v227
v_cvt_pk_bf16_f32 v104, v228, v229
v_cvt_pk_bf16_f32 v105, v230, v231
v_cvt_pk_bf16_f32 v114, v232, v233
v_cvt_pk_bf16_f32 v115, v234, v235
v_cvt_pk_bf16_f32 v106, v236, v237
v_cvt_pk_bf16_f32 v107, v238, v239
v_cvt_pk_bf16_f32 v116, v240, v241
v_cvt_pk_bf16_f32 v117, v242, v243
v_max_f32 v129, v129, v167
v_max_f32 v130, v130, v175
v_max_f32 v131, v131, v183
s_cmp_lg_u32 s44, 0
s_cbranch_scc1 else_65
s_mov_b32 s63, 0
sent_67:
s_waitcnt vmcnt(0)
v_max_u32 v4, v120, v121
v_max3_u32 v4, v4, v122, v123
v_max3_u32 v4, v4, v100, v101
v_max3_u32 v4, v4, v110, v111
v_cmp_eq_u32 vcc, -1, v4
s_cbranch_vccz sentd_68
buffer_load_dwordx4 v[120:123], v58, s[32:35], 0 offen sc1
buffer_load_dwordx2 v[100:101], v59, s[32:35], 0 offen offset:1024 sc1
buffer_load_dwordx2 v[110:111], v59, s[32:35], 0 offen offset:1536 sc1
s_add_u32 s63, s63, 1
s_cmp_lt_u32 s63, 0x80000
s_cbranch_scc1 sent_67
s_waitcnt vmcnt(0)
sentd_68:
v_mov_b32 v132, -1
v_mov_b32 v133, -1
v_mov_b32 v134, -1
v_mov_b32 v135, -1
buffer_store_dwordx4 v[132:135], v58, s[32:35], 0 offen offset:0 sc1
buffer_store_dwordx4 v[132:135], v58, s[32:35], 0 offen offset:1024 sc1
s_branch fi_66
else_65:
s_mov_b32 s63, 0
px_69:
ds_read_b32 v4, v19
ds_read_b128 v[120:123], v53
ds_read_b64 v[100:101], v55 offset:1024
ds_read_b64 v[110:111], v55 offset:1536
s_add_u32 s63, s63, 1
s_cmp_lt_u32 s63, 0x400000
s_waitcnt lgkmcnt(0)
v_cmp_ne_u32 vcc, 1, v4
s_cbranch_vccz pxd_70
s_cbranch_scc1 px_69
pxd_70:
fi_66:
s_cmp_eq_u32 s46, 0
s_cbranch_scc1 slow_71
.p2align 3
v_mfma_f32_16x16x32_bf16 v[160:163], v[120:123], v[156:159], v[44:47]
v_max_f32 v158, v192, v193
v_max_f32 v159, v194, v195
v_permlane32_swap_b32 v130, v131
s_nop 0
v_max_f32 v130, v130, v131
s_nop 2
v_max_f32 v156, v160, v161
v_max_f32 v157, v162, v163
v_max3_f32 v128, v156, v157, v158
v_max_f32 v128, v128, v159
s_nop 1
v_permlane32_swap_b32 v128, v129
s_nop 0
v_max_f32 v128, v128, v129
s_nop 1
v_permlane16_swap_b32 v128, v130
s_nop 0
v_max_f32 v128, v128, v130
v_mov_b32 v130, v128
s_nop 1
v_permlane16_swap_b32 v128, v130
s_nop 0
v_mov_b32 v129, v128
v_mov_b32 v131, v130
s_nop 0
v_permlane32_swap_b32 v128, v129
v_permlane32_swap_b32 v130, v131
v_mul_f32 v128, v128, v124
v_mul_f32 v129, v129, v125
v_pk_fma_f32 v[156:157], v[156:157], v[124:125], v[128:129] op_sel:[0,0,0] op_sel_hi:[1,0,0] neg_lo:[0,0,1] neg_hi:[0,0,1]
v_pk_fma_f32 v[158:159], v[158:159], v[124:125], v[128:129] op_sel:[0,0,0] op_sel_hi:[1,0,0] neg_lo:[0,0,1] neg_hi:[0,0,1]
v_mul_f32 v130, v130, v126
v_mul_f32 v131, v131, v127
v_exp_f32 v156, v156
v_exp_f32 v157, v157
v_exp_f32 v158, v158
v_exp_f32 v159, v159
v_pk_fma_f32 v[164:165], v[164:165], v[124:125], v[128:129] op_sel:[0,1,1] op_sel_hi:[1,1,1] neg_lo:[0,0,1] neg_hi:[0,0,1]
v_pk_fma_f32 v[166:167], v[166:167], v[124:125], v[128:129] op_sel:[0,1,1] op_sel_hi:[1,1,1] neg_lo:[0,0,1] neg_hi:[0,0,1]
v_exp_f32 v164, v164
v_exp_f32 v165, v165
v_exp_f32 v166, v166
v_exp_f32 v167, v167
v_pk_fma_f32 v[172:173], v[172:173], v[126:127], v[130:131] op_sel:[0,0,0] op_sel_hi:[1,0,0] neg_lo:[0,0,1] neg_hi:[0,0,1]
v_pk_fma_f32 v[174:175], v[174:175], v[126:127], v[130:131] op_sel:[0,0,0] op_sel_hi:[1,0,0] neg_lo:[0,0,1] neg_hi:[0,0,1]
v_cvt_pk_bf16_f32 v156, v156, v156
v_cvt_pk_bf16_f32 v157, v157, v157
v_cvt_pk_bf16_f32 v158, v158, v158
v_cvt_pk_bf16_f32 v159, v159, v159
v_exp_f32 v172, v172
v_exp_f32 v173, v173
v_exp_f32 v174, v174
v_exp_f32 v175, v175
v_pk_fma_f32 v[180:181], v[180:181], v[126:127], v[130:131] op_sel:[0,1,1] op_sel_hi:[1,1,1] neg_lo:[0,0,1] neg_hi:[0,0,1]
v_pk_fma_f32 v[182:183], v[182:183], v[126:127], v[130:131] op_sel:[0,1,1] op_sel_hi:[1,1,1] neg_lo:[0,0,1] neg_hi:[0,0,1]
v_and_b32 v156, v52, v156
v_and_b32 v157, v52, v157
v_and_b32 v158, v52, v158
v_and_b32 v159, v52, v159
v_cvt_pk_bf16_f32 v164, v164, v164
v_cvt_pk_bf16_f32 v165, v165, v165
v_mfma_f32_16x16x32_bf16 v[160:163], v[48:51], v[156:159], 0
v_cvt_pk_bf16_f32 v166, v166, v166
v_cvt_pk_bf16_f32 v167, v167, v167
v_mfma_f32_16x16x32_bf16 v[220:223], v[100:103], v[156:159], 0
v_exp_f32 v180, v180
v_mfma_f32_16x16x32_bf16 v[224:227], v[110:113], v[156:159], 0
v_exp_f32 v181, v181
v_exp_f32 v182, v182
v_exp_f32 v183, v183
v_and_b32 v164, v52, v164
v_and_b32 v165, v52, v165
v_and_b32 v166, v52, v166
v_and_b32 v167, v52, v167
v_cvt_pk_bf16_f32 v172, v172, v172
v_cvt_pk_bf16_f32 v173, v173, v173
v_mfma_f32_16x16x32_bf16 v[168:171], v[48:51], v[164:167], 0
v_cvt_pk_bf16_f32 v174, v174, v174
v_cvt_pk_bf16_f32 v175, v175, v175
v_mfma_f32_16x16x32_bf16 v[228:231], v[102:105], v[164:167], 0
v_and_b32 v172, v52, v172
v_and_b32 v173, v52, v173
v_mfma_f32_16x16x32_bf16 v[232:235], v[112:115], v[164:167], 0
v_and_b32 v174, v52, v174
v_and_b32 v175, v52, v175
v_cvt_pk_bf16_f32 v180, v180, v180
v_cvt_pk_bf16_f32 v181, v181, v181
v_mfma_f32_16x16x32_bf16 v[176:179], v[48:51], v[172:175], 0
v_cvt_pk_bf16_f32 v182, v182, v182
v_cvt_pk_bf16_f32 v183, v183, v183
v_mfma_f32_16x16x32_bf16 v[236:239], v[104:107], v[172:175], 0
v_and_b32 v180, v52, v180
v_and_b32 v181, v52, v181
v_mfma_f32_16x16x32_bf16 v[240:243], v[114:117], v[172:175], 0
v_and_b32 v182, v52, v182
v_and_b32 v183, v52, v183
v_rcp_f32 v160, v160
v_rcp_f32 v168, v168
v_pk_mul_f32 v[220:221], v[220:221], v[160:161] op_sel:[0,0] op_sel_hi:[1,0]
v_pk_mul_f32 v[222:223], v[222:223], v[160:161] op_sel:[0,0] op_sel_hi:[1,0]
v_pk_mul_f32 v[228:229], v[228:229], v[168:169] op_sel:[0,0] op_sel_hi:[1,0]
v_pk_mul_f32 v[224:225], v[224:225], v[160:161] op_sel:[0,0] op_sel_hi:[1,0]
v_pk_mul_f32 v[226:227], v[226:227], v[160:161] op_sel:[0,0] op_sel_hi:[1,0]
v_pk_mul_f32 v[230:231], v[230:231], v[168:169] op_sel:[0,0] op_sel_hi:[1,0]
v_pk_mul_f32 v[232:233], v[232:233], v[168:169] op_sel:[0,0] op_sel_hi:[1,0]
v_pk_mul_f32 v[234:235], v[234:235], v[168:169] op_sel:[0,0] op_sel_hi:[1,0]
v_mfma_f32_16x16x32_bf16 v[184:187], v[48:51], v[180:183], 0
v_rcp_f32_e64 v176, v176
v_cvt_pk_bf16_f32 v220, v220, v221
v_cvt_pk_bf16_f32 v221, v222, v223
v_cvt_pk_bf16_f32 v228, v228, v229
v_pk_mul_f32 v[236:237], v[236:237], v[176:177] op_sel:[0,0] op_sel_hi:[1,0]
v_mfma_f32_16x16x32_bf16 v[244:247], v[106:109], v[180:183], 0
v_cvt_pk_bf16_f32 v222, v224, v225
v_cvt_pk_bf16_f32 v223, v226, v227
v_rcp_f32_e64 v184, v184
v_cvt_pk_bf16_f32 v229, v230, v231
v_pk_mul_f32 v[238:239], v[238:239], v[176:177] op_sel:[0,0] op_sel_hi:[1,0]
v_pk_mul_f32 v[240:241], v[240:241], v[176:177] op_sel:[0,0] op_sel_hi:[1,0]
v_pk_mul_f32 v[242:243], v[242:243], v[176:177] op_sel:[0,0] op_sel_hi:[1,0]
v_cvt_pk_bf16_f32 v236, v236, v237
v_pk_mul_f32 v[244:245], v[244:245], v[184:185] op_sel:[0,0] op_sel_hi:[1,0]
v_pk_mul_f32 v[246:247], v[246:247], v[184:185] op_sel:[0,0] op_sel_hi:[1,0]
v_mfma_f32_16x16x32_bf16 v[248:251], v[116:119], v[180:183], 0
buffer_store_dwordx4 v[220:223], v18, s[32:35], s80 offen sc1
v_cvt_pk_bf16_f32 v230, v232, v233
v_cvt_pk_bf16_f32 v231, v234, v235
v_cvt_pk_bf16_f32 v237, v238, v239
v_cvt_pk_bf16_f32 v244, v244, v245
buffer_store_dwordx4 v[228:231], v18, s[32:35], s81 offen sc1
v_cvt_pk_bf16_f32 v238, v240, v241
v_cvt_pk_bf16_f32 v239, v242, v243
v_pk_mul_f32 v[248:249], v[248:249], v[184:185] op_sel:[0,0] op_sel_hi:[1,0]
v_pk_mul_f32 v[250:251], v[250:251], v[184:185] op_sel:[0,0] op_sel_hi:[1,0]
v_cvt_pk_bf16_f32 v245, v246, v247
buffer_store_dwordx4 v[236:239], v18, s[32:35], s82 offen sc1
v_cvt_pk_bf16_f32 v246, v248, v249
v_cvt_pk_bf16_f32 v247, v250, v251
buffer_store_dwordx4 v[244:247], v18, s[32:35], s83 offen sc1
back_72:
s_barrier
v_and_b32 v36, 31, v0
v_lshlrev_b32 v36, 2, v36
s_lshl_b32 s62, s45, 2
v_mov_b32 v4, s62
v_mov_b32 v5, 1
s_mov_b64 exec, 1
s_waitcnt vmcnt(0)
s_cmp_eq_u32 s46, 0
s_cbranch_scc1 slow_73
buffer_store_dword v5, v4, s[32:35], s84 offen
back_74:
s_mov_b64 exec, -1
v_lshrrev_b32 v4, 2, v2
v_and_b32 v5, 3, v0
v_lshl_add_u32 v6, v3, 3, v4
v_lshlrev_b32 v6, 7, v6
v_lshl_add_u32 v6, v5, 3, v6
v_lshrrev_b32 v7, 1, v4
v_and_b32 v8, 1, v3
v_lshl_add_u32 v7, v8, 1, v7
v_lshl_add_u32 v10, v7, 5, v6
v_xor_b32 v11, 32, v10
v_xor_b32 v12, 64, v10
v_xor_b32 v13, 96, v10
v_add_u32 v14, 0x10000, v10
v_add_u32 v15, 0x10000, v11
v_add_u32 v16, 0x10000, v12
v_add_u32 v17, 0x10000, v13
ds_read_b64_tr_b16 v[220:221], v10 offset:0
ds_read_b64_tr_b16 v[222:223], v10 offset:512
ds_read_b64_tr_b16 v[224:225], v11 offset:0
ds_read_b64_tr_b16 v[226:227], v11 offset:512
ds_read_b64_tr_b16 v[228:229], v12 offset:0
ds_read_b64_tr_b16 v[230:231], v12 offset:512
ds_read_b64_tr_b16 v[232:233], v13 offset:0
ds_read_b64_tr_b16 v[234:235], v13 offset:512
ds_read_b64_tr_b16 v[236:237], v10 offset:4096
ds_read_b64_tr_b16 v[238:239], v10 offset:4608
ds_read_b64_tr_b16 v[240:241], v11 offset:4096
ds_read_b64_tr_b16 v[242:243], v11 offset:4608
ds_read_b64_tr_b16 v[244:245], v12 offset:4096
ds_read_b64_tr_b16 v[246:247], v12 offset:4608
ds_read_b64_tr_b16 v[248:249], v13 offset:4096
ds_read_b64_tr_b16 v[250:251], v13 offset:4608
s_lshl_b32 s48, s41, 3
s_lshl_b32 s49, s40, 1
s_add_u32 s48, s48, s49
s_lshl_b32 s48, s48, 15
s_add_u32 s48, s48, 4194304
v_add_u32 v38, s48, v18
v_add_u32 v39, 32768, v38
s_lshl_b32 s57, s75, 11
s_add_u32 s87, s87, 262144
v_lshlrev_b32 v60, 16, v20
v_and_b32 v61, 0xffff0000, v20
v_lshlrev_b32 v62, 16, v21
v_and_b32 v63, 0xffff0000, v21
v_lshlrev_b32 v64, 16, v22
v_and_b32 v65, 0xffff0000, v22
v_lshlrev_b32 v66, 16, v23
v_and_b32 v67, 0xffff0000, v23
v_lshlrev_b32 v68, 16, v24
v_and_b32 v69, 0xffff0000, v24
v_lshlrev_b32 v70, 16, v25
v_and_b32 v71, 0xffff0000, v25
v_lshlrev_b32 v72, 16, v26
v_and_b32 v73, 0xffff0000, v26
v_lshlrev_b32 v74, 16, v27
v_and_b32 v75, 0xffff0000, v27
v_lshlrev_b32 v76, 16, v28
v_and_b32 v77, 0xffff0000, v28
v_lshlrev_b32 v78, 16, v29
v_and_b32 v79, 0xffff0000, v29
v_lshlrev_b32 v80, 16, v30
v_and_b32 v81, 0xffff0000, v30
v_lshlrev_b32 v82, 16, v31
v_and_b32 v83, 0xffff0000, v31
v_lshlrev_b32 v84, 16, v32
v_and_b32 v85, 0xffff0000, v32
v_lshlrev_b32 v86, 16, v33
v_and_b32 v87, 0xffff0000, v33
v_lshlrev_b32 v88, 16, v34
v_and_b32 v89, 0xffff0000, v34
v_lshlrev_b32 v90, 16, v35
v_and_b32 v91, 0xffff0000, v35
v_mov_b32 v6, 0
v_mov_b32 v7, 0
v_mov_b32 v8, 0
v_mov_b32 v9, 0
s_lshl_b32 s62, s42, 2
v_mov_b32 v4, s62
v_mov_b32 v5, 1
buffer_load_dword v37, v36, s[32:35], s84 offen sc1
s_mov_b32 s63, 0
s_waitcnt vmcnt(0)
poll_75:
v_cmp_gt_u32 vcc, 1, v37
s_cbranch_vccz polled_76
buffer_load_dword v37, v36, s[32:35], s84 offen sc1
s_add_u32 s63, s63, 1
s_cmp_lt_u32 s63, 0x80000
s_waitcnt vmcnt(0)
s_cbranch_scc1 poll_75
polled_76:
s_getpc_b64 s[94:95]
pc_77:
s_add_u32 s94, s94, R_oloop_end - pc_77
s_addc_u32 s95, s95, 0
R_oloop:
buffer_load_dwordx4 v[156:159], v38, s[32:35], s57 offen sc1
buffer_load_dwordx4 v[160:163], v39, s[32:35], s57 offen sc1
buffer_load_dwordx4 v[164:167], v38, s[32:35], s57 offen offset:1024 sc1
buffer_load_dwordx4 v[168:171], v39, s[32:35], s57 offen offset:1024 sc1
s_add_u32 s57, s57, 2048
s_and_b32 s57, s57, 0x7fff
buffer_load_dwordx4 v[172:175], v38, s[32:35], s57 offen sc1
buffer_load_dwordx4 v[176:179], v39, s[32:35], s57 offen sc1
buffer_load_dwordx4 v[180:183], v38, s[32:35], s57 offen offset:1024 sc1
buffer_load_dwordx4 v[184:187], v39, s[32:35], s57 offen offset:1024 sc1
s_add_u32 s57, s57, 2048
s_and_b32 s57, s57, 0x7fff
buffer_load_dwordx4 v[188:191], v38, s[32:35], s57 offen sc1
buffer_load_dwordx4 v[192:195], v39, s[32:35], s57 offen sc1
s_waitcnt vmcnt(8) lgkmcnt(8)
v_mfma_f32_16x16x32_bf16 v[60:63], v[220:223], v[156:159], v[60:63]
buffer_load_dwordx4 v[196:199], v38, s[32:35], s57 offen offset:1024 sc1
v_mfma_f32_16x16x32_bf16 v[76:79], v[220:223], v[160:163], v[76:79]
ds_read_b64_tr_b16 v[100:101], v10 offset:8192
ds_read_b64_tr_b16 v[102:103], v10 offset:8704
v_mfma_f32_16x16x32_bf16 v[80:83], v[224:227], v[160:163], v[80:83]
ds_read_b64_tr_b16 v[104:105], v11 offset:8192
ds_read_b64_tr_b16 v[106:107], v11 offset:8704
v_mfma_f32_16x16x32_bf16 v[64:67], v[224:227], v[156:159], v[64:67]
buffer_load_dwordx4 v[200:203], v39, s[32:35], s57 offen offset:1024 sc1
v_mfma_f32_16x16x32_bf16 v[68:71], v[228:231], v[156:159], v[68:71]
ds_read_b64_tr_b16 v[108:109], v12 offset:8192
ds_read_b64_tr_b16 v[110:111], v12 offset:8704
v_mfma_f32_16x16x32_bf16 v[84:87], v[228:231], v[160:163], v[84:87]
ds_read_b64_tr_b16 v[112:113], v13 offset:8192
ds_read_b64_tr_b16 v[114:115], v13 offset:8704
v_mfma_f32_16x16x32_bf16 v[88:91], v[232:235], v[160:163], v[88:91]
s_add_u32 s57, s57, 2048
s_and_b32 s57, s57, 0x7fff
v_mfma_f32_16x16x32_bf16 v[72:75], v[232:235], v[156:159], v[72:75]
s_waitcnt vmcnt(8) lgkmcnt(8)
v_mfma_f32_16x16x32_bf16 v[60:63], v[236:239], v[164:167], v[60:63]
buffer_load_dwordx4 v[204:207], v38, s[32:35], s57 offen sc1
v_mfma_f32_16x16x32_bf16 v[76:79], v[236:239], v[168:171], v[76:79]
ds_read_b64_tr_b16 v[220:221], v10 offset:12288
ds_read_b64_tr_b16 v[222:223], v10 offset:12800
v_mfma_f32_16x16x32_bf16 v[80:83], v[240:243], v[168:171], v[80:83]
ds_read_b64_tr_b16 v[224:225], v11 offset:12288
ds_read_b64_tr_b16 v[226:227], v11 offset:12800
v_mfma_f32_16x16x32_bf16 v[64:67], v[240:243], v[164:167], v[64:67]
buffer_load_dwordx4 v[208:211], v39, s[32:35], s57 offen sc1
v_mfma_f32_16x16x32_bf16 v[68:71], v[244:247], v[164:167], v[68:71]
ds_read_b64_tr_b16 v[228:229], v12 offset:12288
ds_read_b64_tr_b16 v[230:231], v12 offset:12800
v_mfma_f32_16x16x32_bf16 v[84:87], v[244:247], v[168:171], v[84:87]
ds_read_b64_tr_b16 v[232:233], v13 offset:12288
ds_read_b64_tr_b16 v[234:235], v13 offset:12800
v_mfma_f32_16x16x32_bf16 v[88:91], v[248:251], v[168:171], v[88:91]
v_mfma_f32_16x16x32_bf16 v[72:75], v[248:251], v[164:167], v[72:75]
s_waitcnt vmcnt(8) lgkmcnt(8)
v_mfma_f32_16x16x32_bf16 v[60:63], v[100:103], v[172:175], v[60:63]
buffer_load_dwordx4 v[212:215], v38, s[32:35], s57 offen offset:1024 sc1
v_mfma_f32_16x16x32_bf16 v[76:79], v[100:103], v[176:179], v[76:79]
ds_read_b64_tr_b16 v[236:237], v10 offset:16384
ds_read_b64_tr_b16 v[238:239], v10 offset:16896
v_mfma_f32_16x16x32_bf16 v[80:83], v[104:107], v[176:179], v[80:83]
ds_read_b64_tr_b16 v[240:241], v11 offset:16384
ds_read_b64_tr_b16 v[242:243], v11 offset:16896
v_mfma_f32_16x16x32_bf16 v[64:67], v[104:107], v[172:175], v[64:67]
buffer_load_dwordx4 v[216:219], v39, s[32:35], s57 offen offset:1024 sc1
v_mfma_f32_16x16x32_bf16 v[68:71], v[108:111], v[172:175], v[68:71]
ds_read_b64_tr_b16 v[244:245], v12 offset:16384
ds_read_b64_tr_b16 v[246:247], v12 offset:16896
v_mfma_f32_16x16x32_bf16 v[84:87], v[108:111], v[176:179], v[84:87]
ds_read_b64_tr_b16 v[248:249], v13 offset:16384
ds_read_b64_tr_b16 v[250:251], v13 offset:16896
v_mfma_f32_16x16x32_bf16 v[88:91], v[112:115], v[176:179], v[88:91]
s_add_u32 s57, s57, 2048
s_and_b32 s57, s57, 0x7fff
v_mfma_f32_16x16x32_bf16 v[72:75], v[112:115], v[172:175], v[72:75]
s_waitcnt vmcnt(8) lgkmcnt(8)
v_mfma_f32_16x16x32_bf16 v[60:63], v[220:223], v[180:183], v[60:63]
buffer_load_dwordx4 v[156:159], v38, s[32:35], s57 offen sc1
v_mfma_f32_16x16x32_bf16 v[76:79], v[220:223], v[184:187], v[76:79]
ds_read_b64_tr_b16 v[100:101], v10 offset:20480
ds_read_b64_tr_b16 v[102:103], v10 offset:20992
v_mfma_f32_16x16x32_bf16 v[80:83], v[224:227], v[184:187], v[80:83]
ds_read_b64_tr_b16 v[104:105], v11 offset:20480
ds_read_b64_tr_b16 v[106:107], v11 offset:20992
v_mfma_f32_16x16x32_bf16 v[64:67], v[224:227], v[180:183], v[64:67]
buffer_load_dwordx4 v[160:163], v39, s[32:35], s57 offen sc1
v_mfma_f32_16x16x32_bf16 v[68:71], v[228:231], v[180:183], v[68:71]
ds_read_b64_tr_b16 v[108:109], v12 offset:20480
ds_read_b64_tr_b16 v[110:111], v12 offset:20992
v_mfma_f32_16x16x32_bf16 v[84:87], v[228:231], v[184:187], v[84:87]
ds_read_b64_tr_b16 v[112:113], v13 offset:20480
ds_read_b64_tr_b16 v[114:115], v13 offset:20992
v_mfma_f32_16x16x32_bf16 v[88:91], v[232:235], v[184:187], v[88:91]
v_mfma_f32_16x16x32_bf16 v[72:75], v[232:235], v[180:183], v[72:75]
s_waitcnt vmcnt(8) lgkmcnt(8)
v_mfma_f32_16x16x32_bf16 v[60:63], v[236:239], v[188:191], v[60:63]
buffer_load_dwordx4 v[164:167], v38, s[32:35], s57 offen offset:1024 sc1
v_mfma_f32_16x16x32_bf16 v[76:79], v[236:239], v[192:195], v[76:79]
ds_read_b64_tr_b16 v[220:221], v10 offset:24576
ds_read_b64_tr_b16 v[222:223], v10 offset:25088
v_mfma_f32_16x16x32_bf16 v[80:83], v[240:243], v[192:195], v[80:83]
ds_read_b64_tr_b16 v[224:225], v11 offset:24576
ds_read_b64_tr_b16 v[226:227], v11 offset:25088
v_mfma_f32_16x16x32_bf16 v[64:67], v[240:243], v[188:191], v[64:67]
buffer_load_dwordx4 v[168:171], v39, s[32:35], s57 offen offset:1024 sc1
v_mfma_f32_16x16x32_bf16 v[68:71], v[244:247], v[188:191], v[68:71]
ds_read_b64_tr_b16 v[228:229], v12 offset:24576
ds_read_b64_tr_b16 v[230:231], v12 offset:25088
v_mfma_f32_16x16x32_bf16 v[84:87], v[244:247], v[192:195], v[84:87]
ds_read_b64_tr_b16 v[232:233], v13 offset:24576
ds_read_b64_tr_b16 v[234:235], v13 offset:25088
v_mfma_f32_16x16x32_bf16 v[88:91], v[248:251], v[192:195], v[88:91]
s_add_u32 s57, s57, 2048
s_and_b32 s57, s57, 0x7fff
v_mfma_f32_16x16x32_bf16 v[72:75], v[248:251], v[188:191], v[72:75]
s_waitcnt vmcnt(8) lgkmcnt(8)
v_mfma_f32_16x16x32_bf16 v[60:63], v[100:103], v[196:199], v[60:63]
buffer_load_dwordx4 v[172:175], v38, s[32:35], s57 offen sc1
v_mfma_f32_16x16x32_bf16 v[76:79], v[100:103], v[200:203], v[76:79]
ds_read_b64_tr_b16 v[236:237], v10 offset:28672
ds_read_b64_tr_b16 v[238:239], v10 offset:29184
v_mfma_f32_16x16x32_bf16 v[80:83], v[104:107], v[200:203], v[80:83]
ds_read_b64_tr_b16 v[240:241], v11 offset:28672
ds_read_b64_tr_b16 v[242:243], v11 offset:29184
v_mfma_f32_16x16x32_bf16 v[64:67], v[104:107], v[196:199], v[64:67]
buffer_load_dwordx4 v[176:179], v39, s[32:35], s57 offen sc1
v_mfma_f32_16x16x32_bf16 v[68:71], v[108:111], v[196:199], v[68:71]
ds_read_b64_tr_b16 v[244:245], v12 offset:28672
ds_read_b64_tr_b16 v[246:247], v12 offset:29184
v_mfma_f32_16x16x32_bf16 v[84:87], v[108:111], v[200:203], v[84:87]
ds_read_b64_tr_b16 v[248:249], v13 offset:28672
ds_read_b64_tr_b16 v[250:251], v13 offset:29184
v_mfma_f32_16x16x32_bf16 v[88:91], v[112:115], v[200:203], v[88:91]
v_mfma_f32_16x16x32_bf16 v[72:75], v[112:115], v[196:199], v[72:75]
s_waitcnt vmcnt(8) lgkmcnt(8)
v_mfma_f32_16x16x32_bf16 v[60:63], v[220:223], v[204:207], v[60:63]
buffer_load_dwordx4 v[180:183], v38, s[32:35], s57 offen offset:1024 sc1
v_mfma_f32_16x16x32_bf16 v[76:79], v[220:223], v[208:211], v[76:79]
ds_read_b64_tr_b16 v[100:101], v10 offset:32768
ds_read_b64_tr_b16 v[102:103], v10 offset:33280
v_mfma_f32_16x16x32_bf16 v[80:83], v[224:227], v[208:211], v[80:83]
ds_read_b64_tr_b16 v[104:105], v11 offset:32768
ds_read_b64_tr_b16 v[106:107], v11 offset:33280
v_mfma_f32_16x16x32_bf16 v[64:67], v[224:227], v[204:207], v[64:67]
buffer_load_dwordx4 v[184:187], v39, s[32:35], s57 offen offset:1024 sc1
v_mfma_f32_16x16x32_bf16 v[68:71], v[228:231], v[204:207], v[68:71]
ds_read_b64_tr_b16 v[108:109], v12 offset:32768
ds_read_b64_tr_b16 v[110:111], v12 offset:33280
v_mfma_f32_16x16x32_bf16 v[84:87], v[228:231], v[208:211], v[84:87]
ds_read_b64_tr_b16 v[112:113], v13 offset:32768
ds_read_b64_tr_b16 v[114:115], v13 offset:33280
v_mfma_f32_16x16x32_bf16 v[88:91], v[232:235], v[208:211], v[88:91]
s_add_u32 s57, s57, 2048
s_and_b32 s57, s57, 0x7fff
v_mfma_f32_16x16x32_bf16 v[72:75], v[232:235], v[204:207], v[72:75]
s_waitcnt vmcnt(8) lgkmcnt(8)
v_mfma_f32_16x16x32_bf16 v[60:63], v[236:239], v[212:215], v[60:63]
buffer_load_dwordx4 v[188:191], v38, s[32:35], s57 offen sc1
v_mfma_f32_16x16x32_bf16 v[76:79], v[236:239], v[216:219], v[76:79]
ds_read_b64_tr_b16 v[220:221], v10 offset:36864
ds_read_b64_tr_b16 v[222:223], v10 offset:37376
v_mfma_f32_16x16x32_bf16 v[80:83], v[240:243], v[216:219], v[80:83]
ds_read_b64_tr_b16 v[224:225], v11 offset:36864
ds_read_b64_tr_b16 v[226:227], v11 offset:37376
v_mfma_f32_16x16x32_bf16 v[64:67], v[240:243], v[212:215], v[64:67]
buffer_load_dwordx4 v[192:195], v39, s[32:35], s57 offen sc1
v_mfma_f32_16x16x32_bf16 v[68:71], v[244:247], v[212:215], v[68:71]
ds_read_b64_tr_b16 v[228:229], v12 offset:36864
ds_read_b64_tr_b16 v[230:231], v12 offset:37376
v_mfma_f32_16x16x32_bf16 v[84:87], v[244:247], v[216:219], v[84:87]
ds_read_b64_tr_b16 v[232:233], v13 offset:36864
ds_read_b64_tr_b16 v[234:235], v13 offset:37376
v_mfma_f32_16x16x32_bf16 v[88:91], v[248:251], v[216:219], v[88:91]
v_mfma_f32_16x16x32_bf16 v[72:75], v[248:251], v[212:215], v[72:75]
s_waitcnt vmcnt(8) lgkmcnt(8)
v_mfma_f32_16x16x32_bf16 v[60:63], v[100:103], v[156:159], v[60:63]
buffer_load_dwordx4 v[196:199], v38, s[32:35], s57 offen offset:1024 sc1
v_mfma_f32_16x16x32_bf16 v[76:79], v[100:103], v[160:163], v[76:79]
ds_read_b64_tr_b16 v[236:237], v10 offset:40960
ds_read_b64_tr_b16 v[238:239], v10 offset:41472
v_mfma_f32_16x16x32_bf16 v[80:83], v[104:107], v[160:163], v[80:83]
ds_read_b64_tr_b16 v[240:241], v11 offset:40960
ds_read_b64_tr_b16 v[242:243], v11 offset:41472
v_mfma_f32_16x16x32_bf16 v[64:67], v[104:107], v[156:159], v[64:67]
buffer_load_dwordx4 v[200:203], v39, s[32:35], s57 offen offset:1024 sc1
v_mfma_f32_16x16x32_bf16 v[68:71], v[108:111], v[156:159], v[68:71]
ds_read_b64_tr_b16 v[244:245], v12 offset:40960
ds_read_b64_tr_b16 v[246:247], v12 offset:41472
v_mfma_f32_16x16x32_bf16 v[84:87], v[108:111], v[160:163], v[84:87]
ds_read_b64_tr_b16 v[248:249], v13 offset:40960
ds_read_b64_tr_b16 v[250:251], v13 offset:41472
v_mfma_f32_16x16x32_bf16 v[88:91], v[112:115], v[160:163], v[88:91]
s_add_u32 s57, s57, 2048
s_and_b32 s57, s57, 0x7fff
v_mfma_f32_16x16x32_bf16 v[72:75], v[112:115], v[156:159], v[72:75]
s_waitcnt vmcnt(8) lgkmcnt(8)
v_mfma_f32_16x16x32_bf16 v[60:63], v[220:223], v[164:167], v[60:63]
buffer_load_dwordx4 v[204:207], v38, s[32:35], s57 offen sc1
v_mfma_f32_16x16x32_bf16 v[76:79], v[220:223], v[168:171], v[76:79]
ds_read_b64_tr_b16 v[100:101], v10 offset:45056
ds_read_b64_tr_b16 v[102:103], v10 offset:45568
v_mfma_f32_16x16x32_bf16 v[80:83], v[224:227], v[168:171], v[80:83]
ds_read_b64_tr_b16 v[104:105], v11 offset:45056
ds_read_b64_tr_b16 v[106:107], v11 offset:45568
v_mfma_f32_16x16x32_bf16 v[64:67], v[224:227], v[164:167], v[64:67]
buffer_load_dwordx4 v[208:211], v39, s[32:35], s57 offen sc1
v_mfma_f32_16x16x32_bf16 v[68:71], v[228:231], v[164:167], v[68:71]
ds_read_b64_tr_b16 v[108:109], v12 offset:45056
ds_read_b64_tr_b16 v[110:111], v12 offset:45568
v_mfma_f32_16x16x32_bf16 v[84:87], v[228:231], v[168:171], v[84:87]
ds_read_b64_tr_b16 v[112:113], v13 offset:45056
ds_read_b64_tr_b16 v[114:115], v13 offset:45568
v_mfma_f32_16x16x32_bf16 v[88:91], v[232:235], v[168:171], v[88:91]
v_mfma_f32_16x16x32_bf16 v[72:75], v[232:235], v[164:167], v[72:75]
s_waitcnt vmcnt(8) lgkmcnt(8)
v_mfma_f32_16x16x32_bf16 v[60:63], v[236:239], v[172:175], v[60:63]
buffer_load_dwordx4 v[212:215], v38, s[32:35], s57 offen offset:1024 sc1
v_mfma_f32_16x16x32_bf16 v[76:79], v[236:239], v[176:179], v[76:79]
ds_read_b64_tr_b16 v[220:221], v10 offset:49152
ds_read_b64_tr_b16 v[222:223], v10 offset:49664
v_mfma_f32_16x16x32_bf16 v[80:83], v[240:243], v[176:179], v[80:83]
ds_read_b64_tr_b16 v[224:225], v11 offset:49152
ds_read_b64_tr_b16 v[226:227], v11 offset:49664
v_mfma_f32_16x16x32_bf16 v[64:67], v[240:243], v[172:175], v[64:67]
buffer_load_dwordx4 v[216:219], v39, s[32:35], s57 offen offset:1024 sc1
v_mfma_f32_16x16x32_bf16 v[68:71], v[244:247], v[172:175], v[68:71]
ds_read_b64_tr_b16 v[228:229], v12 offset:49152
ds_read_b64_tr_b16 v[230:231], v12 offset:49664
v_mfma_f32_16x16x32_bf16 v[84:87], v[244:247], v[176:179], v[84:87]
ds_read_b64_tr_b16 v[232:233], v13 offset:49152
ds_read_b64_tr_b16 v[234:235], v13 offset:49664
v_mfma_f32_16x16x32_bf16 v[88:91], v[248:251], v[176:179], v[88:91]
s_add_u32 s57, s57, 2048
s_and_b32 s57, s57, 0x7fff
v_mfma_f32_16x16x32_bf16 v[72:75], v[248:251], v[172:175], v[72:75]
s_waitcnt vmcnt(8) lgkmcnt(8)
v_mfma_f32_16x16x32_bf16 v[60:63], v[100:103], v[180:183], v[60:63]
buffer_load_dwordx4 v[156:159], v38, s[32:35], s57 offen sc1
v_mfma_f32_16x16x32_bf16 v[76:79], v[100:103], v[184:187], v[76:79]
ds_read_b64_tr_b16 v[236:237], v10 offset:53248
ds_read_b64_tr_b16 v[238:239], v10 offset:53760
v_mfma_f32_16x16x32_bf16 v[80:83], v[104:107], v[184:187], v[80:83]
ds_read_b64_tr_b16 v[240:241], v11 offset:53248
ds_read_b64_tr_b16 v[242:243], v11 offset:53760
v_mfma_f32_16x16x32_bf16 v[64:67], v[104:107], v[180:183], v[64:67]
buffer_load_dwordx4 v[160:163], v39, s[32:35], s57 offen sc1
v_mfma_f32_16x16x32_bf16 v[68:71], v[108:111], v[180:183], v[68:71]
ds_read_b64_tr_b16 v[244:245], v12 offset:53248
ds_read_b64_tr_b16 v[246:247], v12 offset:53760
v_mfma_f32_16x16x32_bf16 v[84:87], v[108:111], v[184:187], v[84:87]
ds_read_b64_tr_b16 v[248:249], v13 offset:53248
ds_read_b64_tr_b16 v[250:251], v13 offset:53760
v_mfma_f32_16x16x32_bf16 v[88:91], v[112:115], v[184:187], v[88:91]
v_mfma_f32_16x16x32_bf16 v[72:75], v[112:115], v[180:183], v[72:75]
s_waitcnt vmcnt(8) lgkmcnt(8)
v_mfma_f32_16x16x32_bf16 v[60:63], v[220:223], v[188:191], v[60:63]
buffer_load_dwordx4 v[164:167], v38, s[32:35], s57 offen offset:1024 sc1
v_mfma_f32_16x16x32_bf16 v[76:79], v[220:223], v[192:195], v[76:79]
ds_read_b64_tr_b16 v[100:101], v10 offset:57344
ds_read_b64_tr_b16 v[102:103], v10 offset:57856
v_mfma_f32_16x16x32_bf16 v[80:83], v[224:227], v[192:195], v[80:83]
ds_read_b64_tr_b16 v[104:105], v11 offset:57344
ds_read_b64_tr_b16 v[106:107], v11 offset:57856
v_mfma_f32_16x16x32_bf16 v[64:67], v[224:227], v[188:191], v[64:67]
buffer_load_dwordx4 v[168:171], v39, s[32:35], s57 offen offset:1024 sc1
v_mfma_f32_16x16x32_bf16 v[68:71], v[228:231], v[188:191], v[68:71]
ds_read_b64_tr_b16 v[108:109], v12 offset:57344
ds_read_b64_tr_b16 v[110:111], v12 offset:57856
v_mfma_f32_16x16x32_bf16 v[84:87], v[228:231], v[192:195], v[84:87]
ds_read_b64_tr_b16 v[112:113], v13 offset:57344
ds_read_b64_tr_b16 v[114:115], v13 offset:57856
v_mfma_f32_16x16x32_bf16 v[88:91], v[232:235], v[192:195], v[88:91]
s_add_u32 s57, s57, 2048
s_and_b32 s57, s57, 0x7fff
v_mfma_f32_16x16x32_bf16 v[72:75], v[232:235], v[188:191], v[72:75]
s_waitcnt vmcnt(8) lgkmcnt(8)
v_mfma_f32_16x16x32_bf16 v[60:63], v[236:239], v[196:199], v[60:63]
buffer_load_dwordx4 v[172:175], v38, s[32:35], s57 offen sc1
v_mfma_f32_16x16x32_bf16 v[76:79], v[236:239], v[200:203], v[76:79]
ds_read_b64_tr_b16 v[220:221], v10 offset:61440
ds_read_b64_tr_b16 v[222:223], v10 offset:61952
v_mfma_f32_16x16x32_bf16 v[80:83], v[240:243], v[200:203], v[80:83]
ds_read_b64_tr_b16 v[224:225], v11 offset:61440
ds_read_b64_tr_b16 v[226:227], v11 offset:61952
v_mfma_f32_16x16x32_bf16 v[64:67], v[240:243], v[196:199], v[64:67]
buffer_load_dwordx4 v[176:179], v39, s[32:35], s57 offen sc1
v_mfma_f32_16x16x32_bf16 v[68:71], v[244:247], v[196:199], v[68:71]
ds_read_b64_tr_b16 v[228:229], v12 offset:61440
ds_read_b64_tr_b16 v[230:231], v12 offset:61952
v_mfma_f32_16x16x32_bf16 v[84:87], v[244:247], v[200:203], v[84:87]
ds_read_b64_tr_b16 v[232:233], v13 offset:61440
ds_read_b64_tr_b16 v[234:235], v13 offset:61952
v_mfma_f32_16x16x32_bf16 v[88:91], v[248:251], v[200:203], v[88:91]
v_mfma_f32_16x16x32_bf16 v[72:75], v[248:251], v[196:199], v[72:75]
s_waitcnt vmcnt(8) lgkmcnt(8)
v_mfma_f32_16x16x32_bf16 v[60:63], v[100:103], v[204:207], v[60:63]
buffer_load_dwordx4 v[180:183], v38, s[32:35], s57 offen offset:1024 sc1
v_mfma_f32_16x16x32_bf16 v[76:79], v[100:103], v[208:211], v[76:79]
ds_read_b64_tr_b16 v[236:237], v14 offset:0
ds_read_b64_tr_b16 v[238:239], v14 offset:512
v_mfma_f32_16x16x32_bf16 v[80:83], v[104:107], v[208:211], v[80:83]
ds_read_b64_tr_b16 v[240:241], v15 offset:0
ds_read_b64_tr_b16 v[242:243], v15 offset:512
v_mfma_f32_16x16x32_bf16 v[64:67], v[104:107], v[204:207], v[64:67]
buffer_load_dwordx4 v[184:187], v39, s[32:35], s57 offen offset:1024 sc1
v_mfma_f32_16x16x32_bf16 v[68:71], v[108:111], v[204:207], v[68:71]
ds_read_b64_tr_b16 v[244:245], v16 offset:0
ds_read_b64_tr_b16 v[246:247], v16 offset:512
v_mfma_f32_16x16x32_bf16 v[84:87], v[108:111], v[208:211], v[84:87]
ds_read_b64_tr_b16 v[248:249], v17 offset:0
ds_read_b64_tr_b16 v[250:251], v17 offset:512
v_mfma_f32_16x16x32_bf16 v[88:91], v[112:115], v[208:211], v[88:91]
s_add_u32 s57, s57, 2048
s_and_b32 s57, s57, 0x7fff
v_mfma_f32_16x16x32_bf16 v[72:75], v[112:115], v[204:207], v[72:75]
s_waitcnt vmcnt(8) lgkmcnt(8)
v_mfma_f32_16x16x32_bf16 v[60:63], v[220:223], v[212:215], v[60:63]
buffer_load_dwordx4 v[188:191], v38, s[32:35], s57 offen sc1
v_mfma_f32_16x16x32_bf16 v[76:79], v[220:223], v[216:219], v[76:79]
ds_read_b64_tr_b16 v[100:101], v14 offset:4096
ds_read_b64_tr_b16 v[102:103], v14 offset:4608
v_mfma_f32_16x16x32_bf16 v[80:83], v[224:227], v[216:219], v[80:83]
ds_read_b64_tr_b16 v[104:105], v15 offset:4096
ds_read_b64_tr_b16 v[106:107], v15 offset:4608
v_mfma_f32_16x16x32_bf16 v[64:67], v[224:227], v[212:215], v[64:67]
buffer_load_dwordx4 v[192:195], v39, s[32:35], s57 offen sc1
v_mfma_f32_16x16x32_bf16 v[68:71], v[228:231], v[212:215], v[68:71]
ds_read_b64_tr_b16 v[108:109], v16 offset:4096
ds_read_b64_tr_b16 v[110:111], v16 offset:4608
v_mfma_f32_16x16x32_bf16 v[84:87], v[228:231], v[216:219], v[84:87]
ds_read_b64_tr_b16 v[112:113], v17 offset:4096
ds_read_b64_tr_b16 v[114:115], v17 offset:4608
v_mfma_f32_16x16x32_bf16 v[88:91], v[232:235], v[216:219], v[88:91]
v_mfma_f32_16x16x32_bf16 v[72:75], v[232:235], v[212:215], v[72:75]
s_waitcnt vmcnt(8) lgkmcnt(8)
v_mfma_f32_16x16x32_bf16 v[60:63], v[236:239], v[156:159], v[60:63]
buffer_load_dwordx4 v[196:199], v38, s[32:35], s57 offen offset:1024 sc1
v_mfma_f32_16x16x32_bf16 v[76:79], v[236:239], v[160:163], v[76:79]
ds_read_b64_tr_b16 v[220:221], v14 offset:8192
ds_read_b64_tr_b16 v[222:223], v14 offset:8704
v_mfma_f32_16x16x32_bf16 v[80:83], v[240:243], v[160:163], v[80:83]
ds_read_b64_tr_b16 v[224:225], v15 offset:8192
ds_read_b64_tr_b16 v[226:227], v15 offset:8704
v_mfma_f32_16x16x32_bf16 v[64:67], v[240:243], v[156:159], v[64:67]
buffer_load_dwordx4 v[200:203], v39, s[32:35], s57 offen offset:1024 sc1
v_mfma_f32_16x16x32_bf16 v[68:71], v[244:247], v[156:159], v[68:71]
ds_read_b64_tr_b16 v[228:229], v16 offset:8192
ds_read_b64_tr_b16 v[230:231], v16 offset:8704
v_mfma_f32_16x16x32_bf16 v[84:87], v[244:247], v[160:163], v[84:87]
ds_read_b64_tr_b16 v[232:233], v17 offset:8192
ds_read_b64_tr_b16 v[234:235], v17 offset:8704
v_mfma_f32_16x16x32_bf16 v[88:91], v[248:251], v[160:163], v[88:91]
s_add_u32 s57, s57, 2048
s_and_b32 s57, s57, 0x7fff
v_mfma_f32_16x16x32_bf16 v[72:75], v[248:251], v[156:159], v[72:75]
s_waitcnt vmcnt(8) lgkmcnt(8)
v_mfma_f32_16x16x32_bf16 v[60:63], v[100:103], v[164:167], v[60:63]
buffer_load_dwordx4 v[204:207], v38, s[32:35], s57 offen sc1
v_mfma_f32_16x16x32_bf16 v[76:79], v[100:103], v[168:171], v[76:79]
ds_read_b64_tr_b16 v[236:237], v14 offset:12288
ds_read_b64_tr_b16 v[238:239], v14 offset:12800
v_mfma_f32_16x16x32_bf16 v[80:83], v[104:107], v[168:171], v[80:83]
ds_read_b64_tr_b16 v[240:241], v15 offset:12288
ds_read_b64_tr_b16 v[242:243], v15 offset:12800
v_mfma_f32_16x16x32_bf16 v[64:67], v[104:107], v[164:167], v[64:67]
buffer_load_dwordx4 v[208:211], v39, s[32:35], s57 offen sc1
v_mfma_f32_16x16x32_bf16 v[68:71], v[108:111], v[164:167], v[68:71]
ds_read_b64_tr_b16 v[244:245], v16 offset:12288
ds_read_b64_tr_b16 v[246:247], v16 offset:12800
v_mfma_f32_16x16x32_bf16 v[84:87], v[108:111], v[168:171], v[84:87]
ds_read_b64_tr_b16 v[248:249], v17 offset:12288
ds_read_b64_tr_b16 v[250:251], v17 offset:12800
v_mfma_f32_16x16x32_bf16 v[88:91], v[112:115], v[168:171], v[88:91]
v_mfma_f32_16x16x32_bf16 v[72:75], v[112:115], v[164:167], v[72:75]
s_waitcnt vmcnt(8) lgkmcnt(8)
v_mfma_f32_16x16x32_bf16 v[60:63], v[220:223], v[172:175], v[60:63]
buffer_load_dwordx4 v[212:215], v38, s[32:35], s57 offen offset:1024 sc1
v_mfma_f32_16x16x32_bf16 v[76:79], v[220:223], v[176:179], v[76:79]
ds_read_b64_tr_b16 v[100:101], v14 offset:16384
ds_read_b64_tr_b16 v[102:103], v14 offset:16896
v_mfma_f32_16x16x32_bf16 v[80:83], v[224:227], v[176:179], v[80:83]
ds_read_b64_tr_b16 v[104:105], v15 offset:16384
ds_read_b64_tr_b16 v[106:107], v15 offset:16896
v_mfma_f32_16x16x32_bf16 v[64:67], v[224:227], v[172:175], v[64:67]
buffer_load_dwordx4 v[216:219], v39, s[32:35], s57 offen offset:1024 sc1
v_mfma_f32_16x16x32_bf16 v[68:71], v[228:231], v[172:175], v[68:71]
ds_read_b64_tr_b16 v[108:109], v16 offset:16384
ds_read_b64_tr_b16 v[110:111], v16 offset:16896
v_mfma_f32_16x16x32_bf16 v[84:87], v[228:231], v[176:179], v[84:87]
ds_read_b64_tr_b16 v[112:113], v17 offset:16384
ds_read_b64_tr_b16 v[114:115], v17 offset:16896
v_mfma_f32_16x16x32_bf16 v[88:91], v[232:235], v[176:179], v[88:91]
s_add_u32 s57, s57, 2048
s_and_b32 s57, s57, 0x7fff
v_mfma_f32_16x16x32_bf16 v[72:75], v[232:235], v[172:175], v[72:75]
s_waitcnt vmcnt(8) lgkmcnt(8)
v_mfma_f32_16x16x32_bf16 v[60:63], v[236:239], v[180:183], v[60:63]
buffer_load_dwordx4 v[156:159], v38, s[32:35], s57 offen sc1
v_mfma_f32_16x16x32_bf16 v[76:79], v[236:239], v[184:187], v[76:79]
ds_read_b64_tr_b16 v[220:221], v14 offset:20480
ds_read_b64_tr_b16 v[222:223], v14 offset:20992
v_mfma_f32_16x16x32_bf16 v[80:83], v[240:243], v[184:187], v[80:83]
ds_read_b64_tr_b16 v[224:225], v15 offset:20480
ds_read_b64_tr_b16 v[226:227], v15 offset:20992
v_mfma_f32_16x16x32_bf16 v[64:67], v[240:243], v[180:183], v[64:67]
buffer_load_dwordx4 v[160:163], v39, s[32:35], s57 offen sc1
v_mfma_f32_16x16x32_bf16 v[68:71], v[244:247], v[180:183], v[68:71]
ds_read_b64_tr_b16 v[228:229], v16 offset:20480
ds_read_b64_tr_b16 v[230:231], v16 offset:20992
v_mfma_f32_16x16x32_bf16 v[84:87], v[244:247], v[184:187], v[84:87]
ds_read_b64_tr_b16 v[232:233], v17 offset:20480
ds_read_b64_tr_b16 v[234:235], v17 offset:20992
v_mfma_f32_16x16x32_bf16 v[88:91], v[248:251], v[184:187], v[88:91]
v_mfma_f32_16x16x32_bf16 v[72:75], v[248:251], v[180:183], v[72:75]
s_waitcnt vmcnt(8) lgkmcnt(8)
v_mfma_f32_16x16x32_bf16 v[60:63], v[100:103], v[188:191], v[60:63]
buffer_load_dwordx4 v[164:167], v38, s[32:35], s57 offen offset:1024 sc1
v_mfma_f32_16x16x32_bf16 v[76:79], v[100:103], v[192:195], v[76:79]
ds_read_b64_tr_b16 v[236:237], v14 offset:24576
ds_read_b64_tr_b16 v[238:239], v14 offset:25088
v_mfma_f32_16x16x32_bf16 v[80:83], v[104:107], v[192:195], v[80:83]
ds_read_b64_tr_b16 v[240:241], v15 offset:24576
ds_read_b64_tr_b16 v[242:243], v15 offset:25088
v_mfma_f32_16x16x32_bf16 v[64:67], v[104:107], v[188:191], v[64:67]
buffer_load_dwordx4 v[168:171], v39, s[32:35], s57 offen offset:1024 sc1
v_mfma_f32_16x16x32_bf16 v[68:71], v[108:111], v[188:191], v[68:71]
ds_read_b64_tr_b16 v[244:245], v16 offset:24576
ds_read_b64_tr_b16 v[246:247], v16 offset:25088
v_mfma_f32_16x16x32_bf16 v[84:87], v[108:111], v[192:195], v[84:87]
ds_read_b64_tr_b16 v[248:249], v17 offset:24576
ds_read_b64_tr_b16 v[250:251], v17 offset:25088
v_mfma_f32_16x16x32_bf16 v[88:91], v[112:115], v[192:195], v[88:91]
s_add_u32 s57, s57, 2048
s_and_b32 s57, s57, 0x7fff
v_mfma_f32_16x16x32_bf16 v[72:75], v[112:115], v[188:191], v[72:75]
s_waitcnt vmcnt(8) lgkmcnt(8)
v_mfma_f32_16x16x32_bf16 v[60:63], v[220:223], v[196:199], v[60:63]
buffer_load_dwordx4 v[172:175], v38, s[32:35], s57 offen sc1
v_mfma_f32_16x16x32_bf16 v[76:79], v[220:223], v[200:203], v[76:79]
ds_read_b64_tr_b16 v[100:101], v14 offset:28672
ds_read_b64_tr_b16 v[102:103], v14 offset:29184
v_mfma_f32_16x16x32_bf16 v[80:83], v[224:227], v[200:203], v[80:83]
ds_read_b64_tr_b16 v[104:105], v15 offset:28672
ds_read_b64_tr_b16 v[106:107], v15 offset:29184
v_mfma_f32_16x16x32_bf16 v[64:67], v[224:227], v[196:199], v[64:67]
buffer_load_dwordx4 v[176:179], v39, s[32:35], s57 offen sc1
v_mfma_f32_16x16x32_bf16 v[68:71], v[228:231], v[196:199], v[68:71]
ds_read_b64_tr_b16 v[108:109], v16 offset:28672
ds_read_b64_tr_b16 v[110:111], v16 offset:29184
v_mfma_f32_16x16x32_bf16 v[84:87], v[228:231], v[200:203], v[84:87]
ds_read_b64_tr_b16 v[112:113], v17 offset:28672
ds_read_b64_tr_b16 v[114:115], v17 offset:29184
v_mfma_f32_16x16x32_bf16 v[88:91], v[232:235], v[200:203], v[88:91]
v_mfma_f32_16x16x32_bf16 v[72:75], v[232:235], v[196:199], v[72:75]
s_waitcnt vmcnt(8) lgkmcnt(8)
v_mfma_f32_16x16x32_bf16 v[60:63], v[236:239], v[204:207], v[60:63]
buffer_load_dwordx4 v[180:183], v38, s[32:35], s57 offen offset:1024 sc1
v_mfma_f32_16x16x32_bf16 v[76:79], v[236:239], v[208:211], v[76:79]
ds_read_b64_tr_b16 v[220:221], v14 offset:32768
ds_read_b64_tr_b16 v[222:223], v14 offset:33280
v_mfma_f32_16x16x32_bf16 v[80:83], v[240:243], v[208:211], v[80:83]
ds_read_b64_tr_b16 v[224:225], v15 offset:32768
ds_read_b64_tr_b16 v[226:227], v15 offset:33280
v_mfma_f32_16x16x32_bf16 v[64:67], v[240:243], v[204:207], v[64:67]
buffer_load_dwordx4 v[184:187], v39, s[32:35], s57 offen offset:1024 sc1
v_mfma_f32_16x16x32_bf16 v[68:71], v[244:247], v[204:207], v[68:71]
ds_read_b64_tr_b16 v[228:229], v16 offset:32768
ds_read_b64_tr_b16 v[230:231], v16 offset:33280
v_mfma_f32_16x16x32_bf16 v[84:87], v[244:247], v[208:211], v[84:87]
ds_read_b64_tr_b16 v[232:233], v17 offset:32768
ds_read_b64_tr_b16 v[234:235], v17 offset:33280
v_mfma_f32_16x16x32_bf16 v[88:91], v[248:251], v[208:211], v[88:91]
s_add_u32 s57, s57, 2048
s_and_b32 s57, s57, 0x7fff
v_mfma_f32_16x16x32_bf16 v[72:75], v[248:251], v[204:207], v[72:75]
s_waitcnt vmcnt(8) lgkmcnt(8)
v_mfma_f32_16x16x32_bf16 v[60:63], v[100:103], v[212:215], v[60:63]
buffer_load_dwordx4 v[188:191], v38, s[32:35], s57 offen sc1
v_mfma_f32_16x16x32_bf16 v[76:79], v[100:103], v[216:219], v[76:79]
ds_read_b64_tr_b16 v[236:237], v14 offset:36864
ds_read_b64_tr_b16 v[238:239], v14 offset:37376
v_mfma_f32_16x16x32_bf16 v[80:83], v[104:107], v[216:219], v[80:83]
ds_read_b64_tr_b16 v[240:241], v15 offset:36864
ds_read_b64_tr_b16 v[242:243], v15 offset:37376
v_mfma_f32_16x16x32_bf16 v[64:67], v[104:107], v[212:215], v[64:67]
buffer_load_dwordx4 v[192:195], v39, s[32:35], s57 offen sc1
v_mfma_f32_16x16x32_bf16 v[68:71], v[108:111], v[212:215], v[68:71]
ds_read_b64_tr_b16 v[244:245], v16 offset:36864
ds_read_b64_tr_b16 v[246:247], v16 offset:37376
v_mfma_f32_16x16x32_bf16 v[84:87], v[108:111], v[216:219], v[84:87]
ds_read_b64_tr_b16 v[248:249], v17 offset:36864
ds_read_b64_tr_b16 v[250:251], v17 offset:37376
v_mfma_f32_16x16x32_bf16 v[88:91], v[112:115], v[216:219], v[88:91]
v_mfma_f32_16x16x32_bf16 v[72:75], v[112:115], v[212:215], v[72:75]
s_waitcnt vmcnt(8) lgkmcnt(8)
v_mfma_f32_16x16x32_bf16 v[60:63], v[220:223], v[156:159], v[60:63]
buffer_load_dwordx4 v[196:199], v38, s[32:35], s57 offen offset:1024 sc1
v_mfma_f32_16x16x32_bf16 v[76:79], v[220:223], v[160:163], v[76:79]
ds_read_b64_tr_b16 v[100:101], v14 offset:40960
ds_read_b64_tr_b16 v[102:103], v14 offset:41472
v_mfma_f32_16x16x32_bf16 v[80:83], v[224:227], v[160:163], v[80:83]
ds_read_b64_tr_b16 v[104:105], v15 offset:40960
ds_read_b64_tr_b16 v[106:107], v15 offset:41472
v_mfma_f32_16x16x32_bf16 v[64:67], v[224:227], v[156:159], v[64:67]
buffer_load_dwordx4 v[200:203], v39, s[32:35], s57 offen offset:1024 sc1
v_mfma_f32_16x16x32_bf16 v[68:71], v[228:231], v[156:159], v[68:71]
ds_read_b64_tr_b16 v[108:109], v16 offset:40960
ds_read_b64_tr_b16 v[110:111], v16 offset:41472
v_mfma_f32_16x16x32_bf16 v[84:87], v[228:231], v[160:163], v[84:87]
ds_read_b64_tr_b16 v[112:113], v17 offset:40960
ds_read_b64_tr_b16 v[114:115], v17 offset:41472
v_mfma_f32_16x16x32_bf16 v[88:91], v[232:235], v[160:163], v[88:91]
s_add_u32 s57, s57, 2048
s_and_b32 s57, s57, 0x7fff
v_mfma_f32_16x16x32_bf16 v[72:75], v[232:235], v[156:159], v[72:75]
s_waitcnt vmcnt(8) lgkmcnt(8)
v_mfma_f32_16x16x32_bf16 v[60:63], v[236:239], v[164:167], v[60:63]
buffer_load_dwordx4 v[204:207], v38, s[32:35], s57 offen sc1
v_mfma_f32_16x16x32_bf16 v[76:79], v[236:239], v[168:171], v[76:79]
ds_read_b64_tr_b16 v[220:221], v14 offset:45056
ds_read_b64_tr_b16 v[222:223], v14 offset:45568
v_mfma_f32_16x16x32_bf16 v[80:83], v[240:243], v[168:171], v[80:83]
ds_read_b64_tr_b16 v[224:225], v15 offset:45056
ds_read_b64_tr_b16 v[226:227], v15 offset:45568
v_mfma_f32_16x16x32_bf16 v[64:67], v[240:243], v[164:167], v[64:67]
buffer_load_dwordx4 v[208:211], v39, s[32:35], s57 offen sc1
v_mfma_f32_16x16x32_bf16 v[68:71], v[244:247], v[164:167], v[68:71]
ds_read_b64_tr_b16 v[228:229], v16 offset:45056
ds_read_b64_tr_b16 v[230:231], v16 offset:45568
v_mfma_f32_16x16x32_bf16 v[84:87], v[244:247], v[168:171], v[84:87]
ds_read_b64_tr_b16 v[232:233], v17 offset:45056
ds_read_b64_tr_b16 v[234:235], v17 offset:45568
v_mfma_f32_16x16x32_bf16 v[88:91], v[248:251], v[168:171], v[88:91]
v_mfma_f32_16x16x32_bf16 v[72:75], v[248:251], v[164:167], v[72:75]
s_waitcnt vmcnt(8) lgkmcnt(8)
v_mfma_f32_16x16x32_bf16 v[60:63], v[100:103], v[172:175], v[60:63]
buffer_load_dwordx4 v[212:215], v38, s[32:35], s57 offen offset:1024 sc1
v_mfma_f32_16x16x32_bf16 v[76:79], v[100:103], v[176:179], v[76:79]
ds_read_b64_tr_b16 v[236:237], v14 offset:49152
ds_read_b64_tr_b16 v[238:239], v14 offset:49664
v_mfma_f32_16x16x32_bf16 v[80:83], v[104:107], v[176:179], v[80:83]
ds_read_b64_tr_b16 v[240:241], v15 offset:49152
ds_read_b64_tr_b16 v[242:243], v15 offset:49664
v_mfma_f32_16x16x32_bf16 v[64:67], v[104:107], v[172:175], v[64:67]
buffer_load_dwordx4 v[216:219], v39, s[32:35], s57 offen offset:1024 sc1
v_mfma_f32_16x16x32_bf16 v[68:71], v[108:111], v[172:175], v[68:71]
ds_read_b64_tr_b16 v[244:245], v16 offset:49152
ds_read_b64_tr_b16 v[246:247], v16 offset:49664
v_mfma_f32_16x16x32_bf16 v[84:87], v[108:111], v[176:179], v[84:87]
ds_read_b64_tr_b16 v[248:249], v17 offset:49152
ds_read_b64_tr_b16 v[250:251], v17 offset:49664
v_mfma_f32_16x16x32_bf16 v[88:91], v[112:115], v[176:179], v[88:91]
v_mfma_f32_16x16x32_bf16 v[72:75], v[112:115], v[172:175], v[72:75]
s_waitcnt vmcnt(8) lgkmcnt(8)
v_mfma_f32_16x16x32_bf16 v[60:63], v[220:223], v[180:183], v[60:63]
v_mfma_f32_16x16x32_bf16 v[76:79], v[220:223], v[184:187], v[76:79]
ds_read_b64_tr_b16 v[100:101], v14 offset:53248
ds_read_b64_tr_b16 v[102:103], v14 offset:53760
v_mfma_f32_16x16x32_bf16 v[80:83], v[224:227], v[184:187], v[80:83]
ds_read_b64_tr_b16 v[104:105], v15 offset:53248
ds_read_b64_tr_b16 v[106:107], v15 offset:53760
v_mfma_f32_16x16x32_bf16 v[64:67], v[224:227], v[180:183], v[64:67]
v_mfma_f32_16x16x32_bf16 v[68:71], v[228:231], v[180:183], v[68:71]
ds_read_b64_tr_b16 v[108:109], v16 offset:53248
ds_read_b64_tr_b16 v[110:111], v16 offset:53760
v_mfma_f32_16x16x32_bf16 v[84:87], v[228:231], v[184:187], v[84:87]
ds_read_b64_tr_b16 v[112:113], v17 offset:53248
ds_read_b64_tr_b16 v[114:115], v17 offset:53760
v_mfma_f32_16x16x32_bf16 v[88:91], v[232:235], v[184:187], v[88:91]
v_mfma_f32_16x16x32_bf16 v[72:75], v[232:235], v[180:183], v[72:75]
s_waitcnt vmcnt(6) lgkmcnt(8)
v_mfma_f32_16x16x32_bf16 v[60:63], v[236:239], v[188:191], v[60:63]
v_mfma_f32_16x16x32_bf16 v[76:79], v[236:239], v[192:195], v[76:79]
ds_read_b64_tr_b16 v[220:221], v14 offset:57344
ds_read_b64_tr_b16 v[222:223], v14 offset:57856
v_mfma_f32_16x16x32_bf16 v[80:83], v[240:243], v[192:195], v[80:83]
ds_read_b64_tr_b16 v[224:225], v15 offset:57344
ds_read_b64_tr_b16 v[226:227], v15 offset:57856
v_mfma_f32_16x16x32_bf16 v[64:67], v[240:243], v[188:191], v[64:67]
v_mfma_f32_16x16x32_bf16 v[68:71], v[244:247], v[188:191], v[68:71]
ds_read_b64_tr_b16 v[228:229], v16 offset:57344
ds_read_b64_tr_b16 v[230:231], v16 offset:57856
v_mfma_f32_16x16x32_bf16 v[84:87], v[244:247], v[192:195], v[84:87]
ds_read_b64_tr_b16 v[232:233], v17 offset:57344
ds_read_b64_tr_b16 v[234:235], v17 offset:57856
v_mfma_f32_16x16x32_bf16 v[88:91], v[248:251], v[192:195], v[88:91]
v_mfma_f32_16x16x32_bf16 v[72:75], v[248:251], v[188:191], v[72:75]
s_waitcnt vmcnt(4) lgkmcnt(8)
v_mfma_f32_16x16x32_bf16 v[60:63], v[100:103], v[196:199], v[60:63]
v_mfma_f32_16x16x32_bf16 v[76:79], v[100:103], v[200:203], v[76:79]
ds_read_b64_tr_b16 v[236:237], v14 offset:61440
ds_read_b64_tr_b16 v[238:239], v14 offset:61952
v_mfma_f32_16x16x32_bf16 v[80:83], v[104:107], v[200:203], v[80:83]
ds_read_b64_tr_b16 v[240:241], v15 offset:61440
ds_read_b64_tr_b16 v[242:243], v15 offset:61952
v_mfma_f32_16x16x32_bf16 v[64:67], v[104:107], v[196:199], v[64:67]
v_mfma_f32_16x16x32_bf16 v[68:71], v[108:111], v[196:199], v[68:71]
ds_read_b64_tr_b16 v[244:245], v16 offset:61440
ds_read_b64_tr_b16 v[246:247], v16 offset:61952
v_mfma_f32_16x16x32_bf16 v[84:87], v[108:111], v[200:203], v[84:87]
ds_read_b64_tr_b16 v[248:249], v17 offset:61440
ds_read_b64_tr_b16 v[250:251], v17 offset:61952
v_mfma_f32_16x16x32_bf16 v[88:91], v[112:115], v[200:203], v[88:91]
v_mfma_f32_16x16x32_bf16 v[72:75], v[112:115], v[196:199], v[72:75]
s_waitcnt vmcnt(2) lgkmcnt(8)
v_mfma_f32_16x16x32_bf16 v[60:63], v[220:223], v[204:207], v[60:63]
v_mfma_f32_16x16x32_bf16 v[76:79], v[220:223], v[208:211], v[76:79]
v_mfma_f32_16x16x32_bf16 v[80:83], v[224:227], v[208:211], v[80:83]
v_mfma_f32_16x16x32_bf16 v[64:67], v[224:227], v[204:207], v[64:67]
v_mfma_f32_16x16x32_bf16 v[68:71], v[228:231], v[204:207], v[68:71]
v_mfma_f32_16x16x32_bf16 v[84:87], v[228:231], v[208:211], v[84:87]
v_mfma_f32_16x16x32_bf16 v[88:91], v[232:235], v[208:211], v[88:91]
v_mfma_f32_16x16x32_bf16 v[72:75], v[232:235], v[204:207], v[72:75]
s_waitcnt vmcnt(0) lgkmcnt(0)
v_mfma_f32_16x16x32_bf16 v[60:63], v[236:239], v[212:215], v[60:63]
v_mfma_f32_16x16x32_bf16 v[64:67], v[240:243], v[212:215], v[64:67]
v_mfma_f32_16x16x32_bf16 v[68:71], v[244:247], v[212:215], v[68:71]
v_mfma_f32_16x16x32_bf16 v[72:75], v[248:251], v[212:215], v[72:75]
v_mfma_f32_16x16x32_bf16 v[76:79], v[236:239], v[216:219], v[76:79]
v_mfma_f32_16x16x32_bf16 v[80:83], v[240:243], v[216:219], v[80:83]
v_mfma_f32_16x16x32_bf16 v[84:87], v[244:247], v[216:219], v[84:87]
v_mfma_f32_16x16x32_bf16 v[88:91], v[248:251], v[216:219], v[88:91]
s_setpc_b64 s[94:95]
R_oloop_end:
s_cmp_eq_u32 s46, 0
s_cbranch_scc1 slow_78
s_nop 0
v_cvt_pk_bf16_f32 v20, v60, v61
v_cvt_pk_bf16_f32 v21, v62, v63
v_cvt_pk_bf16_f32 v22, v64, v65
v_cvt_pk_bf16_f32 v23, v66, v67
buffer_store_dwordx4 v[20:23], v18, s[32:35], s85 offen offset:0 sc1
v_cvt_pk_bf16_f32 v24, v68, v69
v_cvt_pk_bf16_f32 v25, v70, v71
v_cvt_pk_bf16_f32 v26, v72, v73
v_cvt_pk_bf16_f32 v27, v74, v75
buffer_store_dwordx4 v[24:27], v18, s[32:35], s85 offen offset:1024 sc1
v_cvt_pk_bf16_f32 v28, v76, v77
v_cvt_pk_bf16_f32 v29, v78, v79
v_cvt_pk_bf16_f32 v30, v80, v81
v_cvt_pk_bf16_f32 v31, v82, v83
buffer_store_dwordx4 v[28:31], v18, s[32:35], s86 offen offset:0 sc1
v_cvt_pk_bf16_f32 v32, v84, v85
v_cvt_pk_bf16_f32 v33, v86, v87
v_cvt_pk_bf16_f32 v34, v88, v89
v_cvt_pk_bf16_f32 v35, v90, v91
buffer_store_dwordx4 v[32:35], v18, s[32:35], s86 offen offset:1024 sc1
s_barrier
v_dot2c_f32_bf16 v6, v20, v48
v_dot2c_f32_bf16 v8, v20, v20
v_dot2c_f32_bf16 v7, v28, v48
v_dot2c_f32_bf16 v9, v28, v28
v_dot2c_f32_bf16 v6, v21, v48
v_dot2c_f32_bf16 v8, v21, v21
v_dot2c_f32_bf16 v7, v29, v48
v_dot2c_f32_bf16 v9, v29, v29
v_dot2c_f32_bf16 v6, v22, v48
v_dot2c_f32_bf16 v8, v22, v22
v_dot2c_f32_bf16 v7, v30, v48
v_dot2c_f32_bf16 v9, v30, v30
v_dot2c_f32_bf16 v6, v23, v48
v_dot2c_f32_bf16 v8, v23, v23
v_dot2c_f32_bf16 v7, v31, v48
v_dot2c_f32_bf16 v9, v31, v31
v_dot2c_f32_bf16 v6, v24, v48
v_dot2c_f32_bf16 v8, v24, v24
v_dot2c_f32_bf16 v7, v32, v48
v_dot2c_f32_bf16 v9, v32, v32
v_dot2c_f32_bf16 v6, v25, v48
v_dot2c_f32_bf16 v8, v25, v25
v_dot2c_f32_bf16 v7, v33, v48
v_dot2c_f32_bf16 v9, v33, v33
v_dot2c_f32_bf16 v6, v26, v48
v_dot2c_f32_bf16 v8, v26, v26
v_dot2c_f32_bf16 v7, v34, v48
v_dot2c_f32_bf16 v9, v34, v34
v_dot2c_f32_bf16 v6, v27, v48
v_dot2c_f32_bf16 v8, v27, v27
v_dot2c_f32_bf16 v7, v35, v48
v_dot2c_f32_bf16 v9, v35, v35
s_mov_b64 exec, 1
s_waitcnt vmcnt(0)
buffer_store_dword v5, v4, s[32:35], s88 offen
s_mov_b64 exec, -1
s_nop 1
v_permlane32_swap_b32 v6, v7
v_permlane32_swap_b32 v8, v9
v_add_f32 v6, v6, v7
v_add_f32 v8, v8, v9
s_nop 1
v_permlane16_swap_b32 v6, v8
s_nop 0
v_add_f32 v6, v6, v8
buffer_store_dword v6, v1, s[32:35], s87 offen
back_79:
s_lshl_b32 s49, s44, 13
v_add_u32 v10, s49, v18
v_add_u32 v11, 1024, v10
s_lshl_b32 s48, s43, 1
v_lshrrev_b32 v4, 2, v2
v_and_b32 v5, 3, v0
v_lshl_add_u32 v6, v3, 3, v4
v_lshlrev_b32 v6, 7, v6
v_lshl_add_u32 v6, v5, 3, v6
v_lshrrev_b32 v7, 1, v4
v_and_b32 v8, 1, v3
v_lshl_add_u32 v7, v8, 1, v7
v_xor_b32 v7, s48, v7
v_lshl_add_u32 v12, v7, 5, v6
v_add_u32 v12, 16384, v12
v_xor_b32 v13, 32, v12
v_mov_b32 v14, v10
v_mov_b32 v15, v11
v_add_u32 v16, 122880, v12
v_add_u32 v17, 122880, v13
v_mov_b32 v156, 0
v_mov_b32 v157, 0
v_mov_b32 v158, 0
v_mov_b32 v159, 0
v_mov_b32 v160, 0
v_mov_b32 v161, 0
v_mov_b32 v162, 0
v_mov_b32 v163, 0
v_mov_b32 v164, 0
v_mov_b32 v165, 0
v_mov_b32 v166, 0
v_mov_b32 v167, 0
v_mov_b32 v168, 0
v_mov_b32 v169, 0
v_mov_b32 v170, 0
v_mov_b32 v171, 0
v_mov_b32 v172, 0
v_mov_b32 v173, 0
v_mov_b32 v174, 0
v_mov_b32 v175, 0
v_mov_b32 v176, 0
v_mov_b32 v177, 0
v_mov_b32 v178, 0
v_mov_b32 v179, 0
v_mov_b32 v180, 0
v_mov_b32 v181, 0
v_mov_b32 v182, 0
v_mov_b32 v183, 0
v_mov_b32 v184, 0
v_mov_b32 v185, 0
v_mov_b32 v186, 0
v_mov_b32 v187, 0
v_mov_b32 v188, 0
v_mov_b32 v189, 0
v_mov_b32 v190, 0
v_mov_b32 v191, 0
v_mov_b32 v192, 0
v_mov_b32 v193, 0
v_mov_b32 v194, 0
v_mov_b32 v195, 0
v_mov_b32 v196, 0
v_mov_b32 v197, 0
v_mov_b32 v198, 0
v_mov_b32 v199, 0
v_mov_b32 v200, 0
v_mov_b32 v201, 0
v_mov_b32 v202, 0
v_mov_b32 v203, 0
v_mov_b32 v204, 0
v_mov_b32 v205, 0
v_mov_b32 v206, 0
v_mov_b32 v207, 0
v_mov_b32 v208, 0
v_mov_b32 v209, 0
v_mov_b32 v210, 0
v_mov_b32 v211, 0
v_mov_b32 v212, 0
v_mov_b32 v213, 0
v_mov_b32 v214, 0
v_mov_b32 v215, 0
v_mov_b32 v216, 0
v_mov_b32 v217, 0
v_mov_b32 v218, 0
v_mov_b32 v219, 0
v_mov_b32 v220, 0
v_mov_b32 v221, 0
v_mov_b32 v222, 0
v_mov_b32 v223, 0
v_mov_b32 v224, 0
v_mov_b32 v225, 0
v_mov_b32 v226, 0
v_mov_b32 v227, 0
v_mov_b32 v228, 0
v_mov_b32 v229, 0
v_mov_b32 v230, 0
v_mov_b32 v231, 0
v_mov_b32 v232, 0
v_mov_b32 v233, 0
v_mov_b32 v234, 0
v_mov_b32 v235, 0
v_mov_b32 v236, 0
v_mov_b32 v237, 0
v_mov_b32 v238, 0
v_mov_b32 v239, 0
v_mov_b32 v240, 0
v_mov_b32 v241, 0
v_mov_b32 v242, 0
v_mov_b32 v243, 0
v_mov_b32 v244, 0
v_mov_b32 v245, 0
v_mov_b32 v246, 0
v_mov_b32 v247, 0
v_mov_b32 v248, 0
v_mov_b32 v249, 0
v_mov_b32 v250, 0
v_mov_b32 v251, 0
v_lshrrev_b32 v6, 2, v2
v_cmp_eq_u32 vcc, v6, v3
v_and_b32 v7, 1, v0
v_lshlrev_b32 v7, 4, v7
v_mov_b32 v8, 0x3f80
v_lshlrev_b32 v9, v7, v8
v_cndmask_b32 v7, 0, v9, vcc
v_and_b32 v6, 2, v0
v_cmp_eq_u32 vcc, 0, v6
v_mov_b32 v36, 0
v_mov_b32 v37, 0
v_mov_b32 v40, 0
v_mov_b32 v41, 0
v_cndmask_b32 v38, 0, v7, vcc
v_cndmask_b32 v39, v7, 0, vcc
v_lshrrev_b32 v8, 1, v2
v_cmp_eq_u32 vcc, 0, v8
s_nop 1
v_cndmask_b32 v44, 0, v9, vcc
v_cmp_eq_u32 vcc, 1, v8
s_nop 1
v_cndmask_b32 v45, 0, v9, vcc
v_cmp_eq_u32 vcc, 2, v8
s_nop 1
v_cndmask_b32 v46, 0, v9, vcc
v_cmp_eq_u32 vcc, 3, v8
s_nop 1
v_cndmask_b32 v47, 0, v9, vcc
v_lshrrev_b32 v4, 2, v2
v_lshl_add_u32 v4, v3, 2, v4
v_lshlrev_b32 v4, 6, v4
v_and_b32 v5, 3, v0
v_lshl_add_u32 v4, v5, 3, v4
s_lshl_b32 s48, s43, 11
s_add_u32 s48, s48, 135168
v_add_u32 v53, s48, v4
s_mul_i32 s48, s40, 3072
s_add_u32 s48, s48, 139264
v_add_u32 v42, s48, v18
s_xor_b32 s49, s40, 2
s_mul_i32 s48, s49, 3072
s_add_u32 s48, s48, 139264
v_add_u32 v43, s48, v18
s_lshl_b32 s49, s49, 2
s_add_u32 s49, s49, 134672
v_mov_b32 v19, s49
v_xor_b32 v52, 8, v19
v_lshrrev_b32 v4, 3, v0
v_and_b32 v5, 7, v0
v_lshlrev_b32 v4, 11, v4
v_lshl_add_u32 v55, v5, 4, v4
v_lshlrev_b32 v4, 6, v2
v_lshl_add_u32 v58, v3, 4, v4
v_lshlrev_b32 v4, 4, v2
v_lshl_add_u32 v59, v3, 3, v4
s_mul_i32 s51, s42, 163840
s_add_u32 s51, s51, 9437184
s_lshl_b32 s50, s43, 1
s_add_u32 s50, s50, s44
s_lshl_b32 s48, s50, 15
s_add_u32 s48, s48, s51
s_add_u32 s48, s48, 0
s_lshl_b32 s49, s41, 7
s_add_u32 s53, s48, s49
s_add_u32 s54, s53, 16384
s_lshl_b32 s56, s50, 10
s_add_u32 s56, s56, s51
s_add_u32 s56, s56, 147456
s_xor_b32 s57, s56, 1024
s_lshl_b32 s58, s50, 11
s_add_u32 s58, s58, s51
s_add_u32 s58, s58, 131072
s_xor_b32 s59, s58, 2048
s_add_u32 s79, s58, s49
s_lshl_b32 s50, s41, 11
s_add_u32 s55, s48, s50
s_lshl_b32 s48, s43, 7
s_add_u32 s48, s48, 133888
v_lshl_add_u32 v7, v3, 4, s48
v_lshl_add_u32 v54, v2, 2, s48
s_lshl_b32 s49, s44, 6
v_add_u32 v8, s49, v2
v_lshlrev_b32 v8, 3, v8
v_add_u32 v8, 131072, v8
v_lshl_add_u32 v9, v3, 2, s49
v_lshlrev_b32 v9, 2, v9
v_add_u32 v9, 132096, v9
s_mov_b32 s64, 0
s_mov_b32 s65, 0
s_mov_b32 s66, 0x3fb8aa3b
s_mov_b32 s61, 2
s_lshr_b32 s49, s42, 3
s_xor_b32 s77, s74, s49
s_add_u32 s77, s77, 4
s_lshl_b32 s50, s42, 2
s_add_u32 s50, s50, s40
s_lshl_b32 s50, s50, 4
s_add_u32 s50, s50, s41
s_lshl_b32 s50, s50, 8
s_add_u32 s52, s50, 18087936
ds_read_b64_tr_b16 v[84:85], v16 offset:8192
ds_read_b64_tr_b16 v[86:87], v16 offset:8704
ds_read_b64_tr_b16 v[88:89], v17 offset:8192
ds_read_b64_tr_b16 v[90:91], v17 offset:8704
ds_read_b64_tr_b16 v[92:93], v16 offset:16384
ds_read_b64_tr_b16 v[94:95], v16 offset:16896
ds_read_b64_tr_b16 v[96:97], v17 offset:16384
ds_read_b64_tr_b16 v[98:99], v17 offset:16896
ds_read_b64_tr_b16 v[76:77], v16 offset:0
ds_read_b64_tr_b16 v[78:79], v16 offset:512
ds_read_b64_tr_b16 v[80:81], v17 offset:0
ds_read_b64_tr_b16 v[82:83], v17 offset:512
s_barrier
ds_read_b128 v[60:63], v14 offset:0
ds_read_b128 v[64:67], v14 offset:2048
ds_read_b128 v[68:71], v14 offset:4096
ds_read_b128 v[72:75], v14 offset:6144
s_waitcnt lgkmcnt(0)
c1_loop:
v_mfma_f32_16x16x32_bf16 v[212:215], v[84:87], v[72:75], v[212:215]
ds_read_b128 v[100:103], v15 offset:0
v_mfma_f32_16x16x32_bf16 v[204:207], v[84:87], v[68:71], v[204:207]
ds_read_b128 v[104:107], v15 offset:2048
v_mfma_f32_16x16x32_bf16 v[196:199], v[84:87], v[64:67], v[196:199]
ds_read_b128 v[108:111], v15 offset:4096
v_mfma_f32_16x16x32_bf16 v[188:191], v[84:87], v[60:63], v[188:191]
ds_read_b128 v[112:115], v15 offset:6144
v_mfma_f32_16x16x32_bf16 v[192:195], v[88:91], v[60:63], v[192:195]
ds_read_b64_tr_b16 v[124:125], v16 offset:12288
v_mfma_f32_16x16x32_bf16 v[200:203], v[88:91], v[64:67], v[200:203]
ds_read_b64_tr_b16 v[126:127], v16 offset:12800
v_mfma_f32_16x16x32_bf16 v[208:211], v[88:91], v[68:71], v[208:211]
ds_read_b64_tr_b16 v[128:129], v17 offset:12288
v_mfma_f32_16x16x32_bf16 v[216:219], v[88:91], v[72:75], v[216:219]
ds_read_b64_tr_b16 v[130:131], v17 offset:12800
v_mfma_f32_16x16x32_bf16 v[244:247], v[72:75], v[92:95], v[244:247]
ds_read_b64_tr_b16 v[132:133], v16 offset:20480
v_mfma_f32_16x16x32_bf16 v[248:251], v[72:75], v[96:99], v[248:251]
ds_read_b64_tr_b16 v[134:135], v16 offset:20992
v_mfma_f32_16x16x32_bf16 v[240:243], v[68:71], v[96:99], v[240:243]
ds_read_b64_tr_b16 v[136:137], v17 offset:20480
v_mfma_f32_16x16x32_bf16 v[236:239], v[68:71], v[92:95], v[236:239]
ds_read_b64_tr_b16 v[138:139], v17 offset:20992
v_mfma_f32_16x16x32_bf16 v[228:231], v[64:67], v[92:95], v[228:231]
ds_read_b64_tr_b16 v[116:117], v16 offset:4096
v_mfma_f32_16x16x32_bf16 v[232:235], v[64:67], v[96:99], v[232:235]
ds_read_b64_tr_b16 v[118:119], v16 offset:4608
v_mfma_f32_16x16x32_bf16 v[224:227], v[60:63], v[96:99], v[224:227]
ds_read_b64_tr_b16 v[120:121], v17 offset:4096
v_mfma_f32_16x16x32_bf16 v[220:223], v[60:63], v[92:95], v[220:223]
ds_read_b64_tr_b16 v[122:123], v17 offset:4608
v_mfma_f32_16x16x32_bf16 v[156:159], v[76:79], v[60:63], v[156:159]
s_cmp_eq_u32 s77, s64
s_cbranch_scc1 c1_hook
c1_hook_ret:
v_mfma_f32_16x16x32_bf16 v[164:167], v[76:79], v[64:67], v[164:167]
s_add_u32 s65, s65, 40960
s_cmp_eq_u32 s65, 122880
v_mfma_f32_16x16x32_bf16 v[172:175], v[76:79], v[68:71], v[172:175]
s_cselect_b32 s65, 0, s65
s_add_u32 s64, s64, 1
v_mfma_f32_16x16x32_bf16 v[180:183], v[76:79], v[72:75], v[180:183]
v_add_u32 v14, s65, v10
v_add_u32 v15, s65, v11
v_mfma_f32_16x16x32_bf16 v[184:187], v[80:83], v[72:75], v[184:187]
v_add_u32 v16, s65, v12
v_add_u32 v17, s65, v13
v_mfma_f32_16x16x32_bf16 v[176:179], v[80:83], v[68:71], v[176:179]
s_cmp_eq_u32 s64, 16
s_cbranch_scc1 c1_last
v_mfma_f32_16x16x32_bf16 v[168:171], v[80:83], v[64:67], v[168:171]
s_waitcnt lgkmcnt(0)
v_mfma_f32_16x16x32_bf16 v[160:163], v[80:83], v[60:63], v[160:163]
s_barrier
v_mfma_f32_16x16x32_bf16 v[212:215], v[124:127], v[112:115], v[212:215]
ds_read_b128 v[60:63], v14 offset:0
v_mfma_f32_16x16x32_bf16 v[204:207], v[124:127], v[108:111], v[204:207]
ds_read_b128 v[64:67], v14 offset:2048
v_mfma_f32_16x16x32_bf16 v[196:199], v[124:127], v[104:107], v[196:199]
ds_read_b128 v[68:71], v14 offset:4096
v_mfma_f32_16x16x32_bf16 v[188:191], v[124:127], v[100:103], v[188:191]
ds_read_b128 v[72:75], v14 offset:6144
v_mfma_f32_16x16x32_bf16 v[192:195], v[128:131], v[100:103], v[192:195]
ds_read_b64_tr_b16 v[84:85], v16 offset:8192
v_mfma_f32_16x16x32_bf16 v[200:203], v[128:131], v[104:107], v[200:203]
ds_read_b64_tr_b16 v[86:87], v16 offset:8704
v_mfma_f32_16x16x32_bf16 v[208:211], v[128:131], v[108:111], v[208:211]
ds_read_b64_tr_b16 v[88:89], v17 offset:8192
v_mfma_f32_16x16x32_bf16 v[216:219], v[128:131], v[112:115], v[216:219]
ds_read_b64_tr_b16 v[90:91], v17 offset:8704
v_mfma_f32_16x16x32_bf16 v[244:247], v[112:115], v[132:135], v[244:247]
ds_read_b64_tr_b16 v[92:93], v16 offset:16384
v_mfma_f32_16x16x32_bf16 v[248:251], v[112:115], v[136:139], v[248:251]
ds_read_b64_tr_b16 v[94:95], v16 offset:16896
v_mfma_f32_16x16x32_bf16 v[240:243], v[108:111], v[136:139], v[240:243]
ds_read_b64_tr_b16 v[96:97], v17 offset:16384
v_mfma_f32_16x16x32_bf16 v[236:239], v[108:111], v[132:135], v[236:239]
ds_read_b64_tr_b16 v[98:99], v17 offset:16896
v_mfma_f32_16x16x32_bf16 v[228:231], v[104:107], v[132:135], v[228:231]
ds_read_b64_tr_b16 v[76:77], v16 offset:0
v_mfma_f32_16x16x32_bf16 v[232:235], v[104:107], v[136:139], v[232:235]
ds_read_b64_tr_b16 v[78:79], v16 offset:512
v_mfma_f32_16x16x32_bf16 v[224:227], v[100:103], v[136:139], v[224:227]
ds_read_b64_tr_b16 v[80:81], v17 offset:0
v_mfma_f32_16x16x32_bf16 v[220:223], v[100:103], v[132:135], v[220:223]
ds_read_b64_tr_b16 v[82:83], v17 offset:512
v_mfma_f32_16x16x32_bf16 v[156:159], v[116:119], v[100:103], v[156:159]
v_mfma_f32_16x16x32_bf16 v[164:167], v[116:119], v[104:107], v[164:167]
v_mfma_f32_16x16x32_bf16 v[172:175], v[116:119], v[108:111], v[172:175]
v_mfma_f32_16x16x32_bf16 v[180:183], v[116:119], v[112:115], v[180:183]
v_mfma_f32_16x16x32_bf16 v[184:187], v[120:123], v[112:115], v[184:187]
v_mfma_f32_16x16x32_bf16 v[176:179], v[120:123], v[108:111], v[176:179]
v_mfma_f32_16x16x32_bf16 v[168:171], v[120:123], v[104:107], v[168:171]
s_waitcnt lgkmcnt(0)
v_mfma_f32_16x16x32_bf16 v[160:163], v[120:123], v[100:103], v[160:163]
s_branch c1_loop
c1_hook:
s_waitcnt lgkmcnt(0)
s_cmp_lg_u32 s44, 0
s_cbranch_scc1 else_80
v_mfma_f32_16x16x32_bf16 v[140:143], v[48:51], v[76:79], 0
v_mfma_f32_16x16x32_bf16 v[144:147], v[48:51], v[84:87], 0
v_mfma_f32_16x16x32_bf16 v[148:151], v[48:51], v[92:95], 0
v_mfma_f32_16x16x32_bf16 v[140:143], v[48:51], v[116:119], v[140:143]
v_mfma_f32_16x16x32_bf16 v[144:147], v[48:51], v[124:127], v[144:147]
v_mfma_f32_16x16x32_bf16 v[148:151], v[48:51], v[132:135], v[148:151]
s_branch fi_81
else_80:
v_mfma_f32_16x16x32_bf16 v[140:143], v[48:51], v[80:83], 0
v_mfma_f32_16x16x32_bf16 v[144:147], v[48:51], v[88:91], 0
v_mfma_f32_16x16x32_bf16 v[148:151], v[48:51], v[96:99], 0
v_mfma_f32_16x16x32_bf16 v[140:143], v[48:51], v[120:123], v[140:143]
v_mfma_f32_16x16x32_bf16 v[144:147], v[48:51], v[128:131], v[144:147]
v_mfma_f32_16x16x32_bf16 v[148:151], v[48:51], v[136:139], v[148:151]
fi_81:
s_nop 4
v_cmp_eq_u32 vcc, 0, v3
v_cmp_eq_u32 s[48:49], 1, v3
s_nop 1
v_cndmask_b32 v4, v148, v144, s[48:49]
v_cndmask_b32 v4, v4, v140, vcc
buffer_store_dword v4, v1, s[32:35], s52 offen sc1
s_branch c1_hook_ret
c1_last:
v_mfma_f32_16x16x32_bf16 v[168:171], v[80:83], v[64:67], v[168:171]
s_waitcnt lgkmcnt(0)
v_mfma_f32_16x16x32_bf16 v[160:163], v[80:83], v[60:63], v[160:163]
v_mfma_f32_16x16x32_bf16 v[212:215], v[124:127], v[112:115], v[212:215]
ds_read_b64_tr_b16 v[10:11], v53 offset:0
ds_read_b64_tr_b16 v[12:13], v53 offset:1024
v_mfma_f32_16x16x32_bf16 v[204:207], v[124:127], v[108:111], v[204:207]
ds_read_b64_tr_b16 v[14:15], v53 offset:32
ds_read_b64_tr_b16 v[16:17], v53 offset:1056
v_mfma_f32_16x16x32_bf16 v[196:199], v[124:127], v[104:107], v[196:199]

s_mul_i32 s48, s44, 0x80008000
v_mfma_f32_16x16x32_bf16 v[188:191], v[124:127], v[100:103], v[188:191]

v_mfma_f32_16x16x32_bf16 v[192:195], v[128:131], v[100:103], v[192:195]

v_mfma_f32_16x16x32_bf16 v[200:203], v[128:131], v[104:107], v[200:203]

v_mfma_f32_16x16x32_bf16 v[208:211], v[128:131], v[108:111], v[208:211]

s_waitcnt lgkmcnt(0)
v_mfma_f32_16x16x32_bf16 v[216:219], v[128:131], v[112:115], v[216:219]
s_barrier
v_mfma_f32_16x16x32_bf16 v[244:247], v[112:115], v[132:135], v[244:247]
ds_read_b128 v[140:143], v7 offset:0
ds_read_b128 v[144:147], v7 offset:64
v_mfma_f32_16x16x32_bf16 v[248:251], v[112:115], v[136:139], v[248:251]
ds_read_b128 v[148:151], v7 offset:256
ds_read_b128 v[152:155], v7 offset:320
v_mfma_f32_16x16x32_bf16 v[240:243], v[108:111], v[136:139], v[240:243]
ds_read_b64 v[92:93], v8 offset:0
ds_read_b64 v[94:95], v8 offset:128
v_mfma_f32_16x16x32_bf16 v[236:239], v[108:111], v[132:135], v[236:239]
ds_read_b64 v[96:97], v8 offset:256
ds_read_b64 v[98:99], v8 offset:384
v_mfma_f32_16x16x32_bf16 v[228:231], v[104:107], v[132:135], v[228:231]
ds_read2_b32 v[56:57], v54 offset0:128 offset1:144
v_xor_b32 v10, s48, v10
v_mfma_f32_16x16x32_bf16 v[232:235], v[104:107], v[136:139], v[232:235]
ds_read_b128 v[60:63], v9 offset:0
v_xor_b32 v11, s48, v11
v_mfma_f32_16x16x32_bf16 v[224:227], v[100:103], v[136:139], v[224:227]
ds_read_b128 v[64:67], v9 offset:64
v_xor_b32 v12, s48, v12
v_mfma_f32_16x16x32_bf16 v[220:223], v[100:103], v[132:135], v[220:223]
ds_read_b128 v[68:71], v9 offset:128
v_xor_b32 v13, s48, v13
v_mfma_f32_16x16x32_bf16 v[156:159], v[116:119], v[100:103], v[156:159]
ds_read_b128 v[72:75], v9 offset:192
v_xor_b32 v14, s48, v14
v_mfma_f32_16x16x32_bf16 v[164:167], v[116:119], v[104:107], v[164:167]
ds_read_b128 v[76:79], v9 offset:512
v_xor_b32 v15, s48, v15
v_mfma_f32_16x16x32_bf16 v[172:175], v[116:119], v[108:111], v[172:175]
ds_read_b128 v[80:83], v9 offset:576
v_xor_b32 v16, s48, v16
v_mfma_f32_16x16x32_bf16 v[180:183], v[116:119], v[112:115], v[180:183]
ds_read_b128 v[84:87], v9 offset:640
v_xor_b32 v17, s48, v17
v_mfma_f32_16x16x32_bf16 v[184:187], v[120:123], v[112:115], v[184:187]
ds_read_b128 v[88:91], v9 offset:704
v_mfma_f32_16x16x32_bf16 v[176:179], v[120:123], v[108:111], v[176:179]
v_mfma_f32_16x16x32_bf16 v[168:171], v[120:123], v[104:107], v[168:171]
v_mfma_f32_16x16x32_bf16 v[160:163], v[120:123], v[100:103], v[160:163]
c1_epi:
s_waitcnt lgkmcnt(0)
.p2align 3
v_mul_f32 v129, s66, v94
v_mul_f32 v128, s66, v92
v_mul_f32 v131, s66, v98
v_mul_f32 v130, s66, v96
v_pk_fma_f32 v[190:191], v[150:151], v[92:93], v[190:191] op_sel:[0,1,0] op_sel_hi:[1,1,1]
v_pk_fma_f32 v[212:213], v[148:149], v[98:99], v[212:213] op_sel:[0,1,0] op_sel_hi:[1,1,1]
v_pk_fma_f32 v[214:215], v[150:151], v[98:99], v[214:215] op_sel:[0,1,0] op_sel_hi:[1,1,1]
v_pk_fma_f32 v[188:189], v[148:149], v[92:93], v[188:189] op_sel:[0,1,0] op_sel_hi:[1,1,1]
v_pk_fma_f32 v[218:219], v[154:155], v[98:99], v[218:219] op_sel:[0,1,0] op_sel_hi:[1,1,1]
v_cvt_pk_bf16_f32 v188, v188, v189
v_cvt_pk_bf16_f32 v189, v190, v191
v_pk_fma_f32 v[196:197], v[148:149], v[94:95], v[196:197] op_sel:[0,1,0] op_sel_hi:[1,1,1]
v_pk_fma_f32 v[200:201], v[152:153], v[94:95], v[200:201] op_sel:[0,1,0] op_sel_hi:[1,1,1]
v_pk_fma_f32 v[210:211], v[154:155], v[96:97], v[210:211] op_sel:[0,1,0] op_sel_hi:[1,1,1]
v_pk_fma_f32 v[240:241], v[84:85], v[56:57], v[240:241] op_sel:[0,1,0] op_sel_hi:[1,1,1]
v_pk_fma_f32 v[228:229], v[80:81], v[56:57], v[228:229] op_sel:[0,0,0] op_sel_hi:[1,0,1]
v_pk_fma_f32 v[226:227], v[78:79], v[56:57], v[226:227] op_sel:[0,1,0] op_sel_hi:[1,1,1]
v_pk_fma_f32 v[192:193], v[152:153], v[92:93], v[192:193] op_sel:[0,1,0] op_sel_hi:[1,1,1]
v_cvt_pk_bf16_f32 v190, v192, v193
v_pk_fma_f32 v[238:239], v[86:87], v[56:57], v[238:239] op_sel:[0,0,0] op_sel_hi:[1,0,1]
v_pk_fma_f32 v[234:235], v[82:83], v[56:57], v[234:235] op_sel:[0,1,0] op_sel_hi:[1,1,1]
v_pk_mul_f32 v[226:227], v[226:227], v[62:63]
v_pk_fma_f32 v[204:205], v[148:149], v[96:97], v[204:205] op_sel:[0,1,0] op_sel_hi:[1,1,1]
v_cvt_pk_bf16_f32 v204, v204, v205
v_pk_fma_f32 v[202:203], v[154:155], v[94:95], v[202:203] op_sel:[0,1,0] op_sel_hi:[1,1,1]
v_pk_fma_f32 v[224:225], v[76:77], v[56:57], v[224:225] op_sel:[0,1,0] op_sel_hi:[1,1,1]
v_pk_fma_f32 v[216:217], v[152:153], v[98:99], v[216:217] op_sel:[0,1,0] op_sel_hi:[1,1,1]
v_pk_fma_f32 v[244:245], v[88:89], v[56:57], v[244:245] op_sel:[0,0,0] op_sel_hi:[1,0,1]
v_pk_mul_f32 v[238:239], v[238:239], v[70:71]
v_pk_mul_f32 v[228:229], v[228:229], v[64:65]
v_pk_fma_f32 v[236:237], v[84:85], v[56:57], v[236:237] op_sel:[0,0,0] op_sel_hi:[1,0,1]
v_pk_fma_f32 v[220:221], v[76:77], v[56:57], v[220:221] op_sel:[0,0,0] op_sel_hi:[1,0,1]
v_pk_mul_f32 v[224:225], v[224:225], v[60:61]
v_cvt_pk_bf16_f32 v212, v212, v213
v_cvt_pk_bf16_f32 v213, v214, v215
v_cvt_pk_bf16_f32 v196, v196, v197
v_pk_mul_f32 v[240:241], v[240:241], v[68:69]
v_pk_fma_f32 v[198:199], v[150:151], v[94:95], v[198:199] op_sel:[0,1,0] op_sel_hi:[1,1,1]
v_cvt_pk_bf16_f32 v197, v198, v199
v_cvt_pk_bf16_f32 v198, v200, v201
v_cvt_pk_bf16_f32 v199, v202, v203
v_cvt_pk_bf16_f32 v215, v218, v219
v_pk_fma_f32 v[208:209], v[152:153], v[96:97], v[208:209] op_sel:[0,1,0] op_sel_hi:[1,1,1]
v_pk_fma_f32 v[246:247], v[90:91], v[56:57], v[246:247] op_sel:[0,0,0] op_sel_hi:[1,0,1]
v_pk_fma_f32 v[250:251], v[90:91], v[56:57], v[250:251] op_sel:[0,1,0] op_sel_hi:[1,1,1]
v_pk_mul_f32 v[250:251], v[250:251], v[74:75]
v_pk_fma_f32 v[206:207], v[150:151], v[96:97], v[206:207] op_sel:[0,1,0] op_sel_hi:[1,1,1]
v_cvt_pk_bf16_f32 v205, v206, v207
v_pk_fma_f32 v[242:243], v[86:87], v[56:57], v[242:243] op_sel:[0,1,0] op_sel_hi:[1,1,1]
v_cvt_pk_bf16_f32 v207, v210, v211
v_pk_mul_f32 v[236:237], v[236:237], v[68:69]
v_pk_fma_f32 v[230:231], v[82:83], v[56:57], v[230:231] op_sel:[0,0,0] op_sel_hi:[1,0,1]
v_pk_fma_f32 v[194:195], v[154:155], v[92:93], v[194:195] op_sel:[0,1,0] op_sel_hi:[1,1,1]
v_cvt_pk_bf16_f32 v191, v194, v195
v_pk_fma_f32 v[232:233], v[80:81], v[56:57], v[232:233] op_sel:[0,1,0] op_sel_hi:[1,1,1]
v_pk_mul_f32 v[232:233], v[232:233], v[64:65]
v_pk_mul_f32 v[230:231], v[230:231], v[66:67]
v_pk_fma_f32 v[248:249], v[88:89], v[56:57], v[248:249] op_sel:[0,1,0] op_sel_hi:[1,1,1]
v_pk_mul_f32 v[248:249], v[248:249], v[72:73]
v_pk_mul_f32 v[242:243], v[242:243], v[70:71]
v_mfma_f32_16x16x32_bf16 v[68:71], v[10:13], v[196:199], 0
v_cvt_pk_bf16_f32 v206, v208, v209
v_cvt_pk_bf16_f32 v214, v216, v217
v_cvt_pk_bf16_f32 v121, v226, v227
v_mfma_f32_16x16x32_bf16 v[80:83], v[14:17], v[204:207], 0
v_cvt_pk_bf16_f32 v120, v224, v225
v_cvt_pk_bf16_f32 v114, v228, v229
v_mfma_f32_16x16x32_bf16 v[84:87], v[10:13], v[212:215], 0
v_cvt_pk_bf16_f32 v116, v236, v237
v_min3_f32 v105, v68, v69, v70
v_mfma_f32_16x16x32_bf16 v[88:91], v[14:17], v[212:215], 0
v_max3_f32 v101, v68, v69, v70
v_cvt_pk_bf16_f32 v115, v230, v231
v_cvt_pk_bf16_f32 v122, v232, v233
v_cvt_pk_bf16_f32 v127, v250, v251
v_cvt_pk_bf16_f32 v124, v240, v241
v_pk_mul_f32 v[244:245], v[244:245], v[72:73]
v_pk_fma_f32 v[222:223], v[78:79], v[56:57], v[222:223] op_sel:[0,0,0] op_sel_hi:[1,0,1]
v_pk_mul_f32 v[222:223], v[222:223], v[62:63]
v_mfma_f32_16x16x32_bf16 v[76:79], v[10:13], v[204:207], 0
v_min3_f32 v107, v84, v85, v86
v_min3_f32 v107, v107, v87, v88
v_min3_f32 v107, v107, v89, v90
v_min_f32_e64 v107, v107, v91
v_max3_f32 v103, v84, v85, v86
v_pk_mul_f32 v[220:221], v[220:221], v[60:61]
v_mfma_f32_16x16x32_bf16 v[60:63], v[10:13], v[188:191], 0
v_max3_f32 v103, v103, v87, v88
v_min3_f32 v106, v76, v77, v78
v_min3_f32 v106, v106, v79, v80
v_min3_f32 v106, v106, v81, v82
v_min_f32 v106, v106, v83
v_pk_mul_f32 v[234:235], v[234:235], v[66:67]
v_mfma_f32_16x16x32_bf16 v[64:67], v[14:17], v[188:191], 0
v_permlane32_swap_b32 v106, v107
v_min3_f32 v104, v60, v61, v62
v_min_f32 v106, v106, v107
v_max3_f32 v103, v103, v89, v90
v_pk_mul_f32 v[246:247], v[246:247], v[74:75]
v_mfma_f32_16x16x32_bf16 v[72:75], v[14:17], v[196:199], 0
v_max_f32 v103, v103, v91
v_max3_f32 v102, v76, v77, v78
v_min3_f32 v104, v104, v63, v64
v_min3_f32 v104, v104, v65, v66
v_min_f32 v104, v104, v67
v_max3_f32 v102, v102, v79, v80
v_max3_f32 v102, v102, v81, v82
v_max_f32 v102, v102, v83
v_min3_f32 v105, v105, v71, v72
v_min3_f32 v105, v105, v73, v74
v_min_f32 v105, v105, v75
v_max3_f32 v101, v101, v71, v72
v_max3_f32 v101, v101, v73, v74
v_permlane32_swap_b32 v104, v105
v_permlane32_swap_b32 v102, v103
v_min_f32 v104, v104, v105
v_max_f32 v102, v102, v103
v_max_f32 v101, v101, v75
v_permlane16_swap_b32 v104, v106
v_max3_f32 v100, v60, v61, v62
v_min_f32 v104, v104, v106
v_mov_b32 v106, v104
v_max3_f32 v100, v100, v63, v64
v_max3_f32 v100, v100, v65, v66
v_max_f32 v100, v100, v67
v_permlane16_swap_b32 v104, v106
v_cvt_pk_bf16_f32 v112, v220, v221
v_permlane32_swap_b32 v100, v101
v_mov_b32 v105, v104
v_max_f32 v100, v100, v101
v_mov_b32 v107, v106
v_permlane32_swap_b32 v104, v105
v_permlane16_swap_b32 v100, v102
v_pk_mul_f32 v[104:105], v[104:105], v[128:129]
v_pk_fma_f32 v[226:227], v[66:67], v[128:129], v[104:105] op_sel:[0,0,0] op_sel_hi:[1,0,0] neg_lo:[1,0,0] neg_hi:[1,0,0]
v_pk_fma_f32 v[230:231], v[70:71], v[128:129], v[104:105] op_sel:[0,1,1] op_sel_hi:[1,1,1] neg_lo:[1,0,0] neg_hi:[1,0,0]
v_exp_f32 v226, v226
v_pk_fma_f32 v[224:225], v[64:65], v[128:129], v[104:105] op_sel:[0,0,0] op_sel_hi:[1,0,0] neg_lo:[1,0,0] neg_hi:[1,0,0]
v_exp_f32 v224, v224
v_pk_fma_f32 v[228:229], v[68:69], v[128:129], v[104:105] op_sel:[0,1,1] op_sel_hi:[1,1,1] neg_lo:[1,0,0] neg_hi:[1,0,0]
v_exp_f32 v231, v231
v_cvt_pk_bf16_f32 v113, v222, v223
v_pk_fma_f32 v[222:223], v[62:63], v[128:129], v[104:105] op_sel:[0,0,0] op_sel_hi:[1,0,0] neg_lo:[1,0,0] neg_hi:[1,0,0]
v_exp_f32 v222, v222
v_pk_fma_f32 v[220:221], v[60:61], v[128:129], v[104:105] op_sel:[0,0,0] op_sel_hi:[1,0,0] neg_lo:[1,0,0] neg_hi:[1,0,0]
v_exp_f32 v221, v221
v_exp_f32 v220, v220
v_max_f32 v100, v100, v102
v_exp_f32 v223, v223
v_mov_b32 v102, v100
v_pk_add_f32 v[110:111], v[220:221], v[222:223]
v_exp_f32 v225, v225
v_pk_fma_f32 v[232:233], v[72:73], v[128:129], v[104:105] op_sel:[0,1,1] op_sel_hi:[1,1,1] neg_lo:[1,0,0] neg_hi:[1,0,0]
v_exp_f32 v232, v232
v_exp_f32 v233, v233
v_pk_add_f32 v[110:111], v[110:111], v[224:225]
v_exp_f32 v229, v229
v_exp_f32 v228, v228
v_exp_f32 v227, v227
v_cvt_pk_bf16_f32 v123, v234, v235
v_pk_fma_f32 v[234:235], v[74:75], v[128:129], v[104:105] op_sel:[0,1,1] op_sel_hi:[1,1,1] neg_lo:[1,0,0] neg_hi:[1,0,0]
v_pk_add_f32 v[110:111], v[110:111], v[226:227]
v_add_f32 v104, v110, v111
v_cvt_pk_bf16_f32 v118, v244, v245
v_permlane32_swap_b32 v106, v107
v_permlane16_swap_b32 v100, v102
v_exp_f32 v234, v234
v_mov_b32 v101, v100
v_exp_f32 v235, v235
v_exp_f32_e64 v230, v230
v_cvt_pk_bf16_f32 v125, v242, v243
v_pk_add_f32 v[110:111], v[228:229], v[230:231]
v_pk_add_f32 v[110:111], v[110:111], v[232:233]
v_pk_add_f32 v[110:111], v[110:111], v[234:235]
v_cvt_pk_bf16_f32 v126, v248, v249
v_pk_mul_f32 v[106:107], v[106:107], v[130:131]
v_pk_fma_f32 v[236:237], v[76:77], v[130:131], v[106:107] op_sel:[0,0,0] op_sel_hi:[1,0,0] neg_lo:[1,0,0] neg_hi:[1,0,0]
v_exp_f32 v237, v237
v_exp_f32 v236, v236
v_pk_fma_f32 v[242:243], v[82:83], v[130:131], v[106:107] op_sel:[0,0,0] op_sel_hi:[1,0,0] neg_lo:[1,0,0] neg_hi:[1,0,0]
v_pk_fma_f32 v[250:251], v[90:91], v[130:131], v[106:107] op_sel:[0,1,1] op_sel_hi:[1,1,1] neg_lo:[1,0,0] neg_hi:[1,0,0]
v_add_f32 v105, v110, v111
v_exp_f32 v243, v243
v_cvt_pk_bf16_f32 v119, v246, v247
v_pk_fma_f32 v[246:247], v[86:87], v[130:131], v[106:107] op_sel:[0,1,1] op_sel_hi:[1,1,1] neg_lo:[1,0,0] neg_hi:[1,0,0]
v_exp_f32 v246, v246
v_cvt_pk_bf16_f32 v117, v238, v239
v_pk_fma_f32 v[238:239], v[78:79], v[130:131], v[106:107] op_sel:[0,0,0] op_sel_hi:[1,0,0] neg_lo:[1,0,0] neg_hi:[1,0,0]
v_exp_f32 v238, v238
v_exp_f32 v247, v247
v_pk_fma_f32 v[240:241], v[80:81], v[130:131], v[106:107] op_sel:[0,0,0] op_sel_hi:[1,0,0] neg_lo:[1,0,0] neg_hi:[1,0,0]
v_exp_f32 v240, v240
v_exp_f32 v241, v241
v_permlane32_swap_b32 v100, v101
v_exp_f32 v242, v242
v_pk_fma_f32 v[244:245], v[84:85], v[130:131], v[106:107] op_sel:[0,1,1] op_sel_hi:[1,1,1] neg_lo:[1,0,0] neg_hi:[1,0,0]
v_exp_f32 v244, v244
v_exp_f32_e64 v239, v239
v_pk_mul_f32 v[100:101], v[100:101], v[128:129]
v_pk_fma_f32 v[62:63], v[62:63], v[128:129], v[100:101] op_sel:[0,0,0] op_sel_hi:[1,0,0] neg_lo:[0,0,1] neg_hi:[0,0,1]
v_pk_add_f32 v[110:111], v[236:237], v[238:239]
v_pk_add_f32 v[110:111], v[110:111], v[240:241]
v_pk_add_f32 v[110:111], v[110:111], v[242:243]
v_pk_fma_f32 v[72:73], v[72:73], v[128:129], v[100:101] op_sel:[0,1,1] op_sel_hi:[1,1,1] neg_lo:[0,0,1] neg_hi:[0,0,1]
v_pk_fma_f32 v[66:67], v[66:67], v[128:129], v[100:101] op_sel:[0,0,0] op_sel_hi:[1,0,0] neg_lo:[0,0,1] neg_hi:[0,0,1]
v_exp_f32 v62, v62
v_pk_fma_f32 v[60:61], v[60:61], v[128:129], v[100:101] op_sel:[0,0,0] op_sel_hi:[1,0,0] neg_lo:[0,0,1] neg_hi:[0,0,1]
v_exp_f32 v60, v60
v_exp_f32 v245, v245
v_exp_f32 v73, v73
v_pk_fma_f32 v[248:249], v[88:89], v[130:131], v[106:107] op_sel:[0,1,1] op_sel_hi:[1,1,1] neg_lo:[1,0,0] neg_hi:[1,0,0]
v_add_f32 v106, v110, v111
v_exp_f32 v249, v249
v_pk_add_f32 v[110:111], v[244:245], v[246:247]
v_exp_f32 v248, v248
v_pk_fma_f32 v[64:65], v[64:65], v[128:129], v[100:101] op_sel:[0,0,0] op_sel_hi:[1,0,0] neg_lo:[0,0,1] neg_hi:[0,0,1]
v_exp_f32 v64, v64
v_pk_add_f32 v[110:111], v[110:111], v[248:249]
v_exp_f32 v65, v65
v_exp_f32 v61, v61
v_exp_f32 v66, v66
v_exp_f32 v251, v251
v_exp_f32 v63, v63
v_pk_fma_f32 v[74:75], v[74:75], v[128:129], v[100:101] op_sel:[0,1,1] op_sel_hi:[1,1,1] neg_lo:[0,0,1] neg_hi:[0,0,1]
v_pk_add_f32 v[108:109], v[60:61], v[62:63]
v_exp_f32 v67, v67
v_exp_f32 v250, v250
v_pk_fma_f32 v[68:69], v[68:69], v[128:129], v[100:101] op_sel:[0,1,1] op_sel_hi:[1,1,1] neg_lo:[0,0,1] neg_hi:[0,0,1]
v_pk_add_f32 v[110:111], v[110:111], v[250:251]
v_exp_f32 v68, v68
v_exp_f32 v69, v69
v_add_f32 v107, v110, v111
v_mov_b32 v103, v102
v_pk_fma_f32 v[70:71], v[70:71], v[128:129], v[100:101] op_sel:[0,1,1] op_sel_hi:[1,1,1] neg_lo:[0,0,1] neg_hi:[0,0,1]
v_exp_f32 v71, v71
v_exp_f32 v70, v70
v_permlane32_swap_b32 v106, v107
v_permlane32_swap_b32 v102, v103
v_pk_add_f32 v[108:109], v[108:109], v[64:65]
v_pk_add_f32 v[108:109], v[108:109], v[66:67]
v_add_f32 v100, v108, v109
v_pk_add_f32 v[108:109], v[68:69], v[70:71]
v_pk_mul_f32 v[102:103], v[102:103], v[130:131]
v_pk_fma_f32 v[78:79], v[78:79], v[130:131], v[102:103] op_sel:[0,0,0] op_sel_hi:[1,0,0] neg_lo:[0,0,1] neg_hi:[0,0,1]
v_exp_f32 v79, v79
v_exp_f32 v78, v78
v_exp_f32 v74, v74
v_exp_f32 v72, v72
v_pk_fma_f32 v[86:87], v[86:87], v[130:131], v[102:103] op_sel:[0,1,1] op_sel_hi:[1,1,1] neg_lo:[0,0,1] neg_hi:[0,0,1]
v_exp_f32 v87, v87
v_pk_fma_f32 v[76:77], v[76:77], v[130:131], v[102:103] op_sel:[0,0,0] op_sel_hi:[1,0,0] neg_lo:[0,0,1] neg_hi:[0,0,1]
v_exp_f32 v77, v77
v_add_f32 v106, v106, v107
v_pk_fma_f32 v[80:81], v[80:81], v[130:131], v[102:103] op_sel:[0,0,0] op_sel_hi:[1,0,0] neg_lo:[0,0,1] neg_hi:[0,0,1]
v_exp_f32 v81, v81
v_exp_f32 v80, v80
v_pk_add_f32 v[108:109], v[108:109], v[72:73]
v_permlane32_swap_b32 v104, v105
v_exp_f32 v75, v75
v_add_f32 v104, v104, v105
v_pk_fma_f32 v[82:83], v[82:83], v[130:131], v[102:103] op_sel:[0,0,0] op_sel_hi:[1,0,0] neg_lo:[0,0,1] neg_hi:[0,0,1]
v_exp_f32 v82, v82
v_exp_f32 v83, v83
v_permlane16_swap_b32 v104, v106
v_pk_add_f32 v[108:109], v[108:109], v[74:75]
v_add_f32 v101, v108, v109
v_exp_f32 v76, v76
v_add_f32 v104, v104, v106
v_rcp_f32 v104, v104
v_pk_fma_f32 v[84:85], v[84:85], v[130:131], v[102:103] op_sel:[0,1,1] op_sel_hi:[1,1,1] neg_lo:[0,0,1] neg_hi:[0,0,1]
v_exp_f32 v84, v84
v_exp_f32 v85, v85
v_mov_b32 v106, v104
v_pk_add_f32 v[108:109], v[76:77], v[78:79]
v_pk_add_f32 v[108:109], v[108:109], v[80:81]
v_pk_add_f32 v[108:109], v[108:109], v[82:83]
v_pk_fma_f32 v[88:89], v[88:89], v[130:131], v[102:103] op_sel:[0,1,1] op_sel_hi:[1,1,1] neg_lo:[0,0,1] neg_hi:[0,0,1]
v_exp_f32 v88, v88
v_exp_f32 v89, v89
v_exp_f32 v86, v86
v_pk_fma_f32 v[90:91], v[90:91], v[130:131], v[102:103] op_sel:[0,1,1] op_sel_hi:[1,1,1] neg_lo:[0,0,1] neg_hi:[0,0,1]
v_add_f32 v102, v108, v109
v_pk_add_f32 v[108:109], v[84:85], v[86:87]
v_pk_add_f32 v[108:109], v[108:109], v[88:89]
v_permlane16_swap_b32 v104, v106
v_exp_f32 v90, v90
v_exp_f32 v91, v91
v_permlane32_swap_b32 v100, v101
v_pk_add_f32 v[108:109], v[108:109], v[90:91]
v_add_f32 v103, v108, v109
v_add_f32 v100, v100, v101
v_mov_b32 v105, v104
v_permlane32_swap_b32 v102, v103
v_mov_b32 v107, v106
v_add_f32 v102, v102, v103
v_permlane32_swap_b32 v104, v105
v_permlane32_swap_b32 v106, v107
v_permlane16_swap_b32 v100, v102
v_pk_mul_f32 v[222:223], v[222:223], v[104:105] op_sel:[0,0] op_sel_hi:[1,0]
v_pk_mul_f32 v[226:227], v[226:227], v[104:105] op_sel:[0,0] op_sel_hi:[1,0]
v_pk_mul_f32 v[234:235], v[234:235], v[104:105] op_sel:[0,1] op_sel_hi:[1,1]
v_pk_mul_f32 v[232:233], v[232:233], v[104:105] op_sel:[0,1] op_sel_hi:[1,1]
v_pk_mul_f32 v[230:231], v[230:231], v[104:105] op_sel:[0,1] op_sel_hi:[1,1]
v_add_f32 v100, v100, v102
v_pk_mul_f32 v[228:229], v[228:229], v[104:105] op_sel:[0,1] op_sel_hi:[1,1]
v_cvt_pk_bf16_f32 v228, v228, v229
v_cvt_pk_bf16_f32 v229, v230, v231
v_cvt_pk_bf16_f32 v231, v234, v235
v_cvt_pk_bf16_f32 v230, v232, v233
v_pk_mul_f32 v[220:221], v[220:221], v[104:105] op_sel:[0,0] op_sel_hi:[1,0]
v_cvt_pk_bf16_f32 v220, v220, v221
v_pk_mul_f32 v[224:225], v[224:225], v[104:105] op_sel:[0,0] op_sel_hi:[1,0]
v_pk_mul_f32 v[236:237], v[236:237], v[106:107] op_sel:[0,0] op_sel_hi:[1,0]
v_pk_mul_f32 v[238:239], v[238:239], v[106:107] op_sel:[0,0] op_sel_hi:[1,0]
v_pk_mul_f32 v[240:241], v[240:241], v[106:107] op_sel:[0,0] op_sel_hi:[1,0]
v_pk_mul_f32 v[242:243], v[242:243], v[106:107] op_sel:[0,0] op_sel_hi:[1,0]
v_pk_mul_f32 v[248:249], v[248:249], v[106:107] op_sel:[0,1] op_sel_hi:[1,1]
v_rcp_f32 v100, v100
v_pk_mul_f32 v[244:245], v[244:245], v[106:107] op_sel:[0,1] op_sel_hi:[1,1]
v_mov_b32 v102, v100
v_pk_mul_f32 v[250:251], v[250:251], v[106:107] op_sel:[0,1] op_sel_hi:[1,1]
v_cvt_pk_bf16_f32 v221, v222, v223
v_pk_mul_f32 v[246:247], v[246:247], v[106:107] op_sel:[0,1] op_sel_hi:[1,1]
v_cvt_pk_bf16_f32 v222, v224, v225
v_mfma_f32_16x16x32_bf16 v[200:203], v[228:231], v[36:39], 0
v_cvt_pk_bf16_f32 v223, v226, v227
v_permlane16_swap_b32 v100, v102
v_mfma_f32_16x16x32_bf16 v[196:199], v[228:231], v[38:41], 0
v_mov_b32 v101, v100
v_cvt_pk_bf16_f32 v244, v244, v245
v_mfma_f32_16x16x32_bf16 v[212:215], v[220:223], v[38:41], 0
v_cvt_pk_bf16_f32 v245, v246, v247
v_cvt_pk_bf16_f32 v247, v250, v251
v_mfma_f32_16x16x32_bf16 v[216:219], v[220:223], v[36:39], 0
v_cvt_pk_bf16_f32 v234, v200, v201
v_cvt_pk_bf16_f32 v246, v248, v249
v_cvt_pk_bf16_f32 v226, v196, v197
v_cvt_pk_bf16_f32 v227, v198, v199
v_mfma_f32_16x16x32_bf16 v[196:199], v[244:247], v[38:41], 0
v_cvt_pk_bf16_f32 v225, v214, v215
v_cvt_pk_bf16_f32 v236, v236, v237
v_cvt_pk_bf16_f32 v237, v238, v239
v_cvt_pk_bf16_f32 v232, v216, v217
v_cvt_pk_bf16_f32 v233, v218, v219
v_cvt_pk_bf16_f32 v239, v242, v243
v_cvt_pk_bf16_f32 v238, v240, v241
v_cvt_pk_bf16_f32 v224, v212, v213
v_permlane32_swap_b32 v100, v101
v_mfma_f32_16x16x32_bf16 v[216:219], v[236:239], v[36:39], 0
v_mov_b32 v103, v102
v_cvt_pk_bf16_f32 v235, v202, v203
v_mfma_f32_16x16x32_bf16 v[212:215], v[236:239], v[38:41], 0
v_cvt_pk_bf16_f32 v243, v198, v199
v_permlane32_swap_b32 v102, v103
v_mfma_f32_16x16x32_bf16 v[200:203], v[244:247], v[36:39], 0
v_cvt_pk_bf16_f32 v242, v196, v197
v_mov_b32 v5, s61
v_mfma_f32_16x16x32_bf16 v[220:223], v[232:235], v[120:123], 0
v_cvt_pk_bf16_f32 v249, v218, v219
v_cvt_pk_bf16_f32 v248, v216, v217
v_cvt_pk_bf16_f32 v241, v214, v215
v_cvt_pk_bf16_f32 v240, v212, v213
v_cmp_eq_u32 s[50:51], s41, v2
v_pk_mul_f32 v[64:65], v[64:65], v[100:101] op_sel:[0,0] op_sel_hi:[1,0]
v_pk_mul_f32 v[74:75], v[74:75], v[100:101] op_sel:[0,1] op_sel_hi:[1,1]
v_pk_mul_f32 v[68:69], v[68:69], v[100:101] op_sel:[0,1] op_sel_hi:[1,1]
v_pk_mul_f32 v[72:73], v[72:73], v[100:101] op_sel:[0,1] op_sel_hi:[1,1]
v_pk_mul_f32 v[60:61], v[60:61], v[100:101] op_sel:[0,0] op_sel_hi:[1,0]
v_pk_mul_f32 v[62:63], v[62:63], v[100:101] op_sel:[0,0] op_sel_hi:[1,0]
v_pk_mul_f32 v[66:67], v[66:67], v[100:101] op_sel:[0,0] op_sel_hi:[1,0]
v_pk_mul_f32 v[76:77], v[76:77], v[102:103] op_sel:[0,0] op_sel_hi:[1,0]
v_pk_mul_f32 v[70:71], v[70:71], v[100:101] op_sel:[0,1] op_sel_hi:[1,1]
v_cvt_pk_bf16_f32 v60, v60, v61
v_pk_mul_f32 v[80:81], v[80:81], v[102:103] op_sel:[0,0] op_sel_hi:[1,0]
v_pk_mul_f32 v[78:79], v[78:79], v[102:103] op_sel:[0,0] op_sel_hi:[1,0]
v_pk_mul_f32 v[82:83], v[82:83], v[102:103] op_sel:[0,0] op_sel_hi:[1,0]
v_pk_mul_f32 v[86:87], v[86:87], v[102:103] op_sel:[0,1] op_sel_hi:[1,1]
v_cvt_pk_bf16_f32 v61, v62, v63
v_pk_mul_f32 v[84:85], v[84:85], v[102:103] op_sel:[0,1] op_sel_hi:[1,1]
v_cvt_pk_bf16_f32 v62, v64, v65
v_pk_mul_f32 v[88:89], v[88:89], v[102:103] op_sel:[0,1] op_sel_hi:[1,1]
v_cvt_pk_bf16_f32 v63, v66, v67
v_pk_mul_f32 v[90:91], v[90:91], v[102:103] op_sel:[0,1] op_sel_hi:[1,1]
v_cvt_pk_bf16_f32 v68, v68, v69
v_mfma_f32_16x16x32_bf16 v[208:211], v[60:63], v[36:39], 0
v_cvt_pk_bf16_f32 v69, v70, v71
v_cvt_pk_bf16_f32 v70, v72, v73
v_mfma_f32_16x16x32_bf16 v[204:207], v[60:63], v[38:41], 0
v_cvt_pk_bf16_f32 v71, v74, v75
v_cvt_pk_bf16_f32 v76, v76, v77
v_mfma_f32_16x16x32_bf16 v[60:63], v[232:235], v[112:115], 0
v_cvt_pk_bf16_f32 v250, v200, v201
v_cvt_pk_bf16_f32 v77, v78, v79
v_mfma_f32_16x16x32_bf16 v[192:195], v[68:71], v[36:39], 0
v_cvt_pk_bf16_f32 v78, v80, v81
v_cvt_pk_bf16_f32 v79, v82, v83
v_mfma_f32_16x16x32_bf16 v[188:191], v[68:71], v[38:41], 0
v_cvt_pk_bf16_f32 v65, v206, v207
v_cvt_pk_bf16_f32 v64, v204, v205
v_mfma_f32_16x16x32_bf16 v[68:71], v[224:227], v[120:123], 0
v_cvt_pk_bf16_f32 v251, v202, v203
v_cvt_pk_bf16_f32 v72, v208, v209
v_mfma_f32_16x16x32_bf16 v[152:155], v[224:227], v[112:115], 0
v_cvt_pk_bf16_f32 v73, v210, v211
v_cvt_pk_bf16_f32 v84, v84, v85
v_mfma_f32_16x16x32_bf16 v[60:63], v[248:251], v[116:119], v[60:63]
v_cvt_pk_bf16_f32 v85, v86, v87
v_cvt_pk_bf16_f32 v86, v88, v89
v_mfma_f32_16x16x32_bf16 v[228:231], v[224:227], v[48:51], 0
v_cvt_pk_bf16_f32 v67, v190, v191
v_cvt_pk_bf16_f32 v87, v90, v91
v_mfma_f32_16x16x32_bf16 v[220:223], v[248:251], v[124:127], v[220:223]
v_cvt_pk_bf16_f32 v66, v188, v189
v_cvt_pk_bf16_f32 v74, v192, v193
v_mfma_f32_16x16x32_bf16 v[152:155], v[240:243], v[116:119], v[152:155]
v_cvt_pk_bf16_f32 v75, v194, v195
v_mfma_f32_16x16x32_bf16 v[204:207], v[76:79], v[38:41], 0
v_mfma_f32_16x16x32_bf16 v[208:211], v[76:79], v[36:39], 0
v_mfma_f32_16x16x32_bf16 v[228:231], v[240:243], v[48:51], v[228:231]
v_mfma_f32_16x16x32_bf16 v[68:71], v[240:243], v[124:127], v[68:71]
v_mfma_f32_16x16x32_bf16 v[76:79], v[232:235], v[48:51], 0
s_nop 1
v_cvt_pk_bf16_f32 v152, v152, v153
v_mfma_f32_16x16x32_bf16 v[76:79], v[248:251], v[48:51], v[76:79]
v_cvt_pk_bf16_f32 v153, v154, v155
v_cvt_pk_bf16_f32 v154, v60, v61
v_mfma_f32_16x16x32_bf16 v[192:195], v[84:87], v[36:39], 0
v_cvt_pk_bf16_f32 v68, v68, v69
v_cvt_pk_bf16_f32 v155, v62, v63
v_mfma_f32_16x16x32_bf16 v[188:191], v[84:87], v[38:41], 0
ds_write_b128 v42, v[152:155] offset:0
v_mfma_f32_16x16x32_bf16 v[136:139], v[64:67], v[48:51], 0
v_cvt_pk_bf16_f32 v69, v70, v71
v_cvt_pk_bf16_f32 v228, v228, v229
v_mfma_f32_16x16x32_bf16 v[104:107], v[72:75], v[112:115], 0
v_cvt_pk_bf16_f32 v71, v222, v223
v_cvt_pk_bf16_f32 v229, v230, v231
v_mfma_f32_16x16x32_bf16 v[148:151], v[72:75], v[48:51], 0
v_cvt_pk_bf16_f32 v230, v76, v77
v_cvt_pk_bf16_f32 v70, v220, v221
v_mfma_f32_16x16x32_bf16 v[132:135], v[72:75], v[120:123], 0
ds_write_b128 v42, v[68:71] offset:1024
v_mfma_f32_16x16x32_bf16 v[108:111], v[64:67], v[120:123], 0
v_cvt_pk_bf16_f32 v231, v78, v79
ds_write_b128 v42, v[228:231] offset:2048
v_mfma_f32_16x16x32_bf16 v[100:103], v[64:67], v[112:115], 0
ds_write_b32 v52, v5
v_cvt_pk_bf16_f32 v88, v208, v209
v_cvt_pk_bf16_f32 v83, v190, v191
v_cvt_pk_bf16_f32 v91, v194, v195
v_cvt_pk_bf16_f32 v82, v188, v189
v_cvt_pk_bf16_f32 v80, v204, v205
v_cvt_pk_bf16_f32 v89, v210, v211
v_cvt_pk_bf16_f32 v81, v206, v207
v_cvt_pk_bf16_f32 v90, v192, v193
s_nop 0
v_mfma_f32_16x16x32_bf16 v[100:103], v[80:83], v[116:119], v[100:103]
v_mfma_f32_16x16x32_bf16 v[108:111], v[80:83], v[124:127], v[108:111]
v_mfma_f32_16x16x32_bf16 v[132:135], v[88:91], v[124:127], v[132:135]
v_mfma_f32_16x16x32_bf16 v[148:151], v[88:91], v[48:51], v[148:151]
v_mfma_f32_16x16x32_bf16 v[136:139], v[80:83], v[48:51], v[136:139]
v_mfma_f32_16x16x32_bf16 v[104:107], v[88:91], v[116:119], v[104:107]
s_mov_b32 s63, 0
px_82:
ds_read_b32 v4, v19
ds_read_b128 v[188:191], v43 offset:0
ds_read_b128 v[192:195], v43 offset:1024
ds_read_b128 v[196:199], v43 offset:2048
s_add_u32 s63, s63, 1
s_cmp_lt_u32 s63, 0x400000
s_waitcnt lgkmcnt(0)
v_cmp_ne_u32 vcc, s61, v4
s_cbranch_vccz pxd_83
s_cbranch_scc1 px_82
pxd_83:
v_mfma_f32_16x16x32_bf16 v[100:103], v[38:41], v[188:191], v[100:103]
v_mfma_f32_16x16x32_bf16 v[104:107], v[36:39], v[188:191], v[104:107]
v_mfma_f32_16x16x32_bf16 v[108:111], v[38:41], v[192:195], v[108:111]
v_mfma_f32_16x16x32_bf16 v[132:135], v[36:39], v[192:195], v[132:135]
v_mfma_f32_16x16x32_bf16 v[136:139], v[38:41], v[196:199], v[136:139]
v_mfma_f32_16x16x32_bf16 v[148:151], v[36:39], v[196:199], v[148:151]
s_nop 2
v_cvt_pk_bf16_f32 v100, v100, v101
v_cvt_pk_bf16_f32 v101, v102, v103
v_cvt_pk_bf16_f32 v102, v104, v105
v_cvt_pk_bf16_f32 v103, v106, v107
buffer_store_dwordx4 v[100:103], v55, s[32:35], s53 offen sc1
v_cvt_pk_bf16_f32 v108, v108, v109
v_cvt_pk_bf16_f32 v109, v110, v111
v_cvt_pk_bf16_f32 v110, v132, v133
v_cvt_pk_bf16_f32 v111, v134, v135
buffer_store_dwordx4 v[108:111], v55, s[32:35], s54 offen sc1
v_cvt_pk_bf16_f32 v136, v136, v137
v_cvt_pk_bf16_f32 v137, v138, v139
v_cvt_pk_bf16_f32 v138, v148, v149
v_cvt_pk_bf16_f32 v139, v150, v151
s_mov_b64 exec, s[50:51]
buffer_store_dwordx4 v[136:139], v58, s[32:35], s56 offen sc1
s_mov_b64 exec, -1
s_mov_b32 s51, 0
.p2align 3
v_pk_fma_f32 v[156:157], v[140:141], v[92:93], v[156:157] op_sel:[0,1,0] op_sel_hi:[1,1,1]
v_pk_fma_f32 v[164:165], v[140:141], v[94:95], v[164:165] op_sel:[0,1,0] op_sel_hi:[1,1,1]
v_pk_fma_f32 v[172:173], v[140:141], v[96:97], v[172:173] op_sel:[0,1,0] op_sel_hi:[1,1,1]
v_pk_fma_f32 v[180:181], v[140:141], v[98:99], v[180:181] op_sel:[0,1,0] op_sel_hi:[1,1,1]
v_pk_fma_f32 v[158:159], v[142:143], v[92:93], v[158:159] op_sel:[0,1,0] op_sel_hi:[1,1,1]
v_cvt_pk_bf16_f32 v156, v156, v157
v_pk_fma_f32 v[166:167], v[142:143], v[94:95], v[166:167] op_sel:[0,1,0] op_sel_hi:[1,1,1]
v_cvt_pk_bf16_f32 v164, v164, v165
v_pk_fma_f32 v[174:175], v[142:143], v[96:97], v[174:175] op_sel:[0,1,0] op_sel_hi:[1,1,1]
v_cvt_pk_bf16_f32 v172, v172, v173
v_pk_fma_f32 v[182:183], v[142:143], v[98:99], v[182:183] op_sel:[0,1,0] op_sel_hi:[1,1,1]
v_cvt_pk_bf16_f32 v180, v180, v181
v_pk_fma_f32 v[160:161], v[144:145], v[92:93], v[160:161] op_sel:[0,1,0] op_sel_hi:[1,1,1]
v_pk_fma_f32 v[162:163], v[146:147], v[92:93], v[162:163] op_sel:[0,1,0] op_sel_hi:[1,1,1]
v_cvt_pk_bf16_f32 v157, v158, v159
v_pk_fma_f32 v[168:169], v[144:145], v[94:95], v[168:169] op_sel:[0,1,0] op_sel_hi:[1,1,1]
v_pk_fma_f32 v[170:171], v[146:147], v[94:95], v[170:171] op_sel:[0,1,0] op_sel_hi:[1,1,1]
v_cvt_pk_bf16_f32 v165, v166, v167
v_pk_fma_f32 v[176:177], v[144:145], v[96:97], v[176:177] op_sel:[0,1,0] op_sel_hi:[1,1,1]
v_pk_fma_f32 v[178:179], v[146:147], v[96:97], v[178:179] op_sel:[0,1,0] op_sel_hi:[1,1,1]
v_cvt_pk_bf16_f32 v173, v174, v175
v_pk_fma_f32 v[184:185], v[144:145], v[98:99], v[184:185] op_sel:[0,1,0] op_sel_hi:[1,1,1]
v_pk_fma_f32 v[186:187], v[146:147], v[98:99], v[186:187] op_sel:[0,1,0] op_sel_hi:[1,1,1]
v_cvt_pk_bf16_f32 v181, v182, v183
v_cvt_pk_bf16_f32 v158, v160, v161
v_cvt_pk_bf16_f32 v159, v162, v163
v_cvt_pk_bf16_f32 v166, v168, v169
v_cvt_pk_bf16_f32 v167, v170, v171
v_mfma_f32_16x16x32_bf16 v[60:63], v[10:13], v[156:159], 0
v_cvt_pk_bf16_f32 v174, v176, v177
v_cvt_pk_bf16_f32 v175, v178, v179
v_mfma_f32_16x16x32_bf16 v[68:71], v[10:13], v[164:167], 0
v_cvt_pk_bf16_f32 v182, v184, v185
v_cvt_pk_bf16_f32 v183, v186, v187
v_mfma_f32_16x16x32_bf16 v[76:79], v[10:13], v[172:175], 0
s_nop 0
v_mfma_f32_16x16x32_bf16 v[84:87], v[10:13], v[180:183], 0
v_min3_f32 v104, v60, v61, v62
v_max3_f32 v100, v60, v61, v62
v_mfma_f32_16x16x32_bf16 v[64:67], v[14:17], v[156:159], 0
v_min3_f32 v105, v68, v69, v70
v_max3_f32 v101, v68, v69, v70
v_mfma_f32_16x16x32_bf16 v[72:75], v[14:17], v[164:167], 0
v_min3_f32 v106, v76, v77, v78
v_max3_f32 v102, v76, v77, v78
v_mfma_f32_16x16x32_bf16 v[80:83], v[14:17], v[172:175], 0
v_min3_f32 v107, v84, v85, v86
v_max3_f32 v103, v84, v85, v86
v_mfma_f32_16x16x32_bf16 v[88:91], v[14:17], v[180:183], 0
v_min3_f32 v104, v104, v63, v64
v_max3_f32 v100, v100, v63, v64
v_min3_f32 v105, v105, v71, v72
v_min3_f32 v104, v104, v65, v66
v_max3_f32 v101, v101, v71, v72
v_min3_f32 v106, v106, v79, v80
v_min3_f32 v105, v105, v73, v74
v_max3_f32 v102, v102, v79, v80
v_min3_f32 v107, v107, v87, v88
v_min3_f32 v106, v106, v81, v82
v_max3_f32 v103, v103, v87, v88
v_min3_f32 v107, v107, v89, v90
v_max3_f32 v100, v100, v65, v66
v_min_f32 v104, v104, v67
v_max3_f32 v101, v101, v73, v74
v_min_f32 v105, v105, v75
v_max3_f32 v102, v102, v81, v82
v_min_f32 v106, v106, v83
v_max3_f32 v103, v103, v89, v90
v_min_f32 v107, v107, v91
v_max_f32 v100, v100, v67
v_max_f32 v101, v101, v75
v_max_f32 v102, v102, v83
v_max_f32 v103, v103, v91
v_permlane32_swap_b32 v104, v105
v_permlane32_swap_b32 v106, v107
v_permlane32_swap_b32 v100, v101
v_permlane32_swap_b32 v102, v103
v_min_f32 v104, v104, v105
v_min_f32 v106, v106, v107
v_max_f32 v100, v100, v101
v_max_f32 v102, v102, v103
v_permlane16_swap_b32 v104, v106
s_nop 0
v_permlane16_swap_b32 v100, v102
v_min_f32 v104, v104, v106
v_max_f32 v100, v100, v102
v_mov_b32 v106, v104
v_mov_b32 v102, v100
s_nop 0
v_permlane16_swap_b32 v104, v106
v_permlane16_swap_b32 v100, v102
v_mov_b32 v105, v104
v_mov_b32 v101, v100
v_mov_b32 v103, v102
v_permlane32_swap_b32 v104, v105
v_mov_b32 v107, v106
v_permlane32_swap_b32_e64 v100, v101
v_pk_mul_f32 v[104:105], v[104:105], v[128:129]
v_pk_mul_f32 v[100:101], v[100:101], v[128:129]
v_pk_fma_f32 v[220:221], v[60:61], v[128:129], v[104:105] op_sel:[0,0,0] op_sel_hi:[1,0,0] neg_lo:[1,0,0] neg_hi:[1,0,0]
v_pk_fma_f32 v[222:223], v[62:63], v[128:129], v[104:105] op_sel:[0,0,0] op_sel_hi:[1,0,0] neg_lo:[1,0,0] neg_hi:[1,0,0]
v_pk_fma_f32 v[224:225], v[64:65], v[128:129], v[104:105] op_sel:[0,0,0] op_sel_hi:[1,0,0] neg_lo:[1,0,0] neg_hi:[1,0,0]
v_pk_fma_f32 v[226:227], v[66:67], v[128:129], v[104:105] op_sel:[0,0,0] op_sel_hi:[1,0,0] neg_lo:[1,0,0] neg_hi:[1,0,0]
v_pk_fma_f32 v[228:229], v[68:69], v[128:129], v[104:105] op_sel:[0,1,1] op_sel_hi:[1,1,1] neg_lo:[1,0,0] neg_hi:[1,0,0]
v_pk_fma_f32 v[230:231], v[70:71], v[128:129], v[104:105] op_sel:[0,1,1] op_sel_hi:[1,1,1] neg_lo:[1,0,0] neg_hi:[1,0,0]
v_pk_fma_f32 v[232:233], v[72:73], v[128:129], v[104:105] op_sel:[0,1,1] op_sel_hi:[1,1,1] neg_lo:[1,0,0] neg_hi:[1,0,0]
v_pk_fma_f32 v[234:235], v[74:75], v[128:129], v[104:105] op_sel:[0,1,1] op_sel_hi:[1,1,1] neg_lo:[1,0,0] neg_hi:[1,0,0]
v_permlane32_swap_b32 v102, v103
v_permlane32_swap_b32 v106, v107
v_pk_fma_f32 v[60:61], v[60:61], v[128:129], v[100:101] op_sel:[0,0,0] op_sel_hi:[1,0,0] neg_lo:[0,0,1] neg_hi:[0,0,1]
v_pk_fma_f32 v[62:63], v[62:63], v[128:129], v[100:101] op_sel:[0,0,0] op_sel_hi:[1,0,0] neg_lo:[0,0,1] neg_hi:[0,0,1]
v_pk_fma_f32 v[64:65], v[64:65], v[128:129], v[100:101] op_sel:[0,0,0] op_sel_hi:[1,0,0] neg_lo:[0,0,1] neg_hi:[0,0,1]
v_pk_fma_f32 v[66:67], v[66:67], v[128:129], v[100:101] op_sel:[0,0,0] op_sel_hi:[1,0,0] neg_lo:[0,0,1] neg_hi:[0,0,1]
v_pk_fma_f32 v[68:69], v[68:69], v[128:129], v[100:101] op_sel:[0,1,1] op_sel_hi:[1,1,1] neg_lo:[0,0,1] neg_hi:[0,0,1]
v_pk_fma_f32 v[70:71], v[70:71], v[128:129], v[100:101] op_sel:[0,1,1] op_sel_hi:[1,1,1] neg_lo:[0,0,1] neg_hi:[0,0,1]
v_pk_fma_f32 v[72:73], v[72:73], v[128:129], v[100:101] op_sel:[0,1,1] op_sel_hi:[1,1,1] neg_lo:[0,0,1] neg_hi:[0,0,1]
v_pk_fma_f32 v[74:75], v[74:75], v[128:129], v[100:101] op_sel:[0,1,1] op_sel_hi:[1,1,1] neg_lo:[0,0,1] neg_hi:[0,0,1]
v_exp_f32 v220, v220
v_exp_f32 v60, v60
v_exp_f32 v221, v221
v_exp_f32 v61, v61
v_exp_f32 v222, v222
v_exp_f32 v62, v62
v_exp_f32 v223, v223
v_exp_f32 v63, v63
v_exp_f32 v224, v224
v_exp_f32 v64, v64
v_exp_f32 v225, v225
v_exp_f32 v65, v65
v_exp_f32 v226, v226
v_exp_f32 v66, v66
v_exp_f32 v227, v227
v_exp_f32 v67, v67
v_exp_f32 v228, v228
v_exp_f32 v68, v68
v_exp_f32 v229, v229
v_exp_f32 v69, v69
v_exp_f32 v230, v230
v_exp_f32 v70, v70
v_exp_f32 v231, v231
v_exp_f32 v71, v71
v_exp_f32 v232, v232
v_exp_f32 v72, v72
v_exp_f32 v233, v233
v_exp_f32 v73, v73
v_exp_f32 v234, v234
v_exp_f32 v74, v74
v_exp_f32 v235, v235
v_exp_f32 v75, v75
v_pk_mul_f32 v[102:103], v[102:103], v[130:131]
v_pk_mul_f32 v[106:107], v[106:107], v[130:131]
buffer_load_dwordx4 v[212:215], v18, s[32:35], s55 offen offset:0 sc1
buffer_load_dwordx4 v[216:219], v18, s[32:35], s55 offen offset:1024 sc1
.p2align 3
v_pk_add_f32 v[108:109], v[60:61], v[62:63]
v_pk_add_f32 v[110:111], v[220:221], v[222:223]
v_pk_add_f32 v[108:109], v[108:109], v[64:65]
v_pk_add_f32 v[110:111], v[110:111], v[224:225]
v_pk_add_f32 v[108:109], v[108:109], v[66:67]
v_pk_add_f32 v[110:111], v[110:111], v[226:227]
v_add_f32 v100, v108, v109
v_add_f32 v104, v110, v111
v_pk_fma_f32 v[236:237], v[76:77], v[130:131], v[106:107] op_sel:[0,0,0] op_sel_hi:[1,0,0] neg_lo:[1,0,0] neg_hi:[1,0,0]
v_pk_fma_f32 v[238:239], v[78:79], v[130:131], v[106:107] op_sel:[0,0,0] op_sel_hi:[1,0,0] neg_lo:[1,0,0] neg_hi:[1,0,0]
v_pk_add_f32 v[108:109], v[68:69], v[70:71]
v_pk_add_f32 v[110:111], v[228:229], v[230:231]
v_pk_fma_f32 v[76:77], v[76:77], v[130:131], v[102:103] op_sel:[0,0,0] op_sel_hi:[1,0,0] neg_lo:[0,0,1] neg_hi:[0,0,1]
v_pk_fma_f32 v[78:79], v[78:79], v[130:131], v[102:103] op_sel:[0,0,0] op_sel_hi:[1,0,0] neg_lo:[0,0,1] neg_hi:[0,0,1]
v_pk_fma_f32 v[240:241], v[80:81], v[130:131], v[106:107] op_sel:[0,0,0] op_sel_hi:[1,0,0] neg_lo:[1,0,0] neg_hi:[1,0,0]
v_pk_add_f32 v[108:109], v[108:109], v[72:73]
v_pk_add_f32 v[110:111], v[110:111], v[232:233]
v_exp_f32 v236, v236
v_exp_f32 v76, v76
v_exp_f32 v237, v237
v_exp_f32 v77, v77
v_exp_f32 v238, v238
v_exp_f32 v78, v78
v_exp_f32 v239, v239
v_exp_f32 v79, v79
v_pk_fma_f32 v[80:81], v[80:81], v[130:131], v[102:103] op_sel:[0,0,0] op_sel_hi:[1,0,0] neg_lo:[0,0,1] neg_hi:[0,0,1]
v_pk_fma_f32 v[242:243], v[82:83], v[130:131], v[106:107] op_sel:[0,0,0] op_sel_hi:[1,0,0] neg_lo:[1,0,0] neg_hi:[1,0,0]
v_pk_add_f32 v[108:109], v[108:109], v[74:75]
v_pk_add_f32 v[110:111], v[110:111], v[234:235]
v_exp_f32 v240, v240
v_exp_f32 v80, v80
v_exp_f32 v241, v241
v_exp_f32 v81, v81
v_pk_fma_f32 v[82:83], v[82:83], v[130:131], v[102:103] op_sel:[0,0,0] op_sel_hi:[1,0,0] neg_lo:[0,0,1] neg_hi:[0,0,1]
v_add_f32 v101, v108, v109
v_add_f32 v105, v110, v111
v_exp_f32 v242, v242
v_exp_f32 v82, v82
v_exp_f32 v243, v243
v_exp_f32 v83, v83
v_pk_fma_f32 v[244:245], v[84:85], v[130:131], v[106:107] op_sel:[0,1,1] op_sel_hi:[1,1,1] neg_lo:[1,0,0] neg_hi:[1,0,0]
v_pk_fma_f32 v[246:247], v[86:87], v[130:131], v[106:107] op_sel:[0,1,1] op_sel_hi:[1,1,1] neg_lo:[1,0,0] neg_hi:[1,0,0]
v_pk_add_f32 v[108:109], v[76:77], v[78:79]
v_pk_add_f32 v[110:111], v[236:237], v[238:239]
v_pk_fma_f32 v[84:85], v[84:85], v[130:131], v[102:103] op_sel:[0,1,1] op_sel_hi:[1,1,1] neg_lo:[0,0,1] neg_hi:[0,0,1]
v_pk_fma_f32 v[86:87], v[86:87], v[130:131], v[102:103] op_sel:[0,1,1] op_sel_hi:[1,1,1] neg_lo:[0,0,1] neg_hi:[0,0,1]
v_pk_fma_f32 v[248:249], v[88:89], v[130:131], v[106:107] op_sel:[0,1,1] op_sel_hi:[1,1,1] neg_lo:[1,0,0] neg_hi:[1,0,0]
v_pk_fma_f32 v[250:251], v[90:91], v[130:131], v[106:107] op_sel:[0,1,1] op_sel_hi:[1,1,1] neg_lo:[1,0,0] neg_hi:[1,0,0]
v_pk_add_f32 v[108:109], v[108:109], v[80:81]
v_pk_add_f32 v[110:111], v[110:111], v[240:241]
v_exp_f32 v244, v244
v_exp_f32 v84, v84
v_exp_f32 v245, v245
v_exp_f32 v85, v85
v_exp_f32 v246, v246
v_exp_f32 v86, v86
v_exp_f32 v247, v247
v_exp_f32 v87, v87
v_pk_fma_f32 v[88:89], v[88:89], v[130:131], v[102:103] op_sel:[0,1,1] op_sel_hi:[1,1,1] neg_lo:[0,0,1] neg_hi:[0,0,1]
v_pk_fma_f32 v[90:91], v[90:91], v[130:131], v[102:103] op_sel:[0,1,1] op_sel_hi:[1,1,1] neg_lo:[0,0,1] neg_hi:[0,0,1]
v_pk_add_f32 v[108:109], v[108:109], v[82:83]
v_pk_add_f32 v[110:111], v[110:111], v[242:243]
v_exp_f32 v248, v248
v_exp_f32 v88, v88
v_exp_f32 v249, v249
v_exp_f32 v89, v89
v_add_f32 v102, v108, v109
v_add_f32 v106, v110, v111
v_exp_f32 v250, v250
v_exp_f32 v90, v90
v_exp_f32 v251, v251
v_exp_f32 v91, v91
v_pk_add_f32 v[108:109], v[84:85], v[86:87]
v_pk_add_f32 v[110:111], v[244:245], v[246:247]
v_pk_add_f32 v[108:109], v[108:109], v[88:89]
v_pk_add_f32 v[110:111], v[110:111], v[248:249]
v_pk_add_f32 v[108:109], v[108:109], v[90:91]
v_pk_add_f32 v[110:111], v[110:111], v[250:251]
v_add_f32 v103, v108, v109
v_add_f32 v107, v110, v111
s_cmp_eq_u32 s51, 1
s_cbranch_scc1 chk_84
s_waitcnt vmcnt(0)
v_max_u32 v4, v212, v213
v_max3_u32 v4, v4, v214, v215
v_max3_u32 v4, v4, v216, v217
v_max3_u32 v4, v4, v218, v219
v_cmp_eq_u32 vcc, -1, v4
s_cbranch_vccz red_85
buffer_load_dwordx4 v[212:215], v18, s[32:35], s55 offen offset:0 sc1
buffer_load_dwordx4 v[216:219], v18, s[32:35], s55 offen offset:1024 sc1
s_branch chk_84
red_85:
v_mfma_f32_16x16x32_bf16 v[132:135], v[44:47], v[212:215], 0
v_mfma_f32_16x16x32_bf16 v[132:135], v[44:47], v[216:219], v[132:135]
s_mov_b32 s51, 1
s_nop 6
v_add_f32_dpp v132, v132, v132 row_ror:8 row_mask:0xf bank_mask:0xf
v_add_f32_dpp v133, v133, v133 row_ror:8 row_mask:0xf bank_mask:0xf
v_add_f32_dpp v134, v134, v134 row_ror:8 row_mask:0xf bank_mask:0xf
v_add_f32_dpp v135, v135, v135 row_ror:8 row_mask:0xf bank_mask:0xf
v_cvt_pk_bf16_f32 v132, v132, v133
v_cvt_pk_bf16_f32 v133, v134, v135
s_mov_b64 exec, 0x00ff00ff
buffer_store_dwordx2 v[132:133], v59, s[32:35], s79 offen sc1
s_mov_b64 exec, -1
buffer_load_dwordx4 v[204:207], v58, s[32:35], s56 offen sc1
buffer_load_dwordx4 v[208:211], v58, s[32:35], s57 offen sc1
chk_84:
.p2align 3
v_permlane32_swap_b32 v100, v101
v_permlane32_swap_b32 v102, v103
v_permlane32_swap_b32 v104, v105
v_permlane32_swap_b32 v106, v107
v_add_f32 v100, v100, v101
v_add_f32 v102, v102, v103
v_add_f32 v104, v104, v105
v_add_f32 v106, v106, v107
v_permlane16_swap_b32 v100, v102
s_nop 0
v_permlane16_swap_b32 v104, v106
v_add_f32 v100, v100, v102
v_add_f32 v104, v104, v106
v_rcp_f32 v100, v100
v_rcp_f32 v104, v104
v_mov_b32 v102, v100
v_mov_b32 v106, v104
s_nop 0
v_permlane16_swap_b32 v100, v102
v_permlane16_swap_b32 v104, v106
v_mov_b32 v101, v100
v_mov_b32 v103, v102
v_mov_b32 v105, v104
v_mov_b32 v107, v106
v_permlane32_swap_b32 v100, v101
v_permlane32_swap_b32 v102, v103
v_permlane32_swap_b32 v104, v105
v_permlane32_swap_b32 v106, v107
v_pk_mul_f32 v[60:61], v[60:61], v[100:101] op_sel:[0,0] op_sel_hi:[1,0]
v_pk_mul_f32 v[220:221], v[220:221], v[104:105] op_sel:[0,0] op_sel_hi:[1,0]
v_pk_mul_f32 v[68:69], v[68:69], v[100:101] op_sel:[0,1] op_sel_hi:[1,1]
v_pk_mul_f32 v[228:229], v[228:229], v[104:105] op_sel:[0,1] op_sel_hi:[1,1]
v_pk_mul_f32 v[76:77], v[76:77], v[102:103] op_sel:[0,0] op_sel_hi:[1,0]
v_pk_mul_f32 v[236:237], v[236:237], v[106:107] op_sel:[0,0] op_sel_hi:[1,0]
v_pk_mul_f32 v[84:85], v[84:85], v[102:103] op_sel:[0,1] op_sel_hi:[1,1]
v_pk_mul_f32 v[244:245], v[244:245], v[106:107] op_sel:[0,1] op_sel_hi:[1,1]
v_pk_mul_f32 v[62:63], v[62:63], v[100:101] op_sel:[0,0] op_sel_hi:[1,0]
v_pk_mul_f32 v[222:223], v[222:223], v[104:105] op_sel:[0,0] op_sel_hi:[1,0]
v_cvt_pk_bf16_f32 v60, v60, v61
v_cvt_pk_bf16_f32 v220, v220, v221
v_pk_mul_f32 v[70:71], v[70:71], v[100:101] op_sel:[0,1] op_sel_hi:[1,1]
v_pk_mul_f32 v[230:231], v[230:231], v[104:105] op_sel:[0,1] op_sel_hi:[1,1]
v_cvt_pk_bf16_f32 v68, v68, v69
v_cvt_pk_bf16_f32 v228, v228, v229
v_pk_mul_f32 v[78:79], v[78:79], v[102:103] op_sel:[0,0] op_sel_hi:[1,0]
v_pk_mul_f32 v[238:239], v[238:239], v[106:107] op_sel:[0,0] op_sel_hi:[1,0]
v_cvt_pk_bf16_f32 v76, v76, v77
v_cvt_pk_bf16_f32 v236, v236, v237
v_pk_mul_f32 v[86:87], v[86:87], v[102:103] op_sel:[0,1] op_sel_hi:[1,1]
v_pk_mul_f32 v[246:247], v[246:247], v[106:107] op_sel:[0,1] op_sel_hi:[1,1]
v_cvt_pk_bf16_f32 v84, v84, v85
v_cvt_pk_bf16_f32 v244, v244, v245
v_pk_mul_f32 v[64:65], v[64:65], v[100:101] op_sel:[0,0] op_sel_hi:[1,0]
v_pk_mul_f32 v[66:67], v[66:67], v[100:101] op_sel:[0,0] op_sel_hi:[1,0]
v_pk_mul_f32 v[224:225], v[224:225], v[104:105] op_sel:[0,0] op_sel_hi:[1,0]
v_pk_mul_f32 v[226:227], v[226:227], v[104:105] op_sel:[0,0] op_sel_hi:[1,0]
v_cvt_pk_bf16_f32 v61, v62, v63
v_cvt_pk_bf16_f32 v221, v222, v223
v_pk_mul_f32 v[72:73], v[72:73], v[100:101] op_sel:[0,1] op_sel_hi:[1,1]
v_pk_mul_f32 v[74:75], v[74:75], v[100:101] op_sel:[0,1] op_sel_hi:[1,1]
v_pk_mul_f32 v[232:233], v[232:233], v[104:105] op_sel:[0,1] op_sel_hi:[1,1]
v_pk_mul_f32 v[234:235], v[234:235], v[104:105] op_sel:[0,1] op_sel_hi:[1,1]
v_cvt_pk_bf16_f32 v69, v70, v71
v_cvt_pk_bf16_f32 v229, v230, v231
v_pk_mul_f32 v[80:81], v[80:81], v[102:103] op_sel:[0,0] op_sel_hi:[1,0]
v_pk_mul_f32 v[82:83], v[82:83], v[102:103] op_sel:[0,0] op_sel_hi:[1,0]
v_pk_mul_f32 v[240:241], v[240:241], v[106:107] op_sel:[0,0] op_sel_hi:[1,0]
v_pk_mul_f32 v[242:243], v[242:243], v[106:107] op_sel:[0,0] op_sel_hi:[1,0]
v_cvt_pk_bf16_f32 v77, v78, v79
v_cvt_pk_bf16_f32 v237, v238, v239
v_pk_mul_f32 v[88:89], v[88:89], v[102:103] op_sel:[0,1] op_sel_hi:[1,1]
v_pk_mul_f32 v[90:91], v[90:91], v[102:103] op_sel:[0,1] op_sel_hi:[1,1]
v_pk_mul_f32 v[248:249], v[248:249], v[106:107] op_sel:[0,1] op_sel_hi:[1,1]
v_pk_mul_f32 v[250:251], v[250:251], v[106:107] op_sel:[0,1] op_sel_hi:[1,1]
v_cvt_pk_bf16_f32 v85, v86, v87
v_cvt_pk_bf16_f32 v245, v246, v247
v_cvt_pk_bf16_f32 v62, v64, v65
v_cvt_pk_bf16_f32 v63, v66, v67
v_cvt_pk_bf16_f32 v222, v224, v225
v_cvt_pk_bf16_f32 v223, v226, v227
v_cvt_pk_bf16_f32 v70, v72, v73
v_cvt_pk_bf16_f32 v71, v74, v75
v_cvt_pk_bf16_f32 v230, v232, v233
v_cvt_pk_bf16_f32 v231, v234, v235
v_cvt_pk_bf16_f32 v78, v80, v81
v_cvt_pk_bf16_f32 v79, v82, v83
v_cvt_pk_bf16_f32 v238, v240, v241
v_cvt_pk_bf16_f32 v239, v242, v243
v_cvt_pk_bf16_f32 v86, v88, v89
v_cvt_pk_bf16_f32 v87, v90, v91
v_cvt_pk_bf16_f32 v246, v248, v249
v_cvt_pk_bf16_f32 v247, v250, v251
s_cmp_lg_u32 s51, 0
s_cbranch_scc1 else_86
s_mov_b32 s63, 0
sent_88:
s_waitcnt vmcnt(0)
v_max_u32 v4, v212, v213
v_max3_u32 v4, v4, v214, v215
v_max3_u32 v4, v4, v216, v217
v_max3_u32 v4, v4, v218, v219
v_cmp_eq_u32 vcc, -1, v4
s_cbranch_vccz sentd_89
buffer_load_dwordx4 v[212:215], v18, s[32:35], s55 offen offset:0 sc1
buffer_load_dwordx4 v[216:219], v18, s[32:35], s55 offen offset:1024 sc1
s_add_u32 s63, s63, 1
s_cmp_lt_u32 s63, 0x80000
s_cbranch_scc1 sent_88
s_waitcnt vmcnt(0)
sentd_89:
v_mfma_f32_16x16x32_bf16 v[132:135], v[44:47], v[212:215], 0
v_mfma_f32_16x16x32_bf16 v[132:135], v[44:47], v[216:219], v[132:135]
s_mov_b32 s51, 1
s_nop 6
v_add_f32_dpp v132, v132, v132 row_ror:8 row_mask:0xf bank_mask:0xf
v_add_f32_dpp v133, v133, v133 row_ror:8 row_mask:0xf bank_mask:0xf
v_add_f32_dpp v134, v134, v134 row_ror:8 row_mask:0xf bank_mask:0xf
v_add_f32_dpp v135, v135, v135 row_ror:8 row_mask:0xf bank_mask:0xf
v_cvt_pk_bf16_f32 v132, v132, v133
v_cvt_pk_bf16_f32 v133, v134, v135
s_mov_b64 exec, 0x00ff00ff
buffer_store_dwordx2 v[132:133], v59, s[32:35], s79 offen sc1
s_mov_b64 exec, -1
buffer_load_dwordx4 v[204:207], v58, s[32:35], s56 offen sc1
buffer_load_dwordx4 v[208:211], v58, s[32:35], s57 offen sc1
else_86:
s_mov_b32 s63, 0
sent_90:
s_waitcnt vmcnt(0)
v_max_u32 v4, v204, v205
v_max3_u32 v4, v4, v206, v207
v_max3_u32 v4, v4, v208, v209
v_max3_u32 v4, v4, v210, v211
v_cmp_eq_u32 vcc, -1, v4
s_cbranch_vccz sentd_91
buffer_load_dwordx4 v[204:207], v58, s[32:35], s56 offen sc1
buffer_load_dwordx4 v[208:211], v58, s[32:35], s57 offen sc1
s_add_u32 s63, s63, 1
s_cmp_lt_u32 s63, 0x80000
s_cbranch_scc1 sent_90
s_waitcnt vmcnt(0)
sentd_91:
v_mfma_f32_16x16x32_bf16 v[112:115], v[204:207], v[60:63], 0
v_mfma_f32_16x16x32_bf16 v[116:119], v[204:207], v[68:71], 0
v_mfma_f32_16x16x32_bf16 v[120:123], v[204:207], v[76:79], 0
v_mfma_f32_16x16x32_bf16 v[124:127], v[204:207], v[84:87], 0
v_mfma_f32_16x16x32_bf16 v[112:115], v[208:211], v[220:223], v[112:115]
v_mfma_f32_16x16x32_bf16 v[116:119], v[208:211], v[228:231], v[116:119]
v_mfma_f32_16x16x32_bf16 v[120:123], v[208:211], v[236:239], v[120:123]
v_mfma_f32_16x16x32_bf16 v[124:127], v[208:211], v[244:247], v[124:127]
s_nop 4
v_add_f32 v100, v112, v113
v_add_f32 v114, v114, v115
v_add_f32 v100, v100, v114
v_add_f32 v101, v116, v117
v_add_f32 v118, v118, v119
v_add_f32 v101, v101, v118
v_add_f32 v102, v120, v121
v_add_f32 v122, v122, v123
v_add_f32 v102, v102, v122
v_add_f32 v103, v124, v125
v_add_f32 v126, v126, v127
v_add_f32 v103, v103, v126
s_nop 1
v_permlane32_swap_b32 v100, v101
v_permlane32_swap_b32 v102, v103
v_add_f32 v100, v100, v101
v_add_f32 v102, v102, v103
s_nop 1
v_permlane16_swap_b32 v100, v102
s_nop 0
v_add_f32 v100, v100, v102
v_add_f32 v100, 0x358637bd, v100
v_rcp_f32 v100, v100
s_nop 0
v_mov_b32 v102, v100
s_nop 1
v_permlane16_swap_b32 v100, v102
s_nop 0
v_mov_b32 v101, v100
v_mov_b32 v103, v102
s_nop 0
v_permlane32_swap_b32 v100, v101
v_permlane32_swap_b32 v102, v103
buffer_load_dwordx4 v[188:191], v18, s[32:35], s58 offen offset:0 sc1
buffer_load_dwordx4 v[192:195], v18, s[32:35], s58 offen offset:1024 sc1
buffer_load_dwordx4 v[196:199], v18, s[32:35], s59 offen offset:0 sc1
buffer_load_dwordx4 v[200:203], v18, s[32:35], s59 offen offset:1024 sc1
s_mov_b32 s63, 0
sent_92:
s_waitcnt vmcnt(0)
v_max_u32 v4, v188, v189
v_max3_u32 v4, v4, v190, v191
v_max3_u32 v4, v4, v192, v193
v_max3_u32 v4, v4, v194, v195
v_max3_u32 v4, v4, v196, v197
v_max3_u32 v4, v4, v198, v199
v_max3_u32 v4, v4, v200, v201
v_max3_u32 v4, v4, v202, v203
v_cmp_eq_u32 vcc, -1, v4
s_cbranch_vccz sentd_93
buffer_load_dwordx4 v[188:191], v18, s[32:35], s58 offen offset:0 sc1
buffer_load_dwordx4 v[192:195], v18, s[32:35], s58 offen offset:1024 sc1
buffer_load_dwordx4 v[196:199], v18, s[32:35], s59 offen offset:0 sc1
buffer_load_dwordx4 v[200:203], v18, s[32:35], s59 offen offset:1024 sc1
s_add_u32 s63, s63, 1
s_cmp_lt_u32 s63, 0x80000
s_cbranch_scc1 sent_92
s_waitcnt vmcnt(0)
sentd_93:
s_cmp_eq_u32 s46, 0
s_cbranch_scc1 slow_94
.p2align 3
v_mfma_f32_16x16x32_bf16 v[156:159], v[188:191], v[60:63], 0
v_mfma_f32_16x16x32_bf16 v[164:167], v[188:191], v[68:71], 0
v_mfma_f32_16x16x32_bf16 v[160:163], v[192:195], v[60:63], 0
v_mfma_f32_16x16x32_bf16 v[172:175], v[188:191], v[76:79], 0
v_mfma_f32_16x16x32_bf16 v[168:171], v[192:195], v[68:71], 0
v_mfma_f32_16x16x32_bf16 v[180:183], v[188:191], v[84:87], 0
v_mfma_f32_16x16x32_bf16 v[156:159], v[196:199], v[220:223], v[156:159]
v_mfma_f32_16x16x32_bf16 v[176:179], v[192:195], v[76:79], 0
v_mfma_f32_16x16x32_bf16 v[164:167], v[196:199], v[228:231], v[164:167]
v_mfma_f32_16x16x32_bf16 v[184:187], v[192:195], v[84:87], 0
v_mfma_f32_16x16x32_bf16 v[160:163], v[200:203], v[220:223], v[160:163]
v_mfma_f32_16x16x32_bf16 v[172:175], v[196:199], v[236:239], v[172:175]
v_mfma_f32_16x16x32_bf16 v[168:171], v[200:203], v[228:231], v[168:171]
v_mfma_f32_16x16x32_bf16 v[180:183], v[196:199], v[244:247], v[180:183]
v_mfma_f32_16x16x32_bf16 v[176:179], v[200:203], v[236:239], v[176:179]
v_mfma_f32_16x16x32_bf16 v[184:187], v[200:203], v[244:247], v[184:187]
v_pk_mul_f32 v[156:157], v[156:157], v[100:101] op_sel:[0,0] op_sel_hi:[1,0]
v_pk_mul_f32 v[158:159], v[158:159], v[100:101] op_sel:[0,0] op_sel_hi:[1,0]
v_cvt_pk_bf16_f32 v156, v156, v157
v_pk_mul_f32 v[164:165], v[164:165], v[100:101] op_sel:[0,1] op_sel_hi:[1,1]
v_pk_mul_f32 v[160:161], v[160:161], v[100:101] op_sel:[0,0] op_sel_hi:[1,0]
v_pk_mul_f32 v[162:163], v[162:163], v[100:101] op_sel:[0,0] op_sel_hi:[1,0]
v_cvt_pk_bf16_f32 v157, v158, v159
v_pk_mul_f32 v[166:167], v[166:167], v[100:101] op_sel:[0,1] op_sel_hi:[1,1]
v_cvt_pk_bf16_f32 v164, v164, v165
v_pk_mul_f32 v[172:173], v[172:173], v[102:103] op_sel:[0,0] op_sel_hi:[1,0]
v_cvt_pk_bf16_f32 v158, v160, v161
v_cvt_pk_bf16_f32 v159, v162, v163
v_pk_mul_f32 v[168:169], v[168:169], v[100:101] op_sel:[0,1] op_sel_hi:[1,1]
v_pk_mul_f32 v[170:171], v[170:171], v[100:101] op_sel:[0,1] op_sel_hi:[1,1]
v_cvt_pk_bf16_f32 v165, v166, v167
v_pk_mul_f32 v[174:175], v[174:175], v[102:103] op_sel:[0,0] op_sel_hi:[1,0]
v_cvt_pk_bf16_f32 v172, v172, v173
v_pk_mul_f32 v[180:181], v[180:181], v[102:103] op_sel:[0,1] op_sel_hi:[1,1]
buffer_store_dwordx4 v[156:159], v18, s[32:35], s80 offen
v_cvt_pk_bf16_f32 v166, v168, v169
v_cvt_pk_bf16_f32 v167, v170, v171
v_pk_mul_f32 v[176:177], v[176:177], v[102:103] op_sel:[0,0] op_sel_hi:[1,0]
v_pk_mul_f32 v[178:179], v[178:179], v[102:103] op_sel:[0,0] op_sel_hi:[1,0]
v_cvt_pk_bf16_f32 v173, v174, v175
v_pk_mul_f32 v[182:183], v[182:183], v[102:103] op_sel:[0,1] op_sel_hi:[1,1]
v_cvt_pk_bf16_f32 v180, v180, v181
buffer_store_dwordx4 v[164:167], v18, s[32:35], s81 offen
v_cvt_pk_bf16_f32 v174, v176, v177
v_cvt_pk_bf16_f32 v175, v178, v179
v_pk_mul_f32 v[184:185], v[184:185], v[102:103] op_sel:[0,1] op_sel_hi:[1,1]
v_pk_mul_f32 v[186:187], v[186:187], v[102:103] op_sel:[0,1] op_sel_hi:[1,1]
v_cvt_pk_bf16_f32 v181, v182, v183
buffer_store_dwordx4 v[172:175], v18, s[32:35], s82 offen
v_cvt_pk_bf16_f32 v182, v184, v185
v_cvt_pk_bf16_f32 v183, v186, v187
buffer_store_dwordx4 v[180:183], v18, s[32:35], s83 offen
back_95:
s_barrier
v_and_b32 v36, 31, v0
v_lshlrev_b32 v36, 2, v36
s_lshl_b32 s62, s45, 2
v_mov_b32 v4, s62
v_mov_b32 v5, 2
s_mov_b64 exec, 1
s_waitcnt vmcnt(0)
s_cmp_eq_u32 s46, 0
s_cbranch_scc1 slow_96
buffer_store_dword v5, v4, s[32:35], s84 offen
back_97:
s_mov_b64 exec, -1
v_lshrrev_b32 v4, 2, v2
v_and_b32 v5, 3, v0
v_lshl_add_u32 v6, v3, 3, v4
v_lshlrev_b32 v6, 7, v6
v_lshl_add_u32 v6, v5, 3, v6
v_lshrrev_b32 v7, 1, v4
v_and_b32 v8, 1, v3
v_lshl_add_u32 v7, v8, 1, v7
v_lshl_add_u32 v10, v7, 5, v6
v_xor_b32 v11, 32, v10
v_xor_b32 v12, 64, v10
v_xor_b32 v13, 96, v10
v_add_u32 v14, 0x10000, v10
v_add_u32 v15, 0x10000, v11
v_add_u32 v16, 0x10000, v12
v_add_u32 v17, 0x10000, v13
ds_read_b64_tr_b16 v[220:221], v10 offset:0
ds_read_b64_tr_b16 v[222:223], v10 offset:512
ds_read_b64_tr_b16 v[224:225], v11 offset:0
ds_read_b64_tr_b16 v[226:227], v11 offset:512
ds_read_b64_tr_b16 v[228:229], v12 offset:0
ds_read_b64_tr_b16 v[230:231], v12 offset:512
ds_read_b64_tr_b16 v[232:233], v13 offset:0
ds_read_b64_tr_b16 v[234:235], v13 offset:512
ds_read_b64_tr_b16 v[236:237], v10 offset:4096
ds_read_b64_tr_b16 v[238:239], v10 offset:4608
ds_read_b64_tr_b16 v[240:241], v11 offset:4096
ds_read_b64_tr_b16 v[242:243], v11 offset:4608
ds_read_b64_tr_b16 v[244:245], v12 offset:4096
ds_read_b64_tr_b16 v[246:247], v12 offset:4608
ds_read_b64_tr_b16 v[248:249], v13 offset:4096
ds_read_b64_tr_b16 v[250:251], v13 offset:4608
s_lshl_b32 s48, s41, 3
s_lshl_b32 s49, s40, 1
s_add_u32 s48, s48, s49
s_lshl_b32 s48, s48, 15
s_add_u32 s48, s48, 4194304
v_add_u32 v38, s48, v18
v_add_u32 v39, 32768, v38
s_lshl_b32 s57, s75, 11
s_add_u32 s87, s87, 262144
v_lshlrev_b32 v60, 16, v20
v_and_b32 v61, 0xffff0000, v20
v_lshlrev_b32 v62, 16, v21
v_and_b32 v63, 0xffff0000, v21
v_lshlrev_b32 v64, 16, v22
v_and_b32 v65, 0xffff0000, v22
v_lshlrev_b32 v66, 16, v23
v_and_b32 v67, 0xffff0000, v23
v_lshlrev_b32 v68, 16, v24
v_and_b32 v69, 0xffff0000, v24
v_lshlrev_b32 v70, 16, v25
v_and_b32 v71, 0xffff0000, v25
v_lshlrev_b32 v72, 16, v26
v_and_b32 v73, 0xffff0000, v26
v_lshlrev_b32 v74, 16, v27
v_and_b32 v75, 0xffff0000, v27
v_lshlrev_b32 v76, 16, v28
v_and_b32 v77, 0xffff0000, v28
v_lshlrev_b32 v78, 16, v29
v_and_b32 v79, 0xffff0000, v29
v_lshlrev_b32 v80, 16, v30
v_and_b32 v81, 0xffff0000, v30
v_lshlrev_b32 v82, 16, v31
v_and_b32 v83, 0xffff0000, v31
v_lshlrev_b32 v84, 16, v32
v_and_b32 v85, 0xffff0000, v32
v_lshlrev_b32 v86, 16, v33
v_and_b32 v87, 0xffff0000, v33
v_lshlrev_b32 v88, 16, v34
v_and_b32 v89, 0xffff0000, v34
v_lshlrev_b32 v90, 16, v35
v_and_b32 v91, 0xffff0000, v35
v_mov_b32 v6, 0
v_mov_b32 v7, 0
v_mov_b32 v8, 0
v_mov_b32 v9, 0
s_lshl_b32 s62, s42, 2
v_mov_b32 v4, s62
v_mov_b32 v5, 2
buffer_load_dword v37, v36, s[32:35], s84 offen sc1
s_mov_b32 s63, 0
s_waitcnt vmcnt(0)
poll_98:
v_cmp_gt_u32 vcc, 2, v37
s_cbranch_vccz polled_99
buffer_load_dword v37, v36, s[32:35], s84 offen sc1
s_add_u32 s63, s63, 1
s_cmp_lt_u32 s63, 0x80000
s_waitcnt vmcnt(0)
s_cbranch_scc1 poll_98
polled_99:
s_call_b64 s[94:95], R_oloop
s_cmp_eq_u32 s46, 0
s_cbranch_scc1 slow_100
s_nop 0
v_cvt_pk_bf16_f32 v20, v60, v61
v_cvt_pk_bf16_f32 v21, v62, v63
v_cvt_pk_bf16_f32 v22, v64, v65
v_cvt_pk_bf16_f32 v23, v66, v67
buffer_store_dwordx4 v[20:23], v18, s[32:35], s85 offen offset:0
v_cvt_pk_bf16_f32 v24, v68, v69
v_cvt_pk_bf16_f32 v25, v70, v71
v_cvt_pk_bf16_f32 v26, v72, v73
v_cvt_pk_bf16_f32 v27, v74, v75
buffer_store_dwordx4 v[24:27], v18, s[32:35], s85 offen offset:1024
v_cvt_pk_bf16_f32 v28, v76, v77
v_cvt_pk_bf16_f32 v29, v78, v79
v_cvt_pk_bf16_f32 v30, v80, v81
v_cvt_pk_bf16_f32 v31, v82, v83
buffer_store_dwordx4 v[28:31], v18, s[32:35], s86 offen offset:0
v_cvt_pk_bf16_f32 v32, v84, v85
v_cvt_pk_bf16_f32 v33, v86, v87
v_cvt_pk_bf16_f32 v34, v88, v89
v_cvt_pk_bf16_f32 v35, v90, v91
buffer_store_dwordx4 v[32:35], v18, s[32:35], s86 offen offset:1024
s_barrier
v_dot2c_f32_bf16 v6, v20, v48
v_dot2c_f32_bf16 v8, v20, v20
v_dot2c_f32_bf16 v7, v28, v48
v_dot2c_f32_bf16 v9, v28, v28
v_dot2c_f32_bf16 v6, v21, v48
v_dot2c_f32_bf16 v8, v21, v21
v_dot2c_f32_bf16 v7, v29, v48
v_dot2c_f32_bf16 v9, v29, v29
v_dot2c_f32_bf16 v6, v22, v48
v_dot2c_f32_bf16 v8, v22, v22
v_dot2c_f32_bf16 v7, v30, v48
v_dot2c_f32_bf16 v9, v30, v30
v_dot2c_f32_bf16 v6, v23, v48
v_dot2c_f32_bf16 v8, v23, v23
v_dot2c_f32_bf16 v7, v31, v48
v_dot2c_f32_bf16 v9, v31, v31
v_dot2c_f32_bf16 v6, v24, v48
v_dot2c_f32_bf16 v8, v24, v24
v_dot2c_f32_bf16 v7, v32, v48
v_dot2c_f32_bf16 v9, v32, v32
v_dot2c_f32_bf16 v6, v25, v48
v_dot2c_f32_bf16 v8, v25, v25
v_dot2c_f32_bf16 v7, v33, v48
v_dot2c_f32_bf16 v9, v33, v33
v_dot2c_f32_bf16 v6, v26, v48
v_dot2c_f32_bf16 v8, v26, v26
v_dot2c_f32_bf16 v7, v34, v48
v_dot2c_f32_bf16 v9, v34, v34
v_dot2c_f32_bf16 v6, v27, v48
v_dot2c_f32_bf16 v8, v27, v27
v_dot2c_f32_bf16 v7, v35, v48
v_dot2c_f32_bf16 v9, v35, v35
s_mov_b64 exec, 1
s_waitcnt vmcnt(0)
buffer_store_dword v5, v4, s[32:35], s88 offen
s_mov_b64 exec, -1
s_nop 1
v_permlane32_swap_b32 v6, v7
v_permlane32_swap_b32 v8, v9
v_add_f32 v6, v6, v7
v_add_f32 v8, v8, v9
s_nop 1
v_permlane16_swap_b32 v6, v8
s_nop 0
v_add_f32 v6, v6, v8
buffer_store_dword v6, v1, s[32:35], s87 offen
back_101:
s_lshl_b32 s49, s44, 13
v_add_u32 v10, s49, v18
v_add_u32 v11, 1024, v10
s_lshl_b32 s48, s43, 1
v_lshrrev_b32 v4, 2, v2
v_and_b32 v5, 3, v0
v_lshl_add_u32 v6, v3, 3, v4
v_lshlrev_b32 v6, 7, v6
v_lshl_add_u32 v6, v5, 3, v6
v_lshrrev_b32 v7, 1, v4
v_and_b32 v8, 1, v3
v_lshl_add_u32 v7, v8, 1, v7
v_xor_b32 v7, s48, v7
v_lshl_add_u32 v12, v7, 5, v6
v_add_u32 v12, 16384, v12
v_xor_b32 v13, 32, v12
v_mov_b32 v14, v10
v_mov_b32 v15, v11
v_add_u32 v16, 122880, v12
v_add_u32 v17, 122880, v13
v_mov_b32 v156, 0
v_mov_b32 v157, 0
v_mov_b32 v158, 0
v_mov_b32 v159, 0
v_mov_b32 v160, 0
v_mov_b32 v161, 0
v_mov_b32 v162, 0
v_mov_b32 v163, 0
v_mov_b32 v164, 0
v_mov_b32 v165, 0
v_mov_b32 v166, 0
v_mov_b32 v167, 0
v_mov_b32 v168, 0
v_mov_b32 v169, 0
v_mov_b32 v170, 0
v_mov_b32 v171, 0
v_mov_b32 v172, 0
v_mov_b32 v173, 0
v_mov_b32 v174, 0
v_mov_b32 v175, 0
v_mov_b32 v176, 0
v_mov_b32 v177, 0
v_mov_b32 v178, 0
v_mov_b32 v179, 0
v_mov_b32 v180, 0
v_mov_b32 v181, 0
v_mov_b32 v182, 0
v_mov_b32 v183, 0
v_mov_b32 v184, 0
v_mov_b32 v185, 0
v_mov_b32 v186, 0
v_mov_b32 v187, 0
v_mov_b32 v188, 0
v_mov_b32 v189, 0
v_mov_b32 v190, 0
v_mov_b32 v191, 0
v_mov_b32 v192, 0
v_mov_b32 v193, 0
v_mov_b32 v194, 0
v_mov_b32 v195, 0
v_mov_b32 v196, 0
v_mov_b32 v197, 0
v_mov_b32 v198, 0
v_mov_b32 v199, 0
v_mov_b32 v200, 0
v_mov_b32 v201, 0
v_mov_b32 v202, 0
v_mov_b32 v203, 0
v_mov_b32 v204, 0
v_mov_b32 v205, 0
v_mov_b32 v206, 0
v_mov_b32 v207, 0
v_mov_b32 v208, 0
v_mov_b32 v209, 0
v_mov_b32 v210, 0
v_mov_b32 v211, 0
v_mov_b32 v212, 0
v_mov_b32 v213, 0
v_mov_b32 v214, 0
v_mov_b32 v215, 0
v_mov_b32 v216, 0
v_mov_b32 v217, 0
v_mov_b32 v218, 0
v_mov_b32 v219, 0
v_mov_b32 v220, 0
v_mov_b32 v221, 0
v_mov_b32 v222, 0
v_mov_b32 v223, 0
v_mov_b32 v224, 0
v_mov_b32 v225, 0
v_mov_b32 v226, 0
v_mov_b32 v227, 0
v_mov_b32 v228, 0
v_mov_b32 v229, 0
v_mov_b32 v230, 0
v_mov_b32 v231, 0
v_mov_b32 v232, 0
v_mov_b32 v233, 0
v_mov_b32 v234, 0
v_mov_b32 v235, 0
v_mov_b32 v236, 0
v_mov_b32 v237, 0
v_mov_b32 v238, 0
v_mov_b32 v239, 0
v_mov_b32 v240, 0
v_mov_b32 v241, 0
v_mov_b32 v242, 0
v_mov_b32 v243, 0
v_mov_b32 v244, 0
v_mov_b32 v245, 0
v_mov_b32 v246, 0
v_mov_b32 v247, 0
v_mov_b32 v248, 0
v_mov_b32 v249, 0
v_mov_b32 v250, 0
v_mov_b32 v251, 0
s_mov_b32 s48, 0xf149f2ca
v_mov_b32 v9, s48
v_lshlrev_b32 v4, 2, v3
v_sub_u32 v4, v2, v4
v_subrev_u32 v5, 0, v4
v_and_b32 v6, 0x80000001, v5
v_cmp_eq_u32 vcc, 0, v6
v_add_u32 v5, 1, v5
v_and_b32 v6, 0x80000001, v5
v_cndmask_b32 v40, v9, 0, vcc
v_cmp_eq_u32 vcc, 0x80000001, v6
s_nop 1
v_cndmask_b32 v36, v9, 0, vcc
v_subrev_u32 v5, 1, v4
v_and_b32 v6, 0x80000001, v5
v_cmp_eq_u32 vcc, 0, v6
v_add_u32 v5, 1, v5
v_and_b32 v6, 0x80000001, v5
v_cndmask_b32 v41, v9, 0, vcc
v_cmp_eq_u32 vcc, 0x80000001, v6
s_nop 1
v_cndmask_b32 v37, v9, 0, vcc
v_subrev_u32 v5, 2, v4
v_and_b32 v6, 0x80000001, v5
v_cmp_eq_u32 vcc, 0, v6
v_add_u32 v5, 1, v5
v_and_b32 v6, 0x80000001, v5
v_cndmask_b32 v42, v9, 0, vcc
v_cmp_eq_u32 vcc, 0x80000001, v6
s_nop 1
v_cndmask_b32 v38, v9, 0, vcc
v_subrev_u32 v5, 3, v4
v_and_b32 v6, 0x80000001, v5
v_cmp_eq_u32 vcc, 0, v6
v_add_u32 v5, 1, v5
v_and_b32 v6, 0x80000001, v5
v_cndmask_b32 v43, v9, 0, vcc
v_cmp_eq_u32 vcc, 0x80000001, v6
s_nop 1
v_cndmask_b32 v39, v9, 0, vcc
s_or_b32 s48, s41, s44
s_cmp_eq_u32 s48, 0
s_cselect_b64 vcc, -1, 0
v_cndmask_b32 v44, v36, v9, vcc
v_cndmask_b32 v45, v37, v9, vcc
v_cndmask_b32 v46, v38, v9, vcc
v_cndmask_b32 v47, v39, v9, vcc
v_and_b32 v4, 1, v2
v_lshlrev_b32 v4, 4, v4
v_mov_b32 v5, 0xffff
v_lshlrev_b32 v52, v4, v5
s_lshl_b32 s48, s43, 11
s_add_u32 s48, s48, 135168
v_add_u32 v53, s48, v18
v_lshl_add_u32 v55, v0, 3, s48
s_add_u32 s48, s41, s44
s_sub_u32 s48, s48, 1
s_lshl_b32 s49, s48, 1
s_add_u32 s49, s49, s43
s_lshl_b32 s49, s49, 11
s_mul_i32 s50, s42, 65536
s_add_u32 s49, s49, s50
s_add_u32 s49, s49, 8388608
s_cmp_lt_i32 s48, 0
s_cselect_b32 s49, 0xf0000000, s49
v_add_u32 v58, s49, v18
v_lshl_add_u32 v59, v0, 3, s49
s_lshl_b32 s48, s43, 2
s_add_u32 s48, s48, 134672
v_mov_b32 v19, s48
s_lshl_b32 s48, s43, 7
s_add_u32 s48, s48, 133120
v_lshl_add_u32 v7, v3, 4, s48
v_lshl_add_u32 v54, v2, 2, s48
s_lshl_b32 s49, s44, 6
v_add_u32 v8, s49, v2
v_lshlrev_b32 v8, 3, v8
v_add_u32 v8, 131072, v8
v_lshl_add_u32 v9, v3, 2, s49
v_lshlrev_b32 v9, 2, v9
v_add_u32 v9, 132096, v9
s_mov_b32 s64, 0
s_mov_b32 s65, 0
s_mov_b32 s66, 0x3e8293ee
s_mov_b32 s61, 3
ds_read_b64_tr_b16 v[84:85], v16 offset:8192
ds_read_b64_tr_b16 v[86:87], v16 offset:8704
ds_read_b64_tr_b16 v[88:89], v17 offset:8192
ds_read_b64_tr_b16 v[90:91], v17 offset:8704
ds_read_b64_tr_b16 v[92:93], v16 offset:16384
ds_read_b64_tr_b16 v[94:95], v16 offset:16896
ds_read_b64_tr_b16 v[96:97], v17 offset:16384
ds_read_b64_tr_b16 v[98:99], v17 offset:16896
ds_read_b64_tr_b16 v[76:77], v16 offset:0
ds_read_b64_tr_b16 v[78:79], v16 offset:512
ds_read_b64_tr_b16 v[80:81], v17 offset:0
ds_read_b64_tr_b16 v[82:83], v17 offset:512
s_barrier
ds_read_b128 v[60:63], v14 offset:0
ds_read_b128 v[64:67], v14 offset:2048
ds_read_b128 v[68:71], v14 offset:4096
ds_read_b128 v[72:75], v14 offset:6144
s_waitcnt lgkmcnt(0)
c2_loop:
v_mfma_f32_16x16x32_bf16 v[212:215], v[84:87], v[72:75], v[212:215]
ds_read_b128 v[100:103], v15 offset:0
v_mfma_f32_16x16x32_bf16 v[204:207], v[84:87], v[68:71], v[204:207]
ds_read_b128 v[104:107], v15 offset:2048
v_mfma_f32_16x16x32_bf16 v[196:199], v[84:87], v[64:67], v[196:199]
ds_read_b128 v[108:111], v15 offset:4096
v_mfma_f32_16x16x32_bf16 v[188:191], v[84:87], v[60:63], v[188:191]
ds_read_b128 v[112:115], v15 offset:6144
v_mfma_f32_16x16x32_bf16 v[192:195], v[88:91], v[60:63], v[192:195]
ds_read_b64_tr_b16 v[124:125], v16 offset:12288
v_mfma_f32_16x16x32_bf16 v[200:203], v[88:91], v[64:67], v[200:203]
ds_read_b64_tr_b16 v[126:127], v16 offset:12800
v_mfma_f32_16x16x32_bf16 v[208:211], v[88:91], v[68:71], v[208:211]
ds_read_b64_tr_b16 v[128:129], v17 offset:12288
v_mfma_f32_16x16x32_bf16 v[216:219], v[88:91], v[72:75], v[216:219]
ds_read_b64_tr_b16 v[130:131], v17 offset:12800
v_mfma_f32_16x16x32_bf16 v[244:247], v[72:75], v[92:95], v[244:247]
ds_read_b64_tr_b16 v[132:133], v16 offset:20480
v_mfma_f32_16x16x32_bf16 v[248:251], v[72:75], v[96:99], v[248:251]
ds_read_b64_tr_b16 v[134:135], v16 offset:20992
v_mfma_f32_16x16x32_bf16 v[240:243], v[68:71], v[96:99], v[240:243]
ds_read_b64_tr_b16 v[136:137], v17 offset:20480
v_mfma_f32_16x16x32_bf16 v[236:239], v[68:71], v[92:95], v[236:239]
ds_read_b64_tr_b16 v[138:139], v17 offset:20992
v_mfma_f32_16x16x32_bf16 v[228:231], v[64:67], v[92:95], v[228:231]
ds_read_b64_tr_b16 v[116:117], v16 offset:4096
v_mfma_f32_16x16x32_bf16 v[232:235], v[64:67], v[96:99], v[232:235]
ds_read_b64_tr_b16 v[118:119], v16 offset:4608
v_mfma_f32_16x16x32_bf16 v[224:227], v[60:63], v[96:99], v[224:227]
ds_read_b64_tr_b16 v[120:121], v17 offset:4096
v_mfma_f32_16x16x32_bf16 v[220:223], v[60:63], v[92:95], v[220:223]
ds_read_b64_tr_b16 v[122:123], v17 offset:4608
v_mfma_f32_16x16x32_bf16 v[156:159], v[76:79], v[60:63], v[156:159]
s_add_u32 s65, s65, 40960
s_cmp_eq_u32 s65, 122880
v_mfma_f32_16x16x32_bf16 v[164:167], v[76:79], v[64:67], v[164:167]
s_cselect_b32 s65, 0, s65
s_add_u32 s64, s64, 1
v_mfma_f32_16x16x32_bf16 v[172:175], v[76:79], v[68:71], v[172:175]
v_add_u32 v14, s65, v10
v_add_u32 v15, s65, v11
v_mfma_f32_16x16x32_bf16 v[180:183], v[76:79], v[72:75], v[180:183]
v_add_u32 v16, s65, v12
v_add_u32 v17, s65, v13
v_mfma_f32_16x16x32_bf16 v[184:187], v[80:83], v[72:75], v[184:187]
v_mfma_f32_16x16x32_bf16 v[176:179], v[80:83], v[68:71], v[176:179]
s_cmp_eq_u32 s64, 16
s_cbranch_scc1 c2_last
v_mfma_f32_16x16x32_bf16 v[168:171], v[80:83], v[64:67], v[168:171]
s_waitcnt lgkmcnt(0)
v_mfma_f32_16x16x32_bf16 v[160:163], v[80:83], v[60:63], v[160:163]
s_barrier
v_mfma_f32_16x16x32_bf16 v[212:215], v[124:127], v[112:115], v[212:215]
ds_read_b128 v[60:63], v14 offset:0
v_mfma_f32_16x16x32_bf16 v[204:207], v[124:127], v[108:111], v[204:207]
ds_read_b128 v[64:67], v14 offset:2048
v_mfma_f32_16x16x32_bf16 v[196:199], v[124:127], v[104:107], v[196:199]
ds_read_b128 v[68:71], v14 offset:4096
v_mfma_f32_16x16x32_bf16 v[188:191], v[124:127], v[100:103], v[188:191]
ds_read_b128 v[72:75], v14 offset:6144
v_mfma_f32_16x16x32_bf16 v[192:195], v[128:131], v[100:103], v[192:195]
ds_read_b64_tr_b16 v[84:85], v16 offset:8192
v_mfma_f32_16x16x32_bf16 v[200:203], v[128:131], v[104:107], v[200:203]
ds_read_b64_tr_b16 v[86:87], v16 offset:8704
v_mfma_f32_16x16x32_bf16 v[208:211], v[128:131], v[108:111], v[208:211]
ds_read_b64_tr_b16 v[88:89], v17 offset:8192
v_mfma_f32_16x16x32_bf16 v[216:219], v[128:131], v[112:115], v[216:219]
ds_read_b64_tr_b16 v[90:91], v17 offset:8704
v_mfma_f32_16x16x32_bf16 v[244:247], v[112:115], v[132:135], v[244:247]
ds_read_b64_tr_b16 v[92:93], v16 offset:16384
v_mfma_f32_16x16x32_bf16 v[248:251], v[112:115], v[136:139], v[248:251]
ds_read_b64_tr_b16 v[94:95], v16 offset:16896
v_mfma_f32_16x16x32_bf16 v[240:243], v[108:111], v[136:139], v[240:243]
ds_read_b64_tr_b16 v[96:97], v17 offset:16384
v_mfma_f32_16x16x32_bf16 v[236:239], v[108:111], v[132:135], v[236:239]
ds_read_b64_tr_b16 v[98:99], v17 offset:16896
v_mfma_f32_16x16x32_bf16 v[228:231], v[104:107], v[132:135], v[228:231]
ds_read_b64_tr_b16 v[76:77], v16 offset:0
v_mfma_f32_16x16x32_bf16 v[232:235], v[104:107], v[136:139], v[232:235]
ds_read_b64_tr_b16 v[78:79], v16 offset:512
v_mfma_f32_16x16x32_bf16 v[224:227], v[100:103], v[136:139], v[224:227]
ds_read_b64_tr_b16 v[80:81], v17 offset:0
v_mfma_f32_16x16x32_bf16 v[220:223], v[100:103], v[132:135], v[220:223]
ds_read_b64_tr_b16 v[82:83], v17 offset:512
v_mfma_f32_16x16x32_bf16 v[156:159], v[116:119], v[100:103], v[156:159]
v_mfma_f32_16x16x32_bf16 v[164:167], v[116:119], v[104:107], v[164:167]
v_mfma_f32_16x16x32_bf16 v[172:175], v[116:119], v[108:111], v[172:175]
v_mfma_f32_16x16x32_bf16 v[180:183], v[116:119], v[112:115], v[180:183]
v_mfma_f32_16x16x32_bf16 v[184:187], v[120:123], v[112:115], v[184:187]
v_mfma_f32_16x16x32_bf16 v[176:179], v[120:123], v[108:111], v[176:179]
v_mfma_f32_16x16x32_bf16 v[168:171], v[120:123], v[104:107], v[168:171]
s_waitcnt lgkmcnt(0)
v_mfma_f32_16x16x32_bf16 v[160:163], v[120:123], v[100:103], v[160:163]
s_branch c2_loop
c2_last:
v_mfma_f32_16x16x32_bf16 v[168:171], v[80:83], v[64:67], v[168:171]
s_waitcnt lgkmcnt(0)
v_mfma_f32_16x16x32_bf16 v[160:163], v[80:83], v[60:63], v[160:163]
v_mfma_f32_16x16x32_bf16 v[212:215], v[124:127], v[112:115], v[212:215]
ds_read_b128 v[140:143], v7 offset:0
v_mfma_f32_16x16x32_bf16 v[204:207], v[124:127], v[108:111], v[204:207]
ds_read_b128 v[144:147], v7 offset:64
v_mfma_f32_16x16x32_bf16 v[196:199], v[124:127], v[104:107], v[196:199]
ds_read_b128 v[148:151], v7 offset:256
v_mfma_f32_16x16x32_bf16 v[188:191], v[124:127], v[100:103], v[188:191]
ds_read_b128 v[152:155], v7 offset:320
v_mfma_f32_16x16x32_bf16 v[192:195], v[128:131], v[100:103], v[192:195]
ds_read2_b32 v[56:57], v54 offset0:128 offset1:144
v_mfma_f32_16x16x32_bf16 v[200:203], v[128:131], v[104:107], v[200:203]
v_mfma_f32_16x16x32_bf16 v[208:211], v[128:131], v[108:111], v[208:211]
v_mfma_f32_16x16x32_bf16 v[216:219], v[128:131], v[112:115], v[216:219]
s_barrier
v_mfma_f32_16x16x32_bf16 v[244:247], v[112:115], v[132:135], v[244:247]
ds_read_b64 v[92:93], v8 offset:0
v_mfma_f32_16x16x32_bf16 v[248:251], v[112:115], v[136:139], v[248:251]
ds_read_b64 v[94:95], v8 offset:128
v_mfma_f32_16x16x32_bf16 v[240:243], v[108:111], v[136:139], v[240:243]
ds_read_b64 v[96:97], v8 offset:256
v_mfma_f32_16x16x32_bf16 v[236:239], v[108:111], v[132:135], v[236:239]
ds_read_b64 v[98:99], v8 offset:384
v_mfma_f32_16x16x32_bf16 v[228:231], v[104:107], v[132:135], v[228:231]
ds_read_b128 v[60:63], v9 offset:0
v_mfma_f32_16x16x32_bf16 v[232:235], v[104:107], v[136:139], v[232:235]
ds_read_b128 v[64:67], v9 offset:64
v_mfma_f32_16x16x32_bf16 v[224:227], v[100:103], v[136:139], v[224:227]
ds_read_b128 v[68:71], v9 offset:128
v_mfma_f32_16x16x32_bf16 v[220:223], v[100:103], v[132:135], v[220:223]
ds_read_b128 v[72:75], v9 offset:192
v_mfma_f32_16x16x32_bf16 v[156:159], v[116:119], v[100:103], v[156:159]
ds_read_b128 v[76:79], v9 offset:512
v_mfma_f32_16x16x32_bf16 v[164:167], v[116:119], v[104:107], v[164:167]
ds_read_b128 v[80:83], v9 offset:576
v_mfma_f32_16x16x32_bf16 v[172:175], v[116:119], v[108:111], v[172:175]
ds_read_b128 v[84:87], v9 offset:640
v_mfma_f32_16x16x32_bf16 v[180:183], v[116:119], v[112:115], v[180:183]
ds_read_b128 v[88:91], v9 offset:704
v_mfma_f32_16x16x32_bf16 v[184:187], v[120:123], v[112:115], v[184:187]
v_mfma_f32_16x16x32_bf16 v[176:179], v[120:123], v[108:111], v[176:179]
v_mfma_f32_16x16x32_bf16 v[168:171], v[120:123], v[104:107], v[168:171]
v_mfma_f32_16x16x32_bf16 v[160:163], v[120:123], v[100:103], v[160:163]
c2_epi:
s_waitcnt lgkmcnt(0)
.p2align 3
v_pk_fma_f32 v[212:213], v[148:149], v[98:99], v[212:213] op_sel:[0,1,0] op_sel_hi:[1,1,1]
v_pk_fma_f32 v[214:215], v[150:151], v[98:99], v[214:215] op_sel:[0,1,0] op_sel_hi:[1,1,1]
v_pk_fma_f32 v[216:217], v[152:153], v[98:99], v[216:217] op_sel:[0,1,0] op_sel_hi:[1,1,1]
v_pk_fma_f32 v[218:219], v[154:155], v[98:99], v[218:219] op_sel:[0,1,0] op_sel_hi:[1,1,1]
v_pk_mul_f32 v[212:213], v[212:213], v[98:99] op_sel:[0,0] op_sel_hi:[1,0]
v_pk_mul_f32 v[214:215], v[214:215], v[98:99] op_sel:[0,0] op_sel_hi:[1,0]
v_pk_mul_f32 v[216:217], v[216:217], v[98:99] op_sel:[0,0] op_sel_hi:[1,0]
v_pk_mul_f32 v[218:219], v[218:219], v[98:99] op_sel:[0,0] op_sel_hi:[1,0]
v_cvt_pk_bf16_f32 v212, v212, v213
v_cvt_pk_bf16_f32 v213, v214, v215
v_cvt_pk_bf16_f32 v214, v216, v217
v_cvt_pk_bf16_f32 v215, v218, v219
v_pk_fma_f32 v[244:245], v[88:89], v[56:57], v[244:245] op_sel:[0,0,0] op_sel_hi:[1,0,1]
v_pk_fma_f32 v[246:247], v[90:91], v[56:57], v[246:247] op_sel:[0,0,0] op_sel_hi:[1,0,1]
v_pk_mul_f32 v[244:245], v[244:245], v[72:73]
v_pk_mul_f32 v[246:247], v[246:247], v[74:75]
v_cvt_pk_bf16_f32 v108, v244, v245
v_cvt_pk_bf16_f32 v109, v246, v247
v_pk_fma_f32 v[248:249], v[88:89], v[56:57], v[248:249] op_sel:[0,1,0] op_sel_hi:[1,1,1]
v_pk_fma_f32 v[250:251], v[90:91], v[56:57], v[250:251] op_sel:[0,1,0] op_sel_hi:[1,1,1]
v_pk_mul_f32 v[248:249], v[248:249], v[72:73]
v_pk_mul_f32 v[250:251], v[250:251], v[74:75]
v_cvt_pk_bf16_f32 v118, v248, v249
v_cvt_pk_bf16_f32 v119, v250, v251
s_cmp_lg_u32 s44, 1
s_cbranch_scc1 else_102
buffer_store_dwordx4 v[212:215], v58, s[32:35], 0 offen sc1
buffer_store_dwordx2 v[108:109], v59, s[32:35], 0 offen offset:1024 sc1
buffer_store_dwordx2 v[118:119], v59, s[32:35], 0 offen offset:1536 sc1
s_branch fi_103
else_102:
ds_write_b128 v53, v[212:215]
ds_write_b64 v55, v[108:109] offset:1024
ds_write_b64 v55, v[118:119] offset:1536
v_mov_b32 v4, 3
ds_write_b32 v19, v4
fi_103:
.p2align 3
v_pk_fma_f32 v[188:189], v[148:149], v[92:93], v[188:189] op_sel:[0,1,0] op_sel_hi:[1,1,1]
v_pk_fma_f32 v[196:197], v[148:149], v[94:95], v[196:197] op_sel:[0,1,0] op_sel_hi:[1,1,1]
v_pk_fma_f32 v[204:205], v[148:149], v[96:97], v[204:205] op_sel:[0,1,0] op_sel_hi:[1,1,1]
v_pk_fma_f32 v[164:165], v[140:141], v[94:95], v[164:165] op_sel:[0,1,0] op_sel_hi:[1,1,1]
v_pk_fma_f32 v[172:173], v[140:141], v[96:97], v[172:173] op_sel:[0,1,0] op_sel_hi:[1,1,1]
v_pk_fma_f32 v[180:181], v[140:141], v[98:99], v[180:181] op_sel:[0,1,0] op_sel_hi:[1,1,1]
v_pk_fma_f32 v[190:191], v[150:151], v[92:93], v[190:191] op_sel:[0,1,0] op_sel_hi:[1,1,1]
v_pk_mul_f32 v[188:189], v[188:189], v[92:93] op_sel:[0,0] op_sel_hi:[1,0]
v_pk_fma_f32 v[198:199], v[150:151], v[94:95], v[198:199] op_sel:[0,1,0] op_sel_hi:[1,1,1]
v_pk_mul_f32 v[196:197], v[196:197], v[94:95] op_sel:[0,0] op_sel_hi:[1,0]
v_pk_fma_f32 v[206:207], v[150:151], v[96:97], v[206:207] op_sel:[0,1,0] op_sel_hi:[1,1,1]
v_pk_mul_f32 v[204:205], v[204:205], v[96:97] op_sel:[0,0] op_sel_hi:[1,0]
v_pk_fma_f32 v[166:167], v[142:143], v[94:95], v[166:167] op_sel:[0,1,0] op_sel_hi:[1,1,1]
v_cvt_pk_bf16_f32 v164, v164, v165
v_pk_fma_f32 v[174:175], v[142:143], v[96:97], v[174:175] op_sel:[0,1,0] op_sel_hi:[1,1,1]
v_cvt_pk_bf16_f32 v172, v172, v173
v_pk_fma_f32 v[182:183], v[142:143], v[98:99], v[182:183] op_sel:[0,1,0] op_sel_hi:[1,1,1]
v_cvt_pk_bf16_f32 v180, v180, v181
v_pk_fma_f32 v[192:193], v[152:153], v[92:93], v[192:193] op_sel:[0,1,0] op_sel_hi:[1,1,1]
v_pk_fma_f32 v[194:195], v[154:155], v[92:93], v[194:195] op_sel:[0,1,0] op_sel_hi:[1,1,1]
v_pk_mul_f32 v[190:191], v[190:191], v[92:93] op_sel:[0,0] op_sel_hi:[1,0]
v_cvt_pk_bf16_f32 v188, v188, v189
v_pk_fma_f32 v[200:201], v[152:153], v[94:95], v[200:201] op_sel:[0,1,0] op_sel_hi:[1,1,1]
v_pk_fma_f32 v[202:203], v[154:155], v[94:95], v[202:203] op_sel:[0,1,0] op_sel_hi:[1,1,1]
v_pk_mul_f32 v[198:199], v[198:199], v[94:95] op_sel:[0,0] op_sel_hi:[1,0]
v_cvt_pk_bf16_f32 v196, v196, v197
v_pk_fma_f32 v[208:209], v[152:153], v[96:97], v[208:209] op_sel:[0,1,0] op_sel_hi:[1,1,1]
v_pk_fma_f32 v[210:211], v[154:155], v[96:97], v[210:211] op_sel:[0,1,0] op_sel_hi:[1,1,1]
v_pk_mul_f32 v[206:207], v[206:207], v[96:97] op_sel:[0,0] op_sel_hi:[1,0]
v_cvt_pk_bf16_f32 v204, v204, v205
v_pk_fma_f32 v[168:169], v[144:145], v[94:95], v[168:169] op_sel:[0,1,0] op_sel_hi:[1,1,1]
v_pk_fma_f32 v[170:171], v[146:147], v[94:95], v[170:171] op_sel:[0,1,0] op_sel_hi:[1,1,1]
v_cvt_pk_bf16_f32 v165, v166, v167
v_pk_fma_f32 v[176:177], v[144:145], v[96:97], v[176:177] op_sel:[0,1,0] op_sel_hi:[1,1,1]
v_pk_fma_f32 v[178:179], v[146:147], v[96:97], v[178:179] op_sel:[0,1,0] op_sel_hi:[1,1,1]
v_cvt_pk_bf16_f32 v173, v174, v175
v_pk_fma_f32 v[184:185], v[144:145], v[98:99], v[184:185] op_sel:[0,1,0] op_sel_hi:[1,1,1]
v_pk_fma_f32 v[186:187], v[146:147], v[98:99], v[186:187] op_sel:[0,1,0] op_sel_hi:[1,1,1]
v_cvt_pk_bf16_f32 v181, v182, v183
v_pk_mul_f32 v[192:193], v[192:193], v[92:93] op_sel:[0,0] op_sel_hi:[1,0]
v_pk_mul_f32 v[194:195], v[194:195], v[92:93] op_sel:[0,0] op_sel_hi:[1,0]
v_cvt_pk_bf16_f32 v189, v190, v191
v_pk_mul_f32 v[200:201], v[200:201], v[94:95] op_sel:[0,0] op_sel_hi:[1,0]
v_pk_mul_f32 v[202:203], v[202:203], v[94:95] op_sel:[0,0] op_sel_hi:[1,0]
v_cvt_pk_bf16_f32 v197, v198, v199
v_pk_mul_f32 v[208:209], v[208:209], v[96:97] op_sel:[0,0] op_sel_hi:[1,0]
v_pk_mul_f32 v[210:211], v[210:211], v[96:97] op_sel:[0,0] op_sel_hi:[1,0]
v_cvt_pk_bf16_f32 v205, v206, v207
v_cvt_pk_bf16_f32 v166, v168, v169
v_cvt_pk_bf16_f32 v167, v170, v171
v_cvt_pk_bf16_f32 v174, v176, v177
v_cvt_pk_bf16_f32 v175, v178, v179
v_cvt_pk_bf16_f32 v182, v184, v185
v_cvt_pk_bf16_f32 v183, v186, v187
v_cvt_pk_bf16_f32 v190, v192, v193
v_cvt_pk_bf16_f32 v191, v194, v195
v_mfma_f32_16x16x32_bf16 v[216:219], v[212:215], v[180:183], v[40:43]
v_cvt_pk_bf16_f32 v198, v200, v201
v_cvt_pk_bf16_f32 v199, v202, v203
v_mfma_f32_16x16x32_bf16 v[168:171], v[188:191], v[164:167], v[36:39]
v_cvt_pk_bf16_f32 v206, v208, v209
v_cvt_pk_bf16_f32 v207, v210, v211
v_mfma_f32_16x16x32_bf16 v[200:203], v[196:199], v[164:167], v[40:43]
v_mul_f32 v124, s66, v92
v_mul_f32 v125, s66, v94
v_mfma_f32_16x16x32_bf16 v[208:211], v[204:207], v[172:175], v[40:43]
v_mul_f32 v126, s66, v96
v_mul_f32 v127, s66, v98
v_mfma_f32_16x16x32_bf16 v[176:179], v[196:199], v[172:175], v[36:39]
v_max_f32 v164, v168, v169
v_max_f32 v165, v170, v171
v_mfma_f32_16x16x32_bf16 v[184:187], v[204:207], v[180:183], v[36:39]
v_max_f32 v166, v200, v201
v_max_f32 v182, v216, v217
v_max_f32 v174, v208, v209
v_max_f32 v167, v202, v203
v_max3_f32 v129, v164, v165, v166
v_pk_fma_f32 v[156:157], v[140:141], v[92:93], v[156:157] op_sel:[0,1,0] op_sel_hi:[1,1,1]
v_pk_fma_f32 v[158:159], v[142:143], v[92:93], v[158:159] op_sel:[0,1,0] op_sel_hi:[1,1,1]
v_cvt_pk_bf16_f32 v156, v156, v157
v_pk_fma_f32 v[160:161], v[144:145], v[92:93], v[160:161] op_sel:[0,1,0] op_sel_hi:[1,1,1]
v_pk_fma_f32 v[162:163], v[146:147], v[92:93], v[162:163] op_sel:[0,1,0] op_sel_hi:[1,1,1]
v_cvt_pk_bf16_f32 v157, v158, v159
v_cvt_pk_bf16_f32 v158, v160, v161
v_cvt_pk_bf16_f32 v159, v162, v163
v_pk_fma_f32 v[220:221], v[76:77], v[56:57], v[220:221] op_sel:[0,0,0] op_sel_hi:[1,0,1]
v_pk_fma_f32 v[222:223], v[78:79], v[56:57], v[222:223] op_sel:[0,0,0] op_sel_hi:[1,0,1]
v_mfma_f32_16x16x32_bf16 v[192:195], v[188:191], v[156:159], v[40:43]
v_max_f32 v172, v176, v177
v_max_f32 v173, v178, v179
v_max_f32 v180, v184, v185
v_max_f32 v181, v186, v187
v_max_f32_e64 v175, v210, v211
v_pk_fma_f32 v[224:225], v[76:77], v[56:57], v[224:225] op_sel:[0,1,0] op_sel_hi:[1,1,1]
v_pk_fma_f32 v[226:227], v[78:79], v[56:57], v[226:227] op_sel:[0,1,0] op_sel_hi:[1,1,1]
v_pk_fma_f32 v[228:229], v[80:81], v[56:57], v[228:229] op_sel:[0,0,0] op_sel_hi:[1,0,1]
v_pk_fma_f32 v[230:231], v[82:83], v[56:57], v[230:231] op_sel:[0,0,0] op_sel_hi:[1,0,1]
v_pk_fma_f32 v[232:233], v[80:81], v[56:57], v[232:233] op_sel:[0,1,0] op_sel_hi:[1,1,1]
v_pk_fma_f32 v[234:235], v[82:83], v[56:57], v[234:235] op_sel:[0,1,0] op_sel_hi:[1,1,1]
v_pk_fma_f32 v[236:237], v[84:85], v[56:57], v[236:237] op_sel:[0,0,0] op_sel_hi:[1,0,1]
v_pk_fma_f32 v[238:239], v[86:87], v[56:57], v[238:239] op_sel:[0,0,0] op_sel_hi:[1,0,1]
v_pk_fma_f32 v[240:241], v[84:85], v[56:57], v[240:241] op_sel:[0,1,0] op_sel_hi:[1,1,1]
v_pk_fma_f32 v[242:243], v[86:87], v[56:57], v[242:243] op_sel:[0,1,0] op_sel_hi:[1,1,1]
v_pk_mul_f32 v[220:221], v[220:221], v[60:61]
v_pk_mul_f32 v[222:223], v[222:223], v[62:63]
v_pk_mul_f32 v[224:225], v[224:225], v[60:61]
s_cmp_lg_u32 s44, 0
s_cbranch_scc1 else_104
buffer_load_dwordx4 v[120:123], v58, s[32:35], 0 offen sc1
buffer_load_dwordx2 v[100:101], v59, s[32:35], 0 offen offset:1024 sc1
buffer_load_dwordx2 v[110:111], v59, s[32:35], 0 offen offset:1536 sc1
else_104:
v_pk_mul_f32 v[226:227], v[226:227], v[62:63]
v_pk_mul_f32 v[228:229], v[228:229], v[64:65]
v_pk_mul_f32 v[230:231], v[230:231], v[66:67]
v_pk_mul_f32 v[232:233], v[232:233], v[64:65]
v_pk_mul_f32 v[234:235], v[234:235], v[66:67]
v_pk_mul_f32 v[236:237], v[236:237], v[68:69]
v_pk_mul_f32 v[238:239], v[238:239], v[70:71]
v_pk_mul_f32 v[240:241], v[240:241], v[68:69]
v_pk_mul_f32 v[242:243], v[242:243], v[70:71]
v_max3_f32 v130, v172, v173, v174
v_max_f32_e64 v183, v218, v219
v_max3_f32 v131, v180, v181, v182
v_cvt_pk_bf16_f32 v102, v220, v221
v_cvt_pk_bf16_f32 v103, v222, v223
v_cvt_pk_bf16_f32 v112, v224, v225
v_cvt_pk_bf16_f32 v113, v226, v227
v_cvt_pk_bf16_f32 v104, v228, v229
v_cvt_pk_bf16_f32 v105, v230, v231
v_cvt_pk_bf16_f32 v114, v232, v233
v_cvt_pk_bf16_f32 v115, v234, v235
v_cvt_pk_bf16_f32 v106, v236, v237
v_cvt_pk_bf16_f32 v107, v238, v239
v_cvt_pk_bf16_f32 v116, v240, v241
v_cvt_pk_bf16_f32 v117, v242, v243
v_max_f32 v129, v129, v167
v_max_f32 v130, v130, v175
v_max_f32 v131, v131, v183
s_cmp_lg_u32 s44, 0
s_cbranch_scc1 else_106
s_mov_b32 s63, 0
sent_108:
s_waitcnt vmcnt(0)
v_max_u32 v4, v120, v121
v_max3_u32 v4, v4, v122, v123
v_max3_u32 v4, v4, v100, v101
v_max3_u32 v4, v4, v110, v111
v_cmp_eq_u32 vcc, -1, v4
s_cbranch_vccz sentd_109
buffer_load_dwordx4 v[120:123], v58, s[32:35], 0 offen sc1
buffer_load_dwordx2 v[100:101], v59, s[32:35], 0 offen offset:1024 sc1
buffer_load_dwordx2 v[110:111], v59, s[32:35], 0 offen offset:1536 sc1
s_add_u32 s63, s63, 1
s_cmp_lt_u32 s63, 0x80000
s_cbranch_scc1 sent_108
s_waitcnt vmcnt(0)
sentd_109:
s_branch fi_107
else_106:
s_mov_b32 s63, 0
px_110:
ds_read_b32 v4, v19
ds_read_b128 v[120:123], v53
ds_read_b64 v[100:101], v55 offset:1024
ds_read_b64 v[110:111], v55 offset:1536
s_add_u32 s63, s63, 1
s_cmp_lt_u32 s63, 0x400000
s_waitcnt lgkmcnt(0)
v_cmp_ne_u32 vcc, 3, v4
s_cbranch_vccz pxd_111
s_cbranch_scc1 px_110
pxd_111:
fi_107:
s_cmp_eq_u32 s46, 0
s_cbranch_scc1 slow_112
.p2align 3
v_mfma_f32_16x16x32_bf16 v[160:163], v[120:123], v[156:159], v[44:47]
v_max_f32 v158, v192, v193
v_max_f32 v159, v194, v195
v_permlane32_swap_b32 v130, v131
s_nop 0
v_max_f32 v130, v130, v131
s_nop 2
v_max_f32 v156, v160, v161
v_max_f32 v157, v162, v163
v_max3_f32 v128, v156, v157, v158
v_max_f32 v128, v128, v159
s_nop 1
v_permlane32_swap_b32 v128, v129
s_nop 0
v_max_f32 v128, v128, v129
s_nop 1
v_permlane16_swap_b32 v128, v130
s_nop 0
v_max_f32 v128, v128, v130
v_mov_b32 v130, v128
s_nop 1
v_permlane16_swap_b32 v128, v130
s_nop 0
v_mov_b32 v129, v128
v_mov_b32 v131, v130
s_nop 0
v_permlane32_swap_b32 v128, v129
v_permlane32_swap_b32 v130, v131
v_mul_f32 v128, v128, v124
v_mul_f32 v129, v129, v125
v_pk_fma_f32 v[156:157], v[156:157], v[124:125], v[128:129] op_sel:[0,0,0] op_sel_hi:[1,0,0] neg_lo:[0,0,1] neg_hi:[0,0,1]
v_pk_fma_f32 v[158:159], v[158:159], v[124:125], v[128:129] op_sel:[0,0,0] op_sel_hi:[1,0,0] neg_lo:[0,0,1] neg_hi:[0,0,1]
v_mul_f32 v130, v130, v126
v_mul_f32 v131, v131, v127
v_exp_f32 v156, v156
v_exp_f32 v157, v157
v_exp_f32 v158, v158
v_exp_f32 v159, v159
v_pk_fma_f32 v[164:165], v[164:165], v[124:125], v[128:129] op_sel:[0,1,1] op_sel_hi:[1,1,1] neg_lo:[0,0,1] neg_hi:[0,0,1]
v_pk_fma_f32 v[166:167], v[166:167], v[124:125], v[128:129] op_sel:[0,1,1] op_sel_hi:[1,1,1] neg_lo:[0,0,1] neg_hi:[0,0,1]
v_exp_f32 v164, v164
v_exp_f32 v165, v165
v_exp_f32 v166, v166
v_exp_f32 v167, v167
v_pk_fma_f32 v[172:173], v[172:173], v[126:127], v[130:131] op_sel:[0,0,0] op_sel_hi:[1,0,0] neg_lo:[0,0,1] neg_hi:[0,0,1]
v_pk_fma_f32 v[174:175], v[174:175], v[126:127], v[130:131] op_sel:[0,0,0] op_sel_hi:[1,0,0] neg_lo:[0,0,1] neg_hi:[0,0,1]
v_cvt_pk_bf16_f32 v156, v156, v156
v_cvt_pk_bf16_f32 v157, v157, v157
v_cvt_pk_bf16_f32 v158, v158, v158
v_cvt_pk_bf16_f32 v159, v159, v159
v_exp_f32 v172, v172
v_exp_f32 v173, v173
v_exp_f32 v174, v174
v_exp_f32 v175, v175
v_pk_fma_f32 v[180:181], v[180:181], v[126:127], v[130:131] op_sel:[0,1,1] op_sel_hi:[1,1,1] neg_lo:[0,0,1] neg_hi:[0,0,1]
v_pk_fma_f32 v[182:183], v[182:183], v[126:127], v[130:131] op_sel:[0,1,1] op_sel_hi:[1,1,1] neg_lo:[0,0,1] neg_hi:[0,0,1]
v_and_b32 v156, v52, v156
v_and_b32 v157, v52, v157
v_and_b32 v158, v52, v158
v_and_b32 v159, v52, v159
v_cvt_pk_bf16_f32 v164, v164, v164
v_cvt_pk_bf16_f32 v165, v165, v165
v_mfma_f32_16x16x32_bf16 v[160:163], v[48:51], v[156:159], 0
v_cvt_pk_bf16_f32 v166, v166, v166
v_cvt_pk_bf16_f32 v167, v167, v167
v_mfma_f32_16x16x32_bf16 v[220:223], v[100:103], v[156:159], 0
v_exp_f32 v180, v180
v_mfma_f32_16x16x32_bf16 v[224:227], v[110:113], v[156:159], 0
v_exp_f32 v181, v181
v_exp_f32 v182, v182
v_exp_f32 v183, v183
v_and_b32 v164, v52, v164
v_and_b32 v165, v52, v165
v_and_b32 v166, v52, v166
v_and_b32 v167, v52, v167
v_cvt_pk_bf16_f32 v172, v172, v172
v_cvt_pk_bf16_f32 v173, v173, v173
v_mfma_f32_16x16x32_bf16 v[168:171], v[48:51], v[164:167], 0
v_cvt_pk_bf16_f32 v174, v174, v174
v_cvt_pk_bf16_f32 v175, v175, v175
v_mfma_f32_16x16x32_bf16 v[228:231], v[102:105], v[164:167], 0
v_and_b32 v172, v52, v172
v_and_b32 v173, v52, v173
v_mfma_f32_16x16x32_bf16 v[232:235], v[112:115], v[164:167], 0
v_and_b32 v174, v52, v174
v_and_b32 v175, v52, v175
v_cvt_pk_bf16_f32 v180, v180, v180
v_cvt_pk_bf16_f32 v181, v181, v181
v_mfma_f32_16x16x32_bf16 v[176:179], v[48:51], v[172:175], 0
v_cvt_pk_bf16_f32 v182, v182, v182
v_cvt_pk_bf16_f32 v183, v183, v183
v_mfma_f32_16x16x32_bf16 v[236:239], v[104:107], v[172:175], 0
v_and_b32 v180, v52, v180
v_and_b32 v181, v52, v181
v_mfma_f32_16x16x32_bf16 v[240:243], v[114:117], v[172:175], 0
v_and_b32 v182, v52, v182
v_and_b32 v183, v52, v183
v_rcp_f32 v160, v160
v_rcp_f32 v168, v168
v_pk_mul_f32 v[220:221], v[220:221], v[160:161] op_sel:[0,0] op_sel_hi:[1,0]
v_pk_mul_f32 v[222:223], v[222:223], v[160:161] op_sel:[0,0] op_sel_hi:[1,0]
v_pk_mul_f32 v[228:229], v[228:229], v[168:169] op_sel:[0,0] op_sel_hi:[1,0]
v_pk_mul_f32 v[224:225], v[224:225], v[160:161] op_sel:[0,0] op_sel_hi:[1,0]
v_pk_mul_f32 v[226:227], v[226:227], v[160:161] op_sel:[0,0] op_sel_hi:[1,0]
v_pk_mul_f32 v[230:231], v[230:231], v[168:169] op_sel:[0,0] op_sel_hi:[1,0]
v_pk_mul_f32 v[232:233], v[232:233], v[168:169] op_sel:[0,0] op_sel_hi:[1,0]
v_pk_mul_f32 v[234:235], v[234:235], v[168:169] op_sel:[0,0] op_sel_hi:[1,0]
v_mfma_f32_16x16x32_bf16 v[184:187], v[48:51], v[180:183], 0
v_rcp_f32_e64 v176, v176
v_cvt_pk_bf16_f32 v220, v220, v221
v_cvt_pk_bf16_f32 v221, v222, v223
v_cvt_pk_bf16_f32 v228, v228, v229
v_pk_mul_f32 v[236:237], v[236:237], v[176:177] op_sel:[0,0] op_sel_hi:[1,0]
v_mfma_f32_16x16x32_bf16 v[244:247], v[106:109], v[180:183], 0
v_cvt_pk_bf16_f32 v222, v224, v225
v_cvt_pk_bf16_f32 v223, v226, v227
v_rcp_f32_e64 v184, v184
v_cvt_pk_bf16_f32 v229, v230, v231
v_pk_mul_f32 v[238:239], v[238:239], v[176:177] op_sel:[0,0] op_sel_hi:[1,0]
v_pk_mul_f32 v[240:241], v[240:241], v[176:177] op_sel:[0,0] op_sel_hi:[1,0]
v_pk_mul_f32 v[242:243], v[242:243], v[176:177] op_sel:[0,0] op_sel_hi:[1,0]
v_cvt_pk_bf16_f32 v236, v236, v237
v_pk_mul_f32 v[244:245], v[244:245], v[184:185] op_sel:[0,0] op_sel_hi:[1,0]
v_pk_mul_f32 v[246:247], v[246:247], v[184:185] op_sel:[0,0] op_sel_hi:[1,0]
v_mfma_f32_16x16x32_bf16 v[248:251], v[116:119], v[180:183], 0
buffer_store_dwordx4 v[220:223], v18, s[32:35], s80 offen
v_cvt_pk_bf16_f32 v230, v232, v233
v_cvt_pk_bf16_f32 v231, v234, v235
v_cvt_pk_bf16_f32 v237, v238, v239
v_cvt_pk_bf16_f32 v244, v244, v245
buffer_store_dwordx4 v[228:231], v18, s[32:35], s81 offen
v_cvt_pk_bf16_f32 v238, v240, v241
v_cvt_pk_bf16_f32 v239, v242, v243
v_pk_mul_f32 v[248:249], v[248:249], v[184:185] op_sel:[0,0] op_sel_hi:[1,0]
v_pk_mul_f32 v[250:251], v[250:251], v[184:185] op_sel:[0,0] op_sel_hi:[1,0]
v_cvt_pk_bf16_f32 v245, v246, v247
buffer_store_dwordx4 v[236:239], v18, s[32:35], s82 offen
v_cvt_pk_bf16_f32 v246, v248, v249
v_cvt_pk_bf16_f32 v247, v250, v251
buffer_store_dwordx4 v[244:247], v18, s[32:35], s83 offen
back_113:
s_barrier
v_and_b32 v36, 31, v0
v_lshlrev_b32 v36, 2, v36
s_lshl_b32 s62, s45, 2
v_mov_b32 v4, s62
v_mov_b32 v5, 3
s_mov_b64 exec, 1
s_waitcnt vmcnt(0)
s_cmp_eq_u32 s46, 0
s_cbranch_scc1 slow_114
buffer_store_dword v5, v4, s[32:35], s84 offen
back_115:
s_mov_b64 exec, -1
v_lshrrev_b32 v4, 2, v2
v_and_b32 v5, 3, v0
v_lshl_add_u32 v6, v3, 3, v4
v_lshlrev_b32 v6, 7, v6
v_lshl_add_u32 v6, v5, 3, v6
v_lshrrev_b32 v7, 1, v4
v_and_b32 v8, 1, v3
v_lshl_add_u32 v7, v8, 1, v7
v_lshl_add_u32 v10, v7, 5, v6
v_xor_b32 v11, 32, v10
v_xor_b32 v12, 64, v10
v_xor_b32 v13, 96, v10
v_add_u32 v14, 0x10000, v10
v_add_u32 v15, 0x10000, v11
v_add_u32 v16, 0x10000, v12
v_add_u32 v17, 0x10000, v13
ds_read_b64_tr_b16 v[220:221], v10 offset:0
ds_read_b64_tr_b16 v[222:223], v10 offset:512
ds_read_b64_tr_b16 v[224:225], v11 offset:0
ds_read_b64_tr_b16 v[226:227], v11 offset:512
ds_read_b64_tr_b16 v[228:229], v12 offset:0
ds_read_b64_tr_b16 v[230:231], v12 offset:512
ds_read_b64_tr_b16 v[232:233], v13 offset:0
ds_read_b64_tr_b16 v[234:235], v13 offset:512
ds_read_b64_tr_b16 v[236:237], v10 offset:4096
ds_read_b64_tr_b16 v[238:239], v10 offset:4608
ds_read_b64_tr_b16 v[240:241], v11 offset:4096
ds_read_b64_tr_b16 v[242:243], v11 offset:4608
ds_read_b64_tr_b16 v[244:245], v12 offset:4096
ds_read_b64_tr_b16 v[246:247], v12 offset:4608
ds_read_b64_tr_b16 v[248:249], v13 offset:4096
ds_read_b64_tr_b16 v[250:251], v13 offset:4608
s_lshl_b32 s48, s41, 3
s_lshl_b32 s49, s40, 1
s_add_u32 s48, s48, s49
s_lshl_b32 s48, s48, 15
s_add_u32 s48, s48, 4194304
v_add_u32 v38, s48, v18
v_add_u32 v39, 32768, v38
s_lshl_b32 s57, s75, 11
s_add_u32 s87, s87, 262144
v_lshlrev_b32 v60, 16, v20
v_and_b32 v61, 0xffff0000, v20
v_lshlrev_b32 v62, 16, v21
v_and_b32 v63, 0xffff0000, v21
v_lshlrev_b32 v64, 16, v22
v_and_b32 v65, 0xffff0000, v22
v_lshlrev_b32 v66, 16, v23
v_and_b32 v67, 0xffff0000, v23
v_lshlrev_b32 v68, 16, v24
v_and_b32 v69, 0xffff0000, v24
v_lshlrev_b32 v70, 16, v25
v_and_b32 v71, 0xffff0000, v25
v_lshlrev_b32 v72, 16, v26
v_and_b32 v73, 0xffff0000, v26
v_lshlrev_b32 v74, 16, v27
v_and_b32 v75, 0xffff0000, v27
v_lshlrev_b32 v76, 16, v28
v_and_b32 v77, 0xffff0000, v28
v_lshlrev_b32 v78, 16, v29
v_and_b32 v79, 0xffff0000, v29
v_lshlrev_b32 v80, 16, v30
v_and_b32 v81, 0xffff0000, v30
v_lshlrev_b32 v82, 16, v31
v_and_b32 v83, 0xffff0000, v31
v_lshlrev_b32 v84, 16, v32
v_and_b32 v85, 0xffff0000, v32
v_lshlrev_b32 v86, 16, v33
v_and_b32 v87, 0xffff0000, v33
v_lshlrev_b32 v88, 16, v34
v_and_b32 v89, 0xffff0000, v34
v_lshlrev_b32 v90, 16, v35
v_and_b32 v91, 0xffff0000, v35
v_mov_b32 v6, 0
v_mov_b32 v7, 0
v_mov_b32 v8, 0
v_mov_b32 v9, 0
s_lshl_b32 s62, s42, 2
v_mov_b32 v4, s62
v_mov_b32 v5, 3
buffer_load_dword v37, v36, s[32:35], s84 offen sc1
s_mov_b32 s63, 0
s_waitcnt vmcnt(0)
poll_116:
v_cmp_gt_u32 vcc, 3, v37
s_cbranch_vccz polled_117
buffer_load_dword v37, v36, s[32:35], s84 offen sc1
s_add_u32 s63, s63, 1
s_cmp_lt_u32 s63, 0x80000
s_waitcnt vmcnt(0)
s_cbranch_scc1 poll_116
polled_117:
s_call_b64 s[94:95], R_oloop
s_cmp_eq_u32 s46, 0
s_cbranch_scc1 slow_118
s_nop 0
v_cvt_pk_bf16_f32 v20, v60, v61
v_cvt_pk_bf16_f32 v21, v62, v63
v_cvt_pk_bf16_f32 v22, v64, v65
v_cvt_pk_bf16_f32 v23, v66, v67
buffer_store_dwordx4 v[20:23], v18, s[32:35], s85 offen offset:0
v_cvt_pk_bf16_f32 v24, v68, v69
v_cvt_pk_bf16_f32 v25, v70, v71
v_cvt_pk_bf16_f32 v26, v72, v73
v_cvt_pk_bf16_f32 v27, v74, v75
buffer_store_dwordx4 v[24:27], v18, s[32:35], s85 offen offset:1024
v_cvt_pk_bf16_f32 v28, v76, v77
v_cvt_pk_bf16_f32 v29, v78, v79
v_cvt_pk_bf16_f32 v30, v80, v81
v_cvt_pk_bf16_f32 v31, v82, v83
buffer_store_dwordx4 v[28:31], v18, s[32:35], s86 offen offset:0
v_cvt_pk_bf16_f32 v32, v84, v85
v_cvt_pk_bf16_f32 v33, v86, v87
v_cvt_pk_bf16_f32 v34, v88, v89
v_cvt_pk_bf16_f32 v35, v90, v91
buffer_store_dwordx4 v[32:35], v18, s[32:35], s86 offen offset:1024
s_barrier
v_dot2c_f32_bf16 v6, v20, v48
v_dot2c_f32_bf16 v8, v20, v20
v_dot2c_f32_bf16 v7, v28, v48
v_dot2c_f32_bf16 v9, v28, v28
v_dot2c_f32_bf16 v6, v21, v48
v_dot2c_f32_bf16 v8, v21, v21
v_dot2c_f32_bf16 v7, v29, v48
v_dot2c_f32_bf16 v9, v29, v29
v_dot2c_f32_bf16 v6, v22, v48
v_dot2c_f32_bf16 v8, v22, v22
v_dot2c_f32_bf16 v7, v30, v48
v_dot2c_f32_bf16 v9, v30, v30
v_dot2c_f32_bf16 v6, v23, v48
v_dot2c_f32_bf16 v8, v23, v23
v_dot2c_f32_bf16 v7, v31, v48
v_dot2c_f32_bf16 v9, v31, v31
v_dot2c_f32_bf16 v6, v24, v48
v_dot2c_f32_bf16 v8, v24, v24
v_dot2c_f32_bf16 v7, v32, v48
v_dot2c_f32_bf16 v9, v32, v32
v_dot2c_f32_bf16 v6, v25, v48
v_dot2c_f32_bf16 v8, v25, v25
v_dot2c_f32_bf16 v7, v33, v48
v_dot2c_f32_bf16 v9, v33, v33
v_dot2c_f32_bf16 v6, v26, v48
v_dot2c_f32_bf16 v8, v26, v26
v_dot2c_f32_bf16 v7, v34, v48
v_dot2c_f32_bf16 v9, v34, v34
v_dot2c_f32_bf16 v6, v27, v48
v_dot2c_f32_bf16 v8, v27, v27
v_dot2c_f32_bf16 v7, v35, v48
v_dot2c_f32_bf16 v9, v35, v35
s_mov_b64 exec, 1
s_waitcnt vmcnt(0)
buffer_store_dword v5, v4, s[32:35], s88 offen
s_mov_b64 exec, -1
s_nop 1
v_permlane32_swap_b32 v6, v7
v_permlane32_swap_b32 v8, v9
v_add_f32 v6, v6, v7
v_add_f32 v8, v8, v9
s_nop 1
v_permlane16_swap_b32 v6, v8
s_nop 0
v_add_f32 v6, v6, v8
buffer_store_dword v6, v1, s[32:35], s87 offen
back_119:
s_lshl_b32 s49, s44, 13
v_add_u32 v10, s49, v18
v_add_u32 v11, 1024, v10
s_lshl_b32 s48, s43, 1
v_lshrrev_b32 v4, 2, v2
v_and_b32 v5, 3, v0
v_lshl_add_u32 v6, v3, 3, v4
v_lshlrev_b32 v6, 7, v6
v_lshl_add_u32 v6, v5, 3, v6
v_lshrrev_b32 v7, 1, v4
v_and_b32 v8, 1, v3
v_lshl_add_u32 v7, v8, 1, v7
v_xor_b32 v7, s48, v7
v_lshl_add_u32 v12, v7, 5, v6
v_add_u32 v12, 16384, v12
v_xor_b32 v13, 32, v12
v_mov_b32 v14, v10
v_mov_b32 v15, v11
v_add_u32 v16, 122880, v12
v_add_u32 v17, 122880, v13
v_mov_b32 v156, 0
v_mov_b32 v157, 0
v_mov_b32 v158, 0
v_mov_b32 v159, 0
v_mov_b32 v160, 0
v_mov_b32 v161, 0
v_mov_b32 v162, 0
v_mov_b32 v163, 0
v_mov_b32 v164, 0
v_mov_b32 v165, 0
v_mov_b32 v166, 0
v_mov_b32 v167, 0
v_mov_b32 v168, 0
v_mov_b32 v169, 0
v_mov_b32 v170, 0
v_mov_b32 v171, 0
v_mov_b32 v172, 0
v_mov_b32 v173, 0
v_mov_b32 v174, 0
v_mov_b32 v175, 0
v_mov_b32 v176, 0
v_mov_b32 v177, 0
v_mov_b32 v178, 0
v_mov_b32 v179, 0
v_mov_b32 v180, 0
v_mov_b32 v181, 0
v_mov_b32 v182, 0
v_mov_b32 v183, 0
v_mov_b32 v184, 0
v_mov_b32 v185, 0
v_mov_b32 v186, 0
v_mov_b32 v187, 0
v_mov_b32 v188, 0
v_mov_b32 v189, 0
v_mov_b32 v190, 0
v_mov_b32 v191, 0
v_mov_b32 v192, 0
v_mov_b32 v193, 0
v_mov_b32 v194, 0
v_mov_b32 v195, 0
v_mov_b32 v196, 0
v_mov_b32 v197, 0
v_mov_b32 v198, 0
v_mov_b32 v199, 0
v_mov_b32 v200, 0
v_mov_b32 v201, 0
v_mov_b32 v202, 0
v_mov_b32 v203, 0
v_mov_b32 v204, 0
v_mov_b32 v205, 0
v_mov_b32 v206, 0
v_mov_b32 v207, 0
v_mov_b32 v208, 0
v_mov_b32 v209, 0
v_mov_b32 v210, 0
v_mov_b32 v211, 0
v_mov_b32 v212, 0
v_mov_b32 v213, 0
v_mov_b32 v214, 0
v_mov_b32 v215, 0
v_mov_b32 v216, 0
v_mov_b32 v217, 0
v_mov_b32 v218, 0
v_mov_b32 v219, 0
v_mov_b32 v220, 0
v_mov_b32 v221, 0
v_mov_b32 v222, 0
v_mov_b32 v223, 0
v_mov_b32 v224, 0
v_mov_b32 v225, 0
v_mov_b32 v226, 0
v_mov_b32 v227, 0
v_mov_b32 v228, 0
v_mov_b32 v229, 0
v_mov_b32 v230, 0
v_mov_b32 v231, 0
v_mov_b32 v232, 0
v_mov_b32 v233, 0
v_mov_b32 v234, 0
v_mov_b32 v235, 0
v_mov_b32 v236, 0
v_mov_b32 v237, 0
v_mov_b32 v238, 0
v_mov_b32 v239, 0
v_mov_b32 v240, 0
v_mov_b32 v241, 0
v_mov_b32 v242, 0
v_mov_b32 v243, 0
v_mov_b32 v244, 0
v_mov_b32 v245, 0
v_mov_b32 v246, 0
v_mov_b32 v247, 0
v_mov_b32 v248, 0
v_mov_b32 v249, 0
v_mov_b32 v250, 0
v_mov_b32 v251, 0
v_lshrrev_b32 v6, 2, v2
v_cmp_eq_u32 vcc, v6, v3
v_and_b32 v7, 1, v0
v_lshlrev_b32 v7, 4, v7
v_mov_b32 v8, 0x3f80
v_lshlrev_b32 v9, v7, v8
v_cndmask_b32 v7, 0, v9, vcc
v_and_b32 v6, 2, v0
v_cmp_eq_u32 vcc, 0, v6
v_mov_b32 v36, 0
v_mov_b32 v37, 0
v_mov_b32 v40, 0
v_mov_b32 v41, 0
v_cndmask_b32 v38, 0, v7, vcc
v_cndmask_b32 v39, v7, 0, vcc
v_lshrrev_b32 v8, 1, v2
v_cmp_eq_u32 vcc, 0, v8
s_nop 1
v_cndmask_b32 v44, 0, v9, vcc
v_cmp_eq_u32 vcc, 1, v8
s_nop 1
v_cndmask_b32 v45, 0, v9, vcc
v_cmp_eq_u32 vcc, 2, v8
s_nop 1
v_cndmask_b32 v46, 0, v9, vcc
v_cmp_eq_u32 vcc, 3, v8
s_nop 1
v_cndmask_b32 v47, 0, v9, vcc
v_lshrrev_b32 v4, 2, v2
v_lshl_add_u32 v4, v3, 2, v4
v_lshlrev_b32 v4, 6, v4
v_and_b32 v5, 3, v0
v_lshl_add_u32 v4, v5, 3, v4
s_lshl_b32 s48, s43, 11
s_add_u32 s48, s48, 135168
v_add_u32 v53, s48, v4
s_mul_i32 s48, s40, 3072
s_add_u32 s48, s48, 139264
v_add_u32 v42, s48, v18
s_xor_b32 s49, s40, 2
s_mul_i32 s48, s49, 3072
s_add_u32 s48, s48, 139264
v_add_u32 v43, s48, v18
s_lshl_b32 s49, s49, 2
s_add_u32 s49, s49, 134672
v_mov_b32 v19, s49
v_xor_b32 v52, 8, v19
v_lshrrev_b32 v4, 3, v0
v_and_b32 v5, 7, v0
v_lshlrev_b32 v4, 11, v4
v_lshl_add_u32 v55, v5, 4, v4
v_lshlrev_b32 v4, 6, v2
v_lshl_add_u32 v58, v3, 4, v4
v_lshlrev_b32 v4, 4, v2
v_lshl_add_u32 v59, v3, 3, v4
s_mul_i32 s51, s42, 163840
s_add_u32 s51, s51, 9437184
s_lshl_b32 s50, s43, 1
s_add_u32 s50, s50, s44
s_lshl_b32 s48, s50, 15
s_add_u32 s48, s48, s51
s_add_u32 s48, s48, 0
s_lshl_b32 s49, s41, 7
s_add_u32 s53, s48, s49
s_add_u32 s54, s53, 16384
s_lshl_b32 s56, s50, 10
s_add_u32 s56, s56, s51
s_add_u32 s56, s56, 151552
s_xor_b32 s57, s56, 1024
s_lshl_b32 s58, s50, 11
s_add_u32 s58, s58, s51
s_add_u32 s58, s58, 139264
s_xor_b32 s59, s58, 2048
s_add_u32 s79, s58, s49
s_lshl_b32 s50, s41, 11
s_add_u32 s55, s48, s50
s_lshl_b32 s48, s43, 7
s_add_u32 s48, s48, 133888
v_lshl_add_u32 v7, v3, 4, s48
v_lshl_add_u32 v54, v2, 2, s48
s_lshl_b32 s49, s44, 6
v_add_u32 v8, s49, v2
v_lshlrev_b32 v8, 3, v8
v_add_u32 v8, 131072, v8
v_lshl_add_u32 v9, v3, 2, s49
v_lshlrev_b32 v9, 2, v9
v_add_u32 v9, 132096, v9
s_mov_b32 s64, 0
s_mov_b32 s65, 0
s_mov_b32 s66, 0x3fb8aa3b
s_mov_b32 s61, 4
ds_read_b64_tr_b16 v[84:85], v16 offset:8192
ds_read_b64_tr_b16 v[86:87], v16 offset:8704
ds_read_b64_tr_b16 v[88:89], v17 offset:8192
ds_read_b64_tr_b16 v[90:91], v17 offset:8704
ds_read_b64_tr_b16 v[92:93], v16 offset:16384
ds_read_b64_tr_b16 v[94:95], v16 offset:16896
ds_read_b64_tr_b16 v[96:97], v17 offset:16384
ds_read_b64_tr_b16 v[98:99], v17 offset:16896
ds_read_b64_tr_b16 v[76:77], v16 offset:0
ds_read_b64_tr_b16 v[78:79], v16 offset:512
ds_read_b64_tr_b16 v[80:81], v17 offset:0
ds_read_b64_tr_b16 v[82:83], v17 offset:512
s_barrier
ds_read_b128 v[60:63], v14 offset:0
ds_read_b128 v[64:67], v14 offset:2048
ds_read_b128 v[68:71], v14 offset:4096
ds_read_b128 v[72:75], v14 offset:6144
s_waitcnt lgkmcnt(0)
c3_loop:
v_mfma_f32_16x16x32_bf16 v[212:215], v[84:87], v[72:75], v[212:215]
ds_read_b128 v[100:103], v15 offset:0
v_mfma_f32_16x16x32_bf16 v[204:207], v[84:87], v[68:71], v[204:207]
ds_read_b128 v[104:107], v15 offset:2048
v_mfma_f32_16x16x32_bf16 v[196:199], v[84:87], v[64:67], v[196:199]
ds_read_b128 v[108:111], v15 offset:4096
v_mfma_f32_16x16x32_bf16 v[188:191], v[84:87], v[60:63], v[188:191]
ds_read_b128 v[112:115], v15 offset:6144
v_mfma_f32_16x16x32_bf16 v[192:195], v[88:91], v[60:63], v[192:195]
ds_read_b64_tr_b16 v[124:125], v16 offset:12288
v_mfma_f32_16x16x32_bf16 v[200:203], v[88:91], v[64:67], v[200:203]
ds_read_b64_tr_b16 v[126:127], v16 offset:12800
v_mfma_f32_16x16x32_bf16 v[208:211], v[88:91], v[68:71], v[208:211]
ds_read_b64_tr_b16 v[128:129], v17 offset:12288
v_mfma_f32_16x16x32_bf16 v[216:219], v[88:91], v[72:75], v[216:219]
ds_read_b64_tr_b16 v[130:131], v17 offset:12800
v_mfma_f32_16x16x32_bf16 v[244:247], v[72:75], v[92:95], v[244:247]
ds_read_b64_tr_b16 v[132:133], v16 offset:20480
v_mfma_f32_16x16x32_bf16 v[248:251], v[72:75], v[96:99], v[248:251]
ds_read_b64_tr_b16 v[134:135], v16 offset:20992
v_mfma_f32_16x16x32_bf16 v[240:243], v[68:71], v[96:99], v[240:243]
ds_read_b64_tr_b16 v[136:137], v17 offset:20480
v_mfma_f32_16x16x32_bf16 v[236:239], v[68:71], v[92:95], v[236:239]
ds_read_b64_tr_b16 v[138:139], v17 offset:20992
v_mfma_f32_16x16x32_bf16 v[228:231], v[64:67], v[92:95], v[228:231]
ds_read_b64_tr_b16 v[116:117], v16 offset:4096
v_mfma_f32_16x16x32_bf16 v[232:235], v[64:67], v[96:99], v[232:235]
ds_read_b64_tr_b16 v[118:119], v16 offset:4608
v_mfma_f32_16x16x32_bf16 v[224:227], v[60:63], v[96:99], v[224:227]
ds_read_b64_tr_b16 v[120:121], v17 offset:4096
v_mfma_f32_16x16x32_bf16 v[220:223], v[60:63], v[92:95], v[220:223]
ds_read_b64_tr_b16 v[122:123], v17 offset:4608
v_mfma_f32_16x16x32_bf16 v[156:159], v[76:79], v[60:63], v[156:159]
s_add_u32 s65, s65, 40960
s_cmp_eq_u32 s65, 122880
v_mfma_f32_16x16x32_bf16 v[164:167], v[76:79], v[64:67], v[164:167]
s_cselect_b32 s65, 0, s65
s_add_u32 s64, s64, 1
v_mfma_f32_16x16x32_bf16 v[172:175], v[76:79], v[68:71], v[172:175]
v_add_u32 v14, s65, v10
v_add_u32 v15, s65, v11
v_mfma_f32_16x16x32_bf16 v[180:183], v[76:79], v[72:75], v[180:183]
v_add_u32 v16, s65, v12
v_add_u32 v17, s65, v13
v_mfma_f32_16x16x32_bf16 v[184:187], v[80:83], v[72:75], v[184:187]
v_mfma_f32_16x16x32_bf16 v[176:179], v[80:83], v[68:71], v[176:179]
s_cmp_eq_u32 s64, 16
s_cbranch_scc1 c3_last
v_mfma_f32_16x16x32_bf16 v[168:171], v[80:83], v[64:67], v[168:171]
s_waitcnt lgkmcnt(0)
v_mfma_f32_16x16x32_bf16 v[160:163], v[80:83], v[60:63], v[160:163]
s_barrier
v_mfma_f32_16x16x32_bf16 v[212:215], v[124:127], v[112:115], v[212:215]
ds_read_b128 v[60:63], v14 offset:0
v_mfma_f32_16x16x32_bf16 v[204:207], v[124:127], v[108:111], v[204:207]
ds_read_b128 v[64:67], v14 offset:2048
v_mfma_f32_16x16x32_bf16 v[196:199], v[124:127], v[104:107], v[196:199]
ds_read_b128 v[68:71], v14 offset:4096
v_mfma_f32_16x16x32_bf16 v[188:191], v[124:127], v[100:103], v[188:191]
ds_read_b128 v[72:75], v14 offset:6144
v_mfma_f32_16x16x32_bf16 v[192:195], v[128:131], v[100:103], v[192:195]
ds_read_b64_tr_b16 v[84:85], v16 offset:8192
v_mfma_f32_16x16x32_bf16 v[200:203], v[128:131], v[104:107], v[200:203]
ds_read_b64_tr_b16 v[86:87], v16 offset:8704
v_mfma_f32_16x16x32_bf16 v[208:211], v[128:131], v[108:111], v[208:211]
ds_read_b64_tr_b16 v[88:89], v17 offset:8192
v_mfma_f32_16x16x32_bf16 v[216:219], v[128:131], v[112:115], v[216:219]
ds_read_b64_tr_b16 v[90:91], v17 offset:8704
v_mfma_f32_16x16x32_bf16 v[244:247], v[112:115], v[132:135], v[244:247]
ds_read_b64_tr_b16 v[92:93], v16 offset:16384
v_mfma_f32_16x16x32_bf16 v[248:251], v[112:115], v[136:139], v[248:251]
ds_read_b64_tr_b16 v[94:95], v16 offset:16896
v_mfma_f32_16x16x32_bf16 v[240:243], v[108:111], v[136:139], v[240:243]
ds_read_b64_tr_b16 v[96:97], v17 offset:16384
v_mfma_f32_16x16x32_bf16 v[236:239], v[108:111], v[132:135], v[236:239]
ds_read_b64_tr_b16 v[98:99], v17 offset:16896
v_mfma_f32_16x16x32_bf16 v[228:231], v[104:107], v[132:135], v[228:231]
ds_read_b64_tr_b16 v[76:77], v16 offset:0
v_mfma_f32_16x16x32_bf16 v[232:235], v[104:107], v[136:139], v[232:235]
ds_read_b64_tr_b16 v[78:79], v16 offset:512
v_mfma_f32_16x16x32_bf16 v[224:227], v[100:103], v[136:139], v[224:227]
ds_read_b64_tr_b16 v[80:81], v17 offset:0
v_mfma_f32_16x16x32_bf16 v[220:223], v[100:103], v[132:135], v[220:223]
ds_read_b64_tr_b16 v[82:83], v17 offset:512
v_mfma_f32_16x16x32_bf16 v[156:159], v[116:119], v[100:103], v[156:159]
v_mfma_f32_16x16x32_bf16 v[164:167], v[116:119], v[104:107], v[164:167]
v_mfma_f32_16x16x32_bf16 v[172:175], v[116:119], v[108:111], v[172:175]
v_mfma_f32_16x16x32_bf16 v[180:183], v[116:119], v[112:115], v[180:183]
v_mfma_f32_16x16x32_bf16 v[184:187], v[120:123], v[112:115], v[184:187]
v_mfma_f32_16x16x32_bf16 v[176:179], v[120:123], v[108:111], v[176:179]
v_mfma_f32_16x16x32_bf16 v[168:171], v[120:123], v[104:107], v[168:171]
s_waitcnt lgkmcnt(0)
v_mfma_f32_16x16x32_bf16 v[160:163], v[120:123], v[100:103], v[160:163]
s_branch c3_loop
c3_last:
v_mfma_f32_16x16x32_bf16 v[168:171], v[80:83], v[64:67], v[168:171]
s_waitcnt lgkmcnt(0)
v_mfma_f32_16x16x32_bf16 v[160:163], v[80:83], v[60:63], v[160:163]
v_mfma_f32_16x16x32_bf16 v[212:215], v[124:127], v[112:115], v[212:215]
ds_read_b64_tr_b16 v[10:11], v53 offset:0
ds_read_b64_tr_b16 v[12:13], v53 offset:1024
v_mfma_f32_16x16x32_bf16 v[204:207], v[124:127], v[108:111], v[204:207]
ds_read_b64_tr_b16 v[14:15], v53 offset:32
ds_read_b64_tr_b16 v[16:17], v53 offset:1056
v_mfma_f32_16x16x32_bf16 v[196:199], v[124:127], v[104:107], v[196:199]
ds_read_b128 v[140:143], v7 offset:0
s_mul_i32 s48, s44, 0x80008000
v_mfma_f32_16x16x32_bf16 v[188:191], v[124:127], v[100:103], v[188:191]
ds_read_b128 v[144:147], v7 offset:64
v_mfma_f32_16x16x32_bf16 v[192:195], v[128:131], v[100:103], v[192:195]
ds_read_b128 v[148:151], v7 offset:256
v_mfma_f32_16x16x32_bf16 v[200:203], v[128:131], v[104:107], v[200:203]
ds_read_b128 v[152:155], v7 offset:320
v_mfma_f32_16x16x32_bf16 v[208:211], v[128:131], v[108:111], v[208:211]
ds_read2_b32 v[56:57], v54 offset0:128 offset1:144
s_waitcnt lgkmcnt(5)
v_mfma_f32_16x16x32_bf16 v[216:219], v[128:131], v[112:115], v[216:219]
s_barrier
v_mfma_f32_16x16x32_bf16 v[244:247], v[112:115], v[132:135], v[244:247]
ds_read_b64 v[92:93], v8 offset:0
v_xor_b32 v10, s48, v10
v_mfma_f32_16x16x32_bf16 v[248:251], v[112:115], v[136:139], v[248:251]
ds_read_b64 v[94:95], v8 offset:128
v_xor_b32 v11, s48, v11
v_mfma_f32_16x16x32_bf16 v[240:243], v[108:111], v[136:139], v[240:243]
ds_read_b64 v[96:97], v8 offset:256
v_xor_b32 v12, s48, v12
v_mfma_f32_16x16x32_bf16 v[236:239], v[108:111], v[132:135], v[236:239]
ds_read_b64 v[98:99], v8 offset:384
v_xor_b32 v13, s48, v13
v_mfma_f32_16x16x32_bf16 v[228:231], v[104:107], v[132:135], v[228:231]
ds_read_b128 v[60:63], v9 offset:0
v_xor_b32 v14, s48, v14
v_mfma_f32_16x16x32_bf16 v[232:235], v[104:107], v[136:139], v[232:235]
ds_read_b128 v[64:67], v9 offset:64
v_xor_b32 v15, s48, v15
v_mfma_f32_16x16x32_bf16 v[224:227], v[100:103], v[136:139], v[224:227]
ds_read_b128 v[68:71], v9 offset:128
v_xor_b32 v16, s48, v16
v_mfma_f32_16x16x32_bf16 v[220:223], v[100:103], v[132:135], v[220:223]
ds_read_b128 v[72:75], v9 offset:192
v_xor_b32 v17, s48, v17
v_mfma_f32_16x16x32_bf16 v[156:159], v[116:119], v[100:103], v[156:159]
ds_read_b128 v[76:79], v9 offset:512
v_mfma_f32_16x16x32_bf16 v[164:167], v[116:119], v[104:107], v[164:167]
ds_read_b128 v[80:83], v9 offset:576
v_mfma_f32_16x16x32_bf16 v[172:175], v[116:119], v[108:111], v[172:175]
ds_read_b128 v[84:87], v9 offset:640
v_mfma_f32_16x16x32_bf16 v[180:183], v[116:119], v[112:115], v[180:183]
ds_read_b128 v[88:91], v9 offset:704
v_mfma_f32_16x16x32_bf16 v[184:187], v[120:123], v[112:115], v[184:187]
v_mfma_f32_16x16x32_bf16 v[176:179], v[120:123], v[108:111], v[176:179]
v_mfma_f32_16x16x32_bf16 v[168:171], v[120:123], v[104:107], v[168:171]
v_mfma_f32_16x16x32_bf16 v[160:163], v[120:123], v[100:103], v[160:163]
c3_epi:
s_waitcnt lgkmcnt(0)
.p2align 3
v_mul_f32 v129, s66, v94
v_mul_f32 v128, s66, v92
v_mul_f32 v131, s66, v98
v_mul_f32 v130, s66, v96
v_pk_fma_f32 v[190:191], v[150:151], v[92:93], v[190:191] op_sel:[0,1,0] op_sel_hi:[1,1,1]
v_pk_fma_f32 v[212:213], v[148:149], v[98:99], v[212:213] op_sel:[0,1,0] op_sel_hi:[1,1,1]
v_pk_fma_f32 v[214:215], v[150:151], v[98:99], v[214:215] op_sel:[0,1,0] op_sel_hi:[1,1,1]
v_pk_fma_f32 v[188:189], v[148:149], v[92:93], v[188:189] op_sel:[0,1,0] op_sel_hi:[1,1,1]
v_pk_fma_f32 v[218:219], v[154:155], v[98:99], v[218:219] op_sel:[0,1,0] op_sel_hi:[1,1,1]
v_cvt_pk_bf16_f32 v188, v188, v189
v_cvt_pk_bf16_f32 v189, v190, v191
v_pk_fma_f32 v[196:197], v[148:149], v[94:95], v[196:197] op_sel:[0,1,0] op_sel_hi:[1,1,1]
v_pk_fma_f32 v[200:201], v[152:153], v[94:95], v[200:201] op_sel:[0,1,0] op_sel_hi:[1,1,1]
v_pk_fma_f32 v[210:211], v[154:155], v[96:97], v[210:211] op_sel:[0,1,0] op_sel_hi:[1,1,1]
v_pk_fma_f32 v[240:241], v[84:85], v[56:57], v[240:241] op_sel:[0,1,0] op_sel_hi:[1,1,1]
v_pk_fma_f32 v[228:229], v[80:81], v[56:57], v[228:229] op_sel:[0,0,0] op_sel_hi:[1,0,1]
v_pk_fma_f32 v[226:227], v[78:79], v[56:57], v[226:227] op_sel:[0,1,0] op_sel_hi:[1,1,1]
v_pk_fma_f32 v[192:193], v[152:153], v[92:93], v[192:193] op_sel:[0,1,0] op_sel_hi:[1,1,1]
v_cvt_pk_bf16_f32 v190, v192, v193
v_pk_fma_f32 v[238:239], v[86:87], v[56:57], v[238:239] op_sel:[0,0,0] op_sel_hi:[1,0,1]
v_pk_fma_f32 v[234:235], v[82:83], v[56:57], v[234:235] op_sel:[0,1,0] op_sel_hi:[1,1,1]
v_pk_mul_f32 v[226:227], v[226:227], v[62:63]
v_pk_fma_f32 v[204:205], v[148:149], v[96:97], v[204:205] op_sel:[0,1,0] op_sel_hi:[1,1,1]
v_cvt_pk_bf16_f32 v204, v204, v205
v_pk_fma_f32 v[202:203], v[154:155], v[94:95], v[202:203] op_sel:[0,1,0] op_sel_hi:[1,1,1]
v_pk_fma_f32 v[224:225], v[76:77], v[56:57], v[224:225] op_sel:[0,1,0] op_sel_hi:[1,1,1]
v_pk_fma_f32 v[216:217], v[152:153], v[98:99], v[216:217] op_sel:[0,1,0] op_sel_hi:[1,1,1]
v_pk_fma_f32 v[244:245], v[88:89], v[56:57], v[244:245] op_sel:[0,0,0] op_sel_hi:[1,0,1]
v_pk_mul_f32 v[238:239], v[238:239], v[70:71]
v_pk_mul_f32 v[228:229], v[228:229], v[64:65]
v_pk_fma_f32 v[236:237], v[84:85], v[56:57], v[236:237] op_sel:[0,0,0] op_sel_hi:[1,0,1]
v_pk_fma_f32 v[220:221], v[76:77], v[56:57], v[220:221] op_sel:[0,0,0] op_sel_hi:[1,0,1]
v_pk_mul_f32 v[224:225], v[224:225], v[60:61]
v_cvt_pk_bf16_f32 v212, v212, v213
v_cvt_pk_bf16_f32 v213, v214, v215
v_cvt_pk_bf16_f32 v196, v196, v197
v_pk_mul_f32 v[240:241], v[240:241], v[68:69]
v_pk_fma_f32 v[198:199], v[150:151], v[94:95], v[198:199] op_sel:[0,1,0] op_sel_hi:[1,1,1]
v_cvt_pk_bf16_f32 v197, v198, v199
v_cvt_pk_bf16_f32 v198, v200, v201
v_cvt_pk_bf16_f32 v199, v202, v203
v_cvt_pk_bf16_f32 v215, v218, v219
v_pk_fma_f32 v[208:209], v[152:153], v[96:97], v[208:209] op_sel:[0,1,0] op_sel_hi:[1,1,1]
v_pk_fma_f32 v[246:247], v[90:91], v[56:57], v[246:247] op_sel:[0,0,0] op_sel_hi:[1,0,1]
v_pk_fma_f32 v[250:251], v[90:91], v[56:57], v[250:251] op_sel:[0,1,0] op_sel_hi:[1,1,1]
v_pk_mul_f32 v[250:251], v[250:251], v[74:75]
v_pk_fma_f32 v[206:207], v[150:151], v[96:97], v[206:207] op_sel:[0,1,0] op_sel_hi:[1,1,1]
v_cvt_pk_bf16_f32 v205, v206, v207
v_pk_fma_f32 v[242:243], v[86:87], v[56:57], v[242:243] op_sel:[0,1,0] op_sel_hi:[1,1,1]
v_cvt_pk_bf16_f32 v207, v210, v211
v_pk_mul_f32 v[236:237], v[236:237], v[68:69]
v_pk_fma_f32 v[230:231], v[82:83], v[56:57], v[230:231] op_sel:[0,0,0] op_sel_hi:[1,0,1]
v_pk_fma_f32 v[194:195], v[154:155], v[92:93], v[194:195] op_sel:[0,1,0] op_sel_hi:[1,1,1]
v_cvt_pk_bf16_f32 v191, v194, v195
v_pk_fma_f32 v[232:233], v[80:81], v[56:57], v[232:233] op_sel:[0,1,0] op_sel_hi:[1,1,1]
v_pk_mul_f32 v[232:233], v[232:233], v[64:65]
v_pk_mul_f32 v[230:231], v[230:231], v[66:67]
v_pk_fma_f32 v[248:249], v[88:89], v[56:57], v[248:249] op_sel:[0,1,0] op_sel_hi:[1,1,1]
v_pk_mul_f32 v[248:249], v[248:249], v[72:73]
v_pk_mul_f32 v[242:243], v[242:243], v[70:71]
v_mfma_f32_16x16x32_bf16 v[68:71], v[10:13], v[196:199], 0
v_cvt_pk_bf16_f32 v206, v208, v209
v_cvt_pk_bf16_f32 v214, v216, v217
v_cvt_pk_bf16_f32 v121, v226, v227
v_mfma_f32_16x16x32_bf16 v[80:83], v[14:17], v[204:207], 0
v_cvt_pk_bf16_f32 v120, v224, v225
v_cvt_pk_bf16_f32 v114, v228, v229
v_mfma_f32_16x16x32_bf16 v[84:87], v[10:13], v[212:215], 0
v_cvt_pk_bf16_f32 v116, v236, v237
v_min3_f32 v105, v68, v69, v70
v_mfma_f32_16x16x32_bf16 v[88:91], v[14:17], v[212:215], 0
v_max3_f32 v101, v68, v69, v70
v_cvt_pk_bf16_f32 v115, v230, v231
v_cvt_pk_bf16_f32 v122, v232, v233
v_cvt_pk_bf16_f32 v127, v250, v251
v_cvt_pk_bf16_f32 v124, v240, v241
v_pk_mul_f32 v[244:245], v[244:245], v[72:73]
v_pk_fma_f32 v[222:223], v[78:79], v[56:57], v[222:223] op_sel:[0,0,0] op_sel_hi:[1,0,1]
v_pk_mul_f32 v[222:223], v[222:223], v[62:63]
v_mfma_f32_16x16x32_bf16 v[76:79], v[10:13], v[204:207], 0
v_min3_f32 v107, v84, v85, v86
v_min3_f32 v107, v107, v87, v88
v_min3_f32 v107, v107, v89, v90
v_min_f32_e64 v107, v107, v91
v_max3_f32 v103, v84, v85, v86
v_pk_mul_f32 v[220:221], v[220:221], v[60:61]
v_mfma_f32_16x16x32_bf16 v[60:63], v[10:13], v[188:191], 0
v_max3_f32 v103, v103, v87, v88
v_min3_f32 v106, v76, v77, v78
v_min3_f32 v106, v106, v79, v80
v_min3_f32 v106, v106, v81, v82
v_min_f32 v106, v106, v83
v_pk_mul_f32 v[234:235], v[234:235], v[66:67]
v_mfma_f32_16x16x32_bf16 v[64:67], v[14:17], v[188:191], 0
v_permlane32_swap_b32 v106, v107
v_min3_f32 v104, v60, v61, v62
v_min_f32 v106, v106, v107
v_max3_f32 v103, v103, v89, v90
v_pk_mul_f32 v[246:247], v[246:247], v[74:75]
v_mfma_f32_16x16x32_bf16 v[72:75], v[14:17], v[196:199], 0
v_max_f32 v103, v103, v91
v_max3_f32 v102, v76, v77, v78
v_min3_f32 v104, v104, v63, v64
v_min3_f32 v104, v104, v65, v66
v_min_f32 v104, v104, v67
v_max3_f32 v102, v102, v79, v80
v_max3_f32 v102, v102, v81, v82
v_max_f32 v102, v102, v83
v_min3_f32 v105, v105, v71, v72
v_min3_f32 v105, v105, v73, v74
v_min_f32 v105, v105, v75
v_max3_f32 v101, v101, v71, v72
v_max3_f32 v101, v101, v73, v74
v_permlane32_swap_b32 v104, v105
v_permlane32_swap_b32 v102, v103
v_min_f32 v104, v104, v105
v_max_f32 v102, v102, v103
v_max_f32 v101, v101, v75
v_permlane16_swap_b32 v104, v106
v_max3_f32 v100, v60, v61, v62
v_min_f32 v104, v104, v106
v_mov_b32 v106, v104
v_max3_f32 v100, v100, v63, v64
v_max3_f32 v100, v100, v65, v66
v_max_f32 v100, v100, v67
v_permlane16_swap_b32 v104, v106
v_cvt_pk_bf16_f32 v112, v220, v221
v_permlane32_swap_b32 v100, v101
v_mov_b32 v105, v104
v_max_f32 v100, v100, v101
v_mov_b32 v107, v106
v_permlane32_swap_b32 v104, v105
v_permlane16_swap_b32 v100, v102
v_pk_mul_f32 v[104:105], v[104:105], v[128:129]
v_pk_fma_f32 v[226:227], v[66:67], v[128:129], v[104:105] op_sel:[0,0,0] op_sel_hi:[1,0,0] neg_lo:[1,0,0] neg_hi:[1,0,0]
v_pk_fma_f32 v[230:231], v[70:71], v[128:129], v[104:105] op_sel:[0,1,1] op_sel_hi:[1,1,1] neg_lo:[1,0,0] neg_hi:[1,0,0]
v_exp_f32 v226, v226
v_pk_fma_f32 v[224:225], v[64:65], v[128:129], v[104:105] op_sel:[0,0,0] op_sel_hi:[1,0,0] neg_lo:[1,0,0] neg_hi:[1,0,0]
v_exp_f32 v224, v224
v_pk_fma_f32 v[228:229], v[68:69], v[128:129], v[104:105] op_sel:[0,1,1] op_sel_hi:[1,1,1] neg_lo:[1,0,0] neg_hi:[1,0,0]
v_exp_f32 v231, v231
v_cvt_pk_bf16_f32 v113, v222, v223
v_pk_fma_f32 v[222:223], v[62:63], v[128:129], v[104:105] op_sel:[0,0,0] op_sel_hi:[1,0,0] neg_lo:[1,0,0] neg_hi:[1,0,0]
v_exp_f32 v222, v222
v_pk_fma_f32 v[220:221], v[60:61], v[128:129], v[104:105] op_sel:[0,0,0] op_sel_hi:[1,0,0] neg_lo:[1,0,0] neg_hi:[1,0,0]
v_exp_f32 v221, v221
v_exp_f32 v220, v220
v_max_f32 v100, v100, v102
v_exp_f32 v223, v223
v_mov_b32 v102, v100
v_pk_add_f32 v[110:111], v[220:221], v[222:223]
v_exp_f32 v225, v225
v_pk_fma_f32 v[232:233], v[72:73], v[128:129], v[104:105] op_sel:[0,1,1] op_sel_hi:[1,1,1] neg_lo:[1,0,0] neg_hi:[1,0,0]
v_exp_f32 v232, v232
v_exp_f32 v233, v233
v_pk_add_f32 v[110:111], v[110:111], v[224:225]
v_exp_f32 v229, v229
v_exp_f32 v228, v228
v_exp_f32 v227, v227
v_cvt_pk_bf16_f32 v123, v234, v235
v_pk_fma_f32 v[234:235], v[74:75], v[128:129], v[104:105] op_sel:[0,1,1] op_sel_hi:[1,1,1] neg_lo:[1,0,0] neg_hi:[1,0,0]
v_pk_add_f32 v[110:111], v[110:111], v[226:227]
v_add_f32 v104, v110, v111
v_cvt_pk_bf16_f32 v118, v244, v245
v_permlane32_swap_b32 v106, v107
v_permlane16_swap_b32 v100, v102
v_exp_f32 v234, v234
v_mov_b32 v101, v100
v_exp_f32 v235, v235
v_exp_f32_e64 v230, v230
v_cvt_pk_bf16_f32 v125, v242, v243
v_pk_add_f32 v[110:111], v[228:229], v[230:231]
v_pk_add_f32 v[110:111], v[110:111], v[232:233]
v_pk_add_f32 v[110:111], v[110:111], v[234:235]
v_cvt_pk_bf16_f32 v126, v248, v249
v_pk_mul_f32 v[106:107], v[106:107], v[130:131]
v_pk_fma_f32 v[236:237], v[76:77], v[130:131], v[106:107] op_sel:[0,0,0] op_sel_hi:[1,0,0] neg_lo:[1,0,0] neg_hi:[1,0,0]
v_exp_f32 v237, v237
v_exp_f32 v236, v236
v_pk_fma_f32 v[242:243], v[82:83], v[130:131], v[106:107] op_sel:[0,0,0] op_sel_hi:[1,0,0] neg_lo:[1,0,0] neg_hi:[1,0,0]
v_pk_fma_f32 v[250:251], v[90:91], v[130:131], v[106:107] op_sel:[0,1,1] op_sel_hi:[1,1,1] neg_lo:[1,0,0] neg_hi:[1,0,0]
v_add_f32 v105, v110, v111
v_exp_f32 v243, v243
v_cvt_pk_bf16_f32 v119, v246, v247
v_pk_fma_f32 v[246:247], v[86:87], v[130:131], v[106:107] op_sel:[0,1,1] op_sel_hi:[1,1,1] neg_lo:[1,0,0] neg_hi:[1,0,0]
v_exp_f32 v246, v246
v_cvt_pk_bf16_f32 v117, v238, v239
v_pk_fma_f32 v[238:239], v[78:79], v[130:131], v[106:107] op_sel:[0,0,0] op_sel_hi:[1,0,0] neg_lo:[1,0,0] neg_hi:[1,0,0]
v_exp_f32 v238, v238
v_exp_f32 v247, v247
v_pk_fma_f32 v[240:241], v[80:81], v[130:131], v[106:107] op_sel:[0,0,0] op_sel_hi:[1,0,0] neg_lo:[1,0,0] neg_hi:[1,0,0]
v_exp_f32 v240, v240
v_exp_f32 v241, v241
v_permlane32_swap_b32 v100, v101
v_exp_f32 v242, v242
v_pk_fma_f32 v[244:245], v[84:85], v[130:131], v[106:107] op_sel:[0,1,1] op_sel_hi:[1,1,1] neg_lo:[1,0,0] neg_hi:[1,0,0]
v_exp_f32 v244, v244
v_exp_f32_e64 v239, v239
v_pk_mul_f32 v[100:101], v[100:101], v[128:129]
v_pk_fma_f32 v[62:63], v[62:63], v[128:129], v[100:101] op_sel:[0,0,0] op_sel_hi:[1,0,0] neg_lo:[0,0,1] neg_hi:[0,0,1]
v_pk_add_f32 v[110:111], v[236:237], v[238:239]
v_pk_add_f32 v[110:111], v[110:111], v[240:241]
v_pk_add_f32 v[110:111], v[110:111], v[242:243]
v_pk_fma_f32 v[72:73], v[72:73], v[128:129], v[100:101] op_sel:[0,1,1] op_sel_hi:[1,1,1] neg_lo:[0,0,1] neg_hi:[0,0,1]
v_pk_fma_f32 v[66:67], v[66:67], v[128:129], v[100:101] op_sel:[0,0,0] op_sel_hi:[1,0,0] neg_lo:[0,0,1] neg_hi:[0,0,1]
v_exp_f32 v62, v62
v_pk_fma_f32 v[60:61], v[60:61], v[128:129], v[100:101] op_sel:[0,0,0] op_sel_hi:[1,0,0] neg_lo:[0,0,1] neg_hi:[0,0,1]
v_exp_f32 v60, v60
v_exp_f32 v245, v245
v_exp_f32 v73, v73
v_pk_fma_f32 v[248:249], v[88:89], v[130:131], v[106:107] op_sel:[0,1,1] op_sel_hi:[1,1,1] neg_lo:[1,0,0] neg_hi:[1,0,0]
v_add_f32 v106, v110, v111
v_exp_f32 v249, v249
v_pk_add_f32 v[110:111], v[244:245], v[246:247]
v_exp_f32 v248, v248
v_pk_fma_f32 v[64:65], v[64:65], v[128:129], v[100:101] op_sel:[0,0,0] op_sel_hi:[1,0,0] neg_lo:[0,0,1] neg_hi:[0,0,1]
v_exp_f32 v64, v64
v_pk_add_f32 v[110:111], v[110:111], v[248:249]
v_exp_f32 v65, v65
v_exp_f32 v61, v61
v_exp_f32 v66, v66
v_exp_f32 v251, v251
v_exp_f32 v63, v63
v_pk_fma_f32 v[74:75], v[74:75], v[128:129], v[100:101] op_sel:[0,1,1] op_sel_hi:[1,1,1] neg_lo:[0,0,1] neg_hi:[0,0,1]
v_pk_add_f32 v[108:109], v[60:61], v[62:63]
v_exp_f32 v67, v67
v_exp_f32 v250, v250
v_pk_fma_f32 v[68:69], v[68:69], v[128:129], v[100:101] op_sel:[0,1,1] op_sel_hi:[1,1,1] neg_lo:[0,0,1] neg_hi:[0,0,1]
v_pk_add_f32 v[110:111], v[110:111], v[250:251]
v_exp_f32 v68, v68
v_exp_f32 v69, v69
v_add_f32 v107, v110, v111
v_mov_b32 v103, v102
v_pk_fma_f32 v[70:71], v[70:71], v[128:129], v[100:101] op_sel:[0,1,1] op_sel_hi:[1,1,1] neg_lo:[0,0,1] neg_hi:[0,0,1]
v_exp_f32 v71, v71
v_exp_f32 v70, v70
v_permlane32_swap_b32 v106, v107
v_permlane32_swap_b32 v102, v103
v_pk_add_f32 v[108:109], v[108:109], v[64:65]
v_pk_add_f32 v[108:109], v[108:109], v[66:67]
v_add_f32 v100, v108, v109
v_pk_add_f32 v[108:109], v[68:69], v[70:71]
v_pk_mul_f32 v[102:103], v[102:103], v[130:131]
v_pk_fma_f32 v[78:79], v[78:79], v[130:131], v[102:103] op_sel:[0,0,0] op_sel_hi:[1,0,0] neg_lo:[0,0,1] neg_hi:[0,0,1]
v_exp_f32 v79, v79
v_exp_f32 v78, v78
v_exp_f32 v74, v74
v_exp_f32 v72, v72
v_pk_fma_f32 v[86:87], v[86:87], v[130:131], v[102:103] op_sel:[0,1,1] op_sel_hi:[1,1,1] neg_lo:[0,0,1] neg_hi:[0,0,1]
v_exp_f32 v87, v87
v_pk_fma_f32 v[76:77], v[76:77], v[130:131], v[102:103] op_sel:[0,0,0] op_sel_hi:[1,0,0] neg_lo:[0,0,1] neg_hi:[0,0,1]
v_exp_f32 v77, v77
v_add_f32 v106, v106, v107
v_pk_fma_f32 v[80:81], v[80:81], v[130:131], v[102:103] op_sel:[0,0,0] op_sel_hi:[1,0,0] neg_lo:[0,0,1] neg_hi:[0,0,1]
v_exp_f32 v81, v81
v_exp_f32 v80, v80
v_pk_add_f32 v[108:109], v[108:109], v[72:73]
v_permlane32_swap_b32 v104, v105
v_exp_f32 v75, v75
v_add_f32 v104, v104, v105
v_pk_fma_f32 v[82:83], v[82:83], v[130:131], v[102:103] op_sel:[0,0,0] op_sel_hi:[1,0,0] neg_lo:[0,0,1] neg_hi:[0,0,1]
v_exp_f32 v82, v82
v_exp_f32 v83, v83
v_permlane16_swap_b32 v104, v106
v_pk_add_f32 v[108:109], v[108:109], v[74:75]
v_add_f32 v101, v108, v109
v_exp_f32 v76, v76
v_add_f32 v104, v104, v106
v_rcp_f32 v104, v104
v_pk_fma_f32 v[84:85], v[84:85], v[130:131], v[102:103] op_sel:[0,1,1] op_sel_hi:[1,1,1] neg_lo:[0,0,1] neg_hi:[0,0,1]
v_exp_f32 v84, v84
v_exp_f32 v85, v85
v_mov_b32 v106, v104
v_pk_add_f32 v[108:109], v[76:77], v[78:79]
v_pk_add_f32 v[108:109], v[108:109], v[80:81]
v_pk_add_f32 v[108:109], v[108:109], v[82:83]
v_pk_fma_f32 v[88:89], v[88:89], v[130:131], v[102:103] op_sel:[0,1,1] op_sel_hi:[1,1,1] neg_lo:[0,0,1] neg_hi:[0,0,1]
v_exp_f32 v88, v88
v_exp_f32 v89, v89
v_exp_f32 v86, v86
v_pk_fma_f32 v[90:91], v[90:91], v[130:131], v[102:103] op_sel:[0,1,1] op_sel_hi:[1,1,1] neg_lo:[0,0,1] neg_hi:[0,0,1]
v_add_f32 v102, v108, v109
v_pk_add_f32 v[108:109], v[84:85], v[86:87]
v_pk_add_f32 v[108:109], v[108:109], v[88:89]
v_permlane16_swap_b32 v104, v106
v_exp_f32 v90, v90
v_exp_f32 v91, v91
v_permlane32_swap_b32 v100, v101
v_pk_add_f32 v[108:109], v[108:109], v[90:91]
v_add_f32 v103, v108, v109
v_add_f32 v100, v100, v101
v_mov_b32 v105, v104
v_permlane32_swap_b32 v102, v103
v_mov_b32 v107, v106
v_add_f32 v102, v102, v103
v_permlane32_swap_b32 v104, v105
v_permlane32_swap_b32 v106, v107
v_permlane16_swap_b32 v100, v102
v_pk_mul_f32 v[222:223], v[222:223], v[104:105] op_sel:[0,0] op_sel_hi:[1,0]
v_pk_mul_f32 v[226:227], v[226:227], v[104:105] op_sel:[0,0] op_sel_hi:[1,0]
v_pk_mul_f32 v[234:235], v[234:235], v[104:105] op_sel:[0,1] op_sel_hi:[1,1]
v_pk_mul_f32 v[232:233], v[232:233], v[104:105] op_sel:[0,1] op_sel_hi:[1,1]
v_pk_mul_f32 v[230:231], v[230:231], v[104:105] op_sel:[0,1] op_sel_hi:[1,1]
v_add_f32 v100, v100, v102
v_pk_mul_f32 v[228:229], v[228:229], v[104:105] op_sel:[0,1] op_sel_hi:[1,1]
v_cvt_pk_bf16_f32 v228, v228, v229
v_cvt_pk_bf16_f32 v229, v230, v231
v_cvt_pk_bf16_f32 v231, v234, v235
v_cvt_pk_bf16_f32 v230, v232, v233
v_pk_mul_f32 v[220:221], v[220:221], v[104:105] op_sel:[0,0] op_sel_hi:[1,0]
v_cvt_pk_bf16_f32 v220, v220, v221
v_pk_mul_f32 v[224:225], v[224:225], v[104:105] op_sel:[0,0] op_sel_hi:[1,0]
v_pk_mul_f32 v[236:237], v[236:237], v[106:107] op_sel:[0,0] op_sel_hi:[1,0]
v_pk_mul_f32 v[238:239], v[238:239], v[106:107] op_sel:[0,0] op_sel_hi:[1,0]
v_pk_mul_f32 v[240:241], v[240:241], v[106:107] op_sel:[0,0] op_sel_hi:[1,0]
v_pk_mul_f32 v[242:243], v[242:243], v[106:107] op_sel:[0,0] op_sel_hi:[1,0]
v_pk_mul_f32 v[248:249], v[248:249], v[106:107] op_sel:[0,1] op_sel_hi:[1,1]
v_rcp_f32 v100, v100
v_pk_mul_f32 v[244:245], v[244:245], v[106:107] op_sel:[0,1] op_sel_hi:[1,1]
v_mov_b32 v102, v100
v_pk_mul_f32 v[250:251], v[250:251], v[106:107] op_sel:[0,1] op_sel_hi:[1,1]
v_cvt_pk_bf16_f32 v221, v222, v223
v_pk_mul_f32 v[246:247], v[246:247], v[106:107] op_sel:[0,1] op_sel_hi:[1,1]
v_cvt_pk_bf16_f32 v222, v224, v225
v_mfma_f32_16x16x32_bf16 v[200:203], v[228:231], v[36:39], 0
v_cvt_pk_bf16_f32 v223, v226, v227
v_permlane16_swap_b32 v100, v102
v_mfma_f32_16x16x32_bf16 v[196:199], v[228:231], v[38:41], 0
v_mov_b32 v101, v100
v_cvt_pk_bf16_f32 v244, v244, v245
v_mfma_f32_16x16x32_bf16 v[212:215], v[220:223], v[38:41], 0
v_cvt_pk_bf16_f32 v245, v246, v247
v_cvt_pk_bf16_f32 v247, v250, v251
v_mfma_f32_16x16x32_bf16 v[216:219], v[220:223], v[36:39], 0
v_cvt_pk_bf16_f32 v234, v200, v201
v_cvt_pk_bf16_f32 v246, v248, v249
v_cvt_pk_bf16_f32 v226, v196, v197
v_cvt_pk_bf16_f32 v227, v198, v199
v_mfma_f32_16x16x32_bf16 v[196:199], v[244:247], v[38:41], 0
v_cvt_pk_bf16_f32 v225, v214, v215
v_cvt_pk_bf16_f32 v236, v236, v237
v_cvt_pk_bf16_f32 v237, v238, v239
v_cvt_pk_bf16_f32 v232, v216, v217
v_cvt_pk_bf16_f32 v233, v218, v219
v_cvt_pk_bf16_f32 v239, v242, v243
v_cvt_pk_bf16_f32 v238, v240, v241
v_cvt_pk_bf16_f32 v224, v212, v213
v_permlane32_swap_b32 v100, v101
v_mfma_f32_16x16x32_bf16 v[216:219], v[236:239], v[36:39], 0
v_mov_b32 v103, v102
v_cvt_pk_bf16_f32 v235, v202, v203
v_mfma_f32_16x16x32_bf16 v[212:215], v[236:239], v[38:41], 0
v_cvt_pk_bf16_f32 v243, v198, v199
v_permlane32_swap_b32 v102, v103
v_mfma_f32_16x16x32_bf16 v[200:203], v[244:247], v[36:39], 0
v_cvt_pk_bf16_f32 v242, v196, v197
v_mov_b32 v5, s61
v_mfma_f32_16x16x32_bf16 v[220:223], v[232:235], v[120:123], 0
v_cvt_pk_bf16_f32 v249, v218, v219
v_cvt_pk_bf16_f32 v248, v216, v217
v_cvt_pk_bf16_f32 v241, v214, v215
v_cvt_pk_bf16_f32 v240, v212, v213
v_cmp_eq_u32 s[50:51], s41, v2
v_pk_mul_f32 v[64:65], v[64:65], v[100:101] op_sel:[0,0] op_sel_hi:[1,0]
v_pk_mul_f32 v[74:75], v[74:75], v[100:101] op_sel:[0,1] op_sel_hi:[1,1]
v_pk_mul_f32 v[68:69], v[68:69], v[100:101] op_sel:[0,1] op_sel_hi:[1,1]
v_pk_mul_f32 v[72:73], v[72:73], v[100:101] op_sel:[0,1] op_sel_hi:[1,1]
v_pk_mul_f32 v[60:61], v[60:61], v[100:101] op_sel:[0,0] op_sel_hi:[1,0]
v_pk_mul_f32 v[62:63], v[62:63], v[100:101] op_sel:[0,0] op_sel_hi:[1,0]
v_pk_mul_f32 v[66:67], v[66:67], v[100:101] op_sel:[0,0] op_sel_hi:[1,0]
v_pk_mul_f32 v[76:77], v[76:77], v[102:103] op_sel:[0,0] op_sel_hi:[1,0]
v_pk_mul_f32 v[70:71], v[70:71], v[100:101] op_sel:[0,1] op_sel_hi:[1,1]
v_cvt_pk_bf16_f32 v60, v60, v61
v_pk_mul_f32 v[80:81], v[80:81], v[102:103] op_sel:[0,0] op_sel_hi:[1,0]
v_pk_mul_f32 v[78:79], v[78:79], v[102:103] op_sel:[0,0] op_sel_hi:[1,0]
v_pk_mul_f32 v[82:83], v[82:83], v[102:103] op_sel:[0,0] op_sel_hi:[1,0]
v_pk_mul_f32 v[86:87], v[86:87], v[102:103] op_sel:[0,1] op_sel_hi:[1,1]
v_cvt_pk_bf16_f32 v61, v62, v63
v_pk_mul_f32 v[84:85], v[84:85], v[102:103] op_sel:[0,1] op_sel_hi:[1,1]
v_cvt_pk_bf16_f32 v62, v64, v65
v_pk_mul_f32 v[88:89], v[88:89], v[102:103] op_sel:[0,1] op_sel_hi:[1,1]
v_cvt_pk_bf16_f32 v63, v66, v67
v_pk_mul_f32 v[90:91], v[90:91], v[102:103] op_sel:[0,1] op_sel_hi:[1,1]
v_cvt_pk_bf16_f32 v68, v68, v69
v_mfma_f32_16x16x32_bf16 v[208:211], v[60:63], v[36:39], 0
v_cvt_pk_bf16_f32 v69, v70, v71
v_cvt_pk_bf16_f32 v70, v72, v73
v_mfma_f32_16x16x32_bf16 v[204:207], v[60:63], v[38:41], 0
v_cvt_pk_bf16_f32 v71, v74, v75
v_cvt_pk_bf16_f32 v76, v76, v77
v_mfma_f32_16x16x32_bf16 v[60:63], v[232:235], v[112:115], 0
v_cvt_pk_bf16_f32 v250, v200, v201
v_cvt_pk_bf16_f32 v77, v78, v79
v_mfma_f32_16x16x32_bf16 v[192:195], v[68:71], v[36:39], 0
v_cvt_pk_bf16_f32 v78, v80, v81
v_cvt_pk_bf16_f32 v79, v82, v83
v_mfma_f32_16x16x32_bf16 v[188:191], v[68:71], v[38:41], 0
v_cvt_pk_bf16_f32 v65, v206, v207
v_cvt_pk_bf16_f32 v64, v204, v205
v_mfma_f32_16x16x32_bf16 v[68:71], v[224:227], v[120:123], 0
v_cvt_pk_bf16_f32 v251, v202, v203
v_cvt_pk_bf16_f32 v72, v208, v209
v_mfma_f32_16x16x32_bf16 v[152:155], v[224:227], v[112:115], 0
v_cvt_pk_bf16_f32 v73, v210, v211
v_cvt_pk_bf16_f32 v84, v84, v85
v_mfma_f32_16x16x32_bf16 v[60:63], v[248:251], v[116:119], v[60:63]
v_cvt_pk_bf16_f32 v85, v86, v87
v_cvt_pk_bf16_f32 v86, v88, v89
v_mfma_f32_16x16x32_bf16 v[228:231], v[224:227], v[48:51], 0
v_cvt_pk_bf16_f32 v67, v190, v191
v_cvt_pk_bf16_f32 v87, v90, v91
v_mfma_f32_16x16x32_bf16 v[220:223], v[248:251], v[124:127], v[220:223]
v_cvt_pk_bf16_f32 v66, v188, v189
v_cvt_pk_bf16_f32 v74, v192, v193
v_mfma_f32_16x16x32_bf16 v[152:155], v[240:243], v[116:119], v[152:155]
v_cvt_pk_bf16_f32 v75, v194, v195
v_mfma_f32_16x16x32_bf16 v[204:207], v[76:79], v[38:41], 0
v_mfma_f32_16x16x32_bf16 v[208:211], v[76:79], v[36:39], 0
v_mfma_f32_16x16x32_bf16 v[228:231], v[240:243], v[48:51], v[228:231]
v_mfma_f32_16x16x32_bf16 v[68:71], v[240:243], v[124:127], v[68:71]
v_mfma_f32_16x16x32_bf16 v[76:79], v[232:235], v[48:51], 0
s_nop 1
v_cvt_pk_bf16_f32 v152, v152, v153
v_mfma_f32_16x16x32_bf16 v[76:79], v[248:251], v[48:51], v[76:79]
v_cvt_pk_bf16_f32 v153, v154, v155
v_cvt_pk_bf16_f32 v154, v60, v61
v_mfma_f32_16x16x32_bf16 v[192:195], v[84:87], v[36:39], 0
v_cvt_pk_bf16_f32 v68, v68, v69
v_cvt_pk_bf16_f32 v155, v62, v63
v_mfma_f32_16x16x32_bf16 v[188:191], v[84:87], v[38:41], 0
ds_write_b128 v42, v[152:155] offset:0
v_mfma_f32_16x16x32_bf16 v[136:139], v[64:67], v[48:51], 0
v_cvt_pk_bf16_f32 v69, v70, v71
v_cvt_pk_bf16_f32 v228, v228, v229
v_mfma_f32_16x16x32_bf16 v[104:107], v[72:75], v[112:115], 0
v_cvt_pk_bf16_f32 v71, v222, v223
v_cvt_pk_bf16_f32 v229, v230, v231
v_mfma_f32_16x16x32_bf16 v[148:151], v[72:75], v[48:51], 0
v_cvt_pk_bf16_f32 v230, v76, v77
v_cvt_pk_bf16_f32 v70, v220, v221
v_mfma_f32_16x16x32_bf16 v[132:135], v[72:75], v[120:123], 0
ds_write_b128 v42, v[68:71] offset:1024
v_mfma_f32_16x16x32_bf16 v[108:111], v[64:67], v[120:123], 0
v_cvt_pk_bf16_f32 v231, v78, v79
ds_write_b128 v42, v[228:231] offset:2048
v_mfma_f32_16x16x32_bf16 v[100:103], v[64:67], v[112:115], 0
ds_write_b32 v52, v5
v_cvt_pk_bf16_f32 v88, v208, v209
v_cvt_pk_bf16_f32 v83, v190, v191
v_cvt_pk_bf16_f32 v91, v194, v195
v_cvt_pk_bf16_f32 v82, v188, v189
v_cvt_pk_bf16_f32 v80, v204, v205
v_cvt_pk_bf16_f32 v89, v210, v211
v_cvt_pk_bf16_f32 v81, v206, v207
v_cvt_pk_bf16_f32 v90, v192, v193
s_nop 0
v_mfma_f32_16x16x32_bf16 v[100:103], v[80:83], v[116:119], v[100:103]
v_mfma_f32_16x16x32_bf16 v[108:111], v[80:83], v[124:127], v[108:111]
v_mfma_f32_16x16x32_bf16 v[132:135], v[88:91], v[124:127], v[132:135]
v_mfma_f32_16x16x32_bf16 v[148:151], v[88:91], v[48:51], v[148:151]
v_mfma_f32_16x16x32_bf16 v[136:139], v[80:83], v[48:51], v[136:139]
v_mfma_f32_16x16x32_bf16 v[104:107], v[88:91], v[116:119], v[104:107]
s_mov_b32 s63, 0
px_120:
ds_read_b32 v4, v19
ds_read_b128 v[188:191], v43 offset:0
ds_read_b128 v[192:195], v43 offset:1024
ds_read_b128 v[196:199], v43 offset:2048
s_add_u32 s63, s63, 1
s_cmp_lt_u32 s63, 0x400000
s_waitcnt lgkmcnt(0)
v_cmp_ne_u32 vcc, s61, v4
s_cbranch_vccz pxd_121
s_cbranch_scc1 px_120
pxd_121:
v_mfma_f32_16x16x32_bf16 v[100:103], v[38:41], v[188:191], v[100:103]
v_mfma_f32_16x16x32_bf16 v[104:107], v[36:39], v[188:191], v[104:107]
v_mfma_f32_16x16x32_bf16 v[108:111], v[38:41], v[192:195], v[108:111]
v_mfma_f32_16x16x32_bf16 v[132:135], v[36:39], v[192:195], v[132:135]
v_mfma_f32_16x16x32_bf16 v[136:139], v[38:41], v[196:199], v[136:139]
v_mfma_f32_16x16x32_bf16 v[148:151], v[36:39], v[196:199], v[148:151]
s_nop 2
v_cvt_pk_bf16_f32 v100, v100, v101
v_cvt_pk_bf16_f32 v101, v102, v103
v_cvt_pk_bf16_f32 v102, v104, v105
v_cvt_pk_bf16_f32 v103, v106, v107
buffer_store_dwordx4 v[100:103], v55, s[32:35], s53 offen sc1
v_cvt_pk_bf16_f32 v108, v108, v109
v_cvt_pk_bf16_f32 v109, v110, v111
v_cvt_pk_bf16_f32 v110, v132, v133
v_cvt_pk_bf16_f32 v111, v134, v135
buffer_store_dwordx4 v[108:111], v55, s[32:35], s54 offen sc1
v_cvt_pk_bf16_f32 v136, v136, v137
v_cvt_pk_bf16_f32 v137, v138, v139
v_cvt_pk_bf16_f32 v138, v148, v149
v_cvt_pk_bf16_f32 v139, v150, v151
s_mov_b64 exec, s[50:51]
buffer_store_dwordx4 v[136:139], v58, s[32:35], s56 offen sc1
s_mov_b64 exec, -1
s_mov_b32 s51, 0
.p2align 3
v_pk_fma_f32 v[156:157], v[140:141], v[92:93], v[156:157] op_sel:[0,1,0] op_sel_hi:[1,1,1]
v_pk_fma_f32 v[164:165], v[140:141], v[94:95], v[164:165] op_sel:[0,1,0] op_sel_hi:[1,1,1]
v_pk_fma_f32 v[172:173], v[140:141], v[96:97], v[172:173] op_sel:[0,1,0] op_sel_hi:[1,1,1]
v_pk_fma_f32 v[180:181], v[140:141], v[98:99], v[180:181] op_sel:[0,1,0] op_sel_hi:[1,1,1]
v_pk_fma_f32 v[158:159], v[142:143], v[92:93], v[158:159] op_sel:[0,1,0] op_sel_hi:[1,1,1]
v_cvt_pk_bf16_f32 v156, v156, v157
v_pk_fma_f32 v[166:167], v[142:143], v[94:95], v[166:167] op_sel:[0,1,0] op_sel_hi:[1,1,1]
v_cvt_pk_bf16_f32 v164, v164, v165
v_pk_fma_f32 v[174:175], v[142:143], v[96:97], v[174:175] op_sel:[0,1,0] op_sel_hi:[1,1,1]
v_cvt_pk_bf16_f32 v172, v172, v173
v_pk_fma_f32 v[182:183], v[142:143], v[98:99], v[182:183] op_sel:[0,1,0] op_sel_hi:[1,1,1]
v_cvt_pk_bf16_f32 v180, v180, v181
v_pk_fma_f32 v[160:161], v[144:145], v[92:93], v[160:161] op_sel:[0,1,0] op_sel_hi:[1,1,1]
v_pk_fma_f32 v[162:163], v[146:147], v[92:93], v[162:163] op_sel:[0,1,0] op_sel_hi:[1,1,1]
v_cvt_pk_bf16_f32 v157, v158, v159
v_pk_fma_f32 v[168:169], v[144:145], v[94:95], v[168:169] op_sel:[0,1,0] op_sel_hi:[1,1,1]
v_pk_fma_f32 v[170:171], v[146:147], v[94:95], v[170:171] op_sel:[0,1,0] op_sel_hi:[1,1,1]
v_cvt_pk_bf16_f32 v165, v166, v167
v_pk_fma_f32 v[176:177], v[144:145], v[96:97], v[176:177] op_sel:[0,1,0] op_sel_hi:[1,1,1]
v_pk_fma_f32 v[178:179], v[146:147], v[96:97], v[178:179] op_sel:[0,1,0] op_sel_hi:[1,1,1]
v_cvt_pk_bf16_f32 v173, v174, v175
v_pk_fma_f32 v[184:185], v[144:145], v[98:99], v[184:185] op_sel:[0,1,0] op_sel_hi:[1,1,1]
v_pk_fma_f32 v[186:187], v[146:147], v[98:99], v[186:187] op_sel:[0,1,0] op_sel_hi:[1,1,1]
v_cvt_pk_bf16_f32 v181, v182, v183
v_cvt_pk_bf16_f32 v158, v160, v161
v_cvt_pk_bf16_f32 v159, v162, v163
v_cvt_pk_bf16_f32 v166, v168, v169
v_cvt_pk_bf16_f32 v167, v170, v171
v_mfma_f32_16x16x32_bf16 v[60:63], v[10:13], v[156:159], 0
v_cvt_pk_bf16_f32 v174, v176, v177
v_cvt_pk_bf16_f32 v175, v178, v179
v_mfma_f32_16x16x32_bf16 v[68:71], v[10:13], v[164:167], 0
v_cvt_pk_bf16_f32 v182, v184, v185
v_cvt_pk_bf16_f32 v183, v186, v187
v_mfma_f32_16x16x32_bf16 v[76:79], v[10:13], v[172:175], 0
s_nop 0
v_mfma_f32_16x16x32_bf16 v[84:87], v[10:13], v[180:183], 0
v_min3_f32 v104, v60, v61, v62
v_max3_f32 v100, v60, v61, v62
v_mfma_f32_16x16x32_bf16 v[64:67], v[14:17], v[156:159], 0
v_min3_f32 v105, v68, v69, v70
v_max3_f32 v101, v68, v69, v70
v_mfma_f32_16x16x32_bf16 v[72:75], v[14:17], v[164:167], 0
v_min3_f32 v106, v76, v77, v78
v_max3_f32 v102, v76, v77, v78
v_mfma_f32_16x16x32_bf16 v[80:83], v[14:17], v[172:175], 0
v_min3_f32 v107, v84, v85, v86
v_max3_f32 v103, v84, v85, v86
v_mfma_f32_16x16x32_bf16 v[88:91], v[14:17], v[180:183], 0
v_min3_f32 v104, v104, v63, v64
v_max3_f32 v100, v100, v63, v64
v_min3_f32 v105, v105, v71, v72
v_min3_f32 v104, v104, v65, v66
v_max3_f32 v101, v101, v71, v72
v_min3_f32 v106, v106, v79, v80
v_min3_f32 v105, v105, v73, v74
v_max3_f32 v102, v102, v79, v80
v_min3_f32 v107, v107, v87, v88
v_min3_f32 v106, v106, v81, v82
v_max3_f32 v103, v103, v87, v88
v_min3_f32 v107, v107, v89, v90
v_max3_f32 v100, v100, v65, v66
v_min_f32 v104, v104, v67
v_max3_f32 v101, v101, v73, v74
v_min_f32 v105, v105, v75
v_max3_f32 v102, v102, v81, v82
v_min_f32 v106, v106, v83
v_max3_f32 v103, v103, v89, v90
v_min_f32 v107, v107, v91
v_max_f32 v100, v100, v67
v_max_f32 v101, v101, v75
v_max_f32 v102, v102, v83
v_max_f32 v103, v103, v91
v_permlane32_swap_b32 v104, v105
v_permlane32_swap_b32 v106, v107
v_permlane32_swap_b32 v100, v101
v_permlane32_swap_b32 v102, v103
v_min_f32 v104, v104, v105
v_min_f32 v106, v106, v107
v_max_f32 v100, v100, v101
v_max_f32 v102, v102, v103
v_permlane16_swap_b32 v104, v106
s_nop 0
v_permlane16_swap_b32 v100, v102
v_min_f32 v104, v104, v106
v_max_f32 v100, v100, v102
v_mov_b32 v106, v104
v_mov_b32 v102, v100
s_nop 0
v_permlane16_swap_b32 v104, v106
v_permlane16_swap_b32 v100, v102
v_mov_b32 v105, v104
v_mov_b32 v101, v100
v_mov_b32 v103, v102
v_permlane32_swap_b32 v104, v105
v_mov_b32 v107, v106
v_permlane32_swap_b32_e64 v100, v101
v_pk_mul_f32 v[104:105], v[104:105], v[128:129]
v_pk_mul_f32 v[100:101], v[100:101], v[128:129]
v_pk_fma_f32 v[220:221], v[60:61], v[128:129], v[104:105] op_sel:[0,0,0] op_sel_hi:[1,0,0] neg_lo:[1,0,0] neg_hi:[1,0,0]
v_pk_fma_f32 v[222:223], v[62:63], v[128:129], v[104:105] op_sel:[0,0,0] op_sel_hi:[1,0,0] neg_lo:[1,0,0] neg_hi:[1,0,0]
v_pk_fma_f32 v[224:225], v[64:65], v[128:129], v[104:105] op_sel:[0,0,0] op_sel_hi:[1,0,0] neg_lo:[1,0,0] neg_hi:[1,0,0]
v_pk_fma_f32 v[226:227], v[66:67], v[128:129], v[104:105] op_sel:[0,0,0] op_sel_hi:[1,0,0] neg_lo:[1,0,0] neg_hi:[1,0,0]
v_pk_fma_f32 v[228:229], v[68:69], v[128:129], v[104:105] op_sel:[0,1,1] op_sel_hi:[1,1,1] neg_lo:[1,0,0] neg_hi:[1,0,0]
v_pk_fma_f32 v[230:231], v[70:71], v[128:129], v[104:105] op_sel:[0,1,1] op_sel_hi:[1,1,1] neg_lo:[1,0,0] neg_hi:[1,0,0]
v_pk_fma_f32 v[232:233], v[72:73], v[128:129], v[104:105] op_sel:[0,1,1] op_sel_hi:[1,1,1] neg_lo:[1,0,0] neg_hi:[1,0,0]
v_pk_fma_f32 v[234:235], v[74:75], v[128:129], v[104:105] op_sel:[0,1,1] op_sel_hi:[1,1,1] neg_lo:[1,0,0] neg_hi:[1,0,0]
v_permlane32_swap_b32 v102, v103
v_permlane32_swap_b32 v106, v107
v_pk_fma_f32 v[60:61], v[60:61], v[128:129], v[100:101] op_sel:[0,0,0] op_sel_hi:[1,0,0] neg_lo:[0,0,1] neg_hi:[0,0,1]
v_pk_fma_f32 v[62:63], v[62:63], v[128:129], v[100:101] op_sel:[0,0,0] op_sel_hi:[1,0,0] neg_lo:[0,0,1] neg_hi:[0,0,1]
v_pk_fma_f32 v[64:65], v[64:65], v[128:129], v[100:101] op_sel:[0,0,0] op_sel_hi:[1,0,0] neg_lo:[0,0,1] neg_hi:[0,0,1]
v_pk_fma_f32 v[66:67], v[66:67], v[128:129], v[100:101] op_sel:[0,0,0] op_sel_hi:[1,0,0] neg_lo:[0,0,1] neg_hi:[0,0,1]
v_pk_fma_f32 v[68:69], v[68:69], v[128:129], v[100:101] op_sel:[0,1,1] op_sel_hi:[1,1,1] neg_lo:[0,0,1] neg_hi:[0,0,1]
v_pk_fma_f32 v[70:71], v[70:71], v[128:129], v[100:101] op_sel:[0,1,1] op_sel_hi:[1,1,1] neg_lo:[0,0,1] neg_hi:[0,0,1]
v_pk_fma_f32 v[72:73], v[72:73], v[128:129], v[100:101] op_sel:[0,1,1] op_sel_hi:[1,1,1] neg_lo:[0,0,1] neg_hi:[0,0,1]
v_pk_fma_f32 v[74:75], v[74:75], v[128:129], v[100:101] op_sel:[0,1,1] op_sel_hi:[1,1,1] neg_lo:[0,0,1] neg_hi:[0,0,1]
v_exp_f32 v220, v220
v_exp_f32 v60, v60
v_exp_f32 v221, v221
v_exp_f32 v61, v61
v_exp_f32 v222, v222
v_exp_f32 v62, v62
v_exp_f32 v223, v223
v_exp_f32 v63, v63
v_exp_f32 v224, v224
v_exp_f32 v64, v64
v_exp_f32 v225, v225
v_exp_f32 v65, v65
v_exp_f32 v226, v226
v_exp_f32 v66, v66
v_exp_f32 v227, v227
v_exp_f32 v67, v67
v_exp_f32 v228, v228
v_exp_f32 v68, v68
v_exp_f32 v229, v229
v_exp_f32 v69, v69
v_exp_f32 v230, v230
v_exp_f32 v70, v70
v_exp_f32 v231, v231
v_exp_f32 v71, v71
v_exp_f32 v232, v232
v_exp_f32 v72, v72
v_exp_f32 v233, v233
v_exp_f32 v73, v73
v_exp_f32 v234, v234
v_exp_f32 v74, v74
v_exp_f32 v235, v235
v_exp_f32 v75, v75
v_pk_mul_f32 v[102:103], v[102:103], v[130:131]
v_pk_mul_f32 v[106:107], v[106:107], v[130:131]
buffer_load_dwordx4 v[212:215], v18, s[32:35], s55 offen offset:0 sc1
buffer_load_dwordx4 v[216:219], v18, s[32:35], s55 offen offset:1024 sc1
.p2align 3
v_pk_add_f32 v[108:109], v[60:61], v[62:63]
v_pk_add_f32 v[110:111], v[220:221], v[222:223]
v_pk_add_f32 v[108:109], v[108:109], v[64:65]
v_pk_add_f32 v[110:111], v[110:111], v[224:225]
v_pk_add_f32 v[108:109], v[108:109], v[66:67]
v_pk_add_f32 v[110:111], v[110:111], v[226:227]
v_add_f32 v100, v108, v109
v_add_f32 v104, v110, v111
v_pk_fma_f32 v[236:237], v[76:77], v[130:131], v[106:107] op_sel:[0,0,0] op_sel_hi:[1,0,0] neg_lo:[1,0,0] neg_hi:[1,0,0]
v_pk_fma_f32 v[238:239], v[78:79], v[130:131], v[106:107] op_sel:[0,0,0] op_sel_hi:[1,0,0] neg_lo:[1,0,0] neg_hi:[1,0,0]
v_pk_add_f32 v[108:109], v[68:69], v[70:71]
v_pk_add_f32 v[110:111], v[228:229], v[230:231]
v_pk_fma_f32 v[76:77], v[76:77], v[130:131], v[102:103] op_sel:[0,0,0] op_sel_hi:[1,0,0] neg_lo:[0,0,1] neg_hi:[0,0,1]
v_pk_fma_f32 v[78:79], v[78:79], v[130:131], v[102:103] op_sel:[0,0,0] op_sel_hi:[1,0,0] neg_lo:[0,0,1] neg_hi:[0,0,1]
v_pk_fma_f32 v[240:241], v[80:81], v[130:131], v[106:107] op_sel:[0,0,0] op_sel_hi:[1,0,0] neg_lo:[1,0,0] neg_hi:[1,0,0]
v_pk_add_f32 v[108:109], v[108:109], v[72:73]
v_pk_add_f32 v[110:111], v[110:111], v[232:233]
v_exp_f32 v236, v236
v_exp_f32 v76, v76
v_exp_f32 v237, v237
v_exp_f32 v77, v77
v_exp_f32 v238, v238
v_exp_f32 v78, v78
v_exp_f32 v239, v239
v_exp_f32 v79, v79
v_pk_fma_f32 v[80:81], v[80:81], v[130:131], v[102:103] op_sel:[0,0,0] op_sel_hi:[1,0,0] neg_lo:[0,0,1] neg_hi:[0,0,1]
v_pk_fma_f32 v[242:243], v[82:83], v[130:131], v[106:107] op_sel:[0,0,0] op_sel_hi:[1,0,0] neg_lo:[1,0,0] neg_hi:[1,0,0]
v_pk_add_f32 v[108:109], v[108:109], v[74:75]
v_pk_add_f32 v[110:111], v[110:111], v[234:235]
v_exp_f32 v240, v240
v_exp_f32 v80, v80
v_exp_f32 v241, v241
v_exp_f32 v81, v81
v_pk_fma_f32 v[82:83], v[82:83], v[130:131], v[102:103] op_sel:[0,0,0] op_sel_hi:[1,0,0] neg_lo:[0,0,1] neg_hi:[0,0,1]
v_add_f32 v101, v108, v109
v_add_f32 v105, v110, v111
v_exp_f32 v242, v242
v_exp_f32 v82, v82
v_exp_f32 v243, v243
v_exp_f32 v83, v83
v_pk_fma_f32 v[244:245], v[84:85], v[130:131], v[106:107] op_sel:[0,1,1] op_sel_hi:[1,1,1] neg_lo:[1,0,0] neg_hi:[1,0,0]
v_pk_fma_f32 v[246:247], v[86:87], v[130:131], v[106:107] op_sel:[0,1,1] op_sel_hi:[1,1,1] neg_lo:[1,0,0] neg_hi:[1,0,0]
v_pk_add_f32 v[108:109], v[76:77], v[78:79]
v_pk_add_f32 v[110:111], v[236:237], v[238:239]
v_pk_fma_f32 v[84:85], v[84:85], v[130:131], v[102:103] op_sel:[0,1,1] op_sel_hi:[1,1,1] neg_lo:[0,0,1] neg_hi:[0,0,1]
v_pk_fma_f32 v[86:87], v[86:87], v[130:131], v[102:103] op_sel:[0,1,1] op_sel_hi:[1,1,1] neg_lo:[0,0,1] neg_hi:[0,0,1]
v_pk_fma_f32 v[248:249], v[88:89], v[130:131], v[106:107] op_sel:[0,1,1] op_sel_hi:[1,1,1] neg_lo:[1,0,0] neg_hi:[1,0,0]
v_pk_fma_f32 v[250:251], v[90:91], v[130:131], v[106:107] op_sel:[0,1,1] op_sel_hi:[1,1,1] neg_lo:[1,0,0] neg_hi:[1,0,0]
v_pk_add_f32 v[108:109], v[108:109], v[80:81]
v_pk_add_f32 v[110:111], v[110:111], v[240:241]
v_exp_f32 v244, v244
v_exp_f32 v84, v84
v_exp_f32 v245, v245
v_exp_f32 v85, v85
v_exp_f32 v246, v246
v_exp_f32 v86, v86
v_exp_f32 v247, v247
v_exp_f32 v87, v87
v_pk_fma_f32 v[88:89], v[88:89], v[130:131], v[102:103] op_sel:[0,1,1] op_sel_hi:[1,1,1] neg_lo:[0,0,1] neg_hi:[0,0,1]
v_pk_fma_f32 v[90:91], v[90:91], v[130:131], v[102:103] op_sel:[0,1,1] op_sel_hi:[1,1,1] neg_lo:[0,0,1] neg_hi:[0,0,1]
v_pk_add_f32 v[108:109], v[108:109], v[82:83]
v_pk_add_f32 v[110:111], v[110:111], v[242:243]
v_exp_f32 v248, v248
v_exp_f32 v88, v88
v_exp_f32 v249, v249
v_exp_f32 v89, v89
v_add_f32 v102, v108, v109
v_add_f32 v106, v110, v111
v_exp_f32 v250, v250
v_exp_f32 v90, v90
v_exp_f32 v251, v251
v_exp_f32 v91, v91
v_pk_add_f32 v[108:109], v[84:85], v[86:87]
v_pk_add_f32 v[110:111], v[244:245], v[246:247]
v_pk_add_f32 v[108:109], v[108:109], v[88:89]
v_pk_add_f32 v[110:111], v[110:111], v[248:249]
v_pk_add_f32 v[108:109], v[108:109], v[90:91]
v_pk_add_f32 v[110:111], v[110:111], v[250:251]
v_add_f32 v103, v108, v109
v_add_f32 v107, v110, v111
s_cmp_eq_u32 s51, 1
s_cbranch_scc1 chk_122
s_waitcnt vmcnt(0)
v_max_u32 v4, v212, v213
v_max3_u32 v4, v4, v214, v215
v_max3_u32 v4, v4, v216, v217
v_max3_u32 v4, v4, v218, v219
v_cmp_eq_u32 vcc, -1, v4
s_cbranch_vccz red_123
buffer_load_dwordx4 v[212:215], v18, s[32:35], s55 offen offset:0 sc1
buffer_load_dwordx4 v[216:219], v18, s[32:35], s55 offen offset:1024 sc1
s_branch chk_122
red_123:
v_mfma_f32_16x16x32_bf16 v[132:135], v[44:47], v[212:215], 0
v_mfma_f32_16x16x32_bf16 v[132:135], v[44:47], v[216:219], v[132:135]
s_mov_b32 s51, 1
s_nop 6
v_add_f32_dpp v132, v132, v132 row_ror:8 row_mask:0xf bank_mask:0xf
v_add_f32_dpp v133, v133, v133 row_ror:8 row_mask:0xf bank_mask:0xf
v_add_f32_dpp v134, v134, v134 row_ror:8 row_mask:0xf bank_mask:0xf
v_add_f32_dpp v135, v135, v135 row_ror:8 row_mask:0xf bank_mask:0xf
v_cvt_pk_bf16_f32 v132, v132, v133
v_cvt_pk_bf16_f32 v133, v134, v135
s_mov_b64 exec, 0x00ff00ff
buffer_store_dwordx2 v[132:133], v59, s[32:35], s79 offen sc1
s_mov_b64 exec, -1
buffer_load_dwordx4 v[204:207], v58, s[32:35], s56 offen sc1
buffer_load_dwordx4 v[208:211], v58, s[32:35], s57 offen sc1
chk_122:
.p2align 3
v_permlane32_swap_b32 v100, v101
v_permlane32_swap_b32 v102, v103
v_permlane32_swap_b32 v104, v105
v_permlane32_swap_b32 v106, v107
v_add_f32 v100, v100, v101
v_add_f32 v102, v102, v103
v_add_f32 v104, v104, v105
v_add_f32 v106, v106, v107
v_permlane16_swap_b32 v100, v102
s_nop 0
v_permlane16_swap_b32 v104, v106
v_add_f32 v100, v100, v102
v_add_f32 v104, v104, v106
v_rcp_f32 v100, v100
v_rcp_f32 v104, v104
v_mov_b32 v102, v100
v_mov_b32 v106, v104
s_nop 0
v_permlane16_swap_b32 v100, v102
v_permlane16_swap_b32 v104, v106
v_mov_b32 v101, v100
v_mov_b32 v103, v102
v_mov_b32 v105, v104
v_mov_b32 v107, v106
v_permlane32_swap_b32 v100, v101
v_permlane32_swap_b32 v102, v103
v_permlane32_swap_b32 v104, v105
v_permlane32_swap_b32 v106, v107
v_pk_mul_f32 v[60:61], v[60:61], v[100:101] op_sel:[0,0] op_sel_hi:[1,0]
v_pk_mul_f32 v[220:221], v[220:221], v[104:105] op_sel:[0,0] op_sel_hi:[1,0]
v_pk_mul_f32 v[68:69], v[68:69], v[100:101] op_sel:[0,1] op_sel_hi:[1,1]
v_pk_mul_f32 v[228:229], v[228:229], v[104:105] op_sel:[0,1] op_sel_hi:[1,1]
v_pk_mul_f32 v[76:77], v[76:77], v[102:103] op_sel:[0,0] op_sel_hi:[1,0]
v_pk_mul_f32 v[236:237], v[236:237], v[106:107] op_sel:[0,0] op_sel_hi:[1,0]
v_pk_mul_f32 v[84:85], v[84:85], v[102:103] op_sel:[0,1] op_sel_hi:[1,1]
v_pk_mul_f32 v[244:245], v[244:245], v[106:107] op_sel:[0,1] op_sel_hi:[1,1]
v_pk_mul_f32 v[62:63], v[62:63], v[100:101] op_sel:[0,0] op_sel_hi:[1,0]
v_pk_mul_f32 v[222:223], v[222:223], v[104:105] op_sel:[0,0] op_sel_hi:[1,0]
v_cvt_pk_bf16_f32 v60, v60, v61
v_cvt_pk_bf16_f32 v220, v220, v221
v_pk_mul_f32 v[70:71], v[70:71], v[100:101] op_sel:[0,1] op_sel_hi:[1,1]
v_pk_mul_f32 v[230:231], v[230:231], v[104:105] op_sel:[0,1] op_sel_hi:[1,1]
v_cvt_pk_bf16_f32 v68, v68, v69
v_cvt_pk_bf16_f32 v228, v228, v229
v_pk_mul_f32 v[78:79], v[78:79], v[102:103] op_sel:[0,0] op_sel_hi:[1,0]
v_pk_mul_f32 v[238:239], v[238:239], v[106:107] op_sel:[0,0] op_sel_hi:[1,0]
v_cvt_pk_bf16_f32 v76, v76, v77
v_cvt_pk_bf16_f32 v236, v236, v237
v_pk_mul_f32 v[86:87], v[86:87], v[102:103] op_sel:[0,1] op_sel_hi:[1,1]
v_pk_mul_f32 v[246:247], v[246:247], v[106:107] op_sel:[0,1] op_sel_hi:[1,1]
v_cvt_pk_bf16_f32 v84, v84, v85
v_cvt_pk_bf16_f32 v244, v244, v245
v_pk_mul_f32 v[64:65], v[64:65], v[100:101] op_sel:[0,0] op_sel_hi:[1,0]
v_pk_mul_f32 v[66:67], v[66:67], v[100:101] op_sel:[0,0] op_sel_hi:[1,0]
v_pk_mul_f32 v[224:225], v[224:225], v[104:105] op_sel:[0,0] op_sel_hi:[1,0]
v_pk_mul_f32 v[226:227], v[226:227], v[104:105] op_sel:[0,0] op_sel_hi:[1,0]
v_cvt_pk_bf16_f32 v61, v62, v63
v_cvt_pk_bf16_f32 v221, v222, v223
v_pk_mul_f32 v[72:73], v[72:73], v[100:101] op_sel:[0,1] op_sel_hi:[1,1]
v_pk_mul_f32 v[74:75], v[74:75], v[100:101] op_sel:[0,1] op_sel_hi:[1,1]
v_pk_mul_f32 v[232:233], v[232:233], v[104:105] op_sel:[0,1] op_sel_hi:[1,1]
v_pk_mul_f32 v[234:235], v[234:235], v[104:105] op_sel:[0,1] op_sel_hi:[1,1]
v_cvt_pk_bf16_f32 v69, v70, v71
v_cvt_pk_bf16_f32 v229, v230, v231
v_pk_mul_f32 v[80:81], v[80:81], v[102:103] op_sel:[0,0] op_sel_hi:[1,0]
v_pk_mul_f32 v[82:83], v[82:83], v[102:103] op_sel:[0,0] op_sel_hi:[1,0]
v_pk_mul_f32 v[240:241], v[240:241], v[106:107] op_sel:[0,0] op_sel_hi:[1,0]
v_pk_mul_f32 v[242:243], v[242:243], v[106:107] op_sel:[0,0] op_sel_hi:[1,0]
v_cvt_pk_bf16_f32 v77, v78, v79
v_cvt_pk_bf16_f32 v237, v238, v239
v_pk_mul_f32 v[88:89], v[88:89], v[102:103] op_sel:[0,1] op_sel_hi:[1,1]
v_pk_mul_f32 v[90:91], v[90:91], v[102:103] op_sel:[0,1] op_sel_hi:[1,1]
v_pk_mul_f32 v[248:249], v[248:249], v[106:107] op_sel:[0,1] op_sel_hi:[1,1]
v_pk_mul_f32 v[250:251], v[250:251], v[106:107] op_sel:[0,1] op_sel_hi:[1,1]
v_cvt_pk_bf16_f32 v85, v86, v87
v_cvt_pk_bf16_f32 v245, v246, v247
v_cvt_pk_bf16_f32 v62, v64, v65
v_cvt_pk_bf16_f32 v63, v66, v67
v_cvt_pk_bf16_f32 v222, v224, v225
v_cvt_pk_bf16_f32 v223, v226, v227
v_cvt_pk_bf16_f32 v70, v72, v73
v_cvt_pk_bf16_f32 v71, v74, v75
v_cvt_pk_bf16_f32 v230, v232, v233
v_cvt_pk_bf16_f32 v231, v234, v235
v_cvt_pk_bf16_f32 v78, v80, v81
v_cvt_pk_bf16_f32 v79, v82, v83
v_cvt_pk_bf16_f32 v238, v240, v241
v_cvt_pk_bf16_f32 v239, v242, v243
v_cvt_pk_bf16_f32 v86, v88, v89
v_cvt_pk_bf16_f32 v87, v90, v91
v_cvt_pk_bf16_f32 v246, v248, v249
v_cvt_pk_bf16_f32 v247, v250, v251
s_cmp_lg_u32 s51, 0
s_cbranch_scc1 else_124
s_mov_b32 s63, 0
sent_126:
s_waitcnt vmcnt(0)
v_max_u32 v4, v212, v213
v_max3_u32 v4, v4, v214, v215
v_max3_u32 v4, v4, v216, v217
v_max3_u32 v4, v4, v218, v219
v_cmp_eq_u32 vcc, -1, v4
s_cbranch_vccz sentd_127
buffer_load_dwordx4 v[212:215], v18, s[32:35], s55 offen offset:0 sc1
buffer_load_dwordx4 v[216:219], v18, s[32:35], s55 offen offset:1024 sc1
s_add_u32 s63, s63, 1
s_cmp_lt_u32 s63, 0x80000
s_cbranch_scc1 sent_126
s_waitcnt vmcnt(0)
sentd_127:
v_mfma_f32_16x16x32_bf16 v[132:135], v[44:47], v[212:215], 0
v_mfma_f32_16x16x32_bf16 v[132:135], v[44:47], v[216:219], v[132:135]
s_mov_b32 s51, 1
s_nop 6
v_add_f32_dpp v132, v132, v132 row_ror:8 row_mask:0xf bank_mask:0xf
v_add_f32_dpp v133, v133, v133 row_ror:8 row_mask:0xf bank_mask:0xf
v_add_f32_dpp v134, v134, v134 row_ror:8 row_mask:0xf bank_mask:0xf
v_add_f32_dpp v135, v135, v135 row_ror:8 row_mask:0xf bank_mask:0xf
v_cvt_pk_bf16_f32 v132, v132, v133
v_cvt_pk_bf16_f32 v133, v134, v135
s_mov_b64 exec, 0x00ff00ff
buffer_store_dwordx2 v[132:133], v59, s[32:35], s79 offen sc1
s_mov_b64 exec, -1
buffer_load_dwordx4 v[204:207], v58, s[32:35], s56 offen sc1
buffer_load_dwordx4 v[208:211], v58, s[32:35], s57 offen sc1
else_124:
s_mov_b32 s63, 0
sent_128:
s_waitcnt vmcnt(0)
v_max_u32 v4, v204, v205
v_max3_u32 v4, v4, v206, v207
v_max3_u32 v4, v4, v208, v209
v_max3_u32 v4, v4, v210, v211
v_cmp_eq_u32 vcc, -1, v4
s_cbranch_vccz sentd_129
buffer_load_dwordx4 v[204:207], v58, s[32:35], s56 offen sc1
buffer_load_dwordx4 v[208:211], v58, s[32:35], s57 offen sc1
s_add_u32 s63, s63, 1
s_cmp_lt_u32 s63, 0x80000
s_cbranch_scc1 sent_128
s_waitcnt vmcnt(0)
sentd_129:
v_mfma_f32_16x16x32_bf16 v[112:115], v[204:207], v[60:63], 0
v_mfma_f32_16x16x32_bf16 v[116:119], v[204:207], v[68:71], 0
v_mfma_f32_16x16x32_bf16 v[120:123], v[204:207], v[76:79], 0
v_mfma_f32_16x16x32_bf16 v[124:127], v[204:207], v[84:87], 0
v_mfma_f32_16x16x32_bf16 v[112:115], v[208:211], v[220:223], v[112:115]
v_mfma_f32_16x16x32_bf16 v[116:119], v[208:211], v[228:231], v[116:119]
v_mfma_f32_16x16x32_bf16 v[120:123], v[208:211], v[236:239], v[120:123]
v_mfma_f32_16x16x32_bf16 v[124:127], v[208:211], v[244:247], v[124:127]
s_nop 4
v_add_f32 v100, v112, v113
v_add_f32 v114, v114, v115
v_add_f32 v100, v100, v114
v_add_f32 v101, v116, v117
v_add_f32 v118, v118, v119
v_add_f32 v101, v101, v118
v_add_f32 v102, v120, v121
v_add_f32 v122, v122, v123
v_add_f32 v102, v102, v122
v_add_f32 v103, v124, v125
v_add_f32 v126, v126, v127
v_add_f32 v103, v103, v126
s_nop 1
v_permlane32_swap_b32 v100, v101
v_permlane32_swap_b32 v102, v103
v_add_f32 v100, v100, v101
v_add_f32 v102, v102, v103
s_nop 1
v_permlane16_swap_b32 v100, v102
s_nop 0
v_add_f32 v100, v100, v102
v_add_f32 v100, 0x358637bd, v100
v_rcp_f32 v100, v100
s_nop 0
v_mov_b32 v102, v100
s_nop 1
v_permlane16_swap_b32 v100, v102
s_nop 0
v_mov_b32 v101, v100
v_mov_b32 v103, v102
s_nop 0
v_permlane32_swap_b32 v100, v101
v_permlane32_swap_b32 v102, v103
buffer_load_dwordx4 v[188:191], v18, s[32:35], s58 offen offset:0 sc1
buffer_load_dwordx4 v[192:195], v18, s[32:35], s58 offen offset:1024 sc1
buffer_load_dwordx4 v[196:199], v18, s[32:35], s59 offen offset:0 sc1
buffer_load_dwordx4 v[200:203], v18, s[32:35], s59 offen offset:1024 sc1
s_mov_b32 s63, 0
sent_130:
s_waitcnt vmcnt(0)
v_max_u32 v4, v188, v189
v_max3_u32 v4, v4, v190, v191
v_max3_u32 v4, v4, v192, v193
v_max3_u32 v4, v4, v194, v195
v_max3_u32 v4, v4, v196, v197
v_max3_u32 v4, v4, v198, v199
v_max3_u32 v4, v4, v200, v201
v_max3_u32 v4, v4, v202, v203
v_cmp_eq_u32 vcc, -1, v4
s_cbranch_vccz sentd_131
buffer_load_dwordx4 v[188:191], v18, s[32:35], s58 offen offset:0 sc1
buffer_load_dwordx4 v[192:195], v18, s[32:35], s58 offen offset:1024 sc1
buffer_load_dwordx4 v[196:199], v18, s[32:35], s59 offen offset:0 sc1
buffer_load_dwordx4 v[200:203], v18, s[32:35], s59 offen offset:1024 sc1
s_add_u32 s63, s63, 1
s_cmp_lt_u32 s63, 0x80000
s_cbranch_scc1 sent_130
s_waitcnt vmcnt(0)
sentd_131:
s_cmp_eq_u32 s46, 0
s_cbranch_scc1 slow_132
.p2align 3
v_mfma_f32_16x16x32_bf16 v[156:159], v[188:191], v[60:63], 0
v_mfma_f32_16x16x32_bf16 v[164:167], v[188:191], v[68:71], 0
v_mfma_f32_16x16x32_bf16 v[160:163], v[192:195], v[60:63], 0
v_mfma_f32_16x16x32_bf16 v[172:175], v[188:191], v[76:79], 0
v_mfma_f32_16x16x32_bf16 v[168:171], v[192:195], v[68:71], 0
v_mfma_f32_16x16x32_bf16 v[180:183], v[188:191], v[84:87], 0
v_mfma_f32_16x16x32_bf16 v[156:159], v[196:199], v[220:223], v[156:159]
v_mfma_f32_16x16x32_bf16 v[176:179], v[192:195], v[76:79], 0
v_mfma_f32_16x16x32_bf16 v[164:167], v[196:199], v[228:231], v[164:167]
v_mfma_f32_16x16x32_bf16 v[184:187], v[192:195], v[84:87], 0
v_mfma_f32_16x16x32_bf16 v[160:163], v[200:203], v[220:223], v[160:163]
v_mfma_f32_16x16x32_bf16 v[172:175], v[196:199], v[236:239], v[172:175]
v_mfma_f32_16x16x32_bf16 v[168:171], v[200:203], v[228:231], v[168:171]
v_mfma_f32_16x16x32_bf16 v[180:183], v[196:199], v[244:247], v[180:183]
v_mfma_f32_16x16x32_bf16 v[176:179], v[200:203], v[236:239], v[176:179]
v_mfma_f32_16x16x32_bf16 v[184:187], v[200:203], v[244:247], v[184:187]
v_pk_mul_f32 v[156:157], v[156:157], v[100:101] op_sel:[0,0] op_sel_hi:[1,0]
v_pk_mul_f32 v[158:159], v[158:159], v[100:101] op_sel:[0,0] op_sel_hi:[1,0]
v_cvt_pk_bf16_f32 v156, v156, v157
v_pk_mul_f32 v[164:165], v[164:165], v[100:101] op_sel:[0,1] op_sel_hi:[1,1]
v_pk_mul_f32 v[160:161], v[160:161], v[100:101] op_sel:[0,0] op_sel_hi:[1,0]
v_pk_mul_f32 v[162:163], v[162:163], v[100:101] op_sel:[0,0] op_sel_hi:[1,0]
v_cvt_pk_bf16_f32 v157, v158, v159
v_pk_mul_f32 v[166:167], v[166:167], v[100:101] op_sel:[0,1] op_sel_hi:[1,1]
v_cvt_pk_bf16_f32 v164, v164, v165
v_pk_mul_f32 v[172:173], v[172:173], v[102:103] op_sel:[0,0] op_sel_hi:[1,0]
v_cvt_pk_bf16_f32 v158, v160, v161
v_cvt_pk_bf16_f32 v159, v162, v163
v_pk_mul_f32 v[168:169], v[168:169], v[100:101] op_sel:[0,1] op_sel_hi:[1,1]
v_pk_mul_f32 v[170:171], v[170:171], v[100:101] op_sel:[0,1] op_sel_hi:[1,1]
v_cvt_pk_bf16_f32 v165, v166, v167
v_pk_mul_f32 v[174:175], v[174:175], v[102:103] op_sel:[0,0] op_sel_hi:[1,0]
v_cvt_pk_bf16_f32 v172, v172, v173
v_pk_mul_f32 v[180:181], v[180:181], v[102:103] op_sel:[0,1] op_sel_hi:[1,1]
buffer_store_dwordx4 v[156:159], v18, s[32:35], s80 offen
v_cvt_pk_bf16_f32 v166, v168, v169
v_cvt_pk_bf16_f32 v167, v170, v171
v_pk_mul_f32 v[176:177], v[176:177], v[102:103] op_sel:[0,0] op_sel_hi:[1,0]
v_pk_mul_f32 v[178:179], v[178:179], v[102:103] op_sel:[0,0] op_sel_hi:[1,0]
v_cvt_pk_bf16_f32 v173, v174, v175
v_pk_mul_f32 v[182:183], v[182:183], v[102:103] op_sel:[0,1] op_sel_hi:[1,1]
v_cvt_pk_bf16_f32 v180, v180, v181
buffer_store_dwordx4 v[164:167], v18, s[32:35], s81 offen
v_cvt_pk_bf16_f32 v174, v176, v177
v_cvt_pk_bf16_f32 v175, v178, v179
v_pk_mul_f32 v[184:185], v[184:185], v[102:103] op_sel:[0,1] op_sel_hi:[1,1]
v_pk_mul_f32 v[186:187], v[186:187], v[102:103] op_sel:[0,1] op_sel_hi:[1,1]
v_cvt_pk_bf16_f32 v181, v182, v183
buffer_store_dwordx4 v[172:175], v18, s[32:35], s82 offen
v_cvt_pk_bf16_f32 v182, v184, v185
v_cvt_pk_bf16_f32 v183, v186, v187
buffer_store_dwordx4 v[180:183], v18, s[32:35], s83 offen
back_133:
s_barrier
v_and_b32 v36, 31, v0
v_lshlrev_b32 v36, 2, v36
s_lshl_b32 s62, s45, 2
v_mov_b32 v4, s62
v_mov_b32 v5, 4
s_mov_b64 exec, 1
s_waitcnt vmcnt(0)
s_cmp_eq_u32 s46, 0
s_cbranch_scc1 slow_134
buffer_store_dword v5, v4, s[32:35], s84 offen
back_135:
s_mov_b64 exec, -1
v_lshrrev_b32 v4, 2, v2
v_and_b32 v5, 3, v0
v_lshl_add_u32 v6, v3, 3, v4
v_lshlrev_b32 v6, 7, v6
v_lshl_add_u32 v6, v5, 3, v6
v_lshrrev_b32 v7, 1, v4
v_and_b32 v8, 1, v3
v_lshl_add_u32 v7, v8, 1, v7
v_lshl_add_u32 v10, v7, 5, v6
v_xor_b32 v11, 32, v10
v_xor_b32 v12, 64, v10
v_xor_b32 v13, 96, v10
v_add_u32 v14, 0x10000, v10
v_add_u32 v15, 0x10000, v11
v_add_u32 v16, 0x10000, v12
v_add_u32 v17, 0x10000, v13
ds_read_b64_tr_b16 v[220:221], v10 offset:0
ds_read_b64_tr_b16 v[222:223], v10 offset:512
ds_read_b64_tr_b16 v[224:225], v11 offset:0
ds_read_b64_tr_b16 v[226:227], v11 offset:512
ds_read_b64_tr_b16 v[228:229], v12 offset:0
ds_read_b64_tr_b16 v[230:231], v12 offset:512
ds_read_b64_tr_b16 v[232:233], v13 offset:0
ds_read_b64_tr_b16 v[234:235], v13 offset:512
ds_read_b64_tr_b16 v[236:237], v10 offset:4096
ds_read_b64_tr_b16 v[238:239], v10 offset:4608
ds_read_b64_tr_b16 v[240:241], v11 offset:4096
ds_read_b64_tr_b16 v[242:243], v11 offset:4608
ds_read_b64_tr_b16 v[244:245], v12 offset:4096
ds_read_b64_tr_b16 v[246:247], v12 offset:4608
ds_read_b64_tr_b16 v[248:249], v13 offset:4096
ds_read_b64_tr_b16 v[250:251], v13 offset:4608
s_lshl_b32 s48, s41, 3
s_lshl_b32 s49, s40, 1
s_add_u32 s48, s48, s49
s_lshl_b32 s48, s48, 15
s_add_u32 s48, s48, 4194304
v_add_u32 v38, s48, v18
v_add_u32 v39, 32768, v38
s_lshl_b32 s57, s75, 11
s_add_u32 s87, s87, 262144
v_lshlrev_b32 v60, 16, v20
v_and_b32 v61, 0xffff0000, v20
v_lshlrev_b32 v62, 16, v21
v_and_b32 v63, 0xffff0000, v21
v_lshlrev_b32 v64, 16, v22
v_and_b32 v65, 0xffff0000, v22
v_lshlrev_b32 v66, 16, v23
v_and_b32 v67, 0xffff0000, v23
v_lshlrev_b32 v68, 16, v24
v_and_b32 v69, 0xffff0000, v24
v_lshlrev_b32 v70, 16, v25
v_and_b32 v71, 0xffff0000, v25
v_lshlrev_b32 v72, 16, v26
v_and_b32 v73, 0xffff0000, v26
v_lshlrev_b32 v74, 16, v27
v_and_b32 v75, 0xffff0000, v27
v_lshlrev_b32 v76, 16, v28
v_and_b32 v77, 0xffff0000, v28
v_lshlrev_b32 v78, 16, v29
v_and_b32 v79, 0xffff0000, v29
v_lshlrev_b32 v80, 16, v30
v_and_b32 v81, 0xffff0000, v30
v_lshlrev_b32 v82, 16, v31
v_and_b32 v83, 0xffff0000, v31
v_lshlrev_b32 v84, 16, v32
v_and_b32 v85, 0xffff0000, v32
v_lshlrev_b32 v86, 16, v33
v_and_b32 v87, 0xffff0000, v33
v_lshlrev_b32 v88, 16, v34
v_and_b32 v89, 0xffff0000, v34
v_lshlrev_b32 v90, 16, v35
v_and_b32 v91, 0xffff0000, v35
s_lshl_b32 s48, s40, 12
s_add_u32 s48, s48, 139264
v_lshrrev_b32 v4, 1, v2
v_lshrrev_b32 v5, 1, v3
v_xor_b32 v4, v4, v5
v_lshlrev_b32 v4, 4, v4
v_and_b32 v5, 1, v3
v_lshl_add_u32 v4, v5, 3, v4
v_lshl_add_u32 v4, v2, 7, v4
v_add_u32 v42, s48, v4
v_xor_b32 v43, 32, v42
v_xor_b32 v44, 64, v42
v_xor_b32 v45, 96, v42
v_add_u32 v46, s48, v18
s_lshl_b32 s48, s41, 7
s_lshl_b32 s49, s40, 5
s_add_u32 s48, s48, s49
s_lshl_b32 s48, s48, 11
s_lshl_b32 s49, s78, 7
s_add_u32 s48, s48, s49
s_add_u32 s49, s48, 32768
v_lshrrev_b32 v4, 3, v0
v_and_b32 v5, 7, v0
v_lshrrev_b32 v6, 1, v4
v_xor_b32 v5, v5, v6
v_lshlrev_b32 v4, 11, v4
v_lshl_add_u32 v40, v5, 4, v4
v_xor_b32 v41, 64, v40
v_add_u32 v41, 16384, v41
buffer_load_dword v37, v36, s[32:35], s84 offen sc1
s_mov_b32 s63, 0
s_waitcnt vmcnt(0)
poll_136:
v_cmp_gt_u32 vcc, 4, v37
s_cbranch_vccz polled_137
buffer_load_dword v37, v36, s[32:35], s84 offen sc1
s_add_u32 s63, s63, 1
s_cmp_lt_u32 s63, 0x80000
s_waitcnt vmcnt(0)
s_cbranch_scc1 poll_136
polled_137:
s_call_b64 s[94:95], R_oloop
s_nop 0
v_cvt_pk_bf16_f32 v20, v60, v61
v_cvt_pk_bf16_f32 v21, v62, v63
v_cvt_pk_bf16_f32 v22, v64, v65
v_cvt_pk_bf16_f32 v23, v66, v67
ds_write_b64 v42, v[20:21] offset:0
ds_write_b64 v43, v[22:23] offset:0
v_cvt_pk_bf16_f32 v24, v68, v69
v_cvt_pk_bf16_f32 v25, v70, v71
v_cvt_pk_bf16_f32 v26, v72, v73
v_cvt_pk_bf16_f32 v27, v74, v75
ds_write_b64 v44, v[24:25] offset:0
ds_write_b64 v45, v[26:27] offset:0
v_cvt_pk_bf16_f32 v28, v76, v77
v_cvt_pk_bf16_f32 v29, v78, v79
v_cvt_pk_bf16_f32 v30, v80, v81
v_cvt_pk_bf16_f32 v31, v82, v83
ds_write_b64 v42, v[28:29] offset:2048
ds_write_b64 v43, v[30:31] offset:2048
v_cvt_pk_bf16_f32 v32, v84, v85
v_cvt_pk_bf16_f32 v33, v86, v87
v_cvt_pk_bf16_f32 v34, v88, v89
v_cvt_pk_bf16_f32 v35, v90, v91
ds_write_b64 v44, v[32:33] offset:2048
ds_write_b64 v45, v[34:35] offset:2048
ds_read_b128 v[20:23], v46 offset:0
ds_read_b128 v[24:27], v46 offset:1024
ds_read_b128 v[28:31], v46 offset:2048
ds_read_b128 v[32:35], v46 offset:3072
s_waitcnt lgkmcnt(3)
buffer_store_dwordx4 v[20:23], v40, s[24:27], s48 offen sc1
s_waitcnt lgkmcnt(2)
buffer_store_dwordx4 v[24:27], v41, s[24:27], s48 offen sc1
s_waitcnt lgkmcnt(1)
buffer_store_dwordx4 v[28:31], v40, s[24:27], s49 offen sc1
s_waitcnt lgkmcnt(0)
buffer_store_dwordx4 v[32:35], v41, s[24:27], s49 offen sc1
s_endpgm
L_code_end:
again_22:
s_mov_b32 s63, 0
retry_24:
buffer_load_dwordx4 v[80:83], v37, s[32:35], 0 offen offset:0 sc1
buffer_load_dwordx4 v[84:87], v37, s[32:35], 0 offen offset:1024 sc1
buffer_load_dwordx4 v[88:91], v37, s[32:35], 0 offen offset:2048 sc1
buffer_load_dwordx4 v[92:95], v37, s[32:35], 0 offen offset:3072 sc1
s_waitcnt vmcnt(0)
v_add_f32 v80, v80, v88
v_add_f32 v81, v81, v89
v_add_f32 v82, v82, v90
v_add_f32 v83, v83, v91
v_add_f32 v84, v84, v92
v_add_f32 v85, v85, v93
v_add_f32 v86, v86, v94
v_add_f32 v87, v87, v95
v_add_f32 v80, v80, v84
v_add_f32 v81, v81, v85
v_add_f32 v82, v82, v86
v_add_f32 v83, v83, v87
s_nop 1
v_permlane32_swap_b32 v80, v81
v_permlane32_swap_b32 v82, v83
v_add_f32 v80, v80, v81
v_add_f32 v82, v82, v83
s_nop 1
v_permlane16_swap_b32 v80, v82
s_nop 0
v_add_f32 v80, v80, v82
v_cmp_u_f32 vcc, v80, v80
s_cbranch_vccz summed_23
s_add_u32 s63, s63, 1
s_cmp_lt_u32 s63, 0x10000
s_cbranch_scc1 retry_24
s_branch summed_23
again_25:
s_mov_b32 s63, 0
retry_27:
buffer_load_dwordx4 v[64:67], v38, s[32:35], 0 offen offset:0 sc1
buffer_load_dwordx4 v[68:71], v38, s[32:35], 0 offen offset:1024 sc1
buffer_load_dwordx4 v[72:75], v38, s[32:35], 0 offen offset:2048 sc1
buffer_load_dwordx4 v[76:79], v38, s[32:35], 0 offen offset:3072 sc1
s_waitcnt vmcnt(0)
v_add_f32 v64, v64, v72
v_add_f32 v65, v65, v73
v_add_f32 v66, v66, v74
v_add_f32 v67, v67, v75
v_add_f32 v68, v68, v76
v_add_f32 v69, v69, v77
v_add_f32 v70, v70, v78
v_add_f32 v71, v71, v79
v_add_f32 v64, v64, v68
v_add_f32 v65, v65, v69
v_add_f32 v66, v66, v70
v_add_f32 v67, v67, v71
s_nop 1
v_permlane32_swap_b32 v64, v65
v_permlane32_swap_b32 v66, v67
v_add_f32 v64, v64, v65
v_add_f32 v66, v66, v67
s_nop 1
v_permlane16_swap_b32 v64, v66
s_nop 0
v_add_f32 v64, v64, v66
v_cmp_u_f32 vcc, v64, v64
s_cbranch_vccz summed_26
s_add_u32 s63, s63, 1
s_cmp_lt_u32 s63, 0x10000
s_cbranch_scc1 retry_27
s_branch summed_26
again_33:
s_mov_b32 s63, 0
retry_35:
buffer_load_dwordx4 v[80:83], v37, s[32:35], 0 offen offset:0 sc1
buffer_load_dwordx4 v[84:87], v37, s[32:35], 0 offen offset:1024 sc1
buffer_load_dwordx4 v[88:91], v37, s[32:35], 0 offen offset:2048 sc1
buffer_load_dwordx4 v[92:95], v37, s[32:35], 0 offen offset:3072 sc1
s_waitcnt vmcnt(0)
v_add_f32 v80, v80, v88
v_add_f32 v81, v81, v89
v_add_f32 v82, v82, v90
v_add_f32 v83, v83, v91
v_add_f32 v84, v84, v92
v_add_f32 v85, v85, v93
v_add_f32 v86, v86, v94
v_add_f32 v87, v87, v95
v_add_f32 v80, v80, v84
v_add_f32 v81, v81, v85
v_add_f32 v82, v82, v86
v_add_f32 v83, v83, v87
s_nop 1
v_permlane32_swap_b32 v80, v81
v_permlane32_swap_b32 v82, v83
v_add_f32 v80, v80, v81
v_add_f32 v82, v82, v83
s_nop 1
v_permlane16_swap_b32 v80, v82
s_nop 0
v_add_f32 v80, v80, v82
v_cmp_u_f32 vcc, v80, v80
s_cbranch_vccz summed_34
s_add_u32 s63, s63, 1
s_cmp_lt_u32 s63, 0x10000
s_cbranch_scc1 retry_35
s_branch summed_34
again_36:
s_mov_b32 s63, 0
retry_38:
buffer_load_dwordx4 v[64:67], v38, s[32:35], 0 offen offset:0 sc1
buffer_load_dwordx4 v[68:71], v38, s[32:35], 0 offen offset:1024 sc1
buffer_load_dwordx4 v[72:75], v38, s[32:35], 0 offen offset:2048 sc1
buffer_load_dwordx4 v[76:79], v38, s[32:35], 0 offen offset:3072 sc1
s_waitcnt vmcnt(0)
v_add_f32 v64, v64, v72
v_add_f32 v65, v65, v73
v_add_f32 v66, v66, v74
v_add_f32 v67, v67, v75
v_add_f32 v68, v68, v76
v_add_f32 v69, v69, v77
v_add_f32 v70, v70, v78
v_add_f32 v71, v71, v79
v_add_f32 v64, v64, v68
v_add_f32 v65, v65, v69
v_add_f32 v66, v66, v70
v_add_f32 v67, v67, v71
s_nop 1
v_permlane32_swap_b32 v64, v65
v_permlane32_swap_b32 v66, v67
v_add_f32 v64, v64, v65
v_add_f32 v66, v66, v67
s_nop 1
v_permlane16_swap_b32 v64, v66
s_nop 0
v_add_f32 v64, v64, v66
v_cmp_u_f32 vcc, v64, v64
s_cbranch_vccz summed_37
s_add_u32 s63, s63, 1
s_cmp_lt_u32 s63, 0x10000
s_cbranch_scc1 retry_38
s_branch summed_37
again_42:
s_mov_b32 s63, 0
retry_44:
buffer_load_dwordx4 v[80:83], v37, s[32:35], 0 offen offset:0 sc1
buffer_load_dwordx4 v[84:87], v37, s[32:35], 0 offen offset:1024 sc1
buffer_load_dwordx4 v[88:91], v37, s[32:35], 0 offen offset:2048 sc1
buffer_load_dwordx4 v[92:95], v37, s[32:35], 0 offen offset:3072 sc1
s_waitcnt vmcnt(0)
v_add_f32 v80, v80, v88
v_add_f32 v81, v81, v89
v_add_f32 v82, v82, v90
v_add_f32 v83, v83, v91
v_add_f32 v84, v84, v92
v_add_f32 v85, v85, v93
v_add_f32 v86, v86, v94
v_add_f32 v87, v87, v95
v_add_f32 v80, v80, v84
v_add_f32 v81, v81, v85
v_add_f32 v82, v82, v86
v_add_f32 v83, v83, v87
s_nop 1
v_permlane32_swap_b32 v80, v81
v_permlane32_swap_b32 v82, v83
v_add_f32 v80, v80, v81
v_add_f32 v82, v82, v83
s_nop 1
v_permlane16_swap_b32 v80, v82
s_nop 0
v_add_f32 v80, v80, v82
v_cmp_u_f32 vcc, v80, v80
s_cbranch_vccz summed_43
s_add_u32 s63, s63, 1
s_cmp_lt_u32 s63, 0x10000
s_cbranch_scc1 retry_44
s_branch summed_43
again_50:
s_mov_b32 s63, 0
retry_52:
buffer_load_dwordx4 v[80:83], v37, s[32:35], 0 offen offset:0 sc1
buffer_load_dwordx4 v[84:87], v37, s[32:35], 0 offen offset:1024 sc1
buffer_load_dwordx4 v[88:91], v37, s[32:35], 0 offen offset:2048 sc1
buffer_load_dwordx4 v[92:95], v37, s[32:35], 0 offen offset:3072 sc1
s_waitcnt vmcnt(0)
v_add_f32 v80, v80, v88
v_add_f32 v81, v81, v89
v_add_f32 v82, v82, v90
v_add_f32 v83, v83, v91
v_add_f32 v84, v84, v92
v_add_f32 v85, v85, v93
v_add_f32 v86, v86, v94
v_add_f32 v87, v87, v95
v_add_f32 v80, v80, v84
v_add_f32 v81, v81, v85
v_add_f32 v82, v82, v86
v_add_f32 v83, v83, v87
s_nop 1
v_permlane32_swap_b32 v80, v81
v_permlane32_swap_b32 v82, v83
v_add_f32 v80, v80, v81
v_add_f32 v82, v82, v83
s_nop 1
v_permlane16_swap_b32 v80, v82
s_nop 0
v_add_f32 v80, v80, v82
v_cmp_u_f32 vcc, v80, v80
s_cbranch_vccz summed_51
s_add_u32 s63, s63, 1
s_cmp_lt_u32 s63, 0x10000
s_cbranch_scc1 retry_52
s_branch summed_51
slow_71:
.p2align 3
v_mfma_f32_16x16x32_bf16 v[160:163], v[120:123], v[156:159], v[44:47]
v_max_f32 v158, v192, v193
v_max_f32 v159, v194, v195
v_permlane32_swap_b32 v130, v131
s_nop 0
v_max_f32 v130, v130, v131
s_nop 2
v_max_f32 v156, v160, v161
v_max_f32 v157, v162, v163
v_max3_f32 v128, v156, v157, v158
v_max_f32 v128, v128, v159
s_nop 1
v_permlane32_swap_b32 v128, v129
s_nop 0
v_max_f32 v128, v128, v129
s_nop 1
v_permlane16_swap_b32 v128, v130
s_nop 0
v_max_f32 v128, v128, v130
v_mov_b32 v130, v128
s_nop 1
v_permlane16_swap_b32 v128, v130
s_nop 0
v_mov_b32 v129, v128
v_mov_b32 v131, v130
s_nop 0
v_permlane32_swap_b32 v128, v129
v_permlane32_swap_b32 v130, v131
v_mul_f32 v128, v128, v124
v_mul_f32 v129, v129, v125
v_pk_fma_f32 v[156:157], v[156:157], v[124:125], v[128:129] op_sel:[0,0,0] op_sel_hi:[1,0,0] neg_lo:[0,0,1] neg_hi:[0,0,1]
v_pk_fma_f32 v[158:159], v[158:159], v[124:125], v[128:129] op_sel:[0,0,0] op_sel_hi:[1,0,0] neg_lo:[0,0,1] neg_hi:[0,0,1]
v_mul_f32 v130, v130, v126
v_mul_f32 v131, v131, v127
v_exp_f32 v156, v156
v_exp_f32 v157, v157
v_exp_f32 v158, v158
v_exp_f32 v159, v159
v_pk_fma_f32 v[164:165], v[164:165], v[124:125], v[128:129] op_sel:[0,1,1] op_sel_hi:[1,1,1] neg_lo:[0,0,1] neg_hi:[0,0,1]
v_pk_fma_f32 v[166:167], v[166:167], v[124:125], v[128:129] op_sel:[0,1,1] op_sel_hi:[1,1,1] neg_lo:[0,0,1] neg_hi:[0,0,1]
v_exp_f32 v164, v164
v_exp_f32 v165, v165
v_exp_f32 v166, v166
v_exp_f32 v167, v167
v_pk_fma_f32 v[172:173], v[172:173], v[126:127], v[130:131] op_sel:[0,0,0] op_sel_hi:[1,0,0] neg_lo:[0,0,1] neg_hi:[0,0,1]
v_pk_fma_f32 v[174:175], v[174:175], v[126:127], v[130:131] op_sel:[0,0,0] op_sel_hi:[1,0,0] neg_lo:[0,0,1] neg_hi:[0,0,1]
v_cvt_pk_bf16_f32 v156, v156, v156
v_cvt_pk_bf16_f32 v157, v157, v157
v_cvt_pk_bf16_f32 v158, v158, v158
v_cvt_pk_bf16_f32 v159, v159, v159
v_exp_f32 v172, v172
v_exp_f32 v173, v173
v_exp_f32 v174, v174
v_exp_f32 v175, v175
v_pk_fma_f32 v[180:181], v[180:181], v[126:127], v[130:131] op_sel:[0,1,1] op_sel_hi:[1,1,1] neg_lo:[0,0,1] neg_hi:[0,0,1]
v_pk_fma_f32 v[182:183], v[182:183], v[126:127], v[130:131] op_sel:[0,1,1] op_sel_hi:[1,1,1] neg_lo:[0,0,1] neg_hi:[0,0,1]
v_and_b32 v156, v52, v156
v_and_b32 v157, v52, v157
v_and_b32 v158, v52, v158
v_and_b32 v159, v52, v159
v_cvt_pk_bf16_f32 v164, v164, v164
v_cvt_pk_bf16_f32 v165, v165, v165
v_mfma_f32_16x16x32_bf16 v[160:163], v[48:51], v[156:159], 0
v_cvt_pk_bf16_f32 v166, v166, v166
v_cvt_pk_bf16_f32 v167, v167, v167
v_mfma_f32_16x16x32_bf16 v[220:223], v[100:103], v[156:159], 0
v_exp_f32 v180, v180
v_mfma_f32_16x16x32_bf16 v[224:227], v[110:113], v[156:159], 0
v_exp_f32 v181, v181
v_exp_f32 v182, v182
v_exp_f32 v183, v183
v_and_b32 v164, v52, v164
v_and_b32 v165, v52, v165
v_and_b32 v166, v52, v166
v_and_b32 v167, v52, v167
v_cvt_pk_bf16_f32 v172, v172, v172
v_cvt_pk_bf16_f32 v173, v173, v173
v_mfma_f32_16x16x32_bf16 v[168:171], v[48:51], v[164:167], 0
v_cvt_pk_bf16_f32 v174, v174, v174
v_cvt_pk_bf16_f32 v175, v175, v175
v_mfma_f32_16x16x32_bf16 v[228:231], v[102:105], v[164:167], 0
v_and_b32 v172, v52, v172
v_and_b32 v173, v52, v173
v_mfma_f32_16x16x32_bf16 v[232:235], v[112:115], v[164:167], 0
v_and_b32 v174, v52, v174
v_and_b32 v175, v52, v175
v_cvt_pk_bf16_f32 v180, v180, v180
v_cvt_pk_bf16_f32 v181, v181, v181
v_mfma_f32_16x16x32_bf16 v[176:179], v[48:51], v[172:175], 0
v_cvt_pk_bf16_f32 v182, v182, v182
v_cvt_pk_bf16_f32 v183, v183, v183
v_mfma_f32_16x16x32_bf16 v[236:239], v[104:107], v[172:175], 0
v_and_b32 v180, v52, v180
v_and_b32 v181, v52, v181
v_mfma_f32_16x16x32_bf16 v[240:243], v[114:117], v[172:175], 0
v_and_b32 v182, v52, v182
v_and_b32 v183, v52, v183
v_rcp_f32 v160, v160
v_rcp_f32 v168, v168
v_pk_mul_f32 v[220:221], v[220:221], v[160:161] op_sel:[0,0] op_sel_hi:[1,0]
v_pk_mul_f32 v[222:223], v[222:223], v[160:161] op_sel:[0,0] op_sel_hi:[1,0]
v_pk_mul_f32 v[228:229], v[228:229], v[168:169] op_sel:[0,0] op_sel_hi:[1,0]
v_pk_mul_f32 v[224:225], v[224:225], v[160:161] op_sel:[0,0] op_sel_hi:[1,0]
v_pk_mul_f32 v[226:227], v[226:227], v[160:161] op_sel:[0,0] op_sel_hi:[1,0]
v_pk_mul_f32 v[230:231], v[230:231], v[168:169] op_sel:[0,0] op_sel_hi:[1,0]
v_pk_mul_f32 v[232:233], v[232:233], v[168:169] op_sel:[0,0] op_sel_hi:[1,0]
v_pk_mul_f32 v[234:235], v[234:235], v[168:169] op_sel:[0,0] op_sel_hi:[1,0]
v_mfma_f32_16x16x32_bf16 v[184:187], v[48:51], v[180:183], 0
v_rcp_f32_e64 v176, v176
v_cvt_pk_bf16_f32 v220, v220, v221
v_cvt_pk_bf16_f32 v221, v222, v223
v_cvt_pk_bf16_f32 v228, v228, v229
v_pk_mul_f32 v[236:237], v[236:237], v[176:177] op_sel:[0,0] op_sel_hi:[1,0]
v_mfma_f32_16x16x32_bf16 v[244:247], v[106:109], v[180:183], 0
v_cvt_pk_bf16_f32 v222, v224, v225
v_cvt_pk_bf16_f32 v223, v226, v227
v_rcp_f32_e64 v184, v184
v_cvt_pk_bf16_f32 v229, v230, v231
v_pk_mul_f32 v[238:239], v[238:239], v[176:177] op_sel:[0,0] op_sel_hi:[1,0]
v_pk_mul_f32 v[240:241], v[240:241], v[176:177] op_sel:[0,0] op_sel_hi:[1,0]
v_pk_mul_f32 v[242:243], v[242:243], v[176:177] op_sel:[0,0] op_sel_hi:[1,0]
v_cvt_pk_bf16_f32 v236, v236, v237
v_pk_mul_f32 v[244:245], v[244:245], v[184:185] op_sel:[0,0] op_sel_hi:[1,0]
v_pk_mul_f32 v[246:247], v[246:247], v[184:185] op_sel:[0,0] op_sel_hi:[1,0]
v_mfma_f32_16x16x32_bf16 v[248:251], v[116:119], v[180:183], 0
buffer_store_dwordx4 v[220:223], v18, s[32:35], s80 offen sc1
v_cvt_pk_bf16_f32 v230, v232, v233
v_cvt_pk_bf16_f32 v231, v234, v235
v_cvt_pk_bf16_f32 v237, v238, v239
v_cvt_pk_bf16_f32 v244, v244, v245
buffer_store_dwordx4 v[228:231], v18, s[32:35], s81 offen sc1
v_cvt_pk_bf16_f32 v238, v240, v241
v_cvt_pk_bf16_f32 v239, v242, v243
v_pk_mul_f32 v[248:249], v[248:249], v[184:185] op_sel:[0,0] op_sel_hi:[1,0]
v_pk_mul_f32 v[250:251], v[250:251], v[184:185] op_sel:[0,0] op_sel_hi:[1,0]
v_cvt_pk_bf16_f32 v245, v246, v247
buffer_store_dwordx4 v[236:239], v18, s[32:35], s82 offen sc1
v_cvt_pk_bf16_f32 v246, v248, v249
v_cvt_pk_bf16_f32 v247, v250, v251
buffer_store_dwordx4 v[244:247], v18, s[32:35], s83 offen sc1
s_branch back_72
slow_73:
buffer_store_dword v5, v4, s[32:35], s84 offen sc1
s_branch back_74
slow_78:
s_nop 0
v_cvt_pk_bf16_f32 v20, v60, v61
v_cvt_pk_bf16_f32 v21, v62, v63
v_cvt_pk_bf16_f32 v22, v64, v65
v_cvt_pk_bf16_f32 v23, v66, v67
buffer_store_dwordx4 v[20:23], v18, s[32:35], s85 offen offset:0 sc1
v_cvt_pk_bf16_f32 v24, v68, v69
v_cvt_pk_bf16_f32 v25, v70, v71
v_cvt_pk_bf16_f32 v26, v72, v73
v_cvt_pk_bf16_f32 v27, v74, v75
buffer_store_dwordx4 v[24:27], v18, s[32:35], s85 offen offset:1024 sc1
v_cvt_pk_bf16_f32 v28, v76, v77
v_cvt_pk_bf16_f32 v29, v78, v79
v_cvt_pk_bf16_f32 v30, v80, v81
v_cvt_pk_bf16_f32 v31, v82, v83
buffer_store_dwordx4 v[28:31], v18, s[32:35], s86 offen offset:0 sc1
v_cvt_pk_bf16_f32 v32, v84, v85
v_cvt_pk_bf16_f32 v33, v86, v87
v_cvt_pk_bf16_f32 v34, v88, v89
v_cvt_pk_bf16_f32 v35, v90, v91
buffer_store_dwordx4 v[32:35], v18, s[32:35], s86 offen offset:1024 sc1
s_barrier
v_dot2c_f32_bf16 v6, v20, v48
v_dot2c_f32_bf16 v8, v20, v20
v_dot2c_f32_bf16 v7, v28, v48
v_dot2c_f32_bf16 v9, v28, v28
v_dot2c_f32_bf16 v6, v21, v48
v_dot2c_f32_bf16 v8, v21, v21
v_dot2c_f32_bf16 v7, v29, v48
v_dot2c_f32_bf16 v9, v29, v29
v_dot2c_f32_bf16 v6, v22, v48
v_dot2c_f32_bf16 v8, v22, v22
v_dot2c_f32_bf16 v7, v30, v48
v_dot2c_f32_bf16 v9, v30, v30
v_dot2c_f32_bf16 v6, v23, v48
v_dot2c_f32_bf16 v8, v23, v23
v_dot2c_f32_bf16 v7, v31, v48
v_dot2c_f32_bf16 v9, v31, v31
v_dot2c_f32_bf16 v6, v24, v48
v_dot2c_f32_bf16 v8, v24, v24
v_dot2c_f32_bf16 v7, v32, v48
v_dot2c_f32_bf16 v9, v32, v32
v_dot2c_f32_bf16 v6, v25, v48
v_dot2c_f32_bf16 v8, v25, v25
v_dot2c_f32_bf16 v7, v33, v48
v_dot2c_f32_bf16 v9, v33, v33
v_dot2c_f32_bf16 v6, v26, v48
v_dot2c_f32_bf16 v8, v26, v26
v_dot2c_f32_bf16 v7, v34, v48
v_dot2c_f32_bf16 v9, v34, v34
v_dot2c_f32_bf16 v6, v27, v48
v_dot2c_f32_bf16 v8, v27, v27
v_dot2c_f32_bf16 v7, v35, v48
v_dot2c_f32_bf16 v9, v35, v35
s_mov_b64 exec, 1
s_waitcnt vmcnt(0)
buffer_store_dword v5, v4, s[32:35], s88 offen sc1
s_mov_b64 exec, -1
s_nop 1
v_permlane32_swap_b32 v6, v7
v_permlane32_swap_b32 v8, v9
v_add_f32 v6, v6, v7
v_add_f32 v8, v8, v9
s_nop 1
v_permlane16_swap_b32 v6, v8
s_nop 0
v_add_f32 v6, v6, v8
buffer_store_dword v6, v1, s[32:35], s87 offen sc1
s_branch back_79
slow_94:
.p2align 3
v_mfma_f32_16x16x32_bf16 v[156:159], v[188:191], v[60:63], 0
v_mfma_f32_16x16x32_bf16 v[164:167], v[188:191], v[68:71], 0
v_mfma_f32_16x16x32_bf16 v[160:163], v[192:195], v[60:63], 0
v_mfma_f32_16x16x32_bf16 v[172:175], v[188:191], v[76:79], 0
v_mfma_f32_16x16x32_bf16 v[168:171], v[192:195], v[68:71], 0
v_mfma_f32_16x16x32_bf16 v[180:183], v[188:191], v[84:87], 0
v_mfma_f32_16x16x32_bf16 v[156:159], v[196:199], v[220:223], v[156:159]
v_mfma_f32_16x16x32_bf16 v[176:179], v[192:195], v[76:79], 0
v_mfma_f32_16x16x32_bf16 v[164:167], v[196:199], v[228:231], v[164:167]
v_mfma_f32_16x16x32_bf16 v[184:187], v[192:195], v[84:87], 0
v_mfma_f32_16x16x32_bf16 v[160:163], v[200:203], v[220:223], v[160:163]
v_mfma_f32_16x16x32_bf16 v[172:175], v[196:199], v[236:239], v[172:175]
v_mfma_f32_16x16x32_bf16 v[168:171], v[200:203], v[228:231], v[168:171]
v_mfma_f32_16x16x32_bf16 v[180:183], v[196:199], v[244:247], v[180:183]
v_mfma_f32_16x16x32_bf16 v[176:179], v[200:203], v[236:239], v[176:179]
v_mfma_f32_16x16x32_bf16 v[184:187], v[200:203], v[244:247], v[184:187]
v_pk_mul_f32 v[156:157], v[156:157], v[100:101] op_sel:[0,0] op_sel_hi:[1,0]
v_pk_mul_f32 v[158:159], v[158:159], v[100:101] op_sel:[0,0] op_sel_hi:[1,0]
v_cvt_pk_bf16_f32 v156, v156, v157
v_pk_mul_f32 v[164:165], v[164:165], v[100:101] op_sel:[0,1] op_sel_hi:[1,1]
v_pk_mul_f32 v[160:161], v[160:161], v[100:101] op_sel:[0,0] op_sel_hi:[1,0]
v_pk_mul_f32 v[162:163], v[162:163], v[100:101] op_sel:[0,0] op_sel_hi:[1,0]
v_cvt_pk_bf16_f32 v157, v158, v159
v_pk_mul_f32 v[166:167], v[166:167], v[100:101] op_sel:[0,1] op_sel_hi:[1,1]
v_cvt_pk_bf16_f32 v164, v164, v165
v_pk_mul_f32 v[172:173], v[172:173], v[102:103] op_sel:[0,0] op_sel_hi:[1,0]
v_cvt_pk_bf16_f32 v158, v160, v161
v_cvt_pk_bf16_f32 v159, v162, v163
v_pk_mul_f32 v[168:169], v[168:169], v[100:101] op_sel:[0,1] op_sel_hi:[1,1]
v_pk_mul_f32 v[170:171], v[170:171], v[100:101] op_sel:[0,1] op_sel_hi:[1,1]
v_cvt_pk_bf16_f32 v165, v166, v167
v_pk_mul_f32 v[174:175], v[174:175], v[102:103] op_sel:[0,0] op_sel_hi:[1,0]
v_cvt_pk_bf16_f32 v172, v172, v173
v_pk_mul_f32 v[180:181], v[180:181], v[102:103] op_sel:[0,1] op_sel_hi:[1,1]
buffer_store_dwordx4 v[156:159], v18, s[32:35], s80 offen sc1
v_cvt_pk_bf16_f32 v166, v168, v169
v_cvt_pk_bf16_f32 v167, v170, v171
v_pk_mul_f32 v[176:177], v[176:177], v[102:103] op_sel:[0,0] op_sel_hi:[1,0]
v_pk_mul_f32 v[178:179], v[178:179], v[102:103] op_sel:[0,0] op_sel_hi:[1,0]
v_cvt_pk_bf16_f32 v173, v174, v175
v_pk_mul_f32 v[182:183], v[182:183], v[102:103] op_sel:[0,1] op_sel_hi:[1,1]
v_cvt_pk_bf16_f32 v180, v180, v181
buffer_store_dwordx4 v[164:167], v18, s[32:35], s81 offen sc1
v_cvt_pk_bf16_f32 v174, v176, v177
v_cvt_pk_bf16_f32 v175, v178, v179
v_pk_mul_f32 v[184:185], v[184:185], v[102:103] op_sel:[0,1] op_sel_hi:[1,1]
v_pk_mul_f32 v[186:187], v[186:187], v[102:103] op_sel:[0,1] op_sel_hi:[1,1]
v_cvt_pk_bf16_f32 v181, v182, v183
buffer_store_dwordx4 v[172:175], v18, s[32:35], s82 offen sc1
v_cvt_pk_bf16_f32 v182, v184, v185
v_cvt_pk_bf16_f32 v183, v186, v187
buffer_store_dwordx4 v[180:183], v18, s[32:35], s83 offen sc1
s_branch back_95
slow_96:
buffer_store_dword v5, v4, s[32:35], s84 offen sc1
s_branch back_97
slow_100:
s_nop 0
v_cvt_pk_bf16_f32 v20, v60, v61
v_cvt_pk_bf16_f32 v21, v62, v63
v_cvt_pk_bf16_f32 v22, v64, v65
v_cvt_pk_bf16_f32 v23, v66, v67
buffer_store_dwordx4 v[20:23], v18, s[32:35], s85 offen offset:0 sc1
v_cvt_pk_bf16_f32 v24, v68, v69
v_cvt_pk_bf16_f32 v25, v70, v71
v_cvt_pk_bf16_f32 v26, v72, v73
v_cvt_pk_bf16_f32 v27, v74, v75
buffer_store_dwordx4 v[24:27], v18, s[32:35], s85 offen offset:1024 sc1
v_cvt_pk_bf16_f32 v28, v76, v77
v_cvt_pk_bf16_f32 v29, v78, v79
v_cvt_pk_bf16_f32 v30, v80, v81
v_cvt_pk_bf16_f32 v31, v82, v83
buffer_store_dwordx4 v[28:31], v18, s[32:35], s86 offen offset:0 sc1
v_cvt_pk_bf16_f32 v32, v84, v85
v_cvt_pk_bf16_f32 v33, v86, v87
v_cvt_pk_bf16_f32 v34, v88, v89
v_cvt_pk_bf16_f32 v35, v90, v91
buffer_store_dwordx4 v[32:35], v18, s[32:35], s86 offen offset:1024 sc1
s_barrier
v_dot2c_f32_bf16 v6, v20, v48
v_dot2c_f32_bf16 v8, v20, v20
v_dot2c_f32_bf16 v7, v28, v48
v_dot2c_f32_bf16 v9, v28, v28
v_dot2c_f32_bf16 v6, v21, v48
v_dot2c_f32_bf16 v8, v21, v21
v_dot2c_f32_bf16 v7, v29, v48
v_dot2c_f32_bf16 v9, v29, v29
v_dot2c_f32_bf16 v6, v22, v48
v_dot2c_f32_bf16 v8, v22, v22
v_dot2c_f32_bf16 v7, v30, v48
v_dot2c_f32_bf16 v9, v30, v30
v_dot2c_f32_bf16 v6, v23, v48
v_dot2c_f32_bf16 v8, v23, v23
v_dot2c_f32_bf16 v7, v31, v48
v_dot2c_f32_bf16 v9, v31, v31
v_dot2c_f32_bf16 v6, v24, v48
v_dot2c_f32_bf16 v8, v24, v24
v_dot2c_f32_bf16 v7, v32, v48
v_dot2c_f32_bf16 v9, v32, v32
v_dot2c_f32_bf16 v6, v25, v48
v_dot2c_f32_bf16 v8, v25, v25
v_dot2c_f32_bf16 v7, v33, v48
v_dot2c_f32_bf16 v9, v33, v33
v_dot2c_f32_bf16 v6, v26, v48
v_dot2c_f32_bf16 v8, v26, v26
v_dot2c_f32_bf16 v7, v34, v48
v_dot2c_f32_bf16 v9, v34, v34
v_dot2c_f32_bf16 v6, v27, v48
v_dot2c_f32_bf16 v8, v27, v27
v_dot2c_f32_bf16 v7, v35, v48
v_dot2c_f32_bf16 v9, v35, v35
s_mov_b64 exec, 1
s_waitcnt vmcnt(0)
buffer_store_dword v5, v4, s[32:35], s88 offen sc1
s_mov_b64 exec, -1
s_nop 1
v_permlane32_swap_b32 v6, v7
v_permlane32_swap_b32 v8, v9
v_add_f32 v6, v6, v7
v_add_f32 v8, v8, v9
s_nop 1
v_permlane16_swap_b32 v6, v8
s_nop 0
v_add_f32 v6, v6, v8
buffer_store_dword v6, v1, s[32:35], s87 offen sc1
s_branch back_101
slow_112:
.p2align 3
v_mfma_f32_16x16x32_bf16 v[160:163], v[120:123], v[156:159], v[44:47]
v_max_f32 v158, v192, v193
v_max_f32 v159, v194, v195
v_permlane32_swap_b32 v130, v131
s_nop 0
v_max_f32 v130, v130, v131
s_nop 2
v_max_f32 v156, v160, v161
v_max_f32 v157, v162, v163
v_max3_f32 v128, v156, v157, v158
v_max_f32 v128, v128, v159
s_nop 1
v_permlane32_swap_b32 v128, v129
s_nop 0
v_max_f32 v128, v128, v129
s_nop 1
v_permlane16_swap_b32 v128, v130
s_nop 0
v_max_f32 v128, v128, v130
v_mov_b32 v130, v128
s_nop 1
v_permlane16_swap_b32 v128, v130
s_nop 0
v_mov_b32 v129, v128
v_mov_b32 v131, v130
s_nop 0
v_permlane32_swap_b32 v128, v129
v_permlane32_swap_b32 v130, v131
v_mul_f32 v128, v128, v124
v_mul_f32 v129, v129, v125
v_pk_fma_f32 v[156:157], v[156:157], v[124:125], v[128:129] op_sel:[0,0,0] op_sel_hi:[1,0,0] neg_lo:[0,0,1] neg_hi:[0,0,1]
v_pk_fma_f32 v[158:159], v[158:159], v[124:125], v[128:129] op_sel:[0,0,0] op_sel_hi:[1,0,0] neg_lo:[0,0,1] neg_hi:[0,0,1]
v_mul_f32 v130, v130, v126
v_mul_f32 v131, v131, v127
v_exp_f32 v156, v156
v_exp_f32 v157, v157
v_exp_f32 v158, v158
v_exp_f32 v159, v159
v_pk_fma_f32 v[164:165], v[164:165], v[124:125], v[128:129] op_sel:[0,1,1] op_sel_hi:[1,1,1] neg_lo:[0,0,1] neg_hi:[0,0,1]
v_pk_fma_f32 v[166:167], v[166:167], v[124:125], v[128:129] op_sel:[0,1,1] op_sel_hi:[1,1,1] neg_lo:[0,0,1] neg_hi:[0,0,1]
v_exp_f32 v164, v164
v_exp_f32 v165, v165
v_exp_f32 v166, v166
v_exp_f32 v167, v167
v_pk_fma_f32 v[172:173], v[172:173], v[126:127], v[130:131] op_sel:[0,0,0] op_sel_hi:[1,0,0] neg_lo:[0,0,1] neg_hi:[0,0,1]
v_pk_fma_f32 v[174:175], v[174:175], v[126:127], v[130:131] op_sel:[0,0,0] op_sel_hi:[1,0,0] neg_lo:[0,0,1] neg_hi:[0,0,1]
v_cvt_pk_bf16_f32 v156, v156, v156
v_cvt_pk_bf16_f32 v157, v157, v157
v_cvt_pk_bf16_f32 v158, v158, v158
v_cvt_pk_bf16_f32 v159, v159, v159
v_exp_f32 v172, v172
v_exp_f32 v173, v173
v_exp_f32 v174, v174
v_exp_f32 v175, v175
v_pk_fma_f32 v[180:181], v[180:181], v[126:127], v[130:131] op_sel:[0,1,1] op_sel_hi:[1,1,1] neg_lo:[0,0,1] neg_hi:[0,0,1]
v_pk_fma_f32 v[182:183], v[182:183], v[126:127], v[130:131] op_sel:[0,1,1] op_sel_hi:[1,1,1] neg_lo:[0,0,1] neg_hi:[0,0,1]
v_and_b32 v156, v52, v156
v_and_b32 v157, v52, v157
v_and_b32 v158, v52, v158
v_and_b32 v159, v52, v159
v_cvt_pk_bf16_f32 v164, v164, v164
v_cvt_pk_bf16_f32 v165, v165, v165
v_mfma_f32_16x16x32_bf16 v[160:163], v[48:51], v[156:159], 0
v_cvt_pk_bf16_f32 v166, v166, v166
v_cvt_pk_bf16_f32 v167, v167, v167
v_mfma_f32_16x16x32_bf16 v[220:223], v[100:103], v[156:159], 0
v_exp_f32 v180, v180
v_mfma_f32_16x16x32_bf16 v[224:227], v[110:113], v[156:159], 0
v_exp_f32 v181, v181
v_exp_f32 v182, v182
v_exp_f32 v183, v183
v_and_b32 v164, v52, v164
v_and_b32 v165, v52, v165
v_and_b32 v166, v52, v166
v_and_b32 v167, v52, v167
v_cvt_pk_bf16_f32 v172, v172, v172
v_cvt_pk_bf16_f32 v173, v173, v173
v_mfma_f32_16x16x32_bf16 v[168:171], v[48:51], v[164:167], 0
v_cvt_pk_bf16_f32 v174, v174, v174
v_cvt_pk_bf16_f32 v175, v175, v175
v_mfma_f32_16x16x32_bf16 v[228:231], v[102:105], v[164:167], 0
v_and_b32 v172, v52, v172
v_and_b32 v173, v52, v173
v_mfma_f32_16x16x32_bf16 v[232:235], v[112:115], v[164:167], 0
v_and_b32 v174, v52, v174
v_and_b32 v175, v52, v175
v_cvt_pk_bf16_f32 v180, v180, v180
v_cvt_pk_bf16_f32 v181, v181, v181
v_mfma_f32_16x16x32_bf16 v[176:179], v[48:51], v[172:175], 0
v_cvt_pk_bf16_f32 v182, v182, v182
v_cvt_pk_bf16_f32 v183, v183, v183
v_mfma_f32_16x16x32_bf16 v[236:239], v[104:107], v[172:175], 0
v_and_b32 v180, v52, v180
v_and_b32 v181, v52, v181
v_mfma_f32_16x16x32_bf16 v[240:243], v[114:117], v[172:175], 0
v_and_b32 v182, v52, v182
v_and_b32 v183, v52, v183
v_rcp_f32 v160, v160
v_rcp_f32 v168, v168
v_pk_mul_f32 v[220:221], v[220:221], v[160:161] op_sel:[0,0] op_sel_hi:[1,0]
v_pk_mul_f32 v[222:223], v[222:223], v[160:161] op_sel:[0,0] op_sel_hi:[1,0]
v_pk_mul_f32 v[228:229], v[228:229], v[168:169] op_sel:[0,0] op_sel_hi:[1,0]
v_pk_mul_f32 v[224:225], v[224:225], v[160:161] op_sel:[0,0] op_sel_hi:[1,0]
v_pk_mul_f32 v[226:227], v[226:227], v[160:161] op_sel:[0,0] op_sel_hi:[1,0]
v_pk_mul_f32 v[230:231], v[230:231], v[168:169] op_sel:[0,0] op_sel_hi:[1,0]
v_pk_mul_f32 v[232:233], v[232:233], v[168:169] op_sel:[0,0] op_sel_hi:[1,0]
v_pk_mul_f32 v[234:235], v[234:235], v[168:169] op_sel:[0,0] op_sel_hi:[1,0]
v_mfma_f32_16x16x32_bf16 v[184:187], v[48:51], v[180:183], 0
v_rcp_f32_e64 v176, v176
v_cvt_pk_bf16_f32 v220, v220, v221
v_cvt_pk_bf16_f32 v221, v222, v223
v_cvt_pk_bf16_f32 v228, v228, v229
v_pk_mul_f32 v[236:237], v[236:237], v[176:177] op_sel:[0,0] op_sel_hi:[1,0]
v_mfma_f32_16x16x32_bf16 v[244:247], v[106:109], v[180:183], 0
v_cvt_pk_bf16_f32 v222, v224, v225
v_cvt_pk_bf16_f32 v223, v226, v227
v_rcp_f32_e64 v184, v184
v_cvt_pk_bf16_f32 v229, v230, v231
v_pk_mul_f32 v[238:239], v[238:239], v[176:177] op_sel:[0,0] op_sel_hi:[1,0]
v_pk_mul_f32 v[240:241], v[240:241], v[176:177] op_sel:[0,0] op_sel_hi:[1,0]
v_pk_mul_f32 v[242:243], v[242:243], v[176:177] op_sel:[0,0] op_sel_hi:[1,0]
v_cvt_pk_bf16_f32 v236, v236, v237
v_pk_mul_f32 v[244:245], v[244:245], v[184:185] op_sel:[0,0] op_sel_hi:[1,0]
v_pk_mul_f32 v[246:247], v[246:247], v[184:185] op_sel:[0,0] op_sel_hi:[1,0]
v_mfma_f32_16x16x32_bf16 v[248:251], v[116:119], v[180:183], 0
buffer_store_dwordx4 v[220:223], v18, s[32:35], s80 offen sc1
v_cvt_pk_bf16_f32 v230, v232, v233
v_cvt_pk_bf16_f32 v231, v234, v235
v_cvt_pk_bf16_f32 v237, v238, v239
v_cvt_pk_bf16_f32 v244, v244, v245
buffer_store_dwordx4 v[228:231], v18, s[32:35], s81 offen sc1
v_cvt_pk_bf16_f32 v238, v240, v241
v_cvt_pk_bf16_f32 v239, v242, v243
v_pk_mul_f32 v[248:249], v[248:249], v[184:185] op_sel:[0,0] op_sel_hi:[1,0]
v_pk_mul_f32 v[250:251], v[250:251], v[184:185] op_sel:[0,0] op_sel_hi:[1,0]
v_cvt_pk_bf16_f32 v245, v246, v247
buffer_store_dwordx4 v[236:239], v18, s[32:35], s82 offen sc1
v_cvt_pk_bf16_f32 v246, v248, v249
v_cvt_pk_bf16_f32 v247, v250, v251
buffer_store_dwordx4 v[244:247], v18, s[32:35], s83 offen sc1
s_branch back_113
slow_114:
buffer_store_dword v5, v4, s[32:35], s84 offen sc1
s_branch back_115
slow_118:
s_nop 0
v_cvt_pk_bf16_f32 v20, v60, v61
v_cvt_pk_bf16_f32 v21, v62, v63
v_cvt_pk_bf16_f32 v22, v64, v65
v_cvt_pk_bf16_f32 v23, v66, v67
buffer_store_dwordx4 v[20:23], v18, s[32:35], s85 offen offset:0 sc1
v_cvt_pk_bf16_f32 v24, v68, v69
v_cvt_pk_bf16_f32 v25, v70, v71
v_cvt_pk_bf16_f32 v26, v72, v73
v_cvt_pk_bf16_f32 v27, v74, v75
buffer_store_dwordx4 v[24:27], v18, s[32:35], s85 offen offset:1024 sc1
v_cvt_pk_bf16_f32 v28, v76, v77
v_cvt_pk_bf16_f32 v29, v78, v79
v_cvt_pk_bf16_f32 v30, v80, v81
v_cvt_pk_bf16_f32 v31, v82, v83
buffer_store_dwordx4 v[28:31], v18, s[32:35], s86 offen offset:0 sc1
v_cvt_pk_bf16_f32 v32, v84, v85
v_cvt_pk_bf16_f32 v33, v86, v87
v_cvt_pk_bf16_f32 v34, v88, v89
v_cvt_pk_bf16_f32 v35, v90, v91
buffer_store_dwordx4 v[32:35], v18, s[32:35], s86 offen offset:1024 sc1
s_barrier
v_dot2c_f32_bf16 v6, v20, v48
v_dot2c_f32_bf16 v8, v20, v20
v_dot2c_f32_bf16 v7, v28, v48
v_dot2c_f32_bf16 v9, v28, v28
v_dot2c_f32_bf16 v6, v21, v48
v_dot2c_f32_bf16 v8, v21, v21
v_dot2c_f32_bf16 v7, v29, v48
v_dot2c_f32_bf16 v9, v29, v29
v_dot2c_f32_bf16 v6, v22, v48
v_dot2c_f32_bf16 v8, v22, v22
v_dot2c_f32_bf16 v7, v30, v48
v_dot2c_f32_bf16 v9, v30, v30
v_dot2c_f32_bf16 v6, v23, v48
v_dot2c_f32_bf16 v8, v23, v23
v_dot2c_f32_bf16 v7, v31, v48
v_dot2c_f32_bf16 v9, v31, v31
v_dot2c_f32_bf16 v6, v24, v48
v_dot2c_f32_bf16 v8, v24, v24
v_dot2c_f32_bf16 v7, v32, v48
v_dot2c_f32_bf16 v9, v32, v32
v_dot2c_f32_bf16 v6, v25, v48
v_dot2c_f32_bf16 v8, v25, v25
v_dot2c_f32_bf16 v7, v33, v48
v_dot2c_f32_bf16 v9, v33, v33
v_dot2c_f32_bf16 v6, v26, v48
v_dot2c_f32_bf16 v8, v26, v26
v_dot2c_f32_bf16 v7, v34, v48
v_dot2c_f32_bf16 v9, v34, v34
v_dot2c_f32_bf16 v6, v27, v48
v_dot2c_f32_bf16 v8, v27, v27
v_dot2c_f32_bf16 v7, v35, v48
v_dot2c_f32_bf16 v9, v35, v35
s_mov_b64 exec, 1
s_waitcnt vmcnt(0)
buffer_store_dword v5, v4, s[32:35], s88 offen sc1
s_mov_b64 exec, -1
s_nop 1
v_permlane32_swap_b32 v6, v7
v_permlane32_swap_b32 v8, v9
v_add_f32 v6, v6, v7
v_add_f32 v8, v8, v9
s_nop 1
v_permlane16_swap_b32 v6, v8
s_nop 0
v_add_f32 v6, v6, v8
buffer_store_dword v6, v1, s[32:35], s87 offen sc1
s_branch back_119
slow_132:
.p2align 3
v_mfma_f32_16x16x32_bf16 v[156:159], v[188:191], v[60:63], 0
v_mfma_f32_16x16x32_bf16 v[164:167], v[188:191], v[68:71], 0
v_mfma_f32_16x16x32_bf16 v[160:163], v[192:195], v[60:63], 0
v_mfma_f32_16x16x32_bf16 v[172:175], v[188:191], v[76:79], 0
v_mfma_f32_16x16x32_bf16 v[168:171], v[192:195], v[68:71], 0
v_mfma_f32_16x16x32_bf16 v[180:183], v[188:191], v[84:87], 0
v_mfma_f32_16x16x32_bf16 v[156:159], v[196:199], v[220:223], v[156:159]
v_mfma_f32_16x16x32_bf16 v[176:179], v[192:195], v[76:79], 0
v_mfma_f32_16x16x32_bf16 v[164:167], v[196:199], v[228:231], v[164:167]
v_mfma_f32_16x16x32_bf16 v[184:187], v[192:195], v[84:87], 0
v_mfma_f32_16x16x32_bf16 v[160:163], v[200:203], v[220:223], v[160:163]
v_mfma_f32_16x16x32_bf16 v[172:175], v[196:199], v[236:239], v[172:175]
v_mfma_f32_16x16x32_bf16 v[168:171], v[200:203], v[228:231], v[168:171]
v_mfma_f32_16x16x32_bf16 v[180:183], v[196:199], v[244:247], v[180:183]
v_mfma_f32_16x16x32_bf16 v[176:179], v[200:203], v[236:239], v[176:179]
v_mfma_f32_16x16x32_bf16 v[184:187], v[200:203], v[244:247], v[184:187]
v_pk_mul_f32 v[156:157], v[156:157], v[100:101] op_sel:[0,0] op_sel_hi:[1,0]
v_pk_mul_f32 v[158:159], v[158:159], v[100:101] op_sel:[0,0] op_sel_hi:[1,0]
v_cvt_pk_bf16_f32 v156, v156, v157
v_pk_mul_f32 v[164:165], v[164:165], v[100:101] op_sel:[0,1] op_sel_hi:[1,1]
v_pk_mul_f32 v[160:161], v[160:161], v[100:101] op_sel:[0,0] op_sel_hi:[1,0]
v_pk_mul_f32 v[162:163], v[162:163], v[100:101] op_sel:[0,0] op_sel_hi:[1,0]
v_cvt_pk_bf16_f32 v157, v158, v159
v_pk_mul_f32 v[166:167], v[166:167], v[100:101] op_sel:[0,1] op_sel_hi:[1,1]
v_cvt_pk_bf16_f32 v164, v164, v165
v_pk_mul_f32 v[172:173], v[172:173], v[102:103] op_sel:[0,0] op_sel_hi:[1,0]
v_cvt_pk_bf16_f32 v158, v160, v161
v_cvt_pk_bf16_f32 v159, v162, v163
v_pk_mul_f32 v[168:169], v[168:169], v[100:101] op_sel:[0,1] op_sel_hi:[1,1]
v_pk_mul_f32 v[170:171], v[170:171], v[100:101] op_sel:[0,1] op_sel_hi:[1,1]
v_cvt_pk_bf16_f32 v165, v166, v167
v_pk_mul_f32 v[174:175], v[174:175], v[102:103] op_sel:[0,0] op_sel_hi:[1,0]
v_cvt_pk_bf16_f32 v172, v172, v173
v_pk_mul_f32 v[180:181], v[180:181], v[102:103] op_sel:[0,1] op_sel_hi:[1,1]
buffer_store_dwordx4 v[156:159], v18, s[32:35], s80 offen sc1
v_cvt_pk_bf16_f32 v166, v168, v169
v_cvt_pk_bf16_f32 v167, v170, v171
v_pk_mul_f32 v[176:177], v[176:177], v[102:103] op_sel:[0,0] op_sel_hi:[1,0]
v_pk_mul_f32 v[178:179], v[178:179], v[102:103] op_sel:[0,0] op_sel_hi:[1,0]
v_cvt_pk_bf16_f32 v173, v174, v175
v_pk_mul_f32 v[182:183], v[182:183], v[102:103] op_sel:[0,1] op_sel_hi:[1,1]
v_cvt_pk_bf16_f32 v180, v180, v181
buffer_store_dwordx4 v[164:167], v18, s[32:35], s81 offen sc1
v_cvt_pk_bf16_f32 v174, v176, v177
v_cvt_pk_bf16_f32 v175, v178, v179
v_pk_mul_f32 v[184:185], v[184:185], v[102:103] op_sel:[0,1] op_sel_hi:[1,1]
v_pk_mul_f32 v[186:187], v[186:187], v[102:103] op_sel:[0,1] op_sel_hi:[1,1]
v_cvt_pk_bf16_f32 v181, v182, v183
buffer_store_dwordx4 v[172:175], v18, s[32:35], s82 offen sc1
v_cvt_pk_bf16_f32 v182, v184, v185
v_cvt_pk_bf16_f32 v183, v186, v187
buffer_store_dwordx4 v[180:183], v18, s[32:35], s83 offen sc1
s_branch back_133
slow_134:
buffer_store_dword v5, v4, s[32:35], s84 offen sc1
s_branch back_135
s_endpgm
.section .rodata,"a"
.p2align 6
.amdhsa_kernel interleave_layers__sliding_local_dilated__linear_kernel_hedgehog__prompt_kernel
  .amdhsa_next_free_vgpr 256
  .amdhsa_next_free_sgpr 102
  .amdhsa_accum_offset 256
  .amdhsa_group_segment_fixed_size 0
  .amdhsa_kernarg_size 80
  .amdhsa_user_sgpr_count 2
  .amdhsa_user_sgpr_kernarg_segment_ptr 1
  .amdhsa_system_sgpr_workgroup_id_x 1
.end_amdhsa_kernel
```

```asm
; @launch grid=(256,1,1) block=(512,1,1) lds=163840
.amdgcn_target "amdgcn-amd-amdhsa--gfx950"
.text
.globl interleave_layers__sliding_local_dilated__linear_kernel_hedgehog__prompt_kernel
.p2align 8
.type interleave_layers__sliding_local_dilated__linear_kernel_hedgehog__prompt_kernel,@function
interleave_layers__sliding_local_dilated__linear_kernel_hedgehog__prompt_kernel:
s_cmp_ge_u32 s2, 256
s_cbranch_scc1 L_end
s_load_dwordx16 s[4:19], s[0:1], 0
s_load_dwordx4 s[20:23], s[0:1], 64
v_lshrrev_b32 v1, 6, v0
v_and_b32 v0, 63, v0
v_readfirstlane_b32 s40, v1
v_and_b32 v2, 15, v0
v_lshrrev_b32 v3, 4, v0
v_lshlrev_b32 v18, 4, v0
s_and_b32 s48, s2, 7
s_lshr_b32 s49, s2, 3
s_and_b32 s74, s49, 1
s_lshl_b32 s41, s48, 1
s_add_u32 s41, s41, s74
s_lshr_b32 s42, s49, 1
s_and_b32 s48, s2, 7
s_lshr_b32 s47, s42, 2
s_add_u32 s47, s47, s48
s_and_b32 s47, s47, 3
s_and_b32 s43, s40, 3
s_lshl_b32 s70, s43, 12
s_lshl_b32 s71, s43, 11
s_add_u32 s71, s71, 16384
s_cmp_lt_u32 s40, 4
s_cbranch_scc1 L_compute
v_lshrrev_b32 v4, 3, v0
v_and_b32 v5, 7, v0
s_lshl_b32 s48, s43, 4
v_add_u32 v6, s48, v4
s_lshl_b32 s48, s42, 7
s_mov_b32 s49, 6144
v_mul_u32_u24 v6, s49, v6
v_and_b32 v7, 2, v4
v_xor_b32 v7, v7, v5
v_lshl_add_u32 v26, v7, 4, v6
v_add_u32 v26, s48, v26
s_mul_i32 s49, s49, 8
s_sub_u32 s49, s49, 1024
v_xor_b32 v27, 64, v26
v_add_u32 v27, s49, v27
s_mov_b32 s53, 2048
s_mov_b32 s54, 393216
s_mov_b32 s57, 131072
s_lshl_b32 s48, s41, 7
s_lshl_b32 s49, s43, 5
s_add_u32 s48, s48, s49
v_add_u32 v6, s48, v4
v_lshlrev_b32 v6, 11, v6
v_lshrrev_b32 v7, 1, v4
v_xor_b32 v7, v7, v5
v_lshl_add_u32 v20, v7, 4, v6
v_xor_b32 v21, 64, v20
v_add_u32 v21, 15360, v21
v_add_u32 v22, 30720, v20
v_add_u32 v23, 30720, v21
s_add_u32 s69, s47, 0
s_and_b32 s69, s69, 3
s_add_u32 s69, s69, 0
s_mul_i32 s67, s69, 128
s_mul_i32 s68, s69, s54
s_waitcnt lgkmcnt(0)
s_mov_b32 s24, s4
s_and_b32 s25, s5, 0xffff
s_mov_b32 s26, 4194304
s_mov_b32 s27, 0x00020000
s_mov_b32 s28, s6
s_and_b32 s29, s7, 0xffff
s_mov_b32 s30, 6291456
s_mov_b32 s31, 0x00020000
s_add_u32 m0, s70, 0
s_nop 0
buffer_load_dwordx4 v20, s[24:27], s67 offen offset:0  lds
buffer_load_dwordx4 v21, s[24:27], s67 offen offset:1024  lds
buffer_load_dwordx4 v22, s[24:27], s67 offen offset:2048  lds
buffer_load_dwordx4 v23, s[24:27], s67 offen offset:3072  lds
s_add_u32 s60, s71, 0
s_add_u32 m0, s60, 0
s_mov_b32 s61, s68
buffer_load_dwordx4 v26, s[28:31], s61 offen lds
buffer_load_dwordx4 v27, s[28:31], s61 offen offset:1024 lds
s_add_u32 m0, s60, 8192
s_add_u32 s61, s61, s53
buffer_load_dwordx4 v26, s[28:31], s61 offen lds
buffer_load_dwordx4 v27, s[28:31], s61 offen offset:1024 lds
s_add_u32 m0, s60, 16384
s_add_u32 s61, s61, s53
buffer_load_dwordx4 v26, s[28:31], s61 offen lds
buffer_load_dwordx4 v27, s[28:31], s61 offen offset:1024 lds
s_lshr_b32 s48, s2, 2
s_and_b32 s48, s48, 1
s_lshl_b32 s48, s48, 1
s_add_u32 s48, s48, s74
s_and_b32 s49, s42, 3
s_xor_b32 s77, s48, s49
s_add_u32 s77, s77, 4
s_add_u32 s48, s47, 1
s_and_b32 s48, s48, 3
s_and_b32 s49, s77, 3
s_lshl_b32 s49, s49, 2
s_add_u32 s78, s48, s49
s_and_b32 s48, s2, 7
s_lshl_b32 s48, s48, 1
s_add_u32 s75, s78, s48
s_and_b32 s75, s75, 15
s_mov_b32 s46, 0
s_mov_b32 s32, s22
s_and_b32 s33, s23, 0xffff
s_mov_b32 s34, 268435456
s_mov_b32 s35, 0x00020000
s_mov_b32 s36, s8
s_and_b32 s37, s9, 0xffff
s_mov_b32 s38, 2097152
s_mov_b32 s39, 0x00020000
v_mov_b32 v56, -1
v_mov_b32 v57, -1
v_mov_b32 v58, -1
v_mov_b32 v59, -1
s_lshl_b32 s52, s41, 6
s_add_u32 s52, s52, s42
s_lshl_b32 s52, s52, 8
s_add_u32 s52, s52, 16777216
s_getreg_b32 s50, hwreg(HW_REG_XCC_ID)
s_and_b32 s50, s50, 7
s_lshl_b32 s50, s50, 3
s_lshl_b64 s[94:95], 1, s50
s_and_b32 s96, s2, 7
s_lshl_b32 s96, s96, 5
s_and_b32 s51, s42, 7
s_cmp_gt_u32 s51, 3
s_cselect_b32 s49, 1, 0
s_sub_u32 s49, s51, s49
s_lshl_b32 s49, s49, 1
s_add_u32 s49, s49, s74
s_lshl_b32 s49, s49, 2
s_add_u32 s49, s49, s43
s_lshr_b32 s50, s49, 4
s_lshl_b32 s50, s50, 11
s_and_b32 s49, s49, 15
s_mul_i32 s49, s49, 24576
s_add_u32 s49, s49, s50
s_and_b32 s50, s42, 8
s_or_b32 s50, s50, 3
s_and_b32 s48, s2, 7
s_lshr_b32 s76, s50, 2
s_add_u32 s76, s76, s48
s_and_b32 s76, s76, 3
s_lshl_b32 s50, s50, 7
s_add_u32 s49, s49, s50
s_and_b32 s51, s51, 3
s_cmp_eq_u32 s51, 3
s_cselect_b32 s49, 0x70000000, s49
v_mul_u32_u24 v4, 6144, v4
v_lshl_add_u32 v4, v5, 4, v4
v_lshrrev_b32 v5, 5, v0
v_lshlrev_b32 v5, 30, v5
v_add3_u32 v36, v4, v5, s49
s_mov_b32 s55, -1
s_mov_b32 s56, -1
v_lshrrev_b32 v4, 3, v0
v_and_b32 v5, 7, v0
s_lshr_b32 s48, s43, 1
s_lshl_b32 s48, s48, 5
s_and_b32 s49, s43, 1
s_lshl_b32 s49, s49, 3
s_add_u32 s48, s48, s49
v_lshrrev_b32 v6, 2, v4
v_lshlrev_b32 v6, 4, v6
v_and_b32 v7, 3, v4
v_add3_u32 v6, v6, v7, s48
s_lshl_b32 s48, s78, 7
s_mov_b32 s49, 2048
v_mul_u32_u24 v6, s49, v6
v_and_b32 v7, 2, v4
v_xor_b32 v7, v7, v5
v_lshl_add_u32 v28, v7, 4, v6
v_add_u32 v28, s48, v28
s_mul_i32 s49, s49, 4
s_sub_u32 s49, s49, 1024
v_xor_b32 v29, 64, v28
v_add_u32 v29, s49, v29
v_lshrrev_b32 v4, 3, v0
v_and_b32 v5, 7, v0
s_lshr_b32 s48, s43, 1
s_lshl_b32 s48, s48, 5
s_and_b32 s49, s43, 1
s_lshl_b32 s49, s49, 3
s_add_u32 s48, s48, s49
v_lshrrev_b32 v6, 2, v4
v_lshlrev_b32 v6, 4, v6
v_and_b32 v7, 3, v4
v_add3_u32 v6, v6, v7, s48
s_lshl_b32 s48, s42, 7
s_mov_b32 s49, 6144
s_cmp_ge_i32 s55, 0
s_cselect_b32 s48, 1024, s48
s_cselect_b32 s49, 384, s49
v_mul_u32_u24 v6, s49, v6
v_and_b32 v7, 2, v4
v_xor_b32 v7, v7, v5
v_lshl_add_u32 v60, v7, 4, v6
v_add_u32 v60, s48, v60
s_mul_i32 s49, s49, 4
s_sub_u32 s49, s49, 1024
v_xor_b32 v61, 64, v60
v_add_u32 v61, s49, v61
v_lshrrev_b32 v4, 3, v0
v_and_b32 v5, 7, v0
s_lshr_b32 s48, s43, 1
s_lshl_b32 s48, s48, 5
s_and_b32 s49, s43, 1
s_lshl_b32 s49, s49, 3
s_add_u32 s48, s48, s49
v_lshrrev_b32 v6, 2, v4
v_lshlrev_b32 v6, 4, v6
v_and_b32 v7, 3, v4
v_add3_u32 v6, v6, v7, s48
s_lshl_b32 s48, s78, 7
s_mov_b32 s49, 2048
s_cmp_ge_i32 s56, 0
s_cselect_b32 s48, 1024, s48
s_cselect_b32 s49, 128, s49
v_mul_u32_u24 v6, s49, v6
v_and_b32 v7, 2, v4
v_xor_b32 v7, v7, v5
v_lshl_add_u32 v24, v7, 4, v6
v_add_u32 v24, s48, v24
s_mul_i32 s49, s49, 4
s_sub_u32 s49, s49, 1024
v_xor_b32 v25, 64, v24
v_add_u32 v25, s49, v25
v_lshlrev_b32 v30, 2, v2
v_and_b32 v32, 7, v0
v_lshlrev_b32 v32, 5, v32
s_lshl_b32 s50, s41, 2
s_add_u32 s50, s50, s43
s_lshl_b32 s50, s50, 12
s_add_u32 s50, s50, 16777216
v_add_u32 v37, s50, v18
v_lshrrev_b32 v4, 5, v0
v_lshl_add_u32 v4, v4, 4, v2
s_lshl_b32 s48, s43, 5
v_add_u32 v4, s48, v4
v_lshlrev_b32 v49, 3, v4
v_add_u32 v49, 131072, v49
v_lshlrev_b32 v50, 2, v4
v_add_u32 v50, 132096, v50
s_lshl_b32 s79, s41, 2
s_add_u32 s79, s79, s43
s_lshl_b32 s79, s79, 7
s_add_u32 s79, s79, 18358272
s_lshl_b32 s48, s41, 3
s_lshl_b32 s49, s43, 1
s_add_u32 s48, s48, s49
s_lshl_b32 s80, s48, 15
s_lshl_b32 s49, s42, 11
s_add_u32 s81, s80, s49
s_add_u32 s81, s81, 4194304
s_add_u32 s82, s81, 32768
s_lshl_b32 s48, s43, 11
v_add_u32 v51, s48, v18
v_add_u32 v52, 0x10000, v51
v_add_u32 v14, 0x20000, v51
s_lshl_b32 s48, s2, 2
s_add_u32 s48, s48, s43
s_lshl_b32 s83, s48, 11
s_mul_i32 s87, s48, 6144
v_add_u32 v62, s83, v18
s_add_u32 s87, s87, 3072
v_add_u32 v63, s87, v18
s_and_b32 s48, s2, 7
s_add_u32 s83, s42, s48
s_and_b32 s83, s83, 7
s_mul_i32 s83, s83, 2
s_add_u32 s87, s83, 1
s_and_b32 s87, s87, 15
s_mul_i32 s83, s83, 393216
s_mul_i32 s87, s87, 393216
v_add_u32 v63, 1024, v61
s_cmp_eq_u32 s74, 0
s_cselect_b64 vcc, -1, 0
v_cndmask_b32 v63, v63, v60, vcc
s_lshr_b32 s48, s2, 4
s_and_b32 s49, s2, 7
s_add_u32 s48, s48, s49
s_mul_i32 s49, s48, 8193
s_lshr_b32 s49, s49, 16
s_mul_i32 s49, s49, 8
s_sub_u32 s88, s48, s49
s_lshr_b32 s48, s2, 3
s_lshl_b32 s48, s48, 2
s_add_u32 s48, s48, s43
s_lshl_b32 s48, s48, 14
s_add_u32 s48, s48, 384
v_lshrrev_b32 v4, 3, v0
v_and_b32 v5, 7, v0
v_lshlrev_b32 v4, 11, v4
v_lshl_add_u32 v4, v5, 4, v4
v_add_u32 v15, s48, v4
s_mul_i32 s48, s42, 163840
s_add_u32 s48, s48, 9437184
s_lshl_b32 s49, s43, 4
s_add_u32 s49, s49, s41
s_lshl_b32 s50, s49, 11
s_add_u32 s86, s48, s50
s_lshl_b32 s50, s49, 9
s_add_u32 s89, s48, s50
s_add_u32 s89, s89, 131072
v_lshlrev_b32 v39, 3, v0
s_lshl_b32 s73, s42, 2
s_add_u32 s73, s73, 0
s_lshl_b32 s73, s73, 7
s_add_u32 s73, s73, 18366464
v_mov_b32 v12, 0
s_lshl_b32 s50, s43, 12
s_add_u32 s50, s50, s52
s_add_u32 s50, s50, 262144
v_min_u32 v8, 2, v3
v_lshlrev_b32 v8, 18, v8
v_lshl_add_u32 v8, v2, 4, v8
v_add_u32 v55, s50, v8
s_lshl_b32 s50, s42, 2
s_add_u32 s50, s50, s43
s_lshl_b32 s50, s50, 12
s_add_u32 s50, s50, 17825792
v_add_u32 v38, s50, v18
v_min_u32 v4, 2, v3
v_lshlrev_b32 v4, 8, v4
v_lshl_add_u32 v4, v2, 2, v4
s_and_b32 s48, s43, 1
s_lshl_b32 s48, s48, 7
s_lshr_b32 s49, s43, 1
s_lshl_b32 s49, s49, 6
s_add_u32 s48, s48, s49
s_add_u32 s48, s48, 133120
v_add_u32 v53, s48, v4
s_getpc_b64 s[98:99]
pc_1:
s_add_u32 s98, s98, c0_last - pc_1
s_addc_u32 s99, s99, 0
s_lshr_b32 s50, s2, 3
s_lshl_b32 s50, s50, 2
s_add_u32 s50, s50, s43
s_lshl_b32 s50, s50, 7
v_and_b32 v4, 1, v0
v_lshl_add_u32 v4, v4, 6, s50
v_min_u32 v54, L_code_end - c0_last, v4
s_add_u32 s69, s47, 0
s_and_b32 s69, s69, 3
s_add_u32 s69, s69, 4
s_mul_i32 s67, s69, 128
s_mul_i32 s68, s69, s54
s_add_u32 m0, s70, 40960
s_nop 0
buffer_load_dwordx4 v20, s[24:27], s67 offen offset:0  lds
buffer_load_dwordx4 v21, s[24:27], s67 offen offset:1024  lds
buffer_load_dwordx4 v22, s[24:27], s67 offen offset:2048  lds
buffer_load_dwordx4 v23, s[24:27], s67 offen offset:3072  lds
s_add_u32 s60, s71, 40960
s_add_u32 m0, s60, 0
s_mov_b32 s61, s68
buffer_load_dwordx4 v26, s[28:31], s61 offen lds
buffer_load_dwordx4 v27, s[28:31], s61 offen offset:1024 lds
s_add_u32 m0, s60, 8192
s_add_u32 s61, s61, s53
buffer_load_dwordx4 v26, s[28:31], s61 offen lds
buffer_load_dwordx4 v27, s[28:31], s61 offen offset:1024 lds
s_add_u32 m0, s60, 16384
s_add_u32 s61, s61, s53
buffer_load_dwordx4 v26, s[28:31], s61 offen lds
buffer_load_dwordx4 v27, s[28:31], s61 offen offset:1024 lds
s_waitcnt vmcnt(10)
s_barrier
s_cmp_lg_u32 s43, 3
s_cbranch_scc1 else_2
s_atomic_add_x2 s[94:95], s[20:21], s96
else_2:
s_add_u32 s49, s76, 0
s_and_b32 s49, s49, 3
s_add_u32 s49, s49, 8
s_mul_i32 s49, s49, 393216
buffer_load_dwordx4 v[40:43], v36, s[28:31], s49 offen
s_add_u32 s49, s76, 0
s_and_b32 s49, s49, 3
s_add_u32 s49, s49, 12
s_mul_i32 s49, s49, 393216
buffer_load_dwordx4 v[40:43], v36, s[28:31], s49 offen
s_add_u32 s69, s47, 0
s_and_b32 s69, s69, 3
s_add_u32 s69, s69, 8
s_mul_i32 s67, s69, 128
s_mul_i32 s68, s69, s54
s_add_u32 m0, s70, 81920
s_nop 0
buffer_load_dwordx4 v20, s[24:27], s67 offen offset:0  lds
buffer_load_dwordx4 v21, s[24:27], s67 offen offset:1024  lds
buffer_load_dwordx4 v22, s[24:27], s67 offen offset:2048  lds
buffer_load_dwordx4 v23, s[24:27], s67 offen offset:3072  lds
s_add_u32 s60, s71, 81920
s_add_u32 m0, s60, 0
s_mov_b32 s61, s68
buffer_load_dwordx4 v26, s[28:31], s61 offen lds
buffer_load_dwordx4 v27, s[28:31], s61 offen offset:1024 lds
s_add_u32 m0, s60, 8192
s_add_u32 s61, s61, s53
buffer_load_dwordx4 v26, s[28:31], s61 offen lds
buffer_load_dwordx4 v27, s[28:31], s61 offen offset:1024 lds
s_add_u32 m0, s60, 16384
s_add_u32 s61, s61, s53
buffer_load_dwordx4 v26, s[28:31], s61 offen lds
buffer_load_dwordx4 v27, s[28:31], s61 offen offset:1024 lds
s_add_u32 s49, s76, 1
s_and_b32 s49, s49, 3
s_add_u32 s49, s49, 0
s_mul_i32 s49, s49, 393216
buffer_load_dwordx4 v[40:43], v36, s[28:31], s49 offen
s_mov_b32 s64, 0
s_mov_b32 s65, 0
s_waitcnt vmcnt(11)
s_barrier
s_add_u32 s69, s47, 0
s_and_b32 s69, s69, 3
s_add_u32 s69, s69, 12
s_mul_i32 s67, s69, 128
s_mul_i32 s68, s69, s54
s_add_u32 m0, s70, s65
s_nop 0
buffer_load_dwordx4 v20, s[24:27], s67 offen offset:0  lds
buffer_load_dwordx4 v21, s[24:27], s67 offen offset:1024  lds
buffer_load_dwordx4 v22, s[24:27], s67 offen offset:2048  lds
buffer_load_dwordx4 v23, s[24:27], s67 offen offset:3072  lds
s_add_u32 s60, s71, s65
s_add_u32 m0, s60, 0
s_mov_b32 s61, s68
buffer_load_dwordx4 v26, s[28:31], s61 offen lds
buffer_load_dwordx4 v27, s[28:31], s61 offen offset:1024 lds
s_add_u32 m0, s60, 8192
s_add_u32 s61, s61, s53
buffer_load_dwordx4 v26, s[28:31], s61 offen lds
buffer_load_dwordx4 v27, s[28:31], s61 offen offset:1024 lds
s_add_u32 m0, s60, 16384
s_add_u32 s61, s61, s53
buffer_load_dwordx4 v26, s[28:31], s61 offen lds
buffer_load_dwordx4 v27, s[28:31], s61 offen offset:1024 lds
s_add_u32 s49, s76, 1
s_and_b32 s49, s49, 3
s_add_u32 s49, s49, 4
s_mul_i32 s49, s49, 393216
buffer_load_dwordx4 v[40:43], v36, s[28:31], s49 offen
s_add_u32 s65, s65, 40960
s_cmp_eq_u32 s65, 122880
s_cselect_b32 s65, 0, s65
s_add_u32 s64, s64, 1
s_waitcnt vmcnt(11)
s_barrier
s_add_u32 s69, s47, 1
s_and_b32 s69, s69, 3
s_add_u32 s69, s69, 0
s_mul_i32 s67, s69, 128
s_mul_i32 s68, s69, s54
s_add_u32 m0, s70, s65
s_nop 0
buffer_load_dwordx4 v20, s[24:27], s67 offen offset:0  lds
buffer_load_dwordx4 v21, s[24:27], s67 offen offset:1024  lds
buffer_load_dwordx4 v22, s[24:27], s67 offen offset:2048  lds
buffer_load_dwordx4 v23, s[24:27], s67 offen offset:3072  lds
s_add_u32 s60, s71, s65
s_add_u32 m0, s60, 0
s_mov_b32 s61, s68
buffer_load_dwordx4 v26, s[28:31], s61 offen lds
buffer_load_dwordx4 v27, s[28:31], s61 offen offset:1024 lds
s_add_u32 m0, s60, 8192
s_add_u32 s61, s61, s53
buffer_load_dwordx4 v26, s[28:31], s61 offen lds
buffer_load_dwordx4 v27, s[28:31], s61 offen offset:1024 lds
s_add_u32 m0, s60, 16384
s_add_u32 s61, s61, s53
buffer_load_dwordx4 v26, s[28:31], s61 offen lds
buffer_load_dwordx4 v27, s[28:31], s61 offen offset:1024 lds
s_add_u32 s49, s76, 1
s_and_b32 s49, s49, 3
s_add_u32 s49, s49, 8
s_mul_i32 s49, s49, 393216
buffer_load_dwordx4 v[40:43], v36, s[28:31], s49 offen
s_add_u32 s65, s65, 40960
s_cmp_eq_u32 s65, 122880
s_cselect_b32 s65, 0, s65
s_add_u32 s64, s64, 1
s_waitcnt vmcnt(11)
s_barrier
s_cmp_lg_u32 s88, 0
s_cbranch_scc1 else_4
s_add_u32 s48, s75, 3
s_and_b32 s48, s48, 15
s_mul_i32 s48, s48, s57
buffer_load_dwordx4 v[136:139], v28, s[36:39], s48 offen
buffer_load_dwordx4 v[140:143], v29, s[36:39], s48 offen offset:1024
s_add_u32 s48, s75, 4
s_and_b32 s48, s48, 15
s_mul_i32 s48, s48, s57
buffer_load_dwordx4 v[144:147], v28, s[36:39], s48 offen
buffer_load_dwordx4 v[148:151], v29, s[36:39], s48 offen offset:1024
s_mov_b32 s36, s12
s_and_b32 s37, s13, 0xffff
s_mov_b32 s38, 6291456
s_mov_b32 s39, 0x00020000
s_add_u32 m0, s71, 122880
s_add_u32 s48, s83, 0
buffer_load_dwordx4 v60, s[36:39], s48 offen lds
buffer_load_dwordx4 v61, s[36:39], s48 offen offset:1024 lds
s_add_u32 m0, s71, 131072
s_add_u32 s48, s83, 2048
buffer_load_dwordx4 v60, s[36:39], s48 offen lds
buffer_load_dwordx4 v61, s[36:39], s48 offen offset:1024 lds
s_add_u32 m0, s71, 139264
s_add_u32 s48, s83, 4096
buffer_load_dwordx4 v60, s[36:39], s48 offen lds
buffer_load_dwordx4 v61, s[36:39], s48 offen offset:1024 lds
s_add_u32 s48, s87, 0
buffer_load_dwordx4 v[108:111], v63, s[36:39], s48 offen
s_add_u32 s48, s87, 2048
buffer_load_dwordx4 v[108:111], v63, s[36:39], s48 offen
s_add_u32 s48, s87, 4096
buffer_load_dwordx4 v[108:111], v63, s[36:39], s48 offen
s_mov_b32 s36, s8
s_and_b32 s37, s9, 0xffff
s_mov_b32 s38, 2097152
s_mov_b32 s39, 0x00020000
buffer_store_dwordx4 v[56:59], v18, s[32:35], s86 offen offset:0 sc1
buffer_store_dwordx4 v[56:59], v18, s[32:35], s86 offen offset:1024 sc1
buffer_store_dwordx2 v[56:57], v39, s[32:35], s89 offen sc1
buffer_store_dwordx4 v[56:59], v55, s[32:35], 0 offen sc1
else_4:
s_add_u32 s69, s47, 1
s_and_b32 s69, s69, 3
s_add_u32 s69, s69, 4
s_mul_i32 s67, s69, 128
s_mul_i32 s68, s69, s54
s_add_u32 m0, s70, s65
s_nop 0
buffer_load_dwordx4 v20, s[24:27], s67 offen offset:0  lds
buffer_load_dwordx4 v21, s[24:27], s67 offen offset:1024  lds
buffer_load_dwordx4 v22, s[24:27], s67 offen offset:2048  lds
buffer_load_dwordx4 v23, s[24:27], s67 offen offset:3072  lds
s_add_u32 s60, s71, s65
s_add_u32 m0, s60, 0
s_mov_b32 s61, s68
buffer_load_dwordx4 v26, s[28:31], s61 offen lds
buffer_load_dwordx4 v27, s[28:31], s61 offen offset:1024 lds
s_add_u32 m0, s60, 8192
s_add_u32 s61, s61, s53
buffer_load_dwordx4 v26, s[28:31], s61 offen lds
buffer_load_dwordx4 v27, s[28:31], s61 offen offset:1024 lds
s_add_u32 m0, s60, 16384
s_add_u32 s61, s61, s53
buffer_load_dwordx4 v26, s[28:31], s61 offen lds
buffer_load_dwordx4 v27, s[28:31], s61 offen offset:1024 lds
s_add_u32 s49, s76, 1
s_and_b32 s49, s49, 3
s_add_u32 s49, s49, 12
s_mul_i32 s49, s49, 393216
buffer_load_dwordx4 v[40:43], v36, s[28:31], s49 offen
s_add_u32 s65, s65, 40960
s_cmp_eq_u32 s65, 122880
s_cselect_b32 s65, 0, s65
s_add_u32 s64, s64, 1
s_waitcnt vmcnt(11)
s_barrier
s_cmp_lg_u32 s88, 1
s_cbranch_scc1 else_6
s_add_u32 s48, s75, 3
s_and_b32 s48, s48, 15
s_mul_i32 s48, s48, s57
buffer_load_dwordx4 v[136:139], v28, s[36:39], s48 offen
buffer_load_dwordx4 v[140:143], v29, s[36:39], s48 offen offset:1024
s_add_u32 s48, s75, 4
s_and_b32 s48, s48, 15
s_mul_i32 s48, s48, s57
buffer_load_dwordx4 v[144:147], v28, s[36:39], s48 offen
buffer_load_dwordx4 v[148:151], v29, s[36:39], s48 offen offset:1024
s_mov_b32 s36, s12
s_and_b32 s37, s13, 0xffff
s_mov_b32 s38, 6291456
s_mov_b32 s39, 0x00020000
s_add_u32 m0, s71, 122880
s_add_u32 s48, s83, 0
buffer_load_dwordx4 v60, s[36:39], s48 offen lds
buffer_load_dwordx4 v61, s[36:39], s48 offen offset:1024 lds
s_add_u32 m0, s71, 131072
s_add_u32 s48, s83, 2048
buffer_load_dwordx4 v60, s[36:39], s48 offen lds
buffer_load_dwordx4 v61, s[36:39], s48 offen offset:1024 lds
s_add_u32 m0, s71, 139264
s_add_u32 s48, s83, 4096
buffer_load_dwordx4 v60, s[36:39], s48 offen lds
buffer_load_dwordx4 v61, s[36:39], s48 offen offset:1024 lds
s_add_u32 s48, s87, 0
buffer_load_dwordx4 v[108:111], v63, s[36:39], s48 offen
s_add_u32 s48, s87, 2048
buffer_load_dwordx4 v[108:111], v63, s[36:39], s48 offen
s_add_u32 s48, s87, 4096
buffer_load_dwordx4 v[108:111], v63, s[36:39], s48 offen
s_mov_b32 s36, s8
s_and_b32 s37, s9, 0xffff
s_mov_b32 s38, 2097152
s_mov_b32 s39, 0x00020000
buffer_store_dwordx4 v[56:59], v18, s[32:35], s86 offen offset:0 sc1
buffer_store_dwordx4 v[56:59], v18, s[32:35], s86 offen offset:1024 sc1
buffer_store_dwordx2 v[56:57], v39, s[32:35], s89 offen sc1
buffer_store_dwordx4 v[56:59], v55, s[32:35], 0 offen sc1
else_6:
s_add_u32 s69, s47, 1
s_and_b32 s69, s69, 3
s_add_u32 s69, s69, 8
s_mul_i32 s67, s69, 128
s_mul_i32 s68, s69, s54
s_add_u32 m0, s70, s65
s_nop 0
buffer_load_dwordx4 v20, s[24:27], s67 offen offset:0  lds
buffer_load_dwordx4 v21, s[24:27], s67 offen offset:1024  lds
buffer_load_dwordx4 v22, s[24:27], s67 offen offset:2048  lds
buffer_load_dwordx4 v23, s[24:27], s67 offen offset:3072  lds
s_add_u32 s60, s71, s65
s_add_u32 m0, s60, 0
s_mov_b32 s61, s68
buffer_load_dwordx4 v26, s[28:31], s61 offen lds
buffer_load_dwordx4 v27, s[28:31], s61 offen offset:1024 lds
s_add_u32 m0, s60, 8192
s_add_u32 s61, s61, s53
buffer_load_dwordx4 v26, s[28:31], s61 offen lds
buffer_load_dwordx4 v27, s[28:31], s61 offen offset:1024 lds
s_add_u32 m0, s60, 16384
s_add_u32 s61, s61, s53
buffer_load_dwordx4 v26, s[28:31], s61 offen lds
buffer_load_dwordx4 v27, s[28:31], s61 offen offset:1024 lds
s_add_u32 s49, s76, 2
s_and_b32 s49, s49, 3
s_add_u32 s49, s49, 0
s_mul_i32 s49, s49, 393216
buffer_load_dwordx4 v[40:43], v36, s[28:31], s49 offen
s_add_u32 s65, s65, 40960
s_cmp_eq_u32 s65, 122880
s_cselect_b32 s65, 0, s65
s_add_u32 s64, s64, 1
s_waitcnt vmcnt(11)
s_barrier
s_cmp_lg_u32 s88, 2
s_cbranch_scc1 else_8
s_add_u32 s48, s75, 3
s_and_b32 s48, s48, 15
s_mul_i32 s48, s48, s57
buffer_load_dwordx4 v[136:139], v28, s[36:39], s48 offen
buffer_load_dwordx4 v[140:143], v29, s[36:39], s48 offen offset:1024
s_add_u32 s48, s75, 4
s_and_b32 s48, s48, 15
s_mul_i32 s48, s48, s57
buffer_load_dwordx4 v[144:147], v28, s[36:39], s48 offen
buffer_load_dwordx4 v[148:151], v29, s[36:39], s48 offen offset:1024
s_mov_b32 s36, s12
s_and_b32 s37, s13, 0xffff
s_mov_b32 s38, 6291456
s_mov_b32 s39, 0x00020000
s_add_u32 m0, s71, 122880
s_add_u32 s48, s83, 0
buffer_load_dwordx4 v60, s[36:39], s48 offen lds
buffer_load_dwordx4 v61, s[36:39], s48 offen offset:1024 lds
s_add_u32 m0, s71, 131072
s_add_u32 s48, s83, 2048
buffer_load_dwordx4 v60, s[36:39], s48 offen lds
buffer_load_dwordx4 v61, s[36:39], s48 offen offset:1024 lds
s_add_u32 m0, s71, 139264
s_add_u32 s48, s83, 4096
buffer_load_dwordx4 v60, s[36:39], s48 offen lds
buffer_load_dwordx4 v61, s[36:39], s48 offen offset:1024 lds
s_add_u32 s48, s87, 0
buffer_load_dwordx4 v[108:111], v63, s[36:39], s48 offen
s_add_u32 s48, s87, 2048
buffer_load_dwordx4 v[108:111], v63, s[36:39], s48 offen
s_add_u32 s48, s87, 4096
buffer_load_dwordx4 v[108:111], v63, s[36:39], s48 offen
s_mov_b32 s36, s8
s_and_b32 s37, s9, 0xffff
s_mov_b32 s38, 2097152
s_mov_b32 s39, 0x00020000
buffer_store_dwordx4 v[56:59], v18, s[32:35], s86 offen offset:0 sc1
buffer_store_dwordx4 v[56:59], v18, s[32:35], s86 offen offset:1024 sc1
buffer_store_dwordx2 v[56:57], v39, s[32:35], s89 offen sc1
buffer_store_dwordx4 v[56:59], v55, s[32:35], 0 offen sc1
else_8:
s_add_u32 s69, s47, 1
s_and_b32 s69, s69, 3
s_add_u32 s69, s69, 12
s_mul_i32 s67, s69, 128
s_mul_i32 s68, s69, s54
s_add_u32 m0, s70, s65
s_nop 0
buffer_load_dwordx4 v20, s[24:27], s67 offen offset:0  lds
buffer_load_dwordx4 v21, s[24:27], s67 offen offset:1024  lds
buffer_load_dwordx4 v22, s[24:27], s67 offen offset:2048  lds
buffer_load_dwordx4 v23, s[24:27], s67 offen offset:3072  lds
s_add_u32 s60, s71, s65
s_add_u32 m0, s60, 0
s_mov_b32 s61, s68
buffer_load_dwordx4 v26, s[28:31], s61 offen lds
buffer_load_dwordx4 v27, s[28:31], s61 offen offset:1024 lds
s_add_u32 m0, s60, 8192
s_add_u32 s61, s61, s53
buffer_load_dwordx4 v26, s[28:31], s61 offen lds
buffer_load_dwordx4 v27, s[28:31], s61 offen offset:1024 lds
s_add_u32 m0, s60, 16384
s_add_u32 s61, s61, s53
buffer_load_dwordx4 v26, s[28:31], s61 offen lds
buffer_load_dwordx4 v27, s[28:31], s61 offen offset:1024 lds
s_add_u32 s49, s76, 2
s_and_b32 s49, s49, 3
s_add_u32 s49, s49, 4
s_mul_i32 s49, s49, 393216
buffer_load_dwordx4 v[40:43], v36, s[28:31], s49 offen
s_add_u32 s65, s65, 40960
s_cmp_eq_u32 s65, 122880
s_cselect_b32 s65, 0, s65
s_add_u32 s64, s64, 1
s_waitcnt vmcnt(11)
s_barrier
s_cmp_lg_u32 s88, 3
s_cbranch_scc1 else_10
s_add_u32 s48, s75, 3
s_and_b32 s48, s48, 15
s_mul_i32 s48, s48, s57
buffer_load_dwordx4 v[136:139], v28, s[36:39], s48 offen
buffer_load_dwordx4 v[140:143], v29, s[36:39], s48 offen offset:1024
s_add_u32 s48, s75, 4
s_and_b32 s48, s48, 15
s_mul_i32 s48, s48, s57
buffer_load_dwordx4 v[144:147], v28, s[36:39], s48 offen
buffer_load_dwordx4 v[148:151], v29, s[36:39], s48 offen offset:1024
s_mov_b32 s36, s12
s_and_b32 s37, s13, 0xffff
s_mov_b32 s38, 6291456
s_mov_b32 s39, 0x00020000
s_add_u32 m0, s71, 122880
s_add_u32 s48, s83, 0
buffer_load_dwordx4 v60, s[36:39], s48 offen lds
buffer_load_dwordx4 v61, s[36:39], s48 offen offset:1024 lds
s_add_u32 m0, s71, 131072
s_add_u32 s48, s83, 2048
buffer_load_dwordx4 v60, s[36:39], s48 offen lds
buffer_load_dwordx4 v61, s[36:39], s48 offen offset:1024 lds
s_add_u32 m0, s71, 139264
s_add_u32 s48, s83, 4096
buffer_load_dwordx4 v60, s[36:39], s48 offen lds
buffer_load_dwordx4 v61, s[36:39], s48 offen offset:1024 lds
s_add_u32 s48, s87, 0
buffer_load_dwordx4 v[108:111], v63, s[36:39], s48 offen
s_add_u32 s48, s87, 2048
buffer_load_dwordx4 v[108:111], v63, s[36:39], s48 offen
s_add_u32 s48, s87, 4096
buffer_load_dwordx4 v[108:111], v63, s[36:39], s48 offen
s_mov_b32 s36, s8
s_and_b32 s37, s9, 0xffff
s_mov_b32 s38, 2097152
s_mov_b32 s39, 0x00020000
buffer_store_dwordx4 v[56:59], v18, s[32:35], s86 offen offset:0 sc1
buffer_store_dwordx4 v[56:59], v18, s[32:35], s86 offen offset:1024 sc1
buffer_store_dwordx2 v[56:57], v39, s[32:35], s89 offen sc1
buffer_store_dwordx4 v[56:59], v55, s[32:35], 0 offen sc1
else_10:
s_add_u32 s69, s47, 2
s_and_b32 s69, s69, 3
s_add_u32 s69, s69, 0
s_mul_i32 s67, s69, 128
s_mul_i32 s68, s69, s54
s_add_u32 m0, s70, s65
s_nop 0
buffer_load_dwordx4 v20, s[24:27], s67 offen offset:0  lds
buffer_load_dwordx4 v21, s[24:27], s67 offen offset:1024  lds
buffer_load_dwordx4 v22, s[24:27], s67 offen offset:2048  lds
buffer_load_dwordx4 v23, s[24:27], s67 offen offset:3072  lds
s_add_u32 s60, s71, s65
s_add_u32 m0, s60, 0
s_mov_b32 s61, s68
buffer_load_dwordx4 v26, s[28:31], s61 offen lds
buffer_load_dwordx4 v27, s[28:31], s61 offen offset:1024 lds
s_add_u32 m0, s60, 8192
s_add_u32 s61, s61, s53
buffer_load_dwordx4 v26, s[28:31], s61 offen lds
buffer_load_dwordx4 v27, s[28:31], s61 offen offset:1024 lds
s_add_u32 m0, s60, 16384
s_add_u32 s61, s61, s53
buffer_load_dwordx4 v26, s[28:31], s61 offen lds
buffer_load_dwordx4 v27, s[28:31], s61 offen offset:1024 lds
s_add_u32 s49, s76, 2
s_and_b32 s49, s49, 3
s_add_u32 s49, s49, 8
s_mul_i32 s49, s49, 393216
buffer_load_dwordx4 v[40:43], v36, s[28:31], s49 offen
s_add_u32 s65, s65, 40960
s_cmp_eq_u32 s65, 122880
s_cselect_b32 s65, 0, s65
s_add_u32 s64, s64, 1
s_waitcnt vmcnt(11)
s_barrier
s_cmp_lg_u32 s88, 4
s_cbranch_scc1 else_12
s_add_u32 s48, s75, 3
s_and_b32 s48, s48, 15
s_mul_i32 s48, s48, s57
buffer_load_dwordx4 v[136:139], v28, s[36:39], s48 offen
buffer_load_dwordx4 v[140:143], v29, s[36:39], s48 offen offset:1024
s_add_u32 s48, s75, 4
s_and_b32 s48, s48, 15
s_mul_i32 s48, s48, s57
buffer_load_dwordx4 v[144:147], v28, s[36:39], s48 offen
buffer_load_dwordx4 v[148:151], v29, s[36:39], s48 offen offset:1024
s_mov_b32 s36, s12
s_and_b32 s37, s13, 0xffff
s_mov_b32 s38, 6291456
s_mov_b32 s39, 0x00020000
s_add_u32 m0, s71, 122880
s_add_u32 s48, s83, 0
buffer_load_dwordx4 v60, s[36:39], s48 offen lds
buffer_load_dwordx4 v61, s[36:39], s48 offen offset:1024 lds
s_add_u32 m0, s71, 131072
s_add_u32 s48, s83, 2048
buffer_load_dwordx4 v60, s[36:39], s48 offen lds
buffer_load_dwordx4 v61, s[36:39], s48 offen offset:1024 lds
s_add_u32 m0, s71, 139264
s_add_u32 s48, s83, 4096
buffer_load_dwordx4 v60, s[36:39], s48 offen lds
buffer_load_dwordx4 v61, s[36:39], s48 offen offset:1024 lds
s_add_u32 s48, s87, 0
buffer_load_dwordx4 v[108:111], v63, s[36:39], s48 offen
s_add_u32 s48, s87, 2048
buffer_load_dwordx4 v[108:111], v63, s[36:39], s48 offen
s_add_u32 s48, s87, 4096
buffer_load_dwordx4 v[108:111], v63, s[36:39], s48 offen
s_mov_b32 s36, s8
s_and_b32 s37, s9, 0xffff
s_mov_b32 s38, 2097152
s_mov_b32 s39, 0x00020000
buffer_store_dwordx4 v[56:59], v18, s[32:35], s86 offen offset:0 sc1
buffer_store_dwordx4 v[56:59], v18, s[32:35], s86 offen offset:1024 sc1
buffer_store_dwordx2 v[56:57], v39, s[32:35], s89 offen sc1
buffer_store_dwordx4 v[56:59], v55, s[32:35], 0 offen sc1
else_12:
s_add_u32 s69, s47, 2
s_and_b32 s69, s69, 3
s_add_u32 s69, s69, 4
s_mul_i32 s67, s69, 128
s_mul_i32 s68, s69, s54
s_add_u32 m0, s70, s65
s_nop 0
buffer_load_dwordx4 v20, s[24:27], s67 offen offset:0  lds
buffer_load_dwordx4 v21, s[24:27], s67 offen offset:1024  lds
buffer_load_dwordx4 v22, s[24:27], s67 offen offset:2048  lds
buffer_load_dwordx4 v23, s[24:27], s67 offen offset:3072  lds
s_add_u32 s60, s71, s65
s_add_u32 m0, s60, 0
s_mov_b32 s61, s68
buffer_load_dwordx4 v26, s[28:31], s61 offen lds
buffer_load_dwordx4 v27, s[28:31], s61 offen offset:1024 lds
s_add_u32 m0, s60, 8192
s_add_u32 s61, s61, s53
buffer_load_dwordx4 v26, s[28:31], s61 offen lds
buffer_load_dwordx4 v27, s[28:31], s61 offen offset:1024 lds
s_add_u32 m0, s60, 16384
s_add_u32 s61, s61, s53
buffer_load_dwordx4 v26, s[28:31], s61 offen lds
buffer_load_dwordx4 v27, s[28:31], s61 offen offset:1024 lds
s_add_u32 s49, s76, 2
s_and_b32 s49, s49, 3
s_add_u32 s49, s49, 12
s_mul_i32 s49, s49, 393216
buffer_load_dwordx4 v[40:43], v36, s[28:31], s49 offen
s_add_u32 s65, s65, 40960
s_cmp_eq_u32 s65, 122880
s_cselect_b32 s65, 0, s65
s_add_u32 s64, s64, 1
s_waitcnt vmcnt(11)
s_barrier
s_cmp_lg_u32 s88, 5
s_cbranch_scc1 else_14
s_add_u32 s48, s75, 3
s_and_b32 s48, s48, 15
s_mul_i32 s48, s48, s57
buffer_load_dwordx4 v[136:139], v28, s[36:39], s48 offen
buffer_load_dwordx4 v[140:143], v29, s[36:39], s48 offen offset:1024
s_add_u32 s48, s75, 4
s_and_b32 s48, s48, 15
s_mul_i32 s48, s48, s57
buffer_load_dwordx4 v[144:147], v28, s[36:39], s48 offen
buffer_load_dwordx4 v[148:151], v29, s[36:39], s48 offen offset:1024
s_mov_b32 s36, s12
s_and_b32 s37, s13, 0xffff
s_mov_b32 s38, 6291456
s_mov_b32 s39, 0x00020000
s_add_u32 m0, s71, 122880
s_add_u32 s48, s83, 0
buffer_load_dwordx4 v60, s[36:39], s48 offen lds
buffer_load_dwordx4 v61, s[36:39], s48 offen offset:1024 lds
s_add_u32 m0, s71, 131072
s_add_u32 s48, s83, 2048
buffer_load_dwordx4 v60, s[36:39], s48 offen lds
buffer_load_dwordx4 v61, s[36:39], s48 offen offset:1024 lds
s_add_u32 m0, s71, 139264
s_add_u32 s48, s83, 4096
buffer_load_dwordx4 v60, s[36:39], s48 offen lds
buffer_load_dwordx4 v61, s[36:39], s48 offen offset:1024 lds
s_add_u32 s48, s87, 0
buffer_load_dwordx4 v[108:111], v63, s[36:39], s48 offen
s_add_u32 s48, s87, 2048
buffer_load_dwordx4 v[108:111], v63, s[36:39], s48 offen
s_add_u32 s48, s87, 4096
buffer_load_dwordx4 v[108:111], v63, s[36:39], s48 offen
s_mov_b32 s36, s8
s_and_b32 s37, s9, 0xffff
s_mov_b32 s38, 2097152
s_mov_b32 s39, 0x00020000
buffer_store_dwordx4 v[56:59], v18, s[32:35], s86 offen offset:0 sc1
buffer_store_dwordx4 v[56:59], v18, s[32:35], s86 offen offset:1024 sc1
buffer_store_dwordx2 v[56:57], v39, s[32:35], s89 offen sc1
buffer_store_dwordx4 v[56:59], v55, s[32:35], 0 offen sc1
else_14:
s_add_u32 s69, s47, 2
s_and_b32 s69, s69, 3
s_add_u32 s69, s69, 8
s_mul_i32 s67, s69, 128
s_mul_i32 s68, s69, s54
s_add_u32 m0, s70, s65
s_nop 0
buffer_load_dwordx4 v20, s[24:27], s67 offen offset:0  lds
buffer_load_dwordx4 v21, s[24:27], s67 offen offset:1024  lds
buffer_load_dwordx4 v22, s[24:27], s67 offen offset:2048  lds
buffer_load_dwordx4 v23, s[24:27], s67 offen offset:3072  lds
s_add_u32 s60, s71, s65
s_add_u32 m0, s60, 0
s_mov_b32 s61, s68
buffer_load_dwordx4 v26, s[28:31], s61 offen lds
buffer_load_dwordx4 v27, s[28:31], s61 offen offset:1024 lds
s_add_u32 m0, s60, 8192
s_add_u32 s61, s61, s53
buffer_load_dwordx4 v26, s[28:31], s61 offen lds
buffer_load_dwordx4 v27, s[28:31], s61 offen offset:1024 lds
s_add_u32 m0, s60, 16384
s_add_u32 s61, s61, s53
buffer_load_dwordx4 v26, s[28:31], s61 offen lds
buffer_load_dwordx4 v27, s[28:31], s61 offen offset:1024 lds
s_add_u32 s49, s76, 3
s_and_b32 s49, s49, 3
s_add_u32 s49, s49, 0
s_mul_i32 s49, s49, 393216
buffer_load_dwordx4 v[40:43], v36, s[28:31], s49 offen
s_add_u32 s65, s65, 40960
s_cmp_eq_u32 s65, 122880
s_cselect_b32 s65, 0, s65
s_add_u32 s64, s64, 1
s_waitcnt vmcnt(11)
s_barrier
s_cmp_lg_u32 s88, 6
s_cbranch_scc1 else_16
s_add_u32 s48, s75, 3
s_and_b32 s48, s48, 15
s_mul_i32 s48, s48, s57
buffer_load_dwordx4 v[136:139], v28, s[36:39], s48 offen
buffer_load_dwordx4 v[140:143], v29, s[36:39], s48 offen offset:1024
s_add_u32 s48, s75, 4
s_and_b32 s48, s48, 15
s_mul_i32 s48, s48, s57
buffer_load_dwordx4 v[144:147], v28, s[36:39], s48 offen
buffer_load_dwordx4 v[148:151], v29, s[36:39], s48 offen offset:1024
s_mov_b32 s36, s12
s_and_b32 s37, s13, 0xffff
s_mov_b32 s38, 6291456
s_mov_b32 s39, 0x00020000
s_add_u32 m0, s71, 122880
s_add_u32 s48, s83, 0
buffer_load_dwordx4 v60, s[36:39], s48 offen lds
buffer_load_dwordx4 v61, s[36:39], s48 offen offset:1024 lds
s_add_u32 m0, s71, 131072
s_add_u32 s48, s83, 2048
buffer_load_dwordx4 v60, s[36:39], s48 offen lds
buffer_load_dwordx4 v61, s[36:39], s48 offen offset:1024 lds
s_add_u32 m0, s71, 139264
s_add_u32 s48, s83, 4096
buffer_load_dwordx4 v60, s[36:39], s48 offen lds
buffer_load_dwordx4 v61, s[36:39], s48 offen offset:1024 lds
s_add_u32 s48, s87, 0
buffer_load_dwordx4 v[108:111], v63, s[36:39], s48 offen
s_add_u32 s48, s87, 2048
buffer_load_dwordx4 v[108:111], v63, s[36:39], s48 offen
s_add_u32 s48, s87, 4096
buffer_load_dwordx4 v[108:111], v63, s[36:39], s48 offen
s_mov_b32 s36, s8
s_and_b32 s37, s9, 0xffff
s_mov_b32 s38, 2097152
s_mov_b32 s39, 0x00020000
buffer_store_dwordx4 v[56:59], v18, s[32:35], s86 offen offset:0 sc1
buffer_store_dwordx4 v[56:59], v18, s[32:35], s86 offen offset:1024 sc1
buffer_store_dwordx2 v[56:57], v39, s[32:35], s89 offen sc1
buffer_store_dwordx4 v[56:59], v55, s[32:35], 0 offen sc1
else_16:
s_add_u32 s69, s47, 2
s_and_b32 s69, s69, 3
s_add_u32 s69, s69, 12
s_mul_i32 s67, s69, 128
s_mul_i32 s68, s69, s54
s_add_u32 m0, s70, s65
s_nop 0
buffer_load_dwordx4 v20, s[24:27], s67 offen offset:0  lds
buffer_load_dwordx4 v21, s[24:27], s67 offen offset:1024  lds
buffer_load_dwordx4 v22, s[24:27], s67 offen offset:2048  lds
buffer_load_dwordx4 v23, s[24:27], s67 offen offset:3072  lds
s_add_u32 s60, s71, s65
s_add_u32 m0, s60, 0
s_mov_b32 s61, s68
buffer_load_dwordx4 v26, s[28:31], s61 offen lds
buffer_load_dwordx4 v27, s[28:31], s61 offen offset:1024 lds
s_add_u32 m0, s60, 8192
s_add_u32 s61, s61, s53
buffer_load_dwordx4 v26, s[28:31], s61 offen lds
buffer_load_dwordx4 v27, s[28:31], s61 offen offset:1024 lds
s_add_u32 m0, s60, 16384
s_add_u32 s61, s61, s53
buffer_load_dwordx4 v26, s[28:31], s61 offen lds
buffer_load_dwordx4 v27, s[28:31], s61 offen offset:1024 lds
s_add_u32 s49, s76, 3
s_and_b32 s49, s49, 3
s_add_u32 s49, s49, 4
s_mul_i32 s49, s49, 393216
buffer_load_dwordx4 v[40:43], v36, s[28:31], s49 offen
s_add_u32 s65, s65, 40960
s_cmp_eq_u32 s65, 122880
s_cselect_b32 s65, 0, s65
s_add_u32 s64, s64, 1
s_waitcnt vmcnt(11)
s_barrier
s_cmp_lg_u32 s88, 7
s_cbranch_scc1 else_18
s_add_u32 s48, s75, 3
s_and_b32 s48, s48, 15
s_mul_i32 s48, s48, s57
buffer_load_dwordx4 v[136:139], v28, s[36:39], s48 offen
buffer_load_dwordx4 v[140:143], v29, s[36:39], s48 offen offset:1024
s_add_u32 s48, s75, 4
s_and_b32 s48, s48, 15
s_mul_i32 s48, s48, s57
buffer_load_dwordx4 v[144:147], v28, s[36:39], s48 offen
buffer_load_dwordx4 v[148:151], v29, s[36:39], s48 offen offset:1024
s_mov_b32 s36, s12
s_and_b32 s37, s13, 0xffff
s_mov_b32 s38, 6291456
s_mov_b32 s39, 0x00020000
s_add_u32 m0, s71, 122880
s_add_u32 s48, s83, 0
buffer_load_dwordx4 v60, s[36:39], s48 offen lds
buffer_load_dwordx4 v61, s[36:39], s48 offen offset:1024 lds
s_add_u32 m0, s71, 131072
s_add_u32 s48, s83, 2048
buffer_load_dwordx4 v60, s[36:39], s48 offen lds
buffer_load_dwordx4 v61, s[36:39], s48 offen offset:1024 lds
s_add_u32 m0, s71, 139264
s_add_u32 s48, s83, 4096
buffer_load_dwordx4 v60, s[36:39], s48 offen lds
buffer_load_dwordx4 v61, s[36:39], s48 offen offset:1024 lds
s_add_u32 s48, s87, 0
buffer_load_dwordx4 v[108:111], v63, s[36:39], s48 offen
s_add_u32 s48, s87, 2048
buffer_load_dwordx4 v[108:111], v63, s[36:39], s48 offen
s_add_u32 s48, s87, 4096
buffer_load_dwordx4 v[108:111], v63, s[36:39], s48 offen
s_mov_b32 s36, s8
s_and_b32 s37, s9, 0xffff
s_mov_b32 s38, 2097152
s_mov_b32 s39, 0x00020000
buffer_store_dwordx4 v[56:59], v18, s[32:35], s86 offen offset:0 sc1
buffer_store_dwordx4 v[56:59], v18, s[32:35], s86 offen offset:1024 sc1
buffer_store_dwordx2 v[56:57], v39, s[32:35], s89 offen sc1
buffer_store_dwordx4 v[56:59], v55, s[32:35], 0 offen sc1
else_18:
s_add_u32 s69, s47, 3
s_and_b32 s69, s69, 3
s_add_u32 s69, s69, 0
s_mul_i32 s67, s69, 128
s_mul_i32 s68, s69, s54
s_add_u32 m0, s70, s65
s_nop 0
buffer_load_dwordx4 v20, s[24:27], s67 offen offset:0  lds
buffer_load_dwordx4 v21, s[24:27], s67 offen offset:1024  lds
buffer_load_dwordx4 v22, s[24:27], s67 offen offset:2048  lds
buffer_load_dwordx4 v23, s[24:27], s67 offen offset:3072  lds
s_add_u32 s60, s71, s65
s_add_u32 m0, s60, 0
s_mov_b32 s61, s68
buffer_load_dwordx4 v26, s[28:31], s61 offen lds
buffer_load_dwordx4 v27, s[28:31], s61 offen offset:1024 lds
s_add_u32 m0, s60, 8192
s_add_u32 s61, s61, s53
buffer_load_dwordx4 v26, s[28:31], s61 offen lds
buffer_load_dwordx4 v27, s[28:31], s61 offen offset:1024 lds
s_add_u32 m0, s60, 16384
s_add_u32 s61, s61, s53
buffer_load_dwordx4 v26, s[28:31], s61 offen lds
buffer_load_dwordx4 v27, s[28:31], s61 offen offset:1024 lds
s_add_u32 s49, s76, 3
s_and_b32 s49, s49, 3
s_add_u32 s49, s49, 8
s_mul_i32 s49, s49, 393216
buffer_load_dwordx4 v[40:43], v36, s[28:31], s49 offen
s_add_u32 s65, s65, 40960
s_cmp_eq_u32 s65, 122880
s_cselect_b32 s65, 0, s65
s_add_u32 s64, s64, 1
s_waitcnt vmcnt(11)
s_barrier
s_add_u32 s69, s47, 3
s_and_b32 s69, s69, 3
s_add_u32 s69, s69, 4
s_mul_i32 s67, s69, 128
s_mul_i32 s68, s69, s54
s_add_u32 m0, s70, s65
s_nop 0
buffer_load_dwordx4 v20, s[24:27], s67 offen offset:0  lds
buffer_load_dwordx4 v21, s[24:27], s67 offen offset:1024  lds
buffer_load_dwordx4 v22, s[24:27], s67 offen offset:2048  lds
buffer_load_dwordx4 v23, s[24:27], s67 offen offset:3072  lds
s_add_u32 s60, s71, s65
s_add_u32 m0, s60, 0
s_mov_b32 s61, s68
buffer_load_dwordx4 v26, s[28:31], s61 offen lds
buffer_load_dwordx4 v27, s[28:31], s61 offen offset:1024 lds
s_add_u32 m0, s60, 8192
s_add_u32 s61, s61, s53
buffer_load_dwordx4 v26, s[28:31], s61 offen lds
buffer_load_dwordx4 v27, s[28:31], s61 offen offset:1024 lds
s_add_u32 m0, s60, 16384
s_add_u32 s61, s61, s53
buffer_load_dwordx4 v26, s[28:31], s61 offen lds
buffer_load_dwordx4 v27, s[28:31], s61 offen offset:1024 lds
s_add_u32 s49, s76, 3
s_and_b32 s49, s49, 3
s_add_u32 s49, s49, 12
s_mul_i32 s49, s49, 393216
buffer_load_dwordx4 v[40:43], v36, s[28:31], s49 offen
s_add_u32 s65, s65, 40960
s_cmp_eq_u32 s65, 122880
s_cselect_b32 s65, 0, s65
s_add_u32 s64, s64, 1
s_waitcnt vmcnt(11)
s_barrier
global_load_dwordx2 v[34:35], v32, s[20:21] sc1
s_add_u32 s69, s47, 3
s_and_b32 s69, s69, 3
s_add_u32 s69, s69, 8
s_mul_i32 s67, s69, 128
s_mul_i32 s68, s69, s54
s_add_u32 m0, s70, s65
s_nop 0
buffer_load_dwordx4 v20, s[24:27], s67 offen offset:0  lds
buffer_load_dwordx4 v21, s[24:27], s67 offen offset:1024  lds
buffer_load_dwordx4 v22, s[24:27], s67 offen offset:2048  lds
buffer_load_dwordx4 v23, s[24:27], s67 offen offset:3072  lds
s_add_u32 s60, s71, s65
s_add_u32 m0, s60, 0
s_mov_b32 s61, s68
buffer_load_dwordx4 v26, s[28:31], s61 offen lds
buffer_load_dwordx4 v27, s[28:31], s61 offen offset:1024 lds
s_add_u32 m0, s60, 8192
s_add_u32 s61, s61, s53
buffer_load_dwordx4 v26, s[28:31], s61 offen lds
buffer_load_dwordx4 v27, s[28:31], s61 offen offset:1024 lds
s_add_u32 m0, s60, 16384
s_add_u32 s61, s61, s53
buffer_load_dwordx4 v26, s[28:31], s61 offen lds
buffer_load_dwordx4 v27, s[28:31], s61 offen offset:1024 lds
s_add_u32 s65, s65, 40960
s_cmp_eq_u32 s65, 122880
s_cselect_b32 s65, 0, s65
s_add_u32 s64, s64, 1
s_waitcnt vmcnt(10)
s_barrier
s_mov_b32 s63, 0
ipoll_20:
v_sad_u8 v4, v34, 0, 0
v_sad_u8 v4, v35, 0, v4
v_cmp_gt_u32 vcc, 32, v4
s_cbranch_vccz ipolled_21
global_load_dwordx2 v[34:35], v32, s[20:21] sc1
s_add_u32 s63, s63, 1
s_cmp_lt_u32 s63, 0x80000
s_waitcnt vmcnt(0)
s_cbranch_scc1 ipoll_20
ipolled_21:
s_add_u32 s69, s47, 3
s_and_b32 s69, s69, 3
s_add_u32 s69, s69, 12
s_mul_i32 s67, s69, 128
s_mul_i32 s68, s69, s54
s_add_u32 m0, s70, 0
s_nop 0
buffer_load_dwordx4 v20, s[24:27], s67 offen offset:0  lds
buffer_load_dwordx4 v21, s[24:27], s67 offen offset:1024  lds
buffer_load_dwordx4 v22, s[24:27], s67 offen offset:2048  lds
buffer_load_dwordx4 v23, s[24:27], s67 offen offset:3072  lds
s_add_u32 s60, s71, 0
s_add_u32 m0, s60, 0
s_mov_b32 s61, s68
buffer_load_dwordx4 v26, s[28:31], s61 offen lds
buffer_load_dwordx4 v27, s[28:31], s61 offen offset:1024 lds
s_add_u32 m0, s60, 8192
s_add_u32 s61, s61, s53
buffer_load_dwordx4 v26, s[28:31], s61 offen lds
buffer_load_dwordx4 v27, s[28:31], s61 offen offset:1024 lds
s_add_u32 m0, s60, 16384
s_add_u32 s61, s61, s53
buffer_load_dwordx4 v26, s[28:31], s61 offen lds
buffer_load_dwordx4 v27, s[28:31], s61 offen offset:1024 lds
s_waitcnt vmcnt(10)
s_barrier
s_setprio 0
buffer_load_dwordx4 v[240:243], v15, s[36:39], 0 offen offset:0
buffer_load_dwordx4 v[240:243], v15, s[36:39], 0 offen offset:1024
buffer_load_dwordx4 v[176:179], v37, s[32:35], 0 offen offset:0 sc1
buffer_load_dwordx4 v[180:183], v37, s[32:35], 0 offen offset:1024 sc1
buffer_load_dwordx4 v[184:187], v37, s[32:35], 0 offen offset:2048 sc1
buffer_load_dwordx4 v[188:191], v37, s[32:35], 0 offen offset:3072 sc1
global_load_dword v48, v54, s[98:99]
buffer_load_dwordx4 v[160:163], v38, s[32:35], 0 offen offset:0 sc1
buffer_load_dwordx4 v[164:167], v38, s[32:35], 0 offen offset:1024 sc1
buffer_load_dwordx4 v[168:171], v38, s[32:35], 0 offen offset:2048 sc1
buffer_load_dwordx4 v[172:175], v38, s[32:35], 0 offen offset:3072 sc1
s_add_u32 s48, s75, 15
s_and_b32 s48, s48, 15
s_mul_i32 s48, s48, s57
s_add_u32 m0, s71, 106496
s_nop 0
buffer_load_dwordx4 v28, s[36:39], s48 offen lds
buffer_load_dwordx4 v29, s[36:39], s48 offen offset:1024 lds
s_waitcnt vmcnt(13)
s_barrier
s_add_u32 s48, s75, 5
s_and_b32 s48, s48, 15
s_mul_i32 s48, s48, s57
s_add_u32 m0, s71, 24576
s_nop 0
buffer_load_dwordx4 v28, s[36:39], s48 offen lds
buffer_load_dwordx4 v29, s[36:39], s48 offen offset:1024 lds
s_waitcnt vmcnt(4)
s_add_u32 s48, s75, 6
s_and_b32 s48, s48, 15
s_mul_i32 s48, s48, s57
s_add_u32 m0, s71, 32768
s_nop 0
buffer_load_dwordx4 v28, s[36:39], s48 offen lds
v_add_f32 v176, v176, v184
v_add_f32 v160, v160, v168
v_add_f32 v177, v177, v185
v_add_f32 v161, v161, v169
v_add_f32 v178, v178, v186
v_add_f32 v162, v162, v170
v_add_f32 v179, v179, v187
v_add_f32 v163, v163, v171
v_add_f32 v180, v180, v188
v_add_f32 v164, v164, v172
buffer_load_dwordx4 v29, s[36:39], s48 offen offset:1024 lds
v_add_f32 v181, v181, v189
v_add_f32 v165, v165, v173
v_add_f32 v182, v182, v190
v_add_f32 v166, v166, v174
v_add_f32 v183, v183, v191
v_add_f32 v167, v167, v175
v_add_f32 v176, v176, v180
v_add_f32 v160, v160, v164
v_add_f32 v177, v177, v181
v_add_f32 v161, v161, v165
s_add_u32 s48, s75, 7
s_and_b32 s48, s48, 15
s_mul_i32 s48, s48, s57
s_add_u32 m0, s71, 40960
s_nop 0
buffer_load_dwordx4 v28, s[36:39], s48 offen lds
v_add_f32 v178, v178, v182
v_add_f32 v162, v162, v166
v_add_f32 v179, v179, v183
v_add_f32 v163, v163, v167
s_nop 1
s_nop 1
v_permlane32_swap_b32 v176, v177
v_permlane32_swap_b32 v160, v161
v_permlane32_swap_b32 v178, v179
buffer_load_dwordx4 v29, s[36:39], s48 offen offset:1024 lds
v_permlane32_swap_b32 v162, v163
v_add_f32 v176, v176, v177
v_add_f32 v160, v160, v161
v_add_f32 v178, v178, v179
v_add_f32 v162, v162, v163
s_nop 1
s_nop 1
v_permlane16_swap_b32 v176, v178
v_permlane16_swap_b32 v160, v162
s_nop 0
s_add_u32 s48, s75, 8
s_and_b32 s48, s48, 15
s_mul_i32 s48, s48, s57
s_add_u32 m0, s71, 49152
s_nop 0
buffer_load_dwordx4 v28, s[36:39], s48 offen lds
s_nop 0
v_add_f32 v176, v176, v178
v_add_f32 v160, v160, v162
v_cmp_u_f32 vcc, v176, v176
s_cbranch_vccnz again_22
summed_23:
v_cmp_u_f32 vcc, v160, v160
s_cbranch_vccnz again_25
summed_26:
v_mul_f32 v44, 0x3a800000, v176
ds_write_b32 v53, v160
v_mov_b32 v45, v44
s_nop 1
v_permlane16_swap_b32 v44, v45
buffer_load_dwordx4 v29, s[36:39], s48 offen offset:1024 lds
s_nop 0
v_fma_f32 v45, -v44, v44, v45
v_max_f32 v45, 0, v45
v_add_f32 v45, 0x3727c5ac, v45
v_rsq_f32 v46, v45
v_sub_f32 v47, 0, v44
ds_write_b32 v50, v47 offset:512
ds_write_b64 v49, v[46:47]
ds_write_b32 v50, v46
s_cmp_lg_u32 s43, 2
s_cbranch_scc1 else_28
s_and_b32 s50, s2, 7
v_readlane_b32 s58, v34, s50
v_readlane_b32 s59, v35, s50
s_lshl_b64 s[48:49], s[94:95], 5
v_mov_b32 v4, 134656
s_nop 1
s_cmp_eq_u64 s[48:49], s[58:59]
s_cselect_b32 s48, 1, 0
v_mov_b32 v5, s48
ds_write_b32 v4, v5
else_28:
s_setprio 0
s_waitcnt lgkmcnt(0)
s_waitcnt vmcnt(63)
s_barrier
s_waitcnt vmcnt(5)
s_add_u32 s48, s75, 9
s_and_b32 s48, s48, 15
s_mul_i32 s48, s48, s57
s_add_u32 m0, s71, 57344
s_nop 0
buffer_load_dwordx4 v28, s[36:39], s48 offen lds
ds_write_b128 v51, v[136:139] offset:24576
buffer_load_dwordx4 v29, s[36:39], s48 offen offset:1024 lds
s_waitcnt vmcnt(5)
s_add_u32 s48, s75, 10
s_and_b32 s48, s48, 15
s_mul_i32 s48, s48, s57
s_add_u32 m0, s71, 65536
s_nop 0
buffer_load_dwordx4 v28, s[36:39], s48 offen lds
buffer_load_dwordx4 v29, s[36:39], s48 offen offset:1024 lds
s_waitcnt vmcnt(5)
s_add_u32 s48, s75, 11
s_and_b32 s48, s48, 15
s_mul_i32 s48, s48, s57
s_add_u32 m0, s71, 73728
s_nop 0
buffer_load_dwordx4 v28, s[36:39], s48 offen lds
ds_write_b128 v51, v[140:143] offset:25600
buffer_load_dwordx4 v29, s[36:39], s48 offen offset:1024 lds
s_waitcnt vmcnt(5)
s_add_u32 s48, s75, 12
s_and_b32 s48, s48, 15
s_mul_i32 s48, s48, s57
s_add_u32 m0, s71, 81920
s_nop 0
buffer_load_dwordx4 v28, s[36:39], s48 offen lds
buffer_load_dwordx4 v29, s[36:39], s48 offen offset:1024 lds
s_waitcnt vmcnt(5)
s_add_u32 s48, s75, 13
s_and_b32 s48, s48, 15
s_mul_i32 s48, s48, s57
s_add_u32 m0, s71, 90112
s_nop 0
buffer_load_dwordx4 v28, s[36:39], s48 offen lds
buffer_load_dwordx4 v29, s[36:39], s48 offen offset:1024 lds
ds_write_b128 v51, v[144:147] offset:32768
s_waitcnt vmcnt(5)
s_add_u32 s48, s75, 14
s_and_b32 s48, s48, 15
s_mul_i32 s48, s48, s57
s_add_u32 m0, s71, 98304
s_nop 0
buffer_load_dwordx4 v28, s[36:39], s48 offen lds
buffer_load_dwordx4 v29, s[36:39], s48 offen offset:1024 lds
s_waitcnt vmcnt(5)
s_add_u32 s48, s75, 0
s_and_b32 s48, s48, 15
s_mul_i32 s48, s48, s57
s_add_u32 m0, s71, 4294950912
s_nop 0
buffer_load_dwordx4 v28, s[36:39], s48 offen lds
buffer_load_dwordx4 v29, s[36:39], s48 offen offset:1024 lds
ds_write_b128 v51, v[148:151] offset:33792
s_waitcnt vmcnt(5)
s_add_u32 s48, s75, 1
s_and_b32 s48, s48, 15
s_mul_i32 s48, s48, s57
s_add_u32 m0, s71, 4294959104
s_nop 0
buffer_load_dwordx4 v28, s[36:39], s48 offen lds
buffer_load_dwordx4 v29, s[36:39], s48 offen offset:1024 lds
s_waitcnt vmcnt(5)
s_add_u32 s48, s75, 2
s_and_b32 s48, s48, 15
s_mul_i32 s48, s48, s57
s_add_u32 m0, s71, 0
s_nop 0
buffer_load_dwordx4 v28, s[36:39], s48 offen lds
buffer_load_dwordx4 v29, s[36:39], s48 offen offset:1024 lds
s_mov_b32 s28, s12
s_and_b32 s29, s13, 0xffff
s_mov_b32 s30, 6291456
s_mov_b32 s31, 0x00020000
v_mov_b32 v26, v60
v_mov_b32 v27, v61
v_mov_b32 v28, v24
v_mov_b32 v29, v25
s_cmp_ge_i32 s55, 0
s_cselect_b32 s53, 128, s53
s_cselect_b32 s54, 24576, s54
s_cmp_ge_i32 s56, 0
s_cselect_b32 s57, 8192, s57
s_and_b32 s48, s2, 7
s_add_u32 s47, s42, s48
s_and_b32 s47, s47, 7
s_mul_i32 s47, s47, 2
s_and_b32 s50, s42, 8
s_or_b32 s50, s50, 3
s_and_b32 s48, s2, 7
s_add_u32 s76, s50, s48
s_and_b32 s76, s76, 7
s_mul_i32 s76, s76, 2
s_add_u32 s69, s47, 0
s_and_b32 s69, s69, 15
s_mul_i32 s67, s69, 128
s_mul_i32 s68, s69, s54
s_waitcnt vmcnt(0) lgkmcnt(0)
s_barrier
s_mov_b32 s36, s14
s_and_b32 s37, s15, 0xffff
s_mov_b32 s38, 65536
s_mov_b32 s39, 0x00020000
s_lshl_b32 s48, s42, 12
s_lshl_b32 s49, s43, 10
s_add_u32 s48, s48, s49
s_add_u32 m0, s49, 135168
s_nop 0
buffer_load_dwordx4 v18, s[36:39], s48 offen lds
ds_read_b128 v[232:235], v52 offset:57344
ds_read_b128 v[236:239], v52 offset:58368
ds_read_b128 v[152:155], v51 offset:40960
ds_read_b128 v[156:159], v51 offset:41984
ds_read_b128 v[160:163], v51 offset:49152
ds_read_b128 v[164:167], v51 offset:50176
ds_read_b128 v[168:171], v51 offset:57344
ds_read_b128 v[172:175], v51 offset:58368
ds_read_b128 v[176:179], v52 offset:0
ds_read_b128 v[180:183], v52 offset:1024
ds_read_b128 v[184:187], v52 offset:8192
ds_read_b128 v[188:191], v52 offset:9216
ds_read_b128 v[192:195], v52 offset:16384
ds_read_b128 v[196:199], v52 offset:17408
ds_read_b128 v[200:203], v52 offset:24576
ds_read_b128 v[204:207], v52 offset:25600
ds_read_b128 v[208:211], v52 offset:32768
ds_read_b128 v[212:215], v52 offset:33792
ds_read_b128 v[216:219], v52 offset:40960
ds_read_b128 v[220:223], v52 offset:41984
ds_read_b128 v[224:227], v52 offset:49152
ds_read_b128 v[228:231], v52 offset:50176
ds_read_b128 v[112:115], v51 offset:0
ds_read_b128 v[116:119], v51 offset:1024
ds_read_b128 v[120:123], v51 offset:8192
ds_read_b128 v[124:127], v51 offset:9216
ds_read_b128 v[128:131], v51 offset:16384
ds_read_b128 v[132:135], v51 offset:17408
s_add_u32 s48, s80, 0
v_add_u32 v20, s48, v18
v_mov_b32 v21, v20
v_add_u32 v22, 30720, v20
v_mov_b32 v23, v22
v_add_u32 v37, 262144, v37
s_lshl_b32 s50, s42, 2
s_add_u32 s50, s50, s43
s_lshl_b32 s50, s50, 12
s_add_u32 s50, s50, 18087936
v_add_u32 v38, s50, v18
v_min_u32 v4, 2, v3
v_lshlrev_b32 v4, 8, v4
v_lshl_add_u32 v4, v2, 2, v4
s_and_b32 s48, s43, 1
s_lshl_b32 s48, s48, 7
s_lshr_b32 s49, s43, 1
s_lshl_b32 s49, s49, 6
s_add_u32 s48, s48, s49
s_add_u32 s48, s48, 133888
v_add_u32 v53, s48, v4
s_getpc_b64 s[98:99]
pc_30:
s_add_u32 s98, s98, c1_last - pc_30
s_addc_u32 s99, s99, 0
s_lshr_b32 s50, s2, 3
s_lshl_b32 s50, s50, 2
s_add_u32 s50, s50, s43
s_lshl_b32 s50, s50, 7
v_and_b32 v4, 1, v0
v_lshl_add_u32 v4, v4, 6, s50
v_min_u32 v54, L_code_end - c1_last, v4
s_waitcnt vmcnt(0) lgkmcnt(0)
s_add_u32 s69, s47, 1
s_and_b32 s69, s69, 15
s_mul_i32 s67, s69, 2048
s_mul_i32 s68, s69, s54
s_barrier
s_add_u32 s60, s71, 40960
s_add_u32 m0, s60, 0
s_mov_b32 s61, s68
buffer_load_dwordx4 v26, s[28:31], s61 offen lds
buffer_load_dwordx4 v27, s[28:31], s61 offen offset:1024 lds
s_add_u32 m0, s60, 8192
s_add_u32 s61, s61, s53
buffer_load_dwordx4 v26, s[28:31], s61 offen lds
buffer_load_dwordx4 v27, s[28:31], s61 offen offset:1024 lds
s_add_u32 m0, s60, 16384
s_add_u32 s61, s61, s53
buffer_load_dwordx4 v26, s[28:31], s61 offen lds
buffer_load_dwordx4 v27, s[28:31], s61 offen offset:1024 lds
s_add_u32 s49, s76, 2
s_and_b32 s49, s49, 15
s_mul_i32 s49, s49, 393216
buffer_load_dwordx4 v[40:43], v36, s[28:31], s49 offen
s_add_u32 s49, s76, 3
s_and_b32 s49, s49, 15
s_mul_i32 s49, s49, 393216
buffer_load_dwordx4 v[40:43], v36, s[28:31], s49 offen
buffer_load_dword v5, v30, s[32:35], s79 offen sc1
s_add_u32 s69, s47, 0
s_and_b32 s69, s69, 15
s_mul_i32 s67, s69, 2048
s_mul_i32 s68, s69, s54
s_add_u32 m0, s70, 0
s_nop 0
s_mov_b32 s63, 0
s_waitcnt vmcnt(0)
poll_31:
v_cmp_gt_u32 vcc, 1, v5
s_cbranch_vccz polled_32
buffer_load_dword v5, v30, s[32:35], s79 offen sc1
s_add_u32 s63, s63, 1
s_cmp_lt_u32 s63, 0x80000
s_waitcnt vmcnt(0)
s_cbranch_scc1 poll_31
polled_32:
buffer_load_dwordx4 v20, s[32:35], s67 offen offset:0 sc1 lds
buffer_load_dwordx4 v21, s[32:35], s67 offen offset:1024 sc1 lds
buffer_load_dwordx4 v22, s[32:35], s67 offen offset:2048 sc1 lds
buffer_load_dwordx4 v23, s[32:35], s67 offen offset:3072 sc1 lds
s_add_u32 s69, s47, 1
s_and_b32 s69, s69, 15
s_mul_i32 s67, s69, 2048
s_mul_i32 s68, s69, s54
s_add_u32 m0, s70, 40960
s_nop 0
buffer_load_dwordx4 v20, s[32:35], s67 offen offset:0 sc1 lds
buffer_load_dwordx4 v21, s[32:35], s67 offen offset:1024 sc1 lds
buffer_load_dwordx4 v22, s[32:35], s67 offen offset:2048 sc1 lds
buffer_load_dwordx4 v23, s[32:35], s67 offen offset:3072 sc1 lds
s_waitcnt vmcnt(4) lgkmcnt(0)
s_barrier
s_add_u32 s69, s47, 2
s_and_b32 s69, s69, 15
s_mul_i32 s67, s69, 2048
s_mul_i32 s68, s69, s54
s_add_u32 m0, s70, 81920
s_nop 0
buffer_load_dwordx4 v20, s[32:35], s67 offen offset:0 sc1 lds
buffer_load_dwordx4 v21, s[32:35], s67 offen offset:1024 sc1 lds
buffer_load_dwordx4 v22, s[32:35], s67 offen offset:2048 sc1 lds
buffer_load_dwordx4 v23, s[32:35], s67 offen offset:3072 sc1 lds
s_add_u32 s60, s71, 81920
s_add_u32 m0, s60, 0
s_mov_b32 s61, s68
buffer_load_dwordx4 v26, s[28:31], s61 offen lds
buffer_load_dwordx4 v27, s[28:31], s61 offen offset:1024 lds
s_add_u32 m0, s60, 8192
s_add_u32 s61, s61, s53
buffer_load_dwordx4 v26, s[28:31], s61 offen lds
buffer_load_dwordx4 v27, s[28:31], s61 offen offset:1024 lds
s_add_u32 m0, s60, 16384
s_add_u32 s61, s61, s53
buffer_load_dwordx4 v26, s[28:31], s61 offen lds
buffer_load_dwordx4 v27, s[28:31], s61 offen offset:1024 lds
s_add_u32 s49, s76, 4
s_and_b32 s49, s49, 15
s_mul_i32 s49, s49, 393216
buffer_load_dwordx4 v[40:43], v36, s[28:31], s49 offen
s_mov_b32 s64, 0
s_mov_b32 s65, 0
h1_loop:
s_waitcnt vmcnt(11)
s_barrier
s_add_u32 s69, s69, 1
s_and_b32 s69, s69, 15
s_mul_i32 s67, s69, 2048
s_mul_i32 s68, s69, s54
s_add_u32 m0, s70, s65
s_nop 0
buffer_load_dwordx4 v20, s[32:35], s67 offen offset:0 sc1 lds
buffer_load_dwordx4 v21, s[32:35], s67 offen offset:1024 sc1 lds
buffer_load_dwordx4 v22, s[32:35], s67 offen offset:2048 sc1 lds
buffer_load_dwordx4 v23, s[32:35], s67 offen offset:3072 sc1 lds
s_add_u32 s60, s71, s65
s_add_u32 m0, s60, 0
s_mov_b32 s61, s68
buffer_load_dwordx4 v26, s[28:31], s61 offen lds
buffer_load_dwordx4 v27, s[28:31], s61 offen offset:1024 lds
s_add_u32 m0, s60, 8192
s_add_u32 s61, s61, s53
buffer_load_dwordx4 v26, s[28:31], s61 offen lds
buffer_load_dwordx4 v27, s[28:31], s61 offen offset:1024 lds
s_add_u32 m0, s60, 16384
s_add_u32 s61, s61, s53
buffer_load_dwordx4 v26, s[28:31], s61 offen lds
buffer_load_dwordx4 v27, s[28:31], s61 offen offset:1024 lds
s_add_u32 s48, s64, 5
s_min_u32 s48, s48, 15
s_add_u32 s49, s48, s76
s_and_b32 s49, s49, 15
s_mul_i32 s49, s49, 393216
buffer_load_dwordx4 v[40:43], v36, s[28:31], s49 offen
s_add_u32 s65, s65, 40960
s_cmp_eq_u32 s65, 122880
s_cselect_b32 s65, 0, s65
s_add_u32 s64, s64, 1
s_cmp_lt_u32 s64, 11
s_cbranch_scc1 h1_loop
s_waitcnt vmcnt(11)
s_barrier
s_add_u32 s69, s47, 14
s_and_b32 s69, s69, 15
s_mul_i32 s67, s69, 2048
s_mul_i32 s68, s69, s54
s_add_u32 m0, s70, s65
s_nop 0
buffer_load_dwordx4 v20, s[32:35], s67 offen offset:0 sc1 lds
buffer_load_dwordx4 v21, s[32:35], s67 offen offset:1024 sc1 lds
buffer_load_dwordx4 v22, s[32:35], s67 offen offset:2048 sc1 lds
buffer_load_dwordx4 v23, s[32:35], s67 offen offset:3072 sc1 lds
s_add_u32 s60, s71, s65
s_add_u32 m0, s60, 0
s_mov_b32 s61, s68
buffer_load_dwordx4 v26, s[28:31], s61 offen lds
buffer_load_dwordx4 v27, s[28:31], s61 offen offset:1024 lds
s_add_u32 m0, s60, 8192
s_add_u32 s61, s61, s53
buffer_load_dwordx4 v26, s[28:31], s61 offen lds
buffer_load_dwordx4 v27, s[28:31], s61 offen offset:1024 lds
s_add_u32 m0, s60, 16384
s_add_u32 s61, s61, s53
buffer_load_dwordx4 v26, s[28:31], s61 offen lds
buffer_load_dwordx4 v27, s[28:31], s61 offen offset:1024 lds
s_add_u32 s65, s65, 40960
s_cmp_eq_u32 s65, 122880
s_cselect_b32 s65, 0, s65
s_add_u32 s64, s64, 1
s_mov_b32 s36, s16
s_and_b32 s37, s17, 0xffff
s_mov_b32 s38, 2097152
s_mov_b32 s39, 0x00020000
s_waitcnt vmcnt(10)
s_barrier
s_add_u32 s69, s47, 15
s_and_b32 s69, s69, 15
s_mul_i32 s67, s69, 2048
s_mul_i32 s68, s69, s54
s_add_u32 m0, s70, 0
s_nop 0
buffer_load_dwordx4 v20, s[32:35], s67 offen offset:0 sc1 lds
buffer_load_dwordx4 v21, s[32:35], s67 offen offset:1024 sc1 lds
buffer_load_dwordx4 v22, s[32:35], s67 offen offset:2048 sc1 lds
buffer_load_dwordx4 v23, s[32:35], s67 offen offset:3072 sc1 lds
s_add_u32 s60, s71, 0
s_add_u32 m0, s60, 0
s_mov_b32 s61, s68
buffer_load_dwordx4 v26, s[28:31], s61 offen lds
buffer_load_dwordx4 v27, s[28:31], s61 offen offset:1024 lds
s_add_u32 m0, s60, 8192
s_add_u32 s61, s61, s53
buffer_load_dwordx4 v26, s[28:31], s61 offen lds
buffer_load_dwordx4 v27, s[28:31], s61 offen offset:1024 lds
s_add_u32 m0, s60, 16384
s_add_u32 s61, s61, s53
buffer_load_dwordx4 v26, s[28:31], s61 offen lds
buffer_load_dwordx4 v27, s[28:31], s61 offen offset:1024 lds
s_waitcnt vmcnt(10)
s_barrier
s_setprio 0
buffer_load_dwordx4 v[240:243], v15, s[36:39], 0 offen offset:0
buffer_load_dwordx4 v[240:243], v15, s[36:39], 0 offen offset:1024
buffer_load_dwordx4 v[80:83], v37, s[32:35], 0 offen offset:0 sc1
buffer_load_dwordx4 v[84:87], v37, s[32:35], 0 offen offset:1024 sc1
buffer_load_dwordx4 v[88:91], v37, s[32:35], 0 offen offset:2048 sc1
buffer_load_dwordx4 v[92:95], v37, s[32:35], 0 offen offset:3072 sc1
global_load_dword v48, v54, s[98:99]
buffer_load_dwordx4 v[64:67], v38, s[32:35], 0 offen offset:0 sc1
buffer_load_dwordx4 v[68:71], v38, s[32:35], 0 offen offset:1024 sc1
buffer_load_dwordx4 v[72:75], v38, s[32:35], 0 offen offset:2048 sc1
buffer_load_dwordx4 v[76:79], v38, s[32:35], 0 offen offset:3072 sc1
s_add_u32 s48, s75, 15
s_and_b32 s48, s48, 15
s_mul_i32 s48, s48, s57
s_add_u32 m0, s71, 106496
s_nop 0
buffer_load_dwordx4 v28, s[36:39], s48 offen lds
buffer_load_dwordx4 v29, s[36:39], s48 offen offset:1024 lds
s_waitcnt vmcnt(13)
s_barrier
s_add_u32 s48, s75, 5
s_and_b32 s48, s48, 15
s_mul_i32 s48, s48, s57
s_add_u32 m0, s71, 24576
s_nop 0
buffer_load_dwordx4 v28, s[36:39], s48 offen lds
buffer_load_dwordx4 v29, s[36:39], s48 offen offset:1024 lds
s_waitcnt vmcnt(4)
s_add_u32 s48, s75, 6
s_and_b32 s48, s48, 15
s_mul_i32 s48, s48, s57
s_add_u32 m0, s71, 32768
s_nop 0
buffer_load_dwordx4 v28, s[36:39], s48 offen lds
v_add_f32 v80, v80, v88
v_add_f32 v64, v64, v72
v_add_f32 v81, v81, v89
v_add_f32 v65, v65, v73
v_add_f32 v82, v82, v90
v_add_f32 v66, v66, v74
v_add_f32 v83, v83, v91
v_add_f32 v67, v67, v75
v_add_f32 v84, v84, v92
v_add_f32 v68, v68, v76
buffer_load_dwordx4 v29, s[36:39], s48 offen offset:1024 lds
v_add_f32 v85, v85, v93
v_add_f32 v69, v69, v77
v_add_f32 v86, v86, v94
v_add_f32 v70, v70, v78
v_add_f32 v87, v87, v95
v_add_f32 v71, v71, v79
v_add_f32 v80, v80, v84
v_add_f32 v64, v64, v68
v_add_f32 v81, v81, v85
v_add_f32 v65, v65, v69
s_add_u32 s48, s75, 7
s_and_b32 s48, s48, 15
s_mul_i32 s48, s48, s57
s_add_u32 m0, s71, 40960
s_nop 0
buffer_load_dwordx4 v28, s[36:39], s48 offen lds
v_add_f32 v82, v82, v86
v_add_f32 v66, v66, v70
v_add_f32 v83, v83, v87
v_add_f32 v67, v67, v71
s_nop 1
s_nop 1
v_permlane32_swap_b32 v80, v81
v_permlane32_swap_b32 v64, v65
v_permlane32_swap_b32 v82, v83
buffer_load_dwordx4 v29, s[36:39], s48 offen offset:1024 lds
v_permlane32_swap_b32 v66, v67
v_add_f32 v80, v80, v81
v_add_f32 v64, v64, v65
v_add_f32 v82, v82, v83
v_add_f32 v66, v66, v67
s_nop 1
s_nop 1
v_permlane16_swap_b32 v80, v82
v_permlane16_swap_b32 v64, v66
s_nop 0
s_add_u32 s48, s75, 8
s_and_b32 s48, s48, 15
s_mul_i32 s48, s48, s57
s_add_u32 m0, s71, 49152
s_nop 0
buffer_load_dwordx4 v28, s[36:39], s48 offen lds
s_nop 0
v_add_f32 v80, v80, v82
v_add_f32 v64, v64, v66
v_cmp_u_f32 vcc, v80, v80
s_cbranch_vccnz again_33
summed_34:
v_cmp_u_f32 vcc, v64, v64
s_cbranch_vccnz again_36
summed_37:
v_mul_f32 v44, 0x3a800000, v80
ds_write_b32 v53, v64
v_mov_b32 v45, v44
s_nop 1
v_permlane16_swap_b32 v44, v45
buffer_load_dwordx4 v29, s[36:39], s48 offen offset:1024 lds
s_nop 0
v_fma_f32 v45, -v44, v44, v45
v_max_f32 v45, 0, v45
v_add_f32 v45, 0x3727c5ac, v45
v_rsq_f32 v46, v45
v_sub_f32 v47, 0, v44
ds_write_b32 v50, v47 offset:512
ds_write_b64 v49, v[46:47]
ds_write_b32 v50, v46
s_setprio 0
s_waitcnt lgkmcnt(0)
s_waitcnt vmcnt(63)
s_barrier
s_waitcnt vmcnt(5)
s_add_u32 s48, s75, 9
s_and_b32 s48, s48, 15
s_mul_i32 s48, s48, s57
s_add_u32 m0, s71, 57344
s_nop 0
buffer_load_dwordx4 v28, s[36:39], s48 offen lds
buffer_load_dwordx4 v29, s[36:39], s48 offen offset:1024 lds
s_waitcnt vmcnt(5)
s_add_u32 s48, s75, 10
s_and_b32 s48, s48, 15
s_mul_i32 s48, s48, s57
s_add_u32 m0, s71, 65536
s_nop 0
buffer_load_dwordx4 v28, s[36:39], s48 offen lds
buffer_load_dwordx4 v29, s[36:39], s48 offen offset:1024 lds
s_waitcnt vmcnt(5)
s_add_u32 s48, s75, 11
s_and_b32 s48, s48, 15
s_mul_i32 s48, s48, s57
s_add_u32 m0, s71, 73728
s_nop 0
buffer_load_dwordx4 v28, s[36:39], s48 offen lds
buffer_load_dwordx4 v29, s[36:39], s48 offen offset:1024 lds
s_waitcnt vmcnt(5)
s_add_u32 s48, s75, 12
s_and_b32 s48, s48, 15
s_mul_i32 s48, s48, s57
s_add_u32 m0, s71, 81920
s_nop 0
buffer_load_dwordx4 v28, s[36:39], s48 offen lds
buffer_load_dwordx4 v29, s[36:39], s48 offen offset:1024 lds
s_waitcnt vmcnt(5)
s_add_u32 s48, s75, 13
s_and_b32 s48, s48, 15
s_mul_i32 s48, s48, s57
s_add_u32 m0, s71, 90112
s_nop 0
buffer_load_dwordx4 v28, s[36:39], s48 offen lds
buffer_load_dwordx4 v29, s[36:39], s48 offen offset:1024 lds
s_waitcnt vmcnt(5)
s_add_u32 s48, s75, 14
s_and_b32 s48, s48, 15
s_mul_i32 s48, s48, s57
s_add_u32 m0, s71, 98304
s_nop 0
buffer_load_dwordx4 v28, s[36:39], s48 offen lds
buffer_load_dwordx4 v29, s[36:39], s48 offen offset:1024 lds
s_waitcnt vmcnt(5)
s_add_u32 s48, s75, 0
s_and_b32 s48, s48, 15
s_mul_i32 s48, s48, s57
s_add_u32 m0, s71, 4294950912
s_nop 0
buffer_load_dwordx4 v28, s[36:39], s48 offen lds
buffer_load_dwordx4 v29, s[36:39], s48 offen offset:1024 lds
s_waitcnt vmcnt(5)
s_add_u32 s48, s75, 1
s_and_b32 s48, s48, 15
s_mul_i32 s48, s48, s57
s_add_u32 m0, s71, 4294959104
s_nop 0
buffer_load_dwordx4 v28, s[36:39], s48 offen lds
buffer_load_dwordx4 v29, s[36:39], s48 offen offset:1024 lds
s_waitcnt vmcnt(5)
s_add_u32 s48, s75, 2
s_and_b32 s48, s48, 15
s_mul_i32 s48, s48, s57
s_add_u32 m0, s71, 0
s_nop 0
buffer_load_dwordx4 v28, s[36:39], s48 offen lds
buffer_load_dwordx4 v29, s[36:39], s48 offen offset:1024 lds
s_waitcnt vmcnt(5)
s_add_u32 s48, s75, 3
s_and_b32 s48, s48, 15
s_mul_i32 s48, s48, s57
s_add_u32 m0, s71, 8192
s_nop 0
buffer_load_dwordx4 v28, s[36:39], s48 offen lds
buffer_load_dwordx4 v29, s[36:39], s48 offen offset:1024 lds
s_waitcnt vmcnt(5)
s_add_u32 s48, s75, 4
s_and_b32 s48, s48, 15
s_mul_i32 s48, s48, s57
s_add_u32 m0, s71, 16384
s_nop 0
buffer_load_dwordx4 v28, s[36:39], s48 offen lds
buffer_load_dwordx4 v29, s[36:39], s48 offen offset:1024 lds
s_waitcnt vmcnt(5)
buffer_load_dwordx4 v[240:243], v18, s[32:35], s81 offen offset:0 sc1
buffer_load_dwordx4 v[240:243], v18, s[32:35], s81 offen offset:1024 sc1
s_waitcnt vmcnt(5)
buffer_load_dwordx4 v[240:243], v18, s[32:35], s82 offen offset:0 sc1
buffer_load_dwordx4 v[240:243], v18, s[32:35], s82 offen offset:1024 sc1
s_mov_b32 s28, s6
s_and_b32 s29, s7, 0xffff
s_mov_b32 s30, 6291456
s_mov_b32 s31, 0x00020000
s_and_b32 s48, s2, 7
s_lshl_b32 s48, s48, 1
s_add_u32 s47, s42, s48
s_and_b32 s47, s47, 15
s_and_b32 s50, s42, 8
s_or_b32 s50, s50, 3
s_and_b32 s48, s2, 7
s_lshl_b32 s48, s48, 1
s_add_u32 s76, s50, s48
s_and_b32 s76, s76, 15
s_add_u32 s69, s47, 0
s_and_b32 s69, s69, 15
s_mul_i32 s67, s69, 2048
s_mul_i32 s68, s69, s54
s_waitcnt vmcnt(0) lgkmcnt(0)
s_barrier
s_add_u32 s60, s71, 122880
s_add_u32 m0, s60, 0
s_mov_b32 s61, s68
buffer_load_dwordx4 v26, s[28:31], s61 offen lds
buffer_load_dwordx4 v27, s[28:31], s61 offen offset:1024 lds
s_add_u32 m0, s60, 8192
s_add_u32 s61, s61, s53
buffer_load_dwordx4 v26, s[28:31], s61 offen lds
buffer_load_dwordx4 v27, s[28:31], s61 offen offset:1024 lds
s_add_u32 m0, s60, 16384
s_add_u32 s61, s61, s53
buffer_load_dwordx4 v26, s[28:31], s61 offen lds
buffer_load_dwordx4 v27, s[28:31], s61 offen offset:1024 lds
v_add_u32 v37, 262144, v37
s_getpc_b64 s[98:99]
pc_39:
s_add_u32 s98, s98, c2_last - pc_39
s_addc_u32 s99, s99, 0
s_lshr_b32 s50, s2, 3
s_lshl_b32 s50, s50, 2
s_add_u32 s50, s50, s43
s_lshl_b32 s50, s50, 7
v_and_b32 v4, 1, v0
v_lshl_add_u32 v4, v4, 6, s50
v_min_u32 v54, L_code_end - c2_last, v4
s_waitcnt vmcnt(0) lgkmcnt(0)
s_add_u32 s69, s47, 1
s_and_b32 s69, s69, 15
s_mul_i32 s67, s69, 2048
s_mul_i32 s68, s69, s54
s_barrier
s_add_u32 s60, s71, 40960
s_add_u32 m0, s60, 0
s_mov_b32 s61, s68
buffer_load_dwordx4 v26, s[28:31], s61 offen lds
buffer_load_dwordx4 v27, s[28:31], s61 offen offset:1024 lds
s_add_u32 m0, s60, 8192
s_add_u32 s61, s61, s53
buffer_load_dwordx4 v26, s[28:31], s61 offen lds
buffer_load_dwordx4 v27, s[28:31], s61 offen offset:1024 lds
s_add_u32 m0, s60, 16384
s_add_u32 s61, s61, s53
buffer_load_dwordx4 v26, s[28:31], s61 offen lds
buffer_load_dwordx4 v27, s[28:31], s61 offen offset:1024 lds
s_add_u32 s49, s76, 2
s_and_b32 s49, s49, 15
s_mul_i32 s49, s49, 393216
buffer_load_dwordx4 v[40:43], v36, s[28:31], s49 offen
s_add_u32 s49, s76, 3
s_and_b32 s49, s49, 15
s_mul_i32 s49, s49, 393216
buffer_load_dwordx4 v[40:43], v36, s[28:31], s49 offen
buffer_load_dword v5, v30, s[32:35], s79 offen sc1
s_add_u32 s69, s47, 0
s_and_b32 s69, s69, 15
s_mul_i32 s67, s69, 2048
s_mul_i32 s68, s69, s54
s_add_u32 m0, s70, 0
s_nop 0
s_mov_b32 s63, 0
s_waitcnt vmcnt(0)
poll_40:
v_cmp_gt_u32 vcc, 2, v5
s_cbranch_vccz polled_41
buffer_load_dword v5, v30, s[32:35], s79 offen sc1
s_add_u32 s63, s63, 1
s_cmp_lt_u32 s63, 0x80000
s_waitcnt vmcnt(0)
s_cbranch_scc1 poll_40
polled_41:
buffer_load_dwordx4 v20, s[32:35], s67 offen offset:0 sc1 lds
buffer_load_dwordx4 v21, s[32:35], s67 offen offset:1024 sc1 lds
buffer_load_dwordx4 v22, s[32:35], s67 offen offset:2048 sc1 lds
buffer_load_dwordx4 v23, s[32:35], s67 offen offset:3072 sc1 lds
s_add_u32 s69, s47, 1
s_and_b32 s69, s69, 15
s_mul_i32 s67, s69, 2048
s_mul_i32 s68, s69, s54
s_add_u32 m0, s70, 40960
s_nop 0
buffer_load_dwordx4 v20, s[32:35], s67 offen offset:0 sc1 lds
buffer_load_dwordx4 v21, s[32:35], s67 offen offset:1024 sc1 lds
buffer_load_dwordx4 v22, s[32:35], s67 offen offset:2048 sc1 lds
buffer_load_dwordx4 v23, s[32:35], s67 offen offset:3072 sc1 lds
s_waitcnt vmcnt(4) lgkmcnt(0)
s_barrier
s_add_u32 s69, s47, 2
s_and_b32 s69, s69, 15
s_mul_i32 s67, s69, 2048
s_mul_i32 s68, s69, s54
s_add_u32 m0, s70, 81920
s_nop 0
buffer_load_dwordx4 v20, s[32:35], s67 offen offset:0 sc1 lds
buffer_load_dwordx4 v21, s[32:35], s67 offen offset:1024 sc1 lds
buffer_load_dwordx4 v22, s[32:35], s67 offen offset:2048 sc1 lds
buffer_load_dwordx4 v23, s[32:35], s67 offen offset:3072 sc1 lds
s_add_u32 s60, s71, 81920
s_add_u32 m0, s60, 0
s_mov_b32 s61, s68
buffer_load_dwordx4 v26, s[28:31], s61 offen lds
buffer_load_dwordx4 v27, s[28:31], s61 offen offset:1024 lds
s_add_u32 m0, s60, 8192
s_add_u32 s61, s61, s53
buffer_load_dwordx4 v26, s[28:31], s61 offen lds
buffer_load_dwordx4 v27, s[28:31], s61 offen offset:1024 lds
s_add_u32 m0, s60, 16384
s_add_u32 s61, s61, s53
buffer_load_dwordx4 v26, s[28:31], s61 offen lds
buffer_load_dwordx4 v27, s[28:31], s61 offen offset:1024 lds
s_add_u32 s49, s76, 4
s_and_b32 s49, s49, 15
s_mul_i32 s49, s49, 393216
buffer_load_dwordx4 v[40:43], v36, s[28:31], s49 offen
s_mov_b32 s64, 0
s_mov_b32 s65, 0
h2_loop:
s_waitcnt vmcnt(11)
s_barrier
s_add_u32 s69, s69, 1
s_and_b32 s69, s69, 15
s_mul_i32 s67, s69, 2048
s_mul_i32 s68, s69, s54
s_add_u32 m0, s70, s65
s_nop 0
buffer_load_dwordx4 v20, s[32:35], s67 offen offset:0 sc1 lds
buffer_load_dwordx4 v21, s[32:35], s67 offen offset:1024 sc1 lds
buffer_load_dwordx4 v22, s[32:35], s67 offen offset:2048 sc1 lds
buffer_load_dwordx4 v23, s[32:35], s67 offen offset:3072 sc1 lds
s_add_u32 s60, s71, s65
s_add_u32 m0, s60, 0
s_mov_b32 s61, s68
buffer_load_dwordx4 v26, s[28:31], s61 offen lds
buffer_load_dwordx4 v27, s[28:31], s61 offen offset:1024 lds
s_add_u32 m0, s60, 8192
s_add_u32 s61, s61, s53
buffer_load_dwordx4 v26, s[28:31], s61 offen lds
buffer_load_dwordx4 v27, s[28:31], s61 offen offset:1024 lds
s_add_u32 m0, s60, 16384
s_add_u32 s61, s61, s53
buffer_load_dwordx4 v26, s[28:31], s61 offen lds
buffer_load_dwordx4 v27, s[28:31], s61 offen offset:1024 lds
s_add_u32 s48, s64, 5
s_min_u32 s48, s48, 15
s_add_u32 s49, s48, s76
s_and_b32 s49, s49, 15
s_mul_i32 s49, s49, 393216
buffer_load_dwordx4 v[40:43], v36, s[28:31], s49 offen
s_add_u32 s65, s65, 40960
s_cmp_eq_u32 s65, 122880
s_cselect_b32 s65, 0, s65
s_add_u32 s64, s64, 1
s_cmp_lt_u32 s64, 11
s_cbranch_scc1 h2_loop
s_waitcnt vmcnt(11)
s_barrier
s_add_u32 s69, s47, 14
s_and_b32 s69, s69, 15
s_mul_i32 s67, s69, 2048
s_mul_i32 s68, s69, s54
s_add_u32 m0, s70, s65
s_nop 0
buffer_load_dwordx4 v20, s[32:35], s67 offen offset:0 sc1 lds
buffer_load_dwordx4 v21, s[32:35], s67 offen offset:1024 sc1 lds
buffer_load_dwordx4 v22, s[32:35], s67 offen offset:2048 sc1 lds
buffer_load_dwordx4 v23, s[32:35], s67 offen offset:3072 sc1 lds
s_add_u32 s60, s71, s65
s_add_u32 m0, s60, 0
s_mov_b32 s61, s68
buffer_load_dwordx4 v26, s[28:31], s61 offen lds
buffer_load_dwordx4 v27, s[28:31], s61 offen offset:1024 lds
s_add_u32 m0, s60, 8192
s_add_u32 s61, s61, s53
buffer_load_dwordx4 v26, s[28:31], s61 offen lds
buffer_load_dwordx4 v27, s[28:31], s61 offen offset:1024 lds
s_add_u32 m0, s60, 16384
s_add_u32 s61, s61, s53
buffer_load_dwordx4 v26, s[28:31], s61 offen lds
buffer_load_dwordx4 v27, s[28:31], s61 offen offset:1024 lds
s_add_u32 s65, s65, 40960
s_cmp_eq_u32 s65, 122880
s_cselect_b32 s65, 0, s65
s_add_u32 s64, s64, 1
s_mov_b32 s36, s12
s_and_b32 s37, s13, 0xffff
s_mov_b32 s38, 6291456
s_mov_b32 s39, 0x00020000
s_waitcnt vmcnt(10)
s_barrier
s_add_u32 s69, s47, 15
s_and_b32 s69, s69, 15
s_mul_i32 s67, s69, 2048
s_mul_i32 s68, s69, s54
s_add_u32 m0, s70, 0
s_nop 0
buffer_load_dwordx4 v20, s[32:35], s67 offen offset:0 sc1 lds
buffer_load_dwordx4 v21, s[32:35], s67 offen offset:1024 sc1 lds
buffer_load_dwordx4 v22, s[32:35], s67 offen offset:2048 sc1 lds
buffer_load_dwordx4 v23, s[32:35], s67 offen offset:3072 sc1 lds
s_add_u32 s60, s71, 0
s_add_u32 m0, s60, 0
s_mov_b32 s61, s68
buffer_load_dwordx4 v26, s[28:31], s61 offen lds
buffer_load_dwordx4 v27, s[28:31], s61 offen offset:1024 lds
s_add_u32 m0, s60, 8192
s_add_u32 s61, s61, s53
buffer_load_dwordx4 v26, s[28:31], s61 offen lds
buffer_load_dwordx4 v27, s[28:31], s61 offen offset:1024 lds
s_add_u32 m0, s60, 16384
s_add_u32 s61, s61, s53
buffer_load_dwordx4 v26, s[28:31], s61 offen lds
buffer_load_dwordx4 v27, s[28:31], s61 offen offset:1024 lds
s_waitcnt vmcnt(10)
s_barrier
s_setprio 0
buffer_load_dwordx4 v[80:83], v37, s[32:35], 0 offen offset:0 sc1
buffer_load_dwordx4 v[84:87], v37, s[32:35], 0 offen offset:1024 sc1
buffer_load_dwordx4 v[88:91], v37, s[32:35], 0 offen offset:2048 sc1
buffer_load_dwordx4 v[92:95], v37, s[32:35], 0 offen offset:3072 sc1
global_load_dword v48, v54, s[98:99]
s_add_u32 s69, s47, 0
s_and_b32 s69, s69, 15
s_mul_i32 s67, s69, 2048
s_mul_i32 s68, s69, s54
s_add_u32 s60, s71, 122880
s_add_u32 m0, s60, 0
s_mov_b32 s61, s68
buffer_load_dwordx4 v26, s[36:39], s61 offen lds
buffer_load_dwordx4 v27, s[36:39], s61 offen offset:1024 lds
s_add_u32 m0, s60, 8192
s_add_u32 s61, s61, s53
buffer_load_dwordx4 v26, s[36:39], s61 offen lds
buffer_load_dwordx4 v27, s[36:39], s61 offen offset:1024 lds
s_add_u32 m0, s60, 16384
s_add_u32 s61, s61, s53
buffer_load_dwordx4 v26, s[36:39], s61 offen lds
buffer_load_dwordx4 v27, s[36:39], s61 offen offset:1024 lds
s_waitcnt vmcnt(11)
s_barrier
s_waitcnt vmcnt(7)
buffer_store_dwordx4 v[56:59], v18, s[32:35], s86 offen offset:0 sc1
v_add_f32 v80, v80, v88
v_add_f32 v81, v81, v89
v_add_f32 v82, v82, v90
v_add_f32 v83, v83, v91
v_add_f32 v84, v84, v92
v_add_f32 v85, v85, v93
v_add_f32 v86, v86, v94
buffer_store_dwordx4 v[56:59], v18, s[32:35], s86 offen offset:1024 sc1
v_add_f32 v87, v87, v95
v_add_f32 v80, v80, v84
v_add_f32 v81, v81, v85
v_add_f32 v82, v82, v86
v_add_f32 v83, v83, v87
s_nop 1
buffer_load_dwordx4 v[240:243], v18, s[32:35], s81 offen offset:0 sc1
v_permlane32_swap_b32 v80, v81
v_permlane32_swap_b32 v82, v83
v_add_f32 v80, v80, v81
v_add_f32 v82, v82, v83
s_nop 1
v_permlane16_swap_b32 v80, v82
buffer_load_dwordx4 v[240:243], v18, s[32:35], s81 offen offset:1024 sc1
s_nop 0
v_add_f32 v80, v80, v82
v_cmp_u_f32 vcc, v80, v80
s_cbranch_vccnz again_42
summed_43:
v_mul_f32 v44, 0x3a800000, v80
buffer_load_dwordx4 v[240:243], v18, s[32:35], s82 offen offset:0 sc1
v_mov_b32 v45, v44
s_nop 1
v_permlane16_swap_b32 v44, v45
s_nop 0
v_fma_f32 v45, -v44, v44, v45
v_max_f32 v45, 0, v45
buffer_load_dwordx4 v[240:243], v18, s[32:35], s82 offen offset:1024 sc1
v_add_f32 v45, 0x3727c5ac, v45
v_rsq_f32 v46, v45
v_sub_f32 v47, 0, v44
ds_write_b32 v50, v47 offset:512
ds_write_b64 v49, v[46:47]
ds_write_b32 v50, v46
s_setprio 0
s_waitcnt lgkmcnt(0)
s_waitcnt vmcnt(63)
s_barrier
ds_write_b128 v52, v[232:235] offset:57344
ds_write_b128 v52, v[236:239] offset:58368
ds_write_b128 v51, v[152:155] offset:40960
ds_write_b128 v51, v[156:159] offset:41984
ds_write_b128 v51, v[160:163] offset:49152
ds_write_b128 v51, v[164:167] offset:50176
ds_write_b128 v51, v[168:171] offset:57344
ds_write_b128 v51, v[172:175] offset:58368
ds_write_b128 v52, v[176:179] offset:0
ds_write_b128 v52, v[180:183] offset:1024
ds_write_b128 v52, v[184:187] offset:8192
ds_write_b128 v52, v[188:191] offset:9216
ds_write_b128 v52, v[192:195] offset:16384
ds_write_b128 v52, v[196:199] offset:17408
ds_write_b128 v52, v[200:203] offset:24576
ds_write_b128 v52, v[204:207] offset:25600
ds_write_b128 v52, v[208:211] offset:32768
ds_write_b128 v52, v[212:215] offset:33792
ds_write_b128 v52, v[216:219] offset:40960
ds_write_b128 v52, v[220:223] offset:41984
ds_write_b128 v52, v[224:227] offset:49152
ds_write_b128 v52, v[228:231] offset:50176
ds_write_b128 v51, v[112:115] offset:0
ds_write_b128 v51, v[116:119] offset:1024
ds_write_b128 v51, v[120:123] offset:8192
ds_write_b128 v51, v[124:127] offset:9216
ds_write_b128 v51, v[128:131] offset:16384
ds_write_b128 v51, v[132:135] offset:17408
ds_write_b128 v51, v[136:139] offset:24576
ds_write_b128 v51, v[140:143] offset:25600
ds_write_b128 v51, v[144:147] offset:32768
ds_write_b128 v51, v[148:151] offset:33792
s_mov_b32 s28, s12
s_and_b32 s29, s13, 0xffff
s_mov_b32 s30, 6291456
s_mov_b32 s31, 0x00020000
s_add_u32 s69, s47, 0
s_and_b32 s69, s69, 15
s_mul_i32 s67, s69, 2048
s_mul_i32 s68, s69, s54
s_waitcnt vmcnt(0) lgkmcnt(0)
s_barrier
s_mov_b32 s36, s14
s_and_b32 s37, s15, 0xffff
s_mov_b32 s38, 65536
s_mov_b32 s39, 0x00020000
s_lshl_b32 s48, s42, 12
s_lshl_b32 s49, s43, 10
s_add_u32 s48, s48, s49
s_add_u32 m0, s49, 135168
s_nop 0
buffer_load_dwordx4 v18, s[36:39], s48 offen lds
v_add_u32 v37, 262144, v37
s_getpc_b64 s[98:99]
pc_45:
s_add_u32 s98, s98, c3_last - pc_45
s_addc_u32 s99, s99, 0
s_lshr_b32 s50, s2, 3
s_lshl_b32 s50, s50, 2
s_add_u32 s50, s50, s43
s_lshl_b32 s50, s50, 7
v_and_b32 v4, 1, v0
v_lshl_add_u32 v4, v4, 6, s50
v_min_u32 v54, L_code_end - c3_last, v4
s_cmp_lg_u32 s43, 0
s_cbranch_scc1 else_46
s_mov_b32 s48, 1
s_atomic_add s48, s[22:23], s73
else_46:
s_waitcnt vmcnt(0) lgkmcnt(0)
s_add_u32 s69, s47, 1
s_and_b32 s69, s69, 15
s_mul_i32 s67, s69, 2048
s_mul_i32 s68, s69, s54
s_barrier
s_add_u32 s60, s71, 40960
s_add_u32 m0, s60, 0
s_mov_b32 s61, s68
buffer_load_dwordx4 v26, s[28:31], s61 offen lds
buffer_load_dwordx4 v27, s[28:31], s61 offen offset:1024 lds
s_add_u32 m0, s60, 8192
s_add_u32 s61, s61, s53
buffer_load_dwordx4 v26, s[28:31], s61 offen lds
buffer_load_dwordx4 v27, s[28:31], s61 offen offset:1024 lds
s_add_u32 m0, s60, 16384
s_add_u32 s61, s61, s53
buffer_load_dwordx4 v26, s[28:31], s61 offen lds
buffer_load_dwordx4 v27, s[28:31], s61 offen offset:1024 lds
s_add_u32 s49, s76, 2
s_and_b32 s49, s49, 15
s_mul_i32 s49, s49, 393216
buffer_load_dwordx4 v[40:43], v36, s[28:31], s49 offen
s_add_u32 s49, s76, 3
s_and_b32 s49, s49, 15
s_mul_i32 s49, s49, 393216
buffer_load_dwordx4 v[40:43], v36, s[28:31], s49 offen
buffer_load_dword v5, v30, s[32:35], s79 offen sc1
s_add_u32 s69, s47, 0
s_and_b32 s69, s69, 15
s_mul_i32 s67, s69, 2048
s_mul_i32 s68, s69, s54
s_add_u32 m0, s70, 0
s_nop 0
s_mov_b32 s63, 0
s_waitcnt vmcnt(0)
poll_48:
v_cmp_gt_u32 vcc, 3, v5
s_cbranch_vccz polled_49
buffer_load_dword v5, v30, s[32:35], s79 offen sc1
s_add_u32 s63, s63, 1
s_cmp_lt_u32 s63, 0x80000
s_waitcnt vmcnt(0)
s_cbranch_scc1 poll_48
polled_49:
buffer_load_dwordx4 v20, s[32:35], s67 offen offset:0 sc1 lds
buffer_load_dwordx4 v21, s[32:35], s67 offen offset:1024 sc1 lds
buffer_load_dwordx4 v22, s[32:35], s67 offen offset:2048 sc1 lds
buffer_load_dwordx4 v23, s[32:35], s67 offen offset:3072 sc1 lds
s_add_u32 s69, s47, 1
s_and_b32 s69, s69, 15
s_mul_i32 s67, s69, 2048
s_mul_i32 s68, s69, s54
s_add_u32 m0, s70, 40960
s_nop 0
buffer_load_dwordx4 v20, s[32:35], s67 offen offset:0 sc1 lds
buffer_load_dwordx4 v21, s[32:35], s67 offen offset:1024 sc1 lds
buffer_load_dwordx4 v22, s[32:35], s67 offen offset:2048 sc1 lds
buffer_load_dwordx4 v23, s[32:35], s67 offen offset:3072 sc1 lds
s_waitcnt vmcnt(4) lgkmcnt(0)
s_barrier
s_add_u32 s69, s47, 2
s_and_b32 s69, s69, 15
s_mul_i32 s67, s69, 2048
s_mul_i32 s68, s69, s54
s_add_u32 m0, s70, 81920
s_nop 0
buffer_load_dwordx4 v20, s[32:35], s67 offen offset:0 sc1 lds
buffer_load_dwordx4 v21, s[32:35], s67 offen offset:1024 sc1 lds
buffer_load_dwordx4 v22, s[32:35], s67 offen offset:2048 sc1 lds
buffer_load_dwordx4 v23, s[32:35], s67 offen offset:3072 sc1 lds
s_add_u32 s60, s71, 81920
s_add_u32 m0, s60, 0
s_mov_b32 s61, s68
buffer_load_dwordx4 v26, s[28:31], s61 offen lds
buffer_load_dwordx4 v27, s[28:31], s61 offen offset:1024 lds
s_add_u32 m0, s60, 8192
s_add_u32 s61, s61, s53
buffer_load_dwordx4 v26, s[28:31], s61 offen lds
buffer_load_dwordx4 v27, s[28:31], s61 offen offset:1024 lds
s_add_u32 m0, s60, 16384
s_add_u32 s61, s61, s53
buffer_load_dwordx4 v26, s[28:31], s61 offen lds
buffer_load_dwordx4 v27, s[28:31], s61 offen offset:1024 lds
s_add_u32 s49, s76, 4
s_and_b32 s49, s49, 15
s_mul_i32 s49, s49, 393216
buffer_load_dwordx4 v[40:43], v36, s[28:31], s49 offen
s_mov_b32 s64, 0
s_mov_b32 s65, 0
h3_loop:
s_waitcnt vmcnt(11)
s_barrier
s_add_u32 s69, s69, 1
s_and_b32 s69, s69, 15
s_mul_i32 s67, s69, 2048
s_mul_i32 s68, s69, s54
s_add_u32 m0, s70, s65
s_nop 0
buffer_load_dwordx4 v20, s[32:35], s67 offen offset:0 sc1 lds
buffer_load_dwordx4 v21, s[32:35], s67 offen offset:1024 sc1 lds
buffer_load_dwordx4 v22, s[32:35], s67 offen offset:2048 sc1 lds
buffer_load_dwordx4 v23, s[32:35], s67 offen offset:3072 sc1 lds
s_add_u32 s60, s71, s65
s_add_u32 m0, s60, 0
s_mov_b32 s61, s68
buffer_load_dwordx4 v26, s[28:31], s61 offen lds
buffer_load_dwordx4 v27, s[28:31], s61 offen offset:1024 lds
s_add_u32 m0, s60, 8192
s_add_u32 s61, s61, s53
buffer_load_dwordx4 v26, s[28:31], s61 offen lds
buffer_load_dwordx4 v27, s[28:31], s61 offen offset:1024 lds
s_add_u32 m0, s60, 16384
s_add_u32 s61, s61, s53
buffer_load_dwordx4 v26, s[28:31], s61 offen lds
buffer_load_dwordx4 v27, s[28:31], s61 offen offset:1024 lds
s_add_u32 s48, s64, 5
s_min_u32 s48, s48, 15
s_add_u32 s49, s48, s76
s_and_b32 s49, s49, 15
s_mul_i32 s49, s49, 393216
buffer_load_dwordx4 v[40:43], v36, s[28:31], s49 offen
s_add_u32 s65, s65, 40960
s_cmp_eq_u32 s65, 122880
s_cselect_b32 s65, 0, s65
s_add_u32 s64, s64, 1
s_cmp_lt_u32 s64, 11
s_cbranch_scc1 h3_loop
s_waitcnt vmcnt(11)
s_barrier
s_add_u32 s69, s47, 14
s_and_b32 s69, s69, 15
s_mul_i32 s67, s69, 2048
s_mul_i32 s68, s69, s54
s_add_u32 m0, s70, s65
s_nop 0
buffer_load_dwordx4 v20, s[32:35], s67 offen offset:0 sc1 lds
buffer_load_dwordx4 v21, s[32:35], s67 offen offset:1024 sc1 lds
buffer_load_dwordx4 v22, s[32:35], s67 offen offset:2048 sc1 lds
buffer_load_dwordx4 v23, s[32:35], s67 offen offset:3072 sc1 lds
s_add_u32 s60, s71, s65
s_add_u32 m0, s60, 0
s_mov_b32 s61, s68
buffer_load_dwordx4 v26, s[28:31], s61 offen lds
buffer_load_dwordx4 v27, s[28:31], s61 offen offset:1024 lds
s_add_u32 m0, s60, 8192
s_add_u32 s61, s61, s53
buffer_load_dwordx4 v26, s[28:31], s61 offen lds
buffer_load_dwordx4 v27, s[28:31], s61 offen offset:1024 lds
s_add_u32 m0, s60, 16384
s_add_u32 s61, s61, s53
buffer_load_dwordx4 v26, s[28:31], s61 offen lds
buffer_load_dwordx4 v27, s[28:31], s61 offen offset:1024 lds
s_add_u32 s65, s65, 40960
s_cmp_eq_u32 s65, 122880
s_cselect_b32 s65, 0, s65
s_add_u32 s64, s64, 1
s_mov_b32 s36, s16
s_and_b32 s37, s17, 0xffff
s_mov_b32 s38, 2097152
s_mov_b32 s39, 0x00020000
s_waitcnt vmcnt(10)
s_barrier
s_add_u32 s69, s47, 15
s_and_b32 s69, s69, 15
s_mul_i32 s67, s69, 2048
s_mul_i32 s68, s69, s54
s_add_u32 m0, s70, 0
s_nop 0
buffer_load_dwordx4 v20, s[32:35], s67 offen offset:0 sc1 lds
buffer_load_dwordx4 v21, s[32:35], s67 offen offset:1024 sc1 lds
buffer_load_dwordx4 v22, s[32:35], s67 offen offset:2048 sc1 lds
buffer_load_dwordx4 v23, s[32:35], s67 offen offset:3072 sc1 lds
s_add_u32 s60, s71, 0
s_add_u32 m0, s60, 0
s_mov_b32 s61, s68
buffer_load_dwordx4 v26, s[28:31], s61 offen lds
buffer_load_dwordx4 v27, s[28:31], s61 offen offset:1024 lds
s_add_u32 m0, s60, 8192
s_add_u32 s61, s61, s53
buffer_load_dwordx4 v26, s[28:31], s61 offen lds
buffer_load_dwordx4 v27, s[28:31], s61 offen offset:1024 lds
s_add_u32 m0, s60, 16384
s_add_u32 s61, s61, s53
buffer_load_dwordx4 v26, s[28:31], s61 offen lds
buffer_load_dwordx4 v27, s[28:31], s61 offen offset:1024 lds
s_waitcnt vmcnt(10)
s_barrier
s_setprio 0
buffer_load_dword v33, v12, s[32:35], s73 offen sc1
buffer_load_dwordx4 v[80:83], v37, s[32:35], 0 offen offset:0 sc1
buffer_load_dwordx4 v[84:87], v37, s[32:35], 0 offen offset:1024 sc1
buffer_load_dwordx4 v[88:91], v37, s[32:35], 0 offen offset:2048 sc1
buffer_load_dwordx4 v[92:95], v37, s[32:35], 0 offen offset:3072 sc1
global_load_dword v48, v54, s[98:99]
s_add_u32 s48, s75, 15
s_and_b32 s48, s48, 15
s_mul_i32 s48, s48, s57
s_add_u32 m0, s71, 106496
s_nop 0
buffer_load_dwordx4 v28, s[36:39], s48 offen lds
buffer_load_dwordx4 v29, s[36:39], s48 offen offset:1024 lds
s_add_u32 s48, s75, 5
s_and_b32 s48, s48, 15
s_mul_i32 s48, s48, s57
s_add_u32 m0, s71, 24576
s_nop 0
buffer_load_dwordx4 v28, s[36:39], s48 offen lds
buffer_load_dwordx4 v29, s[36:39], s48 offen offset:1024 lds
s_add_u32 s48, s75, 6
s_and_b32 s48, s48, 15
s_mul_i32 s48, s48, s57
s_add_u32 m0, s71, 32768
s_nop 0
buffer_load_dwordx4 v28, s[36:39], s48 offen lds
buffer_load_dwordx4 v29, s[36:39], s48 offen offset:1024 lds
s_waitcnt vmcnt(12)
s_barrier
s_waitcnt vmcnt(7)
s_mov_b32 s63, 0
poll_53:
v_cmp_gt_u32 vcc, 16, v33
s_cbranch_vccz polled_54
buffer_load_dword v33, v12, s[32:35], s73 offen sc1
s_add_u32 s63, s63, 1
s_cmp_lt_u32 s63, 0x80000
s_waitcnt vmcnt(0)
s_cbranch_scc1 poll_53
polled_54:
s_add_u32 s48, s75, 7
s_and_b32 s48, s48, 15
s_mul_i32 s48, s48, s57
s_add_u32 m0, s71, 40960
s_nop 0
buffer_load_dwordx4 v28, s[36:39], s48 offen lds
v_add_f32 v80, v80, v88
v_add_f32 v81, v81, v89
v_add_f32 v82, v82, v90
v_add_f32 v83, v83, v91
v_add_f32 v84, v84, v92
buffer_load_dwordx4 v29, s[36:39], s48 offen offset:1024 lds
v_add_f32 v85, v85, v93
v_add_f32 v86, v86, v94
v_add_f32 v87, v87, v95
v_add_f32 v80, v80, v84
v_add_f32 v81, v81, v85
s_add_u32 s48, s75, 8
s_and_b32 s48, s48, 15
s_mul_i32 s48, s48, s57
s_add_u32 m0, s71, 49152
s_nop 0
buffer_load_dwordx4 v28, s[36:39], s48 offen lds
v_add_f32 v82, v82, v86
v_add_f32 v83, v83, v87
s_nop 1
v_permlane32_swap_b32 v80, v81
buffer_load_dwordx4 v29, s[36:39], s48 offen offset:1024 lds
v_permlane32_swap_b32 v82, v83
v_add_f32 v80, v80, v81
v_add_f32 v82, v82, v83
s_nop 1
v_permlane16_swap_b32 v80, v82
s_add_u32 s48, s75, 9
s_and_b32 s48, s48, 15
s_mul_i32 s48, s48, s57
s_add_u32 m0, s71, 57344
s_nop 0
buffer_load_dwordx4 v28, s[36:39], s48 offen lds
s_nop 0
v_add_f32 v80, v80, v82
v_cmp_u_f32 vcc, v80, v80
s_cbranch_vccnz again_50
summed_51:
buffer_load_dwordx4 v29, s[36:39], s48 offen offset:1024 lds
v_mul_f32 v44, 0x3a800000, v80
v_mov_b32 v45, v44
s_nop 1
v_permlane16_swap_b32 v44, v45
s_add_u32 s48, s75, 10
s_and_b32 s48, s48, 15
s_mul_i32 s48, s48, s57
s_add_u32 m0, s71, 65536
s_nop 0
buffer_load_dwordx4 v28, s[36:39], s48 offen lds
s_nop 0
v_fma_f32 v45, -v44, v44, v45
v_max_f32 v45, 0, v45
v_add_f32 v45, 0x3727c5ac, v45
v_rsq_f32 v46, v45
buffer_load_dwordx4 v29, s[36:39], s48 offen offset:1024 lds
v_sub_f32 v47, 0, v44
ds_write_b32 v50, v47 offset:512
ds_write_b64 v49, v[46:47]
ds_write_b32 v50, v46
s_setprio 0
s_waitcnt lgkmcnt(0)
s_waitcnt vmcnt(63)
s_barrier
s_waitcnt vmcnt(5)
s_add_u32 s48, s75, 11
s_and_b32 s48, s48, 15
s_mul_i32 s48, s48, s57
s_add_u32 m0, s71, 73728
s_nop 0
buffer_load_dwordx4 v28, s[36:39], s48 offen lds
buffer_load_dwordx4 v29, s[36:39], s48 offen offset:1024 lds
s_waitcnt vmcnt(5)
s_add_u32 s48, s75, 12
s_and_b32 s48, s48, 15
s_mul_i32 s48, s48, s57
s_add_u32 m0, s71, 81920
s_nop 0
buffer_load_dwordx4 v28, s[36:39], s48 offen lds
buffer_load_dwordx4 v29, s[36:39], s48 offen offset:1024 lds
s_waitcnt vmcnt(5)
s_add_u32 s48, s75, 13
s_and_b32 s48, s48, 15
s_mul_i32 s48, s48, s57
s_add_u32 m0, s71, 90112
s_nop 0
buffer_load_dwordx4 v28, s[36:39], s48 offen lds
buffer_load_dwordx4 v29, s[36:39], s48 offen offset:1024 lds
s_waitcnt vmcnt(5)
s_add_u32 s48, s75, 14
s_and_b32 s48, s48, 15
s_mul_i32 s48, s48, s57
s_add_u32 m0, s71, 98304
s_nop 0
buffer_load_dwordx4 v28, s[36:39], s48 offen lds
buffer_load_dwordx4 v29, s[36:39], s48 offen offset:1024 lds
s_waitcnt vmcnt(5)
s_add_u32 s48, s75, 0
s_and_b32 s48, s48, 15
s_mul_i32 s48, s48, s57
s_add_u32 m0, s71, 4294950912
s_nop 0
buffer_load_dwordx4 v28, s[36:39], s48 offen lds
buffer_load_dwordx4 v29, s[36:39], s48 offen offset:1024 lds
s_waitcnt vmcnt(5)
s_add_u32 s48, s75, 1
s_and_b32 s48, s48, 15
s_mul_i32 s48, s48, s57
s_add_u32 m0, s71, 4294959104
s_nop 0
buffer_load_dwordx4 v28, s[36:39], s48 offen lds
buffer_load_dwordx4 v29, s[36:39], s48 offen offset:1024 lds
s_waitcnt vmcnt(5)
s_add_u32 s48, s75, 2
s_and_b32 s48, s48, 15
s_mul_i32 s48, s48, s57
s_add_u32 m0, s71, 0
s_nop 0
buffer_load_dwordx4 v28, s[36:39], s48 offen lds
buffer_load_dwordx4 v29, s[36:39], s48 offen offset:1024 lds
s_waitcnt vmcnt(5)
s_add_u32 s48, s75, 3
s_and_b32 s48, s48, 15
s_mul_i32 s48, s48, s57
s_add_u32 m0, s71, 8192
s_nop 0
buffer_load_dwordx4 v28, s[36:39], s48 offen lds
buffer_load_dwordx4 v29, s[36:39], s48 offen offset:1024 lds
s_waitcnt vmcnt(5)
s_add_u32 s48, s75, 4
s_and_b32 s48, s48, 15
s_mul_i32 s48, s48, s57
s_add_u32 m0, s71, 16384
s_nop 0
buffer_load_dwordx4 v28, s[36:39], s48 offen lds
buffer_load_dwordx4 v29, s[36:39], s48 offen offset:1024 lds
s_waitcnt vmcnt(5)
buffer_load_dwordx4 v[240:243], v18, s[32:35], s81 offen offset:0 sc1
buffer_load_dwordx4 v[240:243], v18, s[32:35], s81 offen offset:1024 sc1
s_waitcnt vmcnt(5)
buffer_load_dwordx4 v[240:243], v18, s[32:35], s82 offen offset:0 sc1
buffer_load_dwordx4 v[240:243], v18, s[32:35], s82 offen offset:1024 sc1
s_waitcnt vmcnt(0) lgkmcnt(0)
s_barrier
L_end:
s_endpgm
L_compute:
s_lshr_b32 s48, s2, 2
s_and_b32 s48, s48, 1
s_lshl_b32 s48, s48, 1
s_add_u32 s48, s48, s74
s_and_b32 s49, s42, 3
s_xor_b32 s77, s48, s49
s_add_u32 s77, s77, 4
s_add_u32 s48, s47, 1
s_and_b32 s48, s48, 3
s_and_b32 s49, s77, 3
s_lshl_b32 s49, s49, 2
s_add_u32 s78, s48, s49
s_and_b32 s48, s2, 7
s_lshl_b32 s48, s48, 1
s_add_u32 s75, s78, s48
s_and_b32 s75, s75, 15
s_mov_b32 s46, 0
s_waitcnt lgkmcnt(0)
s_mov_b32 s32, s22
s_and_b32 s33, s23, 0xffff
s_mov_b32 s34, 268435456
s_mov_b32 s35, 0x00020000
s_mov_b32 s24, s18
s_and_b32 s25, s19, 0xffff
s_mov_b32 s26, 4194304
s_mov_b32 s27, 0x00020000
s_setprio 1
s_and_b32 s43, s40, 1
s_lshr_b32 s44, s40, 1
s_lshl_b32 s45, s42, 1
s_add_u32 s45, s45, s43
s_cmp_lg_u32 s40, 1
s_cbranch_scc1 else_55
s_getpc_b64 s[48:49]
L_pc:
s_sub_u32 s48, s48, L_pc - interleave_layers__sliding_local_dilated__linear_kernel_hedgehog__prompt_kernel
s_subb_u32 s49, s49, 0
s_lshr_b32 s50, s2, 3
s_lshl_b32 s50, s50, 12
v_lshl_add_u32 v8, v0, 6, s50
v_cmp_gt_u32 vcc, L_code_end - interleave_layers__sliding_local_dilated__linear_kernel_hedgehog__prompt_kernel, v8
s_and_saveexec_b64 s[50:51], vcc
s_cbranch_execz nopf_57
global_load_dword v254, v8, s[48:49]
nopf_57:
s_mov_b64 exec, -1
else_55:
s_lshl_b32 s48, s41, 3
s_lshl_b32 s49, s44, 2
s_add_u32 s48, s48, s49
s_lshl_b32 s48, s48, 5
s_add_u32 s48, s48, s45
s_lshl_b32 s48, s48, 10
s_add_u32 s80, s48, 4194304
s_add_u32 s81, s80, 32768
s_add_u32 s82, s80, 65536
s_add_u32 s83, s80, 98304
s_lshl_b32 s84, s41, 2
s_add_u32 s84, s84, s44
s_lshl_b32 s84, s84, 7
s_add_u32 s84, s84, 18350080
s_lshl_b32 s48, s41, 3
s_lshl_b32 s49, s40, 1
s_add_u32 s48, s48, s49
s_lshl_b32 s48, s48, 15
s_lshl_b32 s49, s78, 11
s_add_u32 s85, s48, s49
s_add_u32 s86, s85, 32768
s_lshl_b32 s50, s41, 2
s_add_u32 s50, s50, s40
s_lshl_b32 s50, s50, 4
s_add_u32 s50, s50, s42
s_lshl_b32 s50, s50, 8
s_add_u32 s87, s50, 16777216
s_lshl_b32 s88, s41, 2
s_add_u32 s88, s88, s40
s_lshl_b32 s88, s88, 7
s_add_u32 s88, s88, 18358272
v_lshrrev_b32 v4, 1, v3
v_lshl_add_u32 v4, v2, 2, v4
v_and_b32 v5, 1, v3
v_lshl_add_u32 v4, v5, 1, v4
v_lshlrev_b32 v1, 2, v4
s_lshl_b32 s48, s40, 2
s_add_u32 s48, s48, 134672
v_mov_b32 v10, s48
v_mov_b32 v11, 0
ds_write_b32 v10, v11
v_mov_b32 v140, -1
v_mov_b32 v141, -1
v_mov_b32 v142, -1
v_mov_b32 v143, -1
s_lshl_b32 s50, s42, 2
s_add_u32 s50, s50, s40
s_lshl_b32 s50, s50, 4
s_add_u32 s50, s50, s41
s_lshl_b32 s50, s50, 8
s_add_u32 s50, s50, 17825792
v_mov_b32 v4, s87
v_mov_b32 v5, s50
v_cmp_eq_u32 vcc, 0, v3
v_lshrrev_b32 v6, 1, v3
v_mul_u32_u24 v6, 262144, v6
v_add_u32 v5, v5, v6
v_cndmask_b32 v4, v5, v4, vcc
v_lshl_add_u32 v4, v2, 4, v4
buffer_store_dwordx4 v[140:143], v4, s[32:35], 0 offen sc1
s_lshl_b32 s48, s2, 2
s_add_u32 s49, s48, s40
s_lshl_b32 s48, s49, 10
s_add_u32 s48, s48, 8388608
buffer_store_dwordx4 v[140:143], v18, s[32:35], s48 offen sc1
s_and_b32 s48, s49, 7
s_cmp_lg_u32 s48, 0
s_cbranch_scc1 nofl_58
s_lshl_b32 s48, s49, 5
s_add_u32 s48, s48, 18350080
v_lshlrev_b32 v6, 2, v0
buffer_store_dword v11, v6, s[32:35], s48 offen sc1
nofl_58:
s_lshl_b32 s49, s44, 13
v_lshrrev_b32 v4, 1, v2
v_xor_b32 v4, v4, v3
v_lshlrev_b32 v4, 4, v4
v_lshl_add_u32 v10, v2, 7, v4
v_add_u32 v10, s49, v10
v_xor_b32 v11, 64, v10
s_lshl_b32 s48, s43, 1
v_lshrrev_b32 v4, 2, v2
v_and_b32 v5, 3, v0
v_lshl_add_u32 v6, v3, 3, v4
v_lshlrev_b32 v6, 7, v6
v_lshl_add_u32 v6, v5, 3, v6
v_lshrrev_b32 v7, 1, v4
v_and_b32 v8, 1, v3
v_lshl_add_u32 v7, v8, 1, v7
v_xor_b32 v7, s48, v7
v_lshl_add_u32 v12, v7, 5, v6
v_add_u32 v12, 16384, v12
v_xor_b32 v13, 32, v12
v_mov_b32 v14, v10
v_mov_b32 v15, v11
v_add_u32 v16, 0, v12
v_add_u32 v17, 0, v13
v_mov_b32 v156, 0
v_mov_b32 v157, 0
v_mov_b32 v158, 0
v_mov_b32 v159, 0
v_mov_b32 v160, 0
v_mov_b32 v161, 0
v_mov_b32 v162, 0
v_mov_b32 v163, 0
v_mov_b32 v164, 0
v_mov_b32 v165, 0
v_mov_b32 v166, 0
v_mov_b32 v167, 0
v_mov_b32 v168, 0
v_mov_b32 v169, 0
v_mov_b32 v170, 0
v_mov_b32 v171, 0
v_mov_b32 v172, 0
v_mov_b32 v173, 0
v_mov_b32 v174, 0
v_mov_b32 v175, 0
v_mov_b32 v176, 0
v_mov_b32 v177, 0
v_mov_b32 v178, 0
v_mov_b32 v179, 0
v_mov_b32 v180, 0
v_mov_b32 v181, 0
v_mov_b32 v182, 0
v_mov_b32 v183, 0
v_mov_b32 v184, 0
v_mov_b32 v185, 0
v_mov_b32 v186, 0
v_mov_b32 v187, 0
v_mov_b32 v188, 0
v_mov_b32 v189, 0
v_mov_b32 v190, 0
v_mov_b32 v191, 0
v_mov_b32 v192, 0
v_mov_b32 v193, 0
v_mov_b32 v194, 0
v_mov_b32 v195, 0
v_mov_b32 v196, 0
v_mov_b32 v197, 0
v_mov_b32 v198, 0
v_mov_b32 v199, 0
v_mov_b32 v200, 0
v_mov_b32 v201, 0
v_mov_b32 v202, 0
v_mov_b32 v203, 0
v_mov_b32 v204, 0
v_mov_b32 v205, 0
v_mov_b32 v206, 0
v_mov_b32 v207, 0
v_mov_b32 v208, 0
v_mov_b32 v209, 0
v_mov_b32 v210, 0
v_mov_b32 v211, 0
v_mov_b32 v212, 0
v_mov_b32 v213, 0
v_mov_b32 v214, 0
v_mov_b32 v215, 0
v_mov_b32 v216, 0
v_mov_b32 v217, 0
v_mov_b32 v218, 0
v_mov_b32 v219, 0
v_mov_b32 v220, 0
v_mov_b32 v221, 0
v_mov_b32 v222, 0
v_mov_b32 v223, 0
v_mov_b32 v224, 0
v_mov_b32 v225, 0
v_mov_b32 v226, 0
v_mov_b32 v227, 0
v_mov_b32 v228, 0
v_mov_b32 v229, 0
v_mov_b32 v230, 0
v_mov_b32 v231, 0
v_mov_b32 v232, 0
v_mov_b32 v233, 0
v_mov_b32 v234, 0
v_mov_b32 v235, 0
v_mov_b32 v236, 0
v_mov_b32 v237, 0
v_mov_b32 v238, 0
v_mov_b32 v239, 0
v_mov_b32 v240, 0
v_mov_b32 v241, 0
v_mov_b32 v242, 0
v_mov_b32 v243, 0
v_mov_b32 v244, 0
v_mov_b32 v245, 0
v_mov_b32 v246, 0
v_mov_b32 v247, 0
v_mov_b32 v248, 0
v_mov_b32 v249, 0
v_mov_b32 v250, 0
v_mov_b32 v251, 0
v_mov_b32 v48, 0x3f803f80
v_mov_b32 v49, 0x3f803f80
v_mov_b32 v50, 0x3f803f80
v_mov_b32 v51, 0x3f803f80
s_mov_b32 s48, 0xf149f2ca
v_mov_b32 v9, s48
v_lshlrev_b32 v4, 2, v3
v_sub_u32 v4, v2, v4
v_subrev_u32 v5, 0, v4
v_and_b32 v6, 0x80000001, v5
v_cmp_eq_u32 vcc, 0, v6
v_add_u32 v5, 1, v5
v_and_b32 v6, 0x80000001, v5
v_cndmask_b32 v40, v9, 0, vcc
v_cmp_eq_u32 vcc, 0x80000001, v6
s_nop 1
v_cndmask_b32 v36, v9, 0, vcc
v_subrev_u32 v5, 1, v4
v_and_b32 v6, 0x80000001, v5
v_cmp_eq_u32 vcc, 0, v6
v_add_u32 v5, 1, v5
v_and_b32 v6, 0x80000001, v5
v_cndmask_b32 v41, v9, 0, vcc
v_cmp_eq_u32 vcc, 0x80000001, v6
s_nop 1
v_cndmask_b32 v37, v9, 0, vcc
v_subrev_u32 v5, 2, v4
v_and_b32 v6, 0x80000001, v5
v_cmp_eq_u32 vcc, 0, v6
v_add_u32 v5, 1, v5
v_and_b32 v6, 0x80000001, v5
v_cndmask_b32 v42, v9, 0, vcc
v_cmp_eq_u32 vcc, 0x80000001, v6
s_nop 1
v_cndmask_b32 v38, v9, 0, vcc
v_subrev_u32 v5, 3, v4
v_and_b32 v6, 0x80000001, v5
v_cmp_eq_u32 vcc, 0, v6
v_add_u32 v5, 1, v5
v_and_b32 v6, 0x80000001, v5
v_cndmask_b32 v43, v9, 0, vcc
v_cmp_eq_u32 vcc, 0x80000001, v6
s_nop 1
v_cndmask_b32 v39, v9, 0, vcc
s_or_b32 s48, s41, s44
s_cmp_eq_u32 s48, 0
s_cselect_b64 vcc, -1, 0
v_cndmask_b32 v44, v36, v9, vcc
v_cndmask_b32 v45, v37, v9, vcc
v_cndmask_b32 v46, v38, v9, vcc
v_cndmask_b32 v47, v39, v9, vcc
v_and_b32 v4, 1, v2
v_lshlrev_b32 v4, 4, v4
v_mov_b32 v5, 0xffff
v_lshlrev_b32 v52, v4, v5
s_lshl_b32 s48, s43, 11
s_add_u32 s48, s48, 135168
v_add_u32 v53, s48, v18
v_lshl_add_u32 v55, v0, 3, s48
s_add_u32 s48, s41, s44
s_sub_u32 s48, s48, 1
s_lshl_b32 s49, s48, 1
s_add_u32 s49, s49, s43
s_lshl_b32 s49, s49, 11
s_mul_i32 s50, s42, 65536
s_add_u32 s49, s49, s50
s_add_u32 s49, s49, 8388608
s_cmp_lt_i32 s48, 0
s_cselect_b32 s49, 0xf0000000, s49
v_add_u32 v58, s49, v18
v_lshl_add_u32 v59, v0, 3, s49
s_lshl_b32 s48, s43, 2
s_add_u32 s48, s48, 134672
v_mov_b32 v19, s48
s_lshl_b32 s48, s43, 7
s_add_u32 s48, s48, 133120
v_lshl_add_u32 v7, v3, 4, s48
v_lshl_add_u32 v54, v2, 2, s48
s_lshl_b32 s49, s44, 6
v_add_u32 v8, s49, v2
v_lshlrev_b32 v8, 3, v8
v_add_u32 v8, 131072, v8
v_lshl_add_u32 v9, v3, 2, s49
v_lshlrev_b32 v9, 2, v9
v_add_u32 v9, 132096, v9
s_mov_b32 s64, 0
s_mov_b32 s65, 0
s_mov_b32 s66, 0x3e8293ee
s_mov_b32 s61, 1
s_lshl_b32 s50, s42, 2
s_add_u32 s50, s50, s40
s_lshl_b32 s50, s50, 4
s_add_u32 s50, s50, s41
s_lshl_b32 s50, s50, 8
s_add_u32 s52, s50, 17825792
v_lshrrev_b32 v4, 1, v2
v_lshrrev_b32 v5, 1, v3
v_xor_b32 v4, v4, v5
v_lshlrev_b32 v4, 4, v4
v_and_b32 v5, 1, v3
v_lshl_add_u32 v4, v5, 3, v4
v_lshl_add_u32 v4, v2, 7, v4
s_lshl_b32 s48, s40, 12
v_add_u32 v155, s48, v4
v_mov_b32 v152, 0
v_mov_b32 v153, 0
v_mov_b32 v56, 0
v_mov_b32 v57, 0
s_waitcnt vmcnt(0)
s_lshl_b32 s79, 1, s77
s_or_b32 s79, s79, 0
s_barrier
ds_read_b128 v[60:63], v14 offset:0
ds_read_b128 v[64:67], v14 offset:2048
ds_read_b128 v[68:71], v14 offset:4096
ds_read_b128 v[72:75], v14 offset:6144
ds_read_b64_tr_b16 v[84:85], v16 offset:8192
ds_read_b64_tr_b16 v[86:87], v16 offset:8704
ds_read_b64_tr_b16 v[88:89], v17 offset:8192
ds_read_b64_tr_b16 v[90:91], v17 offset:8704
ds_read_b64_tr_b16 v[92:93], v16 offset:16384
ds_read_b64_tr_b16 v[94:95], v16 offset:16896
ds_read_b64_tr_b16 v[96:97], v17 offset:16384
ds_read_b64_tr_b16 v[98:99], v17 offset:16896
ds_read_b64_tr_b16 v[76:77], v16 offset:0
ds_read_b64_tr_b16 v[78:79], v16 offset:512
ds_read_b64_tr_b16 v[80:81], v17 offset:0
ds_read_b64_tr_b16 v[82:83], v17 offset:512
s_waitcnt lgkmcnt(0)
c0_loop:
v_mfma_f32_16x16x32_bf16 v[212:215], v[84:87], v[72:75], v[212:215]
ds_read_b128 v[100:103], v15 offset:0
v_mfma_f32_16x16x32_bf16 v[204:207], v[84:87], v[68:71], v[204:207]
ds_read_b128 v[104:107], v15 offset:2048
v_mfma_f32_16x16x32_bf16 v[196:199], v[84:87], v[64:67], v[196:199]
ds_read_b128 v[108:111], v15 offset:4096
v_mfma_f32_16x16x32_bf16 v[188:191], v[84:87], v[60:63], v[188:191]
ds_read_b128 v[112:115], v15 offset:6144
v_mfma_f32_16x16x32_bf16 v[192:195], v[88:91], v[60:63], v[192:195]
ds_read_b64_tr_b16 v[124:125], v16 offset:12288
v_mfma_f32_16x16x32_bf16 v[200:203], v[88:91], v[64:67], v[200:203]
ds_read_b64_tr_b16 v[126:127], v16 offset:12800
v_mfma_f32_16x16x32_bf16 v[208:211], v[88:91], v[68:71], v[208:211]
ds_read_b64_tr_b16 v[128:129], v17 offset:12288
v_mfma_f32_16x16x32_bf16 v[216:219], v[88:91], v[72:75], v[216:219]
ds_read_b64_tr_b16 v[130:131], v17 offset:12800
v_mfma_f32_16x16x32_bf16 v[244:247], v[72:75], v[92:95], v[244:247]
ds_read_b64_tr_b16 v[132:133], v16 offset:20480
v_mfma_f32_16x16x32_bf16 v[248:251], v[72:75], v[96:99], v[248:251]
ds_read_b64_tr_b16 v[134:135], v16 offset:20992
v_mfma_f32_16x16x32_bf16 v[240:243], v[68:71], v[96:99], v[240:243]
ds_read_b64_tr_b16 v[136:137], v17 offset:20480
v_mfma_f32_16x16x32_bf16 v[236:239], v[68:71], v[92:95], v[236:239]
ds_read_b64_tr_b16 v[138:139], v17 offset:20992
v_mfma_f32_16x16x32_bf16 v[228:231], v[64:67], v[92:95], v[228:231]
ds_read_b64_tr_b16 v[116:117], v16 offset:4096
v_mfma_f32_16x16x32_bf16 v[232:235], v[64:67], v[96:99], v[232:235]
ds_read_b64_tr_b16 v[118:119], v16 offset:4608
v_mfma_f32_16x16x32_bf16 v[224:227], v[60:63], v[96:99], v[224:227]
ds_read_b64_tr_b16 v[120:121], v17 offset:4096
v_mfma_f32_16x16x32_bf16 v[220:223], v[60:63], v[92:95], v[220:223]
ds_read_b64_tr_b16 v[122:123], v17 offset:4608
v_mfma_f32_16x16x32_bf16 v[156:159], v[76:79], v[60:63], v[156:159]
s_bitcmp1_b32 s79, s64
s_cbranch_scc1 c0_hook
c0_hook_ret:
v_mfma_f32_16x16x32_bf16 v[164:167], v[76:79], v[64:67], v[164:167]
s_add_u32 s65, s65, 40960
s_cmp_eq_u32 s65, 122880
v_mfma_f32_16x16x32_bf16 v[172:175], v[76:79], v[68:71], v[172:175]
s_cselect_b32 s65, 0, s65
s_add_u32 s64, s64, 1
v_mfma_f32_16x16x32_bf16 v[180:183], v[76:79], v[72:75], v[180:183]
v_add_u32 v14, s65, v10
v_add_u32 v15, s65, v11
v_mfma_f32_16x16x32_bf16 v[184:187], v[80:83], v[72:75], v[184:187]
v_add_u32 v16, s65, v12
v_add_u32 v17, s65, v13
v_mfma_f32_16x16x32_bf16 v[176:179], v[80:83], v[68:71], v[176:179]
s_cmp_eq_u32 s64, 16
s_cbranch_scc1 c0_last
v_mfma_f32_16x16x32_bf16 v[168:171], v[80:83], v[64:67], v[168:171]
s_waitcnt lgkmcnt(0)
v_mfma_f32_16x16x32_bf16 v[160:163], v[80:83], v[60:63], v[160:163]
s_barrier
v_mfma_f32_16x16x32_bf16 v[212:215], v[124:127], v[112:115], v[212:215]
ds_read_b128 v[60:63], v14 offset:0
v_mfma_f32_16x16x32_bf16 v[204:207], v[124:127], v[108:111], v[204:207]
ds_read_b128 v[64:67], v14 offset:2048
v_mfma_f32_16x16x32_bf16 v[196:199], v[124:127], v[104:107], v[196:199]
ds_read_b128 v[68:71], v14 offset:4096
v_mfma_f32_16x16x32_bf16 v[188:191], v[124:127], v[100:103], v[188:191]
ds_read_b128 v[72:75], v14 offset:6144
v_mfma_f32_16x16x32_bf16 v[192:195], v[128:131], v[100:103], v[192:195]
ds_read_b64_tr_b16 v[84:85], v16 offset:8192
v_mfma_f32_16x16x32_bf16 v[200:203], v[128:131], v[104:107], v[200:203]
ds_read_b64_tr_b16 v[86:87], v16 offset:8704
v_mfma_f32_16x16x32_bf16 v[208:211], v[128:131], v[108:111], v[208:211]
ds_read_b64_tr_b16 v[88:89], v17 offset:8192
v_mfma_f32_16x16x32_bf16 v[216:219], v[128:131], v[112:115], v[216:219]
ds_read_b64_tr_b16 v[90:91], v17 offset:8704
v_mfma_f32_16x16x32_bf16 v[244:247], v[112:115], v[132:135], v[244:247]
ds_read_b64_tr_b16 v[92:93], v16 offset:16384
v_mfma_f32_16x16x32_bf16 v[248:251], v[112:115], v[136:139], v[248:251]
ds_read_b64_tr_b16 v[94:95], v16 offset:16896
v_mfma_f32_16x16x32_bf16 v[240:243], v[108:111], v[136:139], v[240:243]
ds_read_b64_tr_b16 v[96:97], v17 offset:16384
v_mfma_f32_16x16x32_bf16 v[236:239], v[108:111], v[132:135], v[236:239]
ds_read_b64_tr_b16 v[98:99], v17 offset:16896
v_mfma_f32_16x16x32_bf16 v[228:231], v[104:107], v[132:135], v[228:231]
ds_read_b64_tr_b16 v[76:77], v16 offset:0
v_mfma_f32_16x16x32_bf16 v[232:235], v[104:107], v[136:139], v[232:235]
ds_read_b64_tr_b16 v[78:79], v16 offset:512
v_mfma_f32_16x16x32_bf16 v[224:227], v[100:103], v[136:139], v[224:227]
ds_read_b64_tr_b16 v[80:81], v17 offset:0
v_mfma_f32_16x16x32_bf16 v[220:223], v[100:103], v[132:135], v[220:223]
ds_read_b64_tr_b16 v[82:83], v17 offset:512
v_mfma_f32_16x16x32_bf16 v[156:159], v[116:119], v[100:103], v[156:159]
v_mfma_f32_16x16x32_bf16 v[164:167], v[116:119], v[104:107], v[164:167]
v_mfma_f32_16x16x32_bf16 v[172:175], v[116:119], v[108:111], v[172:175]
v_mfma_f32_16x16x32_bf16 v[180:183], v[116:119], v[112:115], v[180:183]
v_mfma_f32_16x16x32_bf16 v[184:187], v[120:123], v[112:115], v[184:187]
v_mfma_f32_16x16x32_bf16 v[176:179], v[120:123], v[108:111], v[176:179]
v_mfma_f32_16x16x32_bf16 v[168:171], v[120:123], v[104:107], v[168:171]
s_waitcnt lgkmcnt(0)
v_mfma_f32_16x16x32_bf16 v[160:163], v[120:123], v[100:103], v[160:163]
s_branch c0_loop
c0_hook:
v_add_u32 v4, s65, v155
ds_read_b64 v[20:21], v4 offset:0
ds_read_b64 v[28:29], v4 offset:2048
v_xor_b32 v5, 32, v4
ds_read_b64 v[22:23], v5 offset:0
ds_read_b64 v[30:31], v5 offset:2048
v_xor_b32 v5, 64, v4
ds_read_b64 v[24:25], v5 offset:0
ds_read_b64 v[32:33], v5 offset:2048
v_xor_b32 v5, 96, v4
ds_read_b64 v[26:27], v5 offset:0
ds_read_b64 v[34:35], v5 offset:2048
s_waitcnt lgkmcnt(8)
s_cmp_lg_u32 s44, 0
s_cbranch_scc1 else_59
v_mfma_f32_16x16x32_bf16 v[140:143], v[48:51], v[76:79], 0
v_mfma_f32_16x16x32_bf16 v[144:147], v[48:51], v[84:87], 0
v_mfma_f32_16x16x32_bf16 v[148:151], v[48:51], v[92:95], 0
v_mfma_f32_16x16x32_bf16 v[140:143], v[48:51], v[116:119], v[140:143]
v_mfma_f32_16x16x32_bf16 v[144:147], v[48:51], v[124:127], v[144:147]
v_mfma_f32_16x16x32_bf16 v[148:151], v[48:51], v[132:135], v[148:151]
s_branch fi_60
else_59:
v_mfma_f32_16x16x32_bf16 v[140:143], v[48:51], v[80:83], 0
v_mfma_f32_16x16x32_bf16 v[144:147], v[48:51], v[88:91], 0
v_mfma_f32_16x16x32_bf16 v[148:151], v[48:51], v[96:99], 0
v_mfma_f32_16x16x32_bf16 v[140:143], v[48:51], v[120:123], v[140:143]
v_mfma_f32_16x16x32_bf16 v[144:147], v[48:51], v[128:131], v[144:147]
v_mfma_f32_16x16x32_bf16 v[148:151], v[48:51], v[136:139], v[148:151]
fi_60:
s_waitcnt lgkmcnt(0)
v_dot2c_f32_bf16 v152, v20, v48
v_dot2c_f32_bf16 v56, v20, v20
v_dot2c_f32_bf16 v153, v28, v48
v_dot2c_f32_bf16 v57, v28, v28
v_dot2c_f32_bf16 v152, v21, v48
v_dot2c_f32_bf16 v56, v21, v21
v_dot2c_f32_bf16 v153, v29, v48
v_dot2c_f32_bf16 v57, v29, v29
v_dot2c_f32_bf16 v152, v22, v48
v_dot2c_f32_bf16 v56, v22, v22
v_dot2c_f32_bf16 v153, v30, v48
v_dot2c_f32_bf16 v57, v30, v30
v_dot2c_f32_bf16 v152, v23, v48
v_dot2c_f32_bf16 v56, v23, v23
v_dot2c_f32_bf16 v153, v31, v48
v_dot2c_f32_bf16 v57, v31, v31
v_dot2c_f32_bf16 v152, v24, v48
v_dot2c_f32_bf16 v56, v24, v24
v_dot2c_f32_bf16 v153, v32, v48
v_dot2c_f32_bf16 v57, v32, v32
v_dot2c_f32_bf16 v152, v25, v48
v_dot2c_f32_bf16 v56, v25, v25
v_dot2c_f32_bf16 v153, v33, v48
v_dot2c_f32_bf16 v57, v33, v33
v_dot2c_f32_bf16 v152, v26, v48
v_dot2c_f32_bf16 v56, v26, v26
v_dot2c_f32_bf16 v153, v34, v48
v_dot2c_f32_bf16 v57, v34, v34
v_dot2c_f32_bf16 v152, v27, v48
v_dot2c_f32_bf16 v56, v27, v27
v_dot2c_f32_bf16 v153, v35, v48
v_dot2c_f32_bf16 v57, v35, v35
v_cmp_eq_u32 vcc, 0, v3
v_cmp_eq_u32 s[48:49], 1, v3
s_nop 1
v_cndmask_b32 v4, v148, v144, s[48:49]
v_cndmask_b32 v4, v4, v140, vcc
buffer_store_dword v4, v1, s[32:35], s52 offen sc1
s_nop 1
v_permlane32_swap_b32 v152, v153
v_permlane32_swap_b32 v56, v57
v_add_f32 v152, v152, v153
v_add_f32 v56, v56, v57
s_nop 1
v_permlane16_swap_b32 v152, v56
s_nop 0
v_add_f32 v152, v152, v56
buffer_store_dword v152, v1, s[32:35], s87 offen sc1
s_branch c0_hook_ret
c0_last:
v_mfma_f32_16x16x32_bf16 v[168:171], v[80:83], v[64:67], v[168:171]
s_waitcnt lgkmcnt(0)
v_mfma_f32_16x16x32_bf16 v[160:163], v[80:83], v[60:63], v[160:163]
v_mfma_f32_16x16x32_bf16 v[212:215], v[124:127], v[112:115], v[212:215]
v_mfma_f32_16x16x32_bf16 v[204:207], v[124:127], v[108:111], v[204:207]
v_mfma_f32_16x16x32_bf16 v[196:199], v[124:127], v[104:107], v[196:199]
v_mfma_f32_16x16x32_bf16 v[188:191], v[124:127], v[100:103], v[188:191]
v_mfma_f32_16x16x32_bf16 v[192:195], v[128:131], v[100:103], v[192:195]
v_mfma_f32_16x16x32_bf16 v[200:203], v[128:131], v[104:107], v[200:203]
v_mfma_f32_16x16x32_bf16 v[208:211], v[128:131], v[108:111], v[208:211]
v_mfma_f32_16x16x32_bf16 v[216:219], v[128:131], v[112:115], v[216:219]
s_barrier
v_mfma_f32_16x16x32_bf16 v[244:247], v[112:115], v[132:135], v[244:247]
ds_read_b128 v[140:143], v7 offset:0
ds_read_b128 v[144:147], v7 offset:64
v_mfma_f32_16x16x32_bf16 v[248:251], v[112:115], v[136:139], v[248:251]
ds_read_b128 v[148:151], v7 offset:256
ds_read_b128 v[152:155], v7 offset:320
v_mfma_f32_16x16x32_bf16 v[240:243], v[108:111], v[136:139], v[240:243]
ds_read_b64 v[92:93], v8 offset:0
ds_read_b64 v[94:95], v8 offset:128
v_mfma_f32_16x16x32_bf16 v[236:239], v[108:111], v[132:135], v[236:239]
ds_read_b64 v[96:97], v8 offset:256
ds_read_b64 v[98:99], v8 offset:384
v_mfma_f32_16x16x32_bf16 v[228:231], v[104:107], v[132:135], v[228:231]
ds_read2_b32 v[56:57], v54 offset0:128 offset1:144
ds_read_b128 v[60:63], v9 offset:0
v_mfma_f32_16x16x32_bf16 v[232:235], v[104:107], v[136:139], v[232:235]
ds_read_b128 v[64:67], v9 offset:64
v_mfma_f32_16x16x32_bf16 v[224:227], v[100:103], v[136:139], v[224:227]
ds_read_b128 v[68:71], v9 offset:128
v_mfma_f32_16x16x32_bf16 v[220:223], v[100:103], v[132:135], v[220:223]
ds_read_b128 v[72:75], v9 offset:192
v_mfma_f32_16x16x32_bf16 v[156:159], v[116:119], v[100:103], v[156:159]
ds_read_b128 v[76:79], v9 offset:512
v_mfma_f32_16x16x32_bf16 v[164:167], v[116:119], v[104:107], v[164:167]
ds_read_b128 v[80:83], v9 offset:576
v_mfma_f32_16x16x32_bf16 v[172:175], v[116:119], v[108:111], v[172:175]
ds_read_b128 v[84:87], v9 offset:640
v_mfma_f32_16x16x32_bf16 v[180:183], v[116:119], v[112:115], v[180:183]
ds_read_b128 v[88:91], v9 offset:704
v_mfma_f32_16x16x32_bf16 v[184:187], v[120:123], v[112:115], v[184:187]
v_mov_b32 v6, 134656
ds_read_b32 v6, v6
v_mfma_f32_16x16x32_bf16 v[176:179], v[120:123], v[108:111], v[176:179]
v_mfma_f32_16x16x32_bf16 v[168:171], v[120:123], v[104:107], v[168:171]
v_mfma_f32_16x16x32_bf16 v[160:163], v[120:123], v[100:103], v[160:163]
c0_epi:
s_waitcnt lgkmcnt(0)
v_readfirstlane_b32 s46, v6
.p2align 3
v_pk_fma_f32 v[212:213], v[148:149], v[98:99], v[212:213] op_sel:[0,1,0] op_sel_hi:[1,1,1]
v_pk_fma_f32 v[214:215], v[150:151], v[98:99], v[214:215] op_sel:[0,1,0] op_sel_hi:[1,1,1]
v_pk_fma_f32 v[216:217], v[152:153], v[98:99], v[216:217] op_sel:[0,1,0] op_sel_hi:[1,1,1]
v_pk_fma_f32 v[218:219], v[154:155], v[98:99], v[218:219] op_sel:[0,1,0] op_sel_hi:[1,1,1]
v_pk_mul_f32 v[212:213], v[212:213], v[98:99] op_sel:[0,0] op_sel_hi:[1,0]
v_pk_mul_f32 v[214:215], v[214:215], v[98:99] op_sel:[0,0] op_sel_hi:[1,0]
v_pk_mul_f32 v[216:217], v[216:217], v[98:99] op_sel:[0,0] op_sel_hi:[1,0]
v_pk_mul_f32 v[218:219], v[218:219], v[98:99] op_sel:[0,0] op_sel_hi:[1,0]
v_cvt_pk_bf16_f32 v212, v212, v213
v_cvt_pk_bf16_f32 v213, v214, v215
v_cvt_pk_bf16_f32 v214, v216, v217
v_cvt_pk_bf16_f32 v215, v218, v219
v_pk_fma_f32 v[244:245], v[88:89], v[56:57], v[244:245] op_sel:[0,0,0] op_sel_hi:[1,0,1]
v_pk_fma_f32 v[246:247], v[90:91], v[56:57], v[246:247] op_sel:[0,0,0] op_sel_hi:[1,0,1]
v_pk_mul_f32 v[244:245], v[244:245], v[72:73]
v_pk_mul_f32 v[246:247], v[246:247], v[74:75]
v_cvt_pk_bf16_f32 v108, v244, v245
v_cvt_pk_bf16_f32 v109, v246, v247
v_pk_fma_f32 v[248:249], v[88:89], v[56:57], v[248:249] op_sel:[0,1,0] op_sel_hi:[1,1,1]
v_pk_fma_f32 v[250:251], v[90:91], v[56:57], v[250:251] op_sel:[0,1,0] op_sel_hi:[1,1,1]
v_pk_mul_f32 v[248:249], v[248:249], v[72:73]
v_pk_mul_f32 v[250:251], v[250:251], v[74:75]
v_cvt_pk_bf16_f32 v118, v248, v249
v_cvt_pk_bf16_f32 v119, v250, v251
s_cmp_lg_u32 s44, 1
s_cbranch_scc1 else_61
buffer_store_dwordx4 v[212:215], v58, s[32:35], 0 offen sc1
buffer_store_dwordx2 v[108:109], v59, s[32:35], 0 offen offset:1024 sc1
buffer_store_dwordx2 v[118:119], v59, s[32:35], 0 offen offset:1536 sc1
s_branch fi_62
else_61:
ds_write_b128 v53, v[212:215]
ds_write_b64 v55, v[108:109] offset:1024
ds_write_b64 v55, v[118:119] offset:1536
v_mov_b32 v4, 1
ds_write_b32 v19, v4
fi_62:
.p2align 3
v_pk_fma_f32 v[188:189], v[148:149], v[92:93], v[188:189] op_sel:[0,1,0] op_sel_hi:[1,1,1]
v_pk_fma_f32 v[196:197], v[148:149], v[94:95], v[196:197] op_sel:[0,1,0] op_sel_hi:[1,1,1]
v_pk_fma_f32 v[204:205], v[148:149], v[96:97], v[204:205] op_sel:[0,1,0] op_sel_hi:[1,1,1]
v_pk_fma_f32 v[164:165], v[140:141], v[94:95], v[164:165] op_sel:[0,1,0] op_sel_hi:[1,1,1]
v_pk_fma_f32 v[172:173], v[140:141], v[96:97], v[172:173] op_sel:[0,1,0] op_sel_hi:[1,1,1]
v_pk_fma_f32 v[180:181], v[140:141], v[98:99], v[180:181] op_sel:[0,1,0] op_sel_hi:[1,1,1]
v_pk_fma_f32 v[190:191], v[150:151], v[92:93], v[190:191] op_sel:[0,1,0] op_sel_hi:[1,1,1]
v_pk_mul_f32 v[188:189], v[188:189], v[92:93] op_sel:[0,0] op_sel_hi:[1,0]
v_pk_fma_f32 v[198:199], v[150:151], v[94:95], v[198:199] op_sel:[0,1,0] op_sel_hi:[1,1,1]
v_pk_mul_f32 v[196:197], v[196:197], v[94:95] op_sel:[0,0] op_sel_hi:[1,0]
v_pk_fma_f32 v[206:207], v[150:151], v[96:97], v[206:207] op_sel:[0,1,0] op_sel_hi:[1,1,1]
v_pk_mul_f32 v[204:205], v[204:205], v[96:97] op_sel:[0,0] op_sel_hi:[1,0]
v_pk_fma_f32 v[166:167], v[142:143], v[94:95], v[166:167] op_sel:[0,1,0] op_sel_hi:[1,1,1]
v_cvt_pk_bf16_f32 v164, v164, v165
v_pk_fma_f32 v[174:175], v[142:143], v[96:97], v[174:175] op_sel:[0,1,0] op_sel_hi:[1,1,1]
v_cvt_pk_bf16_f32 v172, v172, v173
v_pk_fma_f32 v[182:183], v[142:143], v[98:99], v[182:183] op_sel:[0,1,0] op_sel_hi:[1,1,1]
v_cvt_pk_bf16_f32 v180, v180, v181
v_pk_fma_f32 v[192:193], v[152:153], v[92:93], v[192:193] op_sel:[0,1,0] op_sel_hi:[1,1,1]
v_pk_fma_f32 v[194:195], v[154:155], v[92:93], v[194:195] op_sel:[0,1,0] op_sel_hi:[1,1,1]
v_pk_mul_f32 v[190:191], v[190:191], v[92:93] op_sel:[0,0] op_sel_hi:[1,0]
v_cvt_pk_bf16_f32 v188, v188, v189
v_pk_fma_f32 v[200:201], v[152:153], v[94:95], v[200:201] op_sel:[0,1,0] op_sel_hi:[1,1,1]
v_pk_fma_f32 v[202:203], v[154:155], v[94:95], v[202:203] op_sel:[0,1,0] op_sel_hi:[1,1,1]
v_pk_mul_f32 v[198:199], v[198:199], v[94:95] op_sel:[0,0] op_sel_hi:[1,0]
v_cvt_pk_bf16_f32 v196, v196, v197
v_pk_fma_f32 v[208:209], v[152:153], v[96:97], v[208:209] op_sel:[0,1,0] op_sel_hi:[1,1,1]
v_pk_fma_f32 v[210:211], v[154:155], v[96:97], v[210:211] op_sel:[0,1,0] op_sel_hi:[1,1,1]
v_pk_mul_f32 v[206:207], v[206:207], v[96:97] op_sel:[0,0] op_sel_hi:[1,0]
v_cvt_pk_bf16_f32 v204, v204, v205
v_pk_fma_f32 v[168:169], v[144:145], v[94:95], v[168:169] op_sel:[0,1,0] op_sel_hi:[1,1,1]
v_pk_fma_f32 v[170:171], v[146:147], v[94:95], v[170:171] op_sel:[0,1,0] op_sel_hi:[1,1,1]
v_cvt_pk_bf16_f32 v165, v166, v167
v_pk_fma_f32 v[176:177], v[144:145], v[96:97], v[176:177] op_sel:[0,1,0] op_sel_hi:[1,1,1]
v_pk_fma_f32 v[178:179], v[146:147], v[96:97], v[178:179] op_sel:[0,1,0] op_sel_hi:[1,1,1]
v_cvt_pk_bf16_f32 v173, v174, v175
v_pk_fma_f32 v[184:185], v[144:145], v[98:99], v[184:185] op_sel:[0,1,0] op_sel_hi:[1,1,1]
v_pk_fma_f32 v[186:187], v[146:147], v[98:99], v[186:187] op_sel:[0,1,0] op_sel_hi:[1,1,1]
v_cvt_pk_bf16_f32 v181, v182, v183
v_pk_mul_f32 v[192:193], v[192:193], v[92:93] op_sel:[0,0] op_sel_hi:[1,0]
v_pk_mul_f32 v[194:195], v[194:195], v[92:93] op_sel:[0,0] op_sel_hi:[1,0]
v_cvt_pk_bf16_f32 v189, v190, v191
v_pk_mul_f32 v[200:201], v[200:201], v[94:95] op_sel:[0,0] op_sel_hi:[1,0]
v_pk_mul_f32 v[202:203], v[202:203], v[94:95] op_sel:[0,0] op_sel_hi:[1,0]
v_cvt_pk_bf16_f32 v197, v198, v199
v_pk_mul_f32 v[208:209], v[208:209], v[96:97] op_sel:[0,0] op_sel_hi:[1,0]
v_pk_mul_f32 v[210:211], v[210:211], v[96:97] op_sel:[0,0] op_sel_hi:[1,0]
v_cvt_pk_bf16_f32 v205, v206, v207
v_cvt_pk_bf16_f32 v166, v168, v169
v_cvt_pk_bf16_f32 v167, v170, v171
v_cvt_pk_bf16_f32 v174, v176, v177
v_cvt_pk_bf16_f32 v175, v178, v179
v_cvt_pk_bf16_f32 v182, v184, v185
v_cvt_pk_bf16_f32 v183, v186, v187
v_cvt_pk_bf16_f32 v190, v192, v193
v_cvt_pk_bf16_f32 v191, v194, v195
v_mfma_f32_16x16x32_bf16 v[216:219], v[212:215], v[180:183], v[40:43]
v_cvt_pk_bf16_f32 v198, v200, v201
v_cvt_pk_bf16_f32 v199, v202, v203
v_mfma_f32_16x16x32_bf16 v[168:171], v[188:191], v[164:167], v[36:39]
v_cvt_pk_bf16_f32 v206, v208, v209
v_cvt_pk_bf16_f32 v207, v210, v211
v_mfma_f32_16x16x32_bf16 v[200:203], v[196:199], v[164:167], v[40:43]
v_mul_f32 v124, s66, v92
v_mul_f32 v125, s66, v94
v_mfma_f32_16x16x32_bf16 v[208:211], v[204:207], v[172:175], v[40:43]
v_mul_f32 v126, s66, v96
v_mul_f32 v127, s66, v98
v_mfma_f32_16x16x32_bf16 v[176:179], v[196:199], v[172:175], v[36:39]
v_max_f32 v164, v168, v169
v_max_f32 v165, v170, v171
v_mfma_f32_16x16x32_bf16 v[184:187], v[204:207], v[180:183], v[36:39]
v_max_f32 v166, v200, v201
v_max_f32 v182, v216, v217
v_max_f32 v174, v208, v209
v_max_f32 v167, v202, v203
v_max3_f32 v129, v164, v165, v166
v_pk_fma_f32 v[156:157], v[140:141], v[92:93], v[156:157] op_sel:[0,1,0] op_sel_hi:[1,1,1]
v_pk_fma_f32 v[158:159], v[142:143], v[92:93], v[158:159] op_sel:[0,1,0] op_sel_hi:[1,1,1]
v_cvt_pk_bf16_f32 v156, v156, v157
v_pk_fma_f32 v[160:161], v[144:145], v[92:93], v[160:161] op_sel:[0,1,0] op_sel_hi:[1,1,1]
v_pk_fma_f32 v[162:163], v[146:147], v[92:93], v[162:163] op_sel:[0,1,0] op_sel_hi:[1,1,1]
v_cvt_pk_bf16_f32 v157, v158, v159
v_cvt_pk_bf16_f32 v158, v160, v161
v_cvt_pk_bf16_f32 v159, v162, v163
v_pk_fma_f32 v[220:221], v[76:77], v[56:57], v[220:221] op_sel:[0,0,0] op_sel_hi:[1,0,1]
v_pk_fma_f32 v[222:223], v[78:79], v[56:57], v[222:223] op_sel:[0,0,0] op_sel_hi:[1,0,1]
v_mfma_f32_16x16x32_bf16 v[192:195], v[188:191], v[156:159], v[40:43]
v_max_f32 v172, v176, v177
v_max_f32 v173, v178, v179
v_max_f32 v180, v184, v185
v_max_f32 v181, v186, v187
v_max_f32_e64 v175, v210, v211
v_pk_fma_f32 v[224:225], v[76:77], v[56:57], v[224:225] op_sel:[0,1,0] op_sel_hi:[1,1,1]
v_pk_fma_f32 v[226:227], v[78:79], v[56:57], v[226:227] op_sel:[0,1,0] op_sel_hi:[1,1,1]
v_pk_fma_f32 v[228:229], v[80:81], v[56:57], v[228:229] op_sel:[0,0,0] op_sel_hi:[1,0,1]
v_pk_fma_f32 v[230:231], v[82:83], v[56:57], v[230:231] op_sel:[0,0,0] op_sel_hi:[1,0,1]
v_pk_fma_f32 v[232:233], v[80:81], v[56:57], v[232:233] op_sel:[0,1,0] op_sel_hi:[1,1,1]
v_pk_fma_f32 v[234:235], v[82:83], v[56:57], v[234:235] op_sel:[0,1,0] op_sel_hi:[1,1,1]
v_pk_fma_f32 v[236:237], v[84:85], v[56:57], v[236:237] op_sel:[0,0,0] op_sel_hi:[1,0,1]
v_pk_fma_f32 v[238:239], v[86:87], v[56:57], v[238:239] op_sel:[0,0,0] op_sel_hi:[1,0,1]
v_pk_fma_f32 v[240:241], v[84:85], v[56:57], v[240:241] op_sel:[0,1,0] op_sel_hi:[1,1,1]
v_pk_fma_f32 v[242:243], v[86:87], v[56:57], v[242:243] op_sel:[0,1,0] op_sel_hi:[1,1,1]
v_pk_mul_f32 v[220:221], v[220:221], v[60:61]
v_pk_mul_f32 v[222:223], v[222:223], v[62:63]
v_pk_mul_f32 v[224:225], v[224:225], v[60:61]
s_cmp_lg_u32 s44, 0
s_cbranch_scc1 else_63
buffer_load_dwordx4 v[120:123], v58, s[32:35], 0 offen sc1
buffer_load_dwordx2 v[100:101], v59, s[32:35], 0 offen offset:1024 sc1
buffer_load_dwordx2 v[110:111], v59, s[32:35], 0 offen offset:1536 sc1
else_63:
v_pk_mul_f32 v[226:227], v[226:227], v[62:63]
v_pk_mul_f32 v[228:229], v[228:229], v[64:65]
v_pk_mul_f32 v[230:231], v[230:231], v[66:67]
v_pk_mul_f32 v[232:233], v[232:233], v[64:65]
v_pk_mul_f32 v[234:235], v[234:235], v[66:67]
v_pk_mul_f32 v[236:237], v[236:237], v[68:69]
v_pk_mul_f32 v[238:239], v[238:239], v[70:71]
v_pk_mul_f32 v[240:241], v[240:241], v[68:69]
v_pk_mul_f32 v[242:243], v[242:243], v[70:71]
v_max3_f32 v130, v172, v173, v174
v_max_f32_e64 v183, v218, v219
v_max3_f32 v131, v180, v181, v182
v_cvt_pk_bf16_f32 v102, v220, v221
v_cvt_pk_bf16_f32 v103, v222, v223
v_cvt_pk_bf16_f32 v112, v224, v225
v_cvt_pk_bf16_f32 v113, v226, v227
v_cvt_pk_bf16_f32 v104, v228, v229
v_cvt_pk_bf16_f32 v105, v230, v231
v_cvt_pk_bf16_f32 v114, v232, v233
v_cvt_pk_bf16_f32 v115, v234, v235
v_cvt_pk_bf16_f32 v106, v236, v237
v_cvt_pk_bf16_f32 v107, v238, v239
v_cvt_pk_bf16_f32 v116, v240, v241
v_cvt_pk_bf16_f32 v117, v242, v243
v_max_f32 v129, v129, v167
v_max_f32 v130, v130, v175
v_max_f32 v131, v131, v183
s_cmp_lg_u32 s44, 0
s_cbranch_scc1 else_65
s_mov_b32 s63, 0
sent_67:
s_waitcnt vmcnt(0)
v_max_u32 v4, v120, v121
v_max3_u32 v4, v4, v122, v123
v_max3_u32 v4, v4, v100, v101
v_max3_u32 v4, v4, v110, v111
v_cmp_eq_u32 vcc, -1, v4
s_cbranch_vccz sentd_68
buffer_load_dwordx4 v[120:123], v58, s[32:35], 0 offen sc1
buffer_load_dwordx2 v[100:101], v59, s[32:35], 0 offen offset:1024 sc1
buffer_load_dwordx2 v[110:111], v59, s[32:35], 0 offen offset:1536 sc1
s_add_u32 s63, s63, 1
s_cmp_lt_u32 s63, 0x80000
s_cbranch_scc1 sent_67
s_waitcnt vmcnt(0)
sentd_68:
v_mov_b32 v132, -1
v_mov_b32 v133, -1
v_mov_b32 v134, -1
v_mov_b32 v135, -1
buffer_store_dwordx4 v[132:135], v58, s[32:35], 0 offen offset:0 sc1
buffer_store_dwordx4 v[132:135], v58, s[32:35], 0 offen offset:1024 sc1
s_branch fi_66
else_65:
s_mov_b32 s63, 0
px_69:
ds_read_b32 v4, v19
ds_read_b128 v[120:123], v53
ds_read_b64 v[100:101], v55 offset:1024
ds_read_b64 v[110:111], v55 offset:1536
s_add_u32 s63, s63, 1
s_cmp_lt_u32 s63, 0x400000
s_waitcnt lgkmcnt(0)
v_cmp_ne_u32 vcc, 1, v4
s_cbranch_vccz pxd_70
s_cbranch_scc1 px_69
pxd_70:
fi_66:
s_cmp_eq_u32 s46, 0
s_cbranch_scc1 slow_71
.p2align 3
v_mfma_f32_16x16x32_bf16 v[160:163], v[120:123], v[156:159], v[44:47]
v_max_f32 v158, v192, v193
v_max_f32 v159, v194, v195
v_permlane32_swap_b32 v130, v131
s_nop 0
v_max_f32 v130, v130, v131
s_nop 2
v_max_f32 v156, v160, v161
v_max_f32 v157, v162, v163
v_max3_f32 v128, v156, v157, v158
v_max_f32 v128, v128, v159
s_nop 1
v_permlane32_swap_b32 v128, v129
s_nop 0
v_max_f32 v128, v128, v129
s_nop 1
v_permlane16_swap_b32 v128, v130
s_nop 0
v_max_f32 v128, v128, v130
v_mov_b32 v130, v128
s_nop 1
v_permlane16_swap_b32 v128, v130
s_nop 0
v_mov_b32 v129, v128
v_mov_b32 v131, v130
s_nop 0
v_permlane32_swap_b32 v128, v129
v_permlane32_swap_b32 v130, v131
v_mul_f32 v128, v128, v124
v_mul_f32 v129, v129, v125
v_pk_fma_f32 v[156:157], v[156:157], v[124:125], v[128:129] op_sel:[0,0,0] op_sel_hi:[1,0,0] neg_lo:[0,0,1] neg_hi:[0,0,1]
v_pk_fma_f32 v[158:159], v[158:159], v[124:125], v[128:129] op_sel:[0,0,0] op_sel_hi:[1,0,0] neg_lo:[0,0,1] neg_hi:[0,0,1]
v_mul_f32 v130, v130, v126
v_mul_f32 v131, v131, v127
v_exp_f32 v156, v156
v_exp_f32 v157, v157
v_exp_f32 v158, v158
v_exp_f32 v159, v159
v_pk_fma_f32 v[164:165], v[164:165], v[124:125], v[128:129] op_sel:[0,1,1] op_sel_hi:[1,1,1] neg_lo:[0,0,1] neg_hi:[0,0,1]
v_pk_fma_f32 v[166:167], v[166:167], v[124:125], v[128:129] op_sel:[0,1,1] op_sel_hi:[1,1,1] neg_lo:[0,0,1] neg_hi:[0,0,1]
v_exp_f32 v164, v164
v_exp_f32 v165, v165
v_exp_f32 v166, v166
v_exp_f32 v167, v167
v_pk_fma_f32 v[172:173], v[172:173], v[126:127], v[130:131] op_sel:[0,0,0] op_sel_hi:[1,0,0] neg_lo:[0,0,1] neg_hi:[0,0,1]
v_pk_fma_f32 v[174:175], v[174:175], v[126:127], v[130:131] op_sel:[0,0,0] op_sel_hi:[1,0,0] neg_lo:[0,0,1] neg_hi:[0,0,1]
v_cvt_pk_bf16_f32 v156, v156, v156
v_cvt_pk_bf16_f32 v157, v157, v157
v_cvt_pk_bf16_f32 v158, v158, v158
v_cvt_pk_bf16_f32 v159, v159, v159
v_exp_f32 v172, v172
v_exp_f32 v173, v173
v_exp_f32 v174, v174
v_exp_f32 v175, v175
v_pk_fma_f32 v[180:181], v[180:181], v[126:127], v[130:131] op_sel:[0,1,1] op_sel_hi:[1,1,1] neg_lo:[0,0,1] neg_hi:[0,0,1]
v_pk_fma_f32 v[182:183], v[182:183], v[126:127], v[130:131] op_sel:[0,1,1] op_sel_hi:[1,1,1] neg_lo:[0,0,1] neg_hi:[0,0,1]
v_and_b32 v156, v52, v156
v_and_b32 v157, v52, v157
v_and_b32 v158, v52, v158
v_and_b32 v159, v52, v159
v_cvt_pk_bf16_f32 v164, v164, v164
v_cvt_pk_bf16_f32 v165, v165, v165
v_mfma_f32_16x16x32_bf16 v[160:163], v[48:51], v[156:159], 0
v_cvt_pk_bf16_f32 v166, v166, v166
v_cvt_pk_bf16_f32 v167, v167, v167
v_mfma_f32_16x16x32_bf16 v[220:223], v[100:103], v[156:159], 0
v_exp_f32 v180, v180
v_mfma_f32_16x16x32_bf16 v[224:227], v[110:113], v[156:159], 0
v_exp_f32 v181, v181
v_exp_f32 v182, v182
v_exp_f32 v183, v183
v_and_b32 v164, v52, v164
v_and_b32 v165, v52, v165
v_and_b32 v166, v52, v166
v_and_b32 v167, v52, v167
v_cvt_pk_bf16_f32 v172, v172, v172
v_cvt_pk_bf16_f32 v173, v173, v173
v_mfma_f32_16x16x32_bf16 v[168:171], v[48:51], v[164:167], 0
v_cvt_pk_bf16_f32 v174, v174, v174
v_cvt_pk_bf16_f32 v175, v175, v175
v_mfma_f32_16x16x32_bf16 v[228:231], v[102:105], v[164:167], 0
v_and_b32 v172, v52, v172
v_and_b32 v173, v52, v173
v_mfma_f32_16x16x32_bf16 v[232:235], v[112:115], v[164:167], 0
v_and_b32 v174, v52, v174
v_and_b32 v175, v52, v175
v_cvt_pk_bf16_f32 v180, v180, v180
v_cvt_pk_bf16_f32 v181, v181, v181
v_mfma_f32_16x16x32_bf16 v[176:179], v[48:51], v[172:175], 0
v_cvt_pk_bf16_f32 v182, v182, v182
v_cvt_pk_bf16_f32 v183, v183, v183
v_mfma_f32_16x16x32_bf16 v[236:239], v[104:107], v[172:175], 0
v_and_b32 v180, v52, v180
v_and_b32 v181, v52, v181
v_mfma_f32_16x16x32_bf16 v[240:243], v[114:117], v[172:175], 0
v_and_b32 v182, v52, v182
v_and_b32 v183, v52, v183
v_rcp_f32 v160, v160
v_rcp_f32 v168, v168
v_pk_mul_f32 v[220:221], v[220:221], v[160:161] op_sel:[0,0] op_sel_hi:[1,0]
v_pk_mul_f32 v[222:223], v[222:223], v[160:161] op_sel:[0,0] op_sel_hi:[1,0]
v_pk_mul_f32 v[228:229], v[228:229], v[168:169] op_sel:[0,0] op_sel_hi:[1,0]
v_pk_mul_f32 v[224:225], v[224:225], v[160:161] op_sel:[0,0] op_sel_hi:[1,0]
v_pk_mul_f32 v[226:227], v[226:227], v[160:161] op_sel:[0,0] op_sel_hi:[1,0]
v_pk_mul_f32 v[230:231], v[230:231], v[168:169] op_sel:[0,0] op_sel_hi:[1,0]
v_pk_mul_f32 v[232:233], v[232:233], v[168:169] op_sel:[0,0] op_sel_hi:[1,0]
v_pk_mul_f32 v[234:235], v[234:235], v[168:169] op_sel:[0,0] op_sel_hi:[1,0]
v_mfma_f32_16x16x32_bf16 v[184:187], v[48:51], v[180:183], 0
v_rcp_f32_e64 v176, v176
v_cvt_pk_bf16_f32 v220, v220, v221
v_cvt_pk_bf16_f32 v221, v222, v223
v_cvt_pk_bf16_f32 v228, v228, v229
v_pk_mul_f32 v[236:237], v[236:237], v[176:177] op_sel:[0,0] op_sel_hi:[1,0]
v_mfma_f32_16x16x32_bf16 v[244:247], v[106:109], v[180:183], 0
v_cvt_pk_bf16_f32 v222, v224, v225
v_cvt_pk_bf16_f32 v223, v226, v227
v_rcp_f32_e64 v184, v184
v_cvt_pk_bf16_f32 v229, v230, v231
v_pk_mul_f32 v[238:239], v[238:239], v[176:177] op_sel:[0,0] op_sel_hi:[1,0]
v_pk_mul_f32 v[240:241], v[240:241], v[176:177] op_sel:[0,0] op_sel_hi:[1,0]
v_pk_mul_f32 v[242:243], v[242:243], v[176:177] op_sel:[0,0] op_sel_hi:[1,0]
v_cvt_pk_bf16_f32 v236, v236, v237
v_pk_mul_f32 v[244:245], v[244:245], v[184:185] op_sel:[0,0] op_sel_hi:[1,0]
v_pk_mul_f32 v[246:247], v[246:247], v[184:185] op_sel:[0,0] op_sel_hi:[1,0]
v_mfma_f32_16x16x32_bf16 v[248:251], v[116:119], v[180:183], 0
buffer_store_dwordx4 v[220:223], v18, s[32:35], s80 offen sc1
v_cvt_pk_bf16_f32 v230, v232, v233
v_cvt_pk_bf16_f32 v231, v234, v235
v_cvt_pk_bf16_f32 v237, v238, v239
v_cvt_pk_bf16_f32 v244, v244, v245
buffer_store_dwordx4 v[228:231], v18, s[32:35], s81 offen sc1
v_cvt_pk_bf16_f32 v238, v240, v241
v_cvt_pk_bf16_f32 v239, v242, v243
v_pk_mul_f32 v[248:249], v[248:249], v[184:185] op_sel:[0,0] op_sel_hi:[1,0]
v_pk_mul_f32 v[250:251], v[250:251], v[184:185] op_sel:[0,0] op_sel_hi:[1,0]
v_cvt_pk_bf16_f32 v245, v246, v247
buffer_store_dwordx4 v[236:239], v18, s[32:35], s82 offen sc1
v_cvt_pk_bf16_f32 v246, v248, v249
v_cvt_pk_bf16_f32 v247, v250, v251
buffer_store_dwordx4 v[244:247], v18, s[32:35], s83 offen sc1
back_72:
s_barrier
v_and_b32 v36, 31, v0
v_lshlrev_b32 v36, 2, v36
s_lshl_b32 s62, s45, 2
v_mov_b32 v4, s62
v_mov_b32 v5, 1
s_mov_b64 exec, 1
s_waitcnt vmcnt(0)
s_cmp_eq_u32 s46, 0
s_cbranch_scc1 slow_73
buffer_store_dword v5, v4, s[32:35], s84 offen
back_74:
s_mov_b64 exec, -1
v_lshrrev_b32 v4, 2, v2
v_and_b32 v5, 3, v0
v_lshl_add_u32 v6, v3, 3, v4
v_lshlrev_b32 v6, 7, v6
v_lshl_add_u32 v6, v5, 3, v6
v_lshrrev_b32 v7, 1, v4
v_and_b32 v8, 1, v3
v_lshl_add_u32 v7, v8, 1, v7
v_lshl_add_u32 v10, v7, 5, v6
v_xor_b32 v11, 32, v10
v_xor_b32 v12, 64, v10
v_xor_b32 v13, 96, v10
v_add_u32 v14, 0x10000, v10
v_add_u32 v15, 0x10000, v11
v_add_u32 v16, 0x10000, v12
v_add_u32 v17, 0x10000, v13
ds_read_b64_tr_b16 v[220:221], v10 offset:0
ds_read_b64_tr_b16 v[222:223], v10 offset:512
ds_read_b64_tr_b16 v[224:225], v11 offset:0
ds_read_b64_tr_b16 v[226:227], v11 offset:512
ds_read_b64_tr_b16 v[228:229], v12 offset:0
ds_read_b64_tr_b16 v[230:231], v12 offset:512
ds_read_b64_tr_b16 v[232:233], v13 offset:0
ds_read_b64_tr_b16 v[234:235], v13 offset:512
ds_read_b64_tr_b16 v[236:237], v10 offset:4096
ds_read_b64_tr_b16 v[238:239], v10 offset:4608
ds_read_b64_tr_b16 v[240:241], v11 offset:4096
ds_read_b64_tr_b16 v[242:243], v11 offset:4608
ds_read_b64_tr_b16 v[244:245], v12 offset:4096
ds_read_b64_tr_b16 v[246:247], v12 offset:4608
ds_read_b64_tr_b16 v[248:249], v13 offset:4096
ds_read_b64_tr_b16 v[250:251], v13 offset:4608
s_lshl_b32 s48, s41, 3
s_lshl_b32 s49, s40, 1
s_add_u32 s48, s48, s49
s_lshl_b32 s48, s48, 15
s_add_u32 s48, s48, 4194304
v_add_u32 v38, s48, v18
v_add_u32 v39, 32768, v38
s_lshl_b32 s57, s75, 11
s_add_u32 s87, s87, 262144
v_lshlrev_b32 v60, 16, v20
v_and_b32 v61, 0xffff0000, v20
v_lshlrev_b32 v62, 16, v21
v_and_b32 v63, 0xffff0000, v21
v_lshlrev_b32 v64, 16, v22
v_and_b32 v65, 0xffff0000, v22
v_lshlrev_b32 v66, 16, v23
v_and_b32 v67, 0xffff0000, v23
v_lshlrev_b32 v68, 16, v24
v_and_b32 v69, 0xffff0000, v24
v_lshlrev_b32 v70, 16, v25
v_and_b32 v71, 0xffff0000, v25
v_lshlrev_b32 v72, 16, v26
v_and_b32 v73, 0xffff0000, v26
v_lshlrev_b32 v74, 16, v27
v_and_b32 v75, 0xffff0000, v27
v_lshlrev_b32 v76, 16, v28
v_and_b32 v77, 0xffff0000, v28
v_lshlrev_b32 v78, 16, v29
v_and_b32 v79, 0xffff0000, v29
v_lshlrev_b32 v80, 16, v30
v_and_b32 v81, 0xffff0000, v30
v_lshlrev_b32 v82, 16, v31
v_and_b32 v83, 0xffff0000, v31
v_lshlrev_b32 v84, 16, v32
v_and_b32 v85, 0xffff0000, v32
v_lshlrev_b32 v86, 16, v33
v_and_b32 v87, 0xffff0000, v33
v_lshlrev_b32 v88, 16, v34
v_and_b32 v89, 0xffff0000, v34
v_lshlrev_b32 v90, 16, v35
v_and_b32 v91, 0xffff0000, v35
v_mov_b32 v6, 0
v_mov_b32 v7, 0
v_mov_b32 v8, 0
v_mov_b32 v9, 0
s_lshl_b32 s62, s42, 2
v_mov_b32 v4, s62
v_mov_b32 v5, 1
buffer_load_dword v37, v36, s[32:35], s84 offen sc1
s_mov_b32 s63, 0
s_waitcnt vmcnt(0)
poll_75:
v_cmp_gt_u32 vcc, 1, v37
s_cbranch_vccz polled_76
buffer_load_dword v37, v36, s[32:35], s84 offen sc1
s_add_u32 s63, s63, 1
s_cmp_lt_u32 s63, 0x80000
s_waitcnt vmcnt(0)
s_cbranch_scc1 poll_75
polled_76:
s_getpc_b64 s[94:95]
pc_77:
s_add_u32 s94, s94, R_oloop_end - pc_77
s_addc_u32 s95, s95, 0
R_oloop:
buffer_load_dwordx4 v[156:159], v38, s[32:35], s57 offen sc1
buffer_load_dwordx4 v[160:163], v39, s[32:35], s57 offen sc1
buffer_load_dwordx4 v[164:167], v38, s[32:35], s57 offen offset:1024 sc1
buffer_load_dwordx4 v[168:171], v39, s[32:35], s57 offen offset:1024 sc1
s_add_u32 s57, s57, 2048
s_and_b32 s57, s57, 0x7fff
buffer_load_dwordx4 v[172:175], v38, s[32:35], s57 offen sc1
buffer_load_dwordx4 v[176:179], v39, s[32:35], s57 offen sc1
buffer_load_dwordx4 v[180:183], v38, s[32:35], s57 offen offset:1024 sc1
buffer_load_dwordx4 v[184:187], v39, s[32:35], s57 offen offset:1024 sc1
s_add_u32 s57, s57, 2048
s_and_b32 s57, s57, 0x7fff
buffer_load_dwordx4 v[188:191], v38, s[32:35], s57 offen sc1
buffer_load_dwordx4 v[192:195], v39, s[32:35], s57 offen sc1
s_waitcnt vmcnt(8) lgkmcnt(8)
v_mfma_f32_16x16x32_bf16 v[60:63], v[220:223], v[156:159], v[60:63]
buffer_load_dwordx4 v[196:199], v38, s[32:35], s57 offen offset:1024 sc1
v_mfma_f32_16x16x32_bf16 v[76:79], v[220:223], v[160:163], v[76:79]
ds_read_b64_tr_b16 v[100:101], v10 offset:8192
ds_read_b64_tr_b16 v[102:103], v10 offset:8704
v_mfma_f32_16x16x32_bf16 v[80:83], v[224:227], v[160:163], v[80:83]
ds_read_b64_tr_b16 v[104:105], v11 offset:8192
ds_read_b64_tr_b16 v[106:107], v11 offset:8704
v_mfma_f32_16x16x32_bf16 v[64:67], v[224:227], v[156:159], v[64:67]
buffer_load_dwordx4 v[200:203], v39, s[32:35], s57 offen offset:1024 sc1
v_mfma_f32_16x16x32_bf16 v[68:71], v[228:231], v[156:159], v[68:71]
ds_read_b64_tr_b16 v[108:109], v12 offset:8192
ds_read_b64_tr_b16 v[110:111], v12 offset:8704
v_mfma_f32_16x16x32_bf16 v[84:87], v[228:231], v[160:163], v[84:87]
ds_read_b64_tr_b16 v[112:113], v13 offset:8192
ds_read_b64_tr_b16 v[114:115], v13 offset:8704
v_mfma_f32_16x16x32_bf16 v[88:91], v[232:235], v[160:163], v[88:91]
s_add_u32 s57, s57, 2048
s_and_b32 s57, s57, 0x7fff
v_mfma_f32_16x16x32_bf16 v[72:75], v[232:235], v[156:159], v[72:75]
s_waitcnt vmcnt(8) lgkmcnt(8)
v_mfma_f32_16x16x32_bf16 v[60:63], v[236:239], v[164:167], v[60:63]
buffer_load_dwordx4 v[204:207], v38, s[32:35], s57 offen sc1
v_mfma_f32_16x16x32_bf16 v[76:79], v[236:239], v[168:171], v[76:79]
ds_read_b64_tr_b16 v[220:221], v10 offset:12288
ds_read_b64_tr_b16 v[222:223], v10 offset:12800
v_mfma_f32_16x16x32_bf16 v[80:83], v[240:243], v[168:171], v[80:83]
ds_read_b64_tr_b16 v[224:225], v11 offset:12288
ds_read_b64_tr_b16 v[226:227], v11 offset:12800
v_mfma_f32_16x16x32_bf16 v[64:67], v[240:243], v[164:167], v[64:67]
buffer_load_dwordx4 v[208:211], v39, s[32:35], s57 offen sc1
v_mfma_f32_16x16x32_bf16 v[68:71], v[244:247], v[164:167], v[68:71]
ds_read_b64_tr_b16 v[228:229], v12 offset:12288
ds_read_b64_tr_b16 v[230:231], v12 offset:12800
v_mfma_f32_16x16x32_bf16 v[84:87], v[244:247], v[168:171], v[84:87]
ds_read_b64_tr_b16 v[232:233], v13 offset:12288
ds_read_b64_tr_b16 v[234:235], v13 offset:12800
v_mfma_f32_16x16x32_bf16 v[88:91], v[248:251], v[168:171], v[88:91]
v_mfma_f32_16x16x32_bf16 v[72:75], v[248:251], v[164:167], v[72:75]
s_waitcnt vmcnt(8) lgkmcnt(8)
v_mfma_f32_16x16x32_bf16 v[60:63], v[100:103], v[172:175], v[60:63]
buffer_load_dwordx4 v[212:215], v38, s[32:35], s57 offen offset:1024 sc1
v_mfma_f32_16x16x32_bf16 v[76:79], v[100:103], v[176:179], v[76:79]
ds_read_b64_tr_b16 v[236:237], v10 offset:16384
ds_read_b64_tr_b16 v[238:239], v10 offset:16896
v_mfma_f32_16x16x32_bf16 v[80:83], v[104:107], v[176:179], v[80:83]
ds_read_b64_tr_b16 v[240:241], v11 offset:16384
ds_read_b64_tr_b16 v[242:243], v11 offset:16896
v_mfma_f32_16x16x32_bf16 v[64:67], v[104:107], v[172:175], v[64:67]
buffer_load_dwordx4 v[216:219], v39, s[32:35], s57 offen offset:1024 sc1
v_mfma_f32_16x16x32_bf16 v[68:71], v[108:111], v[172:175], v[68:71]
ds_read_b64_tr_b16 v[244:245], v12 offset:16384
ds_read_b64_tr_b16 v[246:247], v12 offset:16896
v_mfma_f32_16x16x32_bf16 v[84:87], v[108:111], v[176:179], v[84:87]
ds_read_b64_tr_b16 v[248:249], v13 offset:16384
ds_read_b64_tr_b16 v[250:251], v13 offset:16896
v_mfma_f32_16x16x32_bf16 v[88:91], v[112:115], v[176:179], v[88:91]
s_add_u32 s57, s57, 2048
s_and_b32 s57, s57, 0x7fff
v_mfma_f32_16x16x32_bf16 v[72:75], v[112:115], v[172:175], v[72:75]
s_waitcnt vmcnt(8) lgkmcnt(8)
v_mfma_f32_16x16x32_bf16 v[60:63], v[220:223], v[180:183], v[60:63]
buffer_load_dwordx4 v[156:159], v38, s[32:35], s57 offen sc1
v_mfma_f32_16x16x32_bf16 v[76:79], v[220:223], v[184:187], v[76:79]
ds_read_b64_tr_b16 v[100:101], v10 offset:20480
ds_read_b64_tr_b16 v[102:103], v10 offset:20992
v_mfma_f32_16x16x32_bf16 v[80:83], v[224:227], v[184:187], v[80:83]
ds_read_b64_tr_b16 v[104:105], v11 offset:20480
ds_read_b64_tr_b16 v[106:107], v11 offset:20992
v_mfma_f32_16x16x32_bf16 v[64:67], v[224:227], v[180:183], v[64:67]
buffer_load_dwordx4 v[160:163], v39, s[32:35], s57 offen sc1
v_mfma_f32_16x16x32_bf16 v[68:71], v[228:231], v[180:183], v[68:71]
ds_read_b64_tr_b16 v[108:109], v12 offset:20480
ds_read_b64_tr_b16 v[110:111], v12 offset:20992
v_mfma_f32_16x16x32_bf16 v[84:87], v[228:231], v[184:187], v[84:87]
ds_read_b64_tr_b16 v[112:113], v13 offset:20480
ds_read_b64_tr_b16 v[114:115], v13 offset:20992
v_mfma_f32_16x16x32_bf16 v[88:91], v[232:235], v[184:187], v[88:91]
v_mfma_f32_16x16x32_bf16 v[72:75], v[232:235], v[180:183], v[72:75]
s_waitcnt vmcnt(8) lgkmcnt(8)
v_mfma_f32_16x16x32_bf16 v[60:63], v[236:239], v[188:191], v[60:63]
buffer_load_dwordx4 v[164:167], v38, s[32:35], s57 offen offset:1024 sc1
v_mfma_f32_16x16x32_bf16 v[76:79], v[236:239], v[192:195], v[76:79]
ds_read_b64_tr_b16 v[220:221], v10 offset:24576
ds_read_b64_tr_b16 v[222:223], v10 offset:25088
v_mfma_f32_16x16x32_bf16 v[80:83], v[240:243], v[192:195], v[80:83]
ds_read_b64_tr_b16 v[224:225], v11 offset:24576
ds_read_b64_tr_b16 v[226:227], v11 offset:25088
v_mfma_f32_16x16x32_bf16 v[64:67], v[240:243], v[188:191], v[64:67]
buffer_load_dwordx4 v[168:171], v39, s[32:35], s57 offen offset:1024 sc1
v_mfma_f32_16x16x32_bf16 v[68:71], v[244:247], v[188:191], v[68:71]
ds_read_b64_tr_b16 v[228:229], v12 offset:24576
ds_read_b64_tr_b16 v[230:231], v12 offset:25088
v_mfma_f32_16x16x32_bf16 v[84:87], v[244:247], v[192:195], v[84:87]
ds_read_b64_tr_b16 v[232:233], v13 offset:24576
ds_read_b64_tr_b16 v[234:235], v13 offset:25088
v_mfma_f32_16x16x32_bf16 v[88:91], v[248:251], v[192:195], v[88:91]
s_add_u32 s57, s57, 2048
s_and_b32 s57, s57, 0x7fff
v_mfma_f32_16x16x32_bf16 v[72:75], v[248:251], v[188:191], v[72:75]
s_waitcnt vmcnt(8) lgkmcnt(8)
v_mfma_f32_16x16x32_bf16 v[60:63], v[100:103], v[196:199], v[60:63]
buffer_load_dwordx4 v[172:175], v38, s[32:35], s57 offen sc1
v_mfma_f32_16x16x32_bf16 v[76:79], v[100:103], v[200:203], v[76:79]
ds_read_b64_tr_b16 v[236:237], v10 offset:28672
ds_read_b64_tr_b16 v[238:239], v10 offset:29184
v_mfma_f32_16x16x32_bf16 v[80:83], v[104:107], v[200:203], v[80:83]
ds_read_b64_tr_b16 v[240:241], v11 offset:28672
ds_read_b64_tr_b16 v[242:243], v11 offset:29184
v_mfma_f32_16x16x32_bf16 v[64:67], v[104:107], v[196:199], v[64:67]
buffer_load_dwordx4 v[176:179], v39, s[32:35], s57 offen sc1
v_mfma_f32_16x16x32_bf16 v[68:71], v[108:111], v[196:199], v[68:71]
ds_read_b64_tr_b16 v[244:245], v12 offset:28672
ds_read_b64_tr_b16 v[246:247], v12 offset:29184
v_mfma_f32_16x16x32_bf16 v[84:87], v[108:111], v[200:203], v[84:87]
ds_read_b64_tr_b16 v[248:249], v13 offset:28672
ds_read_b64_tr_b16 v[250:251], v13 offset:29184
v_mfma_f32_16x16x32_bf16 v[88:91], v[112:115], v[200:203], v[88:91]
v_mfma_f32_16x16x32_bf16 v[72:75], v[112:115], v[196:199], v[72:75]
s_waitcnt vmcnt(8) lgkmcnt(8)
v_mfma_f32_16x16x32_bf16 v[60:63], v[220:223], v[204:207], v[60:63]
buffer_load_dwordx4 v[180:183], v38, s[32:35], s57 offen offset:1024 sc1
v_mfma_f32_16x16x32_bf16 v[76:79], v[220:223], v[208:211], v[76:79]
ds_read_b64_tr_b16 v[100:101], v10 offset:32768
ds_read_b64_tr_b16 v[102:103], v10 offset:33280
v_mfma_f32_16x16x32_bf16 v[80:83], v[224:227], v[208:211], v[80:83]
ds_read_b64_tr_b16 v[104:105], v11 offset:32768
ds_read_b64_tr_b16 v[106:107], v11 offset:33280
v_mfma_f32_16x16x32_bf16 v[64:67], v[224:227], v[204:207], v[64:67]
buffer_load_dwordx4 v[184:187], v39, s[32:35], s57 offen offset:1024 sc1
v_mfma_f32_16x16x32_bf16 v[68:71], v[228:231], v[204:207], v[68:71]
ds_read_b64_tr_b16 v[108:109], v12 offset:32768
ds_read_b64_tr_b16 v[110:111], v12 offset:33280
v_mfma_f32_16x16x32_bf16 v[84:87], v[228:231], v[208:211], v[84:87]
ds_read_b64_tr_b16 v[112:113], v13 offset:32768
ds_read_b64_tr_b16 v[114:115], v13 offset:33280
v_mfma_f32_16x16x32_bf16 v[88:91], v[232:235], v[208:211], v[88:91]
s_add_u32 s57, s57, 2048
s_and_b32 s57, s57, 0x7fff
v_mfma_f32_16x16x32_bf16 v[72:75], v[232:235], v[204:207], v[72:75]
s_waitcnt vmcnt(8) lgkmcnt(8)
v_mfma_f32_16x16x32_bf16 v[60:63], v[236:239], v[212:215], v[60:63]
buffer_load_dwordx4 v[188:191], v38, s[32:35], s57 offen sc1
v_mfma_f32_16x16x32_bf16 v[76:79], v[236:239], v[216:219], v[76:79]
ds_read_b64_tr_b16 v[220:221], v10 offset:36864
ds_read_b64_tr_b16 v[222:223], v10 offset:37376
v_mfma_f32_16x16x32_bf16 v[80:83], v[240:243], v[216:219], v[80:83]
ds_read_b64_tr_b16 v[224:225], v11 offset:36864
ds_read_b64_tr_b16 v[226:227], v11 offset:37376
v_mfma_f32_16x16x32_bf16 v[64:67], v[240:243], v[212:215], v[64:67]
buffer_load_dwordx4 v[192:195], v39, s[32:35], s57 offen sc1
v_mfma_f32_16x16x32_bf16 v[68:71], v[244:247], v[212:215], v[68:71]
ds_read_b64_tr_b16 v[228:229], v12 offset:36864
ds_read_b64_tr_b16 v[230:231], v12 offset:37376
v_mfma_f32_16x16x32_bf16 v[84:87], v[244:247], v[216:219], v[84:87]
ds_read_b64_tr_b16 v[232:233], v13 offset:36864
ds_read_b64_tr_b16 v[234:235], v13 offset:37376
v_mfma_f32_16x16x32_bf16 v[88:91], v[248:251], v[216:219], v[88:91]
v_mfma_f32_16x16x32_bf16 v[72:75], v[248:251], v[212:215], v[72:75]
s_waitcnt vmcnt(8) lgkmcnt(8)
v_mfma_f32_16x16x32_bf16 v[60:63], v[100:103], v[156:159], v[60:63]
buffer_load_dwordx4 v[196:199], v38, s[32:35], s57 offen offset:1024 sc1
v_mfma_f32_16x16x32_bf16 v[76:79], v[100:103], v[160:163], v[76:79]
ds_read_b64_tr_b16 v[236:237], v10 offset:40960
ds_read_b64_tr_b16 v[238:239], v10 offset:41472
v_mfma_f32_16x16x32_bf16 v[80:83], v[104:107], v[160:163], v[80:83]
ds_read_b64_tr_b16 v[240:241], v11 offset:40960
ds_read_b64_tr_b16 v[242:243], v11 offset:41472
v_mfma_f32_16x16x32_bf16 v[64:67], v[104:107], v[156:159], v[64:67]
buffer_load_dwordx4 v[200:203], v39, s[32:35], s57 offen offset:1024 sc1
v_mfma_f32_16x16x32_bf16 v[68:71], v[108:111], v[156:159], v[68:71]
ds_read_b64_tr_b16 v[244:245], v12 offset:40960
ds_read_b64_tr_b16 v[246:247], v12 offset:41472
v_mfma_f32_16x16x32_bf16 v[84:87], v[108:111], v[160:163], v[84:87]
ds_read_b64_tr_b16 v[248:249], v13 offset:40960
ds_read_b64_tr_b16 v[250:251], v13 offset:41472
v_mfma_f32_16x16x32_bf16 v[88:91], v[112:115], v[160:163], v[88:91]
s_add_u32 s57, s57, 2048
s_and_b32 s57, s57, 0x7fff
v_mfma_f32_16x16x32_bf16 v[72:75], v[112:115], v[156:159], v[72:75]
s_waitcnt vmcnt(8) lgkmcnt(8)
v_mfma_f32_16x16x32_bf16 v[60:63], v[220:223], v[164:167], v[60:63]
buffer_load_dwordx4 v[204:207], v38, s[32:35], s57 offen sc1
v_mfma_f32_16x16x32_bf16 v[76:79], v[220:223], v[168:171], v[76:79]
ds_read_b64_tr_b16 v[100:101], v10 offset:45056
ds_read_b64_tr_b16 v[102:103], v10 offset:45568
v_mfma_f32_16x16x32_bf16 v[80:83], v[224:227], v[168:171], v[80:83]
ds_read_b64_tr_b16 v[104:105], v11 offset:45056
ds_read_b64_tr_b16 v[106:107], v11 offset:45568
v_mfma_f32_16x16x32_bf16 v[64:67], v[224:227], v[164:167], v[64:67]
buffer_load_dwordx4 v[208:211], v39, s[32:35], s57 offen sc1
v_mfma_f32_16x16x32_bf16 v[68:71], v[228:231], v[164:167], v[68:71]
ds_read_b64_tr_b16 v[108:109], v12 offset:45056
ds_read_b64_tr_b16 v[110:111], v12 offset:45568
v_mfma_f32_16x16x32_bf16 v[84:87], v[228:231], v[168:171], v[84:87]
ds_read_b64_tr_b16 v[112:113], v13 offset:45056
ds_read_b64_tr_b16 v[114:115], v13 offset:45568
v_mfma_f32_16x16x32_bf16 v[88:91], v[232:235], v[168:171], v[88:91]
v_mfma_f32_16x16x32_bf16 v[72:75], v[232:235], v[164:167], v[72:75]
s_waitcnt vmcnt(8) lgkmcnt(8)
v_mfma_f32_16x16x32_bf16 v[60:63], v[236:239], v[172:175], v[60:63]
buffer_load_dwordx4 v[212:215], v38, s[32:35], s57 offen offset:1024 sc1
v_mfma_f32_16x16x32_bf16 v[76:79], v[236:239], v[176:179], v[76:79]
ds_read_b64_tr_b16 v[220:221], v10 offset:49152
ds_read_b64_tr_b16 v[222:223], v10 offset:49664
v_mfma_f32_16x16x32_bf16 v[80:83], v[240:243], v[176:179], v[80:83]
ds_read_b64_tr_b16 v[224:225], v11 offset:49152
ds_read_b64_tr_b16 v[226:227], v11 offset:49664
v_mfma_f32_16x16x32_bf16 v[64:67], v[240:243], v[172:175], v[64:67]
buffer_load_dwordx4 v[216:219], v39, s[32:35], s57 offen offset:1024 sc1
v_mfma_f32_16x16x32_bf16 v[68:71], v[244:247], v[172:175], v[68:71]
ds_read_b64_tr_b16 v[228:229], v12 offset:49152
ds_read_b64_tr_b16 v[230:231], v12 offset:49664
v_mfma_f32_16x16x32_bf16 v[84:87], v[244:247], v[176:179], v[84:87]
ds_read_b64_tr_b16 v[232:233], v13 offset:49152
ds_read_b64_tr_b16 v[234:235], v13 offset:49664
v_mfma_f32_16x16x32_bf16 v[88:91], v[248:251], v[176:179], v[88:91]
s_add_u32 s57, s57, 2048
s_and_b32 s57, s57, 0x7fff
v_mfma_f32_16x16x32_bf16 v[72:75], v[248:251], v[172:175], v[72:75]
s_waitcnt vmcnt(8) lgkmcnt(8)
v_mfma_f32_16x16x32_bf16 v[60:63], v[100:103], v[180:183], v[60:63]
buffer_load_dwordx4 v[156:159], v38, s[32:35], s57 offen sc1
v_mfma_f32_16x16x32_bf16 v[76:79], v[100:103], v[184:187], v[76:79]
ds_read_b64_tr_b16 v[236:237], v10 offset:53248
ds_read_b64_tr_b16 v[238:239], v10 offset:53760
v_mfma_f32_16x16x32_bf16 v[80:83], v[104:107], v[184:187], v[80:83]
ds_read_b64_tr_b16 v[240:241], v11 offset:53248
ds_read_b64_tr_b16 v[242:243], v11 offset:53760
v_mfma_f32_16x16x32_bf16 v[64:67], v[104:107], v[180:183], v[64:67]
buffer_load_dwordx4 v[160:163], v39, s[32:35], s57 offen sc1
v_mfma_f32_16x16x32_bf16 v[68:71], v[108:111], v[180:183], v[68:71]
ds_read_b64_tr_b16 v[244:245], v12 offset:53248
ds_read_b64_tr_b16 v[246:247], v12 offset:53760
v_mfma_f32_16x16x32_bf16 v[84:87], v[108:111], v[184:187], v[84:87]
ds_read_b64_tr_b16 v[248:249], v13 offset:53248
ds_read_b64_tr_b16 v[250:251], v13 offset:53760
v_mfma_f32_16x16x32_bf16 v[88:91], v[112:115], v[184:187], v[88:91]
v_mfma_f32_16x16x32_bf16 v[72:75], v[112:115], v[180:183], v[72:75]
s_waitcnt vmcnt(8) lgkmcnt(8)
v_mfma_f32_16x16x32_bf16 v[60:63], v[220:223], v[188:191], v[60:63]
buffer_load_dwordx4 v[164:167], v38, s[32:35], s57 offen offset:1024 sc1
v_mfma_f32_16x16x32_bf16 v[76:79], v[220:223], v[192:195], v[76:79]
ds_read_b64_tr_b16 v[100:101], v10 offset:57344
ds_read_b64_tr_b16 v[102:103], v10 offset:57856
v_mfma_f32_16x16x32_bf16 v[80:83], v[224:227], v[192:195], v[80:83]
ds_read_b64_tr_b16 v[104:105], v11 offset:57344
ds_read_b64_tr_b16 v[106:107], v11 offset:57856
v_mfma_f32_16x16x32_bf16 v[64:67], v[224:227], v[188:191], v[64:67]
buffer_load_dwordx4 v[168:171], v39, s[32:35], s57 offen offset:1024 sc1
v_mfma_f32_16x16x32_bf16 v[68:71], v[228:231], v[188:191], v[68:71]
ds_read_b64_tr_b16 v[108:109], v12 offset:57344
ds_read_b64_tr_b16 v[110:111], v12 offset:57856
v_mfma_f32_16x16x32_bf16 v[84:87], v[228:231], v[192:195], v[84:87]
ds_read_b64_tr_b16 v[112:113], v13 offset:57344
ds_read_b64_tr_b16 v[114:115], v13 offset:57856
v_mfma_f32_16x16x32_bf16 v[88:91], v[232:235], v[192:195], v[88:91]
s_add_u32 s57, s57, 2048
s_and_b32 s57, s57, 0x7fff
v_mfma_f32_16x16x32_bf16 v[72:75], v[232:235], v[188:191], v[72:75]
s_waitcnt vmcnt(8) lgkmcnt(8)
v_mfma_f32_16x16x32_bf16 v[60:63], v[236:239], v[196:199], v[60:63]
buffer_load_dwordx4 v[172:175], v38, s[32:35], s57 offen sc1
v_mfma_f32_16x16x32_bf16 v[76:79], v[236:239], v[200:203], v[76:79]
ds_read_b64_tr_b16 v[220:221], v10 offset:61440
ds_read_b64_tr_b16 v[222:223], v10 offset:61952
v_mfma_f32_16x16x32_bf16 v[80:83], v[240:243], v[200:203], v[80:83]
ds_read_b64_tr_b16 v[224:225], v11 offset:61440
ds_read_b64_tr_b16 v[226:227], v11 offset:61952
v_mfma_f32_16x16x32_bf16 v[64:67], v[240:243], v[196:199], v[64:67]
buffer_load_dwordx4 v[176:179], v39, s[32:35], s57 offen sc1
v_mfma_f32_16x16x32_bf16 v[68:71], v[244:247], v[196:199], v[68:71]
ds_read_b64_tr_b16 v[228:229], v12 offset:61440
ds_read_b64_tr_b16 v[230:231], v12 offset:61952
v_mfma_f32_16x16x32_bf16 v[84:87], v[244:247], v[200:203], v[84:87]
ds_read_b64_tr_b16 v[232:233], v13 offset:61440
ds_read_b64_tr_b16 v[234:235], v13 offset:61952
v_mfma_f32_16x16x32_bf16 v[88:91], v[248:251], v[200:203], v[88:91]
v_mfma_f32_16x16x32_bf16 v[72:75], v[248:251], v[196:199], v[72:75]
s_waitcnt vmcnt(8) lgkmcnt(8)
v_mfma_f32_16x16x32_bf16 v[60:63], v[100:103], v[204:207], v[60:63]
buffer_load_dwordx4 v[180:183], v38, s[32:35], s57 offen offset:1024 sc1
v_mfma_f32_16x16x32_bf16 v[76:79], v[100:103], v[208:211], v[76:79]
ds_read_b64_tr_b16 v[236:237], v14 offset:0
ds_read_b64_tr_b16 v[238:239], v14 offset:512
v_mfma_f32_16x16x32_bf16 v[80:83], v[104:107], v[208:211], v[80:83]
ds_read_b64_tr_b16 v[240:241], v15 offset:0
ds_read_b64_tr_b16 v[242:243], v15 offset:512
v_mfma_f32_16x16x32_bf16 v[64:67], v[104:107], v[204:207], v[64:67]
buffer_load_dwordx4 v[184:187], v39, s[32:35], s57 offen offset:1024 sc1
v_mfma_f32_16x16x32_bf16 v[68:71], v[108:111], v[204:207], v[68:71]
ds_read_b64_tr_b16 v[244:245], v16 offset:0
ds_read_b64_tr_b16 v[246:247], v16 offset:512
v_mfma_f32_16x16x32_bf16 v[84:87], v[108:111], v[208:211], v[84:87]
ds_read_b64_tr_b16 v[248:249], v17 offset:0
ds_read_b64_tr_b16 v[250:251], v17 offset:512
v_mfma_f32_16x16x32_bf16 v[88:91], v[112:115], v[208:211], v[88:91]
s_add_u32 s57, s57, 2048
s_and_b32 s57, s57, 0x7fff
v_mfma_f32_16x16x32_bf16 v[72:75], v[112:115], v[204:207], v[72:75]
s_waitcnt vmcnt(8) lgkmcnt(8)
v_mfma_f32_16x16x32_bf16 v[60:63], v[220:223], v[212:215], v[60:63]
buffer_load_dwordx4 v[188:191], v38, s[32:35], s57 offen sc1
v_mfma_f32_16x16x32_bf16 v[76:79], v[220:223], v[216:219], v[76:79]
ds_read_b64_tr_b16 v[100:101], v14 offset:4096
ds_read_b64_tr_b16 v[102:103], v14 offset:4608
v_mfma_f32_16x16x32_bf16 v[80:83], v[224:227], v[216:219], v[80:83]
ds_read_b64_tr_b16 v[104:105], v15 offset:4096
ds_read_b64_tr_b16 v[106:107], v15 offset:4608
v_mfma_f32_16x16x32_bf16 v[64:67], v[224:227], v[212:215], v[64:67]
buffer_load_dwordx4 v[192:195], v39, s[32:35], s57 offen sc1
v_mfma_f32_16x16x32_bf16 v[68:71], v[228:231], v[212:215], v[68:71]
ds_read_b64_tr_b16 v[108:109], v16 offset:4096
ds_read_b64_tr_b16 v[110:111], v16 offset:4608
v_mfma_f32_16x16x32_bf16 v[84:87], v[228:231], v[216:219], v[84:87]
ds_read_b64_tr_b16 v[112:113], v17 offset:4096
ds_read_b64_tr_b16 v[114:115], v17 offset:4608
v_mfma_f32_16x16x32_bf16 v[88:91], v[232:235], v[216:219], v[88:91]
v_mfma_f32_16x16x32_bf16 v[72:75], v[232:235], v[212:215], v[72:75]
s_waitcnt vmcnt(8) lgkmcnt(8)
v_mfma_f32_16x16x32_bf16 v[60:63], v[236:239], v[156:159], v[60:63]
buffer_load_dwordx4 v[196:199], v38, s[32:35], s57 offen offset:1024 sc1
v_mfma_f32_16x16x32_bf16 v[76:79], v[236:239], v[160:163], v[76:79]
ds_read_b64_tr_b16 v[220:221], v14 offset:8192
ds_read_b64_tr_b16 v[222:223], v14 offset:8704
v_mfma_f32_16x16x32_bf16 v[80:83], v[240:243], v[160:163], v[80:83]
ds_read_b64_tr_b16 v[224:225], v15 offset:8192
ds_read_b64_tr_b16 v[226:227], v15 offset:8704
v_mfma_f32_16x16x32_bf16 v[64:67], v[240:243], v[156:159], v[64:67]
buffer_load_dwordx4 v[200:203], v39, s[32:35], s57 offen offset:1024 sc1
v_mfma_f32_16x16x32_bf16 v[68:71], v[244:247], v[156:159], v[68:71]
ds_read_b64_tr_b16 v[228:229], v16 offset:8192
ds_read_b64_tr_b16 v[230:231], v16 offset:8704
v_mfma_f32_16x16x32_bf16 v[84:87], v[244:247], v[160:163], v[84:87]
ds_read_b64_tr_b16 v[232:233], v17 offset:8192
ds_read_b64_tr_b16 v[234:235], v17 offset:8704
v_mfma_f32_16x16x32_bf16 v[88:91], v[248:251], v[160:163], v[88:91]
s_add_u32 s57, s57, 2048
s_and_b32 s57, s57, 0x7fff
v_mfma_f32_16x16x32_bf16 v[72:75], v[248:251], v[156:159], v[72:75]
s_waitcnt vmcnt(8) lgkmcnt(8)
v_mfma_f32_16x16x32_bf16 v[60:63], v[100:103], v[164:167], v[60:63]
buffer_load_dwordx4 v[204:207], v38, s[32:35], s57 offen sc1
v_mfma_f32_16x16x32_bf16 v[76:79], v[100:103], v[168:171], v[76:79]
ds_read_b64_tr_b16 v[236:237], v14 offset:12288
ds_read_b64_tr_b16 v[238:239], v14 offset:12800
v_mfma_f32_16x16x32_bf16 v[80:83], v[104:107], v[168:171], v[80:83]
ds_read_b64_tr_b16 v[240:241], v15 offset:12288
ds_read_b64_tr_b16 v[242:243], v15 offset:12800
v_mfma_f32_16x16x32_bf16 v[64:67], v[104:107], v[164:167], v[64:67]
buffer_load_dwordx4 v[208:211], v39, s[32:35], s57 offen sc1
v_mfma_f32_16x16x32_bf16 v[68:71], v[108:111], v[164:167], v[68:71]
ds_read_b64_tr_b16 v[244:245], v16 offset:12288
ds_read_b64_tr_b16 v[246:247], v16 offset:12800
v_mfma_f32_16x16x32_bf16 v[84:87], v[108:111], v[168:171], v[84:87]
ds_read_b64_tr_b16 v[248:249], v17 offset:12288
ds_read_b64_tr_b16 v[250:251], v17 offset:12800
v_mfma_f32_16x16x32_bf16 v[88:91], v[112:115], v[168:171], v[88:91]
v_mfma_f32_16x16x32_bf16 v[72:75], v[112:115], v[164:167], v[72:75]
s_waitcnt vmcnt(8) lgkmcnt(8)
v_mfma_f32_16x16x32_bf16 v[60:63], v[220:223], v[172:175], v[60:63]
buffer_load_dwordx4 v[212:215], v38, s[32:35], s57 offen offset:1024 sc1
v_mfma_f32_16x16x32_bf16 v[76:79], v[220:223], v[176:179], v[76:79]
ds_read_b64_tr_b16 v[100:101], v14 offset:16384
ds_read_b64_tr_b16 v[102:103], v14 offset:16896
v_mfma_f32_16x16x32_bf16 v[80:83], v[224:227], v[176:179], v[80:83]
ds_read_b64_tr_b16 v[104:105], v15 offset:16384
ds_read_b64_tr_b16 v[106:107], v15 offset:16896
v_mfma_f32_16x16x32_bf16 v[64:67], v[224:227], v[172:175], v[64:67]
buffer_load_dwordx4 v[216:219], v39, s[32:35], s57 offen offset:1024 sc1
v_mfma_f32_16x16x32_bf16 v[68:71], v[228:231], v[172:175], v[68:71]
ds_read_b64_tr_b16 v[108:109], v16 offset:16384
ds_read_b64_tr_b16 v[110:111], v16 offset:16896
v_mfma_f32_16x16x32_bf16 v[84:87], v[228:231], v[176:179], v[84:87]
ds_read_b64_tr_b16 v[112:113], v17 offset:16384
ds_read_b64_tr_b16 v[114:115], v17 offset:16896
v_mfma_f32_16x16x32_bf16 v[88:91], v[232:235], v[176:179], v[88:91]
s_add_u32 s57, s57, 2048
s_and_b32 s57, s57, 0x7fff
v_mfma_f32_16x16x32_bf16 v[72:75], v[232:235], v[172:175], v[72:75]
s_waitcnt vmcnt(8) lgkmcnt(8)
v_mfma_f32_16x16x32_bf16 v[60:63], v[236:239], v[180:183], v[60:63]
buffer_load_dwordx4 v[156:159], v38, s[32:35], s57 offen sc1
v_mfma_f32_16x16x32_bf16 v[76:79], v[236:239], v[184:187], v[76:79]
ds_read_b64_tr_b16 v[220:221], v14 offset:20480
ds_read_b64_tr_b16 v[222:223], v14 offset:20992
v_mfma_f32_16x16x32_bf16 v[80:83], v[240:243], v[184:187], v[80:83]
ds_read_b64_tr_b16 v[224:225], v15 offset:20480
ds_read_b64_tr_b16 v[226:227], v15 offset:20992
v_mfma_f32_16x16x32_bf16 v[64:67], v[240:243], v[180:183], v[64:67]
buffer_load_dwordx4 v[160:163], v39, s[32:35], s57 offen sc1
v_mfma_f32_16x16x32_bf16 v[68:71], v[244:247], v[180:183], v[68:71]
ds_read_b64_tr_b16 v[228:229], v16 offset:20480
ds_read_b64_tr_b16 v[230:231], v16 offset:20992
v_mfma_f32_16x16x32_bf16 v[84:87], v[244:247], v[184:187], v[84:87]
ds_read_b64_tr_b16 v[232:233], v17 offset:20480
ds_read_b64_tr_b16 v[234:235], v17 offset:20992
v_mfma_f32_16x16x32_bf16 v[88:91], v[248:251], v[184:187], v[88:91]
v_mfma_f32_16x16x32_bf16 v[72:75], v[248:251], v[180:183], v[72:75]
s_waitcnt vmcnt(8) lgkmcnt(8)
v_mfma_f32_16x16x32_bf16 v[60:63], v[100:103], v[188:191], v[60:63]
buffer_load_dwordx4 v[164:167], v38, s[32:35], s57 offen offset:1024 sc1
v_mfma_f32_16x16x32_bf16 v[76:79], v[100:103], v[192:195], v[76:79]
ds_read_b64_tr_b16 v[236:237], v14 offset:24576
ds_read_b64_tr_b16 v[238:239], v14 offset:25088
v_mfma_f32_16x16x32_bf16 v[80:83], v[104:107], v[192:195], v[80:83]
ds_read_b64_tr_b16 v[240:241], v15 offset:24576
ds_read_b64_tr_b16 v[242:243], v15 offset:25088
v_mfma_f32_16x16x32_bf16 v[64:67], v[104:107], v[188:191], v[64:67]
buffer_load_dwordx4 v[168:171], v39, s[32:35], s57 offen offset:1024 sc1
v_mfma_f32_16x16x32_bf16 v[68:71], v[108:111], v[188:191], v[68:71]
ds_read_b64_tr_b16 v[244:245], v16 offset:24576
ds_read_b64_tr_b16 v[246:247], v16 offset:25088
v_mfma_f32_16x16x32_bf16 v[84:87], v[108:111], v[192:195], v[84:87]
ds_read_b64_tr_b16 v[248:249], v17 offset:24576
ds_read_b64_tr_b16 v[250:251], v17 offset:25088
v_mfma_f32_16x16x32_bf16 v[88:91], v[112:115], v[192:195], v[88:91]
s_add_u32 s57, s57, 2048
s_and_b32 s57, s57, 0x7fff
v_mfma_f32_16x16x32_bf16 v[72:75], v[112:115], v[188:191], v[72:75]
s_waitcnt vmcnt(8) lgkmcnt(8)
v_mfma_f32_16x16x32_bf16 v[60:63], v[220:223], v[196:199], v[60:63]
buffer_load_dwordx4 v[172:175], v38, s[32:35], s57 offen sc1
v_mfma_f32_16x16x32_bf16 v[76:79], v[220:223], v[200:203], v[76:79]
ds_read_b64_tr_b16 v[100:101], v14 offset:28672
ds_read_b64_tr_b16 v[102:103], v14 offset:29184
v_mfma_f32_16x16x32_bf16 v[80:83], v[224:227], v[200:203], v[80:83]
ds_read_b64_tr_b16 v[104:105], v15 offset:28672
ds_read_b64_tr_b16 v[106:107], v15 offset:29184
v_mfma_f32_16x16x32_bf16 v[64:67], v[224:227], v[196:199], v[64:67]
buffer_load_dwordx4 v[176:179], v39, s[32:35], s57 offen sc1
v_mfma_f32_16x16x32_bf16 v[68:71], v[228:231], v[196:199], v[68:71]
ds_read_b64_tr_b16 v[108:109], v16 offset:28672
ds_read_b64_tr_b16 v[110:111], v16 offset:29184
v_mfma_f32_16x16x32_bf16 v[84:87], v[228:231], v[200:203], v[84:87]
ds_read_b64_tr_b16 v[112:113], v17 offset:28672
ds_read_b64_tr_b16 v[114:115], v17 offset:29184
v_mfma_f32_16x16x32_bf16 v[88:91], v[232:235], v[200:203], v[88:91]
v_mfma_f32_16x16x32_bf16 v[72:75], v[232:235], v[196:199], v[72:75]
s_waitcnt vmcnt(8) lgkmcnt(8)
v_mfma_f32_16x16x32_bf16 v[60:63], v[236:239], v[204:207], v[60:63]
buffer_load_dwordx4 v[180:183], v38, s[32:35], s57 offen offset:1024 sc1
v_mfma_f32_16x16x32_bf16 v[76:79], v[236:239], v[208:211], v[76:79]
ds_read_b64_tr_b16 v[220:221], v14 offset:32768
ds_read_b64_tr_b16 v[222:223], v14 offset:33280
v_mfma_f32_16x16x32_bf16 v[80:83], v[240:243], v[208:211], v[80:83]
ds_read_b64_tr_b16 v[224:225], v15 offset:32768
ds_read_b64_tr_b16 v[226:227], v15 offset:33280
v_mfma_f32_16x16x32_bf16 v[64:67], v[240:243], v[204:207], v[64:67]
buffer_load_dwordx4 v[184:187], v39, s[32:35], s57 offen offset:1024 sc1
v_mfma_f32_16x16x32_bf16 v[68:71], v[244:247], v[204:207], v[68:71]
ds_read_b64_tr_b16 v[228:229], v16 offset:32768
ds_read_b64_tr_b16 v[230:231], v16 offset:33280
v_mfma_f32_16x16x32_bf16 v[84:87], v[244:247], v[208:211], v[84:87]
ds_read_b64_tr_b16 v[232:233], v17 offset:32768
ds_read_b64_tr_b16 v[234:235], v17 offset:33280
v_mfma_f32_16x16x32_bf16 v[88:91], v[248:251], v[208:211], v[88:91]
s_add_u32 s57, s57, 2048
s_and_b32 s57, s57, 0x7fff
v_mfma_f32_16x16x32_bf16 v[72:75], v[248:251], v[204:207], v[72:75]
s_waitcnt vmcnt(8) lgkmcnt(8)
v_mfma_f32_16x16x32_bf16 v[60:63], v[100:103], v[212:215], v[60:63]
buffer_load_dwordx4 v[188:191], v38, s[32:35], s57 offen sc1
v_mfma_f32_16x16x32_bf16 v[76:79], v[100:103], v[216:219], v[76:79]
ds_read_b64_tr_b16 v[236:237], v14 offset:36864
ds_read_b64_tr_b16 v[238:239], v14 offset:37376
v_mfma_f32_16x16x32_bf16 v[80:83], v[104:107], v[216:219], v[80:83]
ds_read_b64_tr_b16 v[240:241], v15 offset:36864
ds_read_b64_tr_b16 v[242:243], v15 offset:37376
v_mfma_f32_16x16x32_bf16 v[64:67], v[104:107], v[212:215], v[64:67]
buffer_load_dwordx4 v[192:195], v39, s[32:35], s57 offen sc1
v_mfma_f32_16x16x32_bf16 v[68:71], v[108:111], v[212:215], v[68:71]
ds_read_b64_tr_b16 v[244:245], v16 offset:36864
ds_read_b64_tr_b16 v[246:247], v16 offset:37376
v_mfma_f32_16x16x32_bf16 v[84:87], v[108:111], v[216:219], v[84:87]
ds_read_b64_tr_b16 v[248:249], v17 offset:36864
ds_read_b64_tr_b16 v[250:251], v17 offset:37376
v_mfma_f32_16x16x32_bf16 v[88:91], v[112:115], v[216:219], v[88:91]
v_mfma_f32_16x16x32_bf16 v[72:75], v[112:115], v[212:215], v[72:75]
s_waitcnt vmcnt(8) lgkmcnt(8)
v_mfma_f32_16x16x32_bf16 v[60:63], v[220:223], v[156:159], v[60:63]
buffer_load_dwordx4 v[196:199], v38, s[32:35], s57 offen offset:1024 sc1
v_mfma_f32_16x16x32_bf16 v[76:79], v[220:223], v[160:163], v[76:79]
ds_read_b64_tr_b16 v[100:101], v14 offset:40960
ds_read_b64_tr_b16 v[102:103], v14 offset:41472
v_mfma_f32_16x16x32_bf16 v[80:83], v[224:227], v[160:163], v[80:83]
ds_read_b64_tr_b16 v[104:105], v15 offset:40960
ds_read_b64_tr_b16 v[106:107], v15 offset:41472
v_mfma_f32_16x16x32_bf16 v[64:67], v[224:227], v[156:159], v[64:67]
buffer_load_dwordx4 v[200:203], v39, s[32:35], s57 offen offset:1024 sc1
v_mfma_f32_16x16x32_bf16 v[68:71], v[228:231], v[156:159], v[68:71]
ds_read_b64_tr_b16 v[108:109], v16 offset:40960
ds_read_b64_tr_b16 v[110:111], v16 offset:41472
v_mfma_f32_16x16x32_bf16 v[84:87], v[228:231], v[160:163], v[84:87]
ds_read_b64_tr_b16 v[112:113], v17 offset:40960
ds_read_b64_tr_b16 v[114:115], v17 offset:41472
v_mfma_f32_16x16x32_bf16 v[88:91], v[232:235], v[160:163], v[88:91]
s_add_u32 s57, s57, 2048
s_and_b32 s57, s57, 0x7fff
v_mfma_f32_16x16x32_bf16 v[72:75], v[232:235], v[156:159], v[72:75]
s_waitcnt vmcnt(8) lgkmcnt(8)
v_mfma_f32_16x16x32_bf16 v[60:63], v[236:239], v[164:167], v[60:63]
buffer_load_dwordx4 v[204:207], v38, s[32:35], s57 offen sc1
v_mfma_f32_16x16x32_bf16 v[76:79], v[236:239], v[168:171], v[76:79]
ds_read_b64_tr_b16 v[220:221], v14 offset:45056
ds_read_b64_tr_b16 v[222:223], v14 offset:45568
v_mfma_f32_16x16x32_bf16 v[80:83], v[240:243], v[168:171], v[80:83]
ds_read_b64_tr_b16 v[224:225], v15 offset:45056
ds_read_b64_tr_b16 v[226:227], v15 offset:45568
v_mfma_f32_16x16x32_bf16 v[64:67], v[240:243], v[164:167], v[64:67]
buffer_load_dwordx4 v[208:211], v39, s[32:35], s57 offen sc1
v_mfma_f32_16x16x32_bf16 v[68:71], v[244:247], v[164:167], v[68:71]
ds_read_b64_tr_b16 v[228:229], v16 offset:45056
ds_read_b64_tr_b16 v[230:231], v16 offset:45568
v_mfma_f32_16x16x32_bf16 v[84:87], v[244:247], v[168:171], v[84:87]
ds_read_b64_tr_b16 v[232:233], v17 offset:45056
ds_read_b64_tr_b16 v[234:235], v17 offset:45568
v_mfma_f32_16x16x32_bf16 v[88:91], v[248:251], v[168:171], v[88:91]
v_mfma_f32_16x16x32_bf16 v[72:75], v[248:251], v[164:167], v[72:75]
s_waitcnt vmcnt(8) lgkmcnt(8)
v_mfma_f32_16x16x32_bf16 v[60:63], v[100:103], v[172:175], v[60:63]
buffer_load_dwordx4 v[212:215], v38, s[32:35], s57 offen offset:1024 sc1
v_mfma_f32_16x16x32_bf16 v[76:79], v[100:103], v[176:179], v[76:79]
ds_read_b64_tr_b16 v[236:237], v14 offset:49152
ds_read_b64_tr_b16 v[238:239], v14 offset:49664
v_mfma_f32_16x16x32_bf16 v[80:83], v[104:107], v[176:179], v[80:83]
ds_read_b64_tr_b16 v[240:241], v15 offset:49152
ds_read_b64_tr_b16 v[242:243], v15 offset:49664
v_mfma_f32_16x16x32_bf16 v[64:67], v[104:107], v[172:175], v[64:67]
buffer_load_dwordx4 v[216:219], v39, s[32:35], s57 offen offset:1024 sc1
v_mfma_f32_16x16x32_bf16 v[68:71], v[108:111], v[172:175], v[68:71]
ds_read_b64_tr_b16 v[244:245], v16 offset:49152
ds_read_b64_tr_b16 v[246:247], v16 offset:49664
v_mfma_f32_16x16x32_bf16 v[84:87], v[108:111], v[176:179], v[84:87]
ds_read_b64_tr_b16 v[248:249], v17 offset:49152
ds_read_b64_tr_b16 v[250:251], v17 offset:49664
v_mfma_f32_16x16x32_bf16 v[88:91], v[112:115], v[176:179], v[88:91]
v_mfma_f32_16x16x32_bf16 v[72:75], v[112:115], v[172:175], v[72:75]
s_waitcnt vmcnt(8) lgkmcnt(8)
v_mfma_f32_16x16x32_bf16 v[60:63], v[220:223], v[180:183], v[60:63]
v_mfma_f32_16x16x32_bf16 v[76:79], v[220:223], v[184:187], v[76:79]
ds_read_b64_tr_b16 v[100:101], v14 offset:53248
ds_read_b64_tr_b16 v[102:103], v14 offset:53760
v_mfma_f32_16x16x32_bf16 v[80:83], v[224:227], v[184:187], v[80:83]
ds_read_b64_tr_b16 v[104:105], v15 offset:53248
ds_read_b64_tr_b16 v[106:107], v15 offset:53760
v_mfma_f32_16x16x32_bf16 v[64:67], v[224:227], v[180:183], v[64:67]
v_mfma_f32_16x16x32_bf16 v[68:71], v[228:231], v[180:183], v[68:71]
ds_read_b64_tr_b16 v[108:109], v16 offset:53248
ds_read_b64_tr_b16 v[110:111], v16 offset:53760
v_mfma_f32_16x16x32_bf16 v[84:87], v[228:231], v[184:187], v[84:87]
ds_read_b64_tr_b16 v[112:113], v17 offset:53248
ds_read_b64_tr_b16 v[114:115], v17 offset:53760
v_mfma_f32_16x16x32_bf16 v[88:91], v[232:235], v[184:187], v[88:91]
v_mfma_f32_16x16x32_bf16 v[72:75], v[232:235], v[180:183], v[72:75]
s_waitcnt vmcnt(6) lgkmcnt(8)
v_mfma_f32_16x16x32_bf16 v[60:63], v[236:239], v[188:191], v[60:63]
v_mfma_f32_16x16x32_bf16 v[76:79], v[236:239], v[192:195], v[76:79]
ds_read_b64_tr_b16 v[220:221], v14 offset:57344
ds_read_b64_tr_b16 v[222:223], v14 offset:57856
v_mfma_f32_16x16x32_bf16 v[80:83], v[240:243], v[192:195], v[80:83]
ds_read_b64_tr_b16 v[224:225], v15 offset:57344
ds_read_b64_tr_b16 v[226:227], v15 offset:57856
v_mfma_f32_16x16x32_bf16 v[64:67], v[240:243], v[188:191], v[64:67]
v_mfma_f32_16x16x32_bf16 v[68:71], v[244:247], v[188:191], v[68:71]
ds_read_b64_tr_b16 v[228:229], v16 offset:57344
ds_read_b64_tr_b16 v[230:231], v16 offset:57856
v_mfma_f32_16x16x32_bf16 v[84:87], v[244:247], v[192:195], v[84:87]
ds_read_b64_tr_b16 v[232:233], v17 offset:57344
ds_read_b64_tr_b16 v[234:235], v17 offset:57856
v_mfma_f32_16x16x32_bf16 v[88:91], v[248:251], v[192:195], v[88:91]
v_mfma_f32_16x16x32_bf16 v[72:75], v[248:251], v[188:191], v[72:75]
s_waitcnt vmcnt(4) lgkmcnt(8)
v_mfma_f32_16x16x32_bf16 v[60:63], v[100:103], v[196:199], v[60:63]
v_mfma_f32_16x16x32_bf16 v[76:79], v[100:103], v[200:203], v[76:79]
ds_read_b64_tr_b16 v[236:237], v14 offset:61440
ds_read_b64_tr_b16 v[238:239], v14 offset:61952
v_mfma_f32_16x16x32_bf16 v[80:83], v[104:107], v[200:203], v[80:83]
ds_read_b64_tr_b16 v[240:241], v15 offset:61440
ds_read_b64_tr_b16 v[242:243], v15 offset:61952
v_mfma_f32_16x16x32_bf16 v[64:67], v[104:107], v[196:199], v[64:67]
v_mfma_f32_16x16x32_bf16 v[68:71], v[108:111], v[196:199], v[68:71]
ds_read_b64_tr_b16 v[244:245], v16 offset:61440
ds_read_b64_tr_b16 v[246:247], v16 offset:61952
v_mfma_f32_16x16x32_bf16 v[84:87], v[108:111], v[200:203], v[84:87]
ds_read_b64_tr_b16 v[248:249], v17 offset:61440
ds_read_b64_tr_b16 v[250:251], v17 offset:61952
v_mfma_f32_16x16x32_bf16 v[88:91], v[112:115], v[200:203], v[88:91]
v_mfma_f32_16x16x32_bf16 v[72:75], v[112:115], v[196:199], v[72:75]
s_waitcnt vmcnt(2) lgkmcnt(8)
v_mfma_f32_16x16x32_bf16 v[60:63], v[220:223], v[204:207], v[60:63]
v_mfma_f32_16x16x32_bf16 v[76:79], v[220:223], v[208:211], v[76:79]
v_mfma_f32_16x16x32_bf16 v[80:83], v[224:227], v[208:211], v[80:83]
v_mfma_f32_16x16x32_bf16 v[64:67], v[224:227], v[204:207], v[64:67]
v_mfma_f32_16x16x32_bf16 v[68:71], v[228:231], v[204:207], v[68:71]
v_mfma_f32_16x16x32_bf16 v[84:87], v[228:231], v[208:211], v[84:87]
v_mfma_f32_16x16x32_bf16 v[88:91], v[232:235], v[208:211], v[88:91]
v_mfma_f32_16x16x32_bf16 v[72:75], v[232:235], v[204:207], v[72:75]
s_waitcnt vmcnt(0) lgkmcnt(0)
v_mfma_f32_16x16x32_bf16 v[60:63], v[236:239], v[212:215], v[60:63]
v_mfma_f32_16x16x32_bf16 v[64:67], v[240:243], v[212:215], v[64:67]
v_mfma_f32_16x16x32_bf16 v[68:71], v[244:247], v[212:215], v[68:71]
v_mfma_f32_16x16x32_bf16 v[72:75], v[248:251], v[212:215], v[72:75]
v_mfma_f32_16x16x32_bf16 v[76:79], v[236:239], v[216:219], v[76:79]
v_mfma_f32_16x16x32_bf16 v[80:83], v[240:243], v[216:219], v[80:83]
v_mfma_f32_16x16x32_bf16 v[84:87], v[244:247], v[216:219], v[84:87]
v_mfma_f32_16x16x32_bf16 v[88:91], v[248:251], v[216:219], v[88:91]
s_setpc_b64 s[94:95]
R_oloop_end:
s_cmp_eq_u32 s46, 0
s_cbranch_scc1 slow_78
s_nop 0
v_cvt_pk_bf16_f32 v20, v60, v61
v_cvt_pk_bf16_f32 v21, v62, v63
v_cvt_pk_bf16_f32 v22, v64, v65
v_cvt_pk_bf16_f32 v23, v66, v67
buffer_store_dwordx4 v[20:23], v18, s[32:35], s85 offen offset:0 sc1
v_cvt_pk_bf16_f32 v24, v68, v69
v_cvt_pk_bf16_f32 v25, v70, v71
v_cvt_pk_bf16_f32 v26, v72, v73
v_cvt_pk_bf16_f32 v27, v74, v75
buffer_store_dwordx4 v[24:27], v18, s[32:35], s85 offen offset:1024 sc1
v_cvt_pk_bf16_f32 v28, v76, v77
v_cvt_pk_bf16_f32 v29, v78, v79
v_cvt_pk_bf16_f32 v30, v80, v81
v_cvt_pk_bf16_f32 v31, v82, v83
buffer_store_dwordx4 v[28:31], v18, s[32:35], s86 offen offset:0 sc1
v_cvt_pk_bf16_f32 v32, v84, v85
v_cvt_pk_bf16_f32 v33, v86, v87
v_cvt_pk_bf16_f32 v34, v88, v89
v_cvt_pk_bf16_f32 v35, v90, v91
buffer_store_dwordx4 v[32:35], v18, s[32:35], s86 offen offset:1024 sc1
s_barrier
v_dot2c_f32_bf16 v6, v20, v48
v_dot2c_f32_bf16 v8, v20, v20
v_dot2c_f32_bf16 v7, v28, v48
v_dot2c_f32_bf16 v9, v28, v28
v_dot2c_f32_bf16 v6, v21, v48
v_dot2c_f32_bf16 v8, v21, v21
v_dot2c_f32_bf16 v7, v29, v48
v_dot2c_f32_bf16 v9, v29, v29
v_dot2c_f32_bf16 v6, v22, v48
v_dot2c_f32_bf16 v8, v22, v22
v_dot2c_f32_bf16 v7, v30, v48
v_dot2c_f32_bf16 v9, v30, v30
v_dot2c_f32_bf16 v6, v23, v48
v_dot2c_f32_bf16 v8, v23, v23
v_dot2c_f32_bf16 v7, v31, v48
v_dot2c_f32_bf16 v9, v31, v31
v_dot2c_f32_bf16 v6, v24, v48
v_dot2c_f32_bf16 v8, v24, v24
v_dot2c_f32_bf16 v7, v32, v48
v_dot2c_f32_bf16 v9, v32, v32
v_dot2c_f32_bf16 v6, v25, v48
v_dot2c_f32_bf16 v8, v25, v25
v_dot2c_f32_bf16 v7, v33, v48
v_dot2c_f32_bf16 v9, v33, v33
v_dot2c_f32_bf16 v6, v26, v48
v_dot2c_f32_bf16 v8, v26, v26
v_dot2c_f32_bf16 v7, v34, v48
v_dot2c_f32_bf16 v9, v34, v34
v_dot2c_f32_bf16 v6, v27, v48
v_dot2c_f32_bf16 v8, v27, v27
v_dot2c_f32_bf16 v7, v35, v48
v_dot2c_f32_bf16 v9, v35, v35
s_mov_b64 exec, 1
s_waitcnt vmcnt(0)
buffer_store_dword v5, v4, s[32:35], s88 offen
s_mov_b64 exec, -1
s_nop 1
v_permlane32_swap_b32 v6, v7
v_permlane32_swap_b32 v8, v9
v_add_f32 v6, v6, v7
v_add_f32 v8, v8, v9
s_nop 1
v_permlane16_swap_b32 v6, v8
s_nop 0
v_add_f32 v6, v6, v8
buffer_store_dword v6, v1, s[32:35], s87 offen
back_79:
s_lshl_b32 s49, s44, 13
v_add_u32 v10, s49, v18
v_add_u32 v11, 1024, v10
s_lshl_b32 s48, s43, 1
v_lshrrev_b32 v4, 2, v2
v_and_b32 v5, 3, v0
v_lshl_add_u32 v6, v3, 3, v4
v_lshlrev_b32 v6, 7, v6
v_lshl_add_u32 v6, v5, 3, v6
v_lshrrev_b32 v7, 1, v4
v_and_b32 v8, 1, v3
v_lshl_add_u32 v7, v8, 1, v7
v_xor_b32 v7, s48, v7
v_lshl_add_u32 v12, v7, 5, v6
v_add_u32 v12, 16384, v12
v_xor_b32 v13, 32, v12
v_mov_b32 v14, v10
v_mov_b32 v15, v11
v_add_u32 v16, 122880, v12
v_add_u32 v17, 122880, v13
v_mov_b32 v156, 0
v_mov_b32 v157, 0
v_mov_b32 v158, 0
v_mov_b32 v159, 0
v_mov_b32 v160, 0
v_mov_b32 v161, 0
v_mov_b32 v162, 0
v_mov_b32 v163, 0
v_mov_b32 v164, 0
v_mov_b32 v165, 0
v_mov_b32 v166, 0
v_mov_b32 v167, 0
v_mov_b32 v168, 0
v_mov_b32 v169, 0
v_mov_b32 v170, 0
v_mov_b32 v171, 0
v_mov_b32 v172, 0
v_mov_b32 v173, 0
v_mov_b32 v174, 0
v_mov_b32 v175, 0
v_mov_b32 v176, 0
v_mov_b32 v177, 0
v_mov_b32 v178, 0
v_mov_b32 v179, 0
v_mov_b32 v180, 0
v_mov_b32 v181, 0
v_mov_b32 v182, 0
v_mov_b32 v183, 0
v_mov_b32 v184, 0
v_mov_b32 v185, 0
v_mov_b32 v186, 0
v_mov_b32 v187, 0
v_mov_b32 v188, 0
v_mov_b32 v189, 0
v_mov_b32 v190, 0
v_mov_b32 v191, 0
v_mov_b32 v192, 0
v_mov_b32 v193, 0
v_mov_b32 v194, 0
v_mov_b32 v195, 0
v_mov_b32 v196, 0
v_mov_b32 v197, 0
v_mov_b32 v198, 0
v_mov_b32 v199, 0
v_mov_b32 v200, 0
v_mov_b32 v201, 0
v_mov_b32 v202, 0
v_mov_b32 v203, 0
v_mov_b32 v204, 0
v_mov_b32 v205, 0
v_mov_b32 v206, 0
v_mov_b32 v207, 0
v_mov_b32 v208, 0
v_mov_b32 v209, 0
v_mov_b32 v210, 0
v_mov_b32 v211, 0
v_mov_b32 v212, 0
v_mov_b32 v213, 0
v_mov_b32 v214, 0
v_mov_b32 v215, 0
v_mov_b32 v216, 0
v_mov_b32 v217, 0
v_mov_b32 v218, 0
v_mov_b32 v219, 0
v_mov_b32 v220, 0
v_mov_b32 v221, 0
v_mov_b32 v222, 0
v_mov_b32 v223, 0
v_mov_b32 v224, 0
v_mov_b32 v225, 0
v_mov_b32 v226, 0
v_mov_b32 v227, 0
v_mov_b32 v228, 0
v_mov_b32 v229, 0
v_mov_b32 v230, 0
v_mov_b32 v231, 0
v_mov_b32 v232, 0
v_mov_b32 v233, 0
v_mov_b32 v234, 0
v_mov_b32 v235, 0
v_mov_b32 v236, 0
v_mov_b32 v237, 0
v_mov_b32 v238, 0
v_mov_b32 v239, 0
v_mov_b32 v240, 0
v_mov_b32 v241, 0
v_mov_b32 v242, 0
v_mov_b32 v243, 0
v_mov_b32 v244, 0
v_mov_b32 v245, 0
v_mov_b32 v246, 0
v_mov_b32 v247, 0
v_mov_b32 v248, 0
v_mov_b32 v249, 0
v_mov_b32 v250, 0
v_mov_b32 v251, 0
v_lshrrev_b32 v6, 2, v2
v_cmp_eq_u32 vcc, v6, v3
v_and_b32 v7, 1, v0
v_lshlrev_b32 v7, 4, v7
v_mov_b32 v8, 0x3f80
v_lshlrev_b32 v9, v7, v8
v_cndmask_b32 v7, 0, v9, vcc
v_and_b32 v6, 2, v0
v_cmp_eq_u32 vcc, 0, v6
v_mov_b32 v36, 0
v_mov_b32 v37, 0
v_mov_b32 v40, 0
v_mov_b32 v41, 0
v_cndmask_b32 v38, 0, v7, vcc
v_cndmask_b32 v39, v7, 0, vcc
v_lshrrev_b32 v8, 1, v2
v_cmp_eq_u32 vcc, 0, v8
s_nop 1
v_cndmask_b32 v44, 0, v9, vcc
v_cmp_eq_u32 vcc, 1, v8
s_nop 1
v_cndmask_b32 v45, 0, v9, vcc
v_cmp_eq_u32 vcc, 2, v8
s_nop 1
v_cndmask_b32 v46, 0, v9, vcc
v_cmp_eq_u32 vcc, 3, v8
s_nop 1
v_cndmask_b32 v47, 0, v9, vcc
v_lshrrev_b32 v4, 2, v2
v_lshl_add_u32 v4, v3, 2, v4
v_lshlrev_b32 v4, 6, v4
v_and_b32 v5, 3, v0
v_lshl_add_u32 v4, v5, 3, v4
s_lshl_b32 s48, s43, 11
s_add_u32 s48, s48, 135168
v_add_u32 v53, s48, v4
s_mul_i32 s48, s40, 3072
s_add_u32 s48, s48, 139264
v_add_u32 v42, s48, v18
s_xor_b32 s49, s40, 2
s_mul_i32 s48, s49, 3072
s_add_u32 s48, s48, 139264
v_add_u32 v43, s48, v18
s_lshl_b32 s49, s49, 2
s_add_u32 s49, s49, 134672
v_mov_b32 v19, s49
v_xor_b32 v52, 8, v19
v_lshrrev_b32 v4, 3, v0
v_and_b32 v5, 7, v0
v_lshlrev_b32 v4, 11, v4
v_lshl_add_u32 v55, v5, 4, v4
v_lshlrev_b32 v4, 6, v2
v_lshl_add_u32 v58, v3, 4, v4
v_lshlrev_b32 v4, 4, v2
v_lshl_add_u32 v59, v3, 3, v4
s_mul_i32 s51, s42, 163840
s_add_u32 s51, s51, 9437184
s_lshl_b32 s50, s43, 1
s_add_u32 s50, s50, s44
s_lshl_b32 s48, s50, 15
s_add_u32 s48, s48, s51
s_add_u32 s48, s48, 0
s_lshl_b32 s49, s41, 7
s_add_u32 s53, s48, s49
s_add_u32 s54, s53, 16384
s_lshl_b32 s56, s50, 10
s_add_u32 s56, s56, s51
s_add_u32 s56, s56, 147456
s_xor_b32 s57, s56, 1024
s_lshl_b32 s58, s50, 11
s_add_u32 s58, s58, s51
s_add_u32 s58, s58, 131072
s_xor_b32 s59, s58, 2048
s_add_u32 s79, s58, s49
s_lshl_b32 s50, s41, 11
s_add_u32 s55, s48, s50
s_lshl_b32 s48, s43, 7
s_add_u32 s48, s48, 133888
v_lshl_add_u32 v7, v3, 4, s48
v_lshl_add_u32 v54, v2, 2, s48
s_lshl_b32 s49, s44, 6
v_add_u32 v8, s49, v2
v_lshlrev_b32 v8, 3, v8
v_add_u32 v8, 131072, v8
v_lshl_add_u32 v9, v3, 2, s49
v_lshlrev_b32 v9, 2, v9
v_add_u32 v9, 132096, v9
s_mov_b32 s64, 0
s_mov_b32 s65, 0
s_mov_b32 s66, 0x3fb8aa3b
s_mov_b32 s61, 2
s_lshr_b32 s49, s42, 3
s_xor_b32 s77, s74, s49
s_add_u32 s77, s77, 4
s_lshl_b32 s50, s42, 2
s_add_u32 s50, s50, s40
s_lshl_b32 s50, s50, 4
s_add_u32 s50, s50, s41
s_lshl_b32 s50, s50, 8
s_add_u32 s52, s50, 18087936
ds_read_b64_tr_b16 v[84:85], v16 offset:8192
ds_read_b64_tr_b16 v[86:87], v16 offset:8704
ds_read_b64_tr_b16 v[88:89], v17 offset:8192
ds_read_b64_tr_b16 v[90:91], v17 offset:8704
ds_read_b64_tr_b16 v[92:93], v16 offset:16384
ds_read_b64_tr_b16 v[94:95], v16 offset:16896
ds_read_b64_tr_b16 v[96:97], v17 offset:16384
ds_read_b64_tr_b16 v[98:99], v17 offset:16896
ds_read_b64_tr_b16 v[76:77], v16 offset:0
ds_read_b64_tr_b16 v[78:79], v16 offset:512
ds_read_b64_tr_b16 v[80:81], v17 offset:0
ds_read_b64_tr_b16 v[82:83], v17 offset:512
s_barrier
ds_read_b128 v[60:63], v14 offset:0
ds_read_b128 v[64:67], v14 offset:2048
ds_read_b128 v[68:71], v14 offset:4096
ds_read_b128 v[72:75], v14 offset:6144
s_waitcnt lgkmcnt(0)
c1_loop:
v_mfma_f32_16x16x32_bf16 v[212:215], v[84:87], v[72:75], v[212:215]
ds_read_b128 v[100:103], v15 offset:0
v_mfma_f32_16x16x32_bf16 v[204:207], v[84:87], v[68:71], v[204:207]
ds_read_b128 v[104:107], v15 offset:2048
v_mfma_f32_16x16x32_bf16 v[196:199], v[84:87], v[64:67], v[196:199]
ds_read_b128 v[108:111], v15 offset:4096
v_mfma_f32_16x16x32_bf16 v[188:191], v[84:87], v[60:63], v[188:191]
ds_read_b128 v[112:115], v15 offset:6144
v_mfma_f32_16x16x32_bf16 v[192:195], v[88:91], v[60:63], v[192:195]
ds_read_b64_tr_b16 v[124:125], v16 offset:12288
v_mfma_f32_16x16x32_bf16 v[200:203], v[88:91], v[64:67], v[200:203]
ds_read_b64_tr_b16 v[126:127], v16 offset:12800
v_mfma_f32_16x16x32_bf16 v[208:211], v[88:91], v[68:71], v[208:211]
ds_read_b64_tr_b16 v[128:129], v17 offset:12288
v_mfma_f32_16x16x32_bf16 v[216:219], v[88:91], v[72:75], v[216:219]
ds_read_b64_tr_b16 v[130:131], v17 offset:12800
v_mfma_f32_16x16x32_bf16 v[244:247], v[72:75], v[92:95], v[244:247]
ds_read_b64_tr_b16 v[132:133], v16 offset:20480
v_mfma_f32_16x16x32_bf16 v[248:251], v[72:75], v[96:99], v[248:251]
ds_read_b64_tr_b16 v[134:135], v16 offset:20992
v_mfma_f32_16x16x32_bf16 v[240:243], v[68:71], v[96:99], v[240:243]
ds_read_b64_tr_b16 v[136:137], v17 offset:20480
v_mfma_f32_16x16x32_bf16 v[236:239], v[68:71], v[92:95], v[236:239]
ds_read_b64_tr_b16 v[138:139], v17 offset:20992
v_mfma_f32_16x16x32_bf16 v[228:231], v[64:67], v[92:95], v[228:231]
ds_read_b64_tr_b16 v[116:117], v16 offset:4096
v_mfma_f32_16x16x32_bf16 v[232:235], v[64:67], v[96:99], v[232:235]
ds_read_b64_tr_b16 v[118:119], v16 offset:4608
v_mfma_f32_16x16x32_bf16 v[224:227], v[60:63], v[96:99], v[224:227]
ds_read_b64_tr_b16 v[120:121], v17 offset:4096
v_mfma_f32_16x16x32_bf16 v[220:223], v[60:63], v[92:95], v[220:223]
ds_read_b64_tr_b16 v[122:123], v17 offset:4608
v_mfma_f32_16x16x32_bf16 v[156:159], v[76:79], v[60:63], v[156:159]
s_cmp_eq_u32 s77, s64
s_cbranch_scc1 c1_hook
c1_hook_ret:
v_mfma_f32_16x16x32_bf16 v[164:167], v[76:79], v[64:67], v[164:167]
s_add_u32 s65, s65, 40960
s_cmp_eq_u32 s65, 122880
v_mfma_f32_16x16x32_bf16 v[172:175], v[76:79], v[68:71], v[172:175]
s_cselect_b32 s65, 0, s65
s_add_u32 s64, s64, 1
v_mfma_f32_16x16x32_bf16 v[180:183], v[76:79], v[72:75], v[180:183]
v_add_u32 v14, s65, v10
v_add_u32 v15, s65, v11
v_mfma_f32_16x16x32_bf16 v[184:187], v[80:83], v[72:75], v[184:187]
v_add_u32 v16, s65, v12
v_add_u32 v17, s65, v13
v_mfma_f32_16x16x32_bf16 v[176:179], v[80:83], v[68:71], v[176:179]
s_cmp_eq_u32 s64, 16
s_cbranch_scc1 c1_last
v_mfma_f32_16x16x32_bf16 v[168:171], v[80:83], v[64:67], v[168:171]
s_waitcnt lgkmcnt(0)
v_mfma_f32_16x16x32_bf16 v[160:163], v[80:83], v[60:63], v[160:163]
s_barrier
v_mfma_f32_16x16x32_bf16 v[212:215], v[124:127], v[112:115], v[212:215]
ds_read_b128 v[60:63], v14 offset:0
v_mfma_f32_16x16x32_bf16 v[204:207], v[124:127], v[108:111], v[204:207]
ds_read_b128 v[64:67], v14 offset:2048
v_mfma_f32_16x16x32_bf16 v[196:199], v[124:127], v[104:107], v[196:199]
ds_read_b128 v[68:71], v14 offset:4096
v_mfma_f32_16x16x32_bf16 v[188:191], v[124:127], v[100:103], v[188:191]
ds_read_b128 v[72:75], v14 offset:6144
v_mfma_f32_16x16x32_bf16 v[192:195], v[128:131], v[100:103], v[192:195]
ds_read_b64_tr_b16 v[84:85], v16 offset:8192
v_mfma_f32_16x16x32_bf16 v[200:203], v[128:131], v[104:107], v[200:203]
ds_read_b64_tr_b16 v[86:87], v16 offset:8704
v_mfma_f32_16x16x32_bf16 v[208:211], v[128:131], v[108:111], v[208:211]
ds_read_b64_tr_b16 v[88:89], v17 offset:8192
v_mfma_f32_16x16x32_bf16 v[216:219], v[128:131], v[112:115], v[216:219]
ds_read_b64_tr_b16 v[90:91], v17 offset:8704
v_mfma_f32_16x16x32_bf16 v[244:247], v[112:115], v[132:135], v[244:247]
ds_read_b64_tr_b16 v[92:93], v16 offset:16384
v_mfma_f32_16x16x32_bf16 v[248:251], v[112:115], v[136:139], v[248:251]
ds_read_b64_tr_b16 v[94:95], v16 offset:16896
v_mfma_f32_16x16x32_bf16 v[240:243], v[108:111], v[136:139], v[240:243]
ds_read_b64_tr_b16 v[96:97], v17 offset:16384
v_mfma_f32_16x16x32_bf16 v[236:239], v[108:111], v[132:135], v[236:239]
ds_read_b64_tr_b16 v[98:99], v17 offset:16896
v_mfma_f32_16x16x32_bf16 v[228:231], v[104:107], v[132:135], v[228:231]
ds_read_b64_tr_b16 v[76:77], v16 offset:0
v_mfma_f32_16x16x32_bf16 v[232:235], v[104:107], v[136:139], v[232:235]
ds_read_b64_tr_b16 v[78:79], v16 offset:512
v_mfma_f32_16x16x32_bf16 v[224:227], v[100:103], v[136:139], v[224:227]
ds_read_b64_tr_b16 v[80:81], v17 offset:0
v_mfma_f32_16x16x32_bf16 v[220:223], v[100:103], v[132:135], v[220:223]
ds_read_b64_tr_b16 v[82:83], v17 offset:512
v_mfma_f32_16x16x32_bf16 v[156:159], v[116:119], v[100:103], v[156:159]
v_mfma_f32_16x16x32_bf16 v[164:167], v[116:119], v[104:107], v[164:167]
v_mfma_f32_16x16x32_bf16 v[172:175], v[116:119], v[108:111], v[172:175]
v_mfma_f32_16x16x32_bf16 v[180:183], v[116:119], v[112:115], v[180:183]
v_mfma_f32_16x16x32_bf16 v[184:187], v[120:123], v[112:115], v[184:187]
v_mfma_f32_16x16x32_bf16 v[176:179], v[120:123], v[108:111], v[176:179]
v_mfma_f32_16x16x32_bf16 v[168:171], v[120:123], v[104:107], v[168:171]
s_waitcnt lgkmcnt(0)
v_mfma_f32_16x16x32_bf16 v[160:163], v[120:123], v[100:103], v[160:163]
s_branch c1_loop
c1_hook:
s_waitcnt lgkmcnt(0)
s_cmp_lg_u32 s44, 0
s_cbranch_scc1 else_80
v_mfma_f32_16x16x32_bf16 v[140:143], v[48:51], v[76:79], 0
v_mfma_f32_16x16x32_bf16 v[144:147], v[48:51], v[84:87], 0
v_mfma_f32_16x16x32_bf16 v[148:151], v[48:51], v[92:95], 0
v_mfma_f32_16x16x32_bf16 v[140:143], v[48:51], v[116:119], v[140:143]
v_mfma_f32_16x16x32_bf16 v[144:147], v[48:51], v[124:127], v[144:147]
v_mfma_f32_16x16x32_bf16 v[148:151], v[48:51], v[132:135], v[148:151]
s_branch fi_81
else_80:
v_mfma_f32_16x16x32_bf16 v[140:143], v[48:51], v[80:83], 0
v_mfma_f32_16x16x32_bf16 v[144:147], v[48:51], v[88:91], 0
v_mfma_f32_16x16x32_bf16 v[148:151], v[48:51], v[96:99], 0
v_mfma_f32_16x16x32_bf16 v[140:143], v[48:51], v[120:123], v[140:143]
v_mfma_f32_16x16x32_bf16 v[144:147], v[48:51], v[128:131], v[144:147]
v_mfma_f32_16x16x32_bf16 v[148:151], v[48:51], v[136:139], v[148:151]
fi_81:
s_nop 4
v_cmp_eq_u32 vcc, 0, v3
v_cmp_eq_u32 s[48:49], 1, v3
s_nop 1
v_cndmask_b32 v4, v148, v144, s[48:49]
v_cndmask_b32 v4, v4, v140, vcc
buffer_store_dword v4, v1, s[32:35], s52 offen sc1
s_branch c1_hook_ret
c1_last:
v_mfma_f32_16x16x32_bf16 v[168:171], v[80:83], v[64:67], v[168:171]
s_waitcnt lgkmcnt(0)
v_mfma_f32_16x16x32_bf16 v[160:163], v[80:83], v[60:63], v[160:163]
v_mfma_f32_16x16x32_bf16 v[212:215], v[124:127], v[112:115], v[212:215]
ds_read_b64_tr_b16 v[10:11], v53 offset:0
ds_read_b64_tr_b16 v[12:13], v53 offset:1024
v_mfma_f32_16x16x32_bf16 v[204:207], v[124:127], v[108:111], v[204:207]
ds_read_b64_tr_b16 v[14:15], v53 offset:32
ds_read_b64_tr_b16 v[16:17], v53 offset:1056
v_mfma_f32_16x16x32_bf16 v[196:199], v[124:127], v[104:107], v[196:199]

s_mul_i32 s48, s44, 0x80008000
v_mfma_f32_16x16x32_bf16 v[188:191], v[124:127], v[100:103], v[188:191]

v_mfma_f32_16x16x32_bf16 v[192:195], v[128:131], v[100:103], v[192:195]

v_mfma_f32_16x16x32_bf16 v[200:203], v[128:131], v[104:107], v[200:203]

v_mfma_f32_16x16x32_bf16 v[208:211], v[128:131], v[108:111], v[208:211]

s_waitcnt lgkmcnt(0)
v_mfma_f32_16x16x32_bf16 v[216:219], v[128:131], v[112:115], v[216:219]
s_barrier
v_mfma_f32_16x16x32_bf16 v[244:247], v[112:115], v[132:135], v[244:247]
ds_read_b128 v[140:143], v7 offset:0
ds_read_b128 v[144:147], v7 offset:64
v_mfma_f32_16x16x32_bf16 v[248:251], v[112:115], v[136:139], v[248:251]
ds_read_b128 v[148:151], v7 offset:256
ds_read_b128 v[152:155], v7 offset:320
v_mfma_f32_16x16x32_bf16 v[240:243], v[108:111], v[136:139], v[240:243]
ds_read_b64 v[92:93], v8 offset:0
ds_read_b64 v[94:95], v8 offset:128
v_mfma_f32_16x16x32_bf16 v[236:239], v[108:111], v[132:135], v[236:239]
ds_read_b64 v[96:97], v8 offset:256
ds_read_b64 v[98:99], v8 offset:384
v_mfma_f32_16x16x32_bf16 v[228:231], v[104:107], v[132:135], v[228:231]
ds_read2_b32 v[56:57], v54 offset0:128 offset1:144
v_xor_b32 v10, s48, v10
v_mfma_f32_16x16x32_bf16 v[232:235], v[104:107], v[136:139], v[232:235]
ds_read_b128 v[60:63], v9 offset:0
v_xor_b32 v11, s48, v11
v_mfma_f32_16x16x32_bf16 v[224:227], v[100:103], v[136:139], v[224:227]
ds_read_b128 v[64:67], v9 offset:64
v_xor_b32 v12, s48, v12
v_mfma_f32_16x16x32_bf16 v[220:223], v[100:103], v[132:135], v[220:223]
ds_read_b128 v[68:71], v9 offset:128
v_xor_b32 v13, s48, v13
v_mfma_f32_16x16x32_bf16 v[156:159], v[116:119], v[100:103], v[156:159]
ds_read_b128 v[72:75], v9 offset:192
v_xor_b32 v14, s48, v14
v_mfma_f32_16x16x32_bf16 v[164:167], v[116:119], v[104:107], v[164:167]
ds_read_b128 v[76:79], v9 offset:512
v_xor_b32 v15, s48, v15
v_mfma_f32_16x16x32_bf16 v[172:175], v[116:119], v[108:111], v[172:175]
ds_read_b128 v[80:83], v9 offset:576
v_xor_b32 v16, s48, v16
v_mfma_f32_16x16x32_bf16 v[180:183], v[116:119], v[112:115], v[180:183]
ds_read_b128 v[84:87], v9 offset:640
v_xor_b32 v17, s48, v17
v_mfma_f32_16x16x32_bf16 v[184:187], v[120:123], v[112:115], v[184:187]
ds_read_b128 v[88:91], v9 offset:704
v_mfma_f32_16x16x32_bf16 v[176:179], v[120:123], v[108:111], v[176:179]
v_mfma_f32_16x16x32_bf16 v[168:171], v[120:123], v[104:107], v[168:171]
v_mfma_f32_16x16x32_bf16 v[160:163], v[120:123], v[100:103], v[160:163]
c1_epi:
s_waitcnt lgkmcnt(0)
.p2align 3
v_mul_f32 v129, s66, v94
v_mul_f32 v128, s66, v92
v_mul_f32 v131, s66, v98
v_mul_f32 v130, s66, v96
v_pk_fma_f32 v[190:191], v[150:151], v[92:93], v[190:191] op_sel:[0,1,0] op_sel_hi:[1,1,1]
v_pk_fma_f32 v[212:213], v[148:149], v[98:99], v[212:213] op_sel:[0,1,0] op_sel_hi:[1,1,1]
v_pk_fma_f32 v[214:215], v[150:151], v[98:99], v[214:215] op_sel:[0,1,0] op_sel_hi:[1,1,1]
v_pk_fma_f32 v[188:189], v[148:149], v[92:93], v[188:189] op_sel:[0,1,0] op_sel_hi:[1,1,1]
v_pk_fma_f32 v[218:219], v[154:155], v[98:99], v[218:219] op_sel:[0,1,0] op_sel_hi:[1,1,1]
v_cvt_pk_bf16_f32 v188, v188, v189
v_cvt_pk_bf16_f32 v189, v190, v191
v_pk_fma_f32 v[196:197], v[148:149], v[94:95], v[196:197] op_sel:[0,1,0] op_sel_hi:[1,1,1]
v_pk_fma_f32 v[200:201], v[152:153], v[94:95], v[200:201] op_sel:[0,1,0] op_sel_hi:[1,1,1]
v_pk_fma_f32 v[210:211], v[154:155], v[96:97], v[210:211] op_sel:[0,1,0] op_sel_hi:[1,1,1]
v_pk_fma_f32 v[240:241], v[84:85], v[56:57], v[240:241] op_sel:[0,1,0] op_sel_hi:[1,1,1]
v_pk_fma_f32 v[228:229], v[80:81], v[56:57], v[228:229] op_sel:[0,0,0] op_sel_hi:[1,0,1]
v_pk_fma_f32 v[226:227], v[78:79], v[56:57], v[226:227] op_sel:[0,1,0] op_sel_hi:[1,1,1]
v_pk_fma_f32 v[192:193], v[152:153], v[92:93], v[192:193] op_sel:[0,1,0] op_sel_hi:[1,1,1]
v_cvt_pk_bf16_f32 v190, v192, v193
v_pk_fma_f32 v[238:239], v[86:87], v[56:57], v[238:239] op_sel:[0,0,0] op_sel_hi:[1,0,1]
v_pk_fma_f32 v[234:235], v[82:83], v[56:57], v[234:235] op_sel:[0,1,0] op_sel_hi:[1,1,1]
v_pk_mul_f32 v[226:227], v[226:227], v[62:63]
v_pk_fma_f32 v[204:205], v[148:149], v[96:97], v[204:205] op_sel:[0,1,0] op_sel_hi:[1,1,1]
v_cvt_pk_bf16_f32 v204, v204, v205
v_pk_fma_f32 v[202:203], v[154:155], v[94:95], v[202:203] op_sel:[0,1,0] op_sel_hi:[1,1,1]
v_pk_fma_f32 v[224:225], v[76:77], v[56:57], v[224:225] op_sel:[0,1,0] op_sel_hi:[1,1,1]
v_pk_fma_f32 v[216:217], v[152:153], v[98:99], v[216:217] op_sel:[0,1,0] op_sel_hi:[1,1,1]
v_pk_fma_f32 v[244:245], v[88:89], v[56:57], v[244:245] op_sel:[0,0,0] op_sel_hi:[1,0,1]
v_pk_mul_f32 v[238:239], v[238:239], v[70:71]
v_pk_mul_f32 v[228:229], v[228:229], v[64:65]
v_pk_fma_f32 v[236:237], v[84:85], v[56:57], v[236:237] op_sel:[0,0,0] op_sel_hi:[1,0,1]
v_pk_fma_f32 v[220:221], v[76:77], v[56:57], v[220:221] op_sel:[0,0,0] op_sel_hi:[1,0,1]
v_pk_mul_f32 v[224:225], v[224:225], v[60:61]
v_cvt_pk_bf16_f32 v212, v212, v213
v_cvt_pk_bf16_f32 v213, v214, v215
v_cvt_pk_bf16_f32 v196, v196, v197
v_pk_mul_f32 v[240:241], v[240:241], v[68:69]
v_pk_fma_f32 v[198:199], v[150:151], v[94:95], v[198:199] op_sel:[0,1,0] op_sel_hi:[1,1,1]
v_cvt_pk_bf16_f32 v197, v198, v199
v_cvt_pk_bf16_f32 v198, v200, v201
v_cvt_pk_bf16_f32 v199, v202, v203
v_cvt_pk_bf16_f32 v215, v218, v219
v_pk_fma_f32 v[208:209], v[152:153], v[96:97], v[208:209] op_sel:[0,1,0] op_sel_hi:[1,1,1]
v_pk_fma_f32 v[246:247], v[90:91], v[56:57], v[246:247] op_sel:[0,0,0] op_sel_hi:[1,0,1]
v_pk_fma_f32 v[250:251], v[90:91], v[56:57], v[250:251] op_sel:[0,1,0] op_sel_hi:[1,1,1]
v_pk_mul_f32 v[250:251], v[250:251], v[74:75]
v_pk_fma_f32 v[206:207], v[150:151], v[96:97], v[206:207] op_sel:[0,1,0] op_sel_hi:[1,1,1]
v_cvt_pk_bf16_f32 v205, v206, v207
v_pk_fma_f32 v[242:243], v[86:87], v[56:57], v[242:243] op_sel:[0,1,0] op_sel_hi:[1,1,1]
v_cvt_pk_bf16_f32 v207, v210, v211
v_pk_mul_f32 v[236:237], v[236:237], v[68:69]
v_pk_fma_f32 v[230:231], v[82:83], v[56:57], v[230:231] op_sel:[0,0,0] op_sel_hi:[1,0,1]
v_pk_fma_f32 v[194:195], v[154:155], v[92:93], v[194:195] op_sel:[0,1,0] op_sel_hi:[1,1,1]
v_cvt_pk_bf16_f32 v191, v194, v195
v_pk_fma_f32 v[232:233], v[80:81], v[56:57], v[232:233] op_sel:[0,1,0] op_sel_hi:[1,1,1]
v_pk_mul_f32 v[232:233], v[232:233], v[64:65]
v_pk_mul_f32 v[230:231], v[230:231], v[66:67]
v_pk_fma_f32 v[248:249], v[88:89], v[56:57], v[248:249] op_sel:[0,1,0] op_sel_hi:[1,1,1]
v_pk_mul_f32 v[248:249], v[248:249], v[72:73]
v_pk_mul_f32 v[242:243], v[242:243], v[70:71]
v_mfma_f32_16x16x32_bf16 v[68:71], v[10:13], v[196:199], 0
v_cvt_pk_bf16_f32 v206, v208, v209
v_cvt_pk_bf16_f32 v214, v216, v217
v_cvt_pk_bf16_f32 v121, v226, v227
v_mfma_f32_16x16x32_bf16 v[80:83], v[14:17], v[204:207], 0
v_cvt_pk_bf16_f32 v120, v224, v225
v_cvt_pk_bf16_f32 v114, v228, v229
v_mfma_f32_16x16x32_bf16 v[84:87], v[10:13], v[212:215], 0
v_cvt_pk_bf16_f32 v116, v236, v237
v_min3_f32 v105, v68, v69, v70
v_mfma_f32_16x16x32_bf16 v[88:91], v[14:17], v[212:215], 0
v_max3_f32 v101, v68, v69, v70
v_cvt_pk_bf16_f32 v115, v230, v231
v_cvt_pk_bf16_f32 v122, v232, v233
v_cvt_pk_bf16_f32 v127, v250, v251
v_cvt_pk_bf16_f32 v124, v240, v241
v_pk_mul_f32 v[244:245], v[244:245], v[72:73]
v_pk_fma_f32 v[222:223], v[78:79], v[56:57], v[222:223] op_sel:[0,0,0] op_sel_hi:[1,0,1]
v_pk_mul_f32 v[222:223], v[222:223], v[62:63]
v_mfma_f32_16x16x32_bf16 v[76:79], v[10:13], v[204:207], 0
v_min3_f32 v107, v84, v85, v86
v_min3_f32 v107, v107, v87, v88
v_min3_f32 v107, v107, v89, v90
v_min_f32_e64 v107, v107, v91
v_max3_f32 v103, v84, v85, v86
v_pk_mul_f32 v[220:221], v[220:221], v[60:61]
v_mfma_f32_16x16x32_bf16 v[60:63], v[10:13], v[188:191], 0
v_max3_f32 v103, v103, v87, v88
v_min3_f32 v106, v76, v77, v78
v_min3_f32 v106, v106, v79, v80
v_min3_f32 v106, v106, v81, v82
v_min_f32 v106, v106, v83
v_pk_mul_f32 v[234:235], v[234:235], v[66:67]
v_mfma_f32_16x16x32_bf16 v[64:67], v[14:17], v[188:191], 0
v_permlane32_swap_b32 v106, v107
v_min3_f32 v104, v60, v61, v62
v_min_f32 v106, v106, v107
v_max3_f32 v103, v103, v89, v90
v_pk_mul_f32 v[246:247], v[246:247], v[74:75]
v_mfma_f32_16x16x32_bf16 v[72:75], v[14:17], v[196:199], 0
v_max_f32 v103, v103, v91
v_max3_f32 v102, v76, v77, v78
v_min3_f32 v104, v104, v63, v64
v_min3_f32 v104, v104, v65, v66
v_min_f32 v104, v104, v67
v_max3_f32 v102, v102, v79, v80
v_max3_f32 v102, v102, v81, v82
v_max_f32 v102, v102, v83
v_min3_f32 v105, v105, v71, v72
v_min3_f32 v105, v105, v73, v74
v_min_f32 v105, v105, v75
v_max3_f32 v101, v101, v71, v72
v_max3_f32 v101, v101, v73, v74
v_permlane32_swap_b32 v104, v105
v_permlane32_swap_b32 v102, v103
v_min_f32 v104, v104, v105
v_max_f32 v102, v102, v103
v_max_f32 v101, v101, v75
v_permlane16_swap_b32 v104, v106
v_max3_f32 v100, v60, v61, v62
v_min_f32 v104, v104, v106
v_mov_b32 v106, v104
v_max3_f32 v100, v100, v63, v64
v_max3_f32 v100, v100, v65, v66
v_max_f32 v100, v100, v67
v_permlane16_swap_b32 v104, v106
v_cvt_pk_bf16_f32 v112, v220, v221
v_permlane32_swap_b32 v100, v101
v_mov_b32 v105, v104
v_max_f32 v100, v100, v101
v_mov_b32 v107, v106
v_permlane32_swap_b32 v104, v105
v_permlane16_swap_b32 v100, v102
v_pk_mul_f32 v[104:105], v[104:105], v[128:129]
v_pk_fma_f32 v[226:227], v[66:67], v[128:129], v[104:105] op_sel:[0,0,0] op_sel_hi:[1,0,0] neg_lo:[1,0,0] neg_hi:[1,0,0]
v_pk_fma_f32 v[230:231], v[70:71], v[128:129], v[104:105] op_sel:[0,1,1] op_sel_hi:[1,1,1] neg_lo:[1,0,0] neg_hi:[1,0,0]
v_exp_f32 v226, v226
v_pk_fma_f32 v[224:225], v[64:65], v[128:129], v[104:105] op_sel:[0,0,0] op_sel_hi:[1,0,0] neg_lo:[1,0,0] neg_hi:[1,0,0]
v_exp_f32 v224, v224
v_pk_fma_f32 v[228:229], v[68:69], v[128:129], v[104:105] op_sel:[0,1,1] op_sel_hi:[1,1,1] neg_lo:[1,0,0] neg_hi:[1,0,0]
v_exp_f32 v231, v231
v_cvt_pk_bf16_f32 v113, v222, v223
v_pk_fma_f32 v[222:223], v[62:63], v[128:129], v[104:105] op_sel:[0,0,0] op_sel_hi:[1,0,0] neg_lo:[1,0,0] neg_hi:[1,0,0]
v_exp_f32 v222, v222
v_pk_fma_f32 v[220:221], v[60:61], v[128:129], v[104:105] op_sel:[0,0,0] op_sel_hi:[1,0,0] neg_lo:[1,0,0] neg_hi:[1,0,0]
v_exp_f32 v221, v221
v_exp_f32 v220, v220
v_max_f32 v100, v100, v102
v_exp_f32 v223, v223
v_mov_b32 v102, v100
v_pk_add_f32 v[110:111], v[220:221], v[222:223]
v_exp_f32 v225, v225
v_pk_fma_f32 v[232:233], v[72:73], v[128:129], v[104:105] op_sel:[0,1,1] op_sel_hi:[1,1,1] neg_lo:[1,0,0] neg_hi:[1,0,0]
v_exp_f32 v232, v232
v_exp_f32 v233, v233
v_pk_add_f32 v[110:111], v[110:111], v[224:225]
v_exp_f32 v229, v229
v_exp_f32 v228, v228
v_exp_f32 v227, v227
v_cvt_pk_bf16_f32 v123, v234, v235
v_pk_fma_f32 v[234:235], v[74:75], v[128:129], v[104:105] op_sel:[0,1,1] op_sel_hi:[1,1,1] neg_lo:[1,0,0] neg_hi:[1,0,0]
v_pk_add_f32 v[110:111], v[110:111], v[226:227]
v_add_f32 v104, v110, v111
v_cvt_pk_bf16_f32 v118, v244, v245
v_permlane32_swap_b32 v106, v107
v_permlane16_swap_b32 v100, v102
v_exp_f32 v234, v234
v_mov_b32 v101, v100
v_exp_f32 v235, v235
v_exp_f32_e64 v230, v230
v_cvt_pk_bf16_f32 v125, v242, v243
v_pk_add_f32 v[110:111], v[228:229], v[230:231]
v_pk_add_f32 v[110:111], v[110:111], v[232:233]
v_pk_add_f32 v[110:111], v[110:111], v[234:235]
v_cvt_pk_bf16_f32 v126, v248, v249
v_pk_mul_f32 v[106:107], v[106:107], v[130:131]
v_pk_fma_f32 v[236:237], v[76:77], v[130:131], v[106:107] op_sel:[0,0,0] op_sel_hi:[1,0,0] neg_lo:[1,0,0] neg_hi:[1,0,0]
v_exp_f32 v237, v237
v_exp_f32 v236, v236
v_pk_fma_f32 v[242:243], v[82:83], v[130:131], v[106:107] op_sel:[0,0,0] op_sel_hi:[1,0,0] neg_lo:[1,0,0] neg_hi:[1,0,0]
v_pk_fma_f32 v[250:251], v[90:91], v[130:131], v[106:107] op_sel:[0,1,1] op_sel_hi:[1,1,1] neg_lo:[1,0,0] neg_hi:[1,0,0]
v_add_f32 v105, v110, v111
v_exp_f32 v243, v243
v_cvt_pk_bf16_f32 v119, v246, v247
v_pk_fma_f32 v[246:247], v[86:87], v[130:131], v[106:107] op_sel:[0,1,1] op_sel_hi:[1,1,1] neg_lo:[1,0,0] neg_hi:[1,0,0]
v_exp_f32 v246, v246
v_cvt_pk_bf16_f32 v117, v238, v239
v_pk_fma_f32 v[238:239], v[78:79], v[130:131], v[106:107] op_sel:[0,0,0] op_sel_hi:[1,0,0] neg_lo:[1,0,0] neg_hi:[1,0,0]
v_exp_f32 v238, v238
v_exp_f32 v247, v247
v_pk_fma_f32 v[240:241], v[80:81], v[130:131], v[106:107] op_sel:[0,0,0] op_sel_hi:[1,0,0] neg_lo:[1,0,0] neg_hi:[1,0,0]
v_exp_f32 v240, v240
v_exp_f32 v241, v241
v_permlane32_swap_b32 v100, v101
v_exp_f32 v242, v242
v_pk_fma_f32 v[244:245], v[84:85], v[130:131], v[106:107] op_sel:[0,1,1] op_sel_hi:[1,1,1] neg_lo:[1,0,0] neg_hi:[1,0,0]
v_exp_f32 v244, v244
v_exp_f32_e64 v239, v239
v_pk_mul_f32 v[100:101], v[100:101], v[128:129]
v_pk_fma_f32 v[62:63], v[62:63], v[128:129], v[100:101] op_sel:[0,0,0] op_sel_hi:[1,0,0] neg_lo:[0,0,1] neg_hi:[0,0,1]
v_pk_add_f32 v[110:111], v[236:237], v[238:239]
v_pk_add_f32 v[110:111], v[110:111], v[240:241]
v_pk_add_f32 v[110:111], v[110:111], v[242:243]
v_pk_fma_f32 v[72:73], v[72:73], v[128:129], v[100:101] op_sel:[0,1,1] op_sel_hi:[1,1,1] neg_lo:[0,0,1] neg_hi:[0,0,1]
v_pk_fma_f32 v[66:67], v[66:67], v[128:129], v[100:101] op_sel:[0,0,0] op_sel_hi:[1,0,0] neg_lo:[0,0,1] neg_hi:[0,0,1]
v_exp_f32 v62, v62
v_pk_fma_f32 v[60:61], v[60:61], v[128:129], v[100:101] op_sel:[0,0,0] op_sel_hi:[1,0,0] neg_lo:[0,0,1] neg_hi:[0,0,1]
v_exp_f32 v60, v60
v_exp_f32 v245, v245
v_exp_f32 v73, v73
v_pk_fma_f32 v[248:249], v[88:89], v[130:131], v[106:107] op_sel:[0,1,1] op_sel_hi:[1,1,1] neg_lo:[1,0,0] neg_hi:[1,0,0]
v_add_f32 v106, v110, v111
v_exp_f32 v249, v249
v_pk_add_f32 v[110:111], v[244:245], v[246:247]
v_exp_f32 v248, v248
v_pk_fma_f32 v[64:65], v[64:65], v[128:129], v[100:101] op_sel:[0,0,0] op_sel_hi:[1,0,0] neg_lo:[0,0,1] neg_hi:[0,0,1]
v_exp_f32 v64, v64
v_pk_add_f32 v[110:111], v[110:111], v[248:249]
v_exp_f32 v65, v65
v_exp_f32 v61, v61
v_exp_f32 v66, v66
v_exp_f32 v251, v251
v_exp_f32 v63, v63
v_pk_fma_f32 v[74:75], v[74:75], v[128:129], v[100:101] op_sel:[0,1,1] op_sel_hi:[1,1,1] neg_lo:[0,0,1] neg_hi:[0,0,1]
v_pk_add_f32 v[108:109], v[60:61], v[62:63]
v_exp_f32 v67, v67
v_exp_f32 v250, v250
v_pk_fma_f32 v[68:69], v[68:69], v[128:129], v[100:101] op_sel:[0,1,1] op_sel_hi:[1,1,1] neg_lo:[0,0,1] neg_hi:[0,0,1]
v_pk_add_f32 v[110:111], v[110:111], v[250:251]
v_exp_f32 v68, v68
v_exp_f32 v69, v69
v_add_f32 v107, v110, v111
v_mov_b32 v103, v102
v_pk_fma_f32 v[70:71], v[70:71], v[128:129], v[100:101] op_sel:[0,1,1] op_sel_hi:[1,1,1] neg_lo:[0,0,1] neg_hi:[0,0,1]
v_exp_f32 v71, v71
v_exp_f32 v70, v70
v_permlane32_swap_b32 v106, v107
v_permlane32_swap_b32 v102, v103
v_pk_add_f32 v[108:109], v[108:109], v[64:65]
v_pk_add_f32 v[108:109], v[108:109], v[66:67]
v_add_f32 v100, v108, v109
v_pk_add_f32 v[108:109], v[68:69], v[70:71]
v_pk_mul_f32 v[102:103], v[102:103], v[130:131]
v_pk_fma_f32 v[78:79], v[78:79], v[130:131], v[102:103] op_sel:[0,0,0] op_sel_hi:[1,0,0] neg_lo:[0,0,1] neg_hi:[0,0,1]
v_exp_f32 v79, v79
v_exp_f32 v78, v78
v_exp_f32 v74, v74
v_exp_f32 v72, v72
v_pk_fma_f32 v[86:87], v[86:87], v[130:131], v[102:103] op_sel:[0,1,1] op_sel_hi:[1,1,1] neg_lo:[0,0,1] neg_hi:[0,0,1]
v_exp_f32 v87, v87
v_pk_fma_f32 v[76:77], v[76:77], v[130:131], v[102:103] op_sel:[0,0,0] op_sel_hi:[1,0,0] neg_lo:[0,0,1] neg_hi:[0,0,1]
v_exp_f32 v77, v77
v_add_f32 v106, v106, v107
v_pk_fma_f32 v[80:81], v[80:81], v[130:131], v[102:103] op_sel:[0,0,0] op_sel_hi:[1,0,0] neg_lo:[0,0,1] neg_hi:[0,0,1]
v_exp_f32 v81, v81
v_exp_f32 v80, v80
v_pk_add_f32 v[108:109], v[108:109], v[72:73]
v_permlane32_swap_b32 v104, v105
v_exp_f32 v75, v75
v_add_f32 v104, v104, v105
v_pk_fma_f32 v[82:83], v[82:83], v[130:131], v[102:103] op_sel:[0,0,0] op_sel_hi:[1,0,0] neg_lo:[0,0,1] neg_hi:[0,0,1]
v_exp_f32 v82, v82
v_exp_f32 v83, v83
v_permlane16_swap_b32 v104, v106
v_pk_add_f32 v[108:109], v[108:109], v[74:75]
v_add_f32 v101, v108, v109
v_exp_f32 v76, v76
v_add_f32 v104, v104, v106
v_rcp_f32 v104, v104
v_pk_fma_f32 v[84:85], v[84:85], v[130:131], v[102:103] op_sel:[0,1,1] op_sel_hi:[1,1,1] neg_lo:[0,0,1] neg_hi:[0,0,1]
v_exp_f32 v84, v84
v_exp_f32 v85, v85
v_mov_b32 v106, v104
v_pk_add_f32 v[108:109], v[76:77], v[78:79]
v_pk_add_f32 v[108:109], v[108:109], v[80:81]
v_pk_add_f32 v[108:109], v[108:109], v[82:83]
v_pk_fma_f32 v[88:89], v[88:89], v[130:131], v[102:103] op_sel:[0,1,1] op_sel_hi:[1,1,1] neg_lo:[0,0,1] neg_hi:[0,0,1]
v_exp_f32 v88, v88
v_exp_f32 v89, v89
v_exp_f32 v86, v86
v_pk_fma_f32 v[90:91], v[90:91], v[130:131], v[102:103] op_sel:[0,1,1] op_sel_hi:[1,1,1] neg_lo:[0,0,1] neg_hi:[0,0,1]
v_add_f32 v102, v108, v109
v_pk_add_f32 v[108:109], v[84:85], v[86:87]
v_pk_add_f32 v[108:109], v[108:109], v[88:89]
v_permlane16_swap_b32 v104, v106
v_exp_f32 v90, v90
v_exp_f32 v91, v91
v_permlane32_swap_b32 v100, v101
v_pk_add_f32 v[108:109], v[108:109], v[90:91]
v_add_f32 v103, v108, v109
v_add_f32 v100, v100, v101
v_mov_b32 v105, v104
v_permlane32_swap_b32 v102, v103
v_mov_b32 v107, v106
v_add_f32 v102, v102, v103
v_permlane32_swap_b32 v104, v105
v_permlane32_swap_b32 v106, v107
v_permlane16_swap_b32 v100, v102
v_pk_mul_f32 v[222:223], v[222:223], v[104:105] op_sel:[0,0] op_sel_hi:[1,0]
v_pk_mul_f32 v[226:227], v[226:227], v[104:105] op_sel:[0,0] op_sel_hi:[1,0]
v_pk_mul_f32 v[234:235], v[234:235], v[104:105] op_sel:[0,1] op_sel_hi:[1,1]
v_pk_mul_f32 v[232:233], v[232:233], v[104:105] op_sel:[0,1] op_sel_hi:[1,1]
v_pk_mul_f32 v[230:231], v[230:231], v[104:105] op_sel:[0,1] op_sel_hi:[1,1]
v_add_f32 v100, v100, v102
v_pk_mul_f32 v[228:229], v[228:229], v[104:105] op_sel:[0,1] op_sel_hi:[1,1]
v_cvt_pk_bf16_f32 v228, v228, v229
v_cvt_pk_bf16_f32 v229, v230, v231
v_cvt_pk_bf16_f32 v231, v234, v235
v_cvt_pk_bf16_f32 v230, v232, v233
v_pk_mul_f32 v[220:221], v[220:221], v[104:105] op_sel:[0,0] op_sel_hi:[1,0]
v_cvt_pk_bf16_f32 v220, v220, v221
v_pk_mul_f32 v[224:225], v[224:225], v[104:105] op_sel:[0,0] op_sel_hi:[1,0]
v_pk_mul_f32 v[236:237], v[236:237], v[106:107] op_sel:[0,0] op_sel_hi:[1,0]
v_pk_mul_f32 v[238:239], v[238:239], v[106:107] op_sel:[0,0] op_sel_hi:[1,0]
v_pk_mul_f32 v[240:241], v[240:241], v[106:107] op_sel:[0,0] op_sel_hi:[1,0]
v_pk_mul_f32 v[242:243], v[242:243], v[106:107] op_sel:[0,0] op_sel_hi:[1,0]
v_pk_mul_f32 v[248:249], v[248:249], v[106:107] op_sel:[0,1] op_sel_hi:[1,1]
v_rcp_f32 v100, v100
v_pk_mul_f32 v[244:245], v[244:245], v[106:107] op_sel:[0,1] op_sel_hi:[1,1]
v_mov_b32 v102, v100
v_pk_mul_f32 v[250:251], v[250:251], v[106:107] op_sel:[0,1] op_sel_hi:[1,1]
v_cvt_pk_bf16_f32 v221, v222, v223
v_pk_mul_f32 v[246:247], v[246:247], v[106:107] op_sel:[0,1] op_sel_hi:[1,1]
v_cvt_pk_bf16_f32 v222, v224, v225
v_mfma_f32_16x16x32_bf16 v[200:203], v[228:231], v[36:39], 0
v_cvt_pk_bf16_f32 v223, v226, v227
v_permlane16_swap_b32 v100, v102
v_mfma_f32_16x16x32_bf16 v[196:199], v[228:231], v[38:41], 0
v_mov_b32 v101, v100
v_cvt_pk_bf16_f32 v244, v244, v245
v_mfma_f32_16x16x32_bf16 v[212:215], v[220:223], v[38:41], 0
v_cvt_pk_bf16_f32 v245, v246, v247
v_cvt_pk_bf16_f32 v247, v250, v251
v_mfma_f32_16x16x32_bf16 v[216:219], v[220:223], v[36:39], 0
v_cvt_pk_bf16_f32 v234, v200, v201
v_cvt_pk_bf16_f32 v246, v248, v249
v_cvt_pk_bf16_f32 v226, v196, v197
v_cvt_pk_bf16_f32 v227, v198, v199
v_mfma_f32_16x16x32_bf16 v[196:199], v[244:247], v[38:41], 0
v_cvt_pk_bf16_f32 v225, v214, v215
v_cvt_pk_bf16_f32 v236, v236, v237
v_cvt_pk_bf16_f32 v237, v238, v239
v_cvt_pk_bf16_f32 v232, v216, v217
v_cvt_pk_bf16_f32 v233, v218, v219
v_cvt_pk_bf16_f32 v239, v242, v243
v_cvt_pk_bf16_f32 v238, v240, v241
v_cvt_pk_bf16_f32 v224, v212, v213
v_permlane32_swap_b32 v100, v101
v_mfma_f32_16x16x32_bf16 v[216:219], v[236:239], v[36:39], 0
v_mov_b32 v103, v102
v_cvt_pk_bf16_f32 v235, v202, v203
v_mfma_f32_16x16x32_bf16 v[212:215], v[236:239], v[38:41], 0
v_cvt_pk_bf16_f32 v243, v198, v199
v_permlane32_swap_b32 v102, v103
v_mfma_f32_16x16x32_bf16 v[200:203], v[244:247], v[36:39], 0
v_cvt_pk_bf16_f32 v242, v196, v197
v_mov_b32 v5, s61
v_mfma_f32_16x16x32_bf16 v[220:223], v[232:235], v[120:123], 0
v_cvt_pk_bf16_f32 v249, v218, v219
v_cvt_pk_bf16_f32 v248, v216, v217
v_cvt_pk_bf16_f32 v241, v214, v215
v_cvt_pk_bf16_f32 v240, v212, v213
v_cmp_eq_u32 s[50:51], s41, v2
v_pk_mul_f32 v[64:65], v[64:65], v[100:101] op_sel:[0,0] op_sel_hi:[1,0]
v_pk_mul_f32 v[74:75], v[74:75], v[100:101] op_sel:[0,1] op_sel_hi:[1,1]
v_pk_mul_f32 v[68:69], v[68:69], v[100:101] op_sel:[0,1] op_sel_hi:[1,1]
v_pk_mul_f32 v[72:73], v[72:73], v[100:101] op_sel:[0,1] op_sel_hi:[1,1]
v_pk_mul_f32 v[60:61], v[60:61], v[100:101] op_sel:[0,0] op_sel_hi:[1,0]
v_pk_mul_f32 v[62:63], v[62:63], v[100:101] op_sel:[0,0] op_sel_hi:[1,0]
v_pk_mul_f32 v[66:67], v[66:67], v[100:101] op_sel:[0,0] op_sel_hi:[1,0]
v_pk_mul_f32 v[76:77], v[76:77], v[102:103] op_sel:[0,0] op_sel_hi:[1,0]
v_pk_mul_f32 v[70:71], v[70:71], v[100:101] op_sel:[0,1] op_sel_hi:[1,1]
v_cvt_pk_bf16_f32 v60, v60, v61
v_pk_mul_f32 v[80:81], v[80:81], v[102:103] op_sel:[0,0] op_sel_hi:[1,0]
v_pk_mul_f32 v[78:79], v[78:79], v[102:103] op_sel:[0,0] op_sel_hi:[1,0]
v_pk_mul_f32 v[82:83], v[82:83], v[102:103] op_sel:[0,0] op_sel_hi:[1,0]
v_pk_mul_f32 v[86:87], v[86:87], v[102:103] op_sel:[0,1] op_sel_hi:[1,1]
v_cvt_pk_bf16_f32 v61, v62, v63
v_pk_mul_f32 v[84:85], v[84:85], v[102:103] op_sel:[0,1] op_sel_hi:[1,1]
v_cvt_pk_bf16_f32 v62, v64, v65
v_pk_mul_f32 v[88:89], v[88:89], v[102:103] op_sel:[0,1] op_sel_hi:[1,1]
v_cvt_pk_bf16_f32 v63, v66, v67
v_pk_mul_f32 v[90:91], v[90:91], v[102:103] op_sel:[0,1] op_sel_hi:[1,1]
v_cvt_pk_bf16_f32 v68, v68, v69
v_mfma_f32_16x16x32_bf16 v[208:211], v[60:63], v[36:39], 0
v_cvt_pk_bf16_f32 v69, v70, v71
v_cvt_pk_bf16_f32 v70, v72, v73
v_mfma_f32_16x16x32_bf16 v[204:207], v[60:63], v[38:41], 0
v_cvt_pk_bf16_f32 v71, v74, v75
v_cvt_pk_bf16_f32 v76, v76, v77
v_mfma_f32_16x16x32_bf16 v[60:63], v[232:235], v[112:115], 0
v_cvt_pk_bf16_f32 v250, v200, v201
v_cvt_pk_bf16_f32 v77, v78, v79
v_mfma_f32_16x16x32_bf16 v[192:195], v[68:71], v[36:39], 0
v_cvt_pk_bf16_f32 v78, v80, v81
v_cvt_pk_bf16_f32 v79, v82, v83
v_mfma_f32_16x16x32_bf16 v[188:191], v[68:71], v[38:41], 0
v_cvt_pk_bf16_f32 v65, v206, v207
v_cvt_pk_bf16_f32 v64, v204, v205
v_mfma_f32_16x16x32_bf16 v[68:71], v[224:227], v[120:123], 0
v_cvt_pk_bf16_f32 v251, v202, v203
v_cvt_pk_bf16_f32 v72, v208, v209
v_mfma_f32_16x16x32_bf16 v[152:155], v[224:227], v[112:115], 0
v_cvt_pk_bf16_f32 v73, v210, v211
v_cvt_pk_bf16_f32 v84, v84, v85
v_mfma_f32_16x16x32_bf16 v[60:63], v[248:251], v[116:119], v[60:63]
v_cvt_pk_bf16_f32 v85, v86, v87
v_cvt_pk_bf16_f32 v86, v88, v89
v_mfma_f32_16x16x32_bf16 v[228:231], v[224:227], v[48:51], 0
v_cvt_pk_bf16_f32 v67, v190, v191
v_cvt_pk_bf16_f32 v87, v90, v91
v_mfma_f32_16x16x32_bf16 v[220:223], v[248:251], v[124:127], v[220:223]
v_cvt_pk_bf16_f32 v66, v188, v189
v_cvt_pk_bf16_f32 v74, v192, v193
v_mfma_f32_16x16x32_bf16 v[152:155], v[240:243], v[116:119], v[152:155]
v_cvt_pk_bf16_f32 v75, v194, v195
v_mfma_f32_16x16x32_bf16 v[204:207], v[76:79], v[38:41], 0
v_mfma_f32_16x16x32_bf16 v[208:211], v[76:79], v[36:39], 0
v_mfma_f32_16x16x32_bf16 v[228:231], v[240:243], v[48:51], v[228:231]
v_mfma_f32_16x16x32_bf16 v[68:71], v[240:243], v[124:127], v[68:71]
v_mfma_f32_16x16x32_bf16 v[76:79], v[232:235], v[48:51], 0
s_nop 1
v_cvt_pk_bf16_f32 v152, v152, v153
v_mfma_f32_16x16x32_bf16 v[76:79], v[248:251], v[48:51], v[76:79]
v_cvt_pk_bf16_f32 v153, v154, v155
v_cvt_pk_bf16_f32 v154, v60, v61
v_mfma_f32_16x16x32_bf16 v[192:195], v[84:87], v[36:39], 0
v_cvt_pk_bf16_f32 v68, v68, v69
v_cvt_pk_bf16_f32 v155, v62, v63
v_mfma_f32_16x16x32_bf16 v[188:191], v[84:87], v[38:41], 0
ds_write_b128 v42, v[152:155] offset:0
v_mfma_f32_16x16x32_bf16 v[136:139], v[64:67], v[48:51], 0
v_cvt_pk_bf16_f32 v69, v70, v71
v_cvt_pk_bf16_f32 v228, v228, v229
v_mfma_f32_16x16x32_bf16 v[104:107], v[72:75], v[112:115], 0
v_cvt_pk_bf16_f32 v71, v222, v223
v_cvt_pk_bf16_f32 v229, v230, v231
v_mfma_f32_16x16x32_bf16 v[148:151], v[72:75], v[48:51], 0
v_cvt_pk_bf16_f32 v230, v76, v77
v_cvt_pk_bf16_f32 v70, v220, v221
v_mfma_f32_16x16x32_bf16 v[132:135], v[72:75], v[120:123], 0
ds_write_b128 v42, v[68:71] offset:1024
v_mfma_f32_16x16x32_bf16 v[108:111], v[64:67], v[120:123], 0
v_cvt_pk_bf16_f32 v231, v78, v79
ds_write_b128 v42, v[228:231] offset:2048
v_mfma_f32_16x16x32_bf16 v[100:103], v[64:67], v[112:115], 0
ds_write_b32 v52, v5
v_cvt_pk_bf16_f32 v88, v208, v209
v_cvt_pk_bf16_f32 v83, v190, v191
v_cvt_pk_bf16_f32 v91, v194, v195
v_cvt_pk_bf16_f32 v82, v188, v189
v_cvt_pk_bf16_f32 v80, v204, v205
v_cvt_pk_bf16_f32 v89, v210, v211
v_cvt_pk_bf16_f32 v81, v206, v207
v_cvt_pk_bf16_f32 v90, v192, v193
s_nop 0
v_mfma_f32_16x16x32_bf16 v[100:103], v[80:83], v[116:119], v[100:103]
v_mfma_f32_16x16x32_bf16 v[108:111], v[80:83], v[124:127], v[108:111]
v_mfma_f32_16x16x32_bf16 v[132:135], v[88:91], v[124:127], v[132:135]
v_mfma_f32_16x16x32_bf16 v[148:151], v[88:91], v[48:51], v[148:151]
v_mfma_f32_16x16x32_bf16 v[136:139], v[80:83], v[48:51], v[136:139]
v_mfma_f32_16x16x32_bf16 v[104:107], v[88:91], v[116:119], v[104:107]
s_mov_b32 s63, 0
px_82:
ds_read_b32 v4, v19
ds_read_b128 v[188:191], v43 offset:0
ds_read_b128 v[192:195], v43 offset:1024
ds_read_b128 v[196:199], v43 offset:2048
s_add_u32 s63, s63, 1
s_cmp_lt_u32 s63, 0x400000
s_waitcnt lgkmcnt(0)
v_cmp_ne_u32 vcc, s61, v4
s_cbranch_vccz pxd_83
s_cbranch_scc1 px_82
pxd_83:
v_mfma_f32_16x16x32_bf16 v[100:103], v[38:41], v[188:191], v[100:103]
v_mfma_f32_16x16x32_bf16 v[104:107], v[36:39], v[188:191], v[104:107]
v_mfma_f32_16x16x32_bf16 v[108:111], v[38:41], v[192:195], v[108:111]
v_mfma_f32_16x16x32_bf16 v[132:135], v[36:39], v[192:195], v[132:135]
v_mfma_f32_16x16x32_bf16 v[136:139], v[38:41], v[196:199], v[136:139]
v_mfma_f32_16x16x32_bf16 v[148:151], v[36:39], v[196:199], v[148:151]
s_nop 2
v_cvt_pk_bf16_f32 v100, v100, v101
v_cvt_pk_bf16_f32 v101, v102, v103
v_cvt_pk_bf16_f32 v102, v104, v105
v_cvt_pk_bf16_f32 v103, v106, v107
buffer_store_dwordx4 v[100:103], v55, s[32:35], s53 offen sc1
v_cvt_pk_bf16_f32 v108, v108, v109
v_cvt_pk_bf16_f32 v109, v110, v111
v_cvt_pk_bf16_f32 v110, v132, v133
v_cvt_pk_bf16_f32 v111, v134, v135
buffer_store_dwordx4 v[108:111], v55, s[32:35], s54 offen sc1
v_cvt_pk_bf16_f32 v136, v136, v137
v_cvt_pk_bf16_f32 v137, v138, v139
v_cvt_pk_bf16_f32 v138, v148, v149
v_cvt_pk_bf16_f32 v139, v150, v151
s_mov_b64 exec, s[50:51]
buffer_store_dwordx4 v[136:139], v58, s[32:35], s56 offen sc1
s_mov_b64 exec, -1
s_mov_b32 s51, 0
.p2align 3
v_pk_fma_f32 v[156:157], v[140:141], v[92:93], v[156:157] op_sel:[0,1,0] op_sel_hi:[1,1,1]
v_pk_fma_f32 v[164:165], v[140:141], v[94:95], v[164:165] op_sel:[0,1,0] op_sel_hi:[1,1,1]
v_pk_fma_f32 v[172:173], v[140:141], v[96:97], v[172:173] op_sel:[0,1,0] op_sel_hi:[1,1,1]
v_pk_fma_f32 v[180:181], v[140:141], v[98:99], v[180:181] op_sel:[0,1,0] op_sel_hi:[1,1,1]
v_pk_fma_f32 v[158:159], v[142:143], v[92:93], v[158:159] op_sel:[0,1,0] op_sel_hi:[1,1,1]
v_cvt_pk_bf16_f32 v156, v156, v157
v_pk_fma_f32 v[166:167], v[142:143], v[94:95], v[166:167] op_sel:[0,1,0] op_sel_hi:[1,1,1]
v_cvt_pk_bf16_f32 v164, v164, v165
v_pk_fma_f32 v[174:175], v[142:143], v[96:97], v[174:175] op_sel:[0,1,0] op_sel_hi:[1,1,1]
v_cvt_pk_bf16_f32 v172, v172, v173
v_pk_fma_f32 v[182:183], v[142:143], v[98:99], v[182:183] op_sel:[0,1,0] op_sel_hi:[1,1,1]
v_cvt_pk_bf16_f32 v180, v180, v181
v_pk_fma_f32 v[160:161], v[144:145], v[92:93], v[160:161] op_sel:[0,1,0] op_sel_hi:[1,1,1]
v_pk_fma_f32 v[162:163], v[146:147], v[92:93], v[162:163] op_sel:[0,1,0] op_sel_hi:[1,1,1]
v_cvt_pk_bf16_f32 v157, v158, v159
v_pk_fma_f32 v[168:169], v[144:145], v[94:95], v[168:169] op_sel:[0,1,0] op_sel_hi:[1,1,1]
v_pk_fma_f32 v[170:171], v[146:147], v[94:95], v[170:171] op_sel:[0,1,0] op_sel_hi:[1,1,1]
v_cvt_pk_bf16_f32 v165, v166, v167
v_pk_fma_f32 v[176:177], v[144:145], v[96:97], v[176:177] op_sel:[0,1,0] op_sel_hi:[1,1,1]
v_pk_fma_f32 v[178:179], v[146:147], v[96:97], v[178:179] op_sel:[0,1,0] op_sel_hi:[1,1,1]
v_cvt_pk_bf16_f32 v173, v174, v175
v_pk_fma_f32 v[184:185], v[144:145], v[98:99], v[184:185] op_sel:[0,1,0] op_sel_hi:[1,1,1]
v_pk_fma_f32 v[186:187], v[146:147], v[98:99], v[186:187] op_sel:[0,1,0] op_sel_hi:[1,1,1]
v_cvt_pk_bf16_f32 v181, v182, v183
v_cvt_pk_bf16_f32 v158, v160, v161
v_cvt_pk_bf16_f32 v159, v162, v163
v_cvt_pk_bf16_f32 v166, v168, v169
v_cvt_pk_bf16_f32 v167, v170, v171
v_mfma_f32_16x16x32_bf16 v[60:63], v[10:13], v[156:159], 0
v_cvt_pk_bf16_f32 v174, v176, v177
v_cvt_pk_bf16_f32 v175, v178, v179
v_mfma_f32_16x16x32_bf16 v[68:71], v[10:13], v[164:167], 0
v_cvt_pk_bf16_f32 v182, v184, v185
v_cvt_pk_bf16_f32 v183, v186, v187
v_mfma_f32_16x16x32_bf16 v[76:79], v[10:13], v[172:175], 0
s_nop 0
v_mfma_f32_16x16x32_bf16 v[84:87], v[10:13], v[180:183], 0
v_min3_f32 v104, v60, v61, v62
v_max3_f32 v100, v60, v61, v62
v_mfma_f32_16x16x32_bf16 v[64:67], v[14:17], v[156:159], 0
v_min3_f32 v105, v68, v69, v70
v_max3_f32 v101, v68, v69, v70
v_mfma_f32_16x16x32_bf16 v[72:75], v[14:17], v[164:167], 0
v_min3_f32 v106, v76, v77, v78
v_max3_f32 v102, v76, v77, v78
v_mfma_f32_16x16x32_bf16 v[80:83], v[14:17], v[172:175], 0
v_min3_f32 v107, v84, v85, v86
v_max3_f32 v103, v84, v85, v86
v_mfma_f32_16x16x32_bf16 v[88:91], v[14:17], v[180:183], 0
v_min3_f32 v104, v104, v63, v64
v_max3_f32 v100, v100, v63, v64
v_min3_f32 v105, v105, v71, v72
v_min3_f32 v104, v104, v65, v66
v_max3_f32 v101, v101, v71, v72
v_min3_f32 v106, v106, v79, v80
v_min3_f32 v105, v105, v73, v74
v_max3_f32 v102, v102, v79, v80
v_min3_f32 v107, v107, v87, v88
v_min3_f32 v106, v106, v81, v82
v_max3_f32 v103, v103, v87, v88
v_min3_f32 v107, v107, v89, v90
v_max3_f32 v100, v100, v65, v66
v_min_f32 v104, v104, v67
v_max3_f32 v101, v101, v73, v74
v_min_f32 v105, v105, v75
v_max3_f32 v102, v102, v81, v82
v_min_f32 v106, v106, v83
v_max3_f32 v103, v103, v89, v90
v_min_f32 v107, v107, v91
v_max_f32 v100, v100, v67
v_max_f32 v101, v101, v75
v_max_f32 v102, v102, v83
v_max_f32 v103, v103, v91
v_permlane32_swap_b32 v104, v105
v_permlane32_swap_b32 v106, v107
v_permlane32_swap_b32 v100, v101
v_permlane32_swap_b32 v102, v103
v_min_f32 v104, v104, v105
v_min_f32 v106, v106, v107
v_max_f32 v100, v100, v101
v_max_f32 v102, v102, v103
v_permlane16_swap_b32 v104, v106
s_nop 0
v_permlane16_swap_b32 v100, v102
v_min_f32 v104, v104, v106
v_max_f32 v100, v100, v102
v_mov_b32 v106, v104
v_mov_b32 v102, v100
s_nop 0
v_permlane16_swap_b32 v104, v106
v_permlane16_swap_b32 v100, v102
v_mov_b32 v105, v104
v_mov_b32 v101, v100
v_mov_b32 v103, v102
v_permlane32_swap_b32 v104, v105
v_mov_b32 v107, v106
v_permlane32_swap_b32_e64 v100, v101
v_pk_mul_f32 v[104:105], v[104:105], v[128:129]
v_pk_mul_f32 v[100:101], v[100:101], v[128:129]
v_pk_fma_f32 v[220:221], v[60:61], v[128:129], v[104:105] op_sel:[0,0,0] op_sel_hi:[1,0,0] neg_lo:[1,0,0] neg_hi:[1,0,0]
v_pk_fma_f32 v[222:223], v[62:63], v[128:129], v[104:105] op_sel:[0,0,0] op_sel_hi:[1,0,0] neg_lo:[1,0,0] neg_hi:[1,0,0]
v_pk_fma_f32 v[224:225], v[64:65], v[128:129], v[104:105] op_sel:[0,0,0] op_sel_hi:[1,0,0] neg_lo:[1,0,0] neg_hi:[1,0,0]
v_pk_fma_f32 v[226:227], v[66:67], v[128:129], v[104:105] op_sel:[0,0,0] op_sel_hi:[1,0,0] neg_lo:[1,0,0] neg_hi:[1,0,0]
v_pk_fma_f32 v[228:229], v[68:69], v[128:129], v[104:105] op_sel:[0,1,1] op_sel_hi:[1,1,1] neg_lo:[1,0,0] neg_hi:[1,0,0]
v_pk_fma_f32 v[230:231], v[70:71], v[128:129], v[104:105] op_sel:[0,1,1] op_sel_hi:[1,1,1] neg_lo:[1,0,0] neg_hi:[1,0,0]
v_pk_fma_f32 v[232:233], v[72:73], v[128:129], v[104:105] op_sel:[0,1,1] op_sel_hi:[1,1,1] neg_lo:[1,0,0] neg_hi:[1,0,0]
v_pk_fma_f32 v[234:235], v[74:75], v[128:129], v[104:105] op_sel:[0,1,1] op_sel_hi:[1,1,1] neg_lo:[1,0,0] neg_hi:[1,0,0]
v_permlane32_swap_b32 v102, v103
v_permlane32_swap_b32 v106, v107
v_pk_fma_f32 v[60:61], v[60:61], v[128:129], v[100:101] op_sel:[0,0,0] op_sel_hi:[1,0,0] neg_lo:[0,0,1] neg_hi:[0,0,1]
v_pk_fma_f32 v[62:63], v[62:63], v[128:129], v[100:101] op_sel:[0,0,0] op_sel_hi:[1,0,0] neg_lo:[0,0,1] neg_hi:[0,0,1]
v_pk_fma_f32 v[64:65], v[64:65], v[128:129], v[100:101] op_sel:[0,0,0] op_sel_hi:[1,0,0] neg_lo:[0,0,1] neg_hi:[0,0,1]
v_pk_fma_f32 v[66:67], v[66:67], v[128:129], v[100:101] op_sel:[0,0,0] op_sel_hi:[1,0,0] neg_lo:[0,0,1] neg_hi:[0,0,1]
v_pk_fma_f32 v[68:69], v[68:69], v[128:129], v[100:101] op_sel:[0,1,1] op_sel_hi:[1,1,1] neg_lo:[0,0,1] neg_hi:[0,0,1]
v_pk_fma_f32 v[70:71], v[70:71], v[128:129], v[100:101] op_sel:[0,1,1] op_sel_hi:[1,1,1] neg_lo:[0,0,1] neg_hi:[0,0,1]
v_pk_fma_f32 v[72:73], v[72:73], v[128:129], v[100:101] op_sel:[0,1,1] op_sel_hi:[1,1,1] neg_lo:[0,0,1] neg_hi:[0,0,1]
v_pk_fma_f32 v[74:75], v[74:75], v[128:129], v[100:101] op_sel:[0,1,1] op_sel_hi:[1,1,1] neg_lo:[0,0,1] neg_hi:[0,0,1]
v_exp_f32 v220, v220
v_exp_f32 v60, v60
v_exp_f32 v221, v221
v_exp_f32 v61, v61
v_exp_f32 v222, v222
v_exp_f32 v62, v62
v_exp_f32 v223, v223
v_exp_f32 v63, v63
v_exp_f32 v224, v224
v_exp_f32 v64, v64
v_exp_f32 v225, v225
v_exp_f32 v65, v65
v_exp_f32 v226, v226
v_exp_f32 v66, v66
v_exp_f32 v227, v227
v_exp_f32 v67, v67
v_exp_f32 v228, v228
v_exp_f32 v68, v68
v_exp_f32 v229, v229
v_exp_f32 v69, v69
v_exp_f32 v230, v230
v_exp_f32 v70, v70
v_exp_f32 v231, v231
v_exp_f32 v71, v71
v_exp_f32 v232, v232
v_exp_f32 v72, v72
v_exp_f32 v233, v233
v_exp_f32 v73, v73
v_exp_f32 v234, v234
v_exp_f32 v74, v74
v_exp_f32 v235, v235
v_exp_f32 v75, v75
v_pk_mul_f32 v[102:103], v[102:103], v[130:131]
v_pk_mul_f32 v[106:107], v[106:107], v[130:131]
buffer_load_dwordx4 v[212:215], v18, s[32:35], s55 offen offset:0 sc1
buffer_load_dwordx4 v[216:219], v18, s[32:35], s55 offen offset:1024 sc1
.p2align 3
v_pk_add_f32 v[108:109], v[60:61], v[62:63]
v_pk_add_f32 v[110:111], v[220:221], v[222:223]
v_pk_add_f32 v[108:109], v[108:109], v[64:65]
v_pk_add_f32 v[110:111], v[110:111], v[224:225]
v_pk_add_f32 v[108:109], v[108:109], v[66:67]
v_pk_add_f32 v[110:111], v[110:111], v[226:227]
v_add_f32 v100, v108, v109
v_add_f32 v104, v110, v111
v_pk_fma_f32 v[236:237], v[76:77], v[130:131], v[106:107] op_sel:[0,0,0] op_sel_hi:[1,0,0] neg_lo:[1,0,0] neg_hi:[1,0,0]
v_pk_fma_f32 v[238:239], v[78:79], v[130:131], v[106:107] op_sel:[0,0,0] op_sel_hi:[1,0,0] neg_lo:[1,0,0] neg_hi:[1,0,0]
v_pk_add_f32 v[108:109], v[68:69], v[70:71]
v_pk_add_f32 v[110:111], v[228:229], v[230:231]
v_pk_fma_f32 v[76:77], v[76:77], v[130:131], v[102:103] op_sel:[0,0,0] op_sel_hi:[1,0,0] neg_lo:[0,0,1] neg_hi:[0,0,1]
v_pk_fma_f32 v[78:79], v[78:79], v[130:131], v[102:103] op_sel:[0,0,0] op_sel_hi:[1,0,0] neg_lo:[0,0,1] neg_hi:[0,0,1]
v_pk_fma_f32 v[240:241], v[80:81], v[130:131], v[106:107] op_sel:[0,0,0] op_sel_hi:[1,0,0] neg_lo:[1,0,0] neg_hi:[1,0,0]
v_pk_add_f32 v[108:109], v[108:109], v[72:73]
v_pk_add_f32 v[110:111], v[110:111], v[232:233]
v_exp_f32 v236, v236
v_exp_f32 v76, v76
v_exp_f32 v237, v237
v_exp_f32 v77, v77
v_exp_f32 v238, v238
v_exp_f32 v78, v78
v_exp_f32 v239, v239
v_exp_f32 v79, v79
v_pk_fma_f32 v[80:81], v[80:81], v[130:131], v[102:103] op_sel:[0,0,0] op_sel_hi:[1,0,0] neg_lo:[0,0,1] neg_hi:[0,0,1]
v_pk_fma_f32 v[242:243], v[82:83], v[130:131], v[106:107] op_sel:[0,0,0] op_sel_hi:[1,0,0] neg_lo:[1,0,0] neg_hi:[1,0,0]
v_pk_add_f32 v[108:109], v[108:109], v[74:75]
v_pk_add_f32 v[110:111], v[110:111], v[234:235]
v_exp_f32 v240, v240
v_exp_f32 v80, v80
v_exp_f32 v241, v241
v_exp_f32 v81, v81
v_pk_fma_f32 v[82:83], v[82:83], v[130:131], v[102:103] op_sel:[0,0,0] op_sel_hi:[1,0,0] neg_lo:[0,0,1] neg_hi:[0,0,1]
v_add_f32 v101, v108, v109
v_add_f32 v105, v110, v111
v_exp_f32 v242, v242
v_exp_f32 v82, v82
v_exp_f32 v243, v243
v_exp_f32 v83, v83
v_pk_fma_f32 v[244:245], v[84:85], v[130:131], v[106:107] op_sel:[0,1,1] op_sel_hi:[1,1,1] neg_lo:[1,0,0] neg_hi:[1,0,0]
v_pk_fma_f32 v[246:247], v[86:87], v[130:131], v[106:107] op_sel:[0,1,1] op_sel_hi:[1,1,1] neg_lo:[1,0,0] neg_hi:[1,0,0]
v_pk_add_f32 v[108:109], v[76:77], v[78:79]
v_pk_add_f32 v[110:111], v[236:237], v[238:239]
v_pk_fma_f32 v[84:85], v[84:85], v[130:131], v[102:103] op_sel:[0,1,1] op_sel_hi:[1,1,1] neg_lo:[0,0,1] neg_hi:[0,0,1]
v_pk_fma_f32 v[86:87], v[86:87], v[130:131], v[102:103] op_sel:[0,1,1] op_sel_hi:[1,1,1] neg_lo:[0,0,1] neg_hi:[0,0,1]
v_pk_fma_f32 v[248:249], v[88:89], v[130:131], v[106:107] op_sel:[0,1,1] op_sel_hi:[1,1,1] neg_lo:[1,0,0] neg_hi:[1,0,0]
v_pk_fma_f32 v[250:251], v[90:91], v[130:131], v[106:107] op_sel:[0,1,1] op_sel_hi:[1,1,1] neg_lo:[1,0,0] neg_hi:[1,0,0]
v_pk_add_f32 v[108:109], v[108:109], v[80:81]
v_pk_add_f32 v[110:111], v[110:111], v[240:241]
v_exp_f32 v244, v244
v_exp_f32 v84, v84
v_exp_f32 v245, v245
v_exp_f32 v85, v85
v_exp_f32 v246, v246
v_exp_f32 v86, v86
v_exp_f32 v247, v247
v_exp_f32 v87, v87
v_pk_fma_f32 v[88:89], v[88:89], v[130:131], v[102:103] op_sel:[0,1,1] op_sel_hi:[1,1,1] neg_lo:[0,0,1] neg_hi:[0,0,1]
v_pk_fma_f32 v[90:91], v[90:91], v[130:131], v[102:103] op_sel:[0,1,1] op_sel_hi:[1,1,1] neg_lo:[0,0,1] neg_hi:[0,0,1]
v_pk_add_f32 v[108:109], v[108:109], v[82:83]
v_pk_add_f32 v[110:111], v[110:111], v[242:243]
v_exp_f32 v248, v248
v_exp_f32 v88, v88
v_exp_f32 v249, v249
v_exp_f32 v89, v89
v_add_f32 v102, v108, v109
v_add_f32 v106, v110, v111
v_exp_f32 v250, v250
v_exp_f32 v90, v90
v_exp_f32 v251, v251
v_exp_f32 v91, v91
v_pk_add_f32 v[108:109], v[84:85], v[86:87]
v_pk_add_f32 v[110:111], v[244:245], v[246:247]
v_pk_add_f32 v[108:109], v[108:109], v[88:89]
v_pk_add_f32 v[110:111], v[110:111], v[248:249]
v_pk_add_f32 v[108:109], v[108:109], v[90:91]
v_pk_add_f32 v[110:111], v[110:111], v[250:251]
v_add_f32 v103, v108, v109
v_add_f32 v107, v110, v111
s_cmp_eq_u32 s51, 1
s_cbranch_scc1 chk_84
s_waitcnt vmcnt(0)
v_max_u32 v4, v212, v213
v_max3_u32 v4, v4, v214, v215
v_max3_u32 v4, v4, v216, v217
v_max3_u32 v4, v4, v218, v219
v_cmp_eq_u32 vcc, -1, v4
s_cbranch_vccz red_85
buffer_load_dwordx4 v[212:215], v18, s[32:35], s55 offen offset:0 sc1
buffer_load_dwordx4 v[216:219], v18, s[32:35], s55 offen offset:1024 sc1
s_branch chk_84
red_85:
v_mfma_f32_16x16x32_bf16 v[132:135], v[44:47], v[212:215], 0
v_mfma_f32_16x16x32_bf16 v[132:135], v[44:47], v[216:219], v[132:135]
s_mov_b32 s51, 1
s_nop 6
v_add_f32_dpp v132, v132, v132 row_ror:8 row_mask:0xf bank_mask:0xf
v_add_f32_dpp v133, v133, v133 row_ror:8 row_mask:0xf bank_mask:0xf
v_add_f32_dpp v134, v134, v134 row_ror:8 row_mask:0xf bank_mask:0xf
v_add_f32_dpp v135, v135, v135 row_ror:8 row_mask:0xf bank_mask:0xf
v_cvt_pk_bf16_f32 v132, v132, v133
v_cvt_pk_bf16_f32 v133, v134, v135
s_mov_b64 exec, 0x00ff00ff
buffer_store_dwordx2 v[132:133], v59, s[32:35], s79 offen sc1
s_mov_b64 exec, -1
buffer_load_dwordx4 v[204:207], v58, s[32:35], s56 offen sc1
buffer_load_dwordx4 v[208:211], v58, s[32:35], s57 offen sc1
chk_84:
.p2align 3
v_permlane32_swap_b32 v100, v101
v_permlane32_swap_b32 v102, v103
v_permlane32_swap_b32 v104, v105
v_permlane32_swap_b32 v106, v107
v_add_f32 v100, v100, v101
v_add_f32 v102, v102, v103
v_add_f32 v104, v104, v105
v_add_f32 v106, v106, v107
v_permlane16_swap_b32 v100, v102
s_nop 0
v_permlane16_swap_b32 v104, v106
v_add_f32 v100, v100, v102
v_add_f32 v104, v104, v106
v_rcp_f32 v100, v100
v_rcp_f32 v104, v104
v_mov_b32 v102, v100
v_mov_b32 v106, v104
s_nop 0
v_permlane16_swap_b32 v100, v102
v_permlane16_swap_b32 v104, v106
v_mov_b32 v101, v100
v_mov_b32 v103, v102
v_mov_b32 v105, v104
v_mov_b32 v107, v106
v_permlane32_swap_b32 v100, v101
v_permlane32_swap_b32 v102, v103
v_permlane32_swap_b32 v104, v105
v_permlane32_swap_b32 v106, v107
v_pk_mul_f32 v[60:61], v[60:61], v[100:101] op_sel:[0,0] op_sel_hi:[1,0]
v_pk_mul_f32 v[220:221], v[220:221], v[104:105] op_sel:[0,0] op_sel_hi:[1,0]
v_pk_mul_f32 v[68:69], v[68:69], v[100:101] op_sel:[0,1] op_sel_hi:[1,1]
v_pk_mul_f32 v[228:229], v[228:229], v[104:105] op_sel:[0,1] op_sel_hi:[1,1]
v_pk_mul_f32 v[76:77], v[76:77], v[102:103] op_sel:[0,0] op_sel_hi:[1,0]
v_pk_mul_f32 v[236:237], v[236:237], v[106:107] op_sel:[0,0] op_sel_hi:[1,0]
v_pk_mul_f32 v[84:85], v[84:85], v[102:103] op_sel:[0,1] op_sel_hi:[1,1]
v_pk_mul_f32 v[244:245], v[244:245], v[106:107] op_sel:[0,1] op_sel_hi:[1,1]
v_pk_mul_f32 v[62:63], v[62:63], v[100:101] op_sel:[0,0] op_sel_hi:[1,0]
v_pk_mul_f32 v[222:223], v[222:223], v[104:105] op_sel:[0,0] op_sel_hi:[1,0]
v_cvt_pk_bf16_f32 v60, v60, v61
v_cvt_pk_bf16_f32 v220, v220, v221
v_pk_mul_f32 v[70:71], v[70:71], v[100:101] op_sel:[0,1] op_sel_hi:[1,1]
v_pk_mul_f32 v[230:231], v[230:231], v[104:105] op_sel:[0,1] op_sel_hi:[1,1]
v_cvt_pk_bf16_f32 v68, v68, v69
v_cvt_pk_bf16_f32 v228, v228, v229
v_pk_mul_f32 v[78:79], v[78:79], v[102:103] op_sel:[0,0] op_sel_hi:[1,0]
v_pk_mul_f32 v[238:239], v[238:239], v[106:107] op_sel:[0,0] op_sel_hi:[1,0]
v_cvt_pk_bf16_f32 v76, v76, v77
v_cvt_pk_bf16_f32 v236, v236, v237
v_pk_mul_f32 v[86:87], v[86:87], v[102:103] op_sel:[0,1] op_sel_hi:[1,1]
v_pk_mul_f32 v[246:247], v[246:247], v[106:107] op_sel:[0,1] op_sel_hi:[1,1]
v_cvt_pk_bf16_f32 v84, v84, v85
v_cvt_pk_bf16_f32 v244, v244, v245
v_pk_mul_f32 v[64:65], v[64:65], v[100:101] op_sel:[0,0] op_sel_hi:[1,0]
v_pk_mul_f32 v[66:67], v[66:67], v[100:101] op_sel:[0,0] op_sel_hi:[1,0]
v_pk_mul_f32 v[224:225], v[224:225], v[104:105] op_sel:[0,0] op_sel_hi:[1,0]
v_pk_mul_f32 v[226:227], v[226:227], v[104:105] op_sel:[0,0] op_sel_hi:[1,0]
v_cvt_pk_bf16_f32 v61, v62, v63
v_cvt_pk_bf16_f32 v221, v222, v223
v_pk_mul_f32 v[72:73], v[72:73], v[100:101] op_sel:[0,1] op_sel_hi:[1,1]
v_pk_mul_f32 v[74:75], v[74:75], v[100:101] op_sel:[0,1] op_sel_hi:[1,1]
v_pk_mul_f32 v[232:233], v[232:233], v[104:105] op_sel:[0,1] op_sel_hi:[1,1]
v_pk_mul_f32 v[234:235], v[234:235], v[104:105] op_sel:[0,1] op_sel_hi:[1,1]
v_cvt_pk_bf16_f32 v69, v70, v71
v_cvt_pk_bf16_f32 v229, v230, v231
v_pk_mul_f32 v[80:81], v[80:81], v[102:103] op_sel:[0,0] op_sel_hi:[1,0]
v_pk_mul_f32 v[82:83], v[82:83], v[102:103] op_sel:[0,0] op_sel_hi:[1,0]
v_pk_mul_f32 v[240:241], v[240:241], v[106:107] op_sel:[0,0] op_sel_hi:[1,0]
v_pk_mul_f32 v[242:243], v[242:243], v[106:107] op_sel:[0,0] op_sel_hi:[1,0]
v_cvt_pk_bf16_f32 v77, v78, v79
v_cvt_pk_bf16_f32 v237, v238, v239
v_pk_mul_f32 v[88:89], v[88:89], v[102:103] op_sel:[0,1] op_sel_hi:[1,1]
v_pk_mul_f32 v[90:91], v[90:91], v[102:103] op_sel:[0,1] op_sel_hi:[1,1]
v_pk_mul_f32 v[248:249], v[248:249], v[106:107] op_sel:[0,1] op_sel_hi:[1,1]
v_pk_mul_f32 v[250:251], v[250:251], v[106:107] op_sel:[0,1] op_sel_hi:[1,1]
v_cvt_pk_bf16_f32 v85, v86, v87
v_cvt_pk_bf16_f32 v245, v246, v247
v_cvt_pk_bf16_f32 v62, v64, v65
v_cvt_pk_bf16_f32 v63, v66, v67
v_cvt_pk_bf16_f32 v222, v224, v225
v_cvt_pk_bf16_f32 v223, v226, v227
v_cvt_pk_bf16_f32 v70, v72, v73
v_cvt_pk_bf16_f32 v71, v74, v75
v_cvt_pk_bf16_f32 v230, v232, v233
v_cvt_pk_bf16_f32 v231, v234, v235
v_cvt_pk_bf16_f32 v78, v80, v81
v_cvt_pk_bf16_f32 v79, v82, v83
v_cvt_pk_bf16_f32 v238, v240, v241
v_cvt_pk_bf16_f32 v239, v242, v243
v_cvt_pk_bf16_f32 v86, v88, v89
v_cvt_pk_bf16_f32 v87, v90, v91
v_cvt_pk_bf16_f32 v246, v248, v249
v_cvt_pk_bf16_f32 v247, v250, v251
s_cmp_lg_u32 s51, 0
s_cbranch_scc1 else_86
s_mov_b32 s63, 0
sent_88:
s_waitcnt vmcnt(0)
v_max_u32 v4, v212, v213
v_max3_u32 v4, v4, v214, v215
v_max3_u32 v4, v4, v216, v217
v_max3_u32 v4, v4, v218, v219
v_cmp_eq_u32 vcc, -1, v4
s_cbranch_vccz sentd_89
buffer_load_dwordx4 v[212:215], v18, s[32:35], s55 offen offset:0 sc1
buffer_load_dwordx4 v[216:219], v18, s[32:35], s55 offen offset:1024 sc1
s_add_u32 s63, s63, 1
s_cmp_lt_u32 s63, 0x80000
s_cbranch_scc1 sent_88
s_waitcnt vmcnt(0)
sentd_89:
v_mfma_f32_16x16x32_bf16 v[132:135], v[44:47], v[212:215], 0
v_mfma_f32_16x16x32_bf16 v[132:135], v[44:47], v[216:219], v[132:135]
s_mov_b32 s51, 1
s_nop 6
v_add_f32_dpp v132, v132, v132 row_ror:8 row_mask:0xf bank_mask:0xf
v_add_f32_dpp v133, v133, v133 row_ror:8 row_mask:0xf bank_mask:0xf
v_add_f32_dpp v134, v134, v134 row_ror:8 row_mask:0xf bank_mask:0xf
v_add_f32_dpp v135, v135, v135 row_ror:8 row_mask:0xf bank_mask:0xf
v_cvt_pk_bf16_f32 v132, v132, v133
v_cvt_pk_bf16_f32 v133, v134, v135
s_mov_b64 exec, 0x00ff00ff
buffer_store_dwordx2 v[132:133], v59, s[32:35], s79 offen sc1
s_mov_b64 exec, -1
buffer_load_dwordx4 v[204:207], v58, s[32:35], s56 offen sc1
buffer_load_dwordx4 v[208:211], v58, s[32:35], s57 offen sc1
else_86:
s_mov_b32 s63, 0
sent_90:
s_waitcnt vmcnt(0)
v_max_u32 v4, v204, v205
v_max3_u32 v4, v4, v206, v207
v_max3_u32 v4, v4, v208, v209
v_max3_u32 v4, v4, v210, v211
v_cmp_eq_u32 vcc, -1, v4
s_cbranch_vccz sentd_91
buffer_load_dwordx4 v[204:207], v58, s[32:35], s56 offen sc1
buffer_load_dwordx4 v[208:211], v58, s[32:35], s57 offen sc1
s_add_u32 s63, s63, 1
s_cmp_lt_u32 s63, 0x80000
s_cbranch_scc1 sent_90
s_waitcnt vmcnt(0)
sentd_91:
v_mfma_f32_16x16x32_bf16 v[112:115], v[204:207], v[60:63], 0
v_mfma_f32_16x16x32_bf16 v[116:119], v[204:207], v[68:71], 0
v_mfma_f32_16x16x32_bf16 v[120:123], v[204:207], v[76:79], 0
v_mfma_f32_16x16x32_bf16 v[124:127], v[204:207], v[84:87], 0
v_mfma_f32_16x16x32_bf16 v[112:115], v[208:211], v[220:223], v[112:115]
v_mfma_f32_16x16x32_bf16 v[116:119], v[208:211], v[228:231], v[116:119]
v_mfma_f32_16x16x32_bf16 v[120:123], v[208:211], v[236:239], v[120:123]
v_mfma_f32_16x16x32_bf16 v[124:127], v[208:211], v[244:247], v[124:127]
s_nop 4
v_add_f32 v100, v112, v113
v_add_f32 v114, v114, v115
v_add_f32 v100, v100, v114
v_add_f32 v101, v116, v117
v_add_f32 v118, v118, v119
v_add_f32 v101, v101, v118
v_add_f32 v102, v120, v121
v_add_f32 v122, v122, v123
v_add_f32 v102, v102, v122
v_add_f32 v103, v124, v125
v_add_f32 v126, v126, v127
v_add_f32 v103, v103, v126
s_nop 1
v_permlane32_swap_b32 v100, v101
v_permlane32_swap_b32 v102, v103
v_add_f32 v100, v100, v101
v_add_f32 v102, v102, v103
s_nop 1
v_permlane16_swap_b32 v100, v102
s_nop 0
v_add_f32 v100, v100, v102
v_add_f32 v100, 0x358637bd, v100
v_rcp_f32 v100, v100
s_nop 0
v_mov_b32 v102, v100
s_nop 1
v_permlane16_swap_b32 v100, v102
s_nop 0
v_mov_b32 v101, v100
v_mov_b32 v103, v102
s_nop 0
v_permlane32_swap_b32 v100, v101
v_permlane32_swap_b32 v102, v103
buffer_load_dwordx4 v[188:191], v18, s[32:35], s58 offen offset:0 sc1
buffer_load_dwordx4 v[192:195], v18, s[32:35], s58 offen offset:1024 sc1
buffer_load_dwordx4 v[196:199], v18, s[32:35], s59 offen offset:0 sc1
buffer_load_dwordx4 v[200:203], v18, s[32:35], s59 offen offset:1024 sc1
s_mov_b32 s63, 0
sent_92:
s_waitcnt vmcnt(0)
v_max_u32 v4, v188, v189
v_max3_u32 v4, v4, v190, v191
v_max3_u32 v4, v4, v192, v193
v_max3_u32 v4, v4, v194, v195
v_max3_u32 v4, v4, v196, v197
v_max3_u32 v4, v4, v198, v199
v_max3_u32 v4, v4, v200, v201
v_max3_u32 v4, v4, v202, v203
v_cmp_eq_u32 vcc, -1, v4
s_cbranch_vccz sentd_93
buffer_load_dwordx4 v[188:191], v18, s[32:35], s58 offen offset:0 sc1
buffer_load_dwordx4 v[192:195], v18, s[32:35], s58 offen offset:1024 sc1
buffer_load_dwordx4 v[196:199], v18, s[32:35], s59 offen offset:0 sc1
buffer_load_dwordx4 v[200:203], v18, s[32:35], s59 offen offset:1024 sc1
s_add_u32 s63, s63, 1
s_cmp_lt_u32 s63, 0x80000
s_cbranch_scc1 sent_92
s_waitcnt vmcnt(0)
sentd_93:
s_cmp_eq_u32 s46, 0
s_cbranch_scc1 slow_94
.p2align 3
v_mfma_f32_16x16x32_bf16 v[156:159], v[188:191], v[60:63], 0
v_mfma_f32_16x16x32_bf16 v[164:167], v[188:191], v[68:71], 0
v_mfma_f32_16x16x32_bf16 v[160:163], v[192:195], v[60:63], 0
v_mfma_f32_16x16x32_bf16 v[172:175], v[188:191], v[76:79], 0
v_mfma_f32_16x16x32_bf16 v[168:171], v[192:195], v[68:71], 0
v_mfma_f32_16x16x32_bf16 v[180:183], v[188:191], v[84:87], 0
v_mfma_f32_16x16x32_bf16 v[156:159], v[196:199], v[220:223], v[156:159]
v_mfma_f32_16x16x32_bf16 v[176:179], v[192:195], v[76:79], 0
v_mfma_f32_16x16x32_bf16 v[164:167], v[196:199], v[228:231], v[164:167]
v_mfma_f32_16x16x32_bf16 v[184:187], v[192:195], v[84:87], 0
v_mfma_f32_16x16x32_bf16 v[160:163], v[200:203], v[220:223], v[160:163]
v_mfma_f32_16x16x32_bf16 v[172:175], v[196:199], v[236:239], v[172:175]
v_mfma_f32_16x16x32_bf16 v[168:171], v[200:203], v[228:231], v[168:171]
v_mfma_f32_16x16x32_bf16 v[180:183], v[196:199], v[244:247], v[180:183]
v_mfma_f32_16x16x32_bf16 v[176:179], v[200:203], v[236:239], v[176:179]
v_mfma_f32_16x16x32_bf16 v[184:187], v[200:203], v[244:247], v[184:187]
v_pk_mul_f32 v[156:157], v[156:157], v[100:101] op_sel:[0,0] op_sel_hi:[1,0]
v_pk_mul_f32 v[158:159], v[158:159], v[100:101] op_sel:[0,0] op_sel_hi:[1,0]
v_cvt_pk_bf16_f32 v156, v156, v157
v_pk_mul_f32 v[164:165], v[164:165], v[100:101] op_sel:[0,1] op_sel_hi:[1,1]
v_pk_mul_f32 v[160:161], v[160:161], v[100:101] op_sel:[0,0] op_sel_hi:[1,0]
v_pk_mul_f32 v[162:163], v[162:163], v[100:101] op_sel:[0,0] op_sel_hi:[1,0]
v_cvt_pk_bf16_f32 v157, v158, v159
v_pk_mul_f32 v[166:167], v[166:167], v[100:101] op_sel:[0,1] op_sel_hi:[1,1]
v_cvt_pk_bf16_f32 v164, v164, v165
v_pk_mul_f32 v[172:173], v[172:173], v[102:103] op_sel:[0,0] op_sel_hi:[1,0]
v_cvt_pk_bf16_f32 v158, v160, v161
v_cvt_pk_bf16_f32 v159, v162, v163
v_pk_mul_f32 v[168:169], v[168:169], v[100:101] op_sel:[0,1] op_sel_hi:[1,1]
v_pk_mul_f32 v[170:171], v[170:171], v[100:101] op_sel:[0,1] op_sel_hi:[1,1]
v_cvt_pk_bf16_f32 v165, v166, v167
v_pk_mul_f32 v[174:175], v[174:175], v[102:103] op_sel:[0,0] op_sel_hi:[1,0]
v_cvt_pk_bf16_f32 v172, v172, v173
v_pk_mul_f32 v[180:181], v[180:181], v[102:103] op_sel:[0,1] op_sel_hi:[1,1]
buffer_store_dwordx4 v[156:159], v18, s[32:35], s80 offen
v_cvt_pk_bf16_f32 v166, v168, v169
v_cvt_pk_bf16_f32 v167, v170, v171
v_pk_mul_f32 v[176:177], v[176:177], v[102:103] op_sel:[0,0] op_sel_hi:[1,0]
v_pk_mul_f32 v[178:179], v[178:179], v[102:103] op_sel:[0,0] op_sel_hi:[1,0]
v_cvt_pk_bf16_f32 v173, v174, v175
v_pk_mul_f32 v[182:183], v[182:183], v[102:103] op_sel:[0,1] op_sel_hi:[1,1]
v_cvt_pk_bf16_f32 v180, v180, v181
buffer_store_dwordx4 v[164:167], v18, s[32:35], s81 offen
v_cvt_pk_bf16_f32 v174, v176, v177
v_cvt_pk_bf16_f32 v175, v178, v179
v_pk_mul_f32 v[184:185], v[184:185], v[102:103] op_sel:[0,1] op_sel_hi:[1,1]
v_pk_mul_f32 v[186:187], v[186:187], v[102:103] op_sel:[0,1] op_sel_hi:[1,1]
v_cvt_pk_bf16_f32 v181, v182, v183
buffer_store_dwordx4 v[172:175], v18, s[32:35], s82 offen
v_cvt_pk_bf16_f32 v182, v184, v185
v_cvt_pk_bf16_f32 v183, v186, v187
buffer_store_dwordx4 v[180:183], v18, s[32:35], s83 offen
back_95:
s_barrier
v_and_b32 v36, 31, v0
v_lshlrev_b32 v36, 2, v36
s_lshl_b32 s62, s45, 2
v_mov_b32 v4, s62
v_mov_b32 v5, 2
s_mov_b64 exec, 1
s_waitcnt vmcnt(0)
s_cmp_eq_u32 s46, 0
s_cbranch_scc1 slow_96
buffer_store_dword v5, v4, s[32:35], s84 offen
back_97:
s_mov_b64 exec, -1
v_lshrrev_b32 v4, 2, v2
v_and_b32 v5, 3, v0
v_lshl_add_u32 v6, v3, 3, v4
v_lshlrev_b32 v6, 7, v6
v_lshl_add_u32 v6, v5, 3, v6
v_lshrrev_b32 v7, 1, v4
v_and_b32 v8, 1, v3
v_lshl_add_u32 v7, v8, 1, v7
v_lshl_add_u32 v10, v7, 5, v6
v_xor_b32 v11, 32, v10
v_xor_b32 v12, 64, v10
v_xor_b32 v13, 96, v10
v_add_u32 v14, 0x10000, v10
v_add_u32 v15, 0x10000, v11
v_add_u32 v16, 0x10000, v12
v_add_u32 v17, 0x10000, v13
ds_read_b64_tr_b16 v[220:221], v10 offset:0
ds_read_b64_tr_b16 v[222:223], v10 offset:512
ds_read_b64_tr_b16 v[224:225], v11 offset:0
ds_read_b64_tr_b16 v[226:227], v11 offset:512
ds_read_b64_tr_b16 v[228:229], v12 offset:0
ds_read_b64_tr_b16 v[230:231], v12 offset:512
ds_read_b64_tr_b16 v[232:233], v13 offset:0
ds_read_b64_tr_b16 v[234:235], v13 offset:512
ds_read_b64_tr_b16 v[236:237], v10 offset:4096
ds_read_b64_tr_b16 v[238:239], v10 offset:4608
ds_read_b64_tr_b16 v[240:241], v11 offset:4096
ds_read_b64_tr_b16 v[242:243], v11 offset:4608
ds_read_b64_tr_b16 v[244:245], v12 offset:4096
ds_read_b64_tr_b16 v[246:247], v12 offset:4608
ds_read_b64_tr_b16 v[248:249], v13 offset:4096
ds_read_b64_tr_b16 v[250:251], v13 offset:4608
s_lshl_b32 s48, s41, 3
s_lshl_b32 s49, s40, 1
s_add_u32 s48, s48, s49
s_lshl_b32 s48, s48, 15
s_add_u32 s48, s48, 4194304
v_add_u32 v38, s48, v18
v_add_u32 v39, 32768, v38
s_lshl_b32 s57, s75, 11
s_add_u32 s87, s87, 262144
v_lshlrev_b32 v60, 16, v20
v_and_b32 v61, 0xffff0000, v20
v_lshlrev_b32 v62, 16, v21
v_and_b32 v63, 0xffff0000, v21
v_lshlrev_b32 v64, 16, v22
v_and_b32 v65, 0xffff0000, v22
v_lshlrev_b32 v66, 16, v23
v_and_b32 v67, 0xffff0000, v23
v_lshlrev_b32 v68, 16, v24
v_and_b32 v69, 0xffff0000, v24
v_lshlrev_b32 v70, 16, v25
v_and_b32 v71, 0xffff0000, v25
v_lshlrev_b32 v72, 16, v26
v_and_b32 v73, 0xffff0000, v26
v_lshlrev_b32 v74, 16, v27
v_and_b32 v75, 0xffff0000, v27
v_lshlrev_b32 v76, 16, v28
v_and_b32 v77, 0xffff0000, v28
v_lshlrev_b32 v78, 16, v29
v_and_b32 v79, 0xffff0000, v29
v_lshlrev_b32 v80, 16, v30
v_and_b32 v81, 0xffff0000, v30
v_lshlrev_b32 v82, 16, v31
v_and_b32 v83, 0xffff0000, v31
v_lshlrev_b32 v84, 16, v32
v_and_b32 v85, 0xffff0000, v32
v_lshlrev_b32 v86, 16, v33
v_and_b32 v87, 0xffff0000, v33
v_lshlrev_b32 v88, 16, v34
v_and_b32 v89, 0xffff0000, v34
v_lshlrev_b32 v90, 16, v35
v_and_b32 v91, 0xffff0000, v35
v_mov_b32 v6, 0
v_mov_b32 v7, 0
v_mov_b32 v8, 0
v_mov_b32 v9, 0
s_lshl_b32 s62, s42, 2
v_mov_b32 v4, s62
v_mov_b32 v5, 2
buffer_load_dword v37, v36, s[32:35], s84 offen sc1
s_mov_b32 s63, 0
s_waitcnt vmcnt(0)
poll_98:
v_cmp_gt_u32 vcc, 2, v37
s_cbranch_vccz polled_99
buffer_load_dword v37, v36, s[32:35], s84 offen sc1
s_add_u32 s63, s63, 1
s_cmp_lt_u32 s63, 0x80000
s_waitcnt vmcnt(0)
s_cbranch_scc1 poll_98
polled_99:
s_call_b64 s[94:95], R_oloop
s_cmp_eq_u32 s46, 0
s_cbranch_scc1 slow_100
s_nop 0
v_cvt_pk_bf16_f32 v20, v60, v61
v_cvt_pk_bf16_f32 v21, v62, v63
v_cvt_pk_bf16_f32 v22, v64, v65
v_cvt_pk_bf16_f32 v23, v66, v67
buffer_store_dwordx4 v[20:23], v18, s[32:35], s85 offen offset:0
v_cvt_pk_bf16_f32 v24, v68, v69
v_cvt_pk_bf16_f32 v25, v70, v71
v_cvt_pk_bf16_f32 v26, v72, v73
v_cvt_pk_bf16_f32 v27, v74, v75
buffer_store_dwordx4 v[24:27], v18, s[32:35], s85 offen offset:1024
v_cvt_pk_bf16_f32 v28, v76, v77
v_cvt_pk_bf16_f32 v29, v78, v79
v_cvt_pk_bf16_f32 v30, v80, v81
v_cvt_pk_bf16_f32 v31, v82, v83
buffer_store_dwordx4 v[28:31], v18, s[32:35], s86 offen offset:0
v_cvt_pk_bf16_f32 v32, v84, v85
v_cvt_pk_bf16_f32 v33, v86, v87
v_cvt_pk_bf16_f32 v34, v88, v89
v_cvt_pk_bf16_f32 v35, v90, v91
buffer_store_dwordx4 v[32:35], v18, s[32:35], s86 offen offset:1024
s_barrier
v_dot2c_f32_bf16 v6, v20, v48
v_dot2c_f32_bf16 v8, v20, v20
v_dot2c_f32_bf16 v7, v28, v48
v_dot2c_f32_bf16 v9, v28, v28
v_dot2c_f32_bf16 v6, v21, v48
v_dot2c_f32_bf16 v8, v21, v21
v_dot2c_f32_bf16 v7, v29, v48
v_dot2c_f32_bf16 v9, v29, v29
v_dot2c_f32_bf16 v6, v22, v48
v_dot2c_f32_bf16 v8, v22, v22
v_dot2c_f32_bf16 v7, v30, v48
v_dot2c_f32_bf16 v9, v30, v30
v_dot2c_f32_bf16 v6, v23, v48
v_dot2c_f32_bf16 v8, v23, v23
v_dot2c_f32_bf16 v7, v31, v48
v_dot2c_f32_bf16 v9, v31, v31
v_dot2c_f32_bf16 v6, v24, v48
v_dot2c_f32_bf16 v8, v24, v24
v_dot2c_f32_bf16 v7, v32, v48
v_dot2c_f32_bf16 v9, v32, v32
v_dot2c_f32_bf16 v6, v25, v48
v_dot2c_f32_bf16 v8, v25, v25
v_dot2c_f32_bf16 v7, v33, v48
v_dot2c_f32_bf16 v9, v33, v33
v_dot2c_f32_bf16 v6, v26, v48
v_dot2c_f32_bf16 v8, v26, v26
v_dot2c_f32_bf16 v7, v34, v48
v_dot2c_f32_bf16 v9, v34, v34
v_dot2c_f32_bf16 v6, v27, v48
v_dot2c_f32_bf16 v8, v27, v27
v_dot2c_f32_bf16 v7, v35, v48
v_dot2c_f32_bf16 v9, v35, v35
s_mov_b64 exec, 1
s_waitcnt vmcnt(0)
buffer_store_dword v5, v4, s[32:35], s88 offen
s_mov_b64 exec, -1
s_nop 1
v_permlane32_swap_b32 v6, v7
v_permlane32_swap_b32 v8, v9
v_add_f32 v6, v6, v7
v_add_f32 v8, v8, v9
s_nop 1
v_permlane16_swap_b32 v6, v8
s_nop 0
v_add_f32 v6, v6, v8
buffer_store_dword v6, v1, s[32:35], s87 offen
back_101:
s_lshl_b32 s49, s44, 13
v_add_u32 v10, s49, v18
v_add_u32 v11, 1024, v10
s_lshl_b32 s48, s43, 1
v_lshrrev_b32 v4, 2, v2
v_and_b32 v5, 3, v0
v_lshl_add_u32 v6, v3, 3, v4
v_lshlrev_b32 v6, 7, v6
v_lshl_add_u32 v6, v5, 3, v6
v_lshrrev_b32 v7, 1, v4
v_and_b32 v8, 1, v3
v_lshl_add_u32 v7, v8, 1, v7
v_xor_b32 v7, s48, v7
v_lshl_add_u32 v12, v7, 5, v6
v_add_u32 v12, 16384, v12
v_xor_b32 v13, 32, v12
v_mov_b32 v14, v10
v_mov_b32 v15, v11
v_add_u32 v16, 122880, v12
v_add_u32 v17, 122880, v13
v_mov_b32 v156, 0
v_mov_b32 v157, 0
v_mov_b32 v158, 0
v_mov_b32 v159, 0
v_mov_b32 v160, 0
v_mov_b32 v161, 0
v_mov_b32 v162, 0
v_mov_b32 v163, 0
v_mov_b32 v164, 0
v_mov_b32 v165, 0
v_mov_b32 v166, 0
v_mov_b32 v167, 0
v_mov_b32 v168, 0
v_mov_b32 v169, 0
v_mov_b32 v170, 0
v_mov_b32 v171, 0
v_mov_b32 v172, 0
v_mov_b32 v173, 0
v_mov_b32 v174, 0
v_mov_b32 v175, 0
v_mov_b32 v176, 0
v_mov_b32 v177, 0
v_mov_b32 v178, 0
v_mov_b32 v179, 0
v_mov_b32 v180, 0
v_mov_b32 v181, 0
v_mov_b32 v182, 0
v_mov_b32 v183, 0
v_mov_b32 v184, 0
v_mov_b32 v185, 0
v_mov_b32 v186, 0
v_mov_b32 v187, 0
v_mov_b32 v188, 0
v_mov_b32 v189, 0
v_mov_b32 v190, 0
v_mov_b32 v191, 0
v_mov_b32 v192, 0
v_mov_b32 v193, 0
v_mov_b32 v194, 0
v_mov_b32 v195, 0
v_mov_b32 v196, 0
v_mov_b32 v197, 0
v_mov_b32 v198, 0
v_mov_b32 v199, 0
v_mov_b32 v200, 0
v_mov_b32 v201, 0
v_mov_b32 v202, 0
v_mov_b32 v203, 0
v_mov_b32 v204, 0
v_mov_b32 v205, 0
v_mov_b32 v206, 0
v_mov_b32 v207, 0
v_mov_b32 v208, 0
v_mov_b32 v209, 0
v_mov_b32 v210, 0
v_mov_b32 v211, 0
v_mov_b32 v212, 0
v_mov_b32 v213, 0
v_mov_b32 v214, 0
v_mov_b32 v215, 0
v_mov_b32 v216, 0
v_mov_b32 v217, 0
v_mov_b32 v218, 0
v_mov_b32 v219, 0
v_mov_b32 v220, 0
v_mov_b32 v221, 0
v_mov_b32 v222, 0
v_mov_b32 v223, 0
v_mov_b32 v224, 0
v_mov_b32 v225, 0
v_mov_b32 v226, 0
v_mov_b32 v227, 0
v_mov_b32 v228, 0
v_mov_b32 v229, 0
v_mov_b32 v230, 0
v_mov_b32 v231, 0
v_mov_b32 v232, 0
v_mov_b32 v233, 0
v_mov_b32 v234, 0
v_mov_b32 v235, 0
v_mov_b32 v236, 0
v_mov_b32 v237, 0
v_mov_b32 v238, 0
v_mov_b32 v239, 0
v_mov_b32 v240, 0
v_mov_b32 v241, 0
v_mov_b32 v242, 0
v_mov_b32 v243, 0
v_mov_b32 v244, 0
v_mov_b32 v245, 0
v_mov_b32 v246, 0
v_mov_b32 v247, 0
v_mov_b32 v248, 0
v_mov_b32 v249, 0
v_mov_b32 v250, 0
v_mov_b32 v251, 0
s_mov_b32 s48, 0xf149f2ca
v_mov_b32 v9, s48
v_lshlrev_b32 v4, 2, v3
v_sub_u32 v4, v2, v4
v_subrev_u32 v5, 0, v4
v_and_b32 v6, 0x80000001, v5
v_cmp_eq_u32 vcc, 0, v6
v_add_u32 v5, 1, v5
v_and_b32 v6, 0x80000001, v5
v_cndmask_b32 v40, v9, 0, vcc
v_cmp_eq_u32 vcc, 0x80000001, v6
s_nop 1
v_cndmask_b32 v36, v9, 0, vcc
v_subrev_u32 v5, 1, v4
v_and_b32 v6, 0x80000001, v5
v_cmp_eq_u32 vcc, 0, v6
v_add_u32 v5, 1, v5
v_and_b32 v6, 0x80000001, v5
v_cndmask_b32 v41, v9, 0, vcc
v_cmp_eq_u32 vcc, 0x80000001, v6
s_nop 1
v_cndmask_b32 v37, v9, 0, vcc
v_subrev_u32 v5, 2, v4
v_and_b32 v6, 0x80000001, v5
v_cmp_eq_u32 vcc, 0, v6
v_add_u32 v5, 1, v5
v_and_b32 v6, 0x80000001, v5
v_cndmask_b32 v42, v9, 0, vcc
v_cmp_eq_u32 vcc, 0x80000001, v6
s_nop 1
v_cndmask_b32 v38, v9, 0, vcc
v_subrev_u32 v5, 3, v4
v_and_b32 v6, 0x80000001, v5
v_cmp_eq_u32 vcc, 0, v6
v_add_u32 v5, 1, v5
v_and_b32 v6, 0x80000001, v5
v_cndmask_b32 v43, v9, 0, vcc
v_cmp_eq_u32 vcc, 0x80000001, v6
s_nop 1
v_cndmask_b32 v39, v9, 0, vcc
s_or_b32 s48, s41, s44
s_cmp_eq_u32 s48, 0
s_cselect_b64 vcc, -1, 0
v_cndmask_b32 v44, v36, v9, vcc
v_cndmask_b32 v45, v37, v9, vcc
v_cndmask_b32 v46, v38, v9, vcc
v_cndmask_b32 v47, v39, v9, vcc
v_and_b32 v4, 1, v2
v_lshlrev_b32 v4, 4, v4
v_mov_b32 v5, 0xffff
v_lshlrev_b32 v52, v4, v5
s_lshl_b32 s48, s43, 11
s_add_u32 s48, s48, 135168
v_add_u32 v53, s48, v18
v_lshl_add_u32 v55, v0, 3, s48
s_add_u32 s48, s41, s44
s_sub_u32 s48, s48, 1
s_lshl_b32 s49, s48, 1
s_add_u32 s49, s49, s43
s_lshl_b32 s49, s49, 11
s_mul_i32 s50, s42, 65536
s_add_u32 s49, s49, s50
s_add_u32 s49, s49, 8388608
s_cmp_lt_i32 s48, 0
s_cselect_b32 s49, 0xf0000000, s49
v_add_u32 v58, s49, v18
v_lshl_add_u32 v59, v0, 3, s49
s_lshl_b32 s48, s43, 2
s_add_u32 s48, s48, 134672
v_mov_b32 v19, s48
s_lshl_b32 s48, s43, 7
s_add_u32 s48, s48, 133120
v_lshl_add_u32 v7, v3, 4, s48
v_lshl_add_u32 v54, v2, 2, s48
s_lshl_b32 s49, s44, 6
v_add_u32 v8, s49, v2
v_lshlrev_b32 v8, 3, v8
v_add_u32 v8, 131072, v8
v_lshl_add_u32 v9, v3, 2, s49
v_lshlrev_b32 v9, 2, v9
v_add_u32 v9, 132096, v9
s_mov_b32 s64, 0
s_mov_b32 s65, 0
s_mov_b32 s66, 0x3e8293ee
s_mov_b32 s61, 3
ds_read_b64_tr_b16 v[84:85], v16 offset:8192
ds_read_b64_tr_b16 v[86:87], v16 offset:8704
ds_read_b64_tr_b16 v[88:89], v17 offset:8192
ds_read_b64_tr_b16 v[90:91], v17 offset:8704
ds_read_b64_tr_b16 v[92:93], v16 offset:16384
ds_read_b64_tr_b16 v[94:95], v16 offset:16896
ds_read_b64_tr_b16 v[96:97], v17 offset:16384
ds_read_b64_tr_b16 v[98:99], v17 offset:16896
ds_read_b64_tr_b16 v[76:77], v16 offset:0
ds_read_b64_tr_b16 v[78:79], v16 offset:512
ds_read_b64_tr_b16 v[80:81], v17 offset:0
ds_read_b64_tr_b16 v[82:83], v17 offset:512
s_barrier
ds_read_b128 v[60:63], v14 offset:0
ds_read_b128 v[64:67], v14 offset:2048
ds_read_b128 v[68:71], v14 offset:4096
ds_read_b128 v[72:75], v14 offset:6144
s_waitcnt lgkmcnt(0)
c2_loop:
v_mfma_f32_16x16x32_bf16 v[212:215], v[84:87], v[72:75], v[212:215]
ds_read_b128 v[100:103], v15 offset:0
v_mfma_f32_16x16x32_bf16 v[204:207], v[84:87], v[68:71], v[204:207]
ds_read_b128 v[104:107], v15 offset:2048
v_mfma_f32_16x16x32_bf16 v[196:199], v[84:87], v[64:67], v[196:199]
ds_read_b128 v[108:111], v15 offset:4096
v_mfma_f32_16x16x32_bf16 v[188:191], v[84:87], v[60:63], v[188:191]
ds_read_b128 v[112:115], v15 offset:6144
v_mfma_f32_16x16x32_bf16 v[192:195], v[88:91], v[60:63], v[192:195]
ds_read_b64_tr_b16 v[124:125], v16 offset:12288
v_mfma_f32_16x16x32_bf16 v[200:203], v[88:91], v[64:67], v[200:203]
ds_read_b64_tr_b16 v[126:127], v16 offset:12800
v_mfma_f32_16x16x32_bf16 v[208:211], v[88:91], v[68:71], v[208:211]
ds_read_b64_tr_b16 v[128:129], v17 offset:12288
v_mfma_f32_16x16x32_bf16 v[216:219], v[88:91], v[72:75], v[216:219]
ds_read_b64_tr_b16 v[130:131], v17 offset:12800
v_mfma_f32_16x16x32_bf16 v[244:247], v[72:75], v[92:95], v[244:247]
ds_read_b64_tr_b16 v[132:133], v16 offset:20480
v_mfma_f32_16x16x32_bf16 v[248:251], v[72:75], v[96:99], v[248:251]
ds_read_b64_tr_b16 v[134:135], v16 offset:20992
v_mfma_f32_16x16x32_bf16 v[240:243], v[68:71], v[96:99], v[240:243]
ds_read_b64_tr_b16 v[136:137], v17 offset:20480
v_mfma_f32_16x16x32_bf16 v[236:239], v[68:71], v[92:95], v[236:239]
ds_read_b64_tr_b16 v[138:139], v17 offset:20992
v_mfma_f32_16x16x32_bf16 v[228:231], v[64:67], v[92:95], v[228:231]
ds_read_b64_tr_b16 v[116:117], v16 offset:4096
v_mfma_f32_16x16x32_bf16 v[232:235], v[64:67], v[96:99], v[232:235]
ds_read_b64_tr_b16 v[118:119], v16 offset:4608
v_mfma_f32_16x16x32_bf16 v[224:227], v[60:63], v[96:99], v[224:227]
ds_read_b64_tr_b16 v[120:121], v17 offset:4096
v_mfma_f32_16x16x32_bf16 v[220:223], v[60:63], v[92:95], v[220:223]
ds_read_b64_tr_b16 v[122:123], v17 offset:4608
v_mfma_f32_16x16x32_bf16 v[156:159], v[76:79], v[60:63], v[156:159]
s_add_u32 s65, s65, 40960
s_cmp_eq_u32 s65, 122880
v_mfma_f32_16x16x32_bf16 v[164:167], v[76:79], v[64:67], v[164:167]
s_cselect_b32 s65, 0, s65
s_add_u32 s64, s64, 1
v_mfma_f32_16x16x32_bf16 v[172:175], v[76:79], v[68:71], v[172:175]
v_add_u32 v14, s65, v10
v_add_u32 v15, s65, v11
v_mfma_f32_16x16x32_bf16 v[180:183], v[76:79], v[72:75], v[180:183]
v_add_u32 v16, s65, v12
v_add_u32 v17, s65, v13
v_mfma_f32_16x16x32_bf16 v[184:187], v[80:83], v[72:75], v[184:187]
v_mfma_f32_16x16x32_bf16 v[176:179], v[80:83], v[68:71], v[176:179]
s_cmp_eq_u32 s64, 16
s_cbranch_scc1 c2_last
v_mfma_f32_16x16x32_bf16 v[168:171], v[80:83], v[64:67], v[168:171]
s_waitcnt lgkmcnt(0)
v_mfma_f32_16x16x32_bf16 v[160:163], v[80:83], v[60:63], v[160:163]
s_barrier
v_mfma_f32_16x16x32_bf16 v[212:215], v[124:127], v[112:115], v[212:215]
ds_read_b128 v[60:63], v14 offset:0
v_mfma_f32_16x16x32_bf16 v[204:207], v[124:127], v[108:111], v[204:207]
ds_read_b128 v[64:67], v14 offset:2048
v_mfma_f32_16x16x32_bf16 v[196:199], v[124:127], v[104:107], v[196:199]
ds_read_b128 v[68:71], v14 offset:4096
v_mfma_f32_16x16x32_bf16 v[188:191], v[124:127], v[100:103], v[188:191]
ds_read_b128 v[72:75], v14 offset:6144
v_mfma_f32_16x16x32_bf16 v[192:195], v[128:131], v[100:103], v[192:195]
ds_read_b64_tr_b16 v[84:85], v16 offset:8192
v_mfma_f32_16x16x32_bf16 v[200:203], v[128:131], v[104:107], v[200:203]
ds_read_b64_tr_b16 v[86:87], v16 offset:8704
v_mfma_f32_16x16x32_bf16 v[208:211], v[128:131], v[108:111], v[208:211]
ds_read_b64_tr_b16 v[88:89], v17 offset:8192
v_mfma_f32_16x16x32_bf16 v[216:219], v[128:131], v[112:115], v[216:219]
ds_read_b64_tr_b16 v[90:91], v17 offset:8704
v_mfma_f32_16x16x32_bf16 v[244:247], v[112:115], v[132:135], v[244:247]
ds_read_b64_tr_b16 v[92:93], v16 offset:16384
v_mfma_f32_16x16x32_bf16 v[248:251], v[112:115], v[136:139], v[248:251]
ds_read_b64_tr_b16 v[94:95], v16 offset:16896
v_mfma_f32_16x16x32_bf16 v[240:243], v[108:111], v[136:139], v[240:243]
ds_read_b64_tr_b16 v[96:97], v17 offset:16384
v_mfma_f32_16x16x32_bf16 v[236:239], v[108:111], v[132:135], v[236:239]
ds_read_b64_tr_b16 v[98:99], v17 offset:16896
v_mfma_f32_16x16x32_bf16 v[228:231], v[104:107], v[132:135], v[228:231]
ds_read_b64_tr_b16 v[76:77], v16 offset:0
v_mfma_f32_16x16x32_bf16 v[232:235], v[104:107], v[136:139], v[232:235]
ds_read_b64_tr_b16 v[78:79], v16 offset:512
v_mfma_f32_16x16x32_bf16 v[224:227], v[100:103], v[136:139], v[224:227]
ds_read_b64_tr_b16 v[80:81], v17 offset:0
v_mfma_f32_16x16x32_bf16 v[220:223], v[100:103], v[132:135], v[220:223]
ds_read_b64_tr_b16 v[82:83], v17 offset:512
v_mfma_f32_16x16x32_bf16 v[156:159], v[116:119], v[100:103], v[156:159]
v_mfma_f32_16x16x32_bf16 v[164:167], v[116:119], v[104:107], v[164:167]
v_mfma_f32_16x16x32_bf16 v[172:175], v[116:119], v[108:111], v[172:175]
v_mfma_f32_16x16x32_bf16 v[180:183], v[116:119], v[112:115], v[180:183]
v_mfma_f32_16x16x32_bf16 v[184:187], v[120:123], v[112:115], v[184:187]
v_mfma_f32_16x16x32_bf16 v[176:179], v[120:123], v[108:111], v[176:179]
v_mfma_f32_16x16x32_bf16 v[168:171], v[120:123], v[104:107], v[168:171]
s_waitcnt lgkmcnt(0)
v_mfma_f32_16x16x32_bf16 v[160:163], v[120:123], v[100:103], v[160:163]
s_branch c2_loop
c2_last:
v_mfma_f32_16x16x32_bf16 v[168:171], v[80:83], v[64:67], v[168:171]
s_waitcnt lgkmcnt(0)
v_mfma_f32_16x16x32_bf16 v[160:163], v[80:83], v[60:63], v[160:163]
v_mfma_f32_16x16x32_bf16 v[212:215], v[124:127], v[112:115], v[212:215]
ds_read_b128 v[140:143], v7 offset:0
v_mfma_f32_16x16x32_bf16 v[204:207], v[124:127], v[108:111], v[204:207]
ds_read_b128 v[144:147], v7 offset:64
v_mfma_f32_16x16x32_bf16 v[196:199], v[124:127], v[104:107], v[196:199]
ds_read_b128 v[148:151], v7 offset:256
v_mfma_f32_16x16x32_bf16 v[188:191], v[124:127], v[100:103], v[188:191]
ds_read_b128 v[152:155], v7 offset:320
v_mfma_f32_16x16x32_bf16 v[192:195], v[128:131], v[100:103], v[192:195]
ds_read2_b32 v[56:57], v54 offset0:128 offset1:144
v_mfma_f32_16x16x32_bf16 v[200:203], v[128:131], v[104:107], v[200:203]
v_mfma_f32_16x16x32_bf16 v[208:211], v[128:131], v[108:111], v[208:211]
v_mfma_f32_16x16x32_bf16 v[216:219], v[128:131], v[112:115], v[216:219]
s_barrier
v_mfma_f32_16x16x32_bf16 v[244:247], v[112:115], v[132:135], v[244:247]
ds_read_b64 v[92:93], v8 offset:0
v_mfma_f32_16x16x32_bf16 v[248:251], v[112:115], v[136:139], v[248:251]
ds_read_b64 v[94:95], v8 offset:128
v_mfma_f32_16x16x32_bf16 v[240:243], v[108:111], v[136:139], v[240:243]
ds_read_b64 v[96:97], v8 offset:256
v_mfma_f32_16x16x32_bf16 v[236:239], v[108:111], v[132:135], v[236:239]
ds_read_b64 v[98:99], v8 offset:384
v_mfma_f32_16x16x32_bf16 v[228:231], v[104:107], v[132:135], v[228:231]
ds_read_b128 v[60:63], v9 offset:0
v_mfma_f32_16x16x32_bf16 v[232:235], v[104:107], v[136:139], v[232:235]
ds_read_b128 v[64:67], v9 offset:64
v_mfma_f32_16x16x32_bf16 v[224:227], v[100:103], v[136:139], v[224:227]
ds_read_b128 v[68:71], v9 offset:128
v_mfma_f32_16x16x32_bf16 v[220:223], v[100:103], v[132:135], v[220:223]
ds_read_b128 v[72:75], v9 offset:192
v_mfma_f32_16x16x32_bf16 v[156:159], v[116:119], v[100:103], v[156:159]
ds_read_b128 v[76:79], v9 offset:512
v_mfma_f32_16x16x32_bf16 v[164:167], v[116:119], v[104:107], v[164:167]
ds_read_b128 v[80:83], v9 offset:576
v_mfma_f32_16x16x32_bf16 v[172:175], v[116:119], v[108:111], v[172:175]
ds_read_b128 v[84:87], v9 offset:640
v_mfma_f32_16x16x32_bf16 v[180:183], v[116:119], v[112:115], v[180:183]
ds_read_b128 v[88:91], v9 offset:704
v_mfma_f32_16x16x32_bf16 v[184:187], v[120:123], v[112:115], v[184:187]
v_mfma_f32_16x16x32_bf16 v[176:179], v[120:123], v[108:111], v[176:179]
v_mfma_f32_16x16x32_bf16 v[168:171], v[120:123], v[104:107], v[168:171]
v_mfma_f32_16x16x32_bf16 v[160:163], v[120:123], v[100:103], v[160:163]
c2_epi:
s_waitcnt lgkmcnt(0)
.p2align 3
v_pk_fma_f32 v[212:213], v[148:149], v[98:99], v[212:213] op_sel:[0,1,0] op_sel_hi:[1,1,1]
v_pk_fma_f32 v[214:215], v[150:151], v[98:99], v[214:215] op_sel:[0,1,0] op_sel_hi:[1,1,1]
v_pk_fma_f32 v[216:217], v[152:153], v[98:99], v[216:217] op_sel:[0,1,0] op_sel_hi:[1,1,1]
v_pk_fma_f32 v[218:219], v[154:155], v[98:99], v[218:219] op_sel:[0,1,0] op_sel_hi:[1,1,1]
v_pk_mul_f32 v[212:213], v[212:213], v[98:99] op_sel:[0,0] op_sel_hi:[1,0]
v_pk_mul_f32 v[214:215], v[214:215], v[98:99] op_sel:[0,0] op_sel_hi:[1,0]
v_pk_mul_f32 v[216:217], v[216:217], v[98:99] op_sel:[0,0] op_sel_hi:[1,0]
v_pk_mul_f32 v[218:219], v[218:219], v[98:99] op_sel:[0,0] op_sel_hi:[1,0]
v_cvt_pk_bf16_f32 v212, v212, v213
v_cvt_pk_bf16_f32 v213, v214, v215
v_cvt_pk_bf16_f32 v214, v216, v217
v_cvt_pk_bf16_f32 v215, v218, v219
v_pk_fma_f32 v[244:245], v[88:89], v[56:57], v[244:245] op_sel:[0,0,0] op_sel_hi:[1,0,1]
v_pk_fma_f32 v[246:247], v[90:91], v[56:57], v[246:247] op_sel:[0,0,0] op_sel_hi:[1,0,1]
v_pk_mul_f32 v[244:245], v[244:245], v[72:73]
v_pk_mul_f32 v[246:247], v[246:247], v[74:75]
v_cvt_pk_bf16_f32 v108, v244, v245
v_cvt_pk_bf16_f32 v109, v246, v247
v_pk_fma_f32 v[248:249], v[88:89], v[56:57], v[248:249] op_sel:[0,1,0] op_sel_hi:[1,1,1]
v_pk_fma_f32 v[250:251], v[90:91], v[56:57], v[250:251] op_sel:[0,1,0] op_sel_hi:[1,1,1]
v_pk_mul_f32 v[248:249], v[248:249], v[72:73]
v_pk_mul_f32 v[250:251], v[250:251], v[74:75]
v_cvt_pk_bf16_f32 v118, v248, v249
v_cvt_pk_bf16_f32 v119, v250, v251
s_cmp_lg_u32 s44, 1
s_cbranch_scc1 else_102
buffer_store_dwordx4 v[212:215], v58, s[32:35], 0 offen sc1
buffer_store_dwordx2 v[108:109], v59, s[32:35], 0 offen offset:1024 sc1
buffer_store_dwordx2 v[118:119], v59, s[32:35], 0 offen offset:1536 sc1
s_branch fi_103
else_102:
ds_write_b128 v53, v[212:215]
ds_write_b64 v55, v[108:109] offset:1024
ds_write_b64 v55, v[118:119] offset:1536
v_mov_b32 v4, 3
ds_write_b32 v19, v4
fi_103:
.p2align 3
v_pk_fma_f32 v[188:189], v[148:149], v[92:93], v[188:189] op_sel:[0,1,0] op_sel_hi:[1,1,1]
v_pk_fma_f32 v[196:197], v[148:149], v[94:95], v[196:197] op_sel:[0,1,0] op_sel_hi:[1,1,1]
v_pk_fma_f32 v[204:205], v[148:149], v[96:97], v[204:205] op_sel:[0,1,0] op_sel_hi:[1,1,1]
v_pk_fma_f32 v[164:165], v[140:141], v[94:95], v[164:165] op_sel:[0,1,0] op_sel_hi:[1,1,1]
v_pk_fma_f32 v[172:173], v[140:141], v[96:97], v[172:173] op_sel:[0,1,0] op_sel_hi:[1,1,1]
v_pk_fma_f32 v[180:181], v[140:141], v[98:99], v[180:181] op_sel:[0,1,0] op_sel_hi:[1,1,1]
v_pk_fma_f32 v[190:191], v[150:151], v[92:93], v[190:191] op_sel:[0,1,0] op_sel_hi:[1,1,1]
v_pk_mul_f32 v[188:189], v[188:189], v[92:93] op_sel:[0,0] op_sel_hi:[1,0]
v_pk_fma_f32 v[198:199], v[150:151], v[94:95], v[198:199] op_sel:[0,1,0] op_sel_hi:[1,1,1]
v_pk_mul_f32 v[196:197], v[196:197], v[94:95] op_sel:[0,0] op_sel_hi:[1,0]
v_pk_fma_f32 v[206:207], v[150:151], v[96:97], v[206:207] op_sel:[0,1,0] op_sel_hi:[1,1,1]
v_pk_mul_f32 v[204:205], v[204:205], v[96:97] op_sel:[0,0] op_sel_hi:[1,0]
v_pk_fma_f32 v[166:167], v[142:143], v[94:95], v[166:167] op_sel:[0,1,0] op_sel_hi:[1,1,1]
v_cvt_pk_bf16_f32 v164, v164, v165
v_pk_fma_f32 v[174:175], v[142:143], v[96:97], v[174:175] op_sel:[0,1,0] op_sel_hi:[1,1,1]
v_cvt_pk_bf16_f32 v172, v172, v173
v_pk_fma_f32 v[182:183], v[142:143], v[98:99], v[182:183] op_sel:[0,1,0] op_sel_hi:[1,1,1]
v_cvt_pk_bf16_f32 v180, v180, v181
v_pk_fma_f32 v[192:193], v[152:153], v[92:93], v[192:193] op_sel:[0,1,0] op_sel_hi:[1,1,1]
v_pk_fma_f32 v[194:195], v[154:155], v[92:93], v[194:195] op_sel:[0,1,0] op_sel_hi:[1,1,1]
v_pk_mul_f32 v[190:191], v[190:191], v[92:93] op_sel:[0,0] op_sel_hi:[1,0]
v_cvt_pk_bf16_f32 v188, v188, v189
v_pk_fma_f32 v[200:201], v[152:153], v[94:95], v[200:201] op_sel:[0,1,0] op_sel_hi:[1,1,1]
v_pk_fma_f32 v[202:203], v[154:155], v[94:95], v[202:203] op_sel:[0,1,0] op_sel_hi:[1,1,1]
v_pk_mul_f32 v[198:199], v[198:199], v[94:95] op_sel:[0,0] op_sel_hi:[1,0]
v_cvt_pk_bf16_f32 v196, v196, v197
v_pk_fma_f32 v[208:209], v[152:153], v[96:97], v[208:209] op_sel:[0,1,0] op_sel_hi:[1,1,1]
v_pk_fma_f32 v[210:211], v[154:155], v[96:97], v[210:211] op_sel:[0,1,0] op_sel_hi:[1,1,1]
v_pk_mul_f32 v[206:207], v[206:207], v[96:97] op_sel:[0,0] op_sel_hi:[1,0]
v_cvt_pk_bf16_f32 v204, v204, v205
v_pk_fma_f32 v[168:169], v[144:145], v[94:95], v[168:169] op_sel:[0,1,0] op_sel_hi:[1,1,1]
v_pk_fma_f32 v[170:171], v[146:147], v[94:95], v[170:171] op_sel:[0,1,0] op_sel_hi:[1,1,1]
v_cvt_pk_bf16_f32 v165, v166, v167
v_pk_fma_f32 v[176:177], v[144:145], v[96:97], v[176:177] op_sel:[0,1,0] op_sel_hi:[1,1,1]
v_pk_fma_f32 v[178:179], v[146:147], v[96:97], v[178:179] op_sel:[0,1,0] op_sel_hi:[1,1,1]
v_cvt_pk_bf16_f32 v173, v174, v175
v_pk_fma_f32 v[184:185], v[144:145], v[98:99], v[184:185] op_sel:[0,1,0] op_sel_hi:[1,1,1]
v_pk_fma_f32 v[186:187], v[146:147], v[98:99], v[186:187] op_sel:[0,1,0] op_sel_hi:[1,1,1]
v_cvt_pk_bf16_f32 v181, v182, v183
v_pk_mul_f32 v[192:193], v[192:193], v[92:93] op_sel:[0,0] op_sel_hi:[1,0]
v_pk_mul_f32 v[194:195], v[194:195], v[92:93] op_sel:[0,0] op_sel_hi:[1,0]
v_cvt_pk_bf16_f32 v189, v190, v191
v_pk_mul_f32 v[200:201], v[200:201], v[94:95] op_sel:[0,0] op_sel_hi:[1,0]
v_pk_mul_f32 v[202:203], v[202:203], v[94:95] op_sel:[0,0] op_sel_hi:[1,0]
v_cvt_pk_bf16_f32 v197, v198, v199
v_pk_mul_f32 v[208:209], v[208:209], v[96:97] op_sel:[0,0] op_sel_hi:[1,0]
v_pk_mul_f32 v[210:211], v[210:211], v[96:97] op_sel:[0,0] op_sel_hi:[1,0]
v_cvt_pk_bf16_f32 v205, v206, v207
v_cvt_pk_bf16_f32 v166, v168, v169
v_cvt_pk_bf16_f32 v167, v170, v171
v_cvt_pk_bf16_f32 v174, v176, v177
v_cvt_pk_bf16_f32 v175, v178, v179
v_cvt_pk_bf16_f32 v182, v184, v185
v_cvt_pk_bf16_f32 v183, v186, v187
v_cvt_pk_bf16_f32 v190, v192, v193
v_cvt_pk_bf16_f32 v191, v194, v195
v_mfma_f32_16x16x32_bf16 v[216:219], v[212:215], v[180:183], v[40:43]
v_cvt_pk_bf16_f32 v198, v200, v201
v_cvt_pk_bf16_f32 v199, v202, v203
v_mfma_f32_16x16x32_bf16 v[168:171], v[188:191], v[164:167], v[36:39]
v_cvt_pk_bf16_f32 v206, v208, v209
v_cvt_pk_bf16_f32 v207, v210, v211
v_mfma_f32_16x16x32_bf16 v[200:203], v[196:199], v[164:167], v[40:43]
v_mul_f32 v124, s66, v92
v_mul_f32 v125, s66, v94
v_mfma_f32_16x16x32_bf16 v[208:211], v[204:207], v[172:175], v[40:43]
v_mul_f32 v126, s66, v96
v_mul_f32 v127, s66, v98
v_mfma_f32_16x16x32_bf16 v[176:179], v[196:199], v[172:175], v[36:39]
v_max_f32 v164, v168, v169
v_max_f32 v165, v170, v171
v_mfma_f32_16x16x32_bf16 v[184:187], v[204:207], v[180:183], v[36:39]
v_max_f32 v166, v200, v201
v_max_f32 v182, v216, v217
v_max_f32 v174, v208, v209
v_max_f32 v167, v202, v203
v_max3_f32 v129, v164, v165, v166
v_pk_fma_f32 v[156:157], v[140:141], v[92:93], v[156:157] op_sel:[0,1,0] op_sel_hi:[1,1,1]
v_pk_fma_f32 v[158:159], v[142:143], v[92:93], v[158:159] op_sel:[0,1,0] op_sel_hi:[1,1,1]
v_cvt_pk_bf16_f32 v156, v156, v157
v_pk_fma_f32 v[160:161], v[144:145], v[92:93], v[160:161] op_sel:[0,1,0] op_sel_hi:[1,1,1]
v_pk_fma_f32 v[162:163], v[146:147], v[92:93], v[162:163] op_sel:[0,1,0] op_sel_hi:[1,1,1]
v_cvt_pk_bf16_f32 v157, v158, v159
v_cvt_pk_bf16_f32 v158, v160, v161
v_cvt_pk_bf16_f32 v159, v162, v163
v_pk_fma_f32 v[220:221], v[76:77], v[56:57], v[220:221] op_sel:[0,0,0] op_sel_hi:[1,0,1]
v_pk_fma_f32 v[222:223], v[78:79], v[56:57], v[222:223] op_sel:[0,0,0] op_sel_hi:[1,0,1]
v_mfma_f32_16x16x32_bf16 v[192:195], v[188:191], v[156:159], v[40:43]
v_max_f32 v172, v176, v177
v_max_f32 v173, v178, v179
v_max_f32 v180, v184, v185
v_max_f32 v181, v186, v187
v_max_f32_e64 v175, v210, v211
v_pk_fma_f32 v[224:225], v[76:77], v[56:57], v[224:225] op_sel:[0,1,0] op_sel_hi:[1,1,1]
v_pk_fma_f32 v[226:227], v[78:79], v[56:57], v[226:227] op_sel:[0,1,0] op_sel_hi:[1,1,1]
v_pk_fma_f32 v[228:229], v[80:81], v[56:57], v[228:229] op_sel:[0,0,0] op_sel_hi:[1,0,1]
v_pk_fma_f32 v[230:231], v[82:83], v[56:57], v[230:231] op_sel:[0,0,0] op_sel_hi:[1,0,1]
v_pk_fma_f32 v[232:233], v[80:81], v[56:57], v[232:233] op_sel:[0,1,0] op_sel_hi:[1,1,1]
v_pk_fma_f32 v[234:235], v[82:83], v[56:57], v[234:235] op_sel:[0,1,0] op_sel_hi:[1,1,1]
v_pk_fma_f32 v[236:237], v[84:85], v[56:57], v[236:237] op_sel:[0,0,0] op_sel_hi:[1,0,1]
v_pk_fma_f32 v[238:239], v[86:87], v[56:57], v[238:239] op_sel:[0,0,0] op_sel_hi:[1,0,1]
v_pk_fma_f32 v[240:241], v[84:85], v[56:57], v[240:241] op_sel:[0,1,0] op_sel_hi:[1,1,1]
v_pk_fma_f32 v[242:243], v[86:87], v[56:57], v[242:243] op_sel:[0,1,0] op_sel_hi:[1,1,1]
v_pk_mul_f32 v[220:221], v[220:221], v[60:61]
v_pk_mul_f32 v[222:223], v[222:223], v[62:63]
v_pk_mul_f32 v[224:225], v[224:225], v[60:61]
s_cmp_lg_u32 s44, 0
s_cbranch_scc1 else_104
buffer_load_dwordx4 v[120:123], v58, s[32:35], 0 offen sc1
buffer_load_dwordx2 v[100:101], v59, s[32:35], 0 offen offset:1024 sc1
buffer_load_dwordx2 v[110:111], v59, s[32:35], 0 offen offset:1536 sc1
else_104:
v_pk_mul_f32 v[226:227], v[226:227], v[62:63]
v_pk_mul_f32 v[228:229], v[228:229], v[64:65]
v_pk_mul_f32 v[230:231], v[230:231], v[66:67]
v_pk_mul_f32 v[232:233], v[232:233], v[64:65]
v_pk_mul_f32 v[234:235], v[234:235], v[66:67]
v_pk_mul_f32 v[236:237], v[236:237], v[68:69]
v_pk_mul_f32 v[238:239], v[238:239], v[70:71]
v_pk_mul_f32 v[240:241], v[240:241], v[68:69]
v_pk_mul_f32 v[242:243], v[242:243], v[70:71]
v_max3_f32 v130, v172, v173, v174
v_max_f32_e64 v183, v218, v219
v_max3_f32 v131, v180, v181, v182
v_cvt_pk_bf16_f32 v102, v220, v221
v_cvt_pk_bf16_f32 v103, v222, v223
v_cvt_pk_bf16_f32 v112, v224, v225
v_cvt_pk_bf16_f32 v113, v226, v227
v_cvt_pk_bf16_f32 v104, v228, v229
v_cvt_pk_bf16_f32 v105, v230, v231
v_cvt_pk_bf16_f32 v114, v232, v233
v_cvt_pk_bf16_f32 v115, v234, v235
v_cvt_pk_bf16_f32 v106, v236, v237
v_cvt_pk_bf16_f32 v107, v238, v239
v_cvt_pk_bf16_f32 v116, v240, v241
v_cvt_pk_bf16_f32 v117, v242, v243
v_max_f32 v129, v129, v167
v_max_f32 v130, v130, v175
v_max_f32 v131, v131, v183
s_cmp_lg_u32 s44, 0
s_cbranch_scc1 else_106
s_mov_b32 s63, 0
sent_108:
s_waitcnt vmcnt(0)
v_max_u32 v4, v120, v121
v_max3_u32 v4, v4, v122, v123
v_max3_u32 v4, v4, v100, v101
v_max3_u32 v4, v4, v110, v111
v_cmp_eq_u32 vcc, -1, v4
s_cbranch_vccz sentd_109
buffer_load_dwordx4 v[120:123], v58, s[32:35], 0 offen sc1
buffer_load_dwordx2 v[100:101], v59, s[32:35], 0 offen offset:1024 sc1
buffer_load_dwordx2 v[110:111], v59, s[32:35], 0 offen offset:1536 sc1
s_add_u32 s63, s63, 1
s_cmp_lt_u32 s63, 0x80000
s_cbranch_scc1 sent_108
s_waitcnt vmcnt(0)
sentd_109:
s_branch fi_107
else_106:
s_mov_b32 s63, 0
px_110:
ds_read_b32 v4, v19
ds_read_b128 v[120:123], v53
ds_read_b64 v[100:101], v55 offset:1024
ds_read_b64 v[110:111], v55 offset:1536
s_add_u32 s63, s63, 1
s_cmp_lt_u32 s63, 0x400000
s_waitcnt lgkmcnt(0)
v_cmp_ne_u32 vcc, 3, v4
s_cbranch_vccz pxd_111
s_cbranch_scc1 px_110
pxd_111:
fi_107:
s_cmp_eq_u32 s46, 0
s_cbranch_scc1 slow_112
.p2align 3
v_mfma_f32_16x16x32_bf16 v[160:163], v[120:123], v[156:159], v[44:47]
v_max_f32 v158, v192, v193
v_max_f32 v159, v194, v195
v_permlane32_swap_b32 v130, v131
s_nop 0
v_max_f32 v130, v130, v131
s_nop 2
v_max_f32 v156, v160, v161
v_max_f32 v157, v162, v163
v_max3_f32 v128, v156, v157, v158
v_max_f32 v128, v128, v159
s_nop 1
v_permlane32_swap_b32 v128, v129
s_nop 0
v_max_f32 v128, v128, v129
s_nop 1
v_permlane16_swap_b32 v128, v130
s_nop 0
v_max_f32 v128, v128, v130
v_mov_b32 v130, v128
s_nop 1
v_permlane16_swap_b32 v128, v130
s_nop 0
v_mov_b32 v129, v128
v_mov_b32 v131, v130
s_nop 0
v_permlane32_swap_b32 v128, v129
v_permlane32_swap_b32 v130, v131
v_mul_f32 v128, v128, v124
v_mul_f32 v129, v129, v125
v_pk_fma_f32 v[156:157], v[156:157], v[124:125], v[128:129] op_sel:[0,0,0] op_sel_hi:[1,0,0] neg_lo:[0,0,1] neg_hi:[0,0,1]
v_pk_fma_f32 v[158:159], v[158:159], v[124:125], v[128:129] op_sel:[0,0,0] op_sel_hi:[1,0,0] neg_lo:[0,0,1] neg_hi:[0,0,1]
v_mul_f32 v130, v130, v126
v_mul_f32 v131, v131, v127
v_exp_f32 v156, v156
v_exp_f32 v157, v157
v_exp_f32 v158, v158
v_exp_f32 v159, v159
v_pk_fma_f32 v[164:165], v[164:165], v[124:125], v[128:129] op_sel:[0,1,1] op_sel_hi:[1,1,1] neg_lo:[0,0,1] neg_hi:[0,0,1]
v_pk_fma_f32 v[166:167], v[166:167], v[124:125], v[128:129] op_sel:[0,1,1] op_sel_hi:[1,1,1] neg_lo:[0,0,1] neg_hi:[0,0,1]
v_exp_f32 v164, v164
v_exp_f32 v165, v165
v_exp_f32 v166, v166
v_exp_f32 v167, v167
v_pk_fma_f32 v[172:173], v[172:173], v[126:127], v[130:131] op_sel:[0,0,0] op_sel_hi:[1,0,0] neg_lo:[0,0,1] neg_hi:[0,0,1]
v_pk_fma_f32 v[174:175], v[174:175], v[126:127], v[130:131] op_sel:[0,0,0] op_sel_hi:[1,0,0] neg_lo:[0,0,1] neg_hi:[0,0,1]
v_cvt_pk_bf16_f32 v156, v156, v156
v_cvt_pk_bf16_f32 v157, v157, v157
v_cvt_pk_bf16_f32 v158, v158, v158
v_cvt_pk_bf16_f32 v159, v159, v159
v_exp_f32 v172, v172
v_exp_f32 v173, v173
v_exp_f32 v174, v174
v_exp_f32 v175, v175
v_pk_fma_f32 v[180:181], v[180:181], v[126:127], v[130:131] op_sel:[0,1,1] op_sel_hi:[1,1,1] neg_lo:[0,0,1] neg_hi:[0,0,1]
v_pk_fma_f32 v[182:183], v[182:183], v[126:127], v[130:131] op_sel:[0,1,1] op_sel_hi:[1,1,1] neg_lo:[0,0,1] neg_hi:[0,0,1]
v_and_b32 v156, v52, v156
v_and_b32 v157, v52, v157
v_and_b32 v158, v52, v158
v_and_b32 v159, v52, v159
v_cvt_pk_bf16_f32 v164, v164, v164
v_cvt_pk_bf16_f32 v165, v165, v165
v_mfma_f32_16x16x32_bf16 v[160:163], v[48:51], v[156:159], 0
v_cvt_pk_bf16_f32 v166, v166, v166
v_cvt_pk_bf16_f32 v167, v167, v167
v_mfma_f32_16x16x32_bf16 v[220:223], v[100:103], v[156:159], 0
v_exp_f32 v180, v180
v_mfma_f32_16x16x32_bf16 v[224:227], v[110:113], v[156:159], 0
v_exp_f32 v181, v181
v_exp_f32 v182, v182
v_exp_f32 v183, v183
v_and_b32 v164, v52, v164
v_and_b32 v165, v52, v165
v_and_b32 v166, v52, v166
v_and_b32 v167, v52, v167
v_cvt_pk_bf16_f32 v172, v172, v172
v_cvt_pk_bf16_f32 v173, v173, v173
v_mfma_f32_16x16x32_bf16 v[168:171], v[48:51], v[164:167], 0
v_cvt_pk_bf16_f32 v174, v174, v174
v_cvt_pk_bf16_f32 v175, v175, v175
v_mfma_f32_16x16x32_bf16 v[228:231], v[102:105], v[164:167], 0
v_and_b32 v172, v52, v172
v_and_b32 v173, v52, v173
v_mfma_f32_16x16x32_bf16 v[232:235], v[112:115], v[164:167], 0
v_and_b32 v174, v52, v174
v_and_b32 v175, v52, v175
v_cvt_pk_bf16_f32 v180, v180, v180
v_cvt_pk_bf16_f32 v181, v181, v181
v_mfma_f32_16x16x32_bf16 v[176:179], v[48:51], v[172:175], 0
v_cvt_pk_bf16_f32 v182, v182, v182
v_cvt_pk_bf16_f32 v183, v183, v183
v_mfma_f32_16x16x32_bf16 v[236:239], v[104:107], v[172:175], 0
v_and_b32 v180, v52, v180
v_and_b32 v181, v52, v181
v_mfma_f32_16x16x32_bf16 v[240:243], v[114:117], v[172:175], 0
v_and_b32 v182, v52, v182
v_and_b32 v183, v52, v183
v_rcp_f32 v160, v160
v_rcp_f32 v168, v168
v_pk_mul_f32 v[220:221], v[220:221], v[160:161] op_sel:[0,0] op_sel_hi:[1,0]
v_pk_mul_f32 v[222:223], v[222:223], v[160:161] op_sel:[0,0] op_sel_hi:[1,0]
v_pk_mul_f32 v[228:229], v[228:229], v[168:169] op_sel:[0,0] op_sel_hi:[1,0]
v_pk_mul_f32 v[224:225], v[224:225], v[160:161] op_sel:[0,0] op_sel_hi:[1,0]
v_pk_mul_f32 v[226:227], v[226:227], v[160:161] op_sel:[0,0] op_sel_hi:[1,0]
v_pk_mul_f32 v[230:231], v[230:231], v[168:169] op_sel:[0,0] op_sel_hi:[1,0]
v_pk_mul_f32 v[232:233], v[232:233], v[168:169] op_sel:[0,0] op_sel_hi:[1,0]
v_pk_mul_f32 v[234:235], v[234:235], v[168:169] op_sel:[0,0] op_sel_hi:[1,0]
v_mfma_f32_16x16x32_bf16 v[184:187], v[48:51], v[180:183], 0
v_rcp_f32_e64 v176, v176
v_cvt_pk_bf16_f32 v220, v220, v221
v_cvt_pk_bf16_f32 v221, v222, v223
v_cvt_pk_bf16_f32 v228, v228, v229
v_pk_mul_f32 v[236:237], v[236:237], v[176:177] op_sel:[0,0] op_sel_hi:[1,0]
v_mfma_f32_16x16x32_bf16 v[244:247], v[106:109], v[180:183], 0
v_cvt_pk_bf16_f32 v222, v224, v225
v_cvt_pk_bf16_f32 v223, v226, v227
v_rcp_f32_e64 v184, v184
v_cvt_pk_bf16_f32 v229, v230, v231
v_pk_mul_f32 v[238:239], v[238:239], v[176:177] op_sel:[0,0] op_sel_hi:[1,0]
v_pk_mul_f32 v[240:241], v[240:241], v[176:177] op_sel:[0,0] op_sel_hi:[1,0]
v_pk_mul_f32 v[242:243], v[242:243], v[176:177] op_sel:[0,0] op_sel_hi:[1,0]
v_cvt_pk_bf16_f32 v236, v236, v237
v_pk_mul_f32 v[244:245], v[244:245], v[184:185] op_sel:[0,0] op_sel_hi:[1,0]
v_pk_mul_f32 v[246:247], v[246:247], v[184:185] op_sel:[0,0] op_sel_hi:[1,0]
v_mfma_f32_16x16x32_bf16 v[248:251], v[116:119], v[180:183], 0
buffer_store_dwordx4 v[220:223], v18, s[32:35], s80 offen
v_cvt_pk_bf16_f32 v230, v232, v233
v_cvt_pk_bf16_f32 v231, v234, v235
v_cvt_pk_bf16_f32 v237, v238, v239
v_cvt_pk_bf16_f32 v244, v244, v245
buffer_store_dwordx4 v[228:231], v18, s[32:35], s81 offen
v_cvt_pk_bf16_f32 v238, v240, v241
v_cvt_pk_bf16_f32 v239, v242, v243
v_pk_mul_f32 v[248:249], v[248:249], v[184:185] op_sel:[0,0] op_sel_hi:[1,0]
v_pk_mul_f32 v[250:251], v[250:251], v[184:185] op_sel:[0,0] op_sel_hi:[1,0]
v_cvt_pk_bf16_f32 v245, v246, v247
buffer_store_dwordx4 v[236:239], v18, s[32:35], s82 offen
v_cvt_pk_bf16_f32 v246, v248, v249
v_cvt_pk_bf16_f32 v247, v250, v251
buffer_store_dwordx4 v[244:247], v18, s[32:35], s83 offen
back_113:
s_barrier
v_and_b32 v36, 31, v0
v_lshlrev_b32 v36, 2, v36
s_lshl_b32 s62, s45, 2
v_mov_b32 v4, s62
v_mov_b32 v5, 3
s_mov_b64 exec, 1
s_waitcnt vmcnt(0)
s_cmp_eq_u32 s46, 0
s_cbranch_scc1 slow_114
buffer_store_dword v5, v4, s[32:35], s84 offen
back_115:
s_mov_b64 exec, -1
v_lshrrev_b32 v4, 2, v2
v_and_b32 v5, 3, v0
v_lshl_add_u32 v6, v3, 3, v4
v_lshlrev_b32 v6, 7, v6
v_lshl_add_u32 v6, v5, 3, v6
v_lshrrev_b32 v7, 1, v4
v_and_b32 v8, 1, v3
v_lshl_add_u32 v7, v8, 1, v7
v_lshl_add_u32 v10, v7, 5, v6
v_xor_b32 v11, 32, v10
v_xor_b32 v12, 64, v10
v_xor_b32 v13, 96, v10
v_add_u32 v14, 0x10000, v10
v_add_u32 v15, 0x10000, v11
v_add_u32 v16, 0x10000, v12
v_add_u32 v17, 0x10000, v13
ds_read_b64_tr_b16 v[220:221], v10 offset:0
ds_read_b64_tr_b16 v[222:223], v10 offset:512
ds_read_b64_tr_b16 v[224:225], v11 offset:0
ds_read_b64_tr_b16 v[226:227], v11 offset:512
ds_read_b64_tr_b16 v[228:229], v12 offset:0
ds_read_b64_tr_b16 v[230:231], v12 offset:512
ds_read_b64_tr_b16 v[232:233], v13 offset:0
ds_read_b64_tr_b16 v[234:235], v13 offset:512
ds_read_b64_tr_b16 v[236:237], v10 offset:4096
ds_read_b64_tr_b16 v[238:239], v10 offset:4608
ds_read_b64_tr_b16 v[240:241], v11 offset:4096
ds_read_b64_tr_b16 v[242:243], v11 offset:4608
ds_read_b64_tr_b16 v[244:245], v12 offset:4096
ds_read_b64_tr_b16 v[246:247], v12 offset:4608
ds_read_b64_tr_b16 v[248:249], v13 offset:4096
ds_read_b64_tr_b16 v[250:251], v13 offset:4608
s_lshl_b32 s48, s41, 3
s_lshl_b32 s49, s40, 1
s_add_u32 s48, s48, s49
s_lshl_b32 s48, s48, 15
s_add_u32 s48, s48, 4194304
v_add_u32 v38, s48, v18
v_add_u32 v39, 32768, v38
s_lshl_b32 s57, s75, 11
s_add_u32 s87, s87, 262144
v_lshlrev_b32 v60, 16, v20
v_and_b32 v61, 0xffff0000, v20
v_lshlrev_b32 v62, 16, v21
v_and_b32 v63, 0xffff0000, v21
v_lshlrev_b32 v64, 16, v22
v_and_b32 v65, 0xffff0000, v22
v_lshlrev_b32 v66, 16, v23
v_and_b32 v67, 0xffff0000, v23
v_lshlrev_b32 v68, 16, v24
v_and_b32 v69, 0xffff0000, v24
v_lshlrev_b32 v70, 16, v25
v_and_b32 v71, 0xffff0000, v25
v_lshlrev_b32 v72, 16, v26
v_and_b32 v73, 0xffff0000, v26
v_lshlrev_b32 v74, 16, v27
v_and_b32 v75, 0xffff0000, v27
v_lshlrev_b32 v76, 16, v28
v_and_b32 v77, 0xffff0000, v28
v_lshlrev_b32 v78, 16, v29
v_and_b32 v79, 0xffff0000, v29
v_lshlrev_b32 v80, 16, v30
v_and_b32 v81, 0xffff0000, v30
v_lshlrev_b32 v82, 16, v31
v_and_b32 v83, 0xffff0000, v31
v_lshlrev_b32 v84, 16, v32
v_and_b32 v85, 0xffff0000, v32
v_lshlrev_b32 v86, 16, v33
v_and_b32 v87, 0xffff0000, v33
v_lshlrev_b32 v88, 16, v34
v_and_b32 v89, 0xffff0000, v34
v_lshlrev_b32 v90, 16, v35
v_and_b32 v91, 0xffff0000, v35
v_mov_b32 v6, 0
v_mov_b32 v7, 0
v_mov_b32 v8, 0
v_mov_b32 v9, 0
s_lshl_b32 s62, s42, 2
v_mov_b32 v4, s62
v_mov_b32 v5, 3
buffer_load_dword v37, v36, s[32:35], s84 offen sc1
s_mov_b32 s63, 0
s_waitcnt vmcnt(0)
poll_116:
v_cmp_gt_u32 vcc, 3, v37
s_cbranch_vccz polled_117
buffer_load_dword v37, v36, s[32:35], s84 offen sc1
s_add_u32 s63, s63, 1
s_cmp_lt_u32 s63, 0x80000
s_waitcnt vmcnt(0)
s_cbranch_scc1 poll_116
polled_117:
s_call_b64 s[94:95], R_oloop
s_cmp_eq_u32 s46, 0
s_cbranch_scc1 slow_118
s_nop 0
v_cvt_pk_bf16_f32 v20, v60, v61
v_cvt_pk_bf16_f32 v21, v62, v63
v_cvt_pk_bf16_f32 v22, v64, v65
v_cvt_pk_bf16_f32 v23, v66, v67
buffer_store_dwordx4 v[20:23], v18, s[32:35], s85 offen offset:0
v_cvt_pk_bf16_f32 v24, v68, v69
v_cvt_pk_bf16_f32 v25, v70, v71
v_cvt_pk_bf16_f32 v26, v72, v73
v_cvt_pk_bf16_f32 v27, v74, v75
buffer_store_dwordx4 v[24:27], v18, s[32:35], s85 offen offset:1024
v_cvt_pk_bf16_f32 v28, v76, v77
v_cvt_pk_bf16_f32 v29, v78, v79
v_cvt_pk_bf16_f32 v30, v80, v81
v_cvt_pk_bf16_f32 v31, v82, v83
buffer_store_dwordx4 v[28:31], v18, s[32:35], s86 offen offset:0
v_cvt_pk_bf16_f32 v32, v84, v85
v_cvt_pk_bf16_f32 v33, v86, v87
v_cvt_pk_bf16_f32 v34, v88, v89
v_cvt_pk_bf16_f32 v35, v90, v91
buffer_store_dwordx4 v[32:35], v18, s[32:35], s86 offen offset:1024
s_barrier
v_dot2c_f32_bf16 v6, v20, v48
v_dot2c_f32_bf16 v8, v20, v20
v_dot2c_f32_bf16 v7, v28, v48
v_dot2c_f32_bf16 v9, v28, v28
v_dot2c_f32_bf16 v6, v21, v48
v_dot2c_f32_bf16 v8, v21, v21
v_dot2c_f32_bf16 v7, v29, v48
v_dot2c_f32_bf16 v9, v29, v29
v_dot2c_f32_bf16 v6, v22, v48
v_dot2c_f32_bf16 v8, v22, v22
v_dot2c_f32_bf16 v7, v30, v48
v_dot2c_f32_bf16 v9, v30, v30
v_dot2c_f32_bf16 v6, v23, v48
v_dot2c_f32_bf16 v8, v23, v23
v_dot2c_f32_bf16 v7, v31, v48
v_dot2c_f32_bf16 v9, v31, v31
v_dot2c_f32_bf16 v6, v24, v48
v_dot2c_f32_bf16 v8, v24, v24
v_dot2c_f32_bf16 v7, v32, v48
v_dot2c_f32_bf16 v9, v32, v32
v_dot2c_f32_bf16 v6, v25, v48
v_dot2c_f32_bf16 v8, v25, v25
v_dot2c_f32_bf16 v7, v33, v48
v_dot2c_f32_bf16 v9, v33, v33
v_dot2c_f32_bf16 v6, v26, v48
v_dot2c_f32_bf16 v8, v26, v26
v_dot2c_f32_bf16 v7, v34, v48
v_dot2c_f32_bf16 v9, v34, v34
v_dot2c_f32_bf16 v6, v27, v48
v_dot2c_f32_bf16 v8, v27, v27
v_dot2c_f32_bf16 v7, v35, v48
v_dot2c_f32_bf16 v9, v35, v35
s_mov_b64 exec, 1
s_waitcnt vmcnt(0)
buffer_store_dword v5, v4, s[32:35], s88 offen
s_mov_b64 exec, -1
s_nop 1
v_permlane32_swap_b32 v6, v7
v_permlane32_swap_b32 v8, v9
v_add_f32 v6, v6, v7
v_add_f32 v8, v8, v9
s_nop 1
v_permlane16_swap_b32 v6, v8
s_nop 0
v_add_f32 v6, v6, v8
buffer_store_dword v6, v1, s[32:35], s87 offen
back_119:
s_lshl_b32 s49, s44, 13
v_add_u32 v10, s49, v18
v_add_u32 v11, 1024, v10
s_lshl_b32 s48, s43, 1
v_lshrrev_b32 v4, 2, v2
v_and_b32 v5, 3, v0
v_lshl_add_u32 v6, v3, 3, v4
v_lshlrev_b32 v6, 7, v6
v_lshl_add_u32 v6, v5, 3, v6
v_lshrrev_b32 v7, 1, v4
v_and_b32 v8, 1, v3
v_lshl_add_u32 v7, v8, 1, v7
v_xor_b32 v7, s48, v7
v_lshl_add_u32 v12, v7, 5, v6
v_add_u32 v12, 16384, v12
v_xor_b32 v13, 32, v12
v_mov_b32 v14, v10
v_mov_b32 v15, v11
v_add_u32 v16, 122880, v12
v_add_u32 v17, 122880, v13
v_mov_b32 v156, 0
v_mov_b32 v157, 0
v_mov_b32 v158, 0
v_mov_b32 v159, 0
v_mov_b32 v160, 0
v_mov_b32 v161, 0
v_mov_b32 v162, 0
v_mov_b32 v163, 0
v_mov_b32 v164, 0
v_mov_b32 v165, 0
v_mov_b32 v166, 0
v_mov_b32 v167, 0
v_mov_b32 v168, 0
v_mov_b32 v169, 0
v_mov_b32 v170, 0
v_mov_b32 v171, 0
v_mov_b32 v172, 0
v_mov_b32 v173, 0
v_mov_b32 v174, 0
v_mov_b32 v175, 0
v_mov_b32 v176, 0
v_mov_b32 v177, 0
v_mov_b32 v178, 0
v_mov_b32 v179, 0
v_mov_b32 v180, 0
v_mov_b32 v181, 0
v_mov_b32 v182, 0
v_mov_b32 v183, 0
v_mov_b32 v184, 0
v_mov_b32 v185, 0
v_mov_b32 v186, 0
v_mov_b32 v187, 0
v_mov_b32 v188, 0
v_mov_b32 v189, 0
v_mov_b32 v190, 0
v_mov_b32 v191, 0
v_mov_b32 v192, 0
v_mov_b32 v193, 0
v_mov_b32 v194, 0
v_mov_b32 v195, 0
v_mov_b32 v196, 0
v_mov_b32 v197, 0
v_mov_b32 v198, 0
v_mov_b32 v199, 0
v_mov_b32 v200, 0
v_mov_b32 v201, 0
v_mov_b32 v202, 0
v_mov_b32 v203, 0
v_mov_b32 v204, 0
v_mov_b32 v205, 0
v_mov_b32 v206, 0
v_mov_b32 v207, 0
v_mov_b32 v208, 0
v_mov_b32 v209, 0
v_mov_b32 v210, 0
v_mov_b32 v211, 0
v_mov_b32 v212, 0
v_mov_b32 v213, 0
v_mov_b32 v214, 0
v_mov_b32 v215, 0
v_mov_b32 v216, 0
v_mov_b32 v217, 0
v_mov_b32 v218, 0
v_mov_b32 v219, 0
v_mov_b32 v220, 0
v_mov_b32 v221, 0
v_mov_b32 v222, 0
v_mov_b32 v223, 0
v_mov_b32 v224, 0
v_mov_b32 v225, 0
v_mov_b32 v226, 0
v_mov_b32 v227, 0
v_mov_b32 v228, 0
v_mov_b32 v229, 0
v_mov_b32 v230, 0
v_mov_b32 v231, 0
v_mov_b32 v232, 0
v_mov_b32 v233, 0
v_mov_b32 v234, 0
v_mov_b32 v235, 0
v_mov_b32 v236, 0
v_mov_b32 v237, 0
v_mov_b32 v238, 0
v_mov_b32 v239, 0
v_mov_b32 v240, 0
v_mov_b32 v241, 0
v_mov_b32 v242, 0
v_mov_b32 v243, 0
v_mov_b32 v244, 0
v_mov_b32 v245, 0
v_mov_b32 v246, 0
v_mov_b32 v247, 0
v_mov_b32 v248, 0
v_mov_b32 v249, 0
v_mov_b32 v250, 0
v_mov_b32 v251, 0
v_lshrrev_b32 v6, 2, v2
v_cmp_eq_u32 vcc, v6, v3
v_and_b32 v7, 1, v0
v_lshlrev_b32 v7, 4, v7
v_mov_b32 v8, 0x3f80
v_lshlrev_b32 v9, v7, v8
v_cndmask_b32 v7, 0, v9, vcc
v_and_b32 v6, 2, v0
v_cmp_eq_u32 vcc, 0, v6
v_mov_b32 v36, 0
v_mov_b32 v37, 0
v_mov_b32 v40, 0
v_mov_b32 v41, 0
v_cndmask_b32 v38, 0, v7, vcc
v_cndmask_b32 v39, v7, 0, vcc
v_lshrrev_b32 v8, 1, v2
v_cmp_eq_u32 vcc, 0, v8
s_nop 1
v_cndmask_b32 v44, 0, v9, vcc
v_cmp_eq_u32 vcc, 1, v8
s_nop 1
v_cndmask_b32 v45, 0, v9, vcc
v_cmp_eq_u32 vcc, 2, v8
s_nop 1
v_cndmask_b32 v46, 0, v9, vcc
v_cmp_eq_u32 vcc, 3, v8
s_nop 1
v_cndmask_b32 v47, 0, v9, vcc
v_lshrrev_b32 v4, 2, v2
v_lshl_add_u32 v4, v3, 2, v4
v_lshlrev_b32 v4, 6, v4
v_and_b32 v5, 3, v0
v_lshl_add_u32 v4, v5, 3, v4
s_lshl_b32 s48, s43, 11
s_add_u32 s48, s48, 135168
v_add_u32 v53, s48, v4
s_mul_i32 s48, s40, 3072
s_add_u32 s48, s48, 139264
v_add_u32 v42, s48, v18
s_xor_b32 s49, s40, 2
s_mul_i32 s48, s49, 3072
s_add_u32 s48, s48, 139264
v_add_u32 v43, s48, v18
s_lshl_b32 s49, s49, 2
s_add_u32 s49, s49, 134672
v_mov_b32 v19, s49
v_xor_b32 v52, 8, v19
v_lshrrev_b32 v4, 3, v0
v_and_b32 v5, 7, v0
v_lshlrev_b32 v4, 11, v4
v_lshl_add_u32 v55, v5, 4, v4
v_lshlrev_b32 v4, 6, v2
v_lshl_add_u32 v58, v3, 4, v4
v_lshlrev_b32 v4, 4, v2
v_lshl_add_u32 v59, v3, 3, v4
s_mul_i32 s51, s42, 163840
s_add_u32 s51, s51, 9437184
s_lshl_b32 s50, s43, 1
s_add_u32 s50, s50, s44
s_lshl_b32 s48, s50, 15
s_add_u32 s48, s48, s51
s_add_u32 s48, s48, 0
s_lshl_b32 s49, s41, 7
s_add_u32 s53, s48, s49
s_add_u32 s54, s53, 16384
s_lshl_b32 s56, s50, 10
s_add_u32 s56, s56, s51
s_add_u32 s56, s56, 151552
s_xor_b32 s57, s56, 1024
s_lshl_b32 s58, s50, 11
s_add_u32 s58, s58, s51
s_add_u32 s58, s58, 139264
s_xor_b32 s59, s58, 2048
s_add_u32 s79, s58, s49
s_lshl_b32 s50, s41, 11
s_add_u32 s55, s48, s50
s_lshl_b32 s48, s43, 7
s_add_u32 s48, s48, 133888
v_lshl_add_u32 v7, v3, 4, s48
v_lshl_add_u32 v54, v2, 2, s48
s_lshl_b32 s49, s44, 6
v_add_u32 v8, s49, v2
v_lshlrev_b32 v8, 3, v8
v_add_u32 v8, 131072, v8
v_lshl_add_u32 v9, v3, 2, s49
v_lshlrev_b32 v9, 2, v9
v_add_u32 v9, 132096, v9
s_mov_b32 s64, 0
s_mov_b32 s65, 0
s_mov_b32 s66, 0x3fb8aa3b
s_mov_b32 s61, 4
ds_read_b64_tr_b16 v[84:85], v16 offset:8192
ds_read_b64_tr_b16 v[86:87], v16 offset:8704
ds_read_b64_tr_b16 v[88:89], v17 offset:8192
ds_read_b64_tr_b16 v[90:91], v17 offset:8704
ds_read_b64_tr_b16 v[92:93], v16 offset:16384
ds_read_b64_tr_b16 v[94:95], v16 offset:16896
ds_read_b64_tr_b16 v[96:97], v17 offset:16384
ds_read_b64_tr_b16 v[98:99], v17 offset:16896
ds_read_b64_tr_b16 v[76:77], v16 offset:0
ds_read_b64_tr_b16 v[78:79], v16 offset:512
ds_read_b64_tr_b16 v[80:81], v17 offset:0
ds_read_b64_tr_b16 v[82:83], v17 offset:512
s_barrier
ds_read_b128 v[60:63], v14 offset:0
ds_read_b128 v[64:67], v14 offset:2048
ds_read_b128 v[68:71], v14 offset:4096
ds_read_b128 v[72:75], v14 offset:6144
s_waitcnt lgkmcnt(0)
c3_loop:
v_mfma_f32_16x16x32_bf16 v[212:215], v[84:87], v[72:75], v[212:215]
ds_read_b128 v[100:103], v15 offset:0
v_mfma_f32_16x16x32_bf16 v[204:207], v[84:87], v[68:71], v[204:207]
ds_read_b128 v[104:107], v15 offset:2048
v_mfma_f32_16x16x32_bf16 v[196:199], v[84:87], v[64:67], v[196:199]
ds_read_b128 v[108:111], v15 offset:4096
v_mfma_f32_16x16x32_bf16 v[188:191], v[84:87], v[60:63], v[188:191]
ds_read_b128 v[112:115], v15 offset:6144
v_mfma_f32_16x16x32_bf16 v[192:195], v[88:91], v[60:63], v[192:195]
ds_read_b64_tr_b16 v[124:125], v16 offset:12288
v_mfma_f32_16x16x32_bf16 v[200:203], v[88:91], v[64:67], v[200:203]
ds_read_b64_tr_b16 v[126:127], v16 offset:12800
v_mfma_f32_16x16x32_bf16 v[208:211], v[88:91], v[68:71], v[208:211]
ds_read_b64_tr_b16 v[128:129], v17 offset:12288
v_mfma_f32_16x16x32_bf16 v[216:219], v[88:91], v[72:75], v[216:219]
ds_read_b64_tr_b16 v[130:131], v17 offset:12800
v_mfma_f32_16x16x32_bf16 v[244:247], v[72:75], v[92:95], v[244:247]
ds_read_b64_tr_b16 v[132:133], v16 offset:20480
v_mfma_f32_16x16x32_bf16 v[248:251], v[72:75], v[96:99], v[248:251]
ds_read_b64_tr_b16 v[134:135], v16 offset:20992
v_mfma_f32_16x16x32_bf16 v[240:243], v[68:71], v[96:99], v[240:243]
ds_read_b64_tr_b16 v[136:137], v17 offset:20480
v_mfma_f32_16x16x32_bf16 v[236:239], v[68:71], v[92:95], v[236:239]
ds_read_b64_tr_b16 v[138:139], v17 offset:20992
v_mfma_f32_16x16x32_bf16 v[228:231], v[64:67], v[92:95], v[228:231]
ds_read_b64_tr_b16 v[116:117], v16 offset:4096
v_mfma_f32_16x16x32_bf16 v[232:235], v[64:67], v[96:99], v[232:235]
ds_read_b64_tr_b16 v[118:119], v16 offset:4608
v_mfma_f32_16x16x32_bf16 v[224:227], v[60:63], v[96:99], v[224:227]
ds_read_b64_tr_b16 v[120:121], v17 offset:4096
v_mfma_f32_16x16x32_bf16 v[220:223], v[60:63], v[92:95], v[220:223]
ds_read_b64_tr_b16 v[122:123], v17 offset:4608
v_mfma_f32_16x16x32_bf16 v[156:159], v[76:79], v[60:63], v[156:159]
s_add_u32 s65, s65, 40960
s_cmp_eq_u32 s65, 122880
v_mfma_f32_16x16x32_bf16 v[164:167], v[76:79], v[64:67], v[164:167]
s_cselect_b32 s65, 0, s65
s_add_u32 s64, s64, 1
v_mfma_f32_16x16x32_bf16 v[172:175], v[76:79], v[68:71], v[172:175]
v_add_u32 v14, s65, v10
v_add_u32 v15, s65, v11
v_mfma_f32_16x16x32_bf16 v[180:183], v[76:79], v[72:75], v[180:183]
v_add_u32 v16, s65, v12
v_add_u32 v17, s65, v13
v_mfma_f32_16x16x32_bf16 v[184:187], v[80:83], v[72:75], v[184:187]
v_mfma_f32_16x16x32_bf16 v[176:179], v[80:83], v[68:71], v[176:179]
s_cmp_eq_u32 s64, 16
s_cbranch_scc1 c3_last
v_mfma_f32_16x16x32_bf16 v[168:171], v[80:83], v[64:67], v[168:171]
s_waitcnt lgkmcnt(0)
v_mfma_f32_16x16x32_bf16 v[160:163], v[80:83], v[60:63], v[160:163]
s_barrier
v_mfma_f32_16x16x32_bf16 v[212:215], v[124:127], v[112:115], v[212:215]
ds_read_b128 v[60:63], v14 offset:0
v_mfma_f32_16x16x32_bf16 v[204:207], v[124:127], v[108:111], v[204:207]
ds_read_b128 v[64:67], v14 offset:2048
v_mfma_f32_16x16x32_bf16 v[196:199], v[124:127], v[104:107], v[196:199]
ds_read_b128 v[68:71], v14 offset:4096
v_mfma_f32_16x16x32_bf16 v[188:191], v[124:127], v[100:103], v[188:191]
ds_read_b128 v[72:75], v14 offset:6144
v_mfma_f32_16x16x32_bf16 v[192:195], v[128:131], v[100:103], v[192:195]
ds_read_b64_tr_b16 v[84:85], v16 offset:8192
v_mfma_f32_16x16x32_bf16 v[200:203], v[128:131], v[104:107], v[200:203]
ds_read_b64_tr_b16 v[86:87], v16 offset:8704
v_mfma_f32_16x16x32_bf16 v[208:211], v[128:131], v[108:111], v[208:211]
ds_read_b64_tr_b16 v[88:89], v17 offset:8192
v_mfma_f32_16x16x32_bf16 v[216:219], v[128:131], v[112:115], v[216:219]
ds_read_b64_tr_b16 v[90:91], v17 offset:8704
v_mfma_f32_16x16x32_bf16 v[244:247], v[112:115], v[132:135], v[244:247]
ds_read_b64_tr_b16 v[92:93], v16 offset:16384
v_mfma_f32_16x16x32_bf16 v[248:251], v[112:115], v[136:139], v[248:251]
ds_read_b64_tr_b16 v[94:95], v16 offset:16896
v_mfma_f32_16x16x32_bf16 v[240:243], v[108:111], v[136:139], v[240:243]
ds_read_b64_tr_b16 v[96:97], v17 offset:16384
v_mfma_f32_16x16x32_bf16 v[236:239], v[108:111], v[132:135], v[236:239]
ds_read_b64_tr_b16 v[98:99], v17 offset:16896
v_mfma_f32_16x16x32_bf16 v[228:231], v[104:107], v[132:135], v[228:231]
ds_read_b64_tr_b16 v[76:77], v16 offset:0
v_mfma_f32_16x16x32_bf16 v[232:235], v[104:107], v[136:139], v[232:235]
ds_read_b64_tr_b16 v[78:79], v16 offset:512
v_mfma_f32_16x16x32_bf16 v[224:227], v[100:103], v[136:139], v[224:227]
ds_read_b64_tr_b16 v[80:81], v17 offset:0
v_mfma_f32_16x16x32_bf16 v[220:223], v[100:103], v[132:135], v[220:223]
ds_read_b64_tr_b16 v[82:83], v17 offset:512
v_mfma_f32_16x16x32_bf16 v[156:159], v[116:119], v[100:103], v[156:159]
v_mfma_f32_16x16x32_bf16 v[164:167], v[116:119], v[104:107], v[164:167]
v_mfma_f32_16x16x32_bf16 v[172:175], v[116:119], v[108:111], v[172:175]
v_mfma_f32_16x16x32_bf16 v[180:183], v[116:119], v[112:115], v[180:183]
v_mfma_f32_16x16x32_bf16 v[184:187], v[120:123], v[112:115], v[184:187]
v_mfma_f32_16x16x32_bf16 v[176:179], v[120:123], v[108:111], v[176:179]
v_mfma_f32_16x16x32_bf16 v[168:171], v[120:123], v[104:107], v[168:171]
s_waitcnt lgkmcnt(0)
v_mfma_f32_16x16x32_bf16 v[160:163], v[120:123], v[100:103], v[160:163]
s_branch c3_loop
c3_last:
v_mfma_f32_16x16x32_bf16 v[168:171], v[80:83], v[64:67], v[168:171]
s_waitcnt lgkmcnt(0)
v_mfma_f32_16x16x32_bf16 v[160:163], v[80:83], v[60:63], v[160:163]
v_mfma_f32_16x16x32_bf16 v[212:215], v[124:127], v[112:115], v[212:215]
ds_read_b64_tr_b16 v[10:11], v53 offset:0
ds_read_b64_tr_b16 v[12:13], v53 offset:1024
v_mfma_f32_16x16x32_bf16 v[204:207], v[124:127], v[108:111], v[204:207]
ds_read_b64_tr_b16 v[14:15], v53 offset:32
ds_read_b64_tr_b16 v[16:17], v53 offset:1056
v_mfma_f32_16x16x32_bf16 v[196:199], v[124:127], v[104:107], v[196:199]
ds_read_b128 v[140:143], v7 offset:0
s_mul_i32 s48, s44, 0x80008000
v_mfma_f32_16x16x32_bf16 v[188:191], v[124:127], v[100:103], v[188:191]
ds_read_b128 v[144:147], v7 offset:64
v_mfma_f32_16x16x32_bf16 v[192:195], v[128:131], v[100:103], v[192:195]
ds_read_b128 v[148:151], v7 offset:256
v_mfma_f32_16x16x32_bf16 v[200:203], v[128:131], v[104:107], v[200:203]
ds_read_b128 v[152:155], v7 offset:320
v_mfma_f32_16x16x32_bf16 v[208:211], v[128:131], v[108:111], v[208:211]
ds_read2_b32 v[56:57], v54 offset0:128 offset1:144
s_waitcnt lgkmcnt(5)
v_mfma_f32_16x16x32_bf16 v[216:219], v[128:131], v[112:115], v[216:219]
s_barrier
v_mfma_f32_16x16x32_bf16 v[244:247], v[112:115], v[132:135], v[244:247]
ds_read_b64 v[92:93], v8 offset:0
v_xor_b32 v10, s48, v10
v_mfma_f32_16x16x32_bf16 v[248:251], v[112:115], v[136:139], v[248:251]
ds_read_b64 v[94:95], v8 offset:128
v_xor_b32 v11, s48, v11
v_mfma_f32_16x16x32_bf16 v[240:243], v[108:111], v[136:139], v[240:243]
ds_read_b64 v[96:97], v8 offset:256
v_xor_b32 v12, s48, v12
v_mfma_f32_16x16x32_bf16 v[236:239], v[108:111], v[132:135], v[236:239]
ds_read_b64 v[98:99], v8 offset:384
v_xor_b32 v13, s48, v13
v_mfma_f32_16x16x32_bf16 v[228:231], v[104:107], v[132:135], v[228:231]
ds_read_b128 v[60:63], v9 offset:0
v_xor_b32 v14, s48, v14
v_mfma_f32_16x16x32_bf16 v[232:235], v[104:107], v[136:139], v[232:235]
ds_read_b128 v[64:67], v9 offset:64
v_xor_b32 v15, s48, v15
v_mfma_f32_16x16x32_bf16 v[224:227], v[100:103], v[136:139], v[224:227]
ds_read_b128 v[68:71], v9 offset:128
v_xor_b32 v16, s48, v16
v_mfma_f32_16x16x32_bf16 v[220:223], v[100:103], v[132:135], v[220:223]
ds_read_b128 v[72:75], v9 offset:192
v_xor_b32 v17, s48, v17
v_mfma_f32_16x16x32_bf16 v[156:159], v[116:119], v[100:103], v[156:159]
ds_read_b128 v[76:79], v9 offset:512
v_mfma_f32_16x16x32_bf16 v[164:167], v[116:119], v[104:107], v[164:167]
ds_read_b128 v[80:83], v9 offset:576
v_mfma_f32_16x16x32_bf16 v[172:175], v[116:119], v[108:111], v[172:175]
ds_read_b128 v[84:87], v9 offset:640
v_mfma_f32_16x16x32_bf16 v[180:183], v[116:119], v[112:115], v[180:183]
ds_read_b128 v[88:91], v9 offset:704
v_mfma_f32_16x16x32_bf16 v[184:187], v[120:123], v[112:115], v[184:187]
v_mfma_f32_16x16x32_bf16 v[176:179], v[120:123], v[108:111], v[176:179]
v_mfma_f32_16x16x32_bf16 v[168:171], v[120:123], v[104:107], v[168:171]
v_mfma_f32_16x16x32_bf16 v[160:163], v[120:123], v[100:103], v[160:163]
c3_epi:
s_waitcnt lgkmcnt(0)
.p2align 3
v_mul_f32 v129, s66, v94
v_mul_f32 v128, s66, v92
v_mul_f32 v131, s66, v98
v_mul_f32 v130, s66, v96
v_pk_fma_f32 v[190:191], v[150:151], v[92:93], v[190:191] op_sel:[0,1,0] op_sel_hi:[1,1,1]
v_pk_fma_f32 v[212:213], v[148:149], v[98:99], v[212:213] op_sel:[0,1,0] op_sel_hi:[1,1,1]
v_pk_fma_f32 v[214:215], v[150:151], v[98:99], v[214:215] op_sel:[0,1,0] op_sel_hi:[1,1,1]
v_pk_fma_f32 v[188:189], v[148:149], v[92:93], v[188:189] op_sel:[0,1,0] op_sel_hi:[1,1,1]
v_pk_fma_f32 v[218:219], v[154:155], v[98:99], v[218:219] op_sel:[0,1,0] op_sel_hi:[1,1,1]
v_cvt_pk_bf16_f32 v188, v188, v189
v_cvt_pk_bf16_f32 v189, v190, v191
v_pk_fma_f32 v[196:197], v[148:149], v[94:95], v[196:197] op_sel:[0,1,0] op_sel_hi:[1,1,1]
v_pk_fma_f32 v[200:201], v[152:153], v[94:95], v[200:201] op_sel:[0,1,0] op_sel_hi:[1,1,1]
v_pk_fma_f32 v[210:211], v[154:155], v[96:97], v[210:211] op_sel:[0,1,0] op_sel_hi:[1,1,1]
v_pk_fma_f32 v[240:241], v[84:85], v[56:57], v[240:241] op_sel:[0,1,0] op_sel_hi:[1,1,1]
v_pk_fma_f32 v[228:229], v[80:81], v[56:57], v[228:229] op_sel:[0,0,0] op_sel_hi:[1,0,1]
v_pk_fma_f32 v[226:227], v[78:79], v[56:57], v[226:227] op_sel:[0,1,0] op_sel_hi:[1,1,1]
v_pk_fma_f32 v[192:193], v[152:153], v[92:93], v[192:193] op_sel:[0,1,0] op_sel_hi:[1,1,1]
v_cvt_pk_bf16_f32 v190, v192, v193
v_pk_fma_f32 v[238:239], v[86:87], v[56:57], v[238:239] op_sel:[0,0,0] op_sel_hi:[1,0,1]
v_pk_fma_f32 v[234:235], v[82:83], v[56:57], v[234:235] op_sel:[0,1,0] op_sel_hi:[1,1,1]
v_pk_mul_f32 v[226:227], v[226:227], v[62:63]
v_pk_fma_f32 v[204:205], v[148:149], v[96:97], v[204:205] op_sel:[0,1,0] op_sel_hi:[1,1,1]
v_cvt_pk_bf16_f32 v204, v204, v205
v_pk_fma_f32 v[202:203], v[154:155], v[94:95], v[202:203] op_sel:[0,1,0] op_sel_hi:[1,1,1]
v_pk_fma_f32 v[224:225], v[76:77], v[56:57], v[224:225] op_sel:[0,1,0] op_sel_hi:[1,1,1]
v_pk_fma_f32 v[216:217], v[152:153], v[98:99], v[216:217] op_sel:[0,1,0] op_sel_hi:[1,1,1]
v_pk_fma_f32 v[244:245], v[88:89], v[56:57], v[244:245] op_sel:[0,0,0] op_sel_hi:[1,0,1]
v_pk_mul_f32 v[238:239], v[238:239], v[70:71]
v_pk_mul_f32 v[228:229], v[228:229], v[64:65]
v_pk_fma_f32 v[236:237], v[84:85], v[56:57], v[236:237] op_sel:[0,0,0] op_sel_hi:[1,0,1]
v_pk_fma_f32 v[220:221], v[76:77], v[56:57], v[220:221] op_sel:[0,0,0] op_sel_hi:[1,0,1]
v_pk_mul_f32 v[224:225], v[224:225], v[60:61]
v_cvt_pk_bf16_f32 v212, v212, v213
v_cvt_pk_bf16_f32 v213, v214, v215
v_cvt_pk_bf16_f32 v196, v196, v197
v_pk_mul_f32 v[240:241], v[240:241], v[68:69]
v_pk_fma_f32 v[198:199], v[150:151], v[94:95], v[198:199] op_sel:[0,1,0] op_sel_hi:[1,1,1]
v_cvt_pk_bf16_f32 v197, v198, v199
v_cvt_pk_bf16_f32 v198, v200, v201
v_cvt_pk_bf16_f32 v199, v202, v203
v_cvt_pk_bf16_f32 v215, v218, v219
v_pk_fma_f32 v[208:209], v[152:153], v[96:97], v[208:209] op_sel:[0,1,0] op_sel_hi:[1,1,1]
v_pk_fma_f32 v[246:247], v[90:91], v[56:57], v[246:247] op_sel:[0,0,0] op_sel_hi:[1,0,1]
v_pk_fma_f32 v[250:251], v[90:91], v[56:57], v[250:251] op_sel:[0,1,0] op_sel_hi:[1,1,1]
v_pk_mul_f32 v[250:251], v[250:251], v[74:75]
v_pk_fma_f32 v[206:207], v[150:151], v[96:97], v[206:207] op_sel:[0,1,0] op_sel_hi:[1,1,1]
v_cvt_pk_bf16_f32 v205, v206, v207
v_pk_fma_f32 v[242:243], v[86:87], v[56:57], v[242:243] op_sel:[0,1,0] op_sel_hi:[1,1,1]
v_cvt_pk_bf16_f32 v207, v210, v211
v_pk_mul_f32 v[236:237], v[236:237], v[68:69]
v_pk_fma_f32 v[230:231], v[82:83], v[56:57], v[230:231] op_sel:[0,0,0] op_sel_hi:[1,0,1]
v_pk_fma_f32 v[194:195], v[154:155], v[92:93], v[194:195] op_sel:[0,1,0] op_sel_hi:[1,1,1]
v_cvt_pk_bf16_f32 v191, v194, v195
v_pk_fma_f32 v[232:233], v[80:81], v[56:57], v[232:233] op_sel:[0,1,0] op_sel_hi:[1,1,1]
v_pk_mul_f32 v[232:233], v[232:233], v[64:65]
v_pk_mul_f32 v[230:231], v[230:231], v[66:67]
v_pk_fma_f32 v[248:249], v[88:89], v[56:57], v[248:249] op_sel:[0,1,0] op_sel_hi:[1,1,1]
v_pk_mul_f32 v[248:249], v[248:249], v[72:73]
v_pk_mul_f32 v[242:243], v[242:243], v[70:71]
v_mfma_f32_16x16x32_bf16 v[68:71], v[10:13], v[196:199], 0
v_cvt_pk_bf16_f32 v206, v208, v209
v_cvt_pk_bf16_f32 v214, v216, v217
v_cvt_pk_bf16_f32 v121, v226, v227
v_mfma_f32_16x16x32_bf16 v[80:83], v[14:17], v[204:207], 0
v_cvt_pk_bf16_f32 v120, v224, v225
v_cvt_pk_bf16_f32 v114, v228, v229
v_mfma_f32_16x16x32_bf16 v[84:87], v[10:13], v[212:215], 0
v_cvt_pk_bf16_f32 v116, v236, v237
v_min3_f32 v105, v68, v69, v70
v_mfma_f32_16x16x32_bf16 v[88:91], v[14:17], v[212:215], 0
v_max3_f32 v101, v68, v69, v70
v_cvt_pk_bf16_f32 v115, v230, v231
v_cvt_pk_bf16_f32 v122, v232, v233
v_cvt_pk_bf16_f32 v127, v250, v251
v_cvt_pk_bf16_f32 v124, v240, v241
v_pk_mul_f32 v[244:245], v[244:245], v[72:73]
v_pk_fma_f32 v[222:223], v[78:79], v[56:57], v[222:223] op_sel:[0,0,0] op_sel_hi:[1,0,1]
v_pk_mul_f32 v[222:223], v[222:223], v[62:63]
v_mfma_f32_16x16x32_bf16 v[76:79], v[10:13], v[204:207], 0
v_min3_f32 v107, v84, v85, v86
v_min3_f32 v107, v107, v87, v88
v_min3_f32 v107, v107, v89, v90
v_min_f32_e64 v107, v107, v91
v_max3_f32 v103, v84, v85, v86
v_pk_mul_f32 v[220:221], v[220:221], v[60:61]
v_mfma_f32_16x16x32_bf16 v[60:63], v[10:13], v[188:191], 0
v_max3_f32 v103, v103, v87, v88
v_min3_f32 v106, v76, v77, v78
v_min3_f32 v106, v106, v79, v80
v_min3_f32 v106, v106, v81, v82
v_min_f32 v106, v106, v83
v_pk_mul_f32 v[234:235], v[234:235], v[66:67]
v_mfma_f32_16x16x32_bf16 v[64:67], v[14:17], v[188:191], 0
v_permlane32_swap_b32 v106, v107
v_min3_f32 v104, v60, v61, v62
v_min_f32 v106, v106, v107
v_max3_f32 v103, v103, v89, v90
v_pk_mul_f32 v[246:247], v[246:247], v[74:75]
v_mfma_f32_16x16x32_bf16 v[72:75], v[14:17], v[196:199], 0
v_max_f32 v103, v103, v91
v_max3_f32 v102, v76, v77, v78
v_min3_f32 v104, v104, v63, v64
v_min3_f32 v104, v104, v65, v66
v_min_f32 v104, v104, v67
v_max3_f32 v102, v102, v79, v80
v_max3_f32 v102, v102, v81, v82
v_max_f32 v102, v102, v83
v_min3_f32 v105, v105, v71, v72
v_min3_f32 v105, v105, v73, v74
v_min_f32 v105, v105, v75
v_max3_f32 v101, v101, v71, v72
v_max3_f32 v101, v101, v73, v74
v_permlane32_swap_b32 v104, v105
v_permlane32_swap_b32 v102, v103
v_min_f32 v104, v104, v105
v_max_f32 v102, v102, v103
v_max_f32 v101, v101, v75
v_permlane16_swap_b32 v104, v106
v_max3_f32 v100, v60, v61, v62
v_min_f32 v104, v104, v106
v_mov_b32 v106, v104
v_max3_f32 v100, v100, v63, v64
v_max3_f32 v100, v100, v65, v66
v_max_f32 v100, v100, v67
v_permlane16_swap_b32 v104, v106
v_cvt_pk_bf16_f32 v112, v220, v221
v_permlane32_swap_b32 v100, v101
v_mov_b32 v105, v104
v_max_f32 v100, v100, v101
v_mov_b32 v107, v106
v_permlane32_swap_b32 v104, v105
v_permlane16_swap_b32 v100, v102
v_pk_mul_f32 v[104:105], v[104:105], v[128:129]
v_pk_fma_f32 v[226:227], v[66:67], v[128:129], v[104:105] op_sel:[0,0,0] op_sel_hi:[1,0,0] neg_lo:[1,0,0] neg_hi:[1,0,0]
v_pk_fma_f32 v[230:231], v[70:71], v[128:129], v[104:105] op_sel:[0,1,1] op_sel_hi:[1,1,1] neg_lo:[1,0,0] neg_hi:[1,0,0]
v_exp_f32 v226, v226
v_pk_fma_f32 v[224:225], v[64:65], v[128:129], v[104:105] op_sel:[0,0,0] op_sel_hi:[1,0,0] neg_lo:[1,0,0] neg_hi:[1,0,0]
v_exp_f32 v224, v224
v_pk_fma_f32 v[228:229], v[68:69], v[128:129], v[104:105] op_sel:[0,1,1] op_sel_hi:[1,1,1] neg_lo:[1,0,0] neg_hi:[1,0,0]
v_exp_f32 v231, v231
v_cvt_pk_bf16_f32 v113, v222, v223
v_pk_fma_f32 v[222:223], v[62:63], v[128:129], v[104:105] op_sel:[0,0,0] op_sel_hi:[1,0,0] neg_lo:[1,0,0] neg_hi:[1,0,0]
v_exp_f32 v222, v222
v_pk_fma_f32 v[220:221], v[60:61], v[128:129], v[104:105] op_sel:[0,0,0] op_sel_hi:[1,0,0] neg_lo:[1,0,0] neg_hi:[1,0,0]
v_exp_f32 v221, v221
v_exp_f32 v220, v220
v_max_f32 v100, v100, v102
v_exp_f32 v223, v223
v_mov_b32 v102, v100
v_pk_add_f32 v[110:111], v[220:221], v[222:223]
v_exp_f32 v225, v225
v_pk_fma_f32 v[232:233], v[72:73], v[128:129], v[104:105] op_sel:[0,1,1] op_sel_hi:[1,1,1] neg_lo:[1,0,0] neg_hi:[1,0,0]
v_exp_f32 v232, v232
v_exp_f32 v233, v233
v_pk_add_f32 v[110:111], v[110:111], v[224:225]
v_exp_f32 v229, v229
v_exp_f32 v228, v228
v_exp_f32 v227, v227
v_cvt_pk_bf16_f32 v123, v234, v235
v_pk_fma_f32 v[234:235], v[74:75], v[128:129], v[104:105] op_sel:[0,1,1] op_sel_hi:[1,1,1] neg_lo:[1,0,0] neg_hi:[1,0,0]
v_pk_add_f32 v[110:111], v[110:111], v[226:227]
v_add_f32 v104, v110, v111
v_cvt_pk_bf16_f32 v118, v244, v245
v_permlane32_swap_b32 v106, v107
v_permlane16_swap_b32 v100, v102
v_exp_f32 v234, v234
v_mov_b32 v101, v100
v_exp_f32 v235, v235
v_exp_f32_e64 v230, v230
v_cvt_pk_bf16_f32 v125, v242, v243
v_pk_add_f32 v[110:111], v[228:229], v[230:231]
v_pk_add_f32 v[110:111], v[110:111], v[232:233]
v_pk_add_f32 v[110:111], v[110:111], v[234:235]
v_cvt_pk_bf16_f32 v126, v248, v249
v_pk_mul_f32 v[106:107], v[106:107], v[130:131]
v_pk_fma_f32 v[236:237], v[76:77], v[130:131], v[106:107] op_sel:[0,0,0] op_sel_hi:[1,0,0] neg_lo:[1,0,0] neg_hi:[1,0,0]
v_exp_f32 v237, v237
v_exp_f32 v236, v236
v_pk_fma_f32 v[242:243], v[82:83], v[130:131], v[106:107] op_sel:[0,0,0] op_sel_hi:[1,0,0] neg_lo:[1,0,0] neg_hi:[1,0,0]
v_pk_fma_f32 v[250:251], v[90:91], v[130:131], v[106:107] op_sel:[0,1,1] op_sel_hi:[1,1,1] neg_lo:[1,0,0] neg_hi:[1,0,0]
v_add_f32 v105, v110, v111
v_exp_f32 v243, v243
v_cvt_pk_bf16_f32 v119, v246, v247
v_pk_fma_f32 v[246:247], v[86:87], v[130:131], v[106:107] op_sel:[0,1,1] op_sel_hi:[1,1,1] neg_lo:[1,0,0] neg_hi:[1,0,0]
v_exp_f32 v246, v246
v_cvt_pk_bf16_f32 v117, v238, v239
v_pk_fma_f32 v[238:239], v[78:79], v[130:131], v[106:107] op_sel:[0,0,0] op_sel_hi:[1,0,0] neg_lo:[1,0,0] neg_hi:[1,0,0]
v_exp_f32 v238, v238
v_exp_f32 v247, v247
v_pk_fma_f32 v[240:241], v[80:81], v[130:131], v[106:107] op_sel:[0,0,0] op_sel_hi:[1,0,0] neg_lo:[1,0,0] neg_hi:[1,0,0]
v_exp_f32 v240, v240
v_exp_f32 v241, v241
v_permlane32_swap_b32 v100, v101
v_exp_f32 v242, v242
v_pk_fma_f32 v[244:245], v[84:85], v[130:131], v[106:107] op_sel:[0,1,1] op_sel_hi:[1,1,1] neg_lo:[1,0,0] neg_hi:[1,0,0]
v_exp_f32 v244, v244
v_exp_f32_e64 v239, v239
v_pk_mul_f32 v[100:101], v[100:101], v[128:129]
v_pk_fma_f32 v[62:63], v[62:63], v[128:129], v[100:101] op_sel:[0,0,0] op_sel_hi:[1,0,0] neg_lo:[0,0,1] neg_hi:[0,0,1]
v_pk_add_f32 v[110:111], v[236:237], v[238:239]
v_pk_add_f32 v[110:111], v[110:111], v[240:241]
v_pk_add_f32 v[110:111], v[110:111], v[242:243]
v_pk_fma_f32 v[72:73], v[72:73], v[128:129], v[100:101] op_sel:[0,1,1] op_sel_hi:[1,1,1] neg_lo:[0,0,1] neg_hi:[0,0,1]
v_pk_fma_f32 v[66:67], v[66:67], v[128:129], v[100:101] op_sel:[0,0,0] op_sel_hi:[1,0,0] neg_lo:[0,0,1] neg_hi:[0,0,1]
v_exp_f32 v62, v62
v_pk_fma_f32 v[60:61], v[60:61], v[128:129], v[100:101] op_sel:[0,0,0] op_sel_hi:[1,0,0] neg_lo:[0,0,1] neg_hi:[0,0,1]
v_exp_f32 v60, v60
v_exp_f32 v245, v245
v_exp_f32 v73, v73
v_pk_fma_f32 v[248:249], v[88:89], v[130:131], v[106:107] op_sel:[0,1,1] op_sel_hi:[1,1,1] neg_lo:[1,0,0] neg_hi:[1,0,0]
v_add_f32 v106, v110, v111
v_exp_f32 v249, v249
v_pk_add_f32 v[110:111], v[244:245], v[246:247]
v_exp_f32 v248, v248
v_pk_fma_f32 v[64:65], v[64:65], v[128:129], v[100:101] op_sel:[0,0,0] op_sel_hi:[1,0,0] neg_lo:[0,0,1] neg_hi:[0,0,1]
v_exp_f32 v64, v64
v_pk_add_f32 v[110:111], v[110:111], v[248:249]
v_exp_f32 v65, v65
v_exp_f32 v61, v61
v_exp_f32 v66, v66
v_exp_f32 v251, v251
v_exp_f32 v63, v63
v_pk_fma_f32 v[74:75], v[74:75], v[128:129], v[100:101] op_sel:[0,1,1] op_sel_hi:[1,1,1] neg_lo:[0,0,1] neg_hi:[0,0,1]
v_pk_add_f32 v[108:109], v[60:61], v[62:63]
v_exp_f32 v67, v67
v_exp_f32 v250, v250
v_pk_fma_f32 v[68:69], v[68:69], v[128:129], v[100:101] op_sel:[0,1,1] op_sel_hi:[1,1,1] neg_lo:[0,0,1] neg_hi:[0,0,1]
v_pk_add_f32 v[110:111], v[110:111], v[250:251]
v_exp_f32 v68, v68
v_exp_f32 v69, v69
v_add_f32 v107, v110, v111
v_mov_b32 v103, v102
v_pk_fma_f32 v[70:71], v[70:71], v[128:129], v[100:101] op_sel:[0,1,1] op_sel_hi:[1,1,1] neg_lo:[0,0,1] neg_hi:[0,0,1]
v_exp_f32 v71, v71
v_exp_f32 v70, v70
v_permlane32_swap_b32 v106, v107
v_permlane32_swap_b32 v102, v103
v_pk_add_f32 v[108:109], v[108:109], v[64:65]
v_pk_add_f32 v[108:109], v[108:109], v[66:67]
v_add_f32 v100, v108, v109
v_pk_add_f32 v[108:109], v[68:69], v[70:71]
v_pk_mul_f32 v[102:103], v[102:103], v[130:131]
v_pk_fma_f32 v[78:79], v[78:79], v[130:131], v[102:103] op_sel:[0,0,0] op_sel_hi:[1,0,0] neg_lo:[0,0,1] neg_hi:[0,0,1]
v_exp_f32 v79, v79
v_exp_f32 v78, v78
v_exp_f32 v74, v74
v_exp_f32 v72, v72
v_pk_fma_f32 v[86:87], v[86:87], v[130:131], v[102:103] op_sel:[0,1,1] op_sel_hi:[1,1,1] neg_lo:[0,0,1] neg_hi:[0,0,1]
v_exp_f32 v87, v87
v_pk_fma_f32 v[76:77], v[76:77], v[130:131], v[102:103] op_sel:[0,0,0] op_sel_hi:[1,0,0] neg_lo:[0,0,1] neg_hi:[0,0,1]
v_exp_f32 v77, v77
v_add_f32 v106, v106, v107
v_pk_fma_f32 v[80:81], v[80:81], v[130:131], v[102:103] op_sel:[0,0,0] op_sel_hi:[1,0,0] neg_lo:[0,0,1] neg_hi:[0,0,1]
v_exp_f32 v81, v81
v_exp_f32 v80, v80
v_pk_add_f32 v[108:109], v[108:109], v[72:73]
v_permlane32_swap_b32 v104, v105
v_exp_f32 v75, v75
v_add_f32 v104, v104, v105
v_pk_fma_f32 v[82:83], v[82:83], v[130:131], v[102:103] op_sel:[0,0,0] op_sel_hi:[1,0,0] neg_lo:[0,0,1] neg_hi:[0,0,1]
v_exp_f32 v82, v82
v_exp_f32 v83, v83
v_permlane16_swap_b32 v104, v106
v_pk_add_f32 v[108:109], v[108:109], v[74:75]
v_add_f32 v101, v108, v109
v_exp_f32 v76, v76
v_add_f32 v104, v104, v106
v_rcp_f32 v104, v104
v_pk_fma_f32 v[84:85], v[84:85], v[130:131], v[102:103] op_sel:[0,1,1] op_sel_hi:[1,1,1] neg_lo:[0,0,1] neg_hi:[0,0,1]
v_exp_f32 v84, v84
v_exp_f32 v85, v85
v_mov_b32 v106, v104
v_pk_add_f32 v[108:109], v[76:77], v[78:79]
v_pk_add_f32 v[108:109], v[108:109], v[80:81]
v_pk_add_f32 v[108:109], v[108:109], v[82:83]
v_pk_fma_f32 v[88:89], v[88:89], v[130:131], v[102:103] op_sel:[0,1,1] op_sel_hi:[1,1,1] neg_lo:[0,0,1] neg_hi:[0,0,1]
v_exp_f32 v88, v88
v_exp_f32 v89, v89
v_exp_f32 v86, v86
v_pk_fma_f32 v[90:91], v[90:91], v[130:131], v[102:103] op_sel:[0,1,1] op_sel_hi:[1,1,1] neg_lo:[0,0,1] neg_hi:[0,0,1]
v_add_f32 v102, v108, v109
v_pk_add_f32 v[108:109], v[84:85], v[86:87]
v_pk_add_f32 v[108:109], v[108:109], v[88:89]
v_permlane16_swap_b32 v104, v106
v_exp_f32 v90, v90
v_exp_f32 v91, v91
v_permlane32_swap_b32 v100, v101
v_pk_add_f32 v[108:109], v[108:109], v[90:91]
v_add_f32 v103, v108, v109
v_add_f32 v100, v100, v101
v_mov_b32 v105, v104
v_permlane32_swap_b32 v102, v103
v_mov_b32 v107, v106
v_add_f32 v102, v102, v103
v_permlane32_swap_b32 v104, v105
v_permlane32_swap_b32 v106, v107
v_permlane16_swap_b32 v100, v102
v_pk_mul_f32 v[222:223], v[222:223], v[104:105] op_sel:[0,0] op_sel_hi:[1,0]
v_pk_mul_f32 v[226:227], v[226:227], v[104:105] op_sel:[0,0] op_sel_hi:[1,0]
v_pk_mul_f32 v[234:235], v[234:235], v[104:105] op_sel:[0,1] op_sel_hi:[1,1]
v_pk_mul_f32 v[232:233], v[232:233], v[104:105] op_sel:[0,1] op_sel_hi:[1,1]
v_pk_mul_f32 v[230:231], v[230:231], v[104:105] op_sel:[0,1] op_sel_hi:[1,1]
v_add_f32 v100, v100, v102
v_pk_mul_f32 v[228:229], v[228:229], v[104:105] op_sel:[0,1] op_sel_hi:[1,1]
v_cvt_pk_bf16_f32 v228, v228, v229
v_cvt_pk_bf16_f32 v229, v230, v231
v_cvt_pk_bf16_f32 v231, v234, v235
v_cvt_pk_bf16_f32 v230, v232, v233
v_pk_mul_f32 v[220:221], v[220:221], v[104:105] op_sel:[0,0] op_sel_hi:[1,0]
v_cvt_pk_bf16_f32 v220, v220, v221
v_pk_mul_f32 v[224:225], v[224:225], v[104:105] op_sel:[0,0] op_sel_hi:[1,0]
v_pk_mul_f32 v[236:237], v[236:237], v[106:107] op_sel:[0,0] op_sel_hi:[1,0]
v_pk_mul_f32 v[238:239], v[238:239], v[106:107] op_sel:[0,0] op_sel_hi:[1,0]
v_pk_mul_f32 v[240:241], v[240:241], v[106:107] op_sel:[0,0] op_sel_hi:[1,0]
v_pk_mul_f32 v[242:243], v[242:243], v[106:107] op_sel:[0,0] op_sel_hi:[1,0]
v_pk_mul_f32 v[248:249], v[248:249], v[106:107] op_sel:[0,1] op_sel_hi:[1,1]
v_rcp_f32 v100, v100
v_pk_mul_f32 v[244:245], v[244:245], v[106:107] op_sel:[0,1] op_sel_hi:[1,1]
v_mov_b32 v102, v100
v_pk_mul_f32 v[250:251], v[250:251], v[106:107] op_sel:[0,1] op_sel_hi:[1,1]
v_cvt_pk_bf16_f32 v221, v222, v223
v_pk_mul_f32 v[246:247], v[246:247], v[106:107] op_sel:[0,1] op_sel_hi:[1,1]
v_cvt_pk_bf16_f32 v222, v224, v225
v_mfma_f32_16x16x32_bf16 v[200:203], v[228:231], v[36:39], 0
v_cvt_pk_bf16_f32 v223, v226, v227
v_permlane16_swap_b32 v100, v102
v_mfma_f32_16x16x32_bf16 v[196:199], v[228:231], v[38:41], 0
v_mov_b32 v101, v100
v_cvt_pk_bf16_f32 v244, v244, v245
v_mfma_f32_16x16x32_bf16 v[212:215], v[220:223], v[38:41], 0
v_cvt_pk_bf16_f32 v245, v246, v247
v_cvt_pk_bf16_f32 v247, v250, v251
v_mfma_f32_16x16x32_bf16 v[216:219], v[220:223], v[36:39], 0
v_cvt_pk_bf16_f32 v234, v200, v201
v_cvt_pk_bf16_f32 v246, v248, v249
v_cvt_pk_bf16_f32 v226, v196, v197
v_cvt_pk_bf16_f32 v227, v198, v199
v_mfma_f32_16x16x32_bf16 v[196:199], v[244:247], v[38:41], 0
v_cvt_pk_bf16_f32 v225, v214, v215
v_cvt_pk_bf16_f32 v236, v236, v237
v_cvt_pk_bf16_f32 v237, v238, v239
v_cvt_pk_bf16_f32 v232, v216, v217
v_cvt_pk_bf16_f32 v233, v218, v219
v_cvt_pk_bf16_f32 v239, v242, v243
v_cvt_pk_bf16_f32 v238, v240, v241
v_cvt_pk_bf16_f32 v224, v212, v213
v_permlane32_swap_b32 v100, v101
v_mfma_f32_16x16x32_bf16 v[216:219], v[236:239], v[36:39], 0
v_mov_b32 v103, v102
v_cvt_pk_bf16_f32 v235, v202, v203
v_mfma_f32_16x16x32_bf16 v[212:215], v[236:239], v[38:41], 0
v_cvt_pk_bf16_f32 v243, v198, v199
v_permlane32_swap_b32 v102, v103
v_mfma_f32_16x16x32_bf16 v[200:203], v[244:247], v[36:39], 0
v_cvt_pk_bf16_f32 v242, v196, v197
v_mov_b32 v5, s61
v_mfma_f32_16x16x32_bf16 v[220:223], v[232:235], v[120:123], 0
v_cvt_pk_bf16_f32 v249, v218, v219
v_cvt_pk_bf16_f32 v248, v216, v217
v_cvt_pk_bf16_f32 v241, v214, v215
v_cvt_pk_bf16_f32 v240, v212, v213
v_cmp_eq_u32 s[50:51], s41, v2
v_pk_mul_f32 v[64:65], v[64:65], v[100:101] op_sel:[0,0] op_sel_hi:[1,0]
v_pk_mul_f32 v[74:75], v[74:75], v[100:101] op_sel:[0,1] op_sel_hi:[1,1]
v_pk_mul_f32 v[68:69], v[68:69], v[100:101] op_sel:[0,1] op_sel_hi:[1,1]
v_pk_mul_f32 v[72:73], v[72:73], v[100:101] op_sel:[0,1] op_sel_hi:[1,1]
v_pk_mul_f32 v[60:61], v[60:61], v[100:101] op_sel:[0,0] op_sel_hi:[1,0]
v_pk_mul_f32 v[62:63], v[62:63], v[100:101] op_sel:[0,0] op_sel_hi:[1,0]
v_pk_mul_f32 v[66:67], v[66:67], v[100:101] op_sel:[0,0] op_sel_hi:[1,0]
v_pk_mul_f32 v[76:77], v[76:77], v[102:103] op_sel:[0,0] op_sel_hi:[1,0]
v_pk_mul_f32 v[70:71], v[70:71], v[100:101] op_sel:[0,1] op_sel_hi:[1,1]
v_cvt_pk_bf16_f32 v60, v60, v61
v_pk_mul_f32 v[80:81], v[80:81], v[102:103] op_sel:[0,0] op_sel_hi:[1,0]
v_pk_mul_f32 v[78:79], v[78:79], v[102:103] op_sel:[0,0] op_sel_hi:[1,0]
v_pk_mul_f32 v[82:83], v[82:83], v[102:103] op_sel:[0,0] op_sel_hi:[1,0]
v_pk_mul_f32 v[86:87], v[86:87], v[102:103] op_sel:[0,1] op_sel_hi:[1,1]
v_cvt_pk_bf16_f32 v61, v62, v63
v_pk_mul_f32 v[84:85], v[84:85], v[102:103] op_sel:[0,1] op_sel_hi:[1,1]
v_cvt_pk_bf16_f32 v62, v64, v65
v_pk_mul_f32 v[88:89], v[88:89], v[102:103] op_sel:[0,1] op_sel_hi:[1,1]
v_cvt_pk_bf16_f32 v63, v66, v67
v_pk_mul_f32 v[90:91], v[90:91], v[102:103] op_sel:[0,1] op_sel_hi:[1,1]
v_cvt_pk_bf16_f32 v68, v68, v69
v_mfma_f32_16x16x32_bf16 v[208:211], v[60:63], v[36:39], 0
v_cvt_pk_bf16_f32 v69, v70, v71
v_cvt_pk_bf16_f32 v70, v72, v73
v_mfma_f32_16x16x32_bf16 v[204:207], v[60:63], v[38:41], 0
v_cvt_pk_bf16_f32 v71, v74, v75
v_cvt_pk_bf16_f32 v76, v76, v77
v_mfma_f32_16x16x32_bf16 v[60:63], v[232:235], v[112:115], 0
v_cvt_pk_bf16_f32 v250, v200, v201
v_cvt_pk_bf16_f32 v77, v78, v79
v_mfma_f32_16x16x32_bf16 v[192:195], v[68:71], v[36:39], 0
v_cvt_pk_bf16_f32 v78, v80, v81
v_cvt_pk_bf16_f32 v79, v82, v83
v_mfma_f32_16x16x32_bf16 v[188:191], v[68:71], v[38:41], 0
v_cvt_pk_bf16_f32 v65, v206, v207
v_cvt_pk_bf16_f32 v64, v204, v205
v_mfma_f32_16x16x32_bf16 v[68:71], v[224:227], v[120:123], 0
v_cvt_pk_bf16_f32 v251, v202, v203
v_cvt_pk_bf16_f32 v72, v208, v209
v_mfma_f32_16x16x32_bf16 v[152:155], v[224:227], v[112:115], 0
v_cvt_pk_bf16_f32 v73, v210, v211
v_cvt_pk_bf16_f32 v84, v84, v85
v_mfma_f32_16x16x32_bf16 v[60:63], v[248:251], v[116:119], v[60:63]
v_cvt_pk_bf16_f32 v85, v86, v87
v_cvt_pk_bf16_f32 v86, v88, v89
v_mfma_f32_16x16x32_bf16 v[228:231], v[224:227], v[48:51], 0
v_cvt_pk_bf16_f32 v67, v190, v191
v_cvt_pk_bf16_f32 v87, v90, v91
v_mfma_f32_16x16x32_bf16 v[220:223], v[248:251], v[124:127], v[220:223]
v_cvt_pk_bf16_f32 v66, v188, v189
v_cvt_pk_bf16_f32 v74, v192, v193
v_mfma_f32_16x16x32_bf16 v[152:155], v[240:243], v[116:119], v[152:155]
v_cvt_pk_bf16_f32 v75, v194, v195
v_mfma_f32_16x16x32_bf16 v[204:207], v[76:79], v[38:41], 0
v_mfma_f32_16x16x32_bf16 v[208:211], v[76:79], v[36:39], 0
v_mfma_f32_16x16x32_bf16 v[228:231], v[240:243], v[48:51], v[228:231]
v_mfma_f32_16x16x32_bf16 v[68:71], v[240:243], v[124:127], v[68:71]
v_mfma_f32_16x16x32_bf16 v[76:79], v[232:235], v[48:51], 0
s_nop 1
v_cvt_pk_bf16_f32 v152, v152, v153
v_mfma_f32_16x16x32_bf16 v[76:79], v[248:251], v[48:51], v[76:79]
v_cvt_pk_bf16_f32 v153, v154, v155
v_cvt_pk_bf16_f32 v154, v60, v61
v_mfma_f32_16x16x32_bf16 v[192:195], v[84:87], v[36:39], 0
v_cvt_pk_bf16_f32 v68, v68, v69
v_cvt_pk_bf16_f32 v155, v62, v63
v_mfma_f32_16x16x32_bf16 v[188:191], v[84:87], v[38:41], 0
ds_write_b128 v42, v[152:155] offset:0
v_mfma_f32_16x16x32_bf16 v[136:139], v[64:67], v[48:51], 0
v_cvt_pk_bf16_f32 v69, v70, v71
v_cvt_pk_bf16_f32 v228, v228, v229
v_mfma_f32_16x16x32_bf16 v[104:107], v[72:75], v[112:115], 0
v_cvt_pk_bf16_f32 v71, v222, v223
v_cvt_pk_bf16_f32 v229, v230, v231
v_mfma_f32_16x16x32_bf16 v[148:151], v[72:75], v[48:51], 0
v_cvt_pk_bf16_f32 v230, v76, v77
v_cvt_pk_bf16_f32 v70, v220, v221
v_mfma_f32_16x16x32_bf16 v[132:135], v[72:75], v[120:123], 0
ds_write_b128 v42, v[68:71] offset:1024
v_mfma_f32_16x16x32_bf16 v[108:111], v[64:67], v[120:123], 0
v_cvt_pk_bf16_f32 v231, v78, v79
ds_write_b128 v42, v[228:231] offset:2048
v_mfma_f32_16x16x32_bf16 v[100:103], v[64:67], v[112:115], 0
ds_write_b32 v52, v5
v_cvt_pk_bf16_f32 v88, v208, v209
v_cvt_pk_bf16_f32 v83, v190, v191
v_cvt_pk_bf16_f32 v91, v194, v195
v_cvt_pk_bf16_f32 v82, v188, v189
v_cvt_pk_bf16_f32 v80, v204, v205
v_cvt_pk_bf16_f32 v89, v210, v211
v_cvt_pk_bf16_f32 v81, v206, v207
v_cvt_pk_bf16_f32 v90, v192, v193
s_nop 0
v_mfma_f32_16x16x32_bf16 v[100:103], v[80:83], v[116:119], v[100:103]
v_mfma_f32_16x16x32_bf16 v[108:111], v[80:83], v[124:127], v[108:111]
v_mfma_f32_16x16x32_bf16 v[132:135], v[88:91], v[124:127], v[132:135]
v_mfma_f32_16x16x32_bf16 v[148:151], v[88:91], v[48:51], v[148:151]
v_mfma_f32_16x16x32_bf16 v[136:139], v[80:83], v[48:51], v[136:139]
v_mfma_f32_16x16x32_bf16 v[104:107], v[88:91], v[116:119], v[104:107]
s_mov_b32 s63, 0
px_120:
ds_read_b32 v4, v19
ds_read_b128 v[188:191], v43 offset:0
ds_read_b128 v[192:195], v43 offset:1024
ds_read_b128 v[196:199], v43 offset:2048
s_add_u32 s63, s63, 1
s_cmp_lt_u32 s63, 0x400000
s_waitcnt lgkmcnt(0)
v_cmp_ne_u32 vcc, s61, v4
s_cbranch_vccz pxd_121
s_cbranch_scc1 px_120
pxd_121:
v_mfma_f32_16x16x32_bf16 v[100:103], v[38:41], v[188:191], v[100:103]
v_mfma_f32_16x16x32_bf16 v[104:107], v[36:39], v[188:191], v[104:107]
v_mfma_f32_16x16x32_bf16 v[108:111], v[38:41], v[192:195], v[108:111]
v_mfma_f32_16x16x32_bf16 v[132:135], v[36:39], v[192:195], v[132:135]
v_mfma_f32_16x16x32_bf16 v[136:139], v[38:41], v[196:199], v[136:139]
v_mfma_f32_16x16x32_bf16 v[148:151], v[36:39], v[196:199], v[148:151]
s_nop 2
v_cvt_pk_bf16_f32 v100, v100, v101
v_cvt_pk_bf16_f32 v101, v102, v103
v_cvt_pk_bf16_f32 v102, v104, v105
v_cvt_pk_bf16_f32 v103, v106, v107
buffer_store_dwordx4 v[100:103], v55, s[32:35], s53 offen sc1
v_cvt_pk_bf16_f32 v108, v108, v109
v_cvt_pk_bf16_f32 v109, v110, v111
v_cvt_pk_bf16_f32 v110, v132, v133
v_cvt_pk_bf16_f32 v111, v134, v135
buffer_store_dwordx4 v[108:111], v55, s[32:35], s54 offen sc1
v_cvt_pk_bf16_f32 v136, v136, v137
v_cvt_pk_bf16_f32 v137, v138, v139
v_cvt_pk_bf16_f32 v138, v148, v149
v_cvt_pk_bf16_f32 v139, v150, v151
s_mov_b64 exec, s[50:51]
buffer_store_dwordx4 v[136:139], v58, s[32:35], s56 offen sc1
s_mov_b64 exec, -1
s_mov_b32 s51, 0
.p2align 3
v_pk_fma_f32 v[156:157], v[140:141], v[92:93], v[156:157] op_sel:[0,1,0] op_sel_hi:[1,1,1]
v_pk_fma_f32 v[164:165], v[140:141], v[94:95], v[164:165] op_sel:[0,1,0] op_sel_hi:[1,1,1]
v_pk_fma_f32 v[172:173], v[140:141], v[96:97], v[172:173] op_sel:[0,1,0] op_sel_hi:[1,1,1]
v_pk_fma_f32 v[180:181], v[140:141], v[98:99], v[180:181] op_sel:[0,1,0] op_sel_hi:[1,1,1]
v_pk_fma_f32 v[158:159], v[142:143], v[92:93], v[158:159] op_sel:[0,1,0] op_sel_hi:[1,1,1]
v_cvt_pk_bf16_f32 v156, v156, v157
v_pk_fma_f32 v[166:167], v[142:143], v[94:95], v[166:167] op_sel:[0,1,0] op_sel_hi:[1,1,1]
v_cvt_pk_bf16_f32 v164, v164, v165
v_pk_fma_f32 v[174:175], v[142:143], v[96:97], v[174:175] op_sel:[0,1,0] op_sel_hi:[1,1,1]
v_cvt_pk_bf16_f32 v172, v172, v173
v_pk_fma_f32 v[182:183], v[142:143], v[98:99], v[182:183] op_sel:[0,1,0] op_sel_hi:[1,1,1]
v_cvt_pk_bf16_f32 v180, v180, v181
v_pk_fma_f32 v[160:161], v[144:145], v[92:93], v[160:161] op_sel:[0,1,0] op_sel_hi:[1,1,1]
v_pk_fma_f32 v[162:163], v[146:147], v[92:93], v[162:163] op_sel:[0,1,0] op_sel_hi:[1,1,1]
v_cvt_pk_bf16_f32 v157, v158, v159
v_pk_fma_f32 v[168:169], v[144:145], v[94:95], v[168:169] op_sel:[0,1,0] op_sel_hi:[1,1,1]
v_pk_fma_f32 v[170:171], v[146:147], v[94:95], v[170:171] op_sel:[0,1,0] op_sel_hi:[1,1,1]
v_cvt_pk_bf16_f32 v165, v166, v167
v_pk_fma_f32 v[176:177], v[144:145], v[96:97], v[176:177] op_sel:[0,1,0] op_sel_hi:[1,1,1]
v_pk_fma_f32 v[178:179], v[146:147], v[96:97], v[178:179] op_sel:[0,1,0] op_sel_hi:[1,1,1]
v_cvt_pk_bf16_f32 v173, v174, v175
v_pk_fma_f32 v[184:185], v[144:145], v[98:99], v[184:185] op_sel:[0,1,0] op_sel_hi:[1,1,1]
v_pk_fma_f32 v[186:187], v[146:147], v[98:99], v[186:187] op_sel:[0,1,0] op_sel_hi:[1,1,1]
v_cvt_pk_bf16_f32 v181, v182, v183
v_cvt_pk_bf16_f32 v158, v160, v161
v_cvt_pk_bf16_f32 v159, v162, v163
v_cvt_pk_bf16_f32 v166, v168, v169
v_cvt_pk_bf16_f32 v167, v170, v171
v_mfma_f32_16x16x32_bf16 v[60:63], v[10:13], v[156:159], 0
v_cvt_pk_bf16_f32 v174, v176, v177
v_cvt_pk_bf16_f32 v175, v178, v179
v_mfma_f32_16x16x32_bf16 v[68:71], v[10:13], v[164:167], 0
v_cvt_pk_bf16_f32 v182, v184, v185
v_cvt_pk_bf16_f32 v183, v186, v187
v_mfma_f32_16x16x32_bf16 v[76:79], v[10:13], v[172:175], 0
s_nop 0
v_mfma_f32_16x16x32_bf16 v[84:87], v[10:13], v[180:183], 0
v_min3_f32 v104, v60, v61, v62
v_max3_f32 v100, v60, v61, v62
v_mfma_f32_16x16x32_bf16 v[64:67], v[14:17], v[156:159], 0
v_min3_f32 v105, v68, v69, v70
v_max3_f32 v101, v68, v69, v70
v_mfma_f32_16x16x32_bf16 v[72:75], v[14:17], v[164:167], 0
v_min3_f32 v106, v76, v77, v78
v_max3_f32 v102, v76, v77, v78
v_mfma_f32_16x16x32_bf16 v[80:83], v[14:17], v[172:175], 0
v_min3_f32 v107, v84, v85, v86
v_max3_f32 v103, v84, v85, v86
v_mfma_f32_16x16x32_bf16 v[88:91], v[14:17], v[180:183], 0
v_min3_f32 v104, v104, v63, v64
v_max3_f32 v100, v100, v63, v64
v_min3_f32 v105, v105, v71, v72
v_min3_f32 v104, v104, v65, v66
v_max3_f32 v101, v101, v71, v72
v_min3_f32 v106, v106, v79, v80
v_min3_f32 v105, v105, v73, v74
v_max3_f32 v102, v102, v79, v80
v_min3_f32 v107, v107, v87, v88
v_min3_f32 v106, v106, v81, v82
v_max3_f32 v103, v103, v87, v88
v_min3_f32 v107, v107, v89, v90
v_max3_f32 v100, v100, v65, v66
v_min_f32 v104, v104, v67
v_max3_f32 v101, v101, v73, v74
v_min_f32 v105, v105, v75
v_max3_f32 v102, v102, v81, v82
v_min_f32 v106, v106, v83
v_max3_f32 v103, v103, v89, v90
v_min_f32 v107, v107, v91
v_max_f32 v100, v100, v67
v_max_f32 v101, v101, v75
v_max_f32 v102, v102, v83
v_max_f32 v103, v103, v91
v_permlane32_swap_b32 v104, v105
v_permlane32_swap_b32 v106, v107
v_permlane32_swap_b32 v100, v101
v_permlane32_swap_b32 v102, v103
v_min_f32 v104, v104, v105
v_min_f32 v106, v106, v107
v_max_f32 v100, v100, v101
v_max_f32 v102, v102, v103
v_permlane16_swap_b32 v104, v106
s_nop 0
v_permlane16_swap_b32 v100, v102
v_min_f32 v104, v104, v106
v_max_f32 v100, v100, v102
v_mov_b32 v106, v104
v_mov_b32 v102, v100
s_nop 0
v_permlane16_swap_b32 v104, v106
v_permlane16_swap_b32 v100, v102
v_mov_b32 v105, v104
v_mov_b32 v101, v100
v_mov_b32 v103, v102
v_permlane32_swap_b32 v104, v105
v_mov_b32 v107, v106
v_permlane32_swap_b32_e64 v100, v101
v_pk_mul_f32 v[104:105], v[104:105], v[128:129]
v_pk_mul_f32 v[100:101], v[100:101], v[128:129]
v_pk_fma_f32 v[220:221], v[60:61], v[128:129], v[104:105] op_sel:[0,0,0] op_sel_hi:[1,0,0] neg_lo:[1,0,0] neg_hi:[1,0,0]
v_pk_fma_f32 v[222:223], v[62:63], v[128:129], v[104:105] op_sel:[0,0,0] op_sel_hi:[1,0,0] neg_lo:[1,0,0] neg_hi:[1,0,0]
v_pk_fma_f32 v[224:225], v[64:65], v[128:129], v[104:105] op_sel:[0,0,0] op_sel_hi:[1,0,0] neg_lo:[1,0,0] neg_hi:[1,0,0]
v_pk_fma_f32 v[226:227], v[66:67], v[128:129], v[104:105] op_sel:[0,0,0] op_sel_hi:[1,0,0] neg_lo:[1,0,0] neg_hi:[1,0,0]
v_pk_fma_f32 v[228:229], v[68:69], v[128:129], v[104:105] op_sel:[0,1,1] op_sel_hi:[1,1,1] neg_lo:[1,0,0] neg_hi:[1,0,0]
v_pk_fma_f32 v[230:231], v[70:71], v[128:129], v[104:105] op_sel:[0,1,1] op_sel_hi:[1,1,1] neg_lo:[1,0,0] neg_hi:[1,0,0]
v_pk_fma_f32 v[232:233], v[72:73], v[128:129], v[104:105] op_sel:[0,1,1] op_sel_hi:[1,1,1] neg_lo:[1,0,0] neg_hi:[1,0,0]
v_pk_fma_f32 v[234:235], v[74:75], v[128:129], v[104:105] op_sel:[0,1,1] op_sel_hi:[1,1,1] neg_lo:[1,0,0] neg_hi:[1,0,0]
v_permlane32_swap_b32 v102, v103
v_permlane32_swap_b32 v106, v107
v_pk_fma_f32 v[60:61], v[60:61], v[128:129], v[100:101] op_sel:[0,0,0] op_sel_hi:[1,0,0] neg_lo:[0,0,1] neg_hi:[0,0,1]
v_pk_fma_f32 v[62:63], v[62:63], v[128:129], v[100:101] op_sel:[0,0,0] op_sel_hi:[1,0,0] neg_lo:[0,0,1] neg_hi:[0,0,1]
v_pk_fma_f32 v[64:65], v[64:65], v[128:129], v[100:101] op_sel:[0,0,0] op_sel_hi:[1,0,0] neg_lo:[0,0,1] neg_hi:[0,0,1]
v_pk_fma_f32 v[66:67], v[66:67], v[128:129], v[100:101] op_sel:[0,0,0] op_sel_hi:[1,0,0] neg_lo:[0,0,1] neg_hi:[0,0,1]
v_pk_fma_f32 v[68:69], v[68:69], v[128:129], v[100:101] op_sel:[0,1,1] op_sel_hi:[1,1,1] neg_lo:[0,0,1] neg_hi:[0,0,1]
v_pk_fma_f32 v[70:71], v[70:71], v[128:129], v[100:101] op_sel:[0,1,1] op_sel_hi:[1,1,1] neg_lo:[0,0,1] neg_hi:[0,0,1]
v_pk_fma_f32 v[72:73], v[72:73], v[128:129], v[100:101] op_sel:[0,1,1] op_sel_hi:[1,1,1] neg_lo:[0,0,1] neg_hi:[0,0,1]
v_pk_fma_f32 v[74:75], v[74:75], v[128:129], v[100:101] op_sel:[0,1,1] op_sel_hi:[1,1,1] neg_lo:[0,0,1] neg_hi:[0,0,1]
v_exp_f32 v220, v220
v_exp_f32 v60, v60
v_exp_f32 v221, v221
v_exp_f32 v61, v61
v_exp_f32 v222, v222
v_exp_f32 v62, v62
v_exp_f32 v223, v223
v_exp_f32 v63, v63
v_exp_f32 v224, v224
v_exp_f32 v64, v64
v_exp_f32 v225, v225
v_exp_f32 v65, v65
v_exp_f32 v226, v226
v_exp_f32 v66, v66
v_exp_f32 v227, v227
v_exp_f32 v67, v67
v_exp_f32 v228, v228
v_exp_f32 v68, v68
v_exp_f32 v229, v229
v_exp_f32 v69, v69
v_exp_f32 v230, v230
v_exp_f32 v70, v70
v_exp_f32 v231, v231
v_exp_f32 v71, v71
v_exp_f32 v232, v232
v_exp_f32 v72, v72
v_exp_f32 v233, v233
v_exp_f32 v73, v73
v_exp_f32 v234, v234
v_exp_f32 v74, v74
v_exp_f32 v235, v235
v_exp_f32 v75, v75
v_pk_mul_f32 v[102:103], v[102:103], v[130:131]
v_pk_mul_f32 v[106:107], v[106:107], v[130:131]
buffer_load_dwordx4 v[212:215], v18, s[32:35], s55 offen offset:0 sc1
buffer_load_dwordx4 v[216:219], v18, s[32:35], s55 offen offset:1024 sc1
.p2align 3
v_pk_add_f32 v[108:109], v[60:61], v[62:63]
v_pk_add_f32 v[110:111], v[220:221], v[222:223]
v_pk_add_f32 v[108:109], v[108:109], v[64:65]
v_pk_add_f32 v[110:111], v[110:111], v[224:225]
v_pk_add_f32 v[108:109], v[108:109], v[66:67]
v_pk_add_f32 v[110:111], v[110:111], v[226:227]
v_add_f32 v100, v108, v109
v_add_f32 v104, v110, v111
v_pk_fma_f32 v[236:237], v[76:77], v[130:131], v[106:107] op_sel:[0,0,0] op_sel_hi:[1,0,0] neg_lo:[1,0,0] neg_hi:[1,0,0]
v_pk_fma_f32 v[238:239], v[78:79], v[130:131], v[106:107] op_sel:[0,0,0] op_sel_hi:[1,0,0] neg_lo:[1,0,0] neg_hi:[1,0,0]
v_pk_add_f32 v[108:109], v[68:69], v[70:71]
v_pk_add_f32 v[110:111], v[228:229], v[230:231]
v_pk_fma_f32 v[76:77], v[76:77], v[130:131], v[102:103] op_sel:[0,0,0] op_sel_hi:[1,0,0] neg_lo:[0,0,1] neg_hi:[0,0,1]
v_pk_fma_f32 v[78:79], v[78:79], v[130:131], v[102:103] op_sel:[0,0,0] op_sel_hi:[1,0,0] neg_lo:[0,0,1] neg_hi:[0,0,1]
v_pk_fma_f32 v[240:241], v[80:81], v[130:131], v[106:107] op_sel:[0,0,0] op_sel_hi:[1,0,0] neg_lo:[1,0,0] neg_hi:[1,0,0]
v_pk_add_f32 v[108:109], v[108:109], v[72:73]
v_pk_add_f32 v[110:111], v[110:111], v[232:233]
v_exp_f32 v236, v236
v_exp_f32 v76, v76
v_exp_f32 v237, v237
v_exp_f32 v77, v77
v_exp_f32 v238, v238
v_exp_f32 v78, v78
v_exp_f32 v239, v239
v_exp_f32 v79, v79
v_pk_fma_f32 v[80:81], v[80:81], v[130:131], v[102:103] op_sel:[0,0,0] op_sel_hi:[1,0,0] neg_lo:[0,0,1] neg_hi:[0,0,1]
v_pk_fma_f32 v[242:243], v[82:83], v[130:131], v[106:107] op_sel:[0,0,0] op_sel_hi:[1,0,0] neg_lo:[1,0,0] neg_hi:[1,0,0]
v_pk_add_f32 v[108:109], v[108:109], v[74:75]
v_pk_add_f32 v[110:111], v[110:111], v[234:235]
v_exp_f32 v240, v240
v_exp_f32 v80, v80
v_exp_f32 v241, v241
v_exp_f32 v81, v81
v_pk_fma_f32 v[82:83], v[82:83], v[130:131], v[102:103] op_sel:[0,0,0] op_sel_hi:[1,0,0] neg_lo:[0,0,1] neg_hi:[0,0,1]
v_add_f32 v101, v108, v109
v_add_f32 v105, v110, v111
v_exp_f32 v242, v242
v_exp_f32 v82, v82
v_exp_f32 v243, v243
v_exp_f32 v83, v83
v_pk_fma_f32 v[244:245], v[84:85], v[130:131], v[106:107] op_sel:[0,1,1] op_sel_hi:[1,1,1] neg_lo:[1,0,0] neg_hi:[1,0,0]
v_pk_fma_f32 v[246:247], v[86:87], v[130:131], v[106:107] op_sel:[0,1,1] op_sel_hi:[1,1,1] neg_lo:[1,0,0] neg_hi:[1,0,0]
v_pk_add_f32 v[108:109], v[76:77], v[78:79]
v_pk_add_f32 v[110:111], v[236:237], v[238:239]
v_pk_fma_f32 v[84:85], v[84:85], v[130:131], v[102:103] op_sel:[0,1,1] op_sel_hi:[1,1,1] neg_lo:[0,0,1] neg_hi:[0,0,1]
v_pk_fma_f32 v[86:87], v[86:87], v[130:131], v[102:103] op_sel:[0,1,1] op_sel_hi:[1,1,1] neg_lo:[0,0,1] neg_hi:[0,0,1]
v_pk_fma_f32 v[248:249], v[88:89], v[130:131], v[106:107] op_sel:[0,1,1] op_sel_hi:[1,1,1] neg_lo:[1,0,0] neg_hi:[1,0,0]
v_pk_fma_f32 v[250:251], v[90:91], v[130:131], v[106:107] op_sel:[0,1,1] op_sel_hi:[1,1,1] neg_lo:[1,0,0] neg_hi:[1,0,0]
v_pk_add_f32 v[108:109], v[108:109], v[80:81]
v_pk_add_f32 v[110:111], v[110:111], v[240:241]
v_exp_f32 v244, v244
v_exp_f32 v84, v84
v_exp_f32 v245, v245
v_exp_f32 v85, v85
v_exp_f32 v246, v246
v_exp_f32 v86, v86
v_exp_f32 v247, v247
v_exp_f32 v87, v87
v_pk_fma_f32 v[88:89], v[88:89], v[130:131], v[102:103] op_sel:[0,1,1] op_sel_hi:[1,1,1] neg_lo:[0,0,1] neg_hi:[0,0,1]
v_pk_fma_f32 v[90:91], v[90:91], v[130:131], v[102:103] op_sel:[0,1,1] op_sel_hi:[1,1,1] neg_lo:[0,0,1] neg_hi:[0,0,1]
v_pk_add_f32 v[108:109], v[108:109], v[82:83]
v_pk_add_f32 v[110:111], v[110:111], v[242:243]
v_exp_f32 v248, v248
v_exp_f32 v88, v88
v_exp_f32 v249, v249
v_exp_f32 v89, v89
v_add_f32 v102, v108, v109
v_add_f32 v106, v110, v111
v_exp_f32 v250, v250
v_exp_f32 v90, v90
v_exp_f32 v251, v251
v_exp_f32 v91, v91
v_pk_add_f32 v[108:109], v[84:85], v[86:87]
v_pk_add_f32 v[110:111], v[244:245], v[246:247]
v_pk_add_f32 v[108:109], v[108:109], v[88:89]
v_pk_add_f32 v[110:111], v[110:111], v[248:249]
v_pk_add_f32 v[108:109], v[108:109], v[90:91]
v_pk_add_f32 v[110:111], v[110:111], v[250:251]
v_add_f32 v103, v108, v109
v_add_f32 v107, v110, v111
s_cmp_eq_u32 s51, 1
s_cbranch_scc1 chk_122
s_waitcnt vmcnt(0)
v_max_u32 v4, v212, v213
v_max3_u32 v4, v4, v214, v215
v_max3_u32 v4, v4, v216, v217
v_max3_u32 v4, v4, v218, v219
v_cmp_eq_u32 vcc, -1, v4
s_cbranch_vccz red_123
buffer_load_dwordx4 v[212:215], v18, s[32:35], s55 offen offset:0 sc1
buffer_load_dwordx4 v[216:219], v18, s[32:35], s55 offen offset:1024 sc1
s_branch chk_122
red_123:
v_mfma_f32_16x16x32_bf16 v[132:135], v[44:47], v[212:215], 0
v_mfma_f32_16x16x32_bf16 v[132:135], v[44:47], v[216:219], v[132:135]
s_mov_b32 s51, 1
s_nop 6
v_add_f32_dpp v132, v132, v132 row_ror:8 row_mask:0xf bank_mask:0xf
v_add_f32_dpp v133, v133, v133 row_ror:8 row_mask:0xf bank_mask:0xf
v_add_f32_dpp v134, v134, v134 row_ror:8 row_mask:0xf bank_mask:0xf
v_add_f32_dpp v135, v135, v135 row_ror:8 row_mask:0xf bank_mask:0xf
v_cvt_pk_bf16_f32 v132, v132, v133
v_cvt_pk_bf16_f32 v133, v134, v135
s_mov_b64 exec, 0x00ff00ff
buffer_store_dwordx2 v[132:133], v59, s[32:35], s79 offen sc1
s_mov_b64 exec, -1
buffer_load_dwordx4 v[204:207], v58, s[32:35], s56 offen sc1
buffer_load_dwordx4 v[208:211], v58, s[32:35], s57 offen sc1
chk_122:
.p2align 3
v_permlane32_swap_b32 v100, v101
v_permlane32_swap_b32 v102, v103
v_permlane32_swap_b32 v104, v105
v_permlane32_swap_b32 v106, v107
v_add_f32 v100, v100, v101
v_add_f32 v102, v102, v103
v_add_f32 v104, v104, v105
v_add_f32 v106, v106, v107
v_permlane16_swap_b32 v100, v102
s_nop 0
v_permlane16_swap_b32 v104, v106
v_add_f32 v100, v100, v102
v_add_f32 v104, v104, v106
v_rcp_f32 v100, v100
v_rcp_f32 v104, v104
v_mov_b32 v102, v100
v_mov_b32 v106, v104
s_nop 0
v_permlane16_swap_b32 v100, v102
v_permlane16_swap_b32 v104, v106
v_mov_b32 v101, v100
v_mov_b32 v103, v102
v_mov_b32 v105, v104
v_mov_b32 v107, v106
v_permlane32_swap_b32 v100, v101
v_permlane32_swap_b32 v102, v103
v_permlane32_swap_b32 v104, v105
v_permlane32_swap_b32 v106, v107
v_pk_mul_f32 v[60:61], v[60:61], v[100:101] op_sel:[0,0] op_sel_hi:[1,0]
v_pk_mul_f32 v[220:221], v[220:221], v[104:105] op_sel:[0,0] op_sel_hi:[1,0]
v_pk_mul_f32 v[68:69], v[68:69], v[100:101] op_sel:[0,1] op_sel_hi:[1,1]
v_pk_mul_f32 v[228:229], v[228:229], v[104:105] op_sel:[0,1] op_sel_hi:[1,1]
v_pk_mul_f32 v[76:77], v[76:77], v[102:103] op_sel:[0,0] op_sel_hi:[1,0]
v_pk_mul_f32 v[236:237], v[236:237], v[106:107] op_sel:[0,0] op_sel_hi:[1,0]
v_pk_mul_f32 v[84:85], v[84:85], v[102:103] op_sel:[0,1] op_sel_hi:[1,1]
v_pk_mul_f32 v[244:245], v[244:245], v[106:107] op_sel:[0,1] op_sel_hi:[1,1]
v_pk_mul_f32 v[62:63], v[62:63], v[100:101] op_sel:[0,0] op_sel_hi:[1,0]
v_pk_mul_f32 v[222:223], v[222:223], v[104:105] op_sel:[0,0] op_sel_hi:[1,0]
v_cvt_pk_bf16_f32 v60, v60, v61
v_cvt_pk_bf16_f32 v220, v220, v221
v_pk_mul_f32 v[70:71], v[70:71], v[100:101] op_sel:[0,1] op_sel_hi:[1,1]
v_pk_mul_f32 v[230:231], v[230:231], v[104:105] op_sel:[0,1] op_sel_hi:[1,1]
v_cvt_pk_bf16_f32 v68, v68, v69
v_cvt_pk_bf16_f32 v228, v228, v229
v_pk_mul_f32 v[78:79], v[78:79], v[102:103] op_sel:[0,0] op_sel_hi:[1,0]
v_pk_mul_f32 v[238:239], v[238:239], v[106:107] op_sel:[0,0] op_sel_hi:[1,0]
v_cvt_pk_bf16_f32 v76, v76, v77
v_cvt_pk_bf16_f32 v236, v236, v237
v_pk_mul_f32 v[86:87], v[86:87], v[102:103] op_sel:[0,1] op_sel_hi:[1,1]
v_pk_mul_f32 v[246:247], v[246:247], v[106:107] op_sel:[0,1] op_sel_hi:[1,1]
v_cvt_pk_bf16_f32 v84, v84, v85
v_cvt_pk_bf16_f32 v244, v244, v245
v_pk_mul_f32 v[64:65], v[64:65], v[100:101] op_sel:[0,0] op_sel_hi:[1,0]
v_pk_mul_f32 v[66:67], v[66:67], v[100:101] op_sel:[0,0] op_sel_hi:[1,0]
v_pk_mul_f32 v[224:225], v[224:225], v[104:105] op_sel:[0,0] op_sel_hi:[1,0]
v_pk_mul_f32 v[226:227], v[226:227], v[104:105] op_sel:[0,0] op_sel_hi:[1,0]
v_cvt_pk_bf16_f32 v61, v62, v63
v_cvt_pk_bf16_f32 v221, v222, v223
v_pk_mul_f32 v[72:73], v[72:73], v[100:101] op_sel:[0,1] op_sel_hi:[1,1]
v_pk_mul_f32 v[74:75], v[74:75], v[100:101] op_sel:[0,1] op_sel_hi:[1,1]
v_pk_mul_f32 v[232:233], v[232:233], v[104:105] op_sel:[0,1] op_sel_hi:[1,1]
v_pk_mul_f32 v[234:235], v[234:235], v[104:105] op_sel:[0,1] op_sel_hi:[1,1]
v_cvt_pk_bf16_f32 v69, v70, v71
v_cvt_pk_bf16_f32 v229, v230, v231
v_pk_mul_f32 v[80:81], v[80:81], v[102:103] op_sel:[0,0] op_sel_hi:[1,0]
v_pk_mul_f32 v[82:83], v[82:83], v[102:103] op_sel:[0,0] op_sel_hi:[1,0]
v_pk_mul_f32 v[240:241], v[240:241], v[106:107] op_sel:[0,0] op_sel_hi:[1,0]
v_pk_mul_f32 v[242:243], v[242:243], v[106:107] op_sel:[0,0] op_sel_hi:[1,0]
v_cvt_pk_bf16_f32 v77, v78, v79
v_cvt_pk_bf16_f32 v237, v238, v239
v_pk_mul_f32 v[88:89], v[88:89], v[102:103] op_sel:[0,1] op_sel_hi:[1,1]
v_pk_mul_f32 v[90:91], v[90:91], v[102:103] op_sel:[0,1] op_sel_hi:[1,1]
v_pk_mul_f32 v[248:249], v[248:249], v[106:107] op_sel:[0,1] op_sel_hi:[1,1]
v_pk_mul_f32 v[250:251], v[250:251], v[106:107] op_sel:[0,1] op_sel_hi:[1,1]
v_cvt_pk_bf16_f32 v85, v86, v87
v_cvt_pk_bf16_f32 v245, v246, v247
v_cvt_pk_bf16_f32 v62, v64, v65
v_cvt_pk_bf16_f32 v63, v66, v67
v_cvt_pk_bf16_f32 v222, v224, v225
v_cvt_pk_bf16_f32 v223, v226, v227
v_cvt_pk_bf16_f32 v70, v72, v73
v_cvt_pk_bf16_f32 v71, v74, v75
v_cvt_pk_bf16_f32 v230, v232, v233
v_cvt_pk_bf16_f32 v231, v234, v235
v_cvt_pk_bf16_f32 v78, v80, v81
v_cvt_pk_bf16_f32 v79, v82, v83
v_cvt_pk_bf16_f32 v238, v240, v241
v_cvt_pk_bf16_f32 v239, v242, v243
v_cvt_pk_bf16_f32 v86, v88, v89
v_cvt_pk_bf16_f32 v87, v90, v91
v_cvt_pk_bf16_f32 v246, v248, v249
v_cvt_pk_bf16_f32 v247, v250, v251
s_cmp_lg_u32 s51, 0
s_cbranch_scc1 else_124
s_mov_b32 s63, 0
sent_126:
s_waitcnt vmcnt(0)
v_max_u32 v4, v212, v213
v_max3_u32 v4, v4, v214, v215
v_max3_u32 v4, v4, v216, v217
v_max3_u32 v4, v4, v218, v219
v_cmp_eq_u32 vcc, -1, v4
s_cbranch_vccz sentd_127
buffer_load_dwordx4 v[212:215], v18, s[32:35], s55 offen offset:0 sc1
buffer_load_dwordx4 v[216:219], v18, s[32:35], s55 offen offset:1024 sc1
s_add_u32 s63, s63, 1
s_cmp_lt_u32 s63, 0x80000
s_cbranch_scc1 sent_126
s_waitcnt vmcnt(0)
sentd_127:
v_mfma_f32_16x16x32_bf16 v[132:135], v[44:47], v[212:215], 0
v_mfma_f32_16x16x32_bf16 v[132:135], v[44:47], v[216:219], v[132:135]
s_mov_b32 s51, 1
s_nop 6
v_add_f32_dpp v132, v132, v132 row_ror:8 row_mask:0xf bank_mask:0xf
v_add_f32_dpp v133, v133, v133 row_ror:8 row_mask:0xf bank_mask:0xf
v_add_f32_dpp v134, v134, v134 row_ror:8 row_mask:0xf bank_mask:0xf
v_add_f32_dpp v135, v135, v135 row_ror:8 row_mask:0xf bank_mask:0xf
v_cvt_pk_bf16_f32 v132, v132, v133
v_cvt_pk_bf16_f32 v133, v134, v135
s_mov_b64 exec, 0x00ff00ff
buffer_store_dwordx2 v[132:133], v59, s[32:35], s79 offen sc1
s_mov_b64 exec, -1
buffer_load_dwordx4 v[204:207], v58, s[32:35], s56 offen sc1
buffer_load_dwordx4 v[208:211], v58, s[32:35], s57 offen sc1
else_124:
s_mov_b32 s63, 0
sent_128:
s_waitcnt vmcnt(0)
v_max_u32 v4, v204, v205
v_max3_u32 v4, v4, v206, v207
v_max3_u32 v4, v4, v208, v209
v_max3_u32 v4, v4, v210, v211
v_cmp_eq_u32 vcc, -1, v4
s_cbranch_vccz sentd_129
buffer_load_dwordx4 v[204:207], v58, s[32:35], s56 offen sc1
buffer_load_dwordx4 v[208:211], v58, s[32:35], s57 offen sc1
s_add_u32 s63, s63, 1
s_cmp_lt_u32 s63, 0x80000
s_cbranch_scc1 sent_128
s_waitcnt vmcnt(0)
sentd_129:
v_mfma_f32_16x16x32_bf16 v[112:115], v[204:207], v[60:63], 0
v_mfma_f32_16x16x32_bf16 v[116:119], v[204:207], v[68:71], 0
v_mfma_f32_16x16x32_bf16 v[120:123], v[204:207], v[76:79], 0
v_mfma_f32_16x16x32_bf16 v[124:127], v[204:207], v[84:87], 0
v_mfma_f32_16x16x32_bf16 v[112:115], v[208:211], v[220:223], v[112:115]
v_mfma_f32_16x16x32_bf16 v[116:119], v[208:211], v[228:231], v[116:119]
v_mfma_f32_16x16x32_bf16 v[120:123], v[208:211], v[236:239], v[120:123]
v_mfma_f32_16x16x32_bf16 v[124:127], v[208:211], v[244:247], v[124:127]
s_nop 4
v_add_f32 v100, v112, v113
v_add_f32 v114, v114, v115
v_add_f32 v100, v100, v114
v_add_f32 v101, v116, v117
v_add_f32 v118, v118, v119
v_add_f32 v101, v101, v118
v_add_f32 v102, v120, v121
v_add_f32 v122, v122, v123
v_add_f32 v102, v102, v122
v_add_f32 v103, v124, v125
v_add_f32 v126, v126, v127
v_add_f32 v103, v103, v126
s_nop 1
v_permlane32_swap_b32 v100, v101
v_permlane32_swap_b32 v102, v103
v_add_f32 v100, v100, v101
v_add_f32 v102, v102, v103
s_nop 1
v_permlane16_swap_b32 v100, v102
s_nop 0
v_add_f32 v100, v100, v102
v_add_f32 v100, 0x358637bd, v100
v_rcp_f32 v100, v100
s_nop 0
v_mov_b32 v102, v100
s_nop 1
v_permlane16_swap_b32 v100, v102
s_nop 0
v_mov_b32 v101, v100
v_mov_b32 v103, v102
s_nop 0
v_permlane32_swap_b32 v100, v101
v_permlane32_swap_b32 v102, v103
buffer_load_dwordx4 v[188:191], v18, s[32:35], s58 offen offset:0 sc1
buffer_load_dwordx4 v[192:195], v18, s[32:35], s58 offen offset:1024 sc1
buffer_load_dwordx4 v[196:199], v18, s[32:35], s59 offen offset:0 sc1
buffer_load_dwordx4 v[200:203], v18, s[32:35], s59 offen offset:1024 sc1
s_mov_b32 s63, 0
sent_130:
s_waitcnt vmcnt(0)
v_max_u32 v4, v188, v189
v_max3_u32 v4, v4, v190, v191
v_max3_u32 v4, v4, v192, v193
v_max3_u32 v4, v4, v194, v195
v_max3_u32 v4, v4, v196, v197
v_max3_u32 v4, v4, v198, v199
v_max3_u32 v4, v4, v200, v201
v_max3_u32 v4, v4, v202, v203
v_cmp_eq_u32 vcc, -1, v4
s_cbranch_vccz sentd_131
buffer_load_dwordx4 v[188:191], v18, s[32:35], s58 offen offset:0 sc1
buffer_load_dwordx4 v[192:195], v18, s[32:35], s58 offen offset:1024 sc1
buffer_load_dwordx4 v[196:199], v18, s[32:35], s59 offen offset:0 sc1
buffer_load_dwordx4 v[200:203], v18, s[32:35], s59 offen offset:1024 sc1
s_add_u32 s63, s63, 1
s_cmp_lt_u32 s63, 0x80000
s_cbranch_scc1 sent_130
s_waitcnt vmcnt(0)
sentd_131:
s_cmp_eq_u32 s46, 0
s_cbranch_scc1 slow_132
.p2align 3
v_mfma_f32_16x16x32_bf16 v[156:159], v[188:191], v[60:63], 0
v_mfma_f32_16x16x32_bf16 v[164:167], v[188:191], v[68:71], 0
v_mfma_f32_16x16x32_bf16 v[160:163], v[192:195], v[60:63], 0
v_mfma_f32_16x16x32_bf16 v[172:175], v[188:191], v[76:79], 0
v_mfma_f32_16x16x32_bf16 v[168:171], v[192:195], v[68:71], 0
v_mfma_f32_16x16x32_bf16 v[180:183], v[188:191], v[84:87], 0
v_mfma_f32_16x16x32_bf16 v[156:159], v[196:199], v[220:223], v[156:159]
v_mfma_f32_16x16x32_bf16 v[176:179], v[192:195], v[76:79], 0
v_mfma_f32_16x16x32_bf16 v[164:167], v[196:199], v[228:231], v[164:167]
v_mfma_f32_16x16x32_bf16 v[184:187], v[192:195], v[84:87], 0
v_mfma_f32_16x16x32_bf16 v[160:163], v[200:203], v[220:223], v[160:163]
v_mfma_f32_16x16x32_bf16 v[172:175], v[196:199], v[236:239], v[172:175]
v_mfma_f32_16x16x32_bf16 v[168:171], v[200:203], v[228:231], v[168:171]
v_mfma_f32_16x16x32_bf16 v[180:183], v[196:199], v[244:247], v[180:183]
v_mfma_f32_16x16x32_bf16 v[176:179], v[200:203], v[236:239], v[176:179]
v_mfma_f32_16x16x32_bf16 v[184:187], v[200:203], v[244:247], v[184:187]
v_pk_mul_f32 v[156:157], v[156:157], v[100:101] op_sel:[0,0] op_sel_hi:[1,0]
v_pk_mul_f32 v[158:159], v[158:159], v[100:101] op_sel:[0,0] op_sel_hi:[1,0]
v_cvt_pk_bf16_f32 v156, v156, v157
v_pk_mul_f32 v[164:165], v[164:165], v[100:101] op_sel:[0,1] op_sel_hi:[1,1]
v_pk_mul_f32 v[160:161], v[160:161], v[100:101] op_sel:[0,0] op_sel_hi:[1,0]
v_pk_mul_f32 v[162:163], v[162:163], v[100:101] op_sel:[0,0] op_sel_hi:[1,0]
v_cvt_pk_bf16_f32 v157, v158, v159
v_pk_mul_f32 v[166:167], v[166:167], v[100:101] op_sel:[0,1] op_sel_hi:[1,1]
v_cvt_pk_bf16_f32 v164, v164, v165
v_pk_mul_f32 v[172:173], v[172:173], v[102:103] op_sel:[0,0] op_sel_hi:[1,0]
v_cvt_pk_bf16_f32 v158, v160, v161
v_cvt_pk_bf16_f32 v159, v162, v163
v_pk_mul_f32 v[168:169], v[168:169], v[100:101] op_sel:[0,1] op_sel_hi:[1,1]
v_pk_mul_f32 v[170:171], v[170:171], v[100:101] op_sel:[0,1] op_sel_hi:[1,1]
v_cvt_pk_bf16_f32 v165, v166, v167
v_pk_mul_f32 v[174:175], v[174:175], v[102:103] op_sel:[0,0] op_sel_hi:[1,0]
v_cvt_pk_bf16_f32 v172, v172, v173
v_pk_mul_f32 v[180:181], v[180:181], v[102:103] op_sel:[0,1] op_sel_hi:[1,1]
buffer_store_dwordx4 v[156:159], v18, s[32:35], s80 offen
v_cvt_pk_bf16_f32 v166, v168, v169
v_cvt_pk_bf16_f32 v167, v170, v171
v_pk_mul_f32 v[176:177], v[176:177], v[102:103] op_sel:[0,0] op_sel_hi:[1,0]
v_pk_mul_f32 v[178:179], v[178:179], v[102:103] op_sel:[0,0] op_sel_hi:[1,0]
v_cvt_pk_bf16_f32 v173, v174, v175
v_pk_mul_f32 v[182:183], v[182:183], v[102:103] op_sel:[0,1] op_sel_hi:[1,1]
v_cvt_pk_bf16_f32 v180, v180, v181
buffer_store_dwordx4 v[164:167], v18, s[32:35], s81 offen
v_cvt_pk_bf16_f32 v174, v176, v177
v_cvt_pk_bf16_f32 v175, v178, v179
v_pk_mul_f32 v[184:185], v[184:185], v[102:103] op_sel:[0,1] op_sel_hi:[1,1]
v_pk_mul_f32 v[186:187], v[186:187], v[102:103] op_sel:[0,1] op_sel_hi:[1,1]
v_cvt_pk_bf16_f32 v181, v182, v183
buffer_store_dwordx4 v[172:175], v18, s[32:35], s82 offen
v_cvt_pk_bf16_f32 v182, v184, v185
v_cvt_pk_bf16_f32 v183, v186, v187
buffer_store_dwordx4 v[180:183], v18, s[32:35], s83 offen
back_133:
s_barrier
v_and_b32 v36, 31, v0
v_lshlrev_b32 v36, 2, v36
s_lshl_b32 s62, s45, 2
v_mov_b32 v4, s62
v_mov_b32 v5, 4
s_mov_b64 exec, 1
s_waitcnt vmcnt(0)
s_cmp_eq_u32 s46, 0
s_cbranch_scc1 slow_134
buffer_store_dword v5, v4, s[32:35], s84 offen
back_135:
s_mov_b64 exec, -1
v_lshrrev_b32 v4, 2, v2
v_and_b32 v5, 3, v0
v_lshl_add_u32 v6, v3, 3, v4
v_lshlrev_b32 v6, 7, v6
v_lshl_add_u32 v6, v5, 3, v6
v_lshrrev_b32 v7, 1, v4
v_and_b32 v8, 1, v3
v_lshl_add_u32 v7, v8, 1, v7
v_lshl_add_u32 v10, v7, 5, v6
v_xor_b32 v11, 32, v10
v_xor_b32 v12, 64, v10
v_xor_b32 v13, 96, v10
v_add_u32 v14, 0x10000, v10
v_add_u32 v15, 0x10000, v11
v_add_u32 v16, 0x10000, v12
v_add_u32 v17, 0x10000, v13
ds_read_b64_tr_b16 v[220:221], v10 offset:0
ds_read_b64_tr_b16 v[222:223], v10 offset:512
ds_read_b64_tr_b16 v[224:225], v11 offset:0
ds_read_b64_tr_b16 v[226:227], v11 offset:512
ds_read_b64_tr_b16 v[228:229], v12 offset:0
ds_read_b64_tr_b16 v[230:231], v12 offset:512
ds_read_b64_tr_b16 v[232:233], v13 offset:0
ds_read_b64_tr_b16 v[234:235], v13 offset:512
ds_read_b64_tr_b16 v[236:237], v10 offset:4096
ds_read_b64_tr_b16 v[238:239], v10 offset:4608
ds_read_b64_tr_b16 v[240:241], v11 offset:4096
ds_read_b64_tr_b16 v[242:243], v11 offset:4608
ds_read_b64_tr_b16 v[244:245], v12 offset:4096
ds_read_b64_tr_b16 v[246:247], v12 offset:4608
ds_read_b64_tr_b16 v[248:249], v13 offset:4096
ds_read_b64_tr_b16 v[250:251], v13 offset:4608
s_lshl_b32 s48, s41, 3
s_lshl_b32 s49, s40, 1
s_add_u32 s48, s48, s49
s_lshl_b32 s48, s48, 15
s_add_u32 s48, s48, 4194304
v_add_u32 v38, s48, v18
v_add_u32 v39, 32768, v38
s_lshl_b32 s57, s75, 11
s_add_u32 s87, s87, 262144
v_lshlrev_b32 v60, 16, v20
v_and_b32 v61, 0xffff0000, v20
v_lshlrev_b32 v62, 16, v21
v_and_b32 v63, 0xffff0000, v21
v_lshlrev_b32 v64, 16, v22
v_and_b32 v65, 0xffff0000, v22
v_lshlrev_b32 v66, 16, v23
v_and_b32 v67, 0xffff0000, v23
v_lshlrev_b32 v68, 16, v24
v_and_b32 v69, 0xffff0000, v24
v_lshlrev_b32 v70, 16, v25
v_and_b32 v71, 0xffff0000, v25
v_lshlrev_b32 v72, 16, v26
v_and_b32 v73, 0xffff0000, v26
v_lshlrev_b32 v74, 16, v27
v_and_b32 v75, 0xffff0000, v27
v_lshlrev_b32 v76, 16, v28
v_and_b32 v77, 0xffff0000, v28
v_lshlrev_b32 v78, 16, v29
v_and_b32 v79, 0xffff0000, v29
v_lshlrev_b32 v80, 16, v30
v_and_b32 v81, 0xffff0000, v30
v_lshlrev_b32 v82, 16, v31
v_and_b32 v83, 0xffff0000, v31
v_lshlrev_b32 v84, 16, v32
v_and_b32 v85, 0xffff0000, v32
v_lshlrev_b32 v86, 16, v33
v_and_b32 v87, 0xffff0000, v33
v_lshlrev_b32 v88, 16, v34
v_and_b32 v89, 0xffff0000, v34
v_lshlrev_b32 v90, 16, v35
v_and_b32 v91, 0xffff0000, v35
s_lshl_b32 s48, s40, 12
s_add_u32 s48, s48, 139264
v_lshrrev_b32 v4, 1, v2
v_lshrrev_b32 v5, 1, v3
v_xor_b32 v4, v4, v5
v_lshlrev_b32 v4, 4, v4
v_and_b32 v5, 1, v3
v_lshl_add_u32 v4, v5, 3, v4
v_lshl_add_u32 v4, v2, 7, v4
v_add_u32 v42, s48, v4
v_xor_b32 v43, 32, v42
v_xor_b32 v44, 64, v42
v_xor_b32 v45, 96, v42
v_add_u32 v46, s48, v18
s_lshl_b32 s48, s41, 7
s_lshl_b32 s49, s40, 5
s_add_u32 s48, s48, s49
s_lshl_b32 s48, s48, 11
s_lshl_b32 s49, s78, 7
s_add_u32 s48, s48, s49
s_add_u32 s49, s48, 32768
v_lshrrev_b32 v4, 3, v0
v_and_b32 v5, 7, v0
v_lshrrev_b32 v6, 1, v4
v_xor_b32 v5, v5, v6
v_lshlrev_b32 v4, 11, v4
v_lshl_add_u32 v40, v5, 4, v4
v_xor_b32 v41, 64, v40
v_add_u32 v41, 16384, v41
buffer_load_dword v37, v36, s[32:35], s84 offen sc1
s_mov_b32 s63, 0
s_waitcnt vmcnt(0)
poll_136:
v_cmp_gt_u32 vcc, 4, v37
s_cbranch_vccz polled_137
buffer_load_dword v37, v36, s[32:35], s84 offen sc1
s_add_u32 s63, s63, 1
s_cmp_lt_u32 s63, 0x80000
s_waitcnt vmcnt(0)
s_cbranch_scc1 poll_136
polled_137:
s_call_b64 s[94:95], R_oloop
s_nop 0
v_cvt_pk_bf16_f32 v20, v60, v61
v_cvt_pk_bf16_f32 v21, v62, v63
v_cvt_pk_bf16_f32 v22, v64, v65
v_cvt_pk_bf16_f32 v23, v66, v67
ds_write_b64 v42, v[20:21] offset:0
ds_write_b64 v43, v[22:23] offset:0
v_cvt_pk_bf16_f32 v24, v68, v69
v_cvt_pk_bf16_f32 v25, v70, v71
v_cvt_pk_bf16_f32 v26, v72, v73
v_cvt_pk_bf16_f32 v27, v74, v75
ds_write_b64 v44, v[24:25] offset:0
ds_write_b64 v45, v[26:27] offset:0
v_cvt_pk_bf16_f32 v28, v76, v77
v_cvt_pk_bf16_f32 v29, v78, v79
v_cvt_pk_bf16_f32 v30, v80, v81
v_cvt_pk_bf16_f32 v31, v82, v83
ds_write_b64 v42, v[28:29] offset:2048
ds_write_b64 v43, v[30:31] offset:2048
v_cvt_pk_bf16_f32 v32, v84, v85
v_cvt_pk_bf16_f32 v33, v86, v87
v_cvt_pk_bf16_f32 v34, v88, v89
v_cvt_pk_bf16_f32 v35, v90, v91
ds_write_b64 v44, v[32:33] offset:2048
ds_write_b64 v45, v[34:35] offset:2048
ds_read_b128 v[20:23], v46 offset:0
ds_read_b128 v[24:27], v46 offset:1024
ds_read_b128 v[28:31], v46 offset:2048
ds_read_b128 v[32:35], v46 offset:3072
s_waitcnt lgkmcnt(3)
buffer_store_dwordx4 v[20:23], v40, s[24:27], s48 offen sc1
s_waitcnt lgkmcnt(2)
buffer_store_dwordx4 v[24:27], v41, s[24:27], s48 offen sc1
s_waitcnt lgkmcnt(1)
buffer_store_dwordx4 v[28:31], v40, s[24:27], s49 offen sc1
s_waitcnt lgkmcnt(0)
buffer_store_dwordx4 v[32:35], v41, s[24:27], s49 offen sc1
s_endpgm
L_code_end:
again_22:
s_mov_b32 s63, 0
retry_24:
buffer_load_dwordx4 v[176:179], v37, s[32:35], 0 offen offset:0 sc1
buffer_load_dwordx4 v[180:183], v37, s[32:35], 0 offen offset:1024 sc1
buffer_load_dwordx4 v[184:187], v37, s[32:35], 0 offen offset:2048 sc1
buffer_load_dwordx4 v[188:191], v37, s[32:35], 0 offen offset:3072 sc1
s_waitcnt vmcnt(0)
v_add_f32 v176, v176, v184
v_add_f32 v177, v177, v185
v_add_f32 v178, v178, v186
v_add_f32 v179, v179, v187
v_add_f32 v180, v180, v188
v_add_f32 v181, v181, v189
v_add_f32 v182, v182, v190
v_add_f32 v183, v183, v191
v_add_f32 v176, v176, v180
v_add_f32 v177, v177, v181
v_add_f32 v178, v178, v182
v_add_f32 v179, v179, v183
s_nop 1
v_permlane32_swap_b32 v176, v177
v_permlane32_swap_b32 v178, v179
v_add_f32 v176, v176, v177
v_add_f32 v178, v178, v179
s_nop 1
v_permlane16_swap_b32 v176, v178
s_nop 0
v_add_f32 v176, v176, v178
v_cmp_u_f32 vcc, v176, v176
s_cbranch_vccz summed_23
s_add_u32 s63, s63, 1
s_cmp_lt_u32 s63, 0x10000
s_cbranch_scc1 retry_24
s_branch summed_23
again_25:
s_mov_b32 s63, 0
retry_27:
buffer_load_dwordx4 v[160:163], v38, s[32:35], 0 offen offset:0 sc1
buffer_load_dwordx4 v[164:167], v38, s[32:35], 0 offen offset:1024 sc1
buffer_load_dwordx4 v[168:171], v38, s[32:35], 0 offen offset:2048 sc1
buffer_load_dwordx4 v[172:175], v38, s[32:35], 0 offen offset:3072 sc1
s_waitcnt vmcnt(0)
v_add_f32 v160, v160, v168
v_add_f32 v161, v161, v169
v_add_f32 v162, v162, v170
v_add_f32 v163, v163, v171
v_add_f32 v164, v164, v172
v_add_f32 v165, v165, v173
v_add_f32 v166, v166, v174
v_add_f32 v167, v167, v175
v_add_f32 v160, v160, v164
v_add_f32 v161, v161, v165
v_add_f32 v162, v162, v166
v_add_f32 v163, v163, v167
s_nop 1
v_permlane32_swap_b32 v160, v161
v_permlane32_swap_b32 v162, v163
v_add_f32 v160, v160, v161
v_add_f32 v162, v162, v163
s_nop 1
v_permlane16_swap_b32 v160, v162
s_nop 0
v_add_f32 v160, v160, v162
v_cmp_u_f32 vcc, v160, v160
s_cbranch_vccz summed_26
s_add_u32 s63, s63, 1
s_cmp_lt_u32 s63, 0x10000
s_cbranch_scc1 retry_27
s_branch summed_26
again_33:
s_mov_b32 s63, 0
retry_35:
buffer_load_dwordx4 v[80:83], v37, s[32:35], 0 offen offset:0 sc1
buffer_load_dwordx4 v[84:87], v37, s[32:35], 0 offen offset:1024 sc1
buffer_load_dwordx4 v[88:91], v37, s[32:35], 0 offen offset:2048 sc1
buffer_load_dwordx4 v[92:95], v37, s[32:35], 0 offen offset:3072 sc1
s_waitcnt vmcnt(0)
v_add_f32 v80, v80, v88
v_add_f32 v81, v81, v89
v_add_f32 v82, v82, v90
v_add_f32 v83, v83, v91
v_add_f32 v84, v84, v92
v_add_f32 v85, v85, v93
v_add_f32 v86, v86, v94
v_add_f32 v87, v87, v95
v_add_f32 v80, v80, v84
v_add_f32 v81, v81, v85
v_add_f32 v82, v82, v86
v_add_f32 v83, v83, v87
s_nop 1
v_permlane32_swap_b32 v80, v81
v_permlane32_swap_b32 v82, v83
v_add_f32 v80, v80, v81
v_add_f32 v82, v82, v83
s_nop 1
v_permlane16_swap_b32 v80, v82
s_nop 0
v_add_f32 v80, v80, v82
v_cmp_u_f32 vcc, v80, v80
s_cbranch_vccz summed_34
s_add_u32 s63, s63, 1
s_cmp_lt_u32 s63, 0x10000
s_cbranch_scc1 retry_35
s_branch summed_34
again_36:
s_mov_b32 s63, 0
retry_38:
buffer_load_dwordx4 v[64:67], v38, s[32:35], 0 offen offset:0 sc1
buffer_load_dwordx4 v[68:71], v38, s[32:35], 0 offen offset:1024 sc1
buffer_load_dwordx4 v[72:75], v38, s[32:35], 0 offen offset:2048 sc1
buffer_load_dwordx4 v[76:79], v38, s[32:35], 0 offen offset:3072 sc1
s_waitcnt vmcnt(0)
v_add_f32 v64, v64, v72
v_add_f32 v65, v65, v73
v_add_f32 v66, v66, v74
v_add_f32 v67, v67, v75
v_add_f32 v68, v68, v76
v_add_f32 v69, v69, v77
v_add_f32 v70, v70, v78
v_add_f32 v71, v71, v79
v_add_f32 v64, v64, v68
v_add_f32 v65, v65, v69
v_add_f32 v66, v66, v70
v_add_f32 v67, v67, v71
s_nop 1
v_permlane32_swap_b32 v64, v65
v_permlane32_swap_b32 v66, v67
v_add_f32 v64, v64, v65
v_add_f32 v66, v66, v67
s_nop 1
v_permlane16_swap_b32 v64, v66
s_nop 0
v_add_f32 v64, v64, v66
v_cmp_u_f32 vcc, v64, v64
s_cbranch_vccz summed_37
s_add_u32 s63, s63, 1
s_cmp_lt_u32 s63, 0x10000
s_cbranch_scc1 retry_38
s_branch summed_37
again_42:
s_mov_b32 s63, 0
retry_44:
buffer_load_dwordx4 v[80:83], v37, s[32:35], 0 offen offset:0 sc1
buffer_load_dwordx4 v[84:87], v37, s[32:35], 0 offen offset:1024 sc1
buffer_load_dwordx4 v[88:91], v37, s[32:35], 0 offen offset:2048 sc1
buffer_load_dwordx4 v[92:95], v37, s[32:35], 0 offen offset:3072 sc1
s_waitcnt vmcnt(0)
v_add_f32 v80, v80, v88
v_add_f32 v81, v81, v89
v_add_f32 v82, v82, v90
v_add_f32 v83, v83, v91
v_add_f32 v84, v84, v92
v_add_f32 v85, v85, v93
v_add_f32 v86, v86, v94
v_add_f32 v87, v87, v95
v_add_f32 v80, v80, v84
v_add_f32 v81, v81, v85
v_add_f32 v82, v82, v86
v_add_f32 v83, v83, v87
s_nop 1
v_permlane32_swap_b32 v80, v81
v_permlane32_swap_b32 v82, v83
v_add_f32 v80, v80, v81
v_add_f32 v82, v82, v83
s_nop 1
v_permlane16_swap_b32 v80, v82
s_nop 0
v_add_f32 v80, v80, v82
v_cmp_u_f32 vcc, v80, v80
s_cbranch_vccz summed_43
s_add_u32 s63, s63, 1
s_cmp_lt_u32 s63, 0x10000
s_cbranch_scc1 retry_44
s_branch summed_43
again_50:
s_mov_b32 s63, 0
retry_52:
buffer_load_dwordx4 v[80:83], v37, s[32:35], 0 offen offset:0 sc1
buffer_load_dwordx4 v[84:87], v37, s[32:35], 0 offen offset:1024 sc1
buffer_load_dwordx4 v[88:91], v37, s[32:35], 0 offen offset:2048 sc1
buffer_load_dwordx4 v[92:95], v37, s[32:35], 0 offen offset:3072 sc1
s_waitcnt vmcnt(0)
v_add_f32 v80, v80, v88
v_add_f32 v81, v81, v89
v_add_f32 v82, v82, v90
v_add_f32 v83, v83, v91
v_add_f32 v84, v84, v92
v_add_f32 v85, v85, v93
v_add_f32 v86, v86, v94
v_add_f32 v87, v87, v95
v_add_f32 v80, v80, v84
v_add_f32 v81, v81, v85
v_add_f32 v82, v82, v86
v_add_f32 v83, v83, v87
s_nop 1
v_permlane32_swap_b32 v80, v81
v_permlane32_swap_b32 v82, v83
v_add_f32 v80, v80, v81
v_add_f32 v82, v82, v83
s_nop 1
v_permlane16_swap_b32 v80, v82
s_nop 0
v_add_f32 v80, v80, v82
v_cmp_u_f32 vcc, v80, v80
s_cbranch_vccz summed_51
s_add_u32 s63, s63, 1
s_cmp_lt_u32 s63, 0x10000
s_cbranch_scc1 retry_52
s_branch summed_51
slow_71:
.p2align 3
v_mfma_f32_16x16x32_bf16 v[160:163], v[120:123], v[156:159], v[44:47]
v_max_f32 v158, v192, v193
v_max_f32 v159, v194, v195
v_permlane32_swap_b32 v130, v131
s_nop 0
v_max_f32 v130, v130, v131
s_nop 2
v_max_f32 v156, v160, v161
v_max_f32 v157, v162, v163
v_max3_f32 v128, v156, v157, v158
v_max_f32 v128, v128, v159
s_nop 1
v_permlane32_swap_b32 v128, v129
s_nop 0
v_max_f32 v128, v128, v129
s_nop 1
v_permlane16_swap_b32 v128, v130
s_nop 0
v_max_f32 v128, v128, v130
v_mov_b32 v130, v128
s_nop 1
v_permlane16_swap_b32 v128, v130
s_nop 0
v_mov_b32 v129, v128
v_mov_b32 v131, v130
s_nop 0
v_permlane32_swap_b32 v128, v129
v_permlane32_swap_b32 v130, v131
v_mul_f32 v128, v128, v124
v_mul_f32 v129, v129, v125
v_pk_fma_f32 v[156:157], v[156:157], v[124:125], v[128:129] op_sel:[0,0,0] op_sel_hi:[1,0,0] neg_lo:[0,0,1] neg_hi:[0,0,1]
v_pk_fma_f32 v[158:159], v[158:159], v[124:125], v[128:129] op_sel:[0,0,0] op_sel_hi:[1,0,0] neg_lo:[0,0,1] neg_hi:[0,0,1]
v_mul_f32 v130, v130, v126
v_mul_f32 v131, v131, v127
v_exp_f32 v156, v156
v_exp_f32 v157, v157
v_exp_f32 v158, v158
v_exp_f32 v159, v159
v_pk_fma_f32 v[164:165], v[164:165], v[124:125], v[128:129] op_sel:[0,1,1] op_sel_hi:[1,1,1] neg_lo:[0,0,1] neg_hi:[0,0,1]
v_pk_fma_f32 v[166:167], v[166:167], v[124:125], v[128:129] op_sel:[0,1,1] op_sel_hi:[1,1,1] neg_lo:[0,0,1] neg_hi:[0,0,1]
v_exp_f32 v164, v164
v_exp_f32 v165, v165
v_exp_f32 v166, v166
v_exp_f32 v167, v167
v_pk_fma_f32 v[172:173], v[172:173], v[126:127], v[130:131] op_sel:[0,0,0] op_sel_hi:[1,0,0] neg_lo:[0,0,1] neg_hi:[0,0,1]
v_pk_fma_f32 v[174:175], v[174:175], v[126:127], v[130:131] op_sel:[0,0,0] op_sel_hi:[1,0,0] neg_lo:[0,0,1] neg_hi:[0,0,1]
v_cvt_pk_bf16_f32 v156, v156, v156
v_cvt_pk_bf16_f32 v157, v157, v157
v_cvt_pk_bf16_f32 v158, v158, v158
v_cvt_pk_bf16_f32 v159, v159, v159
v_exp_f32 v172, v172
v_exp_f32 v173, v173
v_exp_f32 v174, v174
v_exp_f32 v175, v175
v_pk_fma_f32 v[180:181], v[180:181], v[126:127], v[130:131] op_sel:[0,1,1] op_sel_hi:[1,1,1] neg_lo:[0,0,1] neg_hi:[0,0,1]
v_pk_fma_f32 v[182:183], v[182:183], v[126:127], v[130:131] op_sel:[0,1,1] op_sel_hi:[1,1,1] neg_lo:[0,0,1] neg_hi:[0,0,1]
v_and_b32 v156, v52, v156
v_and_b32 v157, v52, v157
v_and_b32 v158, v52, v158
v_and_b32 v159, v52, v159
v_cvt_pk_bf16_f32 v164, v164, v164
v_cvt_pk_bf16_f32 v165, v165, v165
v_mfma_f32_16x16x32_bf16 v[160:163], v[48:51], v[156:159], 0
v_cvt_pk_bf16_f32 v166, v166, v166
v_cvt_pk_bf16_f32 v167, v167, v167
v_mfma_f32_16x16x32_bf16 v[220:223], v[100:103], v[156:159], 0
v_exp_f32 v180, v180
v_mfma_f32_16x16x32_bf16 v[224:227], v[110:113], v[156:159], 0
v_exp_f32 v181, v181
v_exp_f32 v182, v182
v_exp_f32 v183, v183
v_and_b32 v164, v52, v164
v_and_b32 v165, v52, v165
v_and_b32 v166, v52, v166
v_and_b32 v167, v52, v167
v_cvt_pk_bf16_f32 v172, v172, v172
v_cvt_pk_bf16_f32 v173, v173, v173
v_mfma_f32_16x16x32_bf16 v[168:171], v[48:51], v[164:167], 0
v_cvt_pk_bf16_f32 v174, v174, v174
v_cvt_pk_bf16_f32 v175, v175, v175
v_mfma_f32_16x16x32_bf16 v[228:231], v[102:105], v[164:167], 0
v_and_b32 v172, v52, v172
v_and_b32 v173, v52, v173
v_mfma_f32_16x16x32_bf16 v[232:235], v[112:115], v[164:167], 0
v_and_b32 v174, v52, v174
v_and_b32 v175, v52, v175
v_cvt_pk_bf16_f32 v180, v180, v180
v_cvt_pk_bf16_f32 v181, v181, v181
v_mfma_f32_16x16x32_bf16 v[176:179], v[48:51], v[172:175], 0
v_cvt_pk_bf16_f32 v182, v182, v182
v_cvt_pk_bf16_f32 v183, v183, v183
v_mfma_f32_16x16x32_bf16 v[236:239], v[104:107], v[172:175], 0
v_and_b32 v180, v52, v180
v_and_b32 v181, v52, v181
v_mfma_f32_16x16x32_bf16 v[240:243], v[114:117], v[172:175], 0
v_and_b32 v182, v52, v182
v_and_b32 v183, v52, v183
v_rcp_f32 v160, v160
v_rcp_f32 v168, v168
v_pk_mul_f32 v[220:221], v[220:221], v[160:161] op_sel:[0,0] op_sel_hi:[1,0]
v_pk_mul_f32 v[222:223], v[222:223], v[160:161] op_sel:[0,0] op_sel_hi:[1,0]
v_pk_mul_f32 v[228:229], v[228:229], v[168:169] op_sel:[0,0] op_sel_hi:[1,0]
v_pk_mul_f32 v[224:225], v[224:225], v[160:161] op_sel:[0,0] op_sel_hi:[1,0]
v_pk_mul_f32 v[226:227], v[226:227], v[160:161] op_sel:[0,0] op_sel_hi:[1,0]
v_pk_mul_f32 v[230:231], v[230:231], v[168:169] op_sel:[0,0] op_sel_hi:[1,0]
v_pk_mul_f32 v[232:233], v[232:233], v[168:169] op_sel:[0,0] op_sel_hi:[1,0]
v_pk_mul_f32 v[234:235], v[234:235], v[168:169] op_sel:[0,0] op_sel_hi:[1,0]
v_mfma_f32_16x16x32_bf16 v[184:187], v[48:51], v[180:183], 0
v_rcp_f32_e64 v176, v176
v_cvt_pk_bf16_f32 v220, v220, v221
v_cvt_pk_bf16_f32 v221, v222, v223
v_cvt_pk_bf16_f32 v228, v228, v229
v_pk_mul_f32 v[236:237], v[236:237], v[176:177] op_sel:[0,0] op_sel_hi:[1,0]
v_mfma_f32_16x16x32_bf16 v[244:247], v[106:109], v[180:183], 0
v_cvt_pk_bf16_f32 v222, v224, v225
v_cvt_pk_bf16_f32 v223, v226, v227
v_rcp_f32_e64 v184, v184
v_cvt_pk_bf16_f32 v229, v230, v231
v_pk_mul_f32 v[238:239], v[238:239], v[176:177] op_sel:[0,0] op_sel_hi:[1,0]
v_pk_mul_f32 v[240:241], v[240:241], v[176:177] op_sel:[0,0] op_sel_hi:[1,0]
v_pk_mul_f32 v[242:243], v[242:243], v[176:177] op_sel:[0,0] op_sel_hi:[1,0]
v_cvt_pk_bf16_f32 v236, v236, v237
v_pk_mul_f32 v[244:245], v[244:245], v[184:185] op_sel:[0,0] op_sel_hi:[1,0]
v_pk_mul_f32 v[246:247], v[246:247], v[184:185] op_sel:[0,0] op_sel_hi:[1,0]
v_mfma_f32_16x16x32_bf16 v[248:251], v[116:119], v[180:183], 0
buffer_store_dwordx4 v[220:223], v18, s[32:35], s80 offen sc1
v_cvt_pk_bf16_f32 v230, v232, v233
v_cvt_pk_bf16_f32 v231, v234, v235
v_cvt_pk_bf16_f32 v237, v238, v239
v_cvt_pk_bf16_f32 v244, v244, v245
buffer_store_dwordx4 v[228:231], v18, s[32:35], s81 offen sc1
v_cvt_pk_bf16_f32 v238, v240, v241
v_cvt_pk_bf16_f32 v239, v242, v243
v_pk_mul_f32 v[248:249], v[248:249], v[184:185] op_sel:[0,0] op_sel_hi:[1,0]
v_pk_mul_f32 v[250:251], v[250:251], v[184:185] op_sel:[0,0] op_sel_hi:[1,0]
v_cvt_pk_bf16_f32 v245, v246, v247
buffer_store_dwordx4 v[236:239], v18, s[32:35], s82 offen sc1
v_cvt_pk_bf16_f32 v246, v248, v249
v_cvt_pk_bf16_f32 v247, v250, v251
buffer_store_dwordx4 v[244:247], v18, s[32:35], s83 offen sc1
s_branch back_72
slow_73:
buffer_store_dword v5, v4, s[32:35], s84 offen sc1
s_branch back_74
slow_78:
s_nop 0
v_cvt_pk_bf16_f32 v20, v60, v61
v_cvt_pk_bf16_f32 v21, v62, v63
v_cvt_pk_bf16_f32 v22, v64, v65
v_cvt_pk_bf16_f32 v23, v66, v67
buffer_store_dwordx4 v[20:23], v18, s[32:35], s85 offen offset:0 sc1
v_cvt_pk_bf16_f32 v24, v68, v69
v_cvt_pk_bf16_f32 v25, v70, v71
v_cvt_pk_bf16_f32 v26, v72, v73
v_cvt_pk_bf16_f32 v27, v74, v75
buffer_store_dwordx4 v[24:27], v18, s[32:35], s85 offen offset:1024 sc1
v_cvt_pk_bf16_f32 v28, v76, v77
v_cvt_pk_bf16_f32 v29, v78, v79
v_cvt_pk_bf16_f32 v30, v80, v81
v_cvt_pk_bf16_f32 v31, v82, v83
buffer_store_dwordx4 v[28:31], v18, s[32:35], s86 offen offset:0 sc1
v_cvt_pk_bf16_f32 v32, v84, v85
v_cvt_pk_bf16_f32 v33, v86, v87
v_cvt_pk_bf16_f32 v34, v88, v89
v_cvt_pk_bf16_f32 v35, v90, v91
buffer_store_dwordx4 v[32:35], v18, s[32:35], s86 offen offset:1024 sc1
s_barrier
v_dot2c_f32_bf16 v6, v20, v48
v_dot2c_f32_bf16 v8, v20, v20
v_dot2c_f32_bf16 v7, v28, v48
v_dot2c_f32_bf16 v9, v28, v28
v_dot2c_f32_bf16 v6, v21, v48
v_dot2c_f32_bf16 v8, v21, v21
v_dot2c_f32_bf16 v7, v29, v48
v_dot2c_f32_bf16 v9, v29, v29
v_dot2c_f32_bf16 v6, v22, v48
v_dot2c_f32_bf16 v8, v22, v22
v_dot2c_f32_bf16 v7, v30, v48
v_dot2c_f32_bf16 v9, v30, v30
v_dot2c_f32_bf16 v6, v23, v48
v_dot2c_f32_bf16 v8, v23, v23
v_dot2c_f32_bf16 v7, v31, v48
v_dot2c_f32_bf16 v9, v31, v31
v_dot2c_f32_bf16 v6, v24, v48
v_dot2c_f32_bf16 v8, v24, v24
v_dot2c_f32_bf16 v7, v32, v48
v_dot2c_f32_bf16 v9, v32, v32
v_dot2c_f32_bf16 v6, v25, v48
v_dot2c_f32_bf16 v8, v25, v25
v_dot2c_f32_bf16 v7, v33, v48
v_dot2c_f32_bf16 v9, v33, v33
v_dot2c_f32_bf16 v6, v26, v48
v_dot2c_f32_bf16 v8, v26, v26
v_dot2c_f32_bf16 v7, v34, v48
v_dot2c_f32_bf16 v9, v34, v34
v_dot2c_f32_bf16 v6, v27, v48
v_dot2c_f32_bf16 v8, v27, v27
v_dot2c_f32_bf16 v7, v35, v48
v_dot2c_f32_bf16 v9, v35, v35
s_mov_b64 exec, 1
s_waitcnt vmcnt(0)
buffer_store_dword v5, v4, s[32:35], s88 offen sc1
s_mov_b64 exec, -1
s_nop 1
v_permlane32_swap_b32 v6, v7
v_permlane32_swap_b32 v8, v9
v_add_f32 v6, v6, v7
v_add_f32 v8, v8, v9
s_nop 1
v_permlane16_swap_b32 v6, v8
s_nop 0
v_add_f32 v6, v6, v8
buffer_store_dword v6, v1, s[32:35], s87 offen sc1
s_branch back_79
slow_94:
.p2align 3
v_mfma_f32_16x16x32_bf16 v[156:159], v[188:191], v[60:63], 0
v_mfma_f32_16x16x32_bf16 v[164:167], v[188:191], v[68:71], 0
v_mfma_f32_16x16x32_bf16 v[160:163], v[192:195], v[60:63], 0
v_mfma_f32_16x16x32_bf16 v[172:175], v[188:191], v[76:79], 0
v_mfma_f32_16x16x32_bf16 v[168:171], v[192:195], v[68:71], 0
v_mfma_f32_16x16x32_bf16 v[180:183], v[188:191], v[84:87], 0
v_mfma_f32_16x16x32_bf16 v[156:159], v[196:199], v[220:223], v[156:159]
v_mfma_f32_16x16x32_bf16 v[176:179], v[192:195], v[76:79], 0
v_mfma_f32_16x16x32_bf16 v[164:167], v[196:199], v[228:231], v[164:167]
v_mfma_f32_16x16x32_bf16 v[184:187], v[192:195], v[84:87], 0
v_mfma_f32_16x16x32_bf16 v[160:163], v[200:203], v[220:223], v[160:163]
v_mfma_f32_16x16x32_bf16 v[172:175], v[196:199], v[236:239], v[172:175]
v_mfma_f32_16x16x32_bf16 v[168:171], v[200:203], v[228:231], v[168:171]
v_mfma_f32_16x16x32_bf16 v[180:183], v[196:199], v[244:247], v[180:183]
v_mfma_f32_16x16x32_bf16 v[176:179], v[200:203], v[236:239], v[176:179]
v_mfma_f32_16x16x32_bf16 v[184:187], v[200:203], v[244:247], v[184:187]
v_pk_mul_f32 v[156:157], v[156:157], v[100:101] op_sel:[0,0] op_sel_hi:[1,0]
v_pk_mul_f32 v[158:159], v[158:159], v[100:101] op_sel:[0,0] op_sel_hi:[1,0]
v_cvt_pk_bf16_f32 v156, v156, v157
v_pk_mul_f32 v[164:165], v[164:165], v[100:101] op_sel:[0,1] op_sel_hi:[1,1]
v_pk_mul_f32 v[160:161], v[160:161], v[100:101] op_sel:[0,0] op_sel_hi:[1,0]
v_pk_mul_f32 v[162:163], v[162:163], v[100:101] op_sel:[0,0] op_sel_hi:[1,0]
v_cvt_pk_bf16_f32 v157, v158, v159
v_pk_mul_f32 v[166:167], v[166:167], v[100:101] op_sel:[0,1] op_sel_hi:[1,1]
v_cvt_pk_bf16_f32 v164, v164, v165
v_pk_mul_f32 v[172:173], v[172:173], v[102:103] op_sel:[0,0] op_sel_hi:[1,0]
v_cvt_pk_bf16_f32 v158, v160, v161
v_cvt_pk_bf16_f32 v159, v162, v163
v_pk_mul_f32 v[168:169], v[168:169], v[100:101] op_sel:[0,1] op_sel_hi:[1,1]
v_pk_mul_f32 v[170:171], v[170:171], v[100:101] op_sel:[0,1] op_sel_hi:[1,1]
v_cvt_pk_bf16_f32 v165, v166, v167
v_pk_mul_f32 v[174:175], v[174:175], v[102:103] op_sel:[0,0] op_sel_hi:[1,0]
v_cvt_pk_bf16_f32 v172, v172, v173
v_pk_mul_f32 v[180:181], v[180:181], v[102:103] op_sel:[0,1] op_sel_hi:[1,1]
buffer_store_dwordx4 v[156:159], v18, s[32:35], s80 offen sc1
v_cvt_pk_bf16_f32 v166, v168, v169
v_cvt_pk_bf16_f32 v167, v170, v171
v_pk_mul_f32 v[176:177], v[176:177], v[102:103] op_sel:[0,0] op_sel_hi:[1,0]
v_pk_mul_f32 v[178:179], v[178:179], v[102:103] op_sel:[0,0] op_sel_hi:[1,0]
v_cvt_pk_bf16_f32 v173, v174, v175
v_pk_mul_f32 v[182:183], v[182:183], v[102:103] op_sel:[0,1] op_sel_hi:[1,1]
v_cvt_pk_bf16_f32 v180, v180, v181
buffer_store_dwordx4 v[164:167], v18, s[32:35], s81 offen sc1
v_cvt_pk_bf16_f32 v174, v176, v177
v_cvt_pk_bf16_f32 v175, v178, v179
v_pk_mul_f32 v[184:185], v[184:185], v[102:103] op_sel:[0,1] op_sel_hi:[1,1]
v_pk_mul_f32 v[186:187], v[186:187], v[102:103] op_sel:[0,1] op_sel_hi:[1,1]
v_cvt_pk_bf16_f32 v181, v182, v183
buffer_store_dwordx4 v[172:175], v18, s[32:35], s82 offen sc1
v_cvt_pk_bf16_f32 v182, v184, v185
v_cvt_pk_bf16_f32 v183, v186, v187
buffer_store_dwordx4 v[180:183], v18, s[32:35], s83 offen sc1
s_branch back_95
slow_96:
buffer_store_dword v5, v4, s[32:35], s84 offen sc1
s_branch back_97
slow_100:
s_nop 0
v_cvt_pk_bf16_f32 v20, v60, v61
v_cvt_pk_bf16_f32 v21, v62, v63
v_cvt_pk_bf16_f32 v22, v64, v65
v_cvt_pk_bf16_f32 v23, v66, v67
buffer_store_dwordx4 v[20:23], v18, s[32:35], s85 offen offset:0 sc1
v_cvt_pk_bf16_f32 v24, v68, v69
v_cvt_pk_bf16_f32 v25, v70, v71
v_cvt_pk_bf16_f32 v26, v72, v73
v_cvt_pk_bf16_f32 v27, v74, v75
buffer_store_dwordx4 v[24:27], v18, s[32:35], s85 offen offset:1024 sc1
v_cvt_pk_bf16_f32 v28, v76, v77
v_cvt_pk_bf16_f32 v29, v78, v79
v_cvt_pk_bf16_f32 v30, v80, v81
v_cvt_pk_bf16_f32 v31, v82, v83
buffer_store_dwordx4 v[28:31], v18, s[32:35], s86 offen offset:0 sc1
v_cvt_pk_bf16_f32 v32, v84, v85
v_cvt_pk_bf16_f32 v33, v86, v87
v_cvt_pk_bf16_f32 v34, v88, v89
v_cvt_pk_bf16_f32 v35, v90, v91
buffer_store_dwordx4 v[32:35], v18, s[32:35], s86 offen offset:1024 sc1
s_barrier
v_dot2c_f32_bf16 v6, v20, v48
v_dot2c_f32_bf16 v8, v20, v20
v_dot2c_f32_bf16 v7, v28, v48
v_dot2c_f32_bf16 v9, v28, v28
v_dot2c_f32_bf16 v6, v21, v48
v_dot2c_f32_bf16 v8, v21, v21
v_dot2c_f32_bf16 v7, v29, v48
v_dot2c_f32_bf16 v9, v29, v29
v_dot2c_f32_bf16 v6, v22, v48
v_dot2c_f32_bf16 v8, v22, v22
v_dot2c_f32_bf16 v7, v30, v48
v_dot2c_f32_bf16 v9, v30, v30
v_dot2c_f32_bf16 v6, v23, v48
v_dot2c_f32_bf16 v8, v23, v23
v_dot2c_f32_bf16 v7, v31, v48
v_dot2c_f32_bf16 v9, v31, v31
v_dot2c_f32_bf16 v6, v24, v48
v_dot2c_f32_bf16 v8, v24, v24
v_dot2c_f32_bf16 v7, v32, v48
v_dot2c_f32_bf16 v9, v32, v32
v_dot2c_f32_bf16 v6, v25, v48
v_dot2c_f32_bf16 v8, v25, v25
v_dot2c_f32_bf16 v7, v33, v48
v_dot2c_f32_bf16 v9, v33, v33
v_dot2c_f32_bf16 v6, v26, v48
v_dot2c_f32_bf16 v8, v26, v26
v_dot2c_f32_bf16 v7, v34, v48
v_dot2c_f32_bf16 v9, v34, v34
v_dot2c_f32_bf16 v6, v27, v48
v_dot2c_f32_bf16 v8, v27, v27
v_dot2c_f32_bf16 v7, v35, v48
v_dot2c_f32_bf16 v9, v35, v35
s_mov_b64 exec, 1
s_waitcnt vmcnt(0)
buffer_store_dword v5, v4, s[32:35], s88 offen sc1
s_mov_b64 exec, -1
s_nop 1
v_permlane32_swap_b32 v6, v7
v_permlane32_swap_b32 v8, v9
v_add_f32 v6, v6, v7
v_add_f32 v8, v8, v9
s_nop 1
v_permlane16_swap_b32 v6, v8
s_nop 0
v_add_f32 v6, v6, v8
buffer_store_dword v6, v1, s[32:35], s87 offen sc1
s_branch back_101
slow_112:
.p2align 3
v_mfma_f32_16x16x32_bf16 v[160:163], v[120:123], v[156:159], v[44:47]
v_max_f32 v158, v192, v193
v_max_f32 v159, v194, v195
v_permlane32_swap_b32 v130, v131
s_nop 0
v_max_f32 v130, v130, v131
s_nop 2
v_max_f32 v156, v160, v161
v_max_f32 v157, v162, v163
v_max3_f32 v128, v156, v157, v158
v_max_f32 v128, v128, v159
s_nop 1
v_permlane32_swap_b32 v128, v129
s_nop 0
v_max_f32 v128, v128, v129
s_nop 1
v_permlane16_swap_b32 v128, v130
s_nop 0
v_max_f32 v128, v128, v130
v_mov_b32 v130, v128
s_nop 1
v_permlane16_swap_b32 v128, v130
s_nop 0
v_mov_b32 v129, v128
v_mov_b32 v131, v130
s_nop 0
v_permlane32_swap_b32 v128, v129
v_permlane32_swap_b32 v130, v131
v_mul_f32 v128, v128, v124
v_mul_f32 v129, v129, v125
v_pk_fma_f32 v[156:157], v[156:157], v[124:125], v[128:129] op_sel:[0,0,0] op_sel_hi:[1,0,0] neg_lo:[0,0,1] neg_hi:[0,0,1]
v_pk_fma_f32 v[158:159], v[158:159], v[124:125], v[128:129] op_sel:[0,0,0] op_sel_hi:[1,0,0] neg_lo:[0,0,1] neg_hi:[0,0,1]
v_mul_f32 v130, v130, v126
v_mul_f32 v131, v131, v127
v_exp_f32 v156, v156
v_exp_f32 v157, v157
v_exp_f32 v158, v158
v_exp_f32 v159, v159
v_pk_fma_f32 v[164:165], v[164:165], v[124:125], v[128:129] op_sel:[0,1,1] op_sel_hi:[1,1,1] neg_lo:[0,0,1] neg_hi:[0,0,1]
v_pk_fma_f32 v[166:167], v[166:167], v[124:125], v[128:129] op_sel:[0,1,1] op_sel_hi:[1,1,1] neg_lo:[0,0,1] neg_hi:[0,0,1]
v_exp_f32 v164, v164
v_exp_f32 v165, v165
v_exp_f32 v166, v166
v_exp_f32 v167, v167
v_pk_fma_f32 v[172:173], v[172:173], v[126:127], v[130:131] op_sel:[0,0,0] op_sel_hi:[1,0,0] neg_lo:[0,0,1] neg_hi:[0,0,1]
v_pk_fma_f32 v[174:175], v[174:175], v[126:127], v[130:131] op_sel:[0,0,0] op_sel_hi:[1,0,0] neg_lo:[0,0,1] neg_hi:[0,0,1]
v_cvt_pk_bf16_f32 v156, v156, v156
v_cvt_pk_bf16_f32 v157, v157, v157
v_cvt_pk_bf16_f32 v158, v158, v158
v_cvt_pk_bf16_f32 v159, v159, v159
v_exp_f32 v172, v172
v_exp_f32 v173, v173
v_exp_f32 v174, v174
v_exp_f32 v175, v175
v_pk_fma_f32 v[180:181], v[180:181], v[126:127], v[130:131] op_sel:[0,1,1] op_sel_hi:[1,1,1] neg_lo:[0,0,1] neg_hi:[0,0,1]
v_pk_fma_f32 v[182:183], v[182:183], v[126:127], v[130:131] op_sel:[0,1,1] op_sel_hi:[1,1,1] neg_lo:[0,0,1] neg_hi:[0,0,1]
v_and_b32 v156, v52, v156
v_and_b32 v157, v52, v157
v_and_b32 v158, v52, v158
v_and_b32 v159, v52, v159
v_cvt_pk_bf16_f32 v164, v164, v164
v_cvt_pk_bf16_f32 v165, v165, v165
v_mfma_f32_16x16x32_bf16 v[160:163], v[48:51], v[156:159], 0
v_cvt_pk_bf16_f32 v166, v166, v166
v_cvt_pk_bf16_f32 v167, v167, v167
v_mfma_f32_16x16x32_bf16 v[220:223], v[100:103], v[156:159], 0
v_exp_f32 v180, v180
v_mfma_f32_16x16x32_bf16 v[224:227], v[110:113], v[156:159], 0
v_exp_f32 v181, v181
v_exp_f32 v182, v182
v_exp_f32 v183, v183
v_and_b32 v164, v52, v164
v_and_b32 v165, v52, v165
v_and_b32 v166, v52, v166
v_and_b32 v167, v52, v167
v_cvt_pk_bf16_f32 v172, v172, v172
v_cvt_pk_bf16_f32 v173, v173, v173
v_mfma_f32_16x16x32_bf16 v[168:171], v[48:51], v[164:167], 0
v_cvt_pk_bf16_f32 v174, v174, v174
v_cvt_pk_bf16_f32 v175, v175, v175
v_mfma_f32_16x16x32_bf16 v[228:231], v[102:105], v[164:167], 0
v_and_b32 v172, v52, v172
v_and_b32 v173, v52, v173
v_mfma_f32_16x16x32_bf16 v[232:235], v[112:115], v[164:167], 0
v_and_b32 v174, v52, v174
v_and_b32 v175, v52, v175
v_cvt_pk_bf16_f32 v180, v180, v180
v_cvt_pk_bf16_f32 v181, v181, v181
v_mfma_f32_16x16x32_bf16 v[176:179], v[48:51], v[172:175], 0
v_cvt_pk_bf16_f32 v182, v182, v182
v_cvt_pk_bf16_f32 v183, v183, v183
v_mfma_f32_16x16x32_bf16 v[236:239], v[104:107], v[172:175], 0
v_and_b32 v180, v52, v180
v_and_b32 v181, v52, v181
v_mfma_f32_16x16x32_bf16 v[240:243], v[114:117], v[172:175], 0
v_and_b32 v182, v52, v182
v_and_b32 v183, v52, v183
v_rcp_f32 v160, v160
v_rcp_f32 v168, v168
v_pk_mul_f32 v[220:221], v[220:221], v[160:161] op_sel:[0,0] op_sel_hi:[1,0]
v_pk_mul_f32 v[222:223], v[222:223], v[160:161] op_sel:[0,0] op_sel_hi:[1,0]
v_pk_mul_f32 v[228:229], v[228:229], v[168:169] op_sel:[0,0] op_sel_hi:[1,0]
v_pk_mul_f32 v[224:225], v[224:225], v[160:161] op_sel:[0,0] op_sel_hi:[1,0]
v_pk_mul_f32 v[226:227], v[226:227], v[160:161] op_sel:[0,0] op_sel_hi:[1,0]
v_pk_mul_f32 v[230:231], v[230:231], v[168:169] op_sel:[0,0] op_sel_hi:[1,0]
v_pk_mul_f32 v[232:233], v[232:233], v[168:169] op_sel:[0,0] op_sel_hi:[1,0]
v_pk_mul_f32 v[234:235], v[234:235], v[168:169] op_sel:[0,0] op_sel_hi:[1,0]
v_mfma_f32_16x16x32_bf16 v[184:187], v[48:51], v[180:183], 0
v_rcp_f32_e64 v176, v176
v_cvt_pk_bf16_f32 v220, v220, v221
v_cvt_pk_bf16_f32 v221, v222, v223
v_cvt_pk_bf16_f32 v228, v228, v229
v_pk_mul_f32 v[236:237], v[236:237], v[176:177] op_sel:[0,0] op_sel_hi:[1,0]
v_mfma_f32_16x16x32_bf16 v[244:247], v[106:109], v[180:183], 0
v_cvt_pk_bf16_f32 v222, v224, v225
v_cvt_pk_bf16_f32 v223, v226, v227
v_rcp_f32_e64 v184, v184
v_cvt_pk_bf16_f32 v229, v230, v231
v_pk_mul_f32 v[238:239], v[238:239], v[176:177] op_sel:[0,0] op_sel_hi:[1,0]
v_pk_mul_f32 v[240:241], v[240:241], v[176:177] op_sel:[0,0] op_sel_hi:[1,0]
v_pk_mul_f32 v[242:243], v[242:243], v[176:177] op_sel:[0,0] op_sel_hi:[1,0]
v_cvt_pk_bf16_f32 v236, v236, v237
v_pk_mul_f32 v[244:245], v[244:245], v[184:185] op_sel:[0,0] op_sel_hi:[1,0]
v_pk_mul_f32 v[246:247], v[246:247], v[184:185] op_sel:[0,0] op_sel_hi:[1,0]
v_mfma_f32_16x16x32_bf16 v[248:251], v[116:119], v[180:183], 0
buffer_store_dwordx4 v[220:223], v18, s[32:35], s80 offen sc1
v_cvt_pk_bf16_f32 v230, v232, v233
v_cvt_pk_bf16_f32 v231, v234, v235
v_cvt_pk_bf16_f32 v237, v238, v239
v_cvt_pk_bf16_f32 v244, v244, v245
buffer_store_dwordx4 v[228:231], v18, s[32:35], s81 offen sc1
v_cvt_pk_bf16_f32 v238, v240, v241
v_cvt_pk_bf16_f32 v239, v242, v243
v_pk_mul_f32 v[248:249], v[248:249], v[184:185] op_sel:[0,0] op_sel_hi:[1,0]
v_pk_mul_f32 v[250:251], v[250:251], v[184:185] op_sel:[0,0] op_sel_hi:[1,0]
v_cvt_pk_bf16_f32 v245, v246, v247
buffer_store_dwordx4 v[236:239], v18, s[32:35], s82 offen sc1
v_cvt_pk_bf16_f32 v246, v248, v249
v_cvt_pk_bf16_f32 v247, v250, v251
buffer_store_dwordx4 v[244:247], v18, s[32:35], s83 offen sc1
s_branch back_113
slow_114:
buffer_store_dword v5, v4, s[32:35], s84 offen sc1
s_branch back_115
slow_118:
s_nop 0
v_cvt_pk_bf16_f32 v20, v60, v61
v_cvt_pk_bf16_f32 v21, v62, v63
v_cvt_pk_bf16_f32 v22, v64, v65
v_cvt_pk_bf16_f32 v23, v66, v67
buffer_store_dwordx4 v[20:23], v18, s[32:35], s85 offen offset:0 sc1
v_cvt_pk_bf16_f32 v24, v68, v69
v_cvt_pk_bf16_f32 v25, v70, v71
v_cvt_pk_bf16_f32 v26, v72, v73
v_cvt_pk_bf16_f32 v27, v74, v75
buffer_store_dwordx4 v[24:27], v18, s[32:35], s85 offen offset:1024 sc1
v_cvt_pk_bf16_f32 v28, v76, v77
v_cvt_pk_bf16_f32 v29, v78, v79
v_cvt_pk_bf16_f32 v30, v80, v81
v_cvt_pk_bf16_f32 v31, v82, v83
buffer_store_dwordx4 v[28:31], v18, s[32:35], s86 offen offset:0 sc1
v_cvt_pk_bf16_f32 v32, v84, v85
v_cvt_pk_bf16_f32 v33, v86, v87
v_cvt_pk_bf16_f32 v34, v88, v89
v_cvt_pk_bf16_f32 v35, v90, v91
buffer_store_dwordx4 v[32:35], v18, s[32:35], s86 offen offset:1024 sc1
s_barrier
v_dot2c_f32_bf16 v6, v20, v48
v_dot2c_f32_bf16 v8, v20, v20
v_dot2c_f32_bf16 v7, v28, v48
v_dot2c_f32_bf16 v9, v28, v28
v_dot2c_f32_bf16 v6, v21, v48
v_dot2c_f32_bf16 v8, v21, v21
v_dot2c_f32_bf16 v7, v29, v48
v_dot2c_f32_bf16 v9, v29, v29
v_dot2c_f32_bf16 v6, v22, v48
v_dot2c_f32_bf16 v8, v22, v22
v_dot2c_f32_bf16 v7, v30, v48
v_dot2c_f32_bf16 v9, v30, v30
v_dot2c_f32_bf16 v6, v23, v48
v_dot2c_f32_bf16 v8, v23, v23
v_dot2c_f32_bf16 v7, v31, v48
v_dot2c_f32_bf16 v9, v31, v31
v_dot2c_f32_bf16 v6, v24, v48
v_dot2c_f32_bf16 v8, v24, v24
v_dot2c_f32_bf16 v7, v32, v48
v_dot2c_f32_bf16 v9, v32, v32
v_dot2c_f32_bf16 v6, v25, v48
v_dot2c_f32_bf16 v8, v25, v25
v_dot2c_f32_bf16 v7, v33, v48
v_dot2c_f32_bf16 v9, v33, v33
v_dot2c_f32_bf16 v6, v26, v48
v_dot2c_f32_bf16 v8, v26, v26
v_dot2c_f32_bf16 v7, v34, v48
v_dot2c_f32_bf16 v9, v34, v34
v_dot2c_f32_bf16 v6, v27, v48
v_dot2c_f32_bf16 v8, v27, v27
v_dot2c_f32_bf16 v7, v35, v48
v_dot2c_f32_bf16 v9, v35, v35
s_mov_b64 exec, 1
s_waitcnt vmcnt(0)
buffer_store_dword v5, v4, s[32:35], s88 offen sc1
s_mov_b64 exec, -1
s_nop 1
v_permlane32_swap_b32 v6, v7
v_permlane32_swap_b32 v8, v9
v_add_f32 v6, v6, v7
v_add_f32 v8, v8, v9
s_nop 1
v_permlane16_swap_b32 v6, v8
s_nop 0
v_add_f32 v6, v6, v8
buffer_store_dword v6, v1, s[32:35], s87 offen sc1
s_branch back_119
slow_132:
.p2align 3
v_mfma_f32_16x16x32_bf16 v[156:159], v[188:191], v[60:63], 0
v_mfma_f32_16x16x32_bf16 v[164:167], v[188:191], v[68:71], 0
v_mfma_f32_16x16x32_bf16 v[160:163], v[192:195], v[60:63], 0
v_mfma_f32_16x16x32_bf16 v[172:175], v[188:191], v[76:79], 0
v_mfma_f32_16x16x32_bf16 v[168:171], v[192:195], v[68:71], 0
v_mfma_f32_16x16x32_bf16 v[180:183], v[188:191], v[84:87], 0
v_mfma_f32_16x16x32_bf16 v[156:159], v[196:199], v[220:223], v[156:159]
v_mfma_f32_16x16x32_bf16 v[176:179], v[192:195], v[76:79], 0
v_mfma_f32_16x16x32_bf16 v[164:167], v[196:199], v[228:231], v[164:167]
v_mfma_f32_16x16x32_bf16 v[184:187], v[192:195], v[84:87], 0
v_mfma_f32_16x16x32_bf16 v[160:163], v[200:203], v[220:223], v[160:163]
v_mfma_f32_16x16x32_bf16 v[172:175], v[196:199], v[236:239], v[172:175]
v_mfma_f32_16x16x32_bf16 v[168:171], v[200:203], v[228:231], v[168:171]
v_mfma_f32_16x16x32_bf16 v[180:183], v[196:199], v[244:247], v[180:183]
v_mfma_f32_16x16x32_bf16 v[176:179], v[200:203], v[236:239], v[176:179]
v_mfma_f32_16x16x32_bf16 v[184:187], v[200:203], v[244:247], v[184:187]
v_pk_mul_f32 v[156:157], v[156:157], v[100:101] op_sel:[0,0] op_sel_hi:[1,0]
v_pk_mul_f32 v[158:159], v[158:159], v[100:101] op_sel:[0,0] op_sel_hi:[1,0]
v_cvt_pk_bf16_f32 v156, v156, v157
v_pk_mul_f32 v[164:165], v[164:165], v[100:101] op_sel:[0,1] op_sel_hi:[1,1]
v_pk_mul_f32 v[160:161], v[160:161], v[100:101] op_sel:[0,0] op_sel_hi:[1,0]
v_pk_mul_f32 v[162:163], v[162:163], v[100:101] op_sel:[0,0] op_sel_hi:[1,0]
v_cvt_pk_bf16_f32 v157, v158, v159
v_pk_mul_f32 v[166:167], v[166:167], v[100:101] op_sel:[0,1] op_sel_hi:[1,1]
v_cvt_pk_bf16_f32 v164, v164, v165
v_pk_mul_f32 v[172:173], v[172:173], v[102:103] op_sel:[0,0] op_sel_hi:[1,0]
v_cvt_pk_bf16_f32 v158, v160, v161
v_cvt_pk_bf16_f32 v159, v162, v163
v_pk_mul_f32 v[168:169], v[168:169], v[100:101] op_sel:[0,1] op_sel_hi:[1,1]
v_pk_mul_f32 v[170:171], v[170:171], v[100:101] op_sel:[0,1] op_sel_hi:[1,1]
v_cvt_pk_bf16_f32 v165, v166, v167
v_pk_mul_f32 v[174:175], v[174:175], v[102:103] op_sel:[0,0] op_sel_hi:[1,0]
v_cvt_pk_bf16_f32 v172, v172, v173
v_pk_mul_f32 v[180:181], v[180:181], v[102:103] op_sel:[0,1] op_sel_hi:[1,1]
buffer_store_dwordx4 v[156:159], v18, s[32:35], s80 offen sc1
v_cvt_pk_bf16_f32 v166, v168, v169
v_cvt_pk_bf16_f32 v167, v170, v171
v_pk_mul_f32 v[176:177], v[176:177], v[102:103] op_sel:[0,0] op_sel_hi:[1,0]
v_pk_mul_f32 v[178:179], v[178:179], v[102:103] op_sel:[0,0] op_sel_hi:[1,0]
v_cvt_pk_bf16_f32 v173, v174, v175
v_pk_mul_f32 v[182:183], v[182:183], v[102:103] op_sel:[0,1] op_sel_hi:[1,1]
v_cvt_pk_bf16_f32 v180, v180, v181
buffer_store_dwordx4 v[164:167], v18, s[32:35], s81 offen sc1
v_cvt_pk_bf16_f32 v174, v176, v177
v_cvt_pk_bf16_f32 v175, v178, v179
v_pk_mul_f32 v[184:185], v[184:185], v[102:103] op_sel:[0,1] op_sel_hi:[1,1]
v_pk_mul_f32 v[186:187], v[186:187], v[102:103] op_sel:[0,1] op_sel_hi:[1,1]
v_cvt_pk_bf16_f32 v181, v182, v183
buffer_store_dwordx4 v[172:175], v18, s[32:35], s82 offen sc1
v_cvt_pk_bf16_f32 v182, v184, v185
v_cvt_pk_bf16_f32 v183, v186, v187
buffer_store_dwordx4 v[180:183], v18, s[32:35], s83 offen sc1
s_branch back_133
slow_134:
buffer_store_dword v5, v4, s[32:35], s84 offen sc1
s_branch back_135
s_endpgm
.section .rodata,"a"
.p2align 6
.amdhsa_kernel interleave_layers__sliding_local_dilated__linear_kernel_hedgehog__prompt_kernel
  .amdhsa_next_free_vgpr 256
  .amdhsa_next_free_sgpr 102
  .amdhsa_accum_offset 256
  .amdhsa_group_segment_fixed_size 0
  .amdhsa_kernarg_size 80
  .amdhsa_user_sgpr_count 2
  .amdhsa_user_sgpr_kernarg_segment_ptr 1
  .amdhsa_system_sgpr_workgroup_id_x 1
.end_amdhsa_kernel
```

```asm
; @launch grid=(256,1,1) block=(512,1,1) lds=163840
.amdgcn_target "amdgcn-amd-amdhsa--gfx950"
.text
.globl interleave_layers__sliding_local_dilated__linear_kernel_hedgehog__prompt_kernel
.p2align 8
.type interleave_layers__sliding_local_dilated__linear_kernel_hedgehog__prompt_kernel,@function
interleave_layers__sliding_local_dilated__linear_kernel_hedgehog__prompt_kernel:
s_cmp_ge_u32 s2, 256
s_cbranch_scc1 L_end
s_load_dwordx16 s[4:19], s[0:1], 0
s_load_dwordx4 s[20:23], s[0:1], 64
v_lshrrev_b32 v1, 6, v0
v_and_b32 v0, 63, v0
v_readfirstlane_b32 s40, v1
v_and_b32 v2, 15, v0
v_lshrrev_b32 v3, 4, v0
v_lshlrev_b32 v18, 4, v0
s_and_b32 s48, s2, 7
s_lshr_b32 s49, s2, 3
s_and_b32 s74, s49, 1
s_lshl_b32 s41, s48, 1
s_add_u32 s41, s41, s74
s_lshr_b32 s42, s49, 1
s_and_b32 s48, s2, 7
s_lshr_b32 s47, s42, 2
s_add_u32 s47, s47, s48
s_and_b32 s47, s47, 3
s_and_b32 s43, s40, 3
s_lshl_b32 s70, s43, 12
s_lshl_b32 s71, s43, 11
s_add_u32 s71, s71, 16384
s_cmp_lt_u32 s40, 4
s_cbranch_scc1 L_compute
v_lshrrev_b32 v4, 3, v0
v_and_b32 v5, 7, v0
s_lshl_b32 s48, s43, 4
v_add_u32 v6, s48, v4
s_lshl_b32 s48, s42, 7
s_mov_b32 s49, 6144
v_mul_u32_u24 v6, s49, v6
v_and_b32 v7, 2, v4
v_xor_b32 v7, v7, v5
v_lshl_add_u32 v26, v7, 4, v6
v_add_u32 v26, s48, v26
s_mul_i32 s49, s49, 8
s_sub_u32 s49, s49, 1024
v_xor_b32 v27, 64, v26
v_add_u32 v27, s49, v27
s_mov_b32 s53, 2048
s_mov_b32 s54, 393216
s_mov_b32 s57, 131072
s_lshl_b32 s48, s41, 7
s_lshl_b32 s49, s43, 5
s_add_u32 s48, s48, s49
v_add_u32 v6, s48, v4
v_lshlrev_b32 v6, 11, v6
v_lshrrev_b32 v7, 1, v4
v_xor_b32 v7, v7, v5
v_lshl_add_u32 v20, v7, 4, v6
v_xor_b32 v21, 64, v20
v_add_u32 v21, 15360, v21
v_add_u32 v22, 30720, v20
v_add_u32 v23, 30720, v21
s_add_u32 s69, s47, 0
s_and_b32 s69, s69, 3
s_add_u32 s69, s69, 0
s_mul_i32 s67, s69, 128
s_mul_i32 s68, s69, s54
s_waitcnt lgkmcnt(0)
s_mov_b32 s24, s4
s_and_b32 s25, s5, 0xffff
s_mov_b32 s26, 4194304
s_mov_b32 s27, 0x00020000
s_mov_b32 s28, s6
s_and_b32 s29, s7, 0xffff
s_mov_b32 s30, 6291456
s_mov_b32 s31, 0x00020000
s_add_u32 m0, s70, 0
s_nop 0
buffer_load_dwordx4 v20, s[24:27], s67 offen offset:0  lds
buffer_load_dwordx4 v21, s[24:27], s67 offen offset:1024  lds
buffer_load_dwordx4 v22, s[24:27], s67 offen offset:2048  lds
buffer_load_dwordx4 v23, s[24:27], s67 offen offset:3072  lds
s_add_u32 s60, s71, 0
s_add_u32 m0, s60, 0
s_mov_b32 s61, s68
buffer_load_dwordx4 v26, s[28:31], s61 offen lds
buffer_load_dwordx4 v27, s[28:31], s61 offen offset:1024 lds
s_add_u32 m0, s60, 8192
s_add_u32 s61, s61, s53
buffer_load_dwordx4 v26, s[28:31], s61 offen lds
buffer_load_dwordx4 v27, s[28:31], s61 offen offset:1024 lds
s_add_u32 m0, s60, 16384
s_add_u32 s61, s61, s53
buffer_load_dwordx4 v26, s[28:31], s61 offen lds
buffer_load_dwordx4 v27, s[28:31], s61 offen offset:1024 lds
s_lshr_b32 s48, s2, 2
s_and_b32 s48, s48, 1
s_lshl_b32 s48, s48, 1
s_add_u32 s48, s48, s74
s_and_b32 s49, s42, 3
s_xor_b32 s77, s48, s49
s_add_u32 s77, s77, 4
s_lshr_b32 s48, s77, 2
s_add_u32 s48, s47, s48
s_and_b32 s48, s48, 3
s_and_b32 s49, s77, 3
s_lshl_b32 s49, s49, 2
s_add_u32 s78, s48, s49
s_and_b32 s48, s2, 7
s_lshl_b32 s48, s48, 1
s_add_u32 s75, s78, s48
s_and_b32 s75, s75, 15
s_mov_b32 s46, 0
s_mov_b32 s32, s22
s_and_b32 s33, s23, 0xffff
s_mov_b32 s34, 268435456
s_mov_b32 s35, 0x00020000
s_mov_b32 s36, s8
s_and_b32 s37, s9, 0xffff
s_mov_b32 s38, 2097152
s_mov_b32 s39, 0x00020000
v_mov_b32 v56, -1
v_mov_b32 v57, -1
v_mov_b32 v58, -1
v_mov_b32 v59, -1
s_lshl_b32 s52, s41, 6
s_add_u32 s52, s52, s42
s_lshl_b32 s52, s52, 8
s_add_u32 s52, s52, 16777216
s_getreg_b32 s50, hwreg(HW_REG_XCC_ID)
s_and_b32 s50, s50, 7
s_lshl_b32 s50, s50, 3
s_lshl_b64 s[94:95], 1, s50
s_and_b32 s96, s2, 7
s_lshl_b32 s96, s96, 5
s_and_b32 s51, s42, 7
s_cmp_gt_u32 s51, 3
s_cselect_b32 s49, 1, 0
s_sub_u32 s49, s51, s49
s_lshl_b32 s49, s49, 1
s_add_u32 s49, s49, s74
s_lshl_b32 s49, s49, 2
s_add_u32 s49, s49, s43
s_lshr_b32 s50, s49, 4
s_lshl_b32 s50, s50, 11
s_and_b32 s49, s49, 15
s_mul_i32 s49, s49, 24576
s_add_u32 s49, s49, s50
s_and_b32 s50, s42, 8
s_or_b32 s50, s50, 3
s_and_b32 s48, s2, 7
s_lshr_b32 s76, s50, 2
s_add_u32 s76, s76, s48
s_and_b32 s76, s76, 3
s_lshl_b32 s50, s50, 7
s_add_u32 s49, s49, s50
s_and_b32 s51, s51, 3
s_cmp_eq_u32 s51, 3
s_cselect_b32 s49, 0x70000000, s49
v_mul_u32_u24 v4, 6144, v4
v_lshl_add_u32 v4, v5, 4, v4
v_lshrrev_b32 v5, 5, v0
v_lshlrev_b32 v5, 30, v5
v_add3_u32 v36, v4, v5, s49
s_mov_b32 s55, -1
s_mov_b32 s56, -1
v_lshrrev_b32 v4, 3, v0
v_and_b32 v5, 7, v0
s_lshr_b32 s48, s43, 1
s_lshl_b32 s48, s48, 5
s_and_b32 s49, s43, 1
s_lshl_b32 s49, s49, 3
s_add_u32 s48, s48, s49
v_lshrrev_b32 v6, 2, v4
v_lshlrev_b32 v6, 4, v6
v_and_b32 v7, 3, v4
v_add3_u32 v6, v6, v7, s48
s_lshl_b32 s48, s78, 7
s_mov_b32 s49, 2048
v_mul_u32_u24 v6, s49, v6
v_and_b32 v7, 2, v4
v_xor_b32 v7, v7, v5
v_lshl_add_u32 v28, v7, 4, v6
v_add_u32 v28, s48, v28
s_mul_i32 s49, s49, 4
s_sub_u32 s49, s49, 1024
v_xor_b32 v29, 64, v28
v_add_u32 v29, s49, v29
v_lshrrev_b32 v4, 3, v0
v_and_b32 v5, 7, v0
s_lshr_b32 s48, s43, 1
s_lshl_b32 s48, s48, 5
s_and_b32 s49, s43, 1
s_lshl_b32 s49, s49, 3
s_add_u32 s48, s48, s49
v_lshrrev_b32 v6, 2, v4
v_lshlrev_b32 v6, 4, v6
v_and_b32 v7, 3, v4
v_add3_u32 v6, v6, v7, s48
s_lshl_b32 s48, s42, 7
s_mov_b32 s49, 6144
s_cmp_ge_i32 s55, 0
s_cselect_b32 s48, 1024, s48
s_cselect_b32 s49, 384, s49
v_mul_u32_u24 v6, s49, v6
v_and_b32 v7, 2, v4
v_xor_b32 v7, v7, v5
v_lshl_add_u32 v60, v7, 4, v6
v_add_u32 v60, s48, v60
s_mul_i32 s49, s49, 4
s_sub_u32 s49, s49, 1024
v_xor_b32 v61, 64, v60
v_add_u32 v61, s49, v61
v_lshrrev_b32 v4, 3, v0
v_and_b32 v5, 7, v0
s_lshr_b32 s48, s43, 1
s_lshl_b32 s48, s48, 5
s_and_b32 s49, s43, 1
s_lshl_b32 s49, s49, 3
s_add_u32 s48, s48, s49
v_lshrrev_b32 v6, 2, v4
v_lshlrev_b32 v6, 4, v6
v_and_b32 v7, 3, v4
v_add3_u32 v6, v6, v7, s48
s_lshl_b32 s48, s78, 7
s_mov_b32 s49, 2048
s_cmp_ge_i32 s56, 0
s_cselect_b32 s48, 1024, s48
s_cselect_b32 s49, 128, s49
v_mul_u32_u24 v6, s49, v6
v_and_b32 v7, 2, v4
v_xor_b32 v7, v7, v5
v_lshl_add_u32 v24, v7, 4, v6
v_add_u32 v24, s48, v24
s_mul_i32 s49, s49, 4
s_sub_u32 s49, s49, 1024
v_xor_b32 v25, 64, v24
v_add_u32 v25, s49, v25
v_lshlrev_b32 v30, 2, v2
v_and_b32 v32, 7, v0
v_lshlrev_b32 v32, 5, v32
s_lshl_b32 s50, s41, 2
s_add_u32 s50, s50, s43
s_lshl_b32 s50, s50, 12
s_add_u32 s50, s50, 16777216
v_add_u32 v37, s50, v18
v_lshrrev_b32 v4, 5, v0
v_lshl_add_u32 v4, v4, 4, v2
s_lshl_b32 s48, s43, 5
v_add_u32 v4, s48, v4
v_lshlrev_b32 v49, 3, v4
v_add_u32 v49, 131072, v49
v_lshlrev_b32 v50, 2, v4
v_add_u32 v50, 132096, v50
s_lshl_b32 s79, s41, 2
s_add_u32 s79, s79, s43
s_lshl_b32 s79, s79, 7
s_add_u32 s79, s79, 18358272
s_lshl_b32 s48, s41, 3
s_lshl_b32 s49, s43, 1
s_add_u32 s48, s48, s49
s_lshl_b32 s80, s48, 15
s_lshl_b32 s49, s42, 11
s_add_u32 s81, s80, s49
s_add_u32 s81, s81, 4194304
s_add_u32 s82, s81, 32768
s_lshl_b32 s48, s43, 11
v_add_u32 v51, s48, v18
v_add_u32 v52, 0x10000, v51
v_add_u32 v14, 0x20000, v51
s_lshl_b32 s48, s2, 2
s_add_u32 s48, s48, s43
s_lshl_b32 s83, s48, 11
s_mul_i32 s87, s48, 6144
v_add_u32 v62, s83, v18
s_add_u32 s87, s87, 3072
v_add_u32 v63, s87, v18
s_and_b32 s48, s2, 7
s_add_u32 s83, s42, s48
s_and_b32 s83, s83, 7
s_mul_i32 s83, s83, 2
s_add_u32 s87, s83, 1
s_and_b32 s87, s87, 15
s_mul_i32 s83, s83, 393216
s_mul_i32 s87, s87, 393216
v_add_u32 v63, 1024, v61
s_cmp_eq_u32 s74, 0
s_cselect_b64 vcc, -1, 0
v_cndmask_b32 v63, v63, v60, vcc
s_lshr_b32 s48, s2, 4
s_and_b32 s49, s2, 7
s_add_u32 s48, s48, s49
s_mul_i32 s49, s48, 8193
s_lshr_b32 s49, s49, 16
s_mul_i32 s49, s49, 8
s_sub_u32 s88, s48, s49
s_lshr_b32 s48, s2, 3
s_lshl_b32 s48, s48, 2
s_add_u32 s48, s48, s43
s_lshl_b32 s48, s48, 14
s_add_u32 s48, s48, 384
v_lshrrev_b32 v4, 3, v0
v_and_b32 v5, 7, v0
v_lshlrev_b32 v4, 11, v4
v_lshl_add_u32 v4, v5, 4, v4
v_add_u32 v15, s48, v4
s_mul_i32 s48, s42, 163840
s_add_u32 s48, s48, 9437184
s_lshl_b32 s49, s43, 4
s_add_u32 s49, s49, s41
s_lshl_b32 s50, s49, 11
s_add_u32 s86, s48, s50
s_lshl_b32 s50, s49, 9
s_add_u32 s89, s48, s50
s_add_u32 s89, s89, 131072
v_lshlrev_b32 v39, 3, v0
s_lshl_b32 s73, s42, 2
s_add_u32 s73, s73, 0
s_lshl_b32 s73, s73, 7
s_add_u32 s73, s73, 18366464
v_mov_b32 v12, 0
s_lshl_b32 s50, s43, 12
s_add_u32 s50, s50, s52
s_add_u32 s50, s50, 262144
v_min_u32 v8, 2, v3
v_lshlrev_b32 v8, 18, v8
v_lshl_add_u32 v8, v2, 4, v8
v_add_u32 v55, s50, v8
s_lshl_b32 s50, s42, 2
s_add_u32 s50, s50, s43
s_lshl_b32 s50, s50, 12
s_add_u32 s50, s50, 17825792
v_add_u32 v38, s50, v18
v_min_u32 v4, 2, v3
v_lshlrev_b32 v4, 8, v4
v_lshl_add_u32 v4, v2, 2, v4
s_and_b32 s48, s43, 1
s_lshl_b32 s48, s48, 7
s_lshr_b32 s49, s43, 1
s_lshl_b32 s49, s49, 6
s_add_u32 s48, s48, s49
s_add_u32 s48, s48, 133120
v_add_u32 v53, s48, v4
s_getpc_b64 s[98:99]
pc_1:
s_add_u32 s98, s98, c0_last - pc_1
s_addc_u32 s99, s99, 0
s_lshr_b32 s50, s2, 3
s_lshl_b32 s50, s50, 2
s_add_u32 s50, s50, s43
s_lshl_b32 s50, s50, 7
v_and_b32 v4, 1, v0
v_lshl_add_u32 v4, v4, 6, s50
v_min_u32 v54, L_code_end - c0_last, v4
s_add_u32 s69, s47, 0
s_and_b32 s69, s69, 3
s_add_u32 s69, s69, 4
s_mul_i32 s67, s69, 128
s_mul_i32 s68, s69, s54
s_add_u32 m0, s70, 40960
s_nop 0
buffer_load_dwordx4 v20, s[24:27], s67 offen offset:0  lds
buffer_load_dwordx4 v21, s[24:27], s67 offen offset:1024  lds
buffer_load_dwordx4 v22, s[24:27], s67 offen offset:2048  lds
buffer_load_dwordx4 v23, s[24:27], s67 offen offset:3072  lds
s_add_u32 s60, s71, 40960
s_add_u32 m0, s60, 0
s_mov_b32 s61, s68
buffer_load_dwordx4 v26, s[28:31], s61 offen lds
buffer_load_dwordx4 v27, s[28:31], s61 offen offset:1024 lds
s_add_u32 m0, s60, 8192
s_add_u32 s61, s61, s53
buffer_load_dwordx4 v26, s[28:31], s61 offen lds
buffer_load_dwordx4 v27, s[28:31], s61 offen offset:1024 lds
s_add_u32 m0, s60, 16384
s_add_u32 s61, s61, s53
buffer_load_dwordx4 v26, s[28:31], s61 offen lds
buffer_load_dwordx4 v27, s[28:31], s61 offen offset:1024 lds
s_waitcnt vmcnt(10)
s_barrier
s_cmp_lg_u32 s43, 3
s_cbranch_scc1 else_2
s_atomic_add_x2 s[94:95], s[20:21], s96
else_2:
s_add_u32 s49, s76, 0
s_and_b32 s49, s49, 3
s_add_u32 s49, s49, 8
s_mul_i32 s49, s49, 393216
buffer_load_dwordx4 v[40:43], v36, s[28:31], s49 offen
s_add_u32 s49, s76, 0
s_and_b32 s49, s49, 3
s_add_u32 s49, s49, 12
s_mul_i32 s49, s49, 393216
buffer_load_dwordx4 v[40:43], v36, s[28:31], s49 offen
s_add_u32 s69, s47, 0
s_and_b32 s69, s69, 3
s_add_u32 s69, s69, 8
s_mul_i32 s67, s69, 128
s_mul_i32 s68, s69, s54
s_add_u32 m0, s70, 81920
s_nop 0
buffer_load_dwordx4 v20, s[24:27], s67 offen offset:0  lds
buffer_load_dwordx4 v21, s[24:27], s67 offen offset:1024  lds
buffer_load_dwordx4 v22, s[24:27], s67 offen offset:2048  lds
buffer_load_dwordx4 v23, s[24:27], s67 offen offset:3072  lds
s_add_u32 s60, s71, 81920
s_add_u32 m0, s60, 0
s_mov_b32 s61, s68
buffer_load_dwordx4 v26, s[28:31], s61 offen lds
buffer_load_dwordx4 v27, s[28:31], s61 offen offset:1024 lds
s_add_u32 m0, s60, 8192
s_add_u32 s61, s61, s53
buffer_load_dwordx4 v26, s[28:31], s61 offen lds
buffer_load_dwordx4 v27, s[28:31], s61 offen offset:1024 lds
s_add_u32 m0, s60, 16384
s_add_u32 s61, s61, s53
buffer_load_dwordx4 v26, s[28:31], s61 offen lds
buffer_load_dwordx4 v27, s[28:31], s61 offen offset:1024 lds
s_add_u32 s49, s76, 1
s_and_b32 s49, s49, 3
s_add_u32 s49, s49, 0
s_mul_i32 s49, s49, 393216
buffer_load_dwordx4 v[40:43], v36, s[28:31], s49 offen
s_mov_b32 s64, 0
s_mov_b32 s65, 0
s_waitcnt vmcnt(11)
s_barrier
s_add_u32 s69, s47, 0
s_and_b32 s69, s69, 3
s_add_u32 s69, s69, 12
s_mul_i32 s67, s69, 128
s_mul_i32 s68, s69, s54
s_add_u32 m0, s70, s65
s_nop 0
buffer_load_dwordx4 v20, s[24:27], s67 offen offset:0  lds
buffer_load_dwordx4 v21, s[24:27], s67 offen offset:1024  lds
buffer_load_dwordx4 v22, s[24:27], s67 offen offset:2048  lds
buffer_load_dwordx4 v23, s[24:27], s67 offen offset:3072  lds
s_add_u32 s60, s71, s65
s_add_u32 m0, s60, 0
s_mov_b32 s61, s68
buffer_load_dwordx4 v26, s[28:31], s61 offen lds
buffer_load_dwordx4 v27, s[28:31], s61 offen offset:1024 lds
s_add_u32 m0, s60, 8192
s_add_u32 s61, s61, s53
buffer_load_dwordx4 v26, s[28:31], s61 offen lds
buffer_load_dwordx4 v27, s[28:31], s61 offen offset:1024 lds
s_add_u32 m0, s60, 16384
s_add_u32 s61, s61, s53
buffer_load_dwordx4 v26, s[28:31], s61 offen lds
buffer_load_dwordx4 v27, s[28:31], s61 offen offset:1024 lds
s_add_u32 s49, s76, 1
s_and_b32 s49, s49, 3
s_add_u32 s49, s49, 4
s_mul_i32 s49, s49, 393216
buffer_load_dwordx4 v[40:43], v36, s[28:31], s49 offen
s_add_u32 s65, s65, 40960
s_cmp_eq_u32 s65, 122880
s_cselect_b32 s65, 0, s65
s_add_u32 s64, s64, 1
s_waitcnt vmcnt(11)
s_barrier
s_add_u32 s69, s47, 1
s_and_b32 s69, s69, 3
s_add_u32 s69, s69, 0
s_mul_i32 s67, s69, 128
s_mul_i32 s68, s69, s54
s_add_u32 m0, s70, s65
s_nop 0
buffer_load_dwordx4 v20, s[24:27], s67 offen offset:0  lds
buffer_load_dwordx4 v21, s[24:27], s67 offen offset:1024  lds
buffer_load_dwordx4 v22, s[24:27], s67 offen offset:2048  lds
buffer_load_dwordx4 v23, s[24:27], s67 offen offset:3072  lds
s_add_u32 s60, s71, s65
s_add_u32 m0, s60, 0
s_mov_b32 s61, s68
buffer_load_dwordx4 v26, s[28:31], s61 offen lds
buffer_load_dwordx4 v27, s[28:31], s61 offen offset:1024 lds
s_add_u32 m0, s60, 8192
s_add_u32 s61, s61, s53
buffer_load_dwordx4 v26, s[28:31], s61 offen lds
buffer_load_dwordx4 v27, s[28:31], s61 offen offset:1024 lds
s_add_u32 m0, s60, 16384
s_add_u32 s61, s61, s53
buffer_load_dwordx4 v26, s[28:31], s61 offen lds
buffer_load_dwordx4 v27, s[28:31], s61 offen offset:1024 lds
s_add_u32 s49, s76, 1
s_and_b32 s49, s49, 3
s_add_u32 s49, s49, 8
s_mul_i32 s49, s49, 393216
buffer_load_dwordx4 v[40:43], v36, s[28:31], s49 offen
s_add_u32 s65, s65, 40960
s_cmp_eq_u32 s65, 122880
s_cselect_b32 s65, 0, s65
s_add_u32 s64, s64, 1
s_waitcnt vmcnt(11)
s_barrier
s_add_u32 s69, s47, 1
s_and_b32 s69, s69, 3
s_add_u32 s69, s69, 4
s_mul_i32 s67, s69, 128
s_mul_i32 s68, s69, s54
s_add_u32 m0, s70, s65
s_nop 0
buffer_load_dwordx4 v20, s[24:27], s67 offen offset:0  lds
buffer_load_dwordx4 v21, s[24:27], s67 offen offset:1024  lds
buffer_load_dwordx4 v22, s[24:27], s67 offen offset:2048  lds
buffer_load_dwordx4 v23, s[24:27], s67 offen offset:3072  lds
s_add_u32 s60, s71, s65
s_add_u32 m0, s60, 0
s_mov_b32 s61, s68
buffer_load_dwordx4 v26, s[28:31], s61 offen lds
buffer_load_dwordx4 v27, s[28:31], s61 offen offset:1024 lds
s_add_u32 m0, s60, 8192
s_add_u32 s61, s61, s53
buffer_load_dwordx4 v26, s[28:31], s61 offen lds
buffer_load_dwordx4 v27, s[28:31], s61 offen offset:1024 lds
s_add_u32 m0, s60, 16384
s_add_u32 s61, s61, s53
buffer_load_dwordx4 v26, s[28:31], s61 offen lds
buffer_load_dwordx4 v27, s[28:31], s61 offen offset:1024 lds
s_add_u32 s49, s76, 1
s_and_b32 s49, s49, 3
s_add_u32 s49, s49, 12
s_mul_i32 s49, s49, 393216
buffer_load_dwordx4 v[40:43], v36, s[28:31], s49 offen
s_add_u32 s65, s65, 40960
s_cmp_eq_u32 s65, 122880
s_cselect_b32 s65, 0, s65
s_add_u32 s64, s64, 1
s_waitcnt vmcnt(11)
s_barrier
s_cmp_lg_u32 s88, 0
s_cbranch_scc1 else_4
s_add_u32 s48, s75, 3
s_and_b32 s48, s48, 15
s_mul_i32 s48, s48, s57
buffer_load_dwordx4 v[136:139], v28, s[36:39], s48 offen
buffer_load_dwordx4 v[140:143], v29, s[36:39], s48 offen offset:1024
s_add_u32 s48, s75, 4
s_and_b32 s48, s48, 15
s_mul_i32 s48, s48, s57
buffer_load_dwordx4 v[144:147], v28, s[36:39], s48 offen
buffer_load_dwordx4 v[148:151], v29, s[36:39], s48 offen offset:1024
s_mov_b32 s36, s12
s_and_b32 s37, s13, 0xffff
s_mov_b32 s38, 6291456
s_mov_b32 s39, 0x00020000
s_add_u32 m0, s71, 122880
s_add_u32 s48, s83, 0
buffer_load_dwordx4 v60, s[36:39], s48 offen lds
buffer_load_dwordx4 v61, s[36:39], s48 offen offset:1024 lds
s_add_u32 m0, s71, 131072
s_add_u32 s48, s83, 2048
buffer_load_dwordx4 v60, s[36:39], s48 offen lds
buffer_load_dwordx4 v61, s[36:39], s48 offen offset:1024 lds
s_add_u32 m0, s71, 139264
s_add_u32 s48, s83, 4096
buffer_load_dwordx4 v60, s[36:39], s48 offen lds
buffer_load_dwordx4 v61, s[36:39], s48 offen offset:1024 lds
s_add_u32 s48, s87, 0
buffer_load_dwordx4 v[108:111], v63, s[36:39], s48 offen
s_add_u32 s48, s87, 2048
buffer_load_dwordx4 v[108:111], v63, s[36:39], s48 offen
s_add_u32 s48, s87, 4096
buffer_load_dwordx4 v[108:111], v63, s[36:39], s48 offen
s_mov_b32 s36, s8
s_and_b32 s37, s9, 0xffff
s_mov_b32 s38, 2097152
s_mov_b32 s39, 0x00020000
buffer_store_dwordx4 v[56:59], v18, s[32:35], s86 offen offset:0 sc1
buffer_store_dwordx4 v[56:59], v18, s[32:35], s86 offen offset:1024 sc1
buffer_store_dwordx2 v[56:57], v39, s[32:35], s89 offen sc1
buffer_store_dwordx4 v[56:59], v55, s[32:35], 0 offen sc1
else_4:
s_add_u32 s69, s47, 1
s_and_b32 s69, s69, 3
s_add_u32 s69, s69, 8
s_mul_i32 s67, s69, 128
s_mul_i32 s68, s69, s54
s_add_u32 m0, s70, s65
s_nop 0
buffer_load_dwordx4 v20, s[24:27], s67 offen offset:0  lds
buffer_load_dwordx4 v21, s[24:27], s67 offen offset:1024  lds
buffer_load_dwordx4 v22, s[24:27], s67 offen offset:2048  lds
buffer_load_dwordx4 v23, s[24:27], s67 offen offset:3072  lds
s_add_u32 s60, s71, s65
s_add_u32 m0, s60, 0
s_mov_b32 s61, s68
buffer_load_dwordx4 v26, s[28:31], s61 offen lds
buffer_load_dwordx4 v27, s[28:31], s61 offen offset:1024 lds
s_add_u32 m0, s60, 8192
s_add_u32 s61, s61, s53
buffer_load_dwordx4 v26, s[28:31], s61 offen lds
buffer_load_dwordx4 v27, s[28:31], s61 offen offset:1024 lds
s_add_u32 m0, s60, 16384
s_add_u32 s61, s61, s53
buffer_load_dwordx4 v26, s[28:31], s61 offen lds
buffer_load_dwordx4 v27, s[28:31], s61 offen offset:1024 lds
s_add_u32 s49, s76, 2
s_and_b32 s49, s49, 3
s_add_u32 s49, s49, 0
s_mul_i32 s49, s49, 393216
buffer_load_dwordx4 v[40:43], v36, s[28:31], s49 offen
s_add_u32 s65, s65, 40960
s_cmp_eq_u32 s65, 122880
s_cselect_b32 s65, 0, s65
s_add_u32 s64, s64, 1
s_waitcnt vmcnt(11)
s_barrier
s_cmp_lg_u32 s88, 1
s_cbranch_scc1 else_6
s_add_u32 s48, s75, 3
s_and_b32 s48, s48, 15
s_mul_i32 s48, s48, s57
buffer_load_dwordx4 v[136:139], v28, s[36:39], s48 offen
buffer_load_dwordx4 v[140:143], v29, s[36:39], s48 offen offset:1024
s_add_u32 s48, s75, 4
s_and_b32 s48, s48, 15
s_mul_i32 s48, s48, s57
buffer_load_dwordx4 v[144:147], v28, s[36:39], s48 offen
buffer_load_dwordx4 v[148:151], v29, s[36:39], s48 offen offset:1024
s_mov_b32 s36, s12
s_and_b32 s37, s13, 0xffff
s_mov_b32 s38, 6291456
s_mov_b32 s39, 0x00020000
s_add_u32 m0, s71, 122880
s_add_u32 s48, s83, 0
buffer_load_dwordx4 v60, s[36:39], s48 offen lds
buffer_load_dwordx4 v61, s[36:39], s48 offen offset:1024 lds
s_add_u32 m0, s71, 131072
s_add_u32 s48, s83, 2048
buffer_load_dwordx4 v60, s[36:39], s48 offen lds
buffer_load_dwordx4 v61, s[36:39], s48 offen offset:1024 lds
s_add_u32 m0, s71, 139264
s_add_u32 s48, s83, 4096
buffer_load_dwordx4 v60, s[36:39], s48 offen lds
buffer_load_dwordx4 v61, s[36:39], s48 offen offset:1024 lds
s_add_u32 s48, s87, 0
buffer_load_dwordx4 v[108:111], v63, s[36:39], s48 offen
s_add_u32 s48, s87, 2048
buffer_load_dwordx4 v[108:111], v63, s[36:39], s48 offen
s_add_u32 s48, s87, 4096
buffer_load_dwordx4 v[108:111], v63, s[36:39], s48 offen
s_mov_b32 s36, s8
s_and_b32 s37, s9, 0xffff
s_mov_b32 s38, 2097152
s_mov_b32 s39, 0x00020000
buffer_store_dwordx4 v[56:59], v18, s[32:35], s86 offen offset:0 sc1
buffer_store_dwordx4 v[56:59], v18, s[32:35], s86 offen offset:1024 sc1
buffer_store_dwordx2 v[56:57], v39, s[32:35], s89 offen sc1
buffer_store_dwordx4 v[56:59], v55, s[32:35], 0 offen sc1
else_6:
s_add_u32 s69, s47, 1
s_and_b32 s69, s69, 3
s_add_u32 s69, s69, 12
s_mul_i32 s67, s69, 128
s_mul_i32 s68, s69, s54
s_add_u32 m0, s70, s65
s_nop 0
buffer_load_dwordx4 v20, s[24:27], s67 offen offset:0  lds
buffer_load_dwordx4 v21, s[24:27], s67 offen offset:1024  lds
buffer_load_dwordx4 v22, s[24:27], s67 offen offset:2048  lds
buffer_load_dwordx4 v23, s[24:27], s67 offen offset:3072  lds
s_add_u32 s60, s71, s65
s_add_u32 m0, s60, 0
s_mov_b32 s61, s68
buffer_load_dwordx4 v26, s[28:31], s61 offen lds
buffer_load_dwordx4 v27, s[28:31], s61 offen offset:1024 lds
s_add_u32 m0, s60, 8192
s_add_u32 s61, s61, s53
buffer_load_dwordx4 v26, s[28:31], s61 offen lds
buffer_load_dwordx4 v27, s[28:31], s61 offen offset:1024 lds
s_add_u32 m0, s60, 16384
s_add_u32 s61, s61, s53
buffer_load_dwordx4 v26, s[28:31], s61 offen lds
buffer_load_dwordx4 v27, s[28:31], s61 offen offset:1024 lds
s_add_u32 s49, s76, 2
s_and_b32 s49, s49, 3
s_add_u32 s49, s49, 4
s_mul_i32 s49, s49, 393216
buffer_load_dwordx4 v[40:43], v36, s[28:31], s49 offen
s_add_u32 s65, s65, 40960
s_cmp_eq_u32 s65, 122880
s_cselect_b32 s65, 0, s65
s_add_u32 s64, s64, 1
s_waitcnt vmcnt(11)
s_barrier
s_cmp_lg_u32 s88, 2
s_cbranch_scc1 else_8
s_add_u32 s48, s75, 3
s_and_b32 s48, s48, 15
s_mul_i32 s48, s48, s57
buffer_load_dwordx4 v[136:139], v28, s[36:39], s48 offen
buffer_load_dwordx4 v[140:143], v29, s[36:39], s48 offen offset:1024
s_add_u32 s48, s75, 4
s_and_b32 s48, s48, 15
s_mul_i32 s48, s48, s57
buffer_load_dwordx4 v[144:147], v28, s[36:39], s48 offen
buffer_load_dwordx4 v[148:151], v29, s[36:39], s48 offen offset:1024
s_mov_b32 s36, s12
s_and_b32 s37, s13, 0xffff
s_mov_b32 s38, 6291456
s_mov_b32 s39, 0x00020000
s_add_u32 m0, s71, 122880
s_add_u32 s48, s83, 0
buffer_load_dwordx4 v60, s[36:39], s48 offen lds
buffer_load_dwordx4 v61, s[36:39], s48 offen offset:1024 lds
s_add_u32 m0, s71, 131072
s_add_u32 s48, s83, 2048
buffer_load_dwordx4 v60, s[36:39], s48 offen lds
buffer_load_dwordx4 v61, s[36:39], s48 offen offset:1024 lds
s_add_u32 m0, s71, 139264
s_add_u32 s48, s83, 4096
buffer_load_dwordx4 v60, s[36:39], s48 offen lds
buffer_load_dwordx4 v61, s[36:39], s48 offen offset:1024 lds
s_add_u32 s48, s87, 0
buffer_load_dwordx4 v[108:111], v63, s[36:39], s48 offen
s_add_u32 s48, s87, 2048
buffer_load_dwordx4 v[108:111], v63, s[36:39], s48 offen
s_add_u32 s48, s87, 4096
buffer_load_dwordx4 v[108:111], v63, s[36:39], s48 offen
s_mov_b32 s36, s8
s_and_b32 s37, s9, 0xffff
s_mov_b32 s38, 2097152
s_mov_b32 s39, 0x00020000
buffer_store_dwordx4 v[56:59], v18, s[32:35], s86 offen offset:0 sc1
buffer_store_dwordx4 v[56:59], v18, s[32:35], s86 offen offset:1024 sc1
buffer_store_dwordx2 v[56:57], v39, s[32:35], s89 offen sc1
buffer_store_dwordx4 v[56:59], v55, s[32:35], 0 offen sc1
else_8:
s_add_u32 s69, s47, 2
s_and_b32 s69, s69, 3
s_add_u32 s69, s69, 0
s_mul_i32 s67, s69, 128
s_mul_i32 s68, s69, s54
s_add_u32 m0, s70, s65
s_nop 0
buffer_load_dwordx4 v20, s[24:27], s67 offen offset:0  lds
buffer_load_dwordx4 v21, s[24:27], s67 offen offset:1024  lds
buffer_load_dwordx4 v22, s[24:27], s67 offen offset:2048  lds
buffer_load_dwordx4 v23, s[24:27], s67 offen offset:3072  lds
s_add_u32 s60, s71, s65
s_add_u32 m0, s60, 0
s_mov_b32 s61, s68
buffer_load_dwordx4 v26, s[28:31], s61 offen lds
buffer_load_dwordx4 v27, s[28:31], s61 offen offset:1024 lds
s_add_u32 m0, s60, 8192
s_add_u32 s61, s61, s53
buffer_load_dwordx4 v26, s[28:31], s61 offen lds
buffer_load_dwordx4 v27, s[28:31], s61 offen offset:1024 lds
s_add_u32 m0, s60, 16384
s_add_u32 s61, s61, s53
buffer_load_dwordx4 v26, s[28:31], s61 offen lds
buffer_load_dwordx4 v27, s[28:31], s61 offen offset:1024 lds
s_add_u32 s49, s76, 2
s_and_b32 s49, s49, 3
s_add_u32 s49, s49, 8
s_mul_i32 s49, s49, 393216
buffer_load_dwordx4 v[40:43], v36, s[28:31], s49 offen
s_add_u32 s65, s65, 40960
s_cmp_eq_u32 s65, 122880
s_cselect_b32 s65, 0, s65
s_add_u32 s64, s64, 1
s_waitcnt vmcnt(11)
s_barrier
s_cmp_lg_u32 s88, 3
s_cbranch_scc1 else_10
s_add_u32 s48, s75, 3
s_and_b32 s48, s48, 15
s_mul_i32 s48, s48, s57
buffer_load_dwordx4 v[136:139], v28, s[36:39], s48 offen
buffer_load_dwordx4 v[140:143], v29, s[36:39], s48 offen offset:1024
s_add_u32 s48, s75, 4
s_and_b32 s48, s48, 15
s_mul_i32 s48, s48, s57
buffer_load_dwordx4 v[144:147], v28, s[36:39], s48 offen
buffer_load_dwordx4 v[148:151], v29, s[36:39], s48 offen offset:1024
s_mov_b32 s36, s12
s_and_b32 s37, s13, 0xffff
s_mov_b32 s38, 6291456
s_mov_b32 s39, 0x00020000
s_add_u32 m0, s71, 122880
s_add_u32 s48, s83, 0
buffer_load_dwordx4 v60, s[36:39], s48 offen lds
buffer_load_dwordx4 v61, s[36:39], s48 offen offset:1024 lds
s_add_u32 m0, s71, 131072
s_add_u32 s48, s83, 2048
buffer_load_dwordx4 v60, s[36:39], s48 offen lds
buffer_load_dwordx4 v61, s[36:39], s48 offen offset:1024 lds
s_add_u32 m0, s71, 139264
s_add_u32 s48, s83, 4096
buffer_load_dwordx4 v60, s[36:39], s48 offen lds
buffer_load_dwordx4 v61, s[36:39], s48 offen offset:1024 lds
s_add_u32 s48, s87, 0
buffer_load_dwordx4 v[108:111], v63, s[36:39], s48 offen
s_add_u32 s48, s87, 2048
buffer_load_dwordx4 v[108:111], v63, s[36:39], s48 offen
s_add_u32 s48, s87, 4096
buffer_load_dwordx4 v[108:111], v63, s[36:39], s48 offen
s_mov_b32 s36, s8
s_and_b32 s37, s9, 0xffff
s_mov_b32 s38, 2097152
s_mov_b32 s39, 0x00020000
buffer_store_dwordx4 v[56:59], v18, s[32:35], s86 offen offset:0 sc1
buffer_store_dwordx4 v[56:59], v18, s[32:35], s86 offen offset:1024 sc1
buffer_store_dwordx2 v[56:57], v39, s[32:35], s89 offen sc1
buffer_store_dwordx4 v[56:59], v55, s[32:35], 0 offen sc1
else_10:
s_add_u32 s69, s47, 2
s_and_b32 s69, s69, 3
s_add_u32 s69, s69, 4
s_mul_i32 s67, s69, 128
s_mul_i32 s68, s69, s54
s_add_u32 m0, s70, s65
s_nop 0
buffer_load_dwordx4 v20, s[24:27], s67 offen offset:0  lds
buffer_load_dwordx4 v21, s[24:27], s67 offen offset:1024  lds
buffer_load_dwordx4 v22, s[24:27], s67 offen offset:2048  lds
buffer_load_dwordx4 v23, s[24:27], s67 offen offset:3072  lds
s_add_u32 s60, s71, s65
s_add_u32 m0, s60, 0
s_mov_b32 s61, s68
buffer_load_dwordx4 v26, s[28:31], s61 offen lds
buffer_load_dwordx4 v27, s[28:31], s61 offen offset:1024 lds
s_add_u32 m0, s60, 8192
s_add_u32 s61, s61, s53
buffer_load_dwordx4 v26, s[28:31], s61 offen lds
buffer_load_dwordx4 v27, s[28:31], s61 offen offset:1024 lds
s_add_u32 m0, s60, 16384
s_add_u32 s61, s61, s53
buffer_load_dwordx4 v26, s[28:31], s61 offen lds
buffer_load_dwordx4 v27, s[28:31], s61 offen offset:1024 lds
s_add_u32 s49, s76, 2
s_and_b32 s49, s49, 3
s_add_u32 s49, s49, 12
s_mul_i32 s49, s49, 393216
buffer_load_dwordx4 v[40:43], v36, s[28:31], s49 offen
s_add_u32 s65, s65, 40960
s_cmp_eq_u32 s65, 122880
s_cselect_b32 s65, 0, s65
s_add_u32 s64, s64, 1
s_waitcnt vmcnt(11)
s_barrier
s_cmp_lg_u32 s88, 4
s_cbranch_scc1 else_12
s_add_u32 s48, s75, 3
s_and_b32 s48, s48, 15
s_mul_i32 s48, s48, s57
buffer_load_dwordx4 v[136:139], v28, s[36:39], s48 offen
buffer_load_dwordx4 v[140:143], v29, s[36:39], s48 offen offset:1024
s_add_u32 s48, s75, 4
s_and_b32 s48, s48, 15
s_mul_i32 s48, s48, s57
buffer_load_dwordx4 v[144:147], v28, s[36:39], s48 offen
buffer_load_dwordx4 v[148:151], v29, s[36:39], s48 offen offset:1024
s_mov_b32 s36, s12
s_and_b32 s37, s13, 0xffff
s_mov_b32 s38, 6291456
s_mov_b32 s39, 0x00020000
s_add_u32 m0, s71, 122880
s_add_u32 s48, s83, 0
buffer_load_dwordx4 v60, s[36:39], s48 offen lds
buffer_load_dwordx4 v61, s[36:39], s48 offen offset:1024 lds
s_add_u32 m0, s71, 131072
s_add_u32 s48, s83, 2048
buffer_load_dwordx4 v60, s[36:39], s48 offen lds
buffer_load_dwordx4 v61, s[36:39], s48 offen offset:1024 lds
s_add_u32 m0, s71, 139264
s_add_u32 s48, s83, 4096
buffer_load_dwordx4 v60, s[36:39], s48 offen lds
buffer_load_dwordx4 v61, s[36:39], s48 offen offset:1024 lds
s_add_u32 s48, s87, 0
buffer_load_dwordx4 v[108:111], v63, s[36:39], s48 offen
s_add_u32 s48, s87, 2048
buffer_load_dwordx4 v[108:111], v63, s[36:39], s48 offen
s_add_u32 s48, s87, 4096
buffer_load_dwordx4 v[108:111], v63, s[36:39], s48 offen
s_mov_b32 s36, s8
s_and_b32 s37, s9, 0xffff
s_mov_b32 s38, 2097152
s_mov_b32 s39, 0x00020000
buffer_store_dwordx4 v[56:59], v18, s[32:35], s86 offen offset:0 sc1
buffer_store_dwordx4 v[56:59], v18, s[32:35], s86 offen offset:1024 sc1
buffer_store_dwordx2 v[56:57], v39, s[32:35], s89 offen sc1
buffer_store_dwordx4 v[56:59], v55, s[32:35], 0 offen sc1
else_12:
s_add_u32 s69, s47, 2
s_and_b32 s69, s69, 3
s_add_u32 s69, s69, 8
s_mul_i32 s67, s69, 128
s_mul_i32 s68, s69, s54
s_add_u32 m0, s70, s65
s_nop 0
buffer_load_dwordx4 v20, s[24:27], s67 offen offset:0  lds
buffer_load_dwordx4 v21, s[24:27], s67 offen offset:1024  lds
buffer_load_dwordx4 v22, s[24:27], s67 offen offset:2048  lds
buffer_load_dwordx4 v23, s[24:27], s67 offen offset:3072  lds
s_add_u32 s60, s71, s65
s_add_u32 m0, s60, 0
s_mov_b32 s61, s68
buffer_load_dwordx4 v26, s[28:31], s61 offen lds
buffer_load_dwordx4 v27, s[28:31], s61 offen offset:1024 lds
s_add_u32 m0, s60, 8192
s_add_u32 s61, s61, s53
buffer_load_dwordx4 v26, s[28:31], s61 offen lds
buffer_load_dwordx4 v27, s[28:31], s61 offen offset:1024 lds
s_add_u32 m0, s60, 16384
s_add_u32 s61, s61, s53
buffer_load_dwordx4 v26, s[28:31], s61 offen lds
buffer_load_dwordx4 v27, s[28:31], s61 offen offset:1024 lds
s_add_u32 s49, s76, 3
s_and_b32 s49, s49, 3
s_add_u32 s49, s49, 0
s_mul_i32 s49, s49, 393216
buffer_load_dwordx4 v[40:43], v36, s[28:31], s49 offen
s_add_u32 s65, s65, 40960
s_cmp_eq_u32 s65, 122880
s_cselect_b32 s65, 0, s65
s_add_u32 s64, s64, 1
s_waitcnt vmcnt(11)
s_barrier
s_cmp_lg_u32 s88, 5
s_cbranch_scc1 else_14
s_add_u32 s48, s75, 3
s_and_b32 s48, s48, 15
s_mul_i32 s48, s48, s57
buffer_load_dwordx4 v[136:139], v28, s[36:39], s48 offen
buffer_load_dwordx4 v[140:143], v29, s[36:39], s48 offen offset:1024
s_add_u32 s48, s75, 4
s_and_b32 s48, s48, 15
s_mul_i32 s48, s48, s57
buffer_load_dwordx4 v[144:147], v28, s[36:39], s48 offen
buffer_load_dwordx4 v[148:151], v29, s[36:39], s48 offen offset:1024
s_mov_b32 s36, s12
s_and_b32 s37, s13, 0xffff
s_mov_b32 s38, 6291456
s_mov_b32 s39, 0x00020000
s_add_u32 m0, s71, 122880
s_add_u32 s48, s83, 0
buffer_load_dwordx4 v60, s[36:39], s48 offen lds
buffer_load_dwordx4 v61, s[36:39], s48 offen offset:1024 lds
s_add_u32 m0, s71, 131072
s_add_u32 s48, s83, 2048
buffer_load_dwordx4 v60, s[36:39], s48 offen lds
buffer_load_dwordx4 v61, s[36:39], s48 offen offset:1024 lds
s_add_u32 m0, s71, 139264
s_add_u32 s48, s83, 4096
buffer_load_dwordx4 v60, s[36:39], s48 offen lds
buffer_load_dwordx4 v61, s[36:39], s48 offen offset:1024 lds
s_add_u32 s48, s87, 0
buffer_load_dwordx4 v[108:111], v63, s[36:39], s48 offen
s_add_u32 s48, s87, 2048
buffer_load_dwordx4 v[108:111], v63, s[36:39], s48 offen
s_add_u32 s48, s87, 4096
buffer_load_dwordx4 v[108:111], v63, s[36:39], s48 offen
s_mov_b32 s36, s8
s_and_b32 s37, s9, 0xffff
s_mov_b32 s38, 2097152
s_mov_b32 s39, 0x00020000
buffer_store_dwordx4 v[56:59], v18, s[32:35], s86 offen offset:0 sc1
buffer_store_dwordx4 v[56:59], v18, s[32:35], s86 offen offset:1024 sc1
buffer_store_dwordx2 v[56:57], v39, s[32:35], s89 offen sc1
buffer_store_dwordx4 v[56:59], v55, s[32:35], 0 offen sc1
else_14:
s_add_u32 s69, s47, 2
s_and_b32 s69, s69, 3
s_add_u32 s69, s69, 12
s_mul_i32 s67, s69, 128
s_mul_i32 s68, s69, s54
s_add_u32 m0, s70, s65
s_nop 0
buffer_load_dwordx4 v20, s[24:27], s67 offen offset:0  lds
buffer_load_dwordx4 v21, s[24:27], s67 offen offset:1024  lds
buffer_load_dwordx4 v22, s[24:27], s67 offen offset:2048  lds
buffer_load_dwordx4 v23, s[24:27], s67 offen offset:3072  lds
s_add_u32 s60, s71, s65
s_add_u32 m0, s60, 0
s_mov_b32 s61, s68
buffer_load_dwordx4 v26, s[28:31], s61 offen lds
buffer_load_dwordx4 v27, s[28:31], s61 offen offset:1024 lds
s_add_u32 m0, s60, 8192
s_add_u32 s61, s61, s53
buffer_load_dwordx4 v26, s[28:31], s61 offen lds
buffer_load_dwordx4 v27, s[28:31], s61 offen offset:1024 lds
s_add_u32 m0, s60, 16384
s_add_u32 s61, s61, s53
buffer_load_dwordx4 v26, s[28:31], s61 offen lds
buffer_load_dwordx4 v27, s[28:31], s61 offen offset:1024 lds
s_add_u32 s49, s76, 3
s_and_b32 s49, s49, 3
s_add_u32 s49, s49, 4
s_mul_i32 s49, s49, 393216
buffer_load_dwordx4 v[40:43], v36, s[28:31], s49 offen
s_add_u32 s65, s65, 40960
s_cmp_eq_u32 s65, 122880
s_cselect_b32 s65, 0, s65
s_add_u32 s64, s64, 1
s_waitcnt vmcnt(11)
s_barrier
s_cmp_lg_u32 s88, 6
s_cbranch_scc1 else_16
s_add_u32 s48, s75, 3
s_and_b32 s48, s48, 15
s_mul_i32 s48, s48, s57
buffer_load_dwordx4 v[136:139], v28, s[36:39], s48 offen
buffer_load_dwordx4 v[140:143], v29, s[36:39], s48 offen offset:1024
s_add_u32 s48, s75, 4
s_and_b32 s48, s48, 15
s_mul_i32 s48, s48, s57
buffer_load_dwordx4 v[144:147], v28, s[36:39], s48 offen
buffer_load_dwordx4 v[148:151], v29, s[36:39], s48 offen offset:1024
s_mov_b32 s36, s12
s_and_b32 s37, s13, 0xffff
s_mov_b32 s38, 6291456
s_mov_b32 s39, 0x00020000
s_add_u32 m0, s71, 122880
s_add_u32 s48, s83, 0
buffer_load_dwordx4 v60, s[36:39], s48 offen lds
buffer_load_dwordx4 v61, s[36:39], s48 offen offset:1024 lds
s_add_u32 m0, s71, 131072
s_add_u32 s48, s83, 2048
buffer_load_dwordx4 v60, s[36:39], s48 offen lds
buffer_load_dwordx4 v61, s[36:39], s48 offen offset:1024 lds
s_add_u32 m0, s71, 139264
s_add_u32 s48, s83, 4096
buffer_load_dwordx4 v60, s[36:39], s48 offen lds
buffer_load_dwordx4 v61, s[36:39], s48 offen offset:1024 lds
s_add_u32 s48, s87, 0
buffer_load_dwordx4 v[108:111], v63, s[36:39], s48 offen
s_add_u32 s48, s87, 2048
buffer_load_dwordx4 v[108:111], v63, s[36:39], s48 offen
s_add_u32 s48, s87, 4096
buffer_load_dwordx4 v[108:111], v63, s[36:39], s48 offen
s_mov_b32 s36, s8
s_and_b32 s37, s9, 0xffff
s_mov_b32 s38, 2097152
s_mov_b32 s39, 0x00020000
buffer_store_dwordx4 v[56:59], v18, s[32:35], s86 offen offset:0 sc1
buffer_store_dwordx4 v[56:59], v18, s[32:35], s86 offen offset:1024 sc1
buffer_store_dwordx2 v[56:57], v39, s[32:35], s89 offen sc1
buffer_store_dwordx4 v[56:59], v55, s[32:35], 0 offen sc1
else_16:
s_add_u32 s69, s47, 3
s_and_b32 s69, s69, 3
s_add_u32 s69, s69, 0
s_mul_i32 s67, s69, 128
s_mul_i32 s68, s69, s54
s_add_u32 m0, s70, s65
s_nop 0
buffer_load_dwordx4 v20, s[24:27], s67 offen offset:0  lds
buffer_load_dwordx4 v21, s[24:27], s67 offen offset:1024  lds
buffer_load_dwordx4 v22, s[24:27], s67 offen offset:2048  lds
buffer_load_dwordx4 v23, s[24:27], s67 offen offset:3072  lds
s_add_u32 s60, s71, s65
s_add_u32 m0, s60, 0
s_mov_b32 s61, s68
buffer_load_dwordx4 v26, s[28:31], s61 offen lds
buffer_load_dwordx4 v27, s[28:31], s61 offen offset:1024 lds
s_add_u32 m0, s60, 8192
s_add_u32 s61, s61, s53
buffer_load_dwordx4 v26, s[28:31], s61 offen lds
buffer_load_dwordx4 v27, s[28:31], s61 offen offset:1024 lds
s_add_u32 m0, s60, 16384
s_add_u32 s61, s61, s53
buffer_load_dwordx4 v26, s[28:31], s61 offen lds
buffer_load_dwordx4 v27, s[28:31], s61 offen offset:1024 lds
s_add_u32 s49, s76, 3
s_and_b32 s49, s49, 3
s_add_u32 s49, s49, 8
s_mul_i32 s49, s49, 393216
buffer_load_dwordx4 v[40:43], v36, s[28:31], s49 offen
s_add_u32 s65, s65, 40960
s_cmp_eq_u32 s65, 122880
s_cselect_b32 s65, 0, s65
s_add_u32 s64, s64, 1
s_waitcnt vmcnt(11)
s_barrier
s_cmp_lg_u32 s88, 7
s_cbranch_scc1 else_18
s_add_u32 s48, s75, 3
s_and_b32 s48, s48, 15
s_mul_i32 s48, s48, s57
buffer_load_dwordx4 v[136:139], v28, s[36:39], s48 offen
buffer_load_dwordx4 v[140:143], v29, s[36:39], s48 offen offset:1024
s_add_u32 s48, s75, 4
s_and_b32 s48, s48, 15
s_mul_i32 s48, s48, s57
buffer_load_dwordx4 v[144:147], v28, s[36:39], s48 offen
buffer_load_dwordx4 v[148:151], v29, s[36:39], s48 offen offset:1024
s_mov_b32 s36, s12
s_and_b32 s37, s13, 0xffff
s_mov_b32 s38, 6291456
s_mov_b32 s39, 0x00020000
s_add_u32 m0, s71, 122880
s_add_u32 s48, s83, 0
buffer_load_dwordx4 v60, s[36:39], s48 offen lds
buffer_load_dwordx4 v61, s[36:39], s48 offen offset:1024 lds
s_add_u32 m0, s71, 131072
s_add_u32 s48, s83, 2048
buffer_load_dwordx4 v60, s[36:39], s48 offen lds
buffer_load_dwordx4 v61, s[36:39], s48 offen offset:1024 lds
s_add_u32 m0, s71, 139264
s_add_u32 s48, s83, 4096
buffer_load_dwordx4 v60, s[36:39], s48 offen lds
buffer_load_dwordx4 v61, s[36:39], s48 offen offset:1024 lds
s_add_u32 s48, s87, 0
buffer_load_dwordx4 v[108:111], v63, s[36:39], s48 offen
s_add_u32 s48, s87, 2048
buffer_load_dwordx4 v[108:111], v63, s[36:39], s48 offen
s_add_u32 s48, s87, 4096
buffer_load_dwordx4 v[108:111], v63, s[36:39], s48 offen
s_mov_b32 s36, s8
s_and_b32 s37, s9, 0xffff
s_mov_b32 s38, 2097152
s_mov_b32 s39, 0x00020000
buffer_store_dwordx4 v[56:59], v18, s[32:35], s86 offen offset:0 sc1
buffer_store_dwordx4 v[56:59], v18, s[32:35], s86 offen offset:1024 sc1
buffer_store_dwordx2 v[56:57], v39, s[32:35], s89 offen sc1
buffer_store_dwordx4 v[56:59], v55, s[32:35], 0 offen sc1
else_18:
s_add_u32 s69, s47, 3
s_and_b32 s69, s69, 3
s_add_u32 s69, s69, 4
s_mul_i32 s67, s69, 128
s_mul_i32 s68, s69, s54
s_add_u32 m0, s70, s65
s_nop 0
buffer_load_dwordx4 v20, s[24:27], s67 offen offset:0  lds
buffer_load_dwordx4 v21, s[24:27], s67 offen offset:1024  lds
buffer_load_dwordx4 v22, s[24:27], s67 offen offset:2048  lds
buffer_load_dwordx4 v23, s[24:27], s67 offen offset:3072  lds
s_add_u32 s60, s71, s65
s_add_u32 m0, s60, 0
s_mov_b32 s61, s68
buffer_load_dwordx4 v26, s[28:31], s61 offen lds
buffer_load_dwordx4 v27, s[28:31], s61 offen offset:1024 lds
s_add_u32 m0, s60, 8192
s_add_u32 s61, s61, s53
buffer_load_dwordx4 v26, s[28:31], s61 offen lds
buffer_load_dwordx4 v27, s[28:31], s61 offen offset:1024 lds
s_add_u32 m0, s60, 16384
s_add_u32 s61, s61, s53
buffer_load_dwordx4 v26, s[28:31], s61 offen lds
buffer_load_dwordx4 v27, s[28:31], s61 offen offset:1024 lds
s_add_u32 s49, s76, 3
s_and_b32 s49, s49, 3
s_add_u32 s49, s49, 12
s_mul_i32 s49, s49, 393216
buffer_load_dwordx4 v[40:43], v36, s[28:31], s49 offen
s_add_u32 s65, s65, 40960
s_cmp_eq_u32 s65, 122880
s_cselect_b32 s65, 0, s65
s_add_u32 s64, s64, 1
s_waitcnt vmcnt(11)
s_barrier
global_load_dwordx2 v[34:35], v32, s[20:21] sc1
s_add_u32 s69, s47, 3
s_and_b32 s69, s69, 3
s_add_u32 s69, s69, 8
s_mul_i32 s67, s69, 128
s_mul_i32 s68, s69, s54
s_add_u32 m0, s70, s65
s_nop 0
buffer_load_dwordx4 v20, s[24:27], s67 offen offset:0  lds
buffer_load_dwordx4 v21, s[24:27], s67 offen offset:1024  lds
buffer_load_dwordx4 v22, s[24:27], s67 offen offset:2048  lds
buffer_load_dwordx4 v23, s[24:27], s67 offen offset:3072  lds
s_add_u32 s60, s71, s65
s_add_u32 m0, s60, 0
s_mov_b32 s61, s68
buffer_load_dwordx4 v26, s[28:31], s61 offen lds
buffer_load_dwordx4 v27, s[28:31], s61 offen offset:1024 lds
s_add_u32 m0, s60, 8192
s_add_u32 s61, s61, s53
buffer_load_dwordx4 v26, s[28:31], s61 offen lds
buffer_load_dwordx4 v27, s[28:31], s61 offen offset:1024 lds
s_add_u32 m0, s60, 16384
s_add_u32 s61, s61, s53
buffer_load_dwordx4 v26, s[28:31], s61 offen lds
buffer_load_dwordx4 v27, s[28:31], s61 offen offset:1024 lds
s_add_u32 s65, s65, 40960
s_cmp_eq_u32 s65, 122880
s_cselect_b32 s65, 0, s65
s_add_u32 s64, s64, 1
s_waitcnt vmcnt(10)
s_barrier
s_mov_b32 s63, 0
ipoll_20:
v_sad_u8 v4, v34, 0, 0
v_sad_u8 v4, v35, 0, v4
v_cmp_gt_u32 vcc, 32, v4
s_cbranch_vccz ipolled_21
global_load_dwordx2 v[34:35], v32, s[20:21] sc1
s_add_u32 s63, s63, 1
s_cmp_lt_u32 s63, 0x80000
s_waitcnt vmcnt(0)
s_cbranch_scc1 ipoll_20
ipolled_21:
s_add_u32 s69, s47, 3
s_and_b32 s69, s69, 3
s_add_u32 s69, s69, 12
s_mul_i32 s67, s69, 128
s_mul_i32 s68, s69, s54
s_add_u32 m0, s70, 0
s_nop 0
buffer_load_dwordx4 v20, s[24:27], s67 offen offset:0  lds
buffer_load_dwordx4 v21, s[24:27], s67 offen offset:1024  lds
buffer_load_dwordx4 v22, s[24:27], s67 offen offset:2048  lds
buffer_load_dwordx4 v23, s[24:27], s67 offen offset:3072  lds
s_add_u32 s60, s71, 0
s_add_u32 m0, s60, 0
s_mov_b32 s61, s68
buffer_load_dwordx4 v26, s[28:31], s61 offen lds
buffer_load_dwordx4 v27, s[28:31], s61 offen offset:1024 lds
s_add_u32 m0, s60, 8192
s_add_u32 s61, s61, s53
buffer_load_dwordx4 v26, s[28:31], s61 offen lds
buffer_load_dwordx4 v27, s[28:31], s61 offen offset:1024 lds
s_add_u32 m0, s60, 16384
s_add_u32 s61, s61, s53
buffer_load_dwordx4 v26, s[28:31], s61 offen lds
buffer_load_dwordx4 v27, s[28:31], s61 offen offset:1024 lds
s_waitcnt vmcnt(10)
s_barrier
s_setprio 0
buffer_load_dwordx4 v[240:243], v15, s[36:39], 0 offen offset:0
buffer_load_dwordx4 v[240:243], v15, s[36:39], 0 offen offset:1024
buffer_load_dwordx4 v[176:179], v37, s[32:35], 0 offen offset:0 sc1
buffer_load_dwordx4 v[180:183], v37, s[32:35], 0 offen offset:1024 sc1
buffer_load_dwordx4 v[184:187], v37, s[32:35], 0 offen offset:2048 sc1
buffer_load_dwordx4 v[188:191], v37, s[32:35], 0 offen offset:3072 sc1
global_load_dword v48, v54, s[98:99]
buffer_load_dwordx4 v[160:163], v38, s[32:35], 0 offen offset:0 sc1
buffer_load_dwordx4 v[164:167], v38, s[32:35], 0 offen offset:1024 sc1
buffer_load_dwordx4 v[168:171], v38, s[32:35], 0 offen offset:2048 sc1
buffer_load_dwordx4 v[172:175], v38, s[32:35], 0 offen offset:3072 sc1
s_add_u32 s48, s75, 15
s_and_b32 s48, s48, 15
s_mul_i32 s48, s48, s57
s_add_u32 m0, s71, 106496
s_nop 0
buffer_load_dwordx4 v28, s[36:39], s48 offen lds
buffer_load_dwordx4 v29, s[36:39], s48 offen offset:1024 lds
s_waitcnt vmcnt(13)
s_barrier
s_add_u32 s48, s75, 5
s_and_b32 s48, s48, 15
s_mul_i32 s48, s48, s57
s_add_u32 m0, s71, 24576
s_nop 0
buffer_load_dwordx4 v28, s[36:39], s48 offen lds
buffer_load_dwordx4 v29, s[36:39], s48 offen offset:1024 lds
s_waitcnt vmcnt(4)
s_add_u32 s48, s75, 6
s_and_b32 s48, s48, 15
s_mul_i32 s48, s48, s57
s_add_u32 m0, s71, 32768
s_nop 0
buffer_load_dwordx4 v28, s[36:39], s48 offen lds
v_add_f32 v176, v176, v184
v_add_f32 v160, v160, v168
v_add_f32 v177, v177, v185
v_add_f32 v161, v161, v169
v_add_f32 v178, v178, v186
v_add_f32 v162, v162, v170
v_add_f32 v179, v179, v187
v_add_f32 v163, v163, v171
v_add_f32 v180, v180, v188
v_add_f32 v164, v164, v172
buffer_load_dwordx4 v29, s[36:39], s48 offen offset:1024 lds
v_add_f32 v181, v181, v189
v_add_f32 v165, v165, v173
v_add_f32 v182, v182, v190
v_add_f32 v166, v166, v174
v_add_f32 v183, v183, v191
v_add_f32 v167, v167, v175
v_add_f32 v176, v176, v180
v_add_f32 v160, v160, v164
v_add_f32 v177, v177, v181
v_add_f32 v161, v161, v165
s_add_u32 s48, s75, 7
s_and_b32 s48, s48, 15
s_mul_i32 s48, s48, s57
s_add_u32 m0, s71, 40960
s_nop 0
buffer_load_dwordx4 v28, s[36:39], s48 offen lds
v_add_f32 v178, v178, v182
v_add_f32 v162, v162, v166
v_add_f32 v179, v179, v183
v_add_f32 v163, v163, v167
s_nop 1
s_nop 1
v_permlane32_swap_b32 v176, v177
v_permlane32_swap_b32 v160, v161
v_permlane32_swap_b32 v178, v179
buffer_load_dwordx4 v29, s[36:39], s48 offen offset:1024 lds
v_permlane32_swap_b32 v162, v163
v_add_f32 v176, v176, v177
v_add_f32 v160, v160, v161
v_add_f32 v178, v178, v179
v_add_f32 v162, v162, v163
s_nop 1
s_nop 1
v_permlane16_swap_b32 v176, v178
v_permlane16_swap_b32 v160, v162
s_nop 0
s_add_u32 s48, s75, 8
s_and_b32 s48, s48, 15
s_mul_i32 s48, s48, s57
s_add_u32 m0, s71, 49152
s_nop 0
buffer_load_dwordx4 v28, s[36:39], s48 offen lds
s_nop 0
v_add_f32 v176, v176, v178
v_add_f32 v160, v160, v162
v_cmp_u_f32 vcc, v176, v176
s_cbranch_vccnz again_22
summed_23:
v_cmp_u_f32 vcc, v160, v160
s_cbranch_vccnz again_25
summed_26:
v_mul_f32 v44, 0x3a800000, v176
ds_write_b32 v53, v160
v_mov_b32 v45, v44
s_nop 1
v_permlane16_swap_b32 v44, v45
buffer_load_dwordx4 v29, s[36:39], s48 offen offset:1024 lds
s_nop 0
v_fma_f32 v45, -v44, v44, v45
v_max_f32 v45, 0, v45
v_add_f32 v45, 0x3727c5ac, v45
v_rsq_f32 v46, v45
v_sub_f32 v47, 0, v44
ds_write_b32 v50, v47 offset:512
ds_write_b64 v49, v[46:47]
ds_write_b32 v50, v46
s_cmp_lg_u32 s43, 2
s_cbranch_scc1 else_28
s_and_b32 s50, s2, 7
v_readlane_b32 s58, v34, s50
v_readlane_b32 s59, v35, s50
s_lshl_b64 s[48:49], s[94:95], 5
v_mov_b32 v4, 134656
s_nop 1
s_cmp_eq_u64 s[48:49], s[58:59]
s_cselect_b32 s48, 1, 0
v_mov_b32 v5, s48
ds_write_b32 v4, v5
else_28:
s_setprio 0
s_waitcnt lgkmcnt(0)
s_waitcnt vmcnt(63)
s_barrier
s_waitcnt vmcnt(5)
s_add_u32 s48, s75, 9
s_and_b32 s48, s48, 15
s_mul_i32 s48, s48, s57
s_add_u32 m0, s71, 57344
s_nop 0
buffer_load_dwordx4 v28, s[36:39], s48 offen lds
ds_write_b128 v51, v[136:139] offset:24576
buffer_load_dwordx4 v29, s[36:39], s48 offen offset:1024 lds
s_waitcnt vmcnt(5)
s_add_u32 s48, s75, 10
s_and_b32 s48, s48, 15
s_mul_i32 s48, s48, s57
s_add_u32 m0, s71, 65536
s_nop 0
buffer_load_dwordx4 v28, s[36:39], s48 offen lds
buffer_load_dwordx4 v29, s[36:39], s48 offen offset:1024 lds
s_waitcnt vmcnt(5)
s_add_u32 s48, s75, 11
s_and_b32 s48, s48, 15
s_mul_i32 s48, s48, s57
s_add_u32 m0, s71, 73728
s_nop 0
buffer_load_dwordx4 v28, s[36:39], s48 offen lds
ds_write_b128 v51, v[140:143] offset:25600
buffer_load_dwordx4 v29, s[36:39], s48 offen offset:1024 lds
s_waitcnt vmcnt(5)
s_add_u32 s48, s75, 12
s_and_b32 s48, s48, 15
s_mul_i32 s48, s48, s57
s_add_u32 m0, s71, 81920
s_nop 0
buffer_load_dwordx4 v28, s[36:39], s48 offen lds
buffer_load_dwordx4 v29, s[36:39], s48 offen offset:1024 lds
s_waitcnt vmcnt(5)
s_add_u32 s48, s75, 13
s_and_b32 s48, s48, 15
s_mul_i32 s48, s48, s57
s_add_u32 m0, s71, 90112
s_nop 0
buffer_load_dwordx4 v28, s[36:39], s48 offen lds
buffer_load_dwordx4 v29, s[36:39], s48 offen offset:1024 lds
ds_write_b128 v51, v[144:147] offset:32768
s_waitcnt vmcnt(5)
s_add_u32 s48, s75, 14
s_and_b32 s48, s48, 15
s_mul_i32 s48, s48, s57
s_add_u32 m0, s71, 98304
s_nop 0
buffer_load_dwordx4 v28, s[36:39], s48 offen lds
buffer_load_dwordx4 v29, s[36:39], s48 offen offset:1024 lds
s_waitcnt vmcnt(5)
s_add_u32 s48, s75, 0
s_and_b32 s48, s48, 15
s_mul_i32 s48, s48, s57
s_add_u32 m0, s71, 4294950912
s_nop 0
buffer_load_dwordx4 v28, s[36:39], s48 offen lds
buffer_load_dwordx4 v29, s[36:39], s48 offen offset:1024 lds
ds_write_b128 v51, v[148:151] offset:33792
s_waitcnt vmcnt(5)
s_add_u32 s48, s75, 1
s_and_b32 s48, s48, 15
s_mul_i32 s48, s48, s57
s_add_u32 m0, s71, 4294959104
s_nop 0
buffer_load_dwordx4 v28, s[36:39], s48 offen lds
buffer_load_dwordx4 v29, s[36:39], s48 offen offset:1024 lds
s_waitcnt vmcnt(5)
s_add_u32 s48, s75, 2
s_and_b32 s48, s48, 15
s_mul_i32 s48, s48, s57
s_add_u32 m0, s71, 0
s_nop 0
buffer_load_dwordx4 v28, s[36:39], s48 offen lds
buffer_load_dwordx4 v29, s[36:39], s48 offen offset:1024 lds
s_mov_b32 s28, s12
s_and_b32 s29, s13, 0xffff
s_mov_b32 s30, 6291456
s_mov_b32 s31, 0x00020000
v_mov_b32 v26, v60
v_mov_b32 v27, v61
v_mov_b32 v28, v24
v_mov_b32 v29, v25
s_cmp_ge_i32 s55, 0
s_cselect_b32 s53, 128, s53
s_cselect_b32 s54, 24576, s54
s_cmp_ge_i32 s56, 0
s_cselect_b32 s57, 8192, s57
s_and_b32 s48, s2, 7
s_add_u32 s47, s42, s48
s_and_b32 s47, s47, 7
s_mul_i32 s47, s47, 2
s_and_b32 s50, s42, 8
s_or_b32 s50, s50, 3
s_and_b32 s48, s2, 7
s_add_u32 s76, s50, s48
s_and_b32 s76, s76, 7
s_mul_i32 s76, s76, 2
s_add_u32 s69, s47, 0
s_and_b32 s69, s69, 15
s_mul_i32 s67, s69, 128
s_mul_i32 s68, s69, s54
s_waitcnt vmcnt(0) lgkmcnt(0)
s_barrier
s_mov_b32 s36, s14
s_and_b32 s37, s15, 0xffff
s_mov_b32 s38, 65536
s_mov_b32 s39, 0x00020000
s_lshl_b32 s48, s42, 12
s_lshl_b32 s49, s43, 10
s_add_u32 s48, s48, s49
s_add_u32 m0, s49, 135168
s_nop 0
buffer_load_dwordx4 v18, s[36:39], s48 offen lds
ds_read_b128 v[232:235], v52 offset:57344
ds_read_b128 v[236:239], v52 offset:58368
ds_read_b128 v[152:155], v51 offset:40960
ds_read_b128 v[156:159], v51 offset:41984
ds_read_b128 v[160:163], v51 offset:49152
ds_read_b128 v[164:167], v51 offset:50176
ds_read_b128 v[168:171], v51 offset:57344
ds_read_b128 v[172:175], v51 offset:58368
ds_read_b128 v[176:179], v52 offset:0
ds_read_b128 v[180:183], v52 offset:1024
ds_read_b128 v[184:187], v52 offset:8192
ds_read_b128 v[188:191], v52 offset:9216
ds_read_b128 v[192:195], v52 offset:16384
ds_read_b128 v[196:199], v52 offset:17408
ds_read_b128 v[200:203], v52 offset:24576
ds_read_b128 v[204:207], v52 offset:25600
ds_read_b128 v[208:211], v52 offset:32768
ds_read_b128 v[212:215], v52 offset:33792
ds_read_b128 v[216:219], v52 offset:40960
ds_read_b128 v[220:223], v52 offset:41984
ds_read_b128 v[224:227], v52 offset:49152
ds_read_b128 v[228:231], v52 offset:50176
ds_read_b128 v[112:115], v51 offset:0
ds_read_b128 v[116:119], v51 offset:1024
ds_read_b128 v[120:123], v51 offset:8192
ds_read_b128 v[124:127], v51 offset:9216
ds_read_b128 v[128:131], v51 offset:16384
ds_read_b128 v[132:135], v51 offset:17408
s_add_u32 s48, s80, 0
v_add_u32 v20, s48, v18
v_mov_b32 v21, v20
v_add_u32 v22, 30720, v20
v_mov_b32 v23, v22
v_add_u32 v37, 262144, v37
s_lshl_b32 s50, s42, 2
s_add_u32 s50, s50, s43
s_lshl_b32 s50, s50, 12
s_add_u32 s50, s50, 18087936
v_add_u32 v38, s50, v18
v_min_u32 v4, 2, v3
v_lshlrev_b32 v4, 8, v4
v_lshl_add_u32 v4, v2, 2, v4
s_and_b32 s48, s43, 1
s_lshl_b32 s48, s48, 7
s_lshr_b32 s49, s43, 1
s_lshl_b32 s49, s49, 6
s_add_u32 s48, s48, s49
s_add_u32 s48, s48, 133888
v_add_u32 v53, s48, v4
s_getpc_b64 s[98:99]
pc_30:
s_add_u32 s98, s98, c1_last - pc_30
s_addc_u32 s99, s99, 0
s_lshr_b32 s50, s2, 3
s_lshl_b32 s50, s50, 2
s_add_u32 s50, s50, s43
s_lshl_b32 s50, s50, 7
v_and_b32 v4, 1, v0
v_lshl_add_u32 v4, v4, 6, s50
v_min_u32 v54, L_code_end - c1_last, v4
s_waitcnt vmcnt(0) lgkmcnt(0)
s_add_u32 s69, s47, 1
s_and_b32 s69, s69, 15
s_mul_i32 s67, s69, 2048
s_mul_i32 s68, s69, s54
s_barrier
s_add_u32 s60, s71, 40960
s_add_u32 m0, s60, 0
s_mov_b32 s61, s68
buffer_load_dwordx4 v26, s[28:31], s61 offen lds
buffer_load_dwordx4 v27, s[28:31], s61 offen offset:1024 lds
s_add_u32 m0, s60, 8192
s_add_u32 s61, s61, s53
buffer_load_dwordx4 v26, s[28:31], s61 offen lds
buffer_load_dwordx4 v27, s[28:31], s61 offen offset:1024 lds
s_add_u32 m0, s60, 16384
s_add_u32 s61, s61, s53
buffer_load_dwordx4 v26, s[28:31], s61 offen lds
buffer_load_dwordx4 v27, s[28:31], s61 offen offset:1024 lds
s_add_u32 s49, s76, 2
s_and_b32 s49, s49, 15
s_mul_i32 s49, s49, 393216
buffer_load_dwordx4 v[40:43], v36, s[28:31], s49 offen
s_add_u32 s49, s76, 3
s_and_b32 s49, s49, 15
s_mul_i32 s49, s49, 393216
buffer_load_dwordx4 v[40:43], v36, s[28:31], s49 offen
buffer_load_dword v5, v30, s[32:35], s79 offen sc1
s_add_u32 s69, s47, 0
s_and_b32 s69, s69, 15
s_mul_i32 s67, s69, 2048
s_mul_i32 s68, s69, s54
s_add_u32 m0, s70, 0
s_nop 0
s_mov_b32 s63, 0
s_waitcnt vmcnt(0)
poll_31:
v_cmp_gt_u32 vcc, 1, v5
s_cbranch_vccz polled_32
buffer_load_dword v5, v30, s[32:35], s79 offen sc1
s_add_u32 s63, s63, 1
s_cmp_lt_u32 s63, 0x80000
s_waitcnt vmcnt(0)
s_cbranch_scc1 poll_31
polled_32:
buffer_load_dwordx4 v20, s[32:35], s67 offen offset:0 sc1 lds
buffer_load_dwordx4 v21, s[32:35], s67 offen offset:1024 sc1 lds
buffer_load_dwordx4 v22, s[32:35], s67 offen offset:2048 sc1 lds
buffer_load_dwordx4 v23, s[32:35], s67 offen offset:3072 sc1 lds
s_add_u32 s69, s47, 1
s_and_b32 s69, s69, 15
s_mul_i32 s67, s69, 2048
s_mul_i32 s68, s69, s54
s_add_u32 m0, s70, 40960
s_nop 0
buffer_load_dwordx4 v20, s[32:35], s67 offen offset:0 sc1 lds
buffer_load_dwordx4 v21, s[32:35], s67 offen offset:1024 sc1 lds
buffer_load_dwordx4 v22, s[32:35], s67 offen offset:2048 sc1 lds
buffer_load_dwordx4 v23, s[32:35], s67 offen offset:3072 sc1 lds
s_waitcnt vmcnt(4) lgkmcnt(0)
s_barrier
s_add_u32 s69, s47, 2
s_and_b32 s69, s69, 15
s_mul_i32 s67, s69, 2048
s_mul_i32 s68, s69, s54
s_add_u32 m0, s70, 81920
s_nop 0
buffer_load_dwordx4 v20, s[32:35], s67 offen offset:0 sc1 lds
buffer_load_dwordx4 v21, s[32:35], s67 offen offset:1024 sc1 lds
buffer_load_dwordx4 v22, s[32:35], s67 offen offset:2048 sc1 lds
buffer_load_dwordx4 v23, s[32:35], s67 offen offset:3072 sc1 lds
s_add_u32 s60, s71, 81920
s_add_u32 m0, s60, 0
s_mov_b32 s61, s68
buffer_load_dwordx4 v26, s[28:31], s61 offen lds
buffer_load_dwordx4 v27, s[28:31], s61 offen offset:1024 lds
s_add_u32 m0, s60, 8192
s_add_u32 s61, s61, s53
buffer_load_dwordx4 v26, s[28:31], s61 offen lds
buffer_load_dwordx4 v27, s[28:31], s61 offen offset:1024 lds
s_add_u32 m0, s60, 16384
s_add_u32 s61, s61, s53
buffer_load_dwordx4 v26, s[28:31], s61 offen lds
buffer_load_dwordx4 v27, s[28:31], s61 offen offset:1024 lds
s_add_u32 s49, s76, 4
s_and_b32 s49, s49, 15
s_mul_i32 s49, s49, 393216
buffer_load_dwordx4 v[40:43], v36, s[28:31], s49 offen
s_mov_b32 s64, 0
s_mov_b32 s65, 0
h1_loop:
s_waitcnt vmcnt(11)
s_barrier
s_add_u32 s69, s69, 1
s_and_b32 s69, s69, 15
s_mul_i32 s67, s69, 2048
s_mul_i32 s68, s69, s54
s_add_u32 m0, s70, s65
s_nop 0
buffer_load_dwordx4 v20, s[32:35], s67 offen offset:0 sc1 lds
buffer_load_dwordx4 v21, s[32:35], s67 offen offset:1024 sc1 lds
buffer_load_dwordx4 v22, s[32:35], s67 offen offset:2048 sc1 lds
buffer_load_dwordx4 v23, s[32:35], s67 offen offset:3072 sc1 lds
s_add_u32 s60, s71, s65
s_add_u32 m0, s60, 0
s_mov_b32 s61, s68
buffer_load_dwordx4 v26, s[28:31], s61 offen lds
buffer_load_dwordx4 v27, s[28:31], s61 offen offset:1024 lds
s_add_u32 m0, s60, 8192
s_add_u32 s61, s61, s53
buffer_load_dwordx4 v26, s[28:31], s61 offen lds
buffer_load_dwordx4 v27, s[28:31], s61 offen offset:1024 lds
s_add_u32 m0, s60, 16384
s_add_u32 s61, s61, s53
buffer_load_dwordx4 v26, s[28:31], s61 offen lds
buffer_load_dwordx4 v27, s[28:31], s61 offen offset:1024 lds
s_add_u32 s48, s64, 5
s_min_u32 s48, s48, 15
s_add_u32 s49, s48, s76
s_and_b32 s49, s49, 15
s_mul_i32 s49, s49, 393216
buffer_load_dwordx4 v[40:43], v36, s[28:31], s49 offen
s_add_u32 s65, s65, 40960
s_cmp_eq_u32 s65, 122880
s_cselect_b32 s65, 0, s65
s_add_u32 s64, s64, 1
s_cmp_lt_u32 s64, 11
s_cbranch_scc1 h1_loop
s_waitcnt vmcnt(11)
s_barrier
s_add_u32 s69, s47, 14
s_and_b32 s69, s69, 15
s_mul_i32 s67, s69, 2048
s_mul_i32 s68, s69, s54
s_add_u32 m0, s70, s65
s_nop 0
buffer_load_dwordx4 v20, s[32:35], s67 offen offset:0 sc1 lds
buffer_load_dwordx4 v21, s[32:35], s67 offen offset:1024 sc1 lds
buffer_load_dwordx4 v22, s[32:35], s67 offen offset:2048 sc1 lds
buffer_load_dwordx4 v23, s[32:35], s67 offen offset:3072 sc1 lds
s_add_u32 s60, s71, s65
s_add_u32 m0, s60, 0
s_mov_b32 s61, s68
buffer_load_dwordx4 v26, s[28:31], s61 offen lds
buffer_load_dwordx4 v27, s[28:31], s61 offen offset:1024 lds
s_add_u32 m0, s60, 8192
s_add_u32 s61, s61, s53
buffer_load_dwordx4 v26, s[28:31], s61 offen lds
buffer_load_dwordx4 v27, s[28:31], s61 offen offset:1024 lds
s_add_u32 m0, s60, 16384
s_add_u32 s61, s61, s53
buffer_load_dwordx4 v26, s[28:31], s61 offen lds
buffer_load_dwordx4 v27, s[28:31], s61 offen offset:1024 lds
s_add_u32 s65, s65, 40960
s_cmp_eq_u32 s65, 122880
s_cselect_b32 s65, 0, s65
s_add_u32 s64, s64, 1
s_mov_b32 s36, s16
s_and_b32 s37, s17, 0xffff
s_mov_b32 s38, 2097152
s_mov_b32 s39, 0x00020000
s_waitcnt vmcnt(10)
s_barrier
s_add_u32 s69, s47, 15
s_and_b32 s69, s69, 15
s_mul_i32 s67, s69, 2048
s_mul_i32 s68, s69, s54
s_add_u32 m0, s70, 0
s_nop 0
buffer_load_dwordx4 v20, s[32:35], s67 offen offset:0 sc1 lds
buffer_load_dwordx4 v21, s[32:35], s67 offen offset:1024 sc1 lds
buffer_load_dwordx4 v22, s[32:35], s67 offen offset:2048 sc1 lds
buffer_load_dwordx4 v23, s[32:35], s67 offen offset:3072 sc1 lds
s_add_u32 s60, s71, 0
s_add_u32 m0, s60, 0
s_mov_b32 s61, s68
buffer_load_dwordx4 v26, s[28:31], s61 offen lds
buffer_load_dwordx4 v27, s[28:31], s61 offen offset:1024 lds
s_add_u32 m0, s60, 8192
s_add_u32 s61, s61, s53
buffer_load_dwordx4 v26, s[28:31], s61 offen lds
buffer_load_dwordx4 v27, s[28:31], s61 offen offset:1024 lds
s_add_u32 m0, s60, 16384
s_add_u32 s61, s61, s53
buffer_load_dwordx4 v26, s[28:31], s61 offen lds
buffer_load_dwordx4 v27, s[28:31], s61 offen offset:1024 lds
s_waitcnt vmcnt(10)
s_barrier
s_setprio 0
buffer_load_dwordx4 v[240:243], v15, s[36:39], 0 offen offset:0
buffer_load_dwordx4 v[240:243], v15, s[36:39], 0 offen offset:1024
buffer_load_dwordx4 v[80:83], v37, s[32:35], 0 offen offset:0 sc1
buffer_load_dwordx4 v[84:87], v37, s[32:35], 0 offen offset:1024 sc1
buffer_load_dwordx4 v[88:91], v37, s[32:35], 0 offen offset:2048 sc1
buffer_load_dwordx4 v[92:95], v37, s[32:35], 0 offen offset:3072 sc1
global_load_dword v48, v54, s[98:99]
buffer_load_dwordx4 v[64:67], v38, s[32:35], 0 offen offset:0 sc1
buffer_load_dwordx4 v[68:71], v38, s[32:35], 0 offen offset:1024 sc1
buffer_load_dwordx4 v[72:75], v38, s[32:35], 0 offen offset:2048 sc1
buffer_load_dwordx4 v[76:79], v38, s[32:35], 0 offen offset:3072 sc1
s_add_u32 s48, s75, 15
s_and_b32 s48, s48, 15
s_mul_i32 s48, s48, s57
s_add_u32 m0, s71, 106496
s_nop 0
buffer_load_dwordx4 v28, s[36:39], s48 offen lds
buffer_load_dwordx4 v29, s[36:39], s48 offen offset:1024 lds
s_waitcnt vmcnt(13)
s_barrier
s_add_u32 s48, s75, 5
s_and_b32 s48, s48, 15
s_mul_i32 s48, s48, s57
s_add_u32 m0, s71, 24576
s_nop 0
buffer_load_dwordx4 v28, s[36:39], s48 offen lds
buffer_load_dwordx4 v29, s[36:39], s48 offen offset:1024 lds
s_waitcnt vmcnt(4)
s_add_u32 s48, s75, 6
s_and_b32 s48, s48, 15
s_mul_i32 s48, s48, s57
s_add_u32 m0, s71, 32768
s_nop 0
buffer_load_dwordx4 v28, s[36:39], s48 offen lds
v_add_f32 v80, v80, v88
v_add_f32 v64, v64, v72
v_add_f32 v81, v81, v89
v_add_f32 v65, v65, v73
v_add_f32 v82, v82, v90
v_add_f32 v66, v66, v74
v_add_f32 v83, v83, v91
v_add_f32 v67, v67, v75
v_add_f32 v84, v84, v92
v_add_f32 v68, v68, v76
buffer_load_dwordx4 v29, s[36:39], s48 offen offset:1024 lds
v_add_f32 v85, v85, v93
v_add_f32 v69, v69, v77
v_add_f32 v86, v86, v94
v_add_f32 v70, v70, v78
v_add_f32 v87, v87, v95
v_add_f32 v71, v71, v79
v_add_f32 v80, v80, v84
v_add_f32 v64, v64, v68
v_add_f32 v81, v81, v85
v_add_f32 v65, v65, v69
s_add_u32 s48, s75, 7
s_and_b32 s48, s48, 15
s_mul_i32 s48, s48, s57
s_add_u32 m0, s71, 40960
s_nop 0
buffer_load_dwordx4 v28, s[36:39], s48 offen lds
v_add_f32 v82, v82, v86
v_add_f32 v66, v66, v70
v_add_f32 v83, v83, v87
v_add_f32 v67, v67, v71
s_nop 1
s_nop 1
v_permlane32_swap_b32 v80, v81
v_permlane32_swap_b32 v64, v65
v_permlane32_swap_b32 v82, v83
buffer_load_dwordx4 v29, s[36:39], s48 offen offset:1024 lds
v_permlane32_swap_b32 v66, v67
v_add_f32 v80, v80, v81
v_add_f32 v64, v64, v65
v_add_f32 v82, v82, v83
v_add_f32 v66, v66, v67
s_nop 1
s_nop 1
v_permlane16_swap_b32 v80, v82
v_permlane16_swap_b32 v64, v66
s_nop 0
s_add_u32 s48, s75, 8
s_and_b32 s48, s48, 15
s_mul_i32 s48, s48, s57
s_add_u32 m0, s71, 49152
s_nop 0
buffer_load_dwordx4 v28, s[36:39], s48 offen lds
s_nop 0
v_add_f32 v80, v80, v82
v_add_f32 v64, v64, v66
v_cmp_u_f32 vcc, v80, v80
s_cbranch_vccnz again_33
summed_34:
v_cmp_u_f32 vcc, v64, v64
s_cbranch_vccnz again_36
summed_37:
v_mul_f32 v44, 0x3a800000, v80
ds_write_b32 v53, v64
v_mov_b32 v45, v44
s_nop 1
v_permlane16_swap_b32 v44, v45
buffer_load_dwordx4 v29, s[36:39], s48 offen offset:1024 lds
s_nop 0
v_fma_f32 v45, -v44, v44, v45
v_max_f32 v45, 0, v45
v_add_f32 v45, 0x3727c5ac, v45
v_rsq_f32 v46, v45
v_sub_f32 v47, 0, v44
ds_write_b32 v50, v47 offset:512
ds_write_b64 v49, v[46:47]
ds_write_b32 v50, v46
s_setprio 0
s_waitcnt lgkmcnt(0)
s_waitcnt vmcnt(63)
s_barrier
s_waitcnt vmcnt(5)
s_add_u32 s48, s75, 9
s_and_b32 s48, s48, 15
s_mul_i32 s48, s48, s57
s_add_u32 m0, s71, 57344
s_nop 0
buffer_load_dwordx4 v28, s[36:39], s48 offen lds
buffer_load_dwordx4 v29, s[36:39], s48 offen offset:1024 lds
s_waitcnt vmcnt(5)
s_add_u32 s48, s75, 10
s_and_b32 s48, s48, 15
s_mul_i32 s48, s48, s57
s_add_u32 m0, s71, 65536
s_nop 0
buffer_load_dwordx4 v28, s[36:39], s48 offen lds
buffer_load_dwordx4 v29, s[36:39], s48 offen offset:1024 lds
s_waitcnt vmcnt(5)
s_add_u32 s48, s75, 11
s_and_b32 s48, s48, 15
s_mul_i32 s48, s48, s57
s_add_u32 m0, s71, 73728
s_nop 0
buffer_load_dwordx4 v28, s[36:39], s48 offen lds
buffer_load_dwordx4 v29, s[36:39], s48 offen offset:1024 lds
s_waitcnt vmcnt(5)
s_add_u32 s48, s75, 12
s_and_b32 s48, s48, 15
s_mul_i32 s48, s48, s57
s_add_u32 m0, s71, 81920
s_nop 0
buffer_load_dwordx4 v28, s[36:39], s48 offen lds
buffer_load_dwordx4 v29, s[36:39], s48 offen offset:1024 lds
s_waitcnt vmcnt(5)
s_add_u32 s48, s75, 13
s_and_b32 s48, s48, 15
s_mul_i32 s48, s48, s57
s_add_u32 m0, s71, 90112
s_nop 0
buffer_load_dwordx4 v28, s[36:39], s48 offen lds
buffer_load_dwordx4 v29, s[36:39], s48 offen offset:1024 lds
s_waitcnt vmcnt(5)
s_add_u32 s48, s75, 14
s_and_b32 s48, s48, 15
s_mul_i32 s48, s48, s57
s_add_u32 m0, s71, 98304
s_nop 0
buffer_load_dwordx4 v28, s[36:39], s48 offen lds
buffer_load_dwordx4 v29, s[36:39], s48 offen offset:1024 lds
s_waitcnt vmcnt(5)
s_add_u32 s48, s75, 0
s_and_b32 s48, s48, 15
s_mul_i32 s48, s48, s57
s_add_u32 m0, s71, 4294950912
s_nop 0
buffer_load_dwordx4 v28, s[36:39], s48 offen lds
buffer_load_dwordx4 v29, s[36:39], s48 offen offset:1024 lds
s_waitcnt vmcnt(5)
s_add_u32 s48, s75, 1
s_and_b32 s48, s48, 15
s_mul_i32 s48, s48, s57
s_add_u32 m0, s71, 4294959104
s_nop 0
buffer_load_dwordx4 v28, s[36:39], s48 offen lds
buffer_load_dwordx4 v29, s[36:39], s48 offen offset:1024 lds
s_waitcnt vmcnt(5)
s_add_u32 s48, s75, 2
s_and_b32 s48, s48, 15
s_mul_i32 s48, s48, s57
s_add_u32 m0, s71, 0
s_nop 0
buffer_load_dwordx4 v28, s[36:39], s48 offen lds
buffer_load_dwordx4 v29, s[36:39], s48 offen offset:1024 lds
s_waitcnt vmcnt(5)
s_add_u32 s48, s75, 3
s_and_b32 s48, s48, 15
s_mul_i32 s48, s48, s57
s_add_u32 m0, s71, 8192
s_nop 0
buffer_load_dwordx4 v28, s[36:39], s48 offen lds
buffer_load_dwordx4 v29, s[36:39], s48 offen offset:1024 lds
s_waitcnt vmcnt(5)
s_add_u32 s48, s75, 4
s_and_b32 s48, s48, 15
s_mul_i32 s48, s48, s57
s_add_u32 m0, s71, 16384
s_nop 0
buffer_load_dwordx4 v28, s[36:39], s48 offen lds
buffer_load_dwordx4 v29, s[36:39], s48 offen offset:1024 lds
s_waitcnt vmcnt(5)
buffer_load_dwordx4 v[240:243], v18, s[32:35], s81 offen offset:0 sc1
buffer_load_dwordx4 v[240:243], v18, s[32:35], s81 offen offset:1024 sc1
s_waitcnt vmcnt(5)
buffer_load_dwordx4 v[240:243], v18, s[32:35], s82 offen offset:0 sc1
buffer_load_dwordx4 v[240:243], v18, s[32:35], s82 offen offset:1024 sc1
s_mov_b32 s28, s6
s_and_b32 s29, s7, 0xffff
s_mov_b32 s30, 6291456
s_mov_b32 s31, 0x00020000
s_and_b32 s48, s2, 7
s_lshl_b32 s48, s48, 1
s_add_u32 s47, s42, s48
s_and_b32 s47, s47, 15
s_and_b32 s50, s42, 8
s_or_b32 s50, s50, 3
s_and_b32 s48, s2, 7
s_lshl_b32 s48, s48, 1
s_add_u32 s76, s50, s48
s_and_b32 s76, s76, 15
s_add_u32 s69, s47, 0
s_and_b32 s69, s69, 15
s_mul_i32 s67, s69, 2048
s_mul_i32 s68, s69, s54
s_waitcnt vmcnt(0) lgkmcnt(0)
s_barrier
s_add_u32 s60, s71, 122880
s_add_u32 m0, s60, 0
s_mov_b32 s61, s68
buffer_load_dwordx4 v26, s[28:31], s61 offen lds
buffer_load_dwordx4 v27, s[28:31], s61 offen offset:1024 lds
s_add_u32 m0, s60, 8192
s_add_u32 s61, s61, s53
buffer_load_dwordx4 v26, s[28:31], s61 offen lds
buffer_load_dwordx4 v27, s[28:31], s61 offen offset:1024 lds
s_add_u32 m0, s60, 16384
s_add_u32 s61, s61, s53
buffer_load_dwordx4 v26, s[28:31], s61 offen lds
buffer_load_dwordx4 v27, s[28:31], s61 offen offset:1024 lds
v_add_u32 v37, 262144, v37
s_getpc_b64 s[98:99]
pc_39:
s_add_u32 s98, s98, c2_last - pc_39
s_addc_u32 s99, s99, 0
s_lshr_b32 s50, s2, 3
s_lshl_b32 s50, s50, 2
s_add_u32 s50, s50, s43
s_lshl_b32 s50, s50, 7
v_and_b32 v4, 1, v0
v_lshl_add_u32 v4, v4, 6, s50
v_min_u32 v54, L_code_end - c2_last, v4
s_waitcnt vmcnt(0) lgkmcnt(0)
s_add_u32 s69, s47, 1
s_and_b32 s69, s69, 15
s_mul_i32 s67, s69, 2048
s_mul_i32 s68, s69, s54
s_barrier
s_add_u32 s60, s71, 40960
s_add_u32 m0, s60, 0
s_mov_b32 s61, s68
buffer_load_dwordx4 v26, s[28:31], s61 offen lds
buffer_load_dwordx4 v27, s[28:31], s61 offen offset:1024 lds
s_add_u32 m0, s60, 8192
s_add_u32 s61, s61, s53
buffer_load_dwordx4 v26, s[28:31], s61 offen lds
buffer_load_dwordx4 v27, s[28:31], s61 offen offset:1024 lds
s_add_u32 m0, s60, 16384
s_add_u32 s61, s61, s53
buffer_load_dwordx4 v26, s[28:31], s61 offen lds
buffer_load_dwordx4 v27, s[28:31], s61 offen offset:1024 lds
s_add_u32 s49, s76, 2
s_and_b32 s49, s49, 15
s_mul_i32 s49, s49, 393216
buffer_load_dwordx4 v[40:43], v36, s[28:31], s49 offen
s_add_u32 s49, s76, 3
s_and_b32 s49, s49, 15
s_mul_i32 s49, s49, 393216
buffer_load_dwordx4 v[40:43], v36, s[28:31], s49 offen
buffer_load_dword v5, v30, s[32:35], s79 offen sc1
s_add_u32 s69, s47, 0
s_and_b32 s69, s69, 15
s_mul_i32 s67, s69, 2048
s_mul_i32 s68, s69, s54
s_add_u32 m0, s70, 0
s_nop 0
s_mov_b32 s63, 0
s_waitcnt vmcnt(0)
poll_40:
v_cmp_gt_u32 vcc, 2, v5
s_cbranch_vccz polled_41
buffer_load_dword v5, v30, s[32:35], s79 offen sc1
s_add_u32 s63, s63, 1
s_cmp_lt_u32 s63, 0x80000
s_waitcnt vmcnt(0)
s_cbranch_scc1 poll_40
polled_41:
buffer_load_dwordx4 v20, s[32:35], s67 offen offset:0 sc1 lds
buffer_load_dwordx4 v21, s[32:35], s67 offen offset:1024 sc1 lds
buffer_load_dwordx4 v22, s[32:35], s67 offen offset:2048 sc1 lds
buffer_load_dwordx4 v23, s[32:35], s67 offen offset:3072 sc1 lds
s_add_u32 s69, s47, 1
s_and_b32 s69, s69, 15
s_mul_i32 s67, s69, 2048
s_mul_i32 s68, s69, s54
s_add_u32 m0, s70, 40960
s_nop 0
buffer_load_dwordx4 v20, s[32:35], s67 offen offset:0 sc1 lds
buffer_load_dwordx4 v21, s[32:35], s67 offen offset:1024 sc1 lds
buffer_load_dwordx4 v22, s[32:35], s67 offen offset:2048 sc1 lds
buffer_load_dwordx4 v23, s[32:35], s67 offen offset:3072 sc1 lds
s_waitcnt vmcnt(4) lgkmcnt(0)
s_barrier
s_add_u32 s69, s47, 2
s_and_b32 s69, s69, 15
s_mul_i32 s67, s69, 2048
s_mul_i32 s68, s69, s54
s_add_u32 m0, s70, 81920
s_nop 0
buffer_load_dwordx4 v20, s[32:35], s67 offen offset:0 sc1 lds
buffer_load_dwordx4 v21, s[32:35], s67 offen offset:1024 sc1 lds
buffer_load_dwordx4 v22, s[32:35], s67 offen offset:2048 sc1 lds
buffer_load_dwordx4 v23, s[32:35], s67 offen offset:3072 sc1 lds
s_add_u32 s60, s71, 81920
s_add_u32 m0, s60, 0
s_mov_b32 s61, s68
buffer_load_dwordx4 v26, s[28:31], s61 offen lds
buffer_load_dwordx4 v27, s[28:31], s61 offen offset:1024 lds
s_add_u32 m0, s60, 8192
s_add_u32 s61, s61, s53
buffer_load_dwordx4 v26, s[28:31], s61 offen lds
buffer_load_dwordx4 v27, s[28:31], s61 offen offset:1024 lds
s_add_u32 m0, s60, 16384
s_add_u32 s61, s61, s53
buffer_load_dwordx4 v26, s[28:31], s61 offen lds
buffer_load_dwordx4 v27, s[28:31], s61 offen offset:1024 lds
s_add_u32 s49, s76, 4
s_and_b32 s49, s49, 15
s_mul_i32 s49, s49, 393216
buffer_load_dwordx4 v[40:43], v36, s[28:31], s49 offen
s_mov_b32 s64, 0
s_mov_b32 s65, 0
h2_loop:
s_waitcnt vmcnt(11)
s_barrier
s_add_u32 s69, s69, 1
s_and_b32 s69, s69, 15
s_mul_i32 s67, s69, 2048
s_mul_i32 s68, s69, s54
s_add_u32 m0, s70, s65
s_nop 0
buffer_load_dwordx4 v20, s[32:35], s67 offen offset:0 sc1 lds
buffer_load_dwordx4 v21, s[32:35], s67 offen offset:1024 sc1 lds
buffer_load_dwordx4 v22, s[32:35], s67 offen offset:2048 sc1 lds
buffer_load_dwordx4 v23, s[32:35], s67 offen offset:3072 sc1 lds
s_add_u32 s60, s71, s65
s_add_u32 m0, s60, 0
s_mov_b32 s61, s68
buffer_load_dwordx4 v26, s[28:31], s61 offen lds
buffer_load_dwordx4 v27, s[28:31], s61 offen offset:1024 lds
s_add_u32 m0, s60, 8192
s_add_u32 s61, s61, s53
buffer_load_dwordx4 v26, s[28:31], s61 offen lds
buffer_load_dwordx4 v27, s[28:31], s61 offen offset:1024 lds
s_add_u32 m0, s60, 16384
s_add_u32 s61, s61, s53
buffer_load_dwordx4 v26, s[28:31], s61 offen lds
buffer_load_dwordx4 v27, s[28:31], s61 offen offset:1024 lds
s_add_u32 s48, s64, 5
s_min_u32 s48, s48, 15
s_add_u32 s49, s48, s76
s_and_b32 s49, s49, 15
s_mul_i32 s49, s49, 393216
buffer_load_dwordx4 v[40:43], v36, s[28:31], s49 offen
s_add_u32 s65, s65, 40960
s_cmp_eq_u32 s65, 122880
s_cselect_b32 s65, 0, s65
s_add_u32 s64, s64, 1
s_cmp_lt_u32 s64, 11
s_cbranch_scc1 h2_loop
s_waitcnt vmcnt(11)
s_barrier
s_add_u32 s69, s47, 14
s_and_b32 s69, s69, 15
s_mul_i32 s67, s69, 2048
s_mul_i32 s68, s69, s54
s_add_u32 m0, s70, s65
s_nop 0
buffer_load_dwordx4 v20, s[32:35], s67 offen offset:0 sc1 lds
buffer_load_dwordx4 v21, s[32:35], s67 offen offset:1024 sc1 lds
buffer_load_dwordx4 v22, s[32:35], s67 offen offset:2048 sc1 lds
buffer_load_dwordx4 v23, s[32:35], s67 offen offset:3072 sc1 lds
s_add_u32 s60, s71, s65
s_add_u32 m0, s60, 0
s_mov_b32 s61, s68
buffer_load_dwordx4 v26, s[28:31], s61 offen lds
buffer_load_dwordx4 v27, s[28:31], s61 offen offset:1024 lds
s_add_u32 m0, s60, 8192
s_add_u32 s61, s61, s53
buffer_load_dwordx4 v26, s[28:31], s61 offen lds
buffer_load_dwordx4 v27, s[28:31], s61 offen offset:1024 lds
s_add_u32 m0, s60, 16384
s_add_u32 s61, s61, s53
buffer_load_dwordx4 v26, s[28:31], s61 offen lds
buffer_load_dwordx4 v27, s[28:31], s61 offen offset:1024 lds
s_add_u32 s65, s65, 40960
s_cmp_eq_u32 s65, 122880
s_cselect_b32 s65, 0, s65
s_add_u32 s64, s64, 1
s_mov_b32 s36, s12
s_and_b32 s37, s13, 0xffff
s_mov_b32 s38, 6291456
s_mov_b32 s39, 0x00020000
s_waitcnt vmcnt(10)
s_barrier
s_add_u32 s69, s47, 15
s_and_b32 s69, s69, 15
s_mul_i32 s67, s69, 2048
s_mul_i32 s68, s69, s54
s_add_u32 m0, s70, 0
s_nop 0
buffer_load_dwordx4 v20, s[32:35], s67 offen offset:0 sc1 lds
buffer_load_dwordx4 v21, s[32:35], s67 offen offset:1024 sc1 lds
buffer_load_dwordx4 v22, s[32:35], s67 offen offset:2048 sc1 lds
buffer_load_dwordx4 v23, s[32:35], s67 offen offset:3072 sc1 lds
s_add_u32 s60, s71, 0
s_add_u32 m0, s60, 0
s_mov_b32 s61, s68
buffer_load_dwordx4 v26, s[28:31], s61 offen lds
buffer_load_dwordx4 v27, s[28:31], s61 offen offset:1024 lds
s_add_u32 m0, s60, 8192
s_add_u32 s61, s61, s53
buffer_load_dwordx4 v26, s[28:31], s61 offen lds
buffer_load_dwordx4 v27, s[28:31], s61 offen offset:1024 lds
s_add_u32 m0, s60, 16384
s_add_u32 s61, s61, s53
buffer_load_dwordx4 v26, s[28:31], s61 offen lds
buffer_load_dwordx4 v27, s[28:31], s61 offen offset:1024 lds
s_waitcnt vmcnt(10)
s_barrier
s_setprio 0
buffer_load_dwordx4 v[80:83], v37, s[32:35], 0 offen offset:0 sc1
buffer_load_dwordx4 v[84:87], v37, s[32:35], 0 offen offset:1024 sc1
buffer_load_dwordx4 v[88:91], v37, s[32:35], 0 offen offset:2048 sc1
buffer_load_dwordx4 v[92:95], v37, s[32:35], 0 offen offset:3072 sc1
global_load_dword v48, v54, s[98:99]
s_add_u32 s69, s47, 0
s_and_b32 s69, s69, 15
s_mul_i32 s67, s69, 2048
s_mul_i32 s68, s69, s54
s_add_u32 s60, s71, 122880
s_add_u32 m0, s60, 0
s_mov_b32 s61, s68
buffer_load_dwordx4 v26, s[36:39], s61 offen lds
buffer_load_dwordx4 v27, s[36:39], s61 offen offset:1024 lds
s_add_u32 m0, s60, 8192
s_add_u32 s61, s61, s53
buffer_load_dwordx4 v26, s[36:39], s61 offen lds
buffer_load_dwordx4 v27, s[36:39], s61 offen offset:1024 lds
s_add_u32 m0, s60, 16384
s_add_u32 s61, s61, s53
buffer_load_dwordx4 v26, s[36:39], s61 offen lds
buffer_load_dwordx4 v27, s[36:39], s61 offen offset:1024 lds
s_waitcnt vmcnt(11)
s_barrier
s_waitcnt vmcnt(7)
buffer_store_dwordx4 v[56:59], v18, s[32:35], s86 offen offset:0 sc1
v_add_f32 v80, v80, v88
v_add_f32 v81, v81, v89
v_add_f32 v82, v82, v90
v_add_f32 v83, v83, v91
v_add_f32 v84, v84, v92
v_add_f32 v85, v85, v93
v_add_f32 v86, v86, v94
buffer_store_dwordx4 v[56:59], v18, s[32:35], s86 offen offset:1024 sc1
v_add_f32 v87, v87, v95
v_add_f32 v80, v80, v84
v_add_f32 v81, v81, v85
v_add_f32 v82, v82, v86
v_add_f32 v83, v83, v87
s_nop 1
buffer_load_dwordx4 v[240:243], v18, s[32:35], s81 offen offset:0 sc1
v_permlane32_swap_b32 v80, v81
v_permlane32_swap_b32 v82, v83
v_add_f32 v80, v80, v81
v_add_f32 v82, v82, v83
s_nop 1
v_permlane16_swap_b32 v80, v82
buffer_load_dwordx4 v[240:243], v18, s[32:35], s81 offen offset:1024 sc1
s_nop 0
v_add_f32 v80, v80, v82
v_cmp_u_f32 vcc, v80, v80
s_cbranch_vccnz again_42
summed_43:
v_mul_f32 v44, 0x3a800000, v80
buffer_load_dwordx4 v[240:243], v18, s[32:35], s82 offen offset:0 sc1
v_mov_b32 v45, v44
s_nop 1
v_permlane16_swap_b32 v44, v45
s_nop 0
v_fma_f32 v45, -v44, v44, v45
v_max_f32 v45, 0, v45
buffer_load_dwordx4 v[240:243], v18, s[32:35], s82 offen offset:1024 sc1
v_add_f32 v45, 0x3727c5ac, v45
v_rsq_f32 v46, v45
v_sub_f32 v47, 0, v44
ds_write_b32 v50, v47 offset:512
ds_write_b64 v49, v[46:47]
ds_write_b32 v50, v46
s_setprio 0
s_waitcnt lgkmcnt(0)
s_waitcnt vmcnt(63)
s_barrier
ds_write_b128 v52, v[232:235] offset:57344
ds_write_b128 v52, v[236:239] offset:58368
ds_write_b128 v51, v[152:155] offset:40960
ds_write_b128 v51, v[156:159] offset:41984
ds_write_b128 v51, v[160:163] offset:49152
ds_write_b128 v51, v[164:167] offset:50176
ds_write_b128 v51, v[168:171] offset:57344
ds_write_b128 v51, v[172:175] offset:58368
ds_write_b128 v52, v[176:179] offset:0
ds_write_b128 v52, v[180:183] offset:1024
ds_write_b128 v52, v[184:187] offset:8192
ds_write_b128 v52, v[188:191] offset:9216
ds_write_b128 v52, v[192:195] offset:16384
ds_write_b128 v52, v[196:199] offset:17408
ds_write_b128 v52, v[200:203] offset:24576
ds_write_b128 v52, v[204:207] offset:25600
ds_write_b128 v52, v[208:211] offset:32768
ds_write_b128 v52, v[212:215] offset:33792
ds_write_b128 v52, v[216:219] offset:40960
ds_write_b128 v52, v[220:223] offset:41984
ds_write_b128 v52, v[224:227] offset:49152
ds_write_b128 v52, v[228:231] offset:50176
ds_write_b128 v51, v[112:115] offset:0
ds_write_b128 v51, v[116:119] offset:1024
ds_write_b128 v51, v[120:123] offset:8192
ds_write_b128 v51, v[124:127] offset:9216
ds_write_b128 v51, v[128:131] offset:16384
ds_write_b128 v51, v[132:135] offset:17408
ds_write_b128 v51, v[136:139] offset:24576
ds_write_b128 v51, v[140:143] offset:25600
ds_write_b128 v51, v[144:147] offset:32768
ds_write_b128 v51, v[148:151] offset:33792
s_mov_b32 s28, s12
s_and_b32 s29, s13, 0xffff
s_mov_b32 s30, 6291456
s_mov_b32 s31, 0x00020000
s_add_u32 s69, s47, 0
s_and_b32 s69, s69, 15
s_mul_i32 s67, s69, 2048
s_mul_i32 s68, s69, s54
s_waitcnt vmcnt(0) lgkmcnt(0)
s_barrier
s_mov_b32 s36, s14
s_and_b32 s37, s15, 0xffff
s_mov_b32 s38, 65536
s_mov_b32 s39, 0x00020000
s_lshl_b32 s48, s42, 12
s_lshl_b32 s49, s43, 10
s_add_u32 s48, s48, s49
s_add_u32 m0, s49, 135168
s_nop 0
buffer_load_dwordx4 v18, s[36:39], s48 offen lds
v_add_u32 v37, 262144, v37
s_getpc_b64 s[98:99]
pc_45:
s_add_u32 s98, s98, c3_last - pc_45
s_addc_u32 s99, s99, 0
s_lshr_b32 s50, s2, 3
s_lshl_b32 s50, s50, 2
s_add_u32 s50, s50, s43
s_lshl_b32 s50, s50, 7
v_and_b32 v4, 1, v0
v_lshl_add_u32 v4, v4, 6, s50
v_min_u32 v54, L_code_end - c3_last, v4
s_cmp_lg_u32 s43, 0
s_cbranch_scc1 else_46
s_mov_b32 s48, 1
s_atomic_add s48, s[22:23], s73
else_46:
s_waitcnt vmcnt(0) lgkmcnt(0)
s_add_u32 s69, s47, 1
s_and_b32 s69, s69, 15
s_mul_i32 s67, s69, 2048
s_mul_i32 s68, s69, s54
s_barrier
s_add_u32 s60, s71, 40960
s_add_u32 m0, s60, 0
s_mov_b32 s61, s68
buffer_load_dwordx4 v26, s[28:31], s61 offen lds
buffer_load_dwordx4 v27, s[28:31], s61 offen offset:1024 lds
s_add_u32 m0, s60, 8192
s_add_u32 s61, s61, s53
buffer_load_dwordx4 v26, s[28:31], s61 offen lds
buffer_load_dwordx4 v27, s[28:31], s61 offen offset:1024 lds
s_add_u32 m0, s60, 16384
s_add_u32 s61, s61, s53
buffer_load_dwordx4 v26, s[28:31], s61 offen lds
buffer_load_dwordx4 v27, s[28:31], s61 offen offset:1024 lds
s_add_u32 s49, s76, 2
s_and_b32 s49, s49, 15
s_mul_i32 s49, s49, 393216
buffer_load_dwordx4 v[40:43], v36, s[28:31], s49 offen
s_add_u32 s49, s76, 3
s_and_b32 s49, s49, 15
s_mul_i32 s49, s49, 393216
buffer_load_dwordx4 v[40:43], v36, s[28:31], s49 offen
buffer_load_dword v5, v30, s[32:35], s79 offen sc1
s_add_u32 s69, s47, 0
s_and_b32 s69, s69, 15
s_mul_i32 s67, s69, 2048
s_mul_i32 s68, s69, s54
s_add_u32 m0, s70, 0
s_nop 0
s_mov_b32 s63, 0
s_waitcnt vmcnt(0)
poll_48:
v_cmp_gt_u32 vcc, 3, v5
s_cbranch_vccz polled_49
buffer_load_dword v5, v30, s[32:35], s79 offen sc1
s_add_u32 s63, s63, 1
s_cmp_lt_u32 s63, 0x80000
s_waitcnt vmcnt(0)
s_cbranch_scc1 poll_48
polled_49:
buffer_load_dwordx4 v20, s[32:35], s67 offen offset:0 sc1 lds
buffer_load_dwordx4 v21, s[32:35], s67 offen offset:1024 sc1 lds
buffer_load_dwordx4 v22, s[32:35], s67 offen offset:2048 sc1 lds
buffer_load_dwordx4 v23, s[32:35], s67 offen offset:3072 sc1 lds
s_add_u32 s69, s47, 1
s_and_b32 s69, s69, 15
s_mul_i32 s67, s69, 2048
s_mul_i32 s68, s69, s54
s_add_u32 m0, s70, 40960
s_nop 0
buffer_load_dwordx4 v20, s[32:35], s67 offen offset:0 sc1 lds
buffer_load_dwordx4 v21, s[32:35], s67 offen offset:1024 sc1 lds
buffer_load_dwordx4 v22, s[32:35], s67 offen offset:2048 sc1 lds
buffer_load_dwordx4 v23, s[32:35], s67 offen offset:3072 sc1 lds
s_waitcnt vmcnt(4) lgkmcnt(0)
s_barrier
s_add_u32 s69, s47, 2
s_and_b32 s69, s69, 15
s_mul_i32 s67, s69, 2048
s_mul_i32 s68, s69, s54
s_add_u32 m0, s70, 81920
s_nop 0
buffer_load_dwordx4 v20, s[32:35], s67 offen offset:0 sc1 lds
buffer_load_dwordx4 v21, s[32:35], s67 offen offset:1024 sc1 lds
buffer_load_dwordx4 v22, s[32:35], s67 offen offset:2048 sc1 lds
buffer_load_dwordx4 v23, s[32:35], s67 offen offset:3072 sc1 lds
s_add_u32 s60, s71, 81920
s_add_u32 m0, s60, 0
s_mov_b32 s61, s68
buffer_load_dwordx4 v26, s[28:31], s61 offen lds
buffer_load_dwordx4 v27, s[28:31], s61 offen offset:1024 lds
s_add_u32 m0, s60, 8192
s_add_u32 s61, s61, s53
buffer_load_dwordx4 v26, s[28:31], s61 offen lds
buffer_load_dwordx4 v27, s[28:31], s61 offen offset:1024 lds
s_add_u32 m0, s60, 16384
s_add_u32 s61, s61, s53
buffer_load_dwordx4 v26, s[28:31], s61 offen lds
buffer_load_dwordx4 v27, s[28:31], s61 offen offset:1024 lds
s_add_u32 s49, s76, 4
s_and_b32 s49, s49, 15
s_mul_i32 s49, s49, 393216
buffer_load_dwordx4 v[40:43], v36, s[28:31], s49 offen
s_mov_b32 s64, 0
s_mov_b32 s65, 0
h3_loop:
s_waitcnt vmcnt(11)
s_barrier
s_add_u32 s69, s69, 1
s_and_b32 s69, s69, 15
s_mul_i32 s67, s69, 2048
s_mul_i32 s68, s69, s54
s_add_u32 m0, s70, s65
s_nop 0
buffer_load_dwordx4 v20, s[32:35], s67 offen offset:0 sc1 lds
buffer_load_dwordx4 v21, s[32:35], s67 offen offset:1024 sc1 lds
buffer_load_dwordx4 v22, s[32:35], s67 offen offset:2048 sc1 lds
buffer_load_dwordx4 v23, s[32:35], s67 offen offset:3072 sc1 lds
s_add_u32 s60, s71, s65
s_add_u32 m0, s60, 0
s_mov_b32 s61, s68
buffer_load_dwordx4 v26, s[28:31], s61 offen lds
buffer_load_dwordx4 v27, s[28:31], s61 offen offset:1024 lds
s_add_u32 m0, s60, 8192
s_add_u32 s61, s61, s53
buffer_load_dwordx4 v26, s[28:31], s61 offen lds
buffer_load_dwordx4 v27, s[28:31], s61 offen offset:1024 lds
s_add_u32 m0, s60, 16384
s_add_u32 s61, s61, s53
buffer_load_dwordx4 v26, s[28:31], s61 offen lds
buffer_load_dwordx4 v27, s[28:31], s61 offen offset:1024 lds
s_add_u32 s48, s64, 5
s_min_u32 s48, s48, 15
s_add_u32 s49, s48, s76
s_and_b32 s49, s49, 15
s_mul_i32 s49, s49, 393216
buffer_load_dwordx4 v[40:43], v36, s[28:31], s49 offen
s_add_u32 s65, s65, 40960
s_cmp_eq_u32 s65, 122880
s_cselect_b32 s65, 0, s65
s_add_u32 s64, s64, 1
s_cmp_lt_u32 s64, 11
s_cbranch_scc1 h3_loop
s_waitcnt vmcnt(11)
s_barrier
s_add_u32 s69, s47, 14
s_and_b32 s69, s69, 15
s_mul_i32 s67, s69, 2048
s_mul_i32 s68, s69, s54
s_add_u32 m0, s70, s65
s_nop 0
buffer_load_dwordx4 v20, s[32:35], s67 offen offset:0 sc1 lds
buffer_load_dwordx4 v21, s[32:35], s67 offen offset:1024 sc1 lds
buffer_load_dwordx4 v22, s[32:35], s67 offen offset:2048 sc1 lds
buffer_load_dwordx4 v23, s[32:35], s67 offen offset:3072 sc1 lds
s_add_u32 s60, s71, s65
s_add_u32 m0, s60, 0
s_mov_b32 s61, s68
buffer_load_dwordx4 v26, s[28:31], s61 offen lds
buffer_load_dwordx4 v27, s[28:31], s61 offen offset:1024 lds
s_add_u32 m0, s60, 8192
s_add_u32 s61, s61, s53
buffer_load_dwordx4 v26, s[28:31], s61 offen lds
buffer_load_dwordx4 v27, s[28:31], s61 offen offset:1024 lds
s_add_u32 m0, s60, 16384
s_add_u32 s61, s61, s53
buffer_load_dwordx4 v26, s[28:31], s61 offen lds
buffer_load_dwordx4 v27, s[28:31], s61 offen offset:1024 lds
s_add_u32 s65, s65, 40960
s_cmp_eq_u32 s65, 122880
s_cselect_b32 s65, 0, s65
s_add_u32 s64, s64, 1
s_mov_b32 s36, s16
s_and_b32 s37, s17, 0xffff
s_mov_b32 s38, 2097152
s_mov_b32 s39, 0x00020000
s_waitcnt vmcnt(10)
s_barrier
s_add_u32 s69, s47, 15
s_and_b32 s69, s69, 15
s_mul_i32 s67, s69, 2048
s_mul_i32 s68, s69, s54
s_add_u32 m0, s70, 0
s_nop 0
buffer_load_dwordx4 v20, s[32:35], s67 offen offset:0 sc1 lds
buffer_load_dwordx4 v21, s[32:35], s67 offen offset:1024 sc1 lds
buffer_load_dwordx4 v22, s[32:35], s67 offen offset:2048 sc1 lds
buffer_load_dwordx4 v23, s[32:35], s67 offen offset:3072 sc1 lds
s_add_u32 s60, s71, 0
s_add_u32 m0, s60, 0
s_mov_b32 s61, s68
buffer_load_dwordx4 v26, s[28:31], s61 offen lds
buffer_load_dwordx4 v27, s[28:31], s61 offen offset:1024 lds
s_add_u32 m0, s60, 8192
s_add_u32 s61, s61, s53
buffer_load_dwordx4 v26, s[28:31], s61 offen lds
buffer_load_dwordx4 v27, s[28:31], s61 offen offset:1024 lds
s_add_u32 m0, s60, 16384
s_add_u32 s61, s61, s53
buffer_load_dwordx4 v26, s[28:31], s61 offen lds
buffer_load_dwordx4 v27, s[28:31], s61 offen offset:1024 lds
s_waitcnt vmcnt(10)
s_barrier
s_setprio 0
buffer_load_dword v33, v12, s[32:35], s73 offen sc1
buffer_load_dwordx4 v[80:83], v37, s[32:35], 0 offen offset:0 sc1
buffer_load_dwordx4 v[84:87], v37, s[32:35], 0 offen offset:1024 sc1
buffer_load_dwordx4 v[88:91], v37, s[32:35], 0 offen offset:2048 sc1
buffer_load_dwordx4 v[92:95], v37, s[32:35], 0 offen offset:3072 sc1
global_load_dword v48, v54, s[98:99]
s_add_u32 s48, s75, 15
s_and_b32 s48, s48, 15
s_mul_i32 s48, s48, s57
s_add_u32 m0, s71, 106496
s_nop 0
buffer_load_dwordx4 v28, s[36:39], s48 offen lds
buffer_load_dwordx4 v29, s[36:39], s48 offen offset:1024 lds
s_add_u32 s48, s75, 5
s_and_b32 s48, s48, 15
s_mul_i32 s48, s48, s57
s_add_u32 m0, s71, 24576
s_nop 0
buffer_load_dwordx4 v28, s[36:39], s48 offen lds
buffer_load_dwordx4 v29, s[36:39], s48 offen offset:1024 lds
s_add_u32 s48, s75, 6
s_and_b32 s48, s48, 15
s_mul_i32 s48, s48, s57
s_add_u32 m0, s71, 32768
s_nop 0
buffer_load_dwordx4 v28, s[36:39], s48 offen lds
buffer_load_dwordx4 v29, s[36:39], s48 offen offset:1024 lds
s_waitcnt vmcnt(12)
s_barrier
s_waitcnt vmcnt(7)
s_mov_b32 s63, 0
poll_53:
v_cmp_gt_u32 vcc, 16, v33
s_cbranch_vccz polled_54
buffer_load_dword v33, v12, s[32:35], s73 offen sc1
s_add_u32 s63, s63, 1
s_cmp_lt_u32 s63, 0x80000
s_waitcnt vmcnt(0)
s_cbranch_scc1 poll_53
polled_54:
s_add_u32 s48, s75, 7
s_and_b32 s48, s48, 15
s_mul_i32 s48, s48, s57
s_add_u32 m0, s71, 40960
s_nop 0
buffer_load_dwordx4 v28, s[36:39], s48 offen lds
v_add_f32 v80, v80, v88
v_add_f32 v81, v81, v89
v_add_f32 v82, v82, v90
v_add_f32 v83, v83, v91
v_add_f32 v84, v84, v92
buffer_load_dwordx4 v29, s[36:39], s48 offen offset:1024 lds
v_add_f32 v85, v85, v93
v_add_f32 v86, v86, v94
v_add_f32 v87, v87, v95
v_add_f32 v80, v80, v84
v_add_f32 v81, v81, v85
s_add_u32 s48, s75, 8
s_and_b32 s48, s48, 15
s_mul_i32 s48, s48, s57
s_add_u32 m0, s71, 49152
s_nop 0
buffer_load_dwordx4 v28, s[36:39], s48 offen lds
v_add_f32 v82, v82, v86
v_add_f32 v83, v83, v87
s_nop 1
v_permlane32_swap_b32 v80, v81
buffer_load_dwordx4 v29, s[36:39], s48 offen offset:1024 lds
v_permlane32_swap_b32 v82, v83
v_add_f32 v80, v80, v81
v_add_f32 v82, v82, v83
s_nop 1
v_permlane16_swap_b32 v80, v82
s_add_u32 s48, s75, 9
s_and_b32 s48, s48, 15
s_mul_i32 s48, s48, s57
s_add_u32 m0, s71, 57344
s_nop 0
buffer_load_dwordx4 v28, s[36:39], s48 offen lds
s_nop 0
v_add_f32 v80, v80, v82
v_cmp_u_f32 vcc, v80, v80
s_cbranch_vccnz again_50
summed_51:
buffer_load_dwordx4 v29, s[36:39], s48 offen offset:1024 lds
v_mul_f32 v44, 0x3a800000, v80
v_mov_b32 v45, v44
s_nop 1
v_permlane16_swap_b32 v44, v45
s_add_u32 s48, s75, 10
s_and_b32 s48, s48, 15
s_mul_i32 s48, s48, s57
s_add_u32 m0, s71, 65536
s_nop 0
buffer_load_dwordx4 v28, s[36:39], s48 offen lds
s_nop 0
v_fma_f32 v45, -v44, v44, v45
v_max_f32 v45, 0, v45
v_add_f32 v45, 0x3727c5ac, v45
v_rsq_f32 v46, v45
buffer_load_dwordx4 v29, s[36:39], s48 offen offset:1024 lds
v_sub_f32 v47, 0, v44
ds_write_b32 v50, v47 offset:512
ds_write_b64 v49, v[46:47]
ds_write_b32 v50, v46
s_setprio 0
s_waitcnt lgkmcnt(0)
s_waitcnt vmcnt(63)
s_barrier
s_waitcnt vmcnt(5)
s_add_u32 s48, s75, 11
s_and_b32 s48, s48, 15
s_mul_i32 s48, s48, s57
s_add_u32 m0, s71, 73728
s_nop 0
buffer_load_dwordx4 v28, s[36:39], s48 offen lds
buffer_load_dwordx4 v29, s[36:39], s48 offen offset:1024 lds
s_waitcnt vmcnt(5)
s_add_u32 s48, s75, 12
s_and_b32 s48, s48, 15
s_mul_i32 s48, s48, s57
s_add_u32 m0, s71, 81920
s_nop 0
buffer_load_dwordx4 v28, s[36:39], s48 offen lds
buffer_load_dwordx4 v29, s[36:39], s48 offen offset:1024 lds
s_waitcnt vmcnt(5)
s_add_u32 s48, s75, 13
s_and_b32 s48, s48, 15
s_mul_i32 s48, s48, s57
s_add_u32 m0, s71, 90112
s_nop 0
buffer_load_dwordx4 v28, s[36:39], s48 offen lds
buffer_load_dwordx4 v29, s[36:39], s48 offen offset:1024 lds
s_waitcnt vmcnt(5)
s_add_u32 s48, s75, 14
s_and_b32 s48, s48, 15
s_mul_i32 s48, s48, s57
s_add_u32 m0, s71, 98304
s_nop 0
buffer_load_dwordx4 v28, s[36:39], s48 offen lds
buffer_load_dwordx4 v29, s[36:39], s48 offen offset:1024 lds
s_waitcnt vmcnt(5)
s_add_u32 s48, s75, 0
s_and_b32 s48, s48, 15
s_mul_i32 s48, s48, s57
s_add_u32 m0, s71, 4294950912
s_nop 0
buffer_load_dwordx4 v28, s[36:39], s48 offen lds
buffer_load_dwordx4 v29, s[36:39], s48 offen offset:1024 lds
s_waitcnt vmcnt(5)
s_add_u32 s48, s75, 1
s_and_b32 s48, s48, 15
s_mul_i32 s48, s48, s57
s_add_u32 m0, s71, 4294959104
s_nop 0
buffer_load_dwordx4 v28, s[36:39], s48 offen lds
buffer_load_dwordx4 v29, s[36:39], s48 offen offset:1024 lds
s_waitcnt vmcnt(5)
s_add_u32 s48, s75, 2
s_and_b32 s48, s48, 15
s_mul_i32 s48, s48, s57
s_add_u32 m0, s71, 0
s_nop 0
buffer_load_dwordx4 v28, s[36:39], s48 offen lds
buffer_load_dwordx4 v29, s[36:39], s48 offen offset:1024 lds
s_waitcnt vmcnt(5)
s_add_u32 s48, s75, 3
s_and_b32 s48, s48, 15
s_mul_i32 s48, s48, s57
s_add_u32 m0, s71, 8192
s_nop 0
buffer_load_dwordx4 v28, s[36:39], s48 offen lds
buffer_load_dwordx4 v29, s[36:39], s48 offen offset:1024 lds
s_waitcnt vmcnt(5)
s_add_u32 s48, s75, 4
s_and_b32 s48, s48, 15
s_mul_i32 s48, s48, s57
s_add_u32 m0, s71, 16384
s_nop 0
buffer_load_dwordx4 v28, s[36:39], s48 offen lds
buffer_load_dwordx4 v29, s[36:39], s48 offen offset:1024 lds
s_waitcnt vmcnt(5)
buffer_load_dwordx4 v[240:243], v18, s[32:35], s81 offen offset:0 sc1
buffer_load_dwordx4 v[240:243], v18, s[32:35], s81 offen offset:1024 sc1
s_waitcnt vmcnt(5)
buffer_load_dwordx4 v[240:243], v18, s[32:35], s82 offen offset:0 sc1
buffer_load_dwordx4 v[240:243], v18, s[32:35], s82 offen offset:1024 sc1
s_waitcnt vmcnt(0) lgkmcnt(0)
s_barrier
L_end:
s_endpgm
L_compute:
s_lshr_b32 s48, s2, 2
s_and_b32 s48, s48, 1
s_lshl_b32 s48, s48, 1
s_add_u32 s48, s48, s74
s_and_b32 s49, s42, 3
s_xor_b32 s77, s48, s49
s_add_u32 s77, s77, 4
s_lshr_b32 s48, s77, 2
s_add_u32 s48, s47, s48
s_and_b32 s48, s48, 3
s_and_b32 s49, s77, 3
s_lshl_b32 s49, s49, 2
s_add_u32 s78, s48, s49
s_and_b32 s48, s2, 7
s_lshl_b32 s48, s48, 1
s_add_u32 s75, s78, s48
s_and_b32 s75, s75, 15
s_mov_b32 s46, 0
s_waitcnt lgkmcnt(0)
s_mov_b32 s32, s22
s_and_b32 s33, s23, 0xffff
s_mov_b32 s34, 268435456
s_mov_b32 s35, 0x00020000
s_mov_b32 s24, s18
s_and_b32 s25, s19, 0xffff
s_mov_b32 s26, 4194304
s_mov_b32 s27, 0x00020000
s_setprio 1
s_and_b32 s43, s40, 1
s_lshr_b32 s44, s40, 1
s_lshl_b32 s45, s42, 1
s_add_u32 s45, s45, s43
s_cmp_lg_u32 s40, 1
s_cbranch_scc1 else_55
s_getpc_b64 s[48:49]
L_pc:
s_sub_u32 s48, s48, L_pc - interleave_layers__sliding_local_dilated__linear_kernel_hedgehog__prompt_kernel
s_subb_u32 s49, s49, 0
s_lshr_b32 s50, s2, 3
s_lshl_b32 s50, s50, 12
v_lshl_add_u32 v8, v0, 6, s50
v_cmp_gt_u32 vcc, L_code_end - interleave_layers__sliding_local_dilated__linear_kernel_hedgehog__prompt_kernel, v8
s_and_saveexec_b64 s[50:51], vcc
s_cbranch_execz nopf_57
global_load_dword v254, v8, s[48:49]
nopf_57:
s_mov_b64 exec, -1
else_55:
s_lshl_b32 s48, s41, 3
s_lshl_b32 s49, s44, 2
s_add_u32 s48, s48, s49
s_lshl_b32 s48, s48, 5
s_add_u32 s48, s48, s45
s_lshl_b32 s48, s48, 10
s_add_u32 s80, s48, 4194304
s_add_u32 s81, s80, 32768
s_add_u32 s82, s80, 65536
s_add_u32 s83, s80, 98304
s_lshl_b32 s84, s41, 2
s_add_u32 s84, s84, s44
s_lshl_b32 s84, s84, 7
s_add_u32 s84, s84, 18350080
s_lshl_b32 s48, s41, 3
s_lshl_b32 s49, s40, 1
s_add_u32 s48, s48, s49
s_lshl_b32 s48, s48, 15
s_lshl_b32 s49, s78, 11
s_add_u32 s85, s48, s49
s_add_u32 s86, s85, 32768
s_lshl_b32 s50, s41, 2
s_add_u32 s50, s50, s40
s_lshl_b32 s50, s50, 4
s_add_u32 s50, s50, s42
s_lshl_b32 s50, s50, 8
s_add_u32 s87, s50, 16777216
s_lshl_b32 s88, s41, 2
s_add_u32 s88, s88, s40
s_lshl_b32 s88, s88, 7
s_add_u32 s88, s88, 18358272
v_lshrrev_b32 v4, 1, v3
v_lshl_add_u32 v4, v2, 2, v4
v_and_b32 v5, 1, v3
v_lshl_add_u32 v4, v5, 1, v4
v_lshlrev_b32 v1, 2, v4
s_lshl_b32 s48, s40, 2
s_add_u32 s48, s48, 134672
v_mov_b32 v10, s48
v_mov_b32 v11, 0
ds_write_b32 v10, v11
v_mov_b32 v140, -1
v_mov_b32 v141, -1
v_mov_b32 v142, -1
v_mov_b32 v143, -1
s_lshl_b32 s50, s42, 2
s_add_u32 s50, s50, s40
s_lshl_b32 s50, s50, 4
s_add_u32 s50, s50, s41
s_lshl_b32 s50, s50, 8
s_add_u32 s50, s50, 17825792
v_mov_b32 v4, s87
v_mov_b32 v5, s50
v_cmp_eq_u32 vcc, 0, v3
v_lshrrev_b32 v6, 1, v3
v_mul_u32_u24 v6, 262144, v6
v_add_u32 v5, v5, v6
v_cndmask_b32 v4, v5, v4, vcc
v_lshl_add_u32 v4, v2, 4, v4
buffer_store_dwordx4 v[140:143], v4, s[32:35], 0 offen sc1
s_lshl_b32 s48, s2, 2
s_add_u32 s49, s48, s40
s_lshl_b32 s48, s49, 10
s_add_u32 s48, s48, 8388608
buffer_store_dwordx4 v[140:143], v18, s[32:35], s48 offen sc1
s_and_b32 s48, s49, 7
s_cmp_lg_u32 s48, 0
s_cbranch_scc1 nofl_58
s_lshl_b32 s48, s49, 5
s_add_u32 s48, s48, 18350080
v_lshlrev_b32 v6, 2, v0
buffer_store_dword v11, v6, s[32:35], s48 offen sc1
nofl_58:
s_lshl_b32 s49, s44, 13
v_lshrrev_b32 v4, 1, v2
v_xor_b32 v4, v4, v3
v_lshlrev_b32 v4, 4, v4
v_lshl_add_u32 v10, v2, 7, v4
v_add_u32 v10, s49, v10
v_xor_b32 v11, 64, v10
s_lshl_b32 s48, s43, 1
v_lshrrev_b32 v4, 2, v2
v_and_b32 v5, 3, v0
v_lshl_add_u32 v6, v3, 3, v4
v_lshlrev_b32 v6, 7, v6
v_lshl_add_u32 v6, v5, 3, v6
v_lshrrev_b32 v7, 1, v4
v_and_b32 v8, 1, v3
v_lshl_add_u32 v7, v8, 1, v7
v_xor_b32 v7, s48, v7
v_lshl_add_u32 v12, v7, 5, v6
v_add_u32 v12, 16384, v12
v_xor_b32 v13, 32, v12
v_mov_b32 v14, v10
v_mov_b32 v15, v11
v_add_u32 v16, 0, v12
v_add_u32 v17, 0, v13
v_mov_b32 v156, 0
v_mov_b32 v157, 0
v_mov_b32 v158, 0
v_mov_b32 v159, 0
v_mov_b32 v160, 0
v_mov_b32 v161, 0
v_mov_b32 v162, 0
v_mov_b32 v163, 0
v_mov_b32 v164, 0
v_mov_b32 v165, 0
v_mov_b32 v166, 0
v_mov_b32 v167, 0
v_mov_b32 v168, 0
v_mov_b32 v169, 0
v_mov_b32 v170, 0
v_mov_b32 v171, 0
v_mov_b32 v172, 0
v_mov_b32 v173, 0
v_mov_b32 v174, 0
v_mov_b32 v175, 0
v_mov_b32 v176, 0
v_mov_b32 v177, 0
v_mov_b32 v178, 0
v_mov_b32 v179, 0
v_mov_b32 v180, 0
v_mov_b32 v181, 0
v_mov_b32 v182, 0
v_mov_b32 v183, 0
v_mov_b32 v184, 0
v_mov_b32 v185, 0
v_mov_b32 v186, 0
v_mov_b32 v187, 0
v_mov_b32 v188, 0
v_mov_b32 v189, 0
v_mov_b32 v190, 0
v_mov_b32 v191, 0
v_mov_b32 v192, 0
v_mov_b32 v193, 0
v_mov_b32 v194, 0
v_mov_b32 v195, 0
v_mov_b32 v196, 0
v_mov_b32 v197, 0
v_mov_b32 v198, 0
v_mov_b32 v199, 0
v_mov_b32 v200, 0
v_mov_b32 v201, 0
v_mov_b32 v202, 0
v_mov_b32 v203, 0
v_mov_b32 v204, 0
v_mov_b32 v205, 0
v_mov_b32 v206, 0
v_mov_b32 v207, 0
v_mov_b32 v208, 0
v_mov_b32 v209, 0
v_mov_b32 v210, 0
v_mov_b32 v211, 0
v_mov_b32 v212, 0
v_mov_b32 v213, 0
v_mov_b32 v214, 0
v_mov_b32 v215, 0
v_mov_b32 v216, 0
v_mov_b32 v217, 0
v_mov_b32 v218, 0
v_mov_b32 v219, 0
v_mov_b32 v220, 0
v_mov_b32 v221, 0
v_mov_b32 v222, 0
v_mov_b32 v223, 0
v_mov_b32 v224, 0
v_mov_b32 v225, 0
v_mov_b32 v226, 0
v_mov_b32 v227, 0
v_mov_b32 v228, 0
v_mov_b32 v229, 0
v_mov_b32 v230, 0
v_mov_b32 v231, 0
v_mov_b32 v232, 0
v_mov_b32 v233, 0
v_mov_b32 v234, 0
v_mov_b32 v235, 0
v_mov_b32 v236, 0
v_mov_b32 v237, 0
v_mov_b32 v238, 0
v_mov_b32 v239, 0
v_mov_b32 v240, 0
v_mov_b32 v241, 0
v_mov_b32 v242, 0
v_mov_b32 v243, 0
v_mov_b32 v244, 0
v_mov_b32 v245, 0
v_mov_b32 v246, 0
v_mov_b32 v247, 0
v_mov_b32 v248, 0
v_mov_b32 v249, 0
v_mov_b32 v250, 0
v_mov_b32 v251, 0
v_mov_b32 v48, 0x3f803f80
v_mov_b32 v49, 0x3f803f80
v_mov_b32 v50, 0x3f803f80
v_mov_b32 v51, 0x3f803f80
s_mov_b32 s48, 0xf149f2ca
v_mov_b32 v9, s48
v_lshlrev_b32 v4, 2, v3
v_sub_u32 v4, v2, v4
v_subrev_u32 v5, 0, v4
v_and_b32 v6, 0x80000001, v5
v_cmp_eq_u32 vcc, 0, v6
v_add_u32 v5, 1, v5
v_and_b32 v6, 0x80000001, v5
v_cndmask_b32 v40, v9, 0, vcc
v_cmp_eq_u32 vcc, 0x80000001, v6
s_nop 1
v_cndmask_b32 v36, v9, 0, vcc
v_subrev_u32 v5, 1, v4
v_and_b32 v6, 0x80000001, v5
v_cmp_eq_u32 vcc, 0, v6
v_add_u32 v5, 1, v5
v_and_b32 v6, 0x80000001, v5
v_cndmask_b32 v41, v9, 0, vcc
v_cmp_eq_u32 vcc, 0x80000001, v6
s_nop 1
v_cndmask_b32 v37, v9, 0, vcc
v_subrev_u32 v5, 2, v4
v_and_b32 v6, 0x80000001, v5
v_cmp_eq_u32 vcc, 0, v6
v_add_u32 v5, 1, v5
v_and_b32 v6, 0x80000001, v5
v_cndmask_b32 v42, v9, 0, vcc
v_cmp_eq_u32 vcc, 0x80000001, v6
s_nop 1
v_cndmask_b32 v38, v9, 0, vcc
v_subrev_u32 v5, 3, v4
v_and_b32 v6, 0x80000001, v5
v_cmp_eq_u32 vcc, 0, v6
v_add_u32 v5, 1, v5
v_and_b32 v6, 0x80000001, v5
v_cndmask_b32 v43, v9, 0, vcc
v_cmp_eq_u32 vcc, 0x80000001, v6
s_nop 1
v_cndmask_b32 v39, v9, 0, vcc
s_or_b32 s48, s41, s44
s_cmp_eq_u32 s48, 0
s_cselect_b64 vcc, -1, 0
v_cndmask_b32 v44, v36, v9, vcc
v_cndmask_b32 v45, v37, v9, vcc
v_cndmask_b32 v46, v38, v9, vcc
v_cndmask_b32 v47, v39, v9, vcc
v_and_b32 v4, 1, v2
v_lshlrev_b32 v4, 4, v4
v_mov_b32 v5, 0xffff
v_lshlrev_b32 v52, v4, v5
s_lshl_b32 s48, s43, 11
s_add_u32 s48, s48, 135168
v_add_u32 v53, s48, v18
v_lshl_add_u32 v55, v0, 3, s48
s_add_u32 s48, s41, s44
s_sub_u32 s48, s48, 1
s_lshl_b32 s49, s48, 1
s_add_u32 s49, s49, s43
s_lshl_b32 s49, s49, 11
s_mul_i32 s50, s42, 65536
s_add_u32 s49, s49, s50
s_add_u32 s49, s49, 8388608
s_cmp_lt_i32 s48, 0
s_cselect_b32 s49, 0xf0000000, s49
v_add_u32 v58, s49, v18
v_lshl_add_u32 v59, v0, 3, s49
s_lshl_b32 s48, s43, 2
s_add_u32 s48, s48, 134672
v_mov_b32 v19, s48
s_lshl_b32 s48, s43, 7
s_add_u32 s48, s48, 133120
v_lshl_add_u32 v7, v3, 4, s48
v_lshl_add_u32 v54, v2, 2, s48
s_lshl_b32 s49, s44, 6
v_add_u32 v8, s49, v2
v_lshlrev_b32 v8, 3, v8
v_add_u32 v8, 131072, v8
v_lshl_add_u32 v9, v3, 2, s49
v_lshlrev_b32 v9, 2, v9
v_add_u32 v9, 132096, v9
s_mov_b32 s64, 0
s_mov_b32 s65, 0
s_mov_b32 s66, 0x3e8293ee
s_mov_b32 s61, 1
s_lshl_b32 s50, s42, 2
s_add_u32 s50, s50, s40
s_lshl_b32 s50, s50, 4
s_add_u32 s50, s50, s41
s_lshl_b32 s50, s50, 8
s_add_u32 s52, s50, 17825792
v_lshrrev_b32 v4, 1, v2
v_lshrrev_b32 v5, 1, v3
v_xor_b32 v4, v4, v5
v_lshlrev_b32 v4, 4, v4
v_and_b32 v5, 1, v3
v_lshl_add_u32 v4, v5, 3, v4
v_lshl_add_u32 v4, v2, 7, v4
s_lshl_b32 s48, s40, 12
v_add_u32 v155, s48, v4
v_mov_b32 v152, 0
v_mov_b32 v153, 0
v_mov_b32 v56, 0
v_mov_b32 v57, 0
s_waitcnt vmcnt(0)
s_lshl_b32 s79, 1, s77
s_or_b32 s79, s79, 0
s_barrier
ds_read_b128 v[60:63], v14 offset:0
ds_read_b128 v[64:67], v14 offset:2048
ds_read_b128 v[68:71], v14 offset:4096
ds_read_b128 v[72:75], v14 offset:6144
ds_read_b64_tr_b16 v[84:85], v16 offset:8192
ds_read_b64_tr_b16 v[86:87], v16 offset:8704
ds_read_b64_tr_b16 v[88:89], v17 offset:8192
ds_read_b64_tr_b16 v[90:91], v17 offset:8704
ds_read_b64_tr_b16 v[92:93], v16 offset:16384
ds_read_b64_tr_b16 v[94:95], v16 offset:16896
ds_read_b64_tr_b16 v[96:97], v17 offset:16384
ds_read_b64_tr_b16 v[98:99], v17 offset:16896
ds_read_b64_tr_b16 v[76:77], v16 offset:0
ds_read_b64_tr_b16 v[78:79], v16 offset:512
ds_read_b64_tr_b16 v[80:81], v17 offset:0
ds_read_b64_tr_b16 v[82:83], v17 offset:512
s_waitcnt lgkmcnt(0)
c0_loop:
v_mfma_f32_16x16x32_bf16 v[212:215], v[84:87], v[72:75], v[212:215]
ds_read_b128 v[100:103], v15 offset:0
v_mfma_f32_16x16x32_bf16 v[204:207], v[84:87], v[68:71], v[204:207]
ds_read_b128 v[104:107], v15 offset:2048
v_mfma_f32_16x16x32_bf16 v[196:199], v[84:87], v[64:67], v[196:199]
ds_read_b128 v[108:111], v15 offset:4096
v_mfma_f32_16x16x32_bf16 v[188:191], v[84:87], v[60:63], v[188:191]
ds_read_b128 v[112:115], v15 offset:6144
v_mfma_f32_16x16x32_bf16 v[192:195], v[88:91], v[60:63], v[192:195]
ds_read_b64_tr_b16 v[124:125], v16 offset:12288
v_mfma_f32_16x16x32_bf16 v[200:203], v[88:91], v[64:67], v[200:203]
ds_read_b64_tr_b16 v[126:127], v16 offset:12800
v_mfma_f32_16x16x32_bf16 v[208:211], v[88:91], v[68:71], v[208:211]
ds_read_b64_tr_b16 v[128:129], v17 offset:12288
v_mfma_f32_16x16x32_bf16 v[216:219], v[88:91], v[72:75], v[216:219]
ds_read_b64_tr_b16 v[130:131], v17 offset:12800
v_mfma_f32_16x16x32_bf16 v[244:247], v[72:75], v[92:95], v[244:247]
ds_read_b64_tr_b16 v[132:133], v16 offset:20480
v_mfma_f32_16x16x32_bf16 v[248:251], v[72:75], v[96:99], v[248:251]
ds_read_b64_tr_b16 v[134:135], v16 offset:20992
v_mfma_f32_16x16x32_bf16 v[240:243], v[68:71], v[96:99], v[240:243]
ds_read_b64_tr_b16 v[136:137], v17 offset:20480
v_mfma_f32_16x16x32_bf16 v[236:239], v[68:71], v[92:95], v[236:239]
ds_read_b64_tr_b16 v[138:139], v17 offset:20992
v_mfma_f32_16x16x32_bf16 v[228:231], v[64:67], v[92:95], v[228:231]
ds_read_b64_tr_b16 v[116:117], v16 offset:4096
v_mfma_f32_16x16x32_bf16 v[232:235], v[64:67], v[96:99], v[232:235]
ds_read_b64_tr_b16 v[118:119], v16 offset:4608
v_mfma_f32_16x16x32_bf16 v[224:227], v[60:63], v[96:99], v[224:227]
ds_read_b64_tr_b16 v[120:121], v17 offset:4096
v_mfma_f32_16x16x32_bf16 v[220:223], v[60:63], v[92:95], v[220:223]
ds_read_b64_tr_b16 v[122:123], v17 offset:4608
v_mfma_f32_16x16x32_bf16 v[156:159], v[76:79], v[60:63], v[156:159]
s_bitcmp1_b32 s79, s64
s_cbranch_scc1 c0_hook
c0_hook_ret:
v_mfma_f32_16x16x32_bf16 v[164:167], v[76:79], v[64:67], v[164:167]
s_add_u32 s65, s65, 40960
s_cmp_eq_u32 s65, 122880
v_mfma_f32_16x16x32_bf16 v[172:175], v[76:79], v[68:71], v[172:175]
s_cselect_b32 s65, 0, s65
s_add_u32 s64, s64, 1
v_mfma_f32_16x16x32_bf16 v[180:183], v[76:79], v[72:75], v[180:183]
v_add_u32 v14, s65, v10
v_add_u32 v15, s65, v11
v_mfma_f32_16x16x32_bf16 v[184:187], v[80:83], v[72:75], v[184:187]
v_add_u32 v16, s65, v12
v_add_u32 v17, s65, v13
v_mfma_f32_16x16x32_bf16 v[176:179], v[80:83], v[68:71], v[176:179]
s_cmp_eq_u32 s64, 16
s_cbranch_scc1 c0_last
v_mfma_f32_16x16x32_bf16 v[168:171], v[80:83], v[64:67], v[168:171]
s_waitcnt lgkmcnt(0)
v_mfma_f32_16x16x32_bf16 v[160:163], v[80:83], v[60:63], v[160:163]
s_barrier
v_mfma_f32_16x16x32_bf16 v[212:215], v[124:127], v[112:115], v[212:215]
ds_read_b128 v[60:63], v14 offset:0
v_mfma_f32_16x16x32_bf16 v[204:207], v[124:127], v[108:111], v[204:207]
ds_read_b128 v[64:67], v14 offset:2048
v_mfma_f32_16x16x32_bf16 v[196:199], v[124:127], v[104:107], v[196:199]
ds_read_b128 v[68:71], v14 offset:4096
v_mfma_f32_16x16x32_bf16 v[188:191], v[124:127], v[100:103], v[188:191]
ds_read_b128 v[72:75], v14 offset:6144
v_mfma_f32_16x16x32_bf16 v[192:195], v[128:131], v[100:103], v[192:195]
ds_read_b64_tr_b16 v[84:85], v16 offset:8192
v_mfma_f32_16x16x32_bf16 v[200:203], v[128:131], v[104:107], v[200:203]
ds_read_b64_tr_b16 v[86:87], v16 offset:8704
v_mfma_f32_16x16x32_bf16 v[208:211], v[128:131], v[108:111], v[208:211]
ds_read_b64_tr_b16 v[88:89], v17 offset:8192
v_mfma_f32_16x16x32_bf16 v[216:219], v[128:131], v[112:115], v[216:219]
ds_read_b64_tr_b16 v[90:91], v17 offset:8704
v_mfma_f32_16x16x32_bf16 v[244:247], v[112:115], v[132:135], v[244:247]
ds_read_b64_tr_b16 v[92:93], v16 offset:16384
v_mfma_f32_16x16x32_bf16 v[248:251], v[112:115], v[136:139], v[248:251]
ds_read_b64_tr_b16 v[94:95], v16 offset:16896
v_mfma_f32_16x16x32_bf16 v[240:243], v[108:111], v[136:139], v[240:243]
ds_read_b64_tr_b16 v[96:97], v17 offset:16384
v_mfma_f32_16x16x32_bf16 v[236:239], v[108:111], v[132:135], v[236:239]
ds_read_b64_tr_b16 v[98:99], v17 offset:16896
v_mfma_f32_16x16x32_bf16 v[228:231], v[104:107], v[132:135], v[228:231]
ds_read_b64_tr_b16 v[76:77], v16 offset:0
v_mfma_f32_16x16x32_bf16 v[232:235], v[104:107], v[136:139], v[232:235]
ds_read_b64_tr_b16 v[78:79], v16 offset:512
v_mfma_f32_16x16x32_bf16 v[224:227], v[100:103], v[136:139], v[224:227]
ds_read_b64_tr_b16 v[80:81], v17 offset:0
v_mfma_f32_16x16x32_bf16 v[220:223], v[100:103], v[132:135], v[220:223]
ds_read_b64_tr_b16 v[82:83], v17 offset:512
v_mfma_f32_16x16x32_bf16 v[156:159], v[116:119], v[100:103], v[156:159]
v_mfma_f32_16x16x32_bf16 v[164:167], v[116:119], v[104:107], v[164:167]
v_mfma_f32_16x16x32_bf16 v[172:175], v[116:119], v[108:111], v[172:175]
v_mfma_f32_16x16x32_bf16 v[180:183], v[116:119], v[112:115], v[180:183]
v_mfma_f32_16x16x32_bf16 v[184:187], v[120:123], v[112:115], v[184:187]
v_mfma_f32_16x16x32_bf16 v[176:179], v[120:123], v[108:111], v[176:179]
v_mfma_f32_16x16x32_bf16 v[168:171], v[120:123], v[104:107], v[168:171]
s_waitcnt lgkmcnt(0)
v_mfma_f32_16x16x32_bf16 v[160:163], v[120:123], v[100:103], v[160:163]
s_branch c0_loop
c0_hook:
v_add_u32 v4, s65, v155
ds_read_b64 v[20:21], v4 offset:0
ds_read_b64 v[28:29], v4 offset:2048
v_xor_b32 v5, 32, v4
ds_read_b64 v[22:23], v5 offset:0
ds_read_b64 v[30:31], v5 offset:2048
v_xor_b32 v5, 64, v4
ds_read_b64 v[24:25], v5 offset:0
ds_read_b64 v[32:33], v5 offset:2048
v_xor_b32 v5, 96, v4
ds_read_b64 v[26:27], v5 offset:0
ds_read_b64 v[34:35], v5 offset:2048
s_waitcnt lgkmcnt(8)
s_cmp_lg_u32 s44, 0
s_cbranch_scc1 else_59
v_mfma_f32_16x16x32_bf16 v[140:143], v[48:51], v[76:79], 0
v_mfma_f32_16x16x32_bf16 v[144:147], v[48:51], v[84:87], 0
v_mfma_f32_16x16x32_bf16 v[148:151], v[48:51], v[92:95], 0
v_mfma_f32_16x16x32_bf16 v[140:143], v[48:51], v[116:119], v[140:143]
v_mfma_f32_16x16x32_bf16 v[144:147], v[48:51], v[124:127], v[144:147]
v_mfma_f32_16x16x32_bf16 v[148:151], v[48:51], v[132:135], v[148:151]
s_branch fi_60
else_59:
v_mfma_f32_16x16x32_bf16 v[140:143], v[48:51], v[80:83], 0
v_mfma_f32_16x16x32_bf16 v[144:147], v[48:51], v[88:91], 0
v_mfma_f32_16x16x32_bf16 v[148:151], v[48:51], v[96:99], 0
v_mfma_f32_16x16x32_bf16 v[140:143], v[48:51], v[120:123], v[140:143]
v_mfma_f32_16x16x32_bf16 v[144:147], v[48:51], v[128:131], v[144:147]
v_mfma_f32_16x16x32_bf16 v[148:151], v[48:51], v[136:139], v[148:151]
fi_60:
s_waitcnt lgkmcnt(0)
v_dot2c_f32_bf16 v152, v20, v48
v_dot2c_f32_bf16 v56, v20, v20
v_dot2c_f32_bf16 v153, v28, v48
v_dot2c_f32_bf16 v57, v28, v28
v_dot2c_f32_bf16 v152, v21, v48
v_dot2c_f32_bf16 v56, v21, v21
v_dot2c_f32_bf16 v153, v29, v48
v_dot2c_f32_bf16 v57, v29, v29
v_dot2c_f32_bf16 v152, v22, v48
v_dot2c_f32_bf16 v56, v22, v22
v_dot2c_f32_bf16 v153, v30, v48
v_dot2c_f32_bf16 v57, v30, v30
v_dot2c_f32_bf16 v152, v23, v48
v_dot2c_f32_bf16 v56, v23, v23
v_dot2c_f32_bf16 v153, v31, v48
v_dot2c_f32_bf16 v57, v31, v31
v_dot2c_f32_bf16 v152, v24, v48
v_dot2c_f32_bf16 v56, v24, v24
v_dot2c_f32_bf16 v153, v32, v48
v_dot2c_f32_bf16 v57, v32, v32
v_dot2c_f32_bf16 v152, v25, v48
v_dot2c_f32_bf16 v56, v25, v25
v_dot2c_f32_bf16 v153, v33, v48
v_dot2c_f32_bf16 v57, v33, v33
v_dot2c_f32_bf16 v152, v26, v48
v_dot2c_f32_bf16 v56, v26, v26
v_dot2c_f32_bf16 v153, v34, v48
v_dot2c_f32_bf16 v57, v34, v34
v_dot2c_f32_bf16 v152, v27, v48
v_dot2c_f32_bf16 v56, v27, v27
v_dot2c_f32_bf16 v153, v35, v48
v_dot2c_f32_bf16 v57, v35, v35
v_cmp_eq_u32 vcc, 0, v3
v_cmp_eq_u32 s[48:49], 1, v3
s_nop 1
v_cndmask_b32 v4, v148, v144, s[48:49]
v_cndmask_b32 v4, v4, v140, vcc
buffer_store_dword v4, v1, s[32:35], s52 offen sc1
s_nop 1
v_permlane32_swap_b32 v152, v153
v_permlane32_swap_b32 v56, v57
v_add_f32 v152, v152, v153
v_add_f32 v56, v56, v57
s_nop 1
v_permlane16_swap_b32 v152, v56
s_nop 0
v_add_f32 v152, v152, v56
buffer_store_dword v152, v1, s[32:35], s87 offen sc1
s_branch c0_hook_ret
c0_last:
v_mfma_f32_16x16x32_bf16 v[168:171], v[80:83], v[64:67], v[168:171]
s_waitcnt lgkmcnt(0)
v_mfma_f32_16x16x32_bf16 v[160:163], v[80:83], v[60:63], v[160:163]
v_mfma_f32_16x16x32_bf16 v[212:215], v[124:127], v[112:115], v[212:215]
v_mfma_f32_16x16x32_bf16 v[204:207], v[124:127], v[108:111], v[204:207]
v_mfma_f32_16x16x32_bf16 v[196:199], v[124:127], v[104:107], v[196:199]
v_mfma_f32_16x16x32_bf16 v[188:191], v[124:127], v[100:103], v[188:191]
v_mfma_f32_16x16x32_bf16 v[192:195], v[128:131], v[100:103], v[192:195]
v_mfma_f32_16x16x32_bf16 v[200:203], v[128:131], v[104:107], v[200:203]
v_mfma_f32_16x16x32_bf16 v[208:211], v[128:131], v[108:111], v[208:211]
v_mfma_f32_16x16x32_bf16 v[216:219], v[128:131], v[112:115], v[216:219]
s_barrier
v_mfma_f32_16x16x32_bf16 v[244:247], v[112:115], v[132:135], v[244:247]
ds_read_b128 v[140:143], v7 offset:0
ds_read_b128 v[144:147], v7 offset:64
v_mfma_f32_16x16x32_bf16 v[248:251], v[112:115], v[136:139], v[248:251]
ds_read_b128 v[148:151], v7 offset:256
ds_read_b128 v[152:155], v7 offset:320
v_mfma_f32_16x16x32_bf16 v[240:243], v[108:111], v[136:139], v[240:243]
ds_read_b64 v[92:93], v8 offset:0
ds_read_b64 v[94:95], v8 offset:128
v_mfma_f32_16x16x32_bf16 v[236:239], v[108:111], v[132:135], v[236:239]
ds_read_b64 v[96:97], v8 offset:256
ds_read_b64 v[98:99], v8 offset:384
v_mfma_f32_16x16x32_bf16 v[228:231], v[104:107], v[132:135], v[228:231]
ds_read2_b32 v[56:57], v54 offset0:128 offset1:144
ds_read_b128 v[60:63], v9 offset:0
v_mfma_f32_16x16x32_bf16 v[232:235], v[104:107], v[136:139], v[232:235]
ds_read_b128 v[64:67], v9 offset:64
v_mfma_f32_16x16x32_bf16 v[224:227], v[100:103], v[136:139], v[224:227]
ds_read_b128 v[68:71], v9 offset:128
v_mfma_f32_16x16x32_bf16 v[220:223], v[100:103], v[132:135], v[220:223]
ds_read_b128 v[72:75], v9 offset:192
v_mfma_f32_16x16x32_bf16 v[156:159], v[116:119], v[100:103], v[156:159]
ds_read_b128 v[76:79], v9 offset:512
v_mfma_f32_16x16x32_bf16 v[164:167], v[116:119], v[104:107], v[164:167]
ds_read_b128 v[80:83], v9 offset:576
v_mfma_f32_16x16x32_bf16 v[172:175], v[116:119], v[108:111], v[172:175]
ds_read_b128 v[84:87], v9 offset:640
v_mfma_f32_16x16x32_bf16 v[180:183], v[116:119], v[112:115], v[180:183]
ds_read_b128 v[88:91], v9 offset:704
v_mfma_f32_16x16x32_bf16 v[184:187], v[120:123], v[112:115], v[184:187]
v_mov_b32 v6, 134656
ds_read_b32 v6, v6
v_mfma_f32_16x16x32_bf16 v[176:179], v[120:123], v[108:111], v[176:179]
v_mfma_f32_16x16x32_bf16 v[168:171], v[120:123], v[104:107], v[168:171]
v_mfma_f32_16x16x32_bf16 v[160:163], v[120:123], v[100:103], v[160:163]
c0_epi:
s_waitcnt lgkmcnt(0)
v_readfirstlane_b32 s46, v6
.p2align 3
v_pk_fma_f32 v[212:213], v[148:149], v[98:99], v[212:213] op_sel:[0,1,0] op_sel_hi:[1,1,1]
v_pk_fma_f32 v[214:215], v[150:151], v[98:99], v[214:215] op_sel:[0,1,0] op_sel_hi:[1,1,1]
v_pk_fma_f32 v[216:217], v[152:153], v[98:99], v[216:217] op_sel:[0,1,0] op_sel_hi:[1,1,1]
v_pk_fma_f32 v[218:219], v[154:155], v[98:99], v[218:219] op_sel:[0,1,0] op_sel_hi:[1,1,1]
v_pk_mul_f32 v[212:213], v[212:213], v[98:99] op_sel:[0,0] op_sel_hi:[1,0]
v_pk_mul_f32 v[214:215], v[214:215], v[98:99] op_sel:[0,0] op_sel_hi:[1,0]
v_pk_mul_f32 v[216:217], v[216:217], v[98:99] op_sel:[0,0] op_sel_hi:[1,0]
v_pk_mul_f32 v[218:219], v[218:219], v[98:99] op_sel:[0,0] op_sel_hi:[1,0]
v_cvt_pk_bf16_f32 v212, v212, v213
v_cvt_pk_bf16_f32 v213, v214, v215
v_cvt_pk_bf16_f32 v214, v216, v217
v_cvt_pk_bf16_f32 v215, v218, v219
v_pk_fma_f32 v[244:245], v[88:89], v[56:57], v[244:245] op_sel:[0,0,0] op_sel_hi:[1,0,1]
v_pk_fma_f32 v[246:247], v[90:91], v[56:57], v[246:247] op_sel:[0,0,0] op_sel_hi:[1,0,1]
v_pk_mul_f32 v[244:245], v[244:245], v[72:73]
v_pk_mul_f32 v[246:247], v[246:247], v[74:75]
v_cvt_pk_bf16_f32 v108, v244, v245
v_cvt_pk_bf16_f32 v109, v246, v247
v_pk_fma_f32 v[248:249], v[88:89], v[56:57], v[248:249] op_sel:[0,1,0] op_sel_hi:[1,1,1]
v_pk_fma_f32 v[250:251], v[90:91], v[56:57], v[250:251] op_sel:[0,1,0] op_sel_hi:[1,1,1]
v_pk_mul_f32 v[248:249], v[248:249], v[72:73]
v_pk_mul_f32 v[250:251], v[250:251], v[74:75]
v_cvt_pk_bf16_f32 v118, v248, v249
v_cvt_pk_bf16_f32 v119, v250, v251
s_cmp_lg_u32 s44, 1
s_cbranch_scc1 else_61
buffer_store_dwordx4 v[212:215], v58, s[32:35], 0 offen sc1
buffer_store_dwordx2 v[108:109], v59, s[32:35], 0 offen offset:1024 sc1
buffer_store_dwordx2 v[118:119], v59, s[32:35], 0 offen offset:1536 sc1
s_branch fi_62
else_61:
ds_write_b128 v53, v[212:215]
ds_write_b64 v55, v[108:109] offset:1024
ds_write_b64 v55, v[118:119] offset:1536
v_mov_b32 v4, 1
ds_write_b32 v19, v4
fi_62:
.p2align 3
v_pk_fma_f32 v[188:189], v[148:149], v[92:93], v[188:189] op_sel:[0,1,0] op_sel_hi:[1,1,1]
v_pk_fma_f32 v[196:197], v[148:149], v[94:95], v[196:197] op_sel:[0,1,0] op_sel_hi:[1,1,1]
v_pk_fma_f32 v[204:205], v[148:149], v[96:97], v[204:205] op_sel:[0,1,0] op_sel_hi:[1,1,1]
v_pk_fma_f32 v[164:165], v[140:141], v[94:95], v[164:165] op_sel:[0,1,0] op_sel_hi:[1,1,1]
v_pk_fma_f32 v[172:173], v[140:141], v[96:97], v[172:173] op_sel:[0,1,0] op_sel_hi:[1,1,1]
v_pk_fma_f32 v[180:181], v[140:141], v[98:99], v[180:181] op_sel:[0,1,0] op_sel_hi:[1,1,1]
v_pk_fma_f32 v[190:191], v[150:151], v[92:93], v[190:191] op_sel:[0,1,0] op_sel_hi:[1,1,1]
v_pk_mul_f32 v[188:189], v[188:189], v[92:93] op_sel:[0,0] op_sel_hi:[1,0]
v_pk_fma_f32 v[198:199], v[150:151], v[94:95], v[198:199] op_sel:[0,1,0] op_sel_hi:[1,1,1]
v_pk_mul_f32 v[196:197], v[196:197], v[94:95] op_sel:[0,0] op_sel_hi:[1,0]
v_pk_fma_f32 v[206:207], v[150:151], v[96:97], v[206:207] op_sel:[0,1,0] op_sel_hi:[1,1,1]
v_pk_mul_f32 v[204:205], v[204:205], v[96:97] op_sel:[0,0] op_sel_hi:[1,0]
v_pk_fma_f32 v[166:167], v[142:143], v[94:95], v[166:167] op_sel:[0,1,0] op_sel_hi:[1,1,1]
v_cvt_pk_bf16_f32 v164, v164, v165
v_pk_fma_f32 v[174:175], v[142:143], v[96:97], v[174:175] op_sel:[0,1,0] op_sel_hi:[1,1,1]
v_cvt_pk_bf16_f32 v172, v172, v173
v_pk_fma_f32 v[182:183], v[142:143], v[98:99], v[182:183] op_sel:[0,1,0] op_sel_hi:[1,1,1]
v_cvt_pk_bf16_f32 v180, v180, v181
v_pk_fma_f32 v[192:193], v[152:153], v[92:93], v[192:193] op_sel:[0,1,0] op_sel_hi:[1,1,1]
v_pk_fma_f32 v[194:195], v[154:155], v[92:93], v[194:195] op_sel:[0,1,0] op_sel_hi:[1,1,1]
v_pk_mul_f32 v[190:191], v[190:191], v[92:93] op_sel:[0,0] op_sel_hi:[1,0]
v_cvt_pk_bf16_f32 v188, v188, v189
v_pk_fma_f32 v[200:201], v[152:153], v[94:95], v[200:201] op_sel:[0,1,0] op_sel_hi:[1,1,1]
v_pk_fma_f32 v[202:203], v[154:155], v[94:95], v[202:203] op_sel:[0,1,0] op_sel_hi:[1,1,1]
v_pk_mul_f32 v[198:199], v[198:199], v[94:95] op_sel:[0,0] op_sel_hi:[1,0]
v_cvt_pk_bf16_f32 v196, v196, v197
v_pk_fma_f32 v[208:209], v[152:153], v[96:97], v[208:209] op_sel:[0,1,0] op_sel_hi:[1,1,1]
v_pk_fma_f32 v[210:211], v[154:155], v[96:97], v[210:211] op_sel:[0,1,0] op_sel_hi:[1,1,1]
v_pk_mul_f32 v[206:207], v[206:207], v[96:97] op_sel:[0,0] op_sel_hi:[1,0]
v_cvt_pk_bf16_f32 v204, v204, v205
v_pk_fma_f32 v[168:169], v[144:145], v[94:95], v[168:169] op_sel:[0,1,0] op_sel_hi:[1,1,1]
v_pk_fma_f32 v[170:171], v[146:147], v[94:95], v[170:171] op_sel:[0,1,0] op_sel_hi:[1,1,1]
v_cvt_pk_bf16_f32 v165, v166, v167
v_pk_fma_f32 v[176:177], v[144:145], v[96:97], v[176:177] op_sel:[0,1,0] op_sel_hi:[1,1,1]
v_pk_fma_f32 v[178:179], v[146:147], v[96:97], v[178:179] op_sel:[0,1,0] op_sel_hi:[1,1,1]
v_cvt_pk_bf16_f32 v173, v174, v175
v_pk_fma_f32 v[184:185], v[144:145], v[98:99], v[184:185] op_sel:[0,1,0] op_sel_hi:[1,1,1]
v_pk_fma_f32 v[186:187], v[146:147], v[98:99], v[186:187] op_sel:[0,1,0] op_sel_hi:[1,1,1]
v_cvt_pk_bf16_f32 v181, v182, v183
v_pk_mul_f32 v[192:193], v[192:193], v[92:93] op_sel:[0,0] op_sel_hi:[1,0]
v_pk_mul_f32 v[194:195], v[194:195], v[92:93] op_sel:[0,0] op_sel_hi:[1,0]
v_cvt_pk_bf16_f32 v189, v190, v191
v_pk_mul_f32 v[200:201], v[200:201], v[94:95] op_sel:[0,0] op_sel_hi:[1,0]
v_pk_mul_f32 v[202:203], v[202:203], v[94:95] op_sel:[0,0] op_sel_hi:[1,0]
v_cvt_pk_bf16_f32 v197, v198, v199
v_pk_mul_f32 v[208:209], v[208:209], v[96:97] op_sel:[0,0] op_sel_hi:[1,0]
v_pk_mul_f32 v[210:211], v[210:211], v[96:97] op_sel:[0,0] op_sel_hi:[1,0]
v_cvt_pk_bf16_f32 v205, v206, v207
v_cvt_pk_bf16_f32 v166, v168, v169
v_cvt_pk_bf16_f32 v167, v170, v171
v_cvt_pk_bf16_f32 v174, v176, v177
v_cvt_pk_bf16_f32 v175, v178, v179
v_cvt_pk_bf16_f32 v182, v184, v185
v_cvt_pk_bf16_f32 v183, v186, v187
v_cvt_pk_bf16_f32 v190, v192, v193
v_cvt_pk_bf16_f32 v191, v194, v195
v_mfma_f32_16x16x32_bf16 v[216:219], v[212:215], v[180:183], v[40:43]
v_cvt_pk_bf16_f32 v198, v200, v201
v_cvt_pk_bf16_f32 v199, v202, v203
v_mfma_f32_16x16x32_bf16 v[168:171], v[188:191], v[164:167], v[36:39]
v_cvt_pk_bf16_f32 v206, v208, v209
v_cvt_pk_bf16_f32 v207, v210, v211
v_mfma_f32_16x16x32_bf16 v[200:203], v[196:199], v[164:167], v[40:43]
v_mul_f32 v124, s66, v92
v_mul_f32 v125, s66, v94
v_mfma_f32_16x16x32_bf16 v[208:211], v[204:207], v[172:175], v[40:43]
v_mul_f32 v126, s66, v96
v_mul_f32 v127, s66, v98
v_mfma_f32_16x16x32_bf16 v[176:179], v[196:199], v[172:175], v[36:39]
v_max_f32 v164, v168, v169
v_max_f32 v165, v170, v171
v_mfma_f32_16x16x32_bf16 v[184:187], v[204:207], v[180:183], v[36:39]
v_max_f32 v166, v200, v201
v_max_f32 v182, v216, v217
v_max_f32 v174, v208, v209
v_max_f32 v167, v202, v203
v_max3_f32 v129, v164, v165, v166
v_pk_fma_f32 v[156:157], v[140:141], v[92:93], v[156:157] op_sel:[0,1,0] op_sel_hi:[1,1,1]
v_pk_fma_f32 v[158:159], v[142:143], v[92:93], v[158:159] op_sel:[0,1,0] op_sel_hi:[1,1,1]
v_cvt_pk_bf16_f32 v156, v156, v157
v_pk_fma_f32 v[160:161], v[144:145], v[92:93], v[160:161] op_sel:[0,1,0] op_sel_hi:[1,1,1]
v_pk_fma_f32 v[162:163], v[146:147], v[92:93], v[162:163] op_sel:[0,1,0] op_sel_hi:[1,1,1]
v_cvt_pk_bf16_f32 v157, v158, v159
v_cvt_pk_bf16_f32 v158, v160, v161
v_cvt_pk_bf16_f32 v159, v162, v163
v_pk_fma_f32 v[220:221], v[76:77], v[56:57], v[220:221] op_sel:[0,0,0] op_sel_hi:[1,0,1]
v_pk_fma_f32 v[222:223], v[78:79], v[56:57], v[222:223] op_sel:[0,0,0] op_sel_hi:[1,0,1]
v_mfma_f32_16x16x32_bf16 v[192:195], v[188:191], v[156:159], v[40:43]
v_max_f32 v172, v176, v177
v_max_f32 v173, v178, v179
v_max_f32 v180, v184, v185
v_max_f32 v181, v186, v187
v_max_f32_e64 v175, v210, v211
v_pk_fma_f32 v[224:225], v[76:77], v[56:57], v[224:225] op_sel:[0,1,0] op_sel_hi:[1,1,1]
v_pk_fma_f32 v[226:227], v[78:79], v[56:57], v[226:227] op_sel:[0,1,0] op_sel_hi:[1,1,1]
v_pk_fma_f32 v[228:229], v[80:81], v[56:57], v[228:229] op_sel:[0,0,0] op_sel_hi:[1,0,1]
v_pk_fma_f32 v[230:231], v[82:83], v[56:57], v[230:231] op_sel:[0,0,0] op_sel_hi:[1,0,1]
v_pk_fma_f32 v[232:233], v[80:81], v[56:57], v[232:233] op_sel:[0,1,0] op_sel_hi:[1,1,1]
v_pk_fma_f32 v[234:235], v[82:83], v[56:57], v[234:235] op_sel:[0,1,0] op_sel_hi:[1,1,1]
v_pk_fma_f32 v[236:237], v[84:85], v[56:57], v[236:237] op_sel:[0,0,0] op_sel_hi:[1,0,1]
v_pk_fma_f32 v[238:239], v[86:87], v[56:57], v[238:239] op_sel:[0,0,0] op_sel_hi:[1,0,1]
v_pk_fma_f32 v[240:241], v[84:85], v[56:57], v[240:241] op_sel:[0,1,0] op_sel_hi:[1,1,1]
v_pk_fma_f32 v[242:243], v[86:87], v[56:57], v[242:243] op_sel:[0,1,0] op_sel_hi:[1,1,1]
v_pk_mul_f32 v[220:221], v[220:221], v[60:61]
v_pk_mul_f32 v[222:223], v[222:223], v[62:63]
v_pk_mul_f32 v[224:225], v[224:225], v[60:61]
s_cmp_lg_u32 s44, 0
s_cbranch_scc1 else_63
buffer_load_dwordx4 v[120:123], v58, s[32:35], 0 offen sc1
buffer_load_dwordx2 v[100:101], v59, s[32:35], 0 offen offset:1024 sc1
buffer_load_dwordx2 v[110:111], v59, s[32:35], 0 offen offset:1536 sc1
else_63:
v_pk_mul_f32 v[226:227], v[226:227], v[62:63]
v_pk_mul_f32 v[228:229], v[228:229], v[64:65]
v_pk_mul_f32 v[230:231], v[230:231], v[66:67]
v_pk_mul_f32 v[232:233], v[232:233], v[64:65]
v_pk_mul_f32 v[234:235], v[234:235], v[66:67]
v_pk_mul_f32 v[236:237], v[236:237], v[68:69]
v_pk_mul_f32 v[238:239], v[238:239], v[70:71]
v_pk_mul_f32 v[240:241], v[240:241], v[68:69]
v_pk_mul_f32 v[242:243], v[242:243], v[70:71]
v_max3_f32 v130, v172, v173, v174
v_max_f32_e64 v183, v218, v219
v_max3_f32 v131, v180, v181, v182
v_cvt_pk_bf16_f32 v102, v220, v221
v_cvt_pk_bf16_f32 v103, v222, v223
v_cvt_pk_bf16_f32 v112, v224, v225
v_cvt_pk_bf16_f32 v113, v226, v227
v_cvt_pk_bf16_f32 v104, v228, v229
v_cvt_pk_bf16_f32 v105, v230, v231
v_cvt_pk_bf16_f32 v114, v232, v233
v_cvt_pk_bf16_f32 v115, v234, v235
v_cvt_pk_bf16_f32 v106, v236, v237
v_cvt_pk_bf16_f32 v107, v238, v239
v_cvt_pk_bf16_f32 v116, v240, v241
v_cvt_pk_bf16_f32 v117, v242, v243
v_max_f32 v129, v129, v167
v_max_f32 v130, v130, v175
v_max_f32 v131, v131, v183
s_cmp_lg_u32 s44, 0
s_cbranch_scc1 else_65
s_mov_b32 s63, 0
sent_67:
s_waitcnt vmcnt(0)
v_max_u32 v4, v120, v121
v_max3_u32 v4, v4, v122, v123
v_max3_u32 v4, v4, v100, v101
v_max3_u32 v4, v4, v110, v111
v_cmp_eq_u32 vcc, -1, v4
s_cbranch_vccz sentd_68
buffer_load_dwordx4 v[120:123], v58, s[32:35], 0 offen sc1
buffer_load_dwordx2 v[100:101], v59, s[32:35], 0 offen offset:1024 sc1
buffer_load_dwordx2 v[110:111], v59, s[32:35], 0 offen offset:1536 sc1
s_add_u32 s63, s63, 1
s_cmp_lt_u32 s63, 0x80000
s_cbranch_scc1 sent_67
s_waitcnt vmcnt(0)
sentd_68:
v_mov_b32 v132, -1
v_mov_b32 v133, -1
v_mov_b32 v134, -1
v_mov_b32 v135, -1
buffer_store_dwordx4 v[132:135], v58, s[32:35], 0 offen offset:0 sc1
buffer_store_dwordx4 v[132:135], v58, s[32:35], 0 offen offset:1024 sc1
s_branch fi_66
else_65:
s_mov_b32 s63, 0
px_69:
ds_read_b32 v4, v19
ds_read_b128 v[120:123], v53
ds_read_b64 v[100:101], v55 offset:1024
ds_read_b64 v[110:111], v55 offset:1536
s_add_u32 s63, s63, 1
s_cmp_lt_u32 s63, 0x400000
s_waitcnt lgkmcnt(0)
v_cmp_ne_u32 vcc, 1, v4
s_cbranch_vccz pxd_70
s_cbranch_scc1 px_69
pxd_70:
fi_66:
s_cmp_eq_u32 s46, 0
s_cbranch_scc1 slow_71
.p2align 3
v_mfma_f32_16x16x32_bf16 v[160:163], v[120:123], v[156:159], v[44:47]
v_max_f32 v158, v192, v193
v_max_f32 v159, v194, v195
v_permlane32_swap_b32 v130, v131
s_nop 0
v_max_f32 v130, v130, v131
s_nop 2
v_max_f32 v156, v160, v161
v_max_f32 v157, v162, v163
v_max3_f32 v128, v156, v157, v158
v_max_f32 v128, v128, v159
s_nop 1
v_permlane32_swap_b32 v128, v129
s_nop 0
v_max_f32 v128, v128, v129
s_nop 1
v_permlane16_swap_b32 v128, v130
s_nop 0
v_max_f32 v128, v128, v130
v_mov_b32 v130, v128
s_nop 1
v_permlane16_swap_b32 v128, v130
s_nop 0
v_mov_b32 v129, v128
v_mov_b32 v131, v130
s_nop 0
v_permlane32_swap_b32 v128, v129
v_permlane32_swap_b32 v130, v131
v_mul_f32 v128, v128, v124
v_mul_f32 v129, v129, v125
v_pk_fma_f32 v[156:157], v[156:157], v[124:125], v[128:129] op_sel:[0,0,0] op_sel_hi:[1,0,0] neg_lo:[0,0,1] neg_hi:[0,0,1]
v_pk_fma_f32 v[158:159], v[158:159], v[124:125], v[128:129] op_sel:[0,0,0] op_sel_hi:[1,0,0] neg_lo:[0,0,1] neg_hi:[0,0,1]
v_mul_f32 v130, v130, v126
v_mul_f32 v131, v131, v127
v_exp_f32 v156, v156
v_exp_f32 v157, v157
v_exp_f32 v158, v158
v_exp_f32 v159, v159
v_pk_fma_f32 v[164:165], v[164:165], v[124:125], v[128:129] op_sel:[0,1,1] op_sel_hi:[1,1,1] neg_lo:[0,0,1] neg_hi:[0,0,1]
v_pk_fma_f32 v[166:167], v[166:167], v[124:125], v[128:129] op_sel:[0,1,1] op_sel_hi:[1,1,1] neg_lo:[0,0,1] neg_hi:[0,0,1]
v_exp_f32 v164, v164
v_exp_f32 v165, v165
v_exp_f32 v166, v166
v_exp_f32 v167, v167
v_pk_fma_f32 v[172:173], v[172:173], v[126:127], v[130:131] op_sel:[0,0,0] op_sel_hi:[1,0,0] neg_lo:[0,0,1] neg_hi:[0,0,1]
v_pk_fma_f32 v[174:175], v[174:175], v[126:127], v[130:131] op_sel:[0,0,0] op_sel_hi:[1,0,0] neg_lo:[0,0,1] neg_hi:[0,0,1]
v_cvt_pk_bf16_f32 v156, v156, v156
v_cvt_pk_bf16_f32 v157, v157, v157
v_cvt_pk_bf16_f32 v158, v158, v158
v_cvt_pk_bf16_f32 v159, v159, v159
v_exp_f32 v172, v172
v_exp_f32 v173, v173
v_exp_f32 v174, v174
v_exp_f32 v175, v175
v_pk_fma_f32 v[180:181], v[180:181], v[126:127], v[130:131] op_sel:[0,1,1] op_sel_hi:[1,1,1] neg_lo:[0,0,1] neg_hi:[0,0,1]
v_pk_fma_f32 v[182:183], v[182:183], v[126:127], v[130:131] op_sel:[0,1,1] op_sel_hi:[1,1,1] neg_lo:[0,0,1] neg_hi:[0,0,1]
v_and_b32 v156, v52, v156
v_and_b32 v157, v52, v157
v_and_b32 v158, v52, v158
v_and_b32 v159, v52, v159
v_cvt_pk_bf16_f32 v164, v164, v164
v_cvt_pk_bf16_f32 v165, v165, v165
v_mfma_f32_16x16x32_bf16 v[160:163], v[48:51], v[156:159], 0
v_cvt_pk_bf16_f32 v166, v166, v166
v_cvt_pk_bf16_f32 v167, v167, v167
v_mfma_f32_16x16x32_bf16 v[220:223], v[100:103], v[156:159], 0
v_exp_f32 v180, v180
v_mfma_f32_16x16x32_bf16 v[224:227], v[110:113], v[156:159], 0
v_exp_f32 v181, v181
v_exp_f32 v182, v182
v_exp_f32 v183, v183
v_and_b32 v164, v52, v164
v_and_b32 v165, v52, v165
v_and_b32 v166, v52, v166
v_and_b32 v167, v52, v167
v_cvt_pk_bf16_f32 v172, v172, v172
v_cvt_pk_bf16_f32 v173, v173, v173
v_mfma_f32_16x16x32_bf16 v[168:171], v[48:51], v[164:167], 0
v_cvt_pk_bf16_f32 v174, v174, v174
v_cvt_pk_bf16_f32 v175, v175, v175
v_mfma_f32_16x16x32_bf16 v[228:231], v[102:105], v[164:167], 0
v_and_b32 v172, v52, v172
v_and_b32 v173, v52, v173
v_mfma_f32_16x16x32_bf16 v[232:235], v[112:115], v[164:167], 0
v_and_b32 v174, v52, v174
v_and_b32 v175, v52, v175
v_cvt_pk_bf16_f32 v180, v180, v180
v_cvt_pk_bf16_f32 v181, v181, v181
v_mfma_f32_16x16x32_bf16 v[176:179], v[48:51], v[172:175], 0
v_cvt_pk_bf16_f32 v182, v182, v182
v_cvt_pk_bf16_f32 v183, v183, v183
v_mfma_f32_16x16x32_bf16 v[236:239], v[104:107], v[172:175], 0
v_and_b32 v180, v52, v180
v_and_b32 v181, v52, v181
v_mfma_f32_16x16x32_bf16 v[240:243], v[114:117], v[172:175], 0
v_and_b32 v182, v52, v182
v_and_b32 v183, v52, v183
v_rcp_f32 v160, v160
v_rcp_f32 v168, v168
v_pk_mul_f32 v[220:221], v[220:221], v[160:161] op_sel:[0,0] op_sel_hi:[1,0]
v_pk_mul_f32 v[222:223], v[222:223], v[160:161] op_sel:[0,0] op_sel_hi:[1,0]
v_pk_mul_f32 v[228:229], v[228:229], v[168:169] op_sel:[0,0] op_sel_hi:[1,0]
v_pk_mul_f32 v[224:225], v[224:225], v[160:161] op_sel:[0,0] op_sel_hi:[1,0]
v_pk_mul_f32 v[226:227], v[226:227], v[160:161] op_sel:[0,0] op_sel_hi:[1,0]
v_pk_mul_f32 v[230:231], v[230:231], v[168:169] op_sel:[0,0] op_sel_hi:[1,0]
v_pk_mul_f32 v[232:233], v[232:233], v[168:169] op_sel:[0,0] op_sel_hi:[1,0]
v_pk_mul_f32 v[234:235], v[234:235], v[168:169] op_sel:[0,0] op_sel_hi:[1,0]
v_mfma_f32_16x16x32_bf16 v[184:187], v[48:51], v[180:183], 0
v_rcp_f32_e64 v176, v176
v_cvt_pk_bf16_f32 v220, v220, v221
v_cvt_pk_bf16_f32 v221, v222, v223
v_cvt_pk_bf16_f32 v228, v228, v229
v_pk_mul_f32 v[236:237], v[236:237], v[176:177] op_sel:[0,0] op_sel_hi:[1,0]
v_mfma_f32_16x16x32_bf16 v[244:247], v[106:109], v[180:183], 0
v_cvt_pk_bf16_f32 v222, v224, v225
v_cvt_pk_bf16_f32 v223, v226, v227
v_rcp_f32_e64 v184, v184
v_cvt_pk_bf16_f32 v229, v230, v231
v_pk_mul_f32 v[238:239], v[238:239], v[176:177] op_sel:[0,0] op_sel_hi:[1,0]
v_pk_mul_f32 v[240:241], v[240:241], v[176:177] op_sel:[0,0] op_sel_hi:[1,0]
v_pk_mul_f32 v[242:243], v[242:243], v[176:177] op_sel:[0,0] op_sel_hi:[1,0]
v_cvt_pk_bf16_f32 v236, v236, v237
v_pk_mul_f32 v[244:245], v[244:245], v[184:185] op_sel:[0,0] op_sel_hi:[1,0]
v_pk_mul_f32 v[246:247], v[246:247], v[184:185] op_sel:[0,0] op_sel_hi:[1,0]
v_mfma_f32_16x16x32_bf16 v[248:251], v[116:119], v[180:183], 0
buffer_store_dwordx4 v[220:223], v18, s[32:35], s80 offen sc1
v_cvt_pk_bf16_f32 v230, v232, v233
v_cvt_pk_bf16_f32 v231, v234, v235
v_cvt_pk_bf16_f32 v237, v238, v239
v_cvt_pk_bf16_f32 v244, v244, v245
buffer_store_dwordx4 v[228:231], v18, s[32:35], s81 offen sc1
v_cvt_pk_bf16_f32 v238, v240, v241
v_cvt_pk_bf16_f32 v239, v242, v243
v_pk_mul_f32 v[248:249], v[248:249], v[184:185] op_sel:[0,0] op_sel_hi:[1,0]
v_pk_mul_f32 v[250:251], v[250:251], v[184:185] op_sel:[0,0] op_sel_hi:[1,0]
v_cvt_pk_bf16_f32 v245, v246, v247
buffer_store_dwordx4 v[236:239], v18, s[32:35], s82 offen sc1
v_cvt_pk_bf16_f32 v246, v248, v249
v_cvt_pk_bf16_f32 v247, v250, v251
buffer_store_dwordx4 v[244:247], v18, s[32:35], s83 offen sc1
back_72:
s_barrier
v_and_b32 v36, 31, v0
v_lshlrev_b32 v36, 2, v36
s_lshl_b32 s62, s45, 2
v_mov_b32 v4, s62
v_mov_b32 v5, 1
s_mov_b64 exec, 1
s_waitcnt vmcnt(0)
s_cmp_eq_u32 s46, 0
s_cbranch_scc1 slow_73
buffer_store_dword v5, v4, s[32:35], s84 offen
back_74:
s_mov_b64 exec, -1
v_lshrrev_b32 v4, 2, v2
v_and_b32 v5, 3, v0
v_lshl_add_u32 v6, v3, 3, v4
v_lshlrev_b32 v6, 7, v6
v_lshl_add_u32 v6, v5, 3, v6
v_lshrrev_b32 v7, 1, v4
v_and_b32 v8, 1, v3
v_lshl_add_u32 v7, v8, 1, v7
v_lshl_add_u32 v10, v7, 5, v6
v_xor_b32 v11, 32, v10
v_xor_b32 v12, 64, v10
v_xor_b32 v13, 96, v10
v_add_u32 v14, 0x10000, v10
v_add_u32 v15, 0x10000, v11
v_add_u32 v16, 0x10000, v12
v_add_u32 v17, 0x10000, v13
ds_read_b64_tr_b16 v[220:221], v10 offset:0
ds_read_b64_tr_b16 v[222:223], v10 offset:512
ds_read_b64_tr_b16 v[224:225], v11 offset:0
ds_read_b64_tr_b16 v[226:227], v11 offset:512
ds_read_b64_tr_b16 v[228:229], v12 offset:0
ds_read_b64_tr_b16 v[230:231], v12 offset:512
ds_read_b64_tr_b16 v[232:233], v13 offset:0
ds_read_b64_tr_b16 v[234:235], v13 offset:512
ds_read_b64_tr_b16 v[236:237], v10 offset:4096
ds_read_b64_tr_b16 v[238:239], v10 offset:4608
ds_read_b64_tr_b16 v[240:241], v11 offset:4096
ds_read_b64_tr_b16 v[242:243], v11 offset:4608
ds_read_b64_tr_b16 v[244:245], v12 offset:4096
ds_read_b64_tr_b16 v[246:247], v12 offset:4608
ds_read_b64_tr_b16 v[248:249], v13 offset:4096
ds_read_b64_tr_b16 v[250:251], v13 offset:4608
s_lshl_b32 s48, s41, 3
s_lshl_b32 s49, s40, 1
s_add_u32 s48, s48, s49
s_lshl_b32 s48, s48, 15
s_add_u32 s48, s48, 4194304
v_add_u32 v38, s48, v18
v_add_u32 v39, 32768, v38
s_lshl_b32 s57, s75, 11
s_add_u32 s87, s87, 262144
v_lshlrev_b32 v60, 16, v20
v_and_b32 v61, 0xffff0000, v20
v_lshlrev_b32 v62, 16, v21
v_and_b32 v63, 0xffff0000, v21
v_lshlrev_b32 v64, 16, v22
v_and_b32 v65, 0xffff0000, v22
v_lshlrev_b32 v66, 16, v23
v_and_b32 v67, 0xffff0000, v23
v_lshlrev_b32 v68, 16, v24
v_and_b32 v69, 0xffff0000, v24
v_lshlrev_b32 v70, 16, v25
v_and_b32 v71, 0xffff0000, v25
v_lshlrev_b32 v72, 16, v26
v_and_b32 v73, 0xffff0000, v26
v_lshlrev_b32 v74, 16, v27
v_and_b32 v75, 0xffff0000, v27
v_lshlrev_b32 v76, 16, v28
v_and_b32 v77, 0xffff0000, v28
v_lshlrev_b32 v78, 16, v29
v_and_b32 v79, 0xffff0000, v29
v_lshlrev_b32 v80, 16, v30
v_and_b32 v81, 0xffff0000, v30
v_lshlrev_b32 v82, 16, v31
v_and_b32 v83, 0xffff0000, v31
v_lshlrev_b32 v84, 16, v32
v_and_b32 v85, 0xffff0000, v32
v_lshlrev_b32 v86, 16, v33
v_and_b32 v87, 0xffff0000, v33
v_lshlrev_b32 v88, 16, v34
v_and_b32 v89, 0xffff0000, v34
v_lshlrev_b32 v90, 16, v35
v_and_b32 v91, 0xffff0000, v35
v_mov_b32 v6, 0
v_mov_b32 v7, 0
v_mov_b32 v8, 0
v_mov_b32 v9, 0
s_lshl_b32 s62, s42, 2
v_mov_b32 v4, s62
v_mov_b32 v5, 1
buffer_load_dword v37, v36, s[32:35], s84 offen sc1
s_mov_b32 s63, 0
s_waitcnt vmcnt(0)
poll_75:
v_cmp_gt_u32 vcc, 1, v37
s_cbranch_vccz polled_76
buffer_load_dword v37, v36, s[32:35], s84 offen sc1
s_add_u32 s63, s63, 1
s_cmp_lt_u32 s63, 0x80000
s_waitcnt vmcnt(0)
s_cbranch_scc1 poll_75
polled_76:
s_getpc_b64 s[94:95]
pc_77:
s_add_u32 s94, s94, R_oloop_end - pc_77
s_addc_u32 s95, s95, 0
R_oloop:
buffer_load_dwordx4 v[156:159], v38, s[32:35], s57 offen sc1
buffer_load_dwordx4 v[160:163], v39, s[32:35], s57 offen sc1
buffer_load_dwordx4 v[164:167], v38, s[32:35], s57 offen offset:1024 sc1
buffer_load_dwordx4 v[168:171], v39, s[32:35], s57 offen offset:1024 sc1
s_add_u32 s57, s57, 2048
s_and_b32 s57, s57, 0x7fff
buffer_load_dwordx4 v[172:175], v38, s[32:35], s57 offen sc1
buffer_load_dwordx4 v[176:179], v39, s[32:35], s57 offen sc1
buffer_load_dwordx4 v[180:183], v38, s[32:35], s57 offen offset:1024 sc1
buffer_load_dwordx4 v[184:187], v39, s[32:35], s57 offen offset:1024 sc1
s_add_u32 s57, s57, 2048
s_and_b32 s57, s57, 0x7fff
buffer_load_dwordx4 v[188:191], v38, s[32:35], s57 offen sc1
buffer_load_dwordx4 v[192:195], v39, s[32:35], s57 offen sc1
s_waitcnt vmcnt(8) lgkmcnt(8)
v_mfma_f32_16x16x32_bf16 v[60:63], v[220:223], v[156:159], v[60:63]
buffer_load_dwordx4 v[196:199], v38, s[32:35], s57 offen offset:1024 sc1
v_mfma_f32_16x16x32_bf16 v[76:79], v[220:223], v[160:163], v[76:79]
ds_read_b64_tr_b16 v[100:101], v10 offset:8192
ds_read_b64_tr_b16 v[102:103], v10 offset:8704
v_mfma_f32_16x16x32_bf16 v[80:83], v[224:227], v[160:163], v[80:83]
ds_read_b64_tr_b16 v[104:105], v11 offset:8192
ds_read_b64_tr_b16 v[106:107], v11 offset:8704
v_mfma_f32_16x16x32_bf16 v[64:67], v[224:227], v[156:159], v[64:67]
buffer_load_dwordx4 v[200:203], v39, s[32:35], s57 offen offset:1024 sc1
v_mfma_f32_16x16x32_bf16 v[68:71], v[228:231], v[156:159], v[68:71]
ds_read_b64_tr_b16 v[108:109], v12 offset:8192
ds_read_b64_tr_b16 v[110:111], v12 offset:8704
v_mfma_f32_16x16x32_bf16 v[84:87], v[228:231], v[160:163], v[84:87]
ds_read_b64_tr_b16 v[112:113], v13 offset:8192
ds_read_b64_tr_b16 v[114:115], v13 offset:8704
v_mfma_f32_16x16x32_bf16 v[88:91], v[232:235], v[160:163], v[88:91]
s_add_u32 s57, s57, 2048
s_and_b32 s57, s57, 0x7fff
v_mfma_f32_16x16x32_bf16 v[72:75], v[232:235], v[156:159], v[72:75]
s_waitcnt vmcnt(8) lgkmcnt(8)
v_mfma_f32_16x16x32_bf16 v[60:63], v[236:239], v[164:167], v[60:63]
buffer_load_dwordx4 v[204:207], v38, s[32:35], s57 offen sc1
v_mfma_f32_16x16x32_bf16 v[76:79], v[236:239], v[168:171], v[76:79]
ds_read_b64_tr_b16 v[220:221], v10 offset:12288
ds_read_b64_tr_b16 v[222:223], v10 offset:12800
v_mfma_f32_16x16x32_bf16 v[80:83], v[240:243], v[168:171], v[80:83]
ds_read_b64_tr_b16 v[224:225], v11 offset:12288
ds_read_b64_tr_b16 v[226:227], v11 offset:12800
v_mfma_f32_16x16x32_bf16 v[64:67], v[240:243], v[164:167], v[64:67]
buffer_load_dwordx4 v[208:211], v39, s[32:35], s57 offen sc1
v_mfma_f32_16x16x32_bf16 v[68:71], v[244:247], v[164:167], v[68:71]
ds_read_b64_tr_b16 v[228:229], v12 offset:12288
ds_read_b64_tr_b16 v[230:231], v12 offset:12800
v_mfma_f32_16x16x32_bf16 v[84:87], v[244:247], v[168:171], v[84:87]
ds_read_b64_tr_b16 v[232:233], v13 offset:12288
ds_read_b64_tr_b16 v[234:235], v13 offset:12800
v_mfma_f32_16x16x32_bf16 v[88:91], v[248:251], v[168:171], v[88:91]
v_mfma_f32_16x16x32_bf16 v[72:75], v[248:251], v[164:167], v[72:75]
s_waitcnt vmcnt(8) lgkmcnt(8)
v_mfma_f32_16x16x32_bf16 v[60:63], v[100:103], v[172:175], v[60:63]
buffer_load_dwordx4 v[212:215], v38, s[32:35], s57 offen offset:1024 sc1
v_mfma_f32_16x16x32_bf16 v[76:79], v[100:103], v[176:179], v[76:79]
ds_read_b64_tr_b16 v[236:237], v10 offset:16384
ds_read_b64_tr_b16 v[238:239], v10 offset:16896
v_mfma_f32_16x16x32_bf16 v[80:83], v[104:107], v[176:179], v[80:83]
ds_read_b64_tr_b16 v[240:241], v11 offset:16384
ds_read_b64_tr_b16 v[242:243], v11 offset:16896
v_mfma_f32_16x16x32_bf16 v[64:67], v[104:107], v[172:175], v[64:67]
buffer_load_dwordx4 v[216:219], v39, s[32:35], s57 offen offset:1024 sc1
v_mfma_f32_16x16x32_bf16 v[68:71], v[108:111], v[172:175], v[68:71]
ds_read_b64_tr_b16 v[244:245], v12 offset:16384
ds_read_b64_tr_b16 v[246:247], v12 offset:16896
v_mfma_f32_16x16x32_bf16 v[84:87], v[108:111], v[176:179], v[84:87]
ds_read_b64_tr_b16 v[248:249], v13 offset:16384
ds_read_b64_tr_b16 v[250:251], v13 offset:16896
v_mfma_f32_16x16x32_bf16 v[88:91], v[112:115], v[176:179], v[88:91]
s_add_u32 s57, s57, 2048
s_and_b32 s57, s57, 0x7fff
v_mfma_f32_16x16x32_bf16 v[72:75], v[112:115], v[172:175], v[72:75]
s_waitcnt vmcnt(8) lgkmcnt(8)
v_mfma_f32_16x16x32_bf16 v[60:63], v[220:223], v[180:183], v[60:63]
buffer_load_dwordx4 v[156:159], v38, s[32:35], s57 offen sc1
v_mfma_f32_16x16x32_bf16 v[76:79], v[220:223], v[184:187], v[76:79]
ds_read_b64_tr_b16 v[100:101], v10 offset:20480
ds_read_b64_tr_b16 v[102:103], v10 offset:20992
v_mfma_f32_16x16x32_bf16 v[80:83], v[224:227], v[184:187], v[80:83]
ds_read_b64_tr_b16 v[104:105], v11 offset:20480
ds_read_b64_tr_b16 v[106:107], v11 offset:20992
v_mfma_f32_16x16x32_bf16 v[64:67], v[224:227], v[180:183], v[64:67]
buffer_load_dwordx4 v[160:163], v39, s[32:35], s57 offen sc1
v_mfma_f32_16x16x32_bf16 v[68:71], v[228:231], v[180:183], v[68:71]
ds_read_b64_tr_b16 v[108:109], v12 offset:20480
ds_read_b64_tr_b16 v[110:111], v12 offset:20992
v_mfma_f32_16x16x32_bf16 v[84:87], v[228:231], v[184:187], v[84:87]
ds_read_b64_tr_b16 v[112:113], v13 offset:20480
ds_read_b64_tr_b16 v[114:115], v13 offset:20992
v_mfma_f32_16x16x32_bf16 v[88:91], v[232:235], v[184:187], v[88:91]
v_mfma_f32_16x16x32_bf16 v[72:75], v[232:235], v[180:183], v[72:75]
s_waitcnt vmcnt(8) lgkmcnt(8)
v_mfma_f32_16x16x32_bf16 v[60:63], v[236:239], v[188:191], v[60:63]
buffer_load_dwordx4 v[164:167], v38, s[32:35], s57 offen offset:1024 sc1
v_mfma_f32_16x16x32_bf16 v[76:79], v[236:239], v[192:195], v[76:79]
ds_read_b64_tr_b16 v[220:221], v10 offset:24576
ds_read_b64_tr_b16 v[222:223], v10 offset:25088
v_mfma_f32_16x16x32_bf16 v[80:83], v[240:243], v[192:195], v[80:83]
ds_read_b64_tr_b16 v[224:225], v11 offset:24576
ds_read_b64_tr_b16 v[226:227], v11 offset:25088
v_mfma_f32_16x16x32_bf16 v[64:67], v[240:243], v[188:191], v[64:67]
buffer_load_dwordx4 v[168:171], v39, s[32:35], s57 offen offset:1024 sc1
v_mfma_f32_16x16x32_bf16 v[68:71], v[244:247], v[188:191], v[68:71]
ds_read_b64_tr_b16 v[228:229], v12 offset:24576
ds_read_b64_tr_b16 v[230:231], v12 offset:25088
v_mfma_f32_16x16x32_bf16 v[84:87], v[244:247], v[192:195], v[84:87]
ds_read_b64_tr_b16 v[232:233], v13 offset:24576
ds_read_b64_tr_b16 v[234:235], v13 offset:25088
v_mfma_f32_16x16x32_bf16 v[88:91], v[248:251], v[192:195], v[88:91]
s_add_u32 s57, s57, 2048
s_and_b32 s57, s57, 0x7fff
v_mfma_f32_16x16x32_bf16 v[72:75], v[248:251], v[188:191], v[72:75]
s_waitcnt vmcnt(8) lgkmcnt(8)
v_mfma_f32_16x16x32_bf16 v[60:63], v[100:103], v[196:199], v[60:63]
buffer_load_dwordx4 v[172:175], v38, s[32:35], s57 offen sc1
v_mfma_f32_16x16x32_bf16 v[76:79], v[100:103], v[200:203], v[76:79]
ds_read_b64_tr_b16 v[236:237], v10 offset:28672
ds_read_b64_tr_b16 v[238:239], v10 offset:29184
v_mfma_f32_16x16x32_bf16 v[80:83], v[104:107], v[200:203], v[80:83]
ds_read_b64_tr_b16 v[240:241], v11 offset:28672
ds_read_b64_tr_b16 v[242:243], v11 offset:29184
v_mfma_f32_16x16x32_bf16 v[64:67], v[104:107], v[196:199], v[64:67]
buffer_load_dwordx4 v[176:179], v39, s[32:35], s57 offen sc1
v_mfma_f32_16x16x32_bf16 v[68:71], v[108:111], v[196:199], v[68:71]
ds_read_b64_tr_b16 v[244:245], v12 offset:28672
ds_read_b64_tr_b16 v[246:247], v12 offset:29184
v_mfma_f32_16x16x32_bf16 v[84:87], v[108:111], v[200:203], v[84:87]
ds_read_b64_tr_b16 v[248:249], v13 offset:28672
ds_read_b64_tr_b16 v[250:251], v13 offset:29184
v_mfma_f32_16x16x32_bf16 v[88:91], v[112:115], v[200:203], v[88:91]
v_mfma_f32_16x16x32_bf16 v[72:75], v[112:115], v[196:199], v[72:75]
s_waitcnt vmcnt(8) lgkmcnt(8)
v_mfma_f32_16x16x32_bf16 v[60:63], v[220:223], v[204:207], v[60:63]
buffer_load_dwordx4 v[180:183], v38, s[32:35], s57 offen offset:1024 sc1
v_mfma_f32_16x16x32_bf16 v[76:79], v[220:223], v[208:211], v[76:79]
ds_read_b64_tr_b16 v[100:101], v10 offset:32768
ds_read_b64_tr_b16 v[102:103], v10 offset:33280
v_mfma_f32_16x16x32_bf16 v[80:83], v[224:227], v[208:211], v[80:83]
ds_read_b64_tr_b16 v[104:105], v11 offset:32768
ds_read_b64_tr_b16 v[106:107], v11 offset:33280
v_mfma_f32_16x16x32_bf16 v[64:67], v[224:227], v[204:207], v[64:67]
buffer_load_dwordx4 v[184:187], v39, s[32:35], s57 offen offset:1024 sc1
v_mfma_f32_16x16x32_bf16 v[68:71], v[228:231], v[204:207], v[68:71]
ds_read_b64_tr_b16 v[108:109], v12 offset:32768
ds_read_b64_tr_b16 v[110:111], v12 offset:33280
v_mfma_f32_16x16x32_bf16 v[84:87], v[228:231], v[208:211], v[84:87]
ds_read_b64_tr_b16 v[112:113], v13 offset:32768
ds_read_b64_tr_b16 v[114:115], v13 offset:33280
v_mfma_f32_16x16x32_bf16 v[88:91], v[232:235], v[208:211], v[88:91]
s_add_u32 s57, s57, 2048
s_and_b32 s57, s57, 0x7fff
v_mfma_f32_16x16x32_bf16 v[72:75], v[232:235], v[204:207], v[72:75]
s_waitcnt vmcnt(8) lgkmcnt(8)
v_mfma_f32_16x16x32_bf16 v[60:63], v[236:239], v[212:215], v[60:63]
buffer_load_dwordx4 v[188:191], v38, s[32:35], s57 offen sc1
v_mfma_f32_16x16x32_bf16 v[76:79], v[236:239], v[216:219], v[76:79]
ds_read_b64_tr_b16 v[220:221], v10 offset:36864
ds_read_b64_tr_b16 v[222:223], v10 offset:37376
v_mfma_f32_16x16x32_bf16 v[80:83], v[240:243], v[216:219], v[80:83]
ds_read_b64_tr_b16 v[224:225], v11 offset:36864
ds_read_b64_tr_b16 v[226:227], v11 offset:37376
v_mfma_f32_16x16x32_bf16 v[64:67], v[240:243], v[212:215], v[64:67]
buffer_load_dwordx4 v[192:195], v39, s[32:35], s57 offen sc1
v_mfma_f32_16x16x32_bf16 v[68:71], v[244:247], v[212:215], v[68:71]
ds_read_b64_tr_b16 v[228:229], v12 offset:36864
ds_read_b64_tr_b16 v[230:231], v12 offset:37376
v_mfma_f32_16x16x32_bf16 v[84:87], v[244:247], v[216:219], v[84:87]
ds_read_b64_tr_b16 v[232:233], v13 offset:36864
ds_read_b64_tr_b16 v[234:235], v13 offset:37376
v_mfma_f32_16x16x32_bf16 v[88:91], v[248:251], v[216:219], v[88:91]
v_mfma_f32_16x16x32_bf16 v[72:75], v[248:251], v[212:215], v[72:75]
s_waitcnt vmcnt(8) lgkmcnt(8)
v_mfma_f32_16x16x32_bf16 v[60:63], v[100:103], v[156:159], v[60:63]
buffer_load_dwordx4 v[196:199], v38, s[32:35], s57 offen offset:1024 sc1
v_mfma_f32_16x16x32_bf16 v[76:79], v[100:103], v[160:163], v[76:79]
ds_read_b64_tr_b16 v[236:237], v10 offset:40960
ds_read_b64_tr_b16 v[238:239], v10 offset:41472
v_mfma_f32_16x16x32_bf16 v[80:83], v[104:107], v[160:163], v[80:83]
ds_read_b64_tr_b16 v[240:241], v11 offset:40960
ds_read_b64_tr_b16 v[242:243], v11 offset:41472
v_mfma_f32_16x16x32_bf16 v[64:67], v[104:107], v[156:159], v[64:67]
buffer_load_dwordx4 v[200:203], v39, s[32:35], s57 offen offset:1024 sc1
v_mfma_f32_16x16x32_bf16 v[68:71], v[108:111], v[156:159], v[68:71]
ds_read_b64_tr_b16 v[244:245], v12 offset:40960
ds_read_b64_tr_b16 v[246:247], v12 offset:41472
v_mfma_f32_16x16x32_bf16 v[84:87], v[108:111], v[160:163], v[84:87]
ds_read_b64_tr_b16 v[248:249], v13 offset:40960
ds_read_b64_tr_b16 v[250:251], v13 offset:41472
v_mfma_f32_16x16x32_bf16 v[88:91], v[112:115], v[160:163], v[88:91]
s_add_u32 s57, s57, 2048
s_and_b32 s57, s57, 0x7fff
v_mfma_f32_16x16x32_bf16 v[72:75], v[112:115], v[156:159], v[72:75]
s_waitcnt vmcnt(8) lgkmcnt(8)
v_mfma_f32_16x16x32_bf16 v[60:63], v[220:223], v[164:167], v[60:63]
buffer_load_dwordx4 v[204:207], v38, s[32:35], s57 offen sc1
v_mfma_f32_16x16x32_bf16 v[76:79], v[220:223], v[168:171], v[76:79]
ds_read_b64_tr_b16 v[100:101], v10 offset:45056
ds_read_b64_tr_b16 v[102:103], v10 offset:45568
v_mfma_f32_16x16x32_bf16 v[80:83], v[224:227], v[168:171], v[80:83]
ds_read_b64_tr_b16 v[104:105], v11 offset:45056
ds_read_b64_tr_b16 v[106:107], v11 offset:45568
v_mfma_f32_16x16x32_bf16 v[64:67], v[224:227], v[164:167], v[64:67]
buffer_load_dwordx4 v[208:211], v39, s[32:35], s57 offen sc1
v_mfma_f32_16x16x32_bf16 v[68:71], v[228:231], v[164:167], v[68:71]
ds_read_b64_tr_b16 v[108:109], v12 offset:45056
ds_read_b64_tr_b16 v[110:111], v12 offset:45568
v_mfma_f32_16x16x32_bf16 v[84:87], v[228:231], v[168:171], v[84:87]
ds_read_b64_tr_b16 v[112:113], v13 offset:45056
ds_read_b64_tr_b16 v[114:115], v13 offset:45568
v_mfma_f32_16x16x32_bf16 v[88:91], v[232:235], v[168:171], v[88:91]
v_mfma_f32_16x16x32_bf16 v[72:75], v[232:235], v[164:167], v[72:75]
s_waitcnt vmcnt(8) lgkmcnt(8)
v_mfma_f32_16x16x32_bf16 v[60:63], v[236:239], v[172:175], v[60:63]
buffer_load_dwordx4 v[212:215], v38, s[32:35], s57 offen offset:1024 sc1
v_mfma_f32_16x16x32_bf16 v[76:79], v[236:239], v[176:179], v[76:79]
ds_read_b64_tr_b16 v[220:221], v10 offset:49152
ds_read_b64_tr_b16 v[222:223], v10 offset:49664
v_mfma_f32_16x16x32_bf16 v[80:83], v[240:243], v[176:179], v[80:83]
ds_read_b64_tr_b16 v[224:225], v11 offset:49152
ds_read_b64_tr_b16 v[226:227], v11 offset:49664
v_mfma_f32_16x16x32_bf16 v[64:67], v[240:243], v[172:175], v[64:67]
buffer_load_dwordx4 v[216:219], v39, s[32:35], s57 offen offset:1024 sc1
v_mfma_f32_16x16x32_bf16 v[68:71], v[244:247], v[172:175], v[68:71]
ds_read_b64_tr_b16 v[228:229], v12 offset:49152
ds_read_b64_tr_b16 v[230:231], v12 offset:49664
v_mfma_f32_16x16x32_bf16 v[84:87], v[244:247], v[176:179], v[84:87]
ds_read_b64_tr_b16 v[232:233], v13 offset:49152
ds_read_b64_tr_b16 v[234:235], v13 offset:49664
v_mfma_f32_16x16x32_bf16 v[88:91], v[248:251], v[176:179], v[88:91]
s_add_u32 s57, s57, 2048
s_and_b32 s57, s57, 0x7fff
v_mfma_f32_16x16x32_bf16 v[72:75], v[248:251], v[172:175], v[72:75]
s_waitcnt vmcnt(8) lgkmcnt(8)
v_mfma_f32_16x16x32_bf16 v[60:63], v[100:103], v[180:183], v[60:63]
buffer_load_dwordx4 v[156:159], v38, s[32:35], s57 offen sc1
v_mfma_f32_16x16x32_bf16 v[76:79], v[100:103], v[184:187], v[76:79]
ds_read_b64_tr_b16 v[236:237], v10 offset:53248
ds_read_b64_tr_b16 v[238:239], v10 offset:53760
v_mfma_f32_16x16x32_bf16 v[80:83], v[104:107], v[184:187], v[80:83]
ds_read_b64_tr_b16 v[240:241], v11 offset:53248
ds_read_b64_tr_b16 v[242:243], v11 offset:53760
v_mfma_f32_16x16x32_bf16 v[64:67], v[104:107], v[180:183], v[64:67]
buffer_load_dwordx4 v[160:163], v39, s[32:35], s57 offen sc1
v_mfma_f32_16x16x32_bf16 v[68:71], v[108:111], v[180:183], v[68:71]
ds_read_b64_tr_b16 v[244:245], v12 offset:53248
ds_read_b64_tr_b16 v[246:247], v12 offset:53760
v_mfma_f32_16x16x32_bf16 v[84:87], v[108:111], v[184:187], v[84:87]
ds_read_b64_tr_b16 v[248:249], v13 offset:53248
ds_read_b64_tr_b16 v[250:251], v13 offset:53760
v_mfma_f32_16x16x32_bf16 v[88:91], v[112:115], v[184:187], v[88:91]
v_mfma_f32_16x16x32_bf16 v[72:75], v[112:115], v[180:183], v[72:75]
s_waitcnt vmcnt(8) lgkmcnt(8)
v_mfma_f32_16x16x32_bf16 v[60:63], v[220:223], v[188:191], v[60:63]
buffer_load_dwordx4 v[164:167], v38, s[32:35], s57 offen offset:1024 sc1
v_mfma_f32_16x16x32_bf16 v[76:79], v[220:223], v[192:195], v[76:79]
ds_read_b64_tr_b16 v[100:101], v10 offset:57344
ds_read_b64_tr_b16 v[102:103], v10 offset:57856
v_mfma_f32_16x16x32_bf16 v[80:83], v[224:227], v[192:195], v[80:83]
ds_read_b64_tr_b16 v[104:105], v11 offset:57344
ds_read_b64_tr_b16 v[106:107], v11 offset:57856
v_mfma_f32_16x16x32_bf16 v[64:67], v[224:227], v[188:191], v[64:67]
buffer_load_dwordx4 v[168:171], v39, s[32:35], s57 offen offset:1024 sc1
v_mfma_f32_16x16x32_bf16 v[68:71], v[228:231], v[188:191], v[68:71]
ds_read_b64_tr_b16 v[108:109], v12 offset:57344
ds_read_b64_tr_b16 v[110:111], v12 offset:57856
v_mfma_f32_16x16x32_bf16 v[84:87], v[228:231], v[192:195], v[84:87]
ds_read_b64_tr_b16 v[112:113], v13 offset:57344
ds_read_b64_tr_b16 v[114:115], v13 offset:57856
v_mfma_f32_16x16x32_bf16 v[88:91], v[232:235], v[192:195], v[88:91]
s_add_u32 s57, s57, 2048
s_and_b32 s57, s57, 0x7fff
v_mfma_f32_16x16x32_bf16 v[72:75], v[232:235], v[188:191], v[72:75]
s_waitcnt vmcnt(8) lgkmcnt(8)
v_mfma_f32_16x16x32_bf16 v[60:63], v[236:239], v[196:199], v[60:63]
buffer_load_dwordx4 v[172:175], v38, s[32:35], s57 offen sc1
v_mfma_f32_16x16x32_bf16 v[76:79], v[236:239], v[200:203], v[76:79]
ds_read_b64_tr_b16 v[220:221], v10 offset:61440
ds_read_b64_tr_b16 v[222:223], v10 offset:61952
v_mfma_f32_16x16x32_bf16 v[80:83], v[240:243], v[200:203], v[80:83]
ds_read_b64_tr_b16 v[224:225], v11 offset:61440
ds_read_b64_tr_b16 v[226:227], v11 offset:61952
v_mfma_f32_16x16x32_bf16 v[64:67], v[240:243], v[196:199], v[64:67]
buffer_load_dwordx4 v[176:179], v39, s[32:35], s57 offen sc1
v_mfma_f32_16x16x32_bf16 v[68:71], v[244:247], v[196:199], v[68:71]
ds_read_b64_tr_b16 v[228:229], v12 offset:61440
ds_read_b64_tr_b16 v[230:231], v12 offset:61952
v_mfma_f32_16x16x32_bf16 v[84:87], v[244:247], v[200:203], v[84:87]
ds_read_b64_tr_b16 v[232:233], v13 offset:61440
ds_read_b64_tr_b16 v[234:235], v13 offset:61952
v_mfma_f32_16x16x32_bf16 v[88:91], v[248:251], v[200:203], v[88:91]
v_mfma_f32_16x16x32_bf16 v[72:75], v[248:251], v[196:199], v[72:75]
s_waitcnt vmcnt(8) lgkmcnt(8)
v_mfma_f32_16x16x32_bf16 v[60:63], v[100:103], v[204:207], v[60:63]
buffer_load_dwordx4 v[180:183], v38, s[32:35], s57 offen offset:1024 sc1
v_mfma_f32_16x16x32_bf16 v[76:79], v[100:103], v[208:211], v[76:79]
ds_read_b64_tr_b16 v[236:237], v14 offset:0
ds_read_b64_tr_b16 v[238:239], v14 offset:512
v_mfma_f32_16x16x32_bf16 v[80:83], v[104:107], v[208:211], v[80:83]
ds_read_b64_tr_b16 v[240:241], v15 offset:0
ds_read_b64_tr_b16 v[242:243], v15 offset:512
v_mfma_f32_16x16x32_bf16 v[64:67], v[104:107], v[204:207], v[64:67]
buffer_load_dwordx4 v[184:187], v39, s[32:35], s57 offen offset:1024 sc1
v_mfma_f32_16x16x32_bf16 v[68:71], v[108:111], v[204:207], v[68:71]
ds_read_b64_tr_b16 v[244:245], v16 offset:0
ds_read_b64_tr_b16 v[246:247], v16 offset:512
v_mfma_f32_16x16x32_bf16 v[84:87], v[108:111], v[208:211], v[84:87]
ds_read_b64_tr_b16 v[248:249], v17 offset:0
ds_read_b64_tr_b16 v[250:251], v17 offset:512
v_mfma_f32_16x16x32_bf16 v[88:91], v[112:115], v[208:211], v[88:91]
s_add_u32 s57, s57, 2048
s_and_b32 s57, s57, 0x7fff
v_mfma_f32_16x16x32_bf16 v[72:75], v[112:115], v[204:207], v[72:75]
s_waitcnt vmcnt(8) lgkmcnt(8)
v_mfma_f32_16x16x32_bf16 v[60:63], v[220:223], v[212:215], v[60:63]
buffer_load_dwordx4 v[188:191], v38, s[32:35], s57 offen sc1
v_mfma_f32_16x16x32_bf16 v[76:79], v[220:223], v[216:219], v[76:79]
ds_read_b64_tr_b16 v[100:101], v14 offset:4096
ds_read_b64_tr_b16 v[102:103], v14 offset:4608
v_mfma_f32_16x16x32_bf16 v[80:83], v[224:227], v[216:219], v[80:83]
ds_read_b64_tr_b16 v[104:105], v15 offset:4096
ds_read_b64_tr_b16 v[106:107], v15 offset:4608
v_mfma_f32_16x16x32_bf16 v[64:67], v[224:227], v[212:215], v[64:67]
buffer_load_dwordx4 v[192:195], v39, s[32:35], s57 offen sc1
v_mfma_f32_16x16x32_bf16 v[68:71], v[228:231], v[212:215], v[68:71]
ds_read_b64_tr_b16 v[108:109], v16 offset:4096
ds_read_b64_tr_b16 v[110:111], v16 offset:4608
v_mfma_f32_16x16x32_bf16 v[84:87], v[228:231], v[216:219], v[84:87]
ds_read_b64_tr_b16 v[112:113], v17 offset:4096
ds_read_b64_tr_b16 v[114:115], v17 offset:4608
v_mfma_f32_16x16x32_bf16 v[88:91], v[232:235], v[216:219], v[88:91]
v_mfma_f32_16x16x32_bf16 v[72:75], v[232:235], v[212:215], v[72:75]
s_waitcnt vmcnt(8) lgkmcnt(8)
v_mfma_f32_16x16x32_bf16 v[60:63], v[236:239], v[156:159], v[60:63]
buffer_load_dwordx4 v[196:199], v38, s[32:35], s57 offen offset:1024 sc1
v_mfma_f32_16x16x32_bf16 v[76:79], v[236:239], v[160:163], v[76:79]
ds_read_b64_tr_b16 v[220:221], v14 offset:8192
ds_read_b64_tr_b16 v[222:223], v14 offset:8704
v_mfma_f32_16x16x32_bf16 v[80:83], v[240:243], v[160:163], v[80:83]
ds_read_b64_tr_b16 v[224:225], v15 offset:8192
ds_read_b64_tr_b16 v[226:227], v15 offset:8704
v_mfma_f32_16x16x32_bf16 v[64:67], v[240:243], v[156:159], v[64:67]
buffer_load_dwordx4 v[200:203], v39, s[32:35], s57 offen offset:1024 sc1
v_mfma_f32_16x16x32_bf16 v[68:71], v[244:247], v[156:159], v[68:71]
ds_read_b64_tr_b16 v[228:229], v16 offset:8192
ds_read_b64_tr_b16 v[230:231], v16 offset:8704
v_mfma_f32_16x16x32_bf16 v[84:87], v[244:247], v[160:163], v[84:87]
ds_read_b64_tr_b16 v[232:233], v17 offset:8192
ds_read_b64_tr_b16 v[234:235], v17 offset:8704
v_mfma_f32_16x16x32_bf16 v[88:91], v[248:251], v[160:163], v[88:91]
s_add_u32 s57, s57, 2048
s_and_b32 s57, s57, 0x7fff
v_mfma_f32_16x16x32_bf16 v[72:75], v[248:251], v[156:159], v[72:75]
s_waitcnt vmcnt(8) lgkmcnt(8)
v_mfma_f32_16x16x32_bf16 v[60:63], v[100:103], v[164:167], v[60:63]
buffer_load_dwordx4 v[204:207], v38, s[32:35], s57 offen sc1
v_mfma_f32_16x16x32_bf16 v[76:79], v[100:103], v[168:171], v[76:79]
ds_read_b64_tr_b16 v[236:237], v14 offset:12288
ds_read_b64_tr_b16 v[238:239], v14 offset:12800
v_mfma_f32_16x16x32_bf16 v[80:83], v[104:107], v[168:171], v[80:83]
ds_read_b64_tr_b16 v[240:241], v15 offset:12288
ds_read_b64_tr_b16 v[242:243], v15 offset:12800
v_mfma_f32_16x16x32_bf16 v[64:67], v[104:107], v[164:167], v[64:67]
buffer_load_dwordx4 v[208:211], v39, s[32:35], s57 offen sc1
v_mfma_f32_16x16x32_bf16 v[68:71], v[108:111], v[164:167], v[68:71]
ds_read_b64_tr_b16 v[244:245], v16 offset:12288
ds_read_b64_tr_b16 v[246:247], v16 offset:12800
v_mfma_f32_16x16x32_bf16 v[84:87], v[108:111], v[168:171], v[84:87]
ds_read_b64_tr_b16 v[248:249], v17 offset:12288
ds_read_b64_tr_b16 v[250:251], v17 offset:12800
v_mfma_f32_16x16x32_bf16 v[88:91], v[112:115], v[168:171], v[88:91]
v_mfma_f32_16x16x32_bf16 v[72:75], v[112:115], v[164:167], v[72:75]
s_waitcnt vmcnt(8) lgkmcnt(8)
v_mfma_f32_16x16x32_bf16 v[60:63], v[220:223], v[172:175], v[60:63]
buffer_load_dwordx4 v[212:215], v38, s[32:35], s57 offen offset:1024 sc1
v_mfma_f32_16x16x32_bf16 v[76:79], v[220:223], v[176:179], v[76:79]
ds_read_b64_tr_b16 v[100:101], v14 offset:16384
ds_read_b64_tr_b16 v[102:103], v14 offset:16896
v_mfma_f32_16x16x32_bf16 v[80:83], v[224:227], v[176:179], v[80:83]
ds_read_b64_tr_b16 v[104:105], v15 offset:16384
ds_read_b64_tr_b16 v[106:107], v15 offset:16896
v_mfma_f32_16x16x32_bf16 v[64:67], v[224:227], v[172:175], v[64:67]
buffer_load_dwordx4 v[216:219], v39, s[32:35], s57 offen offset:1024 sc1
v_mfma_f32_16x16x32_bf16 v[68:71], v[228:231], v[172:175], v[68:71]
ds_read_b64_tr_b16 v[108:109], v16 offset:16384
ds_read_b64_tr_b16 v[110:111], v16 offset:16896
v_mfma_f32_16x16x32_bf16 v[84:87], v[228:231], v[176:179], v[84:87]
ds_read_b64_tr_b16 v[112:113], v17 offset:16384
ds_read_b64_tr_b16 v[114:115], v17 offset:16896
v_mfma_f32_16x16x32_bf16 v[88:91], v[232:235], v[176:179], v[88:91]
s_add_u32 s57, s57, 2048
s_and_b32 s57, s57, 0x7fff
v_mfma_f32_16x16x32_bf16 v[72:75], v[232:235], v[172:175], v[72:75]
s_waitcnt vmcnt(8) lgkmcnt(8)
v_mfma_f32_16x16x32_bf16 v[60:63], v[236:239], v[180:183], v[60:63]
buffer_load_dwordx4 v[156:159], v38, s[32:35], s57 offen sc1
v_mfma_f32_16x16x32_bf16 v[76:79], v[236:239], v[184:187], v[76:79]
ds_read_b64_tr_b16 v[220:221], v14 offset:20480
ds_read_b64_tr_b16 v[222:223], v14 offset:20992
v_mfma_f32_16x16x32_bf16 v[80:83], v[240:243], v[184:187], v[80:83]
ds_read_b64_tr_b16 v[224:225], v15 offset:20480
ds_read_b64_tr_b16 v[226:227], v15 offset:20992
v_mfma_f32_16x16x32_bf16 v[64:67], v[240:243], v[180:183], v[64:67]
buffer_load_dwordx4 v[160:163], v39, s[32:35], s57 offen sc1
v_mfma_f32_16x16x32_bf16 v[68:71], v[244:247], v[180:183], v[68:71]
ds_read_b64_tr_b16 v[228:229], v16 offset:20480
ds_read_b64_tr_b16 v[230:231], v16 offset:20992
v_mfma_f32_16x16x32_bf16 v[84:87], v[244:247], v[184:187], v[84:87]
ds_read_b64_tr_b16 v[232:233], v17 offset:20480
ds_read_b64_tr_b16 v[234:235], v17 offset:20992
v_mfma_f32_16x16x32_bf16 v[88:91], v[248:251], v[184:187], v[88:91]
v_mfma_f32_16x16x32_bf16 v[72:75], v[248:251], v[180:183], v[72:75]
s_waitcnt vmcnt(8) lgkmcnt(8)
v_mfma_f32_16x16x32_bf16 v[60:63], v[100:103], v[188:191], v[60:63]
buffer_load_dwordx4 v[164:167], v38, s[32:35], s57 offen offset:1024 sc1
v_mfma_f32_16x16x32_bf16 v[76:79], v[100:103], v[192:195], v[76:79]
ds_read_b64_tr_b16 v[236:237], v14 offset:24576
ds_read_b64_tr_b16 v[238:239], v14 offset:25088
v_mfma_f32_16x16x32_bf16 v[80:83], v[104:107], v[192:195], v[80:83]
ds_read_b64_tr_b16 v[240:241], v15 offset:24576
ds_read_b64_tr_b16 v[242:243], v15 offset:25088
v_mfma_f32_16x16x32_bf16 v[64:67], v[104:107], v[188:191], v[64:67]
buffer_load_dwordx4 v[168:171], v39, s[32:35], s57 offen offset:1024 sc1
v_mfma_f32_16x16x32_bf16 v[68:71], v[108:111], v[188:191], v[68:71]
ds_read_b64_tr_b16 v[244:245], v16 offset:24576
ds_read_b64_tr_b16 v[246:247], v16 offset:25088
v_mfma_f32_16x16x32_bf16 v[84:87], v[108:111], v[192:195], v[84:87]
ds_read_b64_tr_b16 v[248:249], v17 offset:24576
ds_read_b64_tr_b16 v[250:251], v17 offset:25088
v_mfma_f32_16x16x32_bf16 v[88:91], v[112:115], v[192:195], v[88:91]
s_add_u32 s57, s57, 2048
s_and_b32 s57, s57, 0x7fff
v_mfma_f32_16x16x32_bf16 v[72:75], v[112:115], v[188:191], v[72:75]
s_waitcnt vmcnt(8) lgkmcnt(8)
v_mfma_f32_16x16x32_bf16 v[60:63], v[220:223], v[196:199], v[60:63]
buffer_load_dwordx4 v[172:175], v38, s[32:35], s57 offen sc1
v_mfma_f32_16x16x32_bf16 v[76:79], v[220:223], v[200:203], v[76:79]
ds_read_b64_tr_b16 v[100:101], v14 offset:28672
ds_read_b64_tr_b16 v[102:103], v14 offset:29184
v_mfma_f32_16x16x32_bf16 v[80:83], v[224:227], v[200:203], v[80:83]
ds_read_b64_tr_b16 v[104:105], v15 offset:28672
ds_read_b64_tr_b16 v[106:107], v15 offset:29184
v_mfma_f32_16x16x32_bf16 v[64:67], v[224:227], v[196:199], v[64:67]
buffer_load_dwordx4 v[176:179], v39, s[32:35], s57 offen sc1
v_mfma_f32_16x16x32_bf16 v[68:71], v[228:231], v[196:199], v[68:71]
ds_read_b64_tr_b16 v[108:109], v16 offset:28672
ds_read_b64_tr_b16 v[110:111], v16 offset:29184
v_mfma_f32_16x16x32_bf16 v[84:87], v[228:231], v[200:203], v[84:87]
ds_read_b64_tr_b16 v[112:113], v17 offset:28672
ds_read_b64_tr_b16 v[114:115], v17 offset:29184
v_mfma_f32_16x16x32_bf16 v[88:91], v[232:235], v[200:203], v[88:91]
v_mfma_f32_16x16x32_bf16 v[72:75], v[232:235], v[196:199], v[72:75]
s_waitcnt vmcnt(8) lgkmcnt(8)
v_mfma_f32_16x16x32_bf16 v[60:63], v[236:239], v[204:207], v[60:63]
buffer_load_dwordx4 v[180:183], v38, s[32:35], s57 offen offset:1024 sc1
v_mfma_f32_16x16x32_bf16 v[76:79], v[236:239], v[208:211], v[76:79]
ds_read_b64_tr_b16 v[220:221], v14 offset:32768
ds_read_b64_tr_b16 v[222:223], v14 offset:33280
v_mfma_f32_16x16x32_bf16 v[80:83], v[240:243], v[208:211], v[80:83]
ds_read_b64_tr_b16 v[224:225], v15 offset:32768
ds_read_b64_tr_b16 v[226:227], v15 offset:33280
v_mfma_f32_16x16x32_bf16 v[64:67], v[240:243], v[204:207], v[64:67]
buffer_load_dwordx4 v[184:187], v39, s[32:35], s57 offen offset:1024 sc1
v_mfma_f32_16x16x32_bf16 v[68:71], v[244:247], v[204:207], v[68:71]
ds_read_b64_tr_b16 v[228:229], v16 offset:32768
ds_read_b64_tr_b16 v[230:231], v16 offset:33280
v_mfma_f32_16x16x32_bf16 v[84:87], v[244:247], v[208:211], v[84:87]
ds_read_b64_tr_b16 v[232:233], v17 offset:32768
ds_read_b64_tr_b16 v[234:235], v17 offset:33280
v_mfma_f32_16x16x32_bf16 v[88:91], v[248:251], v[208:211], v[88:91]
s_add_u32 s57, s57, 2048
s_and_b32 s57, s57, 0x7fff
v_mfma_f32_16x16x32_bf16 v[72:75], v[248:251], v[204:207], v[72:75]
s_waitcnt vmcnt(8) lgkmcnt(8)
v_mfma_f32_16x16x32_bf16 v[60:63], v[100:103], v[212:215], v[60:63]
buffer_load_dwordx4 v[188:191], v38, s[32:35], s57 offen sc1
v_mfma_f32_16x16x32_bf16 v[76:79], v[100:103], v[216:219], v[76:79]
ds_read_b64_tr_b16 v[236:237], v14 offset:36864
ds_read_b64_tr_b16 v[238:239], v14 offset:37376
v_mfma_f32_16x16x32_bf16 v[80:83], v[104:107], v[216:219], v[80:83]
ds_read_b64_tr_b16 v[240:241], v15 offset:36864
ds_read_b64_tr_b16 v[242:243], v15 offset:37376
v_mfma_f32_16x16x32_bf16 v[64:67], v[104:107], v[212:215], v[64:67]
buffer_load_dwordx4 v[192:195], v39, s[32:35], s57 offen sc1
v_mfma_f32_16x16x32_bf16 v[68:71], v[108:111], v[212:215], v[68:71]
ds_read_b64_tr_b16 v[244:245], v16 offset:36864
ds_read_b64_tr_b16 v[246:247], v16 offset:37376
v_mfma_f32_16x16x32_bf16 v[84:87], v[108:111], v[216:219], v[84:87]
ds_read_b64_tr_b16 v[248:249], v17 offset:36864
ds_read_b64_tr_b16 v[250:251], v17 offset:37376
v_mfma_f32_16x16x32_bf16 v[88:91], v[112:115], v[216:219], v[88:91]
v_mfma_f32_16x16x32_bf16 v[72:75], v[112:115], v[212:215], v[72:75]
s_waitcnt vmcnt(8) lgkmcnt(8)
v_mfma_f32_16x16x32_bf16 v[60:63], v[220:223], v[156:159], v[60:63]
buffer_load_dwordx4 v[196:199], v38, s[32:35], s57 offen offset:1024 sc1
v_mfma_f32_16x16x32_bf16 v[76:79], v[220:223], v[160:163], v[76:79]
ds_read_b64_tr_b16 v[100:101], v14 offset:40960
ds_read_b64_tr_b16 v[102:103], v14 offset:41472
v_mfma_f32_16x16x32_bf16 v[80:83], v[224:227], v[160:163], v[80:83]
ds_read_b64_tr_b16 v[104:105], v15 offset:40960
ds_read_b64_tr_b16 v[106:107], v15 offset:41472
v_mfma_f32_16x16x32_bf16 v[64:67], v[224:227], v[156:159], v[64:67]
buffer_load_dwordx4 v[200:203], v39, s[32:35], s57 offen offset:1024 sc1
v_mfma_f32_16x16x32_bf16 v[68:71], v[228:231], v[156:159], v[68:71]
ds_read_b64_tr_b16 v[108:109], v16 offset:40960
ds_read_b64_tr_b16 v[110:111], v16 offset:41472
v_mfma_f32_16x16x32_bf16 v[84:87], v[228:231], v[160:163], v[84:87]
ds_read_b64_tr_b16 v[112:113], v17 offset:40960
ds_read_b64_tr_b16 v[114:115], v17 offset:41472
v_mfma_f32_16x16x32_bf16 v[88:91], v[232:235], v[160:163], v[88:91]
s_add_u32 s57, s57, 2048
s_and_b32 s57, s57, 0x7fff
v_mfma_f32_16x16x32_bf16 v[72:75], v[232:235], v[156:159], v[72:75]
s_waitcnt vmcnt(8) lgkmcnt(8)
v_mfma_f32_16x16x32_bf16 v[60:63], v[236:239], v[164:167], v[60:63]
buffer_load_dwordx4 v[204:207], v38, s[32:35], s57 offen sc1
v_mfma_f32_16x16x32_bf16 v[76:79], v[236:239], v[168:171], v[76:79]
ds_read_b64_tr_b16 v[220:221], v14 offset:45056
ds_read_b64_tr_b16 v[222:223], v14 offset:45568
v_mfma_f32_16x16x32_bf16 v[80:83], v[240:243], v[168:171], v[80:83]
ds_read_b64_tr_b16 v[224:225], v15 offset:45056
ds_read_b64_tr_b16 v[226:227], v15 offset:45568
v_mfma_f32_16x16x32_bf16 v[64:67], v[240:243], v[164:167], v[64:67]
buffer_load_dwordx4 v[208:211], v39, s[32:35], s57 offen sc1
v_mfma_f32_16x16x32_bf16 v[68:71], v[244:247], v[164:167], v[68:71]
ds_read_b64_tr_b16 v[228:229], v16 offset:45056
ds_read_b64_tr_b16 v[230:231], v16 offset:45568
v_mfma_f32_16x16x32_bf16 v[84:87], v[244:247], v[168:171], v[84:87]
ds_read_b64_tr_b16 v[232:233], v17 offset:45056
ds_read_b64_tr_b16 v[234:235], v17 offset:45568
v_mfma_f32_16x16x32_bf16 v[88:91], v[248:251], v[168:171], v[88:91]
v_mfma_f32_16x16x32_bf16 v[72:75], v[248:251], v[164:167], v[72:75]
s_waitcnt vmcnt(8) lgkmcnt(8)
v_mfma_f32_16x16x32_bf16 v[60:63], v[100:103], v[172:175], v[60:63]
buffer_load_dwordx4 v[212:215], v38, s[32:35], s57 offen offset:1024 sc1
v_mfma_f32_16x16x32_bf16 v[76:79], v[100:103], v[176:179], v[76:79]
ds_read_b64_tr_b16 v[236:237], v14 offset:49152
ds_read_b64_tr_b16 v[238:239], v14 offset:49664
v_mfma_f32_16x16x32_bf16 v[80:83], v[104:107], v[176:179], v[80:83]
ds_read_b64_tr_b16 v[240:241], v15 offset:49152
ds_read_b64_tr_b16 v[242:243], v15 offset:49664
v_mfma_f32_16x16x32_bf16 v[64:67], v[104:107], v[172:175], v[64:67]
buffer_load_dwordx4 v[216:219], v39, s[32:35], s57 offen offset:1024 sc1
v_mfma_f32_16x16x32_bf16 v[68:71], v[108:111], v[172:175], v[68:71]
ds_read_b64_tr_b16 v[244:245], v16 offset:49152
ds_read_b64_tr_b16 v[246:247], v16 offset:49664
v_mfma_f32_16x16x32_bf16 v[84:87], v[108:111], v[176:179], v[84:87]
ds_read_b64_tr_b16 v[248:249], v17 offset:49152
ds_read_b64_tr_b16 v[250:251], v17 offset:49664
v_mfma_f32_16x16x32_bf16 v[88:91], v[112:115], v[176:179], v[88:91]
v_mfma_f32_16x16x32_bf16 v[72:75], v[112:115], v[172:175], v[72:75]
s_waitcnt vmcnt(8) lgkmcnt(8)
v_mfma_f32_16x16x32_bf16 v[60:63], v[220:223], v[180:183], v[60:63]
v_mfma_f32_16x16x32_bf16 v[76:79], v[220:223], v[184:187], v[76:79]
ds_read_b64_tr_b16 v[100:101], v14 offset:53248
ds_read_b64_tr_b16 v[102:103], v14 offset:53760
v_mfma_f32_16x16x32_bf16 v[80:83], v[224:227], v[184:187], v[80:83]
ds_read_b64_tr_b16 v[104:105], v15 offset:53248
ds_read_b64_tr_b16 v[106:107], v15 offset:53760
v_mfma_f32_16x16x32_bf16 v[64:67], v[224:227], v[180:183], v[64:67]
v_mfma_f32_16x16x32_bf16 v[68:71], v[228:231], v[180:183], v[68:71]
ds_read_b64_tr_b16 v[108:109], v16 offset:53248
ds_read_b64_tr_b16 v[110:111], v16 offset:53760
v_mfma_f32_16x16x32_bf16 v[84:87], v[228:231], v[184:187], v[84:87]
ds_read_b64_tr_b16 v[112:113], v17 offset:53248
ds_read_b64_tr_b16 v[114:115], v17 offset:53760
v_mfma_f32_16x16x32_bf16 v[88:91], v[232:235], v[184:187], v[88:91]
v_mfma_f32_16x16x32_bf16 v[72:75], v[232:235], v[180:183], v[72:75]
s_waitcnt vmcnt(6) lgkmcnt(8)
v_mfma_f32_16x16x32_bf16 v[60:63], v[236:239], v[188:191], v[60:63]
v_mfma_f32_16x16x32_bf16 v[76:79], v[236:239], v[192:195], v[76:79]
ds_read_b64_tr_b16 v[220:221], v14 offset:57344
ds_read_b64_tr_b16 v[222:223], v14 offset:57856
v_mfma_f32_16x16x32_bf16 v[80:83], v[240:243], v[192:195], v[80:83]
ds_read_b64_tr_b16 v[224:225], v15 offset:57344
ds_read_b64_tr_b16 v[226:227], v15 offset:57856
v_mfma_f32_16x16x32_bf16 v[64:67], v[240:243], v[188:191], v[64:67]
v_mfma_f32_16x16x32_bf16 v[68:71], v[244:247], v[188:191], v[68:71]
ds_read_b64_tr_b16 v[228:229], v16 offset:57344
ds_read_b64_tr_b16 v[230:231], v16 offset:57856
v_mfma_f32_16x16x32_bf16 v[84:87], v[244:247], v[192:195], v[84:87]
ds_read_b64_tr_b16 v[232:233], v17 offset:57344
ds_read_b64_tr_b16 v[234:235], v17 offset:57856
v_mfma_f32_16x16x32_bf16 v[88:91], v[248:251], v[192:195], v[88:91]
v_mfma_f32_16x16x32_bf16 v[72:75], v[248:251], v[188:191], v[72:75]
s_waitcnt vmcnt(4) lgkmcnt(8)
v_mfma_f32_16x16x32_bf16 v[60:63], v[100:103], v[196:199], v[60:63]
v_mfma_f32_16x16x32_bf16 v[76:79], v[100:103], v[200:203], v[76:79]
ds_read_b64_tr_b16 v[236:237], v14 offset:61440
ds_read_b64_tr_b16 v[238:239], v14 offset:61952
v_mfma_f32_16x16x32_bf16 v[80:83], v[104:107], v[200:203], v[80:83]
ds_read_b64_tr_b16 v[240:241], v15 offset:61440
ds_read_b64_tr_b16 v[242:243], v15 offset:61952
v_mfma_f32_16x16x32_bf16 v[64:67], v[104:107], v[196:199], v[64:67]
v_mfma_f32_16x16x32_bf16 v[68:71], v[108:111], v[196:199], v[68:71]
ds_read_b64_tr_b16 v[244:245], v16 offset:61440
ds_read_b64_tr_b16 v[246:247], v16 offset:61952
v_mfma_f32_16x16x32_bf16 v[84:87], v[108:111], v[200:203], v[84:87]
ds_read_b64_tr_b16 v[248:249], v17 offset:61440
ds_read_b64_tr_b16 v[250:251], v17 offset:61952
v_mfma_f32_16x16x32_bf16 v[88:91], v[112:115], v[200:203], v[88:91]
v_mfma_f32_16x16x32_bf16 v[72:75], v[112:115], v[196:199], v[72:75]
s_waitcnt vmcnt(2) lgkmcnt(8)
v_mfma_f32_16x16x32_bf16 v[60:63], v[220:223], v[204:207], v[60:63]
v_mfma_f32_16x16x32_bf16 v[76:79], v[220:223], v[208:211], v[76:79]
v_mfma_f32_16x16x32_bf16 v[80:83], v[224:227], v[208:211], v[80:83]
v_mfma_f32_16x16x32_bf16 v[64:67], v[224:227], v[204:207], v[64:67]
v_mfma_f32_16x16x32_bf16 v[68:71], v[228:231], v[204:207], v[68:71]
v_mfma_f32_16x16x32_bf16 v[84:87], v[228:231], v[208:211], v[84:87]
v_mfma_f32_16x16x32_bf16 v[88:91], v[232:235], v[208:211], v[88:91]
v_mfma_f32_16x16x32_bf16 v[72:75], v[232:235], v[204:207], v[72:75]
s_waitcnt vmcnt(0) lgkmcnt(0)
v_mfma_f32_16x16x32_bf16 v[60:63], v[236:239], v[212:215], v[60:63]
v_mfma_f32_16x16x32_bf16 v[64:67], v[240:243], v[212:215], v[64:67]
v_mfma_f32_16x16x32_bf16 v[68:71], v[244:247], v[212:215], v[68:71]
v_mfma_f32_16x16x32_bf16 v[72:75], v[248:251], v[212:215], v[72:75]
v_mfma_f32_16x16x32_bf16 v[76:79], v[236:239], v[216:219], v[76:79]
v_mfma_f32_16x16x32_bf16 v[80:83], v[240:243], v[216:219], v[80:83]
v_mfma_f32_16x16x32_bf16 v[84:87], v[244:247], v[216:219], v[84:87]
v_mfma_f32_16x16x32_bf16 v[88:91], v[248:251], v[216:219], v[88:91]
s_setpc_b64 s[94:95]
R_oloop_end:
s_cmp_eq_u32 s46, 0
s_cbranch_scc1 slow_78
s_nop 0
v_cvt_pk_bf16_f32 v20, v60, v61
v_cvt_pk_bf16_f32 v21, v62, v63
v_cvt_pk_bf16_f32 v22, v64, v65
v_cvt_pk_bf16_f32 v23, v66, v67
buffer_store_dwordx4 v[20:23], v18, s[32:35], s85 offen offset:0 sc1
v_cvt_pk_bf16_f32 v24, v68, v69
v_cvt_pk_bf16_f32 v25, v70, v71
v_cvt_pk_bf16_f32 v26, v72, v73
v_cvt_pk_bf16_f32 v27, v74, v75
buffer_store_dwordx4 v[24:27], v18, s[32:35], s85 offen offset:1024 sc1
v_cvt_pk_bf16_f32 v28, v76, v77
v_cvt_pk_bf16_f32 v29, v78, v79
v_cvt_pk_bf16_f32 v30, v80, v81
v_cvt_pk_bf16_f32 v31, v82, v83
buffer_store_dwordx4 v[28:31], v18, s[32:35], s86 offen offset:0 sc1
v_cvt_pk_bf16_f32 v32, v84, v85
v_cvt_pk_bf16_f32 v33, v86, v87
v_cvt_pk_bf16_f32 v34, v88, v89
v_cvt_pk_bf16_f32 v35, v90, v91
buffer_store_dwordx4 v[32:35], v18, s[32:35], s86 offen offset:1024 sc1
s_barrier
v_dot2c_f32_bf16 v6, v20, v48
v_dot2c_f32_bf16 v8, v20, v20
v_dot2c_f32_bf16 v7, v28, v48
v_dot2c_f32_bf16 v9, v28, v28
v_dot2c_f32_bf16 v6, v21, v48
v_dot2c_f32_bf16 v8, v21, v21
v_dot2c_f32_bf16 v7, v29, v48
v_dot2c_f32_bf16 v9, v29, v29
v_dot2c_f32_bf16 v6, v22, v48
v_dot2c_f32_bf16 v8, v22, v22
v_dot2c_f32_bf16 v7, v30, v48
v_dot2c_f32_bf16 v9, v30, v30
v_dot2c_f32_bf16 v6, v23, v48
v_dot2c_f32_bf16 v8, v23, v23
v_dot2c_f32_bf16 v7, v31, v48
v_dot2c_f32_bf16 v9, v31, v31
v_dot2c_f32_bf16 v6, v24, v48
v_dot2c_f32_bf16 v8, v24, v24
v_dot2c_f32_bf16 v7, v32, v48
v_dot2c_f32_bf16 v9, v32, v32
v_dot2c_f32_bf16 v6, v25, v48
v_dot2c_f32_bf16 v8, v25, v25
v_dot2c_f32_bf16 v7, v33, v48
v_dot2c_f32_bf16 v9, v33, v33
v_dot2c_f32_bf16 v6, v26, v48
v_dot2c_f32_bf16 v8, v26, v26
v_dot2c_f32_bf16 v7, v34, v48
v_dot2c_f32_bf16 v9, v34, v34
v_dot2c_f32_bf16 v6, v27, v48
v_dot2c_f32_bf16 v8, v27, v27
v_dot2c_f32_bf16 v7, v35, v48
v_dot2c_f32_bf16 v9, v35, v35
s_mov_b64 exec, 1
s_waitcnt vmcnt(0)
buffer_store_dword v5, v4, s[32:35], s88 offen
s_mov_b64 exec, -1
s_nop 1
v_permlane32_swap_b32 v6, v7
v_permlane32_swap_b32 v8, v9
v_add_f32 v6, v6, v7
v_add_f32 v8, v8, v9
s_nop 1
v_permlane16_swap_b32 v6, v8
s_nop 0
v_add_f32 v6, v6, v8
buffer_store_dword v6, v1, s[32:35], s87 offen
back_79:
s_lshl_b32 s49, s44, 13
v_add_u32 v10, s49, v18
v_add_u32 v11, 1024, v10
s_lshl_b32 s48, s43, 1
v_lshrrev_b32 v4, 2, v2
v_and_b32 v5, 3, v0
v_lshl_add_u32 v6, v3, 3, v4
v_lshlrev_b32 v6, 7, v6
v_lshl_add_u32 v6, v5, 3, v6
v_lshrrev_b32 v7, 1, v4
v_and_b32 v8, 1, v3
v_lshl_add_u32 v7, v8, 1, v7
v_xor_b32 v7, s48, v7
v_lshl_add_u32 v12, v7, 5, v6
v_add_u32 v12, 16384, v12
v_xor_b32 v13, 32, v12
v_mov_b32 v14, v10
v_mov_b32 v15, v11
v_add_u32 v16, 122880, v12
v_add_u32 v17, 122880, v13
v_mov_b32 v156, 0
v_mov_b32 v157, 0
v_mov_b32 v158, 0
v_mov_b32 v159, 0
v_mov_b32 v160, 0
v_mov_b32 v161, 0
v_mov_b32 v162, 0
v_mov_b32 v163, 0
v_mov_b32 v164, 0
v_mov_b32 v165, 0
v_mov_b32 v166, 0
v_mov_b32 v167, 0
v_mov_b32 v168, 0
v_mov_b32 v169, 0
v_mov_b32 v170, 0
v_mov_b32 v171, 0
v_mov_b32 v172, 0
v_mov_b32 v173, 0
v_mov_b32 v174, 0
v_mov_b32 v175, 0
v_mov_b32 v176, 0
v_mov_b32 v177, 0
v_mov_b32 v178, 0
v_mov_b32 v179, 0
v_mov_b32 v180, 0
v_mov_b32 v181, 0
v_mov_b32 v182, 0
v_mov_b32 v183, 0
v_mov_b32 v184, 0
v_mov_b32 v185, 0
v_mov_b32 v186, 0
v_mov_b32 v187, 0
v_mov_b32 v188, 0
v_mov_b32 v189, 0
v_mov_b32 v190, 0
v_mov_b32 v191, 0
v_mov_b32 v192, 0
v_mov_b32 v193, 0
v_mov_b32 v194, 0
v_mov_b32 v195, 0
v_mov_b32 v196, 0
v_mov_b32 v197, 0
v_mov_b32 v198, 0
v_mov_b32 v199, 0
v_mov_b32 v200, 0
v_mov_b32 v201, 0
v_mov_b32 v202, 0
v_mov_b32 v203, 0
v_mov_b32 v204, 0
v_mov_b32 v205, 0
v_mov_b32 v206, 0
v_mov_b32 v207, 0
v_mov_b32 v208, 0
v_mov_b32 v209, 0
v_mov_b32 v210, 0
v_mov_b32 v211, 0
v_mov_b32 v212, 0
v_mov_b32 v213, 0
v_mov_b32 v214, 0
v_mov_b32 v215, 0
v_mov_b32 v216, 0
v_mov_b32 v217, 0
v_mov_b32 v218, 0
v_mov_b32 v219, 0
v_mov_b32 v220, 0
v_mov_b32 v221, 0
v_mov_b32 v222, 0
v_mov_b32 v223, 0
v_mov_b32 v224, 0
v_mov_b32 v225, 0
v_mov_b32 v226, 0
v_mov_b32 v227, 0
v_mov_b32 v228, 0
v_mov_b32 v229, 0
v_mov_b32 v230, 0
v_mov_b32 v231, 0
v_mov_b32 v232, 0
v_mov_b32 v233, 0
v_mov_b32 v234, 0
v_mov_b32 v235, 0
v_mov_b32 v236, 0
v_mov_b32 v237, 0
v_mov_b32 v238, 0
v_mov_b32 v239, 0
v_mov_b32 v240, 0
v_mov_b32 v241, 0
v_mov_b32 v242, 0
v_mov_b32 v243, 0
v_mov_b32 v244, 0
v_mov_b32 v245, 0
v_mov_b32 v246, 0
v_mov_b32 v247, 0
v_mov_b32 v248, 0
v_mov_b32 v249, 0
v_mov_b32 v250, 0
v_mov_b32 v251, 0
v_lshrrev_b32 v6, 2, v2
v_cmp_eq_u32 vcc, v6, v3
v_and_b32 v7, 1, v0
v_lshlrev_b32 v7, 4, v7
v_mov_b32 v8, 0x3f80
v_lshlrev_b32 v9, v7, v8
v_cndmask_b32 v7, 0, v9, vcc
v_and_b32 v6, 2, v0
v_cmp_eq_u32 vcc, 0, v6
v_mov_b32 v36, 0
v_mov_b32 v37, 0
v_mov_b32 v40, 0
v_mov_b32 v41, 0
v_cndmask_b32 v38, 0, v7, vcc
v_cndmask_b32 v39, v7, 0, vcc
v_lshrrev_b32 v8, 1, v2
v_cmp_eq_u32 vcc, 0, v8
s_nop 1
v_cndmask_b32 v44, 0, v9, vcc
v_cmp_eq_u32 vcc, 1, v8
s_nop 1
v_cndmask_b32 v45, 0, v9, vcc
v_cmp_eq_u32 vcc, 2, v8
s_nop 1
v_cndmask_b32 v46, 0, v9, vcc
v_cmp_eq_u32 vcc, 3, v8
s_nop 1
v_cndmask_b32 v47, 0, v9, vcc
v_lshrrev_b32 v4, 2, v2
v_lshl_add_u32 v4, v3, 2, v4
v_lshlrev_b32 v4, 6, v4
v_and_b32 v5, 3, v0
v_lshl_add_u32 v4, v5, 3, v4
s_lshl_b32 s48, s43, 11
s_add_u32 s48, s48, 135168
v_add_u32 v53, s48, v4
s_mul_i32 s48, s40, 3072
s_add_u32 s48, s48, 139264
v_add_u32 v42, s48, v18
s_xor_b32 s49, s40, 2
s_mul_i32 s48, s49, 3072
s_add_u32 s48, s48, 139264
v_add_u32 v43, s48, v18
s_lshl_b32 s49, s49, 2
s_add_u32 s49, s49, 134672
v_mov_b32 v19, s49
v_xor_b32 v52, 8, v19
v_lshrrev_b32 v4, 3, v0
v_and_b32 v5, 7, v0
v_lshlrev_b32 v4, 11, v4
v_lshl_add_u32 v55, v5, 4, v4
v_lshlrev_b32 v4, 6, v2
v_lshl_add_u32 v58, v3, 4, v4
v_lshlrev_b32 v4, 4, v2
v_lshl_add_u32 v59, v3, 3, v4
s_mul_i32 s51, s42, 163840
s_add_u32 s51, s51, 9437184
s_lshl_b32 s50, s43, 1
s_add_u32 s50, s50, s44
s_lshl_b32 s48, s50, 15
s_add_u32 s48, s48, s51
s_add_u32 s48, s48, 0
s_lshl_b32 s49, s41, 7
s_add_u32 s53, s48, s49
s_add_u32 s54, s53, 16384
s_lshl_b32 s56, s50, 10
s_add_u32 s56, s56, s51
s_add_u32 s56, s56, 147456
s_xor_b32 s57, s56, 1024
s_lshl_b32 s58, s50, 11
s_add_u32 s58, s58, s51
s_add_u32 s58, s58, 131072
s_xor_b32 s59, s58, 2048
s_add_u32 s79, s58, s49
s_lshl_b32 s50, s41, 11
s_add_u32 s55, s48, s50
s_lshl_b32 s48, s43, 7
s_add_u32 s48, s48, 133888
v_lshl_add_u32 v7, v3, 4, s48
v_lshl_add_u32 v54, v2, 2, s48
s_lshl_b32 s49, s44, 6
v_add_u32 v8, s49, v2
v_lshlrev_b32 v8, 3, v8
v_add_u32 v8, 131072, v8
v_lshl_add_u32 v9, v3, 2, s49
v_lshlrev_b32 v9, 2, v9
v_add_u32 v9, 132096, v9
s_mov_b32 s64, 0
s_mov_b32 s65, 0
s_mov_b32 s66, 0x3fb8aa3b
s_mov_b32 s61, 2
s_lshr_b32 s49, s42, 3
s_xor_b32 s77, s74, s49
s_add_u32 s77, s77, 4
s_lshl_b32 s50, s42, 2
s_add_u32 s50, s50, s40
s_lshl_b32 s50, s50, 4
s_add_u32 s50, s50, s41
s_lshl_b32 s50, s50, 8
s_add_u32 s52, s50, 18087936
ds_read_b64_tr_b16 v[84:85], v16 offset:8192
ds_read_b64_tr_b16 v[86:87], v16 offset:8704
ds_read_b64_tr_b16 v[88:89], v17 offset:8192
ds_read_b64_tr_b16 v[90:91], v17 offset:8704
ds_read_b64_tr_b16 v[92:93], v16 offset:16384
ds_read_b64_tr_b16 v[94:95], v16 offset:16896
ds_read_b64_tr_b16 v[96:97], v17 offset:16384
ds_read_b64_tr_b16 v[98:99], v17 offset:16896
ds_read_b64_tr_b16 v[76:77], v16 offset:0
ds_read_b64_tr_b16 v[78:79], v16 offset:512
ds_read_b64_tr_b16 v[80:81], v17 offset:0
ds_read_b64_tr_b16 v[82:83], v17 offset:512
s_barrier
ds_read_b128 v[60:63], v14 offset:0
ds_read_b128 v[64:67], v14 offset:2048
ds_read_b128 v[68:71], v14 offset:4096
ds_read_b128 v[72:75], v14 offset:6144
s_waitcnt lgkmcnt(0)
c1_loop:
v_mfma_f32_16x16x32_bf16 v[212:215], v[84:87], v[72:75], v[212:215]
ds_read_b128 v[100:103], v15 offset:0
v_mfma_f32_16x16x32_bf16 v[204:207], v[84:87], v[68:71], v[204:207]
ds_read_b128 v[104:107], v15 offset:2048
v_mfma_f32_16x16x32_bf16 v[196:199], v[84:87], v[64:67], v[196:199]
ds_read_b128 v[108:111], v15 offset:4096
v_mfma_f32_16x16x32_bf16 v[188:191], v[84:87], v[60:63], v[188:191]
ds_read_b128 v[112:115], v15 offset:6144
v_mfma_f32_16x16x32_bf16 v[192:195], v[88:91], v[60:63], v[192:195]
ds_read_b64_tr_b16 v[124:125], v16 offset:12288
v_mfma_f32_16x16x32_bf16 v[200:203], v[88:91], v[64:67], v[200:203]
ds_read_b64_tr_b16 v[126:127], v16 offset:12800
v_mfma_f32_16x16x32_bf16 v[208:211], v[88:91], v[68:71], v[208:211]
ds_read_b64_tr_b16 v[128:129], v17 offset:12288
v_mfma_f32_16x16x32_bf16 v[216:219], v[88:91], v[72:75], v[216:219]
ds_read_b64_tr_b16 v[130:131], v17 offset:12800
v_mfma_f32_16x16x32_bf16 v[244:247], v[72:75], v[92:95], v[244:247]
ds_read_b64_tr_b16 v[132:133], v16 offset:20480
v_mfma_f32_16x16x32_bf16 v[248:251], v[72:75], v[96:99], v[248:251]
ds_read_b64_tr_b16 v[134:135], v16 offset:20992
v_mfma_f32_16x16x32_bf16 v[240:243], v[68:71], v[96:99], v[240:243]
ds_read_b64_tr_b16 v[136:137], v17 offset:20480
v_mfma_f32_16x16x32_bf16 v[236:239], v[68:71], v[92:95], v[236:239]
ds_read_b64_tr_b16 v[138:139], v17 offset:20992
v_mfma_f32_16x16x32_bf16 v[228:231], v[64:67], v[92:95], v[228:231]
ds_read_b64_tr_b16 v[116:117], v16 offset:4096
v_mfma_f32_16x16x32_bf16 v[232:235], v[64:67], v[96:99], v[232:235]
ds_read_b64_tr_b16 v[118:119], v16 offset:4608
v_mfma_f32_16x16x32_bf16 v[224:227], v[60:63], v[96:99], v[224:227]
ds_read_b64_tr_b16 v[120:121], v17 offset:4096
v_mfma_f32_16x16x32_bf16 v[220:223], v[60:63], v[92:95], v[220:223]
ds_read_b64_tr_b16 v[122:123], v17 offset:4608
v_mfma_f32_16x16x32_bf16 v[156:159], v[76:79], v[60:63], v[156:159]
s_cmp_eq_u32 s77, s64
s_cbranch_scc1 c1_hook
c1_hook_ret:
v_mfma_f32_16x16x32_bf16 v[164:167], v[76:79], v[64:67], v[164:167]
s_add_u32 s65, s65, 40960
s_cmp_eq_u32 s65, 122880
v_mfma_f32_16x16x32_bf16 v[172:175], v[76:79], v[68:71], v[172:175]
s_cselect_b32 s65, 0, s65
s_add_u32 s64, s64, 1
v_mfma_f32_16x16x32_bf16 v[180:183], v[76:79], v[72:75], v[180:183]
v_add_u32 v14, s65, v10
v_add_u32 v15, s65, v11
v_mfma_f32_16x16x32_bf16 v[184:187], v[80:83], v[72:75], v[184:187]
v_add_u32 v16, s65, v12
v_add_u32 v17, s65, v13
v_mfma_f32_16x16x32_bf16 v[176:179], v[80:83], v[68:71], v[176:179]
s_cmp_eq_u32 s64, 16
s_cbranch_scc1 c1_last
v_mfma_f32_16x16x32_bf16 v[168:171], v[80:83], v[64:67], v[168:171]
s_waitcnt lgkmcnt(0)
v_mfma_f32_16x16x32_bf16 v[160:163], v[80:83], v[60:63], v[160:163]
s_barrier
v_mfma_f32_16x16x32_bf16 v[212:215], v[124:127], v[112:115], v[212:215]
ds_read_b128 v[60:63], v14 offset:0
v_mfma_f32_16x16x32_bf16 v[204:207], v[124:127], v[108:111], v[204:207]
ds_read_b128 v[64:67], v14 offset:2048
v_mfma_f32_16x16x32_bf16 v[196:199], v[124:127], v[104:107], v[196:199]
ds_read_b128 v[68:71], v14 offset:4096
v_mfma_f32_16x16x32_bf16 v[188:191], v[124:127], v[100:103], v[188:191]
ds_read_b128 v[72:75], v14 offset:6144
v_mfma_f32_16x16x32_bf16 v[192:195], v[128:131], v[100:103], v[192:195]
ds_read_b64_tr_b16 v[84:85], v16 offset:8192
v_mfma_f32_16x16x32_bf16 v[200:203], v[128:131], v[104:107], v[200:203]
ds_read_b64_tr_b16 v[86:87], v16 offset:8704
v_mfma_f32_16x16x32_bf16 v[208:211], v[128:131], v[108:111], v[208:211]
ds_read_b64_tr_b16 v[88:89], v17 offset:8192
v_mfma_f32_16x16x32_bf16 v[216:219], v[128:131], v[112:115], v[216:219]
ds_read_b64_tr_b16 v[90:91], v17 offset:8704
v_mfma_f32_16x16x32_bf16 v[244:247], v[112:115], v[132:135], v[244:247]
ds_read_b64_tr_b16 v[92:93], v16 offset:16384
v_mfma_f32_16x16x32_bf16 v[248:251], v[112:115], v[136:139], v[248:251]
ds_read_b64_tr_b16 v[94:95], v16 offset:16896
v_mfma_f32_16x16x32_bf16 v[240:243], v[108:111], v[136:139], v[240:243]
ds_read_b64_tr_b16 v[96:97], v17 offset:16384
v_mfma_f32_16x16x32_bf16 v[236:239], v[108:111], v[132:135], v[236:239]
ds_read_b64_tr_b16 v[98:99], v17 offset:16896
v_mfma_f32_16x16x32_bf16 v[228:231], v[104:107], v[132:135], v[228:231]
ds_read_b64_tr_b16 v[76:77], v16 offset:0
v_mfma_f32_16x16x32_bf16 v[232:235], v[104:107], v[136:139], v[232:235]
ds_read_b64_tr_b16 v[78:79], v16 offset:512
v_mfma_f32_16x16x32_bf16 v[224:227], v[100:103], v[136:139], v[224:227]
ds_read_b64_tr_b16 v[80:81], v17 offset:0
v_mfma_f32_16x16x32_bf16 v[220:223], v[100:103], v[132:135], v[220:223]
ds_read_b64_tr_b16 v[82:83], v17 offset:512
v_mfma_f32_16x16x32_bf16 v[156:159], v[116:119], v[100:103], v[156:159]
v_mfma_f32_16x16x32_bf16 v[164:167], v[116:119], v[104:107], v[164:167]
v_mfma_f32_16x16x32_bf16 v[172:175], v[116:119], v[108:111], v[172:175]
v_mfma_f32_16x16x32_bf16 v[180:183], v[116:119], v[112:115], v[180:183]
v_mfma_f32_16x16x32_bf16 v[184:187], v[120:123], v[112:115], v[184:187]
v_mfma_f32_16x16x32_bf16 v[176:179], v[120:123], v[108:111], v[176:179]
v_mfma_f32_16x16x32_bf16 v[168:171], v[120:123], v[104:107], v[168:171]
s_waitcnt lgkmcnt(0)
v_mfma_f32_16x16x32_bf16 v[160:163], v[120:123], v[100:103], v[160:163]
s_branch c1_loop
c1_hook:
s_waitcnt lgkmcnt(0)
s_cmp_lg_u32 s44, 0
s_cbranch_scc1 else_80
v_mfma_f32_16x16x32_bf16 v[140:143], v[48:51], v[76:79], 0
v_mfma_f32_16x16x32_bf16 v[144:147], v[48:51], v[84:87], 0
v_mfma_f32_16x16x32_bf16 v[148:151], v[48:51], v[92:95], 0
v_mfma_f32_16x16x32_bf16 v[140:143], v[48:51], v[116:119], v[140:143]
v_mfma_f32_16x16x32_bf16 v[144:147], v[48:51], v[124:127], v[144:147]
v_mfma_f32_16x16x32_bf16 v[148:151], v[48:51], v[132:135], v[148:151]
s_branch fi_81
else_80:
v_mfma_f32_16x16x32_bf16 v[140:143], v[48:51], v[80:83], 0
v_mfma_f32_16x16x32_bf16 v[144:147], v[48:51], v[88:91], 0
v_mfma_f32_16x16x32_bf16 v[148:151], v[48:51], v[96:99], 0
v_mfma_f32_16x16x32_bf16 v[140:143], v[48:51], v[120:123], v[140:143]
v_mfma_f32_16x16x32_bf16 v[144:147], v[48:51], v[128:131], v[144:147]
v_mfma_f32_16x16x32_bf16 v[148:151], v[48:51], v[136:139], v[148:151]
fi_81:
s_nop 4
v_cmp_eq_u32 vcc, 0, v3
v_cmp_eq_u32 s[48:49], 1, v3
s_nop 1
v_cndmask_b32 v4, v148, v144, s[48:49]
v_cndmask_b32 v4, v4, v140, vcc
buffer_store_dword v4, v1, s[32:35], s52 offen sc1
s_branch c1_hook_ret
c1_last:
v_mfma_f32_16x16x32_bf16 v[168:171], v[80:83], v[64:67], v[168:171]
s_waitcnt lgkmcnt(0)
v_mfma_f32_16x16x32_bf16 v[160:163], v[80:83], v[60:63], v[160:163]
v_mfma_f32_16x16x32_bf16 v[212:215], v[124:127], v[112:115], v[212:215]
ds_read_b64_tr_b16 v[10:11], v53 offset:0
ds_read_b64_tr_b16 v[12:13], v53 offset:1024
v_mfma_f32_16x16x32_bf16 v[204:207], v[124:127], v[108:111], v[204:207]
ds_read_b64_tr_b16 v[14:15], v53 offset:32
ds_read_b64_tr_b16 v[16:17], v53 offset:1056
v_mfma_f32_16x16x32_bf16 v[196:199], v[124:127], v[104:107], v[196:199]

s_mul_i32 s48, s44, 0x80008000
v_mfma_f32_16x16x32_bf16 v[188:191], v[124:127], v[100:103], v[188:191]

v_mfma_f32_16x16x32_bf16 v[192:195], v[128:131], v[100:103], v[192:195]

v_mfma_f32_16x16x32_bf16 v[200:203], v[128:131], v[104:107], v[200:203]

v_mfma_f32_16x16x32_bf16 v[208:211], v[128:131], v[108:111], v[208:211]

s_waitcnt lgkmcnt(0)
v_mfma_f32_16x16x32_bf16 v[216:219], v[128:131], v[112:115], v[216:219]
s_barrier
v_mfma_f32_16x16x32_bf16 v[244:247], v[112:115], v[132:135], v[244:247]
ds_read_b128 v[140:143], v7 offset:0
ds_read_b128 v[144:147], v7 offset:64
v_mfma_f32_16x16x32_bf16 v[248:251], v[112:115], v[136:139], v[248:251]
ds_read_b128 v[148:151], v7 offset:256
ds_read_b128 v[152:155], v7 offset:320
v_mfma_f32_16x16x32_bf16 v[240:243], v[108:111], v[136:139], v[240:243]
ds_read_b64 v[92:93], v8 offset:0
ds_read_b64 v[94:95], v8 offset:128
v_mfma_f32_16x16x32_bf16 v[236:239], v[108:111], v[132:135], v[236:239]
ds_read_b64 v[96:97], v8 offset:256
ds_read_b64 v[98:99], v8 offset:384
v_mfma_f32_16x16x32_bf16 v[228:231], v[104:107], v[132:135], v[228:231]
ds_read2_b32 v[56:57], v54 offset0:128 offset1:144
v_xor_b32 v10, s48, v10
v_mfma_f32_16x16x32_bf16 v[232:235], v[104:107], v[136:139], v[232:235]
ds_read_b128 v[60:63], v9 offset:0
v_xor_b32 v11, s48, v11
v_mfma_f32_16x16x32_bf16 v[224:227], v[100:103], v[136:139], v[224:227]
ds_read_b128 v[64:67], v9 offset:64
v_xor_b32 v12, s48, v12
v_mfma_f32_16x16x32_bf16 v[220:223], v[100:103], v[132:135], v[220:223]
ds_read_b128 v[68:71], v9 offset:128
v_xor_b32 v13, s48, v13
v_mfma_f32_16x16x32_bf16 v[156:159], v[116:119], v[100:103], v[156:159]
ds_read_b128 v[72:75], v9 offset:192
v_xor_b32 v14, s48, v14
v_mfma_f32_16x16x32_bf16 v[164:167], v[116:119], v[104:107], v[164:167]
ds_read_b128 v[76:79], v9 offset:512
v_xor_b32 v15, s48, v15
v_mfma_f32_16x16x32_bf16 v[172:175], v[116:119], v[108:111], v[172:175]
ds_read_b128 v[80:83], v9 offset:576
v_xor_b32 v16, s48, v16
v_mfma_f32_16x16x32_bf16 v[180:183], v[116:119], v[112:115], v[180:183]
ds_read_b128 v[84:87], v9 offset:640
v_xor_b32 v17, s48, v17
v_mfma_f32_16x16x32_bf16 v[184:187], v[120:123], v[112:115], v[184:187]
ds_read_b128 v[88:91], v9 offset:704
v_mfma_f32_16x16x32_bf16 v[176:179], v[120:123], v[108:111], v[176:179]
v_mfma_f32_16x16x32_bf16 v[168:171], v[120:123], v[104:107], v[168:171]
v_mfma_f32_16x16x32_bf16 v[160:163], v[120:123], v[100:103], v[160:163]
c1_epi:
s_waitcnt lgkmcnt(0)
.p2align 3
v_mul_f32 v129, s66, v94
v_mul_f32 v128, s66, v92
v_mul_f32 v131, s66, v98
v_mul_f32 v130, s66, v96
v_pk_fma_f32 v[190:191], v[150:151], v[92:93], v[190:191] op_sel:[0,1,0] op_sel_hi:[1,1,1]
v_pk_fma_f32 v[212:213], v[148:149], v[98:99], v[212:213] op_sel:[0,1,0] op_sel_hi:[1,1,1]
v_pk_fma_f32 v[214:215], v[150:151], v[98:99], v[214:215] op_sel:[0,1,0] op_sel_hi:[1,1,1]
v_pk_fma_f32 v[188:189], v[148:149], v[92:93], v[188:189] op_sel:[0,1,0] op_sel_hi:[1,1,1]
v_pk_fma_f32 v[218:219], v[154:155], v[98:99], v[218:219] op_sel:[0,1,0] op_sel_hi:[1,1,1]
v_cvt_pk_bf16_f32 v188, v188, v189
v_cvt_pk_bf16_f32 v189, v190, v191
v_pk_fma_f32 v[196:197], v[148:149], v[94:95], v[196:197] op_sel:[0,1,0] op_sel_hi:[1,1,1]
v_pk_fma_f32 v[200:201], v[152:153], v[94:95], v[200:201] op_sel:[0,1,0] op_sel_hi:[1,1,1]
v_pk_fma_f32 v[210:211], v[154:155], v[96:97], v[210:211] op_sel:[0,1,0] op_sel_hi:[1,1,1]
v_pk_fma_f32 v[240:241], v[84:85], v[56:57], v[240:241] op_sel:[0,1,0] op_sel_hi:[1,1,1]
v_pk_fma_f32 v[228:229], v[80:81], v[56:57], v[228:229] op_sel:[0,0,0] op_sel_hi:[1,0,1]
v_pk_fma_f32 v[226:227], v[78:79], v[56:57], v[226:227] op_sel:[0,1,0] op_sel_hi:[1,1,1]
v_pk_fma_f32 v[192:193], v[152:153], v[92:93], v[192:193] op_sel:[0,1,0] op_sel_hi:[1,1,1]
v_cvt_pk_bf16_f32 v190, v192, v193
v_pk_fma_f32 v[238:239], v[86:87], v[56:57], v[238:239] op_sel:[0,0,0] op_sel_hi:[1,0,1]
v_pk_fma_f32 v[234:235], v[82:83], v[56:57], v[234:235] op_sel:[0,1,0] op_sel_hi:[1,1,1]
v_pk_mul_f32 v[226:227], v[226:227], v[62:63]
v_pk_fma_f32 v[204:205], v[148:149], v[96:97], v[204:205] op_sel:[0,1,0] op_sel_hi:[1,1,1]
v_cvt_pk_bf16_f32 v204, v204, v205
v_pk_fma_f32 v[202:203], v[154:155], v[94:95], v[202:203] op_sel:[0,1,0] op_sel_hi:[1,1,1]
v_pk_fma_f32 v[224:225], v[76:77], v[56:57], v[224:225] op_sel:[0,1,0] op_sel_hi:[1,1,1]
v_pk_fma_f32 v[216:217], v[152:153], v[98:99], v[216:217] op_sel:[0,1,0] op_sel_hi:[1,1,1]
v_pk_fma_f32 v[244:245], v[88:89], v[56:57], v[244:245] op_sel:[0,0,0] op_sel_hi:[1,0,1]
v_pk_mul_f32 v[238:239], v[238:239], v[70:71]
v_pk_mul_f32 v[228:229], v[228:229], v[64:65]
v_pk_fma_f32 v[236:237], v[84:85], v[56:57], v[236:237] op_sel:[0,0,0] op_sel_hi:[1,0,1]
v_pk_fma_f32 v[220:221], v[76:77], v[56:57], v[220:221] op_sel:[0,0,0] op_sel_hi:[1,0,1]
v_pk_mul_f32 v[224:225], v[224:225], v[60:61]
v_cvt_pk_bf16_f32 v212, v212, v213
v_cvt_pk_bf16_f32 v213, v214, v215
v_cvt_pk_bf16_f32 v196, v196, v197
v_pk_mul_f32 v[240:241], v[240:241], v[68:69]
v_pk_fma_f32 v[198:199], v[150:151], v[94:95], v[198:199] op_sel:[0,1,0] op_sel_hi:[1,1,1]
v_cvt_pk_bf16_f32 v197, v198, v199
v_cvt_pk_bf16_f32 v198, v200, v201
v_cvt_pk_bf16_f32 v199, v202, v203
v_cvt_pk_bf16_f32 v215, v218, v219
v_pk_fma_f32 v[208:209], v[152:153], v[96:97], v[208:209] op_sel:[0,1,0] op_sel_hi:[1,1,1]
v_pk_fma_f32 v[246:247], v[90:91], v[56:57], v[246:247] op_sel:[0,0,0] op_sel_hi:[1,0,1]
v_pk_fma_f32 v[250:251], v[90:91], v[56:57], v[250:251] op_sel:[0,1,0] op_sel_hi:[1,1,1]
v_pk_mul_f32 v[250:251], v[250:251], v[74:75]
v_pk_fma_f32 v[206:207], v[150:151], v[96:97], v[206:207] op_sel:[0,1,0] op_sel_hi:[1,1,1]
v_cvt_pk_bf16_f32 v205, v206, v207
v_pk_fma_f32 v[242:243], v[86:87], v[56:57], v[242:243] op_sel:[0,1,0] op_sel_hi:[1,1,1]
v_cvt_pk_bf16_f32 v207, v210, v211
v_pk_mul_f32 v[236:237], v[236:237], v[68:69]
v_pk_fma_f32 v[230:231], v[82:83], v[56:57], v[230:231] op_sel:[0,0,0] op_sel_hi:[1,0,1]
v_pk_fma_f32 v[194:195], v[154:155], v[92:93], v[194:195] op_sel:[0,1,0] op_sel_hi:[1,1,1]
v_cvt_pk_bf16_f32 v191, v194, v195
v_pk_fma_f32 v[232:233], v[80:81], v[56:57], v[232:233] op_sel:[0,1,0] op_sel_hi:[1,1,1]
v_pk_mul_f32 v[232:233], v[232:233], v[64:65]
v_pk_mul_f32 v[230:231], v[230:231], v[66:67]
v_pk_fma_f32 v[248:249], v[88:89], v[56:57], v[248:249] op_sel:[0,1,0] op_sel_hi:[1,1,1]
v_pk_mul_f32 v[248:249], v[248:249], v[72:73]
v_pk_mul_f32 v[242:243], v[242:243], v[70:71]
v_mfma_f32_16x16x32_bf16 v[68:71], v[10:13], v[196:199], 0
v_cvt_pk_bf16_f32 v206, v208, v209
v_cvt_pk_bf16_f32 v214, v216, v217
v_cvt_pk_bf16_f32 v121, v226, v227
v_mfma_f32_16x16x32_bf16 v[80:83], v[14:17], v[204:207], 0
v_cvt_pk_bf16_f32 v120, v224, v225
v_cvt_pk_bf16_f32 v114, v228, v229
v_mfma_f32_16x16x32_bf16 v[84:87], v[10:13], v[212:215], 0
v_cvt_pk_bf16_f32 v116, v236, v237
v_min3_f32 v105, v68, v69, v70
v_mfma_f32_16x16x32_bf16 v[88:91], v[14:17], v[212:215], 0
v_max3_f32 v101, v68, v69, v70
v_cvt_pk_bf16_f32 v115, v230, v231
v_cvt_pk_bf16_f32 v122, v232, v233
v_cvt_pk_bf16_f32 v127, v250, v251
v_cvt_pk_bf16_f32 v124, v240, v241
v_pk_mul_f32 v[244:245], v[244:245], v[72:73]
v_pk_fma_f32 v[222:223], v[78:79], v[56:57], v[222:223] op_sel:[0,0,0] op_sel_hi:[1,0,1]
v_pk_mul_f32 v[222:223], v[222:223], v[62:63]
v_mfma_f32_16x16x32_bf16 v[76:79], v[10:13], v[204:207], 0
v_min3_f32 v107, v84, v85, v86
v_min3_f32 v107, v107, v87, v88
v_min3_f32 v107, v107, v89, v90
v_min_f32_e64 v107, v107, v91
v_max3_f32 v103, v84, v85, v86
v_pk_mul_f32 v[220:221], v[220:221], v[60:61]
v_mfma_f32_16x16x32_bf16 v[60:63], v[10:13], v[188:191], 0
v_max3_f32 v103, v103, v87, v88
v_min3_f32 v106, v76, v77, v78
v_min3_f32 v106, v106, v79, v80
v_min3_f32 v106, v106, v81, v82
v_min_f32 v106, v106, v83
v_pk_mul_f32 v[234:235], v[234:235], v[66:67]
v_mfma_f32_16x16x32_bf16 v[64:67], v[14:17], v[188:191], 0
v_permlane32_swap_b32 v106, v107
v_min3_f32 v104, v60, v61, v62
v_min_f32 v106, v106, v107
v_max3_f32 v103, v103, v89, v90
v_pk_mul_f32 v[246:247], v[246:247], v[74:75]
v_mfma_f32_16x16x32_bf16 v[72:75], v[14:17], v[196:199], 0
v_max_f32 v103, v103, v91
v_max3_f32 v102, v76, v77, v78
v_min3_f32 v104, v104, v63, v64
v_min3_f32 v104, v104, v65, v66
v_min_f32 v104, v104, v67
v_max3_f32 v102, v102, v79, v80
v_max3_f32 v102, v102, v81, v82
v_max_f32 v102, v102, v83
v_min3_f32 v105, v105, v71, v72
v_min3_f32 v105, v105, v73, v74
v_min_f32 v105, v105, v75
v_max3_f32 v101, v101, v71, v72
v_max3_f32 v101, v101, v73, v74
v_permlane32_swap_b32 v104, v105
v_permlane32_swap_b32 v102, v103
v_min_f32 v104, v104, v105
v_max_f32 v102, v102, v103
v_max_f32 v101, v101, v75
v_permlane16_swap_b32 v104, v106
v_max3_f32 v100, v60, v61, v62
v_min_f32 v104, v104, v106
v_mov_b32 v106, v104
v_max3_f32 v100, v100, v63, v64
v_max3_f32 v100, v100, v65, v66
v_max_f32 v100, v100, v67
v_permlane16_swap_b32 v104, v106
v_cvt_pk_bf16_f32 v112, v220, v221
v_permlane32_swap_b32 v100, v101
v_mov_b32 v105, v104
v_max_f32 v100, v100, v101
v_mov_b32 v107, v106
v_permlane32_swap_b32 v104, v105
v_permlane16_swap_b32 v100, v102
v_pk_mul_f32 v[104:105], v[104:105], v[128:129]
v_pk_fma_f32 v[226:227], v[66:67], v[128:129], v[104:105] op_sel:[0,0,0] op_sel_hi:[1,0,0] neg_lo:[1,0,0] neg_hi:[1,0,0]
v_pk_fma_f32 v[230:231], v[70:71], v[128:129], v[104:105] op_sel:[0,1,1] op_sel_hi:[1,1,1] neg_lo:[1,0,0] neg_hi:[1,0,0]
v_exp_f32 v226, v226
v_pk_fma_f32 v[224:225], v[64:65], v[128:129], v[104:105] op_sel:[0,0,0] op_sel_hi:[1,0,0] neg_lo:[1,0,0] neg_hi:[1,0,0]
v_exp_f32 v224, v224
v_pk_fma_f32 v[228:229], v[68:69], v[128:129], v[104:105] op_sel:[0,1,1] op_sel_hi:[1,1,1] neg_lo:[1,0,0] neg_hi:[1,0,0]
v_exp_f32 v231, v231
v_cvt_pk_bf16_f32 v113, v222, v223
v_pk_fma_f32 v[222:223], v[62:63], v[128:129], v[104:105] op_sel:[0,0,0] op_sel_hi:[1,0,0] neg_lo:[1,0,0] neg_hi:[1,0,0]
v_exp_f32 v222, v222
v_pk_fma_f32 v[220:221], v[60:61], v[128:129], v[104:105] op_sel:[0,0,0] op_sel_hi:[1,0,0] neg_lo:[1,0,0] neg_hi:[1,0,0]
v_exp_f32 v221, v221
v_exp_f32 v220, v220
v_max_f32 v100, v100, v102
v_exp_f32 v223, v223
v_mov_b32 v102, v100
v_pk_add_f32 v[110:111], v[220:221], v[222:223]
v_exp_f32 v225, v225
v_pk_fma_f32 v[232:233], v[72:73], v[128:129], v[104:105] op_sel:[0,1,1] op_sel_hi:[1,1,1] neg_lo:[1,0,0] neg_hi:[1,0,0]
v_exp_f32 v232, v232
v_exp_f32 v233, v233
v_pk_add_f32 v[110:111], v[110:111], v[224:225]
v_exp_f32 v229, v229
v_exp_f32 v228, v228
v_exp_f32 v227, v227
v_cvt_pk_bf16_f32 v123, v234, v235
v_pk_fma_f32 v[234:235], v[74:75], v[128:129], v[104:105] op_sel:[0,1,1] op_sel_hi:[1,1,1] neg_lo:[1,0,0] neg_hi:[1,0,0]
v_pk_add_f32 v[110:111], v[110:111], v[226:227]
v_add_f32 v104, v110, v111
v_cvt_pk_bf16_f32 v118, v244, v245
v_permlane32_swap_b32 v106, v107
v_permlane16_swap_b32 v100, v102
v_exp_f32 v234, v234
v_mov_b32 v101, v100
v_exp_f32 v235, v235
v_exp_f32_e64 v230, v230
v_cvt_pk_bf16_f32 v125, v242, v243
v_pk_add_f32 v[110:111], v[228:229], v[230:231]
v_pk_add_f32 v[110:111], v[110:111], v[232:233]
v_pk_add_f32 v[110:111], v[110:111], v[234:235]
v_cvt_pk_bf16_f32 v126, v248, v249
v_pk_mul_f32 v[106:107], v[106:107], v[130:131]
v_pk_fma_f32 v[236:237], v[76:77], v[130:131], v[106:107] op_sel:[0,0,0] op_sel_hi:[1,0,0] neg_lo:[1,0,0] neg_hi:[1,0,0]
v_exp_f32 v237, v237
v_exp_f32 v236, v236
v_pk_fma_f32 v[242:243], v[82:83], v[130:131], v[106:107] op_sel:[0,0,0] op_sel_hi:[1,0,0] neg_lo:[1,0,0] neg_hi:[1,0,0]
v_pk_fma_f32 v[250:251], v[90:91], v[130:131], v[106:107] op_sel:[0,1,1] op_sel_hi:[1,1,1] neg_lo:[1,0,0] neg_hi:[1,0,0]
v_add_f32 v105, v110, v111
v_exp_f32 v243, v243
v_cvt_pk_bf16_f32 v119, v246, v247
v_pk_fma_f32 v[246:247], v[86:87], v[130:131], v[106:107] op_sel:[0,1,1] op_sel_hi:[1,1,1] neg_lo:[1,0,0] neg_hi:[1,0,0]
v_exp_f32 v246, v246
v_cvt_pk_bf16_f32 v117, v238, v239
v_pk_fma_f32 v[238:239], v[78:79], v[130:131], v[106:107] op_sel:[0,0,0] op_sel_hi:[1,0,0] neg_lo:[1,0,0] neg_hi:[1,0,0]
v_exp_f32 v238, v238
v_exp_f32 v247, v247
v_pk_fma_f32 v[240:241], v[80:81], v[130:131], v[106:107] op_sel:[0,0,0] op_sel_hi:[1,0,0] neg_lo:[1,0,0] neg_hi:[1,0,0]
v_exp_f32 v240, v240
v_exp_f32 v241, v241
v_permlane32_swap_b32 v100, v101
v_exp_f32 v242, v242
v_pk_fma_f32 v[244:245], v[84:85], v[130:131], v[106:107] op_sel:[0,1,1] op_sel_hi:[1,1,1] neg_lo:[1,0,0] neg_hi:[1,0,0]
v_exp_f32 v244, v244
v_exp_f32_e64 v239, v239
v_pk_mul_f32 v[100:101], v[100:101], v[128:129]
v_pk_fma_f32 v[62:63], v[62:63], v[128:129], v[100:101] op_sel:[0,0,0] op_sel_hi:[1,0,0] neg_lo:[0,0,1] neg_hi:[0,0,1]
v_pk_add_f32 v[110:111], v[236:237], v[238:239]
v_pk_add_f32 v[110:111], v[110:111], v[240:241]
v_pk_add_f32 v[110:111], v[110:111], v[242:243]
v_pk_fma_f32 v[72:73], v[72:73], v[128:129], v[100:101] op_sel:[0,1,1] op_sel_hi:[1,1,1] neg_lo:[0,0,1] neg_hi:[0,0,1]
v_pk_fma_f32 v[66:67], v[66:67], v[128:129], v[100:101] op_sel:[0,0,0] op_sel_hi:[1,0,0] neg_lo:[0,0,1] neg_hi:[0,0,1]
v_exp_f32 v62, v62
v_pk_fma_f32 v[60:61], v[60:61], v[128:129], v[100:101] op_sel:[0,0,0] op_sel_hi:[1,0,0] neg_lo:[0,0,1] neg_hi:[0,0,1]
v_exp_f32 v60, v60
v_exp_f32 v245, v245
v_exp_f32 v73, v73
v_pk_fma_f32 v[248:249], v[88:89], v[130:131], v[106:107] op_sel:[0,1,1] op_sel_hi:[1,1,1] neg_lo:[1,0,0] neg_hi:[1,0,0]
v_add_f32 v106, v110, v111
v_exp_f32 v249, v249
v_pk_add_f32 v[110:111], v[244:245], v[246:247]
v_exp_f32 v248, v248
v_pk_fma_f32 v[64:65], v[64:65], v[128:129], v[100:101] op_sel:[0,0,0] op_sel_hi:[1,0,0] neg_lo:[0,0,1] neg_hi:[0,0,1]
v_exp_f32 v64, v64
v_pk_add_f32 v[110:111], v[110:111], v[248:249]
v_exp_f32 v65, v65
v_exp_f32 v61, v61
v_exp_f32 v66, v66
v_exp_f32 v251, v251
v_exp_f32 v63, v63
v_pk_fma_f32 v[74:75], v[74:75], v[128:129], v[100:101] op_sel:[0,1,1] op_sel_hi:[1,1,1] neg_lo:[0,0,1] neg_hi:[0,0,1]
v_pk_add_f32 v[108:109], v[60:61], v[62:63]
v_exp_f32 v67, v67
v_exp_f32 v250, v250
v_pk_fma_f32 v[68:69], v[68:69], v[128:129], v[100:101] op_sel:[0,1,1] op_sel_hi:[1,1,1] neg_lo:[0,0,1] neg_hi:[0,0,1]
v_pk_add_f32 v[110:111], v[110:111], v[250:251]
v_exp_f32 v68, v68
v_exp_f32 v69, v69
v_add_f32 v107, v110, v111
v_mov_b32 v103, v102
v_pk_fma_f32 v[70:71], v[70:71], v[128:129], v[100:101] op_sel:[0,1,1] op_sel_hi:[1,1,1] neg_lo:[0,0,1] neg_hi:[0,0,1]
v_exp_f32 v71, v71
v_exp_f32 v70, v70
v_permlane32_swap_b32 v106, v107
v_permlane32_swap_b32 v102, v103
v_pk_add_f32 v[108:109], v[108:109], v[64:65]
v_pk_add_f32 v[108:109], v[108:109], v[66:67]
v_add_f32 v100, v108, v109
v_pk_add_f32 v[108:109], v[68:69], v[70:71]
v_pk_mul_f32 v[102:103], v[102:103], v[130:131]
v_pk_fma_f32 v[78:79], v[78:79], v[130:131], v[102:103] op_sel:[0,0,0] op_sel_hi:[1,0,0] neg_lo:[0,0,1] neg_hi:[0,0,1]
v_exp_f32 v79, v79
v_exp_f32 v78, v78
v_exp_f32 v74, v74
v_exp_f32 v72, v72
v_pk_fma_f32 v[86:87], v[86:87], v[130:131], v[102:103] op_sel:[0,1,1] op_sel_hi:[1,1,1] neg_lo:[0,0,1] neg_hi:[0,0,1]
v_exp_f32 v87, v87
v_pk_fma_f32 v[76:77], v[76:77], v[130:131], v[102:103] op_sel:[0,0,0] op_sel_hi:[1,0,0] neg_lo:[0,0,1] neg_hi:[0,0,1]
v_exp_f32 v77, v77
v_add_f32 v106, v106, v107
v_pk_fma_f32 v[80:81], v[80:81], v[130:131], v[102:103] op_sel:[0,0,0] op_sel_hi:[1,0,0] neg_lo:[0,0,1] neg_hi:[0,0,1]
v_exp_f32 v81, v81
v_exp_f32 v80, v80
v_pk_add_f32 v[108:109], v[108:109], v[72:73]
v_permlane32_swap_b32 v104, v105
v_exp_f32 v75, v75
v_add_f32 v104, v104, v105
v_pk_fma_f32 v[82:83], v[82:83], v[130:131], v[102:103] op_sel:[0,0,0] op_sel_hi:[1,0,0] neg_lo:[0,0,1] neg_hi:[0,0,1]
v_exp_f32 v82, v82
v_exp_f32 v83, v83
v_permlane16_swap_b32 v104, v106
v_pk_add_f32 v[108:109], v[108:109], v[74:75]
v_add_f32 v101, v108, v109
v_exp_f32 v76, v76
v_add_f32 v104, v104, v106
v_rcp_f32 v104, v104
v_pk_fma_f32 v[84:85], v[84:85], v[130:131], v[102:103] op_sel:[0,1,1] op_sel_hi:[1,1,1] neg_lo:[0,0,1] neg_hi:[0,0,1]
v_exp_f32 v84, v84
v_exp_f32 v85, v85
v_mov_b32 v106, v104
v_pk_add_f32 v[108:109], v[76:77], v[78:79]
v_pk_add_f32 v[108:109], v[108:109], v[80:81]
v_pk_add_f32 v[108:109], v[108:109], v[82:83]
v_pk_fma_f32 v[88:89], v[88:89], v[130:131], v[102:103] op_sel:[0,1,1] op_sel_hi:[1,1,1] neg_lo:[0,0,1] neg_hi:[0,0,1]
v_exp_f32 v88, v88
v_exp_f32 v89, v89
v_exp_f32 v86, v86
v_pk_fma_f32 v[90:91], v[90:91], v[130:131], v[102:103] op_sel:[0,1,1] op_sel_hi:[1,1,1] neg_lo:[0,0,1] neg_hi:[0,0,1]
v_add_f32 v102, v108, v109
v_pk_add_f32 v[108:109], v[84:85], v[86:87]
v_pk_add_f32 v[108:109], v[108:109], v[88:89]
v_permlane16_swap_b32 v104, v106
v_exp_f32 v90, v90
v_exp_f32 v91, v91
v_permlane32_swap_b32 v100, v101
v_pk_add_f32 v[108:109], v[108:109], v[90:91]
v_add_f32 v103, v108, v109
v_add_f32 v100, v100, v101
v_mov_b32 v105, v104
v_permlane32_swap_b32 v102, v103
v_mov_b32 v107, v106
v_add_f32 v102, v102, v103
v_permlane32_swap_b32 v104, v105
v_permlane32_swap_b32 v106, v107
v_permlane16_swap_b32 v100, v102
v_pk_mul_f32 v[222:223], v[222:223], v[104:105] op_sel:[0,0] op_sel_hi:[1,0]
v_pk_mul_f32 v[226:227], v[226:227], v[104:105] op_sel:[0,0] op_sel_hi:[1,0]
v_pk_mul_f32 v[234:235], v[234:235], v[104:105] op_sel:[0,1] op_sel_hi:[1,1]
v_pk_mul_f32 v[232:233], v[232:233], v[104:105] op_sel:[0,1] op_sel_hi:[1,1]
v_pk_mul_f32 v[230:231], v[230:231], v[104:105] op_sel:[0,1] op_sel_hi:[1,1]
v_add_f32 v100, v100, v102
v_pk_mul_f32 v[228:229], v[228:229], v[104:105] op_sel:[0,1] op_sel_hi:[1,1]
v_cvt_pk_bf16_f32 v228, v228, v229
v_cvt_pk_bf16_f32 v229, v230, v231
v_cvt_pk_bf16_f32 v231, v234, v235
v_cvt_pk_bf16_f32 v230, v232, v233
v_pk_mul_f32 v[220:221], v[220:221], v[104:105] op_sel:[0,0] op_sel_hi:[1,0]
v_cvt_pk_bf16_f32 v220, v220, v221
v_pk_mul_f32 v[224:225], v[224:225], v[104:105] op_sel:[0,0] op_sel_hi:[1,0]
v_pk_mul_f32 v[236:237], v[236:237], v[106:107] op_sel:[0,0] op_sel_hi:[1,0]
v_pk_mul_f32 v[238:239], v[238:239], v[106:107] op_sel:[0,0] op_sel_hi:[1,0]
v_pk_mul_f32 v[240:241], v[240:241], v[106:107] op_sel:[0,0] op_sel_hi:[1,0]
v_pk_mul_f32 v[242:243], v[242:243], v[106:107] op_sel:[0,0] op_sel_hi:[1,0]
v_pk_mul_f32 v[248:249], v[248:249], v[106:107] op_sel:[0,1] op_sel_hi:[1,1]
v_rcp_f32 v100, v100
v_pk_mul_f32 v[244:245], v[244:245], v[106:107] op_sel:[0,1] op_sel_hi:[1,1]
v_mov_b32 v102, v100
v_pk_mul_f32 v[250:251], v[250:251], v[106:107] op_sel:[0,1] op_sel_hi:[1,1]
v_cvt_pk_bf16_f32 v221, v222, v223
v_pk_mul_f32 v[246:247], v[246:247], v[106:107] op_sel:[0,1] op_sel_hi:[1,1]
v_cvt_pk_bf16_f32 v222, v224, v225
v_mfma_f32_16x16x32_bf16 v[200:203], v[228:231], v[36:39], 0
v_cvt_pk_bf16_f32 v223, v226, v227
v_permlane16_swap_b32 v100, v102
v_mfma_f32_16x16x32_bf16 v[196:199], v[228:231], v[38:41], 0
v_mov_b32 v101, v100
v_cvt_pk_bf16_f32 v244, v244, v245
v_mfma_f32_16x16x32_bf16 v[212:215], v[220:223], v[38:41], 0
v_cvt_pk_bf16_f32 v245, v246, v247
v_cvt_pk_bf16_f32 v247, v250, v251
v_mfma_f32_16x16x32_bf16 v[216:219], v[220:223], v[36:39], 0
v_cvt_pk_bf16_f32 v234, v200, v201
v_cvt_pk_bf16_f32 v246, v248, v249
v_cvt_pk_bf16_f32 v226, v196, v197
v_cvt_pk_bf16_f32 v227, v198, v199
v_mfma_f32_16x16x32_bf16 v[196:199], v[244:247], v[38:41], 0
v_cvt_pk_bf16_f32 v225, v214, v215
v_cvt_pk_bf16_f32 v236, v236, v237
v_cvt_pk_bf16_f32 v237, v238, v239
v_cvt_pk_bf16_f32 v232, v216, v217
v_cvt_pk_bf16_f32 v233, v218, v219
v_cvt_pk_bf16_f32 v239, v242, v243
v_cvt_pk_bf16_f32 v238, v240, v241
v_cvt_pk_bf16_f32 v224, v212, v213
v_permlane32_swap_b32 v100, v101
v_mfma_f32_16x16x32_bf16 v[216:219], v[236:239], v[36:39], 0
v_mov_b32 v103, v102
v_cvt_pk_bf16_f32 v235, v202, v203
v_mfma_f32_16x16x32_bf16 v[212:215], v[236:239], v[38:41], 0
v_cvt_pk_bf16_f32 v243, v198, v199
v_permlane32_swap_b32 v102, v103
v_mfma_f32_16x16x32_bf16 v[200:203], v[244:247], v[36:39], 0
v_cvt_pk_bf16_f32 v242, v196, v197
v_mov_b32 v5, s61
v_mfma_f32_16x16x32_bf16 v[220:223], v[232:235], v[120:123], 0
v_cvt_pk_bf16_f32 v249, v218, v219
v_cvt_pk_bf16_f32 v248, v216, v217
v_cvt_pk_bf16_f32 v241, v214, v215
v_cvt_pk_bf16_f32 v240, v212, v213
v_cmp_eq_u32 s[50:51], s41, v2
v_pk_mul_f32 v[64:65], v[64:65], v[100:101] op_sel:[0,0] op_sel_hi:[1,0]
v_pk_mul_f32 v[74:75], v[74:75], v[100:101] op_sel:[0,1] op_sel_hi:[1,1]
v_pk_mul_f32 v[68:69], v[68:69], v[100:101] op_sel:[0,1] op_sel_hi:[1,1]
v_pk_mul_f32 v[72:73], v[72:73], v[100:101] op_sel:[0,1] op_sel_hi:[1,1]
v_pk_mul_f32 v[60:61], v[60:61], v[100:101] op_sel:[0,0] op_sel_hi:[1,0]
v_pk_mul_f32 v[62:63], v[62:63], v[100:101] op_sel:[0,0] op_sel_hi:[1,0]
v_pk_mul_f32 v[66:67], v[66:67], v[100:101] op_sel:[0,0] op_sel_hi:[1,0]
v_pk_mul_f32 v[76:77], v[76:77], v[102:103] op_sel:[0,0] op_sel_hi:[1,0]
v_pk_mul_f32 v[70:71], v[70:71], v[100:101] op_sel:[0,1] op_sel_hi:[1,1]
v_cvt_pk_bf16_f32 v60, v60, v61
v_pk_mul_f32 v[80:81], v[80:81], v[102:103] op_sel:[0,0] op_sel_hi:[1,0]
v_pk_mul_f32 v[78:79], v[78:79], v[102:103] op_sel:[0,0] op_sel_hi:[1,0]
v_pk_mul_f32 v[82:83], v[82:83], v[102:103] op_sel:[0,0] op_sel_hi:[1,0]
v_pk_mul_f32 v[86:87], v[86:87], v[102:103] op_sel:[0,1] op_sel_hi:[1,1]
v_cvt_pk_bf16_f32 v61, v62, v63
v_pk_mul_f32 v[84:85], v[84:85], v[102:103] op_sel:[0,1] op_sel_hi:[1,1]
v_cvt_pk_bf16_f32 v62, v64, v65
v_pk_mul_f32 v[88:89], v[88:89], v[102:103] op_sel:[0,1] op_sel_hi:[1,1]
v_cvt_pk_bf16_f32 v63, v66, v67
v_pk_mul_f32 v[90:91], v[90:91], v[102:103] op_sel:[0,1] op_sel_hi:[1,1]
v_cvt_pk_bf16_f32 v68, v68, v69
v_mfma_f32_16x16x32_bf16 v[208:211], v[60:63], v[36:39], 0
v_cvt_pk_bf16_f32 v69, v70, v71
v_cvt_pk_bf16_f32 v70, v72, v73
v_mfma_f32_16x16x32_bf16 v[204:207], v[60:63], v[38:41], 0
v_cvt_pk_bf16_f32 v71, v74, v75
v_cvt_pk_bf16_f32 v76, v76, v77
v_mfma_f32_16x16x32_bf16 v[60:63], v[232:235], v[112:115], 0
v_cvt_pk_bf16_f32 v250, v200, v201
v_cvt_pk_bf16_f32 v77, v78, v79
v_mfma_f32_16x16x32_bf16 v[192:195], v[68:71], v[36:39], 0
v_cvt_pk_bf16_f32 v78, v80, v81
v_cvt_pk_bf16_f32 v79, v82, v83
v_mfma_f32_16x16x32_bf16 v[188:191], v[68:71], v[38:41], 0
v_cvt_pk_bf16_f32 v65, v206, v207
v_cvt_pk_bf16_f32 v64, v204, v205
v_mfma_f32_16x16x32_bf16 v[68:71], v[224:227], v[120:123], 0
v_cvt_pk_bf16_f32 v251, v202, v203
v_cvt_pk_bf16_f32 v72, v208, v209
v_mfma_f32_16x16x32_bf16 v[152:155], v[224:227], v[112:115], 0
v_cvt_pk_bf16_f32 v73, v210, v211
v_cvt_pk_bf16_f32 v84, v84, v85
v_mfma_f32_16x16x32_bf16 v[60:63], v[248:251], v[116:119], v[60:63]
v_cvt_pk_bf16_f32 v85, v86, v87
v_cvt_pk_bf16_f32 v86, v88, v89
v_mfma_f32_16x16x32_bf16 v[228:231], v[224:227], v[48:51], 0
v_cvt_pk_bf16_f32 v67, v190, v191
v_cvt_pk_bf16_f32 v87, v90, v91
v_mfma_f32_16x16x32_bf16 v[220:223], v[248:251], v[124:127], v[220:223]
v_cvt_pk_bf16_f32 v66, v188, v189
v_cvt_pk_bf16_f32 v74, v192, v193
v_mfma_f32_16x16x32_bf16 v[152:155], v[240:243], v[116:119], v[152:155]
v_cvt_pk_bf16_f32 v75, v194, v195
v_mfma_f32_16x16x32_bf16 v[204:207], v[76:79], v[38:41], 0
v_mfma_f32_16x16x32_bf16 v[208:211], v[76:79], v[36:39], 0
v_mfma_f32_16x16x32_bf16 v[228:231], v[240:243], v[48:51], v[228:231]
v_mfma_f32_16x16x32_bf16 v[68:71], v[240:243], v[124:127], v[68:71]
v_mfma_f32_16x16x32_bf16 v[76:79], v[232:235], v[48:51], 0
s_nop 1
v_cvt_pk_bf16_f32 v152, v152, v153
v_mfma_f32_16x16x32_bf16 v[76:79], v[248:251], v[48:51], v[76:79]
v_cvt_pk_bf16_f32 v153, v154, v155
v_cvt_pk_bf16_f32 v154, v60, v61
v_mfma_f32_16x16x32_bf16 v[192:195], v[84:87], v[36:39], 0
v_cvt_pk_bf16_f32 v68, v68, v69
v_cvt_pk_bf16_f32 v155, v62, v63
v_mfma_f32_16x16x32_bf16 v[188:191], v[84:87], v[38:41], 0
ds_write_b128 v42, v[152:155] offset:0
v_mfma_f32_16x16x32_bf16 v[136:139], v[64:67], v[48:51], 0
v_cvt_pk_bf16_f32 v69, v70, v71
v_cvt_pk_bf16_f32 v228, v228, v229
v_mfma_f32_16x16x32_bf16 v[104:107], v[72:75], v[112:115], 0
v_cvt_pk_bf16_f32 v71, v222, v223
v_cvt_pk_bf16_f32 v229, v230, v231
v_mfma_f32_16x16x32_bf16 v[148:151], v[72:75], v[48:51], 0
v_cvt_pk_bf16_f32 v230, v76, v77
v_cvt_pk_bf16_f32 v70, v220, v221
v_mfma_f32_16x16x32_bf16 v[132:135], v[72:75], v[120:123], 0
ds_write_b128 v42, v[68:71] offset:1024
v_mfma_f32_16x16x32_bf16 v[108:111], v[64:67], v[120:123], 0
v_cvt_pk_bf16_f32 v231, v78, v79
ds_write_b128 v42, v[228:231] offset:2048
v_mfma_f32_16x16x32_bf16 v[100:103], v[64:67], v[112:115], 0
ds_write_b32 v52, v5
v_cvt_pk_bf16_f32 v88, v208, v209
v_cvt_pk_bf16_f32 v83, v190, v191
v_cvt_pk_bf16_f32 v91, v194, v195
v_cvt_pk_bf16_f32 v82, v188, v189
v_cvt_pk_bf16_f32 v80, v204, v205
v_cvt_pk_bf16_f32 v89, v210, v211
v_cvt_pk_bf16_f32 v81, v206, v207
v_cvt_pk_bf16_f32 v90, v192, v193
s_nop 0
v_mfma_f32_16x16x32_bf16 v[100:103], v[80:83], v[116:119], v[100:103]
v_mfma_f32_16x16x32_bf16 v[108:111], v[80:83], v[124:127], v[108:111]
v_mfma_f32_16x16x32_bf16 v[132:135], v[88:91], v[124:127], v[132:135]
v_mfma_f32_16x16x32_bf16 v[148:151], v[88:91], v[48:51], v[148:151]
v_mfma_f32_16x16x32_bf16 v[136:139], v[80:83], v[48:51], v[136:139]
v_mfma_f32_16x16x32_bf16 v[104:107], v[88:91], v[116:119], v[104:107]
s_mov_b32 s63, 0
px_82:
ds_read_b32 v4, v19
ds_read_b128 v[188:191], v43 offset:0
ds_read_b128 v[192:195], v43 offset:1024
ds_read_b128 v[196:199], v43 offset:2048
s_add_u32 s63, s63, 1
s_cmp_lt_u32 s63, 0x400000
s_waitcnt lgkmcnt(0)
v_cmp_ne_u32 vcc, s61, v4
s_cbranch_vccz pxd_83
s_cbranch_scc1 px_82
pxd_83:
v_mfma_f32_16x16x32_bf16 v[100:103], v[38:41], v[188:191], v[100:103]
v_mfma_f32_16x16x32_bf16 v[104:107], v[36:39], v[188:191], v[104:107]
v_mfma_f32_16x16x32_bf16 v[108:111], v[38:41], v[192:195], v[108:111]
v_mfma_f32_16x16x32_bf16 v[132:135], v[36:39], v[192:195], v[132:135]
v_mfma_f32_16x16x32_bf16 v[136:139], v[38:41], v[196:199], v[136:139]
v_mfma_f32_16x16x32_bf16 v[148:151], v[36:39], v[196:199], v[148:151]
s_nop 2
v_cvt_pk_bf16_f32 v100, v100, v101
v_cvt_pk_bf16_f32 v101, v102, v103
v_cvt_pk_bf16_f32 v102, v104, v105
v_cvt_pk_bf16_f32 v103, v106, v107
buffer_store_dwordx4 v[100:103], v55, s[32:35], s53 offen sc1
v_cvt_pk_bf16_f32 v108, v108, v109
v_cvt_pk_bf16_f32 v109, v110, v111
v_cvt_pk_bf16_f32 v110, v132, v133
v_cvt_pk_bf16_f32 v111, v134, v135
buffer_store_dwordx4 v[108:111], v55, s[32:35], s54 offen sc1
v_cvt_pk_bf16_f32 v136, v136, v137
v_cvt_pk_bf16_f32 v137, v138, v139
v_cvt_pk_bf16_f32 v138, v148, v149
v_cvt_pk_bf16_f32 v139, v150, v151
s_mov_b64 exec, s[50:51]
buffer_store_dwordx4 v[136:139], v58, s[32:35], s56 offen sc1
s_mov_b64 exec, -1
s_mov_b32 s51, 0
.p2align 3
v_pk_fma_f32 v[156:157], v[140:141], v[92:93], v[156:157] op_sel:[0,1,0] op_sel_hi:[1,1,1]
v_pk_fma_f32 v[164:165], v[140:141], v[94:95], v[164:165] op_sel:[0,1,0] op_sel_hi:[1,1,1]
v_pk_fma_f32 v[172:173], v[140:141], v[96:97], v[172:173] op_sel:[0,1,0] op_sel_hi:[1,1,1]
v_pk_fma_f32 v[180:181], v[140:141], v[98:99], v[180:181] op_sel:[0,1,0] op_sel_hi:[1,1,1]
v_pk_fma_f32 v[158:159], v[142:143], v[92:93], v[158:159] op_sel:[0,1,0] op_sel_hi:[1,1,1]
v_cvt_pk_bf16_f32 v156, v156, v157
v_pk_fma_f32 v[166:167], v[142:143], v[94:95], v[166:167] op_sel:[0,1,0] op_sel_hi:[1,1,1]
v_cvt_pk_bf16_f32 v164, v164, v165
v_pk_fma_f32 v[174:175], v[142:143], v[96:97], v[174:175] op_sel:[0,1,0] op_sel_hi:[1,1,1]
v_cvt_pk_bf16_f32 v172, v172, v173
v_pk_fma_f32 v[182:183], v[142:143], v[98:99], v[182:183] op_sel:[0,1,0] op_sel_hi:[1,1,1]
v_cvt_pk_bf16_f32 v180, v180, v181
v_pk_fma_f32 v[160:161], v[144:145], v[92:93], v[160:161] op_sel:[0,1,0] op_sel_hi:[1,1,1]
v_pk_fma_f32 v[162:163], v[146:147], v[92:93], v[162:163] op_sel:[0,1,0] op_sel_hi:[1,1,1]
v_cvt_pk_bf16_f32 v157, v158, v159
v_pk_fma_f32 v[168:169], v[144:145], v[94:95], v[168:169] op_sel:[0,1,0] op_sel_hi:[1,1,1]
v_pk_fma_f32 v[170:171], v[146:147], v[94:95], v[170:171] op_sel:[0,1,0] op_sel_hi:[1,1,1]
v_cvt_pk_bf16_f32 v165, v166, v167
v_pk_fma_f32 v[176:177], v[144:145], v[96:97], v[176:177] op_sel:[0,1,0] op_sel_hi:[1,1,1]
v_pk_fma_f32 v[178:179], v[146:147], v[96:97], v[178:179] op_sel:[0,1,0] op_sel_hi:[1,1,1]
v_cvt_pk_bf16_f32 v173, v174, v175
v_pk_fma_f32 v[184:185], v[144:145], v[98:99], v[184:185] op_sel:[0,1,0] op_sel_hi:[1,1,1]
v_pk_fma_f32 v[186:187], v[146:147], v[98:99], v[186:187] op_sel:[0,1,0] op_sel_hi:[1,1,1]
v_cvt_pk_bf16_f32 v181, v182, v183
v_cvt_pk_bf16_f32 v158, v160, v161
v_cvt_pk_bf16_f32 v159, v162, v163
v_cvt_pk_bf16_f32 v166, v168, v169
v_cvt_pk_bf16_f32 v167, v170, v171
v_mfma_f32_16x16x32_bf16 v[60:63], v[10:13], v[156:159], 0
v_cvt_pk_bf16_f32 v174, v176, v177
v_cvt_pk_bf16_f32 v175, v178, v179
v_mfma_f32_16x16x32_bf16 v[68:71], v[10:13], v[164:167], 0
v_cvt_pk_bf16_f32 v182, v184, v185
v_cvt_pk_bf16_f32 v183, v186, v187
v_mfma_f32_16x16x32_bf16 v[76:79], v[10:13], v[172:175], 0
s_nop 0
v_mfma_f32_16x16x32_bf16 v[84:87], v[10:13], v[180:183], 0
v_min3_f32 v104, v60, v61, v62
v_max3_f32 v100, v60, v61, v62
v_mfma_f32_16x16x32_bf16 v[64:67], v[14:17], v[156:159], 0
v_min3_f32 v105, v68, v69, v70
v_max3_f32 v101, v68, v69, v70
v_mfma_f32_16x16x32_bf16 v[72:75], v[14:17], v[164:167], 0
v_min3_f32 v106, v76, v77, v78
v_max3_f32 v102, v76, v77, v78
v_mfma_f32_16x16x32_bf16 v[80:83], v[14:17], v[172:175], 0
v_min3_f32 v107, v84, v85, v86
v_max3_f32 v103, v84, v85, v86
v_mfma_f32_16x16x32_bf16 v[88:91], v[14:17], v[180:183], 0
v_min3_f32 v104, v104, v63, v64
v_max3_f32 v100, v100, v63, v64
v_min3_f32 v105, v105, v71, v72
v_min3_f32 v104, v104, v65, v66
v_max3_f32 v101, v101, v71, v72
v_min3_f32 v106, v106, v79, v80
v_min3_f32 v105, v105, v73, v74
v_max3_f32 v102, v102, v79, v80
v_min3_f32 v107, v107, v87, v88
v_min3_f32 v106, v106, v81, v82
v_max3_f32 v103, v103, v87, v88
v_min3_f32 v107, v107, v89, v90
v_max3_f32 v100, v100, v65, v66
v_min_f32 v104, v104, v67
v_max3_f32 v101, v101, v73, v74
v_min_f32 v105, v105, v75
v_max3_f32 v102, v102, v81, v82
v_min_f32 v106, v106, v83
v_max3_f32 v103, v103, v89, v90
v_min_f32 v107, v107, v91
v_max_f32 v100, v100, v67
v_max_f32 v101, v101, v75
v_max_f32 v102, v102, v83
v_max_f32 v103, v103, v91
v_permlane32_swap_b32 v104, v105
v_permlane32_swap_b32 v106, v107
v_permlane32_swap_b32 v100, v101
v_permlane32_swap_b32 v102, v103
v_min_f32 v104, v104, v105
v_min_f32 v106, v106, v107
v_max_f32 v100, v100, v101
v_max_f32 v102, v102, v103
v_permlane16_swap_b32 v104, v106
s_nop 0
v_permlane16_swap_b32 v100, v102
v_min_f32 v104, v104, v106
v_max_f32 v100, v100, v102
v_mov_b32 v106, v104
v_mov_b32 v102, v100
s_nop 0
v_permlane16_swap_b32 v104, v106
v_permlane16_swap_b32 v100, v102
v_mov_b32 v105, v104
v_mov_b32 v101, v100
v_mov_b32 v103, v102
v_permlane32_swap_b32 v104, v105
v_mov_b32 v107, v106
v_permlane32_swap_b32_e64 v100, v101
v_pk_mul_f32 v[104:105], v[104:105], v[128:129]
v_pk_mul_f32 v[100:101], v[100:101], v[128:129]
v_pk_fma_f32 v[220:221], v[60:61], v[128:129], v[104:105] op_sel:[0,0,0] op_sel_hi:[1,0,0] neg_lo:[1,0,0] neg_hi:[1,0,0]
v_pk_fma_f32 v[222:223], v[62:63], v[128:129], v[104:105] op_sel:[0,0,0] op_sel_hi:[1,0,0] neg_lo:[1,0,0] neg_hi:[1,0,0]
v_pk_fma_f32 v[224:225], v[64:65], v[128:129], v[104:105] op_sel:[0,0,0] op_sel_hi:[1,0,0] neg_lo:[1,0,0] neg_hi:[1,0,0]
v_pk_fma_f32 v[226:227], v[66:67], v[128:129], v[104:105] op_sel:[0,0,0] op_sel_hi:[1,0,0] neg_lo:[1,0,0] neg_hi:[1,0,0]
v_pk_fma_f32 v[228:229], v[68:69], v[128:129], v[104:105] op_sel:[0,1,1] op_sel_hi:[1,1,1] neg_lo:[1,0,0] neg_hi:[1,0,0]
v_pk_fma_f32 v[230:231], v[70:71], v[128:129], v[104:105] op_sel:[0,1,1] op_sel_hi:[1,1,1] neg_lo:[1,0,0] neg_hi:[1,0,0]
v_pk_fma_f32 v[232:233], v[72:73], v[128:129], v[104:105] op_sel:[0,1,1] op_sel_hi:[1,1,1] neg_lo:[1,0,0] neg_hi:[1,0,0]
v_pk_fma_f32 v[234:235], v[74:75], v[128:129], v[104:105] op_sel:[0,1,1] op_sel_hi:[1,1,1] neg_lo:[1,0,0] neg_hi:[1,0,0]
v_permlane32_swap_b32 v102, v103
v_permlane32_swap_b32 v106, v107
v_pk_fma_f32 v[60:61], v[60:61], v[128:129], v[100:101] op_sel:[0,0,0] op_sel_hi:[1,0,0] neg_lo:[0,0,1] neg_hi:[0,0,1]
v_pk_fma_f32 v[62:63], v[62:63], v[128:129], v[100:101] op_sel:[0,0,0] op_sel_hi:[1,0,0] neg_lo:[0,0,1] neg_hi:[0,0,1]
v_pk_fma_f32 v[64:65], v[64:65], v[128:129], v[100:101] op_sel:[0,0,0] op_sel_hi:[1,0,0] neg_lo:[0,0,1] neg_hi:[0,0,1]
v_pk_fma_f32 v[66:67], v[66:67], v[128:129], v[100:101] op_sel:[0,0,0] op_sel_hi:[1,0,0] neg_lo:[0,0,1] neg_hi:[0,0,1]
v_pk_fma_f32 v[68:69], v[68:69], v[128:129], v[100:101] op_sel:[0,1,1] op_sel_hi:[1,1,1] neg_lo:[0,0,1] neg_hi:[0,0,1]
v_pk_fma_f32 v[70:71], v[70:71], v[128:129], v[100:101] op_sel:[0,1,1] op_sel_hi:[1,1,1] neg_lo:[0,0,1] neg_hi:[0,0,1]
v_pk_fma_f32 v[72:73], v[72:73], v[128:129], v[100:101] op_sel:[0,1,1] op_sel_hi:[1,1,1] neg_lo:[0,0,1] neg_hi:[0,0,1]
v_pk_fma_f32 v[74:75], v[74:75], v[128:129], v[100:101] op_sel:[0,1,1] op_sel_hi:[1,1,1] neg_lo:[0,0,1] neg_hi:[0,0,1]
v_exp_f32 v220, v220
v_exp_f32 v60, v60
v_exp_f32 v221, v221
v_exp_f32 v61, v61
v_exp_f32 v222, v222
v_exp_f32 v62, v62
v_exp_f32 v223, v223
v_exp_f32 v63, v63
v_exp_f32 v224, v224
v_exp_f32 v64, v64
v_exp_f32 v225, v225
v_exp_f32 v65, v65
v_exp_f32 v226, v226
v_exp_f32 v66, v66
v_exp_f32 v227, v227
v_exp_f32 v67, v67
v_exp_f32 v228, v228
v_exp_f32 v68, v68
v_exp_f32 v229, v229
v_exp_f32 v69, v69
v_exp_f32 v230, v230
v_exp_f32 v70, v70
v_exp_f32 v231, v231
v_exp_f32 v71, v71
v_exp_f32 v232, v232
v_exp_f32 v72, v72
v_exp_f32 v233, v233
v_exp_f32 v73, v73
v_exp_f32 v234, v234
v_exp_f32 v74, v74
v_exp_f32 v235, v235
v_exp_f32 v75, v75
v_pk_mul_f32 v[102:103], v[102:103], v[130:131]
v_pk_mul_f32 v[106:107], v[106:107], v[130:131]
buffer_load_dwordx4 v[212:215], v18, s[32:35], s55 offen offset:0 sc1
buffer_load_dwordx4 v[216:219], v18, s[32:35], s55 offen offset:1024 sc1
.p2align 3
v_pk_add_f32 v[108:109], v[60:61], v[62:63]
v_pk_add_f32 v[110:111], v[220:221], v[222:223]
v_pk_add_f32 v[108:109], v[108:109], v[64:65]
v_pk_add_f32 v[110:111], v[110:111], v[224:225]
v_pk_add_f32 v[108:109], v[108:109], v[66:67]
v_pk_add_f32 v[110:111], v[110:111], v[226:227]
v_add_f32 v100, v108, v109
v_add_f32 v104, v110, v111
v_pk_fma_f32 v[236:237], v[76:77], v[130:131], v[106:107] op_sel:[0,0,0] op_sel_hi:[1,0,0] neg_lo:[1,0,0] neg_hi:[1,0,0]
v_pk_fma_f32 v[238:239], v[78:79], v[130:131], v[106:107] op_sel:[0,0,0] op_sel_hi:[1,0,0] neg_lo:[1,0,0] neg_hi:[1,0,0]
v_pk_add_f32 v[108:109], v[68:69], v[70:71]
v_pk_add_f32 v[110:111], v[228:229], v[230:231]
v_pk_fma_f32 v[76:77], v[76:77], v[130:131], v[102:103] op_sel:[0,0,0] op_sel_hi:[1,0,0] neg_lo:[0,0,1] neg_hi:[0,0,1]
v_pk_fma_f32 v[78:79], v[78:79], v[130:131], v[102:103] op_sel:[0,0,0] op_sel_hi:[1,0,0] neg_lo:[0,0,1] neg_hi:[0,0,1]
v_pk_fma_f32 v[240:241], v[80:81], v[130:131], v[106:107] op_sel:[0,0,0] op_sel_hi:[1,0,0] neg_lo:[1,0,0] neg_hi:[1,0,0]
v_pk_add_f32 v[108:109], v[108:109], v[72:73]
v_pk_add_f32 v[110:111], v[110:111], v[232:233]
v_exp_f32 v236, v236
v_exp_f32 v76, v76
v_exp_f32 v237, v237
v_exp_f32 v77, v77
v_exp_f32 v238, v238
v_exp_f32 v78, v78
v_exp_f32 v239, v239
v_exp_f32 v79, v79
v_pk_fma_f32 v[80:81], v[80:81], v[130:131], v[102:103] op_sel:[0,0,0] op_sel_hi:[1,0,0] neg_lo:[0,0,1] neg_hi:[0,0,1]
v_pk_fma_f32 v[242:243], v[82:83], v[130:131], v[106:107] op_sel:[0,0,0] op_sel_hi:[1,0,0] neg_lo:[1,0,0] neg_hi:[1,0,0]
v_pk_add_f32 v[108:109], v[108:109], v[74:75]
v_pk_add_f32 v[110:111], v[110:111], v[234:235]
v_exp_f32 v240, v240
v_exp_f32 v80, v80
v_exp_f32 v241, v241
v_exp_f32 v81, v81
v_pk_fma_f32 v[82:83], v[82:83], v[130:131], v[102:103] op_sel:[0,0,0] op_sel_hi:[1,0,0] neg_lo:[0,0,1] neg_hi:[0,0,1]
v_add_f32 v101, v108, v109
v_add_f32 v105, v110, v111
v_exp_f32 v242, v242
v_exp_f32 v82, v82
v_exp_f32 v243, v243
v_exp_f32 v83, v83
v_pk_fma_f32 v[244:245], v[84:85], v[130:131], v[106:107] op_sel:[0,1,1] op_sel_hi:[1,1,1] neg_lo:[1,0,0] neg_hi:[1,0,0]
v_pk_fma_f32 v[246:247], v[86:87], v[130:131], v[106:107] op_sel:[0,1,1] op_sel_hi:[1,1,1] neg_lo:[1,0,0] neg_hi:[1,0,0]
v_pk_add_f32 v[108:109], v[76:77], v[78:79]
v_pk_add_f32 v[110:111], v[236:237], v[238:239]
v_pk_fma_f32 v[84:85], v[84:85], v[130:131], v[102:103] op_sel:[0,1,1] op_sel_hi:[1,1,1] neg_lo:[0,0,1] neg_hi:[0,0,1]
v_pk_fma_f32 v[86:87], v[86:87], v[130:131], v[102:103] op_sel:[0,1,1] op_sel_hi:[1,1,1] neg_lo:[0,0,1] neg_hi:[0,0,1]
v_pk_fma_f32 v[248:249], v[88:89], v[130:131], v[106:107] op_sel:[0,1,1] op_sel_hi:[1,1,1] neg_lo:[1,0,0] neg_hi:[1,0,0]
v_pk_fma_f32 v[250:251], v[90:91], v[130:131], v[106:107] op_sel:[0,1,1] op_sel_hi:[1,1,1] neg_lo:[1,0,0] neg_hi:[1,0,0]
v_pk_add_f32 v[108:109], v[108:109], v[80:81]
v_pk_add_f32 v[110:111], v[110:111], v[240:241]
v_exp_f32 v244, v244
v_exp_f32 v84, v84
v_exp_f32 v245, v245
v_exp_f32 v85, v85
v_exp_f32 v246, v246
v_exp_f32 v86, v86
v_exp_f32 v247, v247
v_exp_f32 v87, v87
v_pk_fma_f32 v[88:89], v[88:89], v[130:131], v[102:103] op_sel:[0,1,1] op_sel_hi:[1,1,1] neg_lo:[0,0,1] neg_hi:[0,0,1]
v_pk_fma_f32 v[90:91], v[90:91], v[130:131], v[102:103] op_sel:[0,1,1] op_sel_hi:[1,1,1] neg_lo:[0,0,1] neg_hi:[0,0,1]
v_pk_add_f32 v[108:109], v[108:109], v[82:83]
v_pk_add_f32 v[110:111], v[110:111], v[242:243]
v_exp_f32 v248, v248
v_exp_f32 v88, v88
v_exp_f32 v249, v249
v_exp_f32 v89, v89
v_add_f32 v102, v108, v109
v_add_f32 v106, v110, v111
v_exp_f32 v250, v250
v_exp_f32 v90, v90
v_exp_f32 v251, v251
v_exp_f32 v91, v91
v_pk_add_f32 v[108:109], v[84:85], v[86:87]
v_pk_add_f32 v[110:111], v[244:245], v[246:247]
v_pk_add_f32 v[108:109], v[108:109], v[88:89]
v_pk_add_f32 v[110:111], v[110:111], v[248:249]
v_pk_add_f32 v[108:109], v[108:109], v[90:91]
v_pk_add_f32 v[110:111], v[110:111], v[250:251]
v_add_f32 v103, v108, v109
v_add_f32 v107, v110, v111
s_cmp_eq_u32 s51, 1
s_cbranch_scc1 chk_84
s_waitcnt vmcnt(0)
v_max_u32 v4, v212, v213
v_max3_u32 v4, v4, v214, v215
v_max3_u32 v4, v4, v216, v217
v_max3_u32 v4, v4, v218, v219
v_cmp_eq_u32 vcc, -1, v4
s_cbranch_vccz red_85
buffer_load_dwordx4 v[212:215], v18, s[32:35], s55 offen offset:0 sc1
buffer_load_dwordx4 v[216:219], v18, s[32:35], s55 offen offset:1024 sc1
s_branch chk_84
red_85:
v_mfma_f32_16x16x32_bf16 v[132:135], v[44:47], v[212:215], 0
v_mfma_f32_16x16x32_bf16 v[132:135], v[44:47], v[216:219], v[132:135]
s_mov_b32 s51, 1
s_nop 6
v_add_f32_dpp v132, v132, v132 row_ror:8 row_mask:0xf bank_mask:0xf
v_add_f32_dpp v133, v133, v133 row_ror:8 row_mask:0xf bank_mask:0xf
v_add_f32_dpp v134, v134, v134 row_ror:8 row_mask:0xf bank_mask:0xf
v_add_f32_dpp v135, v135, v135 row_ror:8 row_mask:0xf bank_mask:0xf
v_cvt_pk_bf16_f32 v132, v132, v133
v_cvt_pk_bf16_f32 v133, v134, v135
s_mov_b64 exec, 0x00ff00ff
buffer_store_dwordx2 v[132:133], v59, s[32:35], s79 offen sc1
s_mov_b64 exec, -1
buffer_load_dwordx4 v[204:207], v58, s[32:35], s56 offen sc1
buffer_load_dwordx4 v[208:211], v58, s[32:35], s57 offen sc1
chk_84:
.p2align 3
v_permlane32_swap_b32 v100, v101
v_permlane32_swap_b32 v102, v103
v_permlane32_swap_b32 v104, v105
v_permlane32_swap_b32 v106, v107
v_add_f32 v100, v100, v101
v_add_f32 v102, v102, v103
v_add_f32 v104, v104, v105
v_add_f32 v106, v106, v107
v_permlane16_swap_b32 v100, v102
s_nop 0
v_permlane16_swap_b32 v104, v106
v_add_f32 v100, v100, v102
v_add_f32 v104, v104, v106
v_rcp_f32 v100, v100
v_rcp_f32 v104, v104
v_mov_b32 v102, v100
v_mov_b32 v106, v104
s_nop 0
v_permlane16_swap_b32 v100, v102
v_permlane16_swap_b32 v104, v106
v_mov_b32 v101, v100
v_mov_b32 v103, v102
v_mov_b32 v105, v104
v_mov_b32 v107, v106
v_permlane32_swap_b32 v100, v101
v_permlane32_swap_b32 v102, v103
v_permlane32_swap_b32 v104, v105
v_permlane32_swap_b32 v106, v107
v_pk_mul_f32 v[60:61], v[60:61], v[100:101] op_sel:[0,0] op_sel_hi:[1,0]
v_pk_mul_f32 v[220:221], v[220:221], v[104:105] op_sel:[0,0] op_sel_hi:[1,0]
v_pk_mul_f32 v[68:69], v[68:69], v[100:101] op_sel:[0,1] op_sel_hi:[1,1]
v_pk_mul_f32 v[228:229], v[228:229], v[104:105] op_sel:[0,1] op_sel_hi:[1,1]
v_pk_mul_f32 v[76:77], v[76:77], v[102:103] op_sel:[0,0] op_sel_hi:[1,0]
v_pk_mul_f32 v[236:237], v[236:237], v[106:107] op_sel:[0,0] op_sel_hi:[1,0]
v_pk_mul_f32 v[84:85], v[84:85], v[102:103] op_sel:[0,1] op_sel_hi:[1,1]
v_pk_mul_f32 v[244:245], v[244:245], v[106:107] op_sel:[0,1] op_sel_hi:[1,1]
v_pk_mul_f32 v[62:63], v[62:63], v[100:101] op_sel:[0,0] op_sel_hi:[1,0]
v_pk_mul_f32 v[222:223], v[222:223], v[104:105] op_sel:[0,0] op_sel_hi:[1,0]
v_cvt_pk_bf16_f32 v60, v60, v61
v_cvt_pk_bf16_f32 v220, v220, v221
v_pk_mul_f32 v[70:71], v[70:71], v[100:101] op_sel:[0,1] op_sel_hi:[1,1]
v_pk_mul_f32 v[230:231], v[230:231], v[104:105] op_sel:[0,1] op_sel_hi:[1,1]
v_cvt_pk_bf16_f32 v68, v68, v69
v_cvt_pk_bf16_f32 v228, v228, v229
v_pk_mul_f32 v[78:79], v[78:79], v[102:103] op_sel:[0,0] op_sel_hi:[1,0]
v_pk_mul_f32 v[238:239], v[238:239], v[106:107] op_sel:[0,0] op_sel_hi:[1,0]
v_cvt_pk_bf16_f32 v76, v76, v77
v_cvt_pk_bf16_f32 v236, v236, v237
v_pk_mul_f32 v[86:87], v[86:87], v[102:103] op_sel:[0,1] op_sel_hi:[1,1]
v_pk_mul_f32 v[246:247], v[246:247], v[106:107] op_sel:[0,1] op_sel_hi:[1,1]
v_cvt_pk_bf16_f32 v84, v84, v85
v_cvt_pk_bf16_f32 v244, v244, v245
v_pk_mul_f32 v[64:65], v[64:65], v[100:101] op_sel:[0,0] op_sel_hi:[1,0]
v_pk_mul_f32 v[66:67], v[66:67], v[100:101] op_sel:[0,0] op_sel_hi:[1,0]
v_pk_mul_f32 v[224:225], v[224:225], v[104:105] op_sel:[0,0] op_sel_hi:[1,0]
v_pk_mul_f32 v[226:227], v[226:227], v[104:105] op_sel:[0,0] op_sel_hi:[1,0]
v_cvt_pk_bf16_f32 v61, v62, v63
v_cvt_pk_bf16_f32 v221, v222, v223
v_pk_mul_f32 v[72:73], v[72:73], v[100:101] op_sel:[0,1] op_sel_hi:[1,1]
v_pk_mul_f32 v[74:75], v[74:75], v[100:101] op_sel:[0,1] op_sel_hi:[1,1]
v_pk_mul_f32 v[232:233], v[232:233], v[104:105] op_sel:[0,1] op_sel_hi:[1,1]
v_pk_mul_f32 v[234:235], v[234:235], v[104:105] op_sel:[0,1] op_sel_hi:[1,1]
v_cvt_pk_bf16_f32 v69, v70, v71
v_cvt_pk_bf16_f32 v229, v230, v231
v_pk_mul_f32 v[80:81], v[80:81], v[102:103] op_sel:[0,0] op_sel_hi:[1,0]
v_pk_mul_f32 v[82:83], v[82:83], v[102:103] op_sel:[0,0] op_sel_hi:[1,0]
v_pk_mul_f32 v[240:241], v[240:241], v[106:107] op_sel:[0,0] op_sel_hi:[1,0]
v_pk_mul_f32 v[242:243], v[242:243], v[106:107] op_sel:[0,0] op_sel_hi:[1,0]
v_cvt_pk_bf16_f32 v77, v78, v79
v_cvt_pk_bf16_f32 v237, v238, v239
v_pk_mul_f32 v[88:89], v[88:89], v[102:103] op_sel:[0,1] op_sel_hi:[1,1]
v_pk_mul_f32 v[90:91], v[90:91], v[102:103] op_sel:[0,1] op_sel_hi:[1,1]
v_pk_mul_f32 v[248:249], v[248:249], v[106:107] op_sel:[0,1] op_sel_hi:[1,1]
v_pk_mul_f32 v[250:251], v[250:251], v[106:107] op_sel:[0,1] op_sel_hi:[1,1]
v_cvt_pk_bf16_f32 v85, v86, v87
v_cvt_pk_bf16_f32 v245, v246, v247
v_cvt_pk_bf16_f32 v62, v64, v65
v_cvt_pk_bf16_f32 v63, v66, v67
v_cvt_pk_bf16_f32 v222, v224, v225
v_cvt_pk_bf16_f32 v223, v226, v227
v_cvt_pk_bf16_f32 v70, v72, v73
v_cvt_pk_bf16_f32 v71, v74, v75
v_cvt_pk_bf16_f32 v230, v232, v233
v_cvt_pk_bf16_f32 v231, v234, v235
v_cvt_pk_bf16_f32 v78, v80, v81
v_cvt_pk_bf16_f32 v79, v82, v83
v_cvt_pk_bf16_f32 v238, v240, v241
v_cvt_pk_bf16_f32 v239, v242, v243
v_cvt_pk_bf16_f32 v86, v88, v89
v_cvt_pk_bf16_f32 v87, v90, v91
v_cvt_pk_bf16_f32 v246, v248, v249
v_cvt_pk_bf16_f32 v247, v250, v251
s_cmp_lg_u32 s51, 0
s_cbranch_scc1 else_86
s_mov_b32 s63, 0
sent_88:
s_waitcnt vmcnt(0)
v_max_u32 v4, v212, v213
v_max3_u32 v4, v4, v214, v215
v_max3_u32 v4, v4, v216, v217
v_max3_u32 v4, v4, v218, v219
v_cmp_eq_u32 vcc, -1, v4
s_cbranch_vccz sentd_89
buffer_load_dwordx4 v[212:215], v18, s[32:35], s55 offen offset:0 sc1
buffer_load_dwordx4 v[216:219], v18, s[32:35], s55 offen offset:1024 sc1
s_add_u32 s63, s63, 1
s_cmp_lt_u32 s63, 0x80000
s_cbranch_scc1 sent_88
s_waitcnt vmcnt(0)
sentd_89:
v_mfma_f32_16x16x32_bf16 v[132:135], v[44:47], v[212:215], 0
v_mfma_f32_16x16x32_bf16 v[132:135], v[44:47], v[216:219], v[132:135]
s_mov_b32 s51, 1
s_nop 6
v_add_f32_dpp v132, v132, v132 row_ror:8 row_mask:0xf bank_mask:0xf
v_add_f32_dpp v133, v133, v133 row_ror:8 row_mask:0xf bank_mask:0xf
v_add_f32_dpp v134, v134, v134 row_ror:8 row_mask:0xf bank_mask:0xf
v_add_f32_dpp v135, v135, v135 row_ror:8 row_mask:0xf bank_mask:0xf
v_cvt_pk_bf16_f32 v132, v132, v133
v_cvt_pk_bf16_f32 v133, v134, v135
s_mov_b64 exec, 0x00ff00ff
buffer_store_dwordx2 v[132:133], v59, s[32:35], s79 offen sc1
s_mov_b64 exec, -1
buffer_load_dwordx4 v[204:207], v58, s[32:35], s56 offen sc1
buffer_load_dwordx4 v[208:211], v58, s[32:35], s57 offen sc1
else_86:
s_mov_b32 s63, 0
sent_90:
s_waitcnt vmcnt(0)
v_max_u32 v4, v204, v205
v_max3_u32 v4, v4, v206, v207
v_max3_u32 v4, v4, v208, v209
v_max3_u32 v4, v4, v210, v211
v_cmp_eq_u32 vcc, -1, v4
s_cbranch_vccz sentd_91
buffer_load_dwordx4 v[204:207], v58, s[32:35], s56 offen sc1
buffer_load_dwordx4 v[208:211], v58, s[32:35], s57 offen sc1
s_add_u32 s63, s63, 1
s_cmp_lt_u32 s63, 0x80000
s_cbranch_scc1 sent_90
s_waitcnt vmcnt(0)
sentd_91:
v_mfma_f32_16x16x32_bf16 v[112:115], v[204:207], v[60:63], 0
v_mfma_f32_16x16x32_bf16 v[116:119], v[204:207], v[68:71], 0
v_mfma_f32_16x16x32_bf16 v[120:123], v[204:207], v[76:79], 0
v_mfma_f32_16x16x32_bf16 v[124:127], v[204:207], v[84:87], 0
v_mfma_f32_16x16x32_bf16 v[112:115], v[208:211], v[220:223], v[112:115]
v_mfma_f32_16x16x32_bf16 v[116:119], v[208:211], v[228:231], v[116:119]
v_mfma_f32_16x16x32_bf16 v[120:123], v[208:211], v[236:239], v[120:123]
v_mfma_f32_16x16x32_bf16 v[124:127], v[208:211], v[244:247], v[124:127]
s_nop 4
v_add_f32 v100, v112, v113
v_add_f32 v114, v114, v115
v_add_f32 v100, v100, v114
v_add_f32 v101, v116, v117
v_add_f32 v118, v118, v119
v_add_f32 v101, v101, v118
v_add_f32 v102, v120, v121
v_add_f32 v122, v122, v123
v_add_f32 v102, v102, v122
v_add_f32 v103, v124, v125
v_add_f32 v126, v126, v127
v_add_f32 v103, v103, v126
s_nop 1
v_permlane32_swap_b32 v100, v101
v_permlane32_swap_b32 v102, v103
v_add_f32 v100, v100, v101
v_add_f32 v102, v102, v103
s_nop 1
v_permlane16_swap_b32 v100, v102
s_nop 0
v_add_f32 v100, v100, v102
v_add_f32 v100, 0x358637bd, v100
v_rcp_f32 v100, v100
s_nop 0
v_mov_b32 v102, v100
s_nop 1
v_permlane16_swap_b32 v100, v102
s_nop 0
v_mov_b32 v101, v100
v_mov_b32 v103, v102
s_nop 0
v_permlane32_swap_b32 v100, v101
v_permlane32_swap_b32 v102, v103
buffer_load_dwordx4 v[188:191], v18, s[32:35], s58 offen offset:0 sc1
buffer_load_dwordx4 v[192:195], v18, s[32:35], s58 offen offset:1024 sc1
buffer_load_dwordx4 v[196:199], v18, s[32:35], s59 offen offset:0 sc1
buffer_load_dwordx4 v[200:203], v18, s[32:35], s59 offen offset:1024 sc1
s_mov_b32 s63, 0
sent_92:
s_waitcnt vmcnt(0)
v_max_u32 v4, v188, v189
v_max3_u32 v4, v4, v190, v191
v_max3_u32 v4, v4, v192, v193
v_max3_u32 v4, v4, v194, v195
v_max3_u32 v4, v4, v196, v197
v_max3_u32 v4, v4, v198, v199
v_max3_u32 v4, v4, v200, v201
v_max3_u32 v4, v4, v202, v203
v_cmp_eq_u32 vcc, -1, v4
s_cbranch_vccz sentd_93
buffer_load_dwordx4 v[188:191], v18, s[32:35], s58 offen offset:0 sc1
buffer_load_dwordx4 v[192:195], v18, s[32:35], s58 offen offset:1024 sc1
buffer_load_dwordx4 v[196:199], v18, s[32:35], s59 offen offset:0 sc1
buffer_load_dwordx4 v[200:203], v18, s[32:35], s59 offen offset:1024 sc1
s_add_u32 s63, s63, 1
s_cmp_lt_u32 s63, 0x80000
s_cbranch_scc1 sent_92
s_waitcnt vmcnt(0)
sentd_93:
s_cmp_eq_u32 s46, 0
s_cbranch_scc1 slow_94
.p2align 3
v_mfma_f32_16x16x32_bf16 v[156:159], v[188:191], v[60:63], 0
v_mfma_f32_16x16x32_bf16 v[164:167], v[188:191], v[68:71], 0
v_mfma_f32_16x16x32_bf16 v[160:163], v[192:195], v[60:63], 0
v_mfma_f32_16x16x32_bf16 v[172:175], v[188:191], v[76:79], 0
v_mfma_f32_16x16x32_bf16 v[168:171], v[192:195], v[68:71], 0
v_mfma_f32_16x16x32_bf16 v[180:183], v[188:191], v[84:87], 0
v_mfma_f32_16x16x32_bf16 v[156:159], v[196:199], v[220:223], v[156:159]
v_mfma_f32_16x16x32_bf16 v[176:179], v[192:195], v[76:79], 0
v_mfma_f32_16x16x32_bf16 v[164:167], v[196:199], v[228:231], v[164:167]
v_mfma_f32_16x16x32_bf16 v[184:187], v[192:195], v[84:87], 0
v_mfma_f32_16x16x32_bf16 v[160:163], v[200:203], v[220:223], v[160:163]
v_mfma_f32_16x16x32_bf16 v[172:175], v[196:199], v[236:239], v[172:175]
v_mfma_f32_16x16x32_bf16 v[168:171], v[200:203], v[228:231], v[168:171]
v_mfma_f32_16x16x32_bf16 v[180:183], v[196:199], v[244:247], v[180:183]
v_mfma_f32_16x16x32_bf16 v[176:179], v[200:203], v[236:239], v[176:179]
v_mfma_f32_16x16x32_bf16 v[184:187], v[200:203], v[244:247], v[184:187]
v_pk_mul_f32 v[156:157], v[156:157], v[100:101] op_sel:[0,0] op_sel_hi:[1,0]
v_pk_mul_f32 v[158:159], v[158:159], v[100:101] op_sel:[0,0] op_sel_hi:[1,0]
v_cvt_pk_bf16_f32 v156, v156, v157
v_pk_mul_f32 v[164:165], v[164:165], v[100:101] op_sel:[0,1] op_sel_hi:[1,1]
v_pk_mul_f32 v[160:161], v[160:161], v[100:101] op_sel:[0,0] op_sel_hi:[1,0]
v_pk_mul_f32 v[162:163], v[162:163], v[100:101] op_sel:[0,0] op_sel_hi:[1,0]
v_cvt_pk_bf16_f32 v157, v158, v159
v_pk_mul_f32 v[166:167], v[166:167], v[100:101] op_sel:[0,1] op_sel_hi:[1,1]
v_cvt_pk_bf16_f32 v164, v164, v165
v_pk_mul_f32 v[172:173], v[172:173], v[102:103] op_sel:[0,0] op_sel_hi:[1,0]
v_cvt_pk_bf16_f32 v158, v160, v161
v_cvt_pk_bf16_f32 v159, v162, v163
v_pk_mul_f32 v[168:169], v[168:169], v[100:101] op_sel:[0,1] op_sel_hi:[1,1]
v_pk_mul_f32 v[170:171], v[170:171], v[100:101] op_sel:[0,1] op_sel_hi:[1,1]
v_cvt_pk_bf16_f32 v165, v166, v167
v_pk_mul_f32 v[174:175], v[174:175], v[102:103] op_sel:[0,0] op_sel_hi:[1,0]
v_cvt_pk_bf16_f32 v172, v172, v173
v_pk_mul_f32 v[180:181], v[180:181], v[102:103] op_sel:[0,1] op_sel_hi:[1,1]
buffer_store_dwordx4 v[156:159], v18, s[32:35], s80 offen
v_cvt_pk_bf16_f32 v166, v168, v169
v_cvt_pk_bf16_f32 v167, v170, v171
v_pk_mul_f32 v[176:177], v[176:177], v[102:103] op_sel:[0,0] op_sel_hi:[1,0]
v_pk_mul_f32 v[178:179], v[178:179], v[102:103] op_sel:[0,0] op_sel_hi:[1,0]
v_cvt_pk_bf16_f32 v173, v174, v175
v_pk_mul_f32 v[182:183], v[182:183], v[102:103] op_sel:[0,1] op_sel_hi:[1,1]
v_cvt_pk_bf16_f32 v180, v180, v181
buffer_store_dwordx4 v[164:167], v18, s[32:35], s81 offen
v_cvt_pk_bf16_f32 v174, v176, v177
v_cvt_pk_bf16_f32 v175, v178, v179
v_pk_mul_f32 v[184:185], v[184:185], v[102:103] op_sel:[0,1] op_sel_hi:[1,1]
v_pk_mul_f32 v[186:187], v[186:187], v[102:103] op_sel:[0,1] op_sel_hi:[1,1]
v_cvt_pk_bf16_f32 v181, v182, v183
buffer_store_dwordx4 v[172:175], v18, s[32:35], s82 offen
v_cvt_pk_bf16_f32 v182, v184, v185
v_cvt_pk_bf16_f32 v183, v186, v187
buffer_store_dwordx4 v[180:183], v18, s[32:35], s83 offen
back_95:
s_barrier
v_and_b32 v36, 31, v0
v_lshlrev_b32 v36, 2, v36
s_lshl_b32 s62, s45, 2
v_mov_b32 v4, s62
v_mov_b32 v5, 2
s_mov_b64 exec, 1
s_waitcnt vmcnt(0)
s_cmp_eq_u32 s46, 0
s_cbranch_scc1 slow_96
buffer_store_dword v5, v4, s[32:35], s84 offen
back_97:
s_mov_b64 exec, -1
v_lshrrev_b32 v4, 2, v2
v_and_b32 v5, 3, v0
v_lshl_add_u32 v6, v3, 3, v4
v_lshlrev_b32 v6, 7, v6
v_lshl_add_u32 v6, v5, 3, v6
v_lshrrev_b32 v7, 1, v4
v_and_b32 v8, 1, v3
v_lshl_add_u32 v7, v8, 1, v7
v_lshl_add_u32 v10, v7, 5, v6
v_xor_b32 v11, 32, v10
v_xor_b32 v12, 64, v10
v_xor_b32 v13, 96, v10
v_add_u32 v14, 0x10000, v10
v_add_u32 v15, 0x10000, v11
v_add_u32 v16, 0x10000, v12
v_add_u32 v17, 0x10000, v13
ds_read_b64_tr_b16 v[220:221], v10 offset:0
ds_read_b64_tr_b16 v[222:223], v10 offset:512
ds_read_b64_tr_b16 v[224:225], v11 offset:0
ds_read_b64_tr_b16 v[226:227], v11 offset:512
ds_read_b64_tr_b16 v[228:229], v12 offset:0
ds_read_b64_tr_b16 v[230:231], v12 offset:512
ds_read_b64_tr_b16 v[232:233], v13 offset:0
ds_read_b64_tr_b16 v[234:235], v13 offset:512
ds_read_b64_tr_b16 v[236:237], v10 offset:4096
ds_read_b64_tr_b16 v[238:239], v10 offset:4608
ds_read_b64_tr_b16 v[240:241], v11 offset:4096
ds_read_b64_tr_b16 v[242:243], v11 offset:4608
ds_read_b64_tr_b16 v[244:245], v12 offset:4096
ds_read_b64_tr_b16 v[246:247], v12 offset:4608
ds_read_b64_tr_b16 v[248:249], v13 offset:4096
ds_read_b64_tr_b16 v[250:251], v13 offset:4608
s_lshl_b32 s48, s41, 3
s_lshl_b32 s49, s40, 1
s_add_u32 s48, s48, s49
s_lshl_b32 s48, s48, 15
s_add_u32 s48, s48, 4194304
v_add_u32 v38, s48, v18
v_add_u32 v39, 32768, v38
s_lshl_b32 s57, s75, 11
s_add_u32 s87, s87, 262144
v_lshlrev_b32 v60, 16, v20
v_and_b32 v61, 0xffff0000, v20
v_lshlrev_b32 v62, 16, v21
v_and_b32 v63, 0xffff0000, v21
v_lshlrev_b32 v64, 16, v22
v_and_b32 v65, 0xffff0000, v22
v_lshlrev_b32 v66, 16, v23
v_and_b32 v67, 0xffff0000, v23
v_lshlrev_b32 v68, 16, v24
v_and_b32 v69, 0xffff0000, v24
v_lshlrev_b32 v70, 16, v25
v_and_b32 v71, 0xffff0000, v25
v_lshlrev_b32 v72, 16, v26
v_and_b32 v73, 0xffff0000, v26
v_lshlrev_b32 v74, 16, v27
v_and_b32 v75, 0xffff0000, v27
v_lshlrev_b32 v76, 16, v28
v_and_b32 v77, 0xffff0000, v28
v_lshlrev_b32 v78, 16, v29
v_and_b32 v79, 0xffff0000, v29
v_lshlrev_b32 v80, 16, v30
v_and_b32 v81, 0xffff0000, v30
v_lshlrev_b32 v82, 16, v31
v_and_b32 v83, 0xffff0000, v31
v_lshlrev_b32 v84, 16, v32
v_and_b32 v85, 0xffff0000, v32
v_lshlrev_b32 v86, 16, v33
v_and_b32 v87, 0xffff0000, v33
v_lshlrev_b32 v88, 16, v34
v_and_b32 v89, 0xffff0000, v34
v_lshlrev_b32 v90, 16, v35
v_and_b32 v91, 0xffff0000, v35
v_mov_b32 v6, 0
v_mov_b32 v7, 0
v_mov_b32 v8, 0
v_mov_b32 v9, 0
s_lshl_b32 s62, s42, 2
v_mov_b32 v4, s62
v_mov_b32 v5, 2
buffer_load_dword v37, v36, s[32:35], s84 offen sc1
s_mov_b32 s63, 0
s_waitcnt vmcnt(0)
poll_98:
v_cmp_gt_u32 vcc, 2, v37
s_cbranch_vccz polled_99
buffer_load_dword v37, v36, s[32:35], s84 offen sc1
s_add_u32 s63, s63, 1
s_cmp_lt_u32 s63, 0x80000
s_waitcnt vmcnt(0)
s_cbranch_scc1 poll_98
polled_99:
s_call_b64 s[94:95], R_oloop
s_cmp_eq_u32 s46, 0
s_cbranch_scc1 slow_100
s_nop 0
v_cvt_pk_bf16_f32 v20, v60, v61
v_cvt_pk_bf16_f32 v21, v62, v63
v_cvt_pk_bf16_f32 v22, v64, v65
v_cvt_pk_bf16_f32 v23, v66, v67
buffer_store_dwordx4 v[20:23], v18, s[32:35], s85 offen offset:0
v_cvt_pk_bf16_f32 v24, v68, v69
v_cvt_pk_bf16_f32 v25, v70, v71
v_cvt_pk_bf16_f32 v26, v72, v73
v_cvt_pk_bf16_f32 v27, v74, v75
buffer_store_dwordx4 v[24:27], v18, s[32:35], s85 offen offset:1024
v_cvt_pk_bf16_f32 v28, v76, v77
v_cvt_pk_bf16_f32 v29, v78, v79
v_cvt_pk_bf16_f32 v30, v80, v81
v_cvt_pk_bf16_f32 v31, v82, v83
buffer_store_dwordx4 v[28:31], v18, s[32:35], s86 offen offset:0
v_cvt_pk_bf16_f32 v32, v84, v85
v_cvt_pk_bf16_f32 v33, v86, v87
v_cvt_pk_bf16_f32 v34, v88, v89
v_cvt_pk_bf16_f32 v35, v90, v91
buffer_store_dwordx4 v[32:35], v18, s[32:35], s86 offen offset:1024
s_barrier
v_dot2c_f32_bf16 v6, v20, v48
v_dot2c_f32_bf16 v8, v20, v20
v_dot2c_f32_bf16 v7, v28, v48
v_dot2c_f32_bf16 v9, v28, v28
v_dot2c_f32_bf16 v6, v21, v48
v_dot2c_f32_bf16 v8, v21, v21
v_dot2c_f32_bf16 v7, v29, v48
v_dot2c_f32_bf16 v9, v29, v29
v_dot2c_f32_bf16 v6, v22, v48
v_dot2c_f32_bf16 v8, v22, v22
v_dot2c_f32_bf16 v7, v30, v48
v_dot2c_f32_bf16 v9, v30, v30
v_dot2c_f32_bf16 v6, v23, v48
v_dot2c_f32_bf16 v8, v23, v23
v_dot2c_f32_bf16 v7, v31, v48
v_dot2c_f32_bf16 v9, v31, v31
v_dot2c_f32_bf16 v6, v24, v48
v_dot2c_f32_bf16 v8, v24, v24
v_dot2c_f32_bf16 v7, v32, v48
v_dot2c_f32_bf16 v9, v32, v32
v_dot2c_f32_bf16 v6, v25, v48
v_dot2c_f32_bf16 v8, v25, v25
v_dot2c_f32_bf16 v7, v33, v48
v_dot2c_f32_bf16 v9, v33, v33
v_dot2c_f32_bf16 v6, v26, v48
v_dot2c_f32_bf16 v8, v26, v26
v_dot2c_f32_bf16 v7, v34, v48
v_dot2c_f32_bf16 v9, v34, v34
v_dot2c_f32_bf16 v6, v27, v48
v_dot2c_f32_bf16 v8, v27, v27
v_dot2c_f32_bf16 v7, v35, v48
v_dot2c_f32_bf16 v9, v35, v35
s_mov_b64 exec, 1
s_waitcnt vmcnt(0)
buffer_store_dword v5, v4, s[32:35], s88 offen
s_mov_b64 exec, -1
s_nop 1
v_permlane32_swap_b32 v6, v7
v_permlane32_swap_b32 v8, v9
v_add_f32 v6, v6, v7
v_add_f32 v8, v8, v9
s_nop 1
v_permlane16_swap_b32 v6, v8
s_nop 0
v_add_f32 v6, v6, v8
buffer_store_dword v6, v1, s[32:35], s87 offen
back_101:
s_lshl_b32 s49, s44, 13
v_add_u32 v10, s49, v18
v_add_u32 v11, 1024, v10
s_lshl_b32 s48, s43, 1
v_lshrrev_b32 v4, 2, v2
v_and_b32 v5, 3, v0
v_lshl_add_u32 v6, v3, 3, v4
v_lshlrev_b32 v6, 7, v6
v_lshl_add_u32 v6, v5, 3, v6
v_lshrrev_b32 v7, 1, v4
v_and_b32 v8, 1, v3
v_lshl_add_u32 v7, v8, 1, v7
v_xor_b32 v7, s48, v7
v_lshl_add_u32 v12, v7, 5, v6
v_add_u32 v12, 16384, v12
v_xor_b32 v13, 32, v12
v_mov_b32 v14, v10
v_mov_b32 v15, v11
v_add_u32 v16, 122880, v12
v_add_u32 v17, 122880, v13
v_mov_b32 v156, 0
v_mov_b32 v157, 0
v_mov_b32 v158, 0
v_mov_b32 v159, 0
v_mov_b32 v160, 0
v_mov_b32 v161, 0
v_mov_b32 v162, 0
v_mov_b32 v163, 0
v_mov_b32 v164, 0
v_mov_b32 v165, 0
v_mov_b32 v166, 0
v_mov_b32 v167, 0
v_mov_b32 v168, 0
v_mov_b32 v169, 0
v_mov_b32 v170, 0
v_mov_b32 v171, 0
v_mov_b32 v172, 0
v_mov_b32 v173, 0
v_mov_b32 v174, 0
v_mov_b32 v175, 0
v_mov_b32 v176, 0
v_mov_b32 v177, 0
v_mov_b32 v178, 0
v_mov_b32 v179, 0
v_mov_b32 v180, 0
v_mov_b32 v181, 0
v_mov_b32 v182, 0
v_mov_b32 v183, 0
v_mov_b32 v184, 0
v_mov_b32 v185, 0
v_mov_b32 v186, 0
v_mov_b32 v187, 0
v_mov_b32 v188, 0
v_mov_b32 v189, 0
v_mov_b32 v190, 0
v_mov_b32 v191, 0
v_mov_b32 v192, 0
v_mov_b32 v193, 0
v_mov_b32 v194, 0
v_mov_b32 v195, 0
v_mov_b32 v196, 0
v_mov_b32 v197, 0
v_mov_b32 v198, 0
v_mov_b32 v199, 0
v_mov_b32 v200, 0
v_mov_b32 v201, 0
v_mov_b32 v202, 0
v_mov_b32 v203, 0
v_mov_b32 v204, 0
v_mov_b32 v205, 0
v_mov_b32 v206, 0
v_mov_b32 v207, 0
v_mov_b32 v208, 0
v_mov_b32 v209, 0
v_mov_b32 v210, 0
v_mov_b32 v211, 0
v_mov_b32 v212, 0
v_mov_b32 v213, 0
v_mov_b32 v214, 0
v_mov_b32 v215, 0
v_mov_b32 v216, 0
v_mov_b32 v217, 0
v_mov_b32 v218, 0
v_mov_b32 v219, 0
v_mov_b32 v220, 0
v_mov_b32 v221, 0
v_mov_b32 v222, 0
v_mov_b32 v223, 0
v_mov_b32 v224, 0
v_mov_b32 v225, 0
v_mov_b32 v226, 0
v_mov_b32 v227, 0
v_mov_b32 v228, 0
v_mov_b32 v229, 0
v_mov_b32 v230, 0
v_mov_b32 v231, 0
v_mov_b32 v232, 0
v_mov_b32 v233, 0
v_mov_b32 v234, 0
v_mov_b32 v235, 0
v_mov_b32 v236, 0
v_mov_b32 v237, 0
v_mov_b32 v238, 0
v_mov_b32 v239, 0
v_mov_b32 v240, 0
v_mov_b32 v241, 0
v_mov_b32 v242, 0
v_mov_b32 v243, 0
v_mov_b32 v244, 0
v_mov_b32 v245, 0
v_mov_b32 v246, 0
v_mov_b32 v247, 0
v_mov_b32 v248, 0
v_mov_b32 v249, 0
v_mov_b32 v250, 0
v_mov_b32 v251, 0
s_mov_b32 s48, 0xf149f2ca
v_mov_b32 v9, s48
v_lshlrev_b32 v4, 2, v3
v_sub_u32 v4, v2, v4
v_subrev_u32 v5, 0, v4
v_and_b32 v6, 0x80000001, v5
v_cmp_eq_u32 vcc, 0, v6
v_add_u32 v5, 1, v5
v_and_b32 v6, 0x80000001, v5
v_cndmask_b32 v40, v9, 0, vcc
v_cmp_eq_u32 vcc, 0x80000001, v6
s_nop 1
v_cndmask_b32 v36, v9, 0, vcc
v_subrev_u32 v5, 1, v4
v_and_b32 v6, 0x80000001, v5
v_cmp_eq_u32 vcc, 0, v6
v_add_u32 v5, 1, v5
v_and_b32 v6, 0x80000001, v5
v_cndmask_b32 v41, v9, 0, vcc
v_cmp_eq_u32 vcc, 0x80000001, v6
s_nop 1
v_cndmask_b32 v37, v9, 0, vcc
v_subrev_u32 v5, 2, v4
v_and_b32 v6, 0x80000001, v5
v_cmp_eq_u32 vcc, 0, v6
v_add_u32 v5, 1, v5
v_and_b32 v6, 0x80000001, v5
v_cndmask_b32 v42, v9, 0, vcc
v_cmp_eq_u32 vcc, 0x80000001, v6
s_nop 1
v_cndmask_b32 v38, v9, 0, vcc
v_subrev_u32 v5, 3, v4
v_and_b32 v6, 0x80000001, v5
v_cmp_eq_u32 vcc, 0, v6
v_add_u32 v5, 1, v5
v_and_b32 v6, 0x80000001, v5
v_cndmask_b32 v43, v9, 0, vcc
v_cmp_eq_u32 vcc, 0x80000001, v6
s_nop 1
v_cndmask_b32 v39, v9, 0, vcc
s_or_b32 s48, s41, s44
s_cmp_eq_u32 s48, 0
s_cselect_b64 vcc, -1, 0
v_cndmask_b32 v44, v36, v9, vcc
v_cndmask_b32 v45, v37, v9, vcc
v_cndmask_b32 v46, v38, v9, vcc
v_cndmask_b32 v47, v39, v9, vcc
v_and_b32 v4, 1, v2
v_lshlrev_b32 v4, 4, v4
v_mov_b32 v5, 0xffff
v_lshlrev_b32 v52, v4, v5
s_lshl_b32 s48, s43, 11
s_add_u32 s48, s48, 135168
v_add_u32 v53, s48, v18
v_lshl_add_u32 v55, v0, 3, s48
s_add_u32 s48, s41, s44
s_sub_u32 s48, s48, 1
s_lshl_b32 s49, s48, 1
s_add_u32 s49, s49, s43
s_lshl_b32 s49, s49, 11
s_mul_i32 s50, s42, 65536
s_add_u32 s49, s49, s50
s_add_u32 s49, s49, 8388608
s_cmp_lt_i32 s48, 0
s_cselect_b32 s49, 0xf0000000, s49
v_add_u32 v58, s49, v18
v_lshl_add_u32 v59, v0, 3, s49
s_lshl_b32 s48, s43, 2
s_add_u32 s48, s48, 134672
v_mov_b32 v19, s48
s_lshl_b32 s48, s43, 7
s_add_u32 s48, s48, 133120
v_lshl_add_u32 v7, v3, 4, s48
v_lshl_add_u32 v54, v2, 2, s48
s_lshl_b32 s49, s44, 6
v_add_u32 v8, s49, v2
v_lshlrev_b32 v8, 3, v8
v_add_u32 v8, 131072, v8
v_lshl_add_u32 v9, v3, 2, s49
v_lshlrev_b32 v9, 2, v9
v_add_u32 v9, 132096, v9
s_mov_b32 s64, 0
s_mov_b32 s65, 0
s_mov_b32 s66, 0x3e8293ee
s_mov_b32 s61, 3
ds_read_b64_tr_b16 v[84:85], v16 offset:8192
ds_read_b64_tr_b16 v[86:87], v16 offset:8704
ds_read_b64_tr_b16 v[88:89], v17 offset:8192
ds_read_b64_tr_b16 v[90:91], v17 offset:8704
ds_read_b64_tr_b16 v[92:93], v16 offset:16384
ds_read_b64_tr_b16 v[94:95], v16 offset:16896
ds_read_b64_tr_b16 v[96:97], v17 offset:16384
ds_read_b64_tr_b16 v[98:99], v17 offset:16896
ds_read_b64_tr_b16 v[76:77], v16 offset:0
ds_read_b64_tr_b16 v[78:79], v16 offset:512
ds_read_b64_tr_b16 v[80:81], v17 offset:0
ds_read_b64_tr_b16 v[82:83], v17 offset:512
s_barrier
ds_read_b128 v[60:63], v14 offset:0
ds_read_b128 v[64:67], v14 offset:2048
ds_read_b128 v[68:71], v14 offset:4096
ds_read_b128 v[72:75], v14 offset:6144
s_waitcnt lgkmcnt(0)
c2_loop:
v_mfma_f32_16x16x32_bf16 v[212:215], v[84:87], v[72:75], v[212:215]
ds_read_b128 v[100:103], v15 offset:0
v_mfma_f32_16x16x32_bf16 v[204:207], v[84:87], v[68:71], v[204:207]
ds_read_b128 v[104:107], v15 offset:2048
v_mfma_f32_16x16x32_bf16 v[196:199], v[84:87], v[64:67], v[196:199]
ds_read_b128 v[108:111], v15 offset:4096
v_mfma_f32_16x16x32_bf16 v[188:191], v[84:87], v[60:63], v[188:191]
ds_read_b128 v[112:115], v15 offset:6144
v_mfma_f32_16x16x32_bf16 v[192:195], v[88:91], v[60:63], v[192:195]
ds_read_b64_tr_b16 v[124:125], v16 offset:12288
v_mfma_f32_16x16x32_bf16 v[200:203], v[88:91], v[64:67], v[200:203]
ds_read_b64_tr_b16 v[126:127], v16 offset:12800
v_mfma_f32_16x16x32_bf16 v[208:211], v[88:91], v[68:71], v[208:211]
ds_read_b64_tr_b16 v[128:129], v17 offset:12288
v_mfma_f32_16x16x32_bf16 v[216:219], v[88:91], v[72:75], v[216:219]
ds_read_b64_tr_b16 v[130:131], v17 offset:12800
v_mfma_f32_16x16x32_bf16 v[244:247], v[72:75], v[92:95], v[244:247]
ds_read_b64_tr_b16 v[132:133], v16 offset:20480
v_mfma_f32_16x16x32_bf16 v[248:251], v[72:75], v[96:99], v[248:251]
ds_read_b64_tr_b16 v[134:135], v16 offset:20992
v_mfma_f32_16x16x32_bf16 v[240:243], v[68:71], v[96:99], v[240:243]
ds_read_b64_tr_b16 v[136:137], v17 offset:20480
v_mfma_f32_16x16x32_bf16 v[236:239], v[68:71], v[92:95], v[236:239]
ds_read_b64_tr_b16 v[138:139], v17 offset:20992
v_mfma_f32_16x16x32_bf16 v[228:231], v[64:67], v[92:95], v[228:231]
ds_read_b64_tr_b16 v[116:117], v16 offset:4096
v_mfma_f32_16x16x32_bf16 v[232:235], v[64:67], v[96:99], v[232:235]
ds_read_b64_tr_b16 v[118:119], v16 offset:4608
v_mfma_f32_16x16x32_bf16 v[224:227], v[60:63], v[96:99], v[224:227]
ds_read_b64_tr_b16 v[120:121], v17 offset:4096
v_mfma_f32_16x16x32_bf16 v[220:223], v[60:63], v[92:95], v[220:223]
ds_read_b64_tr_b16 v[122:123], v17 offset:4608
v_mfma_f32_16x16x32_bf16 v[156:159], v[76:79], v[60:63], v[156:159]
s_add_u32 s65, s65, 40960
s_cmp_eq_u32 s65, 122880
v_mfma_f32_16x16x32_bf16 v[164:167], v[76:79], v[64:67], v[164:167]
s_cselect_b32 s65, 0, s65
s_add_u32 s64, s64, 1
v_mfma_f32_16x16x32_bf16 v[172:175], v[76:79], v[68:71], v[172:175]
v_add_u32 v14, s65, v10
v_add_u32 v15, s65, v11
v_mfma_f32_16x16x32_bf16 v[180:183], v[76:79], v[72:75], v[180:183]
v_add_u32 v16, s65, v12
v_add_u32 v17, s65, v13
v_mfma_f32_16x16x32_bf16 v[184:187], v[80:83], v[72:75], v[184:187]
v_mfma_f32_16x16x32_bf16 v[176:179], v[80:83], v[68:71], v[176:179]
s_cmp_eq_u32 s64, 16
s_cbranch_scc1 c2_last
v_mfma_f32_16x16x32_bf16 v[168:171], v[80:83], v[64:67], v[168:171]
s_waitcnt lgkmcnt(0)
v_mfma_f32_16x16x32_bf16 v[160:163], v[80:83], v[60:63], v[160:163]
s_barrier
v_mfma_f32_16x16x32_bf16 v[212:215], v[124:127], v[112:115], v[212:215]
ds_read_b128 v[60:63], v14 offset:0
v_mfma_f32_16x16x32_bf16 v[204:207], v[124:127], v[108:111], v[204:207]
ds_read_b128 v[64:67], v14 offset:2048
v_mfma_f32_16x16x32_bf16 v[196:199], v[124:127], v[104:107], v[196:199]
ds_read_b128 v[68:71], v14 offset:4096
v_mfma_f32_16x16x32_bf16 v[188:191], v[124:127], v[100:103], v[188:191]
ds_read_b128 v[72:75], v14 offset:6144
v_mfma_f32_16x16x32_bf16 v[192:195], v[128:131], v[100:103], v[192:195]
ds_read_b64_tr_b16 v[84:85], v16 offset:8192
v_mfma_f32_16x16x32_bf16 v[200:203], v[128:131], v[104:107], v[200:203]
ds_read_b64_tr_b16 v[86:87], v16 offset:8704
v_mfma_f32_16x16x32_bf16 v[208:211], v[128:131], v[108:111], v[208:211]
ds_read_b64_tr_b16 v[88:89], v17 offset:8192
v_mfma_f32_16x16x32_bf16 v[216:219], v[128:131], v[112:115], v[216:219]
ds_read_b64_tr_b16 v[90:91], v17 offset:8704
v_mfma_f32_16x16x32_bf16 v[244:247], v[112:115], v[132:135], v[244:247]
ds_read_b64_tr_b16 v[92:93], v16 offset:16384
v_mfma_f32_16x16x32_bf16 v[248:251], v[112:115], v[136:139], v[248:251]
ds_read_b64_tr_b16 v[94:95], v16 offset:16896
v_mfma_f32_16x16x32_bf16 v[240:243], v[108:111], v[136:139], v[240:243]
ds_read_b64_tr_b16 v[96:97], v17 offset:16384
v_mfma_f32_16x16x32_bf16 v[236:239], v[108:111], v[132:135], v[236:239]
ds_read_b64_tr_b16 v[98:99], v17 offset:16896
v_mfma_f32_16x16x32_bf16 v[228:231], v[104:107], v[132:135], v[228:231]
ds_read_b64_tr_b16 v[76:77], v16 offset:0
v_mfma_f32_16x16x32_bf16 v[232:235], v[104:107], v[136:139], v[232:235]
ds_read_b64_tr_b16 v[78:79], v16 offset:512
v_mfma_f32_16x16x32_bf16 v[224:227], v[100:103], v[136:139], v[224:227]
ds_read_b64_tr_b16 v[80:81], v17 offset:0
v_mfma_f32_16x16x32_bf16 v[220:223], v[100:103], v[132:135], v[220:223]
ds_read_b64_tr_b16 v[82:83], v17 offset:512
v_mfma_f32_16x16x32_bf16 v[156:159], v[116:119], v[100:103], v[156:159]
v_mfma_f32_16x16x32_bf16 v[164:167], v[116:119], v[104:107], v[164:167]
v_mfma_f32_16x16x32_bf16 v[172:175], v[116:119], v[108:111], v[172:175]
v_mfma_f32_16x16x32_bf16 v[180:183], v[116:119], v[112:115], v[180:183]
v_mfma_f32_16x16x32_bf16 v[184:187], v[120:123], v[112:115], v[184:187]
v_mfma_f32_16x16x32_bf16 v[176:179], v[120:123], v[108:111], v[176:179]
v_mfma_f32_16x16x32_bf16 v[168:171], v[120:123], v[104:107], v[168:171]
s_waitcnt lgkmcnt(0)
v_mfma_f32_16x16x32_bf16 v[160:163], v[120:123], v[100:103], v[160:163]
s_branch c2_loop
c2_last:
v_mfma_f32_16x16x32_bf16 v[168:171], v[80:83], v[64:67], v[168:171]
s_waitcnt lgkmcnt(0)
v_mfma_f32_16x16x32_bf16 v[160:163], v[80:83], v[60:63], v[160:163]
v_mfma_f32_16x16x32_bf16 v[212:215], v[124:127], v[112:115], v[212:215]
ds_read_b128 v[140:143], v7 offset:0
v_mfma_f32_16x16x32_bf16 v[204:207], v[124:127], v[108:111], v[204:207]
ds_read_b128 v[144:147], v7 offset:64
v_mfma_f32_16x16x32_bf16 v[196:199], v[124:127], v[104:107], v[196:199]
ds_read_b128 v[148:151], v7 offset:256
v_mfma_f32_16x16x32_bf16 v[188:191], v[124:127], v[100:103], v[188:191]
ds_read_b128 v[152:155], v7 offset:320
v_mfma_f32_16x16x32_bf16 v[192:195], v[128:131], v[100:103], v[192:195]
ds_read2_b32 v[56:57], v54 offset0:128 offset1:144
v_mfma_f32_16x16x32_bf16 v[200:203], v[128:131], v[104:107], v[200:203]
v_mfma_f32_16x16x32_bf16 v[208:211], v[128:131], v[108:111], v[208:211]
v_mfma_f32_16x16x32_bf16 v[216:219], v[128:131], v[112:115], v[216:219]
s_barrier
v_mfma_f32_16x16x32_bf16 v[244:247], v[112:115], v[132:135], v[244:247]
ds_read_b64 v[92:93], v8 offset:0
v_mfma_f32_16x16x32_bf16 v[248:251], v[112:115], v[136:139], v[248:251]
ds_read_b64 v[94:95], v8 offset:128
v_mfma_f32_16x16x32_bf16 v[240:243], v[108:111], v[136:139], v[240:243]
ds_read_b64 v[96:97], v8 offset:256
v_mfma_f32_16x16x32_bf16 v[236:239], v[108:111], v[132:135], v[236:239]
ds_read_b64 v[98:99], v8 offset:384
v_mfma_f32_16x16x32_bf16 v[228:231], v[104:107], v[132:135], v[228:231]
ds_read_b128 v[60:63], v9 offset:0
v_mfma_f32_16x16x32_bf16 v[232:235], v[104:107], v[136:139], v[232:235]
ds_read_b128 v[64:67], v9 offset:64
v_mfma_f32_16x16x32_bf16 v[224:227], v[100:103], v[136:139], v[224:227]
ds_read_b128 v[68:71], v9 offset:128
v_mfma_f32_16x16x32_bf16 v[220:223], v[100:103], v[132:135], v[220:223]
ds_read_b128 v[72:75], v9 offset:192
v_mfma_f32_16x16x32_bf16 v[156:159], v[116:119], v[100:103], v[156:159]
ds_read_b128 v[76:79], v9 offset:512
v_mfma_f32_16x16x32_bf16 v[164:167], v[116:119], v[104:107], v[164:167]
ds_read_b128 v[80:83], v9 offset:576
v_mfma_f32_16x16x32_bf16 v[172:175], v[116:119], v[108:111], v[172:175]
ds_read_b128 v[84:87], v9 offset:640
v_mfma_f32_16x16x32_bf16 v[180:183], v[116:119], v[112:115], v[180:183]
ds_read_b128 v[88:91], v9 offset:704
v_mfma_f32_16x16x32_bf16 v[184:187], v[120:123], v[112:115], v[184:187]
v_mfma_f32_16x16x32_bf16 v[176:179], v[120:123], v[108:111], v[176:179]
v_mfma_f32_16x16x32_bf16 v[168:171], v[120:123], v[104:107], v[168:171]
v_mfma_f32_16x16x32_bf16 v[160:163], v[120:123], v[100:103], v[160:163]
c2_epi:
s_waitcnt lgkmcnt(0)
.p2align 3
v_pk_fma_f32 v[212:213], v[148:149], v[98:99], v[212:213] op_sel:[0,1,0] op_sel_hi:[1,1,1]
v_pk_fma_f32 v[214:215], v[150:151], v[98:99], v[214:215] op_sel:[0,1,0] op_sel_hi:[1,1,1]
v_pk_fma_f32 v[216:217], v[152:153], v[98:99], v[216:217] op_sel:[0,1,0] op_sel_hi:[1,1,1]
v_pk_fma_f32 v[218:219], v[154:155], v[98:99], v[218:219] op_sel:[0,1,0] op_sel_hi:[1,1,1]
v_pk_mul_f32 v[212:213], v[212:213], v[98:99] op_sel:[0,0] op_sel_hi:[1,0]
v_pk_mul_f32 v[214:215], v[214:215], v[98:99] op_sel:[0,0] op_sel_hi:[1,0]
v_pk_mul_f32 v[216:217], v[216:217], v[98:99] op_sel:[0,0] op_sel_hi:[1,0]
v_pk_mul_f32 v[218:219], v[218:219], v[98:99] op_sel:[0,0] op_sel_hi:[1,0]
v_cvt_pk_bf16_f32 v212, v212, v213
v_cvt_pk_bf16_f32 v213, v214, v215
v_cvt_pk_bf16_f32 v214, v216, v217
v_cvt_pk_bf16_f32 v215, v218, v219
v_pk_fma_f32 v[244:245], v[88:89], v[56:57], v[244:245] op_sel:[0,0,0] op_sel_hi:[1,0,1]
v_pk_fma_f32 v[246:247], v[90:91], v[56:57], v[246:247] op_sel:[0,0,0] op_sel_hi:[1,0,1]
v_pk_mul_f32 v[244:245], v[244:245], v[72:73]
v_pk_mul_f32 v[246:247], v[246:247], v[74:75]
v_cvt_pk_bf16_f32 v108, v244, v245
v_cvt_pk_bf16_f32 v109, v246, v247
v_pk_fma_f32 v[248:249], v[88:89], v[56:57], v[248:249] op_sel:[0,1,0] op_sel_hi:[1,1,1]
v_pk_fma_f32 v[250:251], v[90:91], v[56:57], v[250:251] op_sel:[0,1,0] op_sel_hi:[1,1,1]
v_pk_mul_f32 v[248:249], v[248:249], v[72:73]
v_pk_mul_f32 v[250:251], v[250:251], v[74:75]
v_cvt_pk_bf16_f32 v118, v248, v249
v_cvt_pk_bf16_f32 v119, v250, v251
s_cmp_lg_u32 s44, 1
s_cbranch_scc1 else_102
buffer_store_dwordx4 v[212:215], v58, s[32:35], 0 offen sc1
buffer_store_dwordx2 v[108:109], v59, s[32:35], 0 offen offset:1024 sc1
buffer_store_dwordx2 v[118:119], v59, s[32:35], 0 offen offset:1536 sc1
s_branch fi_103
else_102:
ds_write_b128 v53, v[212:215]
ds_write_b64 v55, v[108:109] offset:1024
ds_write_b64 v55, v[118:119] offset:1536
v_mov_b32 v4, 3
ds_write_b32 v19, v4
fi_103:
.p2align 3
v_pk_fma_f32 v[188:189], v[148:149], v[92:93], v[188:189] op_sel:[0,1,0] op_sel_hi:[1,1,1]
v_pk_fma_f32 v[196:197], v[148:149], v[94:95], v[196:197] op_sel:[0,1,0] op_sel_hi:[1,1,1]
v_pk_fma_f32 v[204:205], v[148:149], v[96:97], v[204:205] op_sel:[0,1,0] op_sel_hi:[1,1,1]
v_pk_fma_f32 v[164:165], v[140:141], v[94:95], v[164:165] op_sel:[0,1,0] op_sel_hi:[1,1,1]
v_pk_fma_f32 v[172:173], v[140:141], v[96:97], v[172:173] op_sel:[0,1,0] op_sel_hi:[1,1,1]
v_pk_fma_f32 v[180:181], v[140:141], v[98:99], v[180:181] op_sel:[0,1,0] op_sel_hi:[1,1,1]
v_pk_fma_f32 v[190:191], v[150:151], v[92:93], v[190:191] op_sel:[0,1,0] op_sel_hi:[1,1,1]
v_pk_mul_f32 v[188:189], v[188:189], v[92:93] op_sel:[0,0] op_sel_hi:[1,0]
v_pk_fma_f32 v[198:199], v[150:151], v[94:95], v[198:199] op_sel:[0,1,0] op_sel_hi:[1,1,1]
v_pk_mul_f32 v[196:197], v[196:197], v[94:95] op_sel:[0,0] op_sel_hi:[1,0]
v_pk_fma_f32 v[206:207], v[150:151], v[96:97], v[206:207] op_sel:[0,1,0] op_sel_hi:[1,1,1]
v_pk_mul_f32 v[204:205], v[204:205], v[96:97] op_sel:[0,0] op_sel_hi:[1,0]
v_pk_fma_f32 v[166:167], v[142:143], v[94:95], v[166:167] op_sel:[0,1,0] op_sel_hi:[1,1,1]
v_cvt_pk_bf16_f32 v164, v164, v165
v_pk_fma_f32 v[174:175], v[142:143], v[96:97], v[174:175] op_sel:[0,1,0] op_sel_hi:[1,1,1]
v_cvt_pk_bf16_f32 v172, v172, v173
v_pk_fma_f32 v[182:183], v[142:143], v[98:99], v[182:183] op_sel:[0,1,0] op_sel_hi:[1,1,1]
v_cvt_pk_bf16_f32 v180, v180, v181
v_pk_fma_f32 v[192:193], v[152:153], v[92:93], v[192:193] op_sel:[0,1,0] op_sel_hi:[1,1,1]
v_pk_fma_f32 v[194:195], v[154:155], v[92:93], v[194:195] op_sel:[0,1,0] op_sel_hi:[1,1,1]
v_pk_mul_f32 v[190:191], v[190:191], v[92:93] op_sel:[0,0] op_sel_hi:[1,0]
v_cvt_pk_bf16_f32 v188, v188, v189
v_pk_fma_f32 v[200:201], v[152:153], v[94:95], v[200:201] op_sel:[0,1,0] op_sel_hi:[1,1,1]
v_pk_fma_f32 v[202:203], v[154:155], v[94:95], v[202:203] op_sel:[0,1,0] op_sel_hi:[1,1,1]
v_pk_mul_f32 v[198:199], v[198:199], v[94:95] op_sel:[0,0] op_sel_hi:[1,0]
v_cvt_pk_bf16_f32 v196, v196, v197
v_pk_fma_f32 v[208:209], v[152:153], v[96:97], v[208:209] op_sel:[0,1,0] op_sel_hi:[1,1,1]
v_pk_fma_f32 v[210:211], v[154:155], v[96:97], v[210:211] op_sel:[0,1,0] op_sel_hi:[1,1,1]
v_pk_mul_f32 v[206:207], v[206:207], v[96:97] op_sel:[0,0] op_sel_hi:[1,0]
v_cvt_pk_bf16_f32 v204, v204, v205
v_pk_fma_f32 v[168:169], v[144:145], v[94:95], v[168:169] op_sel:[0,1,0] op_sel_hi:[1,1,1]
v_pk_fma_f32 v[170:171], v[146:147], v[94:95], v[170:171] op_sel:[0,1,0] op_sel_hi:[1,1,1]
v_cvt_pk_bf16_f32 v165, v166, v167
v_pk_fma_f32 v[176:177], v[144:145], v[96:97], v[176:177] op_sel:[0,1,0] op_sel_hi:[1,1,1]
v_pk_fma_f32 v[178:179], v[146:147], v[96:97], v[178:179] op_sel:[0,1,0] op_sel_hi:[1,1,1]
v_cvt_pk_bf16_f32 v173, v174, v175
v_pk_fma_f32 v[184:185], v[144:145], v[98:99], v[184:185] op_sel:[0,1,0] op_sel_hi:[1,1,1]
v_pk_fma_f32 v[186:187], v[146:147], v[98:99], v[186:187] op_sel:[0,1,0] op_sel_hi:[1,1,1]
v_cvt_pk_bf16_f32 v181, v182, v183
v_pk_mul_f32 v[192:193], v[192:193], v[92:93] op_sel:[0,0] op_sel_hi:[1,0]
v_pk_mul_f32 v[194:195], v[194:195], v[92:93] op_sel:[0,0] op_sel_hi:[1,0]
v_cvt_pk_bf16_f32 v189, v190, v191
v_pk_mul_f32 v[200:201], v[200:201], v[94:95] op_sel:[0,0] op_sel_hi:[1,0]
v_pk_mul_f32 v[202:203], v[202:203], v[94:95] op_sel:[0,0] op_sel_hi:[1,0]
v_cvt_pk_bf16_f32 v197, v198, v199
v_pk_mul_f32 v[208:209], v[208:209], v[96:97] op_sel:[0,0] op_sel_hi:[1,0]
v_pk_mul_f32 v[210:211], v[210:211], v[96:97] op_sel:[0,0] op_sel_hi:[1,0]
v_cvt_pk_bf16_f32 v205, v206, v207
v_cvt_pk_bf16_f32 v166, v168, v169
v_cvt_pk_bf16_f32 v167, v170, v171
v_cvt_pk_bf16_f32 v174, v176, v177
v_cvt_pk_bf16_f32 v175, v178, v179
v_cvt_pk_bf16_f32 v182, v184, v185
v_cvt_pk_bf16_f32 v183, v186, v187
v_cvt_pk_bf16_f32 v190, v192, v193
v_cvt_pk_bf16_f32 v191, v194, v195
v_mfma_f32_16x16x32_bf16 v[216:219], v[212:215], v[180:183], v[40:43]
v_cvt_pk_bf16_f32 v198, v200, v201
v_cvt_pk_bf16_f32 v199, v202, v203
v_mfma_f32_16x16x32_bf16 v[168:171], v[188:191], v[164:167], v[36:39]
v_cvt_pk_bf16_f32 v206, v208, v209
v_cvt_pk_bf16_f32 v207, v210, v211
v_mfma_f32_16x16x32_bf16 v[200:203], v[196:199], v[164:167], v[40:43]
v_mul_f32 v124, s66, v92
v_mul_f32 v125, s66, v94
v_mfma_f32_16x16x32_bf16 v[208:211], v[204:207], v[172:175], v[40:43]
v_mul_f32 v126, s66, v96
v_mul_f32 v127, s66, v98
v_mfma_f32_16x16x32_bf16 v[176:179], v[196:199], v[172:175], v[36:39]
v_max_f32 v164, v168, v169
v_max_f32 v165, v170, v171
v_mfma_f32_16x16x32_bf16 v[184:187], v[204:207], v[180:183], v[36:39]
v_max_f32 v166, v200, v201
v_max_f32 v182, v216, v217
v_max_f32 v174, v208, v209
v_max_f32 v167, v202, v203
v_max3_f32 v129, v164, v165, v166
v_pk_fma_f32 v[156:157], v[140:141], v[92:93], v[156:157] op_sel:[0,1,0] op_sel_hi:[1,1,1]
v_pk_fma_f32 v[158:159], v[142:143], v[92:93], v[158:159] op_sel:[0,1,0] op_sel_hi:[1,1,1]
v_cvt_pk_bf16_f32 v156, v156, v157
v_pk_fma_f32 v[160:161], v[144:145], v[92:93], v[160:161] op_sel:[0,1,0] op_sel_hi:[1,1,1]
v_pk_fma_f32 v[162:163], v[146:147], v[92:93], v[162:163] op_sel:[0,1,0] op_sel_hi:[1,1,1]
v_cvt_pk_bf16_f32 v157, v158, v159
v_cvt_pk_bf16_f32 v158, v160, v161
v_cvt_pk_bf16_f32 v159, v162, v163
v_pk_fma_f32 v[220:221], v[76:77], v[56:57], v[220:221] op_sel:[0,0,0] op_sel_hi:[1,0,1]
v_pk_fma_f32 v[222:223], v[78:79], v[56:57], v[222:223] op_sel:[0,0,0] op_sel_hi:[1,0,1]
v_mfma_f32_16x16x32_bf16 v[192:195], v[188:191], v[156:159], v[40:43]
v_max_f32 v172, v176, v177
v_max_f32 v173, v178, v179
v_max_f32 v180, v184, v185
v_max_f32 v181, v186, v187
v_max_f32_e64 v175, v210, v211
v_pk_fma_f32 v[224:225], v[76:77], v[56:57], v[224:225] op_sel:[0,1,0] op_sel_hi:[1,1,1]
v_pk_fma_f32 v[226:227], v[78:79], v[56:57], v[226:227] op_sel:[0,1,0] op_sel_hi:[1,1,1]
v_pk_fma_f32 v[228:229], v[80:81], v[56:57], v[228:229] op_sel:[0,0,0] op_sel_hi:[1,0,1]
v_pk_fma_f32 v[230:231], v[82:83], v[56:57], v[230:231] op_sel:[0,0,0] op_sel_hi:[1,0,1]
v_pk_fma_f32 v[232:233], v[80:81], v[56:57], v[232:233] op_sel:[0,1,0] op_sel_hi:[1,1,1]
v_pk_fma_f32 v[234:235], v[82:83], v[56:57], v[234:235] op_sel:[0,1,0] op_sel_hi:[1,1,1]
v_pk_fma_f32 v[236:237], v[84:85], v[56:57], v[236:237] op_sel:[0,0,0] op_sel_hi:[1,0,1]
v_pk_fma_f32 v[238:239], v[86:87], v[56:57], v[238:239] op_sel:[0,0,0] op_sel_hi:[1,0,1]
v_pk_fma_f32 v[240:241], v[84:85], v[56:57], v[240:241] op_sel:[0,1,0] op_sel_hi:[1,1,1]
v_pk_fma_f32 v[242:243], v[86:87], v[56:57], v[242:243] op_sel:[0,1,0] op_sel_hi:[1,1,1]
v_pk_mul_f32 v[220:221], v[220:221], v[60:61]
v_pk_mul_f32 v[222:223], v[222:223], v[62:63]
v_pk_mul_f32 v[224:225], v[224:225], v[60:61]
s_cmp_lg_u32 s44, 0
s_cbranch_scc1 else_104
buffer_load_dwordx4 v[120:123], v58, s[32:35], 0 offen sc1
buffer_load_dwordx2 v[100:101], v59, s[32:35], 0 offen offset:1024 sc1
buffer_load_dwordx2 v[110:111], v59, s[32:35], 0 offen offset:1536 sc1
else_104:
v_pk_mul_f32 v[226:227], v[226:227], v[62:63]
v_pk_mul_f32 v[228:229], v[228:229], v[64:65]
v_pk_mul_f32 v[230:231], v[230:231], v[66:67]
v_pk_mul_f32 v[232:233], v[232:233], v[64:65]
v_pk_mul_f32 v[234:235], v[234:235], v[66:67]
v_pk_mul_f32 v[236:237], v[236:237], v[68:69]
v_pk_mul_f32 v[238:239], v[238:239], v[70:71]
v_pk_mul_f32 v[240:241], v[240:241], v[68:69]
v_pk_mul_f32 v[242:243], v[242:243], v[70:71]
v_max3_f32 v130, v172, v173, v174
v_max_f32_e64 v183, v218, v219
v_max3_f32 v131, v180, v181, v182
v_cvt_pk_bf16_f32 v102, v220, v221
v_cvt_pk_bf16_f32 v103, v222, v223
v_cvt_pk_bf16_f32 v112, v224, v225
v_cvt_pk_bf16_f32 v113, v226, v227
v_cvt_pk_bf16_f32 v104, v228, v229
v_cvt_pk_bf16_f32 v105, v230, v231
v_cvt_pk_bf16_f32 v114, v232, v233
v_cvt_pk_bf16_f32 v115, v234, v235
v_cvt_pk_bf16_f32 v106, v236, v237
v_cvt_pk_bf16_f32 v107, v238, v239
v_cvt_pk_bf16_f32 v116, v240, v241
v_cvt_pk_bf16_f32 v117, v242, v243
v_max_f32 v129, v129, v167
v_max_f32 v130, v130, v175
v_max_f32 v131, v131, v183
s_cmp_lg_u32 s44, 0
s_cbranch_scc1 else_106
s_mov_b32 s63, 0
sent_108:
s_waitcnt vmcnt(0)
v_max_u32 v4, v120, v121
v_max3_u32 v4, v4, v122, v123
v_max3_u32 v4, v4, v100, v101
v_max3_u32 v4, v4, v110, v111
v_cmp_eq_u32 vcc, -1, v4
s_cbranch_vccz sentd_109
buffer_load_dwordx4 v[120:123], v58, s[32:35], 0 offen sc1
buffer_load_dwordx2 v[100:101], v59, s[32:35], 0 offen offset:1024 sc1
buffer_load_dwordx2 v[110:111], v59, s[32:35], 0 offen offset:1536 sc1
s_add_u32 s63, s63, 1
s_cmp_lt_u32 s63, 0x80000
s_cbranch_scc1 sent_108
s_waitcnt vmcnt(0)
sentd_109:
s_branch fi_107
else_106:
s_mov_b32 s63, 0
px_110:
ds_read_b32 v4, v19
ds_read_b128 v[120:123], v53
ds_read_b64 v[100:101], v55 offset:1024
ds_read_b64 v[110:111], v55 offset:1536
s_add_u32 s63, s63, 1
s_cmp_lt_u32 s63, 0x400000
s_waitcnt lgkmcnt(0)
v_cmp_ne_u32 vcc, 3, v4
s_cbranch_vccz pxd_111
s_cbranch_scc1 px_110
pxd_111:
fi_107:
s_cmp_eq_u32 s46, 0
s_cbranch_scc1 slow_112
.p2align 3
v_mfma_f32_16x16x32_bf16 v[160:163], v[120:123], v[156:159], v[44:47]
v_max_f32 v158, v192, v193
v_max_f32 v159, v194, v195
v_permlane32_swap_b32 v130, v131
s_nop 0
v_max_f32 v130, v130, v131
s_nop 2
v_max_f32 v156, v160, v161
v_max_f32 v157, v162, v163
v_max3_f32 v128, v156, v157, v158
v_max_f32 v128, v128, v159
s_nop 1
v_permlane32_swap_b32 v128, v129
s_nop 0
v_max_f32 v128, v128, v129
s_nop 1
v_permlane16_swap_b32 v128, v130
s_nop 0
v_max_f32 v128, v128, v130
v_mov_b32 v130, v128
s_nop 1
v_permlane16_swap_b32 v128, v130
s_nop 0
v_mov_b32 v129, v128
v_mov_b32 v131, v130
s_nop 0
v_permlane32_swap_b32 v128, v129
v_permlane32_swap_b32 v130, v131
v_mul_f32 v128, v128, v124
v_mul_f32 v129, v129, v125
v_pk_fma_f32 v[156:157], v[156:157], v[124:125], v[128:129] op_sel:[0,0,0] op_sel_hi:[1,0,0] neg_lo:[0,0,1] neg_hi:[0,0,1]
v_pk_fma_f32 v[158:159], v[158:159], v[124:125], v[128:129] op_sel:[0,0,0] op_sel_hi:[1,0,0] neg_lo:[0,0,1] neg_hi:[0,0,1]
v_mul_f32 v130, v130, v126
v_mul_f32 v131, v131, v127
v_exp_f32 v156, v156
v_exp_f32 v157, v157
v_exp_f32 v158, v158
v_exp_f32 v159, v159
v_pk_fma_f32 v[164:165], v[164:165], v[124:125], v[128:129] op_sel:[0,1,1] op_sel_hi:[1,1,1] neg_lo:[0,0,1] neg_hi:[0,0,1]
v_pk_fma_f32 v[166:167], v[166:167], v[124:125], v[128:129] op_sel:[0,1,1] op_sel_hi:[1,1,1] neg_lo:[0,0,1] neg_hi:[0,0,1]
v_exp_f32 v164, v164
v_exp_f32 v165, v165
v_exp_f32 v166, v166
v_exp_f32 v167, v167
v_pk_fma_f32 v[172:173], v[172:173], v[126:127], v[130:131] op_sel:[0,0,0] op_sel_hi:[1,0,0] neg_lo:[0,0,1] neg_hi:[0,0,1]
v_pk_fma_f32 v[174:175], v[174:175], v[126:127], v[130:131] op_sel:[0,0,0] op_sel_hi:[1,0,0] neg_lo:[0,0,1] neg_hi:[0,0,1]
v_cvt_pk_bf16_f32 v156, v156, v156
v_cvt_pk_bf16_f32 v157, v157, v157
v_cvt_pk_bf16_f32 v158, v158, v158
v_cvt_pk_bf16_f32 v159, v159, v159
v_exp_f32 v172, v172
v_exp_f32 v173, v173
v_exp_f32 v174, v174
v_exp_f32 v175, v175
v_pk_fma_f32 v[180:181], v[180:181], v[126:127], v[130:131] op_sel:[0,1,1] op_sel_hi:[1,1,1] neg_lo:[0,0,1] neg_hi:[0,0,1]
v_pk_fma_f32 v[182:183], v[182:183], v[126:127], v[130:131] op_sel:[0,1,1] op_sel_hi:[1,1,1] neg_lo:[0,0,1] neg_hi:[0,0,1]
v_and_b32 v156, v52, v156
v_and_b32 v157, v52, v157
v_and_b32 v158, v52, v158
v_and_b32 v159, v52, v159
v_cvt_pk_bf16_f32 v164, v164, v164
v_cvt_pk_bf16_f32 v165, v165, v165
v_mfma_f32_16x16x32_bf16 v[160:163], v[48:51], v[156:159], 0
v_cvt_pk_bf16_f32 v166, v166, v166
v_cvt_pk_bf16_f32 v167, v167, v167
v_mfma_f32_16x16x32_bf16 v[220:223], v[100:103], v[156:159], 0
v_exp_f32 v180, v180
v_mfma_f32_16x16x32_bf16 v[224:227], v[110:113], v[156:159], 0
v_exp_f32 v181, v181
v_exp_f32 v182, v182
v_exp_f32 v183, v183
v_and_b32 v164, v52, v164
v_and_b32 v165, v52, v165
v_and_b32 v166, v52, v166
v_and_b32 v167, v52, v167
v_cvt_pk_bf16_f32 v172, v172, v172
v_cvt_pk_bf16_f32 v173, v173, v173
v_mfma_f32_16x16x32_bf16 v[168:171], v[48:51], v[164:167], 0
v_cvt_pk_bf16_f32 v174, v174, v174
v_cvt_pk_bf16_f32 v175, v175, v175
v_mfma_f32_16x16x32_bf16 v[228:231], v[102:105], v[164:167], 0
v_and_b32 v172, v52, v172
v_and_b32 v173, v52, v173
v_mfma_f32_16x16x32_bf16 v[232:235], v[112:115], v[164:167], 0
v_and_b32 v174, v52, v174
v_and_b32 v175, v52, v175
v_cvt_pk_bf16_f32 v180, v180, v180
v_cvt_pk_bf16_f32 v181, v181, v181
v_mfma_f32_16x16x32_bf16 v[176:179], v[48:51], v[172:175], 0
v_cvt_pk_bf16_f32 v182, v182, v182
v_cvt_pk_bf16_f32 v183, v183, v183
v_mfma_f32_16x16x32_bf16 v[236:239], v[104:107], v[172:175], 0
v_and_b32 v180, v52, v180
v_and_b32 v181, v52, v181
v_mfma_f32_16x16x32_bf16 v[240:243], v[114:117], v[172:175], 0
v_and_b32 v182, v52, v182
v_and_b32 v183, v52, v183
v_rcp_f32 v160, v160
v_rcp_f32 v168, v168
v_pk_mul_f32 v[220:221], v[220:221], v[160:161] op_sel:[0,0] op_sel_hi:[1,0]
v_pk_mul_f32 v[222:223], v[222:223], v[160:161] op_sel:[0,0] op_sel_hi:[1,0]
v_pk_mul_f32 v[228:229], v[228:229], v[168:169] op_sel:[0,0] op_sel_hi:[1,0]
v_pk_mul_f32 v[224:225], v[224:225], v[160:161] op_sel:[0,0] op_sel_hi:[1,0]
v_pk_mul_f32 v[226:227], v[226:227], v[160:161] op_sel:[0,0] op_sel_hi:[1,0]
v_pk_mul_f32 v[230:231], v[230:231], v[168:169] op_sel:[0,0] op_sel_hi:[1,0]
v_pk_mul_f32 v[232:233], v[232:233], v[168:169] op_sel:[0,0] op_sel_hi:[1,0]
v_pk_mul_f32 v[234:235], v[234:235], v[168:169] op_sel:[0,0] op_sel_hi:[1,0]
v_mfma_f32_16x16x32_bf16 v[184:187], v[48:51], v[180:183], 0
v_rcp_f32_e64 v176, v176
v_cvt_pk_bf16_f32 v220, v220, v221
v_cvt_pk_bf16_f32 v221, v222, v223
v_cvt_pk_bf16_f32 v228, v228, v229
v_pk_mul_f32 v[236:237], v[236:237], v[176:177] op_sel:[0,0] op_sel_hi:[1,0]
v_mfma_f32_16x16x32_bf16 v[244:247], v[106:109], v[180:183], 0
v_cvt_pk_bf16_f32 v222, v224, v225
v_cvt_pk_bf16_f32 v223, v226, v227
v_rcp_f32_e64 v184, v184
v_cvt_pk_bf16_f32 v229, v230, v231
v_pk_mul_f32 v[238:239], v[238:239], v[176:177] op_sel:[0,0] op_sel_hi:[1,0]
v_pk_mul_f32 v[240:241], v[240:241], v[176:177] op_sel:[0,0] op_sel_hi:[1,0]
v_pk_mul_f32 v[242:243], v[242:243], v[176:177] op_sel:[0,0] op_sel_hi:[1,0]
v_cvt_pk_bf16_f32 v236, v236, v237
v_pk_mul_f32 v[244:245], v[244:245], v[184:185] op_sel:[0,0] op_sel_hi:[1,0]
v_pk_mul_f32 v[246:247], v[246:247], v[184:185] op_sel:[0,0] op_sel_hi:[1,0]
v_mfma_f32_16x16x32_bf16 v[248:251], v[116:119], v[180:183], 0
buffer_store_dwordx4 v[220:223], v18, s[32:35], s80 offen
v_cvt_pk_bf16_f32 v230, v232, v233
v_cvt_pk_bf16_f32 v231, v234, v235
v_cvt_pk_bf16_f32 v237, v238, v239
v_cvt_pk_bf16_f32 v244, v244, v245
buffer_store_dwordx4 v[228:231], v18, s[32:35], s81 offen
v_cvt_pk_bf16_f32 v238, v240, v241
v_cvt_pk_bf16_f32 v239, v242, v243
v_pk_mul_f32 v[248:249], v[248:249], v[184:185] op_sel:[0,0] op_sel_hi:[1,0]
v_pk_mul_f32 v[250:251], v[250:251], v[184:185] op_sel:[0,0] op_sel_hi:[1,0]
v_cvt_pk_bf16_f32 v245, v246, v247
buffer_store_dwordx4 v[236:239], v18, s[32:35], s82 offen
v_cvt_pk_bf16_f32 v246, v248, v249
v_cvt_pk_bf16_f32 v247, v250, v251
buffer_store_dwordx4 v[244:247], v18, s[32:35], s83 offen
back_113:
s_barrier
v_and_b32 v36, 31, v0
v_lshlrev_b32 v36, 2, v36
s_lshl_b32 s62, s45, 2
v_mov_b32 v4, s62
v_mov_b32 v5, 3
s_mov_b64 exec, 1
s_waitcnt vmcnt(0)
s_cmp_eq_u32 s46, 0
s_cbranch_scc1 slow_114
buffer_store_dword v5, v4, s[32:35], s84 offen
back_115:
s_mov_b64 exec, -1
v_lshrrev_b32 v4, 2, v2
v_and_b32 v5, 3, v0
v_lshl_add_u32 v6, v3, 3, v4
v_lshlrev_b32 v6, 7, v6
v_lshl_add_u32 v6, v5, 3, v6
v_lshrrev_b32 v7, 1, v4
v_and_b32 v8, 1, v3
v_lshl_add_u32 v7, v8, 1, v7
v_lshl_add_u32 v10, v7, 5, v6
v_xor_b32 v11, 32, v10
v_xor_b32 v12, 64, v10
v_xor_b32 v13, 96, v10
v_add_u32 v14, 0x10000, v10
v_add_u32 v15, 0x10000, v11
v_add_u32 v16, 0x10000, v12
v_add_u32 v17, 0x10000, v13
ds_read_b64_tr_b16 v[220:221], v10 offset:0
ds_read_b64_tr_b16 v[222:223], v10 offset:512
ds_read_b64_tr_b16 v[224:225], v11 offset:0
ds_read_b64_tr_b16 v[226:227], v11 offset:512
ds_read_b64_tr_b16 v[228:229], v12 offset:0
ds_read_b64_tr_b16 v[230:231], v12 offset:512
ds_read_b64_tr_b16 v[232:233], v13 offset:0
ds_read_b64_tr_b16 v[234:235], v13 offset:512
ds_read_b64_tr_b16 v[236:237], v10 offset:4096
ds_read_b64_tr_b16 v[238:239], v10 offset:4608
ds_read_b64_tr_b16 v[240:241], v11 offset:4096
ds_read_b64_tr_b16 v[242:243], v11 offset:4608
ds_read_b64_tr_b16 v[244:245], v12 offset:4096
ds_read_b64_tr_b16 v[246:247], v12 offset:4608
ds_read_b64_tr_b16 v[248:249], v13 offset:4096
ds_read_b64_tr_b16 v[250:251], v13 offset:4608
s_lshl_b32 s48, s41, 3
s_lshl_b32 s49, s40, 1
s_add_u32 s48, s48, s49
s_lshl_b32 s48, s48, 15
s_add_u32 s48, s48, 4194304
v_add_u32 v38, s48, v18
v_add_u32 v39, 32768, v38
s_lshl_b32 s57, s75, 11
s_add_u32 s87, s87, 262144
v_lshlrev_b32 v60, 16, v20
v_and_b32 v61, 0xffff0000, v20
v_lshlrev_b32 v62, 16, v21
v_and_b32 v63, 0xffff0000, v21
v_lshlrev_b32 v64, 16, v22
v_and_b32 v65, 0xffff0000, v22
v_lshlrev_b32 v66, 16, v23
v_and_b32 v67, 0xffff0000, v23
v_lshlrev_b32 v68, 16, v24
v_and_b32 v69, 0xffff0000, v24
v_lshlrev_b32 v70, 16, v25
v_and_b32 v71, 0xffff0000, v25
v_lshlrev_b32 v72, 16, v26
v_and_b32 v73, 0xffff0000, v26
v_lshlrev_b32 v74, 16, v27
v_and_b32 v75, 0xffff0000, v27
v_lshlrev_b32 v76, 16, v28
v_and_b32 v77, 0xffff0000, v28
v_lshlrev_b32 v78, 16, v29
v_and_b32 v79, 0xffff0000, v29
v_lshlrev_b32 v80, 16, v30
v_and_b32 v81, 0xffff0000, v30
v_lshlrev_b32 v82, 16, v31
v_and_b32 v83, 0xffff0000, v31
v_lshlrev_b32 v84, 16, v32
v_and_b32 v85, 0xffff0000, v32
v_lshlrev_b32 v86, 16, v33
v_and_b32 v87, 0xffff0000, v33
v_lshlrev_b32 v88, 16, v34
v_and_b32 v89, 0xffff0000, v34
v_lshlrev_b32 v90, 16, v35
v_and_b32 v91, 0xffff0000, v35
v_mov_b32 v6, 0
v_mov_b32 v7, 0
v_mov_b32 v8, 0
v_mov_b32 v9, 0
s_lshl_b32 s62, s42, 2
v_mov_b32 v4, s62
v_mov_b32 v5, 3
buffer_load_dword v37, v36, s[32:35], s84 offen sc1
s_mov_b32 s63, 0
s_waitcnt vmcnt(0)
poll_116:
v_cmp_gt_u32 vcc, 3, v37
s_cbranch_vccz polled_117
buffer_load_dword v37, v36, s[32:35], s84 offen sc1
s_add_u32 s63, s63, 1
s_cmp_lt_u32 s63, 0x80000
s_waitcnt vmcnt(0)
s_cbranch_scc1 poll_116
polled_117:
s_call_b64 s[94:95], R_oloop
s_cmp_eq_u32 s46, 0
s_cbranch_scc1 slow_118
s_nop 0
v_cvt_pk_bf16_f32 v20, v60, v61
v_cvt_pk_bf16_f32 v21, v62, v63
v_cvt_pk_bf16_f32 v22, v64, v65
v_cvt_pk_bf16_f32 v23, v66, v67
buffer_store_dwordx4 v[20:23], v18, s[32:35], s85 offen offset:0
v_cvt_pk_bf16_f32 v24, v68, v69
v_cvt_pk_bf16_f32 v25, v70, v71
v_cvt_pk_bf16_f32 v26, v72, v73
v_cvt_pk_bf16_f32 v27, v74, v75
buffer_store_dwordx4 v[24:27], v18, s[32:35], s85 offen offset:1024
v_cvt_pk_bf16_f32 v28, v76, v77
v_cvt_pk_bf16_f32 v29, v78, v79
v_cvt_pk_bf16_f32 v30, v80, v81
v_cvt_pk_bf16_f32 v31, v82, v83
buffer_store_dwordx4 v[28:31], v18, s[32:35], s86 offen offset:0
v_cvt_pk_bf16_f32 v32, v84, v85
v_cvt_pk_bf16_f32 v33, v86, v87
v_cvt_pk_bf16_f32 v34, v88, v89
v_cvt_pk_bf16_f32 v35, v90, v91
buffer_store_dwordx4 v[32:35], v18, s[32:35], s86 offen offset:1024
s_barrier
v_dot2c_f32_bf16 v6, v20, v48
v_dot2c_f32_bf16 v8, v20, v20
v_dot2c_f32_bf16 v7, v28, v48
v_dot2c_f32_bf16 v9, v28, v28
v_dot2c_f32_bf16 v6, v21, v48
v_dot2c_f32_bf16 v8, v21, v21
v_dot2c_f32_bf16 v7, v29, v48
v_dot2c_f32_bf16 v9, v29, v29
v_dot2c_f32_bf16 v6, v22, v48
v_dot2c_f32_bf16 v8, v22, v22
v_dot2c_f32_bf16 v7, v30, v48
v_dot2c_f32_bf16 v9, v30, v30
v_dot2c_f32_bf16 v6, v23, v48
v_dot2c_f32_bf16 v8, v23, v23
v_dot2c_f32_bf16 v7, v31, v48
v_dot2c_f32_bf16 v9, v31, v31
v_dot2c_f32_bf16 v6, v24, v48
v_dot2c_f32_bf16 v8, v24, v24
v_dot2c_f32_bf16 v7, v32, v48
v_dot2c_f32_bf16 v9, v32, v32
v_dot2c_f32_bf16 v6, v25, v48
v_dot2c_f32_bf16 v8, v25, v25
v_dot2c_f32_bf16 v7, v33, v48
v_dot2c_f32_bf16 v9, v33, v33
v_dot2c_f32_bf16 v6, v26, v48
v_dot2c_f32_bf16 v8, v26, v26
v_dot2c_f32_bf16 v7, v34, v48
v_dot2c_f32_bf16 v9, v34, v34
v_dot2c_f32_bf16 v6, v27, v48
v_dot2c_f32_bf16 v8, v27, v27
v_dot2c_f32_bf16 v7, v35, v48
v_dot2c_f32_bf16 v9, v35, v35
s_mov_b64 exec, 1
s_waitcnt vmcnt(0)
buffer_store_dword v5, v4, s[32:35], s88 offen
s_mov_b64 exec, -1
s_nop 1
v_permlane32_swap_b32 v6, v7
v_permlane32_swap_b32 v8, v9
v_add_f32 v6, v6, v7
v_add_f32 v8, v8, v9
s_nop 1
v_permlane16_swap_b32 v6, v8
s_nop 0
v_add_f32 v6, v6, v8
buffer_store_dword v6, v1, s[32:35], s87 offen
back_119:
s_lshl_b32 s49, s44, 13
v_add_u32 v10, s49, v18
v_add_u32 v11, 1024, v10
s_lshl_b32 s48, s43, 1
v_lshrrev_b32 v4, 2, v2
v_and_b32 v5, 3, v0
v_lshl_add_u32 v6, v3, 3, v4
v_lshlrev_b32 v6, 7, v6
v_lshl_add_u32 v6, v5, 3, v6
v_lshrrev_b32 v7, 1, v4
v_and_b32 v8, 1, v3
v_lshl_add_u32 v7, v8, 1, v7
v_xor_b32 v7, s48, v7
v_lshl_add_u32 v12, v7, 5, v6
v_add_u32 v12, 16384, v12
v_xor_b32 v13, 32, v12
v_mov_b32 v14, v10
v_mov_b32 v15, v11
v_add_u32 v16, 122880, v12
v_add_u32 v17, 122880, v13
v_mov_b32 v156, 0
v_mov_b32 v157, 0
v_mov_b32 v158, 0
v_mov_b32 v159, 0
v_mov_b32 v160, 0
v_mov_b32 v161, 0
v_mov_b32 v162, 0
v_mov_b32 v163, 0
v_mov_b32 v164, 0
v_mov_b32 v165, 0
v_mov_b32 v166, 0
v_mov_b32 v167, 0
v_mov_b32 v168, 0
v_mov_b32 v169, 0
v_mov_b32 v170, 0
v_mov_b32 v171, 0
v_mov_b32 v172, 0
v_mov_b32 v173, 0
v_mov_b32 v174, 0
v_mov_b32 v175, 0
v_mov_b32 v176, 0
v_mov_b32 v177, 0
v_mov_b32 v178, 0
v_mov_b32 v179, 0
v_mov_b32 v180, 0
v_mov_b32 v181, 0
v_mov_b32 v182, 0
v_mov_b32 v183, 0
v_mov_b32 v184, 0
v_mov_b32 v185, 0
v_mov_b32 v186, 0
v_mov_b32 v187, 0
v_mov_b32 v188, 0
v_mov_b32 v189, 0
v_mov_b32 v190, 0
v_mov_b32 v191, 0
v_mov_b32 v192, 0
v_mov_b32 v193, 0
v_mov_b32 v194, 0
v_mov_b32 v195, 0
v_mov_b32 v196, 0
v_mov_b32 v197, 0
v_mov_b32 v198, 0
v_mov_b32 v199, 0
v_mov_b32 v200, 0
v_mov_b32 v201, 0
v_mov_b32 v202, 0
v_mov_b32 v203, 0
v_mov_b32 v204, 0
v_mov_b32 v205, 0
v_mov_b32 v206, 0
v_mov_b32 v207, 0
v_mov_b32 v208, 0
v_mov_b32 v209, 0
v_mov_b32 v210, 0
v_mov_b32 v211, 0
v_mov_b32 v212, 0
v_mov_b32 v213, 0
v_mov_b32 v214, 0
v_mov_b32 v215, 0
v_mov_b32 v216, 0
v_mov_b32 v217, 0
v_mov_b32 v218, 0
v_mov_b32 v219, 0
v_mov_b32 v220, 0
v_mov_b32 v221, 0
v_mov_b32 v222, 0
v_mov_b32 v223, 0
v_mov_b32 v224, 0
v_mov_b32 v225, 0
v_mov_b32 v226, 0
v_mov_b32 v227, 0
v_mov_b32 v228, 0
v_mov_b32 v229, 0
v_mov_b32 v230, 0
v_mov_b32 v231, 0
v_mov_b32 v232, 0
v_mov_b32 v233, 0
v_mov_b32 v234, 0
v_mov_b32 v235, 0
v_mov_b32 v236, 0
v_mov_b32 v237, 0
v_mov_b32 v238, 0
v_mov_b32 v239, 0
v_mov_b32 v240, 0
v_mov_b32 v241, 0
v_mov_b32 v242, 0
v_mov_b32 v243, 0
v_mov_b32 v244, 0
v_mov_b32 v245, 0
v_mov_b32 v246, 0
v_mov_b32 v247, 0
v_mov_b32 v248, 0
v_mov_b32 v249, 0
v_mov_b32 v250, 0
v_mov_b32 v251, 0
v_lshrrev_b32 v6, 2, v2
v_cmp_eq_u32 vcc, v6, v3
v_and_b32 v7, 1, v0
v_lshlrev_b32 v7, 4, v7
v_mov_b32 v8, 0x3f80
v_lshlrev_b32 v9, v7, v8
v_cndmask_b32 v7, 0, v9, vcc
v_and_b32 v6, 2, v0
v_cmp_eq_u32 vcc, 0, v6
v_mov_b32 v36, 0
v_mov_b32 v37, 0
v_mov_b32 v40, 0
v_mov_b32 v41, 0
v_cndmask_b32 v38, 0, v7, vcc
v_cndmask_b32 v39, v7, 0, vcc
v_lshrrev_b32 v8, 1, v2
v_cmp_eq_u32 vcc, 0, v8
s_nop 1
v_cndmask_b32 v44, 0, v9, vcc
v_cmp_eq_u32 vcc, 1, v8
s_nop 1
v_cndmask_b32 v45, 0, v9, vcc
v_cmp_eq_u32 vcc, 2, v8
s_nop 1
v_cndmask_b32 v46, 0, v9, vcc
v_cmp_eq_u32 vcc, 3, v8
s_nop 1
v_cndmask_b32 v47, 0, v9, vcc
v_lshrrev_b32 v4, 2, v2
v_lshl_add_u32 v4, v3, 2, v4
v_lshlrev_b32 v4, 6, v4
v_and_b32 v5, 3, v0
v_lshl_add_u32 v4, v5, 3, v4
s_lshl_b32 s48, s43, 11
s_add_u32 s48, s48, 135168
v_add_u32 v53, s48, v4
s_mul_i32 s48, s40, 3072
s_add_u32 s48, s48, 139264
v_add_u32 v42, s48, v18
s_xor_b32 s49, s40, 2
s_mul_i32 s48, s49, 3072
s_add_u32 s48, s48, 139264
v_add_u32 v43, s48, v18
s_lshl_b32 s49, s49, 2
s_add_u32 s49, s49, 134672
v_mov_b32 v19, s49
v_xor_b32 v52, 8, v19
v_lshrrev_b32 v4, 3, v0
v_and_b32 v5, 7, v0
v_lshlrev_b32 v4, 11, v4
v_lshl_add_u32 v55, v5, 4, v4
v_lshlrev_b32 v4, 6, v2
v_lshl_add_u32 v58, v3, 4, v4
v_lshlrev_b32 v4, 4, v2
v_lshl_add_u32 v59, v3, 3, v4
s_mul_i32 s51, s42, 163840
s_add_u32 s51, s51, 9437184
s_lshl_b32 s50, s43, 1
s_add_u32 s50, s50, s44
s_lshl_b32 s48, s50, 15
s_add_u32 s48, s48, s51
s_add_u32 s48, s48, 0
s_lshl_b32 s49, s41, 7
s_add_u32 s53, s48, s49
s_add_u32 s54, s53, 16384
s_lshl_b32 s56, s50, 10
s_add_u32 s56, s56, s51
s_add_u32 s56, s56, 151552
s_xor_b32 s57, s56, 1024
s_lshl_b32 s58, s50, 11
s_add_u32 s58, s58, s51
s_add_u32 s58, s58, 139264
s_xor_b32 s59, s58, 2048
s_add_u32 s79, s58, s49
s_lshl_b32 s50, s41, 11
s_add_u32 s55, s48, s50
s_lshl_b32 s48, s43, 7
s_add_u32 s48, s48, 133888
v_lshl_add_u32 v7, v3, 4, s48
v_lshl_add_u32 v54, v2, 2, s48
s_lshl_b32 s49, s44, 6
v_add_u32 v8, s49, v2
v_lshlrev_b32 v8, 3, v8
v_add_u32 v8, 131072, v8
v_lshl_add_u32 v9, v3, 2, s49
v_lshlrev_b32 v9, 2, v9
v_add_u32 v9, 132096, v9
s_mov_b32 s64, 0
s_mov_b32 s65, 0
s_mov_b32 s66, 0x3fb8aa3b
s_mov_b32 s61, 4
ds_read_b64_tr_b16 v[84:85], v16 offset:8192
ds_read_b64_tr_b16 v[86:87], v16 offset:8704
ds_read_b64_tr_b16 v[88:89], v17 offset:8192
ds_read_b64_tr_b16 v[90:91], v17 offset:8704
ds_read_b64_tr_b16 v[92:93], v16 offset:16384
ds_read_b64_tr_b16 v[94:95], v16 offset:16896
ds_read_b64_tr_b16 v[96:97], v17 offset:16384
ds_read_b64_tr_b16 v[98:99], v17 offset:16896
ds_read_b64_tr_b16 v[76:77], v16 offset:0
ds_read_b64_tr_b16 v[78:79], v16 offset:512
ds_read_b64_tr_b16 v[80:81], v17 offset:0
ds_read_b64_tr_b16 v[82:83], v17 offset:512
s_barrier
ds_read_b128 v[60:63], v14 offset:0
ds_read_b128 v[64:67], v14 offset:2048
ds_read_b128 v[68:71], v14 offset:4096
ds_read_b128 v[72:75], v14 offset:6144
s_waitcnt lgkmcnt(0)
c3_loop:
v_mfma_f32_16x16x32_bf16 v[212:215], v[84:87], v[72:75], v[212:215]
ds_read_b128 v[100:103], v15 offset:0
v_mfma_f32_16x16x32_bf16 v[204:207], v[84:87], v[68:71], v[204:207]
ds_read_b128 v[104:107], v15 offset:2048
v_mfma_f32_16x16x32_bf16 v[196:199], v[84:87], v[64:67], v[196:199]
ds_read_b128 v[108:111], v15 offset:4096
v_mfma_f32_16x16x32_bf16 v[188:191], v[84:87], v[60:63], v[188:191]
ds_read_b128 v[112:115], v15 offset:6144
v_mfma_f32_16x16x32_bf16 v[192:195], v[88:91], v[60:63], v[192:195]
ds_read_b64_tr_b16 v[124:125], v16 offset:12288
v_mfma_f32_16x16x32_bf16 v[200:203], v[88:91], v[64:67], v[200:203]
ds_read_b64_tr_b16 v[126:127], v16 offset:12800
v_mfma_f32_16x16x32_bf16 v[208:211], v[88:91], v[68:71], v[208:211]
ds_read_b64_tr_b16 v[128:129], v17 offset:12288
v_mfma_f32_16x16x32_bf16 v[216:219], v[88:91], v[72:75], v[216:219]
ds_read_b64_tr_b16 v[130:131], v17 offset:12800
v_mfma_f32_16x16x32_bf16 v[244:247], v[72:75], v[92:95], v[244:247]
ds_read_b64_tr_b16 v[132:133], v16 offset:20480
v_mfma_f32_16x16x32_bf16 v[248:251], v[72:75], v[96:99], v[248:251]
ds_read_b64_tr_b16 v[134:135], v16 offset:20992
v_mfma_f32_16x16x32_bf16 v[240:243], v[68:71], v[96:99], v[240:243]
ds_read_b64_tr_b16 v[136:137], v17 offset:20480
v_mfma_f32_16x16x32_bf16 v[236:239], v[68:71], v[92:95], v[236:239]
ds_read_b64_tr_b16 v[138:139], v17 offset:20992
v_mfma_f32_16x16x32_bf16 v[228:231], v[64:67], v[92:95], v[228:231]
ds_read_b64_tr_b16 v[116:117], v16 offset:4096
v_mfma_f32_16x16x32_bf16 v[232:235], v[64:67], v[96:99], v[232:235]
ds_read_b64_tr_b16 v[118:119], v16 offset:4608
v_mfma_f32_16x16x32_bf16 v[224:227], v[60:63], v[96:99], v[224:227]
ds_read_b64_tr_b16 v[120:121], v17 offset:4096
v_mfma_f32_16x16x32_bf16 v[220:223], v[60:63], v[92:95], v[220:223]
ds_read_b64_tr_b16 v[122:123], v17 offset:4608
v_mfma_f32_16x16x32_bf16 v[156:159], v[76:79], v[60:63], v[156:159]
s_add_u32 s65, s65, 40960
s_cmp_eq_u32 s65, 122880
v_mfma_f32_16x16x32_bf16 v[164:167], v[76:79], v[64:67], v[164:167]
s_cselect_b32 s65, 0, s65
s_add_u32 s64, s64, 1
v_mfma_f32_16x16x32_bf16 v[172:175], v[76:79], v[68:71], v[172:175]
v_add_u32 v14, s65, v10
v_add_u32 v15, s65, v11
v_mfma_f32_16x16x32_bf16 v[180:183], v[76:79], v[72:75], v[180:183]
v_add_u32 v16, s65, v12
v_add_u32 v17, s65, v13
v_mfma_f32_16x16x32_bf16 v[184:187], v[80:83], v[72:75], v[184:187]
v_mfma_f32_16x16x32_bf16 v[176:179], v[80:83], v[68:71], v[176:179]
s_cmp_eq_u32 s64, 16
s_cbranch_scc1 c3_last
v_mfma_f32_16x16x32_bf16 v[168:171], v[80:83], v[64:67], v[168:171]
s_waitcnt lgkmcnt(0)
v_mfma_f32_16x16x32_bf16 v[160:163], v[80:83], v[60:63], v[160:163]
s_barrier
v_mfma_f32_16x16x32_bf16 v[212:215], v[124:127], v[112:115], v[212:215]
ds_read_b128 v[60:63], v14 offset:0
v_mfma_f32_16x16x32_bf16 v[204:207], v[124:127], v[108:111], v[204:207]
ds_read_b128 v[64:67], v14 offset:2048
v_mfma_f32_16x16x32_bf16 v[196:199], v[124:127], v[104:107], v[196:199]
ds_read_b128 v[68:71], v14 offset:4096
v_mfma_f32_16x16x32_bf16 v[188:191], v[124:127], v[100:103], v[188:191]
ds_read_b128 v[72:75], v14 offset:6144
v_mfma_f32_16x16x32_bf16 v[192:195], v[128:131], v[100:103], v[192:195]
ds_read_b64_tr_b16 v[84:85], v16 offset:8192
v_mfma_f32_16x16x32_bf16 v[200:203], v[128:131], v[104:107], v[200:203]
ds_read_b64_tr_b16 v[86:87], v16 offset:8704
v_mfma_f32_16x16x32_bf16 v[208:211], v[128:131], v[108:111], v[208:211]
ds_read_b64_tr_b16 v[88:89], v17 offset:8192
v_mfma_f32_16x16x32_bf16 v[216:219], v[128:131], v[112:115], v[216:219]
ds_read_b64_tr_b16 v[90:91], v17 offset:8704
v_mfma_f32_16x16x32_bf16 v[244:247], v[112:115], v[132:135], v[244:247]
ds_read_b64_tr_b16 v[92:93], v16 offset:16384
v_mfma_f32_16x16x32_bf16 v[248:251], v[112:115], v[136:139], v[248:251]
ds_read_b64_tr_b16 v[94:95], v16 offset:16896
v_mfma_f32_16x16x32_bf16 v[240:243], v[108:111], v[136:139], v[240:243]
ds_read_b64_tr_b16 v[96:97], v17 offset:16384
v_mfma_f32_16x16x32_bf16 v[236:239], v[108:111], v[132:135], v[236:239]
ds_read_b64_tr_b16 v[98:99], v17 offset:16896
v_mfma_f32_16x16x32_bf16 v[228:231], v[104:107], v[132:135], v[228:231]
ds_read_b64_tr_b16 v[76:77], v16 offset:0
v_mfma_f32_16x16x32_bf16 v[232:235], v[104:107], v[136:139], v[232:235]
ds_read_b64_tr_b16 v[78:79], v16 offset:512
v_mfma_f32_16x16x32_bf16 v[224:227], v[100:103], v[136:139], v[224:227]
ds_read_b64_tr_b16 v[80:81], v17 offset:0
v_mfma_f32_16x16x32_bf16 v[220:223], v[100:103], v[132:135], v[220:223]
ds_read_b64_tr_b16 v[82:83], v17 offset:512
v_mfma_f32_16x16x32_bf16 v[156:159], v[116:119], v[100:103], v[156:159]
v_mfma_f32_16x16x32_bf16 v[164:167], v[116:119], v[104:107], v[164:167]
v_mfma_f32_16x16x32_bf16 v[172:175], v[116:119], v[108:111], v[172:175]
v_mfma_f32_16x16x32_bf16 v[180:183], v[116:119], v[112:115], v[180:183]
v_mfma_f32_16x16x32_bf16 v[184:187], v[120:123], v[112:115], v[184:187]
v_mfma_f32_16x16x32_bf16 v[176:179], v[120:123], v[108:111], v[176:179]
v_mfma_f32_16x16x32_bf16 v[168:171], v[120:123], v[104:107], v[168:171]
s_waitcnt lgkmcnt(0)
v_mfma_f32_16x16x32_bf16 v[160:163], v[120:123], v[100:103], v[160:163]
s_branch c3_loop
c3_last:
v_mfma_f32_16x16x32_bf16 v[168:171], v[80:83], v[64:67], v[168:171]
s_waitcnt lgkmcnt(0)
v_mfma_f32_16x16x32_bf16 v[160:163], v[80:83], v[60:63], v[160:163]
v_mfma_f32_16x16x32_bf16 v[212:215], v[124:127], v[112:115], v[212:215]
ds_read_b64_tr_b16 v[10:11], v53 offset:0
ds_read_b64_tr_b16 v[12:13], v53 offset:1024
v_mfma_f32_16x16x32_bf16 v[204:207], v[124:127], v[108:111], v[204:207]
ds_read_b64_tr_b16 v[14:15], v53 offset:32
ds_read_b64_tr_b16 v[16:17], v53 offset:1056
v_mfma_f32_16x16x32_bf16 v[196:199], v[124:127], v[104:107], v[196:199]
ds_read_b128 v[140:143], v7 offset:0
s_mul_i32 s48, s44, 0x80008000
v_mfma_f32_16x16x32_bf16 v[188:191], v[124:127], v[100:103], v[188:191]
ds_read_b128 v[144:147], v7 offset:64
v_mfma_f32_16x16x32_bf16 v[192:195], v[128:131], v[100:103], v[192:195]
ds_read_b128 v[148:151], v7 offset:256
v_mfma_f32_16x16x32_bf16 v[200:203], v[128:131], v[104:107], v[200:203]
ds_read_b128 v[152:155], v7 offset:320
v_mfma_f32_16x16x32_bf16 v[208:211], v[128:131], v[108:111], v[208:211]
ds_read2_b32 v[56:57], v54 offset0:128 offset1:144
s_waitcnt lgkmcnt(5)
v_mfma_f32_16x16x32_bf16 v[216:219], v[128:131], v[112:115], v[216:219]
s_barrier
v_mfma_f32_16x16x32_bf16 v[244:247], v[112:115], v[132:135], v[244:247]
ds_read_b64 v[92:93], v8 offset:0
v_xor_b32 v10, s48, v10
v_mfma_f32_16x16x32_bf16 v[248:251], v[112:115], v[136:139], v[248:251]
ds_read_b64 v[94:95], v8 offset:128
v_xor_b32 v11, s48, v11
v_mfma_f32_16x16x32_bf16 v[240:243], v[108:111], v[136:139], v[240:243]
ds_read_b64 v[96:97], v8 offset:256
v_xor_b32 v12, s48, v12
v_mfma_f32_16x16x32_bf16 v[236:239], v[108:111], v[132:135], v[236:239]
ds_read_b64 v[98:99], v8 offset:384
v_xor_b32 v13, s48, v13
v_mfma_f32_16x16x32_bf16 v[228:231], v[104:107], v[132:135], v[228:231]
ds_read_b128 v[60:63], v9 offset:0
v_xor_b32 v14, s48, v14
v_mfma_f32_16x16x32_bf16 v[232:235], v[104:107], v[136:139], v[232:235]
ds_read_b128 v[64:67], v9 offset:64
v_xor_b32 v15, s48, v15
v_mfma_f32_16x16x32_bf16 v[224:227], v[100:103], v[136:139], v[224:227]
ds_read_b128 v[68:71], v9 offset:128
v_xor_b32 v16, s48, v16
v_mfma_f32_16x16x32_bf16 v[220:223], v[100:103], v[132:135], v[220:223]
ds_read_b128 v[72:75], v9 offset:192
v_xor_b32 v17, s48, v17
v_mfma_f32_16x16x32_bf16 v[156:159], v[116:119], v[100:103], v[156:159]
ds_read_b128 v[76:79], v9 offset:512
v_mfma_f32_16x16x32_bf16 v[164:167], v[116:119], v[104:107], v[164:167]
ds_read_b128 v[80:83], v9 offset:576
v_mfma_f32_16x16x32_bf16 v[172:175], v[116:119], v[108:111], v[172:175]
ds_read_b128 v[84:87], v9 offset:640
v_mfma_f32_16x16x32_bf16 v[180:183], v[116:119], v[112:115], v[180:183]
ds_read_b128 v[88:91], v9 offset:704
v_mfma_f32_16x16x32_bf16 v[184:187], v[120:123], v[112:115], v[184:187]
v_mfma_f32_16x16x32_bf16 v[176:179], v[120:123], v[108:111], v[176:179]
v_mfma_f32_16x16x32_bf16 v[168:171], v[120:123], v[104:107], v[168:171]
v_mfma_f32_16x16x32_bf16 v[160:163], v[120:123], v[100:103], v[160:163]
c3_epi:
s_waitcnt lgkmcnt(0)
.p2align 3
v_mul_f32 v129, s66, v94
v_mul_f32 v128, s66, v92
v_mul_f32 v131, s66, v98
v_mul_f32 v130, s66, v96
v_pk_fma_f32 v[190:191], v[150:151], v[92:93], v[190:191] op_sel:[0,1,0] op_sel_hi:[1,1,1]
v_pk_fma_f32 v[212:213], v[148:149], v[98:99], v[212:213] op_sel:[0,1,0] op_sel_hi:[1,1,1]
v_pk_fma_f32 v[214:215], v[150:151], v[98:99], v[214:215] op_sel:[0,1,0] op_sel_hi:[1,1,1]
v_pk_fma_f32 v[188:189], v[148:149], v[92:93], v[188:189] op_sel:[0,1,0] op_sel_hi:[1,1,1]
v_pk_fma_f32 v[218:219], v[154:155], v[98:99], v[218:219] op_sel:[0,1,0] op_sel_hi:[1,1,1]
v_cvt_pk_bf16_f32 v188, v188, v189
v_cvt_pk_bf16_f32 v189, v190, v191
v_pk_fma_f32 v[196:197], v[148:149], v[94:95], v[196:197] op_sel:[0,1,0] op_sel_hi:[1,1,1]
v_pk_fma_f32 v[200:201], v[152:153], v[94:95], v[200:201] op_sel:[0,1,0] op_sel_hi:[1,1,1]
v_pk_fma_f32 v[210:211], v[154:155], v[96:97], v[210:211] op_sel:[0,1,0] op_sel_hi:[1,1,1]
v_pk_fma_f32 v[240:241], v[84:85], v[56:57], v[240:241] op_sel:[0,1,0] op_sel_hi:[1,1,1]
v_pk_fma_f32 v[228:229], v[80:81], v[56:57], v[228:229] op_sel:[0,0,0] op_sel_hi:[1,0,1]
v_pk_fma_f32 v[226:227], v[78:79], v[56:57], v[226:227] op_sel:[0,1,0] op_sel_hi:[1,1,1]
v_pk_fma_f32 v[192:193], v[152:153], v[92:93], v[192:193] op_sel:[0,1,0] op_sel_hi:[1,1,1]
v_cvt_pk_bf16_f32 v190, v192, v193
v_pk_fma_f32 v[238:239], v[86:87], v[56:57], v[238:239] op_sel:[0,0,0] op_sel_hi:[1,0,1]
v_pk_fma_f32 v[234:235], v[82:83], v[56:57], v[234:235] op_sel:[0,1,0] op_sel_hi:[1,1,1]
v_pk_mul_f32 v[226:227], v[226:227], v[62:63]
v_pk_fma_f32 v[204:205], v[148:149], v[96:97], v[204:205] op_sel:[0,1,0] op_sel_hi:[1,1,1]
v_cvt_pk_bf16_f32 v204, v204, v205
v_pk_fma_f32 v[202:203], v[154:155], v[94:95], v[202:203] op_sel:[0,1,0] op_sel_hi:[1,1,1]
v_pk_fma_f32 v[224:225], v[76:77], v[56:57], v[224:225] op_sel:[0,1,0] op_sel_hi:[1,1,1]
v_pk_fma_f32 v[216:217], v[152:153], v[98:99], v[216:217] op_sel:[0,1,0] op_sel_hi:[1,1,1]
v_pk_fma_f32 v[244:245], v[88:89], v[56:57], v[244:245] op_sel:[0,0,0] op_sel_hi:[1,0,1]
v_pk_mul_f32 v[238:239], v[238:239], v[70:71]
v_pk_mul_f32 v[228:229], v[228:229], v[64:65]
v_pk_fma_f32 v[236:237], v[84:85], v[56:57], v[236:237] op_sel:[0,0,0] op_sel_hi:[1,0,1]
v_pk_fma_f32 v[220:221], v[76:77], v[56:57], v[220:221] op_sel:[0,0,0] op_sel_hi:[1,0,1]
v_pk_mul_f32 v[224:225], v[224:225], v[60:61]
v_cvt_pk_bf16_f32 v212, v212, v213
v_cvt_pk_bf16_f32 v213, v214, v215
v_cvt_pk_bf16_f32 v196, v196, v197
v_pk_mul_f32 v[240:241], v[240:241], v[68:69]
v_pk_fma_f32 v[198:199], v[150:151], v[94:95], v[198:199] op_sel:[0,1,0] op_sel_hi:[1,1,1]
v_cvt_pk_bf16_f32 v197, v198, v199
v_cvt_pk_bf16_f32 v198, v200, v201
v_cvt_pk_bf16_f32 v199, v202, v203
v_cvt_pk_bf16_f32 v215, v218, v219
v_pk_fma_f32 v[208:209], v[152:153], v[96:97], v[208:209] op_sel:[0,1,0] op_sel_hi:[1,1,1]
v_pk_fma_f32 v[246:247], v[90:91], v[56:57], v[246:247] op_sel:[0,0,0] op_sel_hi:[1,0,1]
v_pk_fma_f32 v[250:251], v[90:91], v[56:57], v[250:251] op_sel:[0,1,0] op_sel_hi:[1,1,1]
v_pk_mul_f32 v[250:251], v[250:251], v[74:75]
v_pk_fma_f32 v[206:207], v[150:151], v[96:97], v[206:207] op_sel:[0,1,0] op_sel_hi:[1,1,1]
v_cvt_pk_bf16_f32 v205, v206, v207
v_pk_fma_f32 v[242:243], v[86:87], v[56:57], v[242:243] op_sel:[0,1,0] op_sel_hi:[1,1,1]
v_cvt_pk_bf16_f32 v207, v210, v211
v_pk_mul_f32 v[236:237], v[236:237], v[68:69]
v_pk_fma_f32 v[230:231], v[82:83], v[56:57], v[230:231] op_sel:[0,0,0] op_sel_hi:[1,0,1]
v_pk_fma_f32 v[194:195], v[154:155], v[92:93], v[194:195] op_sel:[0,1,0] op_sel_hi:[1,1,1]
v_cvt_pk_bf16_f32 v191, v194, v195
v_pk_fma_f32 v[232:233], v[80:81], v[56:57], v[232:233] op_sel:[0,1,0] op_sel_hi:[1,1,1]
v_pk_mul_f32 v[232:233], v[232:233], v[64:65]
v_pk_mul_f32 v[230:231], v[230:231], v[66:67]
v_pk_fma_f32 v[248:249], v[88:89], v[56:57], v[248:249] op_sel:[0,1,0] op_sel_hi:[1,1,1]
v_pk_mul_f32 v[248:249], v[248:249], v[72:73]
v_pk_mul_f32 v[242:243], v[242:243], v[70:71]
v_mfma_f32_16x16x32_bf16 v[68:71], v[10:13], v[196:199], 0
v_cvt_pk_bf16_f32 v206, v208, v209
v_cvt_pk_bf16_f32 v214, v216, v217
v_cvt_pk_bf16_f32 v121, v226, v227
v_mfma_f32_16x16x32_bf16 v[80:83], v[14:17], v[204:207], 0
v_cvt_pk_bf16_f32 v120, v224, v225
v_cvt_pk_bf16_f32 v114, v228, v229
v_mfma_f32_16x16x32_bf16 v[84:87], v[10:13], v[212:215], 0
v_cvt_pk_bf16_f32 v116, v236, v237
v_min3_f32 v105, v68, v69, v70
v_mfma_f32_16x16x32_bf16 v[88:91], v[14:17], v[212:215], 0
v_max3_f32 v101, v68, v69, v70
v_cvt_pk_bf16_f32 v115, v230, v231
v_cvt_pk_bf16_f32 v122, v232, v233
v_cvt_pk_bf16_f32 v127, v250, v251
v_cvt_pk_bf16_f32 v124, v240, v241
v_pk_mul_f32 v[244:245], v[244:245], v[72:73]
v_pk_fma_f32 v[222:223], v[78:79], v[56:57], v[222:223] op_sel:[0,0,0] op_sel_hi:[1,0,1]
v_pk_mul_f32 v[222:223], v[222:223], v[62:63]
v_mfma_f32_16x16x32_bf16 v[76:79], v[10:13], v[204:207], 0
v_min3_f32 v107, v84, v85, v86
v_min3_f32 v107, v107, v87, v88
v_min3_f32 v107, v107, v89, v90
v_min_f32_e64 v107, v107, v91
v_max3_f32 v103, v84, v85, v86
v_pk_mul_f32 v[220:221], v[220:221], v[60:61]
v_mfma_f32_16x16x32_bf16 v[60:63], v[10:13], v[188:191], 0
v_max3_f32 v103, v103, v87, v88
v_min3_f32 v106, v76, v77, v78
v_min3_f32 v106, v106, v79, v80
v_min3_f32 v106, v106, v81, v82
v_min_f32 v106, v106, v83
v_pk_mul_f32 v[234:235], v[234:235], v[66:67]
v_mfma_f32_16x16x32_bf16 v[64:67], v[14:17], v[188:191], 0
v_permlane32_swap_b32 v106, v107
v_min3_f32 v104, v60, v61, v62
v_min_f32 v106, v106, v107
v_max3_f32 v103, v103, v89, v90
v_pk_mul_f32 v[246:247], v[246:247], v[74:75]
v_mfma_f32_16x16x32_bf16 v[72:75], v[14:17], v[196:199], 0
v_max_f32 v103, v103, v91
v_max3_f32 v102, v76, v77, v78
v_min3_f32 v104, v104, v63, v64
v_min3_f32 v104, v104, v65, v66
v_min_f32 v104, v104, v67
v_max3_f32 v102, v102, v79, v80
v_max3_f32 v102, v102, v81, v82
v_max_f32 v102, v102, v83
v_min3_f32 v105, v105, v71, v72
v_min3_f32 v105, v105, v73, v74
v_min_f32 v105, v105, v75
v_max3_f32 v101, v101, v71, v72
v_max3_f32 v101, v101, v73, v74
v_permlane32_swap_b32 v104, v105
v_permlane32_swap_b32 v102, v103
v_min_f32 v104, v104, v105
v_max_f32 v102, v102, v103
v_max_f32 v101, v101, v75
v_permlane16_swap_b32 v104, v106
v_max3_f32 v100, v60, v61, v62
v_min_f32 v104, v104, v106
v_mov_b32 v106, v104
v_max3_f32 v100, v100, v63, v64
v_max3_f32 v100, v100, v65, v66
v_max_f32 v100, v100, v67
v_permlane16_swap_b32 v104, v106
v_cvt_pk_bf16_f32 v112, v220, v221
v_permlane32_swap_b32 v100, v101
v_mov_b32 v105, v104
v_max_f32 v100, v100, v101
v_mov_b32 v107, v106
v_permlane32_swap_b32 v104, v105
v_permlane16_swap_b32 v100, v102
v_pk_mul_f32 v[104:105], v[104:105], v[128:129]
v_pk_fma_f32 v[226:227], v[66:67], v[128:129], v[104:105] op_sel:[0,0,0] op_sel_hi:[1,0,0] neg_lo:[1,0,0] neg_hi:[1,0,0]
v_pk_fma_f32 v[230:231], v[70:71], v[128:129], v[104:105] op_sel:[0,1,1] op_sel_hi:[1,1,1] neg_lo:[1,0,0] neg_hi:[1,0,0]
v_exp_f32 v226, v226
v_pk_fma_f32 v[224:225], v[64:65], v[128:129], v[104:105] op_sel:[0,0,0] op_sel_hi:[1,0,0] neg_lo:[1,0,0] neg_hi:[1,0,0]
v_exp_f32 v224, v224
v_pk_fma_f32 v[228:229], v[68:69], v[128:129], v[104:105] op_sel:[0,1,1] op_sel_hi:[1,1,1] neg_lo:[1,0,0] neg_hi:[1,0,0]
v_exp_f32 v231, v231
v_cvt_pk_bf16_f32 v113, v222, v223
v_pk_fma_f32 v[222:223], v[62:63], v[128:129], v[104:105] op_sel:[0,0,0] op_sel_hi:[1,0,0] neg_lo:[1,0,0] neg_hi:[1,0,0]
v_exp_f32 v222, v222
v_pk_fma_f32 v[220:221], v[60:61], v[128:129], v[104:105] op_sel:[0,0,0] op_sel_hi:[1,0,0] neg_lo:[1,0,0] neg_hi:[1,0,0]
v_exp_f32 v221, v221
v_exp_f32 v220, v220
v_max_f32 v100, v100, v102
v_exp_f32 v223, v223
v_mov_b32 v102, v100
v_pk_add_f32 v[110:111], v[220:221], v[222:223]
v_exp_f32 v225, v225
v_pk_fma_f32 v[232:233], v[72:73], v[128:129], v[104:105] op_sel:[0,1,1] op_sel_hi:[1,1,1] neg_lo:[1,0,0] neg_hi:[1,0,0]
v_exp_f32 v232, v232
v_exp_f32 v233, v233
v_pk_add_f32 v[110:111], v[110:111], v[224:225]
v_exp_f32 v229, v229
v_exp_f32 v228, v228
v_exp_f32 v227, v227
v_cvt_pk_bf16_f32 v123, v234, v235
v_pk_fma_f32 v[234:235], v[74:75], v[128:129], v[104:105] op_sel:[0,1,1] op_sel_hi:[1,1,1] neg_lo:[1,0,0] neg_hi:[1,0,0]
v_pk_add_f32 v[110:111], v[110:111], v[226:227]
v_add_f32 v104, v110, v111
v_cvt_pk_bf16_f32 v118, v244, v245
v_permlane32_swap_b32 v106, v107
v_permlane16_swap_b32 v100, v102
v_exp_f32 v234, v234
v_mov_b32 v101, v100
v_exp_f32 v235, v235
v_exp_f32_e64 v230, v230
v_cvt_pk_bf16_f32 v125, v242, v243
v_pk_add_f32 v[110:111], v[228:229], v[230:231]
v_pk_add_f32 v[110:111], v[110:111], v[232:233]
v_pk_add_f32 v[110:111], v[110:111], v[234:235]
v_cvt_pk_bf16_f32 v126, v248, v249
v_pk_mul_f32 v[106:107], v[106:107], v[130:131]
v_pk_fma_f32 v[236:237], v[76:77], v[130:131], v[106:107] op_sel:[0,0,0] op_sel_hi:[1,0,0] neg_lo:[1,0,0] neg_hi:[1,0,0]
v_exp_f32 v237, v237
v_exp_f32 v236, v236
v_pk_fma_f32 v[242:243], v[82:83], v[130:131], v[106:107] op_sel:[0,0,0] op_sel_hi:[1,0,0] neg_lo:[1,0,0] neg_hi:[1,0,0]
v_pk_fma_f32 v[250:251], v[90:91], v[130:131], v[106:107] op_sel:[0,1,1] op_sel_hi:[1,1,1] neg_lo:[1,0,0] neg_hi:[1,0,0]
v_add_f32 v105, v110, v111
v_exp_f32 v243, v243
v_cvt_pk_bf16_f32 v119, v246, v247
v_pk_fma_f32 v[246:247], v[86:87], v[130:131], v[106:107] op_sel:[0,1,1] op_sel_hi:[1,1,1] neg_lo:[1,0,0] neg_hi:[1,0,0]
v_exp_f32 v246, v246
v_cvt_pk_bf16_f32 v117, v238, v239
v_pk_fma_f32 v[238:239], v[78:79], v[130:131], v[106:107] op_sel:[0,0,0] op_sel_hi:[1,0,0] neg_lo:[1,0,0] neg_hi:[1,0,0]
v_exp_f32 v238, v238
v_exp_f32 v247, v247
v_pk_fma_f32 v[240:241], v[80:81], v[130:131], v[106:107] op_sel:[0,0,0] op_sel_hi:[1,0,0] neg_lo:[1,0,0] neg_hi:[1,0,0]
v_exp_f32 v240, v240
v_exp_f32 v241, v241
v_permlane32_swap_b32 v100, v101
v_exp_f32 v242, v242
v_pk_fma_f32 v[244:245], v[84:85], v[130:131], v[106:107] op_sel:[0,1,1] op_sel_hi:[1,1,1] neg_lo:[1,0,0] neg_hi:[1,0,0]
v_exp_f32 v244, v244
v_exp_f32_e64 v239, v239
v_pk_mul_f32 v[100:101], v[100:101], v[128:129]
v_pk_fma_f32 v[62:63], v[62:63], v[128:129], v[100:101] op_sel:[0,0,0] op_sel_hi:[1,0,0] neg_lo:[0,0,1] neg_hi:[0,0,1]
v_pk_add_f32 v[110:111], v[236:237], v[238:239]
v_pk_add_f32 v[110:111], v[110:111], v[240:241]
v_pk_add_f32 v[110:111], v[110:111], v[242:243]
v_pk_fma_f32 v[72:73], v[72:73], v[128:129], v[100:101] op_sel:[0,1,1] op_sel_hi:[1,1,1] neg_lo:[0,0,1] neg_hi:[0,0,1]
v_pk_fma_f32 v[66:67], v[66:67], v[128:129], v[100:101] op_sel:[0,0,0] op_sel_hi:[1,0,0] neg_lo:[0,0,1] neg_hi:[0,0,1]
v_exp_f32 v62, v62
v_pk_fma_f32 v[60:61], v[60:61], v[128:129], v[100:101] op_sel:[0,0,0] op_sel_hi:[1,0,0] neg_lo:[0,0,1] neg_hi:[0,0,1]
v_exp_f32 v60, v60
v_exp_f32 v245, v245
v_exp_f32 v73, v73
v_pk_fma_f32 v[248:249], v[88:89], v[130:131], v[106:107] op_sel:[0,1,1] op_sel_hi:[1,1,1] neg_lo:[1,0,0] neg_hi:[1,0,0]
v_add_f32 v106, v110, v111
v_exp_f32 v249, v249
v_pk_add_f32 v[110:111], v[244:245], v[246:247]
v_exp_f32 v248, v248
v_pk_fma_f32 v[64:65], v[64:65], v[128:129], v[100:101] op_sel:[0,0,0] op_sel_hi:[1,0,0] neg_lo:[0,0,1] neg_hi:[0,0,1]
v_exp_f32 v64, v64
v_pk_add_f32 v[110:111], v[110:111], v[248:249]
v_exp_f32 v65, v65
v_exp_f32 v61, v61
v_exp_f32 v66, v66
v_exp_f32 v251, v251
v_exp_f32 v63, v63
v_pk_fma_f32 v[74:75], v[74:75], v[128:129], v[100:101] op_sel:[0,1,1] op_sel_hi:[1,1,1] neg_lo:[0,0,1] neg_hi:[0,0,1]
v_pk_add_f32 v[108:109], v[60:61], v[62:63]
v_exp_f32 v67, v67
v_exp_f32 v250, v250
v_pk_fma_f32 v[68:69], v[68:69], v[128:129], v[100:101] op_sel:[0,1,1] op_sel_hi:[1,1,1] neg_lo:[0,0,1] neg_hi:[0,0,1]
v_pk_add_f32 v[110:111], v[110:111], v[250:251]
v_exp_f32 v68, v68
v_exp_f32 v69, v69
v_add_f32 v107, v110, v111
v_mov_b32 v103, v102
v_pk_fma_f32 v[70:71], v[70:71], v[128:129], v[100:101] op_sel:[0,1,1] op_sel_hi:[1,1,1] neg_lo:[0,0,1] neg_hi:[0,0,1]
v_exp_f32 v71, v71
v_exp_f32 v70, v70
v_permlane32_swap_b32 v106, v107
v_permlane32_swap_b32 v102, v103
v_pk_add_f32 v[108:109], v[108:109], v[64:65]
v_pk_add_f32 v[108:109], v[108:109], v[66:67]
v_add_f32 v100, v108, v109
v_pk_add_f32 v[108:109], v[68:69], v[70:71]
v_pk_mul_f32 v[102:103], v[102:103], v[130:131]
v_pk_fma_f32 v[78:79], v[78:79], v[130:131], v[102:103] op_sel:[0,0,0] op_sel_hi:[1,0,0] neg_lo:[0,0,1] neg_hi:[0,0,1]
v_exp_f32 v79, v79
v_exp_f32 v78, v78
v_exp_f32 v74, v74
v_exp_f32 v72, v72
v_pk_fma_f32 v[86:87], v[86:87], v[130:131], v[102:103] op_sel:[0,1,1] op_sel_hi:[1,1,1] neg_lo:[0,0,1] neg_hi:[0,0,1]
v_exp_f32 v87, v87
v_pk_fma_f32 v[76:77], v[76:77], v[130:131], v[102:103] op_sel:[0,0,0] op_sel_hi:[1,0,0] neg_lo:[0,0,1] neg_hi:[0,0,1]
v_exp_f32 v77, v77
v_add_f32 v106, v106, v107
v_pk_fma_f32 v[80:81], v[80:81], v[130:131], v[102:103] op_sel:[0,0,0] op_sel_hi:[1,0,0] neg_lo:[0,0,1] neg_hi:[0,0,1]
v_exp_f32 v81, v81
v_exp_f32 v80, v80
v_pk_add_f32 v[108:109], v[108:109], v[72:73]
v_permlane32_swap_b32 v104, v105
v_exp_f32 v75, v75
v_add_f32 v104, v104, v105
v_pk_fma_f32 v[82:83], v[82:83], v[130:131], v[102:103] op_sel:[0,0,0] op_sel_hi:[1,0,0] neg_lo:[0,0,1] neg_hi:[0,0,1]
v_exp_f32 v82, v82
v_exp_f32 v83, v83
v_permlane16_swap_b32 v104, v106
v_pk_add_f32 v[108:109], v[108:109], v[74:75]
v_add_f32 v101, v108, v109
v_exp_f32 v76, v76
v_add_f32 v104, v104, v106
v_rcp_f32 v104, v104
v_pk_fma_f32 v[84:85], v[84:85], v[130:131], v[102:103] op_sel:[0,1,1] op_sel_hi:[1,1,1] neg_lo:[0,0,1] neg_hi:[0,0,1]
v_exp_f32 v84, v84
v_exp_f32 v85, v85
v_mov_b32 v106, v104
v_pk_add_f32 v[108:109], v[76:77], v[78:79]
v_pk_add_f32 v[108:109], v[108:109], v[80:81]
v_pk_add_f32 v[108:109], v[108:109], v[82:83]
v_pk_fma_f32 v[88:89], v[88:89], v[130:131], v[102:103] op_sel:[0,1,1] op_sel_hi:[1,1,1] neg_lo:[0,0,1] neg_hi:[0,0,1]
v_exp_f32 v88, v88
v_exp_f32 v89, v89
v_exp_f32 v86, v86
v_pk_fma_f32 v[90:91], v[90:91], v[130:131], v[102:103] op_sel:[0,1,1] op_sel_hi:[1,1,1] neg_lo:[0,0,1] neg_hi:[0,0,1]
v_add_f32 v102, v108, v109
v_pk_add_f32 v[108:109], v[84:85], v[86:87]
v_pk_add_f32 v[108:109], v[108:109], v[88:89]
v_permlane16_swap_b32 v104, v106
v_exp_f32 v90, v90
v_exp_f32 v91, v91
v_permlane32_swap_b32 v100, v101
v_pk_add_f32 v[108:109], v[108:109], v[90:91]
v_add_f32 v103, v108, v109
v_add_f32 v100, v100, v101
v_mov_b32 v105, v104
v_permlane32_swap_b32 v102, v103
v_mov_b32 v107, v106
v_add_f32 v102, v102, v103
v_permlane32_swap_b32 v104, v105
v_permlane32_swap_b32 v106, v107
v_permlane16_swap_b32 v100, v102
v_pk_mul_f32 v[222:223], v[222:223], v[104:105] op_sel:[0,0] op_sel_hi:[1,0]
v_pk_mul_f32 v[226:227], v[226:227], v[104:105] op_sel:[0,0] op_sel_hi:[1,0]
v_pk_mul_f32 v[234:235], v[234:235], v[104:105] op_sel:[0,1] op_sel_hi:[1,1]
v_pk_mul_f32 v[232:233], v[232:233], v[104:105] op_sel:[0,1] op_sel_hi:[1,1]
v_pk_mul_f32 v[230:231], v[230:231], v[104:105] op_sel:[0,1] op_sel_hi:[1,1]
v_add_f32 v100, v100, v102
v_pk_mul_f32 v[228:229], v[228:229], v[104:105] op_sel:[0,1] op_sel_hi:[1,1]
v_cvt_pk_bf16_f32 v228, v228, v229
v_cvt_pk_bf16_f32 v229, v230, v231
v_cvt_pk_bf16_f32 v231, v234, v235
v_cvt_pk_bf16_f32 v230, v232, v233
v_pk_mul_f32 v[220:221], v[220:221], v[104:105] op_sel:[0,0] op_sel_hi:[1,0]
v_cvt_pk_bf16_f32 v220, v220, v221
v_pk_mul_f32 v[224:225], v[224:225], v[104:105] op_sel:[0,0] op_sel_hi:[1,0]
v_pk_mul_f32 v[236:237], v[236:237], v[106:107] op_sel:[0,0] op_sel_hi:[1,0]
v_pk_mul_f32 v[238:239], v[238:239], v[106:107] op_sel:[0,0] op_sel_hi:[1,0]
v_pk_mul_f32 v[240:241], v[240:241], v[106:107] op_sel:[0,0] op_sel_hi:[1,0]
v_pk_mul_f32 v[242:243], v[242:243], v[106:107] op_sel:[0,0] op_sel_hi:[1,0]
v_pk_mul_f32 v[248:249], v[248:249], v[106:107] op_sel:[0,1] op_sel_hi:[1,1]
v_rcp_f32 v100, v100
v_pk_mul_f32 v[244:245], v[244:245], v[106:107] op_sel:[0,1] op_sel_hi:[1,1]
v_mov_b32 v102, v100
v_pk_mul_f32 v[250:251], v[250:251], v[106:107] op_sel:[0,1] op_sel_hi:[1,1]
v_cvt_pk_bf16_f32 v221, v222, v223
v_pk_mul_f32 v[246:247], v[246:247], v[106:107] op_sel:[0,1] op_sel_hi:[1,1]
v_cvt_pk_bf16_f32 v222, v224, v225
v_mfma_f32_16x16x32_bf16 v[200:203], v[228:231], v[36:39], 0
v_cvt_pk_bf16_f32 v223, v226, v227
v_permlane16_swap_b32 v100, v102
v_mfma_f32_16x16x32_bf16 v[196:199], v[228:231], v[38:41], 0
v_mov_b32 v101, v100
v_cvt_pk_bf16_f32 v244, v244, v245
v_mfma_f32_16x16x32_bf16 v[212:215], v[220:223], v[38:41], 0
v_cvt_pk_bf16_f32 v245, v246, v247
v_cvt_pk_bf16_f32 v247, v250, v251
v_mfma_f32_16x16x32_bf16 v[216:219], v[220:223], v[36:39], 0
v_cvt_pk_bf16_f32 v234, v200, v201
v_cvt_pk_bf16_f32 v246, v248, v249
v_cvt_pk_bf16_f32 v226, v196, v197
v_cvt_pk_bf16_f32 v227, v198, v199
v_mfma_f32_16x16x32_bf16 v[196:199], v[244:247], v[38:41], 0
v_cvt_pk_bf16_f32 v225, v214, v215
v_cvt_pk_bf16_f32 v236, v236, v237
v_cvt_pk_bf16_f32 v237, v238, v239
v_cvt_pk_bf16_f32 v232, v216, v217
v_cvt_pk_bf16_f32 v233, v218, v219
v_cvt_pk_bf16_f32 v239, v242, v243
v_cvt_pk_bf16_f32 v238, v240, v241
v_cvt_pk_bf16_f32 v224, v212, v213
v_permlane32_swap_b32 v100, v101
v_mfma_f32_16x16x32_bf16 v[216:219], v[236:239], v[36:39], 0
v_mov_b32 v103, v102
v_cvt_pk_bf16_f32 v235, v202, v203
v_mfma_f32_16x16x32_bf16 v[212:215], v[236:239], v[38:41], 0
v_cvt_pk_bf16_f32 v243, v198, v199
v_permlane32_swap_b32 v102, v103
v_mfma_f32_16x16x32_bf16 v[200:203], v[244:247], v[36:39], 0
v_cvt_pk_bf16_f32 v242, v196, v197
v_mov_b32 v5, s61
v_mfma_f32_16x16x32_bf16 v[220:223], v[232:235], v[120:123], 0
v_cvt_pk_bf16_f32 v249, v218, v219
v_cvt_pk_bf16_f32 v248, v216, v217
v_cvt_pk_bf16_f32 v241, v214, v215
v_cvt_pk_bf16_f32 v240, v212, v213
v_cmp_eq_u32 s[50:51], s41, v2
v_pk_mul_f32 v[64:65], v[64:65], v[100:101] op_sel:[0,0] op_sel_hi:[1,0]
v_pk_mul_f32 v[74:75], v[74:75], v[100:101] op_sel:[0,1] op_sel_hi:[1,1]
v_pk_mul_f32 v[68:69], v[68:69], v[100:101] op_sel:[0,1] op_sel_hi:[1,1]
v_pk_mul_f32 v[72:73], v[72:73], v[100:101] op_sel:[0,1] op_sel_hi:[1,1]
v_pk_mul_f32 v[60:61], v[60:61], v[100:101] op_sel:[0,0] op_sel_hi:[1,0]
v_pk_mul_f32 v[62:63], v[62:63], v[100:101] op_sel:[0,0] op_sel_hi:[1,0]
v_pk_mul_f32 v[66:67], v[66:67], v[100:101] op_sel:[0,0] op_sel_hi:[1,0]
v_pk_mul_f32 v[76:77], v[76:77], v[102:103] op_sel:[0,0] op_sel_hi:[1,0]
v_pk_mul_f32 v[70:71], v[70:71], v[100:101] op_sel:[0,1] op_sel_hi:[1,1]
v_cvt_pk_bf16_f32 v60, v60, v61
v_pk_mul_f32 v[80:81], v[80:81], v[102:103] op_sel:[0,0] op_sel_hi:[1,0]
v_pk_mul_f32 v[78:79], v[78:79], v[102:103] op_sel:[0,0] op_sel_hi:[1,0]
v_pk_mul_f32 v[82:83], v[82:83], v[102:103] op_sel:[0,0] op_sel_hi:[1,0]
v_pk_mul_f32 v[86:87], v[86:87], v[102:103] op_sel:[0,1] op_sel_hi:[1,1]
v_cvt_pk_bf16_f32 v61, v62, v63
v_pk_mul_f32 v[84:85], v[84:85], v[102:103] op_sel:[0,1] op_sel_hi:[1,1]
v_cvt_pk_bf16_f32 v62, v64, v65
v_pk_mul_f32 v[88:89], v[88:89], v[102:103] op_sel:[0,1] op_sel_hi:[1,1]
v_cvt_pk_bf16_f32 v63, v66, v67
v_pk_mul_f32 v[90:91], v[90:91], v[102:103] op_sel:[0,1] op_sel_hi:[1,1]
v_cvt_pk_bf16_f32 v68, v68, v69
v_mfma_f32_16x16x32_bf16 v[208:211], v[60:63], v[36:39], 0
v_cvt_pk_bf16_f32 v69, v70, v71
v_cvt_pk_bf16_f32 v70, v72, v73
v_mfma_f32_16x16x32_bf16 v[204:207], v[60:63], v[38:41], 0
v_cvt_pk_bf16_f32 v71, v74, v75
v_cvt_pk_bf16_f32 v76, v76, v77
v_mfma_f32_16x16x32_bf16 v[60:63], v[232:235], v[112:115], 0
v_cvt_pk_bf16_f32 v250, v200, v201
v_cvt_pk_bf16_f32 v77, v78, v79
v_mfma_f32_16x16x32_bf16 v[192:195], v[68:71], v[36:39], 0
v_cvt_pk_bf16_f32 v78, v80, v81
v_cvt_pk_bf16_f32 v79, v82, v83
v_mfma_f32_16x16x32_bf16 v[188:191], v[68:71], v[38:41], 0
v_cvt_pk_bf16_f32 v65, v206, v207
v_cvt_pk_bf16_f32 v64, v204, v205
v_mfma_f32_16x16x32_bf16 v[68:71], v[224:227], v[120:123], 0
v_cvt_pk_bf16_f32 v251, v202, v203
v_cvt_pk_bf16_f32 v72, v208, v209
v_mfma_f32_16x16x32_bf16 v[152:155], v[224:227], v[112:115], 0
v_cvt_pk_bf16_f32 v73, v210, v211
v_cvt_pk_bf16_f32 v84, v84, v85
v_mfma_f32_16x16x32_bf16 v[60:63], v[248:251], v[116:119], v[60:63]
v_cvt_pk_bf16_f32 v85, v86, v87
v_cvt_pk_bf16_f32 v86, v88, v89
v_mfma_f32_16x16x32_bf16 v[228:231], v[224:227], v[48:51], 0
v_cvt_pk_bf16_f32 v67, v190, v191
v_cvt_pk_bf16_f32 v87, v90, v91
v_mfma_f32_16x16x32_bf16 v[220:223], v[248:251], v[124:127], v[220:223]
v_cvt_pk_bf16_f32 v66, v188, v189
v_cvt_pk_bf16_f32 v74, v192, v193
v_mfma_f32_16x16x32_bf16 v[152:155], v[240:243], v[116:119], v[152:155]
v_cvt_pk_bf16_f32 v75, v194, v195
v_mfma_f32_16x16x32_bf16 v[204:207], v[76:79], v[38:41], 0
v_mfma_f32_16x16x32_bf16 v[208:211], v[76:79], v[36:39], 0
v_mfma_f32_16x16x32_bf16 v[228:231], v[240:243], v[48:51], v[228:231]
v_mfma_f32_16x16x32_bf16 v[68:71], v[240:243], v[124:127], v[68:71]
v_mfma_f32_16x16x32_bf16 v[76:79], v[232:235], v[48:51], 0
s_nop 1
v_cvt_pk_bf16_f32 v152, v152, v153
v_mfma_f32_16x16x32_bf16 v[76:79], v[248:251], v[48:51], v[76:79]
v_cvt_pk_bf16_f32 v153, v154, v155
v_cvt_pk_bf16_f32 v154, v60, v61
v_mfma_f32_16x16x32_bf16 v[192:195], v[84:87], v[36:39], 0
v_cvt_pk_bf16_f32 v68, v68, v69
v_cvt_pk_bf16_f32 v155, v62, v63
v_mfma_f32_16x16x32_bf16 v[188:191], v[84:87], v[38:41], 0
ds_write_b128 v42, v[152:155] offset:0
v_mfma_f32_16x16x32_bf16 v[136:139], v[64:67], v[48:51], 0
v_cvt_pk_bf16_f32 v69, v70, v71
v_cvt_pk_bf16_f32 v228, v228, v229
v_mfma_f32_16x16x32_bf16 v[104:107], v[72:75], v[112:115], 0
v_cvt_pk_bf16_f32 v71, v222, v223
v_cvt_pk_bf16_f32 v229, v230, v231
v_mfma_f32_16x16x32_bf16 v[148:151], v[72:75], v[48:51], 0
v_cvt_pk_bf16_f32 v230, v76, v77
v_cvt_pk_bf16_f32 v70, v220, v221
v_mfma_f32_16x16x32_bf16 v[132:135], v[72:75], v[120:123], 0
ds_write_b128 v42, v[68:71] offset:1024
v_mfma_f32_16x16x32_bf16 v[108:111], v[64:67], v[120:123], 0
v_cvt_pk_bf16_f32 v231, v78, v79
ds_write_b128 v42, v[228:231] offset:2048
v_mfma_f32_16x16x32_bf16 v[100:103], v[64:67], v[112:115], 0
ds_write_b32 v52, v5
v_cvt_pk_bf16_f32 v88, v208, v209
v_cvt_pk_bf16_f32 v83, v190, v191
v_cvt_pk_bf16_f32 v91, v194, v195
v_cvt_pk_bf16_f32 v82, v188, v189
v_cvt_pk_bf16_f32 v80, v204, v205
v_cvt_pk_bf16_f32 v89, v210, v211
v_cvt_pk_bf16_f32 v81, v206, v207
v_cvt_pk_bf16_f32 v90, v192, v193
s_nop 0
v_mfma_f32_16x16x32_bf16 v[100:103], v[80:83], v[116:119], v[100:103]
v_mfma_f32_16x16x32_bf16 v[108:111], v[80:83], v[124:127], v[108:111]
v_mfma_f32_16x16x32_bf16 v[132:135], v[88:91], v[124:127], v[132:135]
v_mfma_f32_16x16x32_bf16 v[148:151], v[88:91], v[48:51], v[148:151]
v_mfma_f32_16x16x32_bf16 v[136:139], v[80:83], v[48:51], v[136:139]
v_mfma_f32_16x16x32_bf16 v[104:107], v[88:91], v[116:119], v[104:107]
s_mov_b32 s63, 0
px_120:
ds_read_b32 v4, v19
ds_read_b128 v[188:191], v43 offset:0
ds_read_b128 v[192:195], v43 offset:1024
ds_read_b128 v[196:199], v43 offset:2048
s_add_u32 s63, s63, 1
s_cmp_lt_u32 s63, 0x400000
s_waitcnt lgkmcnt(0)
v_cmp_ne_u32 vcc, s61, v4
s_cbranch_vccz pxd_121
s_cbranch_scc1 px_120
pxd_121:
v_mfma_f32_16x16x32_bf16 v[100:103], v[38:41], v[188:191], v[100:103]
v_mfma_f32_16x16x32_bf16 v[104:107], v[36:39], v[188:191], v[104:107]
v_mfma_f32_16x16x32_bf16 v[108:111], v[38:41], v[192:195], v[108:111]
v_mfma_f32_16x16x32_bf16 v[132:135], v[36:39], v[192:195], v[132:135]
v_mfma_f32_16x16x32_bf16 v[136:139], v[38:41], v[196:199], v[136:139]
v_mfma_f32_16x16x32_bf16 v[148:151], v[36:39], v[196:199], v[148:151]
s_nop 2
v_cvt_pk_bf16_f32 v100, v100, v101
v_cvt_pk_bf16_f32 v101, v102, v103
v_cvt_pk_bf16_f32 v102, v104, v105
v_cvt_pk_bf16_f32 v103, v106, v107
buffer_store_dwordx4 v[100:103], v55, s[32:35], s53 offen sc1
v_cvt_pk_bf16_f32 v108, v108, v109
v_cvt_pk_bf16_f32 v109, v110, v111
v_cvt_pk_bf16_f32 v110, v132, v133
v_cvt_pk_bf16_f32 v111, v134, v135
buffer_store_dwordx4 v[108:111], v55, s[32:35], s54 offen sc1
v_cvt_pk_bf16_f32 v136, v136, v137
v_cvt_pk_bf16_f32 v137, v138, v139
v_cvt_pk_bf16_f32 v138, v148, v149
v_cvt_pk_bf16_f32 v139, v150, v151
s_mov_b64 exec, s[50:51]
buffer_store_dwordx4 v[136:139], v58, s[32:35], s56 offen sc1
s_mov_b64 exec, -1
s_mov_b32 s51, 0
.p2align 3
v_pk_fma_f32 v[156:157], v[140:141], v[92:93], v[156:157] op_sel:[0,1,0] op_sel_hi:[1,1,1]
v_pk_fma_f32 v[164:165], v[140:141], v[94:95], v[164:165] op_sel:[0,1,0] op_sel_hi:[1,1,1]
v_pk_fma_f32 v[172:173], v[140:141], v[96:97], v[172:173] op_sel:[0,1,0] op_sel_hi:[1,1,1]
v_pk_fma_f32 v[180:181], v[140:141], v[98:99], v[180:181] op_sel:[0,1,0] op_sel_hi:[1,1,1]
v_pk_fma_f32 v[158:159], v[142:143], v[92:93], v[158:159] op_sel:[0,1,0] op_sel_hi:[1,1,1]
v_cvt_pk_bf16_f32 v156, v156, v157
v_pk_fma_f32 v[166:167], v[142:143], v[94:95], v[166:167] op_sel:[0,1,0] op_sel_hi:[1,1,1]
v_cvt_pk_bf16_f32 v164, v164, v165
v_pk_fma_f32 v[174:175], v[142:143], v[96:97], v[174:175] op_sel:[0,1,0] op_sel_hi:[1,1,1]
v_cvt_pk_bf16_f32 v172, v172, v173
v_pk_fma_f32 v[182:183], v[142:143], v[98:99], v[182:183] op_sel:[0,1,0] op_sel_hi:[1,1,1]
v_cvt_pk_bf16_f32 v180, v180, v181
v_pk_fma_f32 v[160:161], v[144:145], v[92:93], v[160:161] op_sel:[0,1,0] op_sel_hi:[1,1,1]
v_pk_fma_f32 v[162:163], v[146:147], v[92:93], v[162:163] op_sel:[0,1,0] op_sel_hi:[1,1,1]
v_cvt_pk_bf16_f32 v157, v158, v159
v_pk_fma_f32 v[168:169], v[144:145], v[94:95], v[168:169] op_sel:[0,1,0] op_sel_hi:[1,1,1]
v_pk_fma_f32 v[170:171], v[146:147], v[94:95], v[170:171] op_sel:[0,1,0] op_sel_hi:[1,1,1]
v_cvt_pk_bf16_f32 v165, v166, v167
v_pk_fma_f32 v[176:177], v[144:145], v[96:97], v[176:177] op_sel:[0,1,0] op_sel_hi:[1,1,1]
v_pk_fma_f32 v[178:179], v[146:147], v[96:97], v[178:179] op_sel:[0,1,0] op_sel_hi:[1,1,1]
v_cvt_pk_bf16_f32 v173, v174, v175
v_pk_fma_f32 v[184:185], v[144:145], v[98:99], v[184:185] op_sel:[0,1,0] op_sel_hi:[1,1,1]
v_pk_fma_f32 v[186:187], v[146:147], v[98:99], v[186:187] op_sel:[0,1,0] op_sel_hi:[1,1,1]
v_cvt_pk_bf16_f32 v181, v182, v183
v_cvt_pk_bf16_f32 v158, v160, v161
v_cvt_pk_bf16_f32 v159, v162, v163
v_cvt_pk_bf16_f32 v166, v168, v169
v_cvt_pk_bf16_f32 v167, v170, v171
v_mfma_f32_16x16x32_bf16 v[60:63], v[10:13], v[156:159], 0
v_cvt_pk_bf16_f32 v174, v176, v177
v_cvt_pk_bf16_f32 v175, v178, v179
v_mfma_f32_16x16x32_bf16 v[68:71], v[10:13], v[164:167], 0
v_cvt_pk_bf16_f32 v182, v184, v185
v_cvt_pk_bf16_f32 v183, v186, v187
v_mfma_f32_16x16x32_bf16 v[76:79], v[10:13], v[172:175], 0
s_nop 0
v_mfma_f32_16x16x32_bf16 v[84:87], v[10:13], v[180:183], 0
v_min3_f32 v104, v60, v61, v62
v_max3_f32 v100, v60, v61, v62
v_mfma_f32_16x16x32_bf16 v[64:67], v[14:17], v[156:159], 0
v_min3_f32 v105, v68, v69, v70
v_max3_f32 v101, v68, v69, v70
v_mfma_f32_16x16x32_bf16 v[72:75], v[14:17], v[164:167], 0
v_min3_f32 v106, v76, v77, v78
v_max3_f32 v102, v76, v77, v78
v_mfma_f32_16x16x32_bf16 v[80:83], v[14:17], v[172:175], 0
v_min3_f32 v107, v84, v85, v86
v_max3_f32 v103, v84, v85, v86
v_mfma_f32_16x16x32_bf16 v[88:91], v[14:17], v[180:183], 0
v_min3_f32 v104, v104, v63, v64
v_max3_f32 v100, v100, v63, v64
v_min3_f32 v105, v105, v71, v72
v_min3_f32 v104, v104, v65, v66
v_max3_f32 v101, v101, v71, v72
v_min3_f32 v106, v106, v79, v80
v_min3_f32 v105, v105, v73, v74
v_max3_f32 v102, v102, v79, v80
v_min3_f32 v107, v107, v87, v88
v_min3_f32 v106, v106, v81, v82
v_max3_f32 v103, v103, v87, v88
v_min3_f32 v107, v107, v89, v90
v_max3_f32 v100, v100, v65, v66
v_min_f32 v104, v104, v67
v_max3_f32 v101, v101, v73, v74
v_min_f32 v105, v105, v75
v_max3_f32 v102, v102, v81, v82
v_min_f32 v106, v106, v83
v_max3_f32 v103, v103, v89, v90
v_min_f32 v107, v107, v91
v_max_f32 v100, v100, v67
v_max_f32 v101, v101, v75
v_max_f32 v102, v102, v83
v_max_f32 v103, v103, v91
v_permlane32_swap_b32 v104, v105
v_permlane32_swap_b32 v106, v107
v_permlane32_swap_b32 v100, v101
v_permlane32_swap_b32 v102, v103
v_min_f32 v104, v104, v105
v_min_f32 v106, v106, v107
v_max_f32 v100, v100, v101
v_max_f32 v102, v102, v103
v_permlane16_swap_b32 v104, v106
s_nop 0
v_permlane16_swap_b32 v100, v102
v_min_f32 v104, v104, v106
v_max_f32 v100, v100, v102
v_mov_b32 v106, v104
v_mov_b32 v102, v100
s_nop 0
v_permlane16_swap_b32 v104, v106
v_permlane16_swap_b32 v100, v102
v_mov_b32 v105, v104
v_mov_b32 v101, v100
v_mov_b32 v103, v102
v_permlane32_swap_b32 v104, v105
v_mov_b32 v107, v106
v_permlane32_swap_b32_e64 v100, v101
v_pk_mul_f32 v[104:105], v[104:105], v[128:129]
v_pk_mul_f32 v[100:101], v[100:101], v[128:129]
v_pk_fma_f32 v[220:221], v[60:61], v[128:129], v[104:105] op_sel:[0,0,0] op_sel_hi:[1,0,0] neg_lo:[1,0,0] neg_hi:[1,0,0]
v_pk_fma_f32 v[222:223], v[62:63], v[128:129], v[104:105] op_sel:[0,0,0] op_sel_hi:[1,0,0] neg_lo:[1,0,0] neg_hi:[1,0,0]
v_pk_fma_f32 v[224:225], v[64:65], v[128:129], v[104:105] op_sel:[0,0,0] op_sel_hi:[1,0,0] neg_lo:[1,0,0] neg_hi:[1,0,0]
v_pk_fma_f32 v[226:227], v[66:67], v[128:129], v[104:105] op_sel:[0,0,0] op_sel_hi:[1,0,0] neg_lo:[1,0,0] neg_hi:[1,0,0]
v_pk_fma_f32 v[228:229], v[68:69], v[128:129], v[104:105] op_sel:[0,1,1] op_sel_hi:[1,1,1] neg_lo:[1,0,0] neg_hi:[1,0,0]
v_pk_fma_f32 v[230:231], v[70:71], v[128:129], v[104:105] op_sel:[0,1,1] op_sel_hi:[1,1,1] neg_lo:[1,0,0] neg_hi:[1,0,0]
v_pk_fma_f32 v[232:233], v[72:73], v[128:129], v[104:105] op_sel:[0,1,1] op_sel_hi:[1,1,1] neg_lo:[1,0,0] neg_hi:[1,0,0]
v_pk_fma_f32 v[234:235], v[74:75], v[128:129], v[104:105] op_sel:[0,1,1] op_sel_hi:[1,1,1] neg_lo:[1,0,0] neg_hi:[1,0,0]
v_permlane32_swap_b32 v102, v103
v_permlane32_swap_b32 v106, v107
v_pk_fma_f32 v[60:61], v[60:61], v[128:129], v[100:101] op_sel:[0,0,0] op_sel_hi:[1,0,0] neg_lo:[0,0,1] neg_hi:[0,0,1]
v_pk_fma_f32 v[62:63], v[62:63], v[128:129], v[100:101] op_sel:[0,0,0] op_sel_hi:[1,0,0] neg_lo:[0,0,1] neg_hi:[0,0,1]
v_pk_fma_f32 v[64:65], v[64:65], v[128:129], v[100:101] op_sel:[0,0,0] op_sel_hi:[1,0,0] neg_lo:[0,0,1] neg_hi:[0,0,1]
v_pk_fma_f32 v[66:67], v[66:67], v[128:129], v[100:101] op_sel:[0,0,0] op_sel_hi:[1,0,0] neg_lo:[0,0,1] neg_hi:[0,0,1]
v_pk_fma_f32 v[68:69], v[68:69], v[128:129], v[100:101] op_sel:[0,1,1] op_sel_hi:[1,1,1] neg_lo:[0,0,1] neg_hi:[0,0,1]
v_pk_fma_f32 v[70:71], v[70:71], v[128:129], v[100:101] op_sel:[0,1,1] op_sel_hi:[1,1,1] neg_lo:[0,0,1] neg_hi:[0,0,1]
v_pk_fma_f32 v[72:73], v[72:73], v[128:129], v[100:101] op_sel:[0,1,1] op_sel_hi:[1,1,1] neg_lo:[0,0,1] neg_hi:[0,0,1]
v_pk_fma_f32 v[74:75], v[74:75], v[128:129], v[100:101] op_sel:[0,1,1] op_sel_hi:[1,1,1] neg_lo:[0,0,1] neg_hi:[0,0,1]
v_exp_f32 v220, v220
v_exp_f32 v60, v60
v_exp_f32 v221, v221
v_exp_f32 v61, v61
v_exp_f32 v222, v222
v_exp_f32 v62, v62
v_exp_f32 v223, v223
v_exp_f32 v63, v63
v_exp_f32 v224, v224
v_exp_f32 v64, v64
v_exp_f32 v225, v225
v_exp_f32 v65, v65
v_exp_f32 v226, v226
v_exp_f32 v66, v66
v_exp_f32 v227, v227
v_exp_f32 v67, v67
v_exp_f32 v228, v228
v_exp_f32 v68, v68
v_exp_f32 v229, v229
v_exp_f32 v69, v69
v_exp_f32 v230, v230
v_exp_f32 v70, v70
v_exp_f32 v231, v231
v_exp_f32 v71, v71
v_exp_f32 v232, v232
v_exp_f32 v72, v72
v_exp_f32 v233, v233
v_exp_f32 v73, v73
v_exp_f32 v234, v234
v_exp_f32 v74, v74
v_exp_f32 v235, v235
v_exp_f32 v75, v75
v_pk_mul_f32 v[102:103], v[102:103], v[130:131]
v_pk_mul_f32 v[106:107], v[106:107], v[130:131]
buffer_load_dwordx4 v[212:215], v18, s[32:35], s55 offen offset:0 sc1
buffer_load_dwordx4 v[216:219], v18, s[32:35], s55 offen offset:1024 sc1
.p2align 3
v_pk_add_f32 v[108:109], v[60:61], v[62:63]
v_pk_add_f32 v[110:111], v[220:221], v[222:223]
v_pk_add_f32 v[108:109], v[108:109], v[64:65]
v_pk_add_f32 v[110:111], v[110:111], v[224:225]
v_pk_add_f32 v[108:109], v[108:109], v[66:67]
v_pk_add_f32 v[110:111], v[110:111], v[226:227]
v_add_f32 v100, v108, v109
v_add_f32 v104, v110, v111
v_pk_fma_f32 v[236:237], v[76:77], v[130:131], v[106:107] op_sel:[0,0,0] op_sel_hi:[1,0,0] neg_lo:[1,0,0] neg_hi:[1,0,0]
v_pk_fma_f32 v[238:239], v[78:79], v[130:131], v[106:107] op_sel:[0,0,0] op_sel_hi:[1,0,0] neg_lo:[1,0,0] neg_hi:[1,0,0]
v_pk_add_f32 v[108:109], v[68:69], v[70:71]
v_pk_add_f32 v[110:111], v[228:229], v[230:231]
v_pk_fma_f32 v[76:77], v[76:77], v[130:131], v[102:103] op_sel:[0,0,0] op_sel_hi:[1,0,0] neg_lo:[0,0,1] neg_hi:[0,0,1]
v_pk_fma_f32 v[78:79], v[78:79], v[130:131], v[102:103] op_sel:[0,0,0] op_sel_hi:[1,0,0] neg_lo:[0,0,1] neg_hi:[0,0,1]
v_pk_fma_f32 v[240:241], v[80:81], v[130:131], v[106:107] op_sel:[0,0,0] op_sel_hi:[1,0,0] neg_lo:[1,0,0] neg_hi:[1,0,0]
v_pk_add_f32 v[108:109], v[108:109], v[72:73]
v_pk_add_f32 v[110:111], v[110:111], v[232:233]
v_exp_f32 v236, v236
v_exp_f32 v76, v76
v_exp_f32 v237, v237
v_exp_f32 v77, v77
v_exp_f32 v238, v238
v_exp_f32 v78, v78
v_exp_f32 v239, v239
v_exp_f32 v79, v79
v_pk_fma_f32 v[80:81], v[80:81], v[130:131], v[102:103] op_sel:[0,0,0] op_sel_hi:[1,0,0] neg_lo:[0,0,1] neg_hi:[0,0,1]
v_pk_fma_f32 v[242:243], v[82:83], v[130:131], v[106:107] op_sel:[0,0,0] op_sel_hi:[1,0,0] neg_lo:[1,0,0] neg_hi:[1,0,0]
v_pk_add_f32 v[108:109], v[108:109], v[74:75]
v_pk_add_f32 v[110:111], v[110:111], v[234:235]
v_exp_f32 v240, v240
v_exp_f32 v80, v80
v_exp_f32 v241, v241
v_exp_f32 v81, v81
v_pk_fma_f32 v[82:83], v[82:83], v[130:131], v[102:103] op_sel:[0,0,0] op_sel_hi:[1,0,0] neg_lo:[0,0,1] neg_hi:[0,0,1]
v_add_f32 v101, v108, v109
v_add_f32 v105, v110, v111
v_exp_f32 v242, v242
v_exp_f32 v82, v82
v_exp_f32 v243, v243
v_exp_f32 v83, v83
v_pk_fma_f32 v[244:245], v[84:85], v[130:131], v[106:107] op_sel:[0,1,1] op_sel_hi:[1,1,1] neg_lo:[1,0,0] neg_hi:[1,0,0]
v_pk_fma_f32 v[246:247], v[86:87], v[130:131], v[106:107] op_sel:[0,1,1] op_sel_hi:[1,1,1] neg_lo:[1,0,0] neg_hi:[1,0,0]
v_pk_add_f32 v[108:109], v[76:77], v[78:79]
v_pk_add_f32 v[110:111], v[236:237], v[238:239]
v_pk_fma_f32 v[84:85], v[84:85], v[130:131], v[102:103] op_sel:[0,1,1] op_sel_hi:[1,1,1] neg_lo:[0,0,1] neg_hi:[0,0,1]
v_pk_fma_f32 v[86:87], v[86:87], v[130:131], v[102:103] op_sel:[0,1,1] op_sel_hi:[1,1,1] neg_lo:[0,0,1] neg_hi:[0,0,1]
v_pk_fma_f32 v[248:249], v[88:89], v[130:131], v[106:107] op_sel:[0,1,1] op_sel_hi:[1,1,1] neg_lo:[1,0,0] neg_hi:[1,0,0]
v_pk_fma_f32 v[250:251], v[90:91], v[130:131], v[106:107] op_sel:[0,1,1] op_sel_hi:[1,1,1] neg_lo:[1,0,0] neg_hi:[1,0,0]
v_pk_add_f32 v[108:109], v[108:109], v[80:81]
v_pk_add_f32 v[110:111], v[110:111], v[240:241]
v_exp_f32 v244, v244
v_exp_f32 v84, v84
v_exp_f32 v245, v245
v_exp_f32 v85, v85
v_exp_f32 v246, v246
v_exp_f32 v86, v86
v_exp_f32 v247, v247
v_exp_f32 v87, v87
v_pk_fma_f32 v[88:89], v[88:89], v[130:131], v[102:103] op_sel:[0,1,1] op_sel_hi:[1,1,1] neg_lo:[0,0,1] neg_hi:[0,0,1]
v_pk_fma_f32 v[90:91], v[90:91], v[130:131], v[102:103] op_sel:[0,1,1] op_sel_hi:[1,1,1] neg_lo:[0,0,1] neg_hi:[0,0,1]
v_pk_add_f32 v[108:109], v[108:109], v[82:83]
v_pk_add_f32 v[110:111], v[110:111], v[242:243]
v_exp_f32 v248, v248
v_exp_f32 v88, v88
v_exp_f32 v249, v249
v_exp_f32 v89, v89
v_add_f32 v102, v108, v109
v_add_f32 v106, v110, v111
v_exp_f32 v250, v250
v_exp_f32 v90, v90
v_exp_f32 v251, v251
v_exp_f32 v91, v91
v_pk_add_f32 v[108:109], v[84:85], v[86:87]
v_pk_add_f32 v[110:111], v[244:245], v[246:247]
v_pk_add_f32 v[108:109], v[108:109], v[88:89]
v_pk_add_f32 v[110:111], v[110:111], v[248:249]
v_pk_add_f32 v[108:109], v[108:109], v[90:91]
v_pk_add_f32 v[110:111], v[110:111], v[250:251]
v_add_f32 v103, v108, v109
v_add_f32 v107, v110, v111
s_cmp_eq_u32 s51, 1
s_cbranch_scc1 chk_122
s_waitcnt vmcnt(0)
v_max_u32 v4, v212, v213
v_max3_u32 v4, v4, v214, v215
v_max3_u32 v4, v4, v216, v217
v_max3_u32 v4, v4, v218, v219
v_cmp_eq_u32 vcc, -1, v4
s_cbranch_vccz red_123
buffer_load_dwordx4 v[212:215], v18, s[32:35], s55 offen offset:0 sc1
buffer_load_dwordx4 v[216:219], v18, s[32:35], s55 offen offset:1024 sc1
s_branch chk_122
red_123:
v_mfma_f32_16x16x32_bf16 v[132:135], v[44:47], v[212:215], 0
v_mfma_f32_16x16x32_bf16 v[132:135], v[44:47], v[216:219], v[132:135]
s_mov_b32 s51, 1
s_nop 6
v_add_f32_dpp v132, v132, v132 row_ror:8 row_mask:0xf bank_mask:0xf
v_add_f32_dpp v133, v133, v133 row_ror:8 row_mask:0xf bank_mask:0xf
v_add_f32_dpp v134, v134, v134 row_ror:8 row_mask:0xf bank_mask:0xf
v_add_f32_dpp v135, v135, v135 row_ror:8 row_mask:0xf bank_mask:0xf
v_cvt_pk_bf16_f32 v132, v132, v133
v_cvt_pk_bf16_f32 v133, v134, v135
s_mov_b64 exec, 0x00ff00ff
buffer_store_dwordx2 v[132:133], v59, s[32:35], s79 offen sc1
s_mov_b64 exec, -1
buffer_load_dwordx4 v[204:207], v58, s[32:35], s56 offen sc1
buffer_load_dwordx4 v[208:211], v58, s[32:35], s57 offen sc1
chk_122:
.p2align 3
v_permlane32_swap_b32 v100, v101
v_permlane32_swap_b32 v102, v103
v_permlane32_swap_b32 v104, v105
v_permlane32_swap_b32 v106, v107
v_add_f32 v100, v100, v101
v_add_f32 v102, v102, v103
v_add_f32 v104, v104, v105
v_add_f32 v106, v106, v107
v_permlane16_swap_b32 v100, v102
s_nop 0
v_permlane16_swap_b32 v104, v106
v_add_f32 v100, v100, v102
v_add_f32 v104, v104, v106
v_rcp_f32 v100, v100
v_rcp_f32 v104, v104
v_mov_b32 v102, v100
v_mov_b32 v106, v104
s_nop 0
v_permlane16_swap_b32 v100, v102
v_permlane16_swap_b32 v104, v106
v_mov_b32 v101, v100
v_mov_b32 v103, v102
v_mov_b32 v105, v104
v_mov_b32 v107, v106
v_permlane32_swap_b32 v100, v101
v_permlane32_swap_b32 v102, v103
v_permlane32_swap_b32 v104, v105
v_permlane32_swap_b32 v106, v107
v_pk_mul_f32 v[60:61], v[60:61], v[100:101] op_sel:[0,0] op_sel_hi:[1,0]
v_pk_mul_f32 v[220:221], v[220:221], v[104:105] op_sel:[0,0] op_sel_hi:[1,0]
v_pk_mul_f32 v[68:69], v[68:69], v[100:101] op_sel:[0,1] op_sel_hi:[1,1]
v_pk_mul_f32 v[228:229], v[228:229], v[104:105] op_sel:[0,1] op_sel_hi:[1,1]
v_pk_mul_f32 v[76:77], v[76:77], v[102:103] op_sel:[0,0] op_sel_hi:[1,0]
v_pk_mul_f32 v[236:237], v[236:237], v[106:107] op_sel:[0,0] op_sel_hi:[1,0]
v_pk_mul_f32 v[84:85], v[84:85], v[102:103] op_sel:[0,1] op_sel_hi:[1,1]
v_pk_mul_f32 v[244:245], v[244:245], v[106:107] op_sel:[0,1] op_sel_hi:[1,1]
v_pk_mul_f32 v[62:63], v[62:63], v[100:101] op_sel:[0,0] op_sel_hi:[1,0]
v_pk_mul_f32 v[222:223], v[222:223], v[104:105] op_sel:[0,0] op_sel_hi:[1,0]
v_cvt_pk_bf16_f32 v60, v60, v61
v_cvt_pk_bf16_f32 v220, v220, v221
v_pk_mul_f32 v[70:71], v[70:71], v[100:101] op_sel:[0,1] op_sel_hi:[1,1]
v_pk_mul_f32 v[230:231], v[230:231], v[104:105] op_sel:[0,1] op_sel_hi:[1,1]
v_cvt_pk_bf16_f32 v68, v68, v69
v_cvt_pk_bf16_f32 v228, v228, v229
v_pk_mul_f32 v[78:79], v[78:79], v[102:103] op_sel:[0,0] op_sel_hi:[1,0]
v_pk_mul_f32 v[238:239], v[238:239], v[106:107] op_sel:[0,0] op_sel_hi:[1,0]
v_cvt_pk_bf16_f32 v76, v76, v77
v_cvt_pk_bf16_f32 v236, v236, v237
v_pk_mul_f32 v[86:87], v[86:87], v[102:103] op_sel:[0,1] op_sel_hi:[1,1]
v_pk_mul_f32 v[246:247], v[246:247], v[106:107] op_sel:[0,1] op_sel_hi:[1,1]
v_cvt_pk_bf16_f32 v84, v84, v85
v_cvt_pk_bf16_f32 v244, v244, v245
v_pk_mul_f32 v[64:65], v[64:65], v[100:101] op_sel:[0,0] op_sel_hi:[1,0]
v_pk_mul_f32 v[66:67], v[66:67], v[100:101] op_sel:[0,0] op_sel_hi:[1,0]
v_pk_mul_f32 v[224:225], v[224:225], v[104:105] op_sel:[0,0] op_sel_hi:[1,0]
v_pk_mul_f32 v[226:227], v[226:227], v[104:105] op_sel:[0,0] op_sel_hi:[1,0]
v_cvt_pk_bf16_f32 v61, v62, v63
v_cvt_pk_bf16_f32 v221, v222, v223
v_pk_mul_f32 v[72:73], v[72:73], v[100:101] op_sel:[0,1] op_sel_hi:[1,1]
v_pk_mul_f32 v[74:75], v[74:75], v[100:101] op_sel:[0,1] op_sel_hi:[1,1]
v_pk_mul_f32 v[232:233], v[232:233], v[104:105] op_sel:[0,1] op_sel_hi:[1,1]
v_pk_mul_f32 v[234:235], v[234:235], v[104:105] op_sel:[0,1] op_sel_hi:[1,1]
v_cvt_pk_bf16_f32 v69, v70, v71
v_cvt_pk_bf16_f32 v229, v230, v231
v_pk_mul_f32 v[80:81], v[80:81], v[102:103] op_sel:[0,0] op_sel_hi:[1,0]
v_pk_mul_f32 v[82:83], v[82:83], v[102:103] op_sel:[0,0] op_sel_hi:[1,0]
v_pk_mul_f32 v[240:241], v[240:241], v[106:107] op_sel:[0,0] op_sel_hi:[1,0]
v_pk_mul_f32 v[242:243], v[242:243], v[106:107] op_sel:[0,0] op_sel_hi:[1,0]
v_cvt_pk_bf16_f32 v77, v78, v79
v_cvt_pk_bf16_f32 v237, v238, v239
v_pk_mul_f32 v[88:89], v[88:89], v[102:103] op_sel:[0,1] op_sel_hi:[1,1]
v_pk_mul_f32 v[90:91], v[90:91], v[102:103] op_sel:[0,1] op_sel_hi:[1,1]
v_pk_mul_f32 v[248:249], v[248:249], v[106:107] op_sel:[0,1] op_sel_hi:[1,1]
v_pk_mul_f32 v[250:251], v[250:251], v[106:107] op_sel:[0,1] op_sel_hi:[1,1]
v_cvt_pk_bf16_f32 v85, v86, v87
v_cvt_pk_bf16_f32 v245, v246, v247
v_cvt_pk_bf16_f32 v62, v64, v65
v_cvt_pk_bf16_f32 v63, v66, v67
v_cvt_pk_bf16_f32 v222, v224, v225
v_cvt_pk_bf16_f32 v223, v226, v227
v_cvt_pk_bf16_f32 v70, v72, v73
v_cvt_pk_bf16_f32 v71, v74, v75
v_cvt_pk_bf16_f32 v230, v232, v233
v_cvt_pk_bf16_f32 v231, v234, v235
v_cvt_pk_bf16_f32 v78, v80, v81
v_cvt_pk_bf16_f32 v79, v82, v83
v_cvt_pk_bf16_f32 v238, v240, v241
v_cvt_pk_bf16_f32 v239, v242, v243
v_cvt_pk_bf16_f32 v86, v88, v89
v_cvt_pk_bf16_f32 v87, v90, v91
v_cvt_pk_bf16_f32 v246, v248, v249
v_cvt_pk_bf16_f32 v247, v250, v251
s_cmp_lg_u32 s51, 0
s_cbranch_scc1 else_124
s_mov_b32 s63, 0
sent_126:
s_waitcnt vmcnt(0)
v_max_u32 v4, v212, v213
v_max3_u32 v4, v4, v214, v215
v_max3_u32 v4, v4, v216, v217
v_max3_u32 v4, v4, v218, v219
v_cmp_eq_u32 vcc, -1, v4
s_cbranch_vccz sentd_127
buffer_load_dwordx4 v[212:215], v18, s[32:35], s55 offen offset:0 sc1
buffer_load_dwordx4 v[216:219], v18, s[32:35], s55 offen offset:1024 sc1
s_add_u32 s63, s63, 1
s_cmp_lt_u32 s63, 0x80000
s_cbranch_scc1 sent_126
s_waitcnt vmcnt(0)
sentd_127:
v_mfma_f32_16x16x32_bf16 v[132:135], v[44:47], v[212:215], 0
v_mfma_f32_16x16x32_bf16 v[132:135], v[44:47], v[216:219], v[132:135]
s_mov_b32 s51, 1
s_nop 6
v_add_f32_dpp v132, v132, v132 row_ror:8 row_mask:0xf bank_mask:0xf
v_add_f32_dpp v133, v133, v133 row_ror:8 row_mask:0xf bank_mask:0xf
v_add_f32_dpp v134, v134, v134 row_ror:8 row_mask:0xf bank_mask:0xf
v_add_f32_dpp v135, v135, v135 row_ror:8 row_mask:0xf bank_mask:0xf
v_cvt_pk_bf16_f32 v132, v132, v133
v_cvt_pk_bf16_f32 v133, v134, v135
s_mov_b64 exec, 0x00ff00ff
buffer_store_dwordx2 v[132:133], v59, s[32:35], s79 offen sc1
s_mov_b64 exec, -1
buffer_load_dwordx4 v[204:207], v58, s[32:35], s56 offen sc1
buffer_load_dwordx4 v[208:211], v58, s[32:35], s57 offen sc1
else_124:
s_mov_b32 s63, 0
sent_128:
s_waitcnt vmcnt(0)
v_max_u32 v4, v204, v205
v_max3_u32 v4, v4, v206, v207
v_max3_u32 v4, v4, v208, v209
v_max3_u32 v4, v4, v210, v211
v_cmp_eq_u32 vcc, -1, v4
s_cbranch_vccz sentd_129
buffer_load_dwordx4 v[204:207], v58, s[32:35], s56 offen sc1
buffer_load_dwordx4 v[208:211], v58, s[32:35], s57 offen sc1
s_add_u32 s63, s63, 1
s_cmp_lt_u32 s63, 0x80000
s_cbranch_scc1 sent_128
s_waitcnt vmcnt(0)
sentd_129:
v_mfma_f32_16x16x32_bf16 v[112:115], v[204:207], v[60:63], 0
v_mfma_f32_16x16x32_bf16 v[116:119], v[204:207], v[68:71], 0
v_mfma_f32_16x16x32_bf16 v[120:123], v[204:207], v[76:79], 0
v_mfma_f32_16x16x32_bf16 v[124:127], v[204:207], v[84:87], 0
v_mfma_f32_16x16x32_bf16 v[112:115], v[208:211], v[220:223], v[112:115]
v_mfma_f32_16x16x32_bf16 v[116:119], v[208:211], v[228:231], v[116:119]
v_mfma_f32_16x16x32_bf16 v[120:123], v[208:211], v[236:239], v[120:123]
v_mfma_f32_16x16x32_bf16 v[124:127], v[208:211], v[244:247], v[124:127]
s_nop 4
v_add_f32 v100, v112, v113
v_add_f32 v114, v114, v115
v_add_f32 v100, v100, v114
v_add_f32 v101, v116, v117
v_add_f32 v118, v118, v119
v_add_f32 v101, v101, v118
v_add_f32 v102, v120, v121
v_add_f32 v122, v122, v123
v_add_f32 v102, v102, v122
v_add_f32 v103, v124, v125
v_add_f32 v126, v126, v127
v_add_f32 v103, v103, v126
s_nop 1
v_permlane32_swap_b32 v100, v101
v_permlane32_swap_b32 v102, v103
v_add_f32 v100, v100, v101
v_add_f32 v102, v102, v103
s_nop 1
v_permlane16_swap_b32 v100, v102
s_nop 0
v_add_f32 v100, v100, v102
v_add_f32 v100, 0x358637bd, v100
v_rcp_f32 v100, v100
s_nop 0
v_mov_b32 v102, v100
s_nop 1
v_permlane16_swap_b32 v100, v102
s_nop 0
v_mov_b32 v101, v100
v_mov_b32 v103, v102
s_nop 0
v_permlane32_swap_b32 v100, v101
v_permlane32_swap_b32 v102, v103
buffer_load_dwordx4 v[188:191], v18, s[32:35], s58 offen offset:0 sc1
buffer_load_dwordx4 v[192:195], v18, s[32:35], s58 offen offset:1024 sc1
buffer_load_dwordx4 v[196:199], v18, s[32:35], s59 offen offset:0 sc1
buffer_load_dwordx4 v[200:203], v18, s[32:35], s59 offen offset:1024 sc1
s_mov_b32 s63, 0
sent_130:
s_waitcnt vmcnt(0)
v_max_u32 v4, v188, v189
v_max3_u32 v4, v4, v190, v191
v_max3_u32 v4, v4, v192, v193
v_max3_u32 v4, v4, v194, v195
v_max3_u32 v4, v4, v196, v197
v_max3_u32 v4, v4, v198, v199
v_max3_u32 v4, v4, v200, v201
v_max3_u32 v4, v4, v202, v203
v_cmp_eq_u32 vcc, -1, v4
s_cbranch_vccz sentd_131
buffer_load_dwordx4 v[188:191], v18, s[32:35], s58 offen offset:0 sc1
buffer_load_dwordx4 v[192:195], v18, s[32:35], s58 offen offset:1024 sc1
buffer_load_dwordx4 v[196:199], v18, s[32:35], s59 offen offset:0 sc1
buffer_load_dwordx4 v[200:203], v18, s[32:35], s59 offen offset:1024 sc1
s_add_u32 s63, s63, 1
s_cmp_lt_u32 s63, 0x80000
s_cbranch_scc1 sent_130
s_waitcnt vmcnt(0)
sentd_131:
s_cmp_eq_u32 s46, 0
s_cbranch_scc1 slow_132
.p2align 3
v_mfma_f32_16x16x32_bf16 v[156:159], v[188:191], v[60:63], 0
v_mfma_f32_16x16x32_bf16 v[164:167], v[188:191], v[68:71], 0
v_mfma_f32_16x16x32_bf16 v[160:163], v[192:195], v[60:63], 0
v_mfma_f32_16x16x32_bf16 v[172:175], v[188:191], v[76:79], 0
v_mfma_f32_16x16x32_bf16 v[168:171], v[192:195], v[68:71], 0
v_mfma_f32_16x16x32_bf16 v[180:183], v[188:191], v[84:87], 0
v_mfma_f32_16x16x32_bf16 v[156:159], v[196:199], v[220:223], v[156:159]
v_mfma_f32_16x16x32_bf16 v[176:179], v[192:195], v[76:79], 0
v_mfma_f32_16x16x32_bf16 v[164:167], v[196:199], v[228:231], v[164:167]
v_mfma_f32_16x16x32_bf16 v[184:187], v[192:195], v[84:87], 0
v_mfma_f32_16x16x32_bf16 v[160:163], v[200:203], v[220:223], v[160:163]
v_mfma_f32_16x16x32_bf16 v[172:175], v[196:199], v[236:239], v[172:175]
v_mfma_f32_16x16x32_bf16 v[168:171], v[200:203], v[228:231], v[168:171]
v_mfma_f32_16x16x32_bf16 v[180:183], v[196:199], v[244:247], v[180:183]
v_mfma_f32_16x16x32_bf16 v[176:179], v[200:203], v[236:239], v[176:179]
v_mfma_f32_16x16x32_bf16 v[184:187], v[200:203], v[244:247], v[184:187]
v_pk_mul_f32 v[156:157], v[156:157], v[100:101] op_sel:[0,0] op_sel_hi:[1,0]
v_pk_mul_f32 v[158:159], v[158:159], v[100:101] op_sel:[0,0] op_sel_hi:[1,0]
v_cvt_pk_bf16_f32 v156, v156, v157
v_pk_mul_f32 v[164:165], v[164:165], v[100:101] op_sel:[0,1] op_sel_hi:[1,1]
v_pk_mul_f32 v[160:161], v[160:161], v[100:101] op_sel:[0,0] op_sel_hi:[1,0]
v_pk_mul_f32 v[162:163], v[162:163], v[100:101] op_sel:[0,0] op_sel_hi:[1,0]
v_cvt_pk_bf16_f32 v157, v158, v159
v_pk_mul_f32 v[166:167], v[166:167], v[100:101] op_sel:[0,1] op_sel_hi:[1,1]
v_cvt_pk_bf16_f32 v164, v164, v165
v_pk_mul_f32 v[172:173], v[172:173], v[102:103] op_sel:[0,0] op_sel_hi:[1,0]
v_cvt_pk_bf16_f32 v158, v160, v161
v_cvt_pk_bf16_f32 v159, v162, v163
v_pk_mul_f32 v[168:169], v[168:169], v[100:101] op_sel:[0,1] op_sel_hi:[1,1]
v_pk_mul_f32 v[170:171], v[170:171], v[100:101] op_sel:[0,1] op_sel_hi:[1,1]
v_cvt_pk_bf16_f32 v165, v166, v167
v_pk_mul_f32 v[174:175], v[174:175], v[102:103] op_sel:[0,0] op_sel_hi:[1,0]
v_cvt_pk_bf16_f32 v172, v172, v173
v_pk_mul_f32 v[180:181], v[180:181], v[102:103] op_sel:[0,1] op_sel_hi:[1,1]
buffer_store_dwordx4 v[156:159], v18, s[32:35], s80 offen
v_cvt_pk_bf16_f32 v166, v168, v169
v_cvt_pk_bf16_f32 v167, v170, v171
v_pk_mul_f32 v[176:177], v[176:177], v[102:103] op_sel:[0,0] op_sel_hi:[1,0]
v_pk_mul_f32 v[178:179], v[178:179], v[102:103] op_sel:[0,0] op_sel_hi:[1,0]
v_cvt_pk_bf16_f32 v173, v174, v175
v_pk_mul_f32 v[182:183], v[182:183], v[102:103] op_sel:[0,1] op_sel_hi:[1,1]
v_cvt_pk_bf16_f32 v180, v180, v181
buffer_store_dwordx4 v[164:167], v18, s[32:35], s81 offen
v_cvt_pk_bf16_f32 v174, v176, v177
v_cvt_pk_bf16_f32 v175, v178, v179
v_pk_mul_f32 v[184:185], v[184:185], v[102:103] op_sel:[0,1] op_sel_hi:[1,1]
v_pk_mul_f32 v[186:187], v[186:187], v[102:103] op_sel:[0,1] op_sel_hi:[1,1]
v_cvt_pk_bf16_f32 v181, v182, v183
buffer_store_dwordx4 v[172:175], v18, s[32:35], s82 offen
v_cvt_pk_bf16_f32 v182, v184, v185
v_cvt_pk_bf16_f32 v183, v186, v187
buffer_store_dwordx4 v[180:183], v18, s[32:35], s83 offen
back_133:
s_barrier
v_and_b32 v36, 31, v0
v_lshlrev_b32 v36, 2, v36
s_lshl_b32 s62, s45, 2
v_mov_b32 v4, s62
v_mov_b32 v5, 4
s_mov_b64 exec, 1
s_waitcnt vmcnt(0)
s_cmp_eq_u32 s46, 0
s_cbranch_scc1 slow_134
buffer_store_dword v5, v4, s[32:35], s84 offen
back_135:
s_mov_b64 exec, -1
v_lshrrev_b32 v4, 2, v2
v_and_b32 v5, 3, v0
v_lshl_add_u32 v6, v3, 3, v4
v_lshlrev_b32 v6, 7, v6
v_lshl_add_u32 v6, v5, 3, v6
v_lshrrev_b32 v7, 1, v4
v_and_b32 v8, 1, v3
v_lshl_add_u32 v7, v8, 1, v7
v_lshl_add_u32 v10, v7, 5, v6
v_xor_b32 v11, 32, v10
v_xor_b32 v12, 64, v10
v_xor_b32 v13, 96, v10
v_add_u32 v14, 0x10000, v10
v_add_u32 v15, 0x10000, v11
v_add_u32 v16, 0x10000, v12
v_add_u32 v17, 0x10000, v13
ds_read_b64_tr_b16 v[220:221], v10 offset:0
ds_read_b64_tr_b16 v[222:223], v10 offset:512
ds_read_b64_tr_b16 v[224:225], v11 offset:0
ds_read_b64_tr_b16 v[226:227], v11 offset:512
ds_read_b64_tr_b16 v[228:229], v12 offset:0
ds_read_b64_tr_b16 v[230:231], v12 offset:512
ds_read_b64_tr_b16 v[232:233], v13 offset:0
ds_read_b64_tr_b16 v[234:235], v13 offset:512
ds_read_b64_tr_b16 v[236:237], v10 offset:4096
ds_read_b64_tr_b16 v[238:239], v10 offset:4608
ds_read_b64_tr_b16 v[240:241], v11 offset:4096
ds_read_b64_tr_b16 v[242:243], v11 offset:4608
ds_read_b64_tr_b16 v[244:245], v12 offset:4096
ds_read_b64_tr_b16 v[246:247], v12 offset:4608
ds_read_b64_tr_b16 v[248:249], v13 offset:4096
ds_read_b64_tr_b16 v[250:251], v13 offset:4608
s_lshl_b32 s48, s41, 3
s_lshl_b32 s49, s40, 1
s_add_u32 s48, s48, s49
s_lshl_b32 s48, s48, 15
s_add_u32 s48, s48, 4194304
v_add_u32 v38, s48, v18
v_add_u32 v39, 32768, v38
s_lshl_b32 s57, s75, 11
s_add_u32 s87, s87, 262144
v_lshlrev_b32 v60, 16, v20
v_and_b32 v61, 0xffff0000, v20
v_lshlrev_b32 v62, 16, v21
v_and_b32 v63, 0xffff0000, v21
v_lshlrev_b32 v64, 16, v22
v_and_b32 v65, 0xffff0000, v22
v_lshlrev_b32 v66, 16, v23
v_and_b32 v67, 0xffff0000, v23
v_lshlrev_b32 v68, 16, v24
v_and_b32 v69, 0xffff0000, v24
v_lshlrev_b32 v70, 16, v25
v_and_b32 v71, 0xffff0000, v25
v_lshlrev_b32 v72, 16, v26
v_and_b32 v73, 0xffff0000, v26
v_lshlrev_b32 v74, 16, v27
v_and_b32 v75, 0xffff0000, v27
v_lshlrev_b32 v76, 16, v28
v_and_b32 v77, 0xffff0000, v28
v_lshlrev_b32 v78, 16, v29
v_and_b32 v79, 0xffff0000, v29
v_lshlrev_b32 v80, 16, v30
v_and_b32 v81, 0xffff0000, v30
v_lshlrev_b32 v82, 16, v31
v_and_b32 v83, 0xffff0000, v31
v_lshlrev_b32 v84, 16, v32
v_and_b32 v85, 0xffff0000, v32
v_lshlrev_b32 v86, 16, v33
v_and_b32 v87, 0xffff0000, v33
v_lshlrev_b32 v88, 16, v34
v_and_b32 v89, 0xffff0000, v34
v_lshlrev_b32 v90, 16, v35
v_and_b32 v91, 0xffff0000, v35
s_lshl_b32 s48, s40, 12
s_add_u32 s48, s48, 139264
v_lshrrev_b32 v4, 1, v2
v_lshrrev_b32 v5, 1, v3
v_xor_b32 v4, v4, v5
v_lshlrev_b32 v4, 4, v4
v_and_b32 v5, 1, v3
v_lshl_add_u32 v4, v5, 3, v4
v_lshl_add_u32 v4, v2, 7, v4
v_add_u32 v42, s48, v4
v_xor_b32 v43, 32, v42
v_xor_b32 v44, 64, v42
v_xor_b32 v45, 96, v42
v_add_u32 v46, s48, v18
s_lshl_b32 s48, s41, 7
s_lshl_b32 s49, s40, 5
s_add_u32 s48, s48, s49
s_lshl_b32 s48, s48, 11
s_lshl_b32 s49, s78, 7
s_add_u32 s48, s48, s49
s_add_u32 s49, s48, 32768
v_lshrrev_b32 v4, 3, v0
v_and_b32 v5, 7, v0
v_lshrrev_b32 v6, 1, v4
v_xor_b32 v5, v5, v6
v_lshlrev_b32 v4, 11, v4
v_lshl_add_u32 v40, v5, 4, v4
v_xor_b32 v41, 64, v40
v_add_u32 v41, 16384, v41
buffer_load_dword v37, v36, s[32:35], s84 offen sc1
s_mov_b32 s63, 0
s_waitcnt vmcnt(0)
poll_136:
v_cmp_gt_u32 vcc, 4, v37
s_cbranch_vccz polled_137
buffer_load_dword v37, v36, s[32:35], s84 offen sc1
s_add_u32 s63, s63, 1
s_cmp_lt_u32 s63, 0x80000
s_waitcnt vmcnt(0)
s_cbranch_scc1 poll_136
polled_137:
s_call_b64 s[94:95], R_oloop
s_nop 0
v_cvt_pk_bf16_f32 v20, v60, v61
v_cvt_pk_bf16_f32 v21, v62, v63
v_cvt_pk_bf16_f32 v22, v64, v65
v_cvt_pk_bf16_f32 v23, v66, v67
ds_write_b64 v42, v[20:21] offset:0
ds_write_b64 v43, v[22:23] offset:0
v_cvt_pk_bf16_f32 v24, v68, v69
v_cvt_pk_bf16_f32 v25, v70, v71
v_cvt_pk_bf16_f32 v26, v72, v73
v_cvt_pk_bf16_f32 v27, v74, v75
ds_write_b64 v44, v[24:25] offset:0
ds_write_b64 v45, v[26:27] offset:0
v_cvt_pk_bf16_f32 v28, v76, v77
v_cvt_pk_bf16_f32 v29, v78, v79
v_cvt_pk_bf16_f32 v30, v80, v81
v_cvt_pk_bf16_f32 v31, v82, v83
ds_write_b64 v42, v[28:29] offset:2048
ds_write_b64 v43, v[30:31] offset:2048
v_cvt_pk_bf16_f32 v32, v84, v85
v_cvt_pk_bf16_f32 v33, v86, v87
v_cvt_pk_bf16_f32 v34, v88, v89
v_cvt_pk_bf16_f32 v35, v90, v91
ds_write_b64 v44, v[32:33] offset:2048
ds_write_b64 v45, v[34:35] offset:2048
ds_read_b128 v[20:23], v46 offset:0
ds_read_b128 v[24:27], v46 offset:1024
ds_read_b128 v[28:31], v46 offset:2048
ds_read_b128 v[32:35], v46 offset:3072
s_waitcnt lgkmcnt(3)
buffer_store_dwordx4 v[20:23], v40, s[24:27], s48 offen sc1
s_waitcnt lgkmcnt(2)
buffer_store_dwordx4 v[24:27], v41, s[24:27], s48 offen sc1
s_waitcnt lgkmcnt(1)
buffer_store_dwordx4 v[28:31], v40, s[24:27], s49 offen sc1
s_waitcnt lgkmcnt(0)
buffer_store_dwordx4 v[32:35], v41, s[24:27], s49 offen sc1
s_endpgm
L_code_end:
again_22:
s_mov_b32 s63, 0
retry_24:
buffer_load_dwordx4 v[176:179], v37, s[32:35], 0 offen offset:0 sc1
buffer_load_dwordx4 v[180:183], v37, s[32:35], 0 offen offset:1024 sc1
buffer_load_dwordx4 v[184:187], v37, s[32:35], 0 offen offset:2048 sc1
buffer_load_dwordx4 v[188:191], v37, s[32:35], 0 offen offset:3072 sc1
s_waitcnt vmcnt(0)
v_add_f32 v176, v176, v184
v_add_f32 v177, v177, v185
v_add_f32 v178, v178, v186
v_add_f32 v179, v179, v187
v_add_f32 v180, v180, v188
v_add_f32 v181, v181, v189
v_add_f32 v182, v182, v190
v_add_f32 v183, v183, v191
v_add_f32 v176, v176, v180
v_add_f32 v177, v177, v181
v_add_f32 v178, v178, v182
v_add_f32 v179, v179, v183
s_nop 1
v_permlane32_swap_b32 v176, v177
v_permlane32_swap_b32 v178, v179
v_add_f32 v176, v176, v177
v_add_f32 v178, v178, v179
s_nop 1
v_permlane16_swap_b32 v176, v178
s_nop 0
v_add_f32 v176, v176, v178
v_cmp_u_f32 vcc, v176, v176
s_cbranch_vccz summed_23
s_add_u32 s63, s63, 1
s_cmp_lt_u32 s63, 0x10000
s_cbranch_scc1 retry_24
s_branch summed_23
again_25:
s_mov_b32 s63, 0
retry_27:
buffer_load_dwordx4 v[160:163], v38, s[32:35], 0 offen offset:0 sc1
buffer_load_dwordx4 v[164:167], v38, s[32:35], 0 offen offset:1024 sc1
buffer_load_dwordx4 v[168:171], v38, s[32:35], 0 offen offset:2048 sc1
buffer_load_dwordx4 v[172:175], v38, s[32:35], 0 offen offset:3072 sc1
s_waitcnt vmcnt(0)
v_add_f32 v160, v160, v168
v_add_f32 v161, v161, v169
v_add_f32 v162, v162, v170
v_add_f32 v163, v163, v171
v_add_f32 v164, v164, v172
v_add_f32 v165, v165, v173
v_add_f32 v166, v166, v174
v_add_f32 v167, v167, v175
v_add_f32 v160, v160, v164
v_add_f32 v161, v161, v165
v_add_f32 v162, v162, v166
v_add_f32 v163, v163, v167
s_nop 1
v_permlane32_swap_b32 v160, v161
v_permlane32_swap_b32 v162, v163
v_add_f32 v160, v160, v161
v_add_f32 v162, v162, v163
s_nop 1
v_permlane16_swap_b32 v160, v162
s_nop 0
v_add_f32 v160, v160, v162
v_cmp_u_f32 vcc, v160, v160
s_cbranch_vccz summed_26
s_add_u32 s63, s63, 1
s_cmp_lt_u32 s63, 0x10000
s_cbranch_scc1 retry_27
s_branch summed_26
again_33:
s_mov_b32 s63, 0
retry_35:
buffer_load_dwordx4 v[80:83], v37, s[32:35], 0 offen offset:0 sc1
buffer_load_dwordx4 v[84:87], v37, s[32:35], 0 offen offset:1024 sc1
buffer_load_dwordx4 v[88:91], v37, s[32:35], 0 offen offset:2048 sc1
buffer_load_dwordx4 v[92:95], v37, s[32:35], 0 offen offset:3072 sc1
s_waitcnt vmcnt(0)
v_add_f32 v80, v80, v88
v_add_f32 v81, v81, v89
v_add_f32 v82, v82, v90
v_add_f32 v83, v83, v91
v_add_f32 v84, v84, v92
v_add_f32 v85, v85, v93
v_add_f32 v86, v86, v94
v_add_f32 v87, v87, v95
v_add_f32 v80, v80, v84
v_add_f32 v81, v81, v85
v_add_f32 v82, v82, v86
v_add_f32 v83, v83, v87
s_nop 1
v_permlane32_swap_b32 v80, v81
v_permlane32_swap_b32 v82, v83
v_add_f32 v80, v80, v81
v_add_f32 v82, v82, v83
s_nop 1
v_permlane16_swap_b32 v80, v82
s_nop 0
v_add_f32 v80, v80, v82
v_cmp_u_f32 vcc, v80, v80
s_cbranch_vccz summed_34
s_add_u32 s63, s63, 1
s_cmp_lt_u32 s63, 0x10000
s_cbranch_scc1 retry_35
s_branch summed_34
again_36:
s_mov_b32 s63, 0
retry_38:
buffer_load_dwordx4 v[64:67], v38, s[32:35], 0 offen offset:0 sc1
buffer_load_dwordx4 v[68:71], v38, s[32:35], 0 offen offset:1024 sc1
buffer_load_dwordx4 v[72:75], v38, s[32:35], 0 offen offset:2048 sc1
buffer_load_dwordx4 v[76:79], v38, s[32:35], 0 offen offset:3072 sc1
s_waitcnt vmcnt(0)
v_add_f32 v64, v64, v72
v_add_f32 v65, v65, v73
v_add_f32 v66, v66, v74
v_add_f32 v67, v67, v75
v_add_f32 v68, v68, v76
v_add_f32 v69, v69, v77
v_add_f32 v70, v70, v78
v_add_f32 v71, v71, v79
v_add_f32 v64, v64, v68
v_add_f32 v65, v65, v69
v_add_f32 v66, v66, v70
v_add_f32 v67, v67, v71
s_nop 1
v_permlane32_swap_b32 v64, v65
v_permlane32_swap_b32 v66, v67
v_add_f32 v64, v64, v65
v_add_f32 v66, v66, v67
s_nop 1
v_permlane16_swap_b32 v64, v66
s_nop 0
v_add_f32 v64, v64, v66
v_cmp_u_f32 vcc, v64, v64
s_cbranch_vccz summed_37
s_add_u32 s63, s63, 1
s_cmp_lt_u32 s63, 0x10000
s_cbranch_scc1 retry_38
s_branch summed_37
again_42:
s_mov_b32 s63, 0
retry_44:
buffer_load_dwordx4 v[80:83], v37, s[32:35], 0 offen offset:0 sc1
buffer_load_dwordx4 v[84:87], v37, s[32:35], 0 offen offset:1024 sc1
buffer_load_dwordx4 v[88:91], v37, s[32:35], 0 offen offset:2048 sc1
buffer_load_dwordx4 v[92:95], v37, s[32:35], 0 offen offset:3072 sc1
s_waitcnt vmcnt(0)
v_add_f32 v80, v80, v88
v_add_f32 v81, v81, v89
v_add_f32 v82, v82, v90
v_add_f32 v83, v83, v91
v_add_f32 v84, v84, v92
v_add_f32 v85, v85, v93
v_add_f32 v86, v86, v94
v_add_f32 v87, v87, v95
v_add_f32 v80, v80, v84
v_add_f32 v81, v81, v85
v_add_f32 v82, v82, v86
v_add_f32 v83, v83, v87
s_nop 1
v_permlane32_swap_b32 v80, v81
v_permlane32_swap_b32 v82, v83
v_add_f32 v80, v80, v81
v_add_f32 v82, v82, v83
s_nop 1
v_permlane16_swap_b32 v80, v82
s_nop 0
v_add_f32 v80, v80, v82
v_cmp_u_f32 vcc, v80, v80
s_cbranch_vccz summed_43
s_add_u32 s63, s63, 1
s_cmp_lt_u32 s63, 0x10000
s_cbranch_scc1 retry_44
s_branch summed_43
again_50:
s_mov_b32 s63, 0
retry_52:
buffer_load_dwordx4 v[80:83], v37, s[32:35], 0 offen offset:0 sc1
buffer_load_dwordx4 v[84:87], v37, s[32:35], 0 offen offset:1024 sc1
buffer_load_dwordx4 v[88:91], v37, s[32:35], 0 offen offset:2048 sc1
buffer_load_dwordx4 v[92:95], v37, s[32:35], 0 offen offset:3072 sc1
s_waitcnt vmcnt(0)
v_add_f32 v80, v80, v88
v_add_f32 v81, v81, v89
v_add_f32 v82, v82, v90
v_add_f32 v83, v83, v91
v_add_f32 v84, v84, v92
v_add_f32 v85, v85, v93
v_add_f32 v86, v86, v94
v_add_f32 v87, v87, v95
v_add_f32 v80, v80, v84
v_add_f32 v81, v81, v85
v_add_f32 v82, v82, v86
v_add_f32 v83, v83, v87
s_nop 1
v_permlane32_swap_b32 v80, v81
v_permlane32_swap_b32 v82, v83
v_add_f32 v80, v80, v81
v_add_f32 v82, v82, v83
s_nop 1
v_permlane16_swap_b32 v80, v82
s_nop 0
v_add_f32 v80, v80, v82
v_cmp_u_f32 vcc, v80, v80
s_cbranch_vccz summed_51
s_add_u32 s63, s63, 1
s_cmp_lt_u32 s63, 0x10000
s_cbranch_scc1 retry_52
s_branch summed_51
slow_71:
.p2align 3
v_mfma_f32_16x16x32_bf16 v[160:163], v[120:123], v[156:159], v[44:47]
v_max_f32 v158, v192, v193
v_max_f32 v159, v194, v195
v_permlane32_swap_b32 v130, v131
s_nop 0
v_max_f32 v130, v130, v131
s_nop 2
v_max_f32 v156, v160, v161
v_max_f32 v157, v162, v163
v_max3_f32 v128, v156, v157, v158
v_max_f32 v128, v128, v159
s_nop 1
v_permlane32_swap_b32 v128, v129
s_nop 0
v_max_f32 v128, v128, v129
s_nop 1
v_permlane16_swap_b32 v128, v130
s_nop 0
v_max_f32 v128, v128, v130
v_mov_b32 v130, v128
s_nop 1
v_permlane16_swap_b32 v128, v130
s_nop 0
v_mov_b32 v129, v128
v_mov_b32 v131, v130
s_nop 0
v_permlane32_swap_b32 v128, v129
v_permlane32_swap_b32 v130, v131
v_mul_f32 v128, v128, v124
v_mul_f32 v129, v129, v125
v_pk_fma_f32 v[156:157], v[156:157], v[124:125], v[128:129] op_sel:[0,0,0] op_sel_hi:[1,0,0] neg_lo:[0,0,1] neg_hi:[0,0,1]
v_pk_fma_f32 v[158:159], v[158:159], v[124:125], v[128:129] op_sel:[0,0,0] op_sel_hi:[1,0,0] neg_lo:[0,0,1] neg_hi:[0,0,1]
v_mul_f32 v130, v130, v126
v_mul_f32 v131, v131, v127
v_exp_f32 v156, v156
v_exp_f32 v157, v157
v_exp_f32 v158, v158
v_exp_f32 v159, v159
v_pk_fma_f32 v[164:165], v[164:165], v[124:125], v[128:129] op_sel:[0,1,1] op_sel_hi:[1,1,1] neg_lo:[0,0,1] neg_hi:[0,0,1]
v_pk_fma_f32 v[166:167], v[166:167], v[124:125], v[128:129] op_sel:[0,1,1] op_sel_hi:[1,1,1] neg_lo:[0,0,1] neg_hi:[0,0,1]
v_exp_f32 v164, v164
v_exp_f32 v165, v165
v_exp_f32 v166, v166
v_exp_f32 v167, v167
v_pk_fma_f32 v[172:173], v[172:173], v[126:127], v[130:131] op_sel:[0,0,0] op_sel_hi:[1,0,0] neg_lo:[0,0,1] neg_hi:[0,0,1]
v_pk_fma_f32 v[174:175], v[174:175], v[126:127], v[130:131] op_sel:[0,0,0] op_sel_hi:[1,0,0] neg_lo:[0,0,1] neg_hi:[0,0,1]
v_cvt_pk_bf16_f32 v156, v156, v156
v_cvt_pk_bf16_f32 v157, v157, v157
v_cvt_pk_bf16_f32 v158, v158, v158
v_cvt_pk_bf16_f32 v159, v159, v159
v_exp_f32 v172, v172
v_exp_f32 v173, v173
v_exp_f32 v174, v174
v_exp_f32 v175, v175
v_pk_fma_f32 v[180:181], v[180:181], v[126:127], v[130:131] op_sel:[0,1,1] op_sel_hi:[1,1,1] neg_lo:[0,0,1] neg_hi:[0,0,1]
v_pk_fma_f32 v[182:183], v[182:183], v[126:127], v[130:131] op_sel:[0,1,1] op_sel_hi:[1,1,1] neg_lo:[0,0,1] neg_hi:[0,0,1]
v_and_b32 v156, v52, v156
v_and_b32 v157, v52, v157
v_and_b32 v158, v52, v158
v_and_b32 v159, v52, v159
v_cvt_pk_bf16_f32 v164, v164, v164
v_cvt_pk_bf16_f32 v165, v165, v165
v_mfma_f32_16x16x32_bf16 v[160:163], v[48:51], v[156:159], 0
v_cvt_pk_bf16_f32 v166, v166, v166
v_cvt_pk_bf16_f32 v167, v167, v167
v_mfma_f32_16x16x32_bf16 v[220:223], v[100:103], v[156:159], 0
v_exp_f32 v180, v180
v_mfma_f32_16x16x32_bf16 v[224:227], v[110:113], v[156:159], 0
v_exp_f32 v181, v181
v_exp_f32 v182, v182
v_exp_f32 v183, v183
v_and_b32 v164, v52, v164
v_and_b32 v165, v52, v165
v_and_b32 v166, v52, v166
v_and_b32 v167, v52, v167
v_cvt_pk_bf16_f32 v172, v172, v172
v_cvt_pk_bf16_f32 v173, v173, v173
v_mfma_f32_16x16x32_bf16 v[168:171], v[48:51], v[164:167], 0
v_cvt_pk_bf16_f32 v174, v174, v174
v_cvt_pk_bf16_f32 v175, v175, v175
v_mfma_f32_16x16x32_bf16 v[228:231], v[102:105], v[164:167], 0
v_and_b32 v172, v52, v172
v_and_b32 v173, v52, v173
v_mfma_f32_16x16x32_bf16 v[232:235], v[112:115], v[164:167], 0
v_and_b32 v174, v52, v174
v_and_b32 v175, v52, v175
v_cvt_pk_bf16_f32 v180, v180, v180
v_cvt_pk_bf16_f32 v181, v181, v181
v_mfma_f32_16x16x32_bf16 v[176:179], v[48:51], v[172:175], 0
v_cvt_pk_bf16_f32 v182, v182, v182
v_cvt_pk_bf16_f32 v183, v183, v183
v_mfma_f32_16x16x32_bf16 v[236:239], v[104:107], v[172:175], 0
v_and_b32 v180, v52, v180
v_and_b32 v181, v52, v181
v_mfma_f32_16x16x32_bf16 v[240:243], v[114:117], v[172:175], 0
v_and_b32 v182, v52, v182
v_and_b32 v183, v52, v183
v_rcp_f32 v160, v160
v_rcp_f32 v168, v168
v_pk_mul_f32 v[220:221], v[220:221], v[160:161] op_sel:[0,0] op_sel_hi:[1,0]
v_pk_mul_f32 v[222:223], v[222:223], v[160:161] op_sel:[0,0] op_sel_hi:[1,0]
v_pk_mul_f32 v[228:229], v[228:229], v[168:169] op_sel:[0,0] op_sel_hi:[1,0]
v_pk_mul_f32 v[224:225], v[224:225], v[160:161] op_sel:[0,0] op_sel_hi:[1,0]
v_pk_mul_f32 v[226:227], v[226:227], v[160:161] op_sel:[0,0] op_sel_hi:[1,0]
v_pk_mul_f32 v[230:231], v[230:231], v[168:169] op_sel:[0,0] op_sel_hi:[1,0]
v_pk_mul_f32 v[232:233], v[232:233], v[168:169] op_sel:[0,0] op_sel_hi:[1,0]
v_pk_mul_f32 v[234:235], v[234:235], v[168:169] op_sel:[0,0] op_sel_hi:[1,0]
v_mfma_f32_16x16x32_bf16 v[184:187], v[48:51], v[180:183], 0
v_rcp_f32_e64 v176, v176
v_cvt_pk_bf16_f32 v220, v220, v221
v_cvt_pk_bf16_f32 v221, v222, v223
v_cvt_pk_bf16_f32 v228, v228, v229
v_pk_mul_f32 v[236:237], v[236:237], v[176:177] op_sel:[0,0] op_sel_hi:[1,0]
v_mfma_f32_16x16x32_bf16 v[244:247], v[106:109], v[180:183], 0
v_cvt_pk_bf16_f32 v222, v224, v225
v_cvt_pk_bf16_f32 v223, v226, v227
v_rcp_f32_e64 v184, v184
v_cvt_pk_bf16_f32 v229, v230, v231
v_pk_mul_f32 v[238:239], v[238:239], v[176:177] op_sel:[0,0] op_sel_hi:[1,0]
v_pk_mul_f32 v[240:241], v[240:241], v[176:177] op_sel:[0,0] op_sel_hi:[1,0]
v_pk_mul_f32 v[242:243], v[242:243], v[176:177] op_sel:[0,0] op_sel_hi:[1,0]
v_cvt_pk_bf16_f32 v236, v236, v237
v_pk_mul_f32 v[244:245], v[244:245], v[184:185] op_sel:[0,0] op_sel_hi:[1,0]
v_pk_mul_f32 v[246:247], v[246:247], v[184:185] op_sel:[0,0] op_sel_hi:[1,0]
v_mfma_f32_16x16x32_bf16 v[248:251], v[116:119], v[180:183], 0
buffer_store_dwordx4 v[220:223], v18, s[32:35], s80 offen sc1
v_cvt_pk_bf16_f32 v230, v232, v233
v_cvt_pk_bf16_f32 v231, v234, v235
v_cvt_pk_bf16_f32 v237, v238, v239
v_cvt_pk_bf16_f32 v244, v244, v245
buffer_store_dwordx4 v[228:231], v18, s[32:35], s81 offen sc1
v_cvt_pk_bf16_f32 v238, v240, v241
v_cvt_pk_bf16_f32 v239, v242, v243
v_pk_mul_f32 v[248:249], v[248:249], v[184:185] op_sel:[0,0] op_sel_hi:[1,0]
v_pk_mul_f32 v[250:251], v[250:251], v[184:185] op_sel:[0,0] op_sel_hi:[1,0]
v_cvt_pk_bf16_f32 v245, v246, v247
buffer_store_dwordx4 v[236:239], v18, s[32:35], s82 offen sc1
v_cvt_pk_bf16_f32 v246, v248, v249
v_cvt_pk_bf16_f32 v247, v250, v251
buffer_store_dwordx4 v[244:247], v18, s[32:35], s83 offen sc1
s_branch back_72
slow_73:
buffer_store_dword v5, v4, s[32:35], s84 offen sc1
s_branch back_74
slow_78:
s_nop 0
v_cvt_pk_bf16_f32 v20, v60, v61
v_cvt_pk_bf16_f32 v21, v62, v63
v_cvt_pk_bf16_f32 v22, v64, v65
v_cvt_pk_bf16_f32 v23, v66, v67
buffer_store_dwordx4 v[20:23], v18, s[32:35], s85 offen offset:0 sc1
v_cvt_pk_bf16_f32 v24, v68, v69
v_cvt_pk_bf16_f32 v25, v70, v71
v_cvt_pk_bf16_f32 v26, v72, v73
v_cvt_pk_bf16_f32 v27, v74, v75
buffer_store_dwordx4 v[24:27], v18, s[32:35], s85 offen offset:1024 sc1
v_cvt_pk_bf16_f32 v28, v76, v77
v_cvt_pk_bf16_f32 v29, v78, v79
v_cvt_pk_bf16_f32 v30, v80, v81
v_cvt_pk_bf16_f32 v31, v82, v83
buffer_store_dwordx4 v[28:31], v18, s[32:35], s86 offen offset:0 sc1
v_cvt_pk_bf16_f32 v32, v84, v85
v_cvt_pk_bf16_f32 v33, v86, v87
v_cvt_pk_bf16_f32 v34, v88, v89
v_cvt_pk_bf16_f32 v35, v90, v91
buffer_store_dwordx4 v[32:35], v18, s[32:35], s86 offen offset:1024 sc1
s_barrier
v_dot2c_f32_bf16 v6, v20, v48
v_dot2c_f32_bf16 v8, v20, v20
v_dot2c_f32_bf16 v7, v28, v48
v_dot2c_f32_bf16 v9, v28, v28
v_dot2c_f32_bf16 v6, v21, v48
v_dot2c_f32_bf16 v8, v21, v21
v_dot2c_f32_bf16 v7, v29, v48
v_dot2c_f32_bf16 v9, v29, v29
v_dot2c_f32_bf16 v6, v22, v48
v_dot2c_f32_bf16 v8, v22, v22
v_dot2c_f32_bf16 v7, v30, v48
v_dot2c_f32_bf16 v9, v30, v30
v_dot2c_f32_bf16 v6, v23, v48
v_dot2c_f32_bf16 v8, v23, v23
v_dot2c_f32_bf16 v7, v31, v48
v_dot2c_f32_bf16 v9, v31, v31
v_dot2c_f32_bf16 v6, v24, v48
v_dot2c_f32_bf16 v8, v24, v24
v_dot2c_f32_bf16 v7, v32, v48
v_dot2c_f32_bf16 v9, v32, v32
v_dot2c_f32_bf16 v6, v25, v48
v_dot2c_f32_bf16 v8, v25, v25
v_dot2c_f32_bf16 v7, v33, v48
v_dot2c_f32_bf16 v9, v33, v33
v_dot2c_f32_bf16 v6, v26, v48
v_dot2c_f32_bf16 v8, v26, v26
v_dot2c_f32_bf16 v7, v34, v48
v_dot2c_f32_bf16 v9, v34, v34
v_dot2c_f32_bf16 v6, v27, v48
v_dot2c_f32_bf16 v8, v27, v27
v_dot2c_f32_bf16 v7, v35, v48
v_dot2c_f32_bf16 v9, v35, v35
s_mov_b64 exec, 1
s_waitcnt vmcnt(0)
buffer_store_dword v5, v4, s[32:35], s88 offen sc1
s_mov_b64 exec, -1
s_nop 1
v_permlane32_swap_b32 v6, v7
v_permlane32_swap_b32 v8, v9
v_add_f32 v6, v6, v7
v_add_f32 v8, v8, v9
s_nop 1
v_permlane16_swap_b32 v6, v8
s_nop 0
v_add_f32 v6, v6, v8
buffer_store_dword v6, v1, s[32:35], s87 offen sc1
s_branch back_79
slow_94:
.p2align 3
v_mfma_f32_16x16x32_bf16 v[156:159], v[188:191], v[60:63], 0
v_mfma_f32_16x16x32_bf16 v[164:167], v[188:191], v[68:71], 0
v_mfma_f32_16x16x32_bf16 v[160:163], v[192:195], v[60:63], 0
v_mfma_f32_16x16x32_bf16 v[172:175], v[188:191], v[76:79], 0
v_mfma_f32_16x16x32_bf16 v[168:171], v[192:195], v[68:71], 0
v_mfma_f32_16x16x32_bf16 v[180:183], v[188:191], v[84:87], 0
v_mfma_f32_16x16x32_bf16 v[156:159], v[196:199], v[220:223], v[156:159]
v_mfma_f32_16x16x32_bf16 v[176:179], v[192:195], v[76:79], 0
v_mfma_f32_16x16x32_bf16 v[164:167], v[196:199], v[228:231], v[164:167]
v_mfma_f32_16x16x32_bf16 v[184:187], v[192:195], v[84:87], 0
v_mfma_f32_16x16x32_bf16 v[160:163], v[200:203], v[220:223], v[160:163]
v_mfma_f32_16x16x32_bf16 v[172:175], v[196:199], v[236:239], v[172:175]
v_mfma_f32_16x16x32_bf16 v[168:171], v[200:203], v[228:231], v[168:171]
v_mfma_f32_16x16x32_bf16 v[180:183], v[196:199], v[244:247], v[180:183]
v_mfma_f32_16x16x32_bf16 v[176:179], v[200:203], v[236:239], v[176:179]
v_mfma_f32_16x16x32_bf16 v[184:187], v[200:203], v[244:247], v[184:187]
v_pk_mul_f32 v[156:157], v[156:157], v[100:101] op_sel:[0,0] op_sel_hi:[1,0]
v_pk_mul_f32 v[158:159], v[158:159], v[100:101] op_sel:[0,0] op_sel_hi:[1,0]
v_cvt_pk_bf16_f32 v156, v156, v157
v_pk_mul_f32 v[164:165], v[164:165], v[100:101] op_sel:[0,1] op_sel_hi:[1,1]
v_pk_mul_f32 v[160:161], v[160:161], v[100:101] op_sel:[0,0] op_sel_hi:[1,0]
v_pk_mul_f32 v[162:163], v[162:163], v[100:101] op_sel:[0,0] op_sel_hi:[1,0]
v_cvt_pk_bf16_f32 v157, v158, v159
v_pk_mul_f32 v[166:167], v[166:167], v[100:101] op_sel:[0,1] op_sel_hi:[1,1]
v_cvt_pk_bf16_f32 v164, v164, v165
v_pk_mul_f32 v[172:173], v[172:173], v[102:103] op_sel:[0,0] op_sel_hi:[1,0]
v_cvt_pk_bf16_f32 v158, v160, v161
v_cvt_pk_bf16_f32 v159, v162, v163
v_pk_mul_f32 v[168:169], v[168:169], v[100:101] op_sel:[0,1] op_sel_hi:[1,1]
v_pk_mul_f32 v[170:171], v[170:171], v[100:101] op_sel:[0,1] op_sel_hi:[1,1]
v_cvt_pk_bf16_f32 v165, v166, v167
v_pk_mul_f32 v[174:175], v[174:175], v[102:103] op_sel:[0,0] op_sel_hi:[1,0]
v_cvt_pk_bf16_f32 v172, v172, v173
v_pk_mul_f32 v[180:181], v[180:181], v[102:103] op_sel:[0,1] op_sel_hi:[1,1]
buffer_store_dwordx4 v[156:159], v18, s[32:35], s80 offen sc1
v_cvt_pk_bf16_f32 v166, v168, v169
v_cvt_pk_bf16_f32 v167, v170, v171
v_pk_mul_f32 v[176:177], v[176:177], v[102:103] op_sel:[0,0] op_sel_hi:[1,0]
v_pk_mul_f32 v[178:179], v[178:179], v[102:103] op_sel:[0,0] op_sel_hi:[1,0]
v_cvt_pk_bf16_f32 v173, v174, v175
v_pk_mul_f32 v[182:183], v[182:183], v[102:103] op_sel:[0,1] op_sel_hi:[1,1]
v_cvt_pk_bf16_f32 v180, v180, v181
buffer_store_dwordx4 v[164:167], v18, s[32:35], s81 offen sc1
v_cvt_pk_bf16_f32 v174, v176, v177
v_cvt_pk_bf16_f32 v175, v178, v179
v_pk_mul_f32 v[184:185], v[184:185], v[102:103] op_sel:[0,1] op_sel_hi:[1,1]
v_pk_mul_f32 v[186:187], v[186:187], v[102:103] op_sel:[0,1] op_sel_hi:[1,1]
v_cvt_pk_bf16_f32 v181, v182, v183
buffer_store_dwordx4 v[172:175], v18, s[32:35], s82 offen sc1
v_cvt_pk_bf16_f32 v182, v184, v185
v_cvt_pk_bf16_f32 v183, v186, v187
buffer_store_dwordx4 v[180:183], v18, s[32:35], s83 offen sc1
s_branch back_95
slow_96:
buffer_store_dword v5, v4, s[32:35], s84 offen sc1
s_branch back_97
slow_100:
s_nop 0
v_cvt_pk_bf16_f32 v20, v60, v61
v_cvt_pk_bf16_f32 v21, v62, v63
v_cvt_pk_bf16_f32 v22, v64, v65
v_cvt_pk_bf16_f32 v23, v66, v67
buffer_store_dwordx4 v[20:23], v18, s[32:35], s85 offen offset:0 sc1
v_cvt_pk_bf16_f32 v24, v68, v69
v_cvt_pk_bf16_f32 v25, v70, v71
v_cvt_pk_bf16_f32 v26, v72, v73
v_cvt_pk_bf16_f32 v27, v74, v75
buffer_store_dwordx4 v[24:27], v18, s[32:35], s85 offen offset:1024 sc1
v_cvt_pk_bf16_f32 v28, v76, v77
v_cvt_pk_bf16_f32 v29, v78, v79
v_cvt_pk_bf16_f32 v30, v80, v81
v_cvt_pk_bf16_f32 v31, v82, v83
buffer_store_dwordx4 v[28:31], v18, s[32:35], s86 offen offset:0 sc1
v_cvt_pk_bf16_f32 v32, v84, v85
v_cvt_pk_bf16_f32 v33, v86, v87
v_cvt_pk_bf16_f32 v34, v88, v89
v_cvt_pk_bf16_f32 v35, v90, v91
buffer_store_dwordx4 v[32:35], v18, s[32:35], s86 offen offset:1024 sc1
s_barrier
v_dot2c_f32_bf16 v6, v20, v48
v_dot2c_f32_bf16 v8, v20, v20
v_dot2c_f32_bf16 v7, v28, v48
v_dot2c_f32_bf16 v9, v28, v28
v_dot2c_f32_bf16 v6, v21, v48
v_dot2c_f32_bf16 v8, v21, v21
v_dot2c_f32_bf16 v7, v29, v48
v_dot2c_f32_bf16 v9, v29, v29
v_dot2c_f32_bf16 v6, v22, v48
v_dot2c_f32_bf16 v8, v22, v22
v_dot2c_f32_bf16 v7, v30, v48
v_dot2c_f32_bf16 v9, v30, v30
v_dot2c_f32_bf16 v6, v23, v48
v_dot2c_f32_bf16 v8, v23, v23
v_dot2c_f32_bf16 v7, v31, v48
v_dot2c_f32_bf16 v9, v31, v31
v_dot2c_f32_bf16 v6, v24, v48
v_dot2c_f32_bf16 v8, v24, v24
v_dot2c_f32_bf16 v7, v32, v48
v_dot2c_f32_bf16 v9, v32, v32
v_dot2c_f32_bf16 v6, v25, v48
v_dot2c_f32_bf16 v8, v25, v25
v_dot2c_f32_bf16 v7, v33, v48
v_dot2c_f32_bf16 v9, v33, v33
v_dot2c_f32_bf16 v6, v26, v48
v_dot2c_f32_bf16 v8, v26, v26
v_dot2c_f32_bf16 v7, v34, v48
v_dot2c_f32_bf16 v9, v34, v34
v_dot2c_f32_bf16 v6, v27, v48
v_dot2c_f32_bf16 v8, v27, v27
v_dot2c_f32_bf16 v7, v35, v48
v_dot2c_f32_bf16 v9, v35, v35
s_mov_b64 exec, 1
s_waitcnt vmcnt(0)
buffer_store_dword v5, v4, s[32:35], s88 offen sc1
s_mov_b64 exec, -1
s_nop 1
v_permlane32_swap_b32 v6, v7
v_permlane32_swap_b32 v8, v9
v_add_f32 v6, v6, v7
v_add_f32 v8, v8, v9
s_nop 1
v_permlane16_swap_b32 v6, v8
s_nop 0
v_add_f32 v6, v6, v8
buffer_store_dword v6, v1, s[32:35], s87 offen sc1
s_branch back_101
slow_112:
.p2align 3
v_mfma_f32_16x16x32_bf16 v[160:163], v[120:123], v[156:159], v[44:47]
v_max_f32 v158, v192, v193
v_max_f32 v159, v194, v195
v_permlane32_swap_b32 v130, v131
s_nop 0
v_max_f32 v130, v130, v131
s_nop 2
v_max_f32 v156, v160, v161
v_max_f32 v157, v162, v163
v_max3_f32 v128, v156, v157, v158
v_max_f32 v128, v128, v159
s_nop 1
v_permlane32_swap_b32 v128, v129
s_nop 0
v_max_f32 v128, v128, v129
s_nop 1
v_permlane16_swap_b32 v128, v130
s_nop 0
v_max_f32 v128, v128, v130
v_mov_b32 v130, v128
s_nop 1
v_permlane16_swap_b32 v128, v130
s_nop 0
v_mov_b32 v129, v128
v_mov_b32 v131, v130
s_nop 0
v_permlane32_swap_b32 v128, v129
v_permlane32_swap_b32 v130, v131
v_mul_f32 v128, v128, v124
v_mul_f32 v129, v129, v125
v_pk_fma_f32 v[156:157], v[156:157], v[124:125], v[128:129] op_sel:[0,0,0] op_sel_hi:[1,0,0] neg_lo:[0,0,1] neg_hi:[0,0,1]
v_pk_fma_f32 v[158:159], v[158:159], v[124:125], v[128:129] op_sel:[0,0,0] op_sel_hi:[1,0,0] neg_lo:[0,0,1] neg_hi:[0,0,1]
v_mul_f32 v130, v130, v126
v_mul_f32 v131, v131, v127
v_exp_f32 v156, v156
v_exp_f32 v157, v157
v_exp_f32 v158, v158
v_exp_f32 v159, v159
v_pk_fma_f32 v[164:165], v[164:165], v[124:125], v[128:129] op_sel:[0,1,1] op_sel_hi:[1,1,1] neg_lo:[0,0,1] neg_hi:[0,0,1]
v_pk_fma_f32 v[166:167], v[166:167], v[124:125], v[128:129] op_sel:[0,1,1] op_sel_hi:[1,1,1] neg_lo:[0,0,1] neg_hi:[0,0,1]
v_exp_f32 v164, v164
v_exp_f32 v165, v165
v_exp_f32 v166, v166
v_exp_f32 v167, v167
v_pk_fma_f32 v[172:173], v[172:173], v[126:127], v[130:131] op_sel:[0,0,0] op_sel_hi:[1,0,0] neg_lo:[0,0,1] neg_hi:[0,0,1]
v_pk_fma_f32 v[174:175], v[174:175], v[126:127], v[130:131] op_sel:[0,0,0] op_sel_hi:[1,0,0] neg_lo:[0,0,1] neg_hi:[0,0,1]
v_cvt_pk_bf16_f32 v156, v156, v156
v_cvt_pk_bf16_f32 v157, v157, v157
v_cvt_pk_bf16_f32 v158, v158, v158
v_cvt_pk_bf16_f32 v159, v159, v159
v_exp_f32 v172, v172
v_exp_f32 v173, v173
v_exp_f32 v174, v174
v_exp_f32 v175, v175
v_pk_fma_f32 v[180:181], v[180:181], v[126:127], v[130:131] op_sel:[0,1,1] op_sel_hi:[1,1,1] neg_lo:[0,0,1] neg_hi:[0,0,1]
v_pk_fma_f32 v[182:183], v[182:183], v[126:127], v[130:131] op_sel:[0,1,1] op_sel_hi:[1,1,1] neg_lo:[0,0,1] neg_hi:[0,0,1]
v_and_b32 v156, v52, v156
v_and_b32 v157, v52, v157
v_and_b32 v158, v52, v158
v_and_b32 v159, v52, v159
v_cvt_pk_bf16_f32 v164, v164, v164
v_cvt_pk_bf16_f32 v165, v165, v165
v_mfma_f32_16x16x32_bf16 v[160:163], v[48:51], v[156:159], 0
v_cvt_pk_bf16_f32 v166, v166, v166
v_cvt_pk_bf16_f32 v167, v167, v167
v_mfma_f32_16x16x32_bf16 v[220:223], v[100:103], v[156:159], 0
v_exp_f32 v180, v180
v_mfma_f32_16x16x32_bf16 v[224:227], v[110:113], v[156:159], 0
v_exp_f32 v181, v181
v_exp_f32 v182, v182
v_exp_f32 v183, v183
v_and_b32 v164, v52, v164
v_and_b32 v165, v52, v165
v_and_b32 v166, v52, v166
v_and_b32 v167, v52, v167
v_cvt_pk_bf16_f32 v172, v172, v172
v_cvt_pk_bf16_f32 v173, v173, v173
v_mfma_f32_16x16x32_bf16 v[168:171], v[48:51], v[164:167], 0
v_cvt_pk_bf16_f32 v174, v174, v174
v_cvt_pk_bf16_f32 v175, v175, v175
v_mfma_f32_16x16x32_bf16 v[228:231], v[102:105], v[164:167], 0
v_and_b32 v172, v52, v172
v_and_b32 v173, v52, v173
v_mfma_f32_16x16x32_bf16 v[232:235], v[112:115], v[164:167], 0
v_and_b32 v174, v52, v174
v_and_b32 v175, v52, v175
v_cvt_pk_bf16_f32 v180, v180, v180
v_cvt_pk_bf16_f32 v181, v181, v181
v_mfma_f32_16x16x32_bf16 v[176:179], v[48:51], v[172:175], 0
v_cvt_pk_bf16_f32 v182, v182, v182
v_cvt_pk_bf16_f32 v183, v183, v183
v_mfma_f32_16x16x32_bf16 v[236:239], v[104:107], v[172:175], 0
v_and_b32 v180, v52, v180
v_and_b32 v181, v52, v181
v_mfma_f32_16x16x32_bf16 v[240:243], v[114:117], v[172:175], 0
v_and_b32 v182, v52, v182
v_and_b32 v183, v52, v183
v_rcp_f32 v160, v160
v_rcp_f32 v168, v168
v_pk_mul_f32 v[220:221], v[220:221], v[160:161] op_sel:[0,0] op_sel_hi:[1,0]
v_pk_mul_f32 v[222:223], v[222:223], v[160:161] op_sel:[0,0] op_sel_hi:[1,0]
v_pk_mul_f32 v[228:229], v[228:229], v[168:169] op_sel:[0,0] op_sel_hi:[1,0]
v_pk_mul_f32 v[224:225], v[224:225], v[160:161] op_sel:[0,0] op_sel_hi:[1,0]
v_pk_mul_f32 v[226:227], v[226:227], v[160:161] op_sel:[0,0] op_sel_hi:[1,0]
v_pk_mul_f32 v[230:231], v[230:231], v[168:169] op_sel:[0,0] op_sel_hi:[1,0]
v_pk_mul_f32 v[232:233], v[232:233], v[168:169] op_sel:[0,0] op_sel_hi:[1,0]
v_pk_mul_f32 v[234:235], v[234:235], v[168:169] op_sel:[0,0] op_sel_hi:[1,0]
v_mfma_f32_16x16x32_bf16 v[184:187], v[48:51], v[180:183], 0
v_rcp_f32_e64 v176, v176
v_cvt_pk_bf16_f32 v220, v220, v221
v_cvt_pk_bf16_f32 v221, v222, v223
v_cvt_pk_bf16_f32 v228, v228, v229
v_pk_mul_f32 v[236:237], v[236:237], v[176:177] op_sel:[0,0] op_sel_hi:[1,0]
v_mfma_f32_16x16x32_bf16 v[244:247], v[106:109], v[180:183], 0
v_cvt_pk_bf16_f32 v222, v224, v225
v_cvt_pk_bf16_f32 v223, v226, v227
v_rcp_f32_e64 v184, v184
v_cvt_pk_bf16_f32 v229, v230, v231
v_pk_mul_f32 v[238:239], v[238:239], v[176:177] op_sel:[0,0] op_sel_hi:[1,0]
v_pk_mul_f32 v[240:241], v[240:241], v[176:177] op_sel:[0,0] op_sel_hi:[1,0]
v_pk_mul_f32 v[242:243], v[242:243], v[176:177] op_sel:[0,0] op_sel_hi:[1,0]
v_cvt_pk_bf16_f32 v236, v236, v237
v_pk_mul_f32 v[244:245], v[244:245], v[184:185] op_sel:[0,0] op_sel_hi:[1,0]
v_pk_mul_f32 v[246:247], v[246:247], v[184:185] op_sel:[0,0] op_sel_hi:[1,0]
v_mfma_f32_16x16x32_bf16 v[248:251], v[116:119], v[180:183], 0
buffer_store_dwordx4 v[220:223], v18, s[32:35], s80 offen sc1
v_cvt_pk_bf16_f32 v230, v232, v233
v_cvt_pk_bf16_f32 v231, v234, v235
v_cvt_pk_bf16_f32 v237, v238, v239
v_cvt_pk_bf16_f32 v244, v244, v245
buffer_store_dwordx4 v[228:231], v18, s[32:35], s81 offen sc1
v_cvt_pk_bf16_f32 v238, v240, v241
v_cvt_pk_bf16_f32 v239, v242, v243
v_pk_mul_f32 v[248:249], v[248:249], v[184:185] op_sel:[0,0] op_sel_hi:[1,0]
v_pk_mul_f32 v[250:251], v[250:251], v[184:185] op_sel:[0,0] op_sel_hi:[1,0]
v_cvt_pk_bf16_f32 v245, v246, v247
buffer_store_dwordx4 v[236:239], v18, s[32:35], s82 offen sc1
v_cvt_pk_bf16_f32 v246, v248, v249
v_cvt_pk_bf16_f32 v247, v250, v251
buffer_store_dwordx4 v[244:247], v18, s[32:35], s83 offen sc1
s_branch back_113
slow_114:
buffer_store_dword v5, v4, s[32:35], s84 offen sc1
s_branch back_115
slow_118:
s_nop 0
v_cvt_pk_bf16_f32 v20, v60, v61
v_cvt_pk_bf16_f32 v21, v62, v63
v_cvt_pk_bf16_f32 v22, v64, v65
v_cvt_pk_bf16_f32 v23, v66, v67
buffer_store_dwordx4 v[20:23], v18, s[32:35], s85 offen offset:0 sc1
v_cvt_pk_bf16_f32 v24, v68, v69
v_cvt_pk_bf16_f32 v25, v70, v71
v_cvt_pk_bf16_f32 v26, v72, v73
v_cvt_pk_bf16_f32 v27, v74, v75
buffer_store_dwordx4 v[24:27], v18, s[32:35], s85 offen offset:1024 sc1
v_cvt_pk_bf16_f32 v28, v76, v77
v_cvt_pk_bf16_f32 v29, v78, v79
v_cvt_pk_bf16_f32 v30, v80, v81
v_cvt_pk_bf16_f32 v31, v82, v83
buffer_store_dwordx4 v[28:31], v18, s[32:35], s86 offen offset:0 sc1
v_cvt_pk_bf16_f32 v32, v84, v85
v_cvt_pk_bf16_f32 v33, v86, v87
v_cvt_pk_bf16_f32 v34, v88, v89
v_cvt_pk_bf16_f32 v35, v90, v91
buffer_store_dwordx4 v[32:35], v18, s[32:35], s86 offen offset:1024 sc1
s_barrier
v_dot2c_f32_bf16 v6, v20, v48
v_dot2c_f32_bf16 v8, v20, v20
v_dot2c_f32_bf16 v7, v28, v48
v_dot2c_f32_bf16 v9, v28, v28
v_dot2c_f32_bf16 v6, v21, v48
v_dot2c_f32_bf16 v8, v21, v21
v_dot2c_f32_bf16 v7, v29, v48
v_dot2c_f32_bf16 v9, v29, v29
v_dot2c_f32_bf16 v6, v22, v48
v_dot2c_f32_bf16 v8, v22, v22
v_dot2c_f32_bf16 v7, v30, v48
v_dot2c_f32_bf16 v9, v30, v30
v_dot2c_f32_bf16 v6, v23, v48
v_dot2c_f32_bf16 v8, v23, v23
v_dot2c_f32_bf16 v7, v31, v48
v_dot2c_f32_bf16 v9, v31, v31
v_dot2c_f32_bf16 v6, v24, v48
v_dot2c_f32_bf16 v8, v24, v24
v_dot2c_f32_bf16 v7, v32, v48
v_dot2c_f32_bf16 v9, v32, v32
v_dot2c_f32_bf16 v6, v25, v48
v_dot2c_f32_bf16 v8, v25, v25
v_dot2c_f32_bf16 v7, v33, v48
v_dot2c_f32_bf16 v9, v33, v33
v_dot2c_f32_bf16 v6, v26, v48
v_dot2c_f32_bf16 v8, v26, v26
v_dot2c_f32_bf16 v7, v34, v48
v_dot2c_f32_bf16 v9, v34, v34
v_dot2c_f32_bf16 v6, v27, v48
v_dot2c_f32_bf16 v8, v27, v27
v_dot2c_f32_bf16 v7, v35, v48
v_dot2c_f32_bf16 v9, v35, v35
s_mov_b64 exec, 1
s_waitcnt vmcnt(0)
buffer_store_dword v5, v4, s[32:35], s88 offen sc1
s_mov_b64 exec, -1
s_nop 1
v_permlane32_swap_b32 v6, v7
v_permlane32_swap_b32 v8, v9
v_add_f32 v6, v6, v7
v_add_f32 v8, v8, v9
s_nop 1
v_permlane16_swap_b32 v6, v8
s_nop 0
v_add_f32 v6, v6, v8
buffer_store_dword v6, v1, s[32:35], s87 offen sc1
s_branch back_119
slow_132:
.p2align 3
v_mfma_f32_16x16x32_bf16 v[156:159], v[188:191], v[60:63], 0
v_mfma_f32_16x16x32_bf16 v[164:167], v[188:191], v[68:71], 0
v_mfma_f32_16x16x32_bf16 v[160:163], v[192:195], v[60:63], 0
v_mfma_f32_16x16x32_bf16 v[172:175], v[188:191], v[76:79], 0
v_mfma_f32_16x16x32_bf16 v[168:171], v[192:195], v[68:71], 0
v_mfma_f32_16x16x32_bf16 v[180:183], v[188:191], v[84:87], 0
v_mfma_f32_16x16x32_bf16 v[156:159], v[196:199], v[220:223], v[156:159]
v_mfma_f32_16x16x32_bf16 v[176:179], v[192:195], v[76:79], 0
v_mfma_f32_16x16x32_bf16 v[164:167], v[196:199], v[228:231], v[164:167]
v_mfma_f32_16x16x32_bf16 v[184:187], v[192:195], v[84:87], 0
v_mfma_f32_16x16x32_bf16 v[160:163], v[200:203], v[220:223], v[160:163]
v_mfma_f32_16x16x32_bf16 v[172:175], v[196:199], v[236:239], v[172:175]
v_mfma_f32_16x16x32_bf16 v[168:171], v[200:203], v[228:231], v[168:171]
v_mfma_f32_16x16x32_bf16 v[180:183], v[196:199], v[244:247], v[180:183]
v_mfma_f32_16x16x32_bf16 v[176:179], v[200:203], v[236:239], v[176:179]
v_mfma_f32_16x16x32_bf16 v[184:187], v[200:203], v[244:247], v[184:187]
v_pk_mul_f32 v[156:157], v[156:157], v[100:101] op_sel:[0,0] op_sel_hi:[1,0]
v_pk_mul_f32 v[158:159], v[158:159], v[100:101] op_sel:[0,0] op_sel_hi:[1,0]
v_cvt_pk_bf16_f32 v156, v156, v157
v_pk_mul_f32 v[164:165], v[164:165], v[100:101] op_sel:[0,1] op_sel_hi:[1,1]
v_pk_mul_f32 v[160:161], v[160:161], v[100:101] op_sel:[0,0] op_sel_hi:[1,0]
v_pk_mul_f32 v[162:163], v[162:163], v[100:101] op_sel:[0,0] op_sel_hi:[1,0]
v_cvt_pk_bf16_f32 v157, v158, v159
v_pk_mul_f32 v[166:167], v[166:167], v[100:101] op_sel:[0,1] op_sel_hi:[1,1]
v_cvt_pk_bf16_f32 v164, v164, v165
v_pk_mul_f32 v[172:173], v[172:173], v[102:103] op_sel:[0,0] op_sel_hi:[1,0]
v_cvt_pk_bf16_f32 v158, v160, v161
v_cvt_pk_bf16_f32 v159, v162, v163
v_pk_mul_f32 v[168:169], v[168:169], v[100:101] op_sel:[0,1] op_sel_hi:[1,1]
v_pk_mul_f32 v[170:171], v[170:171], v[100:101] op_sel:[0,1] op_sel_hi:[1,1]
v_cvt_pk_bf16_f32 v165, v166, v167
v_pk_mul_f32 v[174:175], v[174:175], v[102:103] op_sel:[0,0] op_sel_hi:[1,0]
v_cvt_pk_bf16_f32 v172, v172, v173
v_pk_mul_f32 v[180:181], v[180:181], v[102:103] op_sel:[0,1] op_sel_hi:[1,1]
buffer_store_dwordx4 v[156:159], v18, s[32:35], s80 offen sc1
v_cvt_pk_bf16_f32 v166, v168, v169
v_cvt_pk_bf16_f32 v167, v170, v171
v_pk_mul_f32 v[176:177], v[176:177], v[102:103] op_sel:[0,0] op_sel_hi:[1,0]
v_pk_mul_f32 v[178:179], v[178:179], v[102:103] op_sel:[0,0] op_sel_hi:[1,0]
v_cvt_pk_bf16_f32 v173, v174, v175
v_pk_mul_f32 v[182:183], v[182:183], v[102:103] op_sel:[0,1] op_sel_hi:[1,1]
v_cvt_pk_bf16_f32 v180, v180, v181
buffer_store_dwordx4 v[164:167], v18, s[32:35], s81 offen sc1
v_cvt_pk_bf16_f32 v174, v176, v177
v_cvt_pk_bf16_f32 v175, v178, v179
v_pk_mul_f32 v[184:185], v[184:185], v[102:103] op_sel:[0,1] op_sel_hi:[1,1]
v_pk_mul_f32 v[186:187], v[186:187], v[102:103] op_sel:[0,1] op_sel_hi:[1,1]
v_cvt_pk_bf16_f32 v181, v182, v183
buffer_store_dwordx4 v[172:175], v18, s[32:35], s82 offen sc1
v_cvt_pk_bf16_f32 v182, v184, v185
v_cvt_pk_bf16_f32 v183, v186, v187
buffer_store_dwordx4 v[180:183], v18, s[32:35], s83 offen sc1
s_branch back_133
slow_134:
buffer_store_dword v5, v4, s[32:35], s84 offen sc1
s_branch back_135
s_endpgm
.section .rodata,"a"
.p2align 6
.amdhsa_kernel interleave_layers__sliding_local_dilated__linear_kernel_hedgehog__prompt_kernel
  .amdhsa_next_free_vgpr 256
  .amdhsa_next_free_sgpr 102
  .amdhsa_accum_offset 256
  .amdhsa_group_segment_fixed_size 0
  .amdhsa_kernarg_size 80
  .amdhsa_user_sgpr_count 2
  .amdhsa_user_sgpr_kernarg_segment_ptr 1
  .amdhsa_system_sgpr_workgroup_id_x 1
.end_amdhsa_kernel
```

```asm
; @launch grid=(256,1,1) block=(512,1,1) lds=163840
.amdgcn_target "amdgcn-amd-amdhsa--gfx950"
.text
.globl interleave_layers__sliding_local_dilated__linear_kernel_hedgehog__prompt_kernel
.p2align 8
.type interleave_layers__sliding_local_dilated__linear_kernel_hedgehog__prompt_kernel,@function
interleave_layers__sliding_local_dilated__linear_kernel_hedgehog__prompt_kernel:
s_cmp_ge_u32 s2, 256
s_cbranch_scc1 L_end
s_load_dwordx16 s[4:19], s[0:1], 0
s_load_dwordx4 s[20:23], s[0:1], 64
v_lshrrev_b32 v1, 6, v0
v_and_b32 v0, 63, v0
v_readfirstlane_b32 s40, v1
v_and_b32 v2, 15, v0
v_lshrrev_b32 v3, 4, v0
v_lshlrev_b32 v18, 4, v0
s_and_b32 s48, s2, 7
s_lshr_b32 s49, s2, 3
s_and_b32 s74, s49, 1
s_lshl_b32 s41, s48, 1
s_add_u32 s41, s41, s74
s_lshr_b32 s42, s49, 1
s_and_b32 s48, s2, 7
s_lshr_b32 s47, s42, 2
s_add_u32 s47, s47, s48
s_and_b32 s47, s47, 3
s_and_b32 s43, s40, 3
s_lshl_b32 s70, s43, 12
s_lshl_b32 s71, s43, 11
s_add_u32 s71, s71, 16384
s_cmp_lt_u32 s40, 4
s_cbranch_scc1 L_compute
v_lshrrev_b32 v4, 3, v0
v_and_b32 v5, 7, v0
s_lshl_b32 s48, s43, 4
v_add_u32 v6, s48, v4
s_lshl_b32 s48, s42, 7
s_mov_b32 s49, 6144
v_mul_u32_u24 v6, s49, v6
v_and_b32 v7, 2, v4
v_xor_b32 v7, v7, v5
v_lshl_add_u32 v26, v7, 4, v6
v_add_u32 v26, s48, v26
s_mul_i32 s49, s49, 8
s_sub_u32 s49, s49, 1024
v_xor_b32 v27, 64, v26
v_add_u32 v27, s49, v27
s_mov_b32 s53, 2048
s_mov_b32 s54, 393216
s_mov_b32 s57, 131072
s_lshl_b32 s48, s41, 7
s_lshl_b32 s49, s43, 5
s_add_u32 s48, s48, s49
v_add_u32 v6, s48, v4
v_lshlrev_b32 v6, 11, v6
v_lshrrev_b32 v7, 1, v4
v_xor_b32 v7, v7, v5
v_lshl_add_u32 v20, v7, 4, v6
v_xor_b32 v21, 64, v20
v_add_u32 v21, 15360, v21
v_add_u32 v22, 30720, v20
v_add_u32 v23, 30720, v21
s_add_u32 s69, s47, 0
s_and_b32 s69, s69, 3
s_add_u32 s69, s69, 0
s_mul_i32 s67, s69, 128
s_mul_i32 s68, s69, s54
s_waitcnt lgkmcnt(0)
s_mov_b32 s24, s4
s_and_b32 s25, s5, 0xffff
s_mov_b32 s26, 4194304
s_mov_b32 s27, 0x00020000
s_mov_b32 s28, s6
s_and_b32 s29, s7, 0xffff
s_mov_b32 s30, 6291456
s_mov_b32 s31, 0x00020000
s_add_u32 m0, s70, 0
s_nop 0
buffer_load_dwordx4 v20, s[24:27], s67 offen offset:0  lds
buffer_load_dwordx4 v21, s[24:27], s67 offen offset:1024  lds
buffer_load_dwordx4 v22, s[24:27], s67 offen offset:2048  lds
buffer_load_dwordx4 v23, s[24:27], s67 offen offset:3072  lds
s_add_u32 s60, s71, 0
s_add_u32 m0, s60, 0
s_mov_b32 s61, s68
buffer_load_dwordx4 v26, s[28:31], s61 offen lds
buffer_load_dwordx4 v27, s[28:31], s61 offen offset:1024 lds
s_add_u32 m0, s60, 8192
s_add_u32 s61, s61, s53
buffer_load_dwordx4 v26, s[28:31], s61 offen lds
buffer_load_dwordx4 v27, s[28:31], s61 offen offset:1024 lds
s_add_u32 m0, s60, 16384
s_add_u32 s61, s61, s53
buffer_load_dwordx4 v26, s[28:31], s61 offen lds
buffer_load_dwordx4 v27, s[28:31], s61 offen offset:1024 lds
s_lshr_b32 s48, s2, 2
s_and_b32 s48, s48, 1
s_lshl_b32 s48, s48, 1
s_add_u32 s48, s48, s74
s_and_b32 s49, s42, 3
s_xor_b32 s77, s48, s49
s_add_u32 s77, s77, 4
s_lshr_b32 s48, s77, 2
s_add_u32 s48, s47, s48
s_and_b32 s48, s48, 3
s_and_b32 s49, s77, 3
s_lshl_b32 s49, s49, 2
s_add_u32 s78, s48, s49
s_and_b32 s48, s2, 7
s_lshl_b32 s48, s48, 1
s_add_u32 s75, s78, s48
s_and_b32 s75, s75, 15
s_mov_b32 s46, 0
s_mov_b32 s32, s22
s_and_b32 s33, s23, 0xffff
s_mov_b32 s34, 268435456
s_mov_b32 s35, 0x00020000
s_mov_b32 s36, s8
s_and_b32 s37, s9, 0xffff
s_mov_b32 s38, 2097152
s_mov_b32 s39, 0x00020000
v_mov_b32 v56, -1
v_mov_b32 v57, -1
v_mov_b32 v58, -1
v_mov_b32 v59, -1
s_lshl_b32 s52, s41, 6
s_add_u32 s52, s52, s42
s_lshl_b32 s52, s52, 8
s_add_u32 s52, s52, 16777216
s_getreg_b32 s50, hwreg(HW_REG_XCC_ID)
s_and_b32 s50, s50, 7
s_lshl_b32 s50, s50, 3
s_lshl_b64 s[94:95], 1, s50
s_and_b32 s96, s2, 7
s_lshl_b32 s96, s96, 5
s_and_b32 s51, s42, 7
s_cmp_gt_u32 s51, 3
s_cselect_b32 s49, 1, 0
s_sub_u32 s49, s51, s49
s_lshl_b32 s49, s49, 1
s_add_u32 s49, s49, s74
s_lshl_b32 s49, s49, 2
s_add_u32 s49, s49, s43
s_lshr_b32 s50, s49, 4
s_lshl_b32 s50, s50, 11
s_and_b32 s49, s49, 15
s_mul_i32 s49, s49, 24576
s_add_u32 s49, s49, s50
s_and_b32 s50, s42, 8
s_or_b32 s50, s50, 3
s_and_b32 s48, s2, 7
s_lshr_b32 s76, s50, 2
s_add_u32 s76, s76, s48
s_and_b32 s76, s76, 3
s_lshl_b32 s50, s50, 7
s_add_u32 s49, s49, s50
s_and_b32 s51, s51, 3
s_cmp_eq_u32 s51, 3
s_cselect_b32 s49, 0x70000000, s49
v_mul_u32_u24 v4, 6144, v4
v_lshl_add_u32 v4, v5, 4, v4
v_lshrrev_b32 v5, 5, v0
v_lshlrev_b32 v5, 30, v5
v_add3_u32 v36, v4, v5, s49
s_mov_b32 s55, -1
s_mov_b32 s56, -1
v_lshrrev_b32 v4, 3, v0
v_and_b32 v5, 7, v0
s_lshr_b32 s48, s43, 1
s_lshl_b32 s48, s48, 5
s_and_b32 s49, s43, 1
s_lshl_b32 s49, s49, 3
s_add_u32 s48, s48, s49
v_lshrrev_b32 v6, 2, v4
v_lshlrev_b32 v6, 4, v6
v_and_b32 v7, 3, v4
v_add3_u32 v6, v6, v7, s48
s_lshl_b32 s48, s78, 7
s_mov_b32 s49, 2048
v_mul_u32_u24 v6, s49, v6
v_and_b32 v7, 2, v4
v_xor_b32 v7, v7, v5
v_lshl_add_u32 v28, v7, 4, v6
v_add_u32 v28, s48, v28
s_mul_i32 s49, s49, 4
s_sub_u32 s49, s49, 1024
v_xor_b32 v29, 64, v28
v_add_u32 v29, s49, v29
v_lshrrev_b32 v4, 3, v0
v_and_b32 v5, 7, v0
s_lshr_b32 s48, s43, 1
s_lshl_b32 s48, s48, 5
s_and_b32 s49, s43, 1
s_lshl_b32 s49, s49, 3
s_add_u32 s48, s48, s49
v_lshrrev_b32 v6, 2, v4
v_lshlrev_b32 v6, 4, v6
v_and_b32 v7, 3, v4
v_add3_u32 v6, v6, v7, s48
s_lshl_b32 s48, s42, 7
s_mov_b32 s49, 6144
s_cmp_ge_i32 s55, 0
s_cselect_b32 s48, 1024, s48
s_cselect_b32 s49, 384, s49
v_mul_u32_u24 v6, s49, v6
v_and_b32 v7, 2, v4
v_xor_b32 v7, v7, v5
v_lshl_add_u32 v60, v7, 4, v6
v_add_u32 v60, s48, v60
s_mul_i32 s49, s49, 4
s_sub_u32 s49, s49, 1024
v_xor_b32 v61, 64, v60
v_add_u32 v61, s49, v61
v_lshrrev_b32 v4, 3, v0
v_and_b32 v5, 7, v0
s_lshr_b32 s48, s43, 1
s_lshl_b32 s48, s48, 5
s_and_b32 s49, s43, 1
s_lshl_b32 s49, s49, 3
s_add_u32 s48, s48, s49
v_lshrrev_b32 v6, 2, v4
v_lshlrev_b32 v6, 4, v6
v_and_b32 v7, 3, v4
v_add3_u32 v6, v6, v7, s48
s_lshl_b32 s48, s78, 7
s_mov_b32 s49, 2048
s_cmp_ge_i32 s56, 0
s_cselect_b32 s48, 1024, s48
s_cselect_b32 s49, 128, s49
v_mul_u32_u24 v6, s49, v6
v_and_b32 v7, 2, v4
v_xor_b32 v7, v7, v5
v_lshl_add_u32 v24, v7, 4, v6
v_add_u32 v24, s48, v24
s_mul_i32 s49, s49, 4
s_sub_u32 s49, s49, 1024
v_xor_b32 v25, 64, v24
v_add_u32 v25, s49, v25
v_lshlrev_b32 v30, 2, v2
v_and_b32 v32, 7, v0
v_lshlrev_b32 v32, 5, v32
s_lshl_b32 s50, s41, 2
s_add_u32 s50, s50, s43
s_lshl_b32 s50, s50, 12
s_add_u32 s50, s50, 16777216
v_add_u32 v37, s50, v18
v_lshrrev_b32 v4, 5, v0
v_lshl_add_u32 v4, v4, 4, v2
s_lshl_b32 s48, s43, 5
v_add_u32 v4, s48, v4
v_lshlrev_b32 v49, 3, v4
v_add_u32 v49, 131072, v49
v_lshlrev_b32 v50, 2, v4
v_add_u32 v50, 132096, v50
s_lshl_b32 s79, s41, 2
s_add_u32 s79, s79, s43
s_lshl_b32 s79, s79, 7
s_add_u32 s79, s79, 18358272
s_lshl_b32 s48, s41, 3
s_lshl_b32 s49, s43, 1
s_add_u32 s48, s48, s49
s_lshl_b32 s80, s48, 15
s_lshl_b32 s49, s42, 11
s_add_u32 s81, s80, s49
s_add_u32 s81, s81, 4194304
s_add_u32 s82, s81, 32768
s_lshl_b32 s48, s43, 11
v_add_u32 v51, s48, v18
v_add_u32 v52, 0x10000, v51
v_add_u32 v14, 0x20000, v51
s_lshl_b32 s48, s2, 2
s_add_u32 s48, s48, s43
s_lshl_b32 s83, s48, 11
s_mul_i32 s87, s48, 6144
v_add_u32 v62, s83, v18
s_add_u32 s87, s87, 3072
v_add_u32 v63, s87, v18
s_and_b32 s48, s2, 7
s_add_u32 s83, s42, s48
s_and_b32 s83, s83, 7
s_mul_i32 s83, s83, 2
s_add_u32 s87, s83, 1
s_and_b32 s87, s87, 15
s_mul_i32 s83, s83, 393216
s_mul_i32 s87, s87, 393216
v_add_u32 v63, 1024, v61
s_cmp_eq_u32 s74, 0
s_cselect_b64 vcc, -1, 0
v_cndmask_b32 v63, v63, v60, vcc
s_lshr_b32 s48, s2, 4
s_and_b32 s49, s2, 7
s_add_u32 s48, s48, s49
s_mul_i32 s49, s48, 8193
s_lshr_b32 s49, s49, 16
s_mul_i32 s49, s49, 8
s_sub_u32 s88, s48, s49
s_lshr_b32 s48, s2, 3
s_lshl_b32 s48, s48, 2
s_add_u32 s48, s48, s43
s_lshl_b32 s48, s48, 14
s_add_u32 s48, s48, 384
v_lshrrev_b32 v4, 3, v0
v_and_b32 v5, 7, v0
v_lshlrev_b32 v4, 11, v4
v_lshl_add_u32 v4, v5, 4, v4
v_add_u32 v15, s48, v4
s_mul_i32 s48, s42, 163840
s_add_u32 s48, s48, 9437184
s_lshl_b32 s49, s43, 4
s_add_u32 s49, s49, s41
s_lshl_b32 s50, s49, 11
s_add_u32 s86, s48, s50
s_lshl_b32 s50, s49, 9
s_add_u32 s89, s48, s50
s_add_u32 s89, s89, 131072
v_lshlrev_b32 v39, 3, v0
s_lshl_b32 s73, s42, 2
s_add_u32 s73, s73, 0
s_lshl_b32 s73, s73, 7
s_add_u32 s73, s73, 18366464
v_mov_b32 v12, 0
s_lshl_b32 s50, s43, 12
s_add_u32 s50, s50, s52
s_add_u32 s50, s50, 262144
v_min_u32 v8, 2, v3
v_lshlrev_b32 v8, 18, v8
v_lshl_add_u32 v8, v2, 4, v8
v_add_u32 v55, s50, v8
s_lshl_b32 s50, s42, 2
s_add_u32 s50, s50, s43
s_lshl_b32 s50, s50, 12
s_add_u32 s50, s50, 17825792
v_add_u32 v38, s50, v18
v_min_u32 v4, 2, v3
v_lshlrev_b32 v4, 8, v4
v_lshl_add_u32 v4, v2, 2, v4
s_and_b32 s48, s43, 1
s_lshl_b32 s48, s48, 7
s_lshr_b32 s49, s43, 1
s_lshl_b32 s49, s49, 6
s_add_u32 s48, s48, s49
s_add_u32 s48, s48, 133120
v_add_u32 v53, s48, v4
s_getpc_b64 s[98:99]
pc_1:
s_add_u32 s98, s98, c0_last - pc_1
s_addc_u32 s99, s99, 0
s_lshr_b32 s50, s2, 3
s_lshl_b32 s50, s50, 2
s_add_u32 s50, s50, s43
s_lshl_b32 s50, s50, 7
v_and_b32 v4, 1, v0
v_lshl_add_u32 v4, v4, 6, s50
v_min_u32 v54, L_code_end - c0_last, v4
s_add_u32 s69, s47, 0
s_and_b32 s69, s69, 3
s_add_u32 s69, s69, 4
s_mul_i32 s67, s69, 128
s_mul_i32 s68, s69, s54
s_add_u32 m0, s70, 40960
s_nop 0
buffer_load_dwordx4 v20, s[24:27], s67 offen offset:0  lds
buffer_load_dwordx4 v21, s[24:27], s67 offen offset:1024  lds
buffer_load_dwordx4 v22, s[24:27], s67 offen offset:2048  lds
buffer_load_dwordx4 v23, s[24:27], s67 offen offset:3072  lds
s_add_u32 s60, s71, 40960
s_add_u32 m0, s60, 0
s_mov_b32 s61, s68
buffer_load_dwordx4 v26, s[28:31], s61 offen lds
buffer_load_dwordx4 v27, s[28:31], s61 offen offset:1024 lds
s_add_u32 m0, s60, 8192
s_add_u32 s61, s61, s53
buffer_load_dwordx4 v26, s[28:31], s61 offen lds
buffer_load_dwordx4 v27, s[28:31], s61 offen offset:1024 lds
s_add_u32 m0, s60, 16384
s_add_u32 s61, s61, s53
buffer_load_dwordx4 v26, s[28:31], s61 offen lds
buffer_load_dwordx4 v27, s[28:31], s61 offen offset:1024 lds
s_waitcnt vmcnt(10)
s_barrier
s_cmp_lg_u32 s43, 3
s_cbranch_scc1 else_2
s_atomic_add_x2 s[94:95], s[20:21], s96
else_2:
s_add_u32 s49, s76, 0
s_and_b32 s49, s49, 3
s_add_u32 s49, s49, 8
s_mul_i32 s49, s49, 393216
buffer_load_dwordx4 v[40:43], v36, s[28:31], s49 offen
s_add_u32 s49, s76, 0
s_and_b32 s49, s49, 3
s_add_u32 s49, s49, 12
s_mul_i32 s49, s49, 393216
buffer_load_dwordx4 v[40:43], v36, s[28:31], s49 offen
s_add_u32 s69, s47, 0
s_and_b32 s69, s69, 3
s_add_u32 s69, s69, 8
s_mul_i32 s67, s69, 128
s_mul_i32 s68, s69, s54
s_add_u32 m0, s70, 81920
s_nop 0
buffer_load_dwordx4 v20, s[24:27], s67 offen offset:0  lds
buffer_load_dwordx4 v21, s[24:27], s67 offen offset:1024  lds
buffer_load_dwordx4 v22, s[24:27], s67 offen offset:2048  lds
buffer_load_dwordx4 v23, s[24:27], s67 offen offset:3072  lds
s_add_u32 s60, s71, 81920
s_add_u32 m0, s60, 0
s_mov_b32 s61, s68
buffer_load_dwordx4 v26, s[28:31], s61 offen lds
buffer_load_dwordx4 v27, s[28:31], s61 offen offset:1024 lds
s_add_u32 m0, s60, 8192
s_add_u32 s61, s61, s53
buffer_load_dwordx4 v26, s[28:31], s61 offen lds
buffer_load_dwordx4 v27, s[28:31], s61 offen offset:1024 lds
s_add_u32 m0, s60, 16384
s_add_u32 s61, s61, s53
buffer_load_dwordx4 v26, s[28:31], s61 offen lds
buffer_load_dwordx4 v27, s[28:31], s61 offen offset:1024 lds
s_add_u32 s49, s76, 1
s_and_b32 s49, s49, 3
s_add_u32 s49, s49, 0
s_mul_i32 s49, s49, 393216
buffer_load_dwordx4 v[40:43], v36, s[28:31], s49 offen
s_mov_b32 s64, 0
s_mov_b32 s65, 0
s_waitcnt vmcnt(11)
s_barrier
s_add_u32 s69, s47, 0
s_and_b32 s69, s69, 3
s_add_u32 s69, s69, 12
s_mul_i32 s67, s69, 128
s_mul_i32 s68, s69, s54
s_add_u32 m0, s70, s65
s_nop 0
buffer_load_dwordx4 v20, s[24:27], s67 offen offset:0  lds
buffer_load_dwordx4 v21, s[24:27], s67 offen offset:1024  lds
buffer_load_dwordx4 v22, s[24:27], s67 offen offset:2048  lds
buffer_load_dwordx4 v23, s[24:27], s67 offen offset:3072  lds
s_add_u32 s60, s71, s65
s_add_u32 m0, s60, 0
s_mov_b32 s61, s68
buffer_load_dwordx4 v26, s[28:31], s61 offen lds
buffer_load_dwordx4 v27, s[28:31], s61 offen offset:1024 lds
s_add_u32 m0, s60, 8192
s_add_u32 s61, s61, s53
buffer_load_dwordx4 v26, s[28:31], s61 offen lds
buffer_load_dwordx4 v27, s[28:31], s61 offen offset:1024 lds
s_add_u32 m0, s60, 16384
s_add_u32 s61, s61, s53
buffer_load_dwordx4 v26, s[28:31], s61 offen lds
buffer_load_dwordx4 v27, s[28:31], s61 offen offset:1024 lds
s_add_u32 s49, s76, 1
s_and_b32 s49, s49, 3
s_add_u32 s49, s49, 4
s_mul_i32 s49, s49, 393216
buffer_load_dwordx4 v[40:43], v36, s[28:31], s49 offen
s_add_u32 s65, s65, 40960
s_cmp_eq_u32 s65, 122880
s_cselect_b32 s65, 0, s65
s_add_u32 s64, s64, 1
s_waitcnt vmcnt(11)
s_barrier
s_add_u32 s69, s47, 1
s_and_b32 s69, s69, 3
s_add_u32 s69, s69, 0
s_mul_i32 s67, s69, 128
s_mul_i32 s68, s69, s54
s_add_u32 m0, s70, s65
s_nop 0
buffer_load_dwordx4 v20, s[24:27], s67 offen offset:0  lds
buffer_load_dwordx4 v21, s[24:27], s67 offen offset:1024  lds
buffer_load_dwordx4 v22, s[24:27], s67 offen offset:2048  lds
buffer_load_dwordx4 v23, s[24:27], s67 offen offset:3072  lds
s_add_u32 s60, s71, s65
s_add_u32 m0, s60, 0
s_mov_b32 s61, s68
buffer_load_dwordx4 v26, s[28:31], s61 offen lds
buffer_load_dwordx4 v27, s[28:31], s61 offen offset:1024 lds
s_add_u32 m0, s60, 8192
s_add_u32 s61, s61, s53
buffer_load_dwordx4 v26, s[28:31], s61 offen lds
buffer_load_dwordx4 v27, s[28:31], s61 offen offset:1024 lds
s_add_u32 m0, s60, 16384
s_add_u32 s61, s61, s53
buffer_load_dwordx4 v26, s[28:31], s61 offen lds
buffer_load_dwordx4 v27, s[28:31], s61 offen offset:1024 lds
s_add_u32 s49, s76, 1
s_and_b32 s49, s49, 3
s_add_u32 s49, s49, 8
s_mul_i32 s49, s49, 393216
buffer_load_dwordx4 v[40:43], v36, s[28:31], s49 offen
s_add_u32 s65, s65, 40960
s_cmp_eq_u32 s65, 122880
s_cselect_b32 s65, 0, s65
s_add_u32 s64, s64, 1
s_waitcnt vmcnt(11)
s_barrier
s_add_u32 s69, s47, 1
s_and_b32 s69, s69, 3
s_add_u32 s69, s69, 4
s_mul_i32 s67, s69, 128
s_mul_i32 s68, s69, s54
s_add_u32 m0, s70, s65
s_nop 0
buffer_load_dwordx4 v20, s[24:27], s67 offen offset:0  lds
buffer_load_dwordx4 v21, s[24:27], s67 offen offset:1024  lds
buffer_load_dwordx4 v22, s[24:27], s67 offen offset:2048  lds
buffer_load_dwordx4 v23, s[24:27], s67 offen offset:3072  lds
s_add_u32 s60, s71, s65
s_add_u32 m0, s60, 0
s_mov_b32 s61, s68
buffer_load_dwordx4 v26, s[28:31], s61 offen lds
buffer_load_dwordx4 v27, s[28:31], s61 offen offset:1024 lds
s_add_u32 m0, s60, 8192
s_add_u32 s61, s61, s53
buffer_load_dwordx4 v26, s[28:31], s61 offen lds
buffer_load_dwordx4 v27, s[28:31], s61 offen offset:1024 lds
s_add_u32 m0, s60, 16384
s_add_u32 s61, s61, s53
buffer_load_dwordx4 v26, s[28:31], s61 offen lds
buffer_load_dwordx4 v27, s[28:31], s61 offen offset:1024 lds
s_add_u32 s49, s76, 1
s_and_b32 s49, s49, 3
s_add_u32 s49, s49, 12
s_mul_i32 s49, s49, 393216
buffer_load_dwordx4 v[40:43], v36, s[28:31], s49 offen
s_add_u32 s65, s65, 40960
s_cmp_eq_u32 s65, 122880
s_cselect_b32 s65, 0, s65
s_add_u32 s64, s64, 1
s_waitcnt vmcnt(11)
s_barrier
s_cmp_lg_u32 s88, 0
s_cbranch_scc1 else_4
s_add_u32 s48, s75, 3
s_and_b32 s48, s48, 15
s_mul_i32 s48, s48, s57
buffer_load_dwordx4 v[136:139], v28, s[36:39], s48 offen
buffer_load_dwordx4 v[140:143], v29, s[36:39], s48 offen offset:1024
s_add_u32 s48, s75, 4
s_and_b32 s48, s48, 15
s_mul_i32 s48, s48, s57
buffer_load_dwordx4 v[144:147], v28, s[36:39], s48 offen
buffer_load_dwordx4 v[148:151], v29, s[36:39], s48 offen offset:1024
s_mov_b32 s36, s12
s_and_b32 s37, s13, 0xffff
s_mov_b32 s38, 6291456
s_mov_b32 s39, 0x00020000
s_add_u32 m0, s71, 122880
s_add_u32 s48, s83, 0
buffer_load_dwordx4 v60, s[36:39], s48 offen lds
buffer_load_dwordx4 v61, s[36:39], s48 offen offset:1024 lds
s_add_u32 m0, s71, 131072
s_add_u32 s48, s83, 2048
buffer_load_dwordx4 v60, s[36:39], s48 offen lds
buffer_load_dwordx4 v61, s[36:39], s48 offen offset:1024 lds
s_add_u32 m0, s71, 139264
s_add_u32 s48, s83, 4096
buffer_load_dwordx4 v60, s[36:39], s48 offen lds
buffer_load_dwordx4 v61, s[36:39], s48 offen offset:1024 lds
s_add_u32 s48, s87, 0
buffer_load_dwordx4 v[108:111], v63, s[36:39], s48 offen
s_add_u32 s48, s87, 2048
buffer_load_dwordx4 v[108:111], v63, s[36:39], s48 offen
s_add_u32 s48, s87, 4096
buffer_load_dwordx4 v[108:111], v63, s[36:39], s48 offen
s_mov_b32 s36, s8
s_and_b32 s37, s9, 0xffff
s_mov_b32 s38, 2097152
s_mov_b32 s39, 0x00020000
buffer_store_dwordx4 v[56:59], v18, s[32:35], s86 offen offset:0 sc1
buffer_store_dwordx4 v[56:59], v18, s[32:35], s86 offen offset:1024 sc1
buffer_store_dwordx2 v[56:57], v39, s[32:35], s89 offen sc1
buffer_store_dwordx4 v[56:59], v55, s[32:35], 0 offen sc1
else_4:
s_add_u32 s69, s47, 1
s_and_b32 s69, s69, 3
s_add_u32 s69, s69, 8
s_mul_i32 s67, s69, 128
s_mul_i32 s68, s69, s54
s_add_u32 m0, s70, s65
s_nop 0
buffer_load_dwordx4 v20, s[24:27], s67 offen offset:0  lds
buffer_load_dwordx4 v21, s[24:27], s67 offen offset:1024  lds
buffer_load_dwordx4 v22, s[24:27], s67 offen offset:2048  lds
buffer_load_dwordx4 v23, s[24:27], s67 offen offset:3072  lds
s_add_u32 s60, s71, s65
s_add_u32 m0, s60, 0
s_mov_b32 s61, s68
buffer_load_dwordx4 v26, s[28:31], s61 offen lds
buffer_load_dwordx4 v27, s[28:31], s61 offen offset:1024 lds
s_add_u32 m0, s60, 8192
s_add_u32 s61, s61, s53
buffer_load_dwordx4 v26, s[28:31], s61 offen lds
buffer_load_dwordx4 v27, s[28:31], s61 offen offset:1024 lds
s_add_u32 m0, s60, 16384
s_add_u32 s61, s61, s53
buffer_load_dwordx4 v26, s[28:31], s61 offen lds
buffer_load_dwordx4 v27, s[28:31], s61 offen offset:1024 lds
s_add_u32 s49, s76, 2
s_and_b32 s49, s49, 3
s_add_u32 s49, s49, 0
s_mul_i32 s49, s49, 393216
buffer_load_dwordx4 v[40:43], v36, s[28:31], s49 offen
s_add_u32 s65, s65, 40960
s_cmp_eq_u32 s65, 122880
s_cselect_b32 s65, 0, s65
s_add_u32 s64, s64, 1
s_waitcnt vmcnt(11)
s_barrier
s_cmp_lg_u32 s88, 1
s_cbranch_scc1 else_6
s_add_u32 s48, s75, 3
s_and_b32 s48, s48, 15
s_mul_i32 s48, s48, s57
buffer_load_dwordx4 v[136:139], v28, s[36:39], s48 offen
buffer_load_dwordx4 v[140:143], v29, s[36:39], s48 offen offset:1024
s_add_u32 s48, s75, 4
s_and_b32 s48, s48, 15
s_mul_i32 s48, s48, s57
buffer_load_dwordx4 v[144:147], v28, s[36:39], s48 offen
buffer_load_dwordx4 v[148:151], v29, s[36:39], s48 offen offset:1024
s_mov_b32 s36, s12
s_and_b32 s37, s13, 0xffff
s_mov_b32 s38, 6291456
s_mov_b32 s39, 0x00020000
s_add_u32 m0, s71, 122880
s_add_u32 s48, s83, 0
buffer_load_dwordx4 v60, s[36:39], s48 offen lds
buffer_load_dwordx4 v61, s[36:39], s48 offen offset:1024 lds
s_add_u32 m0, s71, 131072
s_add_u32 s48, s83, 2048
buffer_load_dwordx4 v60, s[36:39], s48 offen lds
buffer_load_dwordx4 v61, s[36:39], s48 offen offset:1024 lds
s_add_u32 m0, s71, 139264
s_add_u32 s48, s83, 4096
buffer_load_dwordx4 v60, s[36:39], s48 offen lds
buffer_load_dwordx4 v61, s[36:39], s48 offen offset:1024 lds
s_add_u32 s48, s87, 0
buffer_load_dwordx4 v[108:111], v63, s[36:39], s48 offen
s_add_u32 s48, s87, 2048
buffer_load_dwordx4 v[108:111], v63, s[36:39], s48 offen
s_add_u32 s48, s87, 4096
buffer_load_dwordx4 v[108:111], v63, s[36:39], s48 offen
s_mov_b32 s36, s8
s_and_b32 s37, s9, 0xffff
s_mov_b32 s38, 2097152
s_mov_b32 s39, 0x00020000
buffer_store_dwordx4 v[56:59], v18, s[32:35], s86 offen offset:0 sc1
buffer_store_dwordx4 v[56:59], v18, s[32:35], s86 offen offset:1024 sc1
buffer_store_dwordx2 v[56:57], v39, s[32:35], s89 offen sc1
buffer_store_dwordx4 v[56:59], v55, s[32:35], 0 offen sc1
else_6:
s_add_u32 s69, s47, 1
s_and_b32 s69, s69, 3
s_add_u32 s69, s69, 12
s_mul_i32 s67, s69, 128
s_mul_i32 s68, s69, s54
s_add_u32 m0, s70, s65
s_nop 0
buffer_load_dwordx4 v20, s[24:27], s67 offen offset:0  lds
buffer_load_dwordx4 v21, s[24:27], s67 offen offset:1024  lds
buffer_load_dwordx4 v22, s[24:27], s67 offen offset:2048  lds
buffer_load_dwordx4 v23, s[24:27], s67 offen offset:3072  lds
s_add_u32 s60, s71, s65
s_add_u32 m0, s60, 0
s_mov_b32 s61, s68
buffer_load_dwordx4 v26, s[28:31], s61 offen lds
buffer_load_dwordx4 v27, s[28:31], s61 offen offset:1024 lds
s_add_u32 m0, s60, 8192
s_add_u32 s61, s61, s53
buffer_load_dwordx4 v26, s[28:31], s61 offen lds
buffer_load_dwordx4 v27, s[28:31], s61 offen offset:1024 lds
s_add_u32 m0, s60, 16384
s_add_u32 s61, s61, s53
buffer_load_dwordx4 v26, s[28:31], s61 offen lds
buffer_load_dwordx4 v27, s[28:31], s61 offen offset:1024 lds
s_add_u32 s49, s76, 2
s_and_b32 s49, s49, 3
s_add_u32 s49, s49, 4
s_mul_i32 s49, s49, 393216
buffer_load_dwordx4 v[40:43], v36, s[28:31], s49 offen
s_add_u32 s65, s65, 40960
s_cmp_eq_u32 s65, 122880
s_cselect_b32 s65, 0, s65
s_add_u32 s64, s64, 1
s_waitcnt vmcnt(11)
s_barrier
s_cmp_lg_u32 s88, 2
s_cbranch_scc1 else_8
s_add_u32 s48, s75, 3
s_and_b32 s48, s48, 15
s_mul_i32 s48, s48, s57
buffer_load_dwordx4 v[136:139], v28, s[36:39], s48 offen
buffer_load_dwordx4 v[140:143], v29, s[36:39], s48 offen offset:1024
s_add_u32 s48, s75, 4
s_and_b32 s48, s48, 15
s_mul_i32 s48, s48, s57
buffer_load_dwordx4 v[144:147], v28, s[36:39], s48 offen
buffer_load_dwordx4 v[148:151], v29, s[36:39], s48 offen offset:1024
s_mov_b32 s36, s12
s_and_b32 s37, s13, 0xffff
s_mov_b32 s38, 6291456
s_mov_b32 s39, 0x00020000
s_add_u32 m0, s71, 122880
s_add_u32 s48, s83, 0
buffer_load_dwordx4 v60, s[36:39], s48 offen lds
buffer_load_dwordx4 v61, s[36:39], s48 offen offset:1024 lds
s_add_u32 m0, s71, 131072
s_add_u32 s48, s83, 2048
buffer_load_dwordx4 v60, s[36:39], s48 offen lds
buffer_load_dwordx4 v61, s[36:39], s48 offen offset:1024 lds
s_add_u32 m0, s71, 139264
s_add_u32 s48, s83, 4096
buffer_load_dwordx4 v60, s[36:39], s48 offen lds
buffer_load_dwordx4 v61, s[36:39], s48 offen offset:1024 lds
s_add_u32 s48, s87, 0
buffer_load_dwordx4 v[108:111], v63, s[36:39], s48 offen
s_add_u32 s48, s87, 2048
buffer_load_dwordx4 v[108:111], v63, s[36:39], s48 offen
s_add_u32 s48, s87, 4096
buffer_load_dwordx4 v[108:111], v63, s[36:39], s48 offen
s_mov_b32 s36, s8
s_and_b32 s37, s9, 0xffff
s_mov_b32 s38, 2097152
s_mov_b32 s39, 0x00020000
buffer_store_dwordx4 v[56:59], v18, s[32:35], s86 offen offset:0 sc1
buffer_store_dwordx4 v[56:59], v18, s[32:35], s86 offen offset:1024 sc1
buffer_store_dwordx2 v[56:57], v39, s[32:35], s89 offen sc1
buffer_store_dwordx4 v[56:59], v55, s[32:35], 0 offen sc1
else_8:
s_add_u32 s69, s47, 2
s_and_b32 s69, s69, 3
s_add_u32 s69, s69, 0
s_mul_i32 s67, s69, 128
s_mul_i32 s68, s69, s54
s_add_u32 m0, s70, s65
s_nop 0
buffer_load_dwordx4 v20, s[24:27], s67 offen offset:0  lds
buffer_load_dwordx4 v21, s[24:27], s67 offen offset:1024  lds
buffer_load_dwordx4 v22, s[24:27], s67 offen offset:2048  lds
buffer_load_dwordx4 v23, s[24:27], s67 offen offset:3072  lds
s_add_u32 s60, s71, s65
s_add_u32 m0, s60, 0
s_mov_b32 s61, s68
buffer_load_dwordx4 v26, s[28:31], s61 offen lds
buffer_load_dwordx4 v27, s[28:31], s61 offen offset:1024 lds
s_add_u32 m0, s60, 8192
s_add_u32 s61, s61, s53
buffer_load_dwordx4 v26, s[28:31], s61 offen lds
buffer_load_dwordx4 v27, s[28:31], s61 offen offset:1024 lds
s_add_u32 m0, s60, 16384
s_add_u32 s61, s61, s53
buffer_load_dwordx4 v26, s[28:31], s61 offen lds
buffer_load_dwordx4 v27, s[28:31], s61 offen offset:1024 lds
s_add_u32 s49, s76, 2
s_and_b32 s49, s49, 3
s_add_u32 s49, s49, 8
s_mul_i32 s49, s49, 393216
buffer_load_dwordx4 v[40:43], v36, s[28:31], s49 offen
s_add_u32 s65, s65, 40960
s_cmp_eq_u32 s65, 122880
s_cselect_b32 s65, 0, s65
s_add_u32 s64, s64, 1
s_waitcnt vmcnt(11)
s_barrier
s_cmp_lg_u32 s88, 3
s_cbranch_scc1 else_10
s_add_u32 s48, s75, 3
s_and_b32 s48, s48, 15
s_mul_i32 s48, s48, s57
buffer_load_dwordx4 v[136:139], v28, s[36:39], s48 offen
buffer_load_dwordx4 v[140:143], v29, s[36:39], s48 offen offset:1024
s_add_u32 s48, s75, 4
s_and_b32 s48, s48, 15
s_mul_i32 s48, s48, s57
buffer_load_dwordx4 v[144:147], v28, s[36:39], s48 offen
buffer_load_dwordx4 v[148:151], v29, s[36:39], s48 offen offset:1024
s_mov_b32 s36, s12
s_and_b32 s37, s13, 0xffff
s_mov_b32 s38, 6291456
s_mov_b32 s39, 0x00020000
s_add_u32 m0, s71, 122880
s_add_u32 s48, s83, 0
buffer_load_dwordx4 v60, s[36:39], s48 offen lds
buffer_load_dwordx4 v61, s[36:39], s48 offen offset:1024 lds
s_add_u32 m0, s71, 131072
s_add_u32 s48, s83, 2048
buffer_load_dwordx4 v60, s[36:39], s48 offen lds
buffer_load_dwordx4 v61, s[36:39], s48 offen offset:1024 lds
s_add_u32 m0, s71, 139264
s_add_u32 s48, s83, 4096
buffer_load_dwordx4 v60, s[36:39], s48 offen lds
buffer_load_dwordx4 v61, s[36:39], s48 offen offset:1024 lds
s_add_u32 s48, s87, 0
buffer_load_dwordx4 v[108:111], v63, s[36:39], s48 offen
s_add_u32 s48, s87, 2048
buffer_load_dwordx4 v[108:111], v63, s[36:39], s48 offen
s_add_u32 s48, s87, 4096
buffer_load_dwordx4 v[108:111], v63, s[36:39], s48 offen
s_mov_b32 s36, s8
s_and_b32 s37, s9, 0xffff
s_mov_b32 s38, 2097152
s_mov_b32 s39, 0x00020000
buffer_store_dwordx4 v[56:59], v18, s[32:35], s86 offen offset:0 sc1
buffer_store_dwordx4 v[56:59], v18, s[32:35], s86 offen offset:1024 sc1
buffer_store_dwordx2 v[56:57], v39, s[32:35], s89 offen sc1
buffer_store_dwordx4 v[56:59], v55, s[32:35], 0 offen sc1
else_10:
s_add_u32 s69, s47, 2
s_and_b32 s69, s69, 3
s_add_u32 s69, s69, 4
s_mul_i32 s67, s69, 128
s_mul_i32 s68, s69, s54
s_add_u32 m0, s70, s65
s_nop 0
buffer_load_dwordx4 v20, s[24:27], s67 offen offset:0  lds
buffer_load_dwordx4 v21, s[24:27], s67 offen offset:1024  lds
buffer_load_dwordx4 v22, s[24:27], s67 offen offset:2048  lds
buffer_load_dwordx4 v23, s[24:27], s67 offen offset:3072  lds
s_add_u32 s60, s71, s65
s_add_u32 m0, s60, 0
s_mov_b32 s61, s68
buffer_load_dwordx4 v26, s[28:31], s61 offen lds
buffer_load_dwordx4 v27, s[28:31], s61 offen offset:1024 lds
s_add_u32 m0, s60, 8192
s_add_u32 s61, s61, s53
buffer_load_dwordx4 v26, s[28:31], s61 offen lds
buffer_load_dwordx4 v27, s[28:31], s61 offen offset:1024 lds
s_add_u32 m0, s60, 16384
s_add_u32 s61, s61, s53
buffer_load_dwordx4 v26, s[28:31], s61 offen lds
buffer_load_dwordx4 v27, s[28:31], s61 offen offset:1024 lds
s_add_u32 s49, s76, 2
s_and_b32 s49, s49, 3
s_add_u32 s49, s49, 12
s_mul_i32 s49, s49, 393216
buffer_load_dwordx4 v[40:43], v36, s[28:31], s49 offen
s_add_u32 s65, s65, 40960
s_cmp_eq_u32 s65, 122880
s_cselect_b32 s65, 0, s65
s_add_u32 s64, s64, 1
s_waitcnt vmcnt(11)
s_barrier
s_cmp_lg_u32 s88, 4
s_cbranch_scc1 else_12
s_add_u32 s48, s75, 3
s_and_b32 s48, s48, 15
s_mul_i32 s48, s48, s57
buffer_load_dwordx4 v[136:139], v28, s[36:39], s48 offen
buffer_load_dwordx4 v[140:143], v29, s[36:39], s48 offen offset:1024
s_add_u32 s48, s75, 4
s_and_b32 s48, s48, 15
s_mul_i32 s48, s48, s57
buffer_load_dwordx4 v[144:147], v28, s[36:39], s48 offen
buffer_load_dwordx4 v[148:151], v29, s[36:39], s48 offen offset:1024
s_mov_b32 s36, s12
s_and_b32 s37, s13, 0xffff
s_mov_b32 s38, 6291456
s_mov_b32 s39, 0x00020000
s_add_u32 m0, s71, 122880
s_add_u32 s48, s83, 0
buffer_load_dwordx4 v60, s[36:39], s48 offen lds
buffer_load_dwordx4 v61, s[36:39], s48 offen offset:1024 lds
s_add_u32 m0, s71, 131072
s_add_u32 s48, s83, 2048
buffer_load_dwordx4 v60, s[36:39], s48 offen lds
buffer_load_dwordx4 v61, s[36:39], s48 offen offset:1024 lds
s_add_u32 m0, s71, 139264
s_add_u32 s48, s83, 4096
buffer_load_dwordx4 v60, s[36:39], s48 offen lds
buffer_load_dwordx4 v61, s[36:39], s48 offen offset:1024 lds
s_add_u32 s48, s87, 0
buffer_load_dwordx4 v[108:111], v63, s[36:39], s48 offen
s_add_u32 s48, s87, 2048
buffer_load_dwordx4 v[108:111], v63, s[36:39], s48 offen
s_add_u32 s48, s87, 4096
buffer_load_dwordx4 v[108:111], v63, s[36:39], s48 offen
s_mov_b32 s36, s8
s_and_b32 s37, s9, 0xffff
s_mov_b32 s38, 2097152
s_mov_b32 s39, 0x00020000
buffer_store_dwordx4 v[56:59], v18, s[32:35], s86 offen offset:0 sc1
buffer_store_dwordx4 v[56:59], v18, s[32:35], s86 offen offset:1024 sc1
buffer_store_dwordx2 v[56:57], v39, s[32:35], s89 offen sc1
buffer_store_dwordx4 v[56:59], v55, s[32:35], 0 offen sc1
else_12:
s_add_u32 s69, s47, 2
s_and_b32 s69, s69, 3
s_add_u32 s69, s69, 8
s_mul_i32 s67, s69, 128
s_mul_i32 s68, s69, s54
s_add_u32 m0, s70, s65
s_nop 0
buffer_load_dwordx4 v20, s[24:27], s67 offen offset:0  lds
buffer_load_dwordx4 v21, s[24:27], s67 offen offset:1024  lds
buffer_load_dwordx4 v22, s[24:27], s67 offen offset:2048  lds
buffer_load_dwordx4 v23, s[24:27], s67 offen offset:3072  lds
s_add_u32 s60, s71, s65
s_add_u32 m0, s60, 0
s_mov_b32 s61, s68
buffer_load_dwordx4 v26, s[28:31], s61 offen lds
buffer_load_dwordx4 v27, s[28:31], s61 offen offset:1024 lds
s_add_u32 m0, s60, 8192
s_add_u32 s61, s61, s53
buffer_load_dwordx4 v26, s[28:31], s61 offen lds
buffer_load_dwordx4 v27, s[28:31], s61 offen offset:1024 lds
s_add_u32 m0, s60, 16384
s_add_u32 s61, s61, s53
buffer_load_dwordx4 v26, s[28:31], s61 offen lds
buffer_load_dwordx4 v27, s[28:31], s61 offen offset:1024 lds
s_add_u32 s49, s76, 3
s_and_b32 s49, s49, 3
s_add_u32 s49, s49, 0
s_mul_i32 s49, s49, 393216
buffer_load_dwordx4 v[40:43], v36, s[28:31], s49 offen
s_add_u32 s65, s65, 40960
s_cmp_eq_u32 s65, 122880
s_cselect_b32 s65, 0, s65
s_add_u32 s64, s64, 1
s_waitcnt vmcnt(11)
s_barrier
s_cmp_lg_u32 s88, 5
s_cbranch_scc1 else_14
s_add_u32 s48, s75, 3
s_and_b32 s48, s48, 15
s_mul_i32 s48, s48, s57
buffer_load_dwordx4 v[136:139], v28, s[36:39], s48 offen
buffer_load_dwordx4 v[140:143], v29, s[36:39], s48 offen offset:1024
s_add_u32 s48, s75, 4
s_and_b32 s48, s48, 15
s_mul_i32 s48, s48, s57
buffer_load_dwordx4 v[144:147], v28, s[36:39], s48 offen
buffer_load_dwordx4 v[148:151], v29, s[36:39], s48 offen offset:1024
s_mov_b32 s36, s12
s_and_b32 s37, s13, 0xffff
s_mov_b32 s38, 6291456
s_mov_b32 s39, 0x00020000
s_add_u32 m0, s71, 122880
s_add_u32 s48, s83, 0
buffer_load_dwordx4 v60, s[36:39], s48 offen lds
buffer_load_dwordx4 v61, s[36:39], s48 offen offset:1024 lds
s_add_u32 m0, s71, 131072
s_add_u32 s48, s83, 2048
buffer_load_dwordx4 v60, s[36:39], s48 offen lds
buffer_load_dwordx4 v61, s[36:39], s48 offen offset:1024 lds
s_add_u32 m0, s71, 139264
s_add_u32 s48, s83, 4096
buffer_load_dwordx4 v60, s[36:39], s48 offen lds
buffer_load_dwordx4 v61, s[36:39], s48 offen offset:1024 lds
s_add_u32 s48, s87, 0
buffer_load_dwordx4 v[108:111], v63, s[36:39], s48 offen
s_add_u32 s48, s87, 2048
buffer_load_dwordx4 v[108:111], v63, s[36:39], s48 offen
s_add_u32 s48, s87, 4096
buffer_load_dwordx4 v[108:111], v63, s[36:39], s48 offen
s_mov_b32 s36, s8
s_and_b32 s37, s9, 0xffff
s_mov_b32 s38, 2097152
s_mov_b32 s39, 0x00020000
buffer_store_dwordx4 v[56:59], v18, s[32:35], s86 offen offset:0 sc1
buffer_store_dwordx4 v[56:59], v18, s[32:35], s86 offen offset:1024 sc1
buffer_store_dwordx2 v[56:57], v39, s[32:35], s89 offen sc1
buffer_store_dwordx4 v[56:59], v55, s[32:35], 0 offen sc1
else_14:
s_add_u32 s69, s47, 2
s_and_b32 s69, s69, 3
s_add_u32 s69, s69, 12
s_mul_i32 s67, s69, 128
s_mul_i32 s68, s69, s54
s_add_u32 m0, s70, s65
s_nop 0
buffer_load_dwordx4 v20, s[24:27], s67 offen offset:0  lds
buffer_load_dwordx4 v21, s[24:27], s67 offen offset:1024  lds
buffer_load_dwordx4 v22, s[24:27], s67 offen offset:2048  lds
buffer_load_dwordx4 v23, s[24:27], s67 offen offset:3072  lds
s_add_u32 s60, s71, s65
s_add_u32 m0, s60, 0
s_mov_b32 s61, s68
buffer_load_dwordx4 v26, s[28:31], s61 offen lds
buffer_load_dwordx4 v27, s[28:31], s61 offen offset:1024 lds
s_add_u32 m0, s60, 8192
s_add_u32 s61, s61, s53
buffer_load_dwordx4 v26, s[28:31], s61 offen lds
buffer_load_dwordx4 v27, s[28:31], s61 offen offset:1024 lds
s_add_u32 m0, s60, 16384
s_add_u32 s61, s61, s53
buffer_load_dwordx4 v26, s[28:31], s61 offen lds
buffer_load_dwordx4 v27, s[28:31], s61 offen offset:1024 lds
s_add_u32 s49, s76, 3
s_and_b32 s49, s49, 3
s_add_u32 s49, s49, 4
s_mul_i32 s49, s49, 393216
buffer_load_dwordx4 v[40:43], v36, s[28:31], s49 offen
s_add_u32 s65, s65, 40960
s_cmp_eq_u32 s65, 122880
s_cselect_b32 s65, 0, s65
s_add_u32 s64, s64, 1
s_waitcnt vmcnt(11)
s_barrier
s_cmp_lg_u32 s88, 6
s_cbranch_scc1 else_16
s_add_u32 s48, s75, 3
s_and_b32 s48, s48, 15
s_mul_i32 s48, s48, s57
buffer_load_dwordx4 v[136:139], v28, s[36:39], s48 offen
buffer_load_dwordx4 v[140:143], v29, s[36:39], s48 offen offset:1024
s_add_u32 s48, s75, 4
s_and_b32 s48, s48, 15
s_mul_i32 s48, s48, s57
buffer_load_dwordx4 v[144:147], v28, s[36:39], s48 offen
buffer_load_dwordx4 v[148:151], v29, s[36:39], s48 offen offset:1024
s_mov_b32 s36, s12
s_and_b32 s37, s13, 0xffff
s_mov_b32 s38, 6291456
s_mov_b32 s39, 0x00020000
s_add_u32 m0, s71, 122880
s_add_u32 s48, s83, 0
buffer_load_dwordx4 v60, s[36:39], s48 offen lds
buffer_load_dwordx4 v61, s[36:39], s48 offen offset:1024 lds
s_add_u32 m0, s71, 131072
s_add_u32 s48, s83, 2048
buffer_load_dwordx4 v60, s[36:39], s48 offen lds
buffer_load_dwordx4 v61, s[36:39], s48 offen offset:1024 lds
s_add_u32 m0, s71, 139264
s_add_u32 s48, s83, 4096
buffer_load_dwordx4 v60, s[36:39], s48 offen lds
buffer_load_dwordx4 v61, s[36:39], s48 offen offset:1024 lds
s_add_u32 s48, s87, 0
buffer_load_dwordx4 v[108:111], v63, s[36:39], s48 offen
s_add_u32 s48, s87, 2048
buffer_load_dwordx4 v[108:111], v63, s[36:39], s48 offen
s_add_u32 s48, s87, 4096
buffer_load_dwordx4 v[108:111], v63, s[36:39], s48 offen
s_mov_b32 s36, s8
s_and_b32 s37, s9, 0xffff
s_mov_b32 s38, 2097152
s_mov_b32 s39, 0x00020000
buffer_store_dwordx4 v[56:59], v18, s[32:35], s86 offen offset:0 sc1
buffer_store_dwordx4 v[56:59], v18, s[32:35], s86 offen offset:1024 sc1
buffer_store_dwordx2 v[56:57], v39, s[32:35], s89 offen sc1
buffer_store_dwordx4 v[56:59], v55, s[32:35], 0 offen sc1
else_16:
s_add_u32 s69, s47, 3
s_and_b32 s69, s69, 3
s_add_u32 s69, s69, 0
s_mul_i32 s67, s69, 128
s_mul_i32 s68, s69, s54
s_add_u32 m0, s70, s65
s_nop 0
buffer_load_dwordx4 v20, s[24:27], s67 offen offset:0  lds
buffer_load_dwordx4 v21, s[24:27], s67 offen offset:1024  lds
buffer_load_dwordx4 v22, s[24:27], s67 offen offset:2048  lds
buffer_load_dwordx4 v23, s[24:27], s67 offen offset:3072  lds
s_add_u32 s60, s71, s65
s_add_u32 m0, s60, 0
s_mov_b32 s61, s68
buffer_load_dwordx4 v26, s[28:31], s61 offen lds
buffer_load_dwordx4 v27, s[28:31], s61 offen offset:1024 lds
s_add_u32 m0, s60, 8192
s_add_u32 s61, s61, s53
buffer_load_dwordx4 v26, s[28:31], s61 offen lds
buffer_load_dwordx4 v27, s[28:31], s61 offen offset:1024 lds
s_add_u32 m0, s60, 16384
s_add_u32 s61, s61, s53
buffer_load_dwordx4 v26, s[28:31], s61 offen lds
buffer_load_dwordx4 v27, s[28:31], s61 offen offset:1024 lds
s_add_u32 s49, s76, 3
s_and_b32 s49, s49, 3
s_add_u32 s49, s49, 8
s_mul_i32 s49, s49, 393216
buffer_load_dwordx4 v[40:43], v36, s[28:31], s49 offen
s_add_u32 s65, s65, 40960
s_cmp_eq_u32 s65, 122880
s_cselect_b32 s65, 0, s65
s_add_u32 s64, s64, 1
s_waitcnt vmcnt(11)
s_barrier
s_cmp_lg_u32 s88, 7
s_cbranch_scc1 else_18
s_add_u32 s48, s75, 3
s_and_b32 s48, s48, 15
s_mul_i32 s48, s48, s57
buffer_load_dwordx4 v[136:139], v28, s[36:39], s48 offen
buffer_load_dwordx4 v[140:143], v29, s[36:39], s48 offen offset:1024
s_add_u32 s48, s75, 4
s_and_b32 s48, s48, 15
s_mul_i32 s48, s48, s57
buffer_load_dwordx4 v[144:147], v28, s[36:39], s48 offen
buffer_load_dwordx4 v[148:151], v29, s[36:39], s48 offen offset:1024
s_mov_b32 s36, s12
s_and_b32 s37, s13, 0xffff
s_mov_b32 s38, 6291456
s_mov_b32 s39, 0x00020000
s_add_u32 m0, s71, 122880
s_add_u32 s48, s83, 0
buffer_load_dwordx4 v60, s[36:39], s48 offen lds
buffer_load_dwordx4 v61, s[36:39], s48 offen offset:1024 lds
s_add_u32 m0, s71, 131072
s_add_u32 s48, s83, 2048
buffer_load_dwordx4 v60, s[36:39], s48 offen lds
buffer_load_dwordx4 v61, s[36:39], s48 offen offset:1024 lds
s_add_u32 m0, s71, 139264
s_add_u32 s48, s83, 4096
buffer_load_dwordx4 v60, s[36:39], s48 offen lds
buffer_load_dwordx4 v61, s[36:39], s48 offen offset:1024 lds
s_add_u32 s48, s87, 0
buffer_load_dwordx4 v[108:111], v63, s[36:39], s48 offen
s_add_u32 s48, s87, 2048
buffer_load_dwordx4 v[108:111], v63, s[36:39], s48 offen
s_add_u32 s48, s87, 4096
buffer_load_dwordx4 v[108:111], v63, s[36:39], s48 offen
s_mov_b32 s36, s8
s_and_b32 s37, s9, 0xffff
s_mov_b32 s38, 2097152
s_mov_b32 s39, 0x00020000
buffer_store_dwordx4 v[56:59], v18, s[32:35], s86 offen offset:0 sc1
buffer_store_dwordx4 v[56:59], v18, s[32:35], s86 offen offset:1024 sc1
buffer_store_dwordx2 v[56:57], v39, s[32:35], s89 offen sc1
buffer_store_dwordx4 v[56:59], v55, s[32:35], 0 offen sc1
else_18:
s_add_u32 s69, s47, 3
s_and_b32 s69, s69, 3
s_add_u32 s69, s69, 4
s_mul_i32 s67, s69, 128
s_mul_i32 s68, s69, s54
s_add_u32 m0, s70, s65
s_nop 0
buffer_load_dwordx4 v20, s[24:27], s67 offen offset:0  lds
buffer_load_dwordx4 v21, s[24:27], s67 offen offset:1024  lds
buffer_load_dwordx4 v22, s[24:27], s67 offen offset:2048  lds
buffer_load_dwordx4 v23, s[24:27], s67 offen offset:3072  lds
s_add_u32 s60, s71, s65
s_add_u32 m0, s60, 0
s_mov_b32 s61, s68
buffer_load_dwordx4 v26, s[28:31], s61 offen lds
buffer_load_dwordx4 v27, s[28:31], s61 offen offset:1024 lds
s_add_u32 m0, s60, 8192
s_add_u32 s61, s61, s53
buffer_load_dwordx4 v26, s[28:31], s61 offen lds
buffer_load_dwordx4 v27, s[28:31], s61 offen offset:1024 lds
s_add_u32 m0, s60, 16384
s_add_u32 s61, s61, s53
buffer_load_dwordx4 v26, s[28:31], s61 offen lds
buffer_load_dwordx4 v27, s[28:31], s61 offen offset:1024 lds
s_add_u32 s49, s76, 3
s_and_b32 s49, s49, 3
s_add_u32 s49, s49, 12
s_mul_i32 s49, s49, 393216
buffer_load_dwordx4 v[40:43], v36, s[28:31], s49 offen
s_add_u32 s65, s65, 40960
s_cmp_eq_u32 s65, 122880
s_cselect_b32 s65, 0, s65
s_add_u32 s64, s64, 1
s_waitcnt vmcnt(11)
s_barrier
global_load_dwordx2 v[34:35], v32, s[20:21] sc1
s_add_u32 s69, s47, 3
s_and_b32 s69, s69, 3
s_add_u32 s69, s69, 8
s_mul_i32 s67, s69, 128
s_mul_i32 s68, s69, s54
s_add_u32 m0, s70, s65
s_nop 0
buffer_load_dwordx4 v20, s[24:27], s67 offen offset:0  lds
buffer_load_dwordx4 v21, s[24:27], s67 offen offset:1024  lds
buffer_load_dwordx4 v22, s[24:27], s67 offen offset:2048  lds
buffer_load_dwordx4 v23, s[24:27], s67 offen offset:3072  lds
s_add_u32 s60, s71, s65
s_add_u32 m0, s60, 0
s_mov_b32 s61, s68
buffer_load_dwordx4 v26, s[28:31], s61 offen lds
buffer_load_dwordx4 v27, s[28:31], s61 offen offset:1024 lds
s_add_u32 m0, s60, 8192
s_add_u32 s61, s61, s53
buffer_load_dwordx4 v26, s[28:31], s61 offen lds
buffer_load_dwordx4 v27, s[28:31], s61 offen offset:1024 lds
s_add_u32 m0, s60, 16384
s_add_u32 s61, s61, s53
buffer_load_dwordx4 v26, s[28:31], s61 offen lds
buffer_load_dwordx4 v27, s[28:31], s61 offen offset:1024 lds
s_add_u32 s65, s65, 40960
s_cmp_eq_u32 s65, 122880
s_cselect_b32 s65, 0, s65
s_add_u32 s64, s64, 1
s_waitcnt vmcnt(10)
s_barrier
s_mov_b32 s63, 0
ipoll_20:
v_sad_u8 v4, v34, 0, 0
v_sad_u8 v4, v35, 0, v4
v_cmp_gt_u32 vcc, 32, v4
s_cbranch_vccz ipolled_21
global_load_dwordx2 v[34:35], v32, s[20:21] sc1
s_add_u32 s63, s63, 1
s_cmp_lt_u32 s63, 0x80000
s_waitcnt vmcnt(0)
s_cbranch_scc1 ipoll_20
ipolled_21:
s_add_u32 s69, s47, 3
s_and_b32 s69, s69, 3
s_add_u32 s69, s69, 12
s_mul_i32 s67, s69, 128
s_mul_i32 s68, s69, s54
s_add_u32 m0, s70, 0
s_nop 0
buffer_load_dwordx4 v20, s[24:27], s67 offen offset:0  lds
buffer_load_dwordx4 v21, s[24:27], s67 offen offset:1024  lds
buffer_load_dwordx4 v22, s[24:27], s67 offen offset:2048  lds
buffer_load_dwordx4 v23, s[24:27], s67 offen offset:3072  lds
s_add_u32 s60, s71, 0
s_add_u32 m0, s60, 0
s_mov_b32 s61, s68
buffer_load_dwordx4 v26, s[28:31], s61 offen lds
buffer_load_dwordx4 v27, s[28:31], s61 offen offset:1024 lds
s_add_u32 m0, s60, 8192
s_add_u32 s61, s61, s53
buffer_load_dwordx4 v26, s[28:31], s61 offen lds
buffer_load_dwordx4 v27, s[28:31], s61 offen offset:1024 lds
s_add_u32 m0, s60, 16384
s_add_u32 s61, s61, s53
buffer_load_dwordx4 v26, s[28:31], s61 offen lds
buffer_load_dwordx4 v27, s[28:31], s61 offen offset:1024 lds
s_waitcnt vmcnt(10)
s_barrier
s_setprio 0
buffer_load_dwordx4 v[240:243], v15, s[36:39], 0 offen offset:0
buffer_load_dwordx4 v[240:243], v15, s[36:39], 0 offen offset:1024
buffer_load_dwordx4 v[176:179], v37, s[32:35], 0 offen offset:0 sc1
buffer_load_dwordx4 v[180:183], v37, s[32:35], 0 offen offset:1024 sc1
buffer_load_dwordx4 v[184:187], v37, s[32:35], 0 offen offset:2048 sc1
buffer_load_dwordx4 v[188:191], v37, s[32:35], 0 offen offset:3072 sc1
global_load_dword v48, v54, s[98:99]
buffer_load_dwordx4 v[160:163], v38, s[32:35], 0 offen offset:0 sc1
buffer_load_dwordx4 v[164:167], v38, s[32:35], 0 offen offset:1024 sc1
buffer_load_dwordx4 v[168:171], v38, s[32:35], 0 offen offset:2048 sc1
buffer_load_dwordx4 v[172:175], v38, s[32:35], 0 offen offset:3072 sc1
s_add_u32 s48, s75, 15
s_and_b32 s48, s48, 15
s_mul_i32 s48, s48, s57
s_add_u32 m0, s71, 106496
s_nop 0
buffer_load_dwordx4 v28, s[36:39], s48 offen lds
buffer_load_dwordx4 v29, s[36:39], s48 offen offset:1024 lds
s_waitcnt vmcnt(13)
s_barrier
s_add_u32 s48, s75, 5
s_and_b32 s48, s48, 15
s_mul_i32 s48, s48, s57
s_add_u32 m0, s71, 24576
s_nop 0
buffer_load_dwordx4 v28, s[36:39], s48 offen lds
buffer_load_dwordx4 v29, s[36:39], s48 offen offset:1024 lds
s_waitcnt vmcnt(4)
s_add_u32 s48, s75, 6
s_and_b32 s48, s48, 15
s_mul_i32 s48, s48, s57
s_add_u32 m0, s71, 32768
s_nop 0
buffer_load_dwordx4 v28, s[36:39], s48 offen lds
v_add_f32 v176, v176, v184
v_add_f32 v160, v160, v168
v_add_f32 v177, v177, v185
v_add_f32 v161, v161, v169
v_add_f32 v178, v178, v186
v_add_f32 v162, v162, v170
v_add_f32 v179, v179, v187
v_add_f32 v163, v163, v171
v_add_f32 v180, v180, v188
v_add_f32 v164, v164, v172
buffer_load_dwordx4 v29, s[36:39], s48 offen offset:1024 lds
v_add_f32 v181, v181, v189
v_add_f32 v165, v165, v173
v_add_f32 v182, v182, v190
v_add_f32 v166, v166, v174
v_add_f32 v183, v183, v191
v_add_f32 v167, v167, v175
v_add_f32 v176, v176, v180
v_add_f32 v160, v160, v164
v_add_f32 v177, v177, v181
v_add_f32 v161, v161, v165
s_add_u32 s48, s75, 7
s_and_b32 s48, s48, 15
s_mul_i32 s48, s48, s57
s_add_u32 m0, s71, 40960
s_nop 0
buffer_load_dwordx4 v28, s[36:39], s48 offen lds
v_add_f32 v178, v178, v182
v_add_f32 v162, v162, v166
v_add_f32 v179, v179, v183
v_add_f32 v163, v163, v167
s_nop 1
s_nop 1
v_permlane32_swap_b32 v176, v177
v_permlane32_swap_b32 v160, v161
v_permlane32_swap_b32 v178, v179
buffer_load_dwordx4 v29, s[36:39], s48 offen offset:1024 lds
v_permlane32_swap_b32 v162, v163
v_add_f32 v176, v176, v177
v_add_f32 v160, v160, v161
v_add_f32 v178, v178, v179
v_add_f32 v162, v162, v163
s_nop 1
s_nop 1
v_permlane16_swap_b32 v176, v178
v_permlane16_swap_b32 v160, v162
s_nop 0
s_add_u32 s48, s75, 8
s_and_b32 s48, s48, 15
s_mul_i32 s48, s48, s57
s_add_u32 m0, s71, 49152
s_nop 0
buffer_load_dwordx4 v28, s[36:39], s48 offen lds
s_nop 0
v_add_f32 v176, v176, v178
v_add_f32 v160, v160, v162
v_cmp_u_f32 vcc, v176, v176
s_cbranch_vccnz again_22
summed_23:
v_cmp_u_f32 vcc, v160, v160
s_cbranch_vccnz again_25
summed_26:
v_mul_f32 v44, 0x3a800000, v176
ds_write_b32 v53, v160
v_mov_b32 v45, v44
s_nop 1
v_permlane16_swap_b32 v44, v45
buffer_load_dwordx4 v29, s[36:39], s48 offen offset:1024 lds
s_nop 0
v_fma_f32 v45, -v44, v44, v45
v_max_f32 v45, 0, v45
v_add_f32 v45, 0x3727c5ac, v45
v_rsq_f32 v46, v45
v_sub_f32 v47, 0, v44
ds_write_b32 v50, v47 offset:512
ds_write_b64 v49, v[46:47]
ds_write_b32 v50, v46
s_cmp_lg_u32 s43, 2
s_cbranch_scc1 else_28
s_and_b32 s50, s2, 7
v_readlane_b32 s58, v34, s50
v_readlane_b32 s59, v35, s50
s_lshl_b64 s[48:49], s[94:95], 5
v_mov_b32 v4, 134656
s_nop 1
s_cmp_eq_u64 s[48:49], s[58:59]
s_cselect_b32 s48, 1, 0
v_mov_b32 v5, s48
ds_write_b32 v4, v5
else_28:
s_setprio 0
s_waitcnt lgkmcnt(0)
s_waitcnt vmcnt(63)
s_barrier
s_waitcnt vmcnt(5)
s_add_u32 s48, s75, 9
s_and_b32 s48, s48, 15
s_mul_i32 s48, s48, s57
s_add_u32 m0, s71, 57344
s_nop 0
buffer_load_dwordx4 v28, s[36:39], s48 offen lds
ds_write_b128 v51, v[136:139] offset:24576
buffer_load_dwordx4 v29, s[36:39], s48 offen offset:1024 lds
s_waitcnt vmcnt(5)
s_add_u32 s48, s75, 10
s_and_b32 s48, s48, 15
s_mul_i32 s48, s48, s57
s_add_u32 m0, s71, 65536
s_nop 0
buffer_load_dwordx4 v28, s[36:39], s48 offen lds
buffer_load_dwordx4 v29, s[36:39], s48 offen offset:1024 lds
s_waitcnt vmcnt(5)
s_add_u32 s48, s75, 11
s_and_b32 s48, s48, 15
s_mul_i32 s48, s48, s57
s_add_u32 m0, s71, 73728
s_nop 0
buffer_load_dwordx4 v28, s[36:39], s48 offen lds
ds_write_b128 v51, v[140:143] offset:25600
buffer_load_dwordx4 v29, s[36:39], s48 offen offset:1024 lds
s_waitcnt vmcnt(5)
s_add_u32 s48, s75, 12
s_and_b32 s48, s48, 15
s_mul_i32 s48, s48, s57
s_add_u32 m0, s71, 81920
s_nop 0
buffer_load_dwordx4 v28, s[36:39], s48 offen lds
buffer_load_dwordx4 v29, s[36:39], s48 offen offset:1024 lds
s_waitcnt vmcnt(5)
s_add_u32 s48, s75, 13
s_and_b32 s48, s48, 15
s_mul_i32 s48, s48, s57
s_add_u32 m0, s71, 90112
s_nop 0
buffer_load_dwordx4 v28, s[36:39], s48 offen lds
buffer_load_dwordx4 v29, s[36:39], s48 offen offset:1024 lds
ds_write_b128 v51, v[144:147] offset:32768
s_waitcnt vmcnt(5)
s_add_u32 s48, s75, 14
s_and_b32 s48, s48, 15
s_mul_i32 s48, s48, s57
s_add_u32 m0, s71, 98304
s_nop 0
buffer_load_dwordx4 v28, s[36:39], s48 offen lds
buffer_load_dwordx4 v29, s[36:39], s48 offen offset:1024 lds
s_waitcnt vmcnt(5)
s_add_u32 s48, s75, 0
s_and_b32 s48, s48, 15
s_mul_i32 s48, s48, s57
s_add_u32 m0, s71, 4294950912
s_nop 0
buffer_load_dwordx4 v28, s[36:39], s48 offen lds
buffer_load_dwordx4 v29, s[36:39], s48 offen offset:1024 lds
ds_write_b128 v51, v[148:151] offset:33792
s_waitcnt vmcnt(5)
s_add_u32 s48, s75, 1
s_and_b32 s48, s48, 15
s_mul_i32 s48, s48, s57
s_add_u32 m0, s71, 4294959104
s_nop 0
buffer_load_dwordx4 v28, s[36:39], s48 offen lds
buffer_load_dwordx4 v29, s[36:39], s48 offen offset:1024 lds
s_waitcnt vmcnt(5)
s_add_u32 s48, s75, 2
s_and_b32 s48, s48, 15
s_mul_i32 s48, s48, s57
s_add_u32 m0, s71, 0
s_nop 0
buffer_load_dwordx4 v28, s[36:39], s48 offen lds
buffer_load_dwordx4 v29, s[36:39], s48 offen offset:1024 lds
s_mov_b32 s28, s12
s_and_b32 s29, s13, 0xffff
s_mov_b32 s30, 6291456
s_mov_b32 s31, 0x00020000
v_mov_b32 v26, v60
v_mov_b32 v27, v61
v_mov_b32 v28, v24
v_mov_b32 v29, v25
s_cmp_ge_i32 s55, 0
s_cselect_b32 s53, 128, s53
s_cselect_b32 s54, 24576, s54
s_cmp_ge_i32 s56, 0
s_cselect_b32 s57, 8192, s57
s_and_b32 s48, s2, 7
s_add_u32 s47, s42, s48
s_and_b32 s47, s47, 7
s_mul_i32 s47, s47, 2
s_and_b32 s50, s42, 8
s_or_b32 s50, s50, 3
s_and_b32 s48, s2, 7
s_add_u32 s76, s50, s48
s_and_b32 s76, s76, 7
s_mul_i32 s76, s76, 2
s_add_u32 s69, s47, 0
s_and_b32 s69, s69, 15
s_mul_i32 s67, s69, 128
s_mul_i32 s68, s69, s54
s_waitcnt vmcnt(0) lgkmcnt(0)
s_barrier
s_mov_b32 s36, s14
s_and_b32 s37, s15, 0xffff
s_mov_b32 s38, 65536
s_mov_b32 s39, 0x00020000
s_lshl_b32 s48, s42, 12
s_lshl_b32 s49, s43, 10
s_add_u32 s48, s48, s49
s_add_u32 m0, s49, 135168
s_nop 0
buffer_load_dwordx4 v18, s[36:39], s48 offen lds
ds_read_b128 v[232:235], v52 offset:57344
ds_read_b128 v[236:239], v52 offset:58368
ds_read_b128 v[152:155], v51 offset:40960
ds_read_b128 v[156:159], v51 offset:41984
ds_read_b128 v[160:163], v51 offset:49152
ds_read_b128 v[164:167], v51 offset:50176
ds_read_b128 v[168:171], v51 offset:57344
ds_read_b128 v[172:175], v51 offset:58368
ds_read_b128 v[176:179], v52 offset:0
ds_read_b128 v[180:183], v52 offset:1024
ds_read_b128 v[184:187], v52 offset:8192
ds_read_b128 v[188:191], v52 offset:9216
ds_read_b128 v[192:195], v52 offset:16384
ds_read_b128 v[196:199], v52 offset:17408
ds_read_b128 v[200:203], v52 offset:24576
ds_read_b128 v[204:207], v52 offset:25600
ds_read_b128 v[208:211], v52 offset:32768
ds_read_b128 v[212:215], v52 offset:33792
ds_read_b128 v[216:219], v52 offset:40960
ds_read_b128 v[220:223], v52 offset:41984
ds_read_b128 v[224:227], v52 offset:49152
ds_read_b128 v[228:231], v52 offset:50176
ds_read_b128 v[112:115], v51 offset:0
ds_read_b128 v[116:119], v51 offset:1024
ds_read_b128 v[120:123], v51 offset:8192
ds_read_b128 v[124:127], v51 offset:9216
ds_read_b128 v[128:131], v51 offset:16384
ds_read_b128 v[132:135], v51 offset:17408
s_add_u32 s48, s80, 0
v_add_u32 v20, s48, v18
v_mov_b32 v21, v20
v_add_u32 v22, 30720, v20
v_mov_b32 v23, v22
v_add_u32 v37, 262144, v37
s_lshl_b32 s50, s42, 2
s_add_u32 s50, s50, s43
s_lshl_b32 s50, s50, 12
s_add_u32 s50, s50, 18087936
v_add_u32 v38, s50, v18
v_min_u32 v4, 2, v3
v_lshlrev_b32 v4, 8, v4
v_lshl_add_u32 v4, v2, 2, v4
s_and_b32 s48, s43, 1
s_lshl_b32 s48, s48, 7
s_lshr_b32 s49, s43, 1
s_lshl_b32 s49, s49, 6
s_add_u32 s48, s48, s49
s_add_u32 s48, s48, 133888
v_add_u32 v53, s48, v4
s_getpc_b64 s[98:99]
pc_30:
s_add_u32 s98, s98, c1_last - pc_30
s_addc_u32 s99, s99, 0
s_lshr_b32 s50, s2, 3
s_lshl_b32 s50, s50, 2
s_add_u32 s50, s50, s43
s_lshl_b32 s50, s50, 7
v_and_b32 v4, 1, v0
v_lshl_add_u32 v4, v4, 6, s50
v_min_u32 v54, L_code_end - c1_last, v4
s_mov_b32 s36, s6
s_and_b32 s37, s7, 0xffff
s_mov_b32 s38, 6291456
s_mov_b32 s39, 0x00020000
s_and_b32 s48, s2, 7
s_lshl_b32 s48, s48, 1
s_add_u32 s83, s42, s48
s_and_b32 s83, s83, 15
s_mul_i32 s83, s83, 393216
s_lshr_b32 s48, s2, 4
s_and_b32 s49, s2, 7
s_add_u32 s48, s48, s49
s_mul_i32 s49, s48, 10923
s_lshr_b32 s49, s49, 16
s_mul_i32 s49, s49, 6
s_sub_u32 s88, s48, s49
s_add_u32 s88, s88, 1
s_waitcnt vmcnt(0) lgkmcnt(0)
s_add_u32 s69, s47, 1
s_and_b32 s69, s69, 15
s_mul_i32 s67, s69, 2048
s_mul_i32 s68, s69, s54
s_barrier
s_add_u32 s60, s71, 40960
s_add_u32 m0, s60, 0
s_mov_b32 s61, s68
buffer_load_dwordx4 v26, s[28:31], s61 offen lds
buffer_load_dwordx4 v27, s[28:31], s61 offen offset:1024 lds
s_add_u32 m0, s60, 8192
s_add_u32 s61, s61, s53
buffer_load_dwordx4 v26, s[28:31], s61 offen lds
buffer_load_dwordx4 v27, s[28:31], s61 offen offset:1024 lds
s_add_u32 m0, s60, 16384
s_add_u32 s61, s61, s53
buffer_load_dwordx4 v26, s[28:31], s61 offen lds
buffer_load_dwordx4 v27, s[28:31], s61 offen offset:1024 lds
s_add_u32 s49, s76, 2
s_and_b32 s49, s49, 15
s_mul_i32 s49, s49, 393216
buffer_load_dwordx4 v[40:43], v36, s[28:31], s49 offen
s_add_u32 s49, s76, 3
s_and_b32 s49, s49, 15
s_mul_i32 s49, s49, 393216
buffer_load_dwordx4 v[40:43], v36, s[28:31], s49 offen
buffer_load_dword v5, v30, s[32:35], s79 offen sc1
s_add_u32 s69, s47, 0
s_and_b32 s69, s69, 15
s_mul_i32 s67, s69, 2048
s_mul_i32 s68, s69, s54
s_add_u32 m0, s70, 0
s_nop 0
s_mov_b32 s63, 0
s_waitcnt vmcnt(0)
poll_31:
v_cmp_gt_u32 vcc, 1, v5
s_cbranch_vccz polled_32
buffer_load_dword v5, v30, s[32:35], s79 offen sc1
s_add_u32 s63, s63, 1
s_cmp_lt_u32 s63, 0x80000
s_waitcnt vmcnt(0)
s_cbranch_scc1 poll_31
polled_32:
buffer_load_dwordx4 v20, s[32:35], s67 offen offset:0 sc1 lds
buffer_load_dwordx4 v21, s[32:35], s67 offen offset:1024 sc1 lds
buffer_load_dwordx4 v22, s[32:35], s67 offen offset:2048 sc1 lds
buffer_load_dwordx4 v23, s[32:35], s67 offen offset:3072 sc1 lds
s_add_u32 s69, s47, 1
s_and_b32 s69, s69, 15
s_mul_i32 s67, s69, 2048
s_mul_i32 s68, s69, s54
s_add_u32 m0, s70, 40960
s_nop 0
buffer_load_dwordx4 v20, s[32:35], s67 offen offset:0 sc1 lds
buffer_load_dwordx4 v21, s[32:35], s67 offen offset:1024 sc1 lds
buffer_load_dwordx4 v22, s[32:35], s67 offen offset:2048 sc1 lds
buffer_load_dwordx4 v23, s[32:35], s67 offen offset:3072 sc1 lds
s_waitcnt vmcnt(4) lgkmcnt(0)
s_barrier
s_add_u32 s69, s47, 2
s_and_b32 s69, s69, 15
s_mul_i32 s67, s69, 2048
s_mul_i32 s68, s69, s54
s_add_u32 m0, s70, 81920
s_nop 0
buffer_load_dwordx4 v20, s[32:35], s67 offen offset:0 sc1 lds
buffer_load_dwordx4 v21, s[32:35], s67 offen offset:1024 sc1 lds
buffer_load_dwordx4 v22, s[32:35], s67 offen offset:2048 sc1 lds
buffer_load_dwordx4 v23, s[32:35], s67 offen offset:3072 sc1 lds
s_add_u32 s60, s71, 81920
s_add_u32 m0, s60, 0
s_mov_b32 s61, s68
buffer_load_dwordx4 v26, s[28:31], s61 offen lds
buffer_load_dwordx4 v27, s[28:31], s61 offen offset:1024 lds
s_add_u32 m0, s60, 8192
s_add_u32 s61, s61, s53
buffer_load_dwordx4 v26, s[28:31], s61 offen lds
buffer_load_dwordx4 v27, s[28:31], s61 offen offset:1024 lds
s_add_u32 m0, s60, 16384
s_add_u32 s61, s61, s53
buffer_load_dwordx4 v26, s[28:31], s61 offen lds
buffer_load_dwordx4 v27, s[28:31], s61 offen offset:1024 lds
s_add_u32 s49, s76, 4
s_and_b32 s49, s49, 15
s_mul_i32 s49, s49, 393216
buffer_load_dwordx4 v[40:43], v36, s[28:31], s49 offen
s_mov_b32 s64, 0
s_mov_b32 s65, 0
h1_loop:
s_waitcnt vmcnt(11)
s_barrier
s_cmp_lg_u32 s64, s88
s_cbranch_scc1 else_33
s_add_u32 s48, s83, 0
buffer_load_dwordx4 v[96:99], v26, s[36:39], s48 offen offset:0
buffer_load_dwordx4 v[100:103], v27, s[36:39], s48 offen offset:1024
s_add_u32 s48, s83, 2048
buffer_load_dwordx4 v[104:107], v26, s[36:39], s48 offen offset:0
buffer_load_dwordx4 v[108:111], v27, s[36:39], s48 offen offset:1024
s_add_u32 s48, s83, 4096
buffer_load_dwordx4 v[244:247], v26, s[36:39], s48 offen offset:0
buffer_load_dwordx4 v[8:11], v27, s[36:39], s48 offen offset:1024
else_33:
s_add_u32 s69, s69, 1
s_and_b32 s69, s69, 15
s_mul_i32 s67, s69, 2048
s_mul_i32 s68, s69, s54
s_add_u32 m0, s70, s65
s_nop 0
buffer_load_dwordx4 v20, s[32:35], s67 offen offset:0 sc1 lds
buffer_load_dwordx4 v21, s[32:35], s67 offen offset:1024 sc1 lds
buffer_load_dwordx4 v22, s[32:35], s67 offen offset:2048 sc1 lds
buffer_load_dwordx4 v23, s[32:35], s67 offen offset:3072 sc1 lds
s_add_u32 s60, s71, s65
s_add_u32 m0, s60, 0
s_mov_b32 s61, s68
buffer_load_dwordx4 v26, s[28:31], s61 offen lds
buffer_load_dwordx4 v27, s[28:31], s61 offen offset:1024 lds
s_add_u32 m0, s60, 8192
s_add_u32 s61, s61, s53
buffer_load_dwordx4 v26, s[28:31], s61 offen lds
buffer_load_dwordx4 v27, s[28:31], s61 offen offset:1024 lds
s_add_u32 m0, s60, 16384
s_add_u32 s61, s61, s53
buffer_load_dwordx4 v26, s[28:31], s61 offen lds
buffer_load_dwordx4 v27, s[28:31], s61 offen offset:1024 lds
s_add_u32 s48, s64, 5
s_min_u32 s48, s48, 15
s_add_u32 s49, s48, s76
s_and_b32 s49, s49, 15
s_mul_i32 s49, s49, 393216
buffer_load_dwordx4 v[40:43], v36, s[28:31], s49 offen
s_add_u32 s65, s65, 40960
s_cmp_eq_u32 s65, 122880
s_cselect_b32 s65, 0, s65
s_add_u32 s64, s64, 1
s_cmp_lt_u32 s64, 11
s_cbranch_scc1 h1_loop
s_waitcnt vmcnt(11)
s_barrier
s_add_u32 s69, s47, 14
s_and_b32 s69, s69, 15
s_mul_i32 s67, s69, 2048
s_mul_i32 s68, s69, s54
s_add_u32 m0, s70, s65
s_nop 0
buffer_load_dwordx4 v20, s[32:35], s67 offen offset:0 sc1 lds
buffer_load_dwordx4 v21, s[32:35], s67 offen offset:1024 sc1 lds
buffer_load_dwordx4 v22, s[32:35], s67 offen offset:2048 sc1 lds
buffer_load_dwordx4 v23, s[32:35], s67 offen offset:3072 sc1 lds
s_add_u32 s60, s71, s65
s_add_u32 m0, s60, 0
s_mov_b32 s61, s68
buffer_load_dwordx4 v26, s[28:31], s61 offen lds
buffer_load_dwordx4 v27, s[28:31], s61 offen offset:1024 lds
s_add_u32 m0, s60, 8192
s_add_u32 s61, s61, s53
buffer_load_dwordx4 v26, s[28:31], s61 offen lds
buffer_load_dwordx4 v27, s[28:31], s61 offen offset:1024 lds
s_add_u32 m0, s60, 16384
s_add_u32 s61, s61, s53
buffer_load_dwordx4 v26, s[28:31], s61 offen lds
buffer_load_dwordx4 v27, s[28:31], s61 offen offset:1024 lds
s_add_u32 s65, s65, 40960
s_cmp_eq_u32 s65, 122880
s_cselect_b32 s65, 0, s65
s_add_u32 s64, s64, 1
s_mov_b32 s36, s16
s_and_b32 s37, s17, 0xffff
s_mov_b32 s38, 2097152
s_mov_b32 s39, 0x00020000
s_waitcnt vmcnt(10)
s_barrier
s_add_u32 s69, s47, 15
s_and_b32 s69, s69, 15
s_mul_i32 s67, s69, 2048
s_mul_i32 s68, s69, s54
s_add_u32 m0, s70, 0
s_nop 0
buffer_load_dwordx4 v20, s[32:35], s67 offen offset:0 sc1 lds
buffer_load_dwordx4 v21, s[32:35], s67 offen offset:1024 sc1 lds
buffer_load_dwordx4 v22, s[32:35], s67 offen offset:2048 sc1 lds
buffer_load_dwordx4 v23, s[32:35], s67 offen offset:3072 sc1 lds
s_add_u32 s60, s71, 0
s_add_u32 m0, s60, 0
s_mov_b32 s61, s68
buffer_load_dwordx4 v26, s[28:31], s61 offen lds
buffer_load_dwordx4 v27, s[28:31], s61 offen offset:1024 lds
s_add_u32 m0, s60, 8192
s_add_u32 s61, s61, s53
buffer_load_dwordx4 v26, s[28:31], s61 offen lds
buffer_load_dwordx4 v27, s[28:31], s61 offen offset:1024 lds
s_add_u32 m0, s60, 16384
s_add_u32 s61, s61, s53
buffer_load_dwordx4 v26, s[28:31], s61 offen lds
buffer_load_dwordx4 v27, s[28:31], s61 offen offset:1024 lds
s_waitcnt vmcnt(10)
s_barrier
s_setprio 0
buffer_load_dwordx4 v[240:243], v15, s[36:39], 0 offen offset:0
buffer_load_dwordx4 v[240:243], v15, s[36:39], 0 offen offset:1024
buffer_load_dwordx4 v[80:83], v37, s[32:35], 0 offen offset:0 sc1
buffer_load_dwordx4 v[84:87], v37, s[32:35], 0 offen offset:1024 sc1
buffer_load_dwordx4 v[88:91], v37, s[32:35], 0 offen offset:2048 sc1
buffer_load_dwordx4 v[92:95], v37, s[32:35], 0 offen offset:3072 sc1
global_load_dword v48, v54, s[98:99]
buffer_load_dwordx4 v[64:67], v38, s[32:35], 0 offen offset:0 sc1
buffer_load_dwordx4 v[68:71], v38, s[32:35], 0 offen offset:1024 sc1
buffer_load_dwordx4 v[72:75], v38, s[32:35], 0 offen offset:2048 sc1
buffer_load_dwordx4 v[76:79], v38, s[32:35], 0 offen offset:3072 sc1
s_add_u32 s48, s75, 15
s_and_b32 s48, s48, 15
s_mul_i32 s48, s48, s57
s_add_u32 m0, s71, 106496
s_nop 0
buffer_load_dwordx4 v28, s[36:39], s48 offen lds
buffer_load_dwordx4 v29, s[36:39], s48 offen offset:1024 lds
s_waitcnt vmcnt(13)
s_barrier
s_add_u32 s48, s75, 5
s_and_b32 s48, s48, 15
s_mul_i32 s48, s48, s57
s_add_u32 m0, s71, 24576
s_nop 0
buffer_load_dwordx4 v28, s[36:39], s48 offen lds
buffer_load_dwordx4 v29, s[36:39], s48 offen offset:1024 lds
s_waitcnt vmcnt(4)
s_add_u32 s48, s75, 6
s_and_b32 s48, s48, 15
s_mul_i32 s48, s48, s57
s_add_u32 m0, s71, 32768
s_nop 0
buffer_load_dwordx4 v28, s[36:39], s48 offen lds
v_add_f32 v80, v80, v88
v_add_f32 v64, v64, v72
v_add_f32 v81, v81, v89
v_add_f32 v65, v65, v73
v_add_f32 v82, v82, v90
v_add_f32 v66, v66, v74
v_add_f32 v83, v83, v91
v_add_f32 v67, v67, v75
v_add_f32 v84, v84, v92
v_add_f32 v68, v68, v76
buffer_load_dwordx4 v29, s[36:39], s48 offen offset:1024 lds
v_add_f32 v85, v85, v93
v_add_f32 v69, v69, v77
v_add_f32 v86, v86, v94
v_add_f32 v70, v70, v78
v_add_f32 v87, v87, v95
v_add_f32 v71, v71, v79
v_add_f32 v80, v80, v84
v_add_f32 v64, v64, v68
v_add_f32 v81, v81, v85
v_add_f32 v65, v65, v69
s_add_u32 s48, s75, 7
s_and_b32 s48, s48, 15
s_mul_i32 s48, s48, s57
s_add_u32 m0, s71, 40960
s_nop 0
buffer_load_dwordx4 v28, s[36:39], s48 offen lds
v_add_f32 v82, v82, v86
v_add_f32 v66, v66, v70
v_add_f32 v83, v83, v87
v_add_f32 v67, v67, v71
s_nop 1
s_nop 1
v_permlane32_swap_b32 v80, v81
v_permlane32_swap_b32 v64, v65
v_permlane32_swap_b32 v82, v83
buffer_load_dwordx4 v29, s[36:39], s48 offen offset:1024 lds
v_permlane32_swap_b32 v66, v67
v_add_f32 v80, v80, v81
v_add_f32 v64, v64, v65
v_add_f32 v82, v82, v83
v_add_f32 v66, v66, v67
s_nop 1
s_nop 1
v_permlane16_swap_b32 v80, v82
v_permlane16_swap_b32 v64, v66
s_nop 0
s_add_u32 s48, s75, 8
s_and_b32 s48, s48, 15
s_mul_i32 s48, s48, s57
s_add_u32 m0, s71, 49152
s_nop 0
buffer_load_dwordx4 v28, s[36:39], s48 offen lds
s_nop 0
v_add_f32 v80, v80, v82
v_add_f32 v64, v64, v66
v_cmp_u_f32 vcc, v80, v80
s_cbranch_vccnz again_35
summed_36:
v_cmp_u_f32 vcc, v64, v64
s_cbranch_vccnz again_38
summed_39:
v_mul_f32 v44, 0x3a800000, v80
ds_write_b32 v53, v64
v_mov_b32 v45, v44
s_nop 1
v_permlane16_swap_b32 v44, v45
buffer_load_dwordx4 v29, s[36:39], s48 offen offset:1024 lds
s_nop 0
v_fma_f32 v45, -v44, v44, v45
v_max_f32 v45, 0, v45
v_add_f32 v45, 0x3727c5ac, v45
v_rsq_f32 v46, v45
v_sub_f32 v47, 0, v44
ds_write_b32 v50, v47 offset:512
ds_write_b64 v49, v[46:47]
ds_write_b32 v50, v46
s_setprio 0
s_waitcnt lgkmcnt(0)
s_waitcnt vmcnt(63)
s_barrier
s_waitcnt vmcnt(5)
s_add_u32 s48, s75, 9
s_and_b32 s48, s48, 15
s_mul_i32 s48, s48, s57
s_add_u32 m0, s71, 57344
s_nop 0
buffer_load_dwordx4 v28, s[36:39], s48 offen lds
buffer_load_dwordx4 v29, s[36:39], s48 offen offset:1024 lds
s_waitcnt vmcnt(5)
s_add_u32 s48, s75, 10
s_and_b32 s48, s48, 15
s_mul_i32 s48, s48, s57
s_add_u32 m0, s71, 65536
s_nop 0
buffer_load_dwordx4 v28, s[36:39], s48 offen lds
buffer_load_dwordx4 v29, s[36:39], s48 offen offset:1024 lds
s_waitcnt vmcnt(5)
s_add_u32 s48, s75, 11
s_and_b32 s48, s48, 15
s_mul_i32 s48, s48, s57
s_add_u32 m0, s71, 73728
s_nop 0
buffer_load_dwordx4 v28, s[36:39], s48 offen lds
buffer_load_dwordx4 v29, s[36:39], s48 offen offset:1024 lds
s_waitcnt vmcnt(5)
s_add_u32 s48, s75, 12
s_and_b32 s48, s48, 15
s_mul_i32 s48, s48, s57
s_add_u32 m0, s71, 81920
s_nop 0
buffer_load_dwordx4 v28, s[36:39], s48 offen lds
buffer_load_dwordx4 v29, s[36:39], s48 offen offset:1024 lds
s_waitcnt vmcnt(5)
s_add_u32 s48, s75, 13
s_and_b32 s48, s48, 15
s_mul_i32 s48, s48, s57
s_add_u32 m0, s71, 90112
s_nop 0
buffer_load_dwordx4 v28, s[36:39], s48 offen lds
buffer_load_dwordx4 v29, s[36:39], s48 offen offset:1024 lds
s_waitcnt vmcnt(5)
s_add_u32 s48, s75, 14
s_and_b32 s48, s48, 15
s_mul_i32 s48, s48, s57
s_add_u32 m0, s71, 98304
s_nop 0
buffer_load_dwordx4 v28, s[36:39], s48 offen lds
buffer_load_dwordx4 v29, s[36:39], s48 offen offset:1024 lds
s_waitcnt vmcnt(5)
s_add_u32 s48, s75, 0
s_and_b32 s48, s48, 15
s_mul_i32 s48, s48, s57
s_add_u32 m0, s71, 4294950912
s_nop 0
buffer_load_dwordx4 v28, s[36:39], s48 offen lds
buffer_load_dwordx4 v29, s[36:39], s48 offen offset:1024 lds
s_waitcnt vmcnt(5)
s_add_u32 s48, s75, 1
s_and_b32 s48, s48, 15
s_mul_i32 s48, s48, s57
s_add_u32 m0, s71, 4294959104
s_nop 0
buffer_load_dwordx4 v28, s[36:39], s48 offen lds
buffer_load_dwordx4 v29, s[36:39], s48 offen offset:1024 lds
s_waitcnt vmcnt(5)
s_add_u32 s48, s75, 2
s_and_b32 s48, s48, 15
s_mul_i32 s48, s48, s57
s_add_u32 m0, s71, 0
s_nop 0
buffer_load_dwordx4 v28, s[36:39], s48 offen lds
buffer_load_dwordx4 v29, s[36:39], s48 offen offset:1024 lds
s_waitcnt vmcnt(5)
s_add_u32 s48, s75, 3
s_and_b32 s48, s48, 15
s_mul_i32 s48, s48, s57
s_add_u32 m0, s71, 8192
s_nop 0
buffer_load_dwordx4 v28, s[36:39], s48 offen lds
buffer_load_dwordx4 v29, s[36:39], s48 offen offset:1024 lds
s_waitcnt vmcnt(5)
s_add_u32 s48, s75, 4
s_and_b32 s48, s48, 15
s_mul_i32 s48, s48, s57
s_add_u32 m0, s71, 16384
s_nop 0
buffer_load_dwordx4 v28, s[36:39], s48 offen lds
buffer_load_dwordx4 v29, s[36:39], s48 offen offset:1024 lds
s_waitcnt vmcnt(5)
buffer_load_dwordx4 v[240:243], v18, s[32:35], s81 offen offset:0 sc1
buffer_load_dwordx4 v[240:243], v18, s[32:35], s81 offen offset:1024 sc1
s_waitcnt vmcnt(5)
buffer_load_dwordx4 v[240:243], v18, s[32:35], s82 offen offset:0 sc1
buffer_load_dwordx4 v[240:243], v18, s[32:35], s82 offen offset:1024 sc1
s_mov_b32 s28, s6
s_and_b32 s29, s7, 0xffff
s_mov_b32 s30, 6291456
s_mov_b32 s31, 0x00020000
s_and_b32 s48, s2, 7
s_lshl_b32 s48, s48, 1
s_add_u32 s47, s42, s48
s_and_b32 s47, s47, 15
s_and_b32 s50, s42, 8
s_or_b32 s50, s50, 3
s_and_b32 s48, s2, 7
s_lshl_b32 s48, s48, 1
s_add_u32 s76, s50, s48
s_and_b32 s76, s76, 15
s_add_u32 s69, s47, 0
s_and_b32 s69, s69, 15
s_mul_i32 s67, s69, 2048
s_mul_i32 s68, s69, s54
s_waitcnt vmcnt(0) lgkmcnt(0)
s_barrier
ds_write_b128 v14, v[96:99] offset:8192
ds_write_b128 v14, v[100:103] offset:9216
ds_write_b128 v14, v[104:107] offset:16384
ds_write_b128 v14, v[108:111] offset:17408
ds_write_b128 v14, v[244:247] offset:24576
ds_write_b128 v14, v[8:11] offset:25600
v_add_u32 v37, 262144, v37
s_getpc_b64 s[98:99]
pc_41:
s_add_u32 s98, s98, c2_last - pc_41
s_addc_u32 s99, s99, 0
s_lshr_b32 s50, s2, 3
s_lshl_b32 s50, s50, 2
s_add_u32 s50, s50, s43
s_lshl_b32 s50, s50, 7
v_and_b32 v4, 1, v0
v_lshl_add_u32 v4, v4, 6, s50
v_min_u32 v54, L_code_end - c2_last, v4
s_waitcnt vmcnt(0) lgkmcnt(0)
s_add_u32 s69, s47, 1
s_and_b32 s69, s69, 15
s_mul_i32 s67, s69, 2048
s_mul_i32 s68, s69, s54
s_barrier
s_add_u32 s60, s71, 40960
s_add_u32 m0, s60, 0
s_mov_b32 s61, s68
buffer_load_dwordx4 v26, s[28:31], s61 offen lds
buffer_load_dwordx4 v27, s[28:31], s61 offen offset:1024 lds
s_add_u32 m0, s60, 8192
s_add_u32 s61, s61, s53
buffer_load_dwordx4 v26, s[28:31], s61 offen lds
buffer_load_dwordx4 v27, s[28:31], s61 offen offset:1024 lds
s_add_u32 m0, s60, 16384
s_add_u32 s61, s61, s53
buffer_load_dwordx4 v26, s[28:31], s61 offen lds
buffer_load_dwordx4 v27, s[28:31], s61 offen offset:1024 lds
s_add_u32 s49, s76, 2
s_and_b32 s49, s49, 15
s_mul_i32 s49, s49, 393216
buffer_load_dwordx4 v[40:43], v36, s[28:31], s49 offen
s_add_u32 s49, s76, 3
s_and_b32 s49, s49, 15
s_mul_i32 s49, s49, 393216
buffer_load_dwordx4 v[40:43], v36, s[28:31], s49 offen
buffer_load_dword v5, v30, s[32:35], s79 offen sc1
s_add_u32 s69, s47, 0
s_and_b32 s69, s69, 15
s_mul_i32 s67, s69, 2048
s_mul_i32 s68, s69, s54
s_add_u32 m0, s70, 0
s_nop 0
s_mov_b32 s63, 0
s_waitcnt vmcnt(0)
poll_42:
v_cmp_gt_u32 vcc, 2, v5
s_cbranch_vccz polled_43
buffer_load_dword v5, v30, s[32:35], s79 offen sc1
s_add_u32 s63, s63, 1
s_cmp_lt_u32 s63, 0x80000
s_waitcnt vmcnt(0)
s_cbranch_scc1 poll_42
polled_43:
buffer_load_dwordx4 v20, s[32:35], s67 offen offset:0 sc1 lds
buffer_load_dwordx4 v21, s[32:35], s67 offen offset:1024 sc1 lds
buffer_load_dwordx4 v22, s[32:35], s67 offen offset:2048 sc1 lds
buffer_load_dwordx4 v23, s[32:35], s67 offen offset:3072 sc1 lds
s_add_u32 s69, s47, 1
s_and_b32 s69, s69, 15
s_mul_i32 s67, s69, 2048
s_mul_i32 s68, s69, s54
s_add_u32 m0, s70, 40960
s_nop 0
buffer_load_dwordx4 v20, s[32:35], s67 offen offset:0 sc1 lds
buffer_load_dwordx4 v21, s[32:35], s67 offen offset:1024 sc1 lds
buffer_load_dwordx4 v22, s[32:35], s67 offen offset:2048 sc1 lds
buffer_load_dwordx4 v23, s[32:35], s67 offen offset:3072 sc1 lds
s_waitcnt vmcnt(4) lgkmcnt(0)
s_barrier
s_add_u32 s69, s47, 2
s_and_b32 s69, s69, 15
s_mul_i32 s67, s69, 2048
s_mul_i32 s68, s69, s54
s_add_u32 m0, s70, 81920
s_nop 0
buffer_load_dwordx4 v20, s[32:35], s67 offen offset:0 sc1 lds
buffer_load_dwordx4 v21, s[32:35], s67 offen offset:1024 sc1 lds
buffer_load_dwordx4 v22, s[32:35], s67 offen offset:2048 sc1 lds
buffer_load_dwordx4 v23, s[32:35], s67 offen offset:3072 sc1 lds
s_add_u32 s60, s71, 81920
s_add_u32 m0, s60, 0
s_mov_b32 s61, s68
buffer_load_dwordx4 v26, s[28:31], s61 offen lds
buffer_load_dwordx4 v27, s[28:31], s61 offen offset:1024 lds
s_add_u32 m0, s60, 8192
s_add_u32 s61, s61, s53
buffer_load_dwordx4 v26, s[28:31], s61 offen lds
buffer_load_dwordx4 v27, s[28:31], s61 offen offset:1024 lds
s_add_u32 m0, s60, 16384
s_add_u32 s61, s61, s53
buffer_load_dwordx4 v26, s[28:31], s61 offen lds
buffer_load_dwordx4 v27, s[28:31], s61 offen offset:1024 lds
s_add_u32 s49, s76, 4
s_and_b32 s49, s49, 15
s_mul_i32 s49, s49, 393216
buffer_load_dwordx4 v[40:43], v36, s[28:31], s49 offen
s_mov_b32 s64, 0
s_mov_b32 s65, 0
h2_loop:
s_waitcnt vmcnt(11)
s_barrier
s_add_u32 s69, s69, 1
s_and_b32 s69, s69, 15
s_mul_i32 s67, s69, 2048
s_mul_i32 s68, s69, s54
s_add_u32 m0, s70, s65
s_nop 0
buffer_load_dwordx4 v20, s[32:35], s67 offen offset:0 sc1 lds
buffer_load_dwordx4 v21, s[32:35], s67 offen offset:1024 sc1 lds
buffer_load_dwordx4 v22, s[32:35], s67 offen offset:2048 sc1 lds
buffer_load_dwordx4 v23, s[32:35], s67 offen offset:3072 sc1 lds
s_add_u32 s60, s71, s65
s_add_u32 m0, s60, 0
s_mov_b32 s61, s68
buffer_load_dwordx4 v26, s[28:31], s61 offen lds
buffer_load_dwordx4 v27, s[28:31], s61 offen offset:1024 lds
s_add_u32 m0, s60, 8192
s_add_u32 s61, s61, s53
buffer_load_dwordx4 v26, s[28:31], s61 offen lds
buffer_load_dwordx4 v27, s[28:31], s61 offen offset:1024 lds
s_add_u32 m0, s60, 16384
s_add_u32 s61, s61, s53
buffer_load_dwordx4 v26, s[28:31], s61 offen lds
buffer_load_dwordx4 v27, s[28:31], s61 offen offset:1024 lds
s_add_u32 s48, s64, 5
s_min_u32 s48, s48, 15
s_add_u32 s49, s48, s76
s_and_b32 s49, s49, 15
s_mul_i32 s49, s49, 393216
buffer_load_dwordx4 v[40:43], v36, s[28:31], s49 offen
s_add_u32 s65, s65, 40960
s_cmp_eq_u32 s65, 122880
s_cselect_b32 s65, 0, s65
s_add_u32 s64, s64, 1
s_cmp_lt_u32 s64, 11
s_cbranch_scc1 h2_loop
s_waitcnt vmcnt(11)
s_barrier
s_add_u32 s69, s47, 14
s_and_b32 s69, s69, 15
s_mul_i32 s67, s69, 2048
s_mul_i32 s68, s69, s54
s_add_u32 m0, s70, s65
s_nop 0
buffer_load_dwordx4 v20, s[32:35], s67 offen offset:0 sc1 lds
buffer_load_dwordx4 v21, s[32:35], s67 offen offset:1024 sc1 lds
buffer_load_dwordx4 v22, s[32:35], s67 offen offset:2048 sc1 lds
buffer_load_dwordx4 v23, s[32:35], s67 offen offset:3072 sc1 lds
s_add_u32 s60, s71, s65
s_add_u32 m0, s60, 0
s_mov_b32 s61, s68
buffer_load_dwordx4 v26, s[28:31], s61 offen lds
buffer_load_dwordx4 v27, s[28:31], s61 offen offset:1024 lds
s_add_u32 m0, s60, 8192
s_add_u32 s61, s61, s53
buffer_load_dwordx4 v26, s[28:31], s61 offen lds
buffer_load_dwordx4 v27, s[28:31], s61 offen offset:1024 lds
s_add_u32 m0, s60, 16384
s_add_u32 s61, s61, s53
buffer_load_dwordx4 v26, s[28:31], s61 offen lds
buffer_load_dwordx4 v27, s[28:31], s61 offen offset:1024 lds
s_add_u32 s65, s65, 40960
s_cmp_eq_u32 s65, 122880
s_cselect_b32 s65, 0, s65
s_add_u32 s64, s64, 1
s_mov_b32 s36, s12
s_and_b32 s37, s13, 0xffff
s_mov_b32 s38, 6291456
s_mov_b32 s39, 0x00020000
s_waitcnt vmcnt(10)
s_barrier
s_add_u32 s69, s47, 15
s_and_b32 s69, s69, 15
s_mul_i32 s67, s69, 2048
s_mul_i32 s68, s69, s54
s_add_u32 m0, s70, 0
s_nop 0
buffer_load_dwordx4 v20, s[32:35], s67 offen offset:0 sc1 lds
buffer_load_dwordx4 v21, s[32:35], s67 offen offset:1024 sc1 lds
buffer_load_dwordx4 v22, s[32:35], s67 offen offset:2048 sc1 lds
buffer_load_dwordx4 v23, s[32:35], s67 offen offset:3072 sc1 lds
s_add_u32 s60, s71, 0
s_add_u32 m0, s60, 0
s_mov_b32 s61, s68
buffer_load_dwordx4 v26, s[28:31], s61 offen lds
buffer_load_dwordx4 v27, s[28:31], s61 offen offset:1024 lds
s_add_u32 m0, s60, 8192
s_add_u32 s61, s61, s53
buffer_load_dwordx4 v26, s[28:31], s61 offen lds
buffer_load_dwordx4 v27, s[28:31], s61 offen offset:1024 lds
s_add_u32 m0, s60, 16384
s_add_u32 s61, s61, s53
buffer_load_dwordx4 v26, s[28:31], s61 offen lds
buffer_load_dwordx4 v27, s[28:31], s61 offen offset:1024 lds
s_waitcnt vmcnt(10)
s_barrier
s_setprio 0
buffer_load_dwordx4 v[80:83], v37, s[32:35], 0 offen offset:0 sc1
buffer_load_dwordx4 v[84:87], v37, s[32:35], 0 offen offset:1024 sc1
buffer_load_dwordx4 v[88:91], v37, s[32:35], 0 offen offset:2048 sc1
buffer_load_dwordx4 v[92:95], v37, s[32:35], 0 offen offset:3072 sc1
global_load_dword v48, v54, s[98:99]
s_add_u32 s69, s47, 0
s_and_b32 s69, s69, 15
s_mul_i32 s67, s69, 2048
s_mul_i32 s68, s69, s54
s_add_u32 s60, s71, 122880
s_add_u32 m0, s60, 0
s_mov_b32 s61, s68
buffer_load_dwordx4 v26, s[36:39], s61 offen lds
buffer_load_dwordx4 v27, s[36:39], s61 offen offset:1024 lds
s_add_u32 m0, s60, 8192
s_add_u32 s61, s61, s53
buffer_load_dwordx4 v26, s[36:39], s61 offen lds
buffer_load_dwordx4 v27, s[36:39], s61 offen offset:1024 lds
s_add_u32 m0, s60, 16384
s_add_u32 s61, s61, s53
buffer_load_dwordx4 v26, s[36:39], s61 offen lds
buffer_load_dwordx4 v27, s[36:39], s61 offen offset:1024 lds
s_waitcnt vmcnt(11)
s_barrier
s_waitcnt vmcnt(7)
buffer_store_dwordx4 v[56:59], v18, s[32:35], s86 offen offset:0 sc1
v_add_f32 v80, v80, v88
v_add_f32 v81, v81, v89
v_add_f32 v82, v82, v90
v_add_f32 v83, v83, v91
v_add_f32 v84, v84, v92
v_add_f32 v85, v85, v93
v_add_f32 v86, v86, v94
buffer_store_dwordx4 v[56:59], v18, s[32:35], s86 offen offset:1024 sc1
v_add_f32 v87, v87, v95
v_add_f32 v80, v80, v84
v_add_f32 v81, v81, v85
v_add_f32 v82, v82, v86
v_add_f32 v83, v83, v87
s_nop 1
buffer_load_dwordx4 v[240:243], v18, s[32:35], s81 offen offset:0 sc1
v_permlane32_swap_b32 v80, v81
v_permlane32_swap_b32 v82, v83
v_add_f32 v80, v80, v81
v_add_f32 v82, v82, v83
s_nop 1
v_permlane16_swap_b32 v80, v82
buffer_load_dwordx4 v[240:243], v18, s[32:35], s81 offen offset:1024 sc1
s_nop 0
v_add_f32 v80, v80, v82
v_cmp_u_f32 vcc, v80, v80
s_cbranch_vccnz again_44
summed_45:
v_mul_f32 v44, 0x3a800000, v80
buffer_load_dwordx4 v[240:243], v18, s[32:35], s82 offen offset:0 sc1
v_mov_b32 v45, v44
s_nop 1
v_permlane16_swap_b32 v44, v45
s_nop 0
v_fma_f32 v45, -v44, v44, v45
v_max_f32 v45, 0, v45
buffer_load_dwordx4 v[240:243], v18, s[32:35], s82 offen offset:1024 sc1
v_add_f32 v45, 0x3727c5ac, v45
v_rsq_f32 v46, v45
v_sub_f32 v47, 0, v44
ds_write_b32 v50, v47 offset:512
ds_write_b64 v49, v[46:47]
ds_write_b32 v50, v46
s_setprio 0
s_waitcnt lgkmcnt(0)
s_waitcnt vmcnt(63)
s_barrier
ds_write_b128 v52, v[232:235] offset:57344
ds_write_b128 v52, v[236:239] offset:58368
ds_write_b128 v51, v[152:155] offset:40960
ds_write_b128 v51, v[156:159] offset:41984
ds_write_b128 v51, v[160:163] offset:49152
ds_write_b128 v51, v[164:167] offset:50176
ds_write_b128 v51, v[168:171] offset:57344
ds_write_b128 v51, v[172:175] offset:58368
ds_write_b128 v52, v[176:179] offset:0
ds_write_b128 v52, v[180:183] offset:1024
ds_write_b128 v52, v[184:187] offset:8192
ds_write_b128 v52, v[188:191] offset:9216
ds_write_b128 v52, v[192:195] offset:16384
ds_write_b128 v52, v[196:199] offset:17408
ds_write_b128 v52, v[200:203] offset:24576
ds_write_b128 v52, v[204:207] offset:25600
ds_write_b128 v52, v[208:211] offset:32768
ds_write_b128 v52, v[212:215] offset:33792
ds_write_b128 v52, v[216:219] offset:40960
ds_write_b128 v52, v[220:223] offset:41984
ds_write_b128 v52, v[224:227] offset:49152
ds_write_b128 v52, v[228:231] offset:50176
ds_write_b128 v51, v[112:115] offset:0
ds_write_b128 v51, v[116:119] offset:1024
ds_write_b128 v51, v[120:123] offset:8192
ds_write_b128 v51, v[124:127] offset:9216
ds_write_b128 v51, v[128:131] offset:16384
ds_write_b128 v51, v[132:135] offset:17408
ds_write_b128 v51, v[136:139] offset:24576
ds_write_b128 v51, v[140:143] offset:25600
ds_write_b128 v51, v[144:147] offset:32768
ds_write_b128 v51, v[148:151] offset:33792
s_mov_b32 s28, s12
s_and_b32 s29, s13, 0xffff
s_mov_b32 s30, 6291456
s_mov_b32 s31, 0x00020000
s_add_u32 s69, s47, 0
s_and_b32 s69, s69, 15
s_mul_i32 s67, s69, 2048
s_mul_i32 s68, s69, s54
s_waitcnt vmcnt(0) lgkmcnt(0)
s_barrier
s_mov_b32 s36, s14
s_and_b32 s37, s15, 0xffff
s_mov_b32 s38, 65536
s_mov_b32 s39, 0x00020000
s_lshl_b32 s48, s42, 12
s_lshl_b32 s49, s43, 10
s_add_u32 s48, s48, s49
s_add_u32 m0, s49, 135168
s_nop 0
buffer_load_dwordx4 v18, s[36:39], s48 offen lds
v_add_u32 v37, 262144, v37
s_getpc_b64 s[98:99]
pc_47:
s_add_u32 s98, s98, c3_last - pc_47
s_addc_u32 s99, s99, 0
s_lshr_b32 s50, s2, 3
s_lshl_b32 s50, s50, 2
s_add_u32 s50, s50, s43
s_lshl_b32 s50, s50, 7
v_and_b32 v4, 1, v0
v_lshl_add_u32 v4, v4, 6, s50
v_min_u32 v54, L_code_end - c3_last, v4
s_cmp_lg_u32 s43, 0
s_cbranch_scc1 else_48
s_mov_b32 s48, 1
s_atomic_add s48, s[22:23], s73
else_48:
s_waitcnt vmcnt(0) lgkmcnt(0)
s_add_u32 s69, s47, 1
s_and_b32 s69, s69, 15
s_mul_i32 s67, s69, 2048
s_mul_i32 s68, s69, s54
s_barrier
s_add_u32 s60, s71, 40960
s_add_u32 m0, s60, 0
s_mov_b32 s61, s68
buffer_load_dwordx4 v26, s[28:31], s61 offen lds
buffer_load_dwordx4 v27, s[28:31], s61 offen offset:1024 lds
s_add_u32 m0, s60, 8192
s_add_u32 s61, s61, s53
buffer_load_dwordx4 v26, s[28:31], s61 offen lds
buffer_load_dwordx4 v27, s[28:31], s61 offen offset:1024 lds
s_add_u32 m0, s60, 16384
s_add_u32 s61, s61, s53
buffer_load_dwordx4 v26, s[28:31], s61 offen lds
buffer_load_dwordx4 v27, s[28:31], s61 offen offset:1024 lds
s_add_u32 s49, s76, 2
s_and_b32 s49, s49, 15
s_mul_i32 s49, s49, 393216
buffer_load_dwordx4 v[40:43], v36, s[28:31], s49 offen
s_add_u32 s49, s76, 3
s_and_b32 s49, s49, 15
s_mul_i32 s49, s49, 393216
buffer_load_dwordx4 v[40:43], v36, s[28:31], s49 offen
buffer_load_dword v5, v30, s[32:35], s79 offen sc1
s_add_u32 s69, s47, 0
s_and_b32 s69, s69, 15
s_mul_i32 s67, s69, 2048
s_mul_i32 s68, s69, s54
s_add_u32 m0, s70, 0
s_nop 0
s_mov_b32 s63, 0
s_waitcnt vmcnt(0)
poll_50:
v_cmp_gt_u32 vcc, 3, v5
s_cbranch_vccz polled_51
buffer_load_dword v5, v30, s[32:35], s79 offen sc1
s_add_u32 s63, s63, 1
s_cmp_lt_u32 s63, 0x80000
s_waitcnt vmcnt(0)
s_cbranch_scc1 poll_50
polled_51:
buffer_load_dwordx4 v20, s[32:35], s67 offen offset:0 sc1 lds
buffer_load_dwordx4 v21, s[32:35], s67 offen offset:1024 sc1 lds
buffer_load_dwordx4 v22, s[32:35], s67 offen offset:2048 sc1 lds
buffer_load_dwordx4 v23, s[32:35], s67 offen offset:3072 sc1 lds
s_add_u32 s69, s47, 1
s_and_b32 s69, s69, 15
s_mul_i32 s67, s69, 2048
s_mul_i32 s68, s69, s54
s_add_u32 m0, s70, 40960
s_nop 0
buffer_load_dwordx4 v20, s[32:35], s67 offen offset:0 sc1 lds
buffer_load_dwordx4 v21, s[32:35], s67 offen offset:1024 sc1 lds
buffer_load_dwordx4 v22, s[32:35], s67 offen offset:2048 sc1 lds
buffer_load_dwordx4 v23, s[32:35], s67 offen offset:3072 sc1 lds
s_waitcnt vmcnt(4) lgkmcnt(0)
s_barrier
s_add_u32 s69, s47, 2
s_and_b32 s69, s69, 15
s_mul_i32 s67, s69, 2048
s_mul_i32 s68, s69, s54
s_add_u32 m0, s70, 81920
s_nop 0
buffer_load_dwordx4 v20, s[32:35], s67 offen offset:0 sc1 lds
buffer_load_dwordx4 v21, s[32:35], s67 offen offset:1024 sc1 lds
buffer_load_dwordx4 v22, s[32:35], s67 offen offset:2048 sc1 lds
buffer_load_dwordx4 v23, s[32:35], s67 offen offset:3072 sc1 lds
s_add_u32 s60, s71, 81920
s_add_u32 m0, s60, 0
s_mov_b32 s61, s68
buffer_load_dwordx4 v26, s[28:31], s61 offen lds
buffer_load_dwordx4 v27, s[28:31], s61 offen offset:1024 lds
s_add_u32 m0, s60, 8192
s_add_u32 s61, s61, s53
buffer_load_dwordx4 v26, s[28:31], s61 offen lds
buffer_load_dwordx4 v27, s[28:31], s61 offen offset:1024 lds
s_add_u32 m0, s60, 16384
s_add_u32 s61, s61, s53
buffer_load_dwordx4 v26, s[28:31], s61 offen lds
buffer_load_dwordx4 v27, s[28:31], s61 offen offset:1024 lds
s_add_u32 s49, s76, 4
s_and_b32 s49, s49, 15
s_mul_i32 s49, s49, 393216
buffer_load_dwordx4 v[40:43], v36, s[28:31], s49 offen
s_mov_b32 s64, 0
s_mov_b32 s65, 0
h3_loop:
s_waitcnt vmcnt(11)
s_barrier
s_add_u32 s69, s69, 1
s_and_b32 s69, s69, 15
s_mul_i32 s67, s69, 2048
s_mul_i32 s68, s69, s54
s_add_u32 m0, s70, s65
s_nop 0
buffer_load_dwordx4 v20, s[32:35], s67 offen offset:0 sc1 lds
buffer_load_dwordx4 v21, s[32:35], s67 offen offset:1024 sc1 lds
buffer_load_dwordx4 v22, s[32:35], s67 offen offset:2048 sc1 lds
buffer_load_dwordx4 v23, s[32:35], s67 offen offset:3072 sc1 lds
s_add_u32 s60, s71, s65
s_add_u32 m0, s60, 0
s_mov_b32 s61, s68
buffer_load_dwordx4 v26, s[28:31], s61 offen lds
buffer_load_dwordx4 v27, s[28:31], s61 offen offset:1024 lds
s_add_u32 m0, s60, 8192
s_add_u32 s61, s61, s53
buffer_load_dwordx4 v26, s[28:31], s61 offen lds
buffer_load_dwordx4 v27, s[28:31], s61 offen offset:1024 lds
s_add_u32 m0, s60, 16384
s_add_u32 s61, s61, s53
buffer_load_dwordx4 v26, s[28:31], s61 offen lds
buffer_load_dwordx4 v27, s[28:31], s61 offen offset:1024 lds
s_add_u32 s48, s64, 5
s_min_u32 s48, s48, 15
s_add_u32 s49, s48, s76
s_and_b32 s49, s49, 15
s_mul_i32 s49, s49, 393216
buffer_load_dwordx4 v[40:43], v36, s[28:31], s49 offen
s_add_u32 s65, s65, 40960
s_cmp_eq_u32 s65, 122880
s_cselect_b32 s65, 0, s65
s_add_u32 s64, s64, 1
s_cmp_lt_u32 s64, 11
s_cbranch_scc1 h3_loop
s_waitcnt vmcnt(11)
s_barrier
s_add_u32 s69, s47, 14
s_and_b32 s69, s69, 15
s_mul_i32 s67, s69, 2048
s_mul_i32 s68, s69, s54
s_add_u32 m0, s70, s65
s_nop 0
buffer_load_dwordx4 v20, s[32:35], s67 offen offset:0 sc1 lds
buffer_load_dwordx4 v21, s[32:35], s67 offen offset:1024 sc1 lds
buffer_load_dwordx4 v22, s[32:35], s67 offen offset:2048 sc1 lds
buffer_load_dwordx4 v23, s[32:35], s67 offen offset:3072 sc1 lds
s_add_u32 s60, s71, s65
s_add_u32 m0, s60, 0
s_mov_b32 s61, s68
buffer_load_dwordx4 v26, s[28:31], s61 offen lds
buffer_load_dwordx4 v27, s[28:31], s61 offen offset:1024 lds
s_add_u32 m0, s60, 8192
s_add_u32 s61, s61, s53
buffer_load_dwordx4 v26, s[28:31], s61 offen lds
buffer_load_dwordx4 v27, s[28:31], s61 offen offset:1024 lds
s_add_u32 m0, s60, 16384
s_add_u32 s61, s61, s53
buffer_load_dwordx4 v26, s[28:31], s61 offen lds
buffer_load_dwordx4 v27, s[28:31], s61 offen offset:1024 lds
s_add_u32 s65, s65, 40960
s_cmp_eq_u32 s65, 122880
s_cselect_b32 s65, 0, s65
s_add_u32 s64, s64, 1
s_mov_b32 s36, s16
s_and_b32 s37, s17, 0xffff
s_mov_b32 s38, 2097152
s_mov_b32 s39, 0x00020000
s_waitcnt vmcnt(10)
s_barrier
s_add_u32 s69, s47, 15
s_and_b32 s69, s69, 15
s_mul_i32 s67, s69, 2048
s_mul_i32 s68, s69, s54
s_add_u32 m0, s70, 0
s_nop 0
buffer_load_dwordx4 v20, s[32:35], s67 offen offset:0 sc1 lds
buffer_load_dwordx4 v21, s[32:35], s67 offen offset:1024 sc1 lds
buffer_load_dwordx4 v22, s[32:35], s67 offen offset:2048 sc1 lds
buffer_load_dwordx4 v23, s[32:35], s67 offen offset:3072 sc1 lds
s_add_u32 s60, s71, 0
s_add_u32 m0, s60, 0
s_mov_b32 s61, s68
buffer_load_dwordx4 v26, s[28:31], s61 offen lds
buffer_load_dwordx4 v27, s[28:31], s61 offen offset:1024 lds
s_add_u32 m0, s60, 8192
s_add_u32 s61, s61, s53
buffer_load_dwordx4 v26, s[28:31], s61 offen lds
buffer_load_dwordx4 v27, s[28:31], s61 offen offset:1024 lds
s_add_u32 m0, s60, 16384
s_add_u32 s61, s61, s53
buffer_load_dwordx4 v26, s[28:31], s61 offen lds
buffer_load_dwordx4 v27, s[28:31], s61 offen offset:1024 lds
s_waitcnt vmcnt(10)
s_barrier
s_setprio 0
buffer_load_dword v33, v12, s[32:35], s73 offen sc1
buffer_load_dwordx4 v[80:83], v37, s[32:35], 0 offen offset:0 sc1
buffer_load_dwordx4 v[84:87], v37, s[32:35], 0 offen offset:1024 sc1
buffer_load_dwordx4 v[88:91], v37, s[32:35], 0 offen offset:2048 sc1
buffer_load_dwordx4 v[92:95], v37, s[32:35], 0 offen offset:3072 sc1
global_load_dword v48, v54, s[98:99]
s_add_u32 s48, s75, 15
s_and_b32 s48, s48, 15
s_mul_i32 s48, s48, s57
s_add_u32 m0, s71, 106496
s_nop 0
buffer_load_dwordx4 v28, s[36:39], s48 offen lds
buffer_load_dwordx4 v29, s[36:39], s48 offen offset:1024 lds
s_add_u32 s48, s75, 5
s_and_b32 s48, s48, 15
s_mul_i32 s48, s48, s57
s_add_u32 m0, s71, 24576
s_nop 0
buffer_load_dwordx4 v28, s[36:39], s48 offen lds
buffer_load_dwordx4 v29, s[36:39], s48 offen offset:1024 lds
s_add_u32 s48, s75, 6
s_and_b32 s48, s48, 15
s_mul_i32 s48, s48, s57
s_add_u32 m0, s71, 32768
s_nop 0
buffer_load_dwordx4 v28, s[36:39], s48 offen lds
buffer_load_dwordx4 v29, s[36:39], s48 offen offset:1024 lds
s_waitcnt vmcnt(12)
s_barrier
s_waitcnt vmcnt(7)
s_mov_b32 s63, 0
poll_55:
v_cmp_gt_u32 vcc, 16, v33
s_cbranch_vccz polled_56
buffer_load_dword v33, v12, s[32:35], s73 offen sc1
s_add_u32 s63, s63, 1
s_cmp_lt_u32 s63, 0x80000
s_waitcnt vmcnt(0)
s_cbranch_scc1 poll_55
polled_56:
s_add_u32 s48, s75, 7
s_and_b32 s48, s48, 15
s_mul_i32 s48, s48, s57
s_add_u32 m0, s71, 40960
s_nop 0
buffer_load_dwordx4 v28, s[36:39], s48 offen lds
v_add_f32 v80, v80, v88
v_add_f32 v81, v81, v89
v_add_f32 v82, v82, v90
v_add_f32 v83, v83, v91
v_add_f32 v84, v84, v92
buffer_load_dwordx4 v29, s[36:39], s48 offen offset:1024 lds
v_add_f32 v85, v85, v93
v_add_f32 v86, v86, v94
v_add_f32 v87, v87, v95
v_add_f32 v80, v80, v84
v_add_f32 v81, v81, v85
s_add_u32 s48, s75, 8
s_and_b32 s48, s48, 15
s_mul_i32 s48, s48, s57
s_add_u32 m0, s71, 49152
s_nop 0
buffer_load_dwordx4 v28, s[36:39], s48 offen lds
v_add_f32 v82, v82, v86
v_add_f32 v83, v83, v87
s_nop 1
v_permlane32_swap_b32 v80, v81
buffer_load_dwordx4 v29, s[36:39], s48 offen offset:1024 lds
v_permlane32_swap_b32 v82, v83
v_add_f32 v80, v80, v81
v_add_f32 v82, v82, v83
s_nop 1
v_permlane16_swap_b32 v80, v82
s_add_u32 s48, s75, 9
s_and_b32 s48, s48, 15
s_mul_i32 s48, s48, s57
s_add_u32 m0, s71, 57344
s_nop 0
buffer_load_dwordx4 v28, s[36:39], s48 offen lds
s_nop 0
v_add_f32 v80, v80, v82
v_cmp_u_f32 vcc, v80, v80
s_cbranch_vccnz again_52
summed_53:
buffer_load_dwordx4 v29, s[36:39], s48 offen offset:1024 lds
v_mul_f32 v44, 0x3a800000, v80
v_mov_b32 v45, v44
s_nop 1
v_permlane16_swap_b32 v44, v45
s_add_u32 s48, s75, 10
s_and_b32 s48, s48, 15
s_mul_i32 s48, s48, s57
s_add_u32 m0, s71, 65536
s_nop 0
buffer_load_dwordx4 v28, s[36:39], s48 offen lds
s_nop 0
v_fma_f32 v45, -v44, v44, v45
v_max_f32 v45, 0, v45
v_add_f32 v45, 0x3727c5ac, v45
v_rsq_f32 v46, v45
buffer_load_dwordx4 v29, s[36:39], s48 offen offset:1024 lds
v_sub_f32 v47, 0, v44
ds_write_b32 v50, v47 offset:512
ds_write_b64 v49, v[46:47]
ds_write_b32 v50, v46
s_setprio 0
s_waitcnt lgkmcnt(0)
s_waitcnt vmcnt(63)
s_barrier
s_waitcnt vmcnt(5)
s_add_u32 s48, s75, 11
s_and_b32 s48, s48, 15
s_mul_i32 s48, s48, s57
s_add_u32 m0, s71, 73728
s_nop 0
buffer_load_dwordx4 v28, s[36:39], s48 offen lds
buffer_load_dwordx4 v29, s[36:39], s48 offen offset:1024 lds
s_waitcnt vmcnt(5)
s_add_u32 s48, s75, 12
s_and_b32 s48, s48, 15
s_mul_i32 s48, s48, s57
s_add_u32 m0, s71, 81920
s_nop 0
buffer_load_dwordx4 v28, s[36:39], s48 offen lds
buffer_load_dwordx4 v29, s[36:39], s48 offen offset:1024 lds
s_waitcnt vmcnt(5)
s_add_u32 s48, s75, 13
s_and_b32 s48, s48, 15
s_mul_i32 s48, s48, s57
s_add_u32 m0, s71, 90112
s_nop 0
buffer_load_dwordx4 v28, s[36:39], s48 offen lds
buffer_load_dwordx4 v29, s[36:39], s48 offen offset:1024 lds
s_waitcnt vmcnt(5)
s_add_u32 s48, s75, 14
s_and_b32 s48, s48, 15
s_mul_i32 s48, s48, s57
s_add_u32 m0, s71, 98304
s_nop 0
buffer_load_dwordx4 v28, s[36:39], s48 offen lds
buffer_load_dwordx4 v29, s[36:39], s48 offen offset:1024 lds
s_waitcnt vmcnt(5)
s_add_u32 s48, s75, 0
s_and_b32 s48, s48, 15
s_mul_i32 s48, s48, s57
s_add_u32 m0, s71, 4294950912
s_nop 0
buffer_load_dwordx4 v28, s[36:39], s48 offen lds
buffer_load_dwordx4 v29, s[36:39], s48 offen offset:1024 lds
s_waitcnt vmcnt(5)
s_add_u32 s48, s75, 1
s_and_b32 s48, s48, 15
s_mul_i32 s48, s48, s57
s_add_u32 m0, s71, 4294959104
s_nop 0
buffer_load_dwordx4 v28, s[36:39], s48 offen lds
buffer_load_dwordx4 v29, s[36:39], s48 offen offset:1024 lds
s_waitcnt vmcnt(5)
s_add_u32 s48, s75, 2
s_and_b32 s48, s48, 15
s_mul_i32 s48, s48, s57
s_add_u32 m0, s71, 0
s_nop 0
buffer_load_dwordx4 v28, s[36:39], s48 offen lds
buffer_load_dwordx4 v29, s[36:39], s48 offen offset:1024 lds
s_waitcnt vmcnt(5)
s_add_u32 s48, s75, 3
s_and_b32 s48, s48, 15
s_mul_i32 s48, s48, s57
s_add_u32 m0, s71, 8192
s_nop 0
buffer_load_dwordx4 v28, s[36:39], s48 offen lds
buffer_load_dwordx4 v29, s[36:39], s48 offen offset:1024 lds
s_waitcnt vmcnt(5)
s_add_u32 s48, s75, 4
s_and_b32 s48, s48, 15
s_mul_i32 s48, s48, s57
s_add_u32 m0, s71, 16384
s_nop 0
buffer_load_dwordx4 v28, s[36:39], s48 offen lds
buffer_load_dwordx4 v29, s[36:39], s48 offen offset:1024 lds
s_waitcnt vmcnt(5)
buffer_load_dwordx4 v[240:243], v18, s[32:35], s81 offen offset:0 sc1
buffer_load_dwordx4 v[240:243], v18, s[32:35], s81 offen offset:1024 sc1
s_waitcnt vmcnt(5)
buffer_load_dwordx4 v[240:243], v18, s[32:35], s82 offen offset:0 sc1
buffer_load_dwordx4 v[240:243], v18, s[32:35], s82 offen offset:1024 sc1
s_waitcnt vmcnt(0) lgkmcnt(0)
s_barrier
L_end:
s_endpgm
L_compute:
s_lshr_b32 s48, s2, 2
s_and_b32 s48, s48, 1
s_lshl_b32 s48, s48, 1
s_add_u32 s48, s48, s74
s_and_b32 s49, s42, 3
s_xor_b32 s77, s48, s49
s_add_u32 s77, s77, 4
s_lshr_b32 s48, s77, 2
s_add_u32 s48, s47, s48
s_and_b32 s48, s48, 3
s_and_b32 s49, s77, 3
s_lshl_b32 s49, s49, 2
s_add_u32 s78, s48, s49
s_and_b32 s48, s2, 7
s_lshl_b32 s48, s48, 1
s_add_u32 s75, s78, s48
s_and_b32 s75, s75, 15
s_mov_b32 s46, 0
s_waitcnt lgkmcnt(0)
s_mov_b32 s32, s22
s_and_b32 s33, s23, 0xffff
s_mov_b32 s34, 268435456
s_mov_b32 s35, 0x00020000
s_mov_b32 s24, s18
s_and_b32 s25, s19, 0xffff
s_mov_b32 s26, 4194304
s_mov_b32 s27, 0x00020000
s_setprio 1
s_and_b32 s43, s40, 1
s_lshr_b32 s44, s40, 1
s_lshl_b32 s45, s42, 1
s_add_u32 s45, s45, s43
s_cmp_lg_u32 s40, 1
s_cbranch_scc1 else_57
s_getpc_b64 s[48:49]
L_pc:
s_sub_u32 s48, s48, L_pc - interleave_layers__sliding_local_dilated__linear_kernel_hedgehog__prompt_kernel
s_subb_u32 s49, s49, 0
s_lshr_b32 s50, s2, 3
s_lshl_b32 s50, s50, 12
v_lshl_add_u32 v8, v0, 6, s50
v_cmp_gt_u32 vcc, L_code_end - interleave_layers__sliding_local_dilated__linear_kernel_hedgehog__prompt_kernel, v8
s_and_saveexec_b64 s[50:51], vcc
s_cbranch_execz nopf_59
global_load_dword v254, v8, s[48:49]
nopf_59:
s_mov_b64 exec, -1
else_57:
s_lshl_b32 s48, s41, 3
s_lshl_b32 s49, s44, 2
s_add_u32 s48, s48, s49
s_lshl_b32 s48, s48, 5
s_add_u32 s48, s48, s45
s_lshl_b32 s48, s48, 10
s_add_u32 s80, s48, 4194304
s_add_u32 s81, s80, 32768
s_add_u32 s82, s80, 65536
s_add_u32 s83, s80, 98304
s_lshl_b32 s84, s41, 2
s_add_u32 s84, s84, s44
s_lshl_b32 s84, s84, 7
s_add_u32 s84, s84, 18350080
s_lshl_b32 s48, s41, 3
s_lshl_b32 s49, s40, 1
s_add_u32 s48, s48, s49
s_lshl_b32 s48, s48, 15
s_lshl_b32 s49, s78, 11
s_add_u32 s85, s48, s49
s_add_u32 s86, s85, 32768
s_lshl_b32 s50, s41, 2
s_add_u32 s50, s50, s40
s_lshl_b32 s50, s50, 4
s_add_u32 s50, s50, s42
s_lshl_b32 s50, s50, 8
s_add_u32 s87, s50, 16777216
s_lshl_b32 s88, s41, 2
s_add_u32 s88, s88, s40
s_lshl_b32 s88, s88, 7
s_add_u32 s88, s88, 18358272
v_lshrrev_b32 v4, 1, v3
v_lshl_add_u32 v4, v2, 2, v4
v_and_b32 v5, 1, v3
v_lshl_add_u32 v4, v5, 1, v4
v_lshlrev_b32 v1, 2, v4
s_lshl_b32 s48, s40, 2
s_add_u32 s48, s48, 134672
v_mov_b32 v10, s48
v_mov_b32 v11, 0
ds_write_b32 v10, v11
v_mov_b32 v140, -1
v_mov_b32 v141, -1
v_mov_b32 v142, -1
v_mov_b32 v143, -1
s_lshl_b32 s50, s42, 2
s_add_u32 s50, s50, s40
s_lshl_b32 s50, s50, 4
s_add_u32 s50, s50, s41
s_lshl_b32 s50, s50, 8
s_add_u32 s50, s50, 17825792
v_mov_b32 v4, s87
v_mov_b32 v5, s50
v_cmp_eq_u32 vcc, 0, v3
v_lshrrev_b32 v6, 1, v3
v_mul_u32_u24 v6, 262144, v6
v_add_u32 v5, v5, v6
v_cndmask_b32 v4, v5, v4, vcc
v_lshl_add_u32 v4, v2, 4, v4
buffer_store_dwordx4 v[140:143], v4, s[32:35], 0 offen sc1
s_lshl_b32 s48, s2, 2
s_add_u32 s49, s48, s40
s_lshl_b32 s48, s49, 10
s_add_u32 s48, s48, 8388608
buffer_store_dwordx4 v[140:143], v18, s[32:35], s48 offen sc1
s_and_b32 s48, s49, 7
s_cmp_lg_u32 s48, 0
s_cbranch_scc1 nofl_60
s_lshl_b32 s48, s49, 5
s_add_u32 s48, s48, 18350080
v_lshlrev_b32 v6, 2, v0
buffer_store_dword v11, v6, s[32:35], s48 offen sc1
nofl_60:
s_lshl_b32 s49, s44, 13
v_lshrrev_b32 v4, 1, v2
v_xor_b32 v4, v4, v3
v_lshlrev_b32 v4, 4, v4
v_lshl_add_u32 v10, v2, 7, v4
v_add_u32 v10, s49, v10
v_xor_b32 v11, 64, v10
s_lshl_b32 s48, s43, 1
v_lshrrev_b32 v4, 2, v2
v_and_b32 v5, 3, v0
v_lshl_add_u32 v6, v3, 3, v4
v_lshlrev_b32 v6, 7, v6
v_lshl_add_u32 v6, v5, 3, v6
v_lshrrev_b32 v7, 1, v4
v_and_b32 v8, 1, v3
v_lshl_add_u32 v7, v8, 1, v7
v_xor_b32 v7, s48, v7
v_lshl_add_u32 v12, v7, 5, v6
v_add_u32 v12, 16384, v12
v_xor_b32 v13, 32, v12
v_mov_b32 v14, v10
v_mov_b32 v15, v11
v_add_u32 v16, 0, v12
v_add_u32 v17, 0, v13
v_mov_b32 v156, 0
v_mov_b32 v157, 0
v_mov_b32 v158, 0
v_mov_b32 v159, 0
v_mov_b32 v160, 0
v_mov_b32 v161, 0
v_mov_b32 v162, 0
v_mov_b32 v163, 0
v_mov_b32 v164, 0
v_mov_b32 v165, 0
v_mov_b32 v166, 0
v_mov_b32 v167, 0
v_mov_b32 v168, 0
v_mov_b32 v169, 0
v_mov_b32 v170, 0
v_mov_b32 v171, 0
v_mov_b32 v172, 0
v_mov_b32 v173, 0
v_mov_b32 v174, 0
v_mov_b32 v175, 0
v_mov_b32 v176, 0
v_mov_b32 v177, 0
v_mov_b32 v178, 0
v_mov_b32 v179, 0
v_mov_b32 v180, 0
v_mov_b32 v181, 0
v_mov_b32 v182, 0
v_mov_b32 v183, 0
v_mov_b32 v184, 0
v_mov_b32 v185, 0
v_mov_b32 v186, 0
v_mov_b32 v187, 0
v_mov_b32 v188, 0
v_mov_b32 v189, 0
v_mov_b32 v190, 0
v_mov_b32 v191, 0
v_mov_b32 v192, 0
v_mov_b32 v193, 0
v_mov_b32 v194, 0
v_mov_b32 v195, 0
v_mov_b32 v196, 0
v_mov_b32 v197, 0
v_mov_b32 v198, 0
v_mov_b32 v199, 0
v_mov_b32 v200, 0
v_mov_b32 v201, 0
v_mov_b32 v202, 0
v_mov_b32 v203, 0
v_mov_b32 v204, 0
v_mov_b32 v205, 0
v_mov_b32 v206, 0
v_mov_b32 v207, 0
v_mov_b32 v208, 0
v_mov_b32 v209, 0
v_mov_b32 v210, 0
v_mov_b32 v211, 0
v_mov_b32 v212, 0
v_mov_b32 v213, 0
v_mov_b32 v214, 0
v_mov_b32 v215, 0
v_mov_b32 v216, 0
v_mov_b32 v217, 0
v_mov_b32 v218, 0
v_mov_b32 v219, 0
v_mov_b32 v220, 0
v_mov_b32 v221, 0
v_mov_b32 v222, 0
v_mov_b32 v223, 0
v_mov_b32 v224, 0
v_mov_b32 v225, 0
v_mov_b32 v226, 0
v_mov_b32 v227, 0
v_mov_b32 v228, 0
v_mov_b32 v229, 0
v_mov_b32 v230, 0
v_mov_b32 v231, 0
v_mov_b32 v232, 0
v_mov_b32 v233, 0
v_mov_b32 v234, 0
v_mov_b32 v235, 0
v_mov_b32 v236, 0
v_mov_b32 v237, 0
v_mov_b32 v238, 0
v_mov_b32 v239, 0
v_mov_b32 v240, 0
v_mov_b32 v241, 0
v_mov_b32 v242, 0
v_mov_b32 v243, 0
v_mov_b32 v244, 0
v_mov_b32 v245, 0
v_mov_b32 v246, 0
v_mov_b32 v247, 0
v_mov_b32 v248, 0
v_mov_b32 v249, 0
v_mov_b32 v250, 0
v_mov_b32 v251, 0
v_mov_b32 v48, 0x3f803f80
v_mov_b32 v49, 0x3f803f80
v_mov_b32 v50, 0x3f803f80
v_mov_b32 v51, 0x3f803f80
s_mov_b32 s48, 0xf149f2ca
v_mov_b32 v9, s48
v_lshlrev_b32 v4, 2, v3
v_sub_u32 v4, v2, v4
v_subrev_u32 v5, 0, v4
v_and_b32 v6, 0x80000001, v5
v_cmp_eq_u32 vcc, 0, v6
v_add_u32 v5, 1, v5
v_and_b32 v6, 0x80000001, v5
v_cndmask_b32 v40, v9, 0, vcc
v_cmp_eq_u32 vcc, 0x80000001, v6
s_nop 1
v_cndmask_b32 v36, v9, 0, vcc
v_subrev_u32 v5, 1, v4
v_and_b32 v6, 0x80000001, v5
v_cmp_eq_u32 vcc, 0, v6
v_add_u32 v5, 1, v5
v_and_b32 v6, 0x80000001, v5
v_cndmask_b32 v41, v9, 0, vcc
v_cmp_eq_u32 vcc, 0x80000001, v6
s_nop 1
v_cndmask_b32 v37, v9, 0, vcc
v_subrev_u32 v5, 2, v4
v_and_b32 v6, 0x80000001, v5
v_cmp_eq_u32 vcc, 0, v6
v_add_u32 v5, 1, v5
v_and_b32 v6, 0x80000001, v5
v_cndmask_b32 v42, v9, 0, vcc
v_cmp_eq_u32 vcc, 0x80000001, v6
s_nop 1
v_cndmask_b32 v38, v9, 0, vcc
v_subrev_u32 v5, 3, v4
v_and_b32 v6, 0x80000001, v5
v_cmp_eq_u32 vcc, 0, v6
v_add_u32 v5, 1, v5
v_and_b32 v6, 0x80000001, v5
v_cndmask_b32 v43, v9, 0, vcc
v_cmp_eq_u32 vcc, 0x80000001, v6
s_nop 1
v_cndmask_b32 v39, v9, 0, vcc
s_or_b32 s48, s41, s44
s_cmp_eq_u32 s48, 0
s_cselect_b64 vcc, -1, 0
v_cndmask_b32 v44, v36, v9, vcc
v_cndmask_b32 v45, v37, v9, vcc
v_cndmask_b32 v46, v38, v9, vcc
v_cndmask_b32 v47, v39, v9, vcc
v_and_b32 v4, 1, v2
v_lshlrev_b32 v4, 4, v4
v_mov_b32 v5, 0xffff
v_lshlrev_b32 v52, v4, v5
s_lshl_b32 s48, s43, 11
s_add_u32 s48, s48, 135168
v_add_u32 v53, s48, v18
v_lshl_add_u32 v55, v0, 3, s48
s_add_u32 s48, s41, s44
s_sub_u32 s48, s48, 1
s_lshl_b32 s49, s48, 1
s_add_u32 s49, s49, s43
s_lshl_b32 s49, s49, 11
s_mul_i32 s50, s42, 65536
s_add_u32 s49, s49, s50
s_add_u32 s49, s49, 8388608
s_cmp_lt_i32 s48, 0
s_cselect_b32 s49, 0xf0000000, s49
v_add_u32 v58, s49, v18
v_lshl_add_u32 v59, v0, 3, s49
s_lshl_b32 s48, s43, 2
s_add_u32 s48, s48, 134672
v_mov_b32 v19, s48
s_lshl_b32 s48, s43, 7
s_add_u32 s48, s48, 133120
v_lshl_add_u32 v7, v3, 4, s48
v_lshl_add_u32 v54, v2, 2, s48
s_lshl_b32 s49, s44, 6
v_add_u32 v8, s49, v2
v_lshlrev_b32 v8, 3, v8
v_add_u32 v8, 131072, v8
v_lshl_add_u32 v9, v3, 2, s49
v_lshlrev_b32 v9, 2, v9
v_add_u32 v9, 132096, v9
s_mov_b32 s64, 0
s_mov_b32 s65, 0
s_mov_b32 s66, 0x3e8293ee
s_mov_b32 s61, 1
s_lshl_b32 s50, s42, 2
s_add_u32 s50, s50, s40
s_lshl_b32 s50, s50, 4
s_add_u32 s50, s50, s41
s_lshl_b32 s50, s50, 8
s_add_u32 s52, s50, 17825792
v_lshrrev_b32 v4, 1, v2
v_lshrrev_b32 v5, 1, v3
v_xor_b32 v4, v4, v5
v_lshlrev_b32 v4, 4, v4
v_and_b32 v5, 1, v3
v_lshl_add_u32 v4, v5, 3, v4
v_lshl_add_u32 v4, v2, 7, v4
s_lshl_b32 s48, s40, 12
v_add_u32 v155, s48, v4
v_mov_b32 v152, 0
v_mov_b32 v153, 0
v_mov_b32 v56, 0
v_mov_b32 v57, 0
s_waitcnt vmcnt(0)
s_lshl_b32 s79, 1, s77
s_or_b32 s79, s79, 0
s_barrier
ds_read_b128 v[60:63], v14 offset:0
ds_read_b128 v[64:67], v14 offset:2048
ds_read_b128 v[68:71], v14 offset:4096
ds_read_b128 v[72:75], v14 offset:6144
ds_read_b64_tr_b16 v[84:85], v16 offset:8192
ds_read_b64_tr_b16 v[86:87], v16 offset:8704
ds_read_b64_tr_b16 v[88:89], v17 offset:8192
ds_read_b64_tr_b16 v[90:91], v17 offset:8704
ds_read_b64_tr_b16 v[92:93], v16 offset:16384
ds_read_b64_tr_b16 v[94:95], v16 offset:16896
ds_read_b64_tr_b16 v[96:97], v17 offset:16384
ds_read_b64_tr_b16 v[98:99], v17 offset:16896
ds_read_b64_tr_b16 v[76:77], v16 offset:0
ds_read_b64_tr_b16 v[78:79], v16 offset:512
ds_read_b64_tr_b16 v[80:81], v17 offset:0
ds_read_b64_tr_b16 v[82:83], v17 offset:512
s_waitcnt lgkmcnt(0)
c0_loop:
v_mfma_f32_16x16x32_bf16 v[212:215], v[84:87], v[72:75], v[212:215]
ds_read_b128 v[100:103], v15 offset:0
v_mfma_f32_16x16x32_bf16 v[204:207], v[84:87], v[68:71], v[204:207]
ds_read_b128 v[104:107], v15 offset:2048
v_mfma_f32_16x16x32_bf16 v[196:199], v[84:87], v[64:67], v[196:199]
ds_read_b128 v[108:111], v15 offset:4096
v_mfma_f32_16x16x32_bf16 v[188:191], v[84:87], v[60:63], v[188:191]
ds_read_b128 v[112:115], v15 offset:6144
v_mfma_f32_16x16x32_bf16 v[192:195], v[88:91], v[60:63], v[192:195]
ds_read_b64_tr_b16 v[124:125], v16 offset:12288
v_mfma_f32_16x16x32_bf16 v[200:203], v[88:91], v[64:67], v[200:203]
ds_read_b64_tr_b16 v[126:127], v16 offset:12800
v_mfma_f32_16x16x32_bf16 v[208:211], v[88:91], v[68:71], v[208:211]
ds_read_b64_tr_b16 v[128:129], v17 offset:12288
v_mfma_f32_16x16x32_bf16 v[216:219], v[88:91], v[72:75], v[216:219]
ds_read_b64_tr_b16 v[130:131], v17 offset:12800
v_mfma_f32_16x16x32_bf16 v[244:247], v[72:75], v[92:95], v[244:247]
ds_read_b64_tr_b16 v[132:133], v16 offset:20480
v_mfma_f32_16x16x32_bf16 v[248:251], v[72:75], v[96:99], v[248:251]
ds_read_b64_tr_b16 v[134:135], v16 offset:20992
v_mfma_f32_16x16x32_bf16 v[240:243], v[68:71], v[96:99], v[240:243]
ds_read_b64_tr_b16 v[136:137], v17 offset:20480
v_mfma_f32_16x16x32_bf16 v[236:239], v[68:71], v[92:95], v[236:239]
ds_read_b64_tr_b16 v[138:139], v17 offset:20992
v_mfma_f32_16x16x32_bf16 v[228:231], v[64:67], v[92:95], v[228:231]
ds_read_b64_tr_b16 v[116:117], v16 offset:4096
v_mfma_f32_16x16x32_bf16 v[232:235], v[64:67], v[96:99], v[232:235]
ds_read_b64_tr_b16 v[118:119], v16 offset:4608
v_mfma_f32_16x16x32_bf16 v[224:227], v[60:63], v[96:99], v[224:227]
ds_read_b64_tr_b16 v[120:121], v17 offset:4096
v_mfma_f32_16x16x32_bf16 v[220:223], v[60:63], v[92:95], v[220:223]
ds_read_b64_tr_b16 v[122:123], v17 offset:4608
v_mfma_f32_16x16x32_bf16 v[156:159], v[76:79], v[60:63], v[156:159]
s_bitcmp1_b32 s79, s64
s_cbranch_scc1 c0_hook
c0_hook_ret:
v_mfma_f32_16x16x32_bf16 v[164:167], v[76:79], v[64:67], v[164:167]
s_add_u32 s65, s65, 40960
s_cmp_eq_u32 s65, 122880
v_mfma_f32_16x16x32_bf16 v[172:175], v[76:79], v[68:71], v[172:175]
s_cselect_b32 s65, 0, s65
s_add_u32 s64, s64, 1
v_mfma_f32_16x16x32_bf16 v[180:183], v[76:79], v[72:75], v[180:183]
v_add_u32 v14, s65, v10
v_add_u32 v15, s65, v11
v_mfma_f32_16x16x32_bf16 v[184:187], v[80:83], v[72:75], v[184:187]
v_add_u32 v16, s65, v12
v_add_u32 v17, s65, v13
v_mfma_f32_16x16x32_bf16 v[176:179], v[80:83], v[68:71], v[176:179]
s_cmp_eq_u32 s64, 16
s_cbranch_scc1 c0_last
v_mfma_f32_16x16x32_bf16 v[168:171], v[80:83], v[64:67], v[168:171]
s_waitcnt lgkmcnt(0)
v_mfma_f32_16x16x32_bf16 v[160:163], v[80:83], v[60:63], v[160:163]
s_barrier
v_mfma_f32_16x16x32_bf16 v[212:215], v[124:127], v[112:115], v[212:215]
ds_read_b128 v[60:63], v14 offset:0
v_mfma_f32_16x16x32_bf16 v[204:207], v[124:127], v[108:111], v[204:207]
ds_read_b128 v[64:67], v14 offset:2048
v_mfma_f32_16x16x32_bf16 v[196:199], v[124:127], v[104:107], v[196:199]
ds_read_b128 v[68:71], v14 offset:4096
v_mfma_f32_16x16x32_bf16 v[188:191], v[124:127], v[100:103], v[188:191]
ds_read_b128 v[72:75], v14 offset:6144
v_mfma_f32_16x16x32_bf16 v[192:195], v[128:131], v[100:103], v[192:195]
ds_read_b64_tr_b16 v[84:85], v16 offset:8192
v_mfma_f32_16x16x32_bf16 v[200:203], v[128:131], v[104:107], v[200:203]
ds_read_b64_tr_b16 v[86:87], v16 offset:8704
v_mfma_f32_16x16x32_bf16 v[208:211], v[128:131], v[108:111], v[208:211]
ds_read_b64_tr_b16 v[88:89], v17 offset:8192
v_mfma_f32_16x16x32_bf16 v[216:219], v[128:131], v[112:115], v[216:219]
ds_read_b64_tr_b16 v[90:91], v17 offset:8704
v_mfma_f32_16x16x32_bf16 v[244:247], v[112:115], v[132:135], v[244:247]
ds_read_b64_tr_b16 v[92:93], v16 offset:16384
v_mfma_f32_16x16x32_bf16 v[248:251], v[112:115], v[136:139], v[248:251]
ds_read_b64_tr_b16 v[94:95], v16 offset:16896
v_mfma_f32_16x16x32_bf16 v[240:243], v[108:111], v[136:139], v[240:243]
ds_read_b64_tr_b16 v[96:97], v17 offset:16384
v_mfma_f32_16x16x32_bf16 v[236:239], v[108:111], v[132:135], v[236:239]
ds_read_b64_tr_b16 v[98:99], v17 offset:16896
v_mfma_f32_16x16x32_bf16 v[228:231], v[104:107], v[132:135], v[228:231]
ds_read_b64_tr_b16 v[76:77], v16 offset:0
v_mfma_f32_16x16x32_bf16 v[232:235], v[104:107], v[136:139], v[232:235]
ds_read_b64_tr_b16 v[78:79], v16 offset:512
v_mfma_f32_16x16x32_bf16 v[224:227], v[100:103], v[136:139], v[224:227]
ds_read_b64_tr_b16 v[80:81], v17 offset:0
v_mfma_f32_16x16x32_bf16 v[220:223], v[100:103], v[132:135], v[220:223]
ds_read_b64_tr_b16 v[82:83], v17 offset:512
v_mfma_f32_16x16x32_bf16 v[156:159], v[116:119], v[100:103], v[156:159]
v_mfma_f32_16x16x32_bf16 v[164:167], v[116:119], v[104:107], v[164:167]
v_mfma_f32_16x16x32_bf16 v[172:175], v[116:119], v[108:111], v[172:175]
v_mfma_f32_16x16x32_bf16 v[180:183], v[116:119], v[112:115], v[180:183]
v_mfma_f32_16x16x32_bf16 v[184:187], v[120:123], v[112:115], v[184:187]
v_mfma_f32_16x16x32_bf16 v[176:179], v[120:123], v[108:111], v[176:179]
v_mfma_f32_16x16x32_bf16 v[168:171], v[120:123], v[104:107], v[168:171]
s_waitcnt lgkmcnt(0)
v_mfma_f32_16x16x32_bf16 v[160:163], v[120:123], v[100:103], v[160:163]
s_branch c0_loop
c0_hook:
v_add_u32 v4, s65, v155
ds_read_b64 v[20:21], v4 offset:0
ds_read_b64 v[28:29], v4 offset:2048
v_xor_b32 v5, 32, v4
ds_read_b64 v[22:23], v5 offset:0
ds_read_b64 v[30:31], v5 offset:2048
v_xor_b32 v5, 64, v4
ds_read_b64 v[24:25], v5 offset:0
ds_read_b64 v[32:33], v5 offset:2048
v_xor_b32 v5, 96, v4
ds_read_b64 v[26:27], v5 offset:0
ds_read_b64 v[34:35], v5 offset:2048
s_waitcnt lgkmcnt(8)
s_cmp_lg_u32 s44, 0
s_cbranch_scc1 else_61
v_mfma_f32_16x16x32_bf16 v[140:143], v[48:51], v[76:79], 0
v_mfma_f32_16x16x32_bf16 v[144:147], v[48:51], v[84:87], 0
v_mfma_f32_16x16x32_bf16 v[148:151], v[48:51], v[92:95], 0
v_mfma_f32_16x16x32_bf16 v[140:143], v[48:51], v[116:119], v[140:143]
v_mfma_f32_16x16x32_bf16 v[144:147], v[48:51], v[124:127], v[144:147]
v_mfma_f32_16x16x32_bf16 v[148:151], v[48:51], v[132:135], v[148:151]
s_branch fi_62
else_61:
v_mfma_f32_16x16x32_bf16 v[140:143], v[48:51], v[80:83], 0
v_mfma_f32_16x16x32_bf16 v[144:147], v[48:51], v[88:91], 0
v_mfma_f32_16x16x32_bf16 v[148:151], v[48:51], v[96:99], 0
v_mfma_f32_16x16x32_bf16 v[140:143], v[48:51], v[120:123], v[140:143]
v_mfma_f32_16x16x32_bf16 v[144:147], v[48:51], v[128:131], v[144:147]
v_mfma_f32_16x16x32_bf16 v[148:151], v[48:51], v[136:139], v[148:151]
fi_62:
s_waitcnt lgkmcnt(0)
v_dot2c_f32_bf16 v152, v20, v48
v_dot2c_f32_bf16 v56, v20, v20
v_dot2c_f32_bf16 v153, v28, v48
v_dot2c_f32_bf16 v57, v28, v28
v_dot2c_f32_bf16 v152, v21, v48
v_dot2c_f32_bf16 v56, v21, v21
v_dot2c_f32_bf16 v153, v29, v48
v_dot2c_f32_bf16 v57, v29, v29
v_dot2c_f32_bf16 v152, v22, v48
v_dot2c_f32_bf16 v56, v22, v22
v_dot2c_f32_bf16 v153, v30, v48
v_dot2c_f32_bf16 v57, v30, v30
v_dot2c_f32_bf16 v152, v23, v48
v_dot2c_f32_bf16 v56, v23, v23
v_dot2c_f32_bf16 v153, v31, v48
v_dot2c_f32_bf16 v57, v31, v31
v_dot2c_f32_bf16 v152, v24, v48
v_dot2c_f32_bf16 v56, v24, v24
v_dot2c_f32_bf16 v153, v32, v48
v_dot2c_f32_bf16 v57, v32, v32
v_dot2c_f32_bf16 v152, v25, v48
v_dot2c_f32_bf16 v56, v25, v25
v_dot2c_f32_bf16 v153, v33, v48
v_dot2c_f32_bf16 v57, v33, v33
v_dot2c_f32_bf16 v152, v26, v48
v_dot2c_f32_bf16 v56, v26, v26
v_dot2c_f32_bf16 v153, v34, v48
v_dot2c_f32_bf16 v57, v34, v34
v_dot2c_f32_bf16 v152, v27, v48
v_dot2c_f32_bf16 v56, v27, v27
v_dot2c_f32_bf16 v153, v35, v48
v_dot2c_f32_bf16 v57, v35, v35
v_cmp_eq_u32 vcc, 0, v3
v_cmp_eq_u32 s[48:49], 1, v3
s_nop 1
v_cndmask_b32 v4, v148, v144, s[48:49]
v_cndmask_b32 v4, v4, v140, vcc
buffer_store_dword v4, v1, s[32:35], s52 offen sc1
s_nop 1
v_permlane32_swap_b32 v152, v153
v_permlane32_swap_b32 v56, v57
v_add_f32 v152, v152, v153
v_add_f32 v56, v56, v57
s_nop 1
v_permlane16_swap_b32 v152, v56
s_nop 0
v_add_f32 v152, v152, v56
buffer_store_dword v152, v1, s[32:35], s87 offen sc1
s_branch c0_hook_ret
c0_last:
v_mfma_f32_16x16x32_bf16 v[168:171], v[80:83], v[64:67], v[168:171]
s_waitcnt lgkmcnt(0)
v_mfma_f32_16x16x32_bf16 v[160:163], v[80:83], v[60:63], v[160:163]
v_mfma_f32_16x16x32_bf16 v[212:215], v[124:127], v[112:115], v[212:215]
v_mfma_f32_16x16x32_bf16 v[204:207], v[124:127], v[108:111], v[204:207]
v_mfma_f32_16x16x32_bf16 v[196:199], v[124:127], v[104:107], v[196:199]
v_mfma_f32_16x16x32_bf16 v[188:191], v[124:127], v[100:103], v[188:191]
v_mfma_f32_16x16x32_bf16 v[192:195], v[128:131], v[100:103], v[192:195]
v_mfma_f32_16x16x32_bf16 v[200:203], v[128:131], v[104:107], v[200:203]
v_mfma_f32_16x16x32_bf16 v[208:211], v[128:131], v[108:111], v[208:211]
v_mfma_f32_16x16x32_bf16 v[216:219], v[128:131], v[112:115], v[216:219]
s_barrier
v_mfma_f32_16x16x32_bf16 v[244:247], v[112:115], v[132:135], v[244:247]
ds_read_b128 v[140:143], v7 offset:0
ds_read_b128 v[144:147], v7 offset:64
v_mfma_f32_16x16x32_bf16 v[248:251], v[112:115], v[136:139], v[248:251]
ds_read_b128 v[148:151], v7 offset:256
ds_read_b128 v[152:155], v7 offset:320
v_mfma_f32_16x16x32_bf16 v[240:243], v[108:111], v[136:139], v[240:243]
ds_read_b64 v[92:93], v8 offset:0
ds_read_b64 v[94:95], v8 offset:128
v_mfma_f32_16x16x32_bf16 v[236:239], v[108:111], v[132:135], v[236:239]
ds_read_b64 v[96:97], v8 offset:256
ds_read_b64 v[98:99], v8 offset:384
v_mfma_f32_16x16x32_bf16 v[228:231], v[104:107], v[132:135], v[228:231]
ds_read2_b32 v[56:57], v54 offset0:128 offset1:144
ds_read_b128 v[60:63], v9 offset:0
v_mfma_f32_16x16x32_bf16 v[232:235], v[104:107], v[136:139], v[232:235]
ds_read_b128 v[64:67], v9 offset:64
v_mfma_f32_16x16x32_bf16 v[224:227], v[100:103], v[136:139], v[224:227]
ds_read_b128 v[68:71], v9 offset:128
v_mfma_f32_16x16x32_bf16 v[220:223], v[100:103], v[132:135], v[220:223]
ds_read_b128 v[72:75], v9 offset:192
v_mfma_f32_16x16x32_bf16 v[156:159], v[116:119], v[100:103], v[156:159]
ds_read_b128 v[76:79], v9 offset:512
v_mfma_f32_16x16x32_bf16 v[164:167], v[116:119], v[104:107], v[164:167]
ds_read_b128 v[80:83], v9 offset:576
v_mfma_f32_16x16x32_bf16 v[172:175], v[116:119], v[108:111], v[172:175]
ds_read_b128 v[84:87], v9 offset:640
v_mfma_f32_16x16x32_bf16 v[180:183], v[116:119], v[112:115], v[180:183]
ds_read_b128 v[88:91], v9 offset:704
v_mfma_f32_16x16x32_bf16 v[184:187], v[120:123], v[112:115], v[184:187]
v_mov_b32 v6, 134656
ds_read_b32 v6, v6
v_mfma_f32_16x16x32_bf16 v[176:179], v[120:123], v[108:111], v[176:179]
v_mfma_f32_16x16x32_bf16 v[168:171], v[120:123], v[104:107], v[168:171]
v_mfma_f32_16x16x32_bf16 v[160:163], v[120:123], v[100:103], v[160:163]
c0_epi:
s_waitcnt lgkmcnt(0)
v_readfirstlane_b32 s46, v6
.p2align 3
v_pk_fma_f32 v[212:213], v[148:149], v[98:99], v[212:213] op_sel:[0,1,0] op_sel_hi:[1,1,1]
v_pk_fma_f32 v[214:215], v[150:151], v[98:99], v[214:215] op_sel:[0,1,0] op_sel_hi:[1,1,1]
v_pk_fma_f32 v[216:217], v[152:153], v[98:99], v[216:217] op_sel:[0,1,0] op_sel_hi:[1,1,1]
v_pk_fma_f32 v[218:219], v[154:155], v[98:99], v[218:219] op_sel:[0,1,0] op_sel_hi:[1,1,1]
v_pk_mul_f32 v[212:213], v[212:213], v[98:99] op_sel:[0,0] op_sel_hi:[1,0]
v_pk_mul_f32 v[214:215], v[214:215], v[98:99] op_sel:[0,0] op_sel_hi:[1,0]
v_pk_mul_f32 v[216:217], v[216:217], v[98:99] op_sel:[0,0] op_sel_hi:[1,0]
v_pk_mul_f32 v[218:219], v[218:219], v[98:99] op_sel:[0,0] op_sel_hi:[1,0]
v_cvt_pk_bf16_f32 v212, v212, v213
v_cvt_pk_bf16_f32 v213, v214, v215
v_cvt_pk_bf16_f32 v214, v216, v217
v_cvt_pk_bf16_f32 v215, v218, v219
v_pk_fma_f32 v[244:245], v[88:89], v[56:57], v[244:245] op_sel:[0,0,0] op_sel_hi:[1,0,1]
v_pk_fma_f32 v[246:247], v[90:91], v[56:57], v[246:247] op_sel:[0,0,0] op_sel_hi:[1,0,1]
v_pk_mul_f32 v[244:245], v[244:245], v[72:73]
v_pk_mul_f32 v[246:247], v[246:247], v[74:75]
v_cvt_pk_bf16_f32 v108, v244, v245
v_cvt_pk_bf16_f32 v109, v246, v247
v_pk_fma_f32 v[248:249], v[88:89], v[56:57], v[248:249] op_sel:[0,1,0] op_sel_hi:[1,1,1]
v_pk_fma_f32 v[250:251], v[90:91], v[56:57], v[250:251] op_sel:[0,1,0] op_sel_hi:[1,1,1]
v_pk_mul_f32 v[248:249], v[248:249], v[72:73]
v_pk_mul_f32 v[250:251], v[250:251], v[74:75]
v_cvt_pk_bf16_f32 v118, v248, v249
v_cvt_pk_bf16_f32 v119, v250, v251
s_cmp_lg_u32 s44, 1
s_cbranch_scc1 else_63
buffer_store_dwordx4 v[212:215], v58, s[32:35], 0 offen sc1
buffer_store_dwordx2 v[108:109], v59, s[32:35], 0 offen offset:1024 sc1
buffer_store_dwordx2 v[118:119], v59, s[32:35], 0 offen offset:1536 sc1
s_branch fi_64
else_63:
ds_write_b128 v53, v[212:215]
ds_write_b64 v55, v[108:109] offset:1024
ds_write_b64 v55, v[118:119] offset:1536
v_mov_b32 v4, 1
ds_write_b32 v19, v4
fi_64:
.p2align 3
v_pk_fma_f32 v[188:189], v[148:149], v[92:93], v[188:189] op_sel:[0,1,0] op_sel_hi:[1,1,1]
v_pk_fma_f32 v[196:197], v[148:149], v[94:95], v[196:197] op_sel:[0,1,0] op_sel_hi:[1,1,1]
v_pk_fma_f32 v[204:205], v[148:149], v[96:97], v[204:205] op_sel:[0,1,0] op_sel_hi:[1,1,1]
v_pk_fma_f32 v[164:165], v[140:141], v[94:95], v[164:165] op_sel:[0,1,0] op_sel_hi:[1,1,1]
v_pk_fma_f32 v[172:173], v[140:141], v[96:97], v[172:173] op_sel:[0,1,0] op_sel_hi:[1,1,1]
v_pk_fma_f32 v[180:181], v[140:141], v[98:99], v[180:181] op_sel:[0,1,0] op_sel_hi:[1,1,1]
v_pk_fma_f32 v[190:191], v[150:151], v[92:93], v[190:191] op_sel:[0,1,0] op_sel_hi:[1,1,1]
v_pk_mul_f32 v[188:189], v[188:189], v[92:93] op_sel:[0,0] op_sel_hi:[1,0]
v_pk_fma_f32 v[198:199], v[150:151], v[94:95], v[198:199] op_sel:[0,1,0] op_sel_hi:[1,1,1]
v_pk_mul_f32 v[196:197], v[196:197], v[94:95] op_sel:[0,0] op_sel_hi:[1,0]
v_pk_fma_f32 v[206:207], v[150:151], v[96:97], v[206:207] op_sel:[0,1,0] op_sel_hi:[1,1,1]
v_pk_mul_f32 v[204:205], v[204:205], v[96:97] op_sel:[0,0] op_sel_hi:[1,0]
v_pk_fma_f32 v[166:167], v[142:143], v[94:95], v[166:167] op_sel:[0,1,0] op_sel_hi:[1,1,1]
v_cvt_pk_bf16_f32 v164, v164, v165
v_pk_fma_f32 v[174:175], v[142:143], v[96:97], v[174:175] op_sel:[0,1,0] op_sel_hi:[1,1,1]
v_cvt_pk_bf16_f32 v172, v172, v173
v_pk_fma_f32 v[182:183], v[142:143], v[98:99], v[182:183] op_sel:[0,1,0] op_sel_hi:[1,1,1]
v_cvt_pk_bf16_f32 v180, v180, v181
v_pk_fma_f32 v[192:193], v[152:153], v[92:93], v[192:193] op_sel:[0,1,0] op_sel_hi:[1,1,1]
v_pk_fma_f32 v[194:195], v[154:155], v[92:93], v[194:195] op_sel:[0,1,0] op_sel_hi:[1,1,1]
v_pk_mul_f32 v[190:191], v[190:191], v[92:93] op_sel:[0,0] op_sel_hi:[1,0]
v_cvt_pk_bf16_f32 v188, v188, v189
v_pk_fma_f32 v[200:201], v[152:153], v[94:95], v[200:201] op_sel:[0,1,0] op_sel_hi:[1,1,1]
v_pk_fma_f32 v[202:203], v[154:155], v[94:95], v[202:203] op_sel:[0,1,0] op_sel_hi:[1,1,1]
v_pk_mul_f32 v[198:199], v[198:199], v[94:95] op_sel:[0,0] op_sel_hi:[1,0]
v_cvt_pk_bf16_f32 v196, v196, v197
v_pk_fma_f32 v[208:209], v[152:153], v[96:97], v[208:209] op_sel:[0,1,0] op_sel_hi:[1,1,1]
v_pk_fma_f32 v[210:211], v[154:155], v[96:97], v[210:211] op_sel:[0,1,0] op_sel_hi:[1,1,1]
v_pk_mul_f32 v[206:207], v[206:207], v[96:97] op_sel:[0,0] op_sel_hi:[1,0]
v_cvt_pk_bf16_f32 v204, v204, v205
v_pk_fma_f32 v[168:169], v[144:145], v[94:95], v[168:169] op_sel:[0,1,0] op_sel_hi:[1,1,1]
v_pk_fma_f32 v[170:171], v[146:147], v[94:95], v[170:171] op_sel:[0,1,0] op_sel_hi:[1,1,1]
v_cvt_pk_bf16_f32 v165, v166, v167
v_pk_fma_f32 v[176:177], v[144:145], v[96:97], v[176:177] op_sel:[0,1,0] op_sel_hi:[1,1,1]
v_pk_fma_f32 v[178:179], v[146:147], v[96:97], v[178:179] op_sel:[0,1,0] op_sel_hi:[1,1,1]
v_cvt_pk_bf16_f32 v173, v174, v175
v_pk_fma_f32 v[184:185], v[144:145], v[98:99], v[184:185] op_sel:[0,1,0] op_sel_hi:[1,1,1]
v_pk_fma_f32 v[186:187], v[146:147], v[98:99], v[186:187] op_sel:[0,1,0] op_sel_hi:[1,1,1]
v_cvt_pk_bf16_f32 v181, v182, v183
v_pk_mul_f32 v[192:193], v[192:193], v[92:93] op_sel:[0,0] op_sel_hi:[1,0]
v_pk_mul_f32 v[194:195], v[194:195], v[92:93] op_sel:[0,0] op_sel_hi:[1,0]
v_cvt_pk_bf16_f32 v189, v190, v191
v_pk_mul_f32 v[200:201], v[200:201], v[94:95] op_sel:[0,0] op_sel_hi:[1,0]
v_pk_mul_f32 v[202:203], v[202:203], v[94:95] op_sel:[0,0] op_sel_hi:[1,0]
v_cvt_pk_bf16_f32 v197, v198, v199
v_pk_mul_f32 v[208:209], v[208:209], v[96:97] op_sel:[0,0] op_sel_hi:[1,0]
v_pk_mul_f32 v[210:211], v[210:211], v[96:97] op_sel:[0,0] op_sel_hi:[1,0]
v_cvt_pk_bf16_f32 v205, v206, v207
v_cvt_pk_bf16_f32 v166, v168, v169
v_cvt_pk_bf16_f32 v167, v170, v171
v_cvt_pk_bf16_f32 v174, v176, v177
v_cvt_pk_bf16_f32 v175, v178, v179
v_cvt_pk_bf16_f32 v182, v184, v185
v_cvt_pk_bf16_f32 v183, v186, v187
v_cvt_pk_bf16_f32 v190, v192, v193
v_cvt_pk_bf16_f32 v191, v194, v195
v_mfma_f32_16x16x32_bf16 v[216:219], v[212:215], v[180:183], v[40:43]
v_cvt_pk_bf16_f32 v198, v200, v201
v_cvt_pk_bf16_f32 v199, v202, v203
v_mfma_f32_16x16x32_bf16 v[168:171], v[188:191], v[164:167], v[36:39]
v_cvt_pk_bf16_f32 v206, v208, v209
v_cvt_pk_bf16_f32 v207, v210, v211
v_mfma_f32_16x16x32_bf16 v[200:203], v[196:199], v[164:167], v[40:43]
v_mul_f32 v124, s66, v92
v_mul_f32 v125, s66, v94
v_mfma_f32_16x16x32_bf16 v[208:211], v[204:207], v[172:175], v[40:43]
v_mul_f32 v126, s66, v96
v_mul_f32 v127, s66, v98
v_mfma_f32_16x16x32_bf16 v[176:179], v[196:199], v[172:175], v[36:39]
v_max_f32 v164, v168, v169
v_max_f32 v165, v170, v171
v_mfma_f32_16x16x32_bf16 v[184:187], v[204:207], v[180:183], v[36:39]
v_max_f32 v166, v200, v201
v_max_f32 v182, v216, v217
v_max_f32 v174, v208, v209
v_max_f32 v167, v202, v203
v_max3_f32 v129, v164, v165, v166
v_pk_fma_f32 v[156:157], v[140:141], v[92:93], v[156:157] op_sel:[0,1,0] op_sel_hi:[1,1,1]
v_pk_fma_f32 v[158:159], v[142:143], v[92:93], v[158:159] op_sel:[0,1,0] op_sel_hi:[1,1,1]
v_cvt_pk_bf16_f32 v156, v156, v157
v_pk_fma_f32 v[160:161], v[144:145], v[92:93], v[160:161] op_sel:[0,1,0] op_sel_hi:[1,1,1]
v_pk_fma_f32 v[162:163], v[146:147], v[92:93], v[162:163] op_sel:[0,1,0] op_sel_hi:[1,1,1]
v_cvt_pk_bf16_f32 v157, v158, v159
v_cvt_pk_bf16_f32 v158, v160, v161
v_cvt_pk_bf16_f32 v159, v162, v163
v_pk_fma_f32 v[220:221], v[76:77], v[56:57], v[220:221] op_sel:[0,0,0] op_sel_hi:[1,0,1]
v_pk_fma_f32 v[222:223], v[78:79], v[56:57], v[222:223] op_sel:[0,0,0] op_sel_hi:[1,0,1]
v_mfma_f32_16x16x32_bf16 v[192:195], v[188:191], v[156:159], v[40:43]
v_max_f32 v172, v176, v177
v_max_f32 v173, v178, v179
v_max_f32 v180, v184, v185
v_max_f32 v181, v186, v187
v_max_f32_e64 v175, v210, v211
v_pk_fma_f32 v[224:225], v[76:77], v[56:57], v[224:225] op_sel:[0,1,0] op_sel_hi:[1,1,1]
v_pk_fma_f32 v[226:227], v[78:79], v[56:57], v[226:227] op_sel:[0,1,0] op_sel_hi:[1,1,1]
v_pk_fma_f32 v[228:229], v[80:81], v[56:57], v[228:229] op_sel:[0,0,0] op_sel_hi:[1,0,1]
v_pk_fma_f32 v[230:231], v[82:83], v[56:57], v[230:231] op_sel:[0,0,0] op_sel_hi:[1,0,1]
v_pk_fma_f32 v[232:233], v[80:81], v[56:57], v[232:233] op_sel:[0,1,0] op_sel_hi:[1,1,1]
v_pk_fma_f32 v[234:235], v[82:83], v[56:57], v[234:235] op_sel:[0,1,0] op_sel_hi:[1,1,1]
v_pk_fma_f32 v[236:237], v[84:85], v[56:57], v[236:237] op_sel:[0,0,0] op_sel_hi:[1,0,1]
v_pk_fma_f32 v[238:239], v[86:87], v[56:57], v[238:239] op_sel:[0,0,0] op_sel_hi:[1,0,1]
v_pk_fma_f32 v[240:241], v[84:85], v[56:57], v[240:241] op_sel:[0,1,0] op_sel_hi:[1,1,1]
v_pk_fma_f32 v[242:243], v[86:87], v[56:57], v[242:243] op_sel:[0,1,0] op_sel_hi:[1,1,1]
v_pk_mul_f32 v[220:221], v[220:221], v[60:61]
v_pk_mul_f32 v[222:223], v[222:223], v[62:63]
v_pk_mul_f32 v[224:225], v[224:225], v[60:61]
s_cmp_lg_u32 s44, 0
s_cbranch_scc1 else_65
buffer_load_dwordx4 v[120:123], v58, s[32:35], 0 offen sc1
buffer_load_dwordx2 v[100:101], v59, s[32:35], 0 offen offset:1024 sc1
buffer_load_dwordx2 v[110:111], v59, s[32:35], 0 offen offset:1536 sc1
else_65:
v_pk_mul_f32 v[226:227], v[226:227], v[62:63]
v_pk_mul_f32 v[228:229], v[228:229], v[64:65]
v_pk_mul_f32 v[230:231], v[230:231], v[66:67]
v_pk_mul_f32 v[232:233], v[232:233], v[64:65]
v_pk_mul_f32 v[234:235], v[234:235], v[66:67]
v_pk_mul_f32 v[236:237], v[236:237], v[68:69]
v_pk_mul_f32 v[238:239], v[238:239], v[70:71]
v_pk_mul_f32 v[240:241], v[240:241], v[68:69]
v_pk_mul_f32 v[242:243], v[242:243], v[70:71]
v_max3_f32 v130, v172, v173, v174
v_max_f32_e64 v183, v218, v219
v_max3_f32 v131, v180, v181, v182
v_cvt_pk_bf16_f32 v102, v220, v221
v_cvt_pk_bf16_f32 v103, v222, v223
v_cvt_pk_bf16_f32 v112, v224, v225
v_cvt_pk_bf16_f32 v113, v226, v227
v_cvt_pk_bf16_f32 v104, v228, v229
v_cvt_pk_bf16_f32 v105, v230, v231
v_cvt_pk_bf16_f32 v114, v232, v233
v_cvt_pk_bf16_f32 v115, v234, v235
v_cvt_pk_bf16_f32 v106, v236, v237
v_cvt_pk_bf16_f32 v107, v238, v239
v_cvt_pk_bf16_f32 v116, v240, v241
v_cvt_pk_bf16_f32 v117, v242, v243
v_max_f32 v129, v129, v167
v_max_f32 v130, v130, v175
v_max_f32 v131, v131, v183
s_cmp_lg_u32 s44, 0
s_cbranch_scc1 else_67
s_mov_b32 s63, 0
sent_69:
s_waitcnt vmcnt(0)
v_max_u32 v4, v120, v121
v_max3_u32 v4, v4, v122, v123
v_max3_u32 v4, v4, v100, v101
v_max3_u32 v4, v4, v110, v111
v_cmp_eq_u32 vcc, -1, v4
s_cbranch_vccz sentd_70
buffer_load_dwordx4 v[120:123], v58, s[32:35], 0 offen sc1
buffer_load_dwordx2 v[100:101], v59, s[32:35], 0 offen offset:1024 sc1
buffer_load_dwordx2 v[110:111], v59, s[32:35], 0 offen offset:1536 sc1
s_add_u32 s63, s63, 1
s_cmp_lt_u32 s63, 0x80000
s_cbranch_scc1 sent_69
s_waitcnt vmcnt(0)
sentd_70:
v_mov_b32 v132, -1
v_mov_b32 v133, -1
v_mov_b32 v134, -1
v_mov_b32 v135, -1
buffer_store_dwordx4 v[132:135], v58, s[32:35], 0 offen offset:0 sc1
buffer_store_dwordx4 v[132:135], v58, s[32:35], 0 offen offset:1024 sc1
s_branch fi_68
else_67:
s_mov_b32 s63, 0
px_71:
ds_read_b32 v4, v19
ds_read_b128 v[120:123], v53
ds_read_b64 v[100:101], v55 offset:1024
ds_read_b64 v[110:111], v55 offset:1536
s_add_u32 s63, s63, 1
s_cmp_lt_u32 s63, 0x400000
s_waitcnt lgkmcnt(0)
v_cmp_ne_u32 vcc, 1, v4
s_cbranch_vccz pxd_72
s_cbranch_scc1 px_71
pxd_72:
fi_68:
s_cmp_eq_u32 s46, 0
s_cbranch_scc1 slow_73
.p2align 3
v_mfma_f32_16x16x32_bf16 v[160:163], v[120:123], v[156:159], v[44:47]
v_max_f32 v158, v192, v193
v_max_f32 v159, v194, v195
v_permlane32_swap_b32 v130, v131
s_nop 0
v_max_f32 v130, v130, v131
s_nop 2
v_max_f32 v156, v160, v161
v_max_f32 v157, v162, v163
v_max3_f32 v128, v156, v157, v158
v_max_f32 v128, v128, v159
s_nop 1
v_permlane32_swap_b32 v128, v129
s_nop 0
v_max_f32 v128, v128, v129
s_nop 1
v_permlane16_swap_b32 v128, v130
s_nop 0
v_max_f32 v128, v128, v130
v_mov_b32 v130, v128
s_nop 1
v_permlane16_swap_b32 v128, v130
s_nop 0
v_mov_b32 v129, v128
v_mov_b32 v131, v130
s_nop 0
v_permlane32_swap_b32 v128, v129
v_permlane32_swap_b32 v130, v131
v_mul_f32 v128, v128, v124
v_mul_f32 v129, v129, v125
v_pk_fma_f32 v[156:157], v[156:157], v[124:125], v[128:129] op_sel:[0,0,0] op_sel_hi:[1,0,0] neg_lo:[0,0,1] neg_hi:[0,0,1]
v_pk_fma_f32 v[158:159], v[158:159], v[124:125], v[128:129] op_sel:[0,0,0] op_sel_hi:[1,0,0] neg_lo:[0,0,1] neg_hi:[0,0,1]
v_mul_f32 v130, v130, v126
v_mul_f32 v131, v131, v127
v_exp_f32 v156, v156
v_exp_f32 v157, v157
v_exp_f32 v158, v158
v_exp_f32 v159, v159
v_pk_fma_f32 v[164:165], v[164:165], v[124:125], v[128:129] op_sel:[0,1,1] op_sel_hi:[1,1,1] neg_lo:[0,0,1] neg_hi:[0,0,1]
v_pk_fma_f32 v[166:167], v[166:167], v[124:125], v[128:129] op_sel:[0,1,1] op_sel_hi:[1,1,1] neg_lo:[0,0,1] neg_hi:[0,0,1]
v_exp_f32 v164, v164
v_exp_f32 v165, v165
v_exp_f32 v166, v166
v_exp_f32 v167, v167
v_pk_fma_f32 v[172:173], v[172:173], v[126:127], v[130:131] op_sel:[0,0,0] op_sel_hi:[1,0,0] neg_lo:[0,0,1] neg_hi:[0,0,1]
v_pk_fma_f32 v[174:175], v[174:175], v[126:127], v[130:131] op_sel:[0,0,0] op_sel_hi:[1,0,0] neg_lo:[0,0,1] neg_hi:[0,0,1]
v_cvt_pk_bf16_f32 v156, v156, v156
v_cvt_pk_bf16_f32 v157, v157, v157
v_cvt_pk_bf16_f32 v158, v158, v158
v_cvt_pk_bf16_f32 v159, v159, v159
v_exp_f32 v172, v172
v_exp_f32 v173, v173
v_exp_f32 v174, v174
v_exp_f32 v175, v175
v_pk_fma_f32 v[180:181], v[180:181], v[126:127], v[130:131] op_sel:[0,1,1] op_sel_hi:[1,1,1] neg_lo:[0,0,1] neg_hi:[0,0,1]
v_pk_fma_f32 v[182:183], v[182:183], v[126:127], v[130:131] op_sel:[0,1,1] op_sel_hi:[1,1,1] neg_lo:[0,0,1] neg_hi:[0,0,1]
v_and_b32 v156, v52, v156
v_and_b32 v157, v52, v157
v_and_b32 v158, v52, v158
v_and_b32 v159, v52, v159
v_cvt_pk_bf16_f32 v164, v164, v164
v_cvt_pk_bf16_f32 v165, v165, v165
v_mfma_f32_16x16x32_bf16 v[160:163], v[48:51], v[156:159], 0
v_cvt_pk_bf16_f32 v166, v166, v166
v_cvt_pk_bf16_f32 v167, v167, v167
v_mfma_f32_16x16x32_bf16 v[220:223], v[100:103], v[156:159], 0
v_exp_f32 v180, v180
v_mfma_f32_16x16x32_bf16 v[224:227], v[110:113], v[156:159], 0
v_exp_f32 v181, v181
v_exp_f32 v182, v182
v_exp_f32 v183, v183
v_and_b32 v164, v52, v164
v_and_b32 v165, v52, v165
v_and_b32 v166, v52, v166
v_and_b32 v167, v52, v167
v_cvt_pk_bf16_f32 v172, v172, v172
v_cvt_pk_bf16_f32 v173, v173, v173
v_mfma_f32_16x16x32_bf16 v[168:171], v[48:51], v[164:167], 0
v_cvt_pk_bf16_f32 v174, v174, v174
v_cvt_pk_bf16_f32 v175, v175, v175
v_mfma_f32_16x16x32_bf16 v[228:231], v[102:105], v[164:167], 0
v_and_b32 v172, v52, v172
v_and_b32 v173, v52, v173
v_mfma_f32_16x16x32_bf16 v[232:235], v[112:115], v[164:167], 0
v_and_b32 v174, v52, v174
v_and_b32 v175, v52, v175
v_cvt_pk_bf16_f32 v180, v180, v180
v_cvt_pk_bf16_f32 v181, v181, v181
v_mfma_f32_16x16x32_bf16 v[176:179], v[48:51], v[172:175], 0
v_cvt_pk_bf16_f32 v182, v182, v182
v_cvt_pk_bf16_f32 v183, v183, v183
v_mfma_f32_16x16x32_bf16 v[236:239], v[104:107], v[172:175], 0
v_and_b32 v180, v52, v180
v_and_b32 v181, v52, v181
v_mfma_f32_16x16x32_bf16 v[240:243], v[114:117], v[172:175], 0
v_and_b32 v182, v52, v182
v_and_b32 v183, v52, v183
v_rcp_f32 v160, v160
v_rcp_f32 v168, v168
v_pk_mul_f32 v[220:221], v[220:221], v[160:161] op_sel:[0,0] op_sel_hi:[1,0]
v_pk_mul_f32 v[222:223], v[222:223], v[160:161] op_sel:[0,0] op_sel_hi:[1,0]
v_pk_mul_f32 v[228:229], v[228:229], v[168:169] op_sel:[0,0] op_sel_hi:[1,0]
v_pk_mul_f32 v[224:225], v[224:225], v[160:161] op_sel:[0,0] op_sel_hi:[1,0]
v_pk_mul_f32 v[226:227], v[226:227], v[160:161] op_sel:[0,0] op_sel_hi:[1,0]
v_pk_mul_f32 v[230:231], v[230:231], v[168:169] op_sel:[0,0] op_sel_hi:[1,0]
v_pk_mul_f32 v[232:233], v[232:233], v[168:169] op_sel:[0,0] op_sel_hi:[1,0]
v_pk_mul_f32 v[234:235], v[234:235], v[168:169] op_sel:[0,0] op_sel_hi:[1,0]
v_mfma_f32_16x16x32_bf16 v[184:187], v[48:51], v[180:183], 0
v_rcp_f32_e64 v176, v176
v_cvt_pk_bf16_f32 v220, v220, v221
v_cvt_pk_bf16_f32 v221, v222, v223
v_cvt_pk_bf16_f32 v228, v228, v229
v_pk_mul_f32 v[236:237], v[236:237], v[176:177] op_sel:[0,0] op_sel_hi:[1,0]
v_mfma_f32_16x16x32_bf16 v[244:247], v[106:109], v[180:183], 0
v_cvt_pk_bf16_f32 v222, v224, v225
v_cvt_pk_bf16_f32 v223, v226, v227
v_rcp_f32_e64 v184, v184
v_cvt_pk_bf16_f32 v229, v230, v231
v_pk_mul_f32 v[238:239], v[238:239], v[176:177] op_sel:[0,0] op_sel_hi:[1,0]
v_pk_mul_f32 v[240:241], v[240:241], v[176:177] op_sel:[0,0] op_sel_hi:[1,0]
v_pk_mul_f32 v[242:243], v[242:243], v[176:177] op_sel:[0,0] op_sel_hi:[1,0]
v_cvt_pk_bf16_f32 v236, v236, v237
v_pk_mul_f32 v[244:245], v[244:245], v[184:185] op_sel:[0,0] op_sel_hi:[1,0]
v_pk_mul_f32 v[246:247], v[246:247], v[184:185] op_sel:[0,0] op_sel_hi:[1,0]
v_mfma_f32_16x16x32_bf16 v[248:251], v[116:119], v[180:183], 0
buffer_store_dwordx4 v[220:223], v18, s[32:35], s80 offen sc1
v_cvt_pk_bf16_f32 v230, v232, v233
v_cvt_pk_bf16_f32 v231, v234, v235
v_cvt_pk_bf16_f32 v237, v238, v239
v_cvt_pk_bf16_f32 v244, v244, v245
buffer_store_dwordx4 v[228:231], v18, s[32:35], s81 offen sc1
v_cvt_pk_bf16_f32 v238, v240, v241
v_cvt_pk_bf16_f32 v239, v242, v243
v_pk_mul_f32 v[248:249], v[248:249], v[184:185] op_sel:[0,0] op_sel_hi:[1,0]
v_pk_mul_f32 v[250:251], v[250:251], v[184:185] op_sel:[0,0] op_sel_hi:[1,0]
v_cvt_pk_bf16_f32 v245, v246, v247
buffer_store_dwordx4 v[236:239], v18, s[32:35], s82 offen sc1
v_cvt_pk_bf16_f32 v246, v248, v249
v_cvt_pk_bf16_f32 v247, v250, v251
buffer_store_dwordx4 v[244:247], v18, s[32:35], s83 offen sc1
back_74:
s_barrier
v_and_b32 v36, 31, v0
v_lshlrev_b32 v36, 2, v36
s_lshl_b32 s62, s45, 2
v_mov_b32 v4, s62
v_mov_b32 v5, 1
s_mov_b64 exec, 1
s_waitcnt vmcnt(0)
s_cmp_eq_u32 s46, 0
s_cbranch_scc1 slow_75
buffer_store_dword v5, v4, s[32:35], s84 offen
back_76:
s_mov_b64 exec, -1
v_lshrrev_b32 v4, 2, v2
v_and_b32 v5, 3, v0
v_lshl_add_u32 v6, v3, 3, v4
v_lshlrev_b32 v6, 7, v6
v_lshl_add_u32 v6, v5, 3, v6
v_lshrrev_b32 v7, 1, v4
v_and_b32 v8, 1, v3
v_lshl_add_u32 v7, v8, 1, v7
v_lshl_add_u32 v10, v7, 5, v6
v_xor_b32 v11, 32, v10
v_xor_b32 v12, 64, v10
v_xor_b32 v13, 96, v10
v_add_u32 v14, 0x10000, v10
v_add_u32 v15, 0x10000, v11
v_add_u32 v16, 0x10000, v12
v_add_u32 v17, 0x10000, v13
ds_read_b64_tr_b16 v[220:221], v10 offset:0
ds_read_b64_tr_b16 v[222:223], v10 offset:512
ds_read_b64_tr_b16 v[224:225], v11 offset:0
ds_read_b64_tr_b16 v[226:227], v11 offset:512
ds_read_b64_tr_b16 v[228:229], v12 offset:0
ds_read_b64_tr_b16 v[230:231], v12 offset:512
ds_read_b64_tr_b16 v[232:233], v13 offset:0
ds_read_b64_tr_b16 v[234:235], v13 offset:512
ds_read_b64_tr_b16 v[236:237], v10 offset:4096
ds_read_b64_tr_b16 v[238:239], v10 offset:4608
ds_read_b64_tr_b16 v[240:241], v11 offset:4096
ds_read_b64_tr_b16 v[242:243], v11 offset:4608
ds_read_b64_tr_b16 v[244:245], v12 offset:4096
ds_read_b64_tr_b16 v[246:247], v12 offset:4608
ds_read_b64_tr_b16 v[248:249], v13 offset:4096
ds_read_b64_tr_b16 v[250:251], v13 offset:4608
s_lshl_b32 s48, s41, 3
s_lshl_b32 s49, s40, 1
s_add_u32 s48, s48, s49
s_lshl_b32 s48, s48, 15
s_add_u32 s48, s48, 4194304
v_add_u32 v38, s48, v18
v_add_u32 v39, 32768, v38
s_lshl_b32 s57, s75, 11
s_add_u32 s87, s87, 262144
v_lshlrev_b32 v60, 16, v20
v_and_b32 v61, 0xffff0000, v20
v_lshlrev_b32 v62, 16, v21
v_and_b32 v63, 0xffff0000, v21
v_lshlrev_b32 v64, 16, v22
v_and_b32 v65, 0xffff0000, v22
v_lshlrev_b32 v66, 16, v23
v_and_b32 v67, 0xffff0000, v23
v_lshlrev_b32 v68, 16, v24
v_and_b32 v69, 0xffff0000, v24
v_lshlrev_b32 v70, 16, v25
v_and_b32 v71, 0xffff0000, v25
v_lshlrev_b32 v72, 16, v26
v_and_b32 v73, 0xffff0000, v26
v_lshlrev_b32 v74, 16, v27
v_and_b32 v75, 0xffff0000, v27
v_lshlrev_b32 v76, 16, v28
v_and_b32 v77, 0xffff0000, v28
v_lshlrev_b32 v78, 16, v29
v_and_b32 v79, 0xffff0000, v29
v_lshlrev_b32 v80, 16, v30
v_and_b32 v81, 0xffff0000, v30
v_lshlrev_b32 v82, 16, v31
v_and_b32 v83, 0xffff0000, v31
v_lshlrev_b32 v84, 16, v32
v_and_b32 v85, 0xffff0000, v32
v_lshlrev_b32 v86, 16, v33
v_and_b32 v87, 0xffff0000, v33
v_lshlrev_b32 v88, 16, v34
v_and_b32 v89, 0xffff0000, v34
v_lshlrev_b32 v90, 16, v35
v_and_b32 v91, 0xffff0000, v35
v_mov_b32 v6, 0
v_mov_b32 v7, 0
v_mov_b32 v8, 0
v_mov_b32 v9, 0
s_lshl_b32 s62, s42, 2
v_mov_b32 v4, s62
v_mov_b32 v5, 1
buffer_load_dword v37, v36, s[32:35], s84 offen sc1
s_mov_b32 s63, 0
s_waitcnt vmcnt(0)
poll_77:
v_cmp_gt_u32 vcc, 1, v37
s_cbranch_vccz polled_78
buffer_load_dword v37, v36, s[32:35], s84 offen sc1
s_add_u32 s63, s63, 1
s_cmp_lt_u32 s63, 0x80000
s_waitcnt vmcnt(0)
s_cbranch_scc1 poll_77
polled_78:
s_getpc_b64 s[94:95]
pc_79:
s_add_u32 s94, s94, R_oloop_end - pc_79
s_addc_u32 s95, s95, 0
R_oloop:
buffer_load_dwordx4 v[156:159], v38, s[32:35], s57 offen sc1
buffer_load_dwordx4 v[160:163], v39, s[32:35], s57 offen sc1
buffer_load_dwordx4 v[164:167], v38, s[32:35], s57 offen offset:1024 sc1
buffer_load_dwordx4 v[168:171], v39, s[32:35], s57 offen offset:1024 sc1
s_add_u32 s57, s57, 2048
s_and_b32 s57, s57, 0x7fff
buffer_load_dwordx4 v[172:175], v38, s[32:35], s57 offen sc1
buffer_load_dwordx4 v[176:179], v39, s[32:35], s57 offen sc1
buffer_load_dwordx4 v[180:183], v38, s[32:35], s57 offen offset:1024 sc1
buffer_load_dwordx4 v[184:187], v39, s[32:35], s57 offen offset:1024 sc1
s_add_u32 s57, s57, 2048
s_and_b32 s57, s57, 0x7fff
buffer_load_dwordx4 v[188:191], v38, s[32:35], s57 offen sc1
buffer_load_dwordx4 v[192:195], v39, s[32:35], s57 offen sc1
s_waitcnt vmcnt(8) lgkmcnt(8)
v_mfma_f32_16x16x32_bf16 v[60:63], v[220:223], v[156:159], v[60:63]
buffer_load_dwordx4 v[196:199], v38, s[32:35], s57 offen offset:1024 sc1
v_mfma_f32_16x16x32_bf16 v[76:79], v[220:223], v[160:163], v[76:79]
ds_read_b64_tr_b16 v[100:101], v10 offset:8192
ds_read_b64_tr_b16 v[102:103], v10 offset:8704
v_mfma_f32_16x16x32_bf16 v[80:83], v[224:227], v[160:163], v[80:83]
ds_read_b64_tr_b16 v[104:105], v11 offset:8192
ds_read_b64_tr_b16 v[106:107], v11 offset:8704
v_mfma_f32_16x16x32_bf16 v[64:67], v[224:227], v[156:159], v[64:67]
buffer_load_dwordx4 v[200:203], v39, s[32:35], s57 offen offset:1024 sc1
v_mfma_f32_16x16x32_bf16 v[68:71], v[228:231], v[156:159], v[68:71]
ds_read_b64_tr_b16 v[108:109], v12 offset:8192
ds_read_b64_tr_b16 v[110:111], v12 offset:8704
v_mfma_f32_16x16x32_bf16 v[84:87], v[228:231], v[160:163], v[84:87]
ds_read_b64_tr_b16 v[112:113], v13 offset:8192
ds_read_b64_tr_b16 v[114:115], v13 offset:8704
v_mfma_f32_16x16x32_bf16 v[88:91], v[232:235], v[160:163], v[88:91]
s_add_u32 s57, s57, 2048
s_and_b32 s57, s57, 0x7fff
v_mfma_f32_16x16x32_bf16 v[72:75], v[232:235], v[156:159], v[72:75]
s_waitcnt vmcnt(8) lgkmcnt(8)
v_mfma_f32_16x16x32_bf16 v[60:63], v[236:239], v[164:167], v[60:63]
buffer_load_dwordx4 v[204:207], v38, s[32:35], s57 offen sc1
v_mfma_f32_16x16x32_bf16 v[76:79], v[236:239], v[168:171], v[76:79]
ds_read_b64_tr_b16 v[220:221], v10 offset:12288
ds_read_b64_tr_b16 v[222:223], v10 offset:12800
v_mfma_f32_16x16x32_bf16 v[80:83], v[240:243], v[168:171], v[80:83]
ds_read_b64_tr_b16 v[224:225], v11 offset:12288
ds_read_b64_tr_b16 v[226:227], v11 offset:12800
v_mfma_f32_16x16x32_bf16 v[64:67], v[240:243], v[164:167], v[64:67]
buffer_load_dwordx4 v[208:211], v39, s[32:35], s57 offen sc1
v_mfma_f32_16x16x32_bf16 v[68:71], v[244:247], v[164:167], v[68:71]
ds_read_b64_tr_b16 v[228:229], v12 offset:12288
ds_read_b64_tr_b16 v[230:231], v12 offset:12800
v_mfma_f32_16x16x32_bf16 v[84:87], v[244:247], v[168:171], v[84:87]
ds_read_b64_tr_b16 v[232:233], v13 offset:12288
ds_read_b64_tr_b16 v[234:235], v13 offset:12800
v_mfma_f32_16x16x32_bf16 v[88:91], v[248:251], v[168:171], v[88:91]
v_mfma_f32_16x16x32_bf16 v[72:75], v[248:251], v[164:167], v[72:75]
s_waitcnt vmcnt(8) lgkmcnt(8)
v_mfma_f32_16x16x32_bf16 v[60:63], v[100:103], v[172:175], v[60:63]
buffer_load_dwordx4 v[212:215], v38, s[32:35], s57 offen offset:1024 sc1
v_mfma_f32_16x16x32_bf16 v[76:79], v[100:103], v[176:179], v[76:79]
ds_read_b64_tr_b16 v[236:237], v10 offset:16384
ds_read_b64_tr_b16 v[238:239], v10 offset:16896
v_mfma_f32_16x16x32_bf16 v[80:83], v[104:107], v[176:179], v[80:83]
ds_read_b64_tr_b16 v[240:241], v11 offset:16384
ds_read_b64_tr_b16 v[242:243], v11 offset:16896
v_mfma_f32_16x16x32_bf16 v[64:67], v[104:107], v[172:175], v[64:67]
buffer_load_dwordx4 v[216:219], v39, s[32:35], s57 offen offset:1024 sc1
v_mfma_f32_16x16x32_bf16 v[68:71], v[108:111], v[172:175], v[68:71]
ds_read_b64_tr_b16 v[244:245], v12 offset:16384
ds_read_b64_tr_b16 v[246:247], v12 offset:16896
v_mfma_f32_16x16x32_bf16 v[84:87], v[108:111], v[176:179], v[84:87]
ds_read_b64_tr_b16 v[248:249], v13 offset:16384
ds_read_b64_tr_b16 v[250:251], v13 offset:16896
v_mfma_f32_16x16x32_bf16 v[88:91], v[112:115], v[176:179], v[88:91]
s_add_u32 s57, s57, 2048
s_and_b32 s57, s57, 0x7fff
v_mfma_f32_16x16x32_bf16 v[72:75], v[112:115], v[172:175], v[72:75]
s_waitcnt vmcnt(8) lgkmcnt(8)
v_mfma_f32_16x16x32_bf16 v[60:63], v[220:223], v[180:183], v[60:63]
buffer_load_dwordx4 v[156:159], v38, s[32:35], s57 offen sc1
v_mfma_f32_16x16x32_bf16 v[76:79], v[220:223], v[184:187], v[76:79]
ds_read_b64_tr_b16 v[100:101], v10 offset:20480
ds_read_b64_tr_b16 v[102:103], v10 offset:20992
v_mfma_f32_16x16x32_bf16 v[80:83], v[224:227], v[184:187], v[80:83]
ds_read_b64_tr_b16 v[104:105], v11 offset:20480
ds_read_b64_tr_b16 v[106:107], v11 offset:20992
v_mfma_f32_16x16x32_bf16 v[64:67], v[224:227], v[180:183], v[64:67]
buffer_load_dwordx4 v[160:163], v39, s[32:35], s57 offen sc1
v_mfma_f32_16x16x32_bf16 v[68:71], v[228:231], v[180:183], v[68:71]
ds_read_b64_tr_b16 v[108:109], v12 offset:20480
ds_read_b64_tr_b16 v[110:111], v12 offset:20992
v_mfma_f32_16x16x32_bf16 v[84:87], v[228:231], v[184:187], v[84:87]
ds_read_b64_tr_b16 v[112:113], v13 offset:20480
ds_read_b64_tr_b16 v[114:115], v13 offset:20992
v_mfma_f32_16x16x32_bf16 v[88:91], v[232:235], v[184:187], v[88:91]
v_mfma_f32_16x16x32_bf16 v[72:75], v[232:235], v[180:183], v[72:75]
s_waitcnt vmcnt(8) lgkmcnt(8)
v_mfma_f32_16x16x32_bf16 v[60:63], v[236:239], v[188:191], v[60:63]
buffer_load_dwordx4 v[164:167], v38, s[32:35], s57 offen offset:1024 sc1
v_mfma_f32_16x16x32_bf16 v[76:79], v[236:239], v[192:195], v[76:79]
ds_read_b64_tr_b16 v[220:221], v10 offset:24576
ds_read_b64_tr_b16 v[222:223], v10 offset:25088
v_mfma_f32_16x16x32_bf16 v[80:83], v[240:243], v[192:195], v[80:83]
ds_read_b64_tr_b16 v[224:225], v11 offset:24576
ds_read_b64_tr_b16 v[226:227], v11 offset:25088
v_mfma_f32_16x16x32_bf16 v[64:67], v[240:243], v[188:191], v[64:67]
buffer_load_dwordx4 v[168:171], v39, s[32:35], s57 offen offset:1024 sc1
v_mfma_f32_16x16x32_bf16 v[68:71], v[244:247], v[188:191], v[68:71]
ds_read_b64_tr_b16 v[228:229], v12 offset:24576
ds_read_b64_tr_b16 v[230:231], v12 offset:25088
v_mfma_f32_16x16x32_bf16 v[84:87], v[244:247], v[192:195], v[84:87]
ds_read_b64_tr_b16 v[232:233], v13 offset:24576
ds_read_b64_tr_b16 v[234:235], v13 offset:25088
v_mfma_f32_16x16x32_bf16 v[88:91], v[248:251], v[192:195], v[88:91]
s_add_u32 s57, s57, 2048
s_and_b32 s57, s57, 0x7fff
v_mfma_f32_16x16x32_bf16 v[72:75], v[248:251], v[188:191], v[72:75]
s_waitcnt vmcnt(8) lgkmcnt(8)
v_mfma_f32_16x16x32_bf16 v[60:63], v[100:103], v[196:199], v[60:63]
buffer_load_dwordx4 v[172:175], v38, s[32:35], s57 offen sc1
v_mfma_f32_16x16x32_bf16 v[76:79], v[100:103], v[200:203], v[76:79]
ds_read_b64_tr_b16 v[236:237], v10 offset:28672
ds_read_b64_tr_b16 v[238:239], v10 offset:29184
v_mfma_f32_16x16x32_bf16 v[80:83], v[104:107], v[200:203], v[80:83]
ds_read_b64_tr_b16 v[240:241], v11 offset:28672
ds_read_b64_tr_b16 v[242:243], v11 offset:29184
v_mfma_f32_16x16x32_bf16 v[64:67], v[104:107], v[196:199], v[64:67]
buffer_load_dwordx4 v[176:179], v39, s[32:35], s57 offen sc1
v_mfma_f32_16x16x32_bf16 v[68:71], v[108:111], v[196:199], v[68:71]
ds_read_b64_tr_b16 v[244:245], v12 offset:28672
ds_read_b64_tr_b16 v[246:247], v12 offset:29184
v_mfma_f32_16x16x32_bf16 v[84:87], v[108:111], v[200:203], v[84:87]
ds_read_b64_tr_b16 v[248:249], v13 offset:28672
ds_read_b64_tr_b16 v[250:251], v13 offset:29184
v_mfma_f32_16x16x32_bf16 v[88:91], v[112:115], v[200:203], v[88:91]
v_mfma_f32_16x16x32_bf16 v[72:75], v[112:115], v[196:199], v[72:75]
s_waitcnt vmcnt(8) lgkmcnt(8)
v_mfma_f32_16x16x32_bf16 v[60:63], v[220:223], v[204:207], v[60:63]
buffer_load_dwordx4 v[180:183], v38, s[32:35], s57 offen offset:1024 sc1
v_mfma_f32_16x16x32_bf16 v[76:79], v[220:223], v[208:211], v[76:79]
ds_read_b64_tr_b16 v[100:101], v10 offset:32768
ds_read_b64_tr_b16 v[102:103], v10 offset:33280
v_mfma_f32_16x16x32_bf16 v[80:83], v[224:227], v[208:211], v[80:83]
ds_read_b64_tr_b16 v[104:105], v11 offset:32768
ds_read_b64_tr_b16 v[106:107], v11 offset:33280
v_mfma_f32_16x16x32_bf16 v[64:67], v[224:227], v[204:207], v[64:67]
buffer_load_dwordx4 v[184:187], v39, s[32:35], s57 offen offset:1024 sc1
v_mfma_f32_16x16x32_bf16 v[68:71], v[228:231], v[204:207], v[68:71]
ds_read_b64_tr_b16 v[108:109], v12 offset:32768
ds_read_b64_tr_b16 v[110:111], v12 offset:33280
v_mfma_f32_16x16x32_bf16 v[84:87], v[228:231], v[208:211], v[84:87]
ds_read_b64_tr_b16 v[112:113], v13 offset:32768
ds_read_b64_tr_b16 v[114:115], v13 offset:33280
v_mfma_f32_16x16x32_bf16 v[88:91], v[232:235], v[208:211], v[88:91]
s_add_u32 s57, s57, 2048
s_and_b32 s57, s57, 0x7fff
v_mfma_f32_16x16x32_bf16 v[72:75], v[232:235], v[204:207], v[72:75]
s_waitcnt vmcnt(8) lgkmcnt(8)
v_mfma_f32_16x16x32_bf16 v[60:63], v[236:239], v[212:215], v[60:63]
buffer_load_dwordx4 v[188:191], v38, s[32:35], s57 offen sc1
v_mfma_f32_16x16x32_bf16 v[76:79], v[236:239], v[216:219], v[76:79]
ds_read_b64_tr_b16 v[220:221], v10 offset:36864
ds_read_b64_tr_b16 v[222:223], v10 offset:37376
v_mfma_f32_16x16x32_bf16 v[80:83], v[240:243], v[216:219], v[80:83]
ds_read_b64_tr_b16 v[224:225], v11 offset:36864
ds_read_b64_tr_b16 v[226:227], v11 offset:37376
v_mfma_f32_16x16x32_bf16 v[64:67], v[240:243], v[212:215], v[64:67]
buffer_load_dwordx4 v[192:195], v39, s[32:35], s57 offen sc1
v_mfma_f32_16x16x32_bf16 v[68:71], v[244:247], v[212:215], v[68:71]
ds_read_b64_tr_b16 v[228:229], v12 offset:36864
ds_read_b64_tr_b16 v[230:231], v12 offset:37376
v_mfma_f32_16x16x32_bf16 v[84:87], v[244:247], v[216:219], v[84:87]
ds_read_b64_tr_b16 v[232:233], v13 offset:36864
ds_read_b64_tr_b16 v[234:235], v13 offset:37376
v_mfma_f32_16x16x32_bf16 v[88:91], v[248:251], v[216:219], v[88:91]
v_mfma_f32_16x16x32_bf16 v[72:75], v[248:251], v[212:215], v[72:75]
s_waitcnt vmcnt(8) lgkmcnt(8)
v_mfma_f32_16x16x32_bf16 v[60:63], v[100:103], v[156:159], v[60:63]
buffer_load_dwordx4 v[196:199], v38, s[32:35], s57 offen offset:1024 sc1
v_mfma_f32_16x16x32_bf16 v[76:79], v[100:103], v[160:163], v[76:79]
ds_read_b64_tr_b16 v[236:237], v10 offset:40960
ds_read_b64_tr_b16 v[238:239], v10 offset:41472
v_mfma_f32_16x16x32_bf16 v[80:83], v[104:107], v[160:163], v[80:83]
ds_read_b64_tr_b16 v[240:241], v11 offset:40960
ds_read_b64_tr_b16 v[242:243], v11 offset:41472
v_mfma_f32_16x16x32_bf16 v[64:67], v[104:107], v[156:159], v[64:67]
buffer_load_dwordx4 v[200:203], v39, s[32:35], s57 offen offset:1024 sc1
v_mfma_f32_16x16x32_bf16 v[68:71], v[108:111], v[156:159], v[68:71]
ds_read_b64_tr_b16 v[244:245], v12 offset:40960
ds_read_b64_tr_b16 v[246:247], v12 offset:41472
v_mfma_f32_16x16x32_bf16 v[84:87], v[108:111], v[160:163], v[84:87]
ds_read_b64_tr_b16 v[248:249], v13 offset:40960
ds_read_b64_tr_b16 v[250:251], v13 offset:41472
v_mfma_f32_16x16x32_bf16 v[88:91], v[112:115], v[160:163], v[88:91]
s_add_u32 s57, s57, 2048
s_and_b32 s57, s57, 0x7fff
v_mfma_f32_16x16x32_bf16 v[72:75], v[112:115], v[156:159], v[72:75]
s_waitcnt vmcnt(8) lgkmcnt(8)
v_mfma_f32_16x16x32_bf16 v[60:63], v[220:223], v[164:167], v[60:63]
buffer_load_dwordx4 v[204:207], v38, s[32:35], s57 offen sc1
v_mfma_f32_16x16x32_bf16 v[76:79], v[220:223], v[168:171], v[76:79]
ds_read_b64_tr_b16 v[100:101], v10 offset:45056
ds_read_b64_tr_b16 v[102:103], v10 offset:45568
v_mfma_f32_16x16x32_bf16 v[80:83], v[224:227], v[168:171], v[80:83]
ds_read_b64_tr_b16 v[104:105], v11 offset:45056
ds_read_b64_tr_b16 v[106:107], v11 offset:45568
v_mfma_f32_16x16x32_bf16 v[64:67], v[224:227], v[164:167], v[64:67]
buffer_load_dwordx4 v[208:211], v39, s[32:35], s57 offen sc1
v_mfma_f32_16x16x32_bf16 v[68:71], v[228:231], v[164:167], v[68:71]
ds_read_b64_tr_b16 v[108:109], v12 offset:45056
ds_read_b64_tr_b16 v[110:111], v12 offset:45568
v_mfma_f32_16x16x32_bf16 v[84:87], v[228:231], v[168:171], v[84:87]
ds_read_b64_tr_b16 v[112:113], v13 offset:45056
ds_read_b64_tr_b16 v[114:115], v13 offset:45568
v_mfma_f32_16x16x32_bf16 v[88:91], v[232:235], v[168:171], v[88:91]
v_mfma_f32_16x16x32_bf16 v[72:75], v[232:235], v[164:167], v[72:75]
s_waitcnt vmcnt(8) lgkmcnt(8)
v_mfma_f32_16x16x32_bf16 v[60:63], v[236:239], v[172:175], v[60:63]
buffer_load_dwordx4 v[212:215], v38, s[32:35], s57 offen offset:1024 sc1
v_mfma_f32_16x16x32_bf16 v[76:79], v[236:239], v[176:179], v[76:79]
ds_read_b64_tr_b16 v[220:221], v10 offset:49152
ds_read_b64_tr_b16 v[222:223], v10 offset:49664
v_mfma_f32_16x16x32_bf16 v[80:83], v[240:243], v[176:179], v[80:83]
ds_read_b64_tr_b16 v[224:225], v11 offset:49152
ds_read_b64_tr_b16 v[226:227], v11 offset:49664
v_mfma_f32_16x16x32_bf16 v[64:67], v[240:243], v[172:175], v[64:67]
buffer_load_dwordx4 v[216:219], v39, s[32:35], s57 offen offset:1024 sc1
v_mfma_f32_16x16x32_bf16 v[68:71], v[244:247], v[172:175], v[68:71]
ds_read_b64_tr_b16 v[228:229], v12 offset:49152
ds_read_b64_tr_b16 v[230:231], v12 offset:49664
v_mfma_f32_16x16x32_bf16 v[84:87], v[244:247], v[176:179], v[84:87]
ds_read_b64_tr_b16 v[232:233], v13 offset:49152
ds_read_b64_tr_b16 v[234:235], v13 offset:49664
v_mfma_f32_16x16x32_bf16 v[88:91], v[248:251], v[176:179], v[88:91]
s_add_u32 s57, s57, 2048
s_and_b32 s57, s57, 0x7fff
v_mfma_f32_16x16x32_bf16 v[72:75], v[248:251], v[172:175], v[72:75]
s_waitcnt vmcnt(8) lgkmcnt(8)
v_mfma_f32_16x16x32_bf16 v[60:63], v[100:103], v[180:183], v[60:63]
buffer_load_dwordx4 v[156:159], v38, s[32:35], s57 offen sc1
v_mfma_f32_16x16x32_bf16 v[76:79], v[100:103], v[184:187], v[76:79]
ds_read_b64_tr_b16 v[236:237], v10 offset:53248
ds_read_b64_tr_b16 v[238:239], v10 offset:53760
v_mfma_f32_16x16x32_bf16 v[80:83], v[104:107], v[184:187], v[80:83]
ds_read_b64_tr_b16 v[240:241], v11 offset:53248
ds_read_b64_tr_b16 v[242:243], v11 offset:53760
v_mfma_f32_16x16x32_bf16 v[64:67], v[104:107], v[180:183], v[64:67]
buffer_load_dwordx4 v[160:163], v39, s[32:35], s57 offen sc1
v_mfma_f32_16x16x32_bf16 v[68:71], v[108:111], v[180:183], v[68:71]
ds_read_b64_tr_b16 v[244:245], v12 offset:53248
ds_read_b64_tr_b16 v[246:247], v12 offset:53760
v_mfma_f32_16x16x32_bf16 v[84:87], v[108:111], v[184:187], v[84:87]
ds_read_b64_tr_b16 v[248:249], v13 offset:53248
ds_read_b64_tr_b16 v[250:251], v13 offset:53760
v_mfma_f32_16x16x32_bf16 v[88:91], v[112:115], v[184:187], v[88:91]
v_mfma_f32_16x16x32_bf16 v[72:75], v[112:115], v[180:183], v[72:75]
s_waitcnt vmcnt(8) lgkmcnt(8)
v_mfma_f32_16x16x32_bf16 v[60:63], v[220:223], v[188:191], v[60:63]
buffer_load_dwordx4 v[164:167], v38, s[32:35], s57 offen offset:1024 sc1
v_mfma_f32_16x16x32_bf16 v[76:79], v[220:223], v[192:195], v[76:79]
ds_read_b64_tr_b16 v[100:101], v10 offset:57344
ds_read_b64_tr_b16 v[102:103], v10 offset:57856
v_mfma_f32_16x16x32_bf16 v[80:83], v[224:227], v[192:195], v[80:83]
ds_read_b64_tr_b16 v[104:105], v11 offset:57344
ds_read_b64_tr_b16 v[106:107], v11 offset:57856
v_mfma_f32_16x16x32_bf16 v[64:67], v[224:227], v[188:191], v[64:67]
buffer_load_dwordx4 v[168:171], v39, s[32:35], s57 offen offset:1024 sc1
v_mfma_f32_16x16x32_bf16 v[68:71], v[228:231], v[188:191], v[68:71]
ds_read_b64_tr_b16 v[108:109], v12 offset:57344
ds_read_b64_tr_b16 v[110:111], v12 offset:57856
v_mfma_f32_16x16x32_bf16 v[84:87], v[228:231], v[192:195], v[84:87]
ds_read_b64_tr_b16 v[112:113], v13 offset:57344
ds_read_b64_tr_b16 v[114:115], v13 offset:57856
v_mfma_f32_16x16x32_bf16 v[88:91], v[232:235], v[192:195], v[88:91]
s_add_u32 s57, s57, 2048
s_and_b32 s57, s57, 0x7fff
v_mfma_f32_16x16x32_bf16 v[72:75], v[232:235], v[188:191], v[72:75]
s_waitcnt vmcnt(8) lgkmcnt(8)
v_mfma_f32_16x16x32_bf16 v[60:63], v[236:239], v[196:199], v[60:63]
buffer_load_dwordx4 v[172:175], v38, s[32:35], s57 offen sc1
v_mfma_f32_16x16x32_bf16 v[76:79], v[236:239], v[200:203], v[76:79]
ds_read_b64_tr_b16 v[220:221], v10 offset:61440
ds_read_b64_tr_b16 v[222:223], v10 offset:61952
v_mfma_f32_16x16x32_bf16 v[80:83], v[240:243], v[200:203], v[80:83]
ds_read_b64_tr_b16 v[224:225], v11 offset:61440
ds_read_b64_tr_b16 v[226:227], v11 offset:61952
v_mfma_f32_16x16x32_bf16 v[64:67], v[240:243], v[196:199], v[64:67]
buffer_load_dwordx4 v[176:179], v39, s[32:35], s57 offen sc1
v_mfma_f32_16x16x32_bf16 v[68:71], v[244:247], v[196:199], v[68:71]
ds_read_b64_tr_b16 v[228:229], v12 offset:61440
ds_read_b64_tr_b16 v[230:231], v12 offset:61952
v_mfma_f32_16x16x32_bf16 v[84:87], v[244:247], v[200:203], v[84:87]
ds_read_b64_tr_b16 v[232:233], v13 offset:61440
ds_read_b64_tr_b16 v[234:235], v13 offset:61952
v_mfma_f32_16x16x32_bf16 v[88:91], v[248:251], v[200:203], v[88:91]
v_mfma_f32_16x16x32_bf16 v[72:75], v[248:251], v[196:199], v[72:75]
s_waitcnt vmcnt(8) lgkmcnt(8)
v_mfma_f32_16x16x32_bf16 v[60:63], v[100:103], v[204:207], v[60:63]
buffer_load_dwordx4 v[180:183], v38, s[32:35], s57 offen offset:1024 sc1
v_mfma_f32_16x16x32_bf16 v[76:79], v[100:103], v[208:211], v[76:79]
ds_read_b64_tr_b16 v[236:237], v14 offset:0
ds_read_b64_tr_b16 v[238:239], v14 offset:512
v_mfma_f32_16x16x32_bf16 v[80:83], v[104:107], v[208:211], v[80:83]
ds_read_b64_tr_b16 v[240:241], v15 offset:0
ds_read_b64_tr_b16 v[242:243], v15 offset:512
v_mfma_f32_16x16x32_bf16 v[64:67], v[104:107], v[204:207], v[64:67]
buffer_load_dwordx4 v[184:187], v39, s[32:35], s57 offen offset:1024 sc1
v_mfma_f32_16x16x32_bf16 v[68:71], v[108:111], v[204:207], v[68:71]
ds_read_b64_tr_b16 v[244:245], v16 offset:0
ds_read_b64_tr_b16 v[246:247], v16 offset:512
v_mfma_f32_16x16x32_bf16 v[84:87], v[108:111], v[208:211], v[84:87]
ds_read_b64_tr_b16 v[248:249], v17 offset:0
ds_read_b64_tr_b16 v[250:251], v17 offset:512
v_mfma_f32_16x16x32_bf16 v[88:91], v[112:115], v[208:211], v[88:91]
s_add_u32 s57, s57, 2048
s_and_b32 s57, s57, 0x7fff
v_mfma_f32_16x16x32_bf16 v[72:75], v[112:115], v[204:207], v[72:75]
s_waitcnt vmcnt(8) lgkmcnt(8)
v_mfma_f32_16x16x32_bf16 v[60:63], v[220:223], v[212:215], v[60:63]
buffer_load_dwordx4 v[188:191], v38, s[32:35], s57 offen sc1
v_mfma_f32_16x16x32_bf16 v[76:79], v[220:223], v[216:219], v[76:79]
ds_read_b64_tr_b16 v[100:101], v14 offset:4096
ds_read_b64_tr_b16 v[102:103], v14 offset:4608
v_mfma_f32_16x16x32_bf16 v[80:83], v[224:227], v[216:219], v[80:83]
ds_read_b64_tr_b16 v[104:105], v15 offset:4096
ds_read_b64_tr_b16 v[106:107], v15 offset:4608
v_mfma_f32_16x16x32_bf16 v[64:67], v[224:227], v[212:215], v[64:67]
buffer_load_dwordx4 v[192:195], v39, s[32:35], s57 offen sc1
v_mfma_f32_16x16x32_bf16 v[68:71], v[228:231], v[212:215], v[68:71]
ds_read_b64_tr_b16 v[108:109], v16 offset:4096
ds_read_b64_tr_b16 v[110:111], v16 offset:4608
v_mfma_f32_16x16x32_bf16 v[84:87], v[228:231], v[216:219], v[84:87]
ds_read_b64_tr_b16 v[112:113], v17 offset:4096
ds_read_b64_tr_b16 v[114:115], v17 offset:4608
v_mfma_f32_16x16x32_bf16 v[88:91], v[232:235], v[216:219], v[88:91]
v_mfma_f32_16x16x32_bf16 v[72:75], v[232:235], v[212:215], v[72:75]
s_waitcnt vmcnt(8) lgkmcnt(8)
v_mfma_f32_16x16x32_bf16 v[60:63], v[236:239], v[156:159], v[60:63]
buffer_load_dwordx4 v[196:199], v38, s[32:35], s57 offen offset:1024 sc1
v_mfma_f32_16x16x32_bf16 v[76:79], v[236:239], v[160:163], v[76:79]
ds_read_b64_tr_b16 v[220:221], v14 offset:8192
ds_read_b64_tr_b16 v[222:223], v14 offset:8704
v_mfma_f32_16x16x32_bf16 v[80:83], v[240:243], v[160:163], v[80:83]
ds_read_b64_tr_b16 v[224:225], v15 offset:8192
ds_read_b64_tr_b16 v[226:227], v15 offset:8704
v_mfma_f32_16x16x32_bf16 v[64:67], v[240:243], v[156:159], v[64:67]
buffer_load_dwordx4 v[200:203], v39, s[32:35], s57 offen offset:1024 sc1
v_mfma_f32_16x16x32_bf16 v[68:71], v[244:247], v[156:159], v[68:71]
ds_read_b64_tr_b16 v[228:229], v16 offset:8192
ds_read_b64_tr_b16 v[230:231], v16 offset:8704
v_mfma_f32_16x16x32_bf16 v[84:87], v[244:247], v[160:163], v[84:87]
ds_read_b64_tr_b16 v[232:233], v17 offset:8192
ds_read_b64_tr_b16 v[234:235], v17 offset:8704
v_mfma_f32_16x16x32_bf16 v[88:91], v[248:251], v[160:163], v[88:91]
s_add_u32 s57, s57, 2048
s_and_b32 s57, s57, 0x7fff
v_mfma_f32_16x16x32_bf16 v[72:75], v[248:251], v[156:159], v[72:75]
s_waitcnt vmcnt(8) lgkmcnt(8)
v_mfma_f32_16x16x32_bf16 v[60:63], v[100:103], v[164:167], v[60:63]
buffer_load_dwordx4 v[204:207], v38, s[32:35], s57 offen sc1
v_mfma_f32_16x16x32_bf16 v[76:79], v[100:103], v[168:171], v[76:79]
ds_read_b64_tr_b16 v[236:237], v14 offset:12288
ds_read_b64_tr_b16 v[238:239], v14 offset:12800
v_mfma_f32_16x16x32_bf16 v[80:83], v[104:107], v[168:171], v[80:83]
ds_read_b64_tr_b16 v[240:241], v15 offset:12288
ds_read_b64_tr_b16 v[242:243], v15 offset:12800
v_mfma_f32_16x16x32_bf16 v[64:67], v[104:107], v[164:167], v[64:67]
buffer_load_dwordx4 v[208:211], v39, s[32:35], s57 offen sc1
v_mfma_f32_16x16x32_bf16 v[68:71], v[108:111], v[164:167], v[68:71]
ds_read_b64_tr_b16 v[244:245], v16 offset:12288
ds_read_b64_tr_b16 v[246:247], v16 offset:12800
v_mfma_f32_16x16x32_bf16 v[84:87], v[108:111], v[168:171], v[84:87]
ds_read_b64_tr_b16 v[248:249], v17 offset:12288
ds_read_b64_tr_b16 v[250:251], v17 offset:12800
v_mfma_f32_16x16x32_bf16 v[88:91], v[112:115], v[168:171], v[88:91]
v_mfma_f32_16x16x32_bf16 v[72:75], v[112:115], v[164:167], v[72:75]
s_waitcnt vmcnt(8) lgkmcnt(8)
v_mfma_f32_16x16x32_bf16 v[60:63], v[220:223], v[172:175], v[60:63]
buffer_load_dwordx4 v[212:215], v38, s[32:35], s57 offen offset:1024 sc1
v_mfma_f32_16x16x32_bf16 v[76:79], v[220:223], v[176:179], v[76:79]
ds_read_b64_tr_b16 v[100:101], v14 offset:16384
ds_read_b64_tr_b16 v[102:103], v14 offset:16896
v_mfma_f32_16x16x32_bf16 v[80:83], v[224:227], v[176:179], v[80:83]
ds_read_b64_tr_b16 v[104:105], v15 offset:16384
ds_read_b64_tr_b16 v[106:107], v15 offset:16896
v_mfma_f32_16x16x32_bf16 v[64:67], v[224:227], v[172:175], v[64:67]
buffer_load_dwordx4 v[216:219], v39, s[32:35], s57 offen offset:1024 sc1
v_mfma_f32_16x16x32_bf16 v[68:71], v[228:231], v[172:175], v[68:71]
ds_read_b64_tr_b16 v[108:109], v16 offset:16384
ds_read_b64_tr_b16 v[110:111], v16 offset:16896
v_mfma_f32_16x16x32_bf16 v[84:87], v[228:231], v[176:179], v[84:87]
ds_read_b64_tr_b16 v[112:113], v17 offset:16384
ds_read_b64_tr_b16 v[114:115], v17 offset:16896
v_mfma_f32_16x16x32_bf16 v[88:91], v[232:235], v[176:179], v[88:91]
s_add_u32 s57, s57, 2048
s_and_b32 s57, s57, 0x7fff
v_mfma_f32_16x16x32_bf16 v[72:75], v[232:235], v[172:175], v[72:75]
s_waitcnt vmcnt(8) lgkmcnt(8)
v_mfma_f32_16x16x32_bf16 v[60:63], v[236:239], v[180:183], v[60:63]
buffer_load_dwordx4 v[156:159], v38, s[32:35], s57 offen sc1
v_mfma_f32_16x16x32_bf16 v[76:79], v[236:239], v[184:187], v[76:79]
ds_read_b64_tr_b16 v[220:221], v14 offset:20480
ds_read_b64_tr_b16 v[222:223], v14 offset:20992
v_mfma_f32_16x16x32_bf16 v[80:83], v[240:243], v[184:187], v[80:83]
ds_read_b64_tr_b16 v[224:225], v15 offset:20480
ds_read_b64_tr_b16 v[226:227], v15 offset:20992
v_mfma_f32_16x16x32_bf16 v[64:67], v[240:243], v[180:183], v[64:67]
buffer_load_dwordx4 v[160:163], v39, s[32:35], s57 offen sc1
v_mfma_f32_16x16x32_bf16 v[68:71], v[244:247], v[180:183], v[68:71]
ds_read_b64_tr_b16 v[228:229], v16 offset:20480
ds_read_b64_tr_b16 v[230:231], v16 offset:20992
v_mfma_f32_16x16x32_bf16 v[84:87], v[244:247], v[184:187], v[84:87]
ds_read_b64_tr_b16 v[232:233], v17 offset:20480
ds_read_b64_tr_b16 v[234:235], v17 offset:20992
v_mfma_f32_16x16x32_bf16 v[88:91], v[248:251], v[184:187], v[88:91]
v_mfma_f32_16x16x32_bf16 v[72:75], v[248:251], v[180:183], v[72:75]
s_waitcnt vmcnt(8) lgkmcnt(8)
v_mfma_f32_16x16x32_bf16 v[60:63], v[100:103], v[188:191], v[60:63]
buffer_load_dwordx4 v[164:167], v38, s[32:35], s57 offen offset:1024 sc1
v_mfma_f32_16x16x32_bf16 v[76:79], v[100:103], v[192:195], v[76:79]
ds_read_b64_tr_b16 v[236:237], v14 offset:24576
ds_read_b64_tr_b16 v[238:239], v14 offset:25088
v_mfma_f32_16x16x32_bf16 v[80:83], v[104:107], v[192:195], v[80:83]
ds_read_b64_tr_b16 v[240:241], v15 offset:24576
ds_read_b64_tr_b16 v[242:243], v15 offset:25088
v_mfma_f32_16x16x32_bf16 v[64:67], v[104:107], v[188:191], v[64:67]
buffer_load_dwordx4 v[168:171], v39, s[32:35], s57 offen offset:1024 sc1
v_mfma_f32_16x16x32_bf16 v[68:71], v[108:111], v[188:191], v[68:71]
ds_read_b64_tr_b16 v[244:245], v16 offset:24576
ds_read_b64_tr_b16 v[246:247], v16 offset:25088
v_mfma_f32_16x16x32_bf16 v[84:87], v[108:111], v[192:195], v[84:87]
ds_read_b64_tr_b16 v[248:249], v17 offset:24576
ds_read_b64_tr_b16 v[250:251], v17 offset:25088
v_mfma_f32_16x16x32_bf16 v[88:91], v[112:115], v[192:195], v[88:91]
s_add_u32 s57, s57, 2048
s_and_b32 s57, s57, 0x7fff
v_mfma_f32_16x16x32_bf16 v[72:75], v[112:115], v[188:191], v[72:75]
s_waitcnt vmcnt(8) lgkmcnt(8)
v_mfma_f32_16x16x32_bf16 v[60:63], v[220:223], v[196:199], v[60:63]
buffer_load_dwordx4 v[172:175], v38, s[32:35], s57 offen sc1
v_mfma_f32_16x16x32_bf16 v[76:79], v[220:223], v[200:203], v[76:79]
ds_read_b64_tr_b16 v[100:101], v14 offset:28672
ds_read_b64_tr_b16 v[102:103], v14 offset:29184
v_mfma_f32_16x16x32_bf16 v[80:83], v[224:227], v[200:203], v[80:83]
ds_read_b64_tr_b16 v[104:105], v15 offset:28672
ds_read_b64_tr_b16 v[106:107], v15 offset:29184
v_mfma_f32_16x16x32_bf16 v[64:67], v[224:227], v[196:199], v[64:67]
buffer_load_dwordx4 v[176:179], v39, s[32:35], s57 offen sc1
v_mfma_f32_16x16x32_bf16 v[68:71], v[228:231], v[196:199], v[68:71]
ds_read_b64_tr_b16 v[108:109], v16 offset:28672
ds_read_b64_tr_b16 v[110:111], v16 offset:29184
v_mfma_f32_16x16x32_bf16 v[84:87], v[228:231], v[200:203], v[84:87]
ds_read_b64_tr_b16 v[112:113], v17 offset:28672
ds_read_b64_tr_b16 v[114:115], v17 offset:29184
v_mfma_f32_16x16x32_bf16 v[88:91], v[232:235], v[200:203], v[88:91]
v_mfma_f32_16x16x32_bf16 v[72:75], v[232:235], v[196:199], v[72:75]
s_waitcnt vmcnt(8) lgkmcnt(8)
v_mfma_f32_16x16x32_bf16 v[60:63], v[236:239], v[204:207], v[60:63]
buffer_load_dwordx4 v[180:183], v38, s[32:35], s57 offen offset:1024 sc1
v_mfma_f32_16x16x32_bf16 v[76:79], v[236:239], v[208:211], v[76:79]
ds_read_b64_tr_b16 v[220:221], v14 offset:32768
ds_read_b64_tr_b16 v[222:223], v14 offset:33280
v_mfma_f32_16x16x32_bf16 v[80:83], v[240:243], v[208:211], v[80:83]
ds_read_b64_tr_b16 v[224:225], v15 offset:32768
ds_read_b64_tr_b16 v[226:227], v15 offset:33280
v_mfma_f32_16x16x32_bf16 v[64:67], v[240:243], v[204:207], v[64:67]
buffer_load_dwordx4 v[184:187], v39, s[32:35], s57 offen offset:1024 sc1
v_mfma_f32_16x16x32_bf16 v[68:71], v[244:247], v[204:207], v[68:71]
ds_read_b64_tr_b16 v[228:229], v16 offset:32768
ds_read_b64_tr_b16 v[230:231], v16 offset:33280
v_mfma_f32_16x16x32_bf16 v[84:87], v[244:247], v[208:211], v[84:87]
ds_read_b64_tr_b16 v[232:233], v17 offset:32768
ds_read_b64_tr_b16 v[234:235], v17 offset:33280
v_mfma_f32_16x16x32_bf16 v[88:91], v[248:251], v[208:211], v[88:91]
s_add_u32 s57, s57, 2048
s_and_b32 s57, s57, 0x7fff
v_mfma_f32_16x16x32_bf16 v[72:75], v[248:251], v[204:207], v[72:75]
s_waitcnt vmcnt(8) lgkmcnt(8)
v_mfma_f32_16x16x32_bf16 v[60:63], v[100:103], v[212:215], v[60:63]
buffer_load_dwordx4 v[188:191], v38, s[32:35], s57 offen sc1
v_mfma_f32_16x16x32_bf16 v[76:79], v[100:103], v[216:219], v[76:79]
ds_read_b64_tr_b16 v[236:237], v14 offset:36864
ds_read_b64_tr_b16 v[238:239], v14 offset:37376
v_mfma_f32_16x16x32_bf16 v[80:83], v[104:107], v[216:219], v[80:83]
ds_read_b64_tr_b16 v[240:241], v15 offset:36864
ds_read_b64_tr_b16 v[242:243], v15 offset:37376
v_mfma_f32_16x16x32_bf16 v[64:67], v[104:107], v[212:215], v[64:67]
buffer_load_dwordx4 v[192:195], v39, s[32:35], s57 offen sc1
v_mfma_f32_16x16x32_bf16 v[68:71], v[108:111], v[212:215], v[68:71]
ds_read_b64_tr_b16 v[244:245], v16 offset:36864
ds_read_b64_tr_b16 v[246:247], v16 offset:37376
v_mfma_f32_16x16x32_bf16 v[84:87], v[108:111], v[216:219], v[84:87]
ds_read_b64_tr_b16 v[248:249], v17 offset:36864
ds_read_b64_tr_b16 v[250:251], v17 offset:37376
v_mfma_f32_16x16x32_bf16 v[88:91], v[112:115], v[216:219], v[88:91]
v_mfma_f32_16x16x32_bf16 v[72:75], v[112:115], v[212:215], v[72:75]
s_waitcnt vmcnt(8) lgkmcnt(8)
v_mfma_f32_16x16x32_bf16 v[60:63], v[220:223], v[156:159], v[60:63]
buffer_load_dwordx4 v[196:199], v38, s[32:35], s57 offen offset:1024 sc1
v_mfma_f32_16x16x32_bf16 v[76:79], v[220:223], v[160:163], v[76:79]
ds_read_b64_tr_b16 v[100:101], v14 offset:40960
ds_read_b64_tr_b16 v[102:103], v14 offset:41472
v_mfma_f32_16x16x32_bf16 v[80:83], v[224:227], v[160:163], v[80:83]
ds_read_b64_tr_b16 v[104:105], v15 offset:40960
ds_read_b64_tr_b16 v[106:107], v15 offset:41472
v_mfma_f32_16x16x32_bf16 v[64:67], v[224:227], v[156:159], v[64:67]
buffer_load_dwordx4 v[200:203], v39, s[32:35], s57 offen offset:1024 sc1
v_mfma_f32_16x16x32_bf16 v[68:71], v[228:231], v[156:159], v[68:71]
ds_read_b64_tr_b16 v[108:109], v16 offset:40960
ds_read_b64_tr_b16 v[110:111], v16 offset:41472
v_mfma_f32_16x16x32_bf16 v[84:87], v[228:231], v[160:163], v[84:87]
ds_read_b64_tr_b16 v[112:113], v17 offset:40960
ds_read_b64_tr_b16 v[114:115], v17 offset:41472
v_mfma_f32_16x16x32_bf16 v[88:91], v[232:235], v[160:163], v[88:91]
s_add_u32 s57, s57, 2048
s_and_b32 s57, s57, 0x7fff
v_mfma_f32_16x16x32_bf16 v[72:75], v[232:235], v[156:159], v[72:75]
s_waitcnt vmcnt(8) lgkmcnt(8)
v_mfma_f32_16x16x32_bf16 v[60:63], v[236:239], v[164:167], v[60:63]
buffer_load_dwordx4 v[204:207], v38, s[32:35], s57 offen sc1
v_mfma_f32_16x16x32_bf16 v[76:79], v[236:239], v[168:171], v[76:79]
ds_read_b64_tr_b16 v[220:221], v14 offset:45056
ds_read_b64_tr_b16 v[222:223], v14 offset:45568
v_mfma_f32_16x16x32_bf16 v[80:83], v[240:243], v[168:171], v[80:83]
ds_read_b64_tr_b16 v[224:225], v15 offset:45056
ds_read_b64_tr_b16 v[226:227], v15 offset:45568
v_mfma_f32_16x16x32_bf16 v[64:67], v[240:243], v[164:167], v[64:67]
buffer_load_dwordx4 v[208:211], v39, s[32:35], s57 offen sc1
v_mfma_f32_16x16x32_bf16 v[68:71], v[244:247], v[164:167], v[68:71]
ds_read_b64_tr_b16 v[228:229], v16 offset:45056
ds_read_b64_tr_b16 v[230:231], v16 offset:45568
v_mfma_f32_16x16x32_bf16 v[84:87], v[244:247], v[168:171], v[84:87]
ds_read_b64_tr_b16 v[232:233], v17 offset:45056
ds_read_b64_tr_b16 v[234:235], v17 offset:45568
v_mfma_f32_16x16x32_bf16 v[88:91], v[248:251], v[168:171], v[88:91]
v_mfma_f32_16x16x32_bf16 v[72:75], v[248:251], v[164:167], v[72:75]
s_waitcnt vmcnt(8) lgkmcnt(8)
v_mfma_f32_16x16x32_bf16 v[60:63], v[100:103], v[172:175], v[60:63]
buffer_load_dwordx4 v[212:215], v38, s[32:35], s57 offen offset:1024 sc1
v_mfma_f32_16x16x32_bf16 v[76:79], v[100:103], v[176:179], v[76:79]
ds_read_b64_tr_b16 v[236:237], v14 offset:49152
ds_read_b64_tr_b16 v[238:239], v14 offset:49664
v_mfma_f32_16x16x32_bf16 v[80:83], v[104:107], v[176:179], v[80:83]
ds_read_b64_tr_b16 v[240:241], v15 offset:49152
ds_read_b64_tr_b16 v[242:243], v15 offset:49664
v_mfma_f32_16x16x32_bf16 v[64:67], v[104:107], v[172:175], v[64:67]
buffer_load_dwordx4 v[216:219], v39, s[32:35], s57 offen offset:1024 sc1
v_mfma_f32_16x16x32_bf16 v[68:71], v[108:111], v[172:175], v[68:71]
ds_read_b64_tr_b16 v[244:245], v16 offset:49152
ds_read_b64_tr_b16 v[246:247], v16 offset:49664
v_mfma_f32_16x16x32_bf16 v[84:87], v[108:111], v[176:179], v[84:87]
ds_read_b64_tr_b16 v[248:249], v17 offset:49152
ds_read_b64_tr_b16 v[250:251], v17 offset:49664
v_mfma_f32_16x16x32_bf16 v[88:91], v[112:115], v[176:179], v[88:91]
v_mfma_f32_16x16x32_bf16 v[72:75], v[112:115], v[172:175], v[72:75]
s_waitcnt vmcnt(8) lgkmcnt(8)
v_mfma_f32_16x16x32_bf16 v[60:63], v[220:223], v[180:183], v[60:63]
v_mfma_f32_16x16x32_bf16 v[76:79], v[220:223], v[184:187], v[76:79]
ds_read_b64_tr_b16 v[100:101], v14 offset:53248
ds_read_b64_tr_b16 v[102:103], v14 offset:53760
v_mfma_f32_16x16x32_bf16 v[80:83], v[224:227], v[184:187], v[80:83]
ds_read_b64_tr_b16 v[104:105], v15 offset:53248
ds_read_b64_tr_b16 v[106:107], v15 offset:53760
v_mfma_f32_16x16x32_bf16 v[64:67], v[224:227], v[180:183], v[64:67]
v_mfma_f32_16x16x32_bf16 v[68:71], v[228:231], v[180:183], v[68:71]
ds_read_b64_tr_b16 v[108:109], v16 offset:53248
ds_read_b64_tr_b16 v[110:111], v16 offset:53760
v_mfma_f32_16x16x32_bf16 v[84:87], v[228:231], v[184:187], v[84:87]
ds_read_b64_tr_b16 v[112:113], v17 offset:53248
ds_read_b64_tr_b16 v[114:115], v17 offset:53760
v_mfma_f32_16x16x32_bf16 v[88:91], v[232:235], v[184:187], v[88:91]
v_mfma_f32_16x16x32_bf16 v[72:75], v[232:235], v[180:183], v[72:75]
s_waitcnt vmcnt(6) lgkmcnt(8)
v_mfma_f32_16x16x32_bf16 v[60:63], v[236:239], v[188:191], v[60:63]
v_mfma_f32_16x16x32_bf16 v[76:79], v[236:239], v[192:195], v[76:79]
ds_read_b64_tr_b16 v[220:221], v14 offset:57344
ds_read_b64_tr_b16 v[222:223], v14 offset:57856
v_mfma_f32_16x16x32_bf16 v[80:83], v[240:243], v[192:195], v[80:83]
ds_read_b64_tr_b16 v[224:225], v15 offset:57344
ds_read_b64_tr_b16 v[226:227], v15 offset:57856
v_mfma_f32_16x16x32_bf16 v[64:67], v[240:243], v[188:191], v[64:67]
v_mfma_f32_16x16x32_bf16 v[68:71], v[244:247], v[188:191], v[68:71]
ds_read_b64_tr_b16 v[228:229], v16 offset:57344
ds_read_b64_tr_b16 v[230:231], v16 offset:57856
v_mfma_f32_16x16x32_bf16 v[84:87], v[244:247], v[192:195], v[84:87]
ds_read_b64_tr_b16 v[232:233], v17 offset:57344
ds_read_b64_tr_b16 v[234:235], v17 offset:57856
v_mfma_f32_16x16x32_bf16 v[88:91], v[248:251], v[192:195], v[88:91]
v_mfma_f32_16x16x32_bf16 v[72:75], v[248:251], v[188:191], v[72:75]
s_waitcnt vmcnt(4) lgkmcnt(8)
v_mfma_f32_16x16x32_bf16 v[60:63], v[100:103], v[196:199], v[60:63]
v_mfma_f32_16x16x32_bf16 v[76:79], v[100:103], v[200:203], v[76:79]
ds_read_b64_tr_b16 v[236:237], v14 offset:61440
ds_read_b64_tr_b16 v[238:239], v14 offset:61952
v_mfma_f32_16x16x32_bf16 v[80:83], v[104:107], v[200:203], v[80:83]
ds_read_b64_tr_b16 v[240:241], v15 offset:61440
ds_read_b64_tr_b16 v[242:243], v15 offset:61952
v_mfma_f32_16x16x32_bf16 v[64:67], v[104:107], v[196:199], v[64:67]
v_mfma_f32_16x16x32_bf16 v[68:71], v[108:111], v[196:199], v[68:71]
ds_read_b64_tr_b16 v[244:245], v16 offset:61440
ds_read_b64_tr_b16 v[246:247], v16 offset:61952
v_mfma_f32_16x16x32_bf16 v[84:87], v[108:111], v[200:203], v[84:87]
ds_read_b64_tr_b16 v[248:249], v17 offset:61440
ds_read_b64_tr_b16 v[250:251], v17 offset:61952
v_mfma_f32_16x16x32_bf16 v[88:91], v[112:115], v[200:203], v[88:91]
v_mfma_f32_16x16x32_bf16 v[72:75], v[112:115], v[196:199], v[72:75]
s_waitcnt vmcnt(2) lgkmcnt(8)
v_mfma_f32_16x16x32_bf16 v[60:63], v[220:223], v[204:207], v[60:63]
v_mfma_f32_16x16x32_bf16 v[76:79], v[220:223], v[208:211], v[76:79]
v_mfma_f32_16x16x32_bf16 v[80:83], v[224:227], v[208:211], v[80:83]
v_mfma_f32_16x16x32_bf16 v[64:67], v[224:227], v[204:207], v[64:67]
v_mfma_f32_16x16x32_bf16 v[68:71], v[228:231], v[204:207], v[68:71]
v_mfma_f32_16x16x32_bf16 v[84:87], v[228:231], v[208:211], v[84:87]
v_mfma_f32_16x16x32_bf16 v[88:91], v[232:235], v[208:211], v[88:91]
v_mfma_f32_16x16x32_bf16 v[72:75], v[232:235], v[204:207], v[72:75]
s_waitcnt vmcnt(0) lgkmcnt(0)
v_mfma_f32_16x16x32_bf16 v[60:63], v[236:239], v[212:215], v[60:63]
v_mfma_f32_16x16x32_bf16 v[64:67], v[240:243], v[212:215], v[64:67]
v_mfma_f32_16x16x32_bf16 v[68:71], v[244:247], v[212:215], v[68:71]
v_mfma_f32_16x16x32_bf16 v[72:75], v[248:251], v[212:215], v[72:75]
v_mfma_f32_16x16x32_bf16 v[76:79], v[236:239], v[216:219], v[76:79]
v_mfma_f32_16x16x32_bf16 v[80:83], v[240:243], v[216:219], v[80:83]
v_mfma_f32_16x16x32_bf16 v[84:87], v[244:247], v[216:219], v[84:87]
v_mfma_f32_16x16x32_bf16 v[88:91], v[248:251], v[216:219], v[88:91]
s_setpc_b64 s[94:95]
R_oloop_end:
s_cmp_eq_u32 s46, 0
s_cbranch_scc1 slow_80
s_nop 0
v_cvt_pk_bf16_f32 v20, v60, v61
v_cvt_pk_bf16_f32 v21, v62, v63
v_cvt_pk_bf16_f32 v22, v64, v65
v_cvt_pk_bf16_f32 v23, v66, v67
buffer_store_dwordx4 v[20:23], v18, s[32:35], s85 offen offset:0 sc1
v_cvt_pk_bf16_f32 v24, v68, v69
v_cvt_pk_bf16_f32 v25, v70, v71
v_cvt_pk_bf16_f32 v26, v72, v73
v_cvt_pk_bf16_f32 v27, v74, v75
buffer_store_dwordx4 v[24:27], v18, s[32:35], s85 offen offset:1024 sc1
v_cvt_pk_bf16_f32 v28, v76, v77
v_cvt_pk_bf16_f32 v29, v78, v79
v_cvt_pk_bf16_f32 v30, v80, v81
v_cvt_pk_bf16_f32 v31, v82, v83
buffer_store_dwordx4 v[28:31], v18, s[32:35], s86 offen offset:0 sc1
v_cvt_pk_bf16_f32 v32, v84, v85
v_cvt_pk_bf16_f32 v33, v86, v87
v_cvt_pk_bf16_f32 v34, v88, v89
v_cvt_pk_bf16_f32 v35, v90, v91
buffer_store_dwordx4 v[32:35], v18, s[32:35], s86 offen offset:1024 sc1
s_barrier
v_dot2c_f32_bf16 v6, v20, v48
v_dot2c_f32_bf16 v8, v20, v20
v_dot2c_f32_bf16 v7, v28, v48
v_dot2c_f32_bf16 v9, v28, v28
v_dot2c_f32_bf16 v6, v21, v48
v_dot2c_f32_bf16 v8, v21, v21
v_dot2c_f32_bf16 v7, v29, v48
v_dot2c_f32_bf16 v9, v29, v29
v_dot2c_f32_bf16 v6, v22, v48
v_dot2c_f32_bf16 v8, v22, v22
v_dot2c_f32_bf16 v7, v30, v48
v_dot2c_f32_bf16 v9, v30, v30
v_dot2c_f32_bf16 v6, v23, v48
v_dot2c_f32_bf16 v8, v23, v23
v_dot2c_f32_bf16 v7, v31, v48
v_dot2c_f32_bf16 v9, v31, v31
v_dot2c_f32_bf16 v6, v24, v48
v_dot2c_f32_bf16 v8, v24, v24
v_dot2c_f32_bf16 v7, v32, v48
v_dot2c_f32_bf16 v9, v32, v32
v_dot2c_f32_bf16 v6, v25, v48
v_dot2c_f32_bf16 v8, v25, v25
v_dot2c_f32_bf16 v7, v33, v48
v_dot2c_f32_bf16 v9, v33, v33
v_dot2c_f32_bf16 v6, v26, v48
v_dot2c_f32_bf16 v8, v26, v26
v_dot2c_f32_bf16 v7, v34, v48
v_dot2c_f32_bf16 v9, v34, v34
v_dot2c_f32_bf16 v6, v27, v48
v_dot2c_f32_bf16 v8, v27, v27
v_dot2c_f32_bf16 v7, v35, v48
v_dot2c_f32_bf16 v9, v35, v35
s_mov_b64 exec, 1
s_waitcnt vmcnt(0)
buffer_store_dword v5, v4, s[32:35], s88 offen
s_mov_b64 exec, -1
s_nop 1
v_permlane32_swap_b32 v6, v7
v_permlane32_swap_b32 v8, v9
v_add_f32 v6, v6, v7
v_add_f32 v8, v8, v9
s_nop 1
v_permlane16_swap_b32 v6, v8
s_nop 0
v_add_f32 v6, v6, v8
buffer_store_dword v6, v1, s[32:35], s87 offen
back_81:
s_lshl_b32 s49, s44, 13
v_add_u32 v10, s49, v18
v_add_u32 v11, 1024, v10
s_lshl_b32 s48, s43, 1
v_lshrrev_b32 v4, 2, v2
v_and_b32 v5, 3, v0
v_lshl_add_u32 v6, v3, 3, v4
v_lshlrev_b32 v6, 7, v6
v_lshl_add_u32 v6, v5, 3, v6
v_lshrrev_b32 v7, 1, v4
v_and_b32 v8, 1, v3
v_lshl_add_u32 v7, v8, 1, v7
v_xor_b32 v7, s48, v7
v_lshl_add_u32 v12, v7, 5, v6
v_add_u32 v12, 16384, v12
v_xor_b32 v13, 32, v12
v_mov_b32 v14, v10
v_mov_b32 v15, v11
v_add_u32 v16, 122880, v12
v_add_u32 v17, 122880, v13
v_mov_b32 v156, 0
v_mov_b32 v157, 0
v_mov_b32 v158, 0
v_mov_b32 v159, 0
v_mov_b32 v160, 0
v_mov_b32 v161, 0
v_mov_b32 v162, 0
v_mov_b32 v163, 0
v_mov_b32 v164, 0
v_mov_b32 v165, 0
v_mov_b32 v166, 0
v_mov_b32 v167, 0
v_mov_b32 v168, 0
v_mov_b32 v169, 0
v_mov_b32 v170, 0
v_mov_b32 v171, 0
v_mov_b32 v172, 0
v_mov_b32 v173, 0
v_mov_b32 v174, 0
v_mov_b32 v175, 0
v_mov_b32 v176, 0
v_mov_b32 v177, 0
v_mov_b32 v178, 0
v_mov_b32 v179, 0
v_mov_b32 v180, 0
v_mov_b32 v181, 0
v_mov_b32 v182, 0
v_mov_b32 v183, 0
v_mov_b32 v184, 0
v_mov_b32 v185, 0
v_mov_b32 v186, 0
v_mov_b32 v187, 0
v_mov_b32 v188, 0
v_mov_b32 v189, 0
v_mov_b32 v190, 0
v_mov_b32 v191, 0
v_mov_b32 v192, 0
v_mov_b32 v193, 0
v_mov_b32 v194, 0
v_mov_b32 v195, 0
v_mov_b32 v196, 0
v_mov_b32 v197, 0
v_mov_b32 v198, 0
v_mov_b32 v199, 0
v_mov_b32 v200, 0
v_mov_b32 v201, 0
v_mov_b32 v202, 0
v_mov_b32 v203, 0
v_mov_b32 v204, 0
v_mov_b32 v205, 0
v_mov_b32 v206, 0
v_mov_b32 v207, 0
v_mov_b32 v208, 0
v_mov_b32 v209, 0
v_mov_b32 v210, 0
v_mov_b32 v211, 0
v_mov_b32 v212, 0
v_mov_b32 v213, 0
v_mov_b32 v214, 0
v_mov_b32 v215, 0
v_mov_b32 v216, 0
v_mov_b32 v217, 0
v_mov_b32 v218, 0
v_mov_b32 v219, 0
v_mov_b32 v220, 0
v_mov_b32 v221, 0
v_mov_b32 v222, 0
v_mov_b32 v223, 0
v_mov_b32 v224, 0
v_mov_b32 v225, 0
v_mov_b32 v226, 0
v_mov_b32 v227, 0
v_mov_b32 v228, 0
v_mov_b32 v229, 0
v_mov_b32 v230, 0
v_mov_b32 v231, 0
v_mov_b32 v232, 0
v_mov_b32 v233, 0
v_mov_b32 v234, 0
v_mov_b32 v235, 0
v_mov_b32 v236, 0
v_mov_b32 v237, 0
v_mov_b32 v238, 0
v_mov_b32 v239, 0
v_mov_b32 v240, 0
v_mov_b32 v241, 0
v_mov_b32 v242, 0
v_mov_b32 v243, 0
v_mov_b32 v244, 0
v_mov_b32 v245, 0
v_mov_b32 v246, 0
v_mov_b32 v247, 0
v_mov_b32 v248, 0
v_mov_b32 v249, 0
v_mov_b32 v250, 0
v_mov_b32 v251, 0
v_lshrrev_b32 v6, 2, v2
v_cmp_eq_u32 vcc, v6, v3
v_and_b32 v7, 1, v0
v_lshlrev_b32 v7, 4, v7
v_mov_b32 v8, 0x3f80
v_lshlrev_b32 v9, v7, v8
v_cndmask_b32 v7, 0, v9, vcc
v_and_b32 v6, 2, v0
v_cmp_eq_u32 vcc, 0, v6
v_mov_b32 v36, 0
v_mov_b32 v37, 0
v_mov_b32 v40, 0
v_mov_b32 v41, 0
v_cndmask_b32 v38, 0, v7, vcc
v_cndmask_b32 v39, v7, 0, vcc
v_lshrrev_b32 v8, 1, v2
v_cmp_eq_u32 vcc, 0, v8
s_nop 1
v_cndmask_b32 v44, 0, v9, vcc
v_cmp_eq_u32 vcc, 1, v8
s_nop 1
v_cndmask_b32 v45, 0, v9, vcc
v_cmp_eq_u32 vcc, 2, v8
s_nop 1
v_cndmask_b32 v46, 0, v9, vcc
v_cmp_eq_u32 vcc, 3, v8
s_nop 1
v_cndmask_b32 v47, 0, v9, vcc
v_lshrrev_b32 v4, 2, v2
v_lshl_add_u32 v4, v3, 2, v4
v_lshlrev_b32 v4, 6, v4
v_and_b32 v5, 3, v0
v_lshl_add_u32 v4, v5, 3, v4
s_lshl_b32 s48, s43, 11
s_add_u32 s48, s48, 135168
v_add_u32 v53, s48, v4
s_mul_i32 s48, s40, 3072
s_add_u32 s48, s48, 139264
v_add_u32 v42, s48, v18
s_xor_b32 s49, s40, 2
s_mul_i32 s48, s49, 3072
s_add_u32 s48, s48, 139264
v_add_u32 v43, s48, v18
s_lshl_b32 s49, s49, 2
s_add_u32 s49, s49, 134672
v_mov_b32 v19, s49
v_xor_b32 v52, 8, v19
v_lshrrev_b32 v4, 3, v0
v_and_b32 v5, 7, v0
v_lshlrev_b32 v4, 11, v4
v_lshl_add_u32 v55, v5, 4, v4
v_lshlrev_b32 v4, 6, v2
v_lshl_add_u32 v58, v3, 4, v4
v_lshlrev_b32 v4, 4, v2
v_lshl_add_u32 v59, v3, 3, v4
s_mul_i32 s51, s42, 163840
s_add_u32 s51, s51, 9437184
s_lshl_b32 s50, s43, 1
s_add_u32 s50, s50, s44
s_lshl_b32 s48, s50, 15
s_add_u32 s48, s48, s51
s_add_u32 s48, s48, 0
s_lshl_b32 s49, s41, 7
s_add_u32 s53, s48, s49
s_add_u32 s54, s53, 16384
s_lshl_b32 s56, s50, 10
s_add_u32 s56, s56, s51
s_add_u32 s56, s56, 147456
s_xor_b32 s57, s56, 1024
s_lshl_b32 s58, s50, 11
s_add_u32 s58, s58, s51
s_add_u32 s58, s58, 131072
s_xor_b32 s59, s58, 2048
s_add_u32 s79, s58, s49
s_lshl_b32 s50, s41, 11
s_add_u32 s55, s48, s50
s_lshl_b32 s48, s43, 7
s_add_u32 s48, s48, 133888
v_lshl_add_u32 v7, v3, 4, s48
v_lshl_add_u32 v54, v2, 2, s48
s_lshl_b32 s49, s44, 6
v_add_u32 v8, s49, v2
v_lshlrev_b32 v8, 3, v8
v_add_u32 v8, 131072, v8
v_lshl_add_u32 v9, v3, 2, s49
v_lshlrev_b32 v9, 2, v9
v_add_u32 v9, 132096, v9
s_mov_b32 s64, 0
s_mov_b32 s65, 0
s_mov_b32 s66, 0x3fb8aa3b
s_mov_b32 s61, 2
s_lshr_b32 s49, s42, 3
s_xor_b32 s77, s74, s49
s_add_u32 s77, s77, 3
s_lshl_b32 s50, s42, 2
s_add_u32 s50, s50, s40
s_lshl_b32 s50, s50, 4
s_add_u32 s50, s50, s41
s_lshl_b32 s50, s50, 8
s_add_u32 s52, s50, 18087936
ds_read_b64_tr_b16 v[84:85], v16 offset:8192
ds_read_b64_tr_b16 v[86:87], v16 offset:8704
ds_read_b64_tr_b16 v[88:89], v17 offset:8192
ds_read_b64_tr_b16 v[90:91], v17 offset:8704
ds_read_b64_tr_b16 v[92:93], v16 offset:16384
ds_read_b64_tr_b16 v[94:95], v16 offset:16896
ds_read_b64_tr_b16 v[96:97], v17 offset:16384
ds_read_b64_tr_b16 v[98:99], v17 offset:16896
ds_read_b64_tr_b16 v[76:77], v16 offset:0
ds_read_b64_tr_b16 v[78:79], v16 offset:512
ds_read_b64_tr_b16 v[80:81], v17 offset:0
ds_read_b64_tr_b16 v[82:83], v17 offset:512
s_barrier
ds_read_b128 v[60:63], v14 offset:0
ds_read_b128 v[64:67], v14 offset:2048
ds_read_b128 v[68:71], v14 offset:4096
ds_read_b128 v[72:75], v14 offset:6144
s_waitcnt lgkmcnt(0)
c1_loop:
v_mfma_f32_16x16x32_bf16 v[212:215], v[84:87], v[72:75], v[212:215]
ds_read_b128 v[100:103], v15 offset:0
v_mfma_f32_16x16x32_bf16 v[204:207], v[84:87], v[68:71], v[204:207]
ds_read_b128 v[104:107], v15 offset:2048
v_mfma_f32_16x16x32_bf16 v[196:199], v[84:87], v[64:67], v[196:199]
ds_read_b128 v[108:111], v15 offset:4096
v_mfma_f32_16x16x32_bf16 v[188:191], v[84:87], v[60:63], v[188:191]
ds_read_b128 v[112:115], v15 offset:6144
v_mfma_f32_16x16x32_bf16 v[192:195], v[88:91], v[60:63], v[192:195]
ds_read_b64_tr_b16 v[124:125], v16 offset:12288
v_mfma_f32_16x16x32_bf16 v[200:203], v[88:91], v[64:67], v[200:203]
ds_read_b64_tr_b16 v[126:127], v16 offset:12800
v_mfma_f32_16x16x32_bf16 v[208:211], v[88:91], v[68:71], v[208:211]
ds_read_b64_tr_b16 v[128:129], v17 offset:12288
v_mfma_f32_16x16x32_bf16 v[216:219], v[88:91], v[72:75], v[216:219]
ds_read_b64_tr_b16 v[130:131], v17 offset:12800
v_mfma_f32_16x16x32_bf16 v[244:247], v[72:75], v[92:95], v[244:247]
ds_read_b64_tr_b16 v[132:133], v16 offset:20480
v_mfma_f32_16x16x32_bf16 v[248:251], v[72:75], v[96:99], v[248:251]
ds_read_b64_tr_b16 v[134:135], v16 offset:20992
v_mfma_f32_16x16x32_bf16 v[240:243], v[68:71], v[96:99], v[240:243]
ds_read_b64_tr_b16 v[136:137], v17 offset:20480
v_mfma_f32_16x16x32_bf16 v[236:239], v[68:71], v[92:95], v[236:239]
ds_read_b64_tr_b16 v[138:139], v17 offset:20992
v_mfma_f32_16x16x32_bf16 v[228:231], v[64:67], v[92:95], v[228:231]
ds_read_b64_tr_b16 v[116:117], v16 offset:4096
v_mfma_f32_16x16x32_bf16 v[232:235], v[64:67], v[96:99], v[232:235]
ds_read_b64_tr_b16 v[118:119], v16 offset:4608
v_mfma_f32_16x16x32_bf16 v[224:227], v[60:63], v[96:99], v[224:227]
ds_read_b64_tr_b16 v[120:121], v17 offset:4096
v_mfma_f32_16x16x32_bf16 v[220:223], v[60:63], v[92:95], v[220:223]
ds_read_b64_tr_b16 v[122:123], v17 offset:4608
v_mfma_f32_16x16x32_bf16 v[156:159], v[76:79], v[60:63], v[156:159]
s_cmp_eq_u32 s77, s64
s_cbranch_scc1 c1_hook
c1_hook_ret:
v_mfma_f32_16x16x32_bf16 v[164:167], v[76:79], v[64:67], v[164:167]
s_add_u32 s65, s65, 40960
s_cmp_eq_u32 s65, 122880
v_mfma_f32_16x16x32_bf16 v[172:175], v[76:79], v[68:71], v[172:175]
s_cselect_b32 s65, 0, s65
s_add_u32 s64, s64, 1
v_mfma_f32_16x16x32_bf16 v[180:183], v[76:79], v[72:75], v[180:183]
v_add_u32 v14, s65, v10
v_add_u32 v15, s65, v11
v_mfma_f32_16x16x32_bf16 v[184:187], v[80:83], v[72:75], v[184:187]
v_add_u32 v16, s65, v12
v_add_u32 v17, s65, v13
v_mfma_f32_16x16x32_bf16 v[176:179], v[80:83], v[68:71], v[176:179]
s_cmp_eq_u32 s64, 16
s_cbranch_scc1 c1_last
v_mfma_f32_16x16x32_bf16 v[168:171], v[80:83], v[64:67], v[168:171]
s_waitcnt lgkmcnt(0)
v_mfma_f32_16x16x32_bf16 v[160:163], v[80:83], v[60:63], v[160:163]
s_barrier
v_mfma_f32_16x16x32_bf16 v[212:215], v[124:127], v[112:115], v[212:215]
ds_read_b128 v[60:63], v14 offset:0
v_mfma_f32_16x16x32_bf16 v[204:207], v[124:127], v[108:111], v[204:207]
ds_read_b128 v[64:67], v14 offset:2048
v_mfma_f32_16x16x32_bf16 v[196:199], v[124:127], v[104:107], v[196:199]
ds_read_b128 v[68:71], v14 offset:4096
v_mfma_f32_16x16x32_bf16 v[188:191], v[124:127], v[100:103], v[188:191]
ds_read_b128 v[72:75], v14 offset:6144
v_mfma_f32_16x16x32_bf16 v[192:195], v[128:131], v[100:103], v[192:195]
ds_read_b64_tr_b16 v[84:85], v16 offset:8192
v_mfma_f32_16x16x32_bf16 v[200:203], v[128:131], v[104:107], v[200:203]
ds_read_b64_tr_b16 v[86:87], v16 offset:8704
v_mfma_f32_16x16x32_bf16 v[208:211], v[128:131], v[108:111], v[208:211]
ds_read_b64_tr_b16 v[88:89], v17 offset:8192
v_mfma_f32_16x16x32_bf16 v[216:219], v[128:131], v[112:115], v[216:219]
ds_read_b64_tr_b16 v[90:91], v17 offset:8704
v_mfma_f32_16x16x32_bf16 v[244:247], v[112:115], v[132:135], v[244:247]
ds_read_b64_tr_b16 v[92:93], v16 offset:16384
v_mfma_f32_16x16x32_bf16 v[248:251], v[112:115], v[136:139], v[248:251]
ds_read_b64_tr_b16 v[94:95], v16 offset:16896
v_mfma_f32_16x16x32_bf16 v[240:243], v[108:111], v[136:139], v[240:243]
ds_read_b64_tr_b16 v[96:97], v17 offset:16384
v_mfma_f32_16x16x32_bf16 v[236:239], v[108:111], v[132:135], v[236:239]
ds_read_b64_tr_b16 v[98:99], v17 offset:16896
v_mfma_f32_16x16x32_bf16 v[228:231], v[104:107], v[132:135], v[228:231]
ds_read_b64_tr_b16 v[76:77], v16 offset:0
v_mfma_f32_16x16x32_bf16 v[232:235], v[104:107], v[136:139], v[232:235]
ds_read_b64_tr_b16 v[78:79], v16 offset:512
v_mfma_f32_16x16x32_bf16 v[224:227], v[100:103], v[136:139], v[224:227]
ds_read_b64_tr_b16 v[80:81], v17 offset:0
v_mfma_f32_16x16x32_bf16 v[220:223], v[100:103], v[132:135], v[220:223]
ds_read_b64_tr_b16 v[82:83], v17 offset:512
v_mfma_f32_16x16x32_bf16 v[156:159], v[116:119], v[100:103], v[156:159]
v_mfma_f32_16x16x32_bf16 v[164:167], v[116:119], v[104:107], v[164:167]
v_mfma_f32_16x16x32_bf16 v[172:175], v[116:119], v[108:111], v[172:175]
v_mfma_f32_16x16x32_bf16 v[180:183], v[116:119], v[112:115], v[180:183]
v_mfma_f32_16x16x32_bf16 v[184:187], v[120:123], v[112:115], v[184:187]
v_mfma_f32_16x16x32_bf16 v[176:179], v[120:123], v[108:111], v[176:179]
v_mfma_f32_16x16x32_bf16 v[168:171], v[120:123], v[104:107], v[168:171]
s_waitcnt lgkmcnt(0)
v_mfma_f32_16x16x32_bf16 v[160:163], v[120:123], v[100:103], v[160:163]
s_branch c1_loop
c1_hook:
s_waitcnt lgkmcnt(0)
s_cmp_lg_u32 s44, 0
s_cbranch_scc1 else_82
v_mfma_f32_16x16x32_bf16 v[140:143], v[48:51], v[76:79], 0
v_mfma_f32_16x16x32_bf16 v[144:147], v[48:51], v[84:87], 0
v_mfma_f32_16x16x32_bf16 v[148:151], v[48:51], v[92:95], 0
v_mfma_f32_16x16x32_bf16 v[140:143], v[48:51], v[116:119], v[140:143]
v_mfma_f32_16x16x32_bf16 v[144:147], v[48:51], v[124:127], v[144:147]
v_mfma_f32_16x16x32_bf16 v[148:151], v[48:51], v[132:135], v[148:151]
s_branch fi_83
else_82:
v_mfma_f32_16x16x32_bf16 v[140:143], v[48:51], v[80:83], 0
v_mfma_f32_16x16x32_bf16 v[144:147], v[48:51], v[88:91], 0
v_mfma_f32_16x16x32_bf16 v[148:151], v[48:51], v[96:99], 0
v_mfma_f32_16x16x32_bf16 v[140:143], v[48:51], v[120:123], v[140:143]
v_mfma_f32_16x16x32_bf16 v[144:147], v[48:51], v[128:131], v[144:147]
v_mfma_f32_16x16x32_bf16 v[148:151], v[48:51], v[136:139], v[148:151]
fi_83:
s_nop 4
v_cmp_eq_u32 vcc, 0, v3
v_cmp_eq_u32 s[48:49], 1, v3
s_nop 1
v_cndmask_b32 v4, v148, v144, s[48:49]
v_cndmask_b32 v4, v4, v140, vcc
buffer_store_dword v4, v1, s[32:35], s52 offen sc1
s_branch c1_hook_ret
c1_last:
v_mfma_f32_16x16x32_bf16 v[168:171], v[80:83], v[64:67], v[168:171]
s_waitcnt lgkmcnt(0)
v_mfma_f32_16x16x32_bf16 v[160:163], v[80:83], v[60:63], v[160:163]
v_mfma_f32_16x16x32_bf16 v[212:215], v[124:127], v[112:115], v[212:215]
ds_read_b64_tr_b16 v[10:11], v53 offset:0
ds_read_b64_tr_b16 v[12:13], v53 offset:1024
v_mfma_f32_16x16x32_bf16 v[204:207], v[124:127], v[108:111], v[204:207]
ds_read_b64_tr_b16 v[14:15], v53 offset:32
ds_read_b64_tr_b16 v[16:17], v53 offset:1056
v_mfma_f32_16x16x32_bf16 v[196:199], v[124:127], v[104:107], v[196:199]

s_mul_i32 s48, s44, 0x80008000
v_mfma_f32_16x16x32_bf16 v[188:191], v[124:127], v[100:103], v[188:191]

v_mfma_f32_16x16x32_bf16 v[192:195], v[128:131], v[100:103], v[192:195]

v_mfma_f32_16x16x32_bf16 v[200:203], v[128:131], v[104:107], v[200:203]

v_mfma_f32_16x16x32_bf16 v[208:211], v[128:131], v[108:111], v[208:211]

s_waitcnt lgkmcnt(0)
v_mfma_f32_16x16x32_bf16 v[216:219], v[128:131], v[112:115], v[216:219]
s_barrier
v_mfma_f32_16x16x32_bf16 v[244:247], v[112:115], v[132:135], v[244:247]
ds_read_b128 v[140:143], v7 offset:0
ds_read_b128 v[144:147], v7 offset:64
v_mfma_f32_16x16x32_bf16 v[248:251], v[112:115], v[136:139], v[248:251]
ds_read_b128 v[148:151], v7 offset:256
ds_read_b128 v[152:155], v7 offset:320
v_mfma_f32_16x16x32_bf16 v[240:243], v[108:111], v[136:139], v[240:243]
ds_read_b64 v[92:93], v8 offset:0
ds_read_b64 v[94:95], v8 offset:128
v_mfma_f32_16x16x32_bf16 v[236:239], v[108:111], v[132:135], v[236:239]
ds_read_b64 v[96:97], v8 offset:256
ds_read_b64 v[98:99], v8 offset:384
v_mfma_f32_16x16x32_bf16 v[228:231], v[104:107], v[132:135], v[228:231]
ds_read2_b32 v[56:57], v54 offset0:128 offset1:144
v_xor_b32 v10, s48, v10
v_mfma_f32_16x16x32_bf16 v[232:235], v[104:107], v[136:139], v[232:235]
ds_read_b128 v[60:63], v9 offset:0
v_xor_b32 v11, s48, v11
v_mfma_f32_16x16x32_bf16 v[224:227], v[100:103], v[136:139], v[224:227]
ds_read_b128 v[64:67], v9 offset:64
v_xor_b32 v12, s48, v12
v_mfma_f32_16x16x32_bf16 v[220:223], v[100:103], v[132:135], v[220:223]
ds_read_b128 v[68:71], v9 offset:128
v_xor_b32 v13, s48, v13
v_mfma_f32_16x16x32_bf16 v[156:159], v[116:119], v[100:103], v[156:159]
ds_read_b128 v[72:75], v9 offset:192
v_xor_b32 v14, s48, v14
v_mfma_f32_16x16x32_bf16 v[164:167], v[116:119], v[104:107], v[164:167]
ds_read_b128 v[76:79], v9 offset:512
v_xor_b32 v15, s48, v15
v_mfma_f32_16x16x32_bf16 v[172:175], v[116:119], v[108:111], v[172:175]
ds_read_b128 v[80:83], v9 offset:576
v_xor_b32 v16, s48, v16
v_mfma_f32_16x16x32_bf16 v[180:183], v[116:119], v[112:115], v[180:183]
ds_read_b128 v[84:87], v9 offset:640
v_xor_b32 v17, s48, v17
v_mfma_f32_16x16x32_bf16 v[184:187], v[120:123], v[112:115], v[184:187]
ds_read_b128 v[88:91], v9 offset:704
v_mfma_f32_16x16x32_bf16 v[176:179], v[120:123], v[108:111], v[176:179]
v_mfma_f32_16x16x32_bf16 v[168:171], v[120:123], v[104:107], v[168:171]
v_mfma_f32_16x16x32_bf16 v[160:163], v[120:123], v[100:103], v[160:163]
c1_epi:
s_waitcnt lgkmcnt(0)
.p2align 3
v_mul_f32 v129, s66, v94
v_mul_f32 v128, s66, v92
v_mul_f32 v131, s66, v98
v_mul_f32 v130, s66, v96
v_pk_fma_f32 v[190:191], v[150:151], v[92:93], v[190:191] op_sel:[0,1,0] op_sel_hi:[1,1,1]
v_pk_fma_f32 v[212:213], v[148:149], v[98:99], v[212:213] op_sel:[0,1,0] op_sel_hi:[1,1,1]
v_pk_fma_f32 v[214:215], v[150:151], v[98:99], v[214:215] op_sel:[0,1,0] op_sel_hi:[1,1,1]
v_pk_fma_f32 v[188:189], v[148:149], v[92:93], v[188:189] op_sel:[0,1,0] op_sel_hi:[1,1,1]
v_pk_fma_f32 v[218:219], v[154:155], v[98:99], v[218:219] op_sel:[0,1,0] op_sel_hi:[1,1,1]
v_cvt_pk_bf16_f32 v188, v188, v189
v_cvt_pk_bf16_f32 v189, v190, v191
v_pk_fma_f32 v[196:197], v[148:149], v[94:95], v[196:197] op_sel:[0,1,0] op_sel_hi:[1,1,1]
v_pk_fma_f32 v[200:201], v[152:153], v[94:95], v[200:201] op_sel:[0,1,0] op_sel_hi:[1,1,1]
v_pk_fma_f32 v[210:211], v[154:155], v[96:97], v[210:211] op_sel:[0,1,0] op_sel_hi:[1,1,1]
v_pk_fma_f32 v[240:241], v[84:85], v[56:57], v[240:241] op_sel:[0,1,0] op_sel_hi:[1,1,1]
v_pk_fma_f32 v[228:229], v[80:81], v[56:57], v[228:229] op_sel:[0,0,0] op_sel_hi:[1,0,1]
v_pk_fma_f32 v[226:227], v[78:79], v[56:57], v[226:227] op_sel:[0,1,0] op_sel_hi:[1,1,1]
v_pk_fma_f32 v[192:193], v[152:153], v[92:93], v[192:193] op_sel:[0,1,0] op_sel_hi:[1,1,1]
v_cvt_pk_bf16_f32 v190, v192, v193
v_pk_fma_f32 v[238:239], v[86:87], v[56:57], v[238:239] op_sel:[0,0,0] op_sel_hi:[1,0,1]
v_pk_fma_f32 v[234:235], v[82:83], v[56:57], v[234:235] op_sel:[0,1,0] op_sel_hi:[1,1,1]
v_pk_mul_f32 v[226:227], v[226:227], v[62:63]
v_pk_fma_f32 v[204:205], v[148:149], v[96:97], v[204:205] op_sel:[0,1,0] op_sel_hi:[1,1,1]
v_cvt_pk_bf16_f32 v204, v204, v205
v_pk_fma_f32 v[202:203], v[154:155], v[94:95], v[202:203] op_sel:[0,1,0] op_sel_hi:[1,1,1]
v_pk_fma_f32 v[224:225], v[76:77], v[56:57], v[224:225] op_sel:[0,1,0] op_sel_hi:[1,1,1]
v_pk_fma_f32 v[216:217], v[152:153], v[98:99], v[216:217] op_sel:[0,1,0] op_sel_hi:[1,1,1]
v_pk_fma_f32 v[244:245], v[88:89], v[56:57], v[244:245] op_sel:[0,0,0] op_sel_hi:[1,0,1]
v_pk_mul_f32 v[238:239], v[238:239], v[70:71]
v_pk_mul_f32 v[228:229], v[228:229], v[64:65]
v_pk_fma_f32 v[236:237], v[84:85], v[56:57], v[236:237] op_sel:[0,0,0] op_sel_hi:[1,0,1]
v_pk_fma_f32 v[220:221], v[76:77], v[56:57], v[220:221] op_sel:[0,0,0] op_sel_hi:[1,0,1]
v_pk_mul_f32 v[224:225], v[224:225], v[60:61]
v_cvt_pk_bf16_f32 v212, v212, v213
v_cvt_pk_bf16_f32 v213, v214, v215
v_cvt_pk_bf16_f32 v196, v196, v197
v_pk_mul_f32 v[240:241], v[240:241], v[68:69]
v_pk_fma_f32 v[198:199], v[150:151], v[94:95], v[198:199] op_sel:[0,1,0] op_sel_hi:[1,1,1]
v_cvt_pk_bf16_f32 v197, v198, v199
v_cvt_pk_bf16_f32 v198, v200, v201
v_cvt_pk_bf16_f32 v199, v202, v203
v_cvt_pk_bf16_f32 v215, v218, v219
v_pk_fma_f32 v[208:209], v[152:153], v[96:97], v[208:209] op_sel:[0,1,0] op_sel_hi:[1,1,1]
v_pk_fma_f32 v[246:247], v[90:91], v[56:57], v[246:247] op_sel:[0,0,0] op_sel_hi:[1,0,1]
v_pk_fma_f32 v[250:251], v[90:91], v[56:57], v[250:251] op_sel:[0,1,0] op_sel_hi:[1,1,1]
v_pk_mul_f32 v[250:251], v[250:251], v[74:75]
v_pk_fma_f32 v[206:207], v[150:151], v[96:97], v[206:207] op_sel:[0,1,0] op_sel_hi:[1,1,1]
v_cvt_pk_bf16_f32 v205, v206, v207
v_pk_fma_f32 v[242:243], v[86:87], v[56:57], v[242:243] op_sel:[0,1,0] op_sel_hi:[1,1,1]
v_cvt_pk_bf16_f32 v207, v210, v211
v_pk_mul_f32 v[236:237], v[236:237], v[68:69]
v_pk_fma_f32 v[230:231], v[82:83], v[56:57], v[230:231] op_sel:[0,0,0] op_sel_hi:[1,0,1]
v_pk_fma_f32 v[194:195], v[154:155], v[92:93], v[194:195] op_sel:[0,1,0] op_sel_hi:[1,1,1]
v_cvt_pk_bf16_f32 v191, v194, v195
v_pk_fma_f32 v[232:233], v[80:81], v[56:57], v[232:233] op_sel:[0,1,0] op_sel_hi:[1,1,1]
v_pk_mul_f32 v[232:233], v[232:233], v[64:65]
v_pk_mul_f32 v[230:231], v[230:231], v[66:67]
v_pk_fma_f32 v[248:249], v[88:89], v[56:57], v[248:249] op_sel:[0,1,0] op_sel_hi:[1,1,1]
v_pk_mul_f32 v[248:249], v[248:249], v[72:73]
v_pk_mul_f32 v[242:243], v[242:243], v[70:71]
v_mfma_f32_16x16x32_bf16 v[68:71], v[10:13], v[196:199], 0
v_cvt_pk_bf16_f32 v206, v208, v209
v_cvt_pk_bf16_f32 v214, v216, v217
v_cvt_pk_bf16_f32 v121, v226, v227
v_mfma_f32_16x16x32_bf16 v[80:83], v[14:17], v[204:207], 0
v_cvt_pk_bf16_f32 v120, v224, v225
v_cvt_pk_bf16_f32 v114, v228, v229
v_mfma_f32_16x16x32_bf16 v[84:87], v[10:13], v[212:215], 0
v_cvt_pk_bf16_f32 v116, v236, v237
v_min3_f32 v105, v68, v69, v70
v_mfma_f32_16x16x32_bf16 v[88:91], v[14:17], v[212:215], 0
v_max3_f32 v101, v68, v69, v70
v_cvt_pk_bf16_f32 v115, v230, v231
v_cvt_pk_bf16_f32 v122, v232, v233
v_cvt_pk_bf16_f32 v127, v250, v251
v_cvt_pk_bf16_f32 v124, v240, v241
v_pk_mul_f32 v[244:245], v[244:245], v[72:73]
v_pk_fma_f32 v[222:223], v[78:79], v[56:57], v[222:223] op_sel:[0,0,0] op_sel_hi:[1,0,1]
v_pk_mul_f32 v[222:223], v[222:223], v[62:63]
v_mfma_f32_16x16x32_bf16 v[76:79], v[10:13], v[204:207], 0
v_min3_f32 v107, v84, v85, v86
v_min3_f32 v107, v107, v87, v88
v_min3_f32 v107, v107, v89, v90
v_min_f32_e64 v107, v107, v91
v_max3_f32 v103, v84, v85, v86
v_pk_mul_f32 v[220:221], v[220:221], v[60:61]
v_mfma_f32_16x16x32_bf16 v[60:63], v[10:13], v[188:191], 0
v_max3_f32 v103, v103, v87, v88
v_min3_f32 v106, v76, v77, v78
v_min3_f32 v106, v106, v79, v80
v_min3_f32 v106, v106, v81, v82
v_min_f32 v106, v106, v83
v_pk_mul_f32 v[234:235], v[234:235], v[66:67]
v_mfma_f32_16x16x32_bf16 v[64:67], v[14:17], v[188:191], 0
v_permlane32_swap_b32 v106, v107
v_min3_f32 v104, v60, v61, v62
v_min_f32 v106, v106, v107
v_max3_f32 v103, v103, v89, v90
v_pk_mul_f32 v[246:247], v[246:247], v[74:75]
v_mfma_f32_16x16x32_bf16 v[72:75], v[14:17], v[196:199], 0
v_max_f32 v103, v103, v91
v_max3_f32 v102, v76, v77, v78
v_min3_f32 v104, v104, v63, v64
v_min3_f32 v104, v104, v65, v66
v_min_f32 v104, v104, v67
v_max3_f32 v102, v102, v79, v80
v_max3_f32 v102, v102, v81, v82
v_max_f32 v102, v102, v83
v_min3_f32 v105, v105, v71, v72
v_min3_f32 v105, v105, v73, v74
v_min_f32 v105, v105, v75
v_max3_f32 v101, v101, v71, v72
v_max3_f32 v101, v101, v73, v74
v_permlane32_swap_b32 v104, v105
v_permlane32_swap_b32 v102, v103
v_min_f32 v104, v104, v105
v_max_f32 v102, v102, v103
v_max_f32 v101, v101, v75
v_permlane16_swap_b32 v104, v106
v_max3_f32 v100, v60, v61, v62
v_min_f32 v104, v104, v106
v_mov_b32 v106, v104
v_max3_f32 v100, v100, v63, v64
v_max3_f32 v100, v100, v65, v66
v_max_f32 v100, v100, v67
v_permlane16_swap_b32 v104, v106
v_cvt_pk_bf16_f32 v112, v220, v221
v_permlane32_swap_b32 v100, v101
v_mov_b32 v105, v104
v_max_f32 v100, v100, v101
v_mov_b32 v107, v106
v_permlane32_swap_b32 v104, v105
v_permlane16_swap_b32 v100, v102
v_pk_mul_f32 v[104:105], v[104:105], v[128:129]
v_pk_fma_f32 v[226:227], v[66:67], v[128:129], v[104:105] op_sel:[0,0,0] op_sel_hi:[1,0,0] neg_lo:[1,0,0] neg_hi:[1,0,0]
v_pk_fma_f32 v[230:231], v[70:71], v[128:129], v[104:105] op_sel:[0,1,1] op_sel_hi:[1,1,1] neg_lo:[1,0,0] neg_hi:[1,0,0]
v_exp_f32 v226, v226
v_pk_fma_f32 v[224:225], v[64:65], v[128:129], v[104:105] op_sel:[0,0,0] op_sel_hi:[1,0,0] neg_lo:[1,0,0] neg_hi:[1,0,0]
v_exp_f32 v224, v224
v_pk_fma_f32 v[228:229], v[68:69], v[128:129], v[104:105] op_sel:[0,1,1] op_sel_hi:[1,1,1] neg_lo:[1,0,0] neg_hi:[1,0,0]
v_exp_f32 v231, v231
v_cvt_pk_bf16_f32 v113, v222, v223
v_pk_fma_f32 v[222:223], v[62:63], v[128:129], v[104:105] op_sel:[0,0,0] op_sel_hi:[1,0,0] neg_lo:[1,0,0] neg_hi:[1,0,0]
v_exp_f32 v222, v222
v_pk_fma_f32 v[220:221], v[60:61], v[128:129], v[104:105] op_sel:[0,0,0] op_sel_hi:[1,0,0] neg_lo:[1,0,0] neg_hi:[1,0,0]
v_exp_f32 v221, v221
v_exp_f32 v220, v220
v_max_f32 v100, v100, v102
v_exp_f32 v223, v223
v_mov_b32 v102, v100
v_pk_add_f32 v[110:111], v[220:221], v[222:223]
v_exp_f32 v225, v225
v_pk_fma_f32 v[232:233], v[72:73], v[128:129], v[104:105] op_sel:[0,1,1] op_sel_hi:[1,1,1] neg_lo:[1,0,0] neg_hi:[1,0,0]
v_exp_f32 v232, v232
v_exp_f32 v233, v233
v_pk_add_f32 v[110:111], v[110:111], v[224:225]
v_exp_f32 v229, v229
v_exp_f32 v228, v228
v_exp_f32 v227, v227
v_cvt_pk_bf16_f32 v123, v234, v235
v_pk_fma_f32 v[234:235], v[74:75], v[128:129], v[104:105] op_sel:[0,1,1] op_sel_hi:[1,1,1] neg_lo:[1,0,0] neg_hi:[1,0,0]
v_pk_add_f32 v[110:111], v[110:111], v[226:227]
v_add_f32 v104, v110, v111
v_cvt_pk_bf16_f32 v118, v244, v245
v_permlane32_swap_b32 v106, v107
v_permlane16_swap_b32 v100, v102
v_exp_f32 v234, v234
v_mov_b32 v101, v100
v_exp_f32 v235, v235
v_exp_f32_e64 v230, v230
v_cvt_pk_bf16_f32 v125, v242, v243
v_pk_add_f32 v[110:111], v[228:229], v[230:231]
v_pk_add_f32 v[110:111], v[110:111], v[232:233]
v_pk_add_f32 v[110:111], v[110:111], v[234:235]
v_cvt_pk_bf16_f32 v126, v248, v249
v_pk_mul_f32 v[106:107], v[106:107], v[130:131]
v_pk_fma_f32 v[236:237], v[76:77], v[130:131], v[106:107] op_sel:[0,0,0] op_sel_hi:[1,0,0] neg_lo:[1,0,0] neg_hi:[1,0,0]
v_exp_f32 v237, v237
v_exp_f32 v236, v236
v_pk_fma_f32 v[242:243], v[82:83], v[130:131], v[106:107] op_sel:[0,0,0] op_sel_hi:[1,0,0] neg_lo:[1,0,0] neg_hi:[1,0,0]
v_pk_fma_f32 v[250:251], v[90:91], v[130:131], v[106:107] op_sel:[0,1,1] op_sel_hi:[1,1,1] neg_lo:[1,0,0] neg_hi:[1,0,0]
v_add_f32 v105, v110, v111
v_exp_f32 v243, v243
v_cvt_pk_bf16_f32 v119, v246, v247
v_pk_fma_f32 v[246:247], v[86:87], v[130:131], v[106:107] op_sel:[0,1,1] op_sel_hi:[1,1,1] neg_lo:[1,0,0] neg_hi:[1,0,0]
v_exp_f32 v246, v246
v_cvt_pk_bf16_f32 v117, v238, v239
v_pk_fma_f32 v[238:239], v[78:79], v[130:131], v[106:107] op_sel:[0,0,0] op_sel_hi:[1,0,0] neg_lo:[1,0,0] neg_hi:[1,0,0]
v_exp_f32 v238, v238
v_exp_f32 v247, v247
v_pk_fma_f32 v[240:241], v[80:81], v[130:131], v[106:107] op_sel:[0,0,0] op_sel_hi:[1,0,0] neg_lo:[1,0,0] neg_hi:[1,0,0]
v_exp_f32 v240, v240
v_exp_f32 v241, v241
v_permlane32_swap_b32 v100, v101
v_exp_f32 v242, v242
v_pk_fma_f32 v[244:245], v[84:85], v[130:131], v[106:107] op_sel:[0,1,1] op_sel_hi:[1,1,1] neg_lo:[1,0,0] neg_hi:[1,0,0]
v_exp_f32 v244, v244
v_exp_f32_e64 v239, v239
v_pk_mul_f32 v[100:101], v[100:101], v[128:129]
v_pk_fma_f32 v[62:63], v[62:63], v[128:129], v[100:101] op_sel:[0,0,0] op_sel_hi:[1,0,0] neg_lo:[0,0,1] neg_hi:[0,0,1]
v_pk_add_f32 v[110:111], v[236:237], v[238:239]
v_pk_add_f32 v[110:111], v[110:111], v[240:241]
v_pk_add_f32 v[110:111], v[110:111], v[242:243]
v_pk_fma_f32 v[72:73], v[72:73], v[128:129], v[100:101] op_sel:[0,1,1] op_sel_hi:[1,1,1] neg_lo:[0,0,1] neg_hi:[0,0,1]
v_pk_fma_f32 v[66:67], v[66:67], v[128:129], v[100:101] op_sel:[0,0,0] op_sel_hi:[1,0,0] neg_lo:[0,0,1] neg_hi:[0,0,1]
v_exp_f32 v62, v62
v_pk_fma_f32 v[60:61], v[60:61], v[128:129], v[100:101] op_sel:[0,0,0] op_sel_hi:[1,0,0] neg_lo:[0,0,1] neg_hi:[0,0,1]
v_exp_f32 v60, v60
v_exp_f32 v245, v245
v_exp_f32 v73, v73
v_pk_fma_f32 v[248:249], v[88:89], v[130:131], v[106:107] op_sel:[0,1,1] op_sel_hi:[1,1,1] neg_lo:[1,0,0] neg_hi:[1,0,0]
v_add_f32 v106, v110, v111
v_exp_f32 v249, v249
v_pk_add_f32 v[110:111], v[244:245], v[246:247]
v_exp_f32 v248, v248
v_pk_fma_f32 v[64:65], v[64:65], v[128:129], v[100:101] op_sel:[0,0,0] op_sel_hi:[1,0,0] neg_lo:[0,0,1] neg_hi:[0,0,1]
v_exp_f32 v64, v64
v_pk_add_f32 v[110:111], v[110:111], v[248:249]
v_exp_f32 v65, v65
v_exp_f32 v61, v61
v_exp_f32 v66, v66
v_exp_f32 v251, v251
v_exp_f32 v63, v63
v_pk_fma_f32 v[74:75], v[74:75], v[128:129], v[100:101] op_sel:[0,1,1] op_sel_hi:[1,1,1] neg_lo:[0,0,1] neg_hi:[0,0,1]
v_pk_add_f32 v[108:109], v[60:61], v[62:63]
v_exp_f32 v67, v67
v_exp_f32 v250, v250
v_pk_fma_f32 v[68:69], v[68:69], v[128:129], v[100:101] op_sel:[0,1,1] op_sel_hi:[1,1,1] neg_lo:[0,0,1] neg_hi:[0,0,1]
v_pk_add_f32 v[110:111], v[110:111], v[250:251]
v_exp_f32 v68, v68
v_exp_f32 v69, v69
v_add_f32 v107, v110, v111
v_mov_b32 v103, v102
v_pk_fma_f32 v[70:71], v[70:71], v[128:129], v[100:101] op_sel:[0,1,1] op_sel_hi:[1,1,1] neg_lo:[0,0,1] neg_hi:[0,0,1]
v_exp_f32 v71, v71
v_exp_f32 v70, v70
v_permlane32_swap_b32 v106, v107
v_permlane32_swap_b32 v102, v103
v_pk_add_f32 v[108:109], v[108:109], v[64:65]
v_pk_add_f32 v[108:109], v[108:109], v[66:67]
v_add_f32 v100, v108, v109
v_pk_add_f32 v[108:109], v[68:69], v[70:71]
v_pk_mul_f32 v[102:103], v[102:103], v[130:131]
v_pk_fma_f32 v[78:79], v[78:79], v[130:131], v[102:103] op_sel:[0,0,0] op_sel_hi:[1,0,0] neg_lo:[0,0,1] neg_hi:[0,0,1]
v_exp_f32 v79, v79
v_exp_f32 v78, v78
v_exp_f32 v74, v74
v_exp_f32 v72, v72
v_pk_fma_f32 v[86:87], v[86:87], v[130:131], v[102:103] op_sel:[0,1,1] op_sel_hi:[1,1,1] neg_lo:[0,0,1] neg_hi:[0,0,1]
v_exp_f32 v87, v87
v_pk_fma_f32 v[76:77], v[76:77], v[130:131], v[102:103] op_sel:[0,0,0] op_sel_hi:[1,0,0] neg_lo:[0,0,1] neg_hi:[0,0,1]
v_exp_f32 v77, v77
v_add_f32 v106, v106, v107
v_pk_fma_f32 v[80:81], v[80:81], v[130:131], v[102:103] op_sel:[0,0,0] op_sel_hi:[1,0,0] neg_lo:[0,0,1] neg_hi:[0,0,1]
v_exp_f32 v81, v81
v_exp_f32 v80, v80
v_pk_add_f32 v[108:109], v[108:109], v[72:73]
v_permlane32_swap_b32 v104, v105
v_exp_f32 v75, v75
v_add_f32 v104, v104, v105
v_pk_fma_f32 v[82:83], v[82:83], v[130:131], v[102:103] op_sel:[0,0,0] op_sel_hi:[1,0,0] neg_lo:[0,0,1] neg_hi:[0,0,1]
v_exp_f32 v82, v82
v_exp_f32 v83, v83
v_permlane16_swap_b32 v104, v106
v_pk_add_f32 v[108:109], v[108:109], v[74:75]
v_add_f32 v101, v108, v109
v_exp_f32 v76, v76
v_add_f32 v104, v104, v106
v_rcp_f32 v104, v104
v_pk_fma_f32 v[84:85], v[84:85], v[130:131], v[102:103] op_sel:[0,1,1] op_sel_hi:[1,1,1] neg_lo:[0,0,1] neg_hi:[0,0,1]
v_exp_f32 v84, v84
v_exp_f32 v85, v85
v_mov_b32 v106, v104
v_pk_add_f32 v[108:109], v[76:77], v[78:79]
v_pk_add_f32 v[108:109], v[108:109], v[80:81]
v_pk_add_f32 v[108:109], v[108:109], v[82:83]
v_pk_fma_f32 v[88:89], v[88:89], v[130:131], v[102:103] op_sel:[0,1,1] op_sel_hi:[1,1,1] neg_lo:[0,0,1] neg_hi:[0,0,1]
v_exp_f32 v88, v88
v_exp_f32 v89, v89
v_exp_f32 v86, v86
v_pk_fma_f32 v[90:91], v[90:91], v[130:131], v[102:103] op_sel:[0,1,1] op_sel_hi:[1,1,1] neg_lo:[0,0,1] neg_hi:[0,0,1]
v_add_f32 v102, v108, v109
v_pk_add_f32 v[108:109], v[84:85], v[86:87]
v_pk_add_f32 v[108:109], v[108:109], v[88:89]
v_permlane16_swap_b32 v104, v106
v_exp_f32 v90, v90
v_exp_f32 v91, v91
v_permlane32_swap_b32 v100, v101
v_pk_add_f32 v[108:109], v[108:109], v[90:91]
v_add_f32 v103, v108, v109
v_add_f32 v100, v100, v101
v_mov_b32 v105, v104
v_permlane32_swap_b32 v102, v103
v_mov_b32 v107, v106
v_add_f32 v102, v102, v103
v_permlane32_swap_b32 v104, v105
v_permlane32_swap_b32 v106, v107
v_permlane16_swap_b32 v100, v102
v_pk_mul_f32 v[222:223], v[222:223], v[104:105] op_sel:[0,0] op_sel_hi:[1,0]
v_pk_mul_f32 v[226:227], v[226:227], v[104:105] op_sel:[0,0] op_sel_hi:[1,0]
v_pk_mul_f32 v[234:235], v[234:235], v[104:105] op_sel:[0,1] op_sel_hi:[1,1]
v_pk_mul_f32 v[232:233], v[232:233], v[104:105] op_sel:[0,1] op_sel_hi:[1,1]
v_pk_mul_f32 v[230:231], v[230:231], v[104:105] op_sel:[0,1] op_sel_hi:[1,1]
v_add_f32 v100, v100, v102
v_pk_mul_f32 v[228:229], v[228:229], v[104:105] op_sel:[0,1] op_sel_hi:[1,1]
v_cvt_pk_bf16_f32 v228, v228, v229
v_cvt_pk_bf16_f32 v229, v230, v231
v_cvt_pk_bf16_f32 v231, v234, v235
v_cvt_pk_bf16_f32 v230, v232, v233
v_pk_mul_f32 v[220:221], v[220:221], v[104:105] op_sel:[0,0] op_sel_hi:[1,0]
v_cvt_pk_bf16_f32 v220, v220, v221
v_pk_mul_f32 v[224:225], v[224:225], v[104:105] op_sel:[0,0] op_sel_hi:[1,0]
v_pk_mul_f32 v[236:237], v[236:237], v[106:107] op_sel:[0,0] op_sel_hi:[1,0]
v_pk_mul_f32 v[238:239], v[238:239], v[106:107] op_sel:[0,0] op_sel_hi:[1,0]
v_pk_mul_f32 v[240:241], v[240:241], v[106:107] op_sel:[0,0] op_sel_hi:[1,0]
v_pk_mul_f32 v[242:243], v[242:243], v[106:107] op_sel:[0,0] op_sel_hi:[1,0]
v_pk_mul_f32 v[248:249], v[248:249], v[106:107] op_sel:[0,1] op_sel_hi:[1,1]
v_rcp_f32 v100, v100
v_pk_mul_f32 v[244:245], v[244:245], v[106:107] op_sel:[0,1] op_sel_hi:[1,1]
v_mov_b32 v102, v100
v_pk_mul_f32 v[250:251], v[250:251], v[106:107] op_sel:[0,1] op_sel_hi:[1,1]
v_cvt_pk_bf16_f32 v221, v222, v223
v_pk_mul_f32 v[246:247], v[246:247], v[106:107] op_sel:[0,1] op_sel_hi:[1,1]
v_cvt_pk_bf16_f32 v222, v224, v225
v_mfma_f32_16x16x32_bf16 v[200:203], v[228:231], v[36:39], 0
v_cvt_pk_bf16_f32 v223, v226, v227
v_permlane16_swap_b32 v100, v102
v_mfma_f32_16x16x32_bf16 v[196:199], v[228:231], v[38:41], 0
v_mov_b32 v101, v100
v_cvt_pk_bf16_f32 v244, v244, v245
v_mfma_f32_16x16x32_bf16 v[212:215], v[220:223], v[38:41], 0
v_cvt_pk_bf16_f32 v245, v246, v247
v_cvt_pk_bf16_f32 v247, v250, v251
v_mfma_f32_16x16x32_bf16 v[216:219], v[220:223], v[36:39], 0
v_cvt_pk_bf16_f32 v234, v200, v201
v_cvt_pk_bf16_f32 v246, v248, v249
v_cvt_pk_bf16_f32 v226, v196, v197
v_cvt_pk_bf16_f32 v227, v198, v199
v_mfma_f32_16x16x32_bf16 v[196:199], v[244:247], v[38:41], 0
v_cvt_pk_bf16_f32 v225, v214, v215
v_cvt_pk_bf16_f32 v236, v236, v237
v_cvt_pk_bf16_f32 v237, v238, v239
v_cvt_pk_bf16_f32 v232, v216, v217
v_cvt_pk_bf16_f32 v233, v218, v219
v_cvt_pk_bf16_f32 v239, v242, v243
v_cvt_pk_bf16_f32 v238, v240, v241
v_cvt_pk_bf16_f32 v224, v212, v213
v_permlane32_swap_b32 v100, v101
v_mfma_f32_16x16x32_bf16 v[216:219], v[236:239], v[36:39], 0
v_mov_b32 v103, v102
v_cvt_pk_bf16_f32 v235, v202, v203
v_mfma_f32_16x16x32_bf16 v[212:215], v[236:239], v[38:41], 0
v_cvt_pk_bf16_f32 v243, v198, v199
v_permlane32_swap_b32 v102, v103
v_mfma_f32_16x16x32_bf16 v[200:203], v[244:247], v[36:39], 0
v_cvt_pk_bf16_f32 v242, v196, v197
v_mov_b32 v5, s61
v_mfma_f32_16x16x32_bf16 v[220:223], v[232:235], v[120:123], 0
v_cvt_pk_bf16_f32 v249, v218, v219
v_cvt_pk_bf16_f32 v248, v216, v217
v_cvt_pk_bf16_f32 v241, v214, v215
v_cvt_pk_bf16_f32 v240, v212, v213
v_cmp_eq_u32 s[50:51], s41, v2
v_pk_mul_f32 v[64:65], v[64:65], v[100:101] op_sel:[0,0] op_sel_hi:[1,0]
v_pk_mul_f32 v[74:75], v[74:75], v[100:101] op_sel:[0,1] op_sel_hi:[1,1]
v_pk_mul_f32 v[68:69], v[68:69], v[100:101] op_sel:[0,1] op_sel_hi:[1,1]
v_pk_mul_f32 v[72:73], v[72:73], v[100:101] op_sel:[0,1] op_sel_hi:[1,1]
v_pk_mul_f32 v[60:61], v[60:61], v[100:101] op_sel:[0,0] op_sel_hi:[1,0]
v_pk_mul_f32 v[62:63], v[62:63], v[100:101] op_sel:[0,0] op_sel_hi:[1,0]
v_pk_mul_f32 v[66:67], v[66:67], v[100:101] op_sel:[0,0] op_sel_hi:[1,0]
v_pk_mul_f32 v[76:77], v[76:77], v[102:103] op_sel:[0,0] op_sel_hi:[1,0]
v_pk_mul_f32 v[70:71], v[70:71], v[100:101] op_sel:[0,1] op_sel_hi:[1,1]
v_cvt_pk_bf16_f32 v60, v60, v61
v_pk_mul_f32 v[80:81], v[80:81], v[102:103] op_sel:[0,0] op_sel_hi:[1,0]
v_pk_mul_f32 v[78:79], v[78:79], v[102:103] op_sel:[0,0] op_sel_hi:[1,0]
v_pk_mul_f32 v[82:83], v[82:83], v[102:103] op_sel:[0,0] op_sel_hi:[1,0]
v_pk_mul_f32 v[86:87], v[86:87], v[102:103] op_sel:[0,1] op_sel_hi:[1,1]
v_cvt_pk_bf16_f32 v61, v62, v63
v_pk_mul_f32 v[84:85], v[84:85], v[102:103] op_sel:[0,1] op_sel_hi:[1,1]
v_cvt_pk_bf16_f32 v62, v64, v65
v_pk_mul_f32 v[88:89], v[88:89], v[102:103] op_sel:[0,1] op_sel_hi:[1,1]
v_cvt_pk_bf16_f32 v63, v66, v67
v_pk_mul_f32 v[90:91], v[90:91], v[102:103] op_sel:[0,1] op_sel_hi:[1,1]
v_cvt_pk_bf16_f32 v68, v68, v69
v_mfma_f32_16x16x32_bf16 v[208:211], v[60:63], v[36:39], 0
v_cvt_pk_bf16_f32 v69, v70, v71
v_cvt_pk_bf16_f32 v70, v72, v73
v_mfma_f32_16x16x32_bf16 v[204:207], v[60:63], v[38:41], 0
v_cvt_pk_bf16_f32 v71, v74, v75
v_cvt_pk_bf16_f32 v76, v76, v77
v_mfma_f32_16x16x32_bf16 v[60:63], v[232:235], v[112:115], 0
v_cvt_pk_bf16_f32 v250, v200, v201
v_cvt_pk_bf16_f32 v77, v78, v79
v_mfma_f32_16x16x32_bf16 v[192:195], v[68:71], v[36:39], 0
v_cvt_pk_bf16_f32 v78, v80, v81
v_cvt_pk_bf16_f32 v79, v82, v83
v_mfma_f32_16x16x32_bf16 v[188:191], v[68:71], v[38:41], 0
v_cvt_pk_bf16_f32 v65, v206, v207
v_cvt_pk_bf16_f32 v64, v204, v205
v_mfma_f32_16x16x32_bf16 v[68:71], v[224:227], v[120:123], 0
v_cvt_pk_bf16_f32 v251, v202, v203
v_cvt_pk_bf16_f32 v72, v208, v209
v_mfma_f32_16x16x32_bf16 v[152:155], v[224:227], v[112:115], 0
v_cvt_pk_bf16_f32 v73, v210, v211
v_cvt_pk_bf16_f32 v84, v84, v85
v_mfma_f32_16x16x32_bf16 v[60:63], v[248:251], v[116:119], v[60:63]
v_cvt_pk_bf16_f32 v85, v86, v87
v_cvt_pk_bf16_f32 v86, v88, v89
v_mfma_f32_16x16x32_bf16 v[228:231], v[224:227], v[48:51], 0
v_cvt_pk_bf16_f32 v67, v190, v191
v_cvt_pk_bf16_f32 v87, v90, v91
v_mfma_f32_16x16x32_bf16 v[220:223], v[248:251], v[124:127], v[220:223]
v_cvt_pk_bf16_f32 v66, v188, v189
v_cvt_pk_bf16_f32 v74, v192, v193
v_mfma_f32_16x16x32_bf16 v[152:155], v[240:243], v[116:119], v[152:155]
v_cvt_pk_bf16_f32 v75, v194, v195
v_mfma_f32_16x16x32_bf16 v[204:207], v[76:79], v[38:41], 0
v_mfma_f32_16x16x32_bf16 v[208:211], v[76:79], v[36:39], 0
v_mfma_f32_16x16x32_bf16 v[228:231], v[240:243], v[48:51], v[228:231]
v_mfma_f32_16x16x32_bf16 v[68:71], v[240:243], v[124:127], v[68:71]
v_mfma_f32_16x16x32_bf16 v[76:79], v[232:235], v[48:51], 0
s_nop 1
v_cvt_pk_bf16_f32 v152, v152, v153
v_mfma_f32_16x16x32_bf16 v[76:79], v[248:251], v[48:51], v[76:79]
v_cvt_pk_bf16_f32 v153, v154, v155
v_cvt_pk_bf16_f32 v154, v60, v61
v_mfma_f32_16x16x32_bf16 v[192:195], v[84:87], v[36:39], 0
v_cvt_pk_bf16_f32 v68, v68, v69
v_cvt_pk_bf16_f32 v155, v62, v63
v_mfma_f32_16x16x32_bf16 v[188:191], v[84:87], v[38:41], 0
ds_write_b128 v42, v[152:155] offset:0
v_mfma_f32_16x16x32_bf16 v[136:139], v[64:67], v[48:51], 0
v_cvt_pk_bf16_f32 v69, v70, v71
v_cvt_pk_bf16_f32 v228, v228, v229
v_mfma_f32_16x16x32_bf16 v[104:107], v[72:75], v[112:115], 0
v_cvt_pk_bf16_f32 v71, v222, v223
v_cvt_pk_bf16_f32 v229, v230, v231
v_mfma_f32_16x16x32_bf16 v[148:151], v[72:75], v[48:51], 0
v_cvt_pk_bf16_f32 v230, v76, v77
v_cvt_pk_bf16_f32 v70, v220, v221
v_mfma_f32_16x16x32_bf16 v[132:135], v[72:75], v[120:123], 0
ds_write_b128 v42, v[68:71] offset:1024
v_mfma_f32_16x16x32_bf16 v[108:111], v[64:67], v[120:123], 0
v_cvt_pk_bf16_f32 v231, v78, v79
ds_write_b128 v42, v[228:231] offset:2048
v_mfma_f32_16x16x32_bf16 v[100:103], v[64:67], v[112:115], 0
ds_write_b32 v52, v5
v_cvt_pk_bf16_f32 v88, v208, v209
v_cvt_pk_bf16_f32 v83, v190, v191
v_cvt_pk_bf16_f32 v91, v194, v195
v_cvt_pk_bf16_f32 v82, v188, v189
v_cvt_pk_bf16_f32 v80, v204, v205
v_cvt_pk_bf16_f32 v89, v210, v211
v_cvt_pk_bf16_f32 v81, v206, v207
v_cvt_pk_bf16_f32 v90, v192, v193
s_nop 0
v_mfma_f32_16x16x32_bf16 v[100:103], v[80:83], v[116:119], v[100:103]
v_mfma_f32_16x16x32_bf16 v[108:111], v[80:83], v[124:127], v[108:111]
v_mfma_f32_16x16x32_bf16 v[132:135], v[88:91], v[124:127], v[132:135]
v_mfma_f32_16x16x32_bf16 v[148:151], v[88:91], v[48:51], v[148:151]
v_mfma_f32_16x16x32_bf16 v[136:139], v[80:83], v[48:51], v[136:139]
v_mfma_f32_16x16x32_bf16 v[104:107], v[88:91], v[116:119], v[104:107]
s_mov_b32 s63, 0
px_84:
ds_read_b32 v4, v19
ds_read_b128 v[188:191], v43 offset:0
ds_read_b128 v[192:195], v43 offset:1024
ds_read_b128 v[196:199], v43 offset:2048
s_add_u32 s63, s63, 1
s_cmp_lt_u32 s63, 0x400000
s_waitcnt lgkmcnt(0)
v_cmp_ne_u32 vcc, s61, v4
s_cbranch_vccz pxd_85
s_cbranch_scc1 px_84
pxd_85:
v_mfma_f32_16x16x32_bf16 v[100:103], v[38:41], v[188:191], v[100:103]
v_mfma_f32_16x16x32_bf16 v[104:107], v[36:39], v[188:191], v[104:107]
v_mfma_f32_16x16x32_bf16 v[108:111], v[38:41], v[192:195], v[108:111]
v_mfma_f32_16x16x32_bf16 v[132:135], v[36:39], v[192:195], v[132:135]
v_mfma_f32_16x16x32_bf16 v[136:139], v[38:41], v[196:199], v[136:139]
v_mfma_f32_16x16x32_bf16 v[148:151], v[36:39], v[196:199], v[148:151]
s_nop 2
v_cvt_pk_bf16_f32 v100, v100, v101
v_cvt_pk_bf16_f32 v101, v102, v103
v_cvt_pk_bf16_f32 v102, v104, v105
v_cvt_pk_bf16_f32 v103, v106, v107
buffer_store_dwordx4 v[100:103], v55, s[32:35], s53 offen sc1
v_cvt_pk_bf16_f32 v108, v108, v109
v_cvt_pk_bf16_f32 v109, v110, v111
v_cvt_pk_bf16_f32 v110, v132, v133
v_cvt_pk_bf16_f32 v111, v134, v135
buffer_store_dwordx4 v[108:111], v55, s[32:35], s54 offen sc1
v_cvt_pk_bf16_f32 v136, v136, v137
v_cvt_pk_bf16_f32 v137, v138, v139
v_cvt_pk_bf16_f32 v138, v148, v149
v_cvt_pk_bf16_f32 v139, v150, v151
s_mov_b64 exec, s[50:51]
buffer_store_dwordx4 v[136:139], v58, s[32:35], s56 offen sc1
s_mov_b64 exec, -1
s_mov_b32 s51, 0
.p2align 3
v_pk_fma_f32 v[156:157], v[140:141], v[92:93], v[156:157] op_sel:[0,1,0] op_sel_hi:[1,1,1]
v_pk_fma_f32 v[164:165], v[140:141], v[94:95], v[164:165] op_sel:[0,1,0] op_sel_hi:[1,1,1]
v_pk_fma_f32 v[172:173], v[140:141], v[96:97], v[172:173] op_sel:[0,1,0] op_sel_hi:[1,1,1]
v_pk_fma_f32 v[180:181], v[140:141], v[98:99], v[180:181] op_sel:[0,1,0] op_sel_hi:[1,1,1]
v_pk_fma_f32 v[158:159], v[142:143], v[92:93], v[158:159] op_sel:[0,1,0] op_sel_hi:[1,1,1]
v_cvt_pk_bf16_f32 v156, v156, v157
v_pk_fma_f32 v[166:167], v[142:143], v[94:95], v[166:167] op_sel:[0,1,0] op_sel_hi:[1,1,1]
v_cvt_pk_bf16_f32 v164, v164, v165
v_pk_fma_f32 v[174:175], v[142:143], v[96:97], v[174:175] op_sel:[0,1,0] op_sel_hi:[1,1,1]
v_cvt_pk_bf16_f32 v172, v172, v173
v_pk_fma_f32 v[182:183], v[142:143], v[98:99], v[182:183] op_sel:[0,1,0] op_sel_hi:[1,1,1]
v_cvt_pk_bf16_f32 v180, v180, v181
v_pk_fma_f32 v[160:161], v[144:145], v[92:93], v[160:161] op_sel:[0,1,0] op_sel_hi:[1,1,1]
v_pk_fma_f32 v[162:163], v[146:147], v[92:93], v[162:163] op_sel:[0,1,0] op_sel_hi:[1,1,1]
v_cvt_pk_bf16_f32 v157, v158, v159
v_pk_fma_f32 v[168:169], v[144:145], v[94:95], v[168:169] op_sel:[0,1,0] op_sel_hi:[1,1,1]
v_pk_fma_f32 v[170:171], v[146:147], v[94:95], v[170:171] op_sel:[0,1,0] op_sel_hi:[1,1,1]
v_cvt_pk_bf16_f32 v165, v166, v167
v_pk_fma_f32 v[176:177], v[144:145], v[96:97], v[176:177] op_sel:[0,1,0] op_sel_hi:[1,1,1]
v_pk_fma_f32 v[178:179], v[146:147], v[96:97], v[178:179] op_sel:[0,1,0] op_sel_hi:[1,1,1]
v_cvt_pk_bf16_f32 v173, v174, v175
v_pk_fma_f32 v[184:185], v[144:145], v[98:99], v[184:185] op_sel:[0,1,0] op_sel_hi:[1,1,1]
v_pk_fma_f32 v[186:187], v[146:147], v[98:99], v[186:187] op_sel:[0,1,0] op_sel_hi:[1,1,1]
v_cvt_pk_bf16_f32 v181, v182, v183
v_cvt_pk_bf16_f32 v158, v160, v161
v_cvt_pk_bf16_f32 v159, v162, v163
v_cvt_pk_bf16_f32 v166, v168, v169
v_cvt_pk_bf16_f32 v167, v170, v171
v_mfma_f32_16x16x32_bf16 v[60:63], v[10:13], v[156:159], 0
v_cvt_pk_bf16_f32 v174, v176, v177
v_cvt_pk_bf16_f32 v175, v178, v179
v_mfma_f32_16x16x32_bf16 v[68:71], v[10:13], v[164:167], 0
v_cvt_pk_bf16_f32 v182, v184, v185
v_cvt_pk_bf16_f32 v183, v186, v187
v_mfma_f32_16x16x32_bf16 v[76:79], v[10:13], v[172:175], 0
s_nop 0
v_mfma_f32_16x16x32_bf16 v[84:87], v[10:13], v[180:183], 0
v_min3_f32 v104, v60, v61, v62
v_max3_f32 v100, v60, v61, v62
v_mfma_f32_16x16x32_bf16 v[64:67], v[14:17], v[156:159], 0
v_min3_f32 v105, v68, v69, v70
v_max3_f32 v101, v68, v69, v70
v_mfma_f32_16x16x32_bf16 v[72:75], v[14:17], v[164:167], 0
v_min3_f32 v106, v76, v77, v78
v_max3_f32 v102, v76, v77, v78
v_mfma_f32_16x16x32_bf16 v[80:83], v[14:17], v[172:175], 0
v_min3_f32 v107, v84, v85, v86
v_max3_f32 v103, v84, v85, v86
v_mfma_f32_16x16x32_bf16 v[88:91], v[14:17], v[180:183], 0
v_min3_f32 v104, v104, v63, v64
v_max3_f32 v100, v100, v63, v64
v_min3_f32 v105, v105, v71, v72
v_min3_f32 v104, v104, v65, v66
v_max3_f32 v101, v101, v71, v72
v_min3_f32 v106, v106, v79, v80
v_min3_f32 v105, v105, v73, v74
v_max3_f32 v102, v102, v79, v80
v_min3_f32 v107, v107, v87, v88
v_min3_f32 v106, v106, v81, v82
v_max3_f32 v103, v103, v87, v88
v_min3_f32 v107, v107, v89, v90
v_max3_f32 v100, v100, v65, v66
v_min_f32 v104, v104, v67
v_max3_f32 v101, v101, v73, v74
v_min_f32 v105, v105, v75
v_max3_f32 v102, v102, v81, v82
v_min_f32 v106, v106, v83
v_max3_f32 v103, v103, v89, v90
v_min_f32 v107, v107, v91
v_max_f32 v100, v100, v67
v_max_f32 v101, v101, v75
v_max_f32 v102, v102, v83
v_max_f32 v103, v103, v91
v_permlane32_swap_b32 v104, v105
v_permlane32_swap_b32 v106, v107
v_permlane32_swap_b32 v100, v101
v_permlane32_swap_b32 v102, v103
v_min_f32 v104, v104, v105
v_min_f32 v106, v106, v107
v_max_f32 v100, v100, v101
v_max_f32 v102, v102, v103
v_permlane16_swap_b32 v104, v106
s_nop 0
v_permlane16_swap_b32 v100, v102
v_min_f32 v104, v104, v106
v_max_f32 v100, v100, v102
v_mov_b32 v106, v104
v_mov_b32 v102, v100
s_nop 0
v_permlane16_swap_b32 v104, v106
v_permlane16_swap_b32 v100, v102
v_mov_b32 v105, v104
v_mov_b32 v101, v100
v_mov_b32 v103, v102
v_permlane32_swap_b32 v104, v105
v_mov_b32 v107, v106
v_permlane32_swap_b32_e64 v100, v101
v_pk_mul_f32 v[104:105], v[104:105], v[128:129]
v_pk_mul_f32 v[100:101], v[100:101], v[128:129]
v_pk_fma_f32 v[220:221], v[60:61], v[128:129], v[104:105] op_sel:[0,0,0] op_sel_hi:[1,0,0] neg_lo:[1,0,0] neg_hi:[1,0,0]
v_pk_fma_f32 v[222:223], v[62:63], v[128:129], v[104:105] op_sel:[0,0,0] op_sel_hi:[1,0,0] neg_lo:[1,0,0] neg_hi:[1,0,0]
v_pk_fma_f32 v[224:225], v[64:65], v[128:129], v[104:105] op_sel:[0,0,0] op_sel_hi:[1,0,0] neg_lo:[1,0,0] neg_hi:[1,0,0]
v_pk_fma_f32 v[226:227], v[66:67], v[128:129], v[104:105] op_sel:[0,0,0] op_sel_hi:[1,0,0] neg_lo:[1,0,0] neg_hi:[1,0,0]
v_pk_fma_f32 v[228:229], v[68:69], v[128:129], v[104:105] op_sel:[0,1,1] op_sel_hi:[1,1,1] neg_lo:[1,0,0] neg_hi:[1,0,0]
v_pk_fma_f32 v[230:231], v[70:71], v[128:129], v[104:105] op_sel:[0,1,1] op_sel_hi:[1,1,1] neg_lo:[1,0,0] neg_hi:[1,0,0]
v_pk_fma_f32 v[232:233], v[72:73], v[128:129], v[104:105] op_sel:[0,1,1] op_sel_hi:[1,1,1] neg_lo:[1,0,0] neg_hi:[1,0,0]
v_pk_fma_f32 v[234:235], v[74:75], v[128:129], v[104:105] op_sel:[0,1,1] op_sel_hi:[1,1,1] neg_lo:[1,0,0] neg_hi:[1,0,0]
v_permlane32_swap_b32 v102, v103
v_permlane32_swap_b32 v106, v107
v_pk_fma_f32 v[60:61], v[60:61], v[128:129], v[100:101] op_sel:[0,0,0] op_sel_hi:[1,0,0] neg_lo:[0,0,1] neg_hi:[0,0,1]
v_pk_fma_f32 v[62:63], v[62:63], v[128:129], v[100:101] op_sel:[0,0,0] op_sel_hi:[1,0,0] neg_lo:[0,0,1] neg_hi:[0,0,1]
v_pk_fma_f32 v[64:65], v[64:65], v[128:129], v[100:101] op_sel:[0,0,0] op_sel_hi:[1,0,0] neg_lo:[0,0,1] neg_hi:[0,0,1]
v_pk_fma_f32 v[66:67], v[66:67], v[128:129], v[100:101] op_sel:[0,0,0] op_sel_hi:[1,0,0] neg_lo:[0,0,1] neg_hi:[0,0,1]
v_pk_fma_f32 v[68:69], v[68:69], v[128:129], v[100:101] op_sel:[0,1,1] op_sel_hi:[1,1,1] neg_lo:[0,0,1] neg_hi:[0,0,1]
v_pk_fma_f32 v[70:71], v[70:71], v[128:129], v[100:101] op_sel:[0,1,1] op_sel_hi:[1,1,1] neg_lo:[0,0,1] neg_hi:[0,0,1]
v_pk_fma_f32 v[72:73], v[72:73], v[128:129], v[100:101] op_sel:[0,1,1] op_sel_hi:[1,1,1] neg_lo:[0,0,1] neg_hi:[0,0,1]
v_pk_fma_f32 v[74:75], v[74:75], v[128:129], v[100:101] op_sel:[0,1,1] op_sel_hi:[1,1,1] neg_lo:[0,0,1] neg_hi:[0,0,1]
v_exp_f32 v220, v220
v_exp_f32 v60, v60
v_exp_f32 v221, v221
v_exp_f32 v61, v61
v_exp_f32 v222, v222
v_exp_f32 v62, v62
v_exp_f32 v223, v223
v_exp_f32 v63, v63
v_exp_f32 v224, v224
v_exp_f32 v64, v64
v_exp_f32 v225, v225
v_exp_f32 v65, v65
v_exp_f32 v226, v226
v_exp_f32 v66, v66
v_exp_f32 v227, v227
v_exp_f32 v67, v67
v_exp_f32 v228, v228
v_exp_f32 v68, v68
v_exp_f32 v229, v229
v_exp_f32 v69, v69
v_exp_f32 v230, v230
v_exp_f32 v70, v70
v_exp_f32 v231, v231
v_exp_f32 v71, v71
v_exp_f32 v232, v232
v_exp_f32 v72, v72
v_exp_f32 v233, v233
v_exp_f32 v73, v73
v_exp_f32 v234, v234
v_exp_f32 v74, v74
v_exp_f32 v235, v235
v_exp_f32 v75, v75
v_pk_mul_f32 v[102:103], v[102:103], v[130:131]
v_pk_mul_f32 v[106:107], v[106:107], v[130:131]
buffer_load_dwordx4 v[212:215], v18, s[32:35], s55 offen offset:0 sc1
buffer_load_dwordx4 v[216:219], v18, s[32:35], s55 offen offset:1024 sc1
.p2align 3
v_pk_add_f32 v[108:109], v[60:61], v[62:63]
v_pk_add_f32 v[110:111], v[220:221], v[222:223]
v_pk_add_f32 v[108:109], v[108:109], v[64:65]
v_pk_add_f32 v[110:111], v[110:111], v[224:225]
v_pk_add_f32 v[108:109], v[108:109], v[66:67]
v_pk_add_f32 v[110:111], v[110:111], v[226:227]
v_add_f32 v100, v108, v109
v_add_f32 v104, v110, v111
v_pk_fma_f32 v[236:237], v[76:77], v[130:131], v[106:107] op_sel:[0,0,0] op_sel_hi:[1,0,0] neg_lo:[1,0,0] neg_hi:[1,0,0]
v_pk_fma_f32 v[238:239], v[78:79], v[130:131], v[106:107] op_sel:[0,0,0] op_sel_hi:[1,0,0] neg_lo:[1,0,0] neg_hi:[1,0,0]
v_pk_add_f32 v[108:109], v[68:69], v[70:71]
v_pk_add_f32 v[110:111], v[228:229], v[230:231]
v_pk_fma_f32 v[76:77], v[76:77], v[130:131], v[102:103] op_sel:[0,0,0] op_sel_hi:[1,0,0] neg_lo:[0,0,1] neg_hi:[0,0,1]
v_pk_fma_f32 v[78:79], v[78:79], v[130:131], v[102:103] op_sel:[0,0,0] op_sel_hi:[1,0,0] neg_lo:[0,0,1] neg_hi:[0,0,1]
v_pk_fma_f32 v[240:241], v[80:81], v[130:131], v[106:107] op_sel:[0,0,0] op_sel_hi:[1,0,0] neg_lo:[1,0,0] neg_hi:[1,0,0]
v_pk_add_f32 v[108:109], v[108:109], v[72:73]
v_pk_add_f32 v[110:111], v[110:111], v[232:233]
v_exp_f32 v236, v236
v_exp_f32 v76, v76
v_exp_f32 v237, v237
v_exp_f32 v77, v77
v_exp_f32 v238, v238
v_exp_f32 v78, v78
v_exp_f32 v239, v239
v_exp_f32 v79, v79
v_pk_fma_f32 v[80:81], v[80:81], v[130:131], v[102:103] op_sel:[0,0,0] op_sel_hi:[1,0,0] neg_lo:[0,0,1] neg_hi:[0,0,1]
v_pk_fma_f32 v[242:243], v[82:83], v[130:131], v[106:107] op_sel:[0,0,0] op_sel_hi:[1,0,0] neg_lo:[1,0,0] neg_hi:[1,0,0]
v_pk_add_f32 v[108:109], v[108:109], v[74:75]
v_pk_add_f32 v[110:111], v[110:111], v[234:235]
v_exp_f32 v240, v240
v_exp_f32 v80, v80
v_exp_f32 v241, v241
v_exp_f32 v81, v81
v_pk_fma_f32 v[82:83], v[82:83], v[130:131], v[102:103] op_sel:[0,0,0] op_sel_hi:[1,0,0] neg_lo:[0,0,1] neg_hi:[0,0,1]
v_add_f32 v101, v108, v109
v_add_f32 v105, v110, v111
v_exp_f32 v242, v242
v_exp_f32 v82, v82
v_exp_f32 v243, v243
v_exp_f32 v83, v83
v_pk_fma_f32 v[244:245], v[84:85], v[130:131], v[106:107] op_sel:[0,1,1] op_sel_hi:[1,1,1] neg_lo:[1,0,0] neg_hi:[1,0,0]
v_pk_fma_f32 v[246:247], v[86:87], v[130:131], v[106:107] op_sel:[0,1,1] op_sel_hi:[1,1,1] neg_lo:[1,0,0] neg_hi:[1,0,0]
v_pk_add_f32 v[108:109], v[76:77], v[78:79]
v_pk_add_f32 v[110:111], v[236:237], v[238:239]
v_pk_fma_f32 v[84:85], v[84:85], v[130:131], v[102:103] op_sel:[0,1,1] op_sel_hi:[1,1,1] neg_lo:[0,0,1] neg_hi:[0,0,1]
v_pk_fma_f32 v[86:87], v[86:87], v[130:131], v[102:103] op_sel:[0,1,1] op_sel_hi:[1,1,1] neg_lo:[0,0,1] neg_hi:[0,0,1]
v_pk_fma_f32 v[248:249], v[88:89], v[130:131], v[106:107] op_sel:[0,1,1] op_sel_hi:[1,1,1] neg_lo:[1,0,0] neg_hi:[1,0,0]
v_pk_fma_f32 v[250:251], v[90:91], v[130:131], v[106:107] op_sel:[0,1,1] op_sel_hi:[1,1,1] neg_lo:[1,0,0] neg_hi:[1,0,0]
v_pk_add_f32 v[108:109], v[108:109], v[80:81]
v_pk_add_f32 v[110:111], v[110:111], v[240:241]
v_exp_f32 v244, v244
v_exp_f32 v84, v84
v_exp_f32 v245, v245
v_exp_f32 v85, v85
v_exp_f32 v246, v246
v_exp_f32 v86, v86
v_exp_f32 v247, v247
v_exp_f32 v87, v87
v_pk_fma_f32 v[88:89], v[88:89], v[130:131], v[102:103] op_sel:[0,1,1] op_sel_hi:[1,1,1] neg_lo:[0,0,1] neg_hi:[0,0,1]
v_pk_fma_f32 v[90:91], v[90:91], v[130:131], v[102:103] op_sel:[0,1,1] op_sel_hi:[1,1,1] neg_lo:[0,0,1] neg_hi:[0,0,1]
v_pk_add_f32 v[108:109], v[108:109], v[82:83]
v_pk_add_f32 v[110:111], v[110:111], v[242:243]
v_exp_f32 v248, v248
v_exp_f32 v88, v88
v_exp_f32 v249, v249
v_exp_f32 v89, v89
v_add_f32 v102, v108, v109
v_add_f32 v106, v110, v111
v_exp_f32 v250, v250
v_exp_f32 v90, v90
v_exp_f32 v251, v251
v_exp_f32 v91, v91
v_pk_add_f32 v[108:109], v[84:85], v[86:87]
v_pk_add_f32 v[110:111], v[244:245], v[246:247]
v_pk_add_f32 v[108:109], v[108:109], v[88:89]
v_pk_add_f32 v[110:111], v[110:111], v[248:249]
v_pk_add_f32 v[108:109], v[108:109], v[90:91]
v_pk_add_f32 v[110:111], v[110:111], v[250:251]
v_add_f32 v103, v108, v109
v_add_f32 v107, v110, v111
s_cmp_eq_u32 s51, 1
s_cbranch_scc1 chk_86
s_waitcnt vmcnt(0)
v_max_u32 v4, v212, v213
v_max3_u32 v4, v4, v214, v215
v_max3_u32 v4, v4, v216, v217
v_max3_u32 v4, v4, v218, v219
v_cmp_eq_u32 vcc, -1, v4
s_cbranch_vccz red_87
buffer_load_dwordx4 v[212:215], v18, s[32:35], s55 offen offset:0 sc1
buffer_load_dwordx4 v[216:219], v18, s[32:35], s55 offen offset:1024 sc1
s_branch chk_86
red_87:
v_mfma_f32_16x16x32_bf16 v[132:135], v[44:47], v[212:215], 0
v_mfma_f32_16x16x32_bf16 v[132:135], v[44:47], v[216:219], v[132:135]
s_mov_b32 s51, 1
s_nop 6
v_add_f32_dpp v132, v132, v132 row_ror:8 row_mask:0xf bank_mask:0xf
v_add_f32_dpp v133, v133, v133 row_ror:8 row_mask:0xf bank_mask:0xf
v_add_f32_dpp v134, v134, v134 row_ror:8 row_mask:0xf bank_mask:0xf
v_add_f32_dpp v135, v135, v135 row_ror:8 row_mask:0xf bank_mask:0xf
v_cvt_pk_bf16_f32 v132, v132, v133
v_cvt_pk_bf16_f32 v133, v134, v135
s_mov_b64 exec, 0x00ff00ff
buffer_store_dwordx2 v[132:133], v59, s[32:35], s79 offen sc1
s_mov_b64 exec, -1
buffer_load_dwordx4 v[204:207], v58, s[32:35], s56 offen sc1
buffer_load_dwordx4 v[208:211], v58, s[32:35], s57 offen sc1
chk_86:
.p2align 3
v_permlane32_swap_b32 v100, v101
v_permlane32_swap_b32 v102, v103
v_permlane32_swap_b32 v104, v105
v_permlane32_swap_b32 v106, v107
v_add_f32 v100, v100, v101
v_add_f32 v102, v102, v103
v_add_f32 v104, v104, v105
v_add_f32 v106, v106, v107
v_permlane16_swap_b32 v100, v102
s_nop 0
v_permlane16_swap_b32 v104, v106
v_add_f32 v100, v100, v102
v_add_f32 v104, v104, v106
v_rcp_f32 v100, v100
v_rcp_f32 v104, v104
v_mov_b32 v102, v100
v_mov_b32 v106, v104
s_nop 0
v_permlane16_swap_b32 v100, v102
v_permlane16_swap_b32 v104, v106
v_mov_b32 v101, v100
v_mov_b32 v103, v102
v_mov_b32 v105, v104
v_mov_b32 v107, v106
v_permlane32_swap_b32 v100, v101
v_permlane32_swap_b32 v102, v103
v_permlane32_swap_b32 v104, v105
v_permlane32_swap_b32 v106, v107
v_pk_mul_f32 v[60:61], v[60:61], v[100:101] op_sel:[0,0] op_sel_hi:[1,0]
v_pk_mul_f32 v[220:221], v[220:221], v[104:105] op_sel:[0,0] op_sel_hi:[1,0]
v_pk_mul_f32 v[68:69], v[68:69], v[100:101] op_sel:[0,1] op_sel_hi:[1,1]
v_pk_mul_f32 v[228:229], v[228:229], v[104:105] op_sel:[0,1] op_sel_hi:[1,1]
v_pk_mul_f32 v[76:77], v[76:77], v[102:103] op_sel:[0,0] op_sel_hi:[1,0]
v_pk_mul_f32 v[236:237], v[236:237], v[106:107] op_sel:[0,0] op_sel_hi:[1,0]
v_pk_mul_f32 v[84:85], v[84:85], v[102:103] op_sel:[0,1] op_sel_hi:[1,1]
v_pk_mul_f32 v[244:245], v[244:245], v[106:107] op_sel:[0,1] op_sel_hi:[1,1]
v_pk_mul_f32 v[62:63], v[62:63], v[100:101] op_sel:[0,0] op_sel_hi:[1,0]
v_pk_mul_f32 v[222:223], v[222:223], v[104:105] op_sel:[0,0] op_sel_hi:[1,0]
v_cvt_pk_bf16_f32 v60, v60, v61
v_cvt_pk_bf16_f32 v220, v220, v221
v_pk_mul_f32 v[70:71], v[70:71], v[100:101] op_sel:[0,1] op_sel_hi:[1,1]
v_pk_mul_f32 v[230:231], v[230:231], v[104:105] op_sel:[0,1] op_sel_hi:[1,1]
v_cvt_pk_bf16_f32 v68, v68, v69
v_cvt_pk_bf16_f32 v228, v228, v229
v_pk_mul_f32 v[78:79], v[78:79], v[102:103] op_sel:[0,0] op_sel_hi:[1,0]
v_pk_mul_f32 v[238:239], v[238:239], v[106:107] op_sel:[0,0] op_sel_hi:[1,0]
v_cvt_pk_bf16_f32 v76, v76, v77
v_cvt_pk_bf16_f32 v236, v236, v237
v_pk_mul_f32 v[86:87], v[86:87], v[102:103] op_sel:[0,1] op_sel_hi:[1,1]
v_pk_mul_f32 v[246:247], v[246:247], v[106:107] op_sel:[0,1] op_sel_hi:[1,1]
v_cvt_pk_bf16_f32 v84, v84, v85
v_cvt_pk_bf16_f32 v244, v244, v245
v_pk_mul_f32 v[64:65], v[64:65], v[100:101] op_sel:[0,0] op_sel_hi:[1,0]
v_pk_mul_f32 v[66:67], v[66:67], v[100:101] op_sel:[0,0] op_sel_hi:[1,0]
v_pk_mul_f32 v[224:225], v[224:225], v[104:105] op_sel:[0,0] op_sel_hi:[1,0]
v_pk_mul_f32 v[226:227], v[226:227], v[104:105] op_sel:[0,0] op_sel_hi:[1,0]
v_cvt_pk_bf16_f32 v61, v62, v63
v_cvt_pk_bf16_f32 v221, v222, v223
v_pk_mul_f32 v[72:73], v[72:73], v[100:101] op_sel:[0,1] op_sel_hi:[1,1]
v_pk_mul_f32 v[74:75], v[74:75], v[100:101] op_sel:[0,1] op_sel_hi:[1,1]
v_pk_mul_f32 v[232:233], v[232:233], v[104:105] op_sel:[0,1] op_sel_hi:[1,1]
v_pk_mul_f32 v[234:235], v[234:235], v[104:105] op_sel:[0,1] op_sel_hi:[1,1]
v_cvt_pk_bf16_f32 v69, v70, v71
v_cvt_pk_bf16_f32 v229, v230, v231
v_pk_mul_f32 v[80:81], v[80:81], v[102:103] op_sel:[0,0] op_sel_hi:[1,0]
v_pk_mul_f32 v[82:83], v[82:83], v[102:103] op_sel:[0,0] op_sel_hi:[1,0]
v_pk_mul_f32 v[240:241], v[240:241], v[106:107] op_sel:[0,0] op_sel_hi:[1,0]
v_pk_mul_f32 v[242:243], v[242:243], v[106:107] op_sel:[0,0] op_sel_hi:[1,0]
v_cvt_pk_bf16_f32 v77, v78, v79
v_cvt_pk_bf16_f32 v237, v238, v239
v_pk_mul_f32 v[88:89], v[88:89], v[102:103] op_sel:[0,1] op_sel_hi:[1,1]
v_pk_mul_f32 v[90:91], v[90:91], v[102:103] op_sel:[0,1] op_sel_hi:[1,1]
v_pk_mul_f32 v[248:249], v[248:249], v[106:107] op_sel:[0,1] op_sel_hi:[1,1]
v_pk_mul_f32 v[250:251], v[250:251], v[106:107] op_sel:[0,1] op_sel_hi:[1,1]
v_cvt_pk_bf16_f32 v85, v86, v87
v_cvt_pk_bf16_f32 v245, v246, v247
v_cvt_pk_bf16_f32 v62, v64, v65
v_cvt_pk_bf16_f32 v63, v66, v67
v_cvt_pk_bf16_f32 v222, v224, v225
v_cvt_pk_bf16_f32 v223, v226, v227
v_cvt_pk_bf16_f32 v70, v72, v73
v_cvt_pk_bf16_f32 v71, v74, v75
v_cvt_pk_bf16_f32 v230, v232, v233
v_cvt_pk_bf16_f32 v231, v234, v235
v_cvt_pk_bf16_f32 v78, v80, v81
v_cvt_pk_bf16_f32 v79, v82, v83
v_cvt_pk_bf16_f32 v238, v240, v241
v_cvt_pk_bf16_f32 v239, v242, v243
v_cvt_pk_bf16_f32 v86, v88, v89
v_cvt_pk_bf16_f32 v87, v90, v91
v_cvt_pk_bf16_f32 v246, v248, v249
v_cvt_pk_bf16_f32 v247, v250, v251
s_cmp_lg_u32 s51, 0
s_cbranch_scc1 else_88
s_mov_b32 s63, 0
sent_90:
s_waitcnt vmcnt(0)
v_max_u32 v4, v212, v213
v_max3_u32 v4, v4, v214, v215
v_max3_u32 v4, v4, v216, v217
v_max3_u32 v4, v4, v218, v219
v_cmp_eq_u32 vcc, -1, v4
s_cbranch_vccz sentd_91
buffer_load_dwordx4 v[212:215], v18, s[32:35], s55 offen offset:0 sc1
buffer_load_dwordx4 v[216:219], v18, s[32:35], s55 offen offset:1024 sc1
s_add_u32 s63, s63, 1
s_cmp_lt_u32 s63, 0x80000
s_cbranch_scc1 sent_90
s_waitcnt vmcnt(0)
sentd_91:
v_mfma_f32_16x16x32_bf16 v[132:135], v[44:47], v[212:215], 0
v_mfma_f32_16x16x32_bf16 v[132:135], v[44:47], v[216:219], v[132:135]
s_mov_b32 s51, 1
s_nop 6
v_add_f32_dpp v132, v132, v132 row_ror:8 row_mask:0xf bank_mask:0xf
v_add_f32_dpp v133, v133, v133 row_ror:8 row_mask:0xf bank_mask:0xf
v_add_f32_dpp v134, v134, v134 row_ror:8 row_mask:0xf bank_mask:0xf
v_add_f32_dpp v135, v135, v135 row_ror:8 row_mask:0xf bank_mask:0xf
v_cvt_pk_bf16_f32 v132, v132, v133
v_cvt_pk_bf16_f32 v133, v134, v135
s_mov_b64 exec, 0x00ff00ff
buffer_store_dwordx2 v[132:133], v59, s[32:35], s79 offen sc1
s_mov_b64 exec, -1
buffer_load_dwordx4 v[204:207], v58, s[32:35], s56 offen sc1
buffer_load_dwordx4 v[208:211], v58, s[32:35], s57 offen sc1
else_88:
s_mov_b32 s63, 0
sent_92:
s_waitcnt vmcnt(0)
v_max_u32 v4, v204, v205
v_max3_u32 v4, v4, v206, v207
v_max3_u32 v4, v4, v208, v209
v_max3_u32 v4, v4, v210, v211
v_cmp_eq_u32 vcc, -1, v4
s_cbranch_vccz sentd_93
buffer_load_dwordx4 v[204:207], v58, s[32:35], s56 offen sc1
buffer_load_dwordx4 v[208:211], v58, s[32:35], s57 offen sc1
s_add_u32 s63, s63, 1
s_cmp_lt_u32 s63, 0x80000
s_cbranch_scc1 sent_92
s_waitcnt vmcnt(0)
sentd_93:
v_mfma_f32_16x16x32_bf16 v[112:115], v[204:207], v[60:63], 0
v_mfma_f32_16x16x32_bf16 v[116:119], v[204:207], v[68:71], 0
v_mfma_f32_16x16x32_bf16 v[120:123], v[204:207], v[76:79], 0
v_mfma_f32_16x16x32_bf16 v[124:127], v[204:207], v[84:87], 0
v_mfma_f32_16x16x32_bf16 v[112:115], v[208:211], v[220:223], v[112:115]
v_mfma_f32_16x16x32_bf16 v[116:119], v[208:211], v[228:231], v[116:119]
v_mfma_f32_16x16x32_bf16 v[120:123], v[208:211], v[236:239], v[120:123]
v_mfma_f32_16x16x32_bf16 v[124:127], v[208:211], v[244:247], v[124:127]
s_nop 4
v_add_f32 v100, v112, v113
v_add_f32 v114, v114, v115
v_add_f32 v100, v100, v114
v_add_f32 v101, v116, v117
v_add_f32 v118, v118, v119
v_add_f32 v101, v101, v118
v_add_f32 v102, v120, v121
v_add_f32 v122, v122, v123
v_add_f32 v102, v102, v122
v_add_f32 v103, v124, v125
v_add_f32 v126, v126, v127
v_add_f32 v103, v103, v126
s_nop 1
v_permlane32_swap_b32 v100, v101
v_permlane32_swap_b32 v102, v103
v_add_f32 v100, v100, v101
v_add_f32 v102, v102, v103
s_nop 1
v_permlane16_swap_b32 v100, v102
s_nop 0
v_add_f32 v100, v100, v102
v_add_f32 v100, 0x358637bd, v100
v_rcp_f32 v100, v100
s_nop 0
v_mov_b32 v102, v100
s_nop 1
v_permlane16_swap_b32 v100, v102
s_nop 0
v_mov_b32 v101, v100
v_mov_b32 v103, v102
s_nop 0
v_permlane32_swap_b32 v100, v101
v_permlane32_swap_b32 v102, v103
buffer_load_dwordx4 v[188:191], v18, s[32:35], s58 offen offset:0 sc1
buffer_load_dwordx4 v[192:195], v18, s[32:35], s58 offen offset:1024 sc1
buffer_load_dwordx4 v[196:199], v18, s[32:35], s59 offen offset:0 sc1
buffer_load_dwordx4 v[200:203], v18, s[32:35], s59 offen offset:1024 sc1
s_mov_b32 s63, 0
sent_94:
s_waitcnt vmcnt(0)
v_max_u32 v4, v188, v189
v_max3_u32 v4, v4, v190, v191
v_max3_u32 v4, v4, v192, v193
v_max3_u32 v4, v4, v194, v195
v_max3_u32 v4, v4, v196, v197
v_max3_u32 v4, v4, v198, v199
v_max3_u32 v4, v4, v200, v201
v_max3_u32 v4, v4, v202, v203
v_cmp_eq_u32 vcc, -1, v4
s_cbranch_vccz sentd_95
buffer_load_dwordx4 v[188:191], v18, s[32:35], s58 offen offset:0 sc1
buffer_load_dwordx4 v[192:195], v18, s[32:35], s58 offen offset:1024 sc1
buffer_load_dwordx4 v[196:199], v18, s[32:35], s59 offen offset:0 sc1
buffer_load_dwordx4 v[200:203], v18, s[32:35], s59 offen offset:1024 sc1
s_add_u32 s63, s63, 1
s_cmp_lt_u32 s63, 0x80000
s_cbranch_scc1 sent_94
s_waitcnt vmcnt(0)
sentd_95:
s_cmp_eq_u32 s46, 0
s_cbranch_scc1 slow_96
.p2align 3
v_mfma_f32_16x16x32_bf16 v[156:159], v[188:191], v[60:63], 0
v_mfma_f32_16x16x32_bf16 v[164:167], v[188:191], v[68:71], 0
v_mfma_f32_16x16x32_bf16 v[160:163], v[192:195], v[60:63], 0
v_mfma_f32_16x16x32_bf16 v[172:175], v[188:191], v[76:79], 0
v_mfma_f32_16x16x32_bf16 v[168:171], v[192:195], v[68:71], 0
v_mfma_f32_16x16x32_bf16 v[180:183], v[188:191], v[84:87], 0
v_mfma_f32_16x16x32_bf16 v[156:159], v[196:199], v[220:223], v[156:159]
v_mfma_f32_16x16x32_bf16 v[176:179], v[192:195], v[76:79], 0
v_mfma_f32_16x16x32_bf16 v[164:167], v[196:199], v[228:231], v[164:167]
v_mfma_f32_16x16x32_bf16 v[184:187], v[192:195], v[84:87], 0
v_mfma_f32_16x16x32_bf16 v[160:163], v[200:203], v[220:223], v[160:163]
v_mfma_f32_16x16x32_bf16 v[172:175], v[196:199], v[236:239], v[172:175]
v_mfma_f32_16x16x32_bf16 v[168:171], v[200:203], v[228:231], v[168:171]
v_mfma_f32_16x16x32_bf16 v[180:183], v[196:199], v[244:247], v[180:183]
v_mfma_f32_16x16x32_bf16 v[176:179], v[200:203], v[236:239], v[176:179]
v_mfma_f32_16x16x32_bf16 v[184:187], v[200:203], v[244:247], v[184:187]
v_pk_mul_f32 v[156:157], v[156:157], v[100:101] op_sel:[0,0] op_sel_hi:[1,0]
v_pk_mul_f32 v[158:159], v[158:159], v[100:101] op_sel:[0,0] op_sel_hi:[1,0]
v_cvt_pk_bf16_f32 v156, v156, v157
v_pk_mul_f32 v[164:165], v[164:165], v[100:101] op_sel:[0,1] op_sel_hi:[1,1]
v_pk_mul_f32 v[160:161], v[160:161], v[100:101] op_sel:[0,0] op_sel_hi:[1,0]
v_pk_mul_f32 v[162:163], v[162:163], v[100:101] op_sel:[0,0] op_sel_hi:[1,0]
v_cvt_pk_bf16_f32 v157, v158, v159
v_pk_mul_f32 v[166:167], v[166:167], v[100:101] op_sel:[0,1] op_sel_hi:[1,1]
v_cvt_pk_bf16_f32 v164, v164, v165
v_pk_mul_f32 v[172:173], v[172:173], v[102:103] op_sel:[0,0] op_sel_hi:[1,0]
v_cvt_pk_bf16_f32 v158, v160, v161
v_cvt_pk_bf16_f32 v159, v162, v163
v_pk_mul_f32 v[168:169], v[168:169], v[100:101] op_sel:[0,1] op_sel_hi:[1,1]
v_pk_mul_f32 v[170:171], v[170:171], v[100:101] op_sel:[0,1] op_sel_hi:[1,1]
v_cvt_pk_bf16_f32 v165, v166, v167
v_pk_mul_f32 v[174:175], v[174:175], v[102:103] op_sel:[0,0] op_sel_hi:[1,0]
v_cvt_pk_bf16_f32 v172, v172, v173
v_pk_mul_f32 v[180:181], v[180:181], v[102:103] op_sel:[0,1] op_sel_hi:[1,1]
buffer_store_dwordx4 v[156:159], v18, s[32:35], s80 offen
v_cvt_pk_bf16_f32 v166, v168, v169
v_cvt_pk_bf16_f32 v167, v170, v171
v_pk_mul_f32 v[176:177], v[176:177], v[102:103] op_sel:[0,0] op_sel_hi:[1,0]
v_pk_mul_f32 v[178:179], v[178:179], v[102:103] op_sel:[0,0] op_sel_hi:[1,0]
v_cvt_pk_bf16_f32 v173, v174, v175
v_pk_mul_f32 v[182:183], v[182:183], v[102:103] op_sel:[0,1] op_sel_hi:[1,1]
v_cvt_pk_bf16_f32 v180, v180, v181
buffer_store_dwordx4 v[164:167], v18, s[32:35], s81 offen
v_cvt_pk_bf16_f32 v174, v176, v177
v_cvt_pk_bf16_f32 v175, v178, v179
v_pk_mul_f32 v[184:185], v[184:185], v[102:103] op_sel:[0,1] op_sel_hi:[1,1]
v_pk_mul_f32 v[186:187], v[186:187], v[102:103] op_sel:[0,1] op_sel_hi:[1,1]
v_cvt_pk_bf16_f32 v181, v182, v183
buffer_store_dwordx4 v[172:175], v18, s[32:35], s82 offen
v_cvt_pk_bf16_f32 v182, v184, v185
v_cvt_pk_bf16_f32 v183, v186, v187
buffer_store_dwordx4 v[180:183], v18, s[32:35], s83 offen
back_97:
s_barrier
v_and_b32 v36, 31, v0
v_lshlrev_b32 v36, 2, v36
s_lshl_b32 s62, s45, 2
v_mov_b32 v4, s62
v_mov_b32 v5, 2
s_mov_b64 exec, 1
s_waitcnt vmcnt(0)
s_cmp_eq_u32 s46, 0
s_cbranch_scc1 slow_98
buffer_store_dword v5, v4, s[32:35], s84 offen
back_99:
s_mov_b64 exec, -1
v_lshrrev_b32 v4, 2, v2
v_and_b32 v5, 3, v0
v_lshl_add_u32 v6, v3, 3, v4
v_lshlrev_b32 v6, 7, v6
v_lshl_add_u32 v6, v5, 3, v6
v_lshrrev_b32 v7, 1, v4
v_and_b32 v8, 1, v3
v_lshl_add_u32 v7, v8, 1, v7
v_lshl_add_u32 v10, v7, 5, v6
v_xor_b32 v11, 32, v10
v_xor_b32 v12, 64, v10
v_xor_b32 v13, 96, v10
v_add_u32 v14, 0x10000, v10
v_add_u32 v15, 0x10000, v11
v_add_u32 v16, 0x10000, v12
v_add_u32 v17, 0x10000, v13
ds_read_b64_tr_b16 v[220:221], v10 offset:0
ds_read_b64_tr_b16 v[222:223], v10 offset:512
ds_read_b64_tr_b16 v[224:225], v11 offset:0
ds_read_b64_tr_b16 v[226:227], v11 offset:512
ds_read_b64_tr_b16 v[228:229], v12 offset:0
ds_read_b64_tr_b16 v[230:231], v12 offset:512
ds_read_b64_tr_b16 v[232:233], v13 offset:0
ds_read_b64_tr_b16 v[234:235], v13 offset:512
ds_read_b64_tr_b16 v[236:237], v10 offset:4096
ds_read_b64_tr_b16 v[238:239], v10 offset:4608
ds_read_b64_tr_b16 v[240:241], v11 offset:4096
ds_read_b64_tr_b16 v[242:243], v11 offset:4608
ds_read_b64_tr_b16 v[244:245], v12 offset:4096
ds_read_b64_tr_b16 v[246:247], v12 offset:4608
ds_read_b64_tr_b16 v[248:249], v13 offset:4096
ds_read_b64_tr_b16 v[250:251], v13 offset:4608
s_lshl_b32 s48, s41, 3
s_lshl_b32 s49, s40, 1
s_add_u32 s48, s48, s49
s_lshl_b32 s48, s48, 15
s_add_u32 s48, s48, 4194304
v_add_u32 v38, s48, v18
v_add_u32 v39, 32768, v38
s_lshl_b32 s57, s75, 11
s_add_u32 s87, s87, 262144
v_lshlrev_b32 v60, 16, v20
v_and_b32 v61, 0xffff0000, v20
v_lshlrev_b32 v62, 16, v21
v_and_b32 v63, 0xffff0000, v21
v_lshlrev_b32 v64, 16, v22
v_and_b32 v65, 0xffff0000, v22
v_lshlrev_b32 v66, 16, v23
v_and_b32 v67, 0xffff0000, v23
v_lshlrev_b32 v68, 16, v24
v_and_b32 v69, 0xffff0000, v24
v_lshlrev_b32 v70, 16, v25
v_and_b32 v71, 0xffff0000, v25
v_lshlrev_b32 v72, 16, v26
v_and_b32 v73, 0xffff0000, v26
v_lshlrev_b32 v74, 16, v27
v_and_b32 v75, 0xffff0000, v27
v_lshlrev_b32 v76, 16, v28
v_and_b32 v77, 0xffff0000, v28
v_lshlrev_b32 v78, 16, v29
v_and_b32 v79, 0xffff0000, v29
v_lshlrev_b32 v80, 16, v30
v_and_b32 v81, 0xffff0000, v30
v_lshlrev_b32 v82, 16, v31
v_and_b32 v83, 0xffff0000, v31
v_lshlrev_b32 v84, 16, v32
v_and_b32 v85, 0xffff0000, v32
v_lshlrev_b32 v86, 16, v33
v_and_b32 v87, 0xffff0000, v33
v_lshlrev_b32 v88, 16, v34
v_and_b32 v89, 0xffff0000, v34
v_lshlrev_b32 v90, 16, v35
v_and_b32 v91, 0xffff0000, v35
v_mov_b32 v6, 0
v_mov_b32 v7, 0
v_mov_b32 v8, 0
v_mov_b32 v9, 0
s_lshl_b32 s62, s42, 2
v_mov_b32 v4, s62
v_mov_b32 v5, 2
buffer_load_dword v37, v36, s[32:35], s84 offen sc1
s_mov_b32 s63, 0
s_waitcnt vmcnt(0)
poll_100:
v_cmp_gt_u32 vcc, 2, v37
s_cbranch_vccz polled_101
buffer_load_dword v37, v36, s[32:35], s84 offen sc1
s_add_u32 s63, s63, 1
s_cmp_lt_u32 s63, 0x80000
s_waitcnt vmcnt(0)
s_cbranch_scc1 poll_100
polled_101:
s_call_b64 s[94:95], R_oloop
s_cmp_eq_u32 s46, 0
s_cbranch_scc1 slow_102
s_nop 0
v_cvt_pk_bf16_f32 v20, v60, v61
v_cvt_pk_bf16_f32 v21, v62, v63
v_cvt_pk_bf16_f32 v22, v64, v65
v_cvt_pk_bf16_f32 v23, v66, v67
buffer_store_dwordx4 v[20:23], v18, s[32:35], s85 offen offset:0
v_cvt_pk_bf16_f32 v24, v68, v69
v_cvt_pk_bf16_f32 v25, v70, v71
v_cvt_pk_bf16_f32 v26, v72, v73
v_cvt_pk_bf16_f32 v27, v74, v75
buffer_store_dwordx4 v[24:27], v18, s[32:35], s85 offen offset:1024
v_cvt_pk_bf16_f32 v28, v76, v77
v_cvt_pk_bf16_f32 v29, v78, v79
v_cvt_pk_bf16_f32 v30, v80, v81
v_cvt_pk_bf16_f32 v31, v82, v83
buffer_store_dwordx4 v[28:31], v18, s[32:35], s86 offen offset:0
v_cvt_pk_bf16_f32 v32, v84, v85
v_cvt_pk_bf16_f32 v33, v86, v87
v_cvt_pk_bf16_f32 v34, v88, v89
v_cvt_pk_bf16_f32 v35, v90, v91
buffer_store_dwordx4 v[32:35], v18, s[32:35], s86 offen offset:1024
s_barrier
v_dot2c_f32_bf16 v6, v20, v48
v_dot2c_f32_bf16 v8, v20, v20
v_dot2c_f32_bf16 v7, v28, v48
v_dot2c_f32_bf16 v9, v28, v28
v_dot2c_f32_bf16 v6, v21, v48
v_dot2c_f32_bf16 v8, v21, v21
v_dot2c_f32_bf16 v7, v29, v48
v_dot2c_f32_bf16 v9, v29, v29
v_dot2c_f32_bf16 v6, v22, v48
v_dot2c_f32_bf16 v8, v22, v22
v_dot2c_f32_bf16 v7, v30, v48
v_dot2c_f32_bf16 v9, v30, v30
v_dot2c_f32_bf16 v6, v23, v48
v_dot2c_f32_bf16 v8, v23, v23
v_dot2c_f32_bf16 v7, v31, v48
v_dot2c_f32_bf16 v9, v31, v31
v_dot2c_f32_bf16 v6, v24, v48
v_dot2c_f32_bf16 v8, v24, v24
v_dot2c_f32_bf16 v7, v32, v48
v_dot2c_f32_bf16 v9, v32, v32
v_dot2c_f32_bf16 v6, v25, v48
v_dot2c_f32_bf16 v8, v25, v25
v_dot2c_f32_bf16 v7, v33, v48
v_dot2c_f32_bf16 v9, v33, v33
v_dot2c_f32_bf16 v6, v26, v48
v_dot2c_f32_bf16 v8, v26, v26
v_dot2c_f32_bf16 v7, v34, v48
v_dot2c_f32_bf16 v9, v34, v34
v_dot2c_f32_bf16 v6, v27, v48
v_dot2c_f32_bf16 v8, v27, v27
v_dot2c_f32_bf16 v7, v35, v48
v_dot2c_f32_bf16 v9, v35, v35
s_mov_b64 exec, 1
s_waitcnt vmcnt(0)
buffer_store_dword v5, v4, s[32:35], s88 offen
s_mov_b64 exec, -1
s_nop 1
v_permlane32_swap_b32 v6, v7
v_permlane32_swap_b32 v8, v9
v_add_f32 v6, v6, v7
v_add_f32 v8, v8, v9
s_nop 1
v_permlane16_swap_b32 v6, v8
s_nop 0
v_add_f32 v6, v6, v8
buffer_store_dword v6, v1, s[32:35], s87 offen
back_103:
s_lshl_b32 s49, s44, 13
v_add_u32 v10, s49, v18
v_add_u32 v11, 1024, v10
s_lshl_b32 s48, s43, 1
v_lshrrev_b32 v4, 2, v2
v_and_b32 v5, 3, v0
v_lshl_add_u32 v6, v3, 3, v4
v_lshlrev_b32 v6, 7, v6
v_lshl_add_u32 v6, v5, 3, v6
v_lshrrev_b32 v7, 1, v4
v_and_b32 v8, 1, v3
v_lshl_add_u32 v7, v8, 1, v7
v_xor_b32 v7, s48, v7
v_lshl_add_u32 v12, v7, 5, v6
v_add_u32 v12, 16384, v12
v_xor_b32 v13, 32, v12
v_mov_b32 v14, v10
v_mov_b32 v15, v11
v_add_u32 v16, 122880, v12
v_add_u32 v17, 122880, v13
v_mov_b32 v156, 0
v_mov_b32 v157, 0
v_mov_b32 v158, 0
v_mov_b32 v159, 0
v_mov_b32 v160, 0
v_mov_b32 v161, 0
v_mov_b32 v162, 0
v_mov_b32 v163, 0
v_mov_b32 v164, 0
v_mov_b32 v165, 0
v_mov_b32 v166, 0
v_mov_b32 v167, 0
v_mov_b32 v168, 0
v_mov_b32 v169, 0
v_mov_b32 v170, 0
v_mov_b32 v171, 0
v_mov_b32 v172, 0
v_mov_b32 v173, 0
v_mov_b32 v174, 0
v_mov_b32 v175, 0
v_mov_b32 v176, 0
v_mov_b32 v177, 0
v_mov_b32 v178, 0
v_mov_b32 v179, 0
v_mov_b32 v180, 0
v_mov_b32 v181, 0
v_mov_b32 v182, 0
v_mov_b32 v183, 0
v_mov_b32 v184, 0
v_mov_b32 v185, 0
v_mov_b32 v186, 0
v_mov_b32 v187, 0
v_mov_b32 v188, 0
v_mov_b32 v189, 0
v_mov_b32 v190, 0
v_mov_b32 v191, 0
v_mov_b32 v192, 0
v_mov_b32 v193, 0
v_mov_b32 v194, 0
v_mov_b32 v195, 0
v_mov_b32 v196, 0
v_mov_b32 v197, 0
v_mov_b32 v198, 0
v_mov_b32 v199, 0
v_mov_b32 v200, 0
v_mov_b32 v201, 0
v_mov_b32 v202, 0
v_mov_b32 v203, 0
v_mov_b32 v204, 0
v_mov_b32 v205, 0
v_mov_b32 v206, 0
v_mov_b32 v207, 0
v_mov_b32 v208, 0
v_mov_b32 v209, 0
v_mov_b32 v210, 0
v_mov_b32 v211, 0
v_mov_b32 v212, 0
v_mov_b32 v213, 0
v_mov_b32 v214, 0
v_mov_b32 v215, 0
v_mov_b32 v216, 0
v_mov_b32 v217, 0
v_mov_b32 v218, 0
v_mov_b32 v219, 0
v_mov_b32 v220, 0
v_mov_b32 v221, 0
v_mov_b32 v222, 0
v_mov_b32 v223, 0
v_mov_b32 v224, 0
v_mov_b32 v225, 0
v_mov_b32 v226, 0
v_mov_b32 v227, 0
v_mov_b32 v228, 0
v_mov_b32 v229, 0
v_mov_b32 v230, 0
v_mov_b32 v231, 0
v_mov_b32 v232, 0
v_mov_b32 v233, 0
v_mov_b32 v234, 0
v_mov_b32 v235, 0
v_mov_b32 v236, 0
v_mov_b32 v237, 0
v_mov_b32 v238, 0
v_mov_b32 v239, 0
v_mov_b32 v240, 0
v_mov_b32 v241, 0
v_mov_b32 v242, 0
v_mov_b32 v243, 0
v_mov_b32 v244, 0
v_mov_b32 v245, 0
v_mov_b32 v246, 0
v_mov_b32 v247, 0
v_mov_b32 v248, 0
v_mov_b32 v249, 0
v_mov_b32 v250, 0
v_mov_b32 v251, 0
s_mov_b32 s48, 0xf149f2ca
v_mov_b32 v9, s48
v_lshlrev_b32 v4, 2, v3
v_sub_u32 v4, v2, v4
v_subrev_u32 v5, 0, v4
v_and_b32 v6, 0x80000001, v5
v_cmp_eq_u32 vcc, 0, v6
v_add_u32 v5, 1, v5
v_and_b32 v6, 0x80000001, v5
v_cndmask_b32 v40, v9, 0, vcc
v_cmp_eq_u32 vcc, 0x80000001, v6
s_nop 1
v_cndmask_b32 v36, v9, 0, vcc
v_subrev_u32 v5, 1, v4
v_and_b32 v6, 0x80000001, v5
v_cmp_eq_u32 vcc, 0, v6
v_add_u32 v5, 1, v5
v_and_b32 v6, 0x80000001, v5
v_cndmask_b32 v41, v9, 0, vcc
v_cmp_eq_u32 vcc, 0x80000001, v6
s_nop 1
v_cndmask_b32 v37, v9, 0, vcc
v_subrev_u32 v5, 2, v4
v_and_b32 v6, 0x80000001, v5
v_cmp_eq_u32 vcc, 0, v6
v_add_u32 v5, 1, v5
v_and_b32 v6, 0x80000001, v5
v_cndmask_b32 v42, v9, 0, vcc
v_cmp_eq_u32 vcc, 0x80000001, v6
s_nop 1
v_cndmask_b32 v38, v9, 0, vcc
v_subrev_u32 v5, 3, v4
v_and_b32 v6, 0x80000001, v5
v_cmp_eq_u32 vcc, 0, v6
v_add_u32 v5, 1, v5
v_and_b32 v6, 0x80000001, v5
v_cndmask_b32 v43, v9, 0, vcc
v_cmp_eq_u32 vcc, 0x80000001, v6
s_nop 1
v_cndmask_b32 v39, v9, 0, vcc
s_or_b32 s48, s41, s44
s_cmp_eq_u32 s48, 0
s_cselect_b64 vcc, -1, 0
v_cndmask_b32 v44, v36, v9, vcc
v_cndmask_b32 v45, v37, v9, vcc
v_cndmask_b32 v46, v38, v9, vcc
v_cndmask_b32 v47, v39, v9, vcc
v_and_b32 v4, 1, v2
v_lshlrev_b32 v4, 4, v4
v_mov_b32 v5, 0xffff
v_lshlrev_b32 v52, v4, v5
s_lshl_b32 s48, s43, 11
s_add_u32 s48, s48, 135168
v_add_u32 v53, s48, v18
v_lshl_add_u32 v55, v0, 3, s48
s_add_u32 s48, s41, s44
s_sub_u32 s48, s48, 1
s_lshl_b32 s49, s48, 1
s_add_u32 s49, s49, s43
s_lshl_b32 s49, s49, 11
s_mul_i32 s50, s42, 65536
s_add_u32 s49, s49, s50
s_add_u32 s49, s49, 8388608
s_cmp_lt_i32 s48, 0
s_cselect_b32 s49, 0xf0000000, s49
v_add_u32 v58, s49, v18
v_lshl_add_u32 v59, v0, 3, s49
s_lshl_b32 s48, s43, 2
s_add_u32 s48, s48, 134672
v_mov_b32 v19, s48
s_lshl_b32 s48, s43, 7
s_add_u32 s48, s48, 133120
v_lshl_add_u32 v7, v3, 4, s48
v_lshl_add_u32 v54, v2, 2, s48
s_lshl_b32 s49, s44, 6
v_add_u32 v8, s49, v2
v_lshlrev_b32 v8, 3, v8
v_add_u32 v8, 131072, v8
v_lshl_add_u32 v9, v3, 2, s49
v_lshlrev_b32 v9, 2, v9
v_add_u32 v9, 132096, v9
s_mov_b32 s64, 0
s_mov_b32 s65, 0
s_mov_b32 s66, 0x3e8293ee
s_mov_b32 s61, 3
ds_read_b64_tr_b16 v[84:85], v16 offset:8192
ds_read_b64_tr_b16 v[86:87], v16 offset:8704
ds_read_b64_tr_b16 v[88:89], v17 offset:8192
ds_read_b64_tr_b16 v[90:91], v17 offset:8704
ds_read_b64_tr_b16 v[92:93], v16 offset:16384
ds_read_b64_tr_b16 v[94:95], v16 offset:16896
ds_read_b64_tr_b16 v[96:97], v17 offset:16384
ds_read_b64_tr_b16 v[98:99], v17 offset:16896
ds_read_b64_tr_b16 v[76:77], v16 offset:0
ds_read_b64_tr_b16 v[78:79], v16 offset:512
ds_read_b64_tr_b16 v[80:81], v17 offset:0
ds_read_b64_tr_b16 v[82:83], v17 offset:512
s_barrier
ds_read_b128 v[60:63], v14 offset:0
ds_read_b128 v[64:67], v14 offset:2048
ds_read_b128 v[68:71], v14 offset:4096
ds_read_b128 v[72:75], v14 offset:6144
s_waitcnt lgkmcnt(0)
c2_loop:
v_mfma_f32_16x16x32_bf16 v[212:215], v[84:87], v[72:75], v[212:215]
ds_read_b128 v[100:103], v15 offset:0
v_mfma_f32_16x16x32_bf16 v[204:207], v[84:87], v[68:71], v[204:207]
ds_read_b128 v[104:107], v15 offset:2048
v_mfma_f32_16x16x32_bf16 v[196:199], v[84:87], v[64:67], v[196:199]
ds_read_b128 v[108:111], v15 offset:4096
v_mfma_f32_16x16x32_bf16 v[188:191], v[84:87], v[60:63], v[188:191]
ds_read_b128 v[112:115], v15 offset:6144
v_mfma_f32_16x16x32_bf16 v[192:195], v[88:91], v[60:63], v[192:195]
ds_read_b64_tr_b16 v[124:125], v16 offset:12288
v_mfma_f32_16x16x32_bf16 v[200:203], v[88:91], v[64:67], v[200:203]
ds_read_b64_tr_b16 v[126:127], v16 offset:12800
v_mfma_f32_16x16x32_bf16 v[208:211], v[88:91], v[68:71], v[208:211]
ds_read_b64_tr_b16 v[128:129], v17 offset:12288
v_mfma_f32_16x16x32_bf16 v[216:219], v[88:91], v[72:75], v[216:219]
ds_read_b64_tr_b16 v[130:131], v17 offset:12800
v_mfma_f32_16x16x32_bf16 v[244:247], v[72:75], v[92:95], v[244:247]
ds_read_b64_tr_b16 v[132:133], v16 offset:20480
v_mfma_f32_16x16x32_bf16 v[248:251], v[72:75], v[96:99], v[248:251]
ds_read_b64_tr_b16 v[134:135], v16 offset:20992
v_mfma_f32_16x16x32_bf16 v[240:243], v[68:71], v[96:99], v[240:243]
ds_read_b64_tr_b16 v[136:137], v17 offset:20480
v_mfma_f32_16x16x32_bf16 v[236:239], v[68:71], v[92:95], v[236:239]
ds_read_b64_tr_b16 v[138:139], v17 offset:20992
v_mfma_f32_16x16x32_bf16 v[228:231], v[64:67], v[92:95], v[228:231]
ds_read_b64_tr_b16 v[116:117], v16 offset:4096
v_mfma_f32_16x16x32_bf16 v[232:235], v[64:67], v[96:99], v[232:235]
ds_read_b64_tr_b16 v[118:119], v16 offset:4608
v_mfma_f32_16x16x32_bf16 v[224:227], v[60:63], v[96:99], v[224:227]
ds_read_b64_tr_b16 v[120:121], v17 offset:4096
v_mfma_f32_16x16x32_bf16 v[220:223], v[60:63], v[92:95], v[220:223]
ds_read_b64_tr_b16 v[122:123], v17 offset:4608
v_mfma_f32_16x16x32_bf16 v[156:159], v[76:79], v[60:63], v[156:159]
s_add_u32 s65, s65, 40960
s_cmp_eq_u32 s65, 122880
v_mfma_f32_16x16x32_bf16 v[164:167], v[76:79], v[64:67], v[164:167]
s_cselect_b32 s65, 0, s65
s_add_u32 s64, s64, 1
v_mfma_f32_16x16x32_bf16 v[172:175], v[76:79], v[68:71], v[172:175]
v_add_u32 v14, s65, v10
v_add_u32 v15, s65, v11
v_mfma_f32_16x16x32_bf16 v[180:183], v[76:79], v[72:75], v[180:183]
v_add_u32 v16, s65, v12
v_add_u32 v17, s65, v13
v_mfma_f32_16x16x32_bf16 v[184:187], v[80:83], v[72:75], v[184:187]
v_mfma_f32_16x16x32_bf16 v[176:179], v[80:83], v[68:71], v[176:179]
s_cmp_eq_u32 s64, 16
s_cbranch_scc1 c2_last
v_mfma_f32_16x16x32_bf16 v[168:171], v[80:83], v[64:67], v[168:171]
s_waitcnt lgkmcnt(0)
v_mfma_f32_16x16x32_bf16 v[160:163], v[80:83], v[60:63], v[160:163]
s_barrier
v_mfma_f32_16x16x32_bf16 v[212:215], v[124:127], v[112:115], v[212:215]
ds_read_b128 v[60:63], v14 offset:0
v_mfma_f32_16x16x32_bf16 v[204:207], v[124:127], v[108:111], v[204:207]
ds_read_b128 v[64:67], v14 offset:2048
v_mfma_f32_16x16x32_bf16 v[196:199], v[124:127], v[104:107], v[196:199]
ds_read_b128 v[68:71], v14 offset:4096
v_mfma_f32_16x16x32_bf16 v[188:191], v[124:127], v[100:103], v[188:191]
ds_read_b128 v[72:75], v14 offset:6144
v_mfma_f32_16x16x32_bf16 v[192:195], v[128:131], v[100:103], v[192:195]
ds_read_b64_tr_b16 v[84:85], v16 offset:8192
v_mfma_f32_16x16x32_bf16 v[200:203], v[128:131], v[104:107], v[200:203]
ds_read_b64_tr_b16 v[86:87], v16 offset:8704
v_mfma_f32_16x16x32_bf16 v[208:211], v[128:131], v[108:111], v[208:211]
ds_read_b64_tr_b16 v[88:89], v17 offset:8192
v_mfma_f32_16x16x32_bf16 v[216:219], v[128:131], v[112:115], v[216:219]
ds_read_b64_tr_b16 v[90:91], v17 offset:8704
v_mfma_f32_16x16x32_bf16 v[244:247], v[112:115], v[132:135], v[244:247]
ds_read_b64_tr_b16 v[92:93], v16 offset:16384
v_mfma_f32_16x16x32_bf16 v[248:251], v[112:115], v[136:139], v[248:251]
ds_read_b64_tr_b16 v[94:95], v16 offset:16896
v_mfma_f32_16x16x32_bf16 v[240:243], v[108:111], v[136:139], v[240:243]
ds_read_b64_tr_b16 v[96:97], v17 offset:16384
v_mfma_f32_16x16x32_bf16 v[236:239], v[108:111], v[132:135], v[236:239]
ds_read_b64_tr_b16 v[98:99], v17 offset:16896
v_mfma_f32_16x16x32_bf16 v[228:231], v[104:107], v[132:135], v[228:231]
ds_read_b64_tr_b16 v[76:77], v16 offset:0
v_mfma_f32_16x16x32_bf16 v[232:235], v[104:107], v[136:139], v[232:235]
ds_read_b64_tr_b16 v[78:79], v16 offset:512
v_mfma_f32_16x16x32_bf16 v[224:227], v[100:103], v[136:139], v[224:227]
ds_read_b64_tr_b16 v[80:81], v17 offset:0
v_mfma_f32_16x16x32_bf16 v[220:223], v[100:103], v[132:135], v[220:223]
ds_read_b64_tr_b16 v[82:83], v17 offset:512
v_mfma_f32_16x16x32_bf16 v[156:159], v[116:119], v[100:103], v[156:159]
v_mfma_f32_16x16x32_bf16 v[164:167], v[116:119], v[104:107], v[164:167]
v_mfma_f32_16x16x32_bf16 v[172:175], v[116:119], v[108:111], v[172:175]
v_mfma_f32_16x16x32_bf16 v[180:183], v[116:119], v[112:115], v[180:183]
v_mfma_f32_16x16x32_bf16 v[184:187], v[120:123], v[112:115], v[184:187]
v_mfma_f32_16x16x32_bf16 v[176:179], v[120:123], v[108:111], v[176:179]
v_mfma_f32_16x16x32_bf16 v[168:171], v[120:123], v[104:107], v[168:171]
s_waitcnt lgkmcnt(0)
v_mfma_f32_16x16x32_bf16 v[160:163], v[120:123], v[100:103], v[160:163]
s_branch c2_loop
c2_last:
v_mfma_f32_16x16x32_bf16 v[168:171], v[80:83], v[64:67], v[168:171]
s_waitcnt lgkmcnt(0)
v_mfma_f32_16x16x32_bf16 v[160:163], v[80:83], v[60:63], v[160:163]
v_mfma_f32_16x16x32_bf16 v[212:215], v[124:127], v[112:115], v[212:215]
ds_read_b128 v[140:143], v7 offset:0
v_mfma_f32_16x16x32_bf16 v[204:207], v[124:127], v[108:111], v[204:207]
ds_read_b128 v[144:147], v7 offset:64
v_mfma_f32_16x16x32_bf16 v[196:199], v[124:127], v[104:107], v[196:199]
ds_read_b128 v[148:151], v7 offset:256
v_mfma_f32_16x16x32_bf16 v[188:191], v[124:127], v[100:103], v[188:191]
ds_read_b128 v[152:155], v7 offset:320
v_mfma_f32_16x16x32_bf16 v[192:195], v[128:131], v[100:103], v[192:195]
ds_read2_b32 v[56:57], v54 offset0:128 offset1:144
v_mfma_f32_16x16x32_bf16 v[200:203], v[128:131], v[104:107], v[200:203]
v_mfma_f32_16x16x32_bf16 v[208:211], v[128:131], v[108:111], v[208:211]
v_mfma_f32_16x16x32_bf16 v[216:219], v[128:131], v[112:115], v[216:219]
s_barrier
v_mfma_f32_16x16x32_bf16 v[244:247], v[112:115], v[132:135], v[244:247]
ds_read_b64 v[92:93], v8 offset:0
v_mfma_f32_16x16x32_bf16 v[248:251], v[112:115], v[136:139], v[248:251]
ds_read_b64 v[94:95], v8 offset:128
v_mfma_f32_16x16x32_bf16 v[240:243], v[108:111], v[136:139], v[240:243]
ds_read_b64 v[96:97], v8 offset:256
v_mfma_f32_16x16x32_bf16 v[236:239], v[108:111], v[132:135], v[236:239]
ds_read_b64 v[98:99], v8 offset:384
v_mfma_f32_16x16x32_bf16 v[228:231], v[104:107], v[132:135], v[228:231]
ds_read_b128 v[60:63], v9 offset:0
v_mfma_f32_16x16x32_bf16 v[232:235], v[104:107], v[136:139], v[232:235]
ds_read_b128 v[64:67], v9 offset:64
v_mfma_f32_16x16x32_bf16 v[224:227], v[100:103], v[136:139], v[224:227]
ds_read_b128 v[68:71], v9 offset:128
v_mfma_f32_16x16x32_bf16 v[220:223], v[100:103], v[132:135], v[220:223]
ds_read_b128 v[72:75], v9 offset:192
v_mfma_f32_16x16x32_bf16 v[156:159], v[116:119], v[100:103], v[156:159]
ds_read_b128 v[76:79], v9 offset:512
v_mfma_f32_16x16x32_bf16 v[164:167], v[116:119], v[104:107], v[164:167]
ds_read_b128 v[80:83], v9 offset:576
v_mfma_f32_16x16x32_bf16 v[172:175], v[116:119], v[108:111], v[172:175]
ds_read_b128 v[84:87], v9 offset:640
v_mfma_f32_16x16x32_bf16 v[180:183], v[116:119], v[112:115], v[180:183]
ds_read_b128 v[88:91], v9 offset:704
v_mfma_f32_16x16x32_bf16 v[184:187], v[120:123], v[112:115], v[184:187]
v_mfma_f32_16x16x32_bf16 v[176:179], v[120:123], v[108:111], v[176:179]
v_mfma_f32_16x16x32_bf16 v[168:171], v[120:123], v[104:107], v[168:171]
v_mfma_f32_16x16x32_bf16 v[160:163], v[120:123], v[100:103], v[160:163]
c2_epi:
s_waitcnt lgkmcnt(0)
.p2align 3
v_pk_fma_f32 v[212:213], v[148:149], v[98:99], v[212:213] op_sel:[0,1,0] op_sel_hi:[1,1,1]
v_pk_fma_f32 v[214:215], v[150:151], v[98:99], v[214:215] op_sel:[0,1,0] op_sel_hi:[1,1,1]
v_pk_fma_f32 v[216:217], v[152:153], v[98:99], v[216:217] op_sel:[0,1,0] op_sel_hi:[1,1,1]
v_pk_fma_f32 v[218:219], v[154:155], v[98:99], v[218:219] op_sel:[0,1,0] op_sel_hi:[1,1,1]
v_pk_mul_f32 v[212:213], v[212:213], v[98:99] op_sel:[0,0] op_sel_hi:[1,0]
v_pk_mul_f32 v[214:215], v[214:215], v[98:99] op_sel:[0,0] op_sel_hi:[1,0]
v_pk_mul_f32 v[216:217], v[216:217], v[98:99] op_sel:[0,0] op_sel_hi:[1,0]
v_pk_mul_f32 v[218:219], v[218:219], v[98:99] op_sel:[0,0] op_sel_hi:[1,0]
v_cvt_pk_bf16_f32 v212, v212, v213
v_cvt_pk_bf16_f32 v213, v214, v215
v_cvt_pk_bf16_f32 v214, v216, v217
v_cvt_pk_bf16_f32 v215, v218, v219
v_pk_fma_f32 v[244:245], v[88:89], v[56:57], v[244:245] op_sel:[0,0,0] op_sel_hi:[1,0,1]
v_pk_fma_f32 v[246:247], v[90:91], v[56:57], v[246:247] op_sel:[0,0,0] op_sel_hi:[1,0,1]
v_pk_mul_f32 v[244:245], v[244:245], v[72:73]
v_pk_mul_f32 v[246:247], v[246:247], v[74:75]
v_cvt_pk_bf16_f32 v108, v244, v245
v_cvt_pk_bf16_f32 v109, v246, v247
v_pk_fma_f32 v[248:249], v[88:89], v[56:57], v[248:249] op_sel:[0,1,0] op_sel_hi:[1,1,1]
v_pk_fma_f32 v[250:251], v[90:91], v[56:57], v[250:251] op_sel:[0,1,0] op_sel_hi:[1,1,1]
v_pk_mul_f32 v[248:249], v[248:249], v[72:73]
v_pk_mul_f32 v[250:251], v[250:251], v[74:75]
v_cvt_pk_bf16_f32 v118, v248, v249
v_cvt_pk_bf16_f32 v119, v250, v251
s_cmp_lg_u32 s44, 1
s_cbranch_scc1 else_104
buffer_store_dwordx4 v[212:215], v58, s[32:35], 0 offen sc1
buffer_store_dwordx2 v[108:109], v59, s[32:35], 0 offen offset:1024 sc1
buffer_store_dwordx2 v[118:119], v59, s[32:35], 0 offen offset:1536 sc1
s_branch fi_105
else_104:
ds_write_b128 v53, v[212:215]
ds_write_b64 v55, v[108:109] offset:1024
ds_write_b64 v55, v[118:119] offset:1536
v_mov_b32 v4, 3
ds_write_b32 v19, v4
fi_105:
.p2align 3
v_pk_fma_f32 v[188:189], v[148:149], v[92:93], v[188:189] op_sel:[0,1,0] op_sel_hi:[1,1,1]
v_pk_fma_f32 v[196:197], v[148:149], v[94:95], v[196:197] op_sel:[0,1,0] op_sel_hi:[1,1,1]
v_pk_fma_f32 v[204:205], v[148:149], v[96:97], v[204:205] op_sel:[0,1,0] op_sel_hi:[1,1,1]
v_pk_fma_f32 v[164:165], v[140:141], v[94:95], v[164:165] op_sel:[0,1,0] op_sel_hi:[1,1,1]
v_pk_fma_f32 v[172:173], v[140:141], v[96:97], v[172:173] op_sel:[0,1,0] op_sel_hi:[1,1,1]
v_pk_fma_f32 v[180:181], v[140:141], v[98:99], v[180:181] op_sel:[0,1,0] op_sel_hi:[1,1,1]
v_pk_fma_f32 v[190:191], v[150:151], v[92:93], v[190:191] op_sel:[0,1,0] op_sel_hi:[1,1,1]
v_pk_mul_f32 v[188:189], v[188:189], v[92:93] op_sel:[0,0] op_sel_hi:[1,0]
v_pk_fma_f32 v[198:199], v[150:151], v[94:95], v[198:199] op_sel:[0,1,0] op_sel_hi:[1,1,1]
v_pk_mul_f32 v[196:197], v[196:197], v[94:95] op_sel:[0,0] op_sel_hi:[1,0]
v_pk_fma_f32 v[206:207], v[150:151], v[96:97], v[206:207] op_sel:[0,1,0] op_sel_hi:[1,1,1]
v_pk_mul_f32 v[204:205], v[204:205], v[96:97] op_sel:[0,0] op_sel_hi:[1,0]
v_pk_fma_f32 v[166:167], v[142:143], v[94:95], v[166:167] op_sel:[0,1,0] op_sel_hi:[1,1,1]
v_cvt_pk_bf16_f32 v164, v164, v165
v_pk_fma_f32 v[174:175], v[142:143], v[96:97], v[174:175] op_sel:[0,1,0] op_sel_hi:[1,1,1]
v_cvt_pk_bf16_f32 v172, v172, v173
v_pk_fma_f32 v[182:183], v[142:143], v[98:99], v[182:183] op_sel:[0,1,0] op_sel_hi:[1,1,1]
v_cvt_pk_bf16_f32 v180, v180, v181
v_pk_fma_f32 v[192:193], v[152:153], v[92:93], v[192:193] op_sel:[0,1,0] op_sel_hi:[1,1,1]
v_pk_fma_f32 v[194:195], v[154:155], v[92:93], v[194:195] op_sel:[0,1,0] op_sel_hi:[1,1,1]
v_pk_mul_f32 v[190:191], v[190:191], v[92:93] op_sel:[0,0] op_sel_hi:[1,0]
v_cvt_pk_bf16_f32 v188, v188, v189
v_pk_fma_f32 v[200:201], v[152:153], v[94:95], v[200:201] op_sel:[0,1,0] op_sel_hi:[1,1,1]
v_pk_fma_f32 v[202:203], v[154:155], v[94:95], v[202:203] op_sel:[0,1,0] op_sel_hi:[1,1,1]
v_pk_mul_f32 v[198:199], v[198:199], v[94:95] op_sel:[0,0] op_sel_hi:[1,0]
v_cvt_pk_bf16_f32 v196, v196, v197
v_pk_fma_f32 v[208:209], v[152:153], v[96:97], v[208:209] op_sel:[0,1,0] op_sel_hi:[1,1,1]
v_pk_fma_f32 v[210:211], v[154:155], v[96:97], v[210:211] op_sel:[0,1,0] op_sel_hi:[1,1,1]
v_pk_mul_f32 v[206:207], v[206:207], v[96:97] op_sel:[0,0] op_sel_hi:[1,0]
v_cvt_pk_bf16_f32 v204, v204, v205
v_pk_fma_f32 v[168:169], v[144:145], v[94:95], v[168:169] op_sel:[0,1,0] op_sel_hi:[1,1,1]
v_pk_fma_f32 v[170:171], v[146:147], v[94:95], v[170:171] op_sel:[0,1,0] op_sel_hi:[1,1,1]
v_cvt_pk_bf16_f32 v165, v166, v167
v_pk_fma_f32 v[176:177], v[144:145], v[96:97], v[176:177] op_sel:[0,1,0] op_sel_hi:[1,1,1]
v_pk_fma_f32 v[178:179], v[146:147], v[96:97], v[178:179] op_sel:[0,1,0] op_sel_hi:[1,1,1]
v_cvt_pk_bf16_f32 v173, v174, v175
v_pk_fma_f32 v[184:185], v[144:145], v[98:99], v[184:185] op_sel:[0,1,0] op_sel_hi:[1,1,1]
v_pk_fma_f32 v[186:187], v[146:147], v[98:99], v[186:187] op_sel:[0,1,0] op_sel_hi:[1,1,1]
v_cvt_pk_bf16_f32 v181, v182, v183
v_pk_mul_f32 v[192:193], v[192:193], v[92:93] op_sel:[0,0] op_sel_hi:[1,0]
v_pk_mul_f32 v[194:195], v[194:195], v[92:93] op_sel:[0,0] op_sel_hi:[1,0]
v_cvt_pk_bf16_f32 v189, v190, v191
v_pk_mul_f32 v[200:201], v[200:201], v[94:95] op_sel:[0,0] op_sel_hi:[1,0]
v_pk_mul_f32 v[202:203], v[202:203], v[94:95] op_sel:[0,0] op_sel_hi:[1,0]
v_cvt_pk_bf16_f32 v197, v198, v199
v_pk_mul_f32 v[208:209], v[208:209], v[96:97] op_sel:[0,0] op_sel_hi:[1,0]
v_pk_mul_f32 v[210:211], v[210:211], v[96:97] op_sel:[0,0] op_sel_hi:[1,0]
v_cvt_pk_bf16_f32 v205, v206, v207
v_cvt_pk_bf16_f32 v166, v168, v169
v_cvt_pk_bf16_f32 v167, v170, v171
v_cvt_pk_bf16_f32 v174, v176, v177
v_cvt_pk_bf16_f32 v175, v178, v179
v_cvt_pk_bf16_f32 v182, v184, v185
v_cvt_pk_bf16_f32 v183, v186, v187
v_cvt_pk_bf16_f32 v190, v192, v193
v_cvt_pk_bf16_f32 v191, v194, v195
v_mfma_f32_16x16x32_bf16 v[216:219], v[212:215], v[180:183], v[40:43]
v_cvt_pk_bf16_f32 v198, v200, v201
v_cvt_pk_bf16_f32 v199, v202, v203
v_mfma_f32_16x16x32_bf16 v[168:171], v[188:191], v[164:167], v[36:39]
v_cvt_pk_bf16_f32 v206, v208, v209
v_cvt_pk_bf16_f32 v207, v210, v211
v_mfma_f32_16x16x32_bf16 v[200:203], v[196:199], v[164:167], v[40:43]
v_mul_f32 v124, s66, v92
v_mul_f32 v125, s66, v94
v_mfma_f32_16x16x32_bf16 v[208:211], v[204:207], v[172:175], v[40:43]
v_mul_f32 v126, s66, v96
v_mul_f32 v127, s66, v98
v_mfma_f32_16x16x32_bf16 v[176:179], v[196:199], v[172:175], v[36:39]
v_max_f32 v164, v168, v169
v_max_f32 v165, v170, v171
v_mfma_f32_16x16x32_bf16 v[184:187], v[204:207], v[180:183], v[36:39]
v_max_f32 v166, v200, v201
v_max_f32 v182, v216, v217
v_max_f32 v174, v208, v209
v_max_f32 v167, v202, v203
v_max3_f32 v129, v164, v165, v166
v_pk_fma_f32 v[156:157], v[140:141], v[92:93], v[156:157] op_sel:[0,1,0] op_sel_hi:[1,1,1]
v_pk_fma_f32 v[158:159], v[142:143], v[92:93], v[158:159] op_sel:[0,1,0] op_sel_hi:[1,1,1]
v_cvt_pk_bf16_f32 v156, v156, v157
v_pk_fma_f32 v[160:161], v[144:145], v[92:93], v[160:161] op_sel:[0,1,0] op_sel_hi:[1,1,1]
v_pk_fma_f32 v[162:163], v[146:147], v[92:93], v[162:163] op_sel:[0,1,0] op_sel_hi:[1,1,1]
v_cvt_pk_bf16_f32 v157, v158, v159
v_cvt_pk_bf16_f32 v158, v160, v161
v_cvt_pk_bf16_f32 v159, v162, v163
v_pk_fma_f32 v[220:221], v[76:77], v[56:57], v[220:221] op_sel:[0,0,0] op_sel_hi:[1,0,1]
v_pk_fma_f32 v[222:223], v[78:79], v[56:57], v[222:223] op_sel:[0,0,0] op_sel_hi:[1,0,1]
v_mfma_f32_16x16x32_bf16 v[192:195], v[188:191], v[156:159], v[40:43]
v_max_f32 v172, v176, v177
v_max_f32 v173, v178, v179
v_max_f32 v180, v184, v185
v_max_f32 v181, v186, v187
v_max_f32_e64 v175, v210, v211
v_pk_fma_f32 v[224:225], v[76:77], v[56:57], v[224:225] op_sel:[0,1,0] op_sel_hi:[1,1,1]
v_pk_fma_f32 v[226:227], v[78:79], v[56:57], v[226:227] op_sel:[0,1,0] op_sel_hi:[1,1,1]
v_pk_fma_f32 v[228:229], v[80:81], v[56:57], v[228:229] op_sel:[0,0,0] op_sel_hi:[1,0,1]
v_pk_fma_f32 v[230:231], v[82:83], v[56:57], v[230:231] op_sel:[0,0,0] op_sel_hi:[1,0,1]
v_pk_fma_f32 v[232:233], v[80:81], v[56:57], v[232:233] op_sel:[0,1,0] op_sel_hi:[1,1,1]
v_pk_fma_f32 v[234:235], v[82:83], v[56:57], v[234:235] op_sel:[0,1,0] op_sel_hi:[1,1,1]
v_pk_fma_f32 v[236:237], v[84:85], v[56:57], v[236:237] op_sel:[0,0,0] op_sel_hi:[1,0,1]
v_pk_fma_f32 v[238:239], v[86:87], v[56:57], v[238:239] op_sel:[0,0,0] op_sel_hi:[1,0,1]
v_pk_fma_f32 v[240:241], v[84:85], v[56:57], v[240:241] op_sel:[0,1,0] op_sel_hi:[1,1,1]
v_pk_fma_f32 v[242:243], v[86:87], v[56:57], v[242:243] op_sel:[0,1,0] op_sel_hi:[1,1,1]
v_pk_mul_f32 v[220:221], v[220:221], v[60:61]
v_pk_mul_f32 v[222:223], v[222:223], v[62:63]
v_pk_mul_f32 v[224:225], v[224:225], v[60:61]
s_cmp_lg_u32 s44, 0
s_cbranch_scc1 else_106
buffer_load_dwordx4 v[120:123], v58, s[32:35], 0 offen sc1
buffer_load_dwordx2 v[100:101], v59, s[32:35], 0 offen offset:1024 sc1
buffer_load_dwordx2 v[110:111], v59, s[32:35], 0 offen offset:1536 sc1
else_106:
v_pk_mul_f32 v[226:227], v[226:227], v[62:63]
v_pk_mul_f32 v[228:229], v[228:229], v[64:65]
v_pk_mul_f32 v[230:231], v[230:231], v[66:67]
v_pk_mul_f32 v[232:233], v[232:233], v[64:65]
v_pk_mul_f32 v[234:235], v[234:235], v[66:67]
v_pk_mul_f32 v[236:237], v[236:237], v[68:69]
v_pk_mul_f32 v[238:239], v[238:239], v[70:71]
v_pk_mul_f32 v[240:241], v[240:241], v[68:69]
v_pk_mul_f32 v[242:243], v[242:243], v[70:71]
v_max3_f32 v130, v172, v173, v174
v_max_f32_e64 v183, v218, v219
v_max3_f32 v131, v180, v181, v182
v_cvt_pk_bf16_f32 v102, v220, v221
v_cvt_pk_bf16_f32 v103, v222, v223
v_cvt_pk_bf16_f32 v112, v224, v225
v_cvt_pk_bf16_f32 v113, v226, v227
v_cvt_pk_bf16_f32 v104, v228, v229
v_cvt_pk_bf16_f32 v105, v230, v231
v_cvt_pk_bf16_f32 v114, v232, v233
v_cvt_pk_bf16_f32 v115, v234, v235
v_cvt_pk_bf16_f32 v106, v236, v237
v_cvt_pk_bf16_f32 v107, v238, v239
v_cvt_pk_bf16_f32 v116, v240, v241
v_cvt_pk_bf16_f32 v117, v242, v243
v_max_f32 v129, v129, v167
v_max_f32 v130, v130, v175
v_max_f32 v131, v131, v183
s_cmp_lg_u32 s44, 0
s_cbranch_scc1 else_108
s_mov_b32 s63, 0
sent_110:
s_waitcnt vmcnt(0)
v_max_u32 v4, v120, v121
v_max3_u32 v4, v4, v122, v123
v_max3_u32 v4, v4, v100, v101
v_max3_u32 v4, v4, v110, v111
v_cmp_eq_u32 vcc, -1, v4
s_cbranch_vccz sentd_111
buffer_load_dwordx4 v[120:123], v58, s[32:35], 0 offen sc1
buffer_load_dwordx2 v[100:101], v59, s[32:35], 0 offen offset:1024 sc1
buffer_load_dwordx2 v[110:111], v59, s[32:35], 0 offen offset:1536 sc1
s_add_u32 s63, s63, 1
s_cmp_lt_u32 s63, 0x80000
s_cbranch_scc1 sent_110
s_waitcnt vmcnt(0)
sentd_111:
s_branch fi_109
else_108:
s_mov_b32 s63, 0
px_112:
ds_read_b32 v4, v19
ds_read_b128 v[120:123], v53
ds_read_b64 v[100:101], v55 offset:1024
ds_read_b64 v[110:111], v55 offset:1536
s_add_u32 s63, s63, 1
s_cmp_lt_u32 s63, 0x400000
s_waitcnt lgkmcnt(0)
v_cmp_ne_u32 vcc, 3, v4
s_cbranch_vccz pxd_113
s_cbranch_scc1 px_112
pxd_113:
fi_109:
s_cmp_eq_u32 s46, 0
s_cbranch_scc1 slow_114
.p2align 3
v_mfma_f32_16x16x32_bf16 v[160:163], v[120:123], v[156:159], v[44:47]
v_max_f32 v158, v192, v193
v_max_f32 v159, v194, v195
v_permlane32_swap_b32 v130, v131
s_nop 0
v_max_f32 v130, v130, v131
s_nop 2
v_max_f32 v156, v160, v161
v_max_f32 v157, v162, v163
v_max3_f32 v128, v156, v157, v158
v_max_f32 v128, v128, v159
s_nop 1
v_permlane32_swap_b32 v128, v129
s_nop 0
v_max_f32 v128, v128, v129
s_nop 1
v_permlane16_swap_b32 v128, v130
s_nop 0
v_max_f32 v128, v128, v130
v_mov_b32 v130, v128
s_nop 1
v_permlane16_swap_b32 v128, v130
s_nop 0
v_mov_b32 v129, v128
v_mov_b32 v131, v130
s_nop 0
v_permlane32_swap_b32 v128, v129
v_permlane32_swap_b32 v130, v131
v_mul_f32 v128, v128, v124
v_mul_f32 v129, v129, v125
v_pk_fma_f32 v[156:157], v[156:157], v[124:125], v[128:129] op_sel:[0,0,0] op_sel_hi:[1,0,0] neg_lo:[0,0,1] neg_hi:[0,0,1]
v_pk_fma_f32 v[158:159], v[158:159], v[124:125], v[128:129] op_sel:[0,0,0] op_sel_hi:[1,0,0] neg_lo:[0,0,1] neg_hi:[0,0,1]
v_mul_f32 v130, v130, v126
v_mul_f32 v131, v131, v127
v_exp_f32 v156, v156
v_exp_f32 v157, v157
v_exp_f32 v158, v158
v_exp_f32 v159, v159
v_pk_fma_f32 v[164:165], v[164:165], v[124:125], v[128:129] op_sel:[0,1,1] op_sel_hi:[1,1,1] neg_lo:[0,0,1] neg_hi:[0,0,1]
v_pk_fma_f32 v[166:167], v[166:167], v[124:125], v[128:129] op_sel:[0,1,1] op_sel_hi:[1,1,1] neg_lo:[0,0,1] neg_hi:[0,0,1]
v_exp_f32 v164, v164
v_exp_f32 v165, v165
v_exp_f32 v166, v166
v_exp_f32 v167, v167
v_pk_fma_f32 v[172:173], v[172:173], v[126:127], v[130:131] op_sel:[0,0,0] op_sel_hi:[1,0,0] neg_lo:[0,0,1] neg_hi:[0,0,1]
v_pk_fma_f32 v[174:175], v[174:175], v[126:127], v[130:131] op_sel:[0,0,0] op_sel_hi:[1,0,0] neg_lo:[0,0,1] neg_hi:[0,0,1]
v_cvt_pk_bf16_f32 v156, v156, v156
v_cvt_pk_bf16_f32 v157, v157, v157
v_cvt_pk_bf16_f32 v158, v158, v158
v_cvt_pk_bf16_f32 v159, v159, v159
v_exp_f32 v172, v172
v_exp_f32 v173, v173
v_exp_f32 v174, v174
v_exp_f32 v175, v175
v_pk_fma_f32 v[180:181], v[180:181], v[126:127], v[130:131] op_sel:[0,1,1] op_sel_hi:[1,1,1] neg_lo:[0,0,1] neg_hi:[0,0,1]
v_pk_fma_f32 v[182:183], v[182:183], v[126:127], v[130:131] op_sel:[0,1,1] op_sel_hi:[1,1,1] neg_lo:[0,0,1] neg_hi:[0,0,1]
v_and_b32 v156, v52, v156
v_and_b32 v157, v52, v157
v_and_b32 v158, v52, v158
v_and_b32 v159, v52, v159
v_cvt_pk_bf16_f32 v164, v164, v164
v_cvt_pk_bf16_f32 v165, v165, v165
v_mfma_f32_16x16x32_bf16 v[160:163], v[48:51], v[156:159], 0
v_cvt_pk_bf16_f32 v166, v166, v166
v_cvt_pk_bf16_f32 v167, v167, v167
v_mfma_f32_16x16x32_bf16 v[220:223], v[100:103], v[156:159], 0
v_exp_f32 v180, v180
v_mfma_f32_16x16x32_bf16 v[224:227], v[110:113], v[156:159], 0
v_exp_f32 v181, v181
v_exp_f32 v182, v182
v_exp_f32 v183, v183
v_and_b32 v164, v52, v164
v_and_b32 v165, v52, v165
v_and_b32 v166, v52, v166
v_and_b32 v167, v52, v167
v_cvt_pk_bf16_f32 v172, v172, v172
v_cvt_pk_bf16_f32 v173, v173, v173
v_mfma_f32_16x16x32_bf16 v[168:171], v[48:51], v[164:167], 0
v_cvt_pk_bf16_f32 v174, v174, v174
v_cvt_pk_bf16_f32 v175, v175, v175
v_mfma_f32_16x16x32_bf16 v[228:231], v[102:105], v[164:167], 0
v_and_b32 v172, v52, v172
v_and_b32 v173, v52, v173
v_mfma_f32_16x16x32_bf16 v[232:235], v[112:115], v[164:167], 0
v_and_b32 v174, v52, v174
v_and_b32 v175, v52, v175
v_cvt_pk_bf16_f32 v180, v180, v180
v_cvt_pk_bf16_f32 v181, v181, v181
v_mfma_f32_16x16x32_bf16 v[176:179], v[48:51], v[172:175], 0
v_cvt_pk_bf16_f32 v182, v182, v182
v_cvt_pk_bf16_f32 v183, v183, v183
v_mfma_f32_16x16x32_bf16 v[236:239], v[104:107], v[172:175], 0
v_and_b32 v180, v52, v180
v_and_b32 v181, v52, v181
v_mfma_f32_16x16x32_bf16 v[240:243], v[114:117], v[172:175], 0
v_and_b32 v182, v52, v182
v_and_b32 v183, v52, v183
v_rcp_f32 v160, v160
v_rcp_f32 v168, v168
v_pk_mul_f32 v[220:221], v[220:221], v[160:161] op_sel:[0,0] op_sel_hi:[1,0]
v_pk_mul_f32 v[222:223], v[222:223], v[160:161] op_sel:[0,0] op_sel_hi:[1,0]
v_pk_mul_f32 v[228:229], v[228:229], v[168:169] op_sel:[0,0] op_sel_hi:[1,0]
v_pk_mul_f32 v[224:225], v[224:225], v[160:161] op_sel:[0,0] op_sel_hi:[1,0]
v_pk_mul_f32 v[226:227], v[226:227], v[160:161] op_sel:[0,0] op_sel_hi:[1,0]
v_pk_mul_f32 v[230:231], v[230:231], v[168:169] op_sel:[0,0] op_sel_hi:[1,0]
v_pk_mul_f32 v[232:233], v[232:233], v[168:169] op_sel:[0,0] op_sel_hi:[1,0]
v_pk_mul_f32 v[234:235], v[234:235], v[168:169] op_sel:[0,0] op_sel_hi:[1,0]
v_mfma_f32_16x16x32_bf16 v[184:187], v[48:51], v[180:183], 0
v_rcp_f32_e64 v176, v176
v_cvt_pk_bf16_f32 v220, v220, v221
v_cvt_pk_bf16_f32 v221, v222, v223
v_cvt_pk_bf16_f32 v228, v228, v229
v_pk_mul_f32 v[236:237], v[236:237], v[176:177] op_sel:[0,0] op_sel_hi:[1,0]
v_mfma_f32_16x16x32_bf16 v[244:247], v[106:109], v[180:183], 0
v_cvt_pk_bf16_f32 v222, v224, v225
v_cvt_pk_bf16_f32 v223, v226, v227
v_rcp_f32_e64 v184, v184
v_cvt_pk_bf16_f32 v229, v230, v231
v_pk_mul_f32 v[238:239], v[238:239], v[176:177] op_sel:[0,0] op_sel_hi:[1,0]
v_pk_mul_f32 v[240:241], v[240:241], v[176:177] op_sel:[0,0] op_sel_hi:[1,0]
v_pk_mul_f32 v[242:243], v[242:243], v[176:177] op_sel:[0,0] op_sel_hi:[1,0]
v_cvt_pk_bf16_f32 v236, v236, v237
v_pk_mul_f32 v[244:245], v[244:245], v[184:185] op_sel:[0,0] op_sel_hi:[1,0]
v_pk_mul_f32 v[246:247], v[246:247], v[184:185] op_sel:[0,0] op_sel_hi:[1,0]
v_mfma_f32_16x16x32_bf16 v[248:251], v[116:119], v[180:183], 0
buffer_store_dwordx4 v[220:223], v18, s[32:35], s80 offen
v_cvt_pk_bf16_f32 v230, v232, v233
v_cvt_pk_bf16_f32 v231, v234, v235
v_cvt_pk_bf16_f32 v237, v238, v239
v_cvt_pk_bf16_f32 v244, v244, v245
buffer_store_dwordx4 v[228:231], v18, s[32:35], s81 offen
v_cvt_pk_bf16_f32 v238, v240, v241
v_cvt_pk_bf16_f32 v239, v242, v243
v_pk_mul_f32 v[248:249], v[248:249], v[184:185] op_sel:[0,0] op_sel_hi:[1,0]
v_pk_mul_f32 v[250:251], v[250:251], v[184:185] op_sel:[0,0] op_sel_hi:[1,0]
v_cvt_pk_bf16_f32 v245, v246, v247
buffer_store_dwordx4 v[236:239], v18, s[32:35], s82 offen
v_cvt_pk_bf16_f32 v246, v248, v249
v_cvt_pk_bf16_f32 v247, v250, v251
buffer_store_dwordx4 v[244:247], v18, s[32:35], s83 offen
back_115:
s_barrier
v_and_b32 v36, 31, v0
v_lshlrev_b32 v36, 2, v36
s_lshl_b32 s62, s45, 2
v_mov_b32 v4, s62
v_mov_b32 v5, 3
s_mov_b64 exec, 1
s_waitcnt vmcnt(0)
s_cmp_eq_u32 s46, 0
s_cbranch_scc1 slow_116
buffer_store_dword v5, v4, s[32:35], s84 offen
back_117:
s_mov_b64 exec, -1
v_lshrrev_b32 v4, 2, v2
v_and_b32 v5, 3, v0
v_lshl_add_u32 v6, v3, 3, v4
v_lshlrev_b32 v6, 7, v6
v_lshl_add_u32 v6, v5, 3, v6
v_lshrrev_b32 v7, 1, v4
v_and_b32 v8, 1, v3
v_lshl_add_u32 v7, v8, 1, v7
v_lshl_add_u32 v10, v7, 5, v6
v_xor_b32 v11, 32, v10
v_xor_b32 v12, 64, v10
v_xor_b32 v13, 96, v10
v_add_u32 v14, 0x10000, v10
v_add_u32 v15, 0x10000, v11
v_add_u32 v16, 0x10000, v12
v_add_u32 v17, 0x10000, v13
ds_read_b64_tr_b16 v[220:221], v10 offset:0
ds_read_b64_tr_b16 v[222:223], v10 offset:512
ds_read_b64_tr_b16 v[224:225], v11 offset:0
ds_read_b64_tr_b16 v[226:227], v11 offset:512
ds_read_b64_tr_b16 v[228:229], v12 offset:0
ds_read_b64_tr_b16 v[230:231], v12 offset:512
ds_read_b64_tr_b16 v[232:233], v13 offset:0
ds_read_b64_tr_b16 v[234:235], v13 offset:512
ds_read_b64_tr_b16 v[236:237], v10 offset:4096
ds_read_b64_tr_b16 v[238:239], v10 offset:4608
ds_read_b64_tr_b16 v[240:241], v11 offset:4096
ds_read_b64_tr_b16 v[242:243], v11 offset:4608
ds_read_b64_tr_b16 v[244:245], v12 offset:4096
ds_read_b64_tr_b16 v[246:247], v12 offset:4608
ds_read_b64_tr_b16 v[248:249], v13 offset:4096
ds_read_b64_tr_b16 v[250:251], v13 offset:4608
s_lshl_b32 s48, s41, 3
s_lshl_b32 s49, s40, 1
s_add_u32 s48, s48, s49
s_lshl_b32 s48, s48, 15
s_add_u32 s48, s48, 4194304
v_add_u32 v38, s48, v18
v_add_u32 v39, 32768, v38
s_lshl_b32 s57, s75, 11
s_add_u32 s87, s87, 262144
v_lshlrev_b32 v60, 16, v20
v_and_b32 v61, 0xffff0000, v20
v_lshlrev_b32 v62, 16, v21
v_and_b32 v63, 0xffff0000, v21
v_lshlrev_b32 v64, 16, v22
v_and_b32 v65, 0xffff0000, v22
v_lshlrev_b32 v66, 16, v23
v_and_b32 v67, 0xffff0000, v23
v_lshlrev_b32 v68, 16, v24
v_and_b32 v69, 0xffff0000, v24
v_lshlrev_b32 v70, 16, v25
v_and_b32 v71, 0xffff0000, v25
v_lshlrev_b32 v72, 16, v26
v_and_b32 v73, 0xffff0000, v26
v_lshlrev_b32 v74, 16, v27
v_and_b32 v75, 0xffff0000, v27
v_lshlrev_b32 v76, 16, v28
v_and_b32 v77, 0xffff0000, v28
v_lshlrev_b32 v78, 16, v29
v_and_b32 v79, 0xffff0000, v29
v_lshlrev_b32 v80, 16, v30
v_and_b32 v81, 0xffff0000, v30
v_lshlrev_b32 v82, 16, v31
v_and_b32 v83, 0xffff0000, v31
v_lshlrev_b32 v84, 16, v32
v_and_b32 v85, 0xffff0000, v32
v_lshlrev_b32 v86, 16, v33
v_and_b32 v87, 0xffff0000, v33
v_lshlrev_b32 v88, 16, v34
v_and_b32 v89, 0xffff0000, v34
v_lshlrev_b32 v90, 16, v35
v_and_b32 v91, 0xffff0000, v35
v_mov_b32 v6, 0
v_mov_b32 v7, 0
v_mov_b32 v8, 0
v_mov_b32 v9, 0
s_lshl_b32 s62, s42, 2
v_mov_b32 v4, s62
v_mov_b32 v5, 3
buffer_load_dword v37, v36, s[32:35], s84 offen sc1
s_mov_b32 s63, 0
s_waitcnt vmcnt(0)
poll_118:
v_cmp_gt_u32 vcc, 3, v37
s_cbranch_vccz polled_119
buffer_load_dword v37, v36, s[32:35], s84 offen sc1
s_add_u32 s63, s63, 1
s_cmp_lt_u32 s63, 0x80000
s_waitcnt vmcnt(0)
s_cbranch_scc1 poll_118
polled_119:
s_call_b64 s[94:95], R_oloop
s_cmp_eq_u32 s46, 0
s_cbranch_scc1 slow_120
s_nop 0
v_cvt_pk_bf16_f32 v20, v60, v61
v_cvt_pk_bf16_f32 v21, v62, v63
v_cvt_pk_bf16_f32 v22, v64, v65
v_cvt_pk_bf16_f32 v23, v66, v67
buffer_store_dwordx4 v[20:23], v18, s[32:35], s85 offen offset:0
v_cvt_pk_bf16_f32 v24, v68, v69
v_cvt_pk_bf16_f32 v25, v70, v71
v_cvt_pk_bf16_f32 v26, v72, v73
v_cvt_pk_bf16_f32 v27, v74, v75
buffer_store_dwordx4 v[24:27], v18, s[32:35], s85 offen offset:1024
v_cvt_pk_bf16_f32 v28, v76, v77
v_cvt_pk_bf16_f32 v29, v78, v79
v_cvt_pk_bf16_f32 v30, v80, v81
v_cvt_pk_bf16_f32 v31, v82, v83
buffer_store_dwordx4 v[28:31], v18, s[32:35], s86 offen offset:0
v_cvt_pk_bf16_f32 v32, v84, v85
v_cvt_pk_bf16_f32 v33, v86, v87
v_cvt_pk_bf16_f32 v34, v88, v89
v_cvt_pk_bf16_f32 v35, v90, v91
buffer_store_dwordx4 v[32:35], v18, s[32:35], s86 offen offset:1024
s_barrier
v_dot2c_f32_bf16 v6, v20, v48
v_dot2c_f32_bf16 v8, v20, v20
v_dot2c_f32_bf16 v7, v28, v48
v_dot2c_f32_bf16 v9, v28, v28
v_dot2c_f32_bf16 v6, v21, v48
v_dot2c_f32_bf16 v8, v21, v21
v_dot2c_f32_bf16 v7, v29, v48
v_dot2c_f32_bf16 v9, v29, v29
v_dot2c_f32_bf16 v6, v22, v48
v_dot2c_f32_bf16 v8, v22, v22
v_dot2c_f32_bf16 v7, v30, v48
v_dot2c_f32_bf16 v9, v30, v30
v_dot2c_f32_bf16 v6, v23, v48
v_dot2c_f32_bf16 v8, v23, v23
v_dot2c_f32_bf16 v7, v31, v48
v_dot2c_f32_bf16 v9, v31, v31
v_dot2c_f32_bf16 v6, v24, v48
v_dot2c_f32_bf16 v8, v24, v24
v_dot2c_f32_bf16 v7, v32, v48
v_dot2c_f32_bf16 v9, v32, v32
v_dot2c_f32_bf16 v6, v25, v48
v_dot2c_f32_bf16 v8, v25, v25
v_dot2c_f32_bf16 v7, v33, v48
v_dot2c_f32_bf16 v9, v33, v33
v_dot2c_f32_bf16 v6, v26, v48
v_dot2c_f32_bf16 v8, v26, v26
v_dot2c_f32_bf16 v7, v34, v48
v_dot2c_f32_bf16 v9, v34, v34
v_dot2c_f32_bf16 v6, v27, v48
v_dot2c_f32_bf16 v8, v27, v27
v_dot2c_f32_bf16 v7, v35, v48
v_dot2c_f32_bf16 v9, v35, v35
s_mov_b64 exec, 1
s_waitcnt vmcnt(0)
buffer_store_dword v5, v4, s[32:35], s88 offen
s_mov_b64 exec, -1
s_nop 1
v_permlane32_swap_b32 v6, v7
v_permlane32_swap_b32 v8, v9
v_add_f32 v6, v6, v7
v_add_f32 v8, v8, v9
s_nop 1
v_permlane16_swap_b32 v6, v8
s_nop 0
v_add_f32 v6, v6, v8
buffer_store_dword v6, v1, s[32:35], s87 offen
back_121:
s_lshl_b32 s49, s44, 13
v_add_u32 v10, s49, v18
v_add_u32 v11, 1024, v10
s_lshl_b32 s48, s43, 1
v_lshrrev_b32 v4, 2, v2
v_and_b32 v5, 3, v0
v_lshl_add_u32 v6, v3, 3, v4
v_lshlrev_b32 v6, 7, v6
v_lshl_add_u32 v6, v5, 3, v6
v_lshrrev_b32 v7, 1, v4
v_and_b32 v8, 1, v3
v_lshl_add_u32 v7, v8, 1, v7
v_xor_b32 v7, s48, v7
v_lshl_add_u32 v12, v7, 5, v6
v_add_u32 v12, 16384, v12
v_xor_b32 v13, 32, v12
v_mov_b32 v14, v10
v_mov_b32 v15, v11
v_add_u32 v16, 122880, v12
v_add_u32 v17, 122880, v13
v_mov_b32 v156, 0
v_mov_b32 v157, 0
v_mov_b32 v158, 0
v_mov_b32 v159, 0
v_mov_b32 v160, 0
v_mov_b32 v161, 0
v_mov_b32 v162, 0
v_mov_b32 v163, 0
v_mov_b32 v164, 0
v_mov_b32 v165, 0
v_mov_b32 v166, 0
v_mov_b32 v167, 0
v_mov_b32 v168, 0
v_mov_b32 v169, 0
v_mov_b32 v170, 0
v_mov_b32 v171, 0
v_mov_b32 v172, 0
v_mov_b32 v173, 0
v_mov_b32 v174, 0
v_mov_b32 v175, 0
v_mov_b32 v176, 0
v_mov_b32 v177, 0
v_mov_b32 v178, 0
v_mov_b32 v179, 0
v_mov_b32 v180, 0
v_mov_b32 v181, 0
v_mov_b32 v182, 0
v_mov_b32 v183, 0
v_mov_b32 v184, 0
v_mov_b32 v185, 0
v_mov_b32 v186, 0
v_mov_b32 v187, 0
v_mov_b32 v188, 0
v_mov_b32 v189, 0
v_mov_b32 v190, 0
v_mov_b32 v191, 0
v_mov_b32 v192, 0
v_mov_b32 v193, 0
v_mov_b32 v194, 0
v_mov_b32 v195, 0
v_mov_b32 v196, 0
v_mov_b32 v197, 0
v_mov_b32 v198, 0
v_mov_b32 v199, 0
v_mov_b32 v200, 0
v_mov_b32 v201, 0
v_mov_b32 v202, 0
v_mov_b32 v203, 0
v_mov_b32 v204, 0
v_mov_b32 v205, 0
v_mov_b32 v206, 0
v_mov_b32 v207, 0
v_mov_b32 v208, 0
v_mov_b32 v209, 0
v_mov_b32 v210, 0
v_mov_b32 v211, 0
v_mov_b32 v212, 0
v_mov_b32 v213, 0
v_mov_b32 v214, 0
v_mov_b32 v215, 0
v_mov_b32 v216, 0
v_mov_b32 v217, 0
v_mov_b32 v218, 0
v_mov_b32 v219, 0
v_mov_b32 v220, 0
v_mov_b32 v221, 0
v_mov_b32 v222, 0
v_mov_b32 v223, 0
v_mov_b32 v224, 0
v_mov_b32 v225, 0
v_mov_b32 v226, 0
v_mov_b32 v227, 0
v_mov_b32 v228, 0
v_mov_b32 v229, 0
v_mov_b32 v230, 0
v_mov_b32 v231, 0
v_mov_b32 v232, 0
v_mov_b32 v233, 0
v_mov_b32 v234, 0
v_mov_b32 v235, 0
v_mov_b32 v236, 0
v_mov_b32 v237, 0
v_mov_b32 v238, 0
v_mov_b32 v239, 0
v_mov_b32 v240, 0
v_mov_b32 v241, 0
v_mov_b32 v242, 0
v_mov_b32 v243, 0
v_mov_b32 v244, 0
v_mov_b32 v245, 0
v_mov_b32 v246, 0
v_mov_b32 v247, 0
v_mov_b32 v248, 0
v_mov_b32 v249, 0
v_mov_b32 v250, 0
v_mov_b32 v251, 0
v_lshrrev_b32 v6, 2, v2
v_cmp_eq_u32 vcc, v6, v3
v_and_b32 v7, 1, v0
v_lshlrev_b32 v7, 4, v7
v_mov_b32 v8, 0x3f80
v_lshlrev_b32 v9, v7, v8
v_cndmask_b32 v7, 0, v9, vcc
v_and_b32 v6, 2, v0
v_cmp_eq_u32 vcc, 0, v6
v_mov_b32 v36, 0
v_mov_b32 v37, 0
v_mov_b32 v40, 0
v_mov_b32 v41, 0
v_cndmask_b32 v38, 0, v7, vcc
v_cndmask_b32 v39, v7, 0, vcc
v_lshrrev_b32 v8, 1, v2
v_cmp_eq_u32 vcc, 0, v8
s_nop 1
v_cndmask_b32 v44, 0, v9, vcc
v_cmp_eq_u32 vcc, 1, v8
s_nop 1
v_cndmask_b32 v45, 0, v9, vcc
v_cmp_eq_u32 vcc, 2, v8
s_nop 1
v_cndmask_b32 v46, 0, v9, vcc
v_cmp_eq_u32 vcc, 3, v8
s_nop 1
v_cndmask_b32 v47, 0, v9, vcc
v_lshrrev_b32 v4, 2, v2
v_lshl_add_u32 v4, v3, 2, v4
v_lshlrev_b32 v4, 6, v4
v_and_b32 v5, 3, v0
v_lshl_add_u32 v4, v5, 3, v4
s_lshl_b32 s48, s43, 11
s_add_u32 s48, s48, 135168
v_add_u32 v53, s48, v4
s_mul_i32 s48, s40, 3072
s_add_u32 s48, s48, 139264
v_add_u32 v42, s48, v18
s_xor_b32 s49, s40, 2
s_mul_i32 s48, s49, 3072
s_add_u32 s48, s48, 139264
v_add_u32 v43, s48, v18
s_lshl_b32 s49, s49, 2
s_add_u32 s49, s49, 134672
v_mov_b32 v19, s49
v_xor_b32 v52, 8, v19
v_lshrrev_b32 v4, 3, v0
v_and_b32 v5, 7, v0
v_lshlrev_b32 v4, 11, v4
v_lshl_add_u32 v55, v5, 4, v4
v_lshlrev_b32 v4, 6, v2
v_lshl_add_u32 v58, v3, 4, v4
v_lshlrev_b32 v4, 4, v2
v_lshl_add_u32 v59, v3, 3, v4
s_mul_i32 s51, s42, 163840
s_add_u32 s51, s51, 9437184
s_lshl_b32 s50, s43, 1
s_add_u32 s50, s50, s44
s_lshl_b32 s48, s50, 15
s_add_u32 s48, s48, s51
s_add_u32 s48, s48, 0
s_lshl_b32 s49, s41, 7
s_add_u32 s53, s48, s49
s_add_u32 s54, s53, 16384
s_lshl_b32 s56, s50, 10
s_add_u32 s56, s56, s51
s_add_u32 s56, s56, 151552
s_xor_b32 s57, s56, 1024
s_lshl_b32 s58, s50, 11
s_add_u32 s58, s58, s51
s_add_u32 s58, s58, 139264
s_xor_b32 s59, s58, 2048
s_add_u32 s79, s58, s49
s_lshl_b32 s50, s41, 11
s_add_u32 s55, s48, s50
s_lshl_b32 s48, s43, 7
s_add_u32 s48, s48, 133888
v_lshl_add_u32 v7, v3, 4, s48
v_lshl_add_u32 v54, v2, 2, s48
s_lshl_b32 s49, s44, 6
v_add_u32 v8, s49, v2
v_lshlrev_b32 v8, 3, v8
v_add_u32 v8, 131072, v8
v_lshl_add_u32 v9, v3, 2, s49
v_lshlrev_b32 v9, 2, v9
v_add_u32 v9, 132096, v9
s_mov_b32 s64, 0
s_mov_b32 s65, 0
s_mov_b32 s66, 0x3fb8aa3b
s_mov_b32 s61, 4
ds_read_b64_tr_b16 v[84:85], v16 offset:8192
ds_read_b64_tr_b16 v[86:87], v16 offset:8704
ds_read_b64_tr_b16 v[88:89], v17 offset:8192
ds_read_b64_tr_b16 v[90:91], v17 offset:8704
ds_read_b64_tr_b16 v[92:93], v16 offset:16384
ds_read_b64_tr_b16 v[94:95], v16 offset:16896
ds_read_b64_tr_b16 v[96:97], v17 offset:16384
ds_read_b64_tr_b16 v[98:99], v17 offset:16896
ds_read_b64_tr_b16 v[76:77], v16 offset:0
ds_read_b64_tr_b16 v[78:79], v16 offset:512
ds_read_b64_tr_b16 v[80:81], v17 offset:0
ds_read_b64_tr_b16 v[82:83], v17 offset:512
s_barrier
ds_read_b128 v[60:63], v14 offset:0
ds_read_b128 v[64:67], v14 offset:2048
ds_read_b128 v[68:71], v14 offset:4096
ds_read_b128 v[72:75], v14 offset:6144
s_waitcnt lgkmcnt(0)
c3_loop:
v_mfma_f32_16x16x32_bf16 v[212:215], v[84:87], v[72:75], v[212:215]
ds_read_b128 v[100:103], v15 offset:0
v_mfma_f32_16x16x32_bf16 v[204:207], v[84:87], v[68:71], v[204:207]
ds_read_b128 v[104:107], v15 offset:2048
v_mfma_f32_16x16x32_bf16 v[196:199], v[84:87], v[64:67], v[196:199]
ds_read_b128 v[108:111], v15 offset:4096
v_mfma_f32_16x16x32_bf16 v[188:191], v[84:87], v[60:63], v[188:191]
ds_read_b128 v[112:115], v15 offset:6144
v_mfma_f32_16x16x32_bf16 v[192:195], v[88:91], v[60:63], v[192:195]
ds_read_b64_tr_b16 v[124:125], v16 offset:12288
v_mfma_f32_16x16x32_bf16 v[200:203], v[88:91], v[64:67], v[200:203]
ds_read_b64_tr_b16 v[126:127], v16 offset:12800
v_mfma_f32_16x16x32_bf16 v[208:211], v[88:91], v[68:71], v[208:211]
ds_read_b64_tr_b16 v[128:129], v17 offset:12288
v_mfma_f32_16x16x32_bf16 v[216:219], v[88:91], v[72:75], v[216:219]
ds_read_b64_tr_b16 v[130:131], v17 offset:12800
v_mfma_f32_16x16x32_bf16 v[244:247], v[72:75], v[92:95], v[244:247]
ds_read_b64_tr_b16 v[132:133], v16 offset:20480
v_mfma_f32_16x16x32_bf16 v[248:251], v[72:75], v[96:99], v[248:251]
ds_read_b64_tr_b16 v[134:135], v16 offset:20992
v_mfma_f32_16x16x32_bf16 v[240:243], v[68:71], v[96:99], v[240:243]
ds_read_b64_tr_b16 v[136:137], v17 offset:20480
v_mfma_f32_16x16x32_bf16 v[236:239], v[68:71], v[92:95], v[236:239]
ds_read_b64_tr_b16 v[138:139], v17 offset:20992
v_mfma_f32_16x16x32_bf16 v[228:231], v[64:67], v[92:95], v[228:231]
ds_read_b64_tr_b16 v[116:117], v16 offset:4096
v_mfma_f32_16x16x32_bf16 v[232:235], v[64:67], v[96:99], v[232:235]
ds_read_b64_tr_b16 v[118:119], v16 offset:4608
v_mfma_f32_16x16x32_bf16 v[224:227], v[60:63], v[96:99], v[224:227]
ds_read_b64_tr_b16 v[120:121], v17 offset:4096
v_mfma_f32_16x16x32_bf16 v[220:223], v[60:63], v[92:95], v[220:223]
ds_read_b64_tr_b16 v[122:123], v17 offset:4608
v_mfma_f32_16x16x32_bf16 v[156:159], v[76:79], v[60:63], v[156:159]
s_add_u32 s65, s65, 40960
s_cmp_eq_u32 s65, 122880
v_mfma_f32_16x16x32_bf16 v[164:167], v[76:79], v[64:67], v[164:167]
s_cselect_b32 s65, 0, s65
s_add_u32 s64, s64, 1
v_mfma_f32_16x16x32_bf16 v[172:175], v[76:79], v[68:71], v[172:175]
v_add_u32 v14, s65, v10
v_add_u32 v15, s65, v11
v_mfma_f32_16x16x32_bf16 v[180:183], v[76:79], v[72:75], v[180:183]
v_add_u32 v16, s65, v12
v_add_u32 v17, s65, v13
v_mfma_f32_16x16x32_bf16 v[184:187], v[80:83], v[72:75], v[184:187]
v_mfma_f32_16x16x32_bf16 v[176:179], v[80:83], v[68:71], v[176:179]
s_cmp_eq_u32 s64, 16
s_cbranch_scc1 c3_last
v_mfma_f32_16x16x32_bf16 v[168:171], v[80:83], v[64:67], v[168:171]
s_waitcnt lgkmcnt(0)
v_mfma_f32_16x16x32_bf16 v[160:163], v[80:83], v[60:63], v[160:163]
s_barrier
v_mfma_f32_16x16x32_bf16 v[212:215], v[124:127], v[112:115], v[212:215]
ds_read_b128 v[60:63], v14 offset:0
v_mfma_f32_16x16x32_bf16 v[204:207], v[124:127], v[108:111], v[204:207]
ds_read_b128 v[64:67], v14 offset:2048
v_mfma_f32_16x16x32_bf16 v[196:199], v[124:127], v[104:107], v[196:199]
ds_read_b128 v[68:71], v14 offset:4096
v_mfma_f32_16x16x32_bf16 v[188:191], v[124:127], v[100:103], v[188:191]
ds_read_b128 v[72:75], v14 offset:6144
v_mfma_f32_16x16x32_bf16 v[192:195], v[128:131], v[100:103], v[192:195]
ds_read_b64_tr_b16 v[84:85], v16 offset:8192
v_mfma_f32_16x16x32_bf16 v[200:203], v[128:131], v[104:107], v[200:203]
ds_read_b64_tr_b16 v[86:87], v16 offset:8704
v_mfma_f32_16x16x32_bf16 v[208:211], v[128:131], v[108:111], v[208:211]
ds_read_b64_tr_b16 v[88:89], v17 offset:8192
v_mfma_f32_16x16x32_bf16 v[216:219], v[128:131], v[112:115], v[216:219]
ds_read_b64_tr_b16 v[90:91], v17 offset:8704
v_mfma_f32_16x16x32_bf16 v[244:247], v[112:115], v[132:135], v[244:247]
ds_read_b64_tr_b16 v[92:93], v16 offset:16384
v_mfma_f32_16x16x32_bf16 v[248:251], v[112:115], v[136:139], v[248:251]
ds_read_b64_tr_b16 v[94:95], v16 offset:16896
v_mfma_f32_16x16x32_bf16 v[240:243], v[108:111], v[136:139], v[240:243]
ds_read_b64_tr_b16 v[96:97], v17 offset:16384
v_mfma_f32_16x16x32_bf16 v[236:239], v[108:111], v[132:135], v[236:239]
ds_read_b64_tr_b16 v[98:99], v17 offset:16896
v_mfma_f32_16x16x32_bf16 v[228:231], v[104:107], v[132:135], v[228:231]
ds_read_b64_tr_b16 v[76:77], v16 offset:0
v_mfma_f32_16x16x32_bf16 v[232:235], v[104:107], v[136:139], v[232:235]
ds_read_b64_tr_b16 v[78:79], v16 offset:512
v_mfma_f32_16x16x32_bf16 v[224:227], v[100:103], v[136:139], v[224:227]
ds_read_b64_tr_b16 v[80:81], v17 offset:0
v_mfma_f32_16x16x32_bf16 v[220:223], v[100:103], v[132:135], v[220:223]
ds_read_b64_tr_b16 v[82:83], v17 offset:512
v_mfma_f32_16x16x32_bf16 v[156:159], v[116:119], v[100:103], v[156:159]
v_mfma_f32_16x16x32_bf16 v[164:167], v[116:119], v[104:107], v[164:167]
v_mfma_f32_16x16x32_bf16 v[172:175], v[116:119], v[108:111], v[172:175]
v_mfma_f32_16x16x32_bf16 v[180:183], v[116:119], v[112:115], v[180:183]
v_mfma_f32_16x16x32_bf16 v[184:187], v[120:123], v[112:115], v[184:187]
v_mfma_f32_16x16x32_bf16 v[176:179], v[120:123], v[108:111], v[176:179]
v_mfma_f32_16x16x32_bf16 v[168:171], v[120:123], v[104:107], v[168:171]
s_waitcnt lgkmcnt(0)
v_mfma_f32_16x16x32_bf16 v[160:163], v[120:123], v[100:103], v[160:163]
s_branch c3_loop
c3_last:
v_mfma_f32_16x16x32_bf16 v[168:171], v[80:83], v[64:67], v[168:171]
s_waitcnt lgkmcnt(0)
v_mfma_f32_16x16x32_bf16 v[160:163], v[80:83], v[60:63], v[160:163]
v_mfma_f32_16x16x32_bf16 v[212:215], v[124:127], v[112:115], v[212:215]
ds_read_b64_tr_b16 v[10:11], v53 offset:0
ds_read_b64_tr_b16 v[12:13], v53 offset:1024
v_mfma_f32_16x16x32_bf16 v[204:207], v[124:127], v[108:111], v[204:207]
ds_read_b64_tr_b16 v[14:15], v53 offset:32
ds_read_b64_tr_b16 v[16:17], v53 offset:1056
v_mfma_f32_16x16x32_bf16 v[196:199], v[124:127], v[104:107], v[196:199]
ds_read_b128 v[140:143], v7 offset:0
s_mul_i32 s48, s44, 0x80008000
v_mfma_f32_16x16x32_bf16 v[188:191], v[124:127], v[100:103], v[188:191]
ds_read_b128 v[144:147], v7 offset:64
v_mfma_f32_16x16x32_bf16 v[192:195], v[128:131], v[100:103], v[192:195]
ds_read_b128 v[148:151], v7 offset:256
v_mfma_f32_16x16x32_bf16 v[200:203], v[128:131], v[104:107], v[200:203]
ds_read_b128 v[152:155], v7 offset:320
v_mfma_f32_16x16x32_bf16 v[208:211], v[128:131], v[108:111], v[208:211]
ds_read2_b32 v[56:57], v54 offset0:128 offset1:144
s_waitcnt lgkmcnt(5)
v_mfma_f32_16x16x32_bf16 v[216:219], v[128:131], v[112:115], v[216:219]
s_barrier
v_mfma_f32_16x16x32_bf16 v[244:247], v[112:115], v[132:135], v[244:247]
ds_read_b64 v[92:93], v8 offset:0
v_xor_b32 v10, s48, v10
v_mfma_f32_16x16x32_bf16 v[248:251], v[112:115], v[136:139], v[248:251]
ds_read_b64 v[94:95], v8 offset:128
v_xor_b32 v11, s48, v11
v_mfma_f32_16x16x32_bf16 v[240:243], v[108:111], v[136:139], v[240:243]
ds_read_b64 v[96:97], v8 offset:256
v_xor_b32 v12, s48, v12
v_mfma_f32_16x16x32_bf16 v[236:239], v[108:111], v[132:135], v[236:239]
ds_read_b64 v[98:99], v8 offset:384
v_xor_b32 v13, s48, v13
v_mfma_f32_16x16x32_bf16 v[228:231], v[104:107], v[132:135], v[228:231]
ds_read_b128 v[60:63], v9 offset:0
v_xor_b32 v14, s48, v14
v_mfma_f32_16x16x32_bf16 v[232:235], v[104:107], v[136:139], v[232:235]
ds_read_b128 v[64:67], v9 offset:64
v_xor_b32 v15, s48, v15
v_mfma_f32_16x16x32_bf16 v[224:227], v[100:103], v[136:139], v[224:227]
ds_read_b128 v[68:71], v9 offset:128
v_xor_b32 v16, s48, v16
v_mfma_f32_16x16x32_bf16 v[220:223], v[100:103], v[132:135], v[220:223]
ds_read_b128 v[72:75], v9 offset:192
v_xor_b32 v17, s48, v17
v_mfma_f32_16x16x32_bf16 v[156:159], v[116:119], v[100:103], v[156:159]
ds_read_b128 v[76:79], v9 offset:512
v_mfma_f32_16x16x32_bf16 v[164:167], v[116:119], v[104:107], v[164:167]
ds_read_b128 v[80:83], v9 offset:576
v_mfma_f32_16x16x32_bf16 v[172:175], v[116:119], v[108:111], v[172:175]
ds_read_b128 v[84:87], v9 offset:640
v_mfma_f32_16x16x32_bf16 v[180:183], v[116:119], v[112:115], v[180:183]
ds_read_b128 v[88:91], v9 offset:704
v_mfma_f32_16x16x32_bf16 v[184:187], v[120:123], v[112:115], v[184:187]
v_mfma_f32_16x16x32_bf16 v[176:179], v[120:123], v[108:111], v[176:179]
v_mfma_f32_16x16x32_bf16 v[168:171], v[120:123], v[104:107], v[168:171]
v_mfma_f32_16x16x32_bf16 v[160:163], v[120:123], v[100:103], v[160:163]
c3_epi:
s_waitcnt lgkmcnt(0)
.p2align 3
v_mul_f32 v129, s66, v94
v_mul_f32 v128, s66, v92
v_mul_f32 v131, s66, v98
v_mul_f32 v130, s66, v96
v_pk_fma_f32 v[190:191], v[150:151], v[92:93], v[190:191] op_sel:[0,1,0] op_sel_hi:[1,1,1]
v_pk_fma_f32 v[212:213], v[148:149], v[98:99], v[212:213] op_sel:[0,1,0] op_sel_hi:[1,1,1]
v_pk_fma_f32 v[214:215], v[150:151], v[98:99], v[214:215] op_sel:[0,1,0] op_sel_hi:[1,1,1]
v_pk_fma_f32 v[188:189], v[148:149], v[92:93], v[188:189] op_sel:[0,1,0] op_sel_hi:[1,1,1]
v_pk_fma_f32 v[218:219], v[154:155], v[98:99], v[218:219] op_sel:[0,1,0] op_sel_hi:[1,1,1]
v_cvt_pk_bf16_f32 v188, v188, v189
v_cvt_pk_bf16_f32 v189, v190, v191
v_pk_fma_f32 v[196:197], v[148:149], v[94:95], v[196:197] op_sel:[0,1,0] op_sel_hi:[1,1,1]
v_pk_fma_f32 v[200:201], v[152:153], v[94:95], v[200:201] op_sel:[0,1,0] op_sel_hi:[1,1,1]
v_pk_fma_f32 v[210:211], v[154:155], v[96:97], v[210:211] op_sel:[0,1,0] op_sel_hi:[1,1,1]
v_pk_fma_f32 v[240:241], v[84:85], v[56:57], v[240:241] op_sel:[0,1,0] op_sel_hi:[1,1,1]
v_pk_fma_f32 v[228:229], v[80:81], v[56:57], v[228:229] op_sel:[0,0,0] op_sel_hi:[1,0,1]
v_pk_fma_f32 v[226:227], v[78:79], v[56:57], v[226:227] op_sel:[0,1,0] op_sel_hi:[1,1,1]
v_pk_fma_f32 v[192:193], v[152:153], v[92:93], v[192:193] op_sel:[0,1,0] op_sel_hi:[1,1,1]
v_cvt_pk_bf16_f32 v190, v192, v193
v_pk_fma_f32 v[238:239], v[86:87], v[56:57], v[238:239] op_sel:[0,0,0] op_sel_hi:[1,0,1]
v_pk_fma_f32 v[234:235], v[82:83], v[56:57], v[234:235] op_sel:[0,1,0] op_sel_hi:[1,1,1]
v_pk_mul_f32 v[226:227], v[226:227], v[62:63]
v_pk_fma_f32 v[204:205], v[148:149], v[96:97], v[204:205] op_sel:[0,1,0] op_sel_hi:[1,1,1]
v_cvt_pk_bf16_f32 v204, v204, v205
v_pk_fma_f32 v[202:203], v[154:155], v[94:95], v[202:203] op_sel:[0,1,0] op_sel_hi:[1,1,1]
v_pk_fma_f32 v[224:225], v[76:77], v[56:57], v[224:225] op_sel:[0,1,0] op_sel_hi:[1,1,1]
v_pk_fma_f32 v[216:217], v[152:153], v[98:99], v[216:217] op_sel:[0,1,0] op_sel_hi:[1,1,1]
v_pk_fma_f32 v[244:245], v[88:89], v[56:57], v[244:245] op_sel:[0,0,0] op_sel_hi:[1,0,1]
v_pk_mul_f32 v[238:239], v[238:239], v[70:71]
v_pk_mul_f32 v[228:229], v[228:229], v[64:65]
v_pk_fma_f32 v[236:237], v[84:85], v[56:57], v[236:237] op_sel:[0,0,0] op_sel_hi:[1,0,1]
v_pk_fma_f32 v[220:221], v[76:77], v[56:57], v[220:221] op_sel:[0,0,0] op_sel_hi:[1,0,1]
v_pk_mul_f32 v[224:225], v[224:225], v[60:61]
v_cvt_pk_bf16_f32 v212, v212, v213
v_cvt_pk_bf16_f32 v213, v214, v215
v_cvt_pk_bf16_f32 v196, v196, v197
v_pk_mul_f32 v[240:241], v[240:241], v[68:69]
v_pk_fma_f32 v[198:199], v[150:151], v[94:95], v[198:199] op_sel:[0,1,0] op_sel_hi:[1,1,1]
v_cvt_pk_bf16_f32 v197, v198, v199
v_cvt_pk_bf16_f32 v198, v200, v201
v_cvt_pk_bf16_f32 v199, v202, v203
v_cvt_pk_bf16_f32 v215, v218, v219
v_pk_fma_f32 v[208:209], v[152:153], v[96:97], v[208:209] op_sel:[0,1,0] op_sel_hi:[1,1,1]
v_pk_fma_f32 v[246:247], v[90:91], v[56:57], v[246:247] op_sel:[0,0,0] op_sel_hi:[1,0,1]
v_pk_fma_f32 v[250:251], v[90:91], v[56:57], v[250:251] op_sel:[0,1,0] op_sel_hi:[1,1,1]
v_pk_mul_f32 v[250:251], v[250:251], v[74:75]
v_pk_fma_f32 v[206:207], v[150:151], v[96:97], v[206:207] op_sel:[0,1,0] op_sel_hi:[1,1,1]
v_cvt_pk_bf16_f32 v205, v206, v207
v_pk_fma_f32 v[242:243], v[86:87], v[56:57], v[242:243] op_sel:[0,1,0] op_sel_hi:[1,1,1]
v_cvt_pk_bf16_f32 v207, v210, v211
v_pk_mul_f32 v[236:237], v[236:237], v[68:69]
v_pk_fma_f32 v[230:231], v[82:83], v[56:57], v[230:231] op_sel:[0,0,0] op_sel_hi:[1,0,1]
v_pk_fma_f32 v[194:195], v[154:155], v[92:93], v[194:195] op_sel:[0,1,0] op_sel_hi:[1,1,1]
v_cvt_pk_bf16_f32 v191, v194, v195
v_pk_fma_f32 v[232:233], v[80:81], v[56:57], v[232:233] op_sel:[0,1,0] op_sel_hi:[1,1,1]
v_pk_mul_f32 v[232:233], v[232:233], v[64:65]
v_pk_mul_f32 v[230:231], v[230:231], v[66:67]
v_pk_fma_f32 v[248:249], v[88:89], v[56:57], v[248:249] op_sel:[0,1,0] op_sel_hi:[1,1,1]
v_pk_mul_f32 v[248:249], v[248:249], v[72:73]
v_pk_mul_f32 v[242:243], v[242:243], v[70:71]
v_mfma_f32_16x16x32_bf16 v[68:71], v[10:13], v[196:199], 0
v_cvt_pk_bf16_f32 v206, v208, v209
v_cvt_pk_bf16_f32 v214, v216, v217
v_cvt_pk_bf16_f32 v121, v226, v227
v_mfma_f32_16x16x32_bf16 v[80:83], v[14:17], v[204:207], 0
v_cvt_pk_bf16_f32 v120, v224, v225
v_cvt_pk_bf16_f32 v114, v228, v229
v_mfma_f32_16x16x32_bf16 v[84:87], v[10:13], v[212:215], 0
v_cvt_pk_bf16_f32 v116, v236, v237
v_min3_f32 v105, v68, v69, v70
v_mfma_f32_16x16x32_bf16 v[88:91], v[14:17], v[212:215], 0
v_max3_f32 v101, v68, v69, v70
v_cvt_pk_bf16_f32 v115, v230, v231
v_cvt_pk_bf16_f32 v122, v232, v233
v_cvt_pk_bf16_f32 v127, v250, v251
v_cvt_pk_bf16_f32 v124, v240, v241
v_pk_mul_f32 v[244:245], v[244:245], v[72:73]
v_pk_fma_f32 v[222:223], v[78:79], v[56:57], v[222:223] op_sel:[0,0,0] op_sel_hi:[1,0,1]
v_pk_mul_f32 v[222:223], v[222:223], v[62:63]
v_mfma_f32_16x16x32_bf16 v[76:79], v[10:13], v[204:207], 0
v_min3_f32 v107, v84, v85, v86
v_min3_f32 v107, v107, v87, v88
v_min3_f32 v107, v107, v89, v90
v_min_f32_e64 v107, v107, v91
v_max3_f32 v103, v84, v85, v86
v_pk_mul_f32 v[220:221], v[220:221], v[60:61]
v_mfma_f32_16x16x32_bf16 v[60:63], v[10:13], v[188:191], 0
v_max3_f32 v103, v103, v87, v88
v_min3_f32 v106, v76, v77, v78
v_min3_f32 v106, v106, v79, v80
v_min3_f32 v106, v106, v81, v82
v_min_f32 v106, v106, v83
v_pk_mul_f32 v[234:235], v[234:235], v[66:67]
v_mfma_f32_16x16x32_bf16 v[64:67], v[14:17], v[188:191], 0
v_permlane32_swap_b32 v106, v107
v_min3_f32 v104, v60, v61, v62
v_min_f32 v106, v106, v107
v_max3_f32 v103, v103, v89, v90
v_pk_mul_f32 v[246:247], v[246:247], v[74:75]
v_mfma_f32_16x16x32_bf16 v[72:75], v[14:17], v[196:199], 0
v_max_f32 v103, v103, v91
v_max3_f32 v102, v76, v77, v78
v_min3_f32 v104, v104, v63, v64
v_min3_f32 v104, v104, v65, v66
v_min_f32 v104, v104, v67
v_max3_f32 v102, v102, v79, v80
v_max3_f32 v102, v102, v81, v82
v_max_f32 v102, v102, v83
v_min3_f32 v105, v105, v71, v72
v_min3_f32 v105, v105, v73, v74
v_min_f32 v105, v105, v75
v_max3_f32 v101, v101, v71, v72
v_max3_f32 v101, v101, v73, v74
v_permlane32_swap_b32 v104, v105
v_permlane32_swap_b32 v102, v103
v_min_f32 v104, v104, v105
v_max_f32 v102, v102, v103
v_max_f32 v101, v101, v75
v_permlane16_swap_b32 v104, v106
v_max3_f32 v100, v60, v61, v62
v_min_f32 v104, v104, v106
v_mov_b32 v106, v104
v_max3_f32 v100, v100, v63, v64
v_max3_f32 v100, v100, v65, v66
v_max_f32 v100, v100, v67
v_permlane16_swap_b32 v104, v106
v_cvt_pk_bf16_f32 v112, v220, v221
v_permlane32_swap_b32 v100, v101
v_mov_b32 v105, v104
v_max_f32 v100, v100, v101
v_mov_b32 v107, v106
v_permlane32_swap_b32 v104, v105
v_permlane16_swap_b32 v100, v102
v_pk_mul_f32 v[104:105], v[104:105], v[128:129]
v_pk_fma_f32 v[226:227], v[66:67], v[128:129], v[104:105] op_sel:[0,0,0] op_sel_hi:[1,0,0] neg_lo:[1,0,0] neg_hi:[1,0,0]
v_pk_fma_f32 v[230:231], v[70:71], v[128:129], v[104:105] op_sel:[0,1,1] op_sel_hi:[1,1,1] neg_lo:[1,0,0] neg_hi:[1,0,0]
v_exp_f32 v226, v226
v_pk_fma_f32 v[224:225], v[64:65], v[128:129], v[104:105] op_sel:[0,0,0] op_sel_hi:[1,0,0] neg_lo:[1,0,0] neg_hi:[1,0,0]
v_exp_f32 v224, v224
v_pk_fma_f32 v[228:229], v[68:69], v[128:129], v[104:105] op_sel:[0,1,1] op_sel_hi:[1,1,1] neg_lo:[1,0,0] neg_hi:[1,0,0]
v_exp_f32 v231, v231
v_cvt_pk_bf16_f32 v113, v222, v223
v_pk_fma_f32 v[222:223], v[62:63], v[128:129], v[104:105] op_sel:[0,0,0] op_sel_hi:[1,0,0] neg_lo:[1,0,0] neg_hi:[1,0,0]
v_exp_f32 v222, v222
v_pk_fma_f32 v[220:221], v[60:61], v[128:129], v[104:105] op_sel:[0,0,0] op_sel_hi:[1,0,0] neg_lo:[1,0,0] neg_hi:[1,0,0]
v_exp_f32 v221, v221
v_exp_f32 v220, v220
v_max_f32 v100, v100, v102
v_exp_f32 v223, v223
v_mov_b32 v102, v100
v_pk_add_f32 v[110:111], v[220:221], v[222:223]
v_exp_f32 v225, v225
v_pk_fma_f32 v[232:233], v[72:73], v[128:129], v[104:105] op_sel:[0,1,1] op_sel_hi:[1,1,1] neg_lo:[1,0,0] neg_hi:[1,0,0]
v_exp_f32 v232, v232
v_exp_f32 v233, v233
v_pk_add_f32 v[110:111], v[110:111], v[224:225]
v_exp_f32 v229, v229
v_exp_f32 v228, v228
v_exp_f32 v227, v227
v_cvt_pk_bf16_f32 v123, v234, v235
v_pk_fma_f32 v[234:235], v[74:75], v[128:129], v[104:105] op_sel:[0,1,1] op_sel_hi:[1,1,1] neg_lo:[1,0,0] neg_hi:[1,0,0]
v_pk_add_f32 v[110:111], v[110:111], v[226:227]
v_add_f32 v104, v110, v111
v_cvt_pk_bf16_f32 v118, v244, v245
v_permlane32_swap_b32 v106, v107
v_permlane16_swap_b32 v100, v102
v_exp_f32 v234, v234
v_mov_b32 v101, v100
v_exp_f32 v235, v235
v_exp_f32_e64 v230, v230
v_cvt_pk_bf16_f32 v125, v242, v243
v_pk_add_f32 v[110:111], v[228:229], v[230:231]
v_pk_add_f32 v[110:111], v[110:111], v[232:233]
v_pk_add_f32 v[110:111], v[110:111], v[234:235]
v_cvt_pk_bf16_f32 v126, v248, v249
v_pk_mul_f32 v[106:107], v[106:107], v[130:131]
v_pk_fma_f32 v[236:237], v[76:77], v[130:131], v[106:107] op_sel:[0,0,0] op_sel_hi:[1,0,0] neg_lo:[1,0,0] neg_hi:[1,0,0]
v_exp_f32 v237, v237
v_exp_f32 v236, v236
v_pk_fma_f32 v[242:243], v[82:83], v[130:131], v[106:107] op_sel:[0,0,0] op_sel_hi:[1,0,0] neg_lo:[1,0,0] neg_hi:[1,0,0]
v_pk_fma_f32 v[250:251], v[90:91], v[130:131], v[106:107] op_sel:[0,1,1] op_sel_hi:[1,1,1] neg_lo:[1,0,0] neg_hi:[1,0,0]
v_add_f32 v105, v110, v111
v_exp_f32 v243, v243
v_cvt_pk_bf16_f32 v119, v246, v247
v_pk_fma_f32 v[246:247], v[86:87], v[130:131], v[106:107] op_sel:[0,1,1] op_sel_hi:[1,1,1] neg_lo:[1,0,0] neg_hi:[1,0,0]
v_exp_f32 v246, v246
v_cvt_pk_bf16_f32 v117, v238, v239
v_pk_fma_f32 v[238:239], v[78:79], v[130:131], v[106:107] op_sel:[0,0,0] op_sel_hi:[1,0,0] neg_lo:[1,0,0] neg_hi:[1,0,0]
v_exp_f32 v238, v238
v_exp_f32 v247, v247
v_pk_fma_f32 v[240:241], v[80:81], v[130:131], v[106:107] op_sel:[0,0,0] op_sel_hi:[1,0,0] neg_lo:[1,0,0] neg_hi:[1,0,0]
v_exp_f32 v240, v240
v_exp_f32 v241, v241
v_permlane32_swap_b32 v100, v101
v_exp_f32 v242, v242
v_pk_fma_f32 v[244:245], v[84:85], v[130:131], v[106:107] op_sel:[0,1,1] op_sel_hi:[1,1,1] neg_lo:[1,0,0] neg_hi:[1,0,0]
v_exp_f32 v244, v244
v_exp_f32_e64 v239, v239
v_pk_mul_f32 v[100:101], v[100:101], v[128:129]
v_pk_fma_f32 v[62:63], v[62:63], v[128:129], v[100:101] op_sel:[0,0,0] op_sel_hi:[1,0,0] neg_lo:[0,0,1] neg_hi:[0,0,1]
v_pk_add_f32 v[110:111], v[236:237], v[238:239]
v_pk_add_f32 v[110:111], v[110:111], v[240:241]
v_pk_add_f32 v[110:111], v[110:111], v[242:243]
v_pk_fma_f32 v[72:73], v[72:73], v[128:129], v[100:101] op_sel:[0,1,1] op_sel_hi:[1,1,1] neg_lo:[0,0,1] neg_hi:[0,0,1]
v_pk_fma_f32 v[66:67], v[66:67], v[128:129], v[100:101] op_sel:[0,0,0] op_sel_hi:[1,0,0] neg_lo:[0,0,1] neg_hi:[0,0,1]
v_exp_f32 v62, v62
v_pk_fma_f32 v[60:61], v[60:61], v[128:129], v[100:101] op_sel:[0,0,0] op_sel_hi:[1,0,0] neg_lo:[0,0,1] neg_hi:[0,0,1]
v_exp_f32 v60, v60
v_exp_f32 v245, v245
v_exp_f32 v73, v73
v_pk_fma_f32 v[248:249], v[88:89], v[130:131], v[106:107] op_sel:[0,1,1] op_sel_hi:[1,1,1] neg_lo:[1,0,0] neg_hi:[1,0,0]
v_add_f32 v106, v110, v111
v_exp_f32 v249, v249
v_pk_add_f32 v[110:111], v[244:245], v[246:247]
v_exp_f32 v248, v248
v_pk_fma_f32 v[64:65], v[64:65], v[128:129], v[100:101] op_sel:[0,0,0] op_sel_hi:[1,0,0] neg_lo:[0,0,1] neg_hi:[0,0,1]
v_exp_f32 v64, v64
v_pk_add_f32 v[110:111], v[110:111], v[248:249]
v_exp_f32 v65, v65
v_exp_f32 v61, v61
v_exp_f32 v66, v66
v_exp_f32 v251, v251
v_exp_f32 v63, v63
v_pk_fma_f32 v[74:75], v[74:75], v[128:129], v[100:101] op_sel:[0,1,1] op_sel_hi:[1,1,1] neg_lo:[0,0,1] neg_hi:[0,0,1]
v_pk_add_f32 v[108:109], v[60:61], v[62:63]
v_exp_f32 v67, v67
v_exp_f32 v250, v250
v_pk_fma_f32 v[68:69], v[68:69], v[128:129], v[100:101] op_sel:[0,1,1] op_sel_hi:[1,1,1] neg_lo:[0,0,1] neg_hi:[0,0,1]
v_pk_add_f32 v[110:111], v[110:111], v[250:251]
v_exp_f32 v68, v68
v_exp_f32 v69, v69
v_add_f32 v107, v110, v111
v_mov_b32 v103, v102
v_pk_fma_f32 v[70:71], v[70:71], v[128:129], v[100:101] op_sel:[0,1,1] op_sel_hi:[1,1,1] neg_lo:[0,0,1] neg_hi:[0,0,1]
v_exp_f32 v71, v71
v_exp_f32 v70, v70
v_permlane32_swap_b32 v106, v107
v_permlane32_swap_b32 v102, v103
v_pk_add_f32 v[108:109], v[108:109], v[64:65]
v_pk_add_f32 v[108:109], v[108:109], v[66:67]
v_add_f32 v100, v108, v109
v_pk_add_f32 v[108:109], v[68:69], v[70:71]
v_pk_mul_f32 v[102:103], v[102:103], v[130:131]
v_pk_fma_f32 v[78:79], v[78:79], v[130:131], v[102:103] op_sel:[0,0,0] op_sel_hi:[1,0,0] neg_lo:[0,0,1] neg_hi:[0,0,1]
v_exp_f32 v79, v79
v_exp_f32 v78, v78
v_exp_f32 v74, v74
v_exp_f32 v72, v72
v_pk_fma_f32 v[86:87], v[86:87], v[130:131], v[102:103] op_sel:[0,1,1] op_sel_hi:[1,1,1] neg_lo:[0,0,1] neg_hi:[0,0,1]
v_exp_f32 v87, v87
v_pk_fma_f32 v[76:77], v[76:77], v[130:131], v[102:103] op_sel:[0,0,0] op_sel_hi:[1,0,0] neg_lo:[0,0,1] neg_hi:[0,0,1]
v_exp_f32 v77, v77
v_add_f32 v106, v106, v107
v_pk_fma_f32 v[80:81], v[80:81], v[130:131], v[102:103] op_sel:[0,0,0] op_sel_hi:[1,0,0] neg_lo:[0,0,1] neg_hi:[0,0,1]
v_exp_f32 v81, v81
v_exp_f32 v80, v80
v_pk_add_f32 v[108:109], v[108:109], v[72:73]
v_permlane32_swap_b32 v104, v105
v_exp_f32 v75, v75
v_add_f32 v104, v104, v105
v_pk_fma_f32 v[82:83], v[82:83], v[130:131], v[102:103] op_sel:[0,0,0] op_sel_hi:[1,0,0] neg_lo:[0,0,1] neg_hi:[0,0,1]
v_exp_f32 v82, v82
v_exp_f32 v83, v83
v_permlane16_swap_b32 v104, v106
v_pk_add_f32 v[108:109], v[108:109], v[74:75]
v_add_f32 v101, v108, v109
v_exp_f32 v76, v76
v_add_f32 v104, v104, v106
v_rcp_f32 v104, v104
v_pk_fma_f32 v[84:85], v[84:85], v[130:131], v[102:103] op_sel:[0,1,1] op_sel_hi:[1,1,1] neg_lo:[0,0,1] neg_hi:[0,0,1]
v_exp_f32 v84, v84
v_exp_f32 v85, v85
v_mov_b32 v106, v104
v_pk_add_f32 v[108:109], v[76:77], v[78:79]
v_pk_add_f32 v[108:109], v[108:109], v[80:81]
v_pk_add_f32 v[108:109], v[108:109], v[82:83]
v_pk_fma_f32 v[88:89], v[88:89], v[130:131], v[102:103] op_sel:[0,1,1] op_sel_hi:[1,1,1] neg_lo:[0,0,1] neg_hi:[0,0,1]
v_exp_f32 v88, v88
v_exp_f32 v89, v89
v_exp_f32 v86, v86
v_pk_fma_f32 v[90:91], v[90:91], v[130:131], v[102:103] op_sel:[0,1,1] op_sel_hi:[1,1,1] neg_lo:[0,0,1] neg_hi:[0,0,1]
v_add_f32 v102, v108, v109
v_pk_add_f32 v[108:109], v[84:85], v[86:87]
v_pk_add_f32 v[108:109], v[108:109], v[88:89]
v_permlane16_swap_b32 v104, v106
v_exp_f32 v90, v90
v_exp_f32 v91, v91
v_permlane32_swap_b32 v100, v101
v_pk_add_f32 v[108:109], v[108:109], v[90:91]
v_add_f32 v103, v108, v109
v_add_f32 v100, v100, v101
v_mov_b32 v105, v104
v_permlane32_swap_b32 v102, v103
v_mov_b32 v107, v106
v_add_f32 v102, v102, v103
v_permlane32_swap_b32 v104, v105
v_permlane32_swap_b32 v106, v107
v_permlane16_swap_b32 v100, v102
v_pk_mul_f32 v[222:223], v[222:223], v[104:105] op_sel:[0,0] op_sel_hi:[1,0]
v_pk_mul_f32 v[226:227], v[226:227], v[104:105] op_sel:[0,0] op_sel_hi:[1,0]
v_pk_mul_f32 v[234:235], v[234:235], v[104:105] op_sel:[0,1] op_sel_hi:[1,1]
v_pk_mul_f32 v[232:233], v[232:233], v[104:105] op_sel:[0,1] op_sel_hi:[1,1]
v_pk_mul_f32 v[230:231], v[230:231], v[104:105] op_sel:[0,1] op_sel_hi:[1,1]
v_add_f32 v100, v100, v102
v_pk_mul_f32 v[228:229], v[228:229], v[104:105] op_sel:[0,1] op_sel_hi:[1,1]
v_cvt_pk_bf16_f32 v228, v228, v229
v_cvt_pk_bf16_f32 v229, v230, v231
v_cvt_pk_bf16_f32 v231, v234, v235
v_cvt_pk_bf16_f32 v230, v232, v233
v_pk_mul_f32 v[220:221], v[220:221], v[104:105] op_sel:[0,0] op_sel_hi:[1,0]
v_cvt_pk_bf16_f32 v220, v220, v221
v_pk_mul_f32 v[224:225], v[224:225], v[104:105] op_sel:[0,0] op_sel_hi:[1,0]
v_pk_mul_f32 v[236:237], v[236:237], v[106:107] op_sel:[0,0] op_sel_hi:[1,0]
v_pk_mul_f32 v[238:239], v[238:239], v[106:107] op_sel:[0,0] op_sel_hi:[1,0]
v_pk_mul_f32 v[240:241], v[240:241], v[106:107] op_sel:[0,0] op_sel_hi:[1,0]
v_pk_mul_f32 v[242:243], v[242:243], v[106:107] op_sel:[0,0] op_sel_hi:[1,0]
v_pk_mul_f32 v[248:249], v[248:249], v[106:107] op_sel:[0,1] op_sel_hi:[1,1]
v_rcp_f32 v100, v100
v_pk_mul_f32 v[244:245], v[244:245], v[106:107] op_sel:[0,1] op_sel_hi:[1,1]
v_mov_b32 v102, v100
v_pk_mul_f32 v[250:251], v[250:251], v[106:107] op_sel:[0,1] op_sel_hi:[1,1]
v_cvt_pk_bf16_f32 v221, v222, v223
v_pk_mul_f32 v[246:247], v[246:247], v[106:107] op_sel:[0,1] op_sel_hi:[1,1]
v_cvt_pk_bf16_f32 v222, v224, v225
v_mfma_f32_16x16x32_bf16 v[200:203], v[228:231], v[36:39], 0
v_cvt_pk_bf16_f32 v223, v226, v227
v_permlane16_swap_b32 v100, v102
v_mfma_f32_16x16x32_bf16 v[196:199], v[228:231], v[38:41], 0
v_mov_b32 v101, v100
v_cvt_pk_bf16_f32 v244, v244, v245
v_mfma_f32_16x16x32_bf16 v[212:215], v[220:223], v[38:41], 0
v_cvt_pk_bf16_f32 v245, v246, v247
v_cvt_pk_bf16_f32 v247, v250, v251
v_mfma_f32_16x16x32_bf16 v[216:219], v[220:223], v[36:39], 0
v_cvt_pk_bf16_f32 v234, v200, v201
v_cvt_pk_bf16_f32 v246, v248, v249
v_cvt_pk_bf16_f32 v226, v196, v197
v_cvt_pk_bf16_f32 v227, v198, v199
v_mfma_f32_16x16x32_bf16 v[196:199], v[244:247], v[38:41], 0
v_cvt_pk_bf16_f32 v225, v214, v215
v_cvt_pk_bf16_f32 v236, v236, v237
v_cvt_pk_bf16_f32 v237, v238, v239
v_cvt_pk_bf16_f32 v232, v216, v217
v_cvt_pk_bf16_f32 v233, v218, v219
v_cvt_pk_bf16_f32 v239, v242, v243
v_cvt_pk_bf16_f32 v238, v240, v241
v_cvt_pk_bf16_f32 v224, v212, v213
v_permlane32_swap_b32 v100, v101
v_mfma_f32_16x16x32_bf16 v[216:219], v[236:239], v[36:39], 0
v_mov_b32 v103, v102
v_cvt_pk_bf16_f32 v235, v202, v203
v_mfma_f32_16x16x32_bf16 v[212:215], v[236:239], v[38:41], 0
v_cvt_pk_bf16_f32 v243, v198, v199
v_permlane32_swap_b32 v102, v103
v_mfma_f32_16x16x32_bf16 v[200:203], v[244:247], v[36:39], 0
v_cvt_pk_bf16_f32 v242, v196, v197
v_mov_b32 v5, s61
v_mfma_f32_16x16x32_bf16 v[220:223], v[232:235], v[120:123], 0
v_cvt_pk_bf16_f32 v249, v218, v219
v_cvt_pk_bf16_f32 v248, v216, v217
v_cvt_pk_bf16_f32 v241, v214, v215
v_cvt_pk_bf16_f32 v240, v212, v213
v_cmp_eq_u32 s[50:51], s41, v2
v_pk_mul_f32 v[64:65], v[64:65], v[100:101] op_sel:[0,0] op_sel_hi:[1,0]
v_pk_mul_f32 v[74:75], v[74:75], v[100:101] op_sel:[0,1] op_sel_hi:[1,1]
v_pk_mul_f32 v[68:69], v[68:69], v[100:101] op_sel:[0,1] op_sel_hi:[1,1]
v_pk_mul_f32 v[72:73], v[72:73], v[100:101] op_sel:[0,1] op_sel_hi:[1,1]
v_pk_mul_f32 v[60:61], v[60:61], v[100:101] op_sel:[0,0] op_sel_hi:[1,0]
v_pk_mul_f32 v[62:63], v[62:63], v[100:101] op_sel:[0,0] op_sel_hi:[1,0]
v_pk_mul_f32 v[66:67], v[66:67], v[100:101] op_sel:[0,0] op_sel_hi:[1,0]
v_pk_mul_f32 v[76:77], v[76:77], v[102:103] op_sel:[0,0] op_sel_hi:[1,0]
v_pk_mul_f32 v[70:71], v[70:71], v[100:101] op_sel:[0,1] op_sel_hi:[1,1]
v_cvt_pk_bf16_f32 v60, v60, v61
v_pk_mul_f32 v[80:81], v[80:81], v[102:103] op_sel:[0,0] op_sel_hi:[1,0]
v_pk_mul_f32 v[78:79], v[78:79], v[102:103] op_sel:[0,0] op_sel_hi:[1,0]
v_pk_mul_f32 v[82:83], v[82:83], v[102:103] op_sel:[0,0] op_sel_hi:[1,0]
v_pk_mul_f32 v[86:87], v[86:87], v[102:103] op_sel:[0,1] op_sel_hi:[1,1]
v_cvt_pk_bf16_f32 v61, v62, v63
v_pk_mul_f32 v[84:85], v[84:85], v[102:103] op_sel:[0,1] op_sel_hi:[1,1]
v_cvt_pk_bf16_f32 v62, v64, v65
v_pk_mul_f32 v[88:89], v[88:89], v[102:103] op_sel:[0,1] op_sel_hi:[1,1]
v_cvt_pk_bf16_f32 v63, v66, v67
v_pk_mul_f32 v[90:91], v[90:91], v[102:103] op_sel:[0,1] op_sel_hi:[1,1]
v_cvt_pk_bf16_f32 v68, v68, v69
v_mfma_f32_16x16x32_bf16 v[208:211], v[60:63], v[36:39], 0
v_cvt_pk_bf16_f32 v69, v70, v71
v_cvt_pk_bf16_f32 v70, v72, v73
v_mfma_f32_16x16x32_bf16 v[204:207], v[60:63], v[38:41], 0
v_cvt_pk_bf16_f32 v71, v74, v75
v_cvt_pk_bf16_f32 v76, v76, v77
v_mfma_f32_16x16x32_bf16 v[60:63], v[232:235], v[112:115], 0
v_cvt_pk_bf16_f32 v250, v200, v201
v_cvt_pk_bf16_f32 v77, v78, v79
v_mfma_f32_16x16x32_bf16 v[192:195], v[68:71], v[36:39], 0
v_cvt_pk_bf16_f32 v78, v80, v81
v_cvt_pk_bf16_f32 v79, v82, v83
v_mfma_f32_16x16x32_bf16 v[188:191], v[68:71], v[38:41], 0
v_cvt_pk_bf16_f32 v65, v206, v207
v_cvt_pk_bf16_f32 v64, v204, v205
v_mfma_f32_16x16x32_bf16 v[68:71], v[224:227], v[120:123], 0
v_cvt_pk_bf16_f32 v251, v202, v203
v_cvt_pk_bf16_f32 v72, v208, v209
v_mfma_f32_16x16x32_bf16 v[152:155], v[224:227], v[112:115], 0
v_cvt_pk_bf16_f32 v73, v210, v211
v_cvt_pk_bf16_f32 v84, v84, v85
v_mfma_f32_16x16x32_bf16 v[60:63], v[248:251], v[116:119], v[60:63]
v_cvt_pk_bf16_f32 v85, v86, v87
v_cvt_pk_bf16_f32 v86, v88, v89
v_mfma_f32_16x16x32_bf16 v[228:231], v[224:227], v[48:51], 0
v_cvt_pk_bf16_f32 v67, v190, v191
v_cvt_pk_bf16_f32 v87, v90, v91
v_mfma_f32_16x16x32_bf16 v[220:223], v[248:251], v[124:127], v[220:223]
v_cvt_pk_bf16_f32 v66, v188, v189
v_cvt_pk_bf16_f32 v74, v192, v193
v_mfma_f32_16x16x32_bf16 v[152:155], v[240:243], v[116:119], v[152:155]
v_cvt_pk_bf16_f32 v75, v194, v195
v_mfma_f32_16x16x32_bf16 v[204:207], v[76:79], v[38:41], 0
v_mfma_f32_16x16x32_bf16 v[208:211], v[76:79], v[36:39], 0
v_mfma_f32_16x16x32_bf16 v[228:231], v[240:243], v[48:51], v[228:231]
v_mfma_f32_16x16x32_bf16 v[68:71], v[240:243], v[124:127], v[68:71]
v_mfma_f32_16x16x32_bf16 v[76:79], v[232:235], v[48:51], 0
s_nop 1
v_cvt_pk_bf16_f32 v152, v152, v153
v_mfma_f32_16x16x32_bf16 v[76:79], v[248:251], v[48:51], v[76:79]
v_cvt_pk_bf16_f32 v153, v154, v155
v_cvt_pk_bf16_f32 v154, v60, v61
v_mfma_f32_16x16x32_bf16 v[192:195], v[84:87], v[36:39], 0
v_cvt_pk_bf16_f32 v68, v68, v69
v_cvt_pk_bf16_f32 v155, v62, v63
v_mfma_f32_16x16x32_bf16 v[188:191], v[84:87], v[38:41], 0
ds_write_b128 v42, v[152:155] offset:0
v_mfma_f32_16x16x32_bf16 v[136:139], v[64:67], v[48:51], 0
v_cvt_pk_bf16_f32 v69, v70, v71
v_cvt_pk_bf16_f32 v228, v228, v229
v_mfma_f32_16x16x32_bf16 v[104:107], v[72:75], v[112:115], 0
v_cvt_pk_bf16_f32 v71, v222, v223
v_cvt_pk_bf16_f32 v229, v230, v231
v_mfma_f32_16x16x32_bf16 v[148:151], v[72:75], v[48:51], 0
v_cvt_pk_bf16_f32 v230, v76, v77
v_cvt_pk_bf16_f32 v70, v220, v221
v_mfma_f32_16x16x32_bf16 v[132:135], v[72:75], v[120:123], 0
ds_write_b128 v42, v[68:71] offset:1024
v_mfma_f32_16x16x32_bf16 v[108:111], v[64:67], v[120:123], 0
v_cvt_pk_bf16_f32 v231, v78, v79
ds_write_b128 v42, v[228:231] offset:2048
v_mfma_f32_16x16x32_bf16 v[100:103], v[64:67], v[112:115], 0
ds_write_b32 v52, v5
v_cvt_pk_bf16_f32 v88, v208, v209
v_cvt_pk_bf16_f32 v83, v190, v191
v_cvt_pk_bf16_f32 v91, v194, v195
v_cvt_pk_bf16_f32 v82, v188, v189
v_cvt_pk_bf16_f32 v80, v204, v205
v_cvt_pk_bf16_f32 v89, v210, v211
v_cvt_pk_bf16_f32 v81, v206, v207
v_cvt_pk_bf16_f32 v90, v192, v193
s_nop 0
v_mfma_f32_16x16x32_bf16 v[100:103], v[80:83], v[116:119], v[100:103]
v_mfma_f32_16x16x32_bf16 v[108:111], v[80:83], v[124:127], v[108:111]
v_mfma_f32_16x16x32_bf16 v[132:135], v[88:91], v[124:127], v[132:135]
v_mfma_f32_16x16x32_bf16 v[148:151], v[88:91], v[48:51], v[148:151]
v_mfma_f32_16x16x32_bf16 v[136:139], v[80:83], v[48:51], v[136:139]
v_mfma_f32_16x16x32_bf16 v[104:107], v[88:91], v[116:119], v[104:107]
s_mov_b32 s63, 0
px_122:
ds_read_b32 v4, v19
ds_read_b128 v[188:191], v43 offset:0
ds_read_b128 v[192:195], v43 offset:1024
ds_read_b128 v[196:199], v43 offset:2048
s_add_u32 s63, s63, 1
s_cmp_lt_u32 s63, 0x400000
s_waitcnt lgkmcnt(0)
v_cmp_ne_u32 vcc, s61, v4
s_cbranch_vccz pxd_123
s_cbranch_scc1 px_122
pxd_123:
v_mfma_f32_16x16x32_bf16 v[100:103], v[38:41], v[188:191], v[100:103]
v_mfma_f32_16x16x32_bf16 v[104:107], v[36:39], v[188:191], v[104:107]
v_mfma_f32_16x16x32_bf16 v[108:111], v[38:41], v[192:195], v[108:111]
v_mfma_f32_16x16x32_bf16 v[132:135], v[36:39], v[192:195], v[132:135]
v_mfma_f32_16x16x32_bf16 v[136:139], v[38:41], v[196:199], v[136:139]
v_mfma_f32_16x16x32_bf16 v[148:151], v[36:39], v[196:199], v[148:151]
s_nop 2
v_cvt_pk_bf16_f32 v100, v100, v101
v_cvt_pk_bf16_f32 v101, v102, v103
v_cvt_pk_bf16_f32 v102, v104, v105
v_cvt_pk_bf16_f32 v103, v106, v107
buffer_store_dwordx4 v[100:103], v55, s[32:35], s53 offen sc1
v_cvt_pk_bf16_f32 v108, v108, v109
v_cvt_pk_bf16_f32 v109, v110, v111
v_cvt_pk_bf16_f32 v110, v132, v133
v_cvt_pk_bf16_f32 v111, v134, v135
buffer_store_dwordx4 v[108:111], v55, s[32:35], s54 offen sc1
v_cvt_pk_bf16_f32 v136, v136, v137
v_cvt_pk_bf16_f32 v137, v138, v139
v_cvt_pk_bf16_f32 v138, v148, v149
v_cvt_pk_bf16_f32 v139, v150, v151
s_mov_b64 exec, s[50:51]
buffer_store_dwordx4 v[136:139], v58, s[32:35], s56 offen sc1
s_mov_b64 exec, -1
s_mov_b32 s51, 0
.p2align 3
v_pk_fma_f32 v[156:157], v[140:141], v[92:93], v[156:157] op_sel:[0,1,0] op_sel_hi:[1,1,1]
v_pk_fma_f32 v[164:165], v[140:141], v[94:95], v[164:165] op_sel:[0,1,0] op_sel_hi:[1,1,1]
v_pk_fma_f32 v[172:173], v[140:141], v[96:97], v[172:173] op_sel:[0,1,0] op_sel_hi:[1,1,1]
v_pk_fma_f32 v[180:181], v[140:141], v[98:99], v[180:181] op_sel:[0,1,0] op_sel_hi:[1,1,1]
v_pk_fma_f32 v[158:159], v[142:143], v[92:93], v[158:159] op_sel:[0,1,0] op_sel_hi:[1,1,1]
v_cvt_pk_bf16_f32 v156, v156, v157
v_pk_fma_f32 v[166:167], v[142:143], v[94:95], v[166:167] op_sel:[0,1,0] op_sel_hi:[1,1,1]
v_cvt_pk_bf16_f32 v164, v164, v165
v_pk_fma_f32 v[174:175], v[142:143], v[96:97], v[174:175] op_sel:[0,1,0] op_sel_hi:[1,1,1]
v_cvt_pk_bf16_f32 v172, v172, v173
v_pk_fma_f32 v[182:183], v[142:143], v[98:99], v[182:183] op_sel:[0,1,0] op_sel_hi:[1,1,1]
v_cvt_pk_bf16_f32 v180, v180, v181
v_pk_fma_f32 v[160:161], v[144:145], v[92:93], v[160:161] op_sel:[0,1,0] op_sel_hi:[1,1,1]
v_pk_fma_f32 v[162:163], v[146:147], v[92:93], v[162:163] op_sel:[0,1,0] op_sel_hi:[1,1,1]
v_cvt_pk_bf16_f32 v157, v158, v159
v_pk_fma_f32 v[168:169], v[144:145], v[94:95], v[168:169] op_sel:[0,1,0] op_sel_hi:[1,1,1]
v_pk_fma_f32 v[170:171], v[146:147], v[94:95], v[170:171] op_sel:[0,1,0] op_sel_hi:[1,1,1]
v_cvt_pk_bf16_f32 v165, v166, v167
v_pk_fma_f32 v[176:177], v[144:145], v[96:97], v[176:177] op_sel:[0,1,0] op_sel_hi:[1,1,1]
v_pk_fma_f32 v[178:179], v[146:147], v[96:97], v[178:179] op_sel:[0,1,0] op_sel_hi:[1,1,1]
v_cvt_pk_bf16_f32 v173, v174, v175
v_pk_fma_f32 v[184:185], v[144:145], v[98:99], v[184:185] op_sel:[0,1,0] op_sel_hi:[1,1,1]
v_pk_fma_f32 v[186:187], v[146:147], v[98:99], v[186:187] op_sel:[0,1,0] op_sel_hi:[1,1,1]
v_cvt_pk_bf16_f32 v181, v182, v183
v_cvt_pk_bf16_f32 v158, v160, v161
v_cvt_pk_bf16_f32 v159, v162, v163
v_cvt_pk_bf16_f32 v166, v168, v169
v_cvt_pk_bf16_f32 v167, v170, v171
v_mfma_f32_16x16x32_bf16 v[60:63], v[10:13], v[156:159], 0
v_cvt_pk_bf16_f32 v174, v176, v177
v_cvt_pk_bf16_f32 v175, v178, v179
v_mfma_f32_16x16x32_bf16 v[68:71], v[10:13], v[164:167], 0
v_cvt_pk_bf16_f32 v182, v184, v185
v_cvt_pk_bf16_f32 v183, v186, v187
v_mfma_f32_16x16x32_bf16 v[76:79], v[10:13], v[172:175], 0
s_nop 0
v_mfma_f32_16x16x32_bf16 v[84:87], v[10:13], v[180:183], 0
v_min3_f32 v104, v60, v61, v62
v_max3_f32 v100, v60, v61, v62
v_mfma_f32_16x16x32_bf16 v[64:67], v[14:17], v[156:159], 0
v_min3_f32 v105, v68, v69, v70
v_max3_f32 v101, v68, v69, v70
v_mfma_f32_16x16x32_bf16 v[72:75], v[14:17], v[164:167], 0
v_min3_f32 v106, v76, v77, v78
v_max3_f32 v102, v76, v77, v78
v_mfma_f32_16x16x32_bf16 v[80:83], v[14:17], v[172:175], 0
v_min3_f32 v107, v84, v85, v86
v_max3_f32 v103, v84, v85, v86
v_mfma_f32_16x16x32_bf16 v[88:91], v[14:17], v[180:183], 0
v_min3_f32 v104, v104, v63, v64
v_max3_f32 v100, v100, v63, v64
v_min3_f32 v105, v105, v71, v72
v_min3_f32 v104, v104, v65, v66
v_max3_f32 v101, v101, v71, v72
v_min3_f32 v106, v106, v79, v80
v_min3_f32 v105, v105, v73, v74
v_max3_f32 v102, v102, v79, v80
v_min3_f32 v107, v107, v87, v88
v_min3_f32 v106, v106, v81, v82
v_max3_f32 v103, v103, v87, v88
v_min3_f32 v107, v107, v89, v90
v_max3_f32 v100, v100, v65, v66
v_min_f32 v104, v104, v67
v_max3_f32 v101, v101, v73, v74
v_min_f32 v105, v105, v75
v_max3_f32 v102, v102, v81, v82
v_min_f32 v106, v106, v83
v_max3_f32 v103, v103, v89, v90
v_min_f32 v107, v107, v91
v_max_f32 v100, v100, v67
v_max_f32 v101, v101, v75
v_max_f32 v102, v102, v83
v_max_f32 v103, v103, v91
v_permlane32_swap_b32 v104, v105
v_permlane32_swap_b32 v106, v107
v_permlane32_swap_b32 v100, v101
v_permlane32_swap_b32 v102, v103
v_min_f32 v104, v104, v105
v_min_f32 v106, v106, v107
v_max_f32 v100, v100, v101
v_max_f32 v102, v102, v103
v_permlane16_swap_b32 v104, v106
s_nop 0
v_permlane16_swap_b32 v100, v102
v_min_f32 v104, v104, v106
v_max_f32 v100, v100, v102
v_mov_b32 v106, v104
v_mov_b32 v102, v100
s_nop 0
v_permlane16_swap_b32 v104, v106
v_permlane16_swap_b32 v100, v102
v_mov_b32 v105, v104
v_mov_b32 v101, v100
v_mov_b32 v103, v102
v_permlane32_swap_b32 v104, v105
v_mov_b32 v107, v106
v_permlane32_swap_b32_e64 v100, v101
v_pk_mul_f32 v[104:105], v[104:105], v[128:129]
v_pk_mul_f32 v[100:101], v[100:101], v[128:129]
v_pk_fma_f32 v[220:221], v[60:61], v[128:129], v[104:105] op_sel:[0,0,0] op_sel_hi:[1,0,0] neg_lo:[1,0,0] neg_hi:[1,0,0]
v_pk_fma_f32 v[222:223], v[62:63], v[128:129], v[104:105] op_sel:[0,0,0] op_sel_hi:[1,0,0] neg_lo:[1,0,0] neg_hi:[1,0,0]
v_pk_fma_f32 v[224:225], v[64:65], v[128:129], v[104:105] op_sel:[0,0,0] op_sel_hi:[1,0,0] neg_lo:[1,0,0] neg_hi:[1,0,0]
v_pk_fma_f32 v[226:227], v[66:67], v[128:129], v[104:105] op_sel:[0,0,0] op_sel_hi:[1,0,0] neg_lo:[1,0,0] neg_hi:[1,0,0]
v_pk_fma_f32 v[228:229], v[68:69], v[128:129], v[104:105] op_sel:[0,1,1] op_sel_hi:[1,1,1] neg_lo:[1,0,0] neg_hi:[1,0,0]
v_pk_fma_f32 v[230:231], v[70:71], v[128:129], v[104:105] op_sel:[0,1,1] op_sel_hi:[1,1,1] neg_lo:[1,0,0] neg_hi:[1,0,0]
v_pk_fma_f32 v[232:233], v[72:73], v[128:129], v[104:105] op_sel:[0,1,1] op_sel_hi:[1,1,1] neg_lo:[1,0,0] neg_hi:[1,0,0]
v_pk_fma_f32 v[234:235], v[74:75], v[128:129], v[104:105] op_sel:[0,1,1] op_sel_hi:[1,1,1] neg_lo:[1,0,0] neg_hi:[1,0,0]
v_permlane32_swap_b32 v102, v103
v_permlane32_swap_b32 v106, v107
v_pk_fma_f32 v[60:61], v[60:61], v[128:129], v[100:101] op_sel:[0,0,0] op_sel_hi:[1,0,0] neg_lo:[0,0,1] neg_hi:[0,0,1]
v_pk_fma_f32 v[62:63], v[62:63], v[128:129], v[100:101] op_sel:[0,0,0] op_sel_hi:[1,0,0] neg_lo:[0,0,1] neg_hi:[0,0,1]
v_pk_fma_f32 v[64:65], v[64:65], v[128:129], v[100:101] op_sel:[0,0,0] op_sel_hi:[1,0,0] neg_lo:[0,0,1] neg_hi:[0,0,1]
v_pk_fma_f32 v[66:67], v[66:67], v[128:129], v[100:101] op_sel:[0,0,0] op_sel_hi:[1,0,0] neg_lo:[0,0,1] neg_hi:[0,0,1]
v_pk_fma_f32 v[68:69], v[68:69], v[128:129], v[100:101] op_sel:[0,1,1] op_sel_hi:[1,1,1] neg_lo:[0,0,1] neg_hi:[0,0,1]
v_pk_fma_f32 v[70:71], v[70:71], v[128:129], v[100:101] op_sel:[0,1,1] op_sel_hi:[1,1,1] neg_lo:[0,0,1] neg_hi:[0,0,1]
v_pk_fma_f32 v[72:73], v[72:73], v[128:129], v[100:101] op_sel:[0,1,1] op_sel_hi:[1,1,1] neg_lo:[0,0,1] neg_hi:[0,0,1]
v_pk_fma_f32 v[74:75], v[74:75], v[128:129], v[100:101] op_sel:[0,1,1] op_sel_hi:[1,1,1] neg_lo:[0,0,1] neg_hi:[0,0,1]
v_exp_f32 v220, v220
v_exp_f32 v60, v60
v_exp_f32 v221, v221
v_exp_f32 v61, v61
v_exp_f32 v222, v222
v_exp_f32 v62, v62
v_exp_f32 v223, v223
v_exp_f32 v63, v63
v_exp_f32 v224, v224
v_exp_f32 v64, v64
v_exp_f32 v225, v225
v_exp_f32 v65, v65
v_exp_f32 v226, v226
v_exp_f32 v66, v66
v_exp_f32 v227, v227
v_exp_f32 v67, v67
v_exp_f32 v228, v228
v_exp_f32 v68, v68
v_exp_f32 v229, v229
v_exp_f32 v69, v69
v_exp_f32 v230, v230
v_exp_f32 v70, v70
v_exp_f32 v231, v231
v_exp_f32 v71, v71
v_exp_f32 v232, v232
v_exp_f32 v72, v72
v_exp_f32 v233, v233
v_exp_f32 v73, v73
v_exp_f32 v234, v234
v_exp_f32 v74, v74
v_exp_f32 v235, v235
v_exp_f32 v75, v75
v_pk_mul_f32 v[102:103], v[102:103], v[130:131]
v_pk_mul_f32 v[106:107], v[106:107], v[130:131]
buffer_load_dwordx4 v[212:215], v18, s[32:35], s55 offen offset:0 sc1
buffer_load_dwordx4 v[216:219], v18, s[32:35], s55 offen offset:1024 sc1
.p2align 3
v_pk_add_f32 v[108:109], v[60:61], v[62:63]
v_pk_add_f32 v[110:111], v[220:221], v[222:223]
v_pk_add_f32 v[108:109], v[108:109], v[64:65]
v_pk_add_f32 v[110:111], v[110:111], v[224:225]
v_pk_add_f32 v[108:109], v[108:109], v[66:67]
v_pk_add_f32 v[110:111], v[110:111], v[226:227]
v_add_f32 v100, v108, v109
v_add_f32 v104, v110, v111
v_pk_fma_f32 v[236:237], v[76:77], v[130:131], v[106:107] op_sel:[0,0,0] op_sel_hi:[1,0,0] neg_lo:[1,0,0] neg_hi:[1,0,0]
v_pk_fma_f32 v[238:239], v[78:79], v[130:131], v[106:107] op_sel:[0,0,0] op_sel_hi:[1,0,0] neg_lo:[1,0,0] neg_hi:[1,0,0]
v_pk_add_f32 v[108:109], v[68:69], v[70:71]
v_pk_add_f32 v[110:111], v[228:229], v[230:231]
v_pk_fma_f32 v[76:77], v[76:77], v[130:131], v[102:103] op_sel:[0,0,0] op_sel_hi:[1,0,0] neg_lo:[0,0,1] neg_hi:[0,0,1]
v_pk_fma_f32 v[78:79], v[78:79], v[130:131], v[102:103] op_sel:[0,0,0] op_sel_hi:[1,0,0] neg_lo:[0,0,1] neg_hi:[0,0,1]
v_pk_fma_f32 v[240:241], v[80:81], v[130:131], v[106:107] op_sel:[0,0,0] op_sel_hi:[1,0,0] neg_lo:[1,0,0] neg_hi:[1,0,0]
v_pk_add_f32 v[108:109], v[108:109], v[72:73]
v_pk_add_f32 v[110:111], v[110:111], v[232:233]
v_exp_f32 v236, v236
v_exp_f32 v76, v76
v_exp_f32 v237, v237
v_exp_f32 v77, v77
v_exp_f32 v238, v238
v_exp_f32 v78, v78
v_exp_f32 v239, v239
v_exp_f32 v79, v79
v_pk_fma_f32 v[80:81], v[80:81], v[130:131], v[102:103] op_sel:[0,0,0] op_sel_hi:[1,0,0] neg_lo:[0,0,1] neg_hi:[0,0,1]
v_pk_fma_f32 v[242:243], v[82:83], v[130:131], v[106:107] op_sel:[0,0,0] op_sel_hi:[1,0,0] neg_lo:[1,0,0] neg_hi:[1,0,0]
v_pk_add_f32 v[108:109], v[108:109], v[74:75]
v_pk_add_f32 v[110:111], v[110:111], v[234:235]
v_exp_f32 v240, v240
v_exp_f32 v80, v80
v_exp_f32 v241, v241
v_exp_f32 v81, v81
v_pk_fma_f32 v[82:83], v[82:83], v[130:131], v[102:103] op_sel:[0,0,0] op_sel_hi:[1,0,0] neg_lo:[0,0,1] neg_hi:[0,0,1]
v_add_f32 v101, v108, v109
v_add_f32 v105, v110, v111
v_exp_f32 v242, v242
v_exp_f32 v82, v82
v_exp_f32 v243, v243
v_exp_f32 v83, v83
v_pk_fma_f32 v[244:245], v[84:85], v[130:131], v[106:107] op_sel:[0,1,1] op_sel_hi:[1,1,1] neg_lo:[1,0,0] neg_hi:[1,0,0]
v_pk_fma_f32 v[246:247], v[86:87], v[130:131], v[106:107] op_sel:[0,1,1] op_sel_hi:[1,1,1] neg_lo:[1,0,0] neg_hi:[1,0,0]
v_pk_add_f32 v[108:109], v[76:77], v[78:79]
v_pk_add_f32 v[110:111], v[236:237], v[238:239]
v_pk_fma_f32 v[84:85], v[84:85], v[130:131], v[102:103] op_sel:[0,1,1] op_sel_hi:[1,1,1] neg_lo:[0,0,1] neg_hi:[0,0,1]
v_pk_fma_f32 v[86:87], v[86:87], v[130:131], v[102:103] op_sel:[0,1,1] op_sel_hi:[1,1,1] neg_lo:[0,0,1] neg_hi:[0,0,1]
v_pk_fma_f32 v[248:249], v[88:89], v[130:131], v[106:107] op_sel:[0,1,1] op_sel_hi:[1,1,1] neg_lo:[1,0,0] neg_hi:[1,0,0]
v_pk_fma_f32 v[250:251], v[90:91], v[130:131], v[106:107] op_sel:[0,1,1] op_sel_hi:[1,1,1] neg_lo:[1,0,0] neg_hi:[1,0,0]
v_pk_add_f32 v[108:109], v[108:109], v[80:81]
v_pk_add_f32 v[110:111], v[110:111], v[240:241]
v_exp_f32 v244, v244
v_exp_f32 v84, v84
v_exp_f32 v245, v245
v_exp_f32 v85, v85
v_exp_f32 v246, v246
v_exp_f32 v86, v86
v_exp_f32 v247, v247
v_exp_f32 v87, v87
v_pk_fma_f32 v[88:89], v[88:89], v[130:131], v[102:103] op_sel:[0,1,1] op_sel_hi:[1,1,1] neg_lo:[0,0,1] neg_hi:[0,0,1]
v_pk_fma_f32 v[90:91], v[90:91], v[130:131], v[102:103] op_sel:[0,1,1] op_sel_hi:[1,1,1] neg_lo:[0,0,1] neg_hi:[0,0,1]
v_pk_add_f32 v[108:109], v[108:109], v[82:83]
v_pk_add_f32 v[110:111], v[110:111], v[242:243]
v_exp_f32 v248, v248
v_exp_f32 v88, v88
v_exp_f32 v249, v249
v_exp_f32 v89, v89
v_add_f32 v102, v108, v109
v_add_f32 v106, v110, v111
v_exp_f32 v250, v250
v_exp_f32 v90, v90
v_exp_f32 v251, v251
v_exp_f32 v91, v91
v_pk_add_f32 v[108:109], v[84:85], v[86:87]
v_pk_add_f32 v[110:111], v[244:245], v[246:247]
v_pk_add_f32 v[108:109], v[108:109], v[88:89]
v_pk_add_f32 v[110:111], v[110:111], v[248:249]
v_pk_add_f32 v[108:109], v[108:109], v[90:91]
v_pk_add_f32 v[110:111], v[110:111], v[250:251]
v_add_f32 v103, v108, v109
v_add_f32 v107, v110, v111
s_cmp_eq_u32 s51, 1
s_cbranch_scc1 chk_124
s_waitcnt vmcnt(0)
v_max_u32 v4, v212, v213
v_max3_u32 v4, v4, v214, v215
v_max3_u32 v4, v4, v216, v217
v_max3_u32 v4, v4, v218, v219
v_cmp_eq_u32 vcc, -1, v4
s_cbranch_vccz red_125
buffer_load_dwordx4 v[212:215], v18, s[32:35], s55 offen offset:0 sc1
buffer_load_dwordx4 v[216:219], v18, s[32:35], s55 offen offset:1024 sc1
s_branch chk_124
red_125:
v_mfma_f32_16x16x32_bf16 v[132:135], v[44:47], v[212:215], 0
v_mfma_f32_16x16x32_bf16 v[132:135], v[44:47], v[216:219], v[132:135]
s_mov_b32 s51, 1
s_nop 6
v_add_f32_dpp v132, v132, v132 row_ror:8 row_mask:0xf bank_mask:0xf
v_add_f32_dpp v133, v133, v133 row_ror:8 row_mask:0xf bank_mask:0xf
v_add_f32_dpp v134, v134, v134 row_ror:8 row_mask:0xf bank_mask:0xf
v_add_f32_dpp v135, v135, v135 row_ror:8 row_mask:0xf bank_mask:0xf
v_cvt_pk_bf16_f32 v132, v132, v133
v_cvt_pk_bf16_f32 v133, v134, v135
s_mov_b64 exec, 0x00ff00ff
buffer_store_dwordx2 v[132:133], v59, s[32:35], s79 offen sc1
s_mov_b64 exec, -1
buffer_load_dwordx4 v[204:207], v58, s[32:35], s56 offen sc1
buffer_load_dwordx4 v[208:211], v58, s[32:35], s57 offen sc1
chk_124:
.p2align 3
v_permlane32_swap_b32 v100, v101
v_permlane32_swap_b32 v102, v103
v_permlane32_swap_b32 v104, v105
v_permlane32_swap_b32 v106, v107
v_add_f32 v100, v100, v101
v_add_f32 v102, v102, v103
v_add_f32 v104, v104, v105
v_add_f32 v106, v106, v107
v_permlane16_swap_b32 v100, v102
s_nop 0
v_permlane16_swap_b32 v104, v106
v_add_f32 v100, v100, v102
v_add_f32 v104, v104, v106
v_rcp_f32 v100, v100
v_rcp_f32 v104, v104
v_mov_b32 v102, v100
v_mov_b32 v106, v104
s_nop 0
v_permlane16_swap_b32 v100, v102
v_permlane16_swap_b32 v104, v106
v_mov_b32 v101, v100
v_mov_b32 v103, v102
v_mov_b32 v105, v104
v_mov_b32 v107, v106
v_permlane32_swap_b32 v100, v101
v_permlane32_swap_b32 v102, v103
v_permlane32_swap_b32 v104, v105
v_permlane32_swap_b32 v106, v107
v_pk_mul_f32 v[60:61], v[60:61], v[100:101] op_sel:[0,0] op_sel_hi:[1,0]
v_pk_mul_f32 v[220:221], v[220:221], v[104:105] op_sel:[0,0] op_sel_hi:[1,0]
v_pk_mul_f32 v[68:69], v[68:69], v[100:101] op_sel:[0,1] op_sel_hi:[1,1]
v_pk_mul_f32 v[228:229], v[228:229], v[104:105] op_sel:[0,1] op_sel_hi:[1,1]
v_pk_mul_f32 v[76:77], v[76:77], v[102:103] op_sel:[0,0] op_sel_hi:[1,0]
v_pk_mul_f32 v[236:237], v[236:237], v[106:107] op_sel:[0,0] op_sel_hi:[1,0]
v_pk_mul_f32 v[84:85], v[84:85], v[102:103] op_sel:[0,1] op_sel_hi:[1,1]
v_pk_mul_f32 v[244:245], v[244:245], v[106:107] op_sel:[0,1] op_sel_hi:[1,1]
v_pk_mul_f32 v[62:63], v[62:63], v[100:101] op_sel:[0,0] op_sel_hi:[1,0]
v_pk_mul_f32 v[222:223], v[222:223], v[104:105] op_sel:[0,0] op_sel_hi:[1,0]
v_cvt_pk_bf16_f32 v60, v60, v61
v_cvt_pk_bf16_f32 v220, v220, v221
v_pk_mul_f32 v[70:71], v[70:71], v[100:101] op_sel:[0,1] op_sel_hi:[1,1]
v_pk_mul_f32 v[230:231], v[230:231], v[104:105] op_sel:[0,1] op_sel_hi:[1,1]
v_cvt_pk_bf16_f32 v68, v68, v69
v_cvt_pk_bf16_f32 v228, v228, v229
v_pk_mul_f32 v[78:79], v[78:79], v[102:103] op_sel:[0,0] op_sel_hi:[1,0]
v_pk_mul_f32 v[238:239], v[238:239], v[106:107] op_sel:[0,0] op_sel_hi:[1,0]
v_cvt_pk_bf16_f32 v76, v76, v77
v_cvt_pk_bf16_f32 v236, v236, v237
v_pk_mul_f32 v[86:87], v[86:87], v[102:103] op_sel:[0,1] op_sel_hi:[1,1]
v_pk_mul_f32 v[246:247], v[246:247], v[106:107] op_sel:[0,1] op_sel_hi:[1,1]
v_cvt_pk_bf16_f32 v84, v84, v85
v_cvt_pk_bf16_f32 v244, v244, v245
v_pk_mul_f32 v[64:65], v[64:65], v[100:101] op_sel:[0,0] op_sel_hi:[1,0]
v_pk_mul_f32 v[66:67], v[66:67], v[100:101] op_sel:[0,0] op_sel_hi:[1,0]
v_pk_mul_f32 v[224:225], v[224:225], v[104:105] op_sel:[0,0] op_sel_hi:[1,0]
v_pk_mul_f32 v[226:227], v[226:227], v[104:105] op_sel:[0,0] op_sel_hi:[1,0]
v_cvt_pk_bf16_f32 v61, v62, v63
v_cvt_pk_bf16_f32 v221, v222, v223
v_pk_mul_f32 v[72:73], v[72:73], v[100:101] op_sel:[0,1] op_sel_hi:[1,1]
v_pk_mul_f32 v[74:75], v[74:75], v[100:101] op_sel:[0,1] op_sel_hi:[1,1]
v_pk_mul_f32 v[232:233], v[232:233], v[104:105] op_sel:[0,1] op_sel_hi:[1,1]
v_pk_mul_f32 v[234:235], v[234:235], v[104:105] op_sel:[0,1] op_sel_hi:[1,1]
v_cvt_pk_bf16_f32 v69, v70, v71
v_cvt_pk_bf16_f32 v229, v230, v231
v_pk_mul_f32 v[80:81], v[80:81], v[102:103] op_sel:[0,0] op_sel_hi:[1,0]
v_pk_mul_f32 v[82:83], v[82:83], v[102:103] op_sel:[0,0] op_sel_hi:[1,0]
v_pk_mul_f32 v[240:241], v[240:241], v[106:107] op_sel:[0,0] op_sel_hi:[1,0]
v_pk_mul_f32 v[242:243], v[242:243], v[106:107] op_sel:[0,0] op_sel_hi:[1,0]
v_cvt_pk_bf16_f32 v77, v78, v79
v_cvt_pk_bf16_f32 v237, v238, v239
v_pk_mul_f32 v[88:89], v[88:89], v[102:103] op_sel:[0,1] op_sel_hi:[1,1]
v_pk_mul_f32 v[90:91], v[90:91], v[102:103] op_sel:[0,1] op_sel_hi:[1,1]
v_pk_mul_f32 v[248:249], v[248:249], v[106:107] op_sel:[0,1] op_sel_hi:[1,1]
v_pk_mul_f32 v[250:251], v[250:251], v[106:107] op_sel:[0,1] op_sel_hi:[1,1]
v_cvt_pk_bf16_f32 v85, v86, v87
v_cvt_pk_bf16_f32 v245, v246, v247
v_cvt_pk_bf16_f32 v62, v64, v65
v_cvt_pk_bf16_f32 v63, v66, v67
v_cvt_pk_bf16_f32 v222, v224, v225
v_cvt_pk_bf16_f32 v223, v226, v227
v_cvt_pk_bf16_f32 v70, v72, v73
v_cvt_pk_bf16_f32 v71, v74, v75
v_cvt_pk_bf16_f32 v230, v232, v233
v_cvt_pk_bf16_f32 v231, v234, v235
v_cvt_pk_bf16_f32 v78, v80, v81
v_cvt_pk_bf16_f32 v79, v82, v83
v_cvt_pk_bf16_f32 v238, v240, v241
v_cvt_pk_bf16_f32 v239, v242, v243
v_cvt_pk_bf16_f32 v86, v88, v89
v_cvt_pk_bf16_f32 v87, v90, v91
v_cvt_pk_bf16_f32 v246, v248, v249
v_cvt_pk_bf16_f32 v247, v250, v251
s_cmp_lg_u32 s51, 0
s_cbranch_scc1 else_126
s_mov_b32 s63, 0
sent_128:
s_waitcnt vmcnt(0)
v_max_u32 v4, v212, v213
v_max3_u32 v4, v4, v214, v215
v_max3_u32 v4, v4, v216, v217
v_max3_u32 v4, v4, v218, v219
v_cmp_eq_u32 vcc, -1, v4
s_cbranch_vccz sentd_129
buffer_load_dwordx4 v[212:215], v18, s[32:35], s55 offen offset:0 sc1
buffer_load_dwordx4 v[216:219], v18, s[32:35], s55 offen offset:1024 sc1
s_add_u32 s63, s63, 1
s_cmp_lt_u32 s63, 0x80000
s_cbranch_scc1 sent_128
s_waitcnt vmcnt(0)
sentd_129:
v_mfma_f32_16x16x32_bf16 v[132:135], v[44:47], v[212:215], 0
v_mfma_f32_16x16x32_bf16 v[132:135], v[44:47], v[216:219], v[132:135]
s_mov_b32 s51, 1
s_nop 6
v_add_f32_dpp v132, v132, v132 row_ror:8 row_mask:0xf bank_mask:0xf
v_add_f32_dpp v133, v133, v133 row_ror:8 row_mask:0xf bank_mask:0xf
v_add_f32_dpp v134, v134, v134 row_ror:8 row_mask:0xf bank_mask:0xf
v_add_f32_dpp v135, v135, v135 row_ror:8 row_mask:0xf bank_mask:0xf
v_cvt_pk_bf16_f32 v132, v132, v133
v_cvt_pk_bf16_f32 v133, v134, v135
s_mov_b64 exec, 0x00ff00ff
buffer_store_dwordx2 v[132:133], v59, s[32:35], s79 offen sc1
s_mov_b64 exec, -1
buffer_load_dwordx4 v[204:207], v58, s[32:35], s56 offen sc1
buffer_load_dwordx4 v[208:211], v58, s[32:35], s57 offen sc1
else_126:
s_mov_b32 s63, 0
sent_130:
s_waitcnt vmcnt(0)
v_max_u32 v4, v204, v205
v_max3_u32 v4, v4, v206, v207
v_max3_u32 v4, v4, v208, v209
v_max3_u32 v4, v4, v210, v211
v_cmp_eq_u32 vcc, -1, v4
s_cbranch_vccz sentd_131
buffer_load_dwordx4 v[204:207], v58, s[32:35], s56 offen sc1
buffer_load_dwordx4 v[208:211], v58, s[32:35], s57 offen sc1
s_add_u32 s63, s63, 1
s_cmp_lt_u32 s63, 0x80000
s_cbranch_scc1 sent_130
s_waitcnt vmcnt(0)
sentd_131:
v_mfma_f32_16x16x32_bf16 v[112:115], v[204:207], v[60:63], 0
v_mfma_f32_16x16x32_bf16 v[116:119], v[204:207], v[68:71], 0
v_mfma_f32_16x16x32_bf16 v[120:123], v[204:207], v[76:79], 0
v_mfma_f32_16x16x32_bf16 v[124:127], v[204:207], v[84:87], 0
v_mfma_f32_16x16x32_bf16 v[112:115], v[208:211], v[220:223], v[112:115]
v_mfma_f32_16x16x32_bf16 v[116:119], v[208:211], v[228:231], v[116:119]
v_mfma_f32_16x16x32_bf16 v[120:123], v[208:211], v[236:239], v[120:123]
v_mfma_f32_16x16x32_bf16 v[124:127], v[208:211], v[244:247], v[124:127]
s_nop 4
v_add_f32 v100, v112, v113
v_add_f32 v114, v114, v115
v_add_f32 v100, v100, v114
v_add_f32 v101, v116, v117
v_add_f32 v118, v118, v119
v_add_f32 v101, v101, v118
v_add_f32 v102, v120, v121
v_add_f32 v122, v122, v123
v_add_f32 v102, v102, v122
v_add_f32 v103, v124, v125
v_add_f32 v126, v126, v127
v_add_f32 v103, v103, v126
s_nop 1
v_permlane32_swap_b32 v100, v101
v_permlane32_swap_b32 v102, v103
v_add_f32 v100, v100, v101
v_add_f32 v102, v102, v103
s_nop 1
v_permlane16_swap_b32 v100, v102
s_nop 0
v_add_f32 v100, v100, v102
v_add_f32 v100, 0x358637bd, v100
v_rcp_f32 v100, v100
s_nop 0
v_mov_b32 v102, v100
s_nop 1
v_permlane16_swap_b32 v100, v102
s_nop 0
v_mov_b32 v101, v100
v_mov_b32 v103, v102
s_nop 0
v_permlane32_swap_b32 v100, v101
v_permlane32_swap_b32 v102, v103
buffer_load_dwordx4 v[188:191], v18, s[32:35], s58 offen offset:0 sc1
buffer_load_dwordx4 v[192:195], v18, s[32:35], s58 offen offset:1024 sc1
buffer_load_dwordx4 v[196:199], v18, s[32:35], s59 offen offset:0 sc1
buffer_load_dwordx4 v[200:203], v18, s[32:35], s59 offen offset:1024 sc1
s_mov_b32 s63, 0
sent_132:
s_waitcnt vmcnt(0)
v_max_u32 v4, v188, v189
v_max3_u32 v4, v4, v190, v191
v_max3_u32 v4, v4, v192, v193
v_max3_u32 v4, v4, v194, v195
v_max3_u32 v4, v4, v196, v197
v_max3_u32 v4, v4, v198, v199
v_max3_u32 v4, v4, v200, v201
v_max3_u32 v4, v4, v202, v203
v_cmp_eq_u32 vcc, -1, v4
s_cbranch_vccz sentd_133
buffer_load_dwordx4 v[188:191], v18, s[32:35], s58 offen offset:0 sc1
buffer_load_dwordx4 v[192:195], v18, s[32:35], s58 offen offset:1024 sc1
buffer_load_dwordx4 v[196:199], v18, s[32:35], s59 offen offset:0 sc1
buffer_load_dwordx4 v[200:203], v18, s[32:35], s59 offen offset:1024 sc1
s_add_u32 s63, s63, 1
s_cmp_lt_u32 s63, 0x80000
s_cbranch_scc1 sent_132
s_waitcnt vmcnt(0)
sentd_133:
s_cmp_eq_u32 s46, 0
s_cbranch_scc1 slow_134
.p2align 3
v_mfma_f32_16x16x32_bf16 v[156:159], v[188:191], v[60:63], 0
v_mfma_f32_16x16x32_bf16 v[164:167], v[188:191], v[68:71], 0
v_mfma_f32_16x16x32_bf16 v[160:163], v[192:195], v[60:63], 0
v_mfma_f32_16x16x32_bf16 v[172:175], v[188:191], v[76:79], 0
v_mfma_f32_16x16x32_bf16 v[168:171], v[192:195], v[68:71], 0
v_mfma_f32_16x16x32_bf16 v[180:183], v[188:191], v[84:87], 0
v_mfma_f32_16x16x32_bf16 v[156:159], v[196:199], v[220:223], v[156:159]
v_mfma_f32_16x16x32_bf16 v[176:179], v[192:195], v[76:79], 0
v_mfma_f32_16x16x32_bf16 v[164:167], v[196:199], v[228:231], v[164:167]
v_mfma_f32_16x16x32_bf16 v[184:187], v[192:195], v[84:87], 0
v_mfma_f32_16x16x32_bf16 v[160:163], v[200:203], v[220:223], v[160:163]
v_mfma_f32_16x16x32_bf16 v[172:175], v[196:199], v[236:239], v[172:175]
v_mfma_f32_16x16x32_bf16 v[168:171], v[200:203], v[228:231], v[168:171]
v_mfma_f32_16x16x32_bf16 v[180:183], v[196:199], v[244:247], v[180:183]
v_mfma_f32_16x16x32_bf16 v[176:179], v[200:203], v[236:239], v[176:179]
v_mfma_f32_16x16x32_bf16 v[184:187], v[200:203], v[244:247], v[184:187]
v_pk_mul_f32 v[156:157], v[156:157], v[100:101] op_sel:[0,0] op_sel_hi:[1,0]
v_pk_mul_f32 v[158:159], v[158:159], v[100:101] op_sel:[0,0] op_sel_hi:[1,0]
v_cvt_pk_bf16_f32 v156, v156, v157
v_pk_mul_f32 v[164:165], v[164:165], v[100:101] op_sel:[0,1] op_sel_hi:[1,1]
v_pk_mul_f32 v[160:161], v[160:161], v[100:101] op_sel:[0,0] op_sel_hi:[1,0]
v_pk_mul_f32 v[162:163], v[162:163], v[100:101] op_sel:[0,0] op_sel_hi:[1,0]
v_cvt_pk_bf16_f32 v157, v158, v159
v_pk_mul_f32 v[166:167], v[166:167], v[100:101] op_sel:[0,1] op_sel_hi:[1,1]
v_cvt_pk_bf16_f32 v164, v164, v165
v_pk_mul_f32 v[172:173], v[172:173], v[102:103] op_sel:[0,0] op_sel_hi:[1,0]
v_cvt_pk_bf16_f32 v158, v160, v161
v_cvt_pk_bf16_f32 v159, v162, v163
v_pk_mul_f32 v[168:169], v[168:169], v[100:101] op_sel:[0,1] op_sel_hi:[1,1]
v_pk_mul_f32 v[170:171], v[170:171], v[100:101] op_sel:[0,1] op_sel_hi:[1,1]
v_cvt_pk_bf16_f32 v165, v166, v167
v_pk_mul_f32 v[174:175], v[174:175], v[102:103] op_sel:[0,0] op_sel_hi:[1,0]
v_cvt_pk_bf16_f32 v172, v172, v173
v_pk_mul_f32 v[180:181], v[180:181], v[102:103] op_sel:[0,1] op_sel_hi:[1,1]
buffer_store_dwordx4 v[156:159], v18, s[32:35], s80 offen
v_cvt_pk_bf16_f32 v166, v168, v169
v_cvt_pk_bf16_f32 v167, v170, v171
v_pk_mul_f32 v[176:177], v[176:177], v[102:103] op_sel:[0,0] op_sel_hi:[1,0]
v_pk_mul_f32 v[178:179], v[178:179], v[102:103] op_sel:[0,0] op_sel_hi:[1,0]
v_cvt_pk_bf16_f32 v173, v174, v175
v_pk_mul_f32 v[182:183], v[182:183], v[102:103] op_sel:[0,1] op_sel_hi:[1,1]
v_cvt_pk_bf16_f32 v180, v180, v181
buffer_store_dwordx4 v[164:167], v18, s[32:35], s81 offen
v_cvt_pk_bf16_f32 v174, v176, v177
v_cvt_pk_bf16_f32 v175, v178, v179
v_pk_mul_f32 v[184:185], v[184:185], v[102:103] op_sel:[0,1] op_sel_hi:[1,1]
v_pk_mul_f32 v[186:187], v[186:187], v[102:103] op_sel:[0,1] op_sel_hi:[1,1]
v_cvt_pk_bf16_f32 v181, v182, v183
buffer_store_dwordx4 v[172:175], v18, s[32:35], s82 offen
v_cvt_pk_bf16_f32 v182, v184, v185
v_cvt_pk_bf16_f32 v183, v186, v187
buffer_store_dwordx4 v[180:183], v18, s[32:35], s83 offen
back_135:
s_barrier
v_and_b32 v36, 31, v0
v_lshlrev_b32 v36, 2, v36
s_lshl_b32 s62, s45, 2
v_mov_b32 v4, s62
v_mov_b32 v5, 4
s_mov_b64 exec, 1
s_waitcnt vmcnt(0)
s_cmp_eq_u32 s46, 0
s_cbranch_scc1 slow_136
buffer_store_dword v5, v4, s[32:35], s84 offen
back_137:
s_mov_b64 exec, -1
v_lshrrev_b32 v4, 2, v2
v_and_b32 v5, 3, v0
v_lshl_add_u32 v6, v3, 3, v4
v_lshlrev_b32 v6, 7, v6
v_lshl_add_u32 v6, v5, 3, v6
v_lshrrev_b32 v7, 1, v4
v_and_b32 v8, 1, v3
v_lshl_add_u32 v7, v8, 1, v7
v_lshl_add_u32 v10, v7, 5, v6
v_xor_b32 v11, 32, v10
v_xor_b32 v12, 64, v10
v_xor_b32 v13, 96, v10
v_add_u32 v14, 0x10000, v10
v_add_u32 v15, 0x10000, v11
v_add_u32 v16, 0x10000, v12
v_add_u32 v17, 0x10000, v13
ds_read_b64_tr_b16 v[220:221], v10 offset:0
ds_read_b64_tr_b16 v[222:223], v10 offset:512
ds_read_b64_tr_b16 v[224:225], v11 offset:0
ds_read_b64_tr_b16 v[226:227], v11 offset:512
ds_read_b64_tr_b16 v[228:229], v12 offset:0
ds_read_b64_tr_b16 v[230:231], v12 offset:512
ds_read_b64_tr_b16 v[232:233], v13 offset:0
ds_read_b64_tr_b16 v[234:235], v13 offset:512
ds_read_b64_tr_b16 v[236:237], v10 offset:4096
ds_read_b64_tr_b16 v[238:239], v10 offset:4608
ds_read_b64_tr_b16 v[240:241], v11 offset:4096
ds_read_b64_tr_b16 v[242:243], v11 offset:4608
ds_read_b64_tr_b16 v[244:245], v12 offset:4096
ds_read_b64_tr_b16 v[246:247], v12 offset:4608
ds_read_b64_tr_b16 v[248:249], v13 offset:4096
ds_read_b64_tr_b16 v[250:251], v13 offset:4608
s_lshl_b32 s48, s41, 3
s_lshl_b32 s49, s40, 1
s_add_u32 s48, s48, s49
s_lshl_b32 s48, s48, 15
s_add_u32 s48, s48, 4194304
v_add_u32 v38, s48, v18
v_add_u32 v39, 32768, v38
s_lshl_b32 s57, s75, 11
s_add_u32 s87, s87, 262144
v_lshlrev_b32 v60, 16, v20
v_and_b32 v61, 0xffff0000, v20
v_lshlrev_b32 v62, 16, v21
v_and_b32 v63, 0xffff0000, v21
v_lshlrev_b32 v64, 16, v22
v_and_b32 v65, 0xffff0000, v22
v_lshlrev_b32 v66, 16, v23
v_and_b32 v67, 0xffff0000, v23
v_lshlrev_b32 v68, 16, v24
v_and_b32 v69, 0xffff0000, v24
v_lshlrev_b32 v70, 16, v25
v_and_b32 v71, 0xffff0000, v25
v_lshlrev_b32 v72, 16, v26
v_and_b32 v73, 0xffff0000, v26
v_lshlrev_b32 v74, 16, v27
v_and_b32 v75, 0xffff0000, v27
v_lshlrev_b32 v76, 16, v28
v_and_b32 v77, 0xffff0000, v28
v_lshlrev_b32 v78, 16, v29
v_and_b32 v79, 0xffff0000, v29
v_lshlrev_b32 v80, 16, v30
v_and_b32 v81, 0xffff0000, v30
v_lshlrev_b32 v82, 16, v31
v_and_b32 v83, 0xffff0000, v31
v_lshlrev_b32 v84, 16, v32
v_and_b32 v85, 0xffff0000, v32
v_lshlrev_b32 v86, 16, v33
v_and_b32 v87, 0xffff0000, v33
v_lshlrev_b32 v88, 16, v34
v_and_b32 v89, 0xffff0000, v34
v_lshlrev_b32 v90, 16, v35
v_and_b32 v91, 0xffff0000, v35
s_lshl_b32 s48, s40, 12
s_add_u32 s48, s48, 139264
v_lshrrev_b32 v4, 1, v2
v_lshrrev_b32 v5, 1, v3
v_xor_b32 v4, v4, v5
v_lshlrev_b32 v4, 4, v4
v_and_b32 v5, 1, v3
v_lshl_add_u32 v4, v5, 3, v4
v_lshl_add_u32 v4, v2, 7, v4
v_add_u32 v42, s48, v4
v_xor_b32 v43, 32, v42
v_xor_b32 v44, 64, v42
v_xor_b32 v45, 96, v42
v_add_u32 v46, s48, v18
s_lshl_b32 s48, s41, 7
s_lshl_b32 s49, s40, 5
s_add_u32 s48, s48, s49
s_lshl_b32 s48, s48, 11
s_lshl_b32 s49, s78, 7
s_add_u32 s48, s48, s49
s_add_u32 s49, s48, 32768
v_lshrrev_b32 v4, 3, v0
v_and_b32 v5, 7, v0
v_lshrrev_b32 v6, 1, v4
v_xor_b32 v5, v5, v6
v_lshlrev_b32 v4, 11, v4
v_lshl_add_u32 v40, v5, 4, v4
v_xor_b32 v41, 64, v40
v_add_u32 v41, 16384, v41
buffer_load_dword v37, v36, s[32:35], s84 offen sc1
s_mov_b32 s63, 0
s_waitcnt vmcnt(0)
poll_138:
v_cmp_gt_u32 vcc, 4, v37
s_cbranch_vccz polled_139
buffer_load_dword v37, v36, s[32:35], s84 offen sc1
s_add_u32 s63, s63, 1
s_cmp_lt_u32 s63, 0x80000
s_waitcnt vmcnt(0)
s_cbranch_scc1 poll_138
polled_139:
s_call_b64 s[94:95], R_oloop
s_nop 0
v_cvt_pk_bf16_f32 v20, v60, v61
v_cvt_pk_bf16_f32 v21, v62, v63
v_cvt_pk_bf16_f32 v22, v64, v65
v_cvt_pk_bf16_f32 v23, v66, v67
ds_write_b64 v42, v[20:21] offset:0
ds_write_b64 v43, v[22:23] offset:0
v_cvt_pk_bf16_f32 v24, v68, v69
v_cvt_pk_bf16_f32 v25, v70, v71
v_cvt_pk_bf16_f32 v26, v72, v73
v_cvt_pk_bf16_f32 v27, v74, v75
ds_write_b64 v44, v[24:25] offset:0
ds_write_b64 v45, v[26:27] offset:0
v_cvt_pk_bf16_f32 v28, v76, v77
v_cvt_pk_bf16_f32 v29, v78, v79
v_cvt_pk_bf16_f32 v30, v80, v81
v_cvt_pk_bf16_f32 v31, v82, v83
ds_write_b64 v42, v[28:29] offset:2048
ds_write_b64 v43, v[30:31] offset:2048
v_cvt_pk_bf16_f32 v32, v84, v85
v_cvt_pk_bf16_f32 v33, v86, v87
v_cvt_pk_bf16_f32 v34, v88, v89
v_cvt_pk_bf16_f32 v35, v90, v91
ds_write_b64 v44, v[32:33] offset:2048
ds_write_b64 v45, v[34:35] offset:2048
ds_read_b128 v[20:23], v46 offset:0
ds_read_b128 v[24:27], v46 offset:1024
ds_read_b128 v[28:31], v46 offset:2048
ds_read_b128 v[32:35], v46 offset:3072
s_waitcnt lgkmcnt(3)
buffer_store_dwordx4 v[20:23], v40, s[24:27], s48 offen sc1
s_waitcnt lgkmcnt(2)
buffer_store_dwordx4 v[24:27], v41, s[24:27], s48 offen sc1
s_waitcnt lgkmcnt(1)
buffer_store_dwordx4 v[28:31], v40, s[24:27], s49 offen sc1
s_waitcnt lgkmcnt(0)
buffer_store_dwordx4 v[32:35], v41, s[24:27], s49 offen sc1
s_endpgm
L_code_end:
again_22:
s_mov_b32 s63, 0
retry_24:
buffer_load_dwordx4 v[176:179], v37, s[32:35], 0 offen offset:0 sc1
buffer_load_dwordx4 v[180:183], v37, s[32:35], 0 offen offset:1024 sc1
buffer_load_dwordx4 v[184:187], v37, s[32:35], 0 offen offset:2048 sc1
buffer_load_dwordx4 v[188:191], v37, s[32:35], 0 offen offset:3072 sc1
s_waitcnt vmcnt(0)
v_add_f32 v176, v176, v184
v_add_f32 v177, v177, v185
v_add_f32 v178, v178, v186
v_add_f32 v179, v179, v187
v_add_f32 v180, v180, v188
v_add_f32 v181, v181, v189
v_add_f32 v182, v182, v190
v_add_f32 v183, v183, v191
v_add_f32 v176, v176, v180
v_add_f32 v177, v177, v181
v_add_f32 v178, v178, v182
v_add_f32 v179, v179, v183
s_nop 1
v_permlane32_swap_b32 v176, v177
v_permlane32_swap_b32 v178, v179
v_add_f32 v176, v176, v177
v_add_f32 v178, v178, v179
s_nop 1
v_permlane16_swap_b32 v176, v178
s_nop 0
v_add_f32 v176, v176, v178
v_cmp_u_f32 vcc, v176, v176
s_cbranch_vccz summed_23
s_add_u32 s63, s63, 1
s_cmp_lt_u32 s63, 0x10000
s_cbranch_scc1 retry_24
s_branch summed_23
again_25:
s_mov_b32 s63, 0
retry_27:
buffer_load_dwordx4 v[160:163], v38, s[32:35], 0 offen offset:0 sc1
buffer_load_dwordx4 v[164:167], v38, s[32:35], 0 offen offset:1024 sc1
buffer_load_dwordx4 v[168:171], v38, s[32:35], 0 offen offset:2048 sc1
buffer_load_dwordx4 v[172:175], v38, s[32:35], 0 offen offset:3072 sc1
s_waitcnt vmcnt(0)
v_add_f32 v160, v160, v168
v_add_f32 v161, v161, v169
v_add_f32 v162, v162, v170
v_add_f32 v163, v163, v171
v_add_f32 v164, v164, v172
v_add_f32 v165, v165, v173
v_add_f32 v166, v166, v174
v_add_f32 v167, v167, v175
v_add_f32 v160, v160, v164
v_add_f32 v161, v161, v165
v_add_f32 v162, v162, v166
v_add_f32 v163, v163, v167
s_nop 1
v_permlane32_swap_b32 v160, v161
v_permlane32_swap_b32 v162, v163
v_add_f32 v160, v160, v161
v_add_f32 v162, v162, v163
s_nop 1
v_permlane16_swap_b32 v160, v162
s_nop 0
v_add_f32 v160, v160, v162
v_cmp_u_f32 vcc, v160, v160
s_cbranch_vccz summed_26
s_add_u32 s63, s63, 1
s_cmp_lt_u32 s63, 0x10000
s_cbranch_scc1 retry_27
s_branch summed_26
again_35:
s_mov_b32 s63, 0
retry_37:
buffer_load_dwordx4 v[80:83], v37, s[32:35], 0 offen offset:0 sc1
buffer_load_dwordx4 v[84:87], v37, s[32:35], 0 offen offset:1024 sc1
buffer_load_dwordx4 v[88:91], v37, s[32:35], 0 offen offset:2048 sc1
buffer_load_dwordx4 v[92:95], v37, s[32:35], 0 offen offset:3072 sc1
s_waitcnt vmcnt(0)
v_add_f32 v80, v80, v88
v_add_f32 v81, v81, v89
v_add_f32 v82, v82, v90
v_add_f32 v83, v83, v91
v_add_f32 v84, v84, v92
v_add_f32 v85, v85, v93
v_add_f32 v86, v86, v94
v_add_f32 v87, v87, v95
v_add_f32 v80, v80, v84
v_add_f32 v81, v81, v85
v_add_f32 v82, v82, v86
v_add_f32 v83, v83, v87
s_nop 1
v_permlane32_swap_b32 v80, v81
v_permlane32_swap_b32 v82, v83
v_add_f32 v80, v80, v81
v_add_f32 v82, v82, v83
s_nop 1
v_permlane16_swap_b32 v80, v82
s_nop 0
v_add_f32 v80, v80, v82
v_cmp_u_f32 vcc, v80, v80
s_cbranch_vccz summed_36
s_add_u32 s63, s63, 1
s_cmp_lt_u32 s63, 0x10000
s_cbranch_scc1 retry_37
s_branch summed_36
again_38:
s_mov_b32 s63, 0
retry_40:
buffer_load_dwordx4 v[64:67], v38, s[32:35], 0 offen offset:0 sc1
buffer_load_dwordx4 v[68:71], v38, s[32:35], 0 offen offset:1024 sc1
buffer_load_dwordx4 v[72:75], v38, s[32:35], 0 offen offset:2048 sc1
buffer_load_dwordx4 v[76:79], v38, s[32:35], 0 offen offset:3072 sc1
s_waitcnt vmcnt(0)
v_add_f32 v64, v64, v72
v_add_f32 v65, v65, v73
v_add_f32 v66, v66, v74
v_add_f32 v67, v67, v75
v_add_f32 v68, v68, v76
v_add_f32 v69, v69, v77
v_add_f32 v70, v70, v78
v_add_f32 v71, v71, v79
v_add_f32 v64, v64, v68
v_add_f32 v65, v65, v69
v_add_f32 v66, v66, v70
v_add_f32 v67, v67, v71
s_nop 1
v_permlane32_swap_b32 v64, v65
v_permlane32_swap_b32 v66, v67
v_add_f32 v64, v64, v65
v_add_f32 v66, v66, v67
s_nop 1
v_permlane16_swap_b32 v64, v66
s_nop 0
v_add_f32 v64, v64, v66
v_cmp_u_f32 vcc, v64, v64
s_cbranch_vccz summed_39
s_add_u32 s63, s63, 1
s_cmp_lt_u32 s63, 0x10000
s_cbranch_scc1 retry_40
s_branch summed_39
again_44:
s_mov_b32 s63, 0
retry_46:
buffer_load_dwordx4 v[80:83], v37, s[32:35], 0 offen offset:0 sc1
buffer_load_dwordx4 v[84:87], v37, s[32:35], 0 offen offset:1024 sc1
buffer_load_dwordx4 v[88:91], v37, s[32:35], 0 offen offset:2048 sc1
buffer_load_dwordx4 v[92:95], v37, s[32:35], 0 offen offset:3072 sc1
s_waitcnt vmcnt(0)
v_add_f32 v80, v80, v88
v_add_f32 v81, v81, v89
v_add_f32 v82, v82, v90
v_add_f32 v83, v83, v91
v_add_f32 v84, v84, v92
v_add_f32 v85, v85, v93
v_add_f32 v86, v86, v94
v_add_f32 v87, v87, v95
v_add_f32 v80, v80, v84
v_add_f32 v81, v81, v85
v_add_f32 v82, v82, v86
v_add_f32 v83, v83, v87
s_nop 1
v_permlane32_swap_b32 v80, v81
v_permlane32_swap_b32 v82, v83
v_add_f32 v80, v80, v81
v_add_f32 v82, v82, v83
s_nop 1
v_permlane16_swap_b32 v80, v82
s_nop 0
v_add_f32 v80, v80, v82
v_cmp_u_f32 vcc, v80, v80
s_cbranch_vccz summed_45
s_add_u32 s63, s63, 1
s_cmp_lt_u32 s63, 0x10000
s_cbranch_scc1 retry_46
s_branch summed_45
again_52:
s_mov_b32 s63, 0
retry_54:
buffer_load_dwordx4 v[80:83], v37, s[32:35], 0 offen offset:0 sc1
buffer_load_dwordx4 v[84:87], v37, s[32:35], 0 offen offset:1024 sc1
buffer_load_dwordx4 v[88:91], v37, s[32:35], 0 offen offset:2048 sc1
buffer_load_dwordx4 v[92:95], v37, s[32:35], 0 offen offset:3072 sc1
s_waitcnt vmcnt(0)
v_add_f32 v80, v80, v88
v_add_f32 v81, v81, v89
v_add_f32 v82, v82, v90
v_add_f32 v83, v83, v91
v_add_f32 v84, v84, v92
v_add_f32 v85, v85, v93
v_add_f32 v86, v86, v94
v_add_f32 v87, v87, v95
v_add_f32 v80, v80, v84
v_add_f32 v81, v81, v85
v_add_f32 v82, v82, v86
v_add_f32 v83, v83, v87
s_nop 1
v_permlane32_swap_b32 v80, v81
v_permlane32_swap_b32 v82, v83
v_add_f32 v80, v80, v81
v_add_f32 v82, v82, v83
s_nop 1
v_permlane16_swap_b32 v80, v82
s_nop 0
v_add_f32 v80, v80, v82
v_cmp_u_f32 vcc, v80, v80
s_cbranch_vccz summed_53
s_add_u32 s63, s63, 1
s_cmp_lt_u32 s63, 0x10000
s_cbranch_scc1 retry_54
s_branch summed_53
slow_73:
.p2align 3
v_mfma_f32_16x16x32_bf16 v[160:163], v[120:123], v[156:159], v[44:47]
v_max_f32 v158, v192, v193
v_max_f32 v159, v194, v195
v_permlane32_swap_b32 v130, v131
s_nop 0
v_max_f32 v130, v130, v131
s_nop 2
v_max_f32 v156, v160, v161
v_max_f32 v157, v162, v163
v_max3_f32 v128, v156, v157, v158
v_max_f32 v128, v128, v159
s_nop 1
v_permlane32_swap_b32 v128, v129
s_nop 0
v_max_f32 v128, v128, v129
s_nop 1
v_permlane16_swap_b32 v128, v130
s_nop 0
v_max_f32 v128, v128, v130
v_mov_b32 v130, v128
s_nop 1
v_permlane16_swap_b32 v128, v130
s_nop 0
v_mov_b32 v129, v128
v_mov_b32 v131, v130
s_nop 0
v_permlane32_swap_b32 v128, v129
v_permlane32_swap_b32 v130, v131
v_mul_f32 v128, v128, v124
v_mul_f32 v129, v129, v125
v_pk_fma_f32 v[156:157], v[156:157], v[124:125], v[128:129] op_sel:[0,0,0] op_sel_hi:[1,0,0] neg_lo:[0,0,1] neg_hi:[0,0,1]
v_pk_fma_f32 v[158:159], v[158:159], v[124:125], v[128:129] op_sel:[0,0,0] op_sel_hi:[1,0,0] neg_lo:[0,0,1] neg_hi:[0,0,1]
v_mul_f32 v130, v130, v126
v_mul_f32 v131, v131, v127
v_exp_f32 v156, v156
v_exp_f32 v157, v157
v_exp_f32 v158, v158
v_exp_f32 v159, v159
v_pk_fma_f32 v[164:165], v[164:165], v[124:125], v[128:129] op_sel:[0,1,1] op_sel_hi:[1,1,1] neg_lo:[0,0,1] neg_hi:[0,0,1]
v_pk_fma_f32 v[166:167], v[166:167], v[124:125], v[128:129] op_sel:[0,1,1] op_sel_hi:[1,1,1] neg_lo:[0,0,1] neg_hi:[0,0,1]
v_exp_f32 v164, v164
v_exp_f32 v165, v165
v_exp_f32 v166, v166
v_exp_f32 v167, v167
v_pk_fma_f32 v[172:173], v[172:173], v[126:127], v[130:131] op_sel:[0,0,0] op_sel_hi:[1,0,0] neg_lo:[0,0,1] neg_hi:[0,0,1]
v_pk_fma_f32 v[174:175], v[174:175], v[126:127], v[130:131] op_sel:[0,0,0] op_sel_hi:[1,0,0] neg_lo:[0,0,1] neg_hi:[0,0,1]
v_cvt_pk_bf16_f32 v156, v156, v156
v_cvt_pk_bf16_f32 v157, v157, v157
v_cvt_pk_bf16_f32 v158, v158, v158
v_cvt_pk_bf16_f32 v159, v159, v159
v_exp_f32 v172, v172
v_exp_f32 v173, v173
v_exp_f32 v174, v174
v_exp_f32 v175, v175
v_pk_fma_f32 v[180:181], v[180:181], v[126:127], v[130:131] op_sel:[0,1,1] op_sel_hi:[1,1,1] neg_lo:[0,0,1] neg_hi:[0,0,1]
v_pk_fma_f32 v[182:183], v[182:183], v[126:127], v[130:131] op_sel:[0,1,1] op_sel_hi:[1,1,1] neg_lo:[0,0,1] neg_hi:[0,0,1]
v_and_b32 v156, v52, v156
v_and_b32 v157, v52, v157
v_and_b32 v158, v52, v158
v_and_b32 v159, v52, v159
v_cvt_pk_bf16_f32 v164, v164, v164
v_cvt_pk_bf16_f32 v165, v165, v165
v_mfma_f32_16x16x32_bf16 v[160:163], v[48:51], v[156:159], 0
v_cvt_pk_bf16_f32 v166, v166, v166
v_cvt_pk_bf16_f32 v167, v167, v167
v_mfma_f32_16x16x32_bf16 v[220:223], v[100:103], v[156:159], 0
v_exp_f32 v180, v180
v_mfma_f32_16x16x32_bf16 v[224:227], v[110:113], v[156:159], 0
v_exp_f32 v181, v181
v_exp_f32 v182, v182
v_exp_f32 v183, v183
v_and_b32 v164, v52, v164
v_and_b32 v165, v52, v165
v_and_b32 v166, v52, v166
v_and_b32 v167, v52, v167
v_cvt_pk_bf16_f32 v172, v172, v172
v_cvt_pk_bf16_f32 v173, v173, v173
v_mfma_f32_16x16x32_bf16 v[168:171], v[48:51], v[164:167], 0
v_cvt_pk_bf16_f32 v174, v174, v174
v_cvt_pk_bf16_f32 v175, v175, v175
v_mfma_f32_16x16x32_bf16 v[228:231], v[102:105], v[164:167], 0
v_and_b32 v172, v52, v172
v_and_b32 v173, v52, v173
v_mfma_f32_16x16x32_bf16 v[232:235], v[112:115], v[164:167], 0
v_and_b32 v174, v52, v174
v_and_b32 v175, v52, v175
v_cvt_pk_bf16_f32 v180, v180, v180
v_cvt_pk_bf16_f32 v181, v181, v181
v_mfma_f32_16x16x32_bf16 v[176:179], v[48:51], v[172:175], 0
v_cvt_pk_bf16_f32 v182, v182, v182
v_cvt_pk_bf16_f32 v183, v183, v183
v_mfma_f32_16x16x32_bf16 v[236:239], v[104:107], v[172:175], 0
v_and_b32 v180, v52, v180
v_and_b32 v181, v52, v181
v_mfma_f32_16x16x32_bf16 v[240:243], v[114:117], v[172:175], 0
v_and_b32 v182, v52, v182
v_and_b32 v183, v52, v183
v_rcp_f32 v160, v160
v_rcp_f32 v168, v168
v_pk_mul_f32 v[220:221], v[220:221], v[160:161] op_sel:[0,0] op_sel_hi:[1,0]
v_pk_mul_f32 v[222:223], v[222:223], v[160:161] op_sel:[0,0] op_sel_hi:[1,0]
v_pk_mul_f32 v[228:229], v[228:229], v[168:169] op_sel:[0,0] op_sel_hi:[1,0]
v_pk_mul_f32 v[224:225], v[224:225], v[160:161] op_sel:[0,0] op_sel_hi:[1,0]
v_pk_mul_f32 v[226:227], v[226:227], v[160:161] op_sel:[0,0] op_sel_hi:[1,0]
v_pk_mul_f32 v[230:231], v[230:231], v[168:169] op_sel:[0,0] op_sel_hi:[1,0]
v_pk_mul_f32 v[232:233], v[232:233], v[168:169] op_sel:[0,0] op_sel_hi:[1,0]
v_pk_mul_f32 v[234:235], v[234:235], v[168:169] op_sel:[0,0] op_sel_hi:[1,0]
v_mfma_f32_16x16x32_bf16 v[184:187], v[48:51], v[180:183], 0
v_rcp_f32_e64 v176, v176
v_cvt_pk_bf16_f32 v220, v220, v221
v_cvt_pk_bf16_f32 v221, v222, v223
v_cvt_pk_bf16_f32 v228, v228, v229
v_pk_mul_f32 v[236:237], v[236:237], v[176:177] op_sel:[0,0] op_sel_hi:[1,0]
v_mfma_f32_16x16x32_bf16 v[244:247], v[106:109], v[180:183], 0
v_cvt_pk_bf16_f32 v222, v224, v225
v_cvt_pk_bf16_f32 v223, v226, v227
v_rcp_f32_e64 v184, v184
v_cvt_pk_bf16_f32 v229, v230, v231
v_pk_mul_f32 v[238:239], v[238:239], v[176:177] op_sel:[0,0] op_sel_hi:[1,0]
v_pk_mul_f32 v[240:241], v[240:241], v[176:177] op_sel:[0,0] op_sel_hi:[1,0]
v_pk_mul_f32 v[242:243], v[242:243], v[176:177] op_sel:[0,0] op_sel_hi:[1,0]
v_cvt_pk_bf16_f32 v236, v236, v237
v_pk_mul_f32 v[244:245], v[244:245], v[184:185] op_sel:[0,0] op_sel_hi:[1,0]
v_pk_mul_f32 v[246:247], v[246:247], v[184:185] op_sel:[0,0] op_sel_hi:[1,0]
v_mfma_f32_16x16x32_bf16 v[248:251], v[116:119], v[180:183], 0
buffer_store_dwordx4 v[220:223], v18, s[32:35], s80 offen sc1
v_cvt_pk_bf16_f32 v230, v232, v233
v_cvt_pk_bf16_f32 v231, v234, v235
v_cvt_pk_bf16_f32 v237, v238, v239
v_cvt_pk_bf16_f32 v244, v244, v245
buffer_store_dwordx4 v[228:231], v18, s[32:35], s81 offen sc1
v_cvt_pk_bf16_f32 v238, v240, v241
v_cvt_pk_bf16_f32 v239, v242, v243
v_pk_mul_f32 v[248:249], v[248:249], v[184:185] op_sel:[0,0] op_sel_hi:[1,0]
v_pk_mul_f32 v[250:251], v[250:251], v[184:185] op_sel:[0,0] op_sel_hi:[1,0]
v_cvt_pk_bf16_f32 v245, v246, v247
buffer_store_dwordx4 v[236:239], v18, s[32:35], s82 offen sc1
v_cvt_pk_bf16_f32 v246, v248, v249
v_cvt_pk_bf16_f32 v247, v250, v251
buffer_store_dwordx4 v[244:247], v18, s[32:35], s83 offen sc1
s_branch back_74
slow_75:
buffer_store_dword v5, v4, s[32:35], s84 offen sc1
s_branch back_76
slow_80:
s_nop 0
v_cvt_pk_bf16_f32 v20, v60, v61
v_cvt_pk_bf16_f32 v21, v62, v63
v_cvt_pk_bf16_f32 v22, v64, v65
v_cvt_pk_bf16_f32 v23, v66, v67
buffer_store_dwordx4 v[20:23], v18, s[32:35], s85 offen offset:0 sc1
v_cvt_pk_bf16_f32 v24, v68, v69
v_cvt_pk_bf16_f32 v25, v70, v71
v_cvt_pk_bf16_f32 v26, v72, v73
v_cvt_pk_bf16_f32 v27, v74, v75
buffer_store_dwordx4 v[24:27], v18, s[32:35], s85 offen offset:1024 sc1
v_cvt_pk_bf16_f32 v28, v76, v77
v_cvt_pk_bf16_f32 v29, v78, v79
v_cvt_pk_bf16_f32 v30, v80, v81
v_cvt_pk_bf16_f32 v31, v82, v83
buffer_store_dwordx4 v[28:31], v18, s[32:35], s86 offen offset:0 sc1
v_cvt_pk_bf16_f32 v32, v84, v85
v_cvt_pk_bf16_f32 v33, v86, v87
v_cvt_pk_bf16_f32 v34, v88, v89
v_cvt_pk_bf16_f32 v35, v90, v91
buffer_store_dwordx4 v[32:35], v18, s[32:35], s86 offen offset:1024 sc1
s_barrier
v_dot2c_f32_bf16 v6, v20, v48
v_dot2c_f32_bf16 v8, v20, v20
v_dot2c_f32_bf16 v7, v28, v48
v_dot2c_f32_bf16 v9, v28, v28
v_dot2c_f32_bf16 v6, v21, v48
v_dot2c_f32_bf16 v8, v21, v21
v_dot2c_f32_bf16 v7, v29, v48
v_dot2c_f32_bf16 v9, v29, v29
v_dot2c_f32_bf16 v6, v22, v48
v_dot2c_f32_bf16 v8, v22, v22
v_dot2c_f32_bf16 v7, v30, v48
v_dot2c_f32_bf16 v9, v30, v30
v_dot2c_f32_bf16 v6, v23, v48
v_dot2c_f32_bf16 v8, v23, v23
v_dot2c_f32_bf16 v7, v31, v48
v_dot2c_f32_bf16 v9, v31, v31
v_dot2c_f32_bf16 v6, v24, v48
v_dot2c_f32_bf16 v8, v24, v24
v_dot2c_f32_bf16 v7, v32, v48
v_dot2c_f32_bf16 v9, v32, v32
v_dot2c_f32_bf16 v6, v25, v48
v_dot2c_f32_bf16 v8, v25, v25
v_dot2c_f32_bf16 v7, v33, v48
v_dot2c_f32_bf16 v9, v33, v33
v_dot2c_f32_bf16 v6, v26, v48
v_dot2c_f32_bf16 v8, v26, v26
v_dot2c_f32_bf16 v7, v34, v48
v_dot2c_f32_bf16 v9, v34, v34
v_dot2c_f32_bf16 v6, v27, v48
v_dot2c_f32_bf16 v8, v27, v27
v_dot2c_f32_bf16 v7, v35, v48
v_dot2c_f32_bf16 v9, v35, v35
s_mov_b64 exec, 1
s_waitcnt vmcnt(0)
buffer_store_dword v5, v4, s[32:35], s88 offen sc1
s_mov_b64 exec, -1
s_nop 1
v_permlane32_swap_b32 v6, v7
v_permlane32_swap_b32 v8, v9
v_add_f32 v6, v6, v7
v_add_f32 v8, v8, v9
s_nop 1
v_permlane16_swap_b32 v6, v8
s_nop 0
v_add_f32 v6, v6, v8
buffer_store_dword v6, v1, s[32:35], s87 offen sc1
s_branch back_81
slow_96:
.p2align 3
v_mfma_f32_16x16x32_bf16 v[156:159], v[188:191], v[60:63], 0
v_mfma_f32_16x16x32_bf16 v[164:167], v[188:191], v[68:71], 0
v_mfma_f32_16x16x32_bf16 v[160:163], v[192:195], v[60:63], 0
v_mfma_f32_16x16x32_bf16 v[172:175], v[188:191], v[76:79], 0
v_mfma_f32_16x16x32_bf16 v[168:171], v[192:195], v[68:71], 0
v_mfma_f32_16x16x32_bf16 v[180:183], v[188:191], v[84:87], 0
v_mfma_f32_16x16x32_bf16 v[156:159], v[196:199], v[220:223], v[156:159]
v_mfma_f32_16x16x32_bf16 v[176:179], v[192:195], v[76:79], 0
v_mfma_f32_16x16x32_bf16 v[164:167], v[196:199], v[228:231], v[164:167]
v_mfma_f32_16x16x32_bf16 v[184:187], v[192:195], v[84:87], 0
v_mfma_f32_16x16x32_bf16 v[160:163], v[200:203], v[220:223], v[160:163]
v_mfma_f32_16x16x32_bf16 v[172:175], v[196:199], v[236:239], v[172:175]
v_mfma_f32_16x16x32_bf16 v[168:171], v[200:203], v[228:231], v[168:171]
v_mfma_f32_16x16x32_bf16 v[180:183], v[196:199], v[244:247], v[180:183]
v_mfma_f32_16x16x32_bf16 v[176:179], v[200:203], v[236:239], v[176:179]
v_mfma_f32_16x16x32_bf16 v[184:187], v[200:203], v[244:247], v[184:187]
v_pk_mul_f32 v[156:157], v[156:157], v[100:101] op_sel:[0,0] op_sel_hi:[1,0]
v_pk_mul_f32 v[158:159], v[158:159], v[100:101] op_sel:[0,0] op_sel_hi:[1,0]
v_cvt_pk_bf16_f32 v156, v156, v157
v_pk_mul_f32 v[164:165], v[164:165], v[100:101] op_sel:[0,1] op_sel_hi:[1,1]
v_pk_mul_f32 v[160:161], v[160:161], v[100:101] op_sel:[0,0] op_sel_hi:[1,0]
v_pk_mul_f32 v[162:163], v[162:163], v[100:101] op_sel:[0,0] op_sel_hi:[1,0]
v_cvt_pk_bf16_f32 v157, v158, v159
v_pk_mul_f32 v[166:167], v[166:167], v[100:101] op_sel:[0,1] op_sel_hi:[1,1]
v_cvt_pk_bf16_f32 v164, v164, v165
v_pk_mul_f32 v[172:173], v[172:173], v[102:103] op_sel:[0,0] op_sel_hi:[1,0]
v_cvt_pk_bf16_f32 v158, v160, v161
v_cvt_pk_bf16_f32 v159, v162, v163
v_pk_mul_f32 v[168:169], v[168:169], v[100:101] op_sel:[0,1] op_sel_hi:[1,1]
v_pk_mul_f32 v[170:171], v[170:171], v[100:101] op_sel:[0,1] op_sel_hi:[1,1]
v_cvt_pk_bf16_f32 v165, v166, v167
v_pk_mul_f32 v[174:175], v[174:175], v[102:103] op_sel:[0,0] op_sel_hi:[1,0]
v_cvt_pk_bf16_f32 v172, v172, v173
v_pk_mul_f32 v[180:181], v[180:181], v[102:103] op_sel:[0,1] op_sel_hi:[1,1]
buffer_store_dwordx4 v[156:159], v18, s[32:35], s80 offen sc1
v_cvt_pk_bf16_f32 v166, v168, v169
v_cvt_pk_bf16_f32 v167, v170, v171
v_pk_mul_f32 v[176:177], v[176:177], v[102:103] op_sel:[0,0] op_sel_hi:[1,0]
v_pk_mul_f32 v[178:179], v[178:179], v[102:103] op_sel:[0,0] op_sel_hi:[1,0]
v_cvt_pk_bf16_f32 v173, v174, v175
v_pk_mul_f32 v[182:183], v[182:183], v[102:103] op_sel:[0,1] op_sel_hi:[1,1]
v_cvt_pk_bf16_f32 v180, v180, v181
buffer_store_dwordx4 v[164:167], v18, s[32:35], s81 offen sc1
v_cvt_pk_bf16_f32 v174, v176, v177
v_cvt_pk_bf16_f32 v175, v178, v179
v_pk_mul_f32 v[184:185], v[184:185], v[102:103] op_sel:[0,1] op_sel_hi:[1,1]
v_pk_mul_f32 v[186:187], v[186:187], v[102:103] op_sel:[0,1] op_sel_hi:[1,1]
v_cvt_pk_bf16_f32 v181, v182, v183
buffer_store_dwordx4 v[172:175], v18, s[32:35], s82 offen sc1
v_cvt_pk_bf16_f32 v182, v184, v185
v_cvt_pk_bf16_f32 v183, v186, v187
buffer_store_dwordx4 v[180:183], v18, s[32:35], s83 offen sc1
s_branch back_97
slow_98:
buffer_store_dword v5, v4, s[32:35], s84 offen sc1
s_branch back_99
slow_102:
s_nop 0
v_cvt_pk_bf16_f32 v20, v60, v61
v_cvt_pk_bf16_f32 v21, v62, v63
v_cvt_pk_bf16_f32 v22, v64, v65
v_cvt_pk_bf16_f32 v23, v66, v67
buffer_store_dwordx4 v[20:23], v18, s[32:35], s85 offen offset:0 sc1
v_cvt_pk_bf16_f32 v24, v68, v69
v_cvt_pk_bf16_f32 v25, v70, v71
v_cvt_pk_bf16_f32 v26, v72, v73
v_cvt_pk_bf16_f32 v27, v74, v75
buffer_store_dwordx4 v[24:27], v18, s[32:35], s85 offen offset:1024 sc1
v_cvt_pk_bf16_f32 v28, v76, v77
v_cvt_pk_bf16_f32 v29, v78, v79
v_cvt_pk_bf16_f32 v30, v80, v81
v_cvt_pk_bf16_f32 v31, v82, v83
buffer_store_dwordx4 v[28:31], v18, s[32:35], s86 offen offset:0 sc1
v_cvt_pk_bf16_f32 v32, v84, v85
v_cvt_pk_bf16_f32 v33, v86, v87
v_cvt_pk_bf16_f32 v34, v88, v89
v_cvt_pk_bf16_f32 v35, v90, v91
buffer_store_dwordx4 v[32:35], v18, s[32:35], s86 offen offset:1024 sc1
s_barrier
v_dot2c_f32_bf16 v6, v20, v48
v_dot2c_f32_bf16 v8, v20, v20
v_dot2c_f32_bf16 v7, v28, v48
v_dot2c_f32_bf16 v9, v28, v28
v_dot2c_f32_bf16 v6, v21, v48
v_dot2c_f32_bf16 v8, v21, v21
v_dot2c_f32_bf16 v7, v29, v48
v_dot2c_f32_bf16 v9, v29, v29
v_dot2c_f32_bf16 v6, v22, v48
v_dot2c_f32_bf16 v8, v22, v22
v_dot2c_f32_bf16 v7, v30, v48
v_dot2c_f32_bf16 v9, v30, v30
v_dot2c_f32_bf16 v6, v23, v48
v_dot2c_f32_bf16 v8, v23, v23
v_dot2c_f32_bf16 v7, v31, v48
v_dot2c_f32_bf16 v9, v31, v31
v_dot2c_f32_bf16 v6, v24, v48
v_dot2c_f32_bf16 v8, v24, v24
v_dot2c_f32_bf16 v7, v32, v48
v_dot2c_f32_bf16 v9, v32, v32
v_dot2c_f32_bf16 v6, v25, v48
v_dot2c_f32_bf16 v8, v25, v25
v_dot2c_f32_bf16 v7, v33, v48
v_dot2c_f32_bf16 v9, v33, v33
v_dot2c_f32_bf16 v6, v26, v48
v_dot2c_f32_bf16 v8, v26, v26
v_dot2c_f32_bf16 v7, v34, v48
v_dot2c_f32_bf16 v9, v34, v34
v_dot2c_f32_bf16 v6, v27, v48
v_dot2c_f32_bf16 v8, v27, v27
v_dot2c_f32_bf16 v7, v35, v48
v_dot2c_f32_bf16 v9, v35, v35
s_mov_b64 exec, 1
s_waitcnt vmcnt(0)
buffer_store_dword v5, v4, s[32:35], s88 offen sc1
s_mov_b64 exec, -1
s_nop 1
v_permlane32_swap_b32 v6, v7
v_permlane32_swap_b32 v8, v9
v_add_f32 v6, v6, v7
v_add_f32 v8, v8, v9
s_nop 1
v_permlane16_swap_b32 v6, v8
s_nop 0
v_add_f32 v6, v6, v8
buffer_store_dword v6, v1, s[32:35], s87 offen sc1
s_branch back_103
slow_114:
.p2align 3
v_mfma_f32_16x16x32_bf16 v[160:163], v[120:123], v[156:159], v[44:47]
v_max_f32 v158, v192, v193
v_max_f32 v159, v194, v195
v_permlane32_swap_b32 v130, v131
s_nop 0
v_max_f32 v130, v130, v131
s_nop 2
v_max_f32 v156, v160, v161
v_max_f32 v157, v162, v163
v_max3_f32 v128, v156, v157, v158
v_max_f32 v128, v128, v159
s_nop 1
v_permlane32_swap_b32 v128, v129
s_nop 0
v_max_f32 v128, v128, v129
s_nop 1
v_permlane16_swap_b32 v128, v130
s_nop 0
v_max_f32 v128, v128, v130
v_mov_b32 v130, v128
s_nop 1
v_permlane16_swap_b32 v128, v130
s_nop 0
v_mov_b32 v129, v128
v_mov_b32 v131, v130
s_nop 0
v_permlane32_swap_b32 v128, v129
v_permlane32_swap_b32 v130, v131
v_mul_f32 v128, v128, v124
v_mul_f32 v129, v129, v125
v_pk_fma_f32 v[156:157], v[156:157], v[124:125], v[128:129] op_sel:[0,0,0] op_sel_hi:[1,0,0] neg_lo:[0,0,1] neg_hi:[0,0,1]
v_pk_fma_f32 v[158:159], v[158:159], v[124:125], v[128:129] op_sel:[0,0,0] op_sel_hi:[1,0,0] neg_lo:[0,0,1] neg_hi:[0,0,1]
v_mul_f32 v130, v130, v126
v_mul_f32 v131, v131, v127
v_exp_f32 v156, v156
v_exp_f32 v157, v157
v_exp_f32 v158, v158
v_exp_f32 v159, v159
v_pk_fma_f32 v[164:165], v[164:165], v[124:125], v[128:129] op_sel:[0,1,1] op_sel_hi:[1,1,1] neg_lo:[0,0,1] neg_hi:[0,0,1]
v_pk_fma_f32 v[166:167], v[166:167], v[124:125], v[128:129] op_sel:[0,1,1] op_sel_hi:[1,1,1] neg_lo:[0,0,1] neg_hi:[0,0,1]
v_exp_f32 v164, v164
v_exp_f32 v165, v165
v_exp_f32 v166, v166
v_exp_f32 v167, v167
v_pk_fma_f32 v[172:173], v[172:173], v[126:127], v[130:131] op_sel:[0,0,0] op_sel_hi:[1,0,0] neg_lo:[0,0,1] neg_hi:[0,0,1]
v_pk_fma_f32 v[174:175], v[174:175], v[126:127], v[130:131] op_sel:[0,0,0] op_sel_hi:[1,0,0] neg_lo:[0,0,1] neg_hi:[0,0,1]
v_cvt_pk_bf16_f32 v156, v156, v156
v_cvt_pk_bf16_f32 v157, v157, v157
v_cvt_pk_bf16_f32 v158, v158, v158
v_cvt_pk_bf16_f32 v159, v159, v159
v_exp_f32 v172, v172
v_exp_f32 v173, v173
v_exp_f32 v174, v174
v_exp_f32 v175, v175
v_pk_fma_f32 v[180:181], v[180:181], v[126:127], v[130:131] op_sel:[0,1,1] op_sel_hi:[1,1,1] neg_lo:[0,0,1] neg_hi:[0,0,1]
v_pk_fma_f32 v[182:183], v[182:183], v[126:127], v[130:131] op_sel:[0,1,1] op_sel_hi:[1,1,1] neg_lo:[0,0,1] neg_hi:[0,0,1]
v_and_b32 v156, v52, v156
v_and_b32 v157, v52, v157
v_and_b32 v158, v52, v158
v_and_b32 v159, v52, v159
v_cvt_pk_bf16_f32 v164, v164, v164
v_cvt_pk_bf16_f32 v165, v165, v165
v_mfma_f32_16x16x32_bf16 v[160:163], v[48:51], v[156:159], 0
v_cvt_pk_bf16_f32 v166, v166, v166
v_cvt_pk_bf16_f32 v167, v167, v167
v_mfma_f32_16x16x32_bf16 v[220:223], v[100:103], v[156:159], 0
v_exp_f32 v180, v180
v_mfma_f32_16x16x32_bf16 v[224:227], v[110:113], v[156:159], 0
v_exp_f32 v181, v181
v_exp_f32 v182, v182
v_exp_f32 v183, v183
v_and_b32 v164, v52, v164
v_and_b32 v165, v52, v165
v_and_b32 v166, v52, v166
v_and_b32 v167, v52, v167
v_cvt_pk_bf16_f32 v172, v172, v172
v_cvt_pk_bf16_f32 v173, v173, v173
v_mfma_f32_16x16x32_bf16 v[168:171], v[48:51], v[164:167], 0
v_cvt_pk_bf16_f32 v174, v174, v174
v_cvt_pk_bf16_f32 v175, v175, v175
v_mfma_f32_16x16x32_bf16 v[228:231], v[102:105], v[164:167], 0
v_and_b32 v172, v52, v172
v_and_b32 v173, v52, v173
v_mfma_f32_16x16x32_bf16 v[232:235], v[112:115], v[164:167], 0
v_and_b32 v174, v52, v174
v_and_b32 v175, v52, v175
v_cvt_pk_bf16_f32 v180, v180, v180
v_cvt_pk_bf16_f32 v181, v181, v181
v_mfma_f32_16x16x32_bf16 v[176:179], v[48:51], v[172:175], 0
v_cvt_pk_bf16_f32 v182, v182, v182
v_cvt_pk_bf16_f32 v183, v183, v183
v_mfma_f32_16x16x32_bf16 v[236:239], v[104:107], v[172:175], 0
v_and_b32 v180, v52, v180
v_and_b32 v181, v52, v181
v_mfma_f32_16x16x32_bf16 v[240:243], v[114:117], v[172:175], 0
v_and_b32 v182, v52, v182
v_and_b32 v183, v52, v183
v_rcp_f32 v160, v160
v_rcp_f32 v168, v168
v_pk_mul_f32 v[220:221], v[220:221], v[160:161] op_sel:[0,0] op_sel_hi:[1,0]
v_pk_mul_f32 v[222:223], v[222:223], v[160:161] op_sel:[0,0] op_sel_hi:[1,0]
v_pk_mul_f32 v[228:229], v[228:229], v[168:169] op_sel:[0,0] op_sel_hi:[1,0]
v_pk_mul_f32 v[224:225], v[224:225], v[160:161] op_sel:[0,0] op_sel_hi:[1,0]
v_pk_mul_f32 v[226:227], v[226:227], v[160:161] op_sel:[0,0] op_sel_hi:[1,0]
v_pk_mul_f32 v[230:231], v[230:231], v[168:169] op_sel:[0,0] op_sel_hi:[1,0]
v_pk_mul_f32 v[232:233], v[232:233], v[168:169] op_sel:[0,0] op_sel_hi:[1,0]
v_pk_mul_f32 v[234:235], v[234:235], v[168:169] op_sel:[0,0] op_sel_hi:[1,0]
v_mfma_f32_16x16x32_bf16 v[184:187], v[48:51], v[180:183], 0
v_rcp_f32_e64 v176, v176
v_cvt_pk_bf16_f32 v220, v220, v221
v_cvt_pk_bf16_f32 v221, v222, v223
v_cvt_pk_bf16_f32 v228, v228, v229
v_pk_mul_f32 v[236:237], v[236:237], v[176:177] op_sel:[0,0] op_sel_hi:[1,0]
v_mfma_f32_16x16x32_bf16 v[244:247], v[106:109], v[180:183], 0
v_cvt_pk_bf16_f32 v222, v224, v225
v_cvt_pk_bf16_f32 v223, v226, v227
v_rcp_f32_e64 v184, v184
v_cvt_pk_bf16_f32 v229, v230, v231
v_pk_mul_f32 v[238:239], v[238:239], v[176:177] op_sel:[0,0] op_sel_hi:[1,0]
v_pk_mul_f32 v[240:241], v[240:241], v[176:177] op_sel:[0,0] op_sel_hi:[1,0]
v_pk_mul_f32 v[242:243], v[242:243], v[176:177] op_sel:[0,0] op_sel_hi:[1,0]
v_cvt_pk_bf16_f32 v236, v236, v237
v_pk_mul_f32 v[244:245], v[244:245], v[184:185] op_sel:[0,0] op_sel_hi:[1,0]
v_pk_mul_f32 v[246:247], v[246:247], v[184:185] op_sel:[0,0] op_sel_hi:[1,0]
v_mfma_f32_16x16x32_bf16 v[248:251], v[116:119], v[180:183], 0
buffer_store_dwordx4 v[220:223], v18, s[32:35], s80 offen sc1
v_cvt_pk_bf16_f32 v230, v232, v233
v_cvt_pk_bf16_f32 v231, v234, v235
v_cvt_pk_bf16_f32 v237, v238, v239
v_cvt_pk_bf16_f32 v244, v244, v245
buffer_store_dwordx4 v[228:231], v18, s[32:35], s81 offen sc1
v_cvt_pk_bf16_f32 v238, v240, v241
v_cvt_pk_bf16_f32 v239, v242, v243
v_pk_mul_f32 v[248:249], v[248:249], v[184:185] op_sel:[0,0] op_sel_hi:[1,0]
v_pk_mul_f32 v[250:251], v[250:251], v[184:185] op_sel:[0,0] op_sel_hi:[1,0]
v_cvt_pk_bf16_f32 v245, v246, v247
buffer_store_dwordx4 v[236:239], v18, s[32:35], s82 offen sc1
v_cvt_pk_bf16_f32 v246, v248, v249
v_cvt_pk_bf16_f32 v247, v250, v251
buffer_store_dwordx4 v[244:247], v18, s[32:35], s83 offen sc1
s_branch back_115
slow_116:
buffer_store_dword v5, v4, s[32:35], s84 offen sc1
s_branch back_117
slow_120:
s_nop 0
v_cvt_pk_bf16_f32 v20, v60, v61
v_cvt_pk_bf16_f32 v21, v62, v63
v_cvt_pk_bf16_f32 v22, v64, v65
v_cvt_pk_bf16_f32 v23, v66, v67
buffer_store_dwordx4 v[20:23], v18, s[32:35], s85 offen offset:0 sc1
v_cvt_pk_bf16_f32 v24, v68, v69
v_cvt_pk_bf16_f32 v25, v70, v71
v_cvt_pk_bf16_f32 v26, v72, v73
v_cvt_pk_bf16_f32 v27, v74, v75
buffer_store_dwordx4 v[24:27], v18, s[32:35], s85 offen offset:1024 sc1
v_cvt_pk_bf16_f32 v28, v76, v77
v_cvt_pk_bf16_f32 v29, v78, v79
v_cvt_pk_bf16_f32 v30, v80, v81
v_cvt_pk_bf16_f32 v31, v82, v83
buffer_store_dwordx4 v[28:31], v18, s[32:35], s86 offen offset:0 sc1
v_cvt_pk_bf16_f32 v32, v84, v85
v_cvt_pk_bf16_f32 v33, v86, v87
v_cvt_pk_bf16_f32 v34, v88, v89
v_cvt_pk_bf16_f32 v35, v90, v91
buffer_store_dwordx4 v[32:35], v18, s[32:35], s86 offen offset:1024 sc1
s_barrier
v_dot2c_f32_bf16 v6, v20, v48
v_dot2c_f32_bf16 v8, v20, v20
v_dot2c_f32_bf16 v7, v28, v48
v_dot2c_f32_bf16 v9, v28, v28
v_dot2c_f32_bf16 v6, v21, v48
v_dot2c_f32_bf16 v8, v21, v21
v_dot2c_f32_bf16 v7, v29, v48
v_dot2c_f32_bf16 v9, v29, v29
v_dot2c_f32_bf16 v6, v22, v48
v_dot2c_f32_bf16 v8, v22, v22
v_dot2c_f32_bf16 v7, v30, v48
v_dot2c_f32_bf16 v9, v30, v30
v_dot2c_f32_bf16 v6, v23, v48
v_dot2c_f32_bf16 v8, v23, v23
v_dot2c_f32_bf16 v7, v31, v48
v_dot2c_f32_bf16 v9, v31, v31
v_dot2c_f32_bf16 v6, v24, v48
v_dot2c_f32_bf16 v8, v24, v24
v_dot2c_f32_bf16 v7, v32, v48
v_dot2c_f32_bf16 v9, v32, v32
v_dot2c_f32_bf16 v6, v25, v48
v_dot2c_f32_bf16 v8, v25, v25
v_dot2c_f32_bf16 v7, v33, v48
v_dot2c_f32_bf16 v9, v33, v33
v_dot2c_f32_bf16 v6, v26, v48
v_dot2c_f32_bf16 v8, v26, v26
v_dot2c_f32_bf16 v7, v34, v48
v_dot2c_f32_bf16 v9, v34, v34
v_dot2c_f32_bf16 v6, v27, v48
v_dot2c_f32_bf16 v8, v27, v27
v_dot2c_f32_bf16 v7, v35, v48
v_dot2c_f32_bf16 v9, v35, v35
s_mov_b64 exec, 1
s_waitcnt vmcnt(0)
buffer_store_dword v5, v4, s[32:35], s88 offen sc1
s_mov_b64 exec, -1
s_nop 1
v_permlane32_swap_b32 v6, v7
v_permlane32_swap_b32 v8, v9
v_add_f32 v6, v6, v7
v_add_f32 v8, v8, v9
s_nop 1
v_permlane16_swap_b32 v6, v8
s_nop 0
v_add_f32 v6, v6, v8
buffer_store_dword v6, v1, s[32:35], s87 offen sc1
s_branch back_121
slow_134:
.p2align 3
v_mfma_f32_16x16x32_bf16 v[156:159], v[188:191], v[60:63], 0
v_mfma_f32_16x16x32_bf16 v[164:167], v[188:191], v[68:71], 0
v_mfma_f32_16x16x32_bf16 v[160:163], v[192:195], v[60:63], 0
v_mfma_f32_16x16x32_bf16 v[172:175], v[188:191], v[76:79], 0
v_mfma_f32_16x16x32_bf16 v[168:171], v[192:195], v[68:71], 0
v_mfma_f32_16x16x32_bf16 v[180:183], v[188:191], v[84:87], 0
v_mfma_f32_16x16x32_bf16 v[156:159], v[196:199], v[220:223], v[156:159]
v_mfma_f32_16x16x32_bf16 v[176:179], v[192:195], v[76:79], 0
v_mfma_f32_16x16x32_bf16 v[164:167], v[196:199], v[228:231], v[164:167]
v_mfma_f32_16x16x32_bf16 v[184:187], v[192:195], v[84:87], 0
v_mfma_f32_16x16x32_bf16 v[160:163], v[200:203], v[220:223], v[160:163]
v_mfma_f32_16x16x32_bf16 v[172:175], v[196:199], v[236:239], v[172:175]
v_mfma_f32_16x16x32_bf16 v[168:171], v[200:203], v[228:231], v[168:171]
v_mfma_f32_16x16x32_bf16 v[180:183], v[196:199], v[244:247], v[180:183]
v_mfma_f32_16x16x32_bf16 v[176:179], v[200:203], v[236:239], v[176:179]
v_mfma_f32_16x16x32_bf16 v[184:187], v[200:203], v[244:247], v[184:187]
v_pk_mul_f32 v[156:157], v[156:157], v[100:101] op_sel:[0,0] op_sel_hi:[1,0]
v_pk_mul_f32 v[158:159], v[158:159], v[100:101] op_sel:[0,0] op_sel_hi:[1,0]
v_cvt_pk_bf16_f32 v156, v156, v157
v_pk_mul_f32 v[164:165], v[164:165], v[100:101] op_sel:[0,1] op_sel_hi:[1,1]
v_pk_mul_f32 v[160:161], v[160:161], v[100:101] op_sel:[0,0] op_sel_hi:[1,0]
v_pk_mul_f32 v[162:163], v[162:163], v[100:101] op_sel:[0,0] op_sel_hi:[1,0]
v_cvt_pk_bf16_f32 v157, v158, v159
v_pk_mul_f32 v[166:167], v[166:167], v[100:101] op_sel:[0,1] op_sel_hi:[1,1]
v_cvt_pk_bf16_f32 v164, v164, v165
v_pk_mul_f32 v[172:173], v[172:173], v[102:103] op_sel:[0,0] op_sel_hi:[1,0]
v_cvt_pk_bf16_f32 v158, v160, v161
v_cvt_pk_bf16_f32 v159, v162, v163
v_pk_mul_f32 v[168:169], v[168:169], v[100:101] op_sel:[0,1] op_sel_hi:[1,1]
v_pk_mul_f32 v[170:171], v[170:171], v[100:101] op_sel:[0,1] op_sel_hi:[1,1]
v_cvt_pk_bf16_f32 v165, v166, v167
v_pk_mul_f32 v[174:175], v[174:175], v[102:103] op_sel:[0,0] op_sel_hi:[1,0]
v_cvt_pk_bf16_f32 v172, v172, v173
v_pk_mul_f32 v[180:181], v[180:181], v[102:103] op_sel:[0,1] op_sel_hi:[1,1]
buffer_store_dwordx4 v[156:159], v18, s[32:35], s80 offen sc1
v_cvt_pk_bf16_f32 v166, v168, v169
v_cvt_pk_bf16_f32 v167, v170, v171
v_pk_mul_f32 v[176:177], v[176:177], v[102:103] op_sel:[0,0] op_sel_hi:[1,0]
v_pk_mul_f32 v[178:179], v[178:179], v[102:103] op_sel:[0,0] op_sel_hi:[1,0]
v_cvt_pk_bf16_f32 v173, v174, v175
v_pk_mul_f32 v[182:183], v[182:183], v[102:103] op_sel:[0,1] op_sel_hi:[1,1]
v_cvt_pk_bf16_f32 v180, v180, v181
buffer_store_dwordx4 v[164:167], v18, s[32:35], s81 offen sc1
v_cvt_pk_bf16_f32 v174, v176, v177
v_cvt_pk_bf16_f32 v175, v178, v179
v_pk_mul_f32 v[184:185], v[184:185], v[102:103] op_sel:[0,1] op_sel_hi:[1,1]
v_pk_mul_f32 v[186:187], v[186:187], v[102:103] op_sel:[0,1] op_sel_hi:[1,1]
v_cvt_pk_bf16_f32 v181, v182, v183
buffer_store_dwordx4 v[172:175], v18, s[32:35], s82 offen sc1
v_cvt_pk_bf16_f32 v182, v184, v185
v_cvt_pk_bf16_f32 v183, v186, v187
buffer_store_dwordx4 v[180:183], v18, s[32:35], s83 offen sc1
s_branch back_135
slow_136:
buffer_store_dword v5, v4, s[32:35], s84 offen sc1
s_branch back_137
s_endpgm
.section .rodata,"a"
.p2align 6
.amdhsa_kernel interleave_layers__sliding_local_dilated__linear_kernel_hedgehog__prompt_kernel
  .amdhsa_next_free_vgpr 256
  .amdhsa_next_free_sgpr 102
  .amdhsa_accum_offset 256
  .amdhsa_group_segment_fixed_size 0
  .amdhsa_kernarg_size 80
  .amdhsa_user_sgpr_count 2
  .amdhsa_user_sgpr_kernarg_segment_ptr 1
  .amdhsa_system_sgpr_workgroup_id_x 1
.end_amdhsa_kernel
```

```asm
; @launch grid=(256,1,1) block=(512,1,1) lds=163840
.amdgcn_target "amdgcn-amd-amdhsa--gfx950"
.text
.globl interleave_layers__sliding_local_dilated__linear_kernel_hedgehog__prompt_kernel
.p2align 8
.type interleave_layers__sliding_local_dilated__linear_kernel_hedgehog__prompt_kernel,@function
interleave_layers__sliding_local_dilated__linear_kernel_hedgehog__prompt_kernel:
s_cmp_ge_u32 s2, 256
s_cbranch_scc1 L_end
s_load_dwordx16 s[4:19], s[0:1], 0
s_load_dwordx4 s[20:23], s[0:1], 64
v_lshrrev_b32 v1, 6, v0
v_and_b32 v0, 63, v0
v_readfirstlane_b32 s40, v1
v_and_b32 v2, 15, v0
v_lshrrev_b32 v3, 4, v0
v_lshlrev_b32 v18, 4, v0
s_and_b32 s48, s2, 7
s_lshr_b32 s49, s2, 3
s_and_b32 s74, s49, 1
s_lshl_b32 s41, s48, 1
s_add_u32 s41, s41, s74
s_lshr_b32 s42, s49, 1
s_and_b32 s48, s2, 7
s_lshr_b32 s47, s42, 2
s_add_u32 s47, s47, s48
s_and_b32 s47, s47, 3
s_and_b32 s43, s40, 3
s_lshl_b32 s70, s43, 12
s_lshl_b32 s71, s43, 11
s_add_u32 s71, s71, 16384
s_cmp_lt_u32 s40, 4
s_cbranch_scc1 L_compute
v_lshrrev_b32 v4, 3, v0
v_and_b32 v5, 7, v0
s_lshl_b32 s48, s43, 4
v_add_u32 v6, s48, v4
s_lshl_b32 s48, s42, 7
s_mov_b32 s49, 6144
v_mul_u32_u24 v6, s49, v6
v_and_b32 v7, 2, v4
v_xor_b32 v7, v7, v5
v_lshl_add_u32 v26, v7, 4, v6
v_add_u32 v26, s48, v26
s_mul_i32 s49, s49, 8
s_sub_u32 s49, s49, 1024
v_xor_b32 v27, 64, v26
v_add_u32 v27, s49, v27
s_mov_b32 s53, 2048
s_mov_b32 s54, 393216
s_mov_b32 s57, 131072
s_lshl_b32 s48, s41, 7
s_lshl_b32 s49, s43, 5
s_add_u32 s48, s48, s49
v_add_u32 v6, s48, v4
v_lshlrev_b32 v6, 11, v6
v_lshrrev_b32 v7, 1, v4
v_xor_b32 v7, v7, v5
v_lshl_add_u32 v20, v7, 4, v6
v_xor_b32 v21, 64, v20
v_add_u32 v21, 15360, v21
v_add_u32 v22, 30720, v20
v_add_u32 v23, 30720, v21
s_add_u32 s69, s47, 0
s_and_b32 s69, s69, 3
s_add_u32 s69, s69, 0
s_mul_i32 s67, s69, 128
s_mul_i32 s68, s69, s54
s_waitcnt lgkmcnt(0)
s_mov_b32 s24, s4
s_and_b32 s25, s5, 0xffff
s_mov_b32 s26, 4194304
s_mov_b32 s27, 0x00020000
s_mov_b32 s28, s6
s_and_b32 s29, s7, 0xffff
s_mov_b32 s30, 6291456
s_mov_b32 s31, 0x00020000
s_add_u32 m0, s70, 0
s_nop 0
buffer_load_dwordx4 v20, s[24:27], s67 offen offset:0  lds
buffer_load_dwordx4 v21, s[24:27], s67 offen offset:1024  lds
buffer_load_dwordx4 v22, s[24:27], s67 offen offset:2048  lds
buffer_load_dwordx4 v23, s[24:27], s67 offen offset:3072  lds
s_add_u32 s60, s71, 0
s_add_u32 m0, s60, 0
s_mov_b32 s61, s68
buffer_load_dwordx4 v26, s[28:31], s61 offen lds
buffer_load_dwordx4 v27, s[28:31], s61 offen offset:1024 lds
s_add_u32 m0, s60, 8192
s_add_u32 s61, s61, s53
buffer_load_dwordx4 v26, s[28:31], s61 offen lds
buffer_load_dwordx4 v27, s[28:31], s61 offen offset:1024 lds
s_lshr_b32 s48, s2, 2
s_and_b32 s48, s48, 1
s_lshl_b32 s48, s48, 1
s_add_u32 s48, s48, s74
s_and_b32 s49, s42, 3
s_xor_b32 s77, s48, s49
s_add_u32 s77, s77, 4
s_lshr_b32 s48, s77, 2
s_add_u32 s48, s47, s48
s_and_b32 s48, s48, 3
s_and_b32 s49, s77, 3
s_lshl_b32 s49, s49, 2
s_add_u32 s78, s48, s49
s_and_b32 s48, s2, 7
s_lshl_b32 s48, s48, 1
s_add_u32 s75, s78, s48
s_and_b32 s75, s75, 15
s_mov_b32 s46, 0
s_mov_b32 s32, s22
s_and_b32 s33, s23, 0xffff
s_mov_b32 s34, 268435456
s_mov_b32 s35, 0x00020000
s_mov_b32 s36, s8
s_and_b32 s37, s9, 0xffff
s_mov_b32 s38, 2097152
s_mov_b32 s39, 0x00020000
v_mov_b32 v56, -1
v_mov_b32 v57, -1
v_mov_b32 v58, -1
v_mov_b32 v59, -1
s_lshl_b32 s52, s41, 6
s_add_u32 s52, s52, s42
s_lshl_b32 s52, s52, 8
s_add_u32 s52, s52, 16777216
s_getreg_b32 s50, hwreg(HW_REG_XCC_ID)
s_and_b32 s50, s50, 7
s_lshl_b32 s50, s50, 3
s_lshl_b64 s[94:95], 1, s50
s_and_b32 s96, s2, 7
s_lshl_b32 s96, s96, 5
s_and_b32 s51, s42, 7
s_cmp_gt_u32 s51, 3
s_cselect_b32 s49, 1, 0
s_sub_u32 s49, s51, s49
s_lshl_b32 s49, s49, 1
s_add_u32 s49, s49, s74
s_lshl_b32 s49, s49, 2
s_add_u32 s49, s49, s43
s_lshr_b32 s50, s49, 4
s_lshl_b32 s50, s50, 11
s_and_b32 s49, s49, 15
s_mul_i32 s49, s49, 24576
s_add_u32 s49, s49, s50
s_and_b32 s50, s42, 8
s_or_b32 s50, s50, 3
s_and_b32 s48, s2, 7
s_lshr_b32 s76, s50, 2
s_add_u32 s76, s76, s48
s_and_b32 s76, s76, 3
s_lshl_b32 s50, s50, 7
s_add_u32 s49, s49, s50
s_and_b32 s51, s51, 3
s_cmp_eq_u32 s51, 3
s_cselect_b32 s49, 0x70000000, s49
v_mul_u32_u24 v4, 6144, v4
v_lshl_add_u32 v4, v5, 4, v4
v_lshrrev_b32 v5, 5, v0
v_lshlrev_b32 v5, 30, v5
v_add3_u32 v36, v4, v5, s49
s_mov_b32 s55, -1
s_mov_b32 s56, -1
v_lshrrev_b32 v4, 3, v0
v_and_b32 v5, 7, v0
s_lshr_b32 s48, s43, 1
s_lshl_b32 s48, s48, 5
s_and_b32 s49, s43, 1
s_lshl_b32 s49, s49, 3
s_add_u32 s48, s48, s49
v_lshrrev_b32 v6, 2, v4
v_lshlrev_b32 v6, 4, v6
v_and_b32 v7, 3, v4
v_add3_u32 v6, v6, v7, s48
s_lshl_b32 s48, s78, 7
s_mov_b32 s49, 2048
v_mul_u32_u24 v6, s49, v6
v_and_b32 v7, 2, v4
v_xor_b32 v7, v7, v5
v_lshl_add_u32 v28, v7, 4, v6
v_add_u32 v28, s48, v28
s_mul_i32 s49, s49, 4
s_sub_u32 s49, s49, 1024
v_xor_b32 v29, 64, v28
v_add_u32 v29, s49, v29
v_lshrrev_b32 v4, 3, v0
v_and_b32 v5, 7, v0
s_lshr_b32 s48, s43, 1
s_lshl_b32 s48, s48, 5
s_and_b32 s49, s43, 1
s_lshl_b32 s49, s49, 3
s_add_u32 s48, s48, s49
v_lshrrev_b32 v6, 2, v4
v_lshlrev_b32 v6, 4, v6
v_and_b32 v7, 3, v4
v_add3_u32 v6, v6, v7, s48
s_lshl_b32 s48, s42, 7
s_mov_b32 s49, 6144
s_cmp_ge_i32 s55, 0
s_cselect_b32 s48, 1024, s48
s_cselect_b32 s49, 384, s49
v_mul_u32_u24 v6, s49, v6
v_and_b32 v7, 2, v4
v_xor_b32 v7, v7, v5
v_lshl_add_u32 v60, v7, 4, v6
v_add_u32 v60, s48, v60
s_mul_i32 s49, s49, 4
s_sub_u32 s49, s49, 1024
v_xor_b32 v61, 64, v60
v_add_u32 v61, s49, v61
v_lshrrev_b32 v4, 3, v0
v_and_b32 v5, 7, v0
s_lshr_b32 s48, s43, 1
s_lshl_b32 s48, s48, 5
s_and_b32 s49, s43, 1
s_lshl_b32 s49, s49, 3
s_add_u32 s48, s48, s49
v_lshrrev_b32 v6, 2, v4
v_lshlrev_b32 v6, 4, v6
v_and_b32 v7, 3, v4
v_add3_u32 v6, v6, v7, s48
s_lshl_b32 s48, s78, 7
s_mov_b32 s49, 2048
s_cmp_ge_i32 s56, 0
s_cselect_b32 s48, 1024, s48
s_cselect_b32 s49, 128, s49
v_mul_u32_u24 v6, s49, v6
v_and_b32 v7, 2, v4
v_xor_b32 v7, v7, v5
v_lshl_add_u32 v24, v7, 4, v6
v_add_u32 v24, s48, v24
s_mul_i32 s49, s49, 4
s_sub_u32 s49, s49, 1024
v_xor_b32 v25, 64, v24
v_add_u32 v25, s49, v25
v_lshlrev_b32 v30, 2, v2
v_and_b32 v32, 7, v0
v_lshlrev_b32 v32, 5, v32
s_lshl_b32 s50, s41, 2
s_add_u32 s50, s50, s43
s_lshl_b32 s50, s50, 12
s_add_u32 s50, s50, 16777216
v_add_u32 v37, s50, v18
v_lshrrev_b32 v4, 5, v0
v_lshl_add_u32 v4, v4, 4, v2
s_lshl_b32 s48, s43, 5
v_add_u32 v4, s48, v4
v_lshlrev_b32 v49, 3, v4
v_add_u32 v49, 131072, v49
v_lshlrev_b32 v50, 2, v4
v_add_u32 v50, 132096, v50
s_lshl_b32 s79, s41, 2
s_add_u32 s79, s79, s43
s_lshl_b32 s79, s79, 7
s_add_u32 s79, s79, 18358272
s_lshl_b32 s48, s41, 3
s_lshl_b32 s49, s43, 1
s_add_u32 s48, s48, s49
s_lshl_b32 s80, s48, 15
s_lshl_b32 s49, s42, 11
s_add_u32 s81, s80, s49
s_add_u32 s81, s81, 4194304
s_add_u32 s82, s81, 32768
s_lshl_b32 s48, s43, 11
v_add_u32 v51, s48, v18
v_add_u32 v52, 0x10000, v51
v_add_u32 v14, 0x20000, v51
s_lshl_b32 s48, s2, 2
s_add_u32 s48, s48, s43
s_lshl_b32 s83, s48, 11
s_mul_i32 s87, s48, 6144
v_add_u32 v62, s83, v18
s_add_u32 s87, s87, 3072
v_add_u32 v63, s87, v18
s_and_b32 s48, s2, 7
s_add_u32 s83, s42, s48
s_and_b32 s83, s83, 7
s_mul_i32 s83, s83, 2
s_add_u32 s87, s83, 1
s_and_b32 s87, s87, 15
s_mul_i32 s83, s83, 393216
s_mul_i32 s87, s87, 393216
v_add_u32 v63, 1024, v61
s_cmp_eq_u32 s74, 0
s_cselect_b64 vcc, -1, 0
v_cndmask_b32 v63, v63, v60, vcc
s_lshr_b32 s48, s2, 4
s_and_b32 s49, s2, 7
s_add_u32 s48, s48, s49
s_mul_i32 s49, s48, 8193
s_lshr_b32 s49, s49, 16
s_mul_i32 s49, s49, 8
s_sub_u32 s88, s48, s49
s_lshr_b32 s48, s2, 3
s_lshl_b32 s48, s48, 2
s_add_u32 s48, s48, s43
s_lshl_b32 s48, s48, 14
s_add_u32 s48, s48, 384
v_lshrrev_b32 v4, 3, v0
v_and_b32 v5, 7, v0
v_lshlrev_b32 v4, 11, v4
v_lshl_add_u32 v4, v5, 4, v4
v_add_u32 v15, s48, v4
s_lshl_b32 s49, s43, 10
s_lshl_b32 s48, s42, 12
s_add_u32 s48, s48, s49
v_add_u32 v16, s48, v18
s_add_u32 s49, s49, 135168
v_add_u32 v13, s49, v18
s_mul_i32 s48, s42, 163840
s_add_u32 s48, s48, 9437184
s_lshl_b32 s49, s43, 4
s_add_u32 s49, s49, s41
s_lshl_b32 s50, s49, 11
s_add_u32 s86, s48, s50
s_lshl_b32 s50, s49, 9
s_add_u32 s89, s48, s50
s_add_u32 s89, s89, 131072
v_lshlrev_b32 v39, 3, v0
s_lshl_b32 s73, s42, 2
s_add_u32 s73, s73, 0
s_lshl_b32 s73, s73, 7
s_add_u32 s73, s73, 18366464
v_mov_b32 v12, 0
s_lshl_b32 s50, s43, 12
s_add_u32 s50, s50, s52
s_add_u32 s50, s50, 262144
v_min_u32 v8, 2, v3
v_lshlrev_b32 v8, 18, v8
v_lshl_add_u32 v8, v2, 4, v8
v_add_u32 v55, s50, v8
s_lshl_b32 s50, s42, 2
s_add_u32 s50, s50, s43
s_lshl_b32 s50, s50, 12
s_add_u32 s50, s50, 17825792
v_add_u32 v38, s50, v18
v_min_u32 v4, 2, v3
v_lshlrev_b32 v4, 8, v4
v_lshl_add_u32 v4, v2, 2, v4
s_and_b32 s48, s43, 1
s_lshl_b32 s48, s48, 7
s_lshr_b32 s49, s43, 1
s_lshl_b32 s49, s49, 6
s_add_u32 s48, s48, s49
s_add_u32 s48, s48, 133120
v_add_u32 v53, s48, v4
s_getpc_b64 s[98:99]
pc_1:
s_add_u32 s98, s98, c0_last - pc_1
s_addc_u32 s99, s99, 0
s_lshr_b32 s50, s2, 3
s_lshl_b32 s50, s50, 2
s_add_u32 s50, s50, s43
s_lshl_b32 s50, s50, 7
v_and_b32 v4, 1, v0
v_lshl_add_u32 v4, v4, 6, s50
v_min_u32 v54, L_code_end - c0_last, v4
s_add_u32 m0, s60, 16384
s_add_u32 s61, s61, s53
buffer_load_dwordx4 v26, s[28:31], s61 offen lds
buffer_load_dwordx4 v27, s[28:31], s61 offen offset:1024 lds
s_add_u32 s69, s47, 0
s_and_b32 s69, s69, 3
s_add_u32 s69, s69, 4
s_mul_i32 s67, s69, 128
s_mul_i32 s68, s69, s54
s_add_u32 m0, s70, 40960
s_nop 0
buffer_load_dwordx4 v20, s[24:27], s67 offen offset:0  lds
buffer_load_dwordx4 v21, s[24:27], s67 offen offset:1024  lds
buffer_load_dwordx4 v22, s[24:27], s67 offen offset:2048  lds
buffer_load_dwordx4 v23, s[24:27], s67 offen offset:3072  lds
s_add_u32 s60, s71, 40960
s_add_u32 m0, s60, 0
s_mov_b32 s61, s68
buffer_load_dwordx4 v26, s[28:31], s61 offen lds
buffer_load_dwordx4 v27, s[28:31], s61 offen offset:1024 lds
s_add_u32 m0, s60, 8192
s_add_u32 s61, s61, s53
buffer_load_dwordx4 v26, s[28:31], s61 offen lds
buffer_load_dwordx4 v27, s[28:31], s61 offen offset:1024 lds
s_add_u32 m0, s60, 16384
s_add_u32 s61, s61, s53
buffer_load_dwordx4 v26, s[28:31], s61 offen lds
buffer_load_dwordx4 v27, s[28:31], s61 offen offset:1024 lds
s_waitcnt vmcnt(10)
s_barrier
s_cmp_lg_u32 s43, 3
s_cbranch_scc1 else_2
s_atomic_add_x2 s[94:95], s[20:21], s96
else_2:
s_add_u32 s49, s76, 0
s_and_b32 s49, s49, 3
s_add_u32 s49, s49, 8
s_mul_i32 s49, s49, 393216
buffer_load_dwordx4 v[40:43], v36, s[28:31], s49 offen
s_add_u32 s49, s76, 0
s_and_b32 s49, s49, 3
s_add_u32 s49, s49, 12
s_mul_i32 s49, s49, 393216
buffer_load_dwordx4 v[40:43], v36, s[28:31], s49 offen
s_add_u32 s69, s47, 0
s_and_b32 s69, s69, 3
s_add_u32 s69, s69, 8
s_mul_i32 s67, s69, 128
s_mul_i32 s68, s69, s54
s_add_u32 m0, s70, 81920
s_nop 0
buffer_load_dwordx4 v20, s[24:27], s67 offen offset:0  lds
buffer_load_dwordx4 v21, s[24:27], s67 offen offset:1024  lds
buffer_load_dwordx4 v22, s[24:27], s67 offen offset:2048  lds
buffer_load_dwordx4 v23, s[24:27], s67 offen offset:3072  lds
s_add_u32 s60, s71, 81920
s_add_u32 m0, s60, 0
s_mov_b32 s61, s68
buffer_load_dwordx4 v26, s[28:31], s61 offen lds
buffer_load_dwordx4 v27, s[28:31], s61 offen offset:1024 lds
s_add_u32 m0, s60, 8192
s_add_u32 s61, s61, s53
buffer_load_dwordx4 v26, s[28:31], s61 offen lds
buffer_load_dwordx4 v27, s[28:31], s61 offen offset:1024 lds
s_add_u32 m0, s60, 16384
s_add_u32 s61, s61, s53
buffer_load_dwordx4 v26, s[28:31], s61 offen lds
buffer_load_dwordx4 v27, s[28:31], s61 offen offset:1024 lds
s_add_u32 s49, s76, 1
s_and_b32 s49, s49, 3
s_add_u32 s49, s49, 0
s_mul_i32 s49, s49, 393216
buffer_load_dwordx4 v[40:43], v36, s[28:31], s49 offen
s_mov_b32 s64, 0
s_mov_b32 s65, 0
s_waitcnt vmcnt(11)
s_barrier
s_add_u32 s69, s47, 0
s_and_b32 s69, s69, 3
s_add_u32 s69, s69, 12
s_mul_i32 s67, s69, 128
s_mul_i32 s68, s69, s54
s_add_u32 m0, s70, s65
s_nop 0
buffer_load_dwordx4 v20, s[24:27], s67 offen offset:0  lds
buffer_load_dwordx4 v21, s[24:27], s67 offen offset:1024  lds
buffer_load_dwordx4 v22, s[24:27], s67 offen offset:2048  lds
buffer_load_dwordx4 v23, s[24:27], s67 offen offset:3072  lds
s_add_u32 s60, s71, s65
s_add_u32 m0, s60, 0
s_mov_b32 s61, s68
buffer_load_dwordx4 v26, s[28:31], s61 offen lds
buffer_load_dwordx4 v27, s[28:31], s61 offen offset:1024 lds
s_add_u32 m0, s60, 8192
s_add_u32 s61, s61, s53
buffer_load_dwordx4 v26, s[28:31], s61 offen lds
buffer_load_dwordx4 v27, s[28:31], s61 offen offset:1024 lds
s_add_u32 m0, s60, 16384
s_add_u32 s61, s61, s53
buffer_load_dwordx4 v26, s[28:31], s61 offen lds
buffer_load_dwordx4 v27, s[28:31], s61 offen offset:1024 lds
s_add_u32 s49, s76, 1
s_and_b32 s49, s49, 3
s_add_u32 s49, s49, 4
s_mul_i32 s49, s49, 393216
buffer_load_dwordx4 v[40:43], v36, s[28:31], s49 offen
s_add_u32 s65, s65, 40960
s_cmp_eq_u32 s65, 122880
s_cselect_b32 s65, 0, s65
s_add_u32 s64, s64, 1
s_waitcnt vmcnt(11)
s_barrier
s_add_u32 s69, s47, 1
s_and_b32 s69, s69, 3
s_add_u32 s69, s69, 0
s_mul_i32 s67, s69, 128
s_mul_i32 s68, s69, s54
s_add_u32 m0, s70, s65
s_nop 0
buffer_load_dwordx4 v20, s[24:27], s67 offen offset:0  lds
buffer_load_dwordx4 v21, s[24:27], s67 offen offset:1024  lds
buffer_load_dwordx4 v22, s[24:27], s67 offen offset:2048  lds
buffer_load_dwordx4 v23, s[24:27], s67 offen offset:3072  lds
s_add_u32 s60, s71, s65
s_add_u32 m0, s60, 0
s_mov_b32 s61, s68
buffer_load_dwordx4 v26, s[28:31], s61 offen lds
buffer_load_dwordx4 v27, s[28:31], s61 offen offset:1024 lds
s_add_u32 m0, s60, 8192
s_add_u32 s61, s61, s53
buffer_load_dwordx4 v26, s[28:31], s61 offen lds
buffer_load_dwordx4 v27, s[28:31], s61 offen offset:1024 lds
s_add_u32 m0, s60, 16384
s_add_u32 s61, s61, s53
buffer_load_dwordx4 v26, s[28:31], s61 offen lds
buffer_load_dwordx4 v27, s[28:31], s61 offen offset:1024 lds
s_add_u32 s49, s76, 1
s_and_b32 s49, s49, 3
s_add_u32 s49, s49, 8
s_mul_i32 s49, s49, 393216
buffer_load_dwordx4 v[40:43], v36, s[28:31], s49 offen
s_add_u32 s65, s65, 40960
s_cmp_eq_u32 s65, 122880
s_cselect_b32 s65, 0, s65
s_add_u32 s64, s64, 1
s_waitcnt vmcnt(11)
s_barrier
s_add_u32 s69, s47, 1
s_and_b32 s69, s69, 3
s_add_u32 s69, s69, 4
s_mul_i32 s67, s69, 128
s_mul_i32 s68, s69, s54
s_add_u32 m0, s70, s65
s_nop 0
buffer_load_dwordx4 v20, s[24:27], s67 offen offset:0  lds
buffer_load_dwordx4 v21, s[24:27], s67 offen offset:1024  lds
buffer_load_dwordx4 v22, s[24:27], s67 offen offset:2048  lds
buffer_load_dwordx4 v23, s[24:27], s67 offen offset:3072  lds
s_add_u32 s60, s71, s65
s_add_u32 m0, s60, 0
s_mov_b32 s61, s68
buffer_load_dwordx4 v26, s[28:31], s61 offen lds
buffer_load_dwordx4 v27, s[28:31], s61 offen offset:1024 lds
s_add_u32 m0, s60, 8192
s_add_u32 s61, s61, s53
buffer_load_dwordx4 v26, s[28:31], s61 offen lds
buffer_load_dwordx4 v27, s[28:31], s61 offen offset:1024 lds
s_add_u32 m0, s60, 16384
s_add_u32 s61, s61, s53
buffer_load_dwordx4 v26, s[28:31], s61 offen lds
buffer_load_dwordx4 v27, s[28:31], s61 offen offset:1024 lds
s_add_u32 s49, s76, 1
s_and_b32 s49, s49, 3
s_add_u32 s49, s49, 12
s_mul_i32 s49, s49, 393216
buffer_load_dwordx4 v[40:43], v36, s[28:31], s49 offen
s_add_u32 s65, s65, 40960
s_cmp_eq_u32 s65, 122880
s_cselect_b32 s65, 0, s65
s_add_u32 s64, s64, 1
s_waitcnt vmcnt(11)
s_barrier
s_cmp_lg_u32 s88, 0
s_cbranch_scc1 else_4
global_load_dwordx4 v[240:243], v16, s[14:15]
s_add_u32 s48, s75, 3
s_and_b32 s48, s48, 15
s_mul_i32 s48, s48, s57
buffer_load_dwordx4 v[136:139], v28, s[36:39], s48 offen
buffer_load_dwordx4 v[140:143], v29, s[36:39], s48 offen offset:1024
s_add_u32 s48, s75, 4
s_and_b32 s48, s48, 15
s_mul_i32 s48, s48, s57
buffer_load_dwordx4 v[144:147], v28, s[36:39], s48 offen
buffer_load_dwordx4 v[148:151], v29, s[36:39], s48 offen offset:1024
s_mov_b32 s36, s12
s_and_b32 s37, s13, 0xffff
s_mov_b32 s38, 6291456
s_mov_b32 s39, 0x00020000
s_add_u32 m0, s71, 122880
s_add_u32 s48, s83, 0
buffer_load_dwordx4 v60, s[36:39], s48 offen lds
buffer_load_dwordx4 v61, s[36:39], s48 offen offset:1024 lds
s_add_u32 m0, s71, 131072
s_add_u32 s48, s83, 2048
buffer_load_dwordx4 v60, s[36:39], s48 offen lds
buffer_load_dwordx4 v61, s[36:39], s48 offen offset:1024 lds
s_add_u32 m0, s71, 139264
s_add_u32 s48, s83, 4096
buffer_load_dwordx4 v60, s[36:39], s48 offen lds
buffer_load_dwordx4 v61, s[36:39], s48 offen offset:1024 lds
s_add_u32 s48, s87, 0
buffer_load_dwordx4 v[108:111], v63, s[36:39], s48 offen
s_add_u32 s48, s87, 2048
buffer_load_dwordx4 v[108:111], v63, s[36:39], s48 offen
s_add_u32 s48, s87, 4096
buffer_load_dwordx4 v[108:111], v63, s[36:39], s48 offen
s_mov_b32 s36, s8
s_and_b32 s37, s9, 0xffff
s_mov_b32 s38, 2097152
s_mov_b32 s39, 0x00020000
buffer_store_dwordx4 v[56:59], v18, s[32:35], s86 offen offset:0 sc1
buffer_store_dwordx4 v[56:59], v18, s[32:35], s86 offen offset:1024 sc1
buffer_store_dwordx2 v[56:57], v39, s[32:35], s89 offen sc1
buffer_store_dwordx4 v[56:59], v55, s[32:35], 0 offen sc1
else_4:
s_add_u32 s69, s47, 1
s_and_b32 s69, s69, 3
s_add_u32 s69, s69, 8
s_mul_i32 s67, s69, 128
s_mul_i32 s68, s69, s54
s_add_u32 m0, s70, s65
s_nop 0
buffer_load_dwordx4 v20, s[24:27], s67 offen offset:0  lds
buffer_load_dwordx4 v21, s[24:27], s67 offen offset:1024  lds
buffer_load_dwordx4 v22, s[24:27], s67 offen offset:2048  lds
buffer_load_dwordx4 v23, s[24:27], s67 offen offset:3072  lds
s_add_u32 s60, s71, s65
s_add_u32 m0, s60, 0
s_mov_b32 s61, s68
buffer_load_dwordx4 v26, s[28:31], s61 offen lds
buffer_load_dwordx4 v27, s[28:31], s61 offen offset:1024 lds
s_add_u32 m0, s60, 8192
s_add_u32 s61, s61, s53
buffer_load_dwordx4 v26, s[28:31], s61 offen lds
buffer_load_dwordx4 v27, s[28:31], s61 offen offset:1024 lds
s_add_u32 m0, s60, 16384
s_add_u32 s61, s61, s53
buffer_load_dwordx4 v26, s[28:31], s61 offen lds
buffer_load_dwordx4 v27, s[28:31], s61 offen offset:1024 lds
s_add_u32 s49, s76, 2
s_and_b32 s49, s49, 3
s_add_u32 s49, s49, 0
s_mul_i32 s49, s49, 393216
buffer_load_dwordx4 v[40:43], v36, s[28:31], s49 offen
s_add_u32 s65, s65, 40960
s_cmp_eq_u32 s65, 122880
s_cselect_b32 s65, 0, s65
s_add_u32 s64, s64, 1
s_waitcnt vmcnt(11)
s_barrier
s_cmp_lg_u32 s88, 1
s_cbranch_scc1 else_6
global_load_dwordx4 v[240:243], v16, s[14:15]
s_add_u32 s48, s75, 3
s_and_b32 s48, s48, 15
s_mul_i32 s48, s48, s57
buffer_load_dwordx4 v[136:139], v28, s[36:39], s48 offen
buffer_load_dwordx4 v[140:143], v29, s[36:39], s48 offen offset:1024
s_add_u32 s48, s75, 4
s_and_b32 s48, s48, 15
s_mul_i32 s48, s48, s57
buffer_load_dwordx4 v[144:147], v28, s[36:39], s48 offen
buffer_load_dwordx4 v[148:151], v29, s[36:39], s48 offen offset:1024
s_mov_b32 s36, s12
s_and_b32 s37, s13, 0xffff
s_mov_b32 s38, 6291456
s_mov_b32 s39, 0x00020000
s_add_u32 m0, s71, 122880
s_add_u32 s48, s83, 0
buffer_load_dwordx4 v60, s[36:39], s48 offen lds
buffer_load_dwordx4 v61, s[36:39], s48 offen offset:1024 lds
s_add_u32 m0, s71, 131072
s_add_u32 s48, s83, 2048
buffer_load_dwordx4 v60, s[36:39], s48 offen lds
buffer_load_dwordx4 v61, s[36:39], s48 offen offset:1024 lds
s_add_u32 m0, s71, 139264
s_add_u32 s48, s83, 4096
buffer_load_dwordx4 v60, s[36:39], s48 offen lds
buffer_load_dwordx4 v61, s[36:39], s48 offen offset:1024 lds
s_add_u32 s48, s87, 0
buffer_load_dwordx4 v[108:111], v63, s[36:39], s48 offen
s_add_u32 s48, s87, 2048
buffer_load_dwordx4 v[108:111], v63, s[36:39], s48 offen
s_add_u32 s48, s87, 4096
buffer_load_dwordx4 v[108:111], v63, s[36:39], s48 offen
s_mov_b32 s36, s8
s_and_b32 s37, s9, 0xffff
s_mov_b32 s38, 2097152
s_mov_b32 s39, 0x00020000
buffer_store_dwordx4 v[56:59], v18, s[32:35], s86 offen offset:0 sc1
buffer_store_dwordx4 v[56:59], v18, s[32:35], s86 offen offset:1024 sc1
buffer_store_dwordx2 v[56:57], v39, s[32:35], s89 offen sc1
buffer_store_dwordx4 v[56:59], v55, s[32:35], 0 offen sc1
else_6:
s_add_u32 s69, s47, 1
s_and_b32 s69, s69, 3
s_add_u32 s69, s69, 12
s_mul_i32 s67, s69, 128
s_mul_i32 s68, s69, s54
s_add_u32 m0, s70, s65
s_nop 0
buffer_load_dwordx4 v20, s[24:27], s67 offen offset:0  lds
buffer_load_dwordx4 v21, s[24:27], s67 offen offset:1024  lds
buffer_load_dwordx4 v22, s[24:27], s67 offen offset:2048  lds
buffer_load_dwordx4 v23, s[24:27], s67 offen offset:3072  lds
s_add_u32 s60, s71, s65
s_add_u32 m0, s60, 0
s_mov_b32 s61, s68
buffer_load_dwordx4 v26, s[28:31], s61 offen lds
buffer_load_dwordx4 v27, s[28:31], s61 offen offset:1024 lds
s_add_u32 m0, s60, 8192
s_add_u32 s61, s61, s53
buffer_load_dwordx4 v26, s[28:31], s61 offen lds
buffer_load_dwordx4 v27, s[28:31], s61 offen offset:1024 lds
s_add_u32 m0, s60, 16384
s_add_u32 s61, s61, s53
buffer_load_dwordx4 v26, s[28:31], s61 offen lds
buffer_load_dwordx4 v27, s[28:31], s61 offen offset:1024 lds
s_add_u32 s49, s76, 2
s_and_b32 s49, s49, 3
s_add_u32 s49, s49, 4
s_mul_i32 s49, s49, 393216
buffer_load_dwordx4 v[40:43], v36, s[28:31], s49 offen
s_add_u32 s65, s65, 40960
s_cmp_eq_u32 s65, 122880
s_cselect_b32 s65, 0, s65
s_add_u32 s64, s64, 1
s_waitcnt vmcnt(11)
s_barrier
s_cmp_lg_u32 s88, 2
s_cbranch_scc1 else_8
global_load_dwordx4 v[240:243], v16, s[14:15]
s_add_u32 s48, s75, 3
s_and_b32 s48, s48, 15
s_mul_i32 s48, s48, s57
buffer_load_dwordx4 v[136:139], v28, s[36:39], s48 offen
buffer_load_dwordx4 v[140:143], v29, s[36:39], s48 offen offset:1024
s_add_u32 s48, s75, 4
s_and_b32 s48, s48, 15
s_mul_i32 s48, s48, s57
buffer_load_dwordx4 v[144:147], v28, s[36:39], s48 offen
buffer_load_dwordx4 v[148:151], v29, s[36:39], s48 offen offset:1024
s_mov_b32 s36, s12
s_and_b32 s37, s13, 0xffff
s_mov_b32 s38, 6291456
s_mov_b32 s39, 0x00020000
s_add_u32 m0, s71, 122880
s_add_u32 s48, s83, 0
buffer_load_dwordx4 v60, s[36:39], s48 offen lds
buffer_load_dwordx4 v61, s[36:39], s48 offen offset:1024 lds
s_add_u32 m0, s71, 131072
s_add_u32 s48, s83, 2048
buffer_load_dwordx4 v60, s[36:39], s48 offen lds
buffer_load_dwordx4 v61, s[36:39], s48 offen offset:1024 lds
s_add_u32 m0, s71, 139264
s_add_u32 s48, s83, 4096
buffer_load_dwordx4 v60, s[36:39], s48 offen lds
buffer_load_dwordx4 v61, s[36:39], s48 offen offset:1024 lds
s_add_u32 s48, s87, 0
buffer_load_dwordx4 v[108:111], v63, s[36:39], s48 offen
s_add_u32 s48, s87, 2048
buffer_load_dwordx4 v[108:111], v63, s[36:39], s48 offen
s_add_u32 s48, s87, 4096
buffer_load_dwordx4 v[108:111], v63, s[36:39], s48 offen
s_mov_b32 s36, s8
s_and_b32 s37, s9, 0xffff
s_mov_b32 s38, 2097152
s_mov_b32 s39, 0x00020000
buffer_store_dwordx4 v[56:59], v18, s[32:35], s86 offen offset:0 sc1
buffer_store_dwordx4 v[56:59], v18, s[32:35], s86 offen offset:1024 sc1
buffer_store_dwordx2 v[56:57], v39, s[32:35], s89 offen sc1
buffer_store_dwordx4 v[56:59], v55, s[32:35], 0 offen sc1
else_8:
s_add_u32 s69, s47, 2
s_and_b32 s69, s69, 3
s_add_u32 s69, s69, 0
s_mul_i32 s67, s69, 128
s_mul_i32 s68, s69, s54
s_add_u32 m0, s70, s65
s_nop 0
buffer_load_dwordx4 v20, s[24:27], s67 offen offset:0  lds
buffer_load_dwordx4 v21, s[24:27], s67 offen offset:1024  lds
buffer_load_dwordx4 v22, s[24:27], s67 offen offset:2048  lds
buffer_load_dwordx4 v23, s[24:27], s67 offen offset:3072  lds
s_add_u32 s60, s71, s65
s_add_u32 m0, s60, 0
s_mov_b32 s61, s68
buffer_load_dwordx4 v26, s[28:31], s61 offen lds
buffer_load_dwordx4 v27, s[28:31], s61 offen offset:1024 lds
s_add_u32 m0, s60, 8192
s_add_u32 s61, s61, s53
buffer_load_dwordx4 v26, s[28:31], s61 offen lds
buffer_load_dwordx4 v27, s[28:31], s61 offen offset:1024 lds
s_add_u32 m0, s60, 16384
s_add_u32 s61, s61, s53
buffer_load_dwordx4 v26, s[28:31], s61 offen lds
buffer_load_dwordx4 v27, s[28:31], s61 offen offset:1024 lds
s_add_u32 s49, s76, 2
s_and_b32 s49, s49, 3
s_add_u32 s49, s49, 8
s_mul_i32 s49, s49, 393216
buffer_load_dwordx4 v[40:43], v36, s[28:31], s49 offen
s_add_u32 s65, s65, 40960
s_cmp_eq_u32 s65, 122880
s_cselect_b32 s65, 0, s65
s_add_u32 s64, s64, 1
s_waitcnt vmcnt(11)
s_barrier
s_cmp_lg_u32 s88, 3
s_cbranch_scc1 else_10
global_load_dwordx4 v[240:243], v16, s[14:15]
s_add_u32 s48, s75, 3
s_and_b32 s48, s48, 15
s_mul_i32 s48, s48, s57
buffer_load_dwordx4 v[136:139], v28, s[36:39], s48 offen
buffer_load_dwordx4 v[140:143], v29, s[36:39], s48 offen offset:1024
s_add_u32 s48, s75, 4
s_and_b32 s48, s48, 15
s_mul_i32 s48, s48, s57
buffer_load_dwordx4 v[144:147], v28, s[36:39], s48 offen
buffer_load_dwordx4 v[148:151], v29, s[36:39], s48 offen offset:1024
s_mov_b32 s36, s12
s_and_b32 s37, s13, 0xffff
s_mov_b32 s38, 6291456
s_mov_b32 s39, 0x00020000
s_add_u32 m0, s71, 122880
s_add_u32 s48, s83, 0
buffer_load_dwordx4 v60, s[36:39], s48 offen lds
buffer_load_dwordx4 v61, s[36:39], s48 offen offset:1024 lds
s_add_u32 m0, s71, 131072
s_add_u32 s48, s83, 2048
buffer_load_dwordx4 v60, s[36:39], s48 offen lds
buffer_load_dwordx4 v61, s[36:39], s48 offen offset:1024 lds
s_add_u32 m0, s71, 139264
s_add_u32 s48, s83, 4096
buffer_load_dwordx4 v60, s[36:39], s48 offen lds
buffer_load_dwordx4 v61, s[36:39], s48 offen offset:1024 lds
s_add_u32 s48, s87, 0
buffer_load_dwordx4 v[108:111], v63, s[36:39], s48 offen
s_add_u32 s48, s87, 2048
buffer_load_dwordx4 v[108:111], v63, s[36:39], s48 offen
s_add_u32 s48, s87, 4096
buffer_load_dwordx4 v[108:111], v63, s[36:39], s48 offen
s_mov_b32 s36, s8
s_and_b32 s37, s9, 0xffff
s_mov_b32 s38, 2097152
s_mov_b32 s39, 0x00020000
buffer_store_dwordx4 v[56:59], v18, s[32:35], s86 offen offset:0 sc1
buffer_store_dwordx4 v[56:59], v18, s[32:35], s86 offen offset:1024 sc1
buffer_store_dwordx2 v[56:57], v39, s[32:35], s89 offen sc1
buffer_store_dwordx4 v[56:59], v55, s[32:35], 0 offen sc1
else_10:
s_add_u32 s69, s47, 2
s_and_b32 s69, s69, 3
s_add_u32 s69, s69, 4
s_mul_i32 s67, s69, 128
s_mul_i32 s68, s69, s54
s_add_u32 m0, s70, s65
s_nop 0
buffer_load_dwordx4 v20, s[24:27], s67 offen offset:0  lds
buffer_load_dwordx4 v21, s[24:27], s67 offen offset:1024  lds
buffer_load_dwordx4 v22, s[24:27], s67 offen offset:2048  lds
buffer_load_dwordx4 v23, s[24:27], s67 offen offset:3072  lds
s_add_u32 s60, s71, s65
s_add_u32 m0, s60, 0
s_mov_b32 s61, s68
buffer_load_dwordx4 v26, s[28:31], s61 offen lds
buffer_load_dwordx4 v27, s[28:31], s61 offen offset:1024 lds
s_add_u32 m0, s60, 8192
s_add_u32 s61, s61, s53
buffer_load_dwordx4 v26, s[28:31], s61 offen lds
buffer_load_dwordx4 v27, s[28:31], s61 offen offset:1024 lds
s_add_u32 m0, s60, 16384
s_add_u32 s61, s61, s53
buffer_load_dwordx4 v26, s[28:31], s61 offen lds
buffer_load_dwordx4 v27, s[28:31], s61 offen offset:1024 lds
s_add_u32 s49, s76, 2
s_and_b32 s49, s49, 3
s_add_u32 s49, s49, 12
s_mul_i32 s49, s49, 393216
buffer_load_dwordx4 v[40:43], v36, s[28:31], s49 offen
s_add_u32 s65, s65, 40960
s_cmp_eq_u32 s65, 122880
s_cselect_b32 s65, 0, s65
s_add_u32 s64, s64, 1
s_waitcnt vmcnt(11)
s_barrier
s_cmp_lg_u32 s88, 4
s_cbranch_scc1 else_12
global_load_dwordx4 v[240:243], v16, s[14:15]
s_add_u32 s48, s75, 3
s_and_b32 s48, s48, 15
s_mul_i32 s48, s48, s57
buffer_load_dwordx4 v[136:139], v28, s[36:39], s48 offen
buffer_load_dwordx4 v[140:143], v29, s[36:39], s48 offen offset:1024
s_add_u32 s48, s75, 4
s_and_b32 s48, s48, 15
s_mul_i32 s48, s48, s57
buffer_load_dwordx4 v[144:147], v28, s[36:39], s48 offen
buffer_load_dwordx4 v[148:151], v29, s[36:39], s48 offen offset:1024
s_mov_b32 s36, s12
s_and_b32 s37, s13, 0xffff
s_mov_b32 s38, 6291456
s_mov_b32 s39, 0x00020000
s_add_u32 m0, s71, 122880
s_add_u32 s48, s83, 0
buffer_load_dwordx4 v60, s[36:39], s48 offen lds
buffer_load_dwordx4 v61, s[36:39], s48 offen offset:1024 lds
s_add_u32 m0, s71, 131072
s_add_u32 s48, s83, 2048
buffer_load_dwordx4 v60, s[36:39], s48 offen lds
buffer_load_dwordx4 v61, s[36:39], s48 offen offset:1024 lds
s_add_u32 m0, s71, 139264
s_add_u32 s48, s83, 4096
buffer_load_dwordx4 v60, s[36:39], s48 offen lds
buffer_load_dwordx4 v61, s[36:39], s48 offen offset:1024 lds
s_add_u32 s48, s87, 0
buffer_load_dwordx4 v[108:111], v63, s[36:39], s48 offen
s_add_u32 s48, s87, 2048
buffer_load_dwordx4 v[108:111], v63, s[36:39], s48 offen
s_add_u32 s48, s87, 4096
buffer_load_dwordx4 v[108:111], v63, s[36:39], s48 offen
s_mov_b32 s36, s8
s_and_b32 s37, s9, 0xffff
s_mov_b32 s38, 2097152
s_mov_b32 s39, 0x00020000
buffer_store_dwordx4 v[56:59], v18, s[32:35], s86 offen offset:0 sc1
buffer_store_dwordx4 v[56:59], v18, s[32:35], s86 offen offset:1024 sc1
buffer_store_dwordx2 v[56:57], v39, s[32:35], s89 offen sc1
buffer_store_dwordx4 v[56:59], v55, s[32:35], 0 offen sc1
else_12:
s_add_u32 s69, s47, 2
s_and_b32 s69, s69, 3
s_add_u32 s69, s69, 8
s_mul_i32 s67, s69, 128
s_mul_i32 s68, s69, s54
s_add_u32 m0, s70, s65
s_nop 0
buffer_load_dwordx4 v20, s[24:27], s67 offen offset:0  lds
buffer_load_dwordx4 v21, s[24:27], s67 offen offset:1024  lds
buffer_load_dwordx4 v22, s[24:27], s67 offen offset:2048  lds
buffer_load_dwordx4 v23, s[24:27], s67 offen offset:3072  lds
s_add_u32 s60, s71, s65
s_add_u32 m0, s60, 0
s_mov_b32 s61, s68
buffer_load_dwordx4 v26, s[28:31], s61 offen lds
buffer_load_dwordx4 v27, s[28:31], s61 offen offset:1024 lds
s_add_u32 m0, s60, 8192
s_add_u32 s61, s61, s53
buffer_load_dwordx4 v26, s[28:31], s61 offen lds
buffer_load_dwordx4 v27, s[28:31], s61 offen offset:1024 lds
s_add_u32 m0, s60, 16384
s_add_u32 s61, s61, s53
buffer_load_dwordx4 v26, s[28:31], s61 offen lds
buffer_load_dwordx4 v27, s[28:31], s61 offen offset:1024 lds
s_add_u32 s49, s76, 3
s_and_b32 s49, s49, 3
s_add_u32 s49, s49, 0
s_mul_i32 s49, s49, 393216
buffer_load_dwordx4 v[40:43], v36, s[28:31], s49 offen
s_add_u32 s65, s65, 40960
s_cmp_eq_u32 s65, 122880
s_cselect_b32 s65, 0, s65
s_add_u32 s64, s64, 1
s_waitcnt vmcnt(11)
s_barrier
s_cmp_lg_u32 s88, 5
s_cbranch_scc1 else_14
global_load_dwordx4 v[240:243], v16, s[14:15]
s_add_u32 s48, s75, 3
s_and_b32 s48, s48, 15
s_mul_i32 s48, s48, s57
buffer_load_dwordx4 v[136:139], v28, s[36:39], s48 offen
buffer_load_dwordx4 v[140:143], v29, s[36:39], s48 offen offset:1024
s_add_u32 s48, s75, 4
s_and_b32 s48, s48, 15
s_mul_i32 s48, s48, s57
buffer_load_dwordx4 v[144:147], v28, s[36:39], s48 offen
buffer_load_dwordx4 v[148:151], v29, s[36:39], s48 offen offset:1024
s_mov_b32 s36, s12
s_and_b32 s37, s13, 0xffff
s_mov_b32 s38, 6291456
s_mov_b32 s39, 0x00020000
s_add_u32 m0, s71, 122880
s_add_u32 s48, s83, 0
buffer_load_dwordx4 v60, s[36:39], s48 offen lds
buffer_load_dwordx4 v61, s[36:39], s48 offen offset:1024 lds
s_add_u32 m0, s71, 131072
s_add_u32 s48, s83, 2048
buffer_load_dwordx4 v60, s[36:39], s48 offen lds
buffer_load_dwordx4 v61, s[36:39], s48 offen offset:1024 lds
s_add_u32 m0, s71, 139264
s_add_u32 s48, s83, 4096
buffer_load_dwordx4 v60, s[36:39], s48 offen lds
buffer_load_dwordx4 v61, s[36:39], s48 offen offset:1024 lds
s_add_u32 s48, s87, 0
buffer_load_dwordx4 v[108:111], v63, s[36:39], s48 offen
s_add_u32 s48, s87, 2048
buffer_load_dwordx4 v[108:111], v63, s[36:39], s48 offen
s_add_u32 s48, s87, 4096
buffer_load_dwordx4 v[108:111], v63, s[36:39], s48 offen
s_mov_b32 s36, s8
s_and_b32 s37, s9, 0xffff
s_mov_b32 s38, 2097152
s_mov_b32 s39, 0x00020000
buffer_store_dwordx4 v[56:59], v18, s[32:35], s86 offen offset:0 sc1
buffer_store_dwordx4 v[56:59], v18, s[32:35], s86 offen offset:1024 sc1
buffer_store_dwordx2 v[56:57], v39, s[32:35], s89 offen sc1
buffer_store_dwordx4 v[56:59], v55, s[32:35], 0 offen sc1
else_14:
s_add_u32 s69, s47, 2
s_and_b32 s69, s69, 3
s_add_u32 s69, s69, 12
s_mul_i32 s67, s69, 128
s_mul_i32 s68, s69, s54
s_add_u32 m0, s70, s65
s_nop 0
buffer_load_dwordx4 v20, s[24:27], s67 offen offset:0  lds
buffer_load_dwordx4 v21, s[24:27], s67 offen offset:1024  lds
buffer_load_dwordx4 v22, s[24:27], s67 offen offset:2048  lds
buffer_load_dwordx4 v23, s[24:27], s67 offen offset:3072  lds
s_add_u32 s60, s71, s65
s_add_u32 m0, s60, 0
s_mov_b32 s61, s68
buffer_load_dwordx4 v26, s[28:31], s61 offen lds
buffer_load_dwordx4 v27, s[28:31], s61 offen offset:1024 lds
s_add_u32 m0, s60, 8192
s_add_u32 s61, s61, s53
buffer_load_dwordx4 v26, s[28:31], s61 offen lds
buffer_load_dwordx4 v27, s[28:31], s61 offen offset:1024 lds
s_add_u32 m0, s60, 16384
s_add_u32 s61, s61, s53
buffer_load_dwordx4 v26, s[28:31], s61 offen lds
buffer_load_dwordx4 v27, s[28:31], s61 offen offset:1024 lds
s_add_u32 s49, s76, 3
s_and_b32 s49, s49, 3
s_add_u32 s49, s49, 4
s_mul_i32 s49, s49, 393216
buffer_load_dwordx4 v[40:43], v36, s[28:31], s49 offen
s_add_u32 s65, s65, 40960
s_cmp_eq_u32 s65, 122880
s_cselect_b32 s65, 0, s65
s_add_u32 s64, s64, 1
s_waitcnt vmcnt(11)
s_barrier
s_cmp_lg_u32 s88, 6
s_cbranch_scc1 else_16
global_load_dwordx4 v[240:243], v16, s[14:15]
s_add_u32 s48, s75, 3
s_and_b32 s48, s48, 15
s_mul_i32 s48, s48, s57
buffer_load_dwordx4 v[136:139], v28, s[36:39], s48 offen
buffer_load_dwordx4 v[140:143], v29, s[36:39], s48 offen offset:1024
s_add_u32 s48, s75, 4
s_and_b32 s48, s48, 15
s_mul_i32 s48, s48, s57
buffer_load_dwordx4 v[144:147], v28, s[36:39], s48 offen
buffer_load_dwordx4 v[148:151], v29, s[36:39], s48 offen offset:1024
s_mov_b32 s36, s12
s_and_b32 s37, s13, 0xffff
s_mov_b32 s38, 6291456
s_mov_b32 s39, 0x00020000
s_add_u32 m0, s71, 122880
s_add_u32 s48, s83, 0
buffer_load_dwordx4 v60, s[36:39], s48 offen lds
buffer_load_dwordx4 v61, s[36:39], s48 offen offset:1024 lds
s_add_u32 m0, s71, 131072
s_add_u32 s48, s83, 2048
buffer_load_dwordx4 v60, s[36:39], s48 offen lds
buffer_load_dwordx4 v61, s[36:39], s48 offen offset:1024 lds
s_add_u32 m0, s71, 139264
s_add_u32 s48, s83, 4096
buffer_load_dwordx4 v60, s[36:39], s48 offen lds
buffer_load_dwordx4 v61, s[36:39], s48 offen offset:1024 lds
s_add_u32 s48, s87, 0
buffer_load_dwordx4 v[108:111], v63, s[36:39], s48 offen
s_add_u32 s48, s87, 2048
buffer_load_dwordx4 v[108:111], v63, s[36:39], s48 offen
s_add_u32 s48, s87, 4096
buffer_load_dwordx4 v[108:111], v63, s[36:39], s48 offen
s_mov_b32 s36, s8
s_and_b32 s37, s9, 0xffff
s_mov_b32 s38, 2097152
s_mov_b32 s39, 0x00020000
buffer_store_dwordx4 v[56:59], v18, s[32:35], s86 offen offset:0 sc1
buffer_store_dwordx4 v[56:59], v18, s[32:35], s86 offen offset:1024 sc1
buffer_store_dwordx2 v[56:57], v39, s[32:35], s89 offen sc1
buffer_store_dwordx4 v[56:59], v55, s[32:35], 0 offen sc1
else_16:
s_add_u32 s69, s47, 3
s_and_b32 s69, s69, 3
s_add_u32 s69, s69, 0
s_mul_i32 s67, s69, 128
s_mul_i32 s68, s69, s54
s_add_u32 m0, s70, s65
s_nop 0
buffer_load_dwordx4 v20, s[24:27], s67 offen offset:0  lds
buffer_load_dwordx4 v21, s[24:27], s67 offen offset:1024  lds
buffer_load_dwordx4 v22, s[24:27], s67 offen offset:2048  lds
buffer_load_dwordx4 v23, s[24:27], s67 offen offset:3072  lds
s_add_u32 s60, s71, s65
s_add_u32 m0, s60, 0
s_mov_b32 s61, s68
buffer_load_dwordx4 v26, s[28:31], s61 offen lds
buffer_load_dwordx4 v27, s[28:31], s61 offen offset:1024 lds
s_add_u32 m0, s60, 8192
s_add_u32 s61, s61, s53
buffer_load_dwordx4 v26, s[28:31], s61 offen lds
buffer_load_dwordx4 v27, s[28:31], s61 offen offset:1024 lds
s_add_u32 m0, s60, 16384
s_add_u32 s61, s61, s53
buffer_load_dwordx4 v26, s[28:31], s61 offen lds
buffer_load_dwordx4 v27, s[28:31], s61 offen offset:1024 lds
s_add_u32 s49, s76, 3
s_and_b32 s49, s49, 3
s_add_u32 s49, s49, 8
s_mul_i32 s49, s49, 393216
buffer_load_dwordx4 v[40:43], v36, s[28:31], s49 offen
s_add_u32 s65, s65, 40960
s_cmp_eq_u32 s65, 122880
s_cselect_b32 s65, 0, s65
s_add_u32 s64, s64, 1
s_waitcnt vmcnt(11)
s_barrier
s_cmp_lg_u32 s88, 7
s_cbranch_scc1 else_18
global_load_dwordx4 v[240:243], v16, s[14:15]
s_add_u32 s48, s75, 3
s_and_b32 s48, s48, 15
s_mul_i32 s48, s48, s57
buffer_load_dwordx4 v[136:139], v28, s[36:39], s48 offen
buffer_load_dwordx4 v[140:143], v29, s[36:39], s48 offen offset:1024
s_add_u32 s48, s75, 4
s_and_b32 s48, s48, 15
s_mul_i32 s48, s48, s57
buffer_load_dwordx4 v[144:147], v28, s[36:39], s48 offen
buffer_load_dwordx4 v[148:151], v29, s[36:39], s48 offen offset:1024
s_mov_b32 s36, s12
s_and_b32 s37, s13, 0xffff
s_mov_b32 s38, 6291456
s_mov_b32 s39, 0x00020000
s_add_u32 m0, s71, 122880
s_add_u32 s48, s83, 0
buffer_load_dwordx4 v60, s[36:39], s48 offen lds
buffer_load_dwordx4 v61, s[36:39], s48 offen offset:1024 lds
s_add_u32 m0, s71, 131072
s_add_u32 s48, s83, 2048
buffer_load_dwordx4 v60, s[36:39], s48 offen lds
buffer_load_dwordx4 v61, s[36:39], s48 offen offset:1024 lds
s_add_u32 m0, s71, 139264
s_add_u32 s48, s83, 4096
buffer_load_dwordx4 v60, s[36:39], s48 offen lds
buffer_load_dwordx4 v61, s[36:39], s48 offen offset:1024 lds
s_add_u32 s48, s87, 0
buffer_load_dwordx4 v[108:111], v63, s[36:39], s48 offen
s_add_u32 s48, s87, 2048
buffer_load_dwordx4 v[108:111], v63, s[36:39], s48 offen
s_add_u32 s48, s87, 4096
buffer_load_dwordx4 v[108:111], v63, s[36:39], s48 offen
s_mov_b32 s36, s8
s_and_b32 s37, s9, 0xffff
s_mov_b32 s38, 2097152
s_mov_b32 s39, 0x00020000
buffer_store_dwordx4 v[56:59], v18, s[32:35], s86 offen offset:0 sc1
buffer_store_dwordx4 v[56:59], v18, s[32:35], s86 offen offset:1024 sc1
buffer_store_dwordx2 v[56:57], v39, s[32:35], s89 offen sc1
buffer_store_dwordx4 v[56:59], v55, s[32:35], 0 offen sc1
else_18:
s_add_u32 s69, s47, 3
s_and_b32 s69, s69, 3
s_add_u32 s69, s69, 4
s_mul_i32 s67, s69, 128
s_mul_i32 s68, s69, s54
s_add_u32 m0, s70, s65
s_nop 0
buffer_load_dwordx4 v20, s[24:27], s67 offen offset:0  lds
buffer_load_dwordx4 v21, s[24:27], s67 offen offset:1024  lds
buffer_load_dwordx4 v22, s[24:27], s67 offen offset:2048  lds
buffer_load_dwordx4 v23, s[24:27], s67 offen offset:3072  lds
s_add_u32 s60, s71, s65
s_add_u32 m0, s60, 0
s_mov_b32 s61, s68
buffer_load_dwordx4 v26, s[28:31], s61 offen lds
buffer_load_dwordx4 v27, s[28:31], s61 offen offset:1024 lds
s_add_u32 m0, s60, 8192
s_add_u32 s61, s61, s53
buffer_load_dwordx4 v26, s[28:31], s61 offen lds
buffer_load_dwordx4 v27, s[28:31], s61 offen offset:1024 lds
s_add_u32 m0, s60, 16384
s_add_u32 s61, s61, s53
buffer_load_dwordx4 v26, s[28:31], s61 offen lds
buffer_load_dwordx4 v27, s[28:31], s61 offen offset:1024 lds
s_add_u32 s49, s76, 3
s_and_b32 s49, s49, 3
s_add_u32 s49, s49, 12
s_mul_i32 s49, s49, 393216
buffer_load_dwordx4 v[40:43], v36, s[28:31], s49 offen
s_add_u32 s65, s65, 40960
s_cmp_eq_u32 s65, 122880
s_cselect_b32 s65, 0, s65
s_add_u32 s64, s64, 1
s_waitcnt vmcnt(11)
s_barrier
global_load_dwordx2 v[34:35], v32, s[20:21] sc1
s_add_u32 s69, s47, 3
s_and_b32 s69, s69, 3
s_add_u32 s69, s69, 8
s_mul_i32 s67, s69, 128
s_mul_i32 s68, s69, s54
s_add_u32 m0, s70, s65
s_nop 0
buffer_load_dwordx4 v20, s[24:27], s67 offen offset:0  lds
buffer_load_dwordx4 v21, s[24:27], s67 offen offset:1024  lds
buffer_load_dwordx4 v22, s[24:27], s67 offen offset:2048  lds
buffer_load_dwordx4 v23, s[24:27], s67 offen offset:3072  lds
s_add_u32 s60, s71, s65
s_add_u32 m0, s60, 0
s_mov_b32 s61, s68
buffer_load_dwordx4 v26, s[28:31], s61 offen lds
buffer_load_dwordx4 v27, s[28:31], s61 offen offset:1024 lds
s_add_u32 m0, s60, 8192
s_add_u32 s61, s61, s53
buffer_load_dwordx4 v26, s[28:31], s61 offen lds
buffer_load_dwordx4 v27, s[28:31], s61 offen offset:1024 lds
s_add_u32 m0, s60, 16384
s_add_u32 s61, s61, s53
buffer_load_dwordx4 v26, s[28:31], s61 offen lds
buffer_load_dwordx4 v27, s[28:31], s61 offen offset:1024 lds
s_add_u32 s65, s65, 40960
s_cmp_eq_u32 s65, 122880
s_cselect_b32 s65, 0, s65
s_add_u32 s64, s64, 1
s_waitcnt vmcnt(10)
s_barrier
s_mov_b32 s63, 0
ipoll_20:
v_sad_u8 v4, v34, 0, 0
v_sad_u8 v4, v35, 0, v4
v_cmp_gt_u32 vcc, 32, v4
s_cbranch_vccz ipolled_21
global_load_dwordx2 v[34:35], v32, s[20:21] sc1
s_add_u32 s63, s63, 1
s_cmp_lt_u32 s63, 0x80000
s_waitcnt vmcnt(0)
s_cbranch_scc1 ipoll_20
ipolled_21:
s_add_u32 s69, s47, 3
s_and_b32 s69, s69, 3
s_add_u32 s69, s69, 12
s_mul_i32 s67, s69, 128
s_mul_i32 s68, s69, s54
s_add_u32 m0, s70, 0
s_nop 0
buffer_load_dwordx4 v20, s[24:27], s67 offen offset:0  lds
buffer_load_dwordx4 v21, s[24:27], s67 offen offset:1024  lds
buffer_load_dwordx4 v22, s[24:27], s67 offen offset:2048  lds
buffer_load_dwordx4 v23, s[24:27], s67 offen offset:3072  lds
s_add_u32 s60, s71, 0
s_add_u32 m0, s60, 0
s_mov_b32 s61, s68
buffer_load_dwordx4 v26, s[28:31], s61 offen lds
buffer_load_dwordx4 v27, s[28:31], s61 offen offset:1024 lds
s_add_u32 m0, s60, 8192
s_add_u32 s61, s61, s53
buffer_load_dwordx4 v26, s[28:31], s61 offen lds
buffer_load_dwordx4 v27, s[28:31], s61 offen offset:1024 lds
s_add_u32 m0, s60, 16384
s_add_u32 s61, s61, s53
buffer_load_dwordx4 v26, s[28:31], s61 offen lds
buffer_load_dwordx4 v27, s[28:31], s61 offen offset:1024 lds
s_waitcnt vmcnt(10)
s_barrier
s_setprio 0
buffer_load_dwordx4 v[40:43], v15, s[36:39], 0 offen offset:0
buffer_load_dwordx4 v[40:43], v15, s[36:39], 0 offen offset:1024
buffer_load_dwordx4 v[176:179], v37, s[32:35], 0 offen offset:0 sc1
buffer_load_dwordx4 v[180:183], v37, s[32:35], 0 offen offset:1024 sc1
buffer_load_dwordx4 v[184:187], v37, s[32:35], 0 offen offset:2048 sc1
buffer_load_dwordx4 v[188:191], v37, s[32:35], 0 offen offset:3072 sc1
global_load_dword v48, v54, s[98:99]
buffer_load_dwordx4 v[160:163], v38, s[32:35], 0 offen offset:0 sc1
buffer_load_dwordx4 v[164:167], v38, s[32:35], 0 offen offset:1024 sc1
buffer_load_dwordx4 v[168:171], v38, s[32:35], 0 offen offset:2048 sc1
buffer_load_dwordx4 v[172:175], v38, s[32:35], 0 offen offset:3072 sc1
s_add_u32 s48, s75, 15
s_and_b32 s48, s48, 15
s_mul_i32 s48, s48, s57
s_add_u32 m0, s71, 106496
s_nop 0
buffer_load_dwordx4 v28, s[36:39], s48 offen lds
buffer_load_dwordx4 v29, s[36:39], s48 offen offset:1024 lds
s_waitcnt vmcnt(13)
s_barrier
s_add_u32 s48, s75, 5
s_and_b32 s48, s48, 15
s_mul_i32 s48, s48, s57
s_add_u32 m0, s71, 24576
s_nop 0
buffer_load_dwordx4 v28, s[36:39], s48 offen lds
buffer_load_dwordx4 v29, s[36:39], s48 offen offset:1024 lds
s_waitcnt vmcnt(4)
s_add_u32 s48, s75, 6
s_and_b32 s48, s48, 15
s_mul_i32 s48, s48, s57
s_add_u32 m0, s71, 32768
s_nop 0
buffer_load_dwordx4 v28, s[36:39], s48 offen lds
v_add_f32 v176, v176, v184
v_add_f32 v160, v160, v168
v_add_f32 v177, v177, v185
v_add_f32 v161, v161, v169
v_add_f32 v178, v178, v186
v_add_f32 v162, v162, v170
v_add_f32 v179, v179, v187
v_add_f32 v163, v163, v171
v_add_f32 v180, v180, v188
v_add_f32 v164, v164, v172
buffer_load_dwordx4 v29, s[36:39], s48 offen offset:1024 lds
v_add_f32 v181, v181, v189
v_add_f32 v165, v165, v173
v_add_f32 v182, v182, v190
v_add_f32 v166, v166, v174
v_add_f32 v183, v183, v191
v_add_f32 v167, v167, v175
v_add_f32 v176, v176, v180
v_add_f32 v160, v160, v164
v_add_f32 v177, v177, v181
v_add_f32 v161, v161, v165
s_add_u32 s48, s75, 7
s_and_b32 s48, s48, 15
s_mul_i32 s48, s48, s57
s_add_u32 m0, s71, 40960
s_nop 0
buffer_load_dwordx4 v28, s[36:39], s48 offen lds
v_add_f32 v178, v178, v182
v_add_f32 v162, v162, v166
v_add_f32 v179, v179, v183
v_add_f32 v163, v163, v167
s_nop 1
s_nop 1
v_permlane32_swap_b32 v176, v177
v_permlane32_swap_b32 v160, v161
v_permlane32_swap_b32 v178, v179
buffer_load_dwordx4 v29, s[36:39], s48 offen offset:1024 lds
v_permlane32_swap_b32 v162, v163
v_add_f32 v176, v176, v177
v_add_f32 v160, v160, v161
v_add_f32 v178, v178, v179
v_add_f32 v162, v162, v163
s_nop 1
s_nop 1
v_permlane16_swap_b32 v176, v178
v_permlane16_swap_b32 v160, v162
s_nop 0
s_add_u32 s48, s75, 8
s_and_b32 s48, s48, 15
s_mul_i32 s48, s48, s57
s_add_u32 m0, s71, 49152
s_nop 0
buffer_load_dwordx4 v28, s[36:39], s48 offen lds
s_nop 0
v_add_f32 v176, v176, v178
v_add_f32 v160, v160, v162
v_cmp_u_f32 vcc, v176, v176
s_cbranch_vccnz again_22
summed_23:
v_cmp_u_f32 vcc, v160, v160
s_cbranch_vccnz again_25
summed_26:
v_mul_f32 v44, 0x3a800000, v176
ds_write_b32 v53, v160
v_mov_b32 v45, v44
s_nop 1
v_permlane16_swap_b32 v44, v45
buffer_load_dwordx4 v29, s[36:39], s48 offen offset:1024 lds
s_nop 0
v_fma_f32 v45, -v44, v44, v45
v_max_f32 v45, 0, v45
v_add_f32 v45, 0x3727c5ac, v45
v_rsq_f32 v46, v45
v_sub_f32 v47, 0, v44
ds_write_b32 v50, v47 offset:512
ds_write_b64 v49, v[46:47]
ds_write_b32 v50, v46
s_cmp_lg_u32 s43, 2
s_cbranch_scc1 else_28
s_and_b32 s50, s2, 7
v_readlane_b32 s58, v34, s50
v_readlane_b32 s59, v35, s50
s_lshl_b64 s[48:49], s[94:95], 5
v_mov_b32 v4, 134656
s_nop 1
s_cmp_eq_u64 s[48:49], s[58:59]
s_cselect_b32 s48, 1, 0
v_mov_b32 v5, s48
ds_write_b32 v4, v5
else_28:
s_setprio 0
s_waitcnt lgkmcnt(0)
s_waitcnt vmcnt(63)
s_barrier
s_waitcnt vmcnt(5)
s_add_u32 s48, s75, 9
s_and_b32 s48, s48, 15
s_mul_i32 s48, s48, s57
s_add_u32 m0, s71, 57344
s_nop 0
buffer_load_dwordx4 v28, s[36:39], s48 offen lds
ds_write_b128 v51, v[136:139] offset:24576
buffer_load_dwordx4 v29, s[36:39], s48 offen offset:1024 lds
s_waitcnt vmcnt(5)
s_add_u32 s48, s75, 10
s_and_b32 s48, s48, 15
s_mul_i32 s48, s48, s57
s_add_u32 m0, s71, 65536
s_nop 0
buffer_load_dwordx4 v28, s[36:39], s48 offen lds
buffer_load_dwordx4 v29, s[36:39], s48 offen offset:1024 lds
s_waitcnt vmcnt(5)
s_add_u32 s48, s75, 11
s_and_b32 s48, s48, 15
s_mul_i32 s48, s48, s57
s_add_u32 m0, s71, 73728
s_nop 0
buffer_load_dwordx4 v28, s[36:39], s48 offen lds
ds_write_b128 v51, v[140:143] offset:25600
buffer_load_dwordx4 v29, s[36:39], s48 offen offset:1024 lds
s_waitcnt vmcnt(5)
s_add_u32 s48, s75, 12
s_and_b32 s48, s48, 15
s_mul_i32 s48, s48, s57
s_add_u32 m0, s71, 81920
s_nop 0
buffer_load_dwordx4 v28, s[36:39], s48 offen lds
buffer_load_dwordx4 v29, s[36:39], s48 offen offset:1024 lds
s_waitcnt vmcnt(5)
s_add_u32 s48, s75, 13
s_and_b32 s48, s48, 15
s_mul_i32 s48, s48, s57
s_add_u32 m0, s71, 90112
s_nop 0
buffer_load_dwordx4 v28, s[36:39], s48 offen lds
buffer_load_dwordx4 v29, s[36:39], s48 offen offset:1024 lds
ds_write_b128 v51, v[144:147] offset:32768
s_waitcnt vmcnt(5)
s_add_u32 s48, s75, 14
s_and_b32 s48, s48, 15
s_mul_i32 s48, s48, s57
s_add_u32 m0, s71, 98304
s_nop 0
buffer_load_dwordx4 v28, s[36:39], s48 offen lds
buffer_load_dwordx4 v29, s[36:39], s48 offen offset:1024 lds
s_waitcnt vmcnt(5)
s_add_u32 s48, s75, 0
s_and_b32 s48, s48, 15
s_mul_i32 s48, s48, s57
s_add_u32 m0, s71, 4294950912
s_nop 0
buffer_load_dwordx4 v28, s[36:39], s48 offen lds
buffer_load_dwordx4 v29, s[36:39], s48 offen offset:1024 lds
ds_write_b128 v51, v[148:151] offset:33792
s_waitcnt vmcnt(5)
s_add_u32 s48, s75, 1
s_and_b32 s48, s48, 15
s_mul_i32 s48, s48, s57
s_add_u32 m0, s71, 4294959104
s_nop 0
buffer_load_dwordx4 v28, s[36:39], s48 offen lds
buffer_load_dwordx4 v29, s[36:39], s48 offen offset:1024 lds
s_waitcnt vmcnt(5)
s_add_u32 s48, s75, 2
s_and_b32 s48, s48, 15
s_mul_i32 s48, s48, s57
s_add_u32 m0, s71, 0
s_nop 0
buffer_load_dwordx4 v28, s[36:39], s48 offen lds
buffer_load_dwordx4 v29, s[36:39], s48 offen offset:1024 lds
s_mov_b32 s28, s12
s_and_b32 s29, s13, 0xffff
s_mov_b32 s30, 6291456
s_mov_b32 s31, 0x00020000
v_mov_b32 v26, v60
v_mov_b32 v27, v61
v_mov_b32 v28, v24
v_mov_b32 v29, v25
s_cmp_ge_i32 s55, 0
s_cselect_b32 s53, 128, s53
s_cselect_b32 s54, 24576, s54
s_cmp_ge_i32 s56, 0
s_cselect_b32 s57, 8192, s57
s_and_b32 s48, s2, 7
s_add_u32 s47, s42, s48
s_and_b32 s47, s47, 7
s_mul_i32 s47, s47, 2
s_and_b32 s50, s42, 8
s_or_b32 s50, s50, 3
s_and_b32 s48, s2, 7
s_add_u32 s76, s50, s48
s_and_b32 s76, s76, 7
s_mul_i32 s76, s76, 2
s_add_u32 s69, s47, 0
s_and_b32 s69, s69, 15
s_mul_i32 s67, s69, 128
s_mul_i32 s68, s69, s54
s_waitcnt vmcnt(0) lgkmcnt(0)
s_barrier
ds_write_b128 v13, v[240:243]
ds_read_b128 v[232:235], v52 offset:57344
ds_read_b128 v[236:239], v52 offset:58368
ds_read_b128 v[152:155], v51 offset:40960
ds_read_b128 v[156:159], v51 offset:41984
ds_read_b128 v[160:163], v51 offset:49152
ds_read_b128 v[164:167], v51 offset:50176
ds_read_b128 v[168:171], v51 offset:57344
ds_read_b128 v[172:175], v51 offset:58368
ds_read_b128 v[176:179], v52 offset:0
ds_read_b128 v[180:183], v52 offset:1024
ds_read_b128 v[184:187], v52 offset:8192
ds_read_b128 v[188:191], v52 offset:9216
ds_read_b128 v[192:195], v52 offset:16384
ds_read_b128 v[196:199], v52 offset:17408
ds_read_b128 v[200:203], v52 offset:24576
ds_read_b128 v[204:207], v52 offset:25600
ds_read_b128 v[208:211], v52 offset:32768
ds_read_b128 v[212:215], v52 offset:33792
ds_read_b128 v[216:219], v52 offset:40960
ds_read_b128 v[220:223], v52 offset:41984
ds_read_b128 v[224:227], v52 offset:49152
ds_read_b128 v[228:231], v52 offset:50176
ds_read_b128 v[112:115], v51 offset:0
ds_read_b128 v[116:119], v51 offset:1024
ds_read_b128 v[120:123], v51 offset:8192
ds_read_b128 v[124:127], v51 offset:9216
ds_read_b128 v[128:131], v51 offset:16384
ds_read_b128 v[132:135], v51 offset:17408
s_add_u32 s48, s80, 0
v_add_u32 v20, s48, v18
v_mov_b32 v21, v20
v_add_u32 v22, 30720, v20
v_mov_b32 v23, v22
v_add_u32 v37, 262144, v37
s_lshl_b32 s50, s42, 2
s_add_u32 s50, s50, s43
s_lshl_b32 s50, s50, 12
s_add_u32 s50, s50, 18087936
v_add_u32 v38, s50, v18
v_min_u32 v4, 2, v3
v_lshlrev_b32 v4, 8, v4
v_lshl_add_u32 v4, v2, 2, v4
s_and_b32 s48, s43, 1
s_lshl_b32 s48, s48, 7
s_lshr_b32 s49, s43, 1
s_lshl_b32 s49, s49, 6
s_add_u32 s48, s48, s49
s_add_u32 s48, s48, 133888
v_add_u32 v53, s48, v4
s_getpc_b64 s[98:99]
pc_30:
s_add_u32 s98, s98, c1_last - pc_30
s_addc_u32 s99, s99, 0
s_lshr_b32 s50, s2, 3
s_lshl_b32 s50, s50, 2
s_add_u32 s50, s50, s43
s_lshl_b32 s50, s50, 7
v_and_b32 v4, 1, v0
v_lshl_add_u32 v4, v4, 6, s50
v_min_u32 v54, L_code_end - c1_last, v4
s_mov_b32 s36, s6
s_and_b32 s37, s7, 0xffff
s_mov_b32 s38, 6291456
s_mov_b32 s39, 0x00020000
s_and_b32 s48, s2, 7
s_lshl_b32 s48, s48, 1
s_add_u32 s83, s42, s48
s_and_b32 s83, s83, 15
s_mul_i32 s83, s83, 393216
s_lshr_b32 s48, s2, 4
s_and_b32 s49, s2, 7
s_add_u32 s48, s48, s49
s_mul_i32 s49, s48, 10923
s_lshr_b32 s49, s49, 16
s_mul_i32 s49, s49, 6
s_sub_u32 s88, s48, s49
s_add_u32 s88, s88, 1
s_waitcnt vmcnt(0) lgkmcnt(0)
s_add_u32 s69, s47, 1
s_and_b32 s69, s69, 15
s_mul_i32 s67, s69, 2048
s_mul_i32 s68, s69, s54
s_barrier
s_add_u32 s60, s71, 40960
s_add_u32 m0, s60, 0
s_mov_b32 s61, s68
buffer_load_dwordx4 v26, s[28:31], s61 offen lds
buffer_load_dwordx4 v27, s[28:31], s61 offen offset:1024 lds
s_add_u32 m0, s60, 8192
s_add_u32 s61, s61, s53
buffer_load_dwordx4 v26, s[28:31], s61 offen lds
buffer_load_dwordx4 v27, s[28:31], s61 offen offset:1024 lds
s_add_u32 m0, s60, 16384
s_add_u32 s61, s61, s53
buffer_load_dwordx4 v26, s[28:31], s61 offen lds
buffer_load_dwordx4 v27, s[28:31], s61 offen offset:1024 lds
s_add_u32 s49, s76, 2
s_and_b32 s49, s49, 15
s_mul_i32 s49, s49, 393216
buffer_load_dwordx4 v[40:43], v36, s[28:31], s49 offen
s_add_u32 s49, s76, 3
s_and_b32 s49, s49, 15
s_mul_i32 s49, s49, 393216
buffer_load_dwordx4 v[40:43], v36, s[28:31], s49 offen
buffer_load_dword v5, v30, s[32:35], s79 offen sc1
s_add_u32 s69, s47, 0
s_and_b32 s69, s69, 15
s_mul_i32 s67, s69, 2048
s_mul_i32 s68, s69, s54
s_add_u32 m0, s70, 0
s_nop 0
s_mov_b32 s63, 0
s_waitcnt vmcnt(0)
poll_31:
v_cmp_gt_u32 vcc, 1, v5
s_cbranch_vccz polled_32
buffer_load_dword v5, v30, s[32:35], s79 offen sc1
s_add_u32 s63, s63, 1
s_cmp_lt_u32 s63, 0x80000
s_waitcnt vmcnt(0)
s_cbranch_scc1 poll_31
polled_32:
buffer_load_dwordx4 v20, s[32:35], s67 offen offset:0 sc1 lds
buffer_load_dwordx4 v21, s[32:35], s67 offen offset:1024 sc1 lds
buffer_load_dwordx4 v22, s[32:35], s67 offen offset:2048 sc1 lds
buffer_load_dwordx4 v23, s[32:35], s67 offen offset:3072 sc1 lds
s_add_u32 s69, s47, 1
s_and_b32 s69, s69, 15
s_mul_i32 s67, s69, 2048
s_mul_i32 s68, s69, s54
s_add_u32 m0, s70, 40960
s_nop 0
buffer_load_dwordx4 v20, s[32:35], s67 offen offset:0 sc1 lds
buffer_load_dwordx4 v21, s[32:35], s67 offen offset:1024 sc1 lds
buffer_load_dwordx4 v22, s[32:35], s67 offen offset:2048 sc1 lds
buffer_load_dwordx4 v23, s[32:35], s67 offen offset:3072 sc1 lds
s_waitcnt vmcnt(4) lgkmcnt(0)
s_barrier
s_add_u32 s69, s47, 2
s_and_b32 s69, s69, 15
s_mul_i32 s67, s69, 2048
s_mul_i32 s68, s69, s54
s_add_u32 m0, s70, 81920
s_nop 0
buffer_load_dwordx4 v20, s[32:35], s67 offen offset:0 sc1 lds
buffer_load_dwordx4 v21, s[32:35], s67 offen offset:1024 sc1 lds
buffer_load_dwordx4 v22, s[32:35], s67 offen offset:2048 sc1 lds
buffer_load_dwordx4 v23, s[32:35], s67 offen offset:3072 sc1 lds
s_add_u32 s60, s71, 81920
s_add_u32 m0, s60, 0
s_mov_b32 s61, s68
buffer_load_dwordx4 v26, s[28:31], s61 offen lds
buffer_load_dwordx4 v27, s[28:31], s61 offen offset:1024 lds
s_add_u32 m0, s60, 8192
s_add_u32 s61, s61, s53
buffer_load_dwordx4 v26, s[28:31], s61 offen lds
buffer_load_dwordx4 v27, s[28:31], s61 offen offset:1024 lds
s_add_u32 m0, s60, 16384
s_add_u32 s61, s61, s53
buffer_load_dwordx4 v26, s[28:31], s61 offen lds
buffer_load_dwordx4 v27, s[28:31], s61 offen offset:1024 lds
s_add_u32 s49, s76, 4
s_and_b32 s49, s49, 15
s_mul_i32 s49, s49, 393216
buffer_load_dwordx4 v[40:43], v36, s[28:31], s49 offen
s_mov_b32 s64, 0
s_mov_b32 s65, 0
h1_loop:
s_waitcnt vmcnt(11)
s_barrier
s_cmp_lg_u32 s64, s88
s_cbranch_scc1 else_33
s_add_u32 s48, s83, 0
buffer_load_dwordx4 v[96:99], v26, s[36:39], s48 offen offset:0
buffer_load_dwordx4 v[100:103], v27, s[36:39], s48 offen offset:1024
s_add_u32 s48, s83, 2048
buffer_load_dwordx4 v[104:107], v26, s[36:39], s48 offen offset:0
buffer_load_dwordx4 v[108:111], v27, s[36:39], s48 offen offset:1024
s_add_u32 s48, s83, 4096
buffer_load_dwordx4 v[244:247], v26, s[36:39], s48 offen offset:0
buffer_load_dwordx4 v[8:11], v27, s[36:39], s48 offen offset:1024
else_33:
s_add_u32 s69, s69, 1
s_and_b32 s69, s69, 15
s_mul_i32 s67, s69, 2048
s_mul_i32 s68, s69, s54
s_add_u32 m0, s70, s65
s_nop 0
buffer_load_dwordx4 v20, s[32:35], s67 offen offset:0 sc1 lds
buffer_load_dwordx4 v21, s[32:35], s67 offen offset:1024 sc1 lds
buffer_load_dwordx4 v22, s[32:35], s67 offen offset:2048 sc1 lds
buffer_load_dwordx4 v23, s[32:35], s67 offen offset:3072 sc1 lds
s_add_u32 s60, s71, s65
s_add_u32 m0, s60, 0
s_mov_b32 s61, s68
buffer_load_dwordx4 v26, s[28:31], s61 offen lds
buffer_load_dwordx4 v27, s[28:31], s61 offen offset:1024 lds
s_add_u32 m0, s60, 8192
s_add_u32 s61, s61, s53
buffer_load_dwordx4 v26, s[28:31], s61 offen lds
buffer_load_dwordx4 v27, s[28:31], s61 offen offset:1024 lds
s_add_u32 m0, s60, 16384
s_add_u32 s61, s61, s53
buffer_load_dwordx4 v26, s[28:31], s61 offen lds
buffer_load_dwordx4 v27, s[28:31], s61 offen offset:1024 lds
s_add_u32 s48, s64, 5
s_min_u32 s48, s48, 15
s_add_u32 s49, s48, s76
s_and_b32 s49, s49, 15
s_mul_i32 s49, s49, 393216
buffer_load_dwordx4 v[40:43], v36, s[28:31], s49 offen
s_add_u32 s65, s65, 40960
s_cmp_eq_u32 s65, 122880
s_cselect_b32 s65, 0, s65
s_add_u32 s64, s64, 1
s_cmp_lt_u32 s64, 11
s_cbranch_scc1 h1_loop
s_waitcnt vmcnt(11)
s_barrier
s_add_u32 s69, s47, 14
s_and_b32 s69, s69, 15
s_mul_i32 s67, s69, 2048
s_mul_i32 s68, s69, s54
s_add_u32 m0, s70, s65
s_nop 0
buffer_load_dwordx4 v20, s[32:35], s67 offen offset:0 sc1 lds
buffer_load_dwordx4 v21, s[32:35], s67 offen offset:1024 sc1 lds
buffer_load_dwordx4 v22, s[32:35], s67 offen offset:2048 sc1 lds
buffer_load_dwordx4 v23, s[32:35], s67 offen offset:3072 sc1 lds
s_add_u32 s60, s71, s65
s_add_u32 m0, s60, 0
s_mov_b32 s61, s68
buffer_load_dwordx4 v26, s[28:31], s61 offen lds
buffer_load_dwordx4 v27, s[28:31], s61 offen offset:1024 lds
s_add_u32 m0, s60, 8192
s_add_u32 s61, s61, s53
buffer_load_dwordx4 v26, s[28:31], s61 offen lds
buffer_load_dwordx4 v27, s[28:31], s61 offen offset:1024 lds
s_add_u32 m0, s60, 16384
s_add_u32 s61, s61, s53
buffer_load_dwordx4 v26, s[28:31], s61 offen lds
buffer_load_dwordx4 v27, s[28:31], s61 offen offset:1024 lds
s_add_u32 s65, s65, 40960
s_cmp_eq_u32 s65, 122880
s_cselect_b32 s65, 0, s65
s_add_u32 s64, s64, 1
s_mov_b32 s36, s16
s_and_b32 s37, s17, 0xffff
s_mov_b32 s38, 2097152
s_mov_b32 s39, 0x00020000
s_waitcnt vmcnt(10)
s_barrier
s_add_u32 s69, s47, 15
s_and_b32 s69, s69, 15
s_mul_i32 s67, s69, 2048
s_mul_i32 s68, s69, s54
s_add_u32 m0, s70, 0
s_nop 0
buffer_load_dwordx4 v20, s[32:35], s67 offen offset:0 sc1 lds
buffer_load_dwordx4 v21, s[32:35], s67 offen offset:1024 sc1 lds
buffer_load_dwordx4 v22, s[32:35], s67 offen offset:2048 sc1 lds
buffer_load_dwordx4 v23, s[32:35], s67 offen offset:3072 sc1 lds
s_add_u32 s60, s71, 0
s_add_u32 m0, s60, 0
s_mov_b32 s61, s68
buffer_load_dwordx4 v26, s[28:31], s61 offen lds
buffer_load_dwordx4 v27, s[28:31], s61 offen offset:1024 lds
s_add_u32 m0, s60, 8192
s_add_u32 s61, s61, s53
buffer_load_dwordx4 v26, s[28:31], s61 offen lds
buffer_load_dwordx4 v27, s[28:31], s61 offen offset:1024 lds
s_add_u32 m0, s60, 16384
s_add_u32 s61, s61, s53
buffer_load_dwordx4 v26, s[28:31], s61 offen lds
buffer_load_dwordx4 v27, s[28:31], s61 offen offset:1024 lds
s_waitcnt vmcnt(10)
s_barrier
s_setprio 0
buffer_load_dwordx4 v[40:43], v15, s[36:39], 0 offen offset:0
buffer_load_dwordx4 v[40:43], v15, s[36:39], 0 offen offset:1024
buffer_load_dwordx4 v[80:83], v37, s[32:35], 0 offen offset:0 sc1
buffer_load_dwordx4 v[84:87], v37, s[32:35], 0 offen offset:1024 sc1
buffer_load_dwordx4 v[88:91], v37, s[32:35], 0 offen offset:2048 sc1
buffer_load_dwordx4 v[92:95], v37, s[32:35], 0 offen offset:3072 sc1
global_load_dword v48, v54, s[98:99]
buffer_load_dwordx4 v[64:67], v38, s[32:35], 0 offen offset:0 sc1
buffer_load_dwordx4 v[68:71], v38, s[32:35], 0 offen offset:1024 sc1
buffer_load_dwordx4 v[72:75], v38, s[32:35], 0 offen offset:2048 sc1
buffer_load_dwordx4 v[76:79], v38, s[32:35], 0 offen offset:3072 sc1
s_add_u32 s48, s75, 15
s_and_b32 s48, s48, 15
s_mul_i32 s48, s48, s57
s_add_u32 m0, s71, 106496
s_nop 0
buffer_load_dwordx4 v28, s[36:39], s48 offen lds
buffer_load_dwordx4 v29, s[36:39], s48 offen offset:1024 lds
s_waitcnt vmcnt(13)
s_barrier
s_add_u32 s48, s75, 5
s_and_b32 s48, s48, 15
s_mul_i32 s48, s48, s57
s_add_u32 m0, s71, 24576
s_nop 0
buffer_load_dwordx4 v28, s[36:39], s48 offen lds
buffer_load_dwordx4 v29, s[36:39], s48 offen offset:1024 lds
s_waitcnt vmcnt(4)
s_add_u32 s48, s75, 6
s_and_b32 s48, s48, 15
s_mul_i32 s48, s48, s57
s_add_u32 m0, s71, 32768
s_nop 0
buffer_load_dwordx4 v28, s[36:39], s48 offen lds
v_add_f32 v80, v80, v88
v_add_f32 v64, v64, v72
v_add_f32 v81, v81, v89
v_add_f32 v65, v65, v73
v_add_f32 v82, v82, v90
v_add_f32 v66, v66, v74
v_add_f32 v83, v83, v91
v_add_f32 v67, v67, v75
v_add_f32 v84, v84, v92
v_add_f32 v68, v68, v76
buffer_load_dwordx4 v29, s[36:39], s48 offen offset:1024 lds
v_add_f32 v85, v85, v93
v_add_f32 v69, v69, v77
v_add_f32 v86, v86, v94
v_add_f32 v70, v70, v78
v_add_f32 v87, v87, v95
v_add_f32 v71, v71, v79
v_add_f32 v80, v80, v84
v_add_f32 v64, v64, v68
v_add_f32 v81, v81, v85
v_add_f32 v65, v65, v69
s_add_u32 s48, s75, 7
s_and_b32 s48, s48, 15
s_mul_i32 s48, s48, s57
s_add_u32 m0, s71, 40960
s_nop 0
buffer_load_dwordx4 v28, s[36:39], s48 offen lds
v_add_f32 v82, v82, v86
v_add_f32 v66, v66, v70
v_add_f32 v83, v83, v87
v_add_f32 v67, v67, v71
s_nop 1
s_nop 1
v_permlane32_swap_b32 v80, v81
v_permlane32_swap_b32 v64, v65
v_permlane32_swap_b32 v82, v83
buffer_load_dwordx4 v29, s[36:39], s48 offen offset:1024 lds
v_permlane32_swap_b32 v66, v67
v_add_f32 v80, v80, v81
v_add_f32 v64, v64, v65
v_add_f32 v82, v82, v83
v_add_f32 v66, v66, v67
s_nop 1
s_nop 1
v_permlane16_swap_b32 v80, v82
v_permlane16_swap_b32 v64, v66
s_nop 0
s_add_u32 s48, s75, 8
s_and_b32 s48, s48, 15
s_mul_i32 s48, s48, s57
s_add_u32 m0, s71, 49152
s_nop 0
buffer_load_dwordx4 v28, s[36:39], s48 offen lds
s_nop 0
v_add_f32 v80, v80, v82
v_add_f32 v64, v64, v66
v_cmp_u_f32 vcc, v80, v80
s_cbranch_vccnz again_35
summed_36:
v_cmp_u_f32 vcc, v64, v64
s_cbranch_vccnz again_38
summed_39:
v_mul_f32 v44, 0x3a800000, v80
ds_write_b32 v53, v64
v_mov_b32 v45, v44
s_nop 1
v_permlane16_swap_b32 v44, v45
buffer_load_dwordx4 v29, s[36:39], s48 offen offset:1024 lds
s_nop 0
v_fma_f32 v45, -v44, v44, v45
v_max_f32 v45, 0, v45
v_add_f32 v45, 0x3727c5ac, v45
v_rsq_f32 v46, v45
v_sub_f32 v47, 0, v44
ds_write_b32 v50, v47 offset:512
ds_write_b64 v49, v[46:47]
ds_write_b32 v50, v46
s_setprio 0
s_waitcnt lgkmcnt(0)
s_waitcnt vmcnt(63)
s_barrier
s_waitcnt vmcnt(5)
s_add_u32 s48, s75, 9
s_and_b32 s48, s48, 15
s_mul_i32 s48, s48, s57
s_add_u32 m0, s71, 57344
s_nop 0
buffer_load_dwordx4 v28, s[36:39], s48 offen lds
buffer_load_dwordx4 v29, s[36:39], s48 offen offset:1024 lds
s_waitcnt vmcnt(5)
s_add_u32 s48, s75, 10
s_and_b32 s48, s48, 15
s_mul_i32 s48, s48, s57
s_add_u32 m0, s71, 65536
s_nop 0
buffer_load_dwordx4 v28, s[36:39], s48 offen lds
buffer_load_dwordx4 v29, s[36:39], s48 offen offset:1024 lds
s_waitcnt vmcnt(5)
s_add_u32 s48, s75, 11
s_and_b32 s48, s48, 15
s_mul_i32 s48, s48, s57
s_add_u32 m0, s71, 73728
s_nop 0
buffer_load_dwordx4 v28, s[36:39], s48 offen lds
buffer_load_dwordx4 v29, s[36:39], s48 offen offset:1024 lds
s_waitcnt vmcnt(5)
s_add_u32 s48, s75, 12
s_and_b32 s48, s48, 15
s_mul_i32 s48, s48, s57
s_add_u32 m0, s71, 81920
s_nop 0
buffer_load_dwordx4 v28, s[36:39], s48 offen lds
buffer_load_dwordx4 v29, s[36:39], s48 offen offset:1024 lds
s_waitcnt vmcnt(5)
s_add_u32 s48, s75, 13
s_and_b32 s48, s48, 15
s_mul_i32 s48, s48, s57
s_add_u32 m0, s71, 90112
s_nop 0
buffer_load_dwordx4 v28, s[36:39], s48 offen lds
buffer_load_dwordx4 v29, s[36:39], s48 offen offset:1024 lds
s_waitcnt vmcnt(5)
s_add_u32 s48, s75, 14
s_and_b32 s48, s48, 15
s_mul_i32 s48, s48, s57
s_add_u32 m0, s71, 98304
s_nop 0
buffer_load_dwordx4 v28, s[36:39], s48 offen lds
buffer_load_dwordx4 v29, s[36:39], s48 offen offset:1024 lds
s_waitcnt vmcnt(5)
s_add_u32 s48, s75, 0
s_and_b32 s48, s48, 15
s_mul_i32 s48, s48, s57
s_add_u32 m0, s71, 4294950912
s_nop 0
buffer_load_dwordx4 v28, s[36:39], s48 offen lds
buffer_load_dwordx4 v29, s[36:39], s48 offen offset:1024 lds
s_waitcnt vmcnt(5)
s_add_u32 s48, s75, 1
s_and_b32 s48, s48, 15
s_mul_i32 s48, s48, s57
s_add_u32 m0, s71, 4294959104
s_nop 0
buffer_load_dwordx4 v28, s[36:39], s48 offen lds
buffer_load_dwordx4 v29, s[36:39], s48 offen offset:1024 lds
s_waitcnt vmcnt(5)
s_add_u32 s48, s75, 2
s_and_b32 s48, s48, 15
s_mul_i32 s48, s48, s57
s_add_u32 m0, s71, 0
s_nop 0
buffer_load_dwordx4 v28, s[36:39], s48 offen lds
buffer_load_dwordx4 v29, s[36:39], s48 offen offset:1024 lds
s_waitcnt vmcnt(5)
s_add_u32 s48, s75, 3
s_and_b32 s48, s48, 15
s_mul_i32 s48, s48, s57
s_add_u32 m0, s71, 8192
s_nop 0
buffer_load_dwordx4 v28, s[36:39], s48 offen lds
buffer_load_dwordx4 v29, s[36:39], s48 offen offset:1024 lds
s_waitcnt vmcnt(5)
s_add_u32 s48, s75, 4
s_and_b32 s48, s48, 15
s_mul_i32 s48, s48, s57
s_add_u32 m0, s71, 16384
s_nop 0
buffer_load_dwordx4 v28, s[36:39], s48 offen lds
buffer_load_dwordx4 v29, s[36:39], s48 offen offset:1024 lds
s_waitcnt vmcnt(5)
buffer_load_dwordx4 v[40:43], v18, s[32:35], s81 offen offset:0 sc1
buffer_load_dwordx4 v[40:43], v18, s[32:35], s81 offen offset:1024 sc1
s_waitcnt vmcnt(5)
buffer_load_dwordx4 v[40:43], v18, s[32:35], s82 offen offset:0 sc1
buffer_load_dwordx4 v[40:43], v18, s[32:35], s82 offen offset:1024 sc1
s_mov_b32 s28, s6
s_and_b32 s29, s7, 0xffff
s_mov_b32 s30, 6291456
s_mov_b32 s31, 0x00020000
s_and_b32 s48, s2, 7
s_lshl_b32 s48, s48, 1
s_add_u32 s47, s42, s48
s_and_b32 s47, s47, 15
s_and_b32 s50, s42, 8
s_or_b32 s50, s50, 3
s_and_b32 s48, s2, 7
s_lshl_b32 s48, s48, 1
s_add_u32 s76, s50, s48
s_and_b32 s76, s76, 15
s_add_u32 s69, s47, 0
s_and_b32 s69, s69, 15
s_mul_i32 s67, s69, 2048
s_mul_i32 s68, s69, s54
s_waitcnt vmcnt(0) lgkmcnt(0)
s_barrier
ds_write_b128 v14, v[96:99] offset:8192
ds_write_b128 v14, v[100:103] offset:9216
ds_write_b128 v14, v[104:107] offset:16384
ds_write_b128 v14, v[108:111] offset:17408
ds_write_b128 v14, v[244:247] offset:24576
ds_write_b128 v14, v[8:11] offset:25600
v_add_u32 v37, 262144, v37
s_getpc_b64 s[98:99]
pc_41:
s_add_u32 s98, s98, c2_last - pc_41
s_addc_u32 s99, s99, 0
s_lshr_b32 s50, s2, 3
s_lshl_b32 s50, s50, 2
s_add_u32 s50, s50, s43
s_lshl_b32 s50, s50, 7
v_and_b32 v4, 1, v0
v_lshl_add_u32 v4, v4, 6, s50
v_min_u32 v54, L_code_end - c2_last, v4
s_waitcnt vmcnt(0) lgkmcnt(0)
s_add_u32 s69, s47, 1
s_and_b32 s69, s69, 15
s_mul_i32 s67, s69, 2048
s_mul_i32 s68, s69, s54
s_barrier
s_add_u32 s60, s71, 40960
s_add_u32 m0, s60, 0
s_mov_b32 s61, s68
buffer_load_dwordx4 v26, s[28:31], s61 offen lds
buffer_load_dwordx4 v27, s[28:31], s61 offen offset:1024 lds
s_add_u32 m0, s60, 8192
s_add_u32 s61, s61, s53
buffer_load_dwordx4 v26, s[28:31], s61 offen lds
buffer_load_dwordx4 v27, s[28:31], s61 offen offset:1024 lds
s_add_u32 m0, s60, 16384
s_add_u32 s61, s61, s53
buffer_load_dwordx4 v26, s[28:31], s61 offen lds
buffer_load_dwordx4 v27, s[28:31], s61 offen offset:1024 lds
s_add_u32 s49, s76, 2
s_and_b32 s49, s49, 15
s_mul_i32 s49, s49, 393216
buffer_load_dwordx4 v[40:43], v36, s[28:31], s49 offen
s_add_u32 s49, s76, 3
s_and_b32 s49, s49, 15
s_mul_i32 s49, s49, 393216
buffer_load_dwordx4 v[40:43], v36, s[28:31], s49 offen
buffer_load_dword v5, v30, s[32:35], s79 offen sc1
s_add_u32 s69, s47, 0
s_and_b32 s69, s69, 15
s_mul_i32 s67, s69, 2048
s_mul_i32 s68, s69, s54
s_add_u32 m0, s70, 0
s_nop 0
s_mov_b32 s63, 0
s_waitcnt vmcnt(0)
poll_42:
v_cmp_gt_u32 vcc, 2, v5
s_cbranch_vccz polled_43
buffer_load_dword v5, v30, s[32:35], s79 offen sc1
s_add_u32 s63, s63, 1
s_cmp_lt_u32 s63, 0x80000
s_waitcnt vmcnt(0)
s_cbranch_scc1 poll_42
polled_43:
buffer_load_dwordx4 v20, s[32:35], s67 offen offset:0 sc1 lds
buffer_load_dwordx4 v21, s[32:35], s67 offen offset:1024 sc1 lds
buffer_load_dwordx4 v22, s[32:35], s67 offen offset:2048 sc1 lds
buffer_load_dwordx4 v23, s[32:35], s67 offen offset:3072 sc1 lds
s_add_u32 s69, s47, 1
s_and_b32 s69, s69, 15
s_mul_i32 s67, s69, 2048
s_mul_i32 s68, s69, s54
s_add_u32 m0, s70, 40960
s_nop 0
buffer_load_dwordx4 v20, s[32:35], s67 offen offset:0 sc1 lds
buffer_load_dwordx4 v21, s[32:35], s67 offen offset:1024 sc1 lds
buffer_load_dwordx4 v22, s[32:35], s67 offen offset:2048 sc1 lds
buffer_load_dwordx4 v23, s[32:35], s67 offen offset:3072 sc1 lds
s_waitcnt vmcnt(4) lgkmcnt(0)
s_barrier
s_add_u32 s69, s47, 2
s_and_b32 s69, s69, 15
s_mul_i32 s67, s69, 2048
s_mul_i32 s68, s69, s54
s_add_u32 m0, s70, 81920
s_nop 0
buffer_load_dwordx4 v20, s[32:35], s67 offen offset:0 sc1 lds
buffer_load_dwordx4 v21, s[32:35], s67 offen offset:1024 sc1 lds
buffer_load_dwordx4 v22, s[32:35], s67 offen offset:2048 sc1 lds
buffer_load_dwordx4 v23, s[32:35], s67 offen offset:3072 sc1 lds
s_add_u32 s60, s71, 81920
s_add_u32 m0, s60, 0
s_mov_b32 s61, s68
buffer_load_dwordx4 v26, s[28:31], s61 offen lds
buffer_load_dwordx4 v27, s[28:31], s61 offen offset:1024 lds
s_add_u32 m0, s60, 8192
s_add_u32 s61, s61, s53
buffer_load_dwordx4 v26, s[28:31], s61 offen lds
buffer_load_dwordx4 v27, s[28:31], s61 offen offset:1024 lds
s_add_u32 m0, s60, 16384
s_add_u32 s61, s61, s53
buffer_load_dwordx4 v26, s[28:31], s61 offen lds
buffer_load_dwordx4 v27, s[28:31], s61 offen offset:1024 lds
s_add_u32 s49, s76, 4
s_and_b32 s49, s49, 15
s_mul_i32 s49, s49, 393216
buffer_load_dwordx4 v[40:43], v36, s[28:31], s49 offen
s_mov_b32 s64, 0
s_mov_b32 s65, 0
h2_loop:
s_waitcnt vmcnt(11)
s_barrier
s_add_u32 s69, s69, 1
s_and_b32 s69, s69, 15
s_mul_i32 s67, s69, 2048
s_mul_i32 s68, s69, s54
s_add_u32 m0, s70, s65
s_nop 0
buffer_load_dwordx4 v20, s[32:35], s67 offen offset:0 sc1 lds
buffer_load_dwordx4 v21, s[32:35], s67 offen offset:1024 sc1 lds
buffer_load_dwordx4 v22, s[32:35], s67 offen offset:2048 sc1 lds
buffer_load_dwordx4 v23, s[32:35], s67 offen offset:3072 sc1 lds
s_add_u32 s60, s71, s65
s_add_u32 m0, s60, 0
s_mov_b32 s61, s68
buffer_load_dwordx4 v26, s[28:31], s61 offen lds
buffer_load_dwordx4 v27, s[28:31], s61 offen offset:1024 lds
s_add_u32 m0, s60, 8192
s_add_u32 s61, s61, s53
buffer_load_dwordx4 v26, s[28:31], s61 offen lds
buffer_load_dwordx4 v27, s[28:31], s61 offen offset:1024 lds
s_add_u32 m0, s60, 16384
s_add_u32 s61, s61, s53
buffer_load_dwordx4 v26, s[28:31], s61 offen lds
buffer_load_dwordx4 v27, s[28:31], s61 offen offset:1024 lds
s_add_u32 s48, s64, 5
s_min_u32 s48, s48, 15
s_add_u32 s49, s48, s76
s_and_b32 s49, s49, 15
s_mul_i32 s49, s49, 393216
buffer_load_dwordx4 v[40:43], v36, s[28:31], s49 offen
s_add_u32 s65, s65, 40960
s_cmp_eq_u32 s65, 122880
s_cselect_b32 s65, 0, s65
s_add_u32 s64, s64, 1
s_cmp_lt_u32 s64, 11
s_cbranch_scc1 h2_loop
s_waitcnt vmcnt(11)
s_barrier
s_add_u32 s69, s47, 14
s_and_b32 s69, s69, 15
s_mul_i32 s67, s69, 2048
s_mul_i32 s68, s69, s54
s_add_u32 m0, s70, s65
s_nop 0
buffer_load_dwordx4 v20, s[32:35], s67 offen offset:0 sc1 lds
buffer_load_dwordx4 v21, s[32:35], s67 offen offset:1024 sc1 lds
buffer_load_dwordx4 v22, s[32:35], s67 offen offset:2048 sc1 lds
buffer_load_dwordx4 v23, s[32:35], s67 offen offset:3072 sc1 lds
s_add_u32 s60, s71, s65
s_add_u32 m0, s60, 0
s_mov_b32 s61, s68
buffer_load_dwordx4 v26, s[28:31], s61 offen lds
buffer_load_dwordx4 v27, s[28:31], s61 offen offset:1024 lds
s_add_u32 m0, s60, 8192
s_add_u32 s61, s61, s53
buffer_load_dwordx4 v26, s[28:31], s61 offen lds
buffer_load_dwordx4 v27, s[28:31], s61 offen offset:1024 lds
s_add_u32 m0, s60, 16384
s_add_u32 s61, s61, s53
buffer_load_dwordx4 v26, s[28:31], s61 offen lds
buffer_load_dwordx4 v27, s[28:31], s61 offen offset:1024 lds
s_add_u32 s65, s65, 40960
s_cmp_eq_u32 s65, 122880
s_cselect_b32 s65, 0, s65
s_add_u32 s64, s64, 1
s_mov_b32 s36, s12
s_and_b32 s37, s13, 0xffff
s_mov_b32 s38, 6291456
s_mov_b32 s39, 0x00020000
s_waitcnt vmcnt(10)
s_barrier
s_add_u32 s69, s47, 15
s_and_b32 s69, s69, 15
s_mul_i32 s67, s69, 2048
s_mul_i32 s68, s69, s54
s_add_u32 m0, s70, 0
s_nop 0
buffer_load_dwordx4 v20, s[32:35], s67 offen offset:0 sc1 lds
buffer_load_dwordx4 v21, s[32:35], s67 offen offset:1024 sc1 lds
buffer_load_dwordx4 v22, s[32:35], s67 offen offset:2048 sc1 lds
buffer_load_dwordx4 v23, s[32:35], s67 offen offset:3072 sc1 lds
s_add_u32 s60, s71, 0
s_add_u32 m0, s60, 0
s_mov_b32 s61, s68
buffer_load_dwordx4 v26, s[28:31], s61 offen lds
buffer_load_dwordx4 v27, s[28:31], s61 offen offset:1024 lds
s_add_u32 m0, s60, 8192
s_add_u32 s61, s61, s53
buffer_load_dwordx4 v26, s[28:31], s61 offen lds
buffer_load_dwordx4 v27, s[28:31], s61 offen offset:1024 lds
s_add_u32 m0, s60, 16384
s_add_u32 s61, s61, s53
buffer_load_dwordx4 v26, s[28:31], s61 offen lds
buffer_load_dwordx4 v27, s[28:31], s61 offen offset:1024 lds
s_waitcnt vmcnt(10)
s_barrier
s_setprio 0
buffer_load_dwordx4 v[80:83], v37, s[32:35], 0 offen offset:0 sc1
buffer_load_dwordx4 v[84:87], v37, s[32:35], 0 offen offset:1024 sc1
buffer_load_dwordx4 v[88:91], v37, s[32:35], 0 offen offset:2048 sc1
buffer_load_dwordx4 v[92:95], v37, s[32:35], 0 offen offset:3072 sc1
global_load_dword v48, v54, s[98:99]
s_add_u32 s69, s47, 0
s_and_b32 s69, s69, 15
s_mul_i32 s67, s69, 2048
s_mul_i32 s68, s69, s54
s_add_u32 s60, s71, 122880
s_add_u32 m0, s60, 0
s_mov_b32 s61, s68
buffer_load_dwordx4 v26, s[36:39], s61 offen lds
buffer_load_dwordx4 v27, s[36:39], s61 offen offset:1024 lds
s_add_u32 m0, s60, 8192
s_add_u32 s61, s61, s53
buffer_load_dwordx4 v26, s[36:39], s61 offen lds
buffer_load_dwordx4 v27, s[36:39], s61 offen offset:1024 lds
s_add_u32 m0, s60, 16384
s_add_u32 s61, s61, s53
buffer_load_dwordx4 v26, s[36:39], s61 offen lds
buffer_load_dwordx4 v27, s[36:39], s61 offen offset:1024 lds
s_waitcnt vmcnt(11)
s_barrier
s_waitcnt vmcnt(7)
buffer_store_dwordx4 v[56:59], v18, s[32:35], s86 offen offset:0 sc1
v_add_f32 v80, v80, v88
v_add_f32 v81, v81, v89
v_add_f32 v82, v82, v90
v_add_f32 v83, v83, v91
v_add_f32 v84, v84, v92
v_add_f32 v85, v85, v93
v_add_f32 v86, v86, v94
buffer_store_dwordx4 v[56:59], v18, s[32:35], s86 offen offset:1024 sc1
v_add_f32 v87, v87, v95
v_add_f32 v80, v80, v84
v_add_f32 v81, v81, v85
v_add_f32 v82, v82, v86
v_add_f32 v83, v83, v87
s_nop 1
buffer_load_dwordx4 v[40:43], v18, s[32:35], s81 offen offset:0 sc1
v_permlane32_swap_b32 v80, v81
v_permlane32_swap_b32 v82, v83
v_add_f32 v80, v80, v81
v_add_f32 v82, v82, v83
s_nop 1
v_permlane16_swap_b32 v80, v82
buffer_load_dwordx4 v[40:43], v18, s[32:35], s81 offen offset:1024 sc1
s_nop 0
v_add_f32 v80, v80, v82
v_cmp_u_f32 vcc, v80, v80
s_cbranch_vccnz again_44
summed_45:
v_mul_f32 v44, 0x3a800000, v80
buffer_load_dwordx4 v[40:43], v18, s[32:35], s82 offen offset:0 sc1
v_mov_b32 v45, v44
s_nop 1
v_permlane16_swap_b32 v44, v45
s_nop 0
v_fma_f32 v45, -v44, v44, v45
v_max_f32 v45, 0, v45
buffer_load_dwordx4 v[40:43], v18, s[32:35], s82 offen offset:1024 sc1
v_add_f32 v45, 0x3727c5ac, v45
v_rsq_f32 v46, v45
v_sub_f32 v47, 0, v44
ds_write_b32 v50, v47 offset:512
ds_write_b64 v49, v[46:47]
ds_write_b32 v50, v46
s_setprio 0
s_waitcnt lgkmcnt(0)
s_waitcnt vmcnt(63)
s_barrier
ds_write_b128 v52, v[232:235] offset:57344
ds_write_b128 v52, v[236:239] offset:58368
ds_write_b128 v51, v[152:155] offset:40960
ds_write_b128 v51, v[156:159] offset:41984
ds_write_b128 v51, v[160:163] offset:49152
ds_write_b128 v51, v[164:167] offset:50176
ds_write_b128 v51, v[168:171] offset:57344
ds_write_b128 v51, v[172:175] offset:58368
ds_write_b128 v52, v[176:179] offset:0
ds_write_b128 v52, v[180:183] offset:1024
ds_write_b128 v52, v[184:187] offset:8192
ds_write_b128 v52, v[188:191] offset:9216
ds_write_b128 v52, v[192:195] offset:16384
ds_write_b128 v52, v[196:199] offset:17408
ds_write_b128 v52, v[200:203] offset:24576
ds_write_b128 v52, v[204:207] offset:25600
ds_write_b128 v52, v[208:211] offset:32768
ds_write_b128 v52, v[212:215] offset:33792
ds_write_b128 v52, v[216:219] offset:40960
ds_write_b128 v52, v[220:223] offset:41984
ds_write_b128 v52, v[224:227] offset:49152
ds_write_b128 v52, v[228:231] offset:50176
ds_write_b128 v51, v[112:115] offset:0
ds_write_b128 v51, v[116:119] offset:1024
ds_write_b128 v51, v[120:123] offset:8192
ds_write_b128 v51, v[124:127] offset:9216
ds_write_b128 v51, v[128:131] offset:16384
ds_write_b128 v51, v[132:135] offset:17408
ds_write_b128 v51, v[136:139] offset:24576
ds_write_b128 v51, v[140:143] offset:25600
ds_write_b128 v51, v[144:147] offset:32768
ds_write_b128 v51, v[148:151] offset:33792
s_mov_b32 s28, s12
s_and_b32 s29, s13, 0xffff
s_mov_b32 s30, 6291456
s_mov_b32 s31, 0x00020000
s_add_u32 s69, s47, 0
s_and_b32 s69, s69, 15
s_mul_i32 s67, s69, 2048
s_mul_i32 s68, s69, s54
s_waitcnt vmcnt(0) lgkmcnt(0)
s_barrier
ds_write_b128 v13, v[240:243]
v_add_u32 v37, 262144, v37
s_getpc_b64 s[98:99]
pc_47:
s_add_u32 s98, s98, c3_last - pc_47
s_addc_u32 s99, s99, 0
s_lshr_b32 s50, s2, 3
s_lshl_b32 s50, s50, 2
s_add_u32 s50, s50, s43
s_lshl_b32 s50, s50, 7
v_and_b32 v4, 1, v0
v_lshl_add_u32 v4, v4, 6, s50
v_min_u32 v54, L_code_end - c3_last, v4
s_cmp_lg_u32 s43, 0
s_cbranch_scc1 else_48
s_mov_b32 s48, 1
s_atomic_add s48, s[22:23], s73
else_48:
s_waitcnt vmcnt(0) lgkmcnt(0)
s_add_u32 s69, s47, 1
s_and_b32 s69, s69, 15
s_mul_i32 s67, s69, 2048
s_mul_i32 s68, s69, s54
s_barrier
s_add_u32 s60, s71, 40960
s_add_u32 m0, s60, 0
s_mov_b32 s61, s68
buffer_load_dwordx4 v26, s[28:31], s61 offen lds
buffer_load_dwordx4 v27, s[28:31], s61 offen offset:1024 lds
s_add_u32 m0, s60, 8192
s_add_u32 s61, s61, s53
buffer_load_dwordx4 v26, s[28:31], s61 offen lds
buffer_load_dwordx4 v27, s[28:31], s61 offen offset:1024 lds
s_add_u32 m0, s60, 16384
s_add_u32 s61, s61, s53
buffer_load_dwordx4 v26, s[28:31], s61 offen lds
buffer_load_dwordx4 v27, s[28:31], s61 offen offset:1024 lds
s_add_u32 s49, s76, 2
s_and_b32 s49, s49, 15
s_mul_i32 s49, s49, 393216
buffer_load_dwordx4 v[40:43], v36, s[28:31], s49 offen
s_add_u32 s49, s76, 3
s_and_b32 s49, s49, 15
s_mul_i32 s49, s49, 393216
buffer_load_dwordx4 v[40:43], v36, s[28:31], s49 offen
buffer_load_dword v5, v30, s[32:35], s79 offen sc1
s_add_u32 s69, s47, 0
s_and_b32 s69, s69, 15
s_mul_i32 s67, s69, 2048
s_mul_i32 s68, s69, s54
s_add_u32 m0, s70, 0
s_nop 0
s_mov_b32 s63, 0
s_waitcnt vmcnt(0)
poll_50:
v_cmp_gt_u32 vcc, 3, v5
s_cbranch_vccz polled_51
buffer_load_dword v5, v30, s[32:35], s79 offen sc1
s_add_u32 s63, s63, 1
s_cmp_lt_u32 s63, 0x80000
s_waitcnt vmcnt(0)
s_cbranch_scc1 poll_50
polled_51:
buffer_load_dwordx4 v20, s[32:35], s67 offen offset:0 sc1 lds
buffer_load_dwordx4 v21, s[32:35], s67 offen offset:1024 sc1 lds
buffer_load_dwordx4 v22, s[32:35], s67 offen offset:2048 sc1 lds
buffer_load_dwordx4 v23, s[32:35], s67 offen offset:3072 sc1 lds
s_add_u32 s69, s47, 1
s_and_b32 s69, s69, 15
s_mul_i32 s67, s69, 2048
s_mul_i32 s68, s69, s54
s_add_u32 m0, s70, 40960
s_nop 0
buffer_load_dwordx4 v20, s[32:35], s67 offen offset:0 sc1 lds
buffer_load_dwordx4 v21, s[32:35], s67 offen offset:1024 sc1 lds
buffer_load_dwordx4 v22, s[32:35], s67 offen offset:2048 sc1 lds
buffer_load_dwordx4 v23, s[32:35], s67 offen offset:3072 sc1 lds
s_waitcnt vmcnt(4) lgkmcnt(0)
s_barrier
s_add_u32 s69, s47, 2
s_and_b32 s69, s69, 15
s_mul_i32 s67, s69, 2048
s_mul_i32 s68, s69, s54
s_add_u32 m0, s70, 81920
s_nop 0
buffer_load_dwordx4 v20, s[32:35], s67 offen offset:0 sc1 lds
buffer_load_dwordx4 v21, s[32:35], s67 offen offset:1024 sc1 lds
buffer_load_dwordx4 v22, s[32:35], s67 offen offset:2048 sc1 lds
buffer_load_dwordx4 v23, s[32:35], s67 offen offset:3072 sc1 lds
s_add_u32 s60, s71, 81920
s_add_u32 m0, s60, 0
s_mov_b32 s61, s68
buffer_load_dwordx4 v26, s[28:31], s61 offen lds
buffer_load_dwordx4 v27, s[28:31], s61 offen offset:1024 lds
s_add_u32 m0, s60, 8192
s_add_u32 s61, s61, s53
buffer_load_dwordx4 v26, s[28:31], s61 offen lds
buffer_load_dwordx4 v27, s[28:31], s61 offen offset:1024 lds
s_add_u32 m0, s60, 16384
s_add_u32 s61, s61, s53
buffer_load_dwordx4 v26, s[28:31], s61 offen lds
buffer_load_dwordx4 v27, s[28:31], s61 offen offset:1024 lds
s_add_u32 s49, s76, 4
s_and_b32 s49, s49, 15
s_mul_i32 s49, s49, 393216
buffer_load_dwordx4 v[40:43], v36, s[28:31], s49 offen
s_mov_b32 s64, 0
s_mov_b32 s65, 0
h3_loop:
s_waitcnt vmcnt(11)
s_barrier
s_add_u32 s69, s69, 1
s_and_b32 s69, s69, 15
s_mul_i32 s67, s69, 2048
s_mul_i32 s68, s69, s54
s_add_u32 m0, s70, s65
s_nop 0
buffer_load_dwordx4 v20, s[32:35], s67 offen offset:0 sc1 lds
buffer_load_dwordx4 v21, s[32:35], s67 offen offset:1024 sc1 lds
buffer_load_dwordx4 v22, s[32:35], s67 offen offset:2048 sc1 lds
buffer_load_dwordx4 v23, s[32:35], s67 offen offset:3072 sc1 lds
s_add_u32 s60, s71, s65
s_add_u32 m0, s60, 0
s_mov_b32 s61, s68
buffer_load_dwordx4 v26, s[28:31], s61 offen lds
buffer_load_dwordx4 v27, s[28:31], s61 offen offset:1024 lds
s_add_u32 m0, s60, 8192
s_add_u32 s61, s61, s53
buffer_load_dwordx4 v26, s[28:31], s61 offen lds
buffer_load_dwordx4 v27, s[28:31], s61 offen offset:1024 lds
s_add_u32 m0, s60, 16384
s_add_u32 s61, s61, s53
buffer_load_dwordx4 v26, s[28:31], s61 offen lds
buffer_load_dwordx4 v27, s[28:31], s61 offen offset:1024 lds
s_add_u32 s48, s64, 5
s_min_u32 s48, s48, 15
s_add_u32 s49, s48, s76
s_and_b32 s49, s49, 15
s_mul_i32 s49, s49, 393216
buffer_load_dwordx4 v[40:43], v36, s[28:31], s49 offen
s_add_u32 s65, s65, 40960
s_cmp_eq_u32 s65, 122880
s_cselect_b32 s65, 0, s65
s_add_u32 s64, s64, 1
s_cmp_lt_u32 s64, 11
s_cbranch_scc1 h3_loop
s_waitcnt vmcnt(11)
s_barrier
s_add_u32 s69, s47, 14
s_and_b32 s69, s69, 15
s_mul_i32 s67, s69, 2048
s_mul_i32 s68, s69, s54
s_add_u32 m0, s70, s65
s_nop 0
buffer_load_dwordx4 v20, s[32:35], s67 offen offset:0 sc1 lds
buffer_load_dwordx4 v21, s[32:35], s67 offen offset:1024 sc1 lds
buffer_load_dwordx4 v22, s[32:35], s67 offen offset:2048 sc1 lds
buffer_load_dwordx4 v23, s[32:35], s67 offen offset:3072 sc1 lds
s_add_u32 s60, s71, s65
s_add_u32 m0, s60, 0
s_mov_b32 s61, s68
buffer_load_dwordx4 v26, s[28:31], s61 offen lds
buffer_load_dwordx4 v27, s[28:31], s61 offen offset:1024 lds
s_add_u32 m0, s60, 8192
s_add_u32 s61, s61, s53
buffer_load_dwordx4 v26, s[28:31], s61 offen lds
buffer_load_dwordx4 v27, s[28:31], s61 offen offset:1024 lds
s_add_u32 m0, s60, 16384
s_add_u32 s61, s61, s53
buffer_load_dwordx4 v26, s[28:31], s61 offen lds
buffer_load_dwordx4 v27, s[28:31], s61 offen offset:1024 lds
s_add_u32 s65, s65, 40960
s_cmp_eq_u32 s65, 122880
s_cselect_b32 s65, 0, s65
s_add_u32 s64, s64, 1
s_mov_b32 s36, s16
s_and_b32 s37, s17, 0xffff
s_mov_b32 s38, 2097152
s_mov_b32 s39, 0x00020000
s_waitcnt vmcnt(10)
s_barrier
s_add_u32 s69, s47, 15
s_and_b32 s69, s69, 15
s_mul_i32 s67, s69, 2048
s_mul_i32 s68, s69, s54
s_add_u32 m0, s70, 0
s_nop 0
buffer_load_dwordx4 v20, s[32:35], s67 offen offset:0 sc1 lds
buffer_load_dwordx4 v21, s[32:35], s67 offen offset:1024 sc1 lds
buffer_load_dwordx4 v22, s[32:35], s67 offen offset:2048 sc1 lds
buffer_load_dwordx4 v23, s[32:35], s67 offen offset:3072 sc1 lds
s_add_u32 s60, s71, 0
s_add_u32 m0, s60, 0
s_mov_b32 s61, s68
buffer_load_dwordx4 v26, s[28:31], s61 offen lds
buffer_load_dwordx4 v27, s[28:31], s61 offen offset:1024 lds
s_add_u32 m0, s60, 8192
s_add_u32 s61, s61, s53
buffer_load_dwordx4 v26, s[28:31], s61 offen lds
buffer_load_dwordx4 v27, s[28:31], s61 offen offset:1024 lds
s_add_u32 m0, s60, 16384
s_add_u32 s61, s61, s53
buffer_load_dwordx4 v26, s[28:31], s61 offen lds
buffer_load_dwordx4 v27, s[28:31], s61 offen offset:1024 lds
s_waitcnt vmcnt(10)
s_barrier
s_setprio 0
buffer_load_dword v33, v12, s[32:35], s73 offen sc1
buffer_load_dwordx4 v[80:83], v37, s[32:35], 0 offen offset:0 sc1
buffer_load_dwordx4 v[84:87], v37, s[32:35], 0 offen offset:1024 sc1
buffer_load_dwordx4 v[88:91], v37, s[32:35], 0 offen offset:2048 sc1
buffer_load_dwordx4 v[92:95], v37, s[32:35], 0 offen offset:3072 sc1
global_load_dword v48, v54, s[98:99]
s_add_u32 s48, s75, 15
s_and_b32 s48, s48, 15
s_mul_i32 s48, s48, s57
s_add_u32 m0, s71, 106496
s_nop 0
buffer_load_dwordx4 v28, s[36:39], s48 offen lds
buffer_load_dwordx4 v29, s[36:39], s48 offen offset:1024 lds
s_add_u32 s48, s75, 5
s_and_b32 s48, s48, 15
s_mul_i32 s48, s48, s57
s_add_u32 m0, s71, 24576
s_nop 0
buffer_load_dwordx4 v28, s[36:39], s48 offen lds
buffer_load_dwordx4 v29, s[36:39], s48 offen offset:1024 lds
s_add_u32 s48, s75, 6
s_and_b32 s48, s48, 15
s_mul_i32 s48, s48, s57
s_add_u32 m0, s71, 32768
s_nop 0
buffer_load_dwordx4 v28, s[36:39], s48 offen lds
buffer_load_dwordx4 v29, s[36:39], s48 offen offset:1024 lds
s_waitcnt vmcnt(12)
s_barrier
s_waitcnt vmcnt(7)
s_mov_b32 s63, 0
poll_55:
v_cmp_gt_u32 vcc, 16, v33
s_cbranch_vccz polled_56
buffer_load_dword v33, v12, s[32:35], s73 offen sc1
s_add_u32 s63, s63, 1
s_cmp_lt_u32 s63, 0x80000
s_waitcnt vmcnt(0)
s_cbranch_scc1 poll_55
polled_56:
s_add_u32 s48, s75, 7
s_and_b32 s48, s48, 15
s_mul_i32 s48, s48, s57
s_add_u32 m0, s71, 40960
s_nop 0
buffer_load_dwordx4 v28, s[36:39], s48 offen lds
v_add_f32 v80, v80, v88
v_add_f32 v81, v81, v89
v_add_f32 v82, v82, v90
v_add_f32 v83, v83, v91
v_add_f32 v84, v84, v92
buffer_load_dwordx4 v29, s[36:39], s48 offen offset:1024 lds
v_add_f32 v85, v85, v93
v_add_f32 v86, v86, v94
v_add_f32 v87, v87, v95
v_add_f32 v80, v80, v84
v_add_f32 v81, v81, v85
s_add_u32 s48, s75, 8
s_and_b32 s48, s48, 15
s_mul_i32 s48, s48, s57
s_add_u32 m0, s71, 49152
s_nop 0
buffer_load_dwordx4 v28, s[36:39], s48 offen lds
v_add_f32 v82, v82, v86
v_add_f32 v83, v83, v87
s_nop 1
v_permlane32_swap_b32 v80, v81
buffer_load_dwordx4 v29, s[36:39], s48 offen offset:1024 lds
v_permlane32_swap_b32 v82, v83
v_add_f32 v80, v80, v81
v_add_f32 v82, v82, v83
s_nop 1
v_permlane16_swap_b32 v80, v82
s_add_u32 s48, s75, 9
s_and_b32 s48, s48, 15
s_mul_i32 s48, s48, s57
s_add_u32 m0, s71, 57344
s_nop 0
buffer_load_dwordx4 v28, s[36:39], s48 offen lds
s_nop 0
v_add_f32 v80, v80, v82
v_cmp_u_f32 vcc, v80, v80
s_cbranch_vccnz again_52
summed_53:
buffer_load_dwordx4 v29, s[36:39], s48 offen offset:1024 lds
v_mul_f32 v44, 0x3a800000, v80
v_mov_b32 v45, v44
s_nop 1
v_permlane16_swap_b32 v44, v45
s_add_u32 s48, s75, 10
s_and_b32 s48, s48, 15
s_mul_i32 s48, s48, s57
s_add_u32 m0, s71, 65536
s_nop 0
buffer_load_dwordx4 v28, s[36:39], s48 offen lds
s_nop 0
v_fma_f32 v45, -v44, v44, v45
v_max_f32 v45, 0, v45
v_add_f32 v45, 0x3727c5ac, v45
v_rsq_f32 v46, v45
buffer_load_dwordx4 v29, s[36:39], s48 offen offset:1024 lds
v_sub_f32 v47, 0, v44
ds_write_b32 v50, v47 offset:512
ds_write_b64 v49, v[46:47]
ds_write_b32 v50, v46
s_setprio 0
s_waitcnt lgkmcnt(0)
s_waitcnt vmcnt(63)
s_barrier
s_waitcnt vmcnt(5)
s_add_u32 s48, s75, 11
s_and_b32 s48, s48, 15
s_mul_i32 s48, s48, s57
s_add_u32 m0, s71, 73728
s_nop 0
buffer_load_dwordx4 v28, s[36:39], s48 offen lds
buffer_load_dwordx4 v29, s[36:39], s48 offen offset:1024 lds
s_waitcnt vmcnt(5)
s_add_u32 s48, s75, 12
s_and_b32 s48, s48, 15
s_mul_i32 s48, s48, s57
s_add_u32 m0, s71, 81920
s_nop 0
buffer_load_dwordx4 v28, s[36:39], s48 offen lds
buffer_load_dwordx4 v29, s[36:39], s48 offen offset:1024 lds
s_waitcnt vmcnt(5)
s_add_u32 s48, s75, 13
s_and_b32 s48, s48, 15
s_mul_i32 s48, s48, s57
s_add_u32 m0, s71, 90112
s_nop 0
buffer_load_dwordx4 v28, s[36:39], s48 offen lds
buffer_load_dwordx4 v29, s[36:39], s48 offen offset:1024 lds
s_waitcnt vmcnt(5)
s_add_u32 s48, s75, 14
s_and_b32 s48, s48, 15
s_mul_i32 s48, s48, s57
s_add_u32 m0, s71, 98304
s_nop 0
buffer_load_dwordx4 v28, s[36:39], s48 offen lds
buffer_load_dwordx4 v29, s[36:39], s48 offen offset:1024 lds
s_waitcnt vmcnt(5)
s_add_u32 s48, s75, 0
s_and_b32 s48, s48, 15
s_mul_i32 s48, s48, s57
s_add_u32 m0, s71, 4294950912
s_nop 0
buffer_load_dwordx4 v28, s[36:39], s48 offen lds
buffer_load_dwordx4 v29, s[36:39], s48 offen offset:1024 lds
s_waitcnt vmcnt(5)
s_add_u32 s48, s75, 1
s_and_b32 s48, s48, 15
s_mul_i32 s48, s48, s57
s_add_u32 m0, s71, 4294959104
s_nop 0
buffer_load_dwordx4 v28, s[36:39], s48 offen lds
buffer_load_dwordx4 v29, s[36:39], s48 offen offset:1024 lds
s_waitcnt vmcnt(5)
s_add_u32 s48, s75, 2
s_and_b32 s48, s48, 15
s_mul_i32 s48, s48, s57
s_add_u32 m0, s71, 0
s_nop 0
buffer_load_dwordx4 v28, s[36:39], s48 offen lds
buffer_load_dwordx4 v29, s[36:39], s48 offen offset:1024 lds
s_waitcnt vmcnt(5)
s_add_u32 s48, s75, 3
s_and_b32 s48, s48, 15
s_mul_i32 s48, s48, s57
s_add_u32 m0, s71, 8192
s_nop 0
buffer_load_dwordx4 v28, s[36:39], s48 offen lds
buffer_load_dwordx4 v29, s[36:39], s48 offen offset:1024 lds
s_waitcnt vmcnt(5)
s_add_u32 s48, s75, 4
s_and_b32 s48, s48, 15
s_mul_i32 s48, s48, s57
s_add_u32 m0, s71, 16384
s_nop 0
buffer_load_dwordx4 v28, s[36:39], s48 offen lds
buffer_load_dwordx4 v29, s[36:39], s48 offen offset:1024 lds
s_waitcnt vmcnt(5)
buffer_load_dwordx4 v[40:43], v18, s[32:35], s81 offen offset:0 sc1
buffer_load_dwordx4 v[40:43], v18, s[32:35], s81 offen offset:1024 sc1
s_waitcnt vmcnt(5)
buffer_load_dwordx4 v[40:43], v18, s[32:35], s82 offen offset:0 sc1
buffer_load_dwordx4 v[40:43], v18, s[32:35], s82 offen offset:1024 sc1
s_waitcnt vmcnt(0) lgkmcnt(0)
s_barrier
L_end:
s_endpgm
L_compute:
s_lshr_b32 s48, s2, 2
s_and_b32 s48, s48, 1
s_lshl_b32 s48, s48, 1
s_add_u32 s48, s48, s74
s_and_b32 s49, s42, 3
s_xor_b32 s77, s48, s49
s_add_u32 s77, s77, 4
s_lshr_b32 s48, s77, 2
s_add_u32 s48, s47, s48
s_and_b32 s48, s48, 3
s_and_b32 s49, s77, 3
s_lshl_b32 s49, s49, 2
s_add_u32 s78, s48, s49
s_and_b32 s48, s2, 7
s_lshl_b32 s48, s48, 1
s_add_u32 s75, s78, s48
s_and_b32 s75, s75, 15
s_mov_b32 s46, 0
s_waitcnt lgkmcnt(0)
s_mov_b32 s32, s22
s_and_b32 s33, s23, 0xffff
s_mov_b32 s34, 268435456
s_mov_b32 s35, 0x00020000
s_mov_b32 s24, s18
s_and_b32 s25, s19, 0xffff
s_mov_b32 s26, 4194304
s_mov_b32 s27, 0x00020000
s_setprio 1
s_and_b32 s43, s40, 1
s_lshr_b32 s44, s40, 1
s_lshl_b32 s45, s42, 1
s_add_u32 s45, s45, s43
s_cmp_lg_u32 s40, 1
s_cbranch_scc1 else_57
s_getpc_b64 s[48:49]
L_pc:
s_sub_u32 s48, s48, L_pc - interleave_layers__sliding_local_dilated__linear_kernel_hedgehog__prompt_kernel
s_subb_u32 s49, s49, 0
s_lshr_b32 s50, s2, 3
s_lshl_b32 s50, s50, 12
v_lshl_add_u32 v8, v0, 6, s50
v_cmp_gt_u32 vcc, L_code_end - interleave_layers__sliding_local_dilated__linear_kernel_hedgehog__prompt_kernel, v8
s_and_saveexec_b64 s[50:51], vcc
s_cbranch_execz nopf_59
global_load_dword v254, v8, s[48:49]
nopf_59:
s_mov_b64 exec, -1
else_57:
s_lshl_b32 s48, s41, 3
s_lshl_b32 s49, s44, 2
s_add_u32 s48, s48, s49
s_lshl_b32 s48, s48, 5
s_add_u32 s48, s48, s45
s_lshl_b32 s48, s48, 10
s_add_u32 s80, s48, 4194304
s_add_u32 s81, s80, 32768
s_add_u32 s82, s80, 65536
s_add_u32 s83, s80, 98304
s_lshl_b32 s84, s41, 2
s_add_u32 s84, s84, s44
s_lshl_b32 s84, s84, 7
s_add_u32 s84, s84, 18350080
s_lshl_b32 s48, s41, 3
s_lshl_b32 s49, s40, 1
s_add_u32 s48, s48, s49
s_lshl_b32 s48, s48, 15
s_lshl_b32 s49, s78, 11
s_add_u32 s85, s48, s49
s_add_u32 s86, s85, 32768
s_lshl_b32 s50, s41, 2
s_add_u32 s50, s50, s40
s_lshl_b32 s50, s50, 4
s_add_u32 s50, s50, s42
s_lshl_b32 s50, s50, 8
s_add_u32 s87, s50, 16777216
s_lshl_b32 s88, s41, 2
s_add_u32 s88, s88, s40
s_lshl_b32 s88, s88, 7
s_add_u32 s88, s88, 18358272
v_lshrrev_b32 v4, 1, v3
v_lshl_add_u32 v4, v2, 2, v4
v_and_b32 v5, 1, v3
v_lshl_add_u32 v4, v5, 1, v4
v_lshlrev_b32 v1, 2, v4
s_lshl_b32 s48, s40, 2
s_add_u32 s48, s48, 134672
v_mov_b32 v10, s48
v_mov_b32 v11, 0
ds_write_b32 v10, v11
v_mov_b32 v140, -1
v_mov_b32 v141, -1
v_mov_b32 v142, -1
v_mov_b32 v143, -1
s_lshl_b32 s50, s42, 2
s_add_u32 s50, s50, s40
s_lshl_b32 s50, s50, 4
s_add_u32 s50, s50, s41
s_lshl_b32 s50, s50, 8
s_add_u32 s50, s50, 17825792
v_mov_b32 v4, s87
v_mov_b32 v5, s50
v_cmp_eq_u32 vcc, 0, v3
v_lshrrev_b32 v6, 1, v3
v_mul_u32_u24 v6, 262144, v6
v_add_u32 v5, v5, v6
v_cndmask_b32 v4, v5, v4, vcc
v_lshl_add_u32 v4, v2, 4, v4
buffer_store_dwordx4 v[140:143], v4, s[32:35], 0 offen sc1
s_lshl_b32 s48, s2, 2
s_add_u32 s49, s48, s40
s_lshl_b32 s48, s49, 10
s_add_u32 s48, s48, 8388608
buffer_store_dwordx4 v[140:143], v18, s[32:35], s48 offen sc1
s_and_b32 s48, s49, 7
s_cmp_lg_u32 s48, 0
s_cbranch_scc1 nofl_60
s_lshl_b32 s48, s49, 5
s_add_u32 s48, s48, 18350080
v_lshlrev_b32 v6, 2, v0
buffer_store_dword v11, v6, s[32:35], s48 offen sc1
nofl_60:
s_lshl_b32 s49, s44, 13
v_lshrrev_b32 v4, 1, v2
v_xor_b32 v4, v4, v3
v_lshlrev_b32 v4, 4, v4
v_lshl_add_u32 v10, v2, 7, v4
v_add_u32 v10, s49, v10
v_xor_b32 v11, 64, v10
s_lshl_b32 s48, s43, 1
v_lshrrev_b32 v4, 2, v2
v_and_b32 v5, 3, v0
v_lshl_add_u32 v6, v3, 3, v4
v_lshlrev_b32 v6, 7, v6
v_lshl_add_u32 v6, v5, 3, v6
v_lshrrev_b32 v7, 1, v4
v_and_b32 v8, 1, v3
v_lshl_add_u32 v7, v8, 1, v7
v_xor_b32 v7, s48, v7
v_lshl_add_u32 v12, v7, 5, v6
v_add_u32 v12, 16384, v12
v_xor_b32 v13, 32, v12
v_mov_b32 v14, v10
v_mov_b32 v15, v11
v_add_u32 v16, 0, v12
v_add_u32 v17, 0, v13
v_mov_b32 v156, 0
v_mov_b32 v157, 0
v_mov_b32 v158, 0
v_mov_b32 v159, 0
v_mov_b32 v160, 0
v_mov_b32 v161, 0
v_mov_b32 v162, 0
v_mov_b32 v163, 0
v_mov_b32 v164, 0
v_mov_b32 v165, 0
v_mov_b32 v166, 0
v_mov_b32 v167, 0
v_mov_b32 v168, 0
v_mov_b32 v169, 0
v_mov_b32 v170, 0
v_mov_b32 v171, 0
v_mov_b32 v172, 0
v_mov_b32 v173, 0
v_mov_b32 v174, 0
v_mov_b32 v175, 0
v_mov_b32 v176, 0
v_mov_b32 v177, 0
v_mov_b32 v178, 0
v_mov_b32 v179, 0
v_mov_b32 v180, 0
v_mov_b32 v181, 0
v_mov_b32 v182, 0
v_mov_b32 v183, 0
v_mov_b32 v184, 0
v_mov_b32 v185, 0
v_mov_b32 v186, 0
v_mov_b32 v187, 0
v_mov_b32 v188, 0
v_mov_b32 v189, 0
v_mov_b32 v190, 0
v_mov_b32 v191, 0
v_mov_b32 v192, 0
v_mov_b32 v193, 0
v_mov_b32 v194, 0
v_mov_b32 v195, 0
v_mov_b32 v196, 0
v_mov_b32 v197, 0
v_mov_b32 v198, 0
v_mov_b32 v199, 0
v_mov_b32 v200, 0
v_mov_b32 v201, 0
v_mov_b32 v202, 0
v_mov_b32 v203, 0
v_mov_b32 v204, 0
v_mov_b32 v205, 0
v_mov_b32 v206, 0
v_mov_b32 v207, 0
v_mov_b32 v208, 0
v_mov_b32 v209, 0
v_mov_b32 v210, 0
v_mov_b32 v211, 0
v_mov_b32 v212, 0
v_mov_b32 v213, 0
v_mov_b32 v214, 0
v_mov_b32 v215, 0
v_mov_b32 v216, 0
v_mov_b32 v217, 0
v_mov_b32 v218, 0
v_mov_b32 v219, 0
v_mov_b32 v220, 0
v_mov_b32 v221, 0
v_mov_b32 v222, 0
v_mov_b32 v223, 0
v_mov_b32 v224, 0
v_mov_b32 v225, 0
v_mov_b32 v226, 0
v_mov_b32 v227, 0
v_mov_b32 v228, 0
v_mov_b32 v229, 0
v_mov_b32 v230, 0
v_mov_b32 v231, 0
v_mov_b32 v232, 0
v_mov_b32 v233, 0
v_mov_b32 v234, 0
v_mov_b32 v235, 0
v_mov_b32 v236, 0
v_mov_b32 v237, 0
v_mov_b32 v238, 0
v_mov_b32 v239, 0
v_mov_b32 v240, 0
v_mov_b32 v241, 0
v_mov_b32 v242, 0
v_mov_b32 v243, 0
v_mov_b32 v244, 0
v_mov_b32 v245, 0
v_mov_b32 v246, 0
v_mov_b32 v247, 0
v_mov_b32 v248, 0
v_mov_b32 v249, 0
v_mov_b32 v250, 0
v_mov_b32 v251, 0
v_mov_b32 v48, 0x3f803f80
v_mov_b32 v49, 0x3f803f80
v_mov_b32 v50, 0x3f803f80
v_mov_b32 v51, 0x3f803f80
s_mov_b32 s48, 0xf149f2ca
v_mov_b32 v9, s48
v_lshlrev_b32 v4, 2, v3
v_sub_u32 v4, v2, v4
v_subrev_u32 v5, 0, v4
v_and_b32 v6, 0x80000001, v5
v_cmp_eq_u32 vcc, 0, v6
v_add_u32 v5, 1, v5
v_and_b32 v6, 0x80000001, v5
v_cndmask_b32 v40, v9, 0, vcc
v_cmp_eq_u32 vcc, 0x80000001, v6
s_nop 1
v_cndmask_b32 v36, v9, 0, vcc
v_subrev_u32 v5, 1, v4
v_and_b32 v6, 0x80000001, v5
v_cmp_eq_u32 vcc, 0, v6
v_add_u32 v5, 1, v5
v_and_b32 v6, 0x80000001, v5
v_cndmask_b32 v41, v9, 0, vcc
v_cmp_eq_u32 vcc, 0x80000001, v6
s_nop 1
v_cndmask_b32 v37, v9, 0, vcc
v_subrev_u32 v5, 2, v4
v_and_b32 v6, 0x80000001, v5
v_cmp_eq_u32 vcc, 0, v6
v_add_u32 v5, 1, v5
v_and_b32 v6, 0x80000001, v5
v_cndmask_b32 v42, v9, 0, vcc
v_cmp_eq_u32 vcc, 0x80000001, v6
s_nop 1
v_cndmask_b32 v38, v9, 0, vcc
v_subrev_u32 v5, 3, v4
v_and_b32 v6, 0x80000001, v5
v_cmp_eq_u32 vcc, 0, v6
v_add_u32 v5, 1, v5
v_and_b32 v6, 0x80000001, v5
v_cndmask_b32 v43, v9, 0, vcc
v_cmp_eq_u32 vcc, 0x80000001, v6
s_nop 1
v_cndmask_b32 v39, v9, 0, vcc
s_or_b32 s48, s41, s44
s_cmp_eq_u32 s48, 0
s_cselect_b64 vcc, -1, 0
v_cndmask_b32 v44, v36, v9, vcc
v_cndmask_b32 v45, v37, v9, vcc
v_cndmask_b32 v46, v38, v9, vcc
v_cndmask_b32 v47, v39, v9, vcc
v_and_b32 v4, 1, v2
v_lshlrev_b32 v4, 4, v4
v_mov_b32 v5, 0xffff
v_lshlrev_b32 v52, v4, v5
s_lshl_b32 s48, s43, 11
s_add_u32 s48, s48, 135168
v_add_u32 v53, s48, v18
v_lshl_add_u32 v55, v0, 3, s48
s_add_u32 s48, s41, s44
s_sub_u32 s48, s48, 1
s_lshl_b32 s49, s48, 1
s_add_u32 s49, s49, s43
s_lshl_b32 s49, s49, 11
s_mul_i32 s50, s42, 65536
s_add_u32 s49, s49, s50
s_add_u32 s49, s49, 8388608
s_cmp_lt_i32 s48, 0
s_cselect_b32 s49, 0xf0000000, s49
v_add_u32 v58, s49, v18
v_lshl_add_u32 v59, v0, 3, s49
s_lshl_b32 s48, s43, 2
s_add_u32 s48, s48, 134672
v_mov_b32 v19, s48
s_lshl_b32 s48, s43, 7
s_add_u32 s48, s48, 133120
v_lshl_add_u32 v7, v3, 4, s48
v_lshl_add_u32 v54, v2, 2, s48
s_lshl_b32 s49, s44, 6
v_add_u32 v8, s49, v2
v_lshlrev_b32 v8, 3, v8
v_add_u32 v8, 131072, v8
v_lshl_add_u32 v9, v3, 2, s49
v_lshlrev_b32 v9, 2, v9
v_add_u32 v9, 132096, v9
s_mov_b32 s64, 0
s_mov_b32 s65, 0
s_mov_b32 s66, 0x3e8293ee
s_mov_b32 s61, 1
s_lshl_b32 s50, s42, 2
s_add_u32 s50, s50, s40
s_lshl_b32 s50, s50, 4
s_add_u32 s50, s50, s41
s_lshl_b32 s50, s50, 8
s_add_u32 s52, s50, 17825792
v_lshrrev_b32 v4, 1, v2
v_lshrrev_b32 v5, 1, v3
v_xor_b32 v4, v4, v5
v_lshlrev_b32 v4, 4, v4
v_and_b32 v5, 1, v3
v_lshl_add_u32 v4, v5, 3, v4
v_lshl_add_u32 v4, v2, 7, v4
s_lshl_b32 s48, s40, 12
v_add_u32 v155, s48, v4
v_mov_b32 v152, 0
v_mov_b32 v153, 0
v_mov_b32 v56, 0
v_mov_b32 v57, 0
s_waitcnt vmcnt(0)
s_lshl_b32 s79, 1, s77
s_or_b32 s79, s79, 0
s_barrier
ds_read_b128 v[60:63], v14 offset:0
ds_read_b128 v[64:67], v14 offset:2048
ds_read_b128 v[68:71], v14 offset:4096
ds_read_b128 v[72:75], v14 offset:6144
ds_read_b64_tr_b16 v[84:85], v16 offset:8192
ds_read_b64_tr_b16 v[86:87], v16 offset:8704
ds_read_b64_tr_b16 v[88:89], v17 offset:8192
ds_read_b64_tr_b16 v[90:91], v17 offset:8704
ds_read_b64_tr_b16 v[92:93], v16 offset:16384
ds_read_b64_tr_b16 v[94:95], v16 offset:16896
ds_read_b64_tr_b16 v[96:97], v17 offset:16384
ds_read_b64_tr_b16 v[98:99], v17 offset:16896
ds_read_b64_tr_b16 v[76:77], v16 offset:0
ds_read_b64_tr_b16 v[78:79], v16 offset:512
ds_read_b64_tr_b16 v[80:81], v17 offset:0
ds_read_b64_tr_b16 v[82:83], v17 offset:512
s_waitcnt lgkmcnt(0)
c0_loop:
v_mfma_f32_16x16x32_bf16 v[212:215], v[84:87], v[72:75], v[212:215]
ds_read_b128 v[100:103], v15 offset:0
v_mfma_f32_16x16x32_bf16 v[204:207], v[84:87], v[68:71], v[204:207]
ds_read_b128 v[104:107], v15 offset:2048
v_mfma_f32_16x16x32_bf16 v[196:199], v[84:87], v[64:67], v[196:199]
ds_read_b128 v[108:111], v15 offset:4096
v_mfma_f32_16x16x32_bf16 v[188:191], v[84:87], v[60:63], v[188:191]
ds_read_b128 v[112:115], v15 offset:6144
v_mfma_f32_16x16x32_bf16 v[192:195], v[88:91], v[60:63], v[192:195]
ds_read_b64_tr_b16 v[124:125], v16 offset:12288
v_mfma_f32_16x16x32_bf16 v[200:203], v[88:91], v[64:67], v[200:203]
ds_read_b64_tr_b16 v[126:127], v16 offset:12800
v_mfma_f32_16x16x32_bf16 v[208:211], v[88:91], v[68:71], v[208:211]
ds_read_b64_tr_b16 v[128:129], v17 offset:12288
v_mfma_f32_16x16x32_bf16 v[216:219], v[88:91], v[72:75], v[216:219]
ds_read_b64_tr_b16 v[130:131], v17 offset:12800
v_mfma_f32_16x16x32_bf16 v[244:247], v[72:75], v[92:95], v[244:247]
ds_read_b64_tr_b16 v[132:133], v16 offset:20480
v_mfma_f32_16x16x32_bf16 v[248:251], v[72:75], v[96:99], v[248:251]
ds_read_b64_tr_b16 v[134:135], v16 offset:20992
v_mfma_f32_16x16x32_bf16 v[240:243], v[68:71], v[96:99], v[240:243]
ds_read_b64_tr_b16 v[136:137], v17 offset:20480
v_mfma_f32_16x16x32_bf16 v[236:239], v[68:71], v[92:95], v[236:239]
ds_read_b64_tr_b16 v[138:139], v17 offset:20992
v_mfma_f32_16x16x32_bf16 v[228:231], v[64:67], v[92:95], v[228:231]
ds_read_b64_tr_b16 v[116:117], v16 offset:4096
v_mfma_f32_16x16x32_bf16 v[232:235], v[64:67], v[96:99], v[232:235]
ds_read_b64_tr_b16 v[118:119], v16 offset:4608
v_mfma_f32_16x16x32_bf16 v[224:227], v[60:63], v[96:99], v[224:227]
ds_read_b64_tr_b16 v[120:121], v17 offset:4096
v_mfma_f32_16x16x32_bf16 v[220:223], v[60:63], v[92:95], v[220:223]
ds_read_b64_tr_b16 v[122:123], v17 offset:4608
v_mfma_f32_16x16x32_bf16 v[156:159], v[76:79], v[60:63], v[156:159]
s_bitcmp1_b32 s79, s64
s_cbranch_scc1 c0_hook
c0_hook_ret:
v_mfma_f32_16x16x32_bf16 v[164:167], v[76:79], v[64:67], v[164:167]
s_add_u32 s65, s65, 40960
s_cmp_eq_u32 s65, 122880
v_mfma_f32_16x16x32_bf16 v[172:175], v[76:79], v[68:71], v[172:175]
s_cselect_b32 s65, 0, s65
s_add_u32 s64, s64, 1
v_mfma_f32_16x16x32_bf16 v[180:183], v[76:79], v[72:75], v[180:183]
v_add_u32 v14, s65, v10
v_add_u32 v15, s65, v11
v_mfma_f32_16x16x32_bf16 v[184:187], v[80:83], v[72:75], v[184:187]
v_add_u32 v16, s65, v12
v_add_u32 v17, s65, v13
v_mfma_f32_16x16x32_bf16 v[176:179], v[80:83], v[68:71], v[176:179]
s_cmp_eq_u32 s64, 16
s_cbranch_scc1 c0_last
v_mfma_f32_16x16x32_bf16 v[168:171], v[80:83], v[64:67], v[168:171]
s_waitcnt lgkmcnt(0)
v_mfma_f32_16x16x32_bf16 v[160:163], v[80:83], v[60:63], v[160:163]
s_barrier
v_mfma_f32_16x16x32_bf16 v[212:215], v[124:127], v[112:115], v[212:215]
ds_read_b128 v[60:63], v14 offset:0
v_mfma_f32_16x16x32_bf16 v[204:207], v[124:127], v[108:111], v[204:207]
ds_read_b128 v[64:67], v14 offset:2048
v_mfma_f32_16x16x32_bf16 v[196:199], v[124:127], v[104:107], v[196:199]
ds_read_b128 v[68:71], v14 offset:4096
v_mfma_f32_16x16x32_bf16 v[188:191], v[124:127], v[100:103], v[188:191]
ds_read_b128 v[72:75], v14 offset:6144
v_mfma_f32_16x16x32_bf16 v[192:195], v[128:131], v[100:103], v[192:195]
ds_read_b64_tr_b16 v[84:85], v16 offset:8192
v_mfma_f32_16x16x32_bf16 v[200:203], v[128:131], v[104:107], v[200:203]
ds_read_b64_tr_b16 v[86:87], v16 offset:8704
v_mfma_f32_16x16x32_bf16 v[208:211], v[128:131], v[108:111], v[208:211]
ds_read_b64_tr_b16 v[88:89], v17 offset:8192
v_mfma_f32_16x16x32_bf16 v[216:219], v[128:131], v[112:115], v[216:219]
ds_read_b64_tr_b16 v[90:91], v17 offset:8704
v_mfma_f32_16x16x32_bf16 v[244:247], v[112:115], v[132:135], v[244:247]
ds_read_b64_tr_b16 v[92:93], v16 offset:16384
v_mfma_f32_16x16x32_bf16 v[248:251], v[112:115], v[136:139], v[248:251]
ds_read_b64_tr_b16 v[94:95], v16 offset:16896
v_mfma_f32_16x16x32_bf16 v[240:243], v[108:111], v[136:139], v[240:243]
ds_read_b64_tr_b16 v[96:97], v17 offset:16384
v_mfma_f32_16x16x32_bf16 v[236:239], v[108:111], v[132:135], v[236:239]
ds_read_b64_tr_b16 v[98:99], v17 offset:16896
v_mfma_f32_16x16x32_bf16 v[228:231], v[104:107], v[132:135], v[228:231]
ds_read_b64_tr_b16 v[76:77], v16 offset:0
v_mfma_f32_16x16x32_bf16 v[232:235], v[104:107], v[136:139], v[232:235]
ds_read_b64_tr_b16 v[78:79], v16 offset:512
v_mfma_f32_16x16x32_bf16 v[224:227], v[100:103], v[136:139], v[224:227]
ds_read_b64_tr_b16 v[80:81], v17 offset:0
v_mfma_f32_16x16x32_bf16 v[220:223], v[100:103], v[132:135], v[220:223]
ds_read_b64_tr_b16 v[82:83], v17 offset:512
v_mfma_f32_16x16x32_bf16 v[156:159], v[116:119], v[100:103], v[156:159]
v_mfma_f32_16x16x32_bf16 v[164:167], v[116:119], v[104:107], v[164:167]
v_mfma_f32_16x16x32_bf16 v[172:175], v[116:119], v[108:111], v[172:175]
v_mfma_f32_16x16x32_bf16 v[180:183], v[116:119], v[112:115], v[180:183]
v_mfma_f32_16x16x32_bf16 v[184:187], v[120:123], v[112:115], v[184:187]
v_mfma_f32_16x16x32_bf16 v[176:179], v[120:123], v[108:111], v[176:179]
v_mfma_f32_16x16x32_bf16 v[168:171], v[120:123], v[104:107], v[168:171]
s_waitcnt lgkmcnt(0)
v_mfma_f32_16x16x32_bf16 v[160:163], v[120:123], v[100:103], v[160:163]
s_branch c0_loop
c0_hook:
v_add_u32 v4, s65, v155
ds_read_b64 v[20:21], v4 offset:0
ds_read_b64 v[28:29], v4 offset:2048
v_xor_b32 v5, 32, v4
ds_read_b64 v[22:23], v5 offset:0
ds_read_b64 v[30:31], v5 offset:2048
v_xor_b32 v5, 64, v4
ds_read_b64 v[24:25], v5 offset:0
ds_read_b64 v[32:33], v5 offset:2048
v_xor_b32 v5, 96, v4
ds_read_b64 v[26:27], v5 offset:0
ds_read_b64 v[34:35], v5 offset:2048
s_waitcnt lgkmcnt(8)
s_cmp_lg_u32 s44, 0
s_cbranch_scc1 else_61
v_mfma_f32_16x16x32_bf16 v[140:143], v[48:51], v[76:79], 0
v_mfma_f32_16x16x32_bf16 v[144:147], v[48:51], v[84:87], 0
v_mfma_f32_16x16x32_bf16 v[148:151], v[48:51], v[92:95], 0
v_mfma_f32_16x16x32_bf16 v[140:143], v[48:51], v[116:119], v[140:143]
v_mfma_f32_16x16x32_bf16 v[144:147], v[48:51], v[124:127], v[144:147]
v_mfma_f32_16x16x32_bf16 v[148:151], v[48:51], v[132:135], v[148:151]
s_branch fi_62
else_61:
v_mfma_f32_16x16x32_bf16 v[140:143], v[48:51], v[80:83], 0
v_mfma_f32_16x16x32_bf16 v[144:147], v[48:51], v[88:91], 0
v_mfma_f32_16x16x32_bf16 v[148:151], v[48:51], v[96:99], 0
v_mfma_f32_16x16x32_bf16 v[140:143], v[48:51], v[120:123], v[140:143]
v_mfma_f32_16x16x32_bf16 v[144:147], v[48:51], v[128:131], v[144:147]
v_mfma_f32_16x16x32_bf16 v[148:151], v[48:51], v[136:139], v[148:151]
fi_62:
s_waitcnt lgkmcnt(0)
v_dot2c_f32_bf16 v152, v20, v48
v_dot2c_f32_bf16 v56, v20, v20
v_dot2c_f32_bf16 v153, v28, v48
v_dot2c_f32_bf16 v57, v28, v28
v_dot2c_f32_bf16 v152, v21, v48
v_dot2c_f32_bf16 v56, v21, v21
v_dot2c_f32_bf16 v153, v29, v48
v_dot2c_f32_bf16 v57, v29, v29
v_dot2c_f32_bf16 v152, v22, v48
v_dot2c_f32_bf16 v56, v22, v22
v_dot2c_f32_bf16 v153, v30, v48
v_dot2c_f32_bf16 v57, v30, v30
v_dot2c_f32_bf16 v152, v23, v48
v_dot2c_f32_bf16 v56, v23, v23
v_dot2c_f32_bf16 v153, v31, v48
v_dot2c_f32_bf16 v57, v31, v31
v_dot2c_f32_bf16 v152, v24, v48
v_dot2c_f32_bf16 v56, v24, v24
v_dot2c_f32_bf16 v153, v32, v48
v_dot2c_f32_bf16 v57, v32, v32
v_dot2c_f32_bf16 v152, v25, v48
v_dot2c_f32_bf16 v56, v25, v25
v_dot2c_f32_bf16 v153, v33, v48
v_dot2c_f32_bf16 v57, v33, v33
v_dot2c_f32_bf16 v152, v26, v48
v_dot2c_f32_bf16 v56, v26, v26
v_dot2c_f32_bf16 v153, v34, v48
v_dot2c_f32_bf16 v57, v34, v34
v_dot2c_f32_bf16 v152, v27, v48
v_dot2c_f32_bf16 v56, v27, v27
v_dot2c_f32_bf16 v153, v35, v48
v_dot2c_f32_bf16 v57, v35, v35
v_cmp_eq_u32 vcc, 0, v3
v_cmp_eq_u32 s[48:49], 1, v3
s_nop 1
v_cndmask_b32 v4, v148, v144, s[48:49]
v_cndmask_b32 v4, v4, v140, vcc
buffer_store_dword v4, v1, s[32:35], s52 offen sc1
s_nop 1
v_permlane32_swap_b32 v152, v153
v_permlane32_swap_b32 v56, v57
v_add_f32 v152, v152, v153
v_add_f32 v56, v56, v57
s_nop 1
v_permlane16_swap_b32 v152, v56
s_nop 0
v_add_f32 v152, v152, v56
buffer_store_dword v152, v1, s[32:35], s87 offen sc1
s_branch c0_hook_ret
c0_last:
v_mfma_f32_16x16x32_bf16 v[168:171], v[80:83], v[64:67], v[168:171]
s_waitcnt lgkmcnt(0)
v_mfma_f32_16x16x32_bf16 v[160:163], v[80:83], v[60:63], v[160:163]
v_mfma_f32_16x16x32_bf16 v[212:215], v[124:127], v[112:115], v[212:215]
v_mfma_f32_16x16x32_bf16 v[204:207], v[124:127], v[108:111], v[204:207]
v_mfma_f32_16x16x32_bf16 v[196:199], v[124:127], v[104:107], v[196:199]
v_mfma_f32_16x16x32_bf16 v[188:191], v[124:127], v[100:103], v[188:191]
v_mfma_f32_16x16x32_bf16 v[192:195], v[128:131], v[100:103], v[192:195]
v_mfma_f32_16x16x32_bf16 v[200:203], v[128:131], v[104:107], v[200:203]
v_mfma_f32_16x16x32_bf16 v[208:211], v[128:131], v[108:111], v[208:211]
v_mfma_f32_16x16x32_bf16 v[216:219], v[128:131], v[112:115], v[216:219]
s_barrier
v_mfma_f32_16x16x32_bf16 v[244:247], v[112:115], v[132:135], v[244:247]
ds_read_b128 v[140:143], v7 offset:0
ds_read_b128 v[144:147], v7 offset:64
v_mfma_f32_16x16x32_bf16 v[248:251], v[112:115], v[136:139], v[248:251]
ds_read_b128 v[148:151], v7 offset:256
ds_read_b128 v[152:155], v7 offset:320
v_mfma_f32_16x16x32_bf16 v[240:243], v[108:111], v[136:139], v[240:243]
ds_read_b64 v[92:93], v8 offset:0
ds_read_b64 v[94:95], v8 offset:128
v_mfma_f32_16x16x32_bf16 v[236:239], v[108:111], v[132:135], v[236:239]
ds_read_b64 v[96:97], v8 offset:256
ds_read_b64 v[98:99], v8 offset:384
v_mfma_f32_16x16x32_bf16 v[228:231], v[104:107], v[132:135], v[228:231]
ds_read2_b32 v[56:57], v54 offset0:128 offset1:144
ds_read_b128 v[60:63], v9 offset:0
v_mfma_f32_16x16x32_bf16 v[232:235], v[104:107], v[136:139], v[232:235]
ds_read_b128 v[64:67], v9 offset:64
v_mfma_f32_16x16x32_bf16 v[224:227], v[100:103], v[136:139], v[224:227]
ds_read_b128 v[68:71], v9 offset:128
v_mfma_f32_16x16x32_bf16 v[220:223], v[100:103], v[132:135], v[220:223]
ds_read_b128 v[72:75], v9 offset:192
v_mfma_f32_16x16x32_bf16 v[156:159], v[116:119], v[100:103], v[156:159]
ds_read_b128 v[76:79], v9 offset:512
v_mfma_f32_16x16x32_bf16 v[164:167], v[116:119], v[104:107], v[164:167]
ds_read_b128 v[80:83], v9 offset:576
v_mfma_f32_16x16x32_bf16 v[172:175], v[116:119], v[108:111], v[172:175]
ds_read_b128 v[84:87], v9 offset:640
v_mfma_f32_16x16x32_bf16 v[180:183], v[116:119], v[112:115], v[180:183]
ds_read_b128 v[88:91], v9 offset:704
v_mfma_f32_16x16x32_bf16 v[184:187], v[120:123], v[112:115], v[184:187]
v_mov_b32 v6, 134656
ds_read_b32 v6, v6
v_mfma_f32_16x16x32_bf16 v[176:179], v[120:123], v[108:111], v[176:179]
v_mfma_f32_16x16x32_bf16 v[168:171], v[120:123], v[104:107], v[168:171]
v_mfma_f32_16x16x32_bf16 v[160:163], v[120:123], v[100:103], v[160:163]
c0_epi:
s_waitcnt lgkmcnt(0)
v_readfirstlane_b32 s46, v6
.p2align 3
v_pk_fma_f32 v[212:213], v[148:149], v[98:99], v[212:213] op_sel:[0,1,0] op_sel_hi:[1,1,1]
v_pk_fma_f32 v[214:215], v[150:151], v[98:99], v[214:215] op_sel:[0,1,0] op_sel_hi:[1,1,1]
v_pk_fma_f32 v[216:217], v[152:153], v[98:99], v[216:217] op_sel:[0,1,0] op_sel_hi:[1,1,1]
v_pk_fma_f32 v[218:219], v[154:155], v[98:99], v[218:219] op_sel:[0,1,0] op_sel_hi:[1,1,1]
v_pk_mul_f32 v[212:213], v[212:213], v[98:99] op_sel:[0,0] op_sel_hi:[1,0]
v_pk_mul_f32 v[214:215], v[214:215], v[98:99] op_sel:[0,0] op_sel_hi:[1,0]
v_pk_mul_f32 v[216:217], v[216:217], v[98:99] op_sel:[0,0] op_sel_hi:[1,0]
v_pk_mul_f32 v[218:219], v[218:219], v[98:99] op_sel:[0,0] op_sel_hi:[1,0]
v_cvt_pk_bf16_f32 v212, v212, v213
v_cvt_pk_bf16_f32 v213, v214, v215
v_cvt_pk_bf16_f32 v214, v216, v217
v_cvt_pk_bf16_f32 v215, v218, v219
v_pk_fma_f32 v[244:245], v[88:89], v[56:57], v[244:245] op_sel:[0,0,0] op_sel_hi:[1,0,1]
v_pk_fma_f32 v[246:247], v[90:91], v[56:57], v[246:247] op_sel:[0,0,0] op_sel_hi:[1,0,1]
v_pk_mul_f32 v[244:245], v[244:245], v[72:73]
v_pk_mul_f32 v[246:247], v[246:247], v[74:75]
v_cvt_pk_bf16_f32 v108, v244, v245
v_cvt_pk_bf16_f32 v109, v246, v247
v_pk_fma_f32 v[248:249], v[88:89], v[56:57], v[248:249] op_sel:[0,1,0] op_sel_hi:[1,1,1]
v_pk_fma_f32 v[250:251], v[90:91], v[56:57], v[250:251] op_sel:[0,1,0] op_sel_hi:[1,1,1]
v_pk_mul_f32 v[248:249], v[248:249], v[72:73]
v_pk_mul_f32 v[250:251], v[250:251], v[74:75]
v_cvt_pk_bf16_f32 v118, v248, v249
v_cvt_pk_bf16_f32 v119, v250, v251
s_cmp_lg_u32 s44, 1
s_cbranch_scc1 else_63
buffer_store_dwordx4 v[212:215], v58, s[32:35], 0 offen sc1
buffer_store_dwordx2 v[108:109], v59, s[32:35], 0 offen offset:1024 sc1
buffer_store_dwordx2 v[118:119], v59, s[32:35], 0 offen offset:1536 sc1
s_branch fi_64
else_63:
ds_write_b128 v53, v[212:215]
ds_write_b64 v55, v[108:109] offset:1024
ds_write_b64 v55, v[118:119] offset:1536
v_mov_b32 v4, 1
ds_write_b32 v19, v4
fi_64:
.p2align 3
v_pk_fma_f32 v[188:189], v[148:149], v[92:93], v[188:189] op_sel:[0,1,0] op_sel_hi:[1,1,1]
v_pk_fma_f32 v[196:197], v[148:149], v[94:95], v[196:197] op_sel:[0,1,0] op_sel_hi:[1,1,1]
v_pk_fma_f32 v[204:205], v[148:149], v[96:97], v[204:205] op_sel:[0,1,0] op_sel_hi:[1,1,1]
v_pk_fma_f32 v[164:165], v[140:141], v[94:95], v[164:165] op_sel:[0,1,0] op_sel_hi:[1,1,1]
v_pk_fma_f32 v[172:173], v[140:141], v[96:97], v[172:173] op_sel:[0,1,0] op_sel_hi:[1,1,1]
v_pk_fma_f32 v[180:181], v[140:141], v[98:99], v[180:181] op_sel:[0,1,0] op_sel_hi:[1,1,1]
v_pk_fma_f32 v[190:191], v[150:151], v[92:93], v[190:191] op_sel:[0,1,0] op_sel_hi:[1,1,1]
v_pk_mul_f32 v[188:189], v[188:189], v[92:93] op_sel:[0,0] op_sel_hi:[1,0]
v_pk_fma_f32 v[198:199], v[150:151], v[94:95], v[198:199] op_sel:[0,1,0] op_sel_hi:[1,1,1]
v_pk_mul_f32 v[196:197], v[196:197], v[94:95] op_sel:[0,0] op_sel_hi:[1,0]
v_pk_fma_f32 v[206:207], v[150:151], v[96:97], v[206:207] op_sel:[0,1,0] op_sel_hi:[1,1,1]
v_pk_mul_f32 v[204:205], v[204:205], v[96:97] op_sel:[0,0] op_sel_hi:[1,0]
v_pk_fma_f32 v[166:167], v[142:143], v[94:95], v[166:167] op_sel:[0,1,0] op_sel_hi:[1,1,1]
v_cvt_pk_bf16_f32 v164, v164, v165
v_pk_fma_f32 v[174:175], v[142:143], v[96:97], v[174:175] op_sel:[0,1,0] op_sel_hi:[1,1,1]
v_cvt_pk_bf16_f32 v172, v172, v173
v_pk_fma_f32 v[182:183], v[142:143], v[98:99], v[182:183] op_sel:[0,1,0] op_sel_hi:[1,1,1]
v_cvt_pk_bf16_f32 v180, v180, v181
v_pk_fma_f32 v[192:193], v[152:153], v[92:93], v[192:193] op_sel:[0,1,0] op_sel_hi:[1,1,1]
v_pk_fma_f32 v[194:195], v[154:155], v[92:93], v[194:195] op_sel:[0,1,0] op_sel_hi:[1,1,1]
v_pk_mul_f32 v[190:191], v[190:191], v[92:93] op_sel:[0,0] op_sel_hi:[1,0]
v_cvt_pk_bf16_f32 v188, v188, v189
v_pk_fma_f32 v[200:201], v[152:153], v[94:95], v[200:201] op_sel:[0,1,0] op_sel_hi:[1,1,1]
v_pk_fma_f32 v[202:203], v[154:155], v[94:95], v[202:203] op_sel:[0,1,0] op_sel_hi:[1,1,1]
v_pk_mul_f32 v[198:199], v[198:199], v[94:95] op_sel:[0,0] op_sel_hi:[1,0]
v_cvt_pk_bf16_f32 v196, v196, v197
v_pk_fma_f32 v[208:209], v[152:153], v[96:97], v[208:209] op_sel:[0,1,0] op_sel_hi:[1,1,1]
v_pk_fma_f32 v[210:211], v[154:155], v[96:97], v[210:211] op_sel:[0,1,0] op_sel_hi:[1,1,1]
v_pk_mul_f32 v[206:207], v[206:207], v[96:97] op_sel:[0,0] op_sel_hi:[1,0]
v_cvt_pk_bf16_f32 v204, v204, v205
v_pk_fma_f32 v[168:169], v[144:145], v[94:95], v[168:169] op_sel:[0,1,0] op_sel_hi:[1,1,1]
v_pk_fma_f32 v[170:171], v[146:147], v[94:95], v[170:171] op_sel:[0,1,0] op_sel_hi:[1,1,1]
v_cvt_pk_bf16_f32 v165, v166, v167
v_pk_fma_f32 v[176:177], v[144:145], v[96:97], v[176:177] op_sel:[0,1,0] op_sel_hi:[1,1,1]
v_pk_fma_f32 v[178:179], v[146:147], v[96:97], v[178:179] op_sel:[0,1,0] op_sel_hi:[1,1,1]
v_cvt_pk_bf16_f32 v173, v174, v175
v_pk_fma_f32 v[184:185], v[144:145], v[98:99], v[184:185] op_sel:[0,1,0] op_sel_hi:[1,1,1]
v_pk_fma_f32 v[186:187], v[146:147], v[98:99], v[186:187] op_sel:[0,1,0] op_sel_hi:[1,1,1]
v_cvt_pk_bf16_f32 v181, v182, v183
v_pk_mul_f32 v[192:193], v[192:193], v[92:93] op_sel:[0,0] op_sel_hi:[1,0]
v_pk_mul_f32 v[194:195], v[194:195], v[92:93] op_sel:[0,0] op_sel_hi:[1,0]
v_cvt_pk_bf16_f32 v189, v190, v191
v_pk_mul_f32 v[200:201], v[200:201], v[94:95] op_sel:[0,0] op_sel_hi:[1,0]
v_pk_mul_f32 v[202:203], v[202:203], v[94:95] op_sel:[0,0] op_sel_hi:[1,0]
v_cvt_pk_bf16_f32 v197, v198, v199
v_pk_mul_f32 v[208:209], v[208:209], v[96:97] op_sel:[0,0] op_sel_hi:[1,0]
v_pk_mul_f32 v[210:211], v[210:211], v[96:97] op_sel:[0,0] op_sel_hi:[1,0]
v_cvt_pk_bf16_f32 v205, v206, v207
v_cvt_pk_bf16_f32 v166, v168, v169
v_cvt_pk_bf16_f32 v167, v170, v171
v_cvt_pk_bf16_f32 v174, v176, v177
v_cvt_pk_bf16_f32 v175, v178, v179
v_cvt_pk_bf16_f32 v182, v184, v185
v_cvt_pk_bf16_f32 v183, v186, v187
v_cvt_pk_bf16_f32 v190, v192, v193
v_cvt_pk_bf16_f32 v191, v194, v195
v_mfma_f32_16x16x32_bf16 v[216:219], v[212:215], v[180:183], v[40:43]
v_cvt_pk_bf16_f32 v198, v200, v201
v_cvt_pk_bf16_f32 v199, v202, v203
v_mfma_f32_16x16x32_bf16 v[168:171], v[188:191], v[164:167], v[36:39]
v_cvt_pk_bf16_f32 v206, v208, v209
v_cvt_pk_bf16_f32 v207, v210, v211
v_mfma_f32_16x16x32_bf16 v[200:203], v[196:199], v[164:167], v[40:43]
v_mul_f32 v124, s66, v92
v_mul_f32 v125, s66, v94
v_mfma_f32_16x16x32_bf16 v[208:211], v[204:207], v[172:175], v[40:43]
v_mul_f32 v126, s66, v96
v_mul_f32 v127, s66, v98
v_mfma_f32_16x16x32_bf16 v[176:179], v[196:199], v[172:175], v[36:39]
v_max_f32 v164, v168, v169
v_max_f32 v165, v170, v171
v_mfma_f32_16x16x32_bf16 v[184:187], v[204:207], v[180:183], v[36:39]
v_max_f32 v166, v200, v201
v_max_f32 v182, v216, v217
v_max_f32 v174, v208, v209
v_max_f32 v167, v202, v203
v_max3_f32 v129, v164, v165, v166
v_pk_fma_f32 v[156:157], v[140:141], v[92:93], v[156:157] op_sel:[0,1,0] op_sel_hi:[1,1,1]
v_pk_fma_f32 v[158:159], v[142:143], v[92:93], v[158:159] op_sel:[0,1,0] op_sel_hi:[1,1,1]
v_cvt_pk_bf16_f32 v156, v156, v157
v_pk_fma_f32 v[160:161], v[144:145], v[92:93], v[160:161] op_sel:[0,1,0] op_sel_hi:[1,1,1]
v_pk_fma_f32 v[162:163], v[146:147], v[92:93], v[162:163] op_sel:[0,1,0] op_sel_hi:[1,1,1]
v_cvt_pk_bf16_f32 v157, v158, v159
v_cvt_pk_bf16_f32 v158, v160, v161
v_cvt_pk_bf16_f32 v159, v162, v163
v_pk_fma_f32 v[220:221], v[76:77], v[56:57], v[220:221] op_sel:[0,0,0] op_sel_hi:[1,0,1]
v_pk_fma_f32 v[222:223], v[78:79], v[56:57], v[222:223] op_sel:[0,0,0] op_sel_hi:[1,0,1]
v_mfma_f32_16x16x32_bf16 v[192:195], v[188:191], v[156:159], v[40:43]
v_max_f32 v172, v176, v177
v_max_f32 v173, v178, v179
v_max_f32 v180, v184, v185
v_max_f32 v181, v186, v187
v_max_f32_e64 v175, v210, v211
v_pk_fma_f32 v[224:225], v[76:77], v[56:57], v[224:225] op_sel:[0,1,0] op_sel_hi:[1,1,1]
v_pk_fma_f32 v[226:227], v[78:79], v[56:57], v[226:227] op_sel:[0,1,0] op_sel_hi:[1,1,1]
v_pk_fma_f32 v[228:229], v[80:81], v[56:57], v[228:229] op_sel:[0,0,0] op_sel_hi:[1,0,1]
v_pk_fma_f32 v[230:231], v[82:83], v[56:57], v[230:231] op_sel:[0,0,0] op_sel_hi:[1,0,1]
v_pk_fma_f32 v[232:233], v[80:81], v[56:57], v[232:233] op_sel:[0,1,0] op_sel_hi:[1,1,1]
v_pk_fma_f32 v[234:235], v[82:83], v[56:57], v[234:235] op_sel:[0,1,0] op_sel_hi:[1,1,1]
v_pk_fma_f32 v[236:237], v[84:85], v[56:57], v[236:237] op_sel:[0,0,0] op_sel_hi:[1,0,1]
v_pk_fma_f32 v[238:239], v[86:87], v[56:57], v[238:239] op_sel:[0,0,0] op_sel_hi:[1,0,1]
v_pk_fma_f32 v[240:241], v[84:85], v[56:57], v[240:241] op_sel:[0,1,0] op_sel_hi:[1,1,1]
v_pk_fma_f32 v[242:243], v[86:87], v[56:57], v[242:243] op_sel:[0,1,0] op_sel_hi:[1,1,1]
v_pk_mul_f32 v[220:221], v[220:221], v[60:61]
v_pk_mul_f32 v[222:223], v[222:223], v[62:63]
v_pk_mul_f32 v[224:225], v[224:225], v[60:61]
s_cmp_lg_u32 s44, 0
s_cbranch_scc1 else_65
buffer_load_dwordx4 v[120:123], v58, s[32:35], 0 offen sc1
buffer_load_dwordx2 v[100:101], v59, s[32:35], 0 offen offset:1024 sc1
buffer_load_dwordx2 v[110:111], v59, s[32:35], 0 offen offset:1536 sc1
else_65:
v_pk_mul_f32 v[226:227], v[226:227], v[62:63]
v_pk_mul_f32 v[228:229], v[228:229], v[64:65]
v_pk_mul_f32 v[230:231], v[230:231], v[66:67]
v_pk_mul_f32 v[232:233], v[232:233], v[64:65]
v_pk_mul_f32 v[234:235], v[234:235], v[66:67]
v_pk_mul_f32 v[236:237], v[236:237], v[68:69]
v_pk_mul_f32 v[238:239], v[238:239], v[70:71]
v_pk_mul_f32 v[240:241], v[240:241], v[68:69]
v_pk_mul_f32 v[242:243], v[242:243], v[70:71]
v_max3_f32 v130, v172, v173, v174
v_max_f32_e64 v183, v218, v219
v_max3_f32 v131, v180, v181, v182
v_cvt_pk_bf16_f32 v102, v220, v221
v_cvt_pk_bf16_f32 v103, v222, v223
v_cvt_pk_bf16_f32 v112, v224, v225
v_cvt_pk_bf16_f32 v113, v226, v227
v_cvt_pk_bf16_f32 v104, v228, v229
v_cvt_pk_bf16_f32 v105, v230, v231
v_cvt_pk_bf16_f32 v114, v232, v233
v_cvt_pk_bf16_f32 v115, v234, v235
v_cvt_pk_bf16_f32 v106, v236, v237
v_cvt_pk_bf16_f32 v107, v238, v239
v_cvt_pk_bf16_f32 v116, v240, v241
v_cvt_pk_bf16_f32 v117, v242, v243
v_max_f32 v129, v129, v167
v_max_f32 v130, v130, v175
v_max_f32 v131, v131, v183
s_cmp_lg_u32 s44, 0
s_cbranch_scc1 else_67
s_mov_b32 s63, 0
sent_69:
s_waitcnt vmcnt(0)
v_max_u32 v4, v120, v121
v_max3_u32 v4, v4, v122, v123
v_max3_u32 v4, v4, v100, v101
v_max3_u32 v4, v4, v110, v111
v_cmp_eq_u32 vcc, -1, v4
s_cbranch_vccz sentd_70
buffer_load_dwordx4 v[120:123], v58, s[32:35], 0 offen sc1
buffer_load_dwordx2 v[100:101], v59, s[32:35], 0 offen offset:1024 sc1
buffer_load_dwordx2 v[110:111], v59, s[32:35], 0 offen offset:1536 sc1
s_add_u32 s63, s63, 1
s_cmp_lt_u32 s63, 0x80000
s_cbranch_scc1 sent_69
s_waitcnt vmcnt(0)
sentd_70:
v_mov_b32 v132, -1
v_mov_b32 v133, -1
v_mov_b32 v134, -1
v_mov_b32 v135, -1
buffer_store_dwordx4 v[132:135], v58, s[32:35], 0 offen offset:0 sc1
buffer_store_dwordx4 v[132:135], v58, s[32:35], 0 offen offset:1024 sc1
s_branch fi_68
else_67:
s_mov_b32 s63, 0
px_71:
ds_read_b32 v4, v19
ds_read_b128 v[120:123], v53
ds_read_b64 v[100:101], v55 offset:1024
ds_read_b64 v[110:111], v55 offset:1536
s_add_u32 s63, s63, 1
s_cmp_lt_u32 s63, 0x400000
s_waitcnt lgkmcnt(0)
v_cmp_ne_u32 vcc, 1, v4
s_cbranch_vccz pxd_72
s_cbranch_scc1 px_71
pxd_72:
fi_68:
s_cmp_eq_u32 s46, 0
s_cbranch_scc1 slow_73
.p2align 3
v_mfma_f32_16x16x32_bf16 v[160:163], v[120:123], v[156:159], v[44:47]
v_max_f32 v158, v192, v193
v_max_f32 v159, v194, v195
v_permlane32_swap_b32 v130, v131
s_nop 0
v_max_f32 v130, v130, v131
s_nop 2
v_max_f32 v156, v160, v161
v_max_f32 v157, v162, v163
v_max3_f32 v128, v156, v157, v158
v_max_f32 v128, v128, v159
s_nop 1
v_permlane32_swap_b32 v128, v129
s_nop 0
v_max_f32 v128, v128, v129
s_nop 1
v_permlane16_swap_b32 v128, v130
s_nop 0
v_max_f32 v128, v128, v130
v_mov_b32 v130, v128
s_nop 1
v_permlane16_swap_b32 v128, v130
s_nop 0
v_mov_b32 v129, v128
v_mov_b32 v131, v130
s_nop 0
v_permlane32_swap_b32 v128, v129
v_permlane32_swap_b32 v130, v131
v_mul_f32 v128, v128, v124
v_mul_f32 v129, v129, v125
v_pk_fma_f32 v[156:157], v[156:157], v[124:125], v[128:129] op_sel:[0,0,0] op_sel_hi:[1,0,0] neg_lo:[0,0,1] neg_hi:[0,0,1]
v_pk_fma_f32 v[158:159], v[158:159], v[124:125], v[128:129] op_sel:[0,0,0] op_sel_hi:[1,0,0] neg_lo:[0,0,1] neg_hi:[0,0,1]
v_mul_f32 v130, v130, v126
v_mul_f32 v131, v131, v127
v_exp_f32 v156, v156
v_exp_f32 v157, v157
v_exp_f32 v158, v158
v_exp_f32 v159, v159
v_pk_fma_f32 v[164:165], v[164:165], v[124:125], v[128:129] op_sel:[0,1,1] op_sel_hi:[1,1,1] neg_lo:[0,0,1] neg_hi:[0,0,1]
v_pk_fma_f32 v[166:167], v[166:167], v[124:125], v[128:129] op_sel:[0,1,1] op_sel_hi:[1,1,1] neg_lo:[0,0,1] neg_hi:[0,0,1]
v_exp_f32 v164, v164
v_exp_f32 v165, v165
v_exp_f32 v166, v166
v_exp_f32 v167, v167
v_pk_fma_f32 v[172:173], v[172:173], v[126:127], v[130:131] op_sel:[0,0,0] op_sel_hi:[1,0,0] neg_lo:[0,0,1] neg_hi:[0,0,1]
v_pk_fma_f32 v[174:175], v[174:175], v[126:127], v[130:131] op_sel:[0,0,0] op_sel_hi:[1,0,0] neg_lo:[0,0,1] neg_hi:[0,0,1]
v_cvt_pk_bf16_f32 v156, v156, v156
v_cvt_pk_bf16_f32 v157, v157, v157
v_cvt_pk_bf16_f32 v158, v158, v158
v_cvt_pk_bf16_f32 v159, v159, v159
v_exp_f32 v172, v172
v_exp_f32 v173, v173
v_exp_f32 v174, v174
v_exp_f32 v175, v175
v_pk_fma_f32 v[180:181], v[180:181], v[126:127], v[130:131] op_sel:[0,1,1] op_sel_hi:[1,1,1] neg_lo:[0,0,1] neg_hi:[0,0,1]
v_pk_fma_f32 v[182:183], v[182:183], v[126:127], v[130:131] op_sel:[0,1,1] op_sel_hi:[1,1,1] neg_lo:[0,0,1] neg_hi:[0,0,1]
v_and_b32 v156, v52, v156
v_and_b32 v157, v52, v157
v_and_b32 v158, v52, v158
v_and_b32 v159, v52, v159
v_cvt_pk_bf16_f32 v164, v164, v164
v_cvt_pk_bf16_f32 v165, v165, v165
v_mfma_f32_16x16x32_bf16 v[160:163], v[48:51], v[156:159], 0
v_cvt_pk_bf16_f32 v166, v166, v166
v_cvt_pk_bf16_f32 v167, v167, v167
v_mfma_f32_16x16x32_bf16 v[220:223], v[100:103], v[156:159], 0
v_exp_f32 v180, v180
v_mfma_f32_16x16x32_bf16 v[224:227], v[110:113], v[156:159], 0
v_exp_f32 v181, v181
v_exp_f32 v182, v182
v_exp_f32 v183, v183
v_and_b32 v164, v52, v164
v_and_b32 v165, v52, v165
v_and_b32 v166, v52, v166
v_and_b32 v167, v52, v167
v_cvt_pk_bf16_f32 v172, v172, v172
v_cvt_pk_bf16_f32 v173, v173, v173
v_mfma_f32_16x16x32_bf16 v[168:171], v[48:51], v[164:167], 0
v_cvt_pk_bf16_f32 v174, v174, v174
v_cvt_pk_bf16_f32 v175, v175, v175
v_mfma_f32_16x16x32_bf16 v[228:231], v[102:105], v[164:167], 0
v_and_b32 v172, v52, v172
v_and_b32 v173, v52, v173
v_mfma_f32_16x16x32_bf16 v[232:235], v[112:115], v[164:167], 0
v_and_b32 v174, v52, v174
v_and_b32 v175, v52, v175
v_cvt_pk_bf16_f32 v180, v180, v180
v_cvt_pk_bf16_f32 v181, v181, v181
v_mfma_f32_16x16x32_bf16 v[176:179], v[48:51], v[172:175], 0
v_cvt_pk_bf16_f32 v182, v182, v182
v_cvt_pk_bf16_f32 v183, v183, v183
v_mfma_f32_16x16x32_bf16 v[236:239], v[104:107], v[172:175], 0
v_and_b32 v180, v52, v180
v_and_b32 v181, v52, v181
v_mfma_f32_16x16x32_bf16 v[240:243], v[114:117], v[172:175], 0
v_and_b32 v182, v52, v182
v_and_b32 v183, v52, v183
v_rcp_f32 v160, v160
v_rcp_f32 v168, v168
v_pk_mul_f32 v[220:221], v[220:221], v[160:161] op_sel:[0,0] op_sel_hi:[1,0]
v_pk_mul_f32 v[222:223], v[222:223], v[160:161] op_sel:[0,0] op_sel_hi:[1,0]
v_pk_mul_f32 v[228:229], v[228:229], v[168:169] op_sel:[0,0] op_sel_hi:[1,0]
v_pk_mul_f32 v[224:225], v[224:225], v[160:161] op_sel:[0,0] op_sel_hi:[1,0]
v_pk_mul_f32 v[226:227], v[226:227], v[160:161] op_sel:[0,0] op_sel_hi:[1,0]
v_pk_mul_f32 v[230:231], v[230:231], v[168:169] op_sel:[0,0] op_sel_hi:[1,0]
v_pk_mul_f32 v[232:233], v[232:233], v[168:169] op_sel:[0,0] op_sel_hi:[1,0]
v_pk_mul_f32 v[234:235], v[234:235], v[168:169] op_sel:[0,0] op_sel_hi:[1,0]
v_mfma_f32_16x16x32_bf16 v[184:187], v[48:51], v[180:183], 0
v_rcp_f32_e64 v176, v176
v_cvt_pk_bf16_f32 v220, v220, v221
v_cvt_pk_bf16_f32 v221, v222, v223
v_cvt_pk_bf16_f32 v228, v228, v229
v_pk_mul_f32 v[236:237], v[236:237], v[176:177] op_sel:[0,0] op_sel_hi:[1,0]
v_mfma_f32_16x16x32_bf16 v[244:247], v[106:109], v[180:183], 0
v_cvt_pk_bf16_f32 v222, v224, v225
v_cvt_pk_bf16_f32 v223, v226, v227
v_rcp_f32_e64 v184, v184
v_cvt_pk_bf16_f32 v229, v230, v231
v_pk_mul_f32 v[238:239], v[238:239], v[176:177] op_sel:[0,0] op_sel_hi:[1,0]
v_pk_mul_f32 v[240:241], v[240:241], v[176:177] op_sel:[0,0] op_sel_hi:[1,0]
v_pk_mul_f32 v[242:243], v[242:243], v[176:177] op_sel:[0,0] op_sel_hi:[1,0]
v_cvt_pk_bf16_f32 v236, v236, v237
v_pk_mul_f32 v[244:245], v[244:245], v[184:185] op_sel:[0,0] op_sel_hi:[1,0]
v_pk_mul_f32 v[246:247], v[246:247], v[184:185] op_sel:[0,0] op_sel_hi:[1,0]
v_mfma_f32_16x16x32_bf16 v[248:251], v[116:119], v[180:183], 0
buffer_store_dwordx4 v[220:223], v18, s[32:35], s80 offen sc1
v_cvt_pk_bf16_f32 v230, v232, v233
v_cvt_pk_bf16_f32 v231, v234, v235
v_cvt_pk_bf16_f32 v237, v238, v239
v_cvt_pk_bf16_f32 v244, v244, v245
buffer_store_dwordx4 v[228:231], v18, s[32:35], s81 offen sc1
v_cvt_pk_bf16_f32 v238, v240, v241
v_cvt_pk_bf16_f32 v239, v242, v243
v_pk_mul_f32 v[248:249], v[248:249], v[184:185] op_sel:[0,0] op_sel_hi:[1,0]
v_pk_mul_f32 v[250:251], v[250:251], v[184:185] op_sel:[0,0] op_sel_hi:[1,0]
v_cvt_pk_bf16_f32 v245, v246, v247
buffer_store_dwordx4 v[236:239], v18, s[32:35], s82 offen sc1
v_cvt_pk_bf16_f32 v246, v248, v249
v_cvt_pk_bf16_f32 v247, v250, v251
buffer_store_dwordx4 v[244:247], v18, s[32:35], s83 offen sc1
back_74:
s_barrier
v_and_b32 v36, 31, v0
v_lshlrev_b32 v36, 2, v36
s_lshl_b32 s62, s45, 2
v_mov_b32 v4, s62
v_mov_b32 v5, 1
s_mov_b64 exec, 1
s_waitcnt vmcnt(0)
s_cmp_eq_u32 s46, 0
s_cbranch_scc1 slow_75
buffer_store_dword v5, v4, s[32:35], s84 offen
back_76:
s_mov_b64 exec, -1
v_lshrrev_b32 v4, 2, v2
v_and_b32 v5, 3, v0
v_lshl_add_u32 v6, v3, 3, v4
v_lshlrev_b32 v6, 7, v6
v_lshl_add_u32 v6, v5, 3, v6
v_lshrrev_b32 v7, 1, v4
v_and_b32 v8, 1, v3
v_lshl_add_u32 v7, v8, 1, v7
v_lshl_add_u32 v10, v7, 5, v6
v_xor_b32 v11, 32, v10
v_xor_b32 v12, 64, v10
v_xor_b32 v13, 96, v10
v_add_u32 v14, 0x10000, v10
v_add_u32 v15, 0x10000, v11
v_add_u32 v16, 0x10000, v12
v_add_u32 v17, 0x10000, v13
ds_read_b64_tr_b16 v[220:221], v10 offset:0
ds_read_b64_tr_b16 v[222:223], v10 offset:512
ds_read_b64_tr_b16 v[224:225], v11 offset:0
ds_read_b64_tr_b16 v[226:227], v11 offset:512
ds_read_b64_tr_b16 v[228:229], v12 offset:0
ds_read_b64_tr_b16 v[230:231], v12 offset:512
ds_read_b64_tr_b16 v[232:233], v13 offset:0
ds_read_b64_tr_b16 v[234:235], v13 offset:512
ds_read_b64_tr_b16 v[236:237], v10 offset:4096
ds_read_b64_tr_b16 v[238:239], v10 offset:4608
ds_read_b64_tr_b16 v[240:241], v11 offset:4096
ds_read_b64_tr_b16 v[242:243], v11 offset:4608
ds_read_b64_tr_b16 v[244:245], v12 offset:4096
ds_read_b64_tr_b16 v[246:247], v12 offset:4608
ds_read_b64_tr_b16 v[248:249], v13 offset:4096
ds_read_b64_tr_b16 v[250:251], v13 offset:4608
s_lshl_b32 s48, s41, 3
s_lshl_b32 s49, s40, 1
s_add_u32 s48, s48, s49
s_lshl_b32 s48, s48, 15
s_add_u32 s48, s48, 4194304
v_add_u32 v38, s48, v18
v_add_u32 v39, 32768, v38
s_lshl_b32 s57, s75, 11
s_add_u32 s87, s87, 262144
v_lshlrev_b32 v60, 16, v20
v_and_b32 v61, 0xffff0000, v20
v_lshlrev_b32 v62, 16, v21
v_and_b32 v63, 0xffff0000, v21
v_lshlrev_b32 v64, 16, v22
v_and_b32 v65, 0xffff0000, v22
v_lshlrev_b32 v66, 16, v23
v_and_b32 v67, 0xffff0000, v23
v_lshlrev_b32 v68, 16, v24
v_and_b32 v69, 0xffff0000, v24
v_lshlrev_b32 v70, 16, v25
v_and_b32 v71, 0xffff0000, v25
v_lshlrev_b32 v72, 16, v26
v_and_b32 v73, 0xffff0000, v26
v_lshlrev_b32 v74, 16, v27
v_and_b32 v75, 0xffff0000, v27
v_lshlrev_b32 v76, 16, v28
v_and_b32 v77, 0xffff0000, v28
v_lshlrev_b32 v78, 16, v29
v_and_b32 v79, 0xffff0000, v29
v_lshlrev_b32 v80, 16, v30
v_and_b32 v81, 0xffff0000, v30
v_lshlrev_b32 v82, 16, v31
v_and_b32 v83, 0xffff0000, v31
v_lshlrev_b32 v84, 16, v32
v_and_b32 v85, 0xffff0000, v32
v_lshlrev_b32 v86, 16, v33
v_and_b32 v87, 0xffff0000, v33
v_lshlrev_b32 v88, 16, v34
v_and_b32 v89, 0xffff0000, v34
v_lshlrev_b32 v90, 16, v35
v_and_b32 v91, 0xffff0000, v35
v_mov_b32 v6, 0
v_mov_b32 v7, 0
v_mov_b32 v8, 0
v_mov_b32 v9, 0
s_lshl_b32 s62, s42, 2
v_mov_b32 v4, s62
v_mov_b32 v5, 1
buffer_load_dword v37, v36, s[32:35], s84 offen sc1
s_mov_b32 s63, 0
s_waitcnt vmcnt(0)
poll_77:
v_cmp_gt_u32 vcc, 1, v37
s_cbranch_vccz polled_78
buffer_load_dword v37, v36, s[32:35], s84 offen sc1
s_add_u32 s63, s63, 1
s_cmp_lt_u32 s63, 0x80000
s_waitcnt vmcnt(0)
s_cbranch_scc1 poll_77
polled_78:
s_getpc_b64 s[94:95]
pc_79:
s_add_u32 s94, s94, R_oloop_end - pc_79
s_addc_u32 s95, s95, 0
R_oloop:
buffer_load_dwordx4 v[156:159], v38, s[32:35], s57 offen sc1
buffer_load_dwordx4 v[160:163], v39, s[32:35], s57 offen sc1
buffer_load_dwordx4 v[164:167], v38, s[32:35], s57 offen offset:1024 sc1
buffer_load_dwordx4 v[168:171], v39, s[32:35], s57 offen offset:1024 sc1
s_add_u32 s57, s57, 2048
s_and_b32 s57, s57, 0x7fff
buffer_load_dwordx4 v[172:175], v38, s[32:35], s57 offen sc1
buffer_load_dwordx4 v[176:179], v39, s[32:35], s57 offen sc1
buffer_load_dwordx4 v[180:183], v38, s[32:35], s57 offen offset:1024 sc1
buffer_load_dwordx4 v[184:187], v39, s[32:35], s57 offen offset:1024 sc1
s_add_u32 s57, s57, 2048
s_and_b32 s57, s57, 0x7fff
buffer_load_dwordx4 v[188:191], v38, s[32:35], s57 offen sc1
buffer_load_dwordx4 v[192:195], v39, s[32:35], s57 offen sc1
s_waitcnt vmcnt(8) lgkmcnt(8)
v_mfma_f32_16x16x32_bf16 v[60:63], v[220:223], v[156:159], v[60:63]
buffer_load_dwordx4 v[196:199], v38, s[32:35], s57 offen offset:1024 sc1
v_mfma_f32_16x16x32_bf16 v[76:79], v[220:223], v[160:163], v[76:79]
ds_read_b64_tr_b16 v[100:101], v10 offset:8192
ds_read_b64_tr_b16 v[102:103], v10 offset:8704
v_mfma_f32_16x16x32_bf16 v[80:83], v[224:227], v[160:163], v[80:83]
ds_read_b64_tr_b16 v[104:105], v11 offset:8192
ds_read_b64_tr_b16 v[106:107], v11 offset:8704
v_mfma_f32_16x16x32_bf16 v[64:67], v[224:227], v[156:159], v[64:67]
buffer_load_dwordx4 v[200:203], v39, s[32:35], s57 offen offset:1024 sc1
v_mfma_f32_16x16x32_bf16 v[68:71], v[228:231], v[156:159], v[68:71]
ds_read_b64_tr_b16 v[108:109], v12 offset:8192
ds_read_b64_tr_b16 v[110:111], v12 offset:8704
v_mfma_f32_16x16x32_bf16 v[84:87], v[228:231], v[160:163], v[84:87]
ds_read_b64_tr_b16 v[112:113], v13 offset:8192
ds_read_b64_tr_b16 v[114:115], v13 offset:8704
v_mfma_f32_16x16x32_bf16 v[88:91], v[232:235], v[160:163], v[88:91]
s_add_u32 s57, s57, 2048
s_and_b32 s57, s57, 0x7fff
v_mfma_f32_16x16x32_bf16 v[72:75], v[232:235], v[156:159], v[72:75]
s_waitcnt vmcnt(8) lgkmcnt(8)
v_mfma_f32_16x16x32_bf16 v[60:63], v[236:239], v[164:167], v[60:63]
buffer_load_dwordx4 v[204:207], v38, s[32:35], s57 offen sc1
v_mfma_f32_16x16x32_bf16 v[76:79], v[236:239], v[168:171], v[76:79]
ds_read_b64_tr_b16 v[220:221], v10 offset:12288
ds_read_b64_tr_b16 v[222:223], v10 offset:12800
v_mfma_f32_16x16x32_bf16 v[80:83], v[240:243], v[168:171], v[80:83]
ds_read_b64_tr_b16 v[224:225], v11 offset:12288
ds_read_b64_tr_b16 v[226:227], v11 offset:12800
v_mfma_f32_16x16x32_bf16 v[64:67], v[240:243], v[164:167], v[64:67]
buffer_load_dwordx4 v[208:211], v39, s[32:35], s57 offen sc1
v_mfma_f32_16x16x32_bf16 v[68:71], v[244:247], v[164:167], v[68:71]
ds_read_b64_tr_b16 v[228:229], v12 offset:12288
ds_read_b64_tr_b16 v[230:231], v12 offset:12800
v_mfma_f32_16x16x32_bf16 v[84:87], v[244:247], v[168:171], v[84:87]
ds_read_b64_tr_b16 v[232:233], v13 offset:12288
ds_read_b64_tr_b16 v[234:235], v13 offset:12800
v_mfma_f32_16x16x32_bf16 v[88:91], v[248:251], v[168:171], v[88:91]
v_mfma_f32_16x16x32_bf16 v[72:75], v[248:251], v[164:167], v[72:75]
s_waitcnt vmcnt(8) lgkmcnt(8)
v_mfma_f32_16x16x32_bf16 v[60:63], v[100:103], v[172:175], v[60:63]
buffer_load_dwordx4 v[212:215], v38, s[32:35], s57 offen offset:1024 sc1
v_mfma_f32_16x16x32_bf16 v[76:79], v[100:103], v[176:179], v[76:79]
ds_read_b64_tr_b16 v[236:237], v10 offset:16384
ds_read_b64_tr_b16 v[238:239], v10 offset:16896
v_mfma_f32_16x16x32_bf16 v[80:83], v[104:107], v[176:179], v[80:83]
ds_read_b64_tr_b16 v[240:241], v11 offset:16384
ds_read_b64_tr_b16 v[242:243], v11 offset:16896
v_mfma_f32_16x16x32_bf16 v[64:67], v[104:107], v[172:175], v[64:67]
buffer_load_dwordx4 v[216:219], v39, s[32:35], s57 offen offset:1024 sc1
v_mfma_f32_16x16x32_bf16 v[68:71], v[108:111], v[172:175], v[68:71]
ds_read_b64_tr_b16 v[244:245], v12 offset:16384
ds_read_b64_tr_b16 v[246:247], v12 offset:16896
v_mfma_f32_16x16x32_bf16 v[84:87], v[108:111], v[176:179], v[84:87]
ds_read_b64_tr_b16 v[248:249], v13 offset:16384
ds_read_b64_tr_b16 v[250:251], v13 offset:16896
v_mfma_f32_16x16x32_bf16 v[88:91], v[112:115], v[176:179], v[88:91]
s_add_u32 s57, s57, 2048
s_and_b32 s57, s57, 0x7fff
v_mfma_f32_16x16x32_bf16 v[72:75], v[112:115], v[172:175], v[72:75]
s_waitcnt vmcnt(8) lgkmcnt(8)
v_mfma_f32_16x16x32_bf16 v[60:63], v[220:223], v[180:183], v[60:63]
buffer_load_dwordx4 v[156:159], v38, s[32:35], s57 offen sc1
v_mfma_f32_16x16x32_bf16 v[76:79], v[220:223], v[184:187], v[76:79]
ds_read_b64_tr_b16 v[100:101], v10 offset:20480
ds_read_b64_tr_b16 v[102:103], v10 offset:20992
v_mfma_f32_16x16x32_bf16 v[80:83], v[224:227], v[184:187], v[80:83]
ds_read_b64_tr_b16 v[104:105], v11 offset:20480
ds_read_b64_tr_b16 v[106:107], v11 offset:20992
v_mfma_f32_16x16x32_bf16 v[64:67], v[224:227], v[180:183], v[64:67]
buffer_load_dwordx4 v[160:163], v39, s[32:35], s57 offen sc1
v_mfma_f32_16x16x32_bf16 v[68:71], v[228:231], v[180:183], v[68:71]
ds_read_b64_tr_b16 v[108:109], v12 offset:20480
ds_read_b64_tr_b16 v[110:111], v12 offset:20992
v_mfma_f32_16x16x32_bf16 v[84:87], v[228:231], v[184:187], v[84:87]
ds_read_b64_tr_b16 v[112:113], v13 offset:20480
ds_read_b64_tr_b16 v[114:115], v13 offset:20992
v_mfma_f32_16x16x32_bf16 v[88:91], v[232:235], v[184:187], v[88:91]
v_mfma_f32_16x16x32_bf16 v[72:75], v[232:235], v[180:183], v[72:75]
s_waitcnt vmcnt(8) lgkmcnt(8)
v_mfma_f32_16x16x32_bf16 v[60:63], v[236:239], v[188:191], v[60:63]
buffer_load_dwordx4 v[164:167], v38, s[32:35], s57 offen offset:1024 sc1
v_mfma_f32_16x16x32_bf16 v[76:79], v[236:239], v[192:195], v[76:79]
ds_read_b64_tr_b16 v[220:221], v10 offset:24576
ds_read_b64_tr_b16 v[222:223], v10 offset:25088
v_mfma_f32_16x16x32_bf16 v[80:83], v[240:243], v[192:195], v[80:83]
ds_read_b64_tr_b16 v[224:225], v11 offset:24576
ds_read_b64_tr_b16 v[226:227], v11 offset:25088
v_mfma_f32_16x16x32_bf16 v[64:67], v[240:243], v[188:191], v[64:67]
buffer_load_dwordx4 v[168:171], v39, s[32:35], s57 offen offset:1024 sc1
v_mfma_f32_16x16x32_bf16 v[68:71], v[244:247], v[188:191], v[68:71]
ds_read_b64_tr_b16 v[228:229], v12 offset:24576
ds_read_b64_tr_b16 v[230:231], v12 offset:25088
v_mfma_f32_16x16x32_bf16 v[84:87], v[244:247], v[192:195], v[84:87]
ds_read_b64_tr_b16 v[232:233], v13 offset:24576
ds_read_b64_tr_b16 v[234:235], v13 offset:25088
v_mfma_f32_16x16x32_bf16 v[88:91], v[248:251], v[192:195], v[88:91]
s_add_u32 s57, s57, 2048
s_and_b32 s57, s57, 0x7fff
v_mfma_f32_16x16x32_bf16 v[72:75], v[248:251], v[188:191], v[72:75]
s_waitcnt vmcnt(8) lgkmcnt(8)
v_mfma_f32_16x16x32_bf16 v[60:63], v[100:103], v[196:199], v[60:63]
buffer_load_dwordx4 v[172:175], v38, s[32:35], s57 offen sc1
v_mfma_f32_16x16x32_bf16 v[76:79], v[100:103], v[200:203], v[76:79]
ds_read_b64_tr_b16 v[236:237], v10 offset:28672
ds_read_b64_tr_b16 v[238:239], v10 offset:29184
v_mfma_f32_16x16x32_bf16 v[80:83], v[104:107], v[200:203], v[80:83]
ds_read_b64_tr_b16 v[240:241], v11 offset:28672
ds_read_b64_tr_b16 v[242:243], v11 offset:29184
v_mfma_f32_16x16x32_bf16 v[64:67], v[104:107], v[196:199], v[64:67]
buffer_load_dwordx4 v[176:179], v39, s[32:35], s57 offen sc1
v_mfma_f32_16x16x32_bf16 v[68:71], v[108:111], v[196:199], v[68:71]
ds_read_b64_tr_b16 v[244:245], v12 offset:28672
ds_read_b64_tr_b16 v[246:247], v12 offset:29184
v_mfma_f32_16x16x32_bf16 v[84:87], v[108:111], v[200:203], v[84:87]
ds_read_b64_tr_b16 v[248:249], v13 offset:28672
ds_read_b64_tr_b16 v[250:251], v13 offset:29184
v_mfma_f32_16x16x32_bf16 v[88:91], v[112:115], v[200:203], v[88:91]
v_mfma_f32_16x16x32_bf16 v[72:75], v[112:115], v[196:199], v[72:75]
s_waitcnt vmcnt(8) lgkmcnt(8)
v_mfma_f32_16x16x32_bf16 v[60:63], v[220:223], v[204:207], v[60:63]
buffer_load_dwordx4 v[180:183], v38, s[32:35], s57 offen offset:1024 sc1
v_mfma_f32_16x16x32_bf16 v[76:79], v[220:223], v[208:211], v[76:79]
ds_read_b64_tr_b16 v[100:101], v10 offset:32768
ds_read_b64_tr_b16 v[102:103], v10 offset:33280
v_mfma_f32_16x16x32_bf16 v[80:83], v[224:227], v[208:211], v[80:83]
ds_read_b64_tr_b16 v[104:105], v11 offset:32768
ds_read_b64_tr_b16 v[106:107], v11 offset:33280
v_mfma_f32_16x16x32_bf16 v[64:67], v[224:227], v[204:207], v[64:67]
buffer_load_dwordx4 v[184:187], v39, s[32:35], s57 offen offset:1024 sc1
v_mfma_f32_16x16x32_bf16 v[68:71], v[228:231], v[204:207], v[68:71]
ds_read_b64_tr_b16 v[108:109], v12 offset:32768
ds_read_b64_tr_b16 v[110:111], v12 offset:33280
v_mfma_f32_16x16x32_bf16 v[84:87], v[228:231], v[208:211], v[84:87]
ds_read_b64_tr_b16 v[112:113], v13 offset:32768
ds_read_b64_tr_b16 v[114:115], v13 offset:33280
v_mfma_f32_16x16x32_bf16 v[88:91], v[232:235], v[208:211], v[88:91]
s_add_u32 s57, s57, 2048
s_and_b32 s57, s57, 0x7fff
v_mfma_f32_16x16x32_bf16 v[72:75], v[232:235], v[204:207], v[72:75]
s_waitcnt vmcnt(8) lgkmcnt(8)
v_mfma_f32_16x16x32_bf16 v[60:63], v[236:239], v[212:215], v[60:63]
buffer_load_dwordx4 v[188:191], v38, s[32:35], s57 offen sc1
v_mfma_f32_16x16x32_bf16 v[76:79], v[236:239], v[216:219], v[76:79]
ds_read_b64_tr_b16 v[220:221], v10 offset:36864
ds_read_b64_tr_b16 v[222:223], v10 offset:37376
v_mfma_f32_16x16x32_bf16 v[80:83], v[240:243], v[216:219], v[80:83]
ds_read_b64_tr_b16 v[224:225], v11 offset:36864
ds_read_b64_tr_b16 v[226:227], v11 offset:37376
v_mfma_f32_16x16x32_bf16 v[64:67], v[240:243], v[212:215], v[64:67]
buffer_load_dwordx4 v[192:195], v39, s[32:35], s57 offen sc1
v_mfma_f32_16x16x32_bf16 v[68:71], v[244:247], v[212:215], v[68:71]
ds_read_b64_tr_b16 v[228:229], v12 offset:36864
ds_read_b64_tr_b16 v[230:231], v12 offset:37376
v_mfma_f32_16x16x32_bf16 v[84:87], v[244:247], v[216:219], v[84:87]
ds_read_b64_tr_b16 v[232:233], v13 offset:36864
ds_read_b64_tr_b16 v[234:235], v13 offset:37376
v_mfma_f32_16x16x32_bf16 v[88:91], v[248:251], v[216:219], v[88:91]
v_mfma_f32_16x16x32_bf16 v[72:75], v[248:251], v[212:215], v[72:75]
s_waitcnt vmcnt(8) lgkmcnt(8)
v_mfma_f32_16x16x32_bf16 v[60:63], v[100:103], v[156:159], v[60:63]
buffer_load_dwordx4 v[196:199], v38, s[32:35], s57 offen offset:1024 sc1
v_mfma_f32_16x16x32_bf16 v[76:79], v[100:103], v[160:163], v[76:79]
ds_read_b64_tr_b16 v[236:237], v10 offset:40960
ds_read_b64_tr_b16 v[238:239], v10 offset:41472
v_mfma_f32_16x16x32_bf16 v[80:83], v[104:107], v[160:163], v[80:83]
ds_read_b64_tr_b16 v[240:241], v11 offset:40960
ds_read_b64_tr_b16 v[242:243], v11 offset:41472
v_mfma_f32_16x16x32_bf16 v[64:67], v[104:107], v[156:159], v[64:67]
buffer_load_dwordx4 v[200:203], v39, s[32:35], s57 offen offset:1024 sc1
v_mfma_f32_16x16x32_bf16 v[68:71], v[108:111], v[156:159], v[68:71]
ds_read_b64_tr_b16 v[244:245], v12 offset:40960
ds_read_b64_tr_b16 v[246:247], v12 offset:41472
v_mfma_f32_16x16x32_bf16 v[84:87], v[108:111], v[160:163], v[84:87]
ds_read_b64_tr_b16 v[248:249], v13 offset:40960
ds_read_b64_tr_b16 v[250:251], v13 offset:41472
v_mfma_f32_16x16x32_bf16 v[88:91], v[112:115], v[160:163], v[88:91]
s_add_u32 s57, s57, 2048
s_and_b32 s57, s57, 0x7fff
v_mfma_f32_16x16x32_bf16 v[72:75], v[112:115], v[156:159], v[72:75]
s_waitcnt vmcnt(8) lgkmcnt(8)
v_mfma_f32_16x16x32_bf16 v[60:63], v[220:223], v[164:167], v[60:63]
buffer_load_dwordx4 v[204:207], v38, s[32:35], s57 offen sc1
v_mfma_f32_16x16x32_bf16 v[76:79], v[220:223], v[168:171], v[76:79]
ds_read_b64_tr_b16 v[100:101], v10 offset:45056
ds_read_b64_tr_b16 v[102:103], v10 offset:45568
v_mfma_f32_16x16x32_bf16 v[80:83], v[224:227], v[168:171], v[80:83]
ds_read_b64_tr_b16 v[104:105], v11 offset:45056
ds_read_b64_tr_b16 v[106:107], v11 offset:45568
v_mfma_f32_16x16x32_bf16 v[64:67], v[224:227], v[164:167], v[64:67]
buffer_load_dwordx4 v[208:211], v39, s[32:35], s57 offen sc1
v_mfma_f32_16x16x32_bf16 v[68:71], v[228:231], v[164:167], v[68:71]
ds_read_b64_tr_b16 v[108:109], v12 offset:45056
ds_read_b64_tr_b16 v[110:111], v12 offset:45568
v_mfma_f32_16x16x32_bf16 v[84:87], v[228:231], v[168:171], v[84:87]
ds_read_b64_tr_b16 v[112:113], v13 offset:45056
ds_read_b64_tr_b16 v[114:115], v13 offset:45568
v_mfma_f32_16x16x32_bf16 v[88:91], v[232:235], v[168:171], v[88:91]
v_mfma_f32_16x16x32_bf16 v[72:75], v[232:235], v[164:167], v[72:75]
s_waitcnt vmcnt(8) lgkmcnt(8)
v_mfma_f32_16x16x32_bf16 v[60:63], v[236:239], v[172:175], v[60:63]
buffer_load_dwordx4 v[212:215], v38, s[32:35], s57 offen offset:1024 sc1
v_mfma_f32_16x16x32_bf16 v[76:79], v[236:239], v[176:179], v[76:79]
ds_read_b64_tr_b16 v[220:221], v10 offset:49152
ds_read_b64_tr_b16 v[222:223], v10 offset:49664
v_mfma_f32_16x16x32_bf16 v[80:83], v[240:243], v[176:179], v[80:83]
ds_read_b64_tr_b16 v[224:225], v11 offset:49152
ds_read_b64_tr_b16 v[226:227], v11 offset:49664
v_mfma_f32_16x16x32_bf16 v[64:67], v[240:243], v[172:175], v[64:67]
buffer_load_dwordx4 v[216:219], v39, s[32:35], s57 offen offset:1024 sc1
v_mfma_f32_16x16x32_bf16 v[68:71], v[244:247], v[172:175], v[68:71]
ds_read_b64_tr_b16 v[228:229], v12 offset:49152
ds_read_b64_tr_b16 v[230:231], v12 offset:49664
v_mfma_f32_16x16x32_bf16 v[84:87], v[244:247], v[176:179], v[84:87]
ds_read_b64_tr_b16 v[232:233], v13 offset:49152
ds_read_b64_tr_b16 v[234:235], v13 offset:49664
v_mfma_f32_16x16x32_bf16 v[88:91], v[248:251], v[176:179], v[88:91]
s_add_u32 s57, s57, 2048
s_and_b32 s57, s57, 0x7fff
v_mfma_f32_16x16x32_bf16 v[72:75], v[248:251], v[172:175], v[72:75]
s_waitcnt vmcnt(8) lgkmcnt(8)
v_mfma_f32_16x16x32_bf16 v[60:63], v[100:103], v[180:183], v[60:63]
buffer_load_dwordx4 v[156:159], v38, s[32:35], s57 offen sc1
v_mfma_f32_16x16x32_bf16 v[76:79], v[100:103], v[184:187], v[76:79]
ds_read_b64_tr_b16 v[236:237], v10 offset:53248
ds_read_b64_tr_b16 v[238:239], v10 offset:53760
v_mfma_f32_16x16x32_bf16 v[80:83], v[104:107], v[184:187], v[80:83]
ds_read_b64_tr_b16 v[240:241], v11 offset:53248
ds_read_b64_tr_b16 v[242:243], v11 offset:53760
v_mfma_f32_16x16x32_bf16 v[64:67], v[104:107], v[180:183], v[64:67]
buffer_load_dwordx4 v[160:163], v39, s[32:35], s57 offen sc1
v_mfma_f32_16x16x32_bf16 v[68:71], v[108:111], v[180:183], v[68:71]
ds_read_b64_tr_b16 v[244:245], v12 offset:53248
ds_read_b64_tr_b16 v[246:247], v12 offset:53760
v_mfma_f32_16x16x32_bf16 v[84:87], v[108:111], v[184:187], v[84:87]
ds_read_b64_tr_b16 v[248:249], v13 offset:53248
ds_read_b64_tr_b16 v[250:251], v13 offset:53760
v_mfma_f32_16x16x32_bf16 v[88:91], v[112:115], v[184:187], v[88:91]
v_mfma_f32_16x16x32_bf16 v[72:75], v[112:115], v[180:183], v[72:75]
s_waitcnt vmcnt(8) lgkmcnt(8)
v_mfma_f32_16x16x32_bf16 v[60:63], v[220:223], v[188:191], v[60:63]
buffer_load_dwordx4 v[164:167], v38, s[32:35], s57 offen offset:1024 sc1
v_mfma_f32_16x16x32_bf16 v[76:79], v[220:223], v[192:195], v[76:79]
ds_read_b64_tr_b16 v[100:101], v10 offset:57344
ds_read_b64_tr_b16 v[102:103], v10 offset:57856
v_mfma_f32_16x16x32_bf16 v[80:83], v[224:227], v[192:195], v[80:83]
ds_read_b64_tr_b16 v[104:105], v11 offset:57344
ds_read_b64_tr_b16 v[106:107], v11 offset:57856
v_mfma_f32_16x16x32_bf16 v[64:67], v[224:227], v[188:191], v[64:67]
buffer_load_dwordx4 v[168:171], v39, s[32:35], s57 offen offset:1024 sc1
v_mfma_f32_16x16x32_bf16 v[68:71], v[228:231], v[188:191], v[68:71]
ds_read_b64_tr_b16 v[108:109], v12 offset:57344
ds_read_b64_tr_b16 v[110:111], v12 offset:57856
v_mfma_f32_16x16x32_bf16 v[84:87], v[228:231], v[192:195], v[84:87]
ds_read_b64_tr_b16 v[112:113], v13 offset:57344
ds_read_b64_tr_b16 v[114:115], v13 offset:57856
v_mfma_f32_16x16x32_bf16 v[88:91], v[232:235], v[192:195], v[88:91]
s_add_u32 s57, s57, 2048
s_and_b32 s57, s57, 0x7fff
v_mfma_f32_16x16x32_bf16 v[72:75], v[232:235], v[188:191], v[72:75]
s_waitcnt vmcnt(8) lgkmcnt(8)
v_mfma_f32_16x16x32_bf16 v[60:63], v[236:239], v[196:199], v[60:63]
buffer_load_dwordx4 v[172:175], v38, s[32:35], s57 offen sc1
v_mfma_f32_16x16x32_bf16 v[76:79], v[236:239], v[200:203], v[76:79]
ds_read_b64_tr_b16 v[220:221], v10 offset:61440
ds_read_b64_tr_b16 v[222:223], v10 offset:61952
v_mfma_f32_16x16x32_bf16 v[80:83], v[240:243], v[200:203], v[80:83]
ds_read_b64_tr_b16 v[224:225], v11 offset:61440
ds_read_b64_tr_b16 v[226:227], v11 offset:61952
v_mfma_f32_16x16x32_bf16 v[64:67], v[240:243], v[196:199], v[64:67]
buffer_load_dwordx4 v[176:179], v39, s[32:35], s57 offen sc1
v_mfma_f32_16x16x32_bf16 v[68:71], v[244:247], v[196:199], v[68:71]
ds_read_b64_tr_b16 v[228:229], v12 offset:61440
ds_read_b64_tr_b16 v[230:231], v12 offset:61952
v_mfma_f32_16x16x32_bf16 v[84:87], v[244:247], v[200:203], v[84:87]
ds_read_b64_tr_b16 v[232:233], v13 offset:61440
ds_read_b64_tr_b16 v[234:235], v13 offset:61952
v_mfma_f32_16x16x32_bf16 v[88:91], v[248:251], v[200:203], v[88:91]
v_mfma_f32_16x16x32_bf16 v[72:75], v[248:251], v[196:199], v[72:75]
s_waitcnt vmcnt(8) lgkmcnt(8)
v_mfma_f32_16x16x32_bf16 v[60:63], v[100:103], v[204:207], v[60:63]
buffer_load_dwordx4 v[180:183], v38, s[32:35], s57 offen offset:1024 sc1
v_mfma_f32_16x16x32_bf16 v[76:79], v[100:103], v[208:211], v[76:79]
ds_read_b64_tr_b16 v[236:237], v14 offset:0
ds_read_b64_tr_b16 v[238:239], v14 offset:512
v_mfma_f32_16x16x32_bf16 v[80:83], v[104:107], v[208:211], v[80:83]
ds_read_b64_tr_b16 v[240:241], v15 offset:0
ds_read_b64_tr_b16 v[242:243], v15 offset:512
v_mfma_f32_16x16x32_bf16 v[64:67], v[104:107], v[204:207], v[64:67]
buffer_load_dwordx4 v[184:187], v39, s[32:35], s57 offen offset:1024 sc1
v_mfma_f32_16x16x32_bf16 v[68:71], v[108:111], v[204:207], v[68:71]
ds_read_b64_tr_b16 v[244:245], v16 offset:0
ds_read_b64_tr_b16 v[246:247], v16 offset:512
v_mfma_f32_16x16x32_bf16 v[84:87], v[108:111], v[208:211], v[84:87]
ds_read_b64_tr_b16 v[248:249], v17 offset:0
ds_read_b64_tr_b16 v[250:251], v17 offset:512
v_mfma_f32_16x16x32_bf16 v[88:91], v[112:115], v[208:211], v[88:91]
s_add_u32 s57, s57, 2048
s_and_b32 s57, s57, 0x7fff
v_mfma_f32_16x16x32_bf16 v[72:75], v[112:115], v[204:207], v[72:75]
s_waitcnt vmcnt(8) lgkmcnt(8)
v_mfma_f32_16x16x32_bf16 v[60:63], v[220:223], v[212:215], v[60:63]
buffer_load_dwordx4 v[188:191], v38, s[32:35], s57 offen sc1
v_mfma_f32_16x16x32_bf16 v[76:79], v[220:223], v[216:219], v[76:79]
ds_read_b64_tr_b16 v[100:101], v14 offset:4096
ds_read_b64_tr_b16 v[102:103], v14 offset:4608
v_mfma_f32_16x16x32_bf16 v[80:83], v[224:227], v[216:219], v[80:83]
ds_read_b64_tr_b16 v[104:105], v15 offset:4096
ds_read_b64_tr_b16 v[106:107], v15 offset:4608
v_mfma_f32_16x16x32_bf16 v[64:67], v[224:227], v[212:215], v[64:67]
buffer_load_dwordx4 v[192:195], v39, s[32:35], s57 offen sc1
v_mfma_f32_16x16x32_bf16 v[68:71], v[228:231], v[212:215], v[68:71]
ds_read_b64_tr_b16 v[108:109], v16 offset:4096
ds_read_b64_tr_b16 v[110:111], v16 offset:4608
v_mfma_f32_16x16x32_bf16 v[84:87], v[228:231], v[216:219], v[84:87]
ds_read_b64_tr_b16 v[112:113], v17 offset:4096
ds_read_b64_tr_b16 v[114:115], v17 offset:4608
v_mfma_f32_16x16x32_bf16 v[88:91], v[232:235], v[216:219], v[88:91]
v_mfma_f32_16x16x32_bf16 v[72:75], v[232:235], v[212:215], v[72:75]
s_waitcnt vmcnt(8) lgkmcnt(8)
v_mfma_f32_16x16x32_bf16 v[60:63], v[236:239], v[156:159], v[60:63]
buffer_load_dwordx4 v[196:199], v38, s[32:35], s57 offen offset:1024 sc1
v_mfma_f32_16x16x32_bf16 v[76:79], v[236:239], v[160:163], v[76:79]
ds_read_b64_tr_b16 v[220:221], v14 offset:8192
ds_read_b64_tr_b16 v[222:223], v14 offset:8704
v_mfma_f32_16x16x32_bf16 v[80:83], v[240:243], v[160:163], v[80:83]
ds_read_b64_tr_b16 v[224:225], v15 offset:8192
ds_read_b64_tr_b16 v[226:227], v15 offset:8704
v_mfma_f32_16x16x32_bf16 v[64:67], v[240:243], v[156:159], v[64:67]
buffer_load_dwordx4 v[200:203], v39, s[32:35], s57 offen offset:1024 sc1
v_mfma_f32_16x16x32_bf16 v[68:71], v[244:247], v[156:159], v[68:71]
ds_read_b64_tr_b16 v[228:229], v16 offset:8192
ds_read_b64_tr_b16 v[230:231], v16 offset:8704
v_mfma_f32_16x16x32_bf16 v[84:87], v[244:247], v[160:163], v[84:87]
ds_read_b64_tr_b16 v[232:233], v17 offset:8192
ds_read_b64_tr_b16 v[234:235], v17 offset:8704
v_mfma_f32_16x16x32_bf16 v[88:91], v[248:251], v[160:163], v[88:91]
s_add_u32 s57, s57, 2048
s_and_b32 s57, s57, 0x7fff
v_mfma_f32_16x16x32_bf16 v[72:75], v[248:251], v[156:159], v[72:75]
s_waitcnt vmcnt(8) lgkmcnt(8)
v_mfma_f32_16x16x32_bf16 v[60:63], v[100:103], v[164:167], v[60:63]
buffer_load_dwordx4 v[204:207], v38, s[32:35], s57 offen sc1
v_mfma_f32_16x16x32_bf16 v[76:79], v[100:103], v[168:171], v[76:79]
ds_read_b64_tr_b16 v[236:237], v14 offset:12288
ds_read_b64_tr_b16 v[238:239], v14 offset:12800
v_mfma_f32_16x16x32_bf16 v[80:83], v[104:107], v[168:171], v[80:83]
ds_read_b64_tr_b16 v[240:241], v15 offset:12288
ds_read_b64_tr_b16 v[242:243], v15 offset:12800
v_mfma_f32_16x16x32_bf16 v[64:67], v[104:107], v[164:167], v[64:67]
buffer_load_dwordx4 v[208:211], v39, s[32:35], s57 offen sc1
v_mfma_f32_16x16x32_bf16 v[68:71], v[108:111], v[164:167], v[68:71]
ds_read_b64_tr_b16 v[244:245], v16 offset:12288
ds_read_b64_tr_b16 v[246:247], v16 offset:12800
v_mfma_f32_16x16x32_bf16 v[84:87], v[108:111], v[168:171], v[84:87]
ds_read_b64_tr_b16 v[248:249], v17 offset:12288
ds_read_b64_tr_b16 v[250:251], v17 offset:12800
v_mfma_f32_16x16x32_bf16 v[88:91], v[112:115], v[168:171], v[88:91]
v_mfma_f32_16x16x32_bf16 v[72:75], v[112:115], v[164:167], v[72:75]
s_waitcnt vmcnt(8) lgkmcnt(8)
v_mfma_f32_16x16x32_bf16 v[60:63], v[220:223], v[172:175], v[60:63]
buffer_load_dwordx4 v[212:215], v38, s[32:35], s57 offen offset:1024 sc1
v_mfma_f32_16x16x32_bf16 v[76:79], v[220:223], v[176:179], v[76:79]
ds_read_b64_tr_b16 v[100:101], v14 offset:16384
ds_read_b64_tr_b16 v[102:103], v14 offset:16896
v_mfma_f32_16x16x32_bf16 v[80:83], v[224:227], v[176:179], v[80:83]
ds_read_b64_tr_b16 v[104:105], v15 offset:16384
ds_read_b64_tr_b16 v[106:107], v15 offset:16896
v_mfma_f32_16x16x32_bf16 v[64:67], v[224:227], v[172:175], v[64:67]
buffer_load_dwordx4 v[216:219], v39, s[32:35], s57 offen offset:1024 sc1
v_mfma_f32_16x16x32_bf16 v[68:71], v[228:231], v[172:175], v[68:71]
ds_read_b64_tr_b16 v[108:109], v16 offset:16384
ds_read_b64_tr_b16 v[110:111], v16 offset:16896
v_mfma_f32_16x16x32_bf16 v[84:87], v[228:231], v[176:179], v[84:87]
ds_read_b64_tr_b16 v[112:113], v17 offset:16384
ds_read_b64_tr_b16 v[114:115], v17 offset:16896
v_mfma_f32_16x16x32_bf16 v[88:91], v[232:235], v[176:179], v[88:91]
s_add_u32 s57, s57, 2048
s_and_b32 s57, s57, 0x7fff
v_mfma_f32_16x16x32_bf16 v[72:75], v[232:235], v[172:175], v[72:75]
s_waitcnt vmcnt(8) lgkmcnt(8)
v_mfma_f32_16x16x32_bf16 v[60:63], v[236:239], v[180:183], v[60:63]
buffer_load_dwordx4 v[156:159], v38, s[32:35], s57 offen sc1
v_mfma_f32_16x16x32_bf16 v[76:79], v[236:239], v[184:187], v[76:79]
ds_read_b64_tr_b16 v[220:221], v14 offset:20480
ds_read_b64_tr_b16 v[222:223], v14 offset:20992
v_mfma_f32_16x16x32_bf16 v[80:83], v[240:243], v[184:187], v[80:83]
ds_read_b64_tr_b16 v[224:225], v15 offset:20480
ds_read_b64_tr_b16 v[226:227], v15 offset:20992
v_mfma_f32_16x16x32_bf16 v[64:67], v[240:243], v[180:183], v[64:67]
buffer_load_dwordx4 v[160:163], v39, s[32:35], s57 offen sc1
v_mfma_f32_16x16x32_bf16 v[68:71], v[244:247], v[180:183], v[68:71]
ds_read_b64_tr_b16 v[228:229], v16 offset:20480
ds_read_b64_tr_b16 v[230:231], v16 offset:20992
v_mfma_f32_16x16x32_bf16 v[84:87], v[244:247], v[184:187], v[84:87]
ds_read_b64_tr_b16 v[232:233], v17 offset:20480
ds_read_b64_tr_b16 v[234:235], v17 offset:20992
v_mfma_f32_16x16x32_bf16 v[88:91], v[248:251], v[184:187], v[88:91]
v_mfma_f32_16x16x32_bf16 v[72:75], v[248:251], v[180:183], v[72:75]
s_waitcnt vmcnt(8) lgkmcnt(8)
v_mfma_f32_16x16x32_bf16 v[60:63], v[100:103], v[188:191], v[60:63]
buffer_load_dwordx4 v[164:167], v38, s[32:35], s57 offen offset:1024 sc1
v_mfma_f32_16x16x32_bf16 v[76:79], v[100:103], v[192:195], v[76:79]
ds_read_b64_tr_b16 v[236:237], v14 offset:24576
ds_read_b64_tr_b16 v[238:239], v14 offset:25088
v_mfma_f32_16x16x32_bf16 v[80:83], v[104:107], v[192:195], v[80:83]
ds_read_b64_tr_b16 v[240:241], v15 offset:24576
ds_read_b64_tr_b16 v[242:243], v15 offset:25088
v_mfma_f32_16x16x32_bf16 v[64:67], v[104:107], v[188:191], v[64:67]
buffer_load_dwordx4 v[168:171], v39, s[32:35], s57 offen offset:1024 sc1
v_mfma_f32_16x16x32_bf16 v[68:71], v[108:111], v[188:191], v[68:71]
ds_read_b64_tr_b16 v[244:245], v16 offset:24576
ds_read_b64_tr_b16 v[246:247], v16 offset:25088
v_mfma_f32_16x16x32_bf16 v[84:87], v[108:111], v[192:195], v[84:87]
ds_read_b64_tr_b16 v[248:249], v17 offset:24576
ds_read_b64_tr_b16 v[250:251], v17 offset:25088
v_mfma_f32_16x16x32_bf16 v[88:91], v[112:115], v[192:195], v[88:91]
s_add_u32 s57, s57, 2048
s_and_b32 s57, s57, 0x7fff
v_mfma_f32_16x16x32_bf16 v[72:75], v[112:115], v[188:191], v[72:75]
s_waitcnt vmcnt(8) lgkmcnt(8)
v_mfma_f32_16x16x32_bf16 v[60:63], v[220:223], v[196:199], v[60:63]
buffer_load_dwordx4 v[172:175], v38, s[32:35], s57 offen sc1
v_mfma_f32_16x16x32_bf16 v[76:79], v[220:223], v[200:203], v[76:79]
ds_read_b64_tr_b16 v[100:101], v14 offset:28672
ds_read_b64_tr_b16 v[102:103], v14 offset:29184
v_mfma_f32_16x16x32_bf16 v[80:83], v[224:227], v[200:203], v[80:83]
ds_read_b64_tr_b16 v[104:105], v15 offset:28672
ds_read_b64_tr_b16 v[106:107], v15 offset:29184
v_mfma_f32_16x16x32_bf16 v[64:67], v[224:227], v[196:199], v[64:67]
buffer_load_dwordx4 v[176:179], v39, s[32:35], s57 offen sc1
v_mfma_f32_16x16x32_bf16 v[68:71], v[228:231], v[196:199], v[68:71]
ds_read_b64_tr_b16 v[108:109], v16 offset:28672
ds_read_b64_tr_b16 v[110:111], v16 offset:29184
v_mfma_f32_16x16x32_bf16 v[84:87], v[228:231], v[200:203], v[84:87]
ds_read_b64_tr_b16 v[112:113], v17 offset:28672
ds_read_b64_tr_b16 v[114:115], v17 offset:29184
v_mfma_f32_16x16x32_bf16 v[88:91], v[232:235], v[200:203], v[88:91]
v_mfma_f32_16x16x32_bf16 v[72:75], v[232:235], v[196:199], v[72:75]
s_waitcnt vmcnt(8) lgkmcnt(8)
v_mfma_f32_16x16x32_bf16 v[60:63], v[236:239], v[204:207], v[60:63]
buffer_load_dwordx4 v[180:183], v38, s[32:35], s57 offen offset:1024 sc1
v_mfma_f32_16x16x32_bf16 v[76:79], v[236:239], v[208:211], v[76:79]
ds_read_b64_tr_b16 v[220:221], v14 offset:32768
ds_read_b64_tr_b16 v[222:223], v14 offset:33280
v_mfma_f32_16x16x32_bf16 v[80:83], v[240:243], v[208:211], v[80:83]
ds_read_b64_tr_b16 v[224:225], v15 offset:32768
ds_read_b64_tr_b16 v[226:227], v15 offset:33280
v_mfma_f32_16x16x32_bf16 v[64:67], v[240:243], v[204:207], v[64:67]
buffer_load_dwordx4 v[184:187], v39, s[32:35], s57 offen offset:1024 sc1
v_mfma_f32_16x16x32_bf16 v[68:71], v[244:247], v[204:207], v[68:71]
ds_read_b64_tr_b16 v[228:229], v16 offset:32768
ds_read_b64_tr_b16 v[230:231], v16 offset:33280
v_mfma_f32_16x16x32_bf16 v[84:87], v[244:247], v[208:211], v[84:87]
ds_read_b64_tr_b16 v[232:233], v17 offset:32768
ds_read_b64_tr_b16 v[234:235], v17 offset:33280
v_mfma_f32_16x16x32_bf16 v[88:91], v[248:251], v[208:211], v[88:91]
s_add_u32 s57, s57, 2048
s_and_b32 s57, s57, 0x7fff
v_mfma_f32_16x16x32_bf16 v[72:75], v[248:251], v[204:207], v[72:75]
s_waitcnt vmcnt(8) lgkmcnt(8)
v_mfma_f32_16x16x32_bf16 v[60:63], v[100:103], v[212:215], v[60:63]
buffer_load_dwordx4 v[188:191], v38, s[32:35], s57 offen sc1
v_mfma_f32_16x16x32_bf16 v[76:79], v[100:103], v[216:219], v[76:79]
ds_read_b64_tr_b16 v[236:237], v14 offset:36864
ds_read_b64_tr_b16 v[238:239], v14 offset:37376
v_mfma_f32_16x16x32_bf16 v[80:83], v[104:107], v[216:219], v[80:83]
ds_read_b64_tr_b16 v[240:241], v15 offset:36864
ds_read_b64_tr_b16 v[242:243], v15 offset:37376
v_mfma_f32_16x16x32_bf16 v[64:67], v[104:107], v[212:215], v[64:67]
buffer_load_dwordx4 v[192:195], v39, s[32:35], s57 offen sc1
v_mfma_f32_16x16x32_bf16 v[68:71], v[108:111], v[212:215], v[68:71]
ds_read_b64_tr_b16 v[244:245], v16 offset:36864
ds_read_b64_tr_b16 v[246:247], v16 offset:37376
v_mfma_f32_16x16x32_bf16 v[84:87], v[108:111], v[216:219], v[84:87]
ds_read_b64_tr_b16 v[248:249], v17 offset:36864
ds_read_b64_tr_b16 v[250:251], v17 offset:37376
v_mfma_f32_16x16x32_bf16 v[88:91], v[112:115], v[216:219], v[88:91]
v_mfma_f32_16x16x32_bf16 v[72:75], v[112:115], v[212:215], v[72:75]
s_waitcnt vmcnt(8) lgkmcnt(8)
v_mfma_f32_16x16x32_bf16 v[60:63], v[220:223], v[156:159], v[60:63]
buffer_load_dwordx4 v[196:199], v38, s[32:35], s57 offen offset:1024 sc1
v_mfma_f32_16x16x32_bf16 v[76:79], v[220:223], v[160:163], v[76:79]
ds_read_b64_tr_b16 v[100:101], v14 offset:40960
ds_read_b64_tr_b16 v[102:103], v14 offset:41472
v_mfma_f32_16x16x32_bf16 v[80:83], v[224:227], v[160:163], v[80:83]
ds_read_b64_tr_b16 v[104:105], v15 offset:40960
ds_read_b64_tr_b16 v[106:107], v15 offset:41472
v_mfma_f32_16x16x32_bf16 v[64:67], v[224:227], v[156:159], v[64:67]
buffer_load_dwordx4 v[200:203], v39, s[32:35], s57 offen offset:1024 sc1
v_mfma_f32_16x16x32_bf16 v[68:71], v[228:231], v[156:159], v[68:71]
ds_read_b64_tr_b16 v[108:109], v16 offset:40960
ds_read_b64_tr_b16 v[110:111], v16 offset:41472
v_mfma_f32_16x16x32_bf16 v[84:87], v[228:231], v[160:163], v[84:87]
ds_read_b64_tr_b16 v[112:113], v17 offset:40960
ds_read_b64_tr_b16 v[114:115], v17 offset:41472
v_mfma_f32_16x16x32_bf16 v[88:91], v[232:235], v[160:163], v[88:91]
s_add_u32 s57, s57, 2048
s_and_b32 s57, s57, 0x7fff
v_mfma_f32_16x16x32_bf16 v[72:75], v[232:235], v[156:159], v[72:75]
s_waitcnt vmcnt(8) lgkmcnt(8)
v_mfma_f32_16x16x32_bf16 v[60:63], v[236:239], v[164:167], v[60:63]
buffer_load_dwordx4 v[204:207], v38, s[32:35], s57 offen sc1
v_mfma_f32_16x16x32_bf16 v[76:79], v[236:239], v[168:171], v[76:79]
ds_read_b64_tr_b16 v[220:221], v14 offset:45056
ds_read_b64_tr_b16 v[222:223], v14 offset:45568
v_mfma_f32_16x16x32_bf16 v[80:83], v[240:243], v[168:171], v[80:83]
ds_read_b64_tr_b16 v[224:225], v15 offset:45056
ds_read_b64_tr_b16 v[226:227], v15 offset:45568
v_mfma_f32_16x16x32_bf16 v[64:67], v[240:243], v[164:167], v[64:67]
buffer_load_dwordx4 v[208:211], v39, s[32:35], s57 offen sc1
v_mfma_f32_16x16x32_bf16 v[68:71], v[244:247], v[164:167], v[68:71]
ds_read_b64_tr_b16 v[228:229], v16 offset:45056
ds_read_b64_tr_b16 v[230:231], v16 offset:45568
v_mfma_f32_16x16x32_bf16 v[84:87], v[244:247], v[168:171], v[84:87]
ds_read_b64_tr_b16 v[232:233], v17 offset:45056
ds_read_b64_tr_b16 v[234:235], v17 offset:45568
v_mfma_f32_16x16x32_bf16 v[88:91], v[248:251], v[168:171], v[88:91]
v_mfma_f32_16x16x32_bf16 v[72:75], v[248:251], v[164:167], v[72:75]
s_waitcnt vmcnt(8) lgkmcnt(8)
v_mfma_f32_16x16x32_bf16 v[60:63], v[100:103], v[172:175], v[60:63]
buffer_load_dwordx4 v[212:215], v38, s[32:35], s57 offen offset:1024 sc1
v_mfma_f32_16x16x32_bf16 v[76:79], v[100:103], v[176:179], v[76:79]
ds_read_b64_tr_b16 v[236:237], v14 offset:49152
ds_read_b64_tr_b16 v[238:239], v14 offset:49664
v_mfma_f32_16x16x32_bf16 v[80:83], v[104:107], v[176:179], v[80:83]
ds_read_b64_tr_b16 v[240:241], v15 offset:49152
ds_read_b64_tr_b16 v[242:243], v15 offset:49664
v_mfma_f32_16x16x32_bf16 v[64:67], v[104:107], v[172:175], v[64:67]
buffer_load_dwordx4 v[216:219], v39, s[32:35], s57 offen offset:1024 sc1
v_mfma_f32_16x16x32_bf16 v[68:71], v[108:111], v[172:175], v[68:71]
ds_read_b64_tr_b16 v[244:245], v16 offset:49152
ds_read_b64_tr_b16 v[246:247], v16 offset:49664
v_mfma_f32_16x16x32_bf16 v[84:87], v[108:111], v[176:179], v[84:87]
ds_read_b64_tr_b16 v[248:249], v17 offset:49152
ds_read_b64_tr_b16 v[250:251], v17 offset:49664
v_mfma_f32_16x16x32_bf16 v[88:91], v[112:115], v[176:179], v[88:91]
v_mfma_f32_16x16x32_bf16 v[72:75], v[112:115], v[172:175], v[72:75]
s_waitcnt vmcnt(8) lgkmcnt(8)
v_mfma_f32_16x16x32_bf16 v[60:63], v[220:223], v[180:183], v[60:63]
v_mfma_f32_16x16x32_bf16 v[76:79], v[220:223], v[184:187], v[76:79]
ds_read_b64_tr_b16 v[100:101], v14 offset:53248
ds_read_b64_tr_b16 v[102:103], v14 offset:53760
v_mfma_f32_16x16x32_bf16 v[80:83], v[224:227], v[184:187], v[80:83]
ds_read_b64_tr_b16 v[104:105], v15 offset:53248
ds_read_b64_tr_b16 v[106:107], v15 offset:53760
v_mfma_f32_16x16x32_bf16 v[64:67], v[224:227], v[180:183], v[64:67]
v_mfma_f32_16x16x32_bf16 v[68:71], v[228:231], v[180:183], v[68:71]
ds_read_b64_tr_b16 v[108:109], v16 offset:53248
ds_read_b64_tr_b16 v[110:111], v16 offset:53760
v_mfma_f32_16x16x32_bf16 v[84:87], v[228:231], v[184:187], v[84:87]
ds_read_b64_tr_b16 v[112:113], v17 offset:53248
ds_read_b64_tr_b16 v[114:115], v17 offset:53760
v_mfma_f32_16x16x32_bf16 v[88:91], v[232:235], v[184:187], v[88:91]
v_mfma_f32_16x16x32_bf16 v[72:75], v[232:235], v[180:183], v[72:75]
s_waitcnt vmcnt(6) lgkmcnt(8)
v_mfma_f32_16x16x32_bf16 v[60:63], v[236:239], v[188:191], v[60:63]
v_mfma_f32_16x16x32_bf16 v[76:79], v[236:239], v[192:195], v[76:79]
ds_read_b64_tr_b16 v[220:221], v14 offset:57344
ds_read_b64_tr_b16 v[222:223], v14 offset:57856
v_mfma_f32_16x16x32_bf16 v[80:83], v[240:243], v[192:195], v[80:83]
ds_read_b64_tr_b16 v[224:225], v15 offset:57344
ds_read_b64_tr_b16 v[226:227], v15 offset:57856
v_mfma_f32_16x16x32_bf16 v[64:67], v[240:243], v[188:191], v[64:67]
v_mfma_f32_16x16x32_bf16 v[68:71], v[244:247], v[188:191], v[68:71]
ds_read_b64_tr_b16 v[228:229], v16 offset:57344
ds_read_b64_tr_b16 v[230:231], v16 offset:57856
v_mfma_f32_16x16x32_bf16 v[84:87], v[244:247], v[192:195], v[84:87]
ds_read_b64_tr_b16 v[232:233], v17 offset:57344
ds_read_b64_tr_b16 v[234:235], v17 offset:57856
v_mfma_f32_16x16x32_bf16 v[88:91], v[248:251], v[192:195], v[88:91]
v_mfma_f32_16x16x32_bf16 v[72:75], v[248:251], v[188:191], v[72:75]
s_waitcnt vmcnt(4) lgkmcnt(8)
v_mfma_f32_16x16x32_bf16 v[60:63], v[100:103], v[196:199], v[60:63]
v_mfma_f32_16x16x32_bf16 v[76:79], v[100:103], v[200:203], v[76:79]
ds_read_b64_tr_b16 v[236:237], v14 offset:61440
ds_read_b64_tr_b16 v[238:239], v14 offset:61952
v_mfma_f32_16x16x32_bf16 v[80:83], v[104:107], v[200:203], v[80:83]
ds_read_b64_tr_b16 v[240:241], v15 offset:61440
ds_read_b64_tr_b16 v[242:243], v15 offset:61952
v_mfma_f32_16x16x32_bf16 v[64:67], v[104:107], v[196:199], v[64:67]
v_mfma_f32_16x16x32_bf16 v[68:71], v[108:111], v[196:199], v[68:71]
ds_read_b64_tr_b16 v[244:245], v16 offset:61440
ds_read_b64_tr_b16 v[246:247], v16 offset:61952
v_mfma_f32_16x16x32_bf16 v[84:87], v[108:111], v[200:203], v[84:87]
ds_read_b64_tr_b16 v[248:249], v17 offset:61440
ds_read_b64_tr_b16 v[250:251], v17 offset:61952
v_mfma_f32_16x16x32_bf16 v[88:91], v[112:115], v[200:203], v[88:91]
v_mfma_f32_16x16x32_bf16 v[72:75], v[112:115], v[196:199], v[72:75]
s_waitcnt vmcnt(2) lgkmcnt(8)
v_mfma_f32_16x16x32_bf16 v[60:63], v[220:223], v[204:207], v[60:63]
v_mfma_f32_16x16x32_bf16 v[76:79], v[220:223], v[208:211], v[76:79]
v_mfma_f32_16x16x32_bf16 v[80:83], v[224:227], v[208:211], v[80:83]
v_mfma_f32_16x16x32_bf16 v[64:67], v[224:227], v[204:207], v[64:67]
v_mfma_f32_16x16x32_bf16 v[68:71], v[228:231], v[204:207], v[68:71]
v_mfma_f32_16x16x32_bf16 v[84:87], v[228:231], v[208:211], v[84:87]
v_mfma_f32_16x16x32_bf16 v[88:91], v[232:235], v[208:211], v[88:91]
v_mfma_f32_16x16x32_bf16 v[72:75], v[232:235], v[204:207], v[72:75]
s_waitcnt vmcnt(0) lgkmcnt(0)
v_mfma_f32_16x16x32_bf16 v[60:63], v[236:239], v[212:215], v[60:63]
v_mfma_f32_16x16x32_bf16 v[64:67], v[240:243], v[212:215], v[64:67]
v_mfma_f32_16x16x32_bf16 v[68:71], v[244:247], v[212:215], v[68:71]
v_mfma_f32_16x16x32_bf16 v[72:75], v[248:251], v[212:215], v[72:75]
v_mfma_f32_16x16x32_bf16 v[76:79], v[236:239], v[216:219], v[76:79]
v_mfma_f32_16x16x32_bf16 v[80:83], v[240:243], v[216:219], v[80:83]
v_mfma_f32_16x16x32_bf16 v[84:87], v[244:247], v[216:219], v[84:87]
v_mfma_f32_16x16x32_bf16 v[88:91], v[248:251], v[216:219], v[88:91]
s_setpc_b64 s[94:95]
R_oloop_end:
s_cmp_eq_u32 s46, 0
s_cbranch_scc1 slow_80
s_nop 0
v_cvt_pk_bf16_f32 v20, v60, v61
v_cvt_pk_bf16_f32 v21, v62, v63
v_cvt_pk_bf16_f32 v22, v64, v65
v_cvt_pk_bf16_f32 v23, v66, v67
buffer_store_dwordx4 v[20:23], v18, s[32:35], s85 offen offset:0 sc1
v_cvt_pk_bf16_f32 v24, v68, v69
v_cvt_pk_bf16_f32 v25, v70, v71
v_cvt_pk_bf16_f32 v26, v72, v73
v_cvt_pk_bf16_f32 v27, v74, v75
buffer_store_dwordx4 v[24:27], v18, s[32:35], s85 offen offset:1024 sc1
v_cvt_pk_bf16_f32 v28, v76, v77
v_cvt_pk_bf16_f32 v29, v78, v79
v_cvt_pk_bf16_f32 v30, v80, v81
v_cvt_pk_bf16_f32 v31, v82, v83
buffer_store_dwordx4 v[28:31], v18, s[32:35], s86 offen offset:0 sc1
v_cvt_pk_bf16_f32 v32, v84, v85
v_cvt_pk_bf16_f32 v33, v86, v87
v_cvt_pk_bf16_f32 v34, v88, v89
v_cvt_pk_bf16_f32 v35, v90, v91
buffer_store_dwordx4 v[32:35], v18, s[32:35], s86 offen offset:1024 sc1
s_barrier
v_dot2c_f32_bf16 v6, v20, v48
v_dot2c_f32_bf16 v8, v20, v20
v_dot2c_f32_bf16 v7, v28, v48
v_dot2c_f32_bf16 v9, v28, v28
v_dot2c_f32_bf16 v6, v21, v48
v_dot2c_f32_bf16 v8, v21, v21
v_dot2c_f32_bf16 v7, v29, v48
v_dot2c_f32_bf16 v9, v29, v29
v_dot2c_f32_bf16 v6, v22, v48
v_dot2c_f32_bf16 v8, v22, v22
v_dot2c_f32_bf16 v7, v30, v48
v_dot2c_f32_bf16 v9, v30, v30
v_dot2c_f32_bf16 v6, v23, v48
v_dot2c_f32_bf16 v8, v23, v23
v_dot2c_f32_bf16 v7, v31, v48
v_dot2c_f32_bf16 v9, v31, v31
v_dot2c_f32_bf16 v6, v24, v48
v_dot2c_f32_bf16 v8, v24, v24
v_dot2c_f32_bf16 v7, v32, v48
v_dot2c_f32_bf16 v9, v32, v32
v_dot2c_f32_bf16 v6, v25, v48
v_dot2c_f32_bf16 v8, v25, v25
v_dot2c_f32_bf16 v7, v33, v48
v_dot2c_f32_bf16 v9, v33, v33
v_dot2c_f32_bf16 v6, v26, v48
v_dot2c_f32_bf16 v8, v26, v26
v_dot2c_f32_bf16 v7, v34, v48
v_dot2c_f32_bf16 v9, v34, v34
v_dot2c_f32_bf16 v6, v27, v48
v_dot2c_f32_bf16 v8, v27, v27
v_dot2c_f32_bf16 v7, v35, v48
v_dot2c_f32_bf16 v9, v35, v35
s_mov_b64 exec, 1
s_waitcnt vmcnt(0)
buffer_store_dword v5, v4, s[32:35], s88 offen
s_mov_b64 exec, -1
s_nop 1
v_permlane32_swap_b32 v6, v7
v_permlane32_swap_b32 v8, v9
v_add_f32 v6, v6, v7
v_add_f32 v8, v8, v9
s_nop 1
v_permlane16_swap_b32 v6, v8
s_nop 0
v_add_f32 v6, v6, v8
buffer_store_dword v6, v1, s[32:35], s87 offen
back_81:
s_lshl_b32 s49, s44, 13
v_add_u32 v10, s49, v18
v_add_u32 v11, 1024, v10
s_lshl_b32 s48, s43, 1
v_lshrrev_b32 v4, 2, v2
v_and_b32 v5, 3, v0
v_lshl_add_u32 v6, v3, 3, v4
v_lshlrev_b32 v6, 7, v6
v_lshl_add_u32 v6, v5, 3, v6
v_lshrrev_b32 v7, 1, v4
v_and_b32 v8, 1, v3
v_lshl_add_u32 v7, v8, 1, v7
v_xor_b32 v7, s48, v7
v_lshl_add_u32 v12, v7, 5, v6
v_add_u32 v12, 16384, v12
v_xor_b32 v13, 32, v12
v_mov_b32 v14, v10
v_mov_b32 v15, v11
v_add_u32 v16, 122880, v12
v_add_u32 v17, 122880, v13
v_mov_b32 v156, 0
v_mov_b32 v157, 0
v_mov_b32 v158, 0
v_mov_b32 v159, 0
v_mov_b32 v160, 0
v_mov_b32 v161, 0
v_mov_b32 v162, 0
v_mov_b32 v163, 0
v_mov_b32 v164, 0
v_mov_b32 v165, 0
v_mov_b32 v166, 0
v_mov_b32 v167, 0
v_mov_b32 v168, 0
v_mov_b32 v169, 0
v_mov_b32 v170, 0
v_mov_b32 v171, 0
v_mov_b32 v172, 0
v_mov_b32 v173, 0
v_mov_b32 v174, 0
v_mov_b32 v175, 0
v_mov_b32 v176, 0
v_mov_b32 v177, 0
v_mov_b32 v178, 0
v_mov_b32 v179, 0
v_mov_b32 v180, 0
v_mov_b32 v181, 0
v_mov_b32 v182, 0
v_mov_b32 v183, 0
v_mov_b32 v184, 0
v_mov_b32 v185, 0
v_mov_b32 v186, 0
v_mov_b32 v187, 0
v_mov_b32 v188, 0
v_mov_b32 v189, 0
v_mov_b32 v190, 0
v_mov_b32 v191, 0
v_mov_b32 v192, 0
v_mov_b32 v193, 0
v_mov_b32 v194, 0
v_mov_b32 v195, 0
v_mov_b32 v196, 0
v_mov_b32 v197, 0
v_mov_b32 v198, 0
v_mov_b32 v199, 0
v_mov_b32 v200, 0
v_mov_b32 v201, 0
v_mov_b32 v202, 0
v_mov_b32 v203, 0
v_mov_b32 v204, 0
v_mov_b32 v205, 0
v_mov_b32 v206, 0
v_mov_b32 v207, 0
v_mov_b32 v208, 0
v_mov_b32 v209, 0
v_mov_b32 v210, 0
v_mov_b32 v211, 0
v_mov_b32 v212, 0
v_mov_b32 v213, 0
v_mov_b32 v214, 0
v_mov_b32 v215, 0
v_mov_b32 v216, 0
v_mov_b32 v217, 0
v_mov_b32 v218, 0
v_mov_b32 v219, 0
v_mov_b32 v220, 0
v_mov_b32 v221, 0
v_mov_b32 v222, 0
v_mov_b32 v223, 0
v_mov_b32 v224, 0
v_mov_b32 v225, 0
v_mov_b32 v226, 0
v_mov_b32 v227, 0
v_mov_b32 v228, 0
v_mov_b32 v229, 0
v_mov_b32 v230, 0
v_mov_b32 v231, 0
v_mov_b32 v232, 0
v_mov_b32 v233, 0
v_mov_b32 v234, 0
v_mov_b32 v235, 0
v_mov_b32 v236, 0
v_mov_b32 v237, 0
v_mov_b32 v238, 0
v_mov_b32 v239, 0
v_mov_b32 v240, 0
v_mov_b32 v241, 0
v_mov_b32 v242, 0
v_mov_b32 v243, 0
v_mov_b32 v244, 0
v_mov_b32 v245, 0
v_mov_b32 v246, 0
v_mov_b32 v247, 0
v_mov_b32 v248, 0
v_mov_b32 v249, 0
v_mov_b32 v250, 0
v_mov_b32 v251, 0
v_lshrrev_b32 v6, 2, v2
v_cmp_eq_u32 vcc, v6, v3
v_and_b32 v7, 1, v0
v_lshlrev_b32 v7, 4, v7
v_mov_b32 v8, 0x3f80
v_lshlrev_b32 v9, v7, v8
v_cndmask_b32 v7, 0, v9, vcc
v_and_b32 v6, 2, v0
v_cmp_eq_u32 vcc, 0, v6
v_mov_b32 v36, 0
v_mov_b32 v37, 0
v_mov_b32 v40, 0
v_mov_b32 v41, 0
v_cndmask_b32 v38, 0, v7, vcc
v_cndmask_b32 v39, v7, 0, vcc
v_lshrrev_b32 v8, 1, v2
v_cmp_eq_u32 vcc, 0, v8
s_nop 1
v_cndmask_b32 v44, 0, v9, vcc
v_cmp_eq_u32 vcc, 1, v8
s_nop 1
v_cndmask_b32 v45, 0, v9, vcc
v_cmp_eq_u32 vcc, 2, v8
s_nop 1
v_cndmask_b32 v46, 0, v9, vcc
v_cmp_eq_u32 vcc, 3, v8
s_nop 1
v_cndmask_b32 v47, 0, v9, vcc
v_lshrrev_b32 v4, 2, v2
v_lshl_add_u32 v4, v3, 2, v4
v_lshlrev_b32 v4, 6, v4
v_and_b32 v5, 3, v0
v_lshl_add_u32 v4, v5, 3, v4
s_lshl_b32 s48, s43, 11
s_add_u32 s48, s48, 135168
v_add_u32 v53, s48, v4
s_mul_i32 s48, s40, 3072
s_add_u32 s48, s48, 139264
v_add_u32 v42, s48, v18
s_xor_b32 s49, s40, 2
s_mul_i32 s48, s49, 3072
s_add_u32 s48, s48, 139264
v_add_u32 v43, s48, v18
s_lshl_b32 s49, s49, 2
s_add_u32 s49, s49, 134672
v_mov_b32 v19, s49
v_xor_b32 v52, 8, v19
v_lshrrev_b32 v4, 3, v0
v_and_b32 v5, 7, v0
v_lshlrev_b32 v4, 11, v4
v_lshl_add_u32 v55, v5, 4, v4
v_lshlrev_b32 v4, 6, v2
v_lshl_add_u32 v58, v3, 4, v4
v_lshlrev_b32 v4, 4, v2
v_lshl_add_u32 v59, v3, 3, v4
s_mul_i32 s51, s42, 163840
s_add_u32 s51, s51, 9437184
s_lshl_b32 s50, s43, 1
s_add_u32 s50, s50, s44
s_lshl_b32 s48, s50, 15
s_add_u32 s48, s48, s51
s_add_u32 s48, s48, 0
s_lshl_b32 s49, s41, 7
s_add_u32 s53, s48, s49
s_add_u32 s54, s53, 16384
s_lshl_b32 s56, s50, 10
s_add_u32 s56, s56, s51
s_add_u32 s56, s56, 147456
s_xor_b32 s57, s56, 1024
s_lshl_b32 s58, s50, 11
s_add_u32 s58, s58, s51
s_add_u32 s58, s58, 131072
s_xor_b32 s59, s58, 2048
s_add_u32 s79, s58, s49
s_lshl_b32 s50, s41, 11
s_add_u32 s55, s48, s50
s_lshl_b32 s48, s43, 7
s_add_u32 s48, s48, 133888
v_lshl_add_u32 v7, v3, 4, s48
v_lshl_add_u32 v54, v2, 2, s48
s_lshl_b32 s49, s44, 6
v_add_u32 v8, s49, v2
v_lshlrev_b32 v8, 3, v8
v_add_u32 v8, 131072, v8
v_lshl_add_u32 v9, v3, 2, s49
v_lshlrev_b32 v9, 2, v9
v_add_u32 v9, 132096, v9
s_mov_b32 s64, 0
s_mov_b32 s65, 0
s_mov_b32 s66, 0x3fb8aa3b
s_mov_b32 s61, 2
s_lshr_b32 s49, s42, 3
s_xor_b32 s77, s74, s49
s_add_u32 s77, s77, 3
s_lshl_b32 s50, s42, 2
s_add_u32 s50, s50, s40
s_lshl_b32 s50, s50, 4
s_add_u32 s50, s50, s41
s_lshl_b32 s50, s50, 8
s_add_u32 s52, s50, 18087936
ds_read_b64_tr_b16 v[84:85], v16 offset:8192
ds_read_b64_tr_b16 v[86:87], v16 offset:8704
ds_read_b64_tr_b16 v[88:89], v17 offset:8192
ds_read_b64_tr_b16 v[90:91], v17 offset:8704
ds_read_b64_tr_b16 v[92:93], v16 offset:16384
ds_read_b64_tr_b16 v[94:95], v16 offset:16896
ds_read_b64_tr_b16 v[96:97], v17 offset:16384
ds_read_b64_tr_b16 v[98:99], v17 offset:16896
ds_read_b64_tr_b16 v[76:77], v16 offset:0
ds_read_b64_tr_b16 v[78:79], v16 offset:512
ds_read_b64_tr_b16 v[80:81], v17 offset:0
ds_read_b64_tr_b16 v[82:83], v17 offset:512
s_barrier
ds_read_b128 v[60:63], v14 offset:0
ds_read_b128 v[64:67], v14 offset:2048
ds_read_b128 v[68:71], v14 offset:4096
ds_read_b128 v[72:75], v14 offset:6144
s_waitcnt lgkmcnt(0)
c1_loop:
v_mfma_f32_16x16x32_bf16 v[212:215], v[84:87], v[72:75], v[212:215]
ds_read_b128 v[100:103], v15 offset:0
v_mfma_f32_16x16x32_bf16 v[204:207], v[84:87], v[68:71], v[204:207]
ds_read_b128 v[104:107], v15 offset:2048
v_mfma_f32_16x16x32_bf16 v[196:199], v[84:87], v[64:67], v[196:199]
ds_read_b128 v[108:111], v15 offset:4096
v_mfma_f32_16x16x32_bf16 v[188:191], v[84:87], v[60:63], v[188:191]
ds_read_b128 v[112:115], v15 offset:6144
v_mfma_f32_16x16x32_bf16 v[192:195], v[88:91], v[60:63], v[192:195]
ds_read_b64_tr_b16 v[124:125], v16 offset:12288
v_mfma_f32_16x16x32_bf16 v[200:203], v[88:91], v[64:67], v[200:203]
ds_read_b64_tr_b16 v[126:127], v16 offset:12800
v_mfma_f32_16x16x32_bf16 v[208:211], v[88:91], v[68:71], v[208:211]
ds_read_b64_tr_b16 v[128:129], v17 offset:12288
v_mfma_f32_16x16x32_bf16 v[216:219], v[88:91], v[72:75], v[216:219]
ds_read_b64_tr_b16 v[130:131], v17 offset:12800
v_mfma_f32_16x16x32_bf16 v[244:247], v[72:75], v[92:95], v[244:247]
ds_read_b64_tr_b16 v[132:133], v16 offset:20480
v_mfma_f32_16x16x32_bf16 v[248:251], v[72:75], v[96:99], v[248:251]
ds_read_b64_tr_b16 v[134:135], v16 offset:20992
v_mfma_f32_16x16x32_bf16 v[240:243], v[68:71], v[96:99], v[240:243]
ds_read_b64_tr_b16 v[136:137], v17 offset:20480
v_mfma_f32_16x16x32_bf16 v[236:239], v[68:71], v[92:95], v[236:239]
ds_read_b64_tr_b16 v[138:139], v17 offset:20992
v_mfma_f32_16x16x32_bf16 v[228:231], v[64:67], v[92:95], v[228:231]
ds_read_b64_tr_b16 v[116:117], v16 offset:4096
v_mfma_f32_16x16x32_bf16 v[232:235], v[64:67], v[96:99], v[232:235]
ds_read_b64_tr_b16 v[118:119], v16 offset:4608
v_mfma_f32_16x16x32_bf16 v[224:227], v[60:63], v[96:99], v[224:227]
ds_read_b64_tr_b16 v[120:121], v17 offset:4096
v_mfma_f32_16x16x32_bf16 v[220:223], v[60:63], v[92:95], v[220:223]
ds_read_b64_tr_b16 v[122:123], v17 offset:4608
v_mfma_f32_16x16x32_bf16 v[156:159], v[76:79], v[60:63], v[156:159]
s_cmp_eq_u32 s77, s64
s_cbranch_scc1 c1_hook
c1_hook_ret:
v_mfma_f32_16x16x32_bf16 v[164:167], v[76:79], v[64:67], v[164:167]
s_add_u32 s65, s65, 40960
s_cmp_eq_u32 s65, 122880
v_mfma_f32_16x16x32_bf16 v[172:175], v[76:79], v[68:71], v[172:175]
s_cselect_b32 s65, 0, s65
s_add_u32 s64, s64, 1
v_mfma_f32_16x16x32_bf16 v[180:183], v[76:79], v[72:75], v[180:183]
v_add_u32 v14, s65, v10
v_add_u32 v15, s65, v11
v_mfma_f32_16x16x32_bf16 v[184:187], v[80:83], v[72:75], v[184:187]
v_add_u32 v16, s65, v12
v_add_u32 v17, s65, v13
v_mfma_f32_16x16x32_bf16 v[176:179], v[80:83], v[68:71], v[176:179]
s_cmp_eq_u32 s64, 16
s_cbranch_scc1 c1_last
v_mfma_f32_16x16x32_bf16 v[168:171], v[80:83], v[64:67], v[168:171]
s_waitcnt lgkmcnt(0)
v_mfma_f32_16x16x32_bf16 v[160:163], v[80:83], v[60:63], v[160:163]
s_barrier
v_mfma_f32_16x16x32_bf16 v[212:215], v[124:127], v[112:115], v[212:215]
ds_read_b128 v[60:63], v14 offset:0
v_mfma_f32_16x16x32_bf16 v[204:207], v[124:127], v[108:111], v[204:207]
ds_read_b128 v[64:67], v14 offset:2048
v_mfma_f32_16x16x32_bf16 v[196:199], v[124:127], v[104:107], v[196:199]
ds_read_b128 v[68:71], v14 offset:4096
v_mfma_f32_16x16x32_bf16 v[188:191], v[124:127], v[100:103], v[188:191]
ds_read_b128 v[72:75], v14 offset:6144
v_mfma_f32_16x16x32_bf16 v[192:195], v[128:131], v[100:103], v[192:195]
ds_read_b64_tr_b16 v[84:85], v16 offset:8192
v_mfma_f32_16x16x32_bf16 v[200:203], v[128:131], v[104:107], v[200:203]
ds_read_b64_tr_b16 v[86:87], v16 offset:8704
v_mfma_f32_16x16x32_bf16 v[208:211], v[128:131], v[108:111], v[208:211]
ds_read_b64_tr_b16 v[88:89], v17 offset:8192
v_mfma_f32_16x16x32_bf16 v[216:219], v[128:131], v[112:115], v[216:219]
ds_read_b64_tr_b16 v[90:91], v17 offset:8704
v_mfma_f32_16x16x32_bf16 v[244:247], v[112:115], v[132:135], v[244:247]
ds_read_b64_tr_b16 v[92:93], v16 offset:16384
v_mfma_f32_16x16x32_bf16 v[248:251], v[112:115], v[136:139], v[248:251]
ds_read_b64_tr_b16 v[94:95], v16 offset:16896
v_mfma_f32_16x16x32_bf16 v[240:243], v[108:111], v[136:139], v[240:243]
ds_read_b64_tr_b16 v[96:97], v17 offset:16384
v_mfma_f32_16x16x32_bf16 v[236:239], v[108:111], v[132:135], v[236:239]
ds_read_b64_tr_b16 v[98:99], v17 offset:16896
v_mfma_f32_16x16x32_bf16 v[228:231], v[104:107], v[132:135], v[228:231]
ds_read_b64_tr_b16 v[76:77], v16 offset:0
v_mfma_f32_16x16x32_bf16 v[232:235], v[104:107], v[136:139], v[232:235]
ds_read_b64_tr_b16 v[78:79], v16 offset:512
v_mfma_f32_16x16x32_bf16 v[224:227], v[100:103], v[136:139], v[224:227]
ds_read_b64_tr_b16 v[80:81], v17 offset:0
v_mfma_f32_16x16x32_bf16 v[220:223], v[100:103], v[132:135], v[220:223]
ds_read_b64_tr_b16 v[82:83], v17 offset:512
v_mfma_f32_16x16x32_bf16 v[156:159], v[116:119], v[100:103], v[156:159]
v_mfma_f32_16x16x32_bf16 v[164:167], v[116:119], v[104:107], v[164:167]
v_mfma_f32_16x16x32_bf16 v[172:175], v[116:119], v[108:111], v[172:175]
v_mfma_f32_16x16x32_bf16 v[180:183], v[116:119], v[112:115], v[180:183]
v_mfma_f32_16x16x32_bf16 v[184:187], v[120:123], v[112:115], v[184:187]
v_mfma_f32_16x16x32_bf16 v[176:179], v[120:123], v[108:111], v[176:179]
v_mfma_f32_16x16x32_bf16 v[168:171], v[120:123], v[104:107], v[168:171]
s_waitcnt lgkmcnt(0)
v_mfma_f32_16x16x32_bf16 v[160:163], v[120:123], v[100:103], v[160:163]
s_branch c1_loop
c1_hook:
s_waitcnt lgkmcnt(0)
s_cmp_lg_u32 s44, 0
s_cbranch_scc1 else_82
v_mfma_f32_16x16x32_bf16 v[140:143], v[48:51], v[76:79], 0
v_mfma_f32_16x16x32_bf16 v[144:147], v[48:51], v[84:87], 0
v_mfma_f32_16x16x32_bf16 v[148:151], v[48:51], v[92:95], 0
v_mfma_f32_16x16x32_bf16 v[140:143], v[48:51], v[116:119], v[140:143]
v_mfma_f32_16x16x32_bf16 v[144:147], v[48:51], v[124:127], v[144:147]
v_mfma_f32_16x16x32_bf16 v[148:151], v[48:51], v[132:135], v[148:151]
s_branch fi_83
else_82:
v_mfma_f32_16x16x32_bf16 v[140:143], v[48:51], v[80:83], 0
v_mfma_f32_16x16x32_bf16 v[144:147], v[48:51], v[88:91], 0
v_mfma_f32_16x16x32_bf16 v[148:151], v[48:51], v[96:99], 0
v_mfma_f32_16x16x32_bf16 v[140:143], v[48:51], v[120:123], v[140:143]
v_mfma_f32_16x16x32_bf16 v[144:147], v[48:51], v[128:131], v[144:147]
v_mfma_f32_16x16x32_bf16 v[148:151], v[48:51], v[136:139], v[148:151]
fi_83:
s_nop 4
v_cmp_eq_u32 vcc, 0, v3
v_cmp_eq_u32 s[48:49], 1, v3
s_nop 1
v_cndmask_b32 v4, v148, v144, s[48:49]
v_cndmask_b32 v4, v4, v140, vcc
buffer_store_dword v4, v1, s[32:35], s52 offen sc1
s_branch c1_hook_ret
c1_last:
v_mfma_f32_16x16x32_bf16 v[168:171], v[80:83], v[64:67], v[168:171]
s_waitcnt lgkmcnt(0)
v_mfma_f32_16x16x32_bf16 v[160:163], v[80:83], v[60:63], v[160:163]
v_mfma_f32_16x16x32_bf16 v[212:215], v[124:127], v[112:115], v[212:215]
ds_read_b64_tr_b16 v[10:11], v53 offset:0
ds_read_b64_tr_b16 v[12:13], v53 offset:1024
v_mfma_f32_16x16x32_bf16 v[204:207], v[124:127], v[108:111], v[204:207]
ds_read_b64_tr_b16 v[14:15], v53 offset:32
ds_read_b64_tr_b16 v[16:17], v53 offset:1056
v_mfma_f32_16x16x32_bf16 v[196:199], v[124:127], v[104:107], v[196:199]

s_mul_i32 s48, s44, 0x80008000
v_mfma_f32_16x16x32_bf16 v[188:191], v[124:127], v[100:103], v[188:191]

v_mfma_f32_16x16x32_bf16 v[192:195], v[128:131], v[100:103], v[192:195]

v_mfma_f32_16x16x32_bf16 v[200:203], v[128:131], v[104:107], v[200:203]

v_mfma_f32_16x16x32_bf16 v[208:211], v[128:131], v[108:111], v[208:211]

s_waitcnt lgkmcnt(0)
v_mfma_f32_16x16x32_bf16 v[216:219], v[128:131], v[112:115], v[216:219]
s_barrier
v_mfma_f32_16x16x32_bf16 v[244:247], v[112:115], v[132:135], v[244:247]
ds_read_b128 v[140:143], v7 offset:0
ds_read_b128 v[144:147], v7 offset:64
v_mfma_f32_16x16x32_bf16 v[248:251], v[112:115], v[136:139], v[248:251]
ds_read_b128 v[148:151], v7 offset:256
ds_read_b128 v[152:155], v7 offset:320
v_mfma_f32_16x16x32_bf16 v[240:243], v[108:111], v[136:139], v[240:243]
ds_read_b64 v[92:93], v8 offset:0
ds_read_b64 v[94:95], v8 offset:128
v_mfma_f32_16x16x32_bf16 v[236:239], v[108:111], v[132:135], v[236:239]
ds_read_b64 v[96:97], v8 offset:256
ds_read_b64 v[98:99], v8 offset:384
v_mfma_f32_16x16x32_bf16 v[228:231], v[104:107], v[132:135], v[228:231]
ds_read2_b32 v[56:57], v54 offset0:128 offset1:144
v_xor_b32 v10, s48, v10
v_mfma_f32_16x16x32_bf16 v[232:235], v[104:107], v[136:139], v[232:235]
ds_read_b128 v[60:63], v9 offset:0
v_xor_b32 v11, s48, v11
v_mfma_f32_16x16x32_bf16 v[224:227], v[100:103], v[136:139], v[224:227]
ds_read_b128 v[64:67], v9 offset:64
v_xor_b32 v12, s48, v12
v_mfma_f32_16x16x32_bf16 v[220:223], v[100:103], v[132:135], v[220:223]
ds_read_b128 v[68:71], v9 offset:128
v_xor_b32 v13, s48, v13
v_mfma_f32_16x16x32_bf16 v[156:159], v[116:119], v[100:103], v[156:159]
ds_read_b128 v[72:75], v9 offset:192
v_xor_b32 v14, s48, v14
v_mfma_f32_16x16x32_bf16 v[164:167], v[116:119], v[104:107], v[164:167]
ds_read_b128 v[76:79], v9 offset:512
v_xor_b32 v15, s48, v15
v_mfma_f32_16x16x32_bf16 v[172:175], v[116:119], v[108:111], v[172:175]
ds_read_b128 v[80:83], v9 offset:576
v_xor_b32 v16, s48, v16
v_mfma_f32_16x16x32_bf16 v[180:183], v[116:119], v[112:115], v[180:183]
ds_read_b128 v[84:87], v9 offset:640
v_xor_b32 v17, s48, v17
v_mfma_f32_16x16x32_bf16 v[184:187], v[120:123], v[112:115], v[184:187]
ds_read_b128 v[88:91], v9 offset:704
v_mfma_f32_16x16x32_bf16 v[176:179], v[120:123], v[108:111], v[176:179]
v_mfma_f32_16x16x32_bf16 v[168:171], v[120:123], v[104:107], v[168:171]
v_mfma_f32_16x16x32_bf16 v[160:163], v[120:123], v[100:103], v[160:163]
c1_epi:
s_waitcnt lgkmcnt(0)
.p2align 3
v_mul_f32 v129, s66, v94
v_mul_f32 v128, s66, v92
v_mul_f32 v131, s66, v98
v_mul_f32 v130, s66, v96
v_pk_fma_f32 v[190:191], v[150:151], v[92:93], v[190:191] op_sel:[0,1,0] op_sel_hi:[1,1,1]
v_pk_fma_f32 v[212:213], v[148:149], v[98:99], v[212:213] op_sel:[0,1,0] op_sel_hi:[1,1,1]
v_pk_fma_f32 v[214:215], v[150:151], v[98:99], v[214:215] op_sel:[0,1,0] op_sel_hi:[1,1,1]
v_pk_fma_f32 v[188:189], v[148:149], v[92:93], v[188:189] op_sel:[0,1,0] op_sel_hi:[1,1,1]
v_pk_fma_f32 v[218:219], v[154:155], v[98:99], v[218:219] op_sel:[0,1,0] op_sel_hi:[1,1,1]
v_cvt_pk_bf16_f32 v188, v188, v189
v_cvt_pk_bf16_f32 v189, v190, v191
v_pk_fma_f32 v[196:197], v[148:149], v[94:95], v[196:197] op_sel:[0,1,0] op_sel_hi:[1,1,1]
v_pk_fma_f32 v[200:201], v[152:153], v[94:95], v[200:201] op_sel:[0,1,0] op_sel_hi:[1,1,1]
v_pk_fma_f32 v[210:211], v[154:155], v[96:97], v[210:211] op_sel:[0,1,0] op_sel_hi:[1,1,1]
v_pk_fma_f32 v[240:241], v[84:85], v[56:57], v[240:241] op_sel:[0,1,0] op_sel_hi:[1,1,1]
v_pk_fma_f32 v[228:229], v[80:81], v[56:57], v[228:229] op_sel:[0,0,0] op_sel_hi:[1,0,1]
v_pk_fma_f32 v[226:227], v[78:79], v[56:57], v[226:227] op_sel:[0,1,0] op_sel_hi:[1,1,1]
v_pk_fma_f32 v[192:193], v[152:153], v[92:93], v[192:193] op_sel:[0,1,0] op_sel_hi:[1,1,1]
v_cvt_pk_bf16_f32 v190, v192, v193
v_pk_fma_f32 v[238:239], v[86:87], v[56:57], v[238:239] op_sel:[0,0,0] op_sel_hi:[1,0,1]
v_pk_fma_f32 v[234:235], v[82:83], v[56:57], v[234:235] op_sel:[0,1,0] op_sel_hi:[1,1,1]
v_pk_mul_f32 v[226:227], v[226:227], v[62:63]
v_pk_fma_f32 v[204:205], v[148:149], v[96:97], v[204:205] op_sel:[0,1,0] op_sel_hi:[1,1,1]
v_cvt_pk_bf16_f32 v204, v204, v205
v_pk_fma_f32 v[202:203], v[154:155], v[94:95], v[202:203] op_sel:[0,1,0] op_sel_hi:[1,1,1]
v_pk_fma_f32 v[224:225], v[76:77], v[56:57], v[224:225] op_sel:[0,1,0] op_sel_hi:[1,1,1]
v_pk_fma_f32 v[216:217], v[152:153], v[98:99], v[216:217] op_sel:[0,1,0] op_sel_hi:[1,1,1]
v_pk_fma_f32 v[244:245], v[88:89], v[56:57], v[244:245] op_sel:[0,0,0] op_sel_hi:[1,0,1]
v_pk_mul_f32 v[238:239], v[238:239], v[70:71]
v_pk_mul_f32 v[228:229], v[228:229], v[64:65]
v_pk_fma_f32 v[236:237], v[84:85], v[56:57], v[236:237] op_sel:[0,0,0] op_sel_hi:[1,0,1]
v_pk_fma_f32 v[220:221], v[76:77], v[56:57], v[220:221] op_sel:[0,0,0] op_sel_hi:[1,0,1]
v_pk_mul_f32 v[224:225], v[224:225], v[60:61]
v_cvt_pk_bf16_f32 v212, v212, v213
v_cvt_pk_bf16_f32 v213, v214, v215
v_cvt_pk_bf16_f32 v196, v196, v197
v_pk_mul_f32 v[240:241], v[240:241], v[68:69]
v_pk_fma_f32 v[198:199], v[150:151], v[94:95], v[198:199] op_sel:[0,1,0] op_sel_hi:[1,1,1]
v_cvt_pk_bf16_f32 v197, v198, v199
v_cvt_pk_bf16_f32 v198, v200, v201
v_cvt_pk_bf16_f32 v199, v202, v203
v_cvt_pk_bf16_f32 v215, v218, v219
v_pk_fma_f32 v[208:209], v[152:153], v[96:97], v[208:209] op_sel:[0,1,0] op_sel_hi:[1,1,1]
v_pk_fma_f32 v[246:247], v[90:91], v[56:57], v[246:247] op_sel:[0,0,0] op_sel_hi:[1,0,1]
v_pk_fma_f32 v[250:251], v[90:91], v[56:57], v[250:251] op_sel:[0,1,0] op_sel_hi:[1,1,1]
v_pk_mul_f32 v[250:251], v[250:251], v[74:75]
v_pk_fma_f32 v[206:207], v[150:151], v[96:97], v[206:207] op_sel:[0,1,0] op_sel_hi:[1,1,1]
v_cvt_pk_bf16_f32 v205, v206, v207
v_pk_fma_f32 v[242:243], v[86:87], v[56:57], v[242:243] op_sel:[0,1,0] op_sel_hi:[1,1,1]
v_cvt_pk_bf16_f32 v207, v210, v211
v_pk_mul_f32 v[236:237], v[236:237], v[68:69]
v_pk_fma_f32 v[230:231], v[82:83], v[56:57], v[230:231] op_sel:[0,0,0] op_sel_hi:[1,0,1]
v_pk_fma_f32 v[194:195], v[154:155], v[92:93], v[194:195] op_sel:[0,1,0] op_sel_hi:[1,1,1]
v_cvt_pk_bf16_f32 v191, v194, v195
v_pk_fma_f32 v[232:233], v[80:81], v[56:57], v[232:233] op_sel:[0,1,0] op_sel_hi:[1,1,1]
v_pk_mul_f32 v[232:233], v[232:233], v[64:65]
v_pk_mul_f32 v[230:231], v[230:231], v[66:67]
v_pk_fma_f32 v[248:249], v[88:89], v[56:57], v[248:249] op_sel:[0,1,0] op_sel_hi:[1,1,1]
v_pk_mul_f32 v[248:249], v[248:249], v[72:73]
v_pk_mul_f32 v[242:243], v[242:243], v[70:71]
v_mfma_f32_16x16x32_bf16 v[68:71], v[10:13], v[196:199], 0
v_cvt_pk_bf16_f32 v206, v208, v209
v_cvt_pk_bf16_f32 v214, v216, v217
v_cvt_pk_bf16_f32 v121, v226, v227
v_mfma_f32_16x16x32_bf16 v[80:83], v[14:17], v[204:207], 0
v_cvt_pk_bf16_f32 v120, v224, v225
v_cvt_pk_bf16_f32 v114, v228, v229
v_mfma_f32_16x16x32_bf16 v[84:87], v[10:13], v[212:215], 0
v_cvt_pk_bf16_f32 v116, v236, v237
v_min3_f32 v105, v68, v69, v70
v_mfma_f32_16x16x32_bf16 v[88:91], v[14:17], v[212:215], 0
v_max3_f32 v101, v68, v69, v70
v_cvt_pk_bf16_f32 v115, v230, v231
v_cvt_pk_bf16_f32 v122, v232, v233
v_cvt_pk_bf16_f32 v127, v250, v251
v_cvt_pk_bf16_f32 v124, v240, v241
v_pk_mul_f32 v[244:245], v[244:245], v[72:73]
v_pk_fma_f32 v[222:223], v[78:79], v[56:57], v[222:223] op_sel:[0,0,0] op_sel_hi:[1,0,1]
v_pk_mul_f32 v[222:223], v[222:223], v[62:63]
v_mfma_f32_16x16x32_bf16 v[76:79], v[10:13], v[204:207], 0
v_min3_f32 v107, v84, v85, v86
v_min3_f32 v107, v107, v87, v88
v_min3_f32 v107, v107, v89, v90
v_min_f32_e64 v107, v107, v91
v_max3_f32 v103, v84, v85, v86
v_pk_mul_f32 v[220:221], v[220:221], v[60:61]
v_mfma_f32_16x16x32_bf16 v[60:63], v[10:13], v[188:191], 0
v_max3_f32 v103, v103, v87, v88
v_min3_f32 v106, v76, v77, v78
v_min3_f32 v106, v106, v79, v80
v_min3_f32 v106, v106, v81, v82
v_min_f32 v106, v106, v83
v_pk_mul_f32 v[234:235], v[234:235], v[66:67]
v_mfma_f32_16x16x32_bf16 v[64:67], v[14:17], v[188:191], 0
v_permlane32_swap_b32 v106, v107
v_min3_f32 v104, v60, v61, v62
v_min_f32 v106, v106, v107
v_max3_f32 v103, v103, v89, v90
v_pk_mul_f32 v[246:247], v[246:247], v[74:75]
v_mfma_f32_16x16x32_bf16 v[72:75], v[14:17], v[196:199], 0
v_max_f32 v103, v103, v91
v_max3_f32 v102, v76, v77, v78
v_min3_f32 v104, v104, v63, v64
v_min3_f32 v104, v104, v65, v66
v_min_f32 v104, v104, v67
v_max3_f32 v102, v102, v79, v80
v_max3_f32 v102, v102, v81, v82
v_max_f32 v102, v102, v83
v_min3_f32 v105, v105, v71, v72
v_min3_f32 v105, v105, v73, v74
v_min_f32 v105, v105, v75
v_max3_f32 v101, v101, v71, v72
v_max3_f32 v101, v101, v73, v74
v_permlane32_swap_b32 v104, v105
v_permlane32_swap_b32 v102, v103
v_min_f32 v104, v104, v105
v_max_f32 v102, v102, v103
v_max_f32 v101, v101, v75
v_permlane16_swap_b32 v104, v106
v_max3_f32 v100, v60, v61, v62
v_min_f32 v104, v104, v106
v_mov_b32 v106, v104
v_max3_f32 v100, v100, v63, v64
v_max3_f32 v100, v100, v65, v66
v_max_f32 v100, v100, v67
v_permlane16_swap_b32 v104, v106
v_cvt_pk_bf16_f32 v112, v220, v221
v_permlane32_swap_b32 v100, v101
v_mov_b32 v105, v104
v_max_f32 v100, v100, v101
v_mov_b32 v107, v106
v_permlane32_swap_b32 v104, v105
v_permlane16_swap_b32 v100, v102
v_pk_mul_f32 v[104:105], v[104:105], v[128:129]
v_pk_fma_f32 v[226:227], v[66:67], v[128:129], v[104:105] op_sel:[0,0,0] op_sel_hi:[1,0,0] neg_lo:[1,0,0] neg_hi:[1,0,0]
v_pk_fma_f32 v[230:231], v[70:71], v[128:129], v[104:105] op_sel:[0,1,1] op_sel_hi:[1,1,1] neg_lo:[1,0,0] neg_hi:[1,0,0]
v_exp_f32 v226, v226
v_pk_fma_f32 v[224:225], v[64:65], v[128:129], v[104:105] op_sel:[0,0,0] op_sel_hi:[1,0,0] neg_lo:[1,0,0] neg_hi:[1,0,0]
v_exp_f32 v224, v224
v_pk_fma_f32 v[228:229], v[68:69], v[128:129], v[104:105] op_sel:[0,1,1] op_sel_hi:[1,1,1] neg_lo:[1,0,0] neg_hi:[1,0,0]
v_exp_f32 v231, v231
v_cvt_pk_bf16_f32 v113, v222, v223
v_pk_fma_f32 v[222:223], v[62:63], v[128:129], v[104:105] op_sel:[0,0,0] op_sel_hi:[1,0,0] neg_lo:[1,0,0] neg_hi:[1,0,0]
v_exp_f32 v222, v222
v_pk_fma_f32 v[220:221], v[60:61], v[128:129], v[104:105] op_sel:[0,0,0] op_sel_hi:[1,0,0] neg_lo:[1,0,0] neg_hi:[1,0,0]
v_exp_f32 v221, v221
v_exp_f32 v220, v220
v_max_f32 v100, v100, v102
v_exp_f32 v223, v223
v_mov_b32 v102, v100
v_pk_add_f32 v[110:111], v[220:221], v[222:223]
v_exp_f32 v225, v225
v_pk_fma_f32 v[232:233], v[72:73], v[128:129], v[104:105] op_sel:[0,1,1] op_sel_hi:[1,1,1] neg_lo:[1,0,0] neg_hi:[1,0,0]
v_exp_f32 v232, v232
v_exp_f32 v233, v233
v_pk_add_f32 v[110:111], v[110:111], v[224:225]
v_exp_f32 v229, v229
v_exp_f32 v228, v228
v_exp_f32 v227, v227
v_cvt_pk_bf16_f32 v123, v234, v235
v_pk_fma_f32 v[234:235], v[74:75], v[128:129], v[104:105] op_sel:[0,1,1] op_sel_hi:[1,1,1] neg_lo:[1,0,0] neg_hi:[1,0,0]
v_pk_add_f32 v[110:111], v[110:111], v[226:227]
v_add_f32 v104, v110, v111
v_cvt_pk_bf16_f32 v118, v244, v245
v_permlane32_swap_b32 v106, v107
v_permlane16_swap_b32 v100, v102
v_exp_f32 v234, v234
v_mov_b32 v101, v100
v_exp_f32 v235, v235
v_exp_f32_e64 v230, v230
v_cvt_pk_bf16_f32 v125, v242, v243
v_pk_add_f32 v[110:111], v[228:229], v[230:231]
v_pk_add_f32 v[110:111], v[110:111], v[232:233]
v_pk_add_f32 v[110:111], v[110:111], v[234:235]
v_cvt_pk_bf16_f32 v126, v248, v249
v_pk_mul_f32 v[106:107], v[106:107], v[130:131]
v_pk_fma_f32 v[236:237], v[76:77], v[130:131], v[106:107] op_sel:[0,0,0] op_sel_hi:[1,0,0] neg_lo:[1,0,0] neg_hi:[1,0,0]
v_exp_f32 v237, v237
v_exp_f32 v236, v236
v_pk_fma_f32 v[242:243], v[82:83], v[130:131], v[106:107] op_sel:[0,0,0] op_sel_hi:[1,0,0] neg_lo:[1,0,0] neg_hi:[1,0,0]
v_pk_fma_f32 v[250:251], v[90:91], v[130:131], v[106:107] op_sel:[0,1,1] op_sel_hi:[1,1,1] neg_lo:[1,0,0] neg_hi:[1,0,0]
v_add_f32 v105, v110, v111
v_exp_f32 v243, v243
v_cvt_pk_bf16_f32 v119, v246, v247
v_pk_fma_f32 v[246:247], v[86:87], v[130:131], v[106:107] op_sel:[0,1,1] op_sel_hi:[1,1,1] neg_lo:[1,0,0] neg_hi:[1,0,0]
v_exp_f32 v246, v246
v_cvt_pk_bf16_f32 v117, v238, v239
v_pk_fma_f32 v[238:239], v[78:79], v[130:131], v[106:107] op_sel:[0,0,0] op_sel_hi:[1,0,0] neg_lo:[1,0,0] neg_hi:[1,0,0]
v_exp_f32 v238, v238
v_exp_f32 v247, v247
v_pk_fma_f32 v[240:241], v[80:81], v[130:131], v[106:107] op_sel:[0,0,0] op_sel_hi:[1,0,0] neg_lo:[1,0,0] neg_hi:[1,0,0]
v_exp_f32 v240, v240
v_exp_f32 v241, v241
v_permlane32_swap_b32 v100, v101
v_exp_f32 v242, v242
v_pk_fma_f32 v[244:245], v[84:85], v[130:131], v[106:107] op_sel:[0,1,1] op_sel_hi:[1,1,1] neg_lo:[1,0,0] neg_hi:[1,0,0]
v_exp_f32 v244, v244
v_exp_f32_e64 v239, v239
v_pk_mul_f32 v[100:101], v[100:101], v[128:129]
v_pk_fma_f32 v[62:63], v[62:63], v[128:129], v[100:101] op_sel:[0,0,0] op_sel_hi:[1,0,0] neg_lo:[0,0,1] neg_hi:[0,0,1]
v_pk_add_f32 v[110:111], v[236:237], v[238:239]
v_pk_add_f32 v[110:111], v[110:111], v[240:241]
v_pk_add_f32 v[110:111], v[110:111], v[242:243]
v_pk_fma_f32 v[72:73], v[72:73], v[128:129], v[100:101] op_sel:[0,1,1] op_sel_hi:[1,1,1] neg_lo:[0,0,1] neg_hi:[0,0,1]
v_pk_fma_f32 v[66:67], v[66:67], v[128:129], v[100:101] op_sel:[0,0,0] op_sel_hi:[1,0,0] neg_lo:[0,0,1] neg_hi:[0,0,1]
v_exp_f32 v62, v62
v_pk_fma_f32 v[60:61], v[60:61], v[128:129], v[100:101] op_sel:[0,0,0] op_sel_hi:[1,0,0] neg_lo:[0,0,1] neg_hi:[0,0,1]
v_exp_f32 v60, v60
v_exp_f32 v245, v245
v_exp_f32 v73, v73
v_pk_fma_f32 v[248:249], v[88:89], v[130:131], v[106:107] op_sel:[0,1,1] op_sel_hi:[1,1,1] neg_lo:[1,0,0] neg_hi:[1,0,0]
v_add_f32 v106, v110, v111
v_exp_f32 v249, v249
v_pk_add_f32 v[110:111], v[244:245], v[246:247]
v_exp_f32 v248, v248
v_pk_fma_f32 v[64:65], v[64:65], v[128:129], v[100:101] op_sel:[0,0,0] op_sel_hi:[1,0,0] neg_lo:[0,0,1] neg_hi:[0,0,1]
v_exp_f32 v64, v64
v_pk_add_f32 v[110:111], v[110:111], v[248:249]
v_exp_f32 v65, v65
v_exp_f32 v61, v61
v_exp_f32 v66, v66
v_exp_f32 v251, v251
v_exp_f32 v63, v63
v_pk_fma_f32 v[74:75], v[74:75], v[128:129], v[100:101] op_sel:[0,1,1] op_sel_hi:[1,1,1] neg_lo:[0,0,1] neg_hi:[0,0,1]
v_pk_add_f32 v[108:109], v[60:61], v[62:63]
v_exp_f32 v67, v67
v_exp_f32 v250, v250
v_pk_fma_f32 v[68:69], v[68:69], v[128:129], v[100:101] op_sel:[0,1,1] op_sel_hi:[1,1,1] neg_lo:[0,0,1] neg_hi:[0,0,1]
v_pk_add_f32 v[110:111], v[110:111], v[250:251]
v_exp_f32 v68, v68
v_exp_f32 v69, v69
v_add_f32 v107, v110, v111
v_mov_b32 v103, v102
v_pk_fma_f32 v[70:71], v[70:71], v[128:129], v[100:101] op_sel:[0,1,1] op_sel_hi:[1,1,1] neg_lo:[0,0,1] neg_hi:[0,0,1]
v_exp_f32 v71, v71
v_exp_f32 v70, v70
v_permlane32_swap_b32 v106, v107
v_permlane32_swap_b32 v102, v103
v_pk_add_f32 v[108:109], v[108:109], v[64:65]
v_pk_add_f32 v[108:109], v[108:109], v[66:67]
v_add_f32 v100, v108, v109
v_pk_add_f32 v[108:109], v[68:69], v[70:71]
v_pk_mul_f32 v[102:103], v[102:103], v[130:131]
v_pk_fma_f32 v[78:79], v[78:79], v[130:131], v[102:103] op_sel:[0,0,0] op_sel_hi:[1,0,0] neg_lo:[0,0,1] neg_hi:[0,0,1]
v_exp_f32 v79, v79
v_exp_f32 v78, v78
v_exp_f32 v74, v74
v_exp_f32 v72, v72
v_pk_fma_f32 v[86:87], v[86:87], v[130:131], v[102:103] op_sel:[0,1,1] op_sel_hi:[1,1,1] neg_lo:[0,0,1] neg_hi:[0,0,1]
v_exp_f32 v87, v87
v_pk_fma_f32 v[76:77], v[76:77], v[130:131], v[102:103] op_sel:[0,0,0] op_sel_hi:[1,0,0] neg_lo:[0,0,1] neg_hi:[0,0,1]
v_exp_f32 v77, v77
v_add_f32 v106, v106, v107
v_pk_fma_f32 v[80:81], v[80:81], v[130:131], v[102:103] op_sel:[0,0,0] op_sel_hi:[1,0,0] neg_lo:[0,0,1] neg_hi:[0,0,1]
v_exp_f32 v81, v81
v_exp_f32 v80, v80
v_pk_add_f32 v[108:109], v[108:109], v[72:73]
v_permlane32_swap_b32 v104, v105
v_exp_f32 v75, v75
v_add_f32 v104, v104, v105
v_pk_fma_f32 v[82:83], v[82:83], v[130:131], v[102:103] op_sel:[0,0,0] op_sel_hi:[1,0,0] neg_lo:[0,0,1] neg_hi:[0,0,1]
v_exp_f32 v82, v82
v_exp_f32 v83, v83
v_permlane16_swap_b32 v104, v106
v_pk_add_f32 v[108:109], v[108:109], v[74:75]
v_add_f32 v101, v108, v109
v_exp_f32 v76, v76
v_add_f32 v104, v104, v106
v_rcp_f32 v104, v104
v_pk_fma_f32 v[84:85], v[84:85], v[130:131], v[102:103] op_sel:[0,1,1] op_sel_hi:[1,1,1] neg_lo:[0,0,1] neg_hi:[0,0,1]
v_exp_f32 v84, v84
v_exp_f32 v85, v85
v_mov_b32 v106, v104
v_pk_add_f32 v[108:109], v[76:77], v[78:79]
v_pk_add_f32 v[108:109], v[108:109], v[80:81]
v_pk_add_f32 v[108:109], v[108:109], v[82:83]
v_pk_fma_f32 v[88:89], v[88:89], v[130:131], v[102:103] op_sel:[0,1,1] op_sel_hi:[1,1,1] neg_lo:[0,0,1] neg_hi:[0,0,1]
v_exp_f32 v88, v88
v_exp_f32 v89, v89
v_exp_f32 v86, v86
v_pk_fma_f32 v[90:91], v[90:91], v[130:131], v[102:103] op_sel:[0,1,1] op_sel_hi:[1,1,1] neg_lo:[0,0,1] neg_hi:[0,0,1]
v_add_f32 v102, v108, v109
v_pk_add_f32 v[108:109], v[84:85], v[86:87]
v_pk_add_f32 v[108:109], v[108:109], v[88:89]
v_permlane16_swap_b32 v104, v106
v_exp_f32 v90, v90
v_exp_f32 v91, v91
v_permlane32_swap_b32 v100, v101
v_pk_add_f32 v[108:109], v[108:109], v[90:91]
v_add_f32 v103, v108, v109
v_add_f32 v100, v100, v101
v_mov_b32 v105, v104
v_permlane32_swap_b32 v102, v103
v_mov_b32 v107, v106
v_add_f32 v102, v102, v103
v_permlane32_swap_b32 v104, v105
v_permlane32_swap_b32 v106, v107
v_permlane16_swap_b32 v100, v102
v_pk_mul_f32 v[222:223], v[222:223], v[104:105] op_sel:[0,0] op_sel_hi:[1,0]
v_pk_mul_f32 v[226:227], v[226:227], v[104:105] op_sel:[0,0] op_sel_hi:[1,0]
v_pk_mul_f32 v[234:235], v[234:235], v[104:105] op_sel:[0,1] op_sel_hi:[1,1]
v_pk_mul_f32 v[232:233], v[232:233], v[104:105] op_sel:[0,1] op_sel_hi:[1,1]
v_pk_mul_f32 v[230:231], v[230:231], v[104:105] op_sel:[0,1] op_sel_hi:[1,1]
v_add_f32 v100, v100, v102
v_pk_mul_f32 v[228:229], v[228:229], v[104:105] op_sel:[0,1] op_sel_hi:[1,1]
v_cvt_pk_bf16_f32 v228, v228, v229
v_cvt_pk_bf16_f32 v229, v230, v231
v_cvt_pk_bf16_f32 v231, v234, v235
v_cvt_pk_bf16_f32 v230, v232, v233
v_pk_mul_f32 v[220:221], v[220:221], v[104:105] op_sel:[0,0] op_sel_hi:[1,0]
v_cvt_pk_bf16_f32 v220, v220, v221
v_pk_mul_f32 v[224:225], v[224:225], v[104:105] op_sel:[0,0] op_sel_hi:[1,0]
v_pk_mul_f32 v[236:237], v[236:237], v[106:107] op_sel:[0,0] op_sel_hi:[1,0]
v_pk_mul_f32 v[238:239], v[238:239], v[106:107] op_sel:[0,0] op_sel_hi:[1,0]
v_pk_mul_f32 v[240:241], v[240:241], v[106:107] op_sel:[0,0] op_sel_hi:[1,0]
v_pk_mul_f32 v[242:243], v[242:243], v[106:107] op_sel:[0,0] op_sel_hi:[1,0]
v_pk_mul_f32 v[248:249], v[248:249], v[106:107] op_sel:[0,1] op_sel_hi:[1,1]
v_rcp_f32 v100, v100
v_pk_mul_f32 v[244:245], v[244:245], v[106:107] op_sel:[0,1] op_sel_hi:[1,1]
v_mov_b32 v102, v100
v_pk_mul_f32 v[250:251], v[250:251], v[106:107] op_sel:[0,1] op_sel_hi:[1,1]
v_cvt_pk_bf16_f32 v221, v222, v223
v_pk_mul_f32 v[246:247], v[246:247], v[106:107] op_sel:[0,1] op_sel_hi:[1,1]
v_cvt_pk_bf16_f32 v222, v224, v225
v_mfma_f32_16x16x32_bf16 v[200:203], v[228:231], v[36:39], 0
v_cvt_pk_bf16_f32 v223, v226, v227
v_permlane16_swap_b32 v100, v102
v_mfma_f32_16x16x32_bf16 v[196:199], v[228:231], v[38:41], 0
v_mov_b32 v101, v100
v_cvt_pk_bf16_f32 v244, v244, v245
v_mfma_f32_16x16x32_bf16 v[212:215], v[220:223], v[38:41], 0
v_cvt_pk_bf16_f32 v245, v246, v247
v_cvt_pk_bf16_f32 v247, v250, v251
v_mfma_f32_16x16x32_bf16 v[216:219], v[220:223], v[36:39], 0
v_cvt_pk_bf16_f32 v234, v200, v201
v_cvt_pk_bf16_f32 v246, v248, v249
v_cvt_pk_bf16_f32 v226, v196, v197
v_cvt_pk_bf16_f32 v227, v198, v199
v_mfma_f32_16x16x32_bf16 v[196:199], v[244:247], v[38:41], 0
v_cvt_pk_bf16_f32 v225, v214, v215
v_cvt_pk_bf16_f32 v236, v236, v237
v_cvt_pk_bf16_f32 v237, v238, v239
v_cvt_pk_bf16_f32 v232, v216, v217
v_cvt_pk_bf16_f32 v233, v218, v219
v_cvt_pk_bf16_f32 v239, v242, v243
v_cvt_pk_bf16_f32 v238, v240, v241
v_cvt_pk_bf16_f32 v224, v212, v213
v_permlane32_swap_b32 v100, v101
v_mfma_f32_16x16x32_bf16 v[216:219], v[236:239], v[36:39], 0
v_mov_b32 v103, v102
v_cvt_pk_bf16_f32 v235, v202, v203
v_mfma_f32_16x16x32_bf16 v[212:215], v[236:239], v[38:41], 0
v_cvt_pk_bf16_f32 v243, v198, v199
v_permlane32_swap_b32 v102, v103
v_mfma_f32_16x16x32_bf16 v[200:203], v[244:247], v[36:39], 0
v_cvt_pk_bf16_f32 v242, v196, v197
v_mov_b32 v5, s61
v_mfma_f32_16x16x32_bf16 v[220:223], v[232:235], v[120:123], 0
v_cvt_pk_bf16_f32 v249, v218, v219
v_cvt_pk_bf16_f32 v248, v216, v217
v_cvt_pk_bf16_f32 v241, v214, v215
v_cvt_pk_bf16_f32 v240, v212, v213
v_cmp_eq_u32 s[50:51], s41, v2
v_pk_mul_f32 v[64:65], v[64:65], v[100:101] op_sel:[0,0] op_sel_hi:[1,0]
v_pk_mul_f32 v[74:75], v[74:75], v[100:101] op_sel:[0,1] op_sel_hi:[1,1]
v_pk_mul_f32 v[68:69], v[68:69], v[100:101] op_sel:[0,1] op_sel_hi:[1,1]
v_pk_mul_f32 v[72:73], v[72:73], v[100:101] op_sel:[0,1] op_sel_hi:[1,1]
v_pk_mul_f32 v[60:61], v[60:61], v[100:101] op_sel:[0,0] op_sel_hi:[1,0]
v_pk_mul_f32 v[62:63], v[62:63], v[100:101] op_sel:[0,0] op_sel_hi:[1,0]
v_pk_mul_f32 v[66:67], v[66:67], v[100:101] op_sel:[0,0] op_sel_hi:[1,0]
v_pk_mul_f32 v[76:77], v[76:77], v[102:103] op_sel:[0,0] op_sel_hi:[1,0]
v_pk_mul_f32 v[70:71], v[70:71], v[100:101] op_sel:[0,1] op_sel_hi:[1,1]
v_cvt_pk_bf16_f32 v60, v60, v61
v_pk_mul_f32 v[80:81], v[80:81], v[102:103] op_sel:[0,0] op_sel_hi:[1,0]
v_pk_mul_f32 v[78:79], v[78:79], v[102:103] op_sel:[0,0] op_sel_hi:[1,0]
v_pk_mul_f32 v[82:83], v[82:83], v[102:103] op_sel:[0,0] op_sel_hi:[1,0]
v_pk_mul_f32 v[86:87], v[86:87], v[102:103] op_sel:[0,1] op_sel_hi:[1,1]
v_cvt_pk_bf16_f32 v61, v62, v63
v_pk_mul_f32 v[84:85], v[84:85], v[102:103] op_sel:[0,1] op_sel_hi:[1,1]
v_cvt_pk_bf16_f32 v62, v64, v65
v_pk_mul_f32 v[88:89], v[88:89], v[102:103] op_sel:[0,1] op_sel_hi:[1,1]
v_cvt_pk_bf16_f32 v63, v66, v67
v_pk_mul_f32 v[90:91], v[90:91], v[102:103] op_sel:[0,1] op_sel_hi:[1,1]
v_cvt_pk_bf16_f32 v68, v68, v69
v_mfma_f32_16x16x32_bf16 v[208:211], v[60:63], v[36:39], 0
v_cvt_pk_bf16_f32 v69, v70, v71
v_cvt_pk_bf16_f32 v70, v72, v73
v_mfma_f32_16x16x32_bf16 v[204:207], v[60:63], v[38:41], 0
v_cvt_pk_bf16_f32 v71, v74, v75
v_cvt_pk_bf16_f32 v76, v76, v77
v_mfma_f32_16x16x32_bf16 v[60:63], v[232:235], v[112:115], 0
v_cvt_pk_bf16_f32 v250, v200, v201
v_cvt_pk_bf16_f32 v77, v78, v79
v_mfma_f32_16x16x32_bf16 v[192:195], v[68:71], v[36:39], 0
v_cvt_pk_bf16_f32 v78, v80, v81
v_cvt_pk_bf16_f32 v79, v82, v83
v_mfma_f32_16x16x32_bf16 v[188:191], v[68:71], v[38:41], 0
v_cvt_pk_bf16_f32 v65, v206, v207
v_cvt_pk_bf16_f32 v64, v204, v205
v_mfma_f32_16x16x32_bf16 v[68:71], v[224:227], v[120:123], 0
v_cvt_pk_bf16_f32 v251, v202, v203
v_cvt_pk_bf16_f32 v72, v208, v209
v_mfma_f32_16x16x32_bf16 v[152:155], v[224:227], v[112:115], 0
v_cvt_pk_bf16_f32 v73, v210, v211
v_cvt_pk_bf16_f32 v84, v84, v85
v_mfma_f32_16x16x32_bf16 v[60:63], v[248:251], v[116:119], v[60:63]
v_cvt_pk_bf16_f32 v85, v86, v87
v_cvt_pk_bf16_f32 v86, v88, v89
v_mfma_f32_16x16x32_bf16 v[228:231], v[224:227], v[48:51], 0
v_cvt_pk_bf16_f32 v67, v190, v191
v_cvt_pk_bf16_f32 v87, v90, v91
v_mfma_f32_16x16x32_bf16 v[220:223], v[248:251], v[124:127], v[220:223]
v_cvt_pk_bf16_f32 v66, v188, v189
v_cvt_pk_bf16_f32 v74, v192, v193
v_mfma_f32_16x16x32_bf16 v[152:155], v[240:243], v[116:119], v[152:155]
v_cvt_pk_bf16_f32 v75, v194, v195
v_mfma_f32_16x16x32_bf16 v[204:207], v[76:79], v[38:41], 0
v_mfma_f32_16x16x32_bf16 v[208:211], v[76:79], v[36:39], 0
v_mfma_f32_16x16x32_bf16 v[228:231], v[240:243], v[48:51], v[228:231]
v_mfma_f32_16x16x32_bf16 v[68:71], v[240:243], v[124:127], v[68:71]
v_mfma_f32_16x16x32_bf16 v[76:79], v[232:235], v[48:51], 0
s_nop 1
v_cvt_pk_bf16_f32 v152, v152, v153
v_mfma_f32_16x16x32_bf16 v[76:79], v[248:251], v[48:51], v[76:79]
v_cvt_pk_bf16_f32 v153, v154, v155
v_cvt_pk_bf16_f32 v154, v60, v61
v_mfma_f32_16x16x32_bf16 v[192:195], v[84:87], v[36:39], 0
v_cvt_pk_bf16_f32 v68, v68, v69
v_cvt_pk_bf16_f32 v155, v62, v63
v_mfma_f32_16x16x32_bf16 v[188:191], v[84:87], v[38:41], 0
ds_write_b128 v42, v[152:155] offset:0
v_mfma_f32_16x16x32_bf16 v[136:139], v[64:67], v[48:51], 0
v_cvt_pk_bf16_f32 v69, v70, v71
v_cvt_pk_bf16_f32 v228, v228, v229
v_mfma_f32_16x16x32_bf16 v[104:107], v[72:75], v[112:115], 0
v_cvt_pk_bf16_f32 v71, v222, v223
v_cvt_pk_bf16_f32 v229, v230, v231
v_mfma_f32_16x16x32_bf16 v[148:151], v[72:75], v[48:51], 0
v_cvt_pk_bf16_f32 v230, v76, v77
v_cvt_pk_bf16_f32 v70, v220, v221
v_mfma_f32_16x16x32_bf16 v[132:135], v[72:75], v[120:123], 0
ds_write_b128 v42, v[68:71] offset:1024
v_mfma_f32_16x16x32_bf16 v[108:111], v[64:67], v[120:123], 0
v_cvt_pk_bf16_f32 v231, v78, v79
ds_write_b128 v42, v[228:231] offset:2048
v_mfma_f32_16x16x32_bf16 v[100:103], v[64:67], v[112:115], 0
ds_write_b32 v52, v5
v_cvt_pk_bf16_f32 v88, v208, v209
v_cvt_pk_bf16_f32 v83, v190, v191
v_cvt_pk_bf16_f32 v91, v194, v195
v_cvt_pk_bf16_f32 v82, v188, v189
v_cvt_pk_bf16_f32 v80, v204, v205
v_cvt_pk_bf16_f32 v89, v210, v211
v_cvt_pk_bf16_f32 v81, v206, v207
v_cvt_pk_bf16_f32 v90, v192, v193
s_nop 0
v_mfma_f32_16x16x32_bf16 v[100:103], v[80:83], v[116:119], v[100:103]
v_mfma_f32_16x16x32_bf16 v[108:111], v[80:83], v[124:127], v[108:111]
v_mfma_f32_16x16x32_bf16 v[132:135], v[88:91], v[124:127], v[132:135]
v_mfma_f32_16x16x32_bf16 v[148:151], v[88:91], v[48:51], v[148:151]
v_mfma_f32_16x16x32_bf16 v[136:139], v[80:83], v[48:51], v[136:139]
v_mfma_f32_16x16x32_bf16 v[104:107], v[88:91], v[116:119], v[104:107]
s_mov_b32 s63, 0
px_84:
ds_read_b32 v4, v19
ds_read_b128 v[188:191], v43 offset:0
ds_read_b128 v[192:195], v43 offset:1024
ds_read_b128 v[196:199], v43 offset:2048
s_add_u32 s63, s63, 1
s_cmp_lt_u32 s63, 0x400000
s_waitcnt lgkmcnt(0)
v_cmp_ne_u32 vcc, s61, v4
s_cbranch_vccz pxd_85
s_cbranch_scc1 px_84
pxd_85:
v_mfma_f32_16x16x32_bf16 v[100:103], v[38:41], v[188:191], v[100:103]
v_mfma_f32_16x16x32_bf16 v[104:107], v[36:39], v[188:191], v[104:107]
v_mfma_f32_16x16x32_bf16 v[108:111], v[38:41], v[192:195], v[108:111]
v_mfma_f32_16x16x32_bf16 v[132:135], v[36:39], v[192:195], v[132:135]
v_mfma_f32_16x16x32_bf16 v[136:139], v[38:41], v[196:199], v[136:139]
v_mfma_f32_16x16x32_bf16 v[148:151], v[36:39], v[196:199], v[148:151]
s_nop 2
v_cvt_pk_bf16_f32 v100, v100, v101
v_cvt_pk_bf16_f32 v101, v102, v103
v_cvt_pk_bf16_f32 v102, v104, v105
v_cvt_pk_bf16_f32 v103, v106, v107
buffer_store_dwordx4 v[100:103], v55, s[32:35], s53 offen sc1
v_cvt_pk_bf16_f32 v108, v108, v109
v_cvt_pk_bf16_f32 v109, v110, v111
v_cvt_pk_bf16_f32 v110, v132, v133
v_cvt_pk_bf16_f32 v111, v134, v135
buffer_store_dwordx4 v[108:111], v55, s[32:35], s54 offen sc1
v_cvt_pk_bf16_f32 v136, v136, v137
v_cvt_pk_bf16_f32 v137, v138, v139
v_cvt_pk_bf16_f32 v138, v148, v149
v_cvt_pk_bf16_f32 v139, v150, v151
s_mov_b64 exec, s[50:51]
buffer_store_dwordx4 v[136:139], v58, s[32:35], s56 offen sc1
s_mov_b64 exec, -1
s_mov_b32 s51, 0
.p2align 3
v_pk_fma_f32 v[156:157], v[140:141], v[92:93], v[156:157] op_sel:[0,1,0] op_sel_hi:[1,1,1]
v_pk_fma_f32 v[164:165], v[140:141], v[94:95], v[164:165] op_sel:[0,1,0] op_sel_hi:[1,1,1]
v_pk_fma_f32 v[172:173], v[140:141], v[96:97], v[172:173] op_sel:[0,1,0] op_sel_hi:[1,1,1]
v_pk_fma_f32 v[180:181], v[140:141], v[98:99], v[180:181] op_sel:[0,1,0] op_sel_hi:[1,1,1]
v_pk_fma_f32 v[158:159], v[142:143], v[92:93], v[158:159] op_sel:[0,1,0] op_sel_hi:[1,1,1]
v_cvt_pk_bf16_f32 v156, v156, v157
v_pk_fma_f32 v[166:167], v[142:143], v[94:95], v[166:167] op_sel:[0,1,0] op_sel_hi:[1,1,1]
v_cvt_pk_bf16_f32 v164, v164, v165
v_pk_fma_f32 v[174:175], v[142:143], v[96:97], v[174:175] op_sel:[0,1,0] op_sel_hi:[1,1,1]
v_cvt_pk_bf16_f32 v172, v172, v173
v_pk_fma_f32 v[182:183], v[142:143], v[98:99], v[182:183] op_sel:[0,1,0] op_sel_hi:[1,1,1]
v_cvt_pk_bf16_f32 v180, v180, v181
v_pk_fma_f32 v[160:161], v[144:145], v[92:93], v[160:161] op_sel:[0,1,0] op_sel_hi:[1,1,1]
v_pk_fma_f32 v[162:163], v[146:147], v[92:93], v[162:163] op_sel:[0,1,0] op_sel_hi:[1,1,1]
v_cvt_pk_bf16_f32 v157, v158, v159
v_pk_fma_f32 v[168:169], v[144:145], v[94:95], v[168:169] op_sel:[0,1,0] op_sel_hi:[1,1,1]
v_pk_fma_f32 v[170:171], v[146:147], v[94:95], v[170:171] op_sel:[0,1,0] op_sel_hi:[1,1,1]
v_cvt_pk_bf16_f32 v165, v166, v167
v_pk_fma_f32 v[176:177], v[144:145], v[96:97], v[176:177] op_sel:[0,1,0] op_sel_hi:[1,1,1]
v_pk_fma_f32 v[178:179], v[146:147], v[96:97], v[178:179] op_sel:[0,1,0] op_sel_hi:[1,1,1]
v_cvt_pk_bf16_f32 v173, v174, v175
v_pk_fma_f32 v[184:185], v[144:145], v[98:99], v[184:185] op_sel:[0,1,0] op_sel_hi:[1,1,1]
v_pk_fma_f32 v[186:187], v[146:147], v[98:99], v[186:187] op_sel:[0,1,0] op_sel_hi:[1,1,1]
v_cvt_pk_bf16_f32 v181, v182, v183
v_cvt_pk_bf16_f32 v158, v160, v161
v_cvt_pk_bf16_f32 v159, v162, v163
v_cvt_pk_bf16_f32 v166, v168, v169
v_cvt_pk_bf16_f32 v167, v170, v171
v_mfma_f32_16x16x32_bf16 v[60:63], v[10:13], v[156:159], 0
v_cvt_pk_bf16_f32 v174, v176, v177
v_cvt_pk_bf16_f32 v175, v178, v179
v_mfma_f32_16x16x32_bf16 v[68:71], v[10:13], v[164:167], 0
v_cvt_pk_bf16_f32 v182, v184, v185
v_cvt_pk_bf16_f32 v183, v186, v187
v_mfma_f32_16x16x32_bf16 v[76:79], v[10:13], v[172:175], 0
s_nop 0
v_mfma_f32_16x16x32_bf16 v[84:87], v[10:13], v[180:183], 0
v_min3_f32 v104, v60, v61, v62
v_max3_f32 v100, v60, v61, v62
v_mfma_f32_16x16x32_bf16 v[64:67], v[14:17], v[156:159], 0
v_min3_f32 v105, v68, v69, v70
v_max3_f32 v101, v68, v69, v70
v_mfma_f32_16x16x32_bf16 v[72:75], v[14:17], v[164:167], 0
v_min3_f32 v106, v76, v77, v78
v_max3_f32 v102, v76, v77, v78
v_mfma_f32_16x16x32_bf16 v[80:83], v[14:17], v[172:175], 0
v_min3_f32 v107, v84, v85, v86
v_max3_f32 v103, v84, v85, v86
v_mfma_f32_16x16x32_bf16 v[88:91], v[14:17], v[180:183], 0
v_min3_f32 v104, v104, v63, v64
v_max3_f32 v100, v100, v63, v64
v_min3_f32 v105, v105, v71, v72
v_min3_f32 v104, v104, v65, v66
v_max3_f32 v101, v101, v71, v72
v_min3_f32 v106, v106, v79, v80
v_min3_f32 v105, v105, v73, v74
v_max3_f32 v102, v102, v79, v80
v_min3_f32 v107, v107, v87, v88
v_min3_f32 v106, v106, v81, v82
v_max3_f32 v103, v103, v87, v88
v_min3_f32 v107, v107, v89, v90
v_max3_f32 v100, v100, v65, v66
v_min_f32 v104, v104, v67
v_max3_f32 v101, v101, v73, v74
v_min_f32 v105, v105, v75
v_max3_f32 v102, v102, v81, v82
v_min_f32 v106, v106, v83
v_max3_f32 v103, v103, v89, v90
v_min_f32 v107, v107, v91
v_max_f32 v100, v100, v67
v_max_f32 v101, v101, v75
v_max_f32 v102, v102, v83
v_max_f32 v103, v103, v91
v_permlane32_swap_b32 v104, v105
v_permlane32_swap_b32 v106, v107
v_permlane32_swap_b32 v100, v101
v_permlane32_swap_b32 v102, v103
v_min_f32 v104, v104, v105
v_min_f32 v106, v106, v107
v_max_f32 v100, v100, v101
v_max_f32 v102, v102, v103
v_permlane16_swap_b32 v104, v106
s_nop 0
v_permlane16_swap_b32 v100, v102
v_min_f32 v104, v104, v106
v_max_f32 v100, v100, v102
v_mov_b32 v106, v104
v_mov_b32 v102, v100
s_nop 0
v_permlane16_swap_b32 v104, v106
v_permlane16_swap_b32 v100, v102
v_mov_b32 v105, v104
v_mov_b32 v101, v100
v_mov_b32 v103, v102
v_permlane32_swap_b32 v104, v105
v_mov_b32 v107, v106
v_permlane32_swap_b32_e64 v100, v101
v_pk_mul_f32 v[104:105], v[104:105], v[128:129]
v_pk_mul_f32 v[100:101], v[100:101], v[128:129]
v_pk_fma_f32 v[220:221], v[60:61], v[128:129], v[104:105] op_sel:[0,0,0] op_sel_hi:[1,0,0] neg_lo:[1,0,0] neg_hi:[1,0,0]
v_pk_fma_f32 v[222:223], v[62:63], v[128:129], v[104:105] op_sel:[0,0,0] op_sel_hi:[1,0,0] neg_lo:[1,0,0] neg_hi:[1,0,0]
v_pk_fma_f32 v[224:225], v[64:65], v[128:129], v[104:105] op_sel:[0,0,0] op_sel_hi:[1,0,0] neg_lo:[1,0,0] neg_hi:[1,0,0]
v_pk_fma_f32 v[226:227], v[66:67], v[128:129], v[104:105] op_sel:[0,0,0] op_sel_hi:[1,0,0] neg_lo:[1,0,0] neg_hi:[1,0,0]
v_pk_fma_f32 v[228:229], v[68:69], v[128:129], v[104:105] op_sel:[0,1,1] op_sel_hi:[1,1,1] neg_lo:[1,0,0] neg_hi:[1,0,0]
v_pk_fma_f32 v[230:231], v[70:71], v[128:129], v[104:105] op_sel:[0,1,1] op_sel_hi:[1,1,1] neg_lo:[1,0,0] neg_hi:[1,0,0]
v_pk_fma_f32 v[232:233], v[72:73], v[128:129], v[104:105] op_sel:[0,1,1] op_sel_hi:[1,1,1] neg_lo:[1,0,0] neg_hi:[1,0,0]
v_pk_fma_f32 v[234:235], v[74:75], v[128:129], v[104:105] op_sel:[0,1,1] op_sel_hi:[1,1,1] neg_lo:[1,0,0] neg_hi:[1,0,0]
v_permlane32_swap_b32 v102, v103
v_permlane32_swap_b32 v106, v107
v_pk_fma_f32 v[60:61], v[60:61], v[128:129], v[100:101] op_sel:[0,0,0] op_sel_hi:[1,0,0] neg_lo:[0,0,1] neg_hi:[0,0,1]
v_pk_fma_f32 v[62:63], v[62:63], v[128:129], v[100:101] op_sel:[0,0,0] op_sel_hi:[1,0,0] neg_lo:[0,0,1] neg_hi:[0,0,1]
v_pk_fma_f32 v[64:65], v[64:65], v[128:129], v[100:101] op_sel:[0,0,0] op_sel_hi:[1,0,0] neg_lo:[0,0,1] neg_hi:[0,0,1]
v_pk_fma_f32 v[66:67], v[66:67], v[128:129], v[100:101] op_sel:[0,0,0] op_sel_hi:[1,0,0] neg_lo:[0,0,1] neg_hi:[0,0,1]
v_pk_fma_f32 v[68:69], v[68:69], v[128:129], v[100:101] op_sel:[0,1,1] op_sel_hi:[1,1,1] neg_lo:[0,0,1] neg_hi:[0,0,1]
v_pk_fma_f32 v[70:71], v[70:71], v[128:129], v[100:101] op_sel:[0,1,1] op_sel_hi:[1,1,1] neg_lo:[0,0,1] neg_hi:[0,0,1]
v_pk_fma_f32 v[72:73], v[72:73], v[128:129], v[100:101] op_sel:[0,1,1] op_sel_hi:[1,1,1] neg_lo:[0,0,1] neg_hi:[0,0,1]
v_pk_fma_f32 v[74:75], v[74:75], v[128:129], v[100:101] op_sel:[0,1,1] op_sel_hi:[1,1,1] neg_lo:[0,0,1] neg_hi:[0,0,1]
v_exp_f32 v220, v220
v_exp_f32 v60, v60
v_exp_f32 v221, v221
v_exp_f32 v61, v61
v_exp_f32 v222, v222
v_exp_f32 v62, v62
v_exp_f32 v223, v223
v_exp_f32 v63, v63
v_exp_f32 v224, v224
v_exp_f32 v64, v64
v_exp_f32 v225, v225
v_exp_f32 v65, v65
v_exp_f32 v226, v226
v_exp_f32 v66, v66
v_exp_f32 v227, v227
v_exp_f32 v67, v67
v_exp_f32 v228, v228
v_exp_f32 v68, v68
v_exp_f32 v229, v229
v_exp_f32 v69, v69
v_exp_f32 v230, v230
v_exp_f32 v70, v70
v_exp_f32 v231, v231
v_exp_f32 v71, v71
v_exp_f32 v232, v232
v_exp_f32 v72, v72
v_exp_f32 v233, v233
v_exp_f32 v73, v73
v_exp_f32 v234, v234
v_exp_f32 v74, v74
v_exp_f32 v235, v235
v_exp_f32 v75, v75
v_pk_mul_f32 v[102:103], v[102:103], v[130:131]
v_pk_mul_f32 v[106:107], v[106:107], v[130:131]
buffer_load_dwordx4 v[212:215], v18, s[32:35], s55 offen offset:0 sc1
buffer_load_dwordx4 v[216:219], v18, s[32:35], s55 offen offset:1024 sc1
.p2align 3
v_pk_add_f32 v[108:109], v[60:61], v[62:63]
v_pk_add_f32 v[110:111], v[220:221], v[222:223]
v_pk_add_f32 v[108:109], v[108:109], v[64:65]
v_pk_add_f32 v[110:111], v[110:111], v[224:225]
v_pk_add_f32 v[108:109], v[108:109], v[66:67]
v_pk_add_f32 v[110:111], v[110:111], v[226:227]
v_add_f32 v100, v108, v109
v_add_f32 v104, v110, v111
v_pk_fma_f32 v[236:237], v[76:77], v[130:131], v[106:107] op_sel:[0,0,0] op_sel_hi:[1,0,0] neg_lo:[1,0,0] neg_hi:[1,0,0]
v_pk_fma_f32 v[238:239], v[78:79], v[130:131], v[106:107] op_sel:[0,0,0] op_sel_hi:[1,0,0] neg_lo:[1,0,0] neg_hi:[1,0,0]
v_pk_add_f32 v[108:109], v[68:69], v[70:71]
v_pk_add_f32 v[110:111], v[228:229], v[230:231]
v_pk_fma_f32 v[76:77], v[76:77], v[130:131], v[102:103] op_sel:[0,0,0] op_sel_hi:[1,0,0] neg_lo:[0,0,1] neg_hi:[0,0,1]
v_pk_fma_f32 v[78:79], v[78:79], v[130:131], v[102:103] op_sel:[0,0,0] op_sel_hi:[1,0,0] neg_lo:[0,0,1] neg_hi:[0,0,1]
v_pk_fma_f32 v[240:241], v[80:81], v[130:131], v[106:107] op_sel:[0,0,0] op_sel_hi:[1,0,0] neg_lo:[1,0,0] neg_hi:[1,0,0]
v_pk_add_f32 v[108:109], v[108:109], v[72:73]
v_pk_add_f32 v[110:111], v[110:111], v[232:233]
v_exp_f32 v236, v236
v_exp_f32 v76, v76
v_exp_f32 v237, v237
v_exp_f32 v77, v77
v_exp_f32 v238, v238
v_exp_f32 v78, v78
v_exp_f32 v239, v239
v_exp_f32 v79, v79
v_pk_fma_f32 v[80:81], v[80:81], v[130:131], v[102:103] op_sel:[0,0,0] op_sel_hi:[1,0,0] neg_lo:[0,0,1] neg_hi:[0,0,1]
v_pk_fma_f32 v[242:243], v[82:83], v[130:131], v[106:107] op_sel:[0,0,0] op_sel_hi:[1,0,0] neg_lo:[1,0,0] neg_hi:[1,0,0]
v_pk_add_f32 v[108:109], v[108:109], v[74:75]
v_pk_add_f32 v[110:111], v[110:111], v[234:235]
v_exp_f32 v240, v240
v_exp_f32 v80, v80
v_exp_f32 v241, v241
v_exp_f32 v81, v81
v_pk_fma_f32 v[82:83], v[82:83], v[130:131], v[102:103] op_sel:[0,0,0] op_sel_hi:[1,0,0] neg_lo:[0,0,1] neg_hi:[0,0,1]
v_add_f32 v101, v108, v109
v_add_f32 v105, v110, v111
v_exp_f32 v242, v242
v_exp_f32 v82, v82
v_exp_f32 v243, v243
v_exp_f32 v83, v83
v_pk_fma_f32 v[244:245], v[84:85], v[130:131], v[106:107] op_sel:[0,1,1] op_sel_hi:[1,1,1] neg_lo:[1,0,0] neg_hi:[1,0,0]
v_pk_fma_f32 v[246:247], v[86:87], v[130:131], v[106:107] op_sel:[0,1,1] op_sel_hi:[1,1,1] neg_lo:[1,0,0] neg_hi:[1,0,0]
v_pk_add_f32 v[108:109], v[76:77], v[78:79]
v_pk_add_f32 v[110:111], v[236:237], v[238:239]
v_pk_fma_f32 v[84:85], v[84:85], v[130:131], v[102:103] op_sel:[0,1,1] op_sel_hi:[1,1,1] neg_lo:[0,0,1] neg_hi:[0,0,1]
v_pk_fma_f32 v[86:87], v[86:87], v[130:131], v[102:103] op_sel:[0,1,1] op_sel_hi:[1,1,1] neg_lo:[0,0,1] neg_hi:[0,0,1]
v_pk_fma_f32 v[248:249], v[88:89], v[130:131], v[106:107] op_sel:[0,1,1] op_sel_hi:[1,1,1] neg_lo:[1,0,0] neg_hi:[1,0,0]
v_pk_fma_f32 v[250:251], v[90:91], v[130:131], v[106:107] op_sel:[0,1,1] op_sel_hi:[1,1,1] neg_lo:[1,0,0] neg_hi:[1,0,0]
v_pk_add_f32 v[108:109], v[108:109], v[80:81]
v_pk_add_f32 v[110:111], v[110:111], v[240:241]
v_exp_f32 v244, v244
v_exp_f32 v84, v84
v_exp_f32 v245, v245
v_exp_f32 v85, v85
v_exp_f32 v246, v246
v_exp_f32 v86, v86
v_exp_f32 v247, v247
v_exp_f32 v87, v87
v_pk_fma_f32 v[88:89], v[88:89], v[130:131], v[102:103] op_sel:[0,1,1] op_sel_hi:[1,1,1] neg_lo:[0,0,1] neg_hi:[0,0,1]
v_pk_fma_f32 v[90:91], v[90:91], v[130:131], v[102:103] op_sel:[0,1,1] op_sel_hi:[1,1,1] neg_lo:[0,0,1] neg_hi:[0,0,1]
v_pk_add_f32 v[108:109], v[108:109], v[82:83]
v_pk_add_f32 v[110:111], v[110:111], v[242:243]
v_exp_f32 v248, v248
v_exp_f32 v88, v88
v_exp_f32 v249, v249
v_exp_f32 v89, v89
v_add_f32 v102, v108, v109
v_add_f32 v106, v110, v111
v_exp_f32 v250, v250
v_exp_f32 v90, v90
v_exp_f32 v251, v251
v_exp_f32 v91, v91
v_pk_add_f32 v[108:109], v[84:85], v[86:87]
v_pk_add_f32 v[110:111], v[244:245], v[246:247]
v_pk_add_f32 v[108:109], v[108:109], v[88:89]
v_pk_add_f32 v[110:111], v[110:111], v[248:249]
v_pk_add_f32 v[108:109], v[108:109], v[90:91]
v_pk_add_f32 v[110:111], v[110:111], v[250:251]
v_add_f32 v103, v108, v109
v_add_f32 v107, v110, v111
s_cmp_eq_u32 s51, 1
s_cbranch_scc1 chk_86
s_waitcnt vmcnt(0)
v_max_u32 v4, v212, v213
v_max3_u32 v4, v4, v214, v215
v_max3_u32 v4, v4, v216, v217
v_max3_u32 v4, v4, v218, v219
v_cmp_eq_u32 vcc, -1, v4
s_cbranch_vccz red_87
buffer_load_dwordx4 v[212:215], v18, s[32:35], s55 offen offset:0 sc1
buffer_load_dwordx4 v[216:219], v18, s[32:35], s55 offen offset:1024 sc1
s_branch chk_86
red_87:
v_mfma_f32_16x16x32_bf16 v[132:135], v[44:47], v[212:215], 0
v_mfma_f32_16x16x32_bf16 v[132:135], v[44:47], v[216:219], v[132:135]
s_mov_b32 s51, 1
s_nop 6
v_add_f32_dpp v132, v132, v132 row_ror:8 row_mask:0xf bank_mask:0xf
v_add_f32_dpp v133, v133, v133 row_ror:8 row_mask:0xf bank_mask:0xf
v_add_f32_dpp v134, v134, v134 row_ror:8 row_mask:0xf bank_mask:0xf
v_add_f32_dpp v135, v135, v135 row_ror:8 row_mask:0xf bank_mask:0xf
v_cvt_pk_bf16_f32 v132, v132, v133
v_cvt_pk_bf16_f32 v133, v134, v135
s_mov_b64 exec, 0x00ff00ff
buffer_store_dwordx2 v[132:133], v59, s[32:35], s79 offen sc1
s_mov_b64 exec, -1
buffer_load_dwordx4 v[204:207], v58, s[32:35], s56 offen sc1
buffer_load_dwordx4 v[208:211], v58, s[32:35], s57 offen sc1
chk_86:
.p2align 3
v_permlane32_swap_b32 v100, v101
v_permlane32_swap_b32 v102, v103
v_permlane32_swap_b32 v104, v105
v_permlane32_swap_b32 v106, v107
v_add_f32 v100, v100, v101
v_add_f32 v102, v102, v103
v_add_f32 v104, v104, v105
v_add_f32 v106, v106, v107
v_permlane16_swap_b32 v100, v102
s_nop 0
v_permlane16_swap_b32 v104, v106
v_add_f32 v100, v100, v102
v_add_f32 v104, v104, v106
v_rcp_f32 v100, v100
v_rcp_f32 v104, v104
v_mov_b32 v102, v100
v_mov_b32 v106, v104
s_nop 0
v_permlane16_swap_b32 v100, v102
v_permlane16_swap_b32 v104, v106
v_mov_b32 v101, v100
v_mov_b32 v103, v102
v_mov_b32 v105, v104
v_mov_b32 v107, v106
v_permlane32_swap_b32 v100, v101
v_permlane32_swap_b32 v102, v103
v_permlane32_swap_b32 v104, v105
v_permlane32_swap_b32 v106, v107
v_pk_mul_f32 v[60:61], v[60:61], v[100:101] op_sel:[0,0] op_sel_hi:[1,0]
v_pk_mul_f32 v[220:221], v[220:221], v[104:105] op_sel:[0,0] op_sel_hi:[1,0]
v_pk_mul_f32 v[68:69], v[68:69], v[100:101] op_sel:[0,1] op_sel_hi:[1,1]
v_pk_mul_f32 v[228:229], v[228:229], v[104:105] op_sel:[0,1] op_sel_hi:[1,1]
v_pk_mul_f32 v[76:77], v[76:77], v[102:103] op_sel:[0,0] op_sel_hi:[1,0]
v_pk_mul_f32 v[236:237], v[236:237], v[106:107] op_sel:[0,0] op_sel_hi:[1,0]
v_pk_mul_f32 v[84:85], v[84:85], v[102:103] op_sel:[0,1] op_sel_hi:[1,1]
v_pk_mul_f32 v[244:245], v[244:245], v[106:107] op_sel:[0,1] op_sel_hi:[1,1]
v_pk_mul_f32 v[62:63], v[62:63], v[100:101] op_sel:[0,0] op_sel_hi:[1,0]
v_pk_mul_f32 v[222:223], v[222:223], v[104:105] op_sel:[0,0] op_sel_hi:[1,0]
v_cvt_pk_bf16_f32 v60, v60, v61
v_cvt_pk_bf16_f32 v220, v220, v221
v_pk_mul_f32 v[70:71], v[70:71], v[100:101] op_sel:[0,1] op_sel_hi:[1,1]
v_pk_mul_f32 v[230:231], v[230:231], v[104:105] op_sel:[0,1] op_sel_hi:[1,1]
v_cvt_pk_bf16_f32 v68, v68, v69
v_cvt_pk_bf16_f32 v228, v228, v229
v_pk_mul_f32 v[78:79], v[78:79], v[102:103] op_sel:[0,0] op_sel_hi:[1,0]
v_pk_mul_f32 v[238:239], v[238:239], v[106:107] op_sel:[0,0] op_sel_hi:[1,0]
v_cvt_pk_bf16_f32 v76, v76, v77
v_cvt_pk_bf16_f32 v236, v236, v237
v_pk_mul_f32 v[86:87], v[86:87], v[102:103] op_sel:[0,1] op_sel_hi:[1,1]
v_pk_mul_f32 v[246:247], v[246:247], v[106:107] op_sel:[0,1] op_sel_hi:[1,1]
v_cvt_pk_bf16_f32 v84, v84, v85
v_cvt_pk_bf16_f32 v244, v244, v245
v_pk_mul_f32 v[64:65], v[64:65], v[100:101] op_sel:[0,0] op_sel_hi:[1,0]
v_pk_mul_f32 v[66:67], v[66:67], v[100:101] op_sel:[0,0] op_sel_hi:[1,0]
v_pk_mul_f32 v[224:225], v[224:225], v[104:105] op_sel:[0,0] op_sel_hi:[1,0]
v_pk_mul_f32 v[226:227], v[226:227], v[104:105] op_sel:[0,0] op_sel_hi:[1,0]
v_cvt_pk_bf16_f32 v61, v62, v63
v_cvt_pk_bf16_f32 v221, v222, v223
v_pk_mul_f32 v[72:73], v[72:73], v[100:101] op_sel:[0,1] op_sel_hi:[1,1]
v_pk_mul_f32 v[74:75], v[74:75], v[100:101] op_sel:[0,1] op_sel_hi:[1,1]
v_pk_mul_f32 v[232:233], v[232:233], v[104:105] op_sel:[0,1] op_sel_hi:[1,1]
v_pk_mul_f32 v[234:235], v[234:235], v[104:105] op_sel:[0,1] op_sel_hi:[1,1]
v_cvt_pk_bf16_f32 v69, v70, v71
v_cvt_pk_bf16_f32 v229, v230, v231
v_pk_mul_f32 v[80:81], v[80:81], v[102:103] op_sel:[0,0] op_sel_hi:[1,0]
v_pk_mul_f32 v[82:83], v[82:83], v[102:103] op_sel:[0,0] op_sel_hi:[1,0]
v_pk_mul_f32 v[240:241], v[240:241], v[106:107] op_sel:[0,0] op_sel_hi:[1,0]
v_pk_mul_f32 v[242:243], v[242:243], v[106:107] op_sel:[0,0] op_sel_hi:[1,0]
v_cvt_pk_bf16_f32 v77, v78, v79
v_cvt_pk_bf16_f32 v237, v238, v239
v_pk_mul_f32 v[88:89], v[88:89], v[102:103] op_sel:[0,1] op_sel_hi:[1,1]
v_pk_mul_f32 v[90:91], v[90:91], v[102:103] op_sel:[0,1] op_sel_hi:[1,1]
v_pk_mul_f32 v[248:249], v[248:249], v[106:107] op_sel:[0,1] op_sel_hi:[1,1]
v_pk_mul_f32 v[250:251], v[250:251], v[106:107] op_sel:[0,1] op_sel_hi:[1,1]
v_cvt_pk_bf16_f32 v85, v86, v87
v_cvt_pk_bf16_f32 v245, v246, v247
v_cvt_pk_bf16_f32 v62, v64, v65
v_cvt_pk_bf16_f32 v63, v66, v67
v_cvt_pk_bf16_f32 v222, v224, v225
v_cvt_pk_bf16_f32 v223, v226, v227
v_cvt_pk_bf16_f32 v70, v72, v73
v_cvt_pk_bf16_f32 v71, v74, v75
v_cvt_pk_bf16_f32 v230, v232, v233
v_cvt_pk_bf16_f32 v231, v234, v235
v_cvt_pk_bf16_f32 v78, v80, v81
v_cvt_pk_bf16_f32 v79, v82, v83
v_cvt_pk_bf16_f32 v238, v240, v241
v_cvt_pk_bf16_f32 v239, v242, v243
v_cvt_pk_bf16_f32 v86, v88, v89
v_cvt_pk_bf16_f32 v87, v90, v91
v_cvt_pk_bf16_f32 v246, v248, v249
v_cvt_pk_bf16_f32 v247, v250, v251
s_cmp_lg_u32 s51, 0
s_cbranch_scc1 else_88
s_mov_b32 s63, 0
sent_90:
s_waitcnt vmcnt(0)
v_max_u32 v4, v212, v213
v_max3_u32 v4, v4, v214, v215
v_max3_u32 v4, v4, v216, v217
v_max3_u32 v4, v4, v218, v219
v_cmp_eq_u32 vcc, -1, v4
s_cbranch_vccz sentd_91
buffer_load_dwordx4 v[212:215], v18, s[32:35], s55 offen offset:0 sc1
buffer_load_dwordx4 v[216:219], v18, s[32:35], s55 offen offset:1024 sc1
s_add_u32 s63, s63, 1
s_cmp_lt_u32 s63, 0x80000
s_cbranch_scc1 sent_90
s_waitcnt vmcnt(0)
sentd_91:
v_mfma_f32_16x16x32_bf16 v[132:135], v[44:47], v[212:215], 0
v_mfma_f32_16x16x32_bf16 v[132:135], v[44:47], v[216:219], v[132:135]
s_mov_b32 s51, 1
s_nop 6
v_add_f32_dpp v132, v132, v132 row_ror:8 row_mask:0xf bank_mask:0xf
v_add_f32_dpp v133, v133, v133 row_ror:8 row_mask:0xf bank_mask:0xf
v_add_f32_dpp v134, v134, v134 row_ror:8 row_mask:0xf bank_mask:0xf
v_add_f32_dpp v135, v135, v135 row_ror:8 row_mask:0xf bank_mask:0xf
v_cvt_pk_bf16_f32 v132, v132, v133
v_cvt_pk_bf16_f32 v133, v134, v135
s_mov_b64 exec, 0x00ff00ff
buffer_store_dwordx2 v[132:133], v59, s[32:35], s79 offen sc1
s_mov_b64 exec, -1
buffer_load_dwordx4 v[204:207], v58, s[32:35], s56 offen sc1
buffer_load_dwordx4 v[208:211], v58, s[32:35], s57 offen sc1
else_88:
s_mov_b32 s63, 0
sent_92:
s_waitcnt vmcnt(0)
v_max_u32 v4, v204, v205
v_max3_u32 v4, v4, v206, v207
v_max3_u32 v4, v4, v208, v209
v_max3_u32 v4, v4, v210, v211
v_cmp_eq_u32 vcc, -1, v4
s_cbranch_vccz sentd_93
buffer_load_dwordx4 v[204:207], v58, s[32:35], s56 offen sc1
buffer_load_dwordx4 v[208:211], v58, s[32:35], s57 offen sc1
s_add_u32 s63, s63, 1
s_cmp_lt_u32 s63, 0x80000
s_cbranch_scc1 sent_92
s_waitcnt vmcnt(0)
sentd_93:
v_mfma_f32_16x16x32_bf16 v[112:115], v[204:207], v[60:63], 0
v_mfma_f32_16x16x32_bf16 v[116:119], v[204:207], v[68:71], 0
v_mfma_f32_16x16x32_bf16 v[120:123], v[204:207], v[76:79], 0
v_mfma_f32_16x16x32_bf16 v[124:127], v[204:207], v[84:87], 0
v_mfma_f32_16x16x32_bf16 v[112:115], v[208:211], v[220:223], v[112:115]
v_mfma_f32_16x16x32_bf16 v[116:119], v[208:211], v[228:231], v[116:119]
v_mfma_f32_16x16x32_bf16 v[120:123], v[208:211], v[236:239], v[120:123]
v_mfma_f32_16x16x32_bf16 v[124:127], v[208:211], v[244:247], v[124:127]
s_nop 4
v_add_f32 v100, v112, v113
v_add_f32 v114, v114, v115
v_add_f32 v100, v100, v114
v_add_f32 v101, v116, v117
v_add_f32 v118, v118, v119
v_add_f32 v101, v101, v118
v_add_f32 v102, v120, v121
v_add_f32 v122, v122, v123
v_add_f32 v102, v102, v122
v_add_f32 v103, v124, v125
v_add_f32 v126, v126, v127
v_add_f32 v103, v103, v126
s_nop 1
v_permlane32_swap_b32 v100, v101
v_permlane32_swap_b32 v102, v103
v_add_f32 v100, v100, v101
v_add_f32 v102, v102, v103
s_nop 1
v_permlane16_swap_b32 v100, v102
s_nop 0
v_add_f32 v100, v100, v102
v_add_f32 v100, 0x358637bd, v100
v_rcp_f32 v100, v100
s_nop 0
v_mov_b32 v102, v100
s_nop 1
v_permlane16_swap_b32 v100, v102
s_nop 0
v_mov_b32 v101, v100
v_mov_b32 v103, v102
s_nop 0
v_permlane32_swap_b32 v100, v101
v_permlane32_swap_b32 v102, v103
buffer_load_dwordx4 v[188:191], v18, s[32:35], s58 offen offset:0 sc1
buffer_load_dwordx4 v[192:195], v18, s[32:35], s58 offen offset:1024 sc1
buffer_load_dwordx4 v[196:199], v18, s[32:35], s59 offen offset:0 sc1
buffer_load_dwordx4 v[200:203], v18, s[32:35], s59 offen offset:1024 sc1
s_mov_b32 s63, 0
sent_94:
s_waitcnt vmcnt(0)
v_max_u32 v4, v188, v189
v_max3_u32 v4, v4, v190, v191
v_max3_u32 v4, v4, v192, v193
v_max3_u32 v4, v4, v194, v195
v_max3_u32 v4, v4, v196, v197
v_max3_u32 v4, v4, v198, v199
v_max3_u32 v4, v4, v200, v201
v_max3_u32 v4, v4, v202, v203
v_cmp_eq_u32 vcc, -1, v4
s_cbranch_vccz sentd_95
buffer_load_dwordx4 v[188:191], v18, s[32:35], s58 offen offset:0 sc1
buffer_load_dwordx4 v[192:195], v18, s[32:35], s58 offen offset:1024 sc1
buffer_load_dwordx4 v[196:199], v18, s[32:35], s59 offen offset:0 sc1
buffer_load_dwordx4 v[200:203], v18, s[32:35], s59 offen offset:1024 sc1
s_add_u32 s63, s63, 1
s_cmp_lt_u32 s63, 0x80000
s_cbranch_scc1 sent_94
s_waitcnt vmcnt(0)
sentd_95:
s_cmp_eq_u32 s46, 0
s_cbranch_scc1 slow_96
.p2align 3
v_mfma_f32_16x16x32_bf16 v[156:159], v[188:191], v[60:63], 0
v_mfma_f32_16x16x32_bf16 v[164:167], v[188:191], v[68:71], 0
v_mfma_f32_16x16x32_bf16 v[160:163], v[192:195], v[60:63], 0
v_mfma_f32_16x16x32_bf16 v[172:175], v[188:191], v[76:79], 0
v_mfma_f32_16x16x32_bf16 v[168:171], v[192:195], v[68:71], 0
v_mfma_f32_16x16x32_bf16 v[180:183], v[188:191], v[84:87], 0
v_mfma_f32_16x16x32_bf16 v[156:159], v[196:199], v[220:223], v[156:159]
v_mfma_f32_16x16x32_bf16 v[176:179], v[192:195], v[76:79], 0
v_mfma_f32_16x16x32_bf16 v[164:167], v[196:199], v[228:231], v[164:167]
v_mfma_f32_16x16x32_bf16 v[184:187], v[192:195], v[84:87], 0
v_mfma_f32_16x16x32_bf16 v[160:163], v[200:203], v[220:223], v[160:163]
v_mfma_f32_16x16x32_bf16 v[172:175], v[196:199], v[236:239], v[172:175]
v_mfma_f32_16x16x32_bf16 v[168:171], v[200:203], v[228:231], v[168:171]
v_mfma_f32_16x16x32_bf16 v[180:183], v[196:199], v[244:247], v[180:183]
v_mfma_f32_16x16x32_bf16 v[176:179], v[200:203], v[236:239], v[176:179]
v_mfma_f32_16x16x32_bf16 v[184:187], v[200:203], v[244:247], v[184:187]
v_pk_mul_f32 v[156:157], v[156:157], v[100:101] op_sel:[0,0] op_sel_hi:[1,0]
v_pk_mul_f32 v[158:159], v[158:159], v[100:101] op_sel:[0,0] op_sel_hi:[1,0]
v_cvt_pk_bf16_f32 v156, v156, v157
v_pk_mul_f32 v[164:165], v[164:165], v[100:101] op_sel:[0,1] op_sel_hi:[1,1]
v_pk_mul_f32 v[160:161], v[160:161], v[100:101] op_sel:[0,0] op_sel_hi:[1,0]
v_pk_mul_f32 v[162:163], v[162:163], v[100:101] op_sel:[0,0] op_sel_hi:[1,0]
v_cvt_pk_bf16_f32 v157, v158, v159
v_pk_mul_f32 v[166:167], v[166:167], v[100:101] op_sel:[0,1] op_sel_hi:[1,1]
v_cvt_pk_bf16_f32 v164, v164, v165
v_pk_mul_f32 v[172:173], v[172:173], v[102:103] op_sel:[0,0] op_sel_hi:[1,0]
v_cvt_pk_bf16_f32 v158, v160, v161
v_cvt_pk_bf16_f32 v159, v162, v163
v_pk_mul_f32 v[168:169], v[168:169], v[100:101] op_sel:[0,1] op_sel_hi:[1,1]
v_pk_mul_f32 v[170:171], v[170:171], v[100:101] op_sel:[0,1] op_sel_hi:[1,1]
v_cvt_pk_bf16_f32 v165, v166, v167
v_pk_mul_f32 v[174:175], v[174:175], v[102:103] op_sel:[0,0] op_sel_hi:[1,0]
v_cvt_pk_bf16_f32 v172, v172, v173
v_pk_mul_f32 v[180:181], v[180:181], v[102:103] op_sel:[0,1] op_sel_hi:[1,1]
buffer_store_dwordx4 v[156:159], v18, s[32:35], s80 offen
v_cvt_pk_bf16_f32 v166, v168, v169
v_cvt_pk_bf16_f32 v167, v170, v171
v_pk_mul_f32 v[176:177], v[176:177], v[102:103] op_sel:[0,0] op_sel_hi:[1,0]
v_pk_mul_f32 v[178:179], v[178:179], v[102:103] op_sel:[0,0] op_sel_hi:[1,0]
v_cvt_pk_bf16_f32 v173, v174, v175
v_pk_mul_f32 v[182:183], v[182:183], v[102:103] op_sel:[0,1] op_sel_hi:[1,1]
v_cvt_pk_bf16_f32 v180, v180, v181
buffer_store_dwordx4 v[164:167], v18, s[32:35], s81 offen
v_cvt_pk_bf16_f32 v174, v176, v177
v_cvt_pk_bf16_f32 v175, v178, v179
v_pk_mul_f32 v[184:185], v[184:185], v[102:103] op_sel:[0,1] op_sel_hi:[1,1]
v_pk_mul_f32 v[186:187], v[186:187], v[102:103] op_sel:[0,1] op_sel_hi:[1,1]
v_cvt_pk_bf16_f32 v181, v182, v183
buffer_store_dwordx4 v[172:175], v18, s[32:35], s82 offen
v_cvt_pk_bf16_f32 v182, v184, v185
v_cvt_pk_bf16_f32 v183, v186, v187
buffer_store_dwordx4 v[180:183], v18, s[32:35], s83 offen
back_97:
s_barrier
v_and_b32 v36, 31, v0
v_lshlrev_b32 v36, 2, v36
s_lshl_b32 s62, s45, 2
v_mov_b32 v4, s62
v_mov_b32 v5, 2
s_mov_b64 exec, 1
s_waitcnt vmcnt(0)
s_cmp_eq_u32 s46, 0
s_cbranch_scc1 slow_98
buffer_store_dword v5, v4, s[32:35], s84 offen
back_99:
s_mov_b64 exec, -1
v_lshrrev_b32 v4, 2, v2
v_and_b32 v5, 3, v0
v_lshl_add_u32 v6, v3, 3, v4
v_lshlrev_b32 v6, 7, v6
v_lshl_add_u32 v6, v5, 3, v6
v_lshrrev_b32 v7, 1, v4
v_and_b32 v8, 1, v3
v_lshl_add_u32 v7, v8, 1, v7
v_lshl_add_u32 v10, v7, 5, v6
v_xor_b32 v11, 32, v10
v_xor_b32 v12, 64, v10
v_xor_b32 v13, 96, v10
v_add_u32 v14, 0x10000, v10
v_add_u32 v15, 0x10000, v11
v_add_u32 v16, 0x10000, v12
v_add_u32 v17, 0x10000, v13
ds_read_b64_tr_b16 v[220:221], v10 offset:0
ds_read_b64_tr_b16 v[222:223], v10 offset:512
ds_read_b64_tr_b16 v[224:225], v11 offset:0
ds_read_b64_tr_b16 v[226:227], v11 offset:512
ds_read_b64_tr_b16 v[228:229], v12 offset:0
ds_read_b64_tr_b16 v[230:231], v12 offset:512
ds_read_b64_tr_b16 v[232:233], v13 offset:0
ds_read_b64_tr_b16 v[234:235], v13 offset:512
ds_read_b64_tr_b16 v[236:237], v10 offset:4096
ds_read_b64_tr_b16 v[238:239], v10 offset:4608
ds_read_b64_tr_b16 v[240:241], v11 offset:4096
ds_read_b64_tr_b16 v[242:243], v11 offset:4608
ds_read_b64_tr_b16 v[244:245], v12 offset:4096
ds_read_b64_tr_b16 v[246:247], v12 offset:4608
ds_read_b64_tr_b16 v[248:249], v13 offset:4096
ds_read_b64_tr_b16 v[250:251], v13 offset:4608
s_lshl_b32 s48, s41, 3
s_lshl_b32 s49, s40, 1
s_add_u32 s48, s48, s49
s_lshl_b32 s48, s48, 15
s_add_u32 s48, s48, 4194304
v_add_u32 v38, s48, v18
v_add_u32 v39, 32768, v38
s_lshl_b32 s57, s75, 11
s_add_u32 s87, s87, 262144
v_lshlrev_b32 v60, 16, v20
v_and_b32 v61, 0xffff0000, v20
v_lshlrev_b32 v62, 16, v21
v_and_b32 v63, 0xffff0000, v21
v_lshlrev_b32 v64, 16, v22
v_and_b32 v65, 0xffff0000, v22
v_lshlrev_b32 v66, 16, v23
v_and_b32 v67, 0xffff0000, v23
v_lshlrev_b32 v68, 16, v24
v_and_b32 v69, 0xffff0000, v24
v_lshlrev_b32 v70, 16, v25
v_and_b32 v71, 0xffff0000, v25
v_lshlrev_b32 v72, 16, v26
v_and_b32 v73, 0xffff0000, v26
v_lshlrev_b32 v74, 16, v27
v_and_b32 v75, 0xffff0000, v27
v_lshlrev_b32 v76, 16, v28
v_and_b32 v77, 0xffff0000, v28
v_lshlrev_b32 v78, 16, v29
v_and_b32 v79, 0xffff0000, v29
v_lshlrev_b32 v80, 16, v30
v_and_b32 v81, 0xffff0000, v30
v_lshlrev_b32 v82, 16, v31
v_and_b32 v83, 0xffff0000, v31
v_lshlrev_b32 v84, 16, v32
v_and_b32 v85, 0xffff0000, v32
v_lshlrev_b32 v86, 16, v33
v_and_b32 v87, 0xffff0000, v33
v_lshlrev_b32 v88, 16, v34
v_and_b32 v89, 0xffff0000, v34
v_lshlrev_b32 v90, 16, v35
v_and_b32 v91, 0xffff0000, v35
v_mov_b32 v6, 0
v_mov_b32 v7, 0
v_mov_b32 v8, 0
v_mov_b32 v9, 0
s_lshl_b32 s62, s42, 2
v_mov_b32 v4, s62
v_mov_b32 v5, 2
buffer_load_dword v37, v36, s[32:35], s84 offen sc1
s_mov_b32 s63, 0
s_waitcnt vmcnt(0)
poll_100:
v_cmp_gt_u32 vcc, 2, v37
s_cbranch_vccz polled_101
buffer_load_dword v37, v36, s[32:35], s84 offen sc1
s_add_u32 s63, s63, 1
s_cmp_lt_u32 s63, 0x80000
s_waitcnt vmcnt(0)
s_cbranch_scc1 poll_100
polled_101:
s_call_b64 s[94:95], R_oloop
s_cmp_eq_u32 s46, 0
s_cbranch_scc1 slow_102
s_nop 0
v_cvt_pk_bf16_f32 v20, v60, v61
v_cvt_pk_bf16_f32 v21, v62, v63
v_cvt_pk_bf16_f32 v22, v64, v65
v_cvt_pk_bf16_f32 v23, v66, v67
buffer_store_dwordx4 v[20:23], v18, s[32:35], s85 offen offset:0
v_cvt_pk_bf16_f32 v24, v68, v69
v_cvt_pk_bf16_f32 v25, v70, v71
v_cvt_pk_bf16_f32 v26, v72, v73
v_cvt_pk_bf16_f32 v27, v74, v75
buffer_store_dwordx4 v[24:27], v18, s[32:35], s85 offen offset:1024
v_cvt_pk_bf16_f32 v28, v76, v77
v_cvt_pk_bf16_f32 v29, v78, v79
v_cvt_pk_bf16_f32 v30, v80, v81
v_cvt_pk_bf16_f32 v31, v82, v83
buffer_store_dwordx4 v[28:31], v18, s[32:35], s86 offen offset:0
v_cvt_pk_bf16_f32 v32, v84, v85
v_cvt_pk_bf16_f32 v33, v86, v87
v_cvt_pk_bf16_f32 v34, v88, v89
v_cvt_pk_bf16_f32 v35, v90, v91
buffer_store_dwordx4 v[32:35], v18, s[32:35], s86 offen offset:1024
s_barrier
v_dot2c_f32_bf16 v6, v20, v48
v_dot2c_f32_bf16 v8, v20, v20
v_dot2c_f32_bf16 v7, v28, v48
v_dot2c_f32_bf16 v9, v28, v28
v_dot2c_f32_bf16 v6, v21, v48
v_dot2c_f32_bf16 v8, v21, v21
v_dot2c_f32_bf16 v7, v29, v48
v_dot2c_f32_bf16 v9, v29, v29
v_dot2c_f32_bf16 v6, v22, v48
v_dot2c_f32_bf16 v8, v22, v22
v_dot2c_f32_bf16 v7, v30, v48
v_dot2c_f32_bf16 v9, v30, v30
v_dot2c_f32_bf16 v6, v23, v48
v_dot2c_f32_bf16 v8, v23, v23
v_dot2c_f32_bf16 v7, v31, v48
v_dot2c_f32_bf16 v9, v31, v31
v_dot2c_f32_bf16 v6, v24, v48
v_dot2c_f32_bf16 v8, v24, v24
v_dot2c_f32_bf16 v7, v32, v48
v_dot2c_f32_bf16 v9, v32, v32
v_dot2c_f32_bf16 v6, v25, v48
v_dot2c_f32_bf16 v8, v25, v25
v_dot2c_f32_bf16 v7, v33, v48
v_dot2c_f32_bf16 v9, v33, v33
v_dot2c_f32_bf16 v6, v26, v48
v_dot2c_f32_bf16 v8, v26, v26
v_dot2c_f32_bf16 v7, v34, v48
v_dot2c_f32_bf16 v9, v34, v34
v_dot2c_f32_bf16 v6, v27, v48
v_dot2c_f32_bf16 v8, v27, v27
v_dot2c_f32_bf16 v7, v35, v48
v_dot2c_f32_bf16 v9, v35, v35
s_mov_b64 exec, 1
s_waitcnt vmcnt(0)
buffer_store_dword v5, v4, s[32:35], s88 offen
s_mov_b64 exec, -1
s_nop 1
v_permlane32_swap_b32 v6, v7
v_permlane32_swap_b32 v8, v9
v_add_f32 v6, v6, v7
v_add_f32 v8, v8, v9
s_nop 1
v_permlane16_swap_b32 v6, v8
s_nop 0
v_add_f32 v6, v6, v8
buffer_store_dword v6, v1, s[32:35], s87 offen
back_103:
s_lshl_b32 s49, s44, 13
v_add_u32 v10, s49, v18
v_add_u32 v11, 1024, v10
s_lshl_b32 s48, s43, 1
v_lshrrev_b32 v4, 2, v2
v_and_b32 v5, 3, v0
v_lshl_add_u32 v6, v3, 3, v4
v_lshlrev_b32 v6, 7, v6
v_lshl_add_u32 v6, v5, 3, v6
v_lshrrev_b32 v7, 1, v4
v_and_b32 v8, 1, v3
v_lshl_add_u32 v7, v8, 1, v7
v_xor_b32 v7, s48, v7
v_lshl_add_u32 v12, v7, 5, v6
v_add_u32 v12, 16384, v12
v_xor_b32 v13, 32, v12
v_mov_b32 v14, v10
v_mov_b32 v15, v11
v_add_u32 v16, 122880, v12
v_add_u32 v17, 122880, v13
v_mov_b32 v156, 0
v_mov_b32 v157, 0
v_mov_b32 v158, 0
v_mov_b32 v159, 0
v_mov_b32 v160, 0
v_mov_b32 v161, 0
v_mov_b32 v162, 0
v_mov_b32 v163, 0
v_mov_b32 v164, 0
v_mov_b32 v165, 0
v_mov_b32 v166, 0
v_mov_b32 v167, 0
v_mov_b32 v168, 0
v_mov_b32 v169, 0
v_mov_b32 v170, 0
v_mov_b32 v171, 0
v_mov_b32 v172, 0
v_mov_b32 v173, 0
v_mov_b32 v174, 0
v_mov_b32 v175, 0
v_mov_b32 v176, 0
v_mov_b32 v177, 0
v_mov_b32 v178, 0
v_mov_b32 v179, 0
v_mov_b32 v180, 0
v_mov_b32 v181, 0
v_mov_b32 v182, 0
v_mov_b32 v183, 0
v_mov_b32 v184, 0
v_mov_b32 v185, 0
v_mov_b32 v186, 0
v_mov_b32 v187, 0
v_mov_b32 v188, 0
v_mov_b32 v189, 0
v_mov_b32 v190, 0
v_mov_b32 v191, 0
v_mov_b32 v192, 0
v_mov_b32 v193, 0
v_mov_b32 v194, 0
v_mov_b32 v195, 0
v_mov_b32 v196, 0
v_mov_b32 v197, 0
v_mov_b32 v198, 0
v_mov_b32 v199, 0
v_mov_b32 v200, 0
v_mov_b32 v201, 0
v_mov_b32 v202, 0
v_mov_b32 v203, 0
v_mov_b32 v204, 0
v_mov_b32 v205, 0
v_mov_b32 v206, 0
v_mov_b32 v207, 0
v_mov_b32 v208, 0
v_mov_b32 v209, 0
v_mov_b32 v210, 0
v_mov_b32 v211, 0
v_mov_b32 v212, 0
v_mov_b32 v213, 0
v_mov_b32 v214, 0
v_mov_b32 v215, 0
v_mov_b32 v216, 0
v_mov_b32 v217, 0
v_mov_b32 v218, 0
v_mov_b32 v219, 0
v_mov_b32 v220, 0
v_mov_b32 v221, 0
v_mov_b32 v222, 0
v_mov_b32 v223, 0
v_mov_b32 v224, 0
v_mov_b32 v225, 0
v_mov_b32 v226, 0
v_mov_b32 v227, 0
v_mov_b32 v228, 0
v_mov_b32 v229, 0
v_mov_b32 v230, 0
v_mov_b32 v231, 0
v_mov_b32 v232, 0
v_mov_b32 v233, 0
v_mov_b32 v234, 0
v_mov_b32 v235, 0
v_mov_b32 v236, 0
v_mov_b32 v237, 0
v_mov_b32 v238, 0
v_mov_b32 v239, 0
v_mov_b32 v240, 0
v_mov_b32 v241, 0
v_mov_b32 v242, 0
v_mov_b32 v243, 0
v_mov_b32 v244, 0
v_mov_b32 v245, 0
v_mov_b32 v246, 0
v_mov_b32 v247, 0
v_mov_b32 v248, 0
v_mov_b32 v249, 0
v_mov_b32 v250, 0
v_mov_b32 v251, 0
s_mov_b32 s48, 0xf149f2ca
v_mov_b32 v9, s48
v_lshlrev_b32 v4, 2, v3
v_sub_u32 v4, v2, v4
v_subrev_u32 v5, 0, v4
v_and_b32 v6, 0x80000001, v5
v_cmp_eq_u32 vcc, 0, v6
v_add_u32 v5, 1, v5
v_and_b32 v6, 0x80000001, v5
v_cndmask_b32 v40, v9, 0, vcc
v_cmp_eq_u32 vcc, 0x80000001, v6
s_nop 1
v_cndmask_b32 v36, v9, 0, vcc
v_subrev_u32 v5, 1, v4
v_and_b32 v6, 0x80000001, v5
v_cmp_eq_u32 vcc, 0, v6
v_add_u32 v5, 1, v5
v_and_b32 v6, 0x80000001, v5
v_cndmask_b32 v41, v9, 0, vcc
v_cmp_eq_u32 vcc, 0x80000001, v6
s_nop 1
v_cndmask_b32 v37, v9, 0, vcc
v_subrev_u32 v5, 2, v4
v_and_b32 v6, 0x80000001, v5
v_cmp_eq_u32 vcc, 0, v6
v_add_u32 v5, 1, v5
v_and_b32 v6, 0x80000001, v5
v_cndmask_b32 v42, v9, 0, vcc
v_cmp_eq_u32 vcc, 0x80000001, v6
s_nop 1
v_cndmask_b32 v38, v9, 0, vcc
v_subrev_u32 v5, 3, v4
v_and_b32 v6, 0x80000001, v5
v_cmp_eq_u32 vcc, 0, v6
v_add_u32 v5, 1, v5
v_and_b32 v6, 0x80000001, v5
v_cndmask_b32 v43, v9, 0, vcc
v_cmp_eq_u32 vcc, 0x80000001, v6
s_nop 1
v_cndmask_b32 v39, v9, 0, vcc
s_or_b32 s48, s41, s44
s_cmp_eq_u32 s48, 0
s_cselect_b64 vcc, -1, 0
v_cndmask_b32 v44, v36, v9, vcc
v_cndmask_b32 v45, v37, v9, vcc
v_cndmask_b32 v46, v38, v9, vcc
v_cndmask_b32 v47, v39, v9, vcc
v_and_b32 v4, 1, v2
v_lshlrev_b32 v4, 4, v4
v_mov_b32 v5, 0xffff
v_lshlrev_b32 v52, v4, v5
s_lshl_b32 s48, s43, 11
s_add_u32 s48, s48, 135168
v_add_u32 v53, s48, v18
v_lshl_add_u32 v55, v0, 3, s48
s_add_u32 s48, s41, s44
s_sub_u32 s48, s48, 1
s_lshl_b32 s49, s48, 1
s_add_u32 s49, s49, s43
s_lshl_b32 s49, s49, 11
s_mul_i32 s50, s42, 65536
s_add_u32 s49, s49, s50
s_add_u32 s49, s49, 8388608
s_cmp_lt_i32 s48, 0
s_cselect_b32 s49, 0xf0000000, s49
v_add_u32 v58, s49, v18
v_lshl_add_u32 v59, v0, 3, s49
s_lshl_b32 s48, s43, 2
s_add_u32 s48, s48, 134672
v_mov_b32 v19, s48
s_lshl_b32 s48, s43, 7
s_add_u32 s48, s48, 133120
v_lshl_add_u32 v7, v3, 4, s48
v_lshl_add_u32 v54, v2, 2, s48
s_lshl_b32 s49, s44, 6
v_add_u32 v8, s49, v2
v_lshlrev_b32 v8, 3, v8
v_add_u32 v8, 131072, v8
v_lshl_add_u32 v9, v3, 2, s49
v_lshlrev_b32 v9, 2, v9
v_add_u32 v9, 132096, v9
s_mov_b32 s64, 0
s_mov_b32 s65, 0
s_mov_b32 s66, 0x3e8293ee
s_mov_b32 s61, 3
ds_read_b64_tr_b16 v[84:85], v16 offset:8192
ds_read_b64_tr_b16 v[86:87], v16 offset:8704
ds_read_b64_tr_b16 v[88:89], v17 offset:8192
ds_read_b64_tr_b16 v[90:91], v17 offset:8704
ds_read_b64_tr_b16 v[92:93], v16 offset:16384
ds_read_b64_tr_b16 v[94:95], v16 offset:16896
ds_read_b64_tr_b16 v[96:97], v17 offset:16384
ds_read_b64_tr_b16 v[98:99], v17 offset:16896
ds_read_b64_tr_b16 v[76:77], v16 offset:0
ds_read_b64_tr_b16 v[78:79], v16 offset:512
ds_read_b64_tr_b16 v[80:81], v17 offset:0
ds_read_b64_tr_b16 v[82:83], v17 offset:512
s_barrier
ds_read_b128 v[60:63], v14 offset:0
ds_read_b128 v[64:67], v14 offset:2048
ds_read_b128 v[68:71], v14 offset:4096
ds_read_b128 v[72:75], v14 offset:6144
s_waitcnt lgkmcnt(0)
c2_loop:
v_mfma_f32_16x16x32_bf16 v[212:215], v[84:87], v[72:75], v[212:215]
ds_read_b128 v[100:103], v15 offset:0
v_mfma_f32_16x16x32_bf16 v[204:207], v[84:87], v[68:71], v[204:207]
ds_read_b128 v[104:107], v15 offset:2048
v_mfma_f32_16x16x32_bf16 v[196:199], v[84:87], v[64:67], v[196:199]
ds_read_b128 v[108:111], v15 offset:4096
v_mfma_f32_16x16x32_bf16 v[188:191], v[84:87], v[60:63], v[188:191]
ds_read_b128 v[112:115], v15 offset:6144
v_mfma_f32_16x16x32_bf16 v[192:195], v[88:91], v[60:63], v[192:195]
ds_read_b64_tr_b16 v[124:125], v16 offset:12288
v_mfma_f32_16x16x32_bf16 v[200:203], v[88:91], v[64:67], v[200:203]
ds_read_b64_tr_b16 v[126:127], v16 offset:12800
v_mfma_f32_16x16x32_bf16 v[208:211], v[88:91], v[68:71], v[208:211]
ds_read_b64_tr_b16 v[128:129], v17 offset:12288
v_mfma_f32_16x16x32_bf16 v[216:219], v[88:91], v[72:75], v[216:219]
ds_read_b64_tr_b16 v[130:131], v17 offset:12800
v_mfma_f32_16x16x32_bf16 v[244:247], v[72:75], v[92:95], v[244:247]
ds_read_b64_tr_b16 v[132:133], v16 offset:20480
v_mfma_f32_16x16x32_bf16 v[248:251], v[72:75], v[96:99], v[248:251]
ds_read_b64_tr_b16 v[134:135], v16 offset:20992
v_mfma_f32_16x16x32_bf16 v[240:243], v[68:71], v[96:99], v[240:243]
ds_read_b64_tr_b16 v[136:137], v17 offset:20480
v_mfma_f32_16x16x32_bf16 v[236:239], v[68:71], v[92:95], v[236:239]
ds_read_b64_tr_b16 v[138:139], v17 offset:20992
v_mfma_f32_16x16x32_bf16 v[228:231], v[64:67], v[92:95], v[228:231]
ds_read_b64_tr_b16 v[116:117], v16 offset:4096
v_mfma_f32_16x16x32_bf16 v[232:235], v[64:67], v[96:99], v[232:235]
ds_read_b64_tr_b16 v[118:119], v16 offset:4608
v_mfma_f32_16x16x32_bf16 v[224:227], v[60:63], v[96:99], v[224:227]
ds_read_b64_tr_b16 v[120:121], v17 offset:4096
v_mfma_f32_16x16x32_bf16 v[220:223], v[60:63], v[92:95], v[220:223]
ds_read_b64_tr_b16 v[122:123], v17 offset:4608
v_mfma_f32_16x16x32_bf16 v[156:159], v[76:79], v[60:63], v[156:159]
s_add_u32 s65, s65, 40960
s_cmp_eq_u32 s65, 122880
v_mfma_f32_16x16x32_bf16 v[164:167], v[76:79], v[64:67], v[164:167]
s_cselect_b32 s65, 0, s65
s_add_u32 s64, s64, 1
v_mfma_f32_16x16x32_bf16 v[172:175], v[76:79], v[68:71], v[172:175]
v_add_u32 v14, s65, v10
v_add_u32 v15, s65, v11
v_mfma_f32_16x16x32_bf16 v[180:183], v[76:79], v[72:75], v[180:183]
v_add_u32 v16, s65, v12
v_add_u32 v17, s65, v13
v_mfma_f32_16x16x32_bf16 v[184:187], v[80:83], v[72:75], v[184:187]
v_mfma_f32_16x16x32_bf16 v[176:179], v[80:83], v[68:71], v[176:179]
s_cmp_eq_u32 s64, 16
s_cbranch_scc1 c2_last
v_mfma_f32_16x16x32_bf16 v[168:171], v[80:83], v[64:67], v[168:171]
s_waitcnt lgkmcnt(0)
v_mfma_f32_16x16x32_bf16 v[160:163], v[80:83], v[60:63], v[160:163]
s_barrier
v_mfma_f32_16x16x32_bf16 v[212:215], v[124:127], v[112:115], v[212:215]
ds_read_b128 v[60:63], v14 offset:0
v_mfma_f32_16x16x32_bf16 v[204:207], v[124:127], v[108:111], v[204:207]
ds_read_b128 v[64:67], v14 offset:2048
v_mfma_f32_16x16x32_bf16 v[196:199], v[124:127], v[104:107], v[196:199]
ds_read_b128 v[68:71], v14 offset:4096
v_mfma_f32_16x16x32_bf16 v[188:191], v[124:127], v[100:103], v[188:191]
ds_read_b128 v[72:75], v14 offset:6144
v_mfma_f32_16x16x32_bf16 v[192:195], v[128:131], v[100:103], v[192:195]
ds_read_b64_tr_b16 v[84:85], v16 offset:8192
v_mfma_f32_16x16x32_bf16 v[200:203], v[128:131], v[104:107], v[200:203]
ds_read_b64_tr_b16 v[86:87], v16 offset:8704
v_mfma_f32_16x16x32_bf16 v[208:211], v[128:131], v[108:111], v[208:211]
ds_read_b64_tr_b16 v[88:89], v17 offset:8192
v_mfma_f32_16x16x32_bf16 v[216:219], v[128:131], v[112:115], v[216:219]
ds_read_b64_tr_b16 v[90:91], v17 offset:8704
v_mfma_f32_16x16x32_bf16 v[244:247], v[112:115], v[132:135], v[244:247]
ds_read_b64_tr_b16 v[92:93], v16 offset:16384
v_mfma_f32_16x16x32_bf16 v[248:251], v[112:115], v[136:139], v[248:251]
ds_read_b64_tr_b16 v[94:95], v16 offset:16896
v_mfma_f32_16x16x32_bf16 v[240:243], v[108:111], v[136:139], v[240:243]
ds_read_b64_tr_b16 v[96:97], v17 offset:16384
v_mfma_f32_16x16x32_bf16 v[236:239], v[108:111], v[132:135], v[236:239]
ds_read_b64_tr_b16 v[98:99], v17 offset:16896
v_mfma_f32_16x16x32_bf16 v[228:231], v[104:107], v[132:135], v[228:231]
ds_read_b64_tr_b16 v[76:77], v16 offset:0
v_mfma_f32_16x16x32_bf16 v[232:235], v[104:107], v[136:139], v[232:235]
ds_read_b64_tr_b16 v[78:79], v16 offset:512
v_mfma_f32_16x16x32_bf16 v[224:227], v[100:103], v[136:139], v[224:227]
ds_read_b64_tr_b16 v[80:81], v17 offset:0
v_mfma_f32_16x16x32_bf16 v[220:223], v[100:103], v[132:135], v[220:223]
ds_read_b64_tr_b16 v[82:83], v17 offset:512
v_mfma_f32_16x16x32_bf16 v[156:159], v[116:119], v[100:103], v[156:159]
v_mfma_f32_16x16x32_bf16 v[164:167], v[116:119], v[104:107], v[164:167]
v_mfma_f32_16x16x32_bf16 v[172:175], v[116:119], v[108:111], v[172:175]
v_mfma_f32_16x16x32_bf16 v[180:183], v[116:119], v[112:115], v[180:183]
v_mfma_f32_16x16x32_bf16 v[184:187], v[120:123], v[112:115], v[184:187]
v_mfma_f32_16x16x32_bf16 v[176:179], v[120:123], v[108:111], v[176:179]
v_mfma_f32_16x16x32_bf16 v[168:171], v[120:123], v[104:107], v[168:171]
s_waitcnt lgkmcnt(0)
v_mfma_f32_16x16x32_bf16 v[160:163], v[120:123], v[100:103], v[160:163]
s_branch c2_loop
c2_last:
v_mfma_f32_16x16x32_bf16 v[168:171], v[80:83], v[64:67], v[168:171]
s_waitcnt lgkmcnt(0)
v_mfma_f32_16x16x32_bf16 v[160:163], v[80:83], v[60:63], v[160:163]
v_mfma_f32_16x16x32_bf16 v[212:215], v[124:127], v[112:115], v[212:215]
ds_read_b128 v[140:143], v7 offset:0
v_mfma_f32_16x16x32_bf16 v[204:207], v[124:127], v[108:111], v[204:207]
ds_read_b128 v[144:147], v7 offset:64
v_mfma_f32_16x16x32_bf16 v[196:199], v[124:127], v[104:107], v[196:199]
ds_read_b128 v[148:151], v7 offset:256
v_mfma_f32_16x16x32_bf16 v[188:191], v[124:127], v[100:103], v[188:191]
ds_read_b128 v[152:155], v7 offset:320
v_mfma_f32_16x16x32_bf16 v[192:195], v[128:131], v[100:103], v[192:195]
ds_read2_b32 v[56:57], v54 offset0:128 offset1:144
v_mfma_f32_16x16x32_bf16 v[200:203], v[128:131], v[104:107], v[200:203]
v_mfma_f32_16x16x32_bf16 v[208:211], v[128:131], v[108:111], v[208:211]
v_mfma_f32_16x16x32_bf16 v[216:219], v[128:131], v[112:115], v[216:219]
s_barrier
v_mfma_f32_16x16x32_bf16 v[244:247], v[112:115], v[132:135], v[244:247]
ds_read_b64 v[92:93], v8 offset:0
v_mfma_f32_16x16x32_bf16 v[248:251], v[112:115], v[136:139], v[248:251]
ds_read_b64 v[94:95], v8 offset:128
v_mfma_f32_16x16x32_bf16 v[240:243], v[108:111], v[136:139], v[240:243]
ds_read_b64 v[96:97], v8 offset:256
v_mfma_f32_16x16x32_bf16 v[236:239], v[108:111], v[132:135], v[236:239]
ds_read_b64 v[98:99], v8 offset:384
v_mfma_f32_16x16x32_bf16 v[228:231], v[104:107], v[132:135], v[228:231]
ds_read_b128 v[60:63], v9 offset:0
v_mfma_f32_16x16x32_bf16 v[232:235], v[104:107], v[136:139], v[232:235]
ds_read_b128 v[64:67], v9 offset:64
v_mfma_f32_16x16x32_bf16 v[224:227], v[100:103], v[136:139], v[224:227]
ds_read_b128 v[68:71], v9 offset:128
v_mfma_f32_16x16x32_bf16 v[220:223], v[100:103], v[132:135], v[220:223]
ds_read_b128 v[72:75], v9 offset:192
v_mfma_f32_16x16x32_bf16 v[156:159], v[116:119], v[100:103], v[156:159]
ds_read_b128 v[76:79], v9 offset:512
v_mfma_f32_16x16x32_bf16 v[164:167], v[116:119], v[104:107], v[164:167]
ds_read_b128 v[80:83], v9 offset:576
v_mfma_f32_16x16x32_bf16 v[172:175], v[116:119], v[108:111], v[172:175]
ds_read_b128 v[84:87], v9 offset:640
v_mfma_f32_16x16x32_bf16 v[180:183], v[116:119], v[112:115], v[180:183]
ds_read_b128 v[88:91], v9 offset:704
v_mfma_f32_16x16x32_bf16 v[184:187], v[120:123], v[112:115], v[184:187]
v_mfma_f32_16x16x32_bf16 v[176:179], v[120:123], v[108:111], v[176:179]
v_mfma_f32_16x16x32_bf16 v[168:171], v[120:123], v[104:107], v[168:171]
v_mfma_f32_16x16x32_bf16 v[160:163], v[120:123], v[100:103], v[160:163]
c2_epi:
s_waitcnt lgkmcnt(0)
.p2align 3
v_pk_fma_f32 v[212:213], v[148:149], v[98:99], v[212:213] op_sel:[0,1,0] op_sel_hi:[1,1,1]
v_pk_fma_f32 v[214:215], v[150:151], v[98:99], v[214:215] op_sel:[0,1,0] op_sel_hi:[1,1,1]
v_pk_fma_f32 v[216:217], v[152:153], v[98:99], v[216:217] op_sel:[0,1,0] op_sel_hi:[1,1,1]
v_pk_fma_f32 v[218:219], v[154:155], v[98:99], v[218:219] op_sel:[0,1,0] op_sel_hi:[1,1,1]
v_pk_mul_f32 v[212:213], v[212:213], v[98:99] op_sel:[0,0] op_sel_hi:[1,0]
v_pk_mul_f32 v[214:215], v[214:215], v[98:99] op_sel:[0,0] op_sel_hi:[1,0]
v_pk_mul_f32 v[216:217], v[216:217], v[98:99] op_sel:[0,0] op_sel_hi:[1,0]
v_pk_mul_f32 v[218:219], v[218:219], v[98:99] op_sel:[0,0] op_sel_hi:[1,0]
v_cvt_pk_bf16_f32 v212, v212, v213
v_cvt_pk_bf16_f32 v213, v214, v215
v_cvt_pk_bf16_f32 v214, v216, v217
v_cvt_pk_bf16_f32 v215, v218, v219
v_pk_fma_f32 v[244:245], v[88:89], v[56:57], v[244:245] op_sel:[0,0,0] op_sel_hi:[1,0,1]
v_pk_fma_f32 v[246:247], v[90:91], v[56:57], v[246:247] op_sel:[0,0,0] op_sel_hi:[1,0,1]
v_pk_mul_f32 v[244:245], v[244:245], v[72:73]
v_pk_mul_f32 v[246:247], v[246:247], v[74:75]
v_cvt_pk_bf16_f32 v108, v244, v245
v_cvt_pk_bf16_f32 v109, v246, v247
v_pk_fma_f32 v[248:249], v[88:89], v[56:57], v[248:249] op_sel:[0,1,0] op_sel_hi:[1,1,1]
v_pk_fma_f32 v[250:251], v[90:91], v[56:57], v[250:251] op_sel:[0,1,0] op_sel_hi:[1,1,1]
v_pk_mul_f32 v[248:249], v[248:249], v[72:73]
v_pk_mul_f32 v[250:251], v[250:251], v[74:75]
v_cvt_pk_bf16_f32 v118, v248, v249
v_cvt_pk_bf16_f32 v119, v250, v251
s_cmp_lg_u32 s44, 1
s_cbranch_scc1 else_104
buffer_store_dwordx4 v[212:215], v58, s[32:35], 0 offen sc1
buffer_store_dwordx2 v[108:109], v59, s[32:35], 0 offen offset:1024 sc1
buffer_store_dwordx2 v[118:119], v59, s[32:35], 0 offen offset:1536 sc1
s_branch fi_105
else_104:
ds_write_b128 v53, v[212:215]
ds_write_b64 v55, v[108:109] offset:1024
ds_write_b64 v55, v[118:119] offset:1536
v_mov_b32 v4, 3
ds_write_b32 v19, v4
fi_105:
.p2align 3
v_pk_fma_f32 v[188:189], v[148:149], v[92:93], v[188:189] op_sel:[0,1,0] op_sel_hi:[1,1,1]
v_pk_fma_f32 v[196:197], v[148:149], v[94:95], v[196:197] op_sel:[0,1,0] op_sel_hi:[1,1,1]
v_pk_fma_f32 v[204:205], v[148:149], v[96:97], v[204:205] op_sel:[0,1,0] op_sel_hi:[1,1,1]
v_pk_fma_f32 v[164:165], v[140:141], v[94:95], v[164:165] op_sel:[0,1,0] op_sel_hi:[1,1,1]
v_pk_fma_f32 v[172:173], v[140:141], v[96:97], v[172:173] op_sel:[0,1,0] op_sel_hi:[1,1,1]
v_pk_fma_f32 v[180:181], v[140:141], v[98:99], v[180:181] op_sel:[0,1,0] op_sel_hi:[1,1,1]
v_pk_fma_f32 v[190:191], v[150:151], v[92:93], v[190:191] op_sel:[0,1,0] op_sel_hi:[1,1,1]
v_pk_mul_f32 v[188:189], v[188:189], v[92:93] op_sel:[0,0] op_sel_hi:[1,0]
v_pk_fma_f32 v[198:199], v[150:151], v[94:95], v[198:199] op_sel:[0,1,0] op_sel_hi:[1,1,1]
v_pk_mul_f32 v[196:197], v[196:197], v[94:95] op_sel:[0,0] op_sel_hi:[1,0]
v_pk_fma_f32 v[206:207], v[150:151], v[96:97], v[206:207] op_sel:[0,1,0] op_sel_hi:[1,1,1]
v_pk_mul_f32 v[204:205], v[204:205], v[96:97] op_sel:[0,0] op_sel_hi:[1,0]
v_pk_fma_f32 v[166:167], v[142:143], v[94:95], v[166:167] op_sel:[0,1,0] op_sel_hi:[1,1,1]
v_cvt_pk_bf16_f32 v164, v164, v165
v_pk_fma_f32 v[174:175], v[142:143], v[96:97], v[174:175] op_sel:[0,1,0] op_sel_hi:[1,1,1]
v_cvt_pk_bf16_f32 v172, v172, v173
v_pk_fma_f32 v[182:183], v[142:143], v[98:99], v[182:183] op_sel:[0,1,0] op_sel_hi:[1,1,1]
v_cvt_pk_bf16_f32 v180, v180, v181
v_pk_fma_f32 v[192:193], v[152:153], v[92:93], v[192:193] op_sel:[0,1,0] op_sel_hi:[1,1,1]
v_pk_fma_f32 v[194:195], v[154:155], v[92:93], v[194:195] op_sel:[0,1,0] op_sel_hi:[1,1,1]
v_pk_mul_f32 v[190:191], v[190:191], v[92:93] op_sel:[0,0] op_sel_hi:[1,0]
v_cvt_pk_bf16_f32 v188, v188, v189
v_pk_fma_f32 v[200:201], v[152:153], v[94:95], v[200:201] op_sel:[0,1,0] op_sel_hi:[1,1,1]
v_pk_fma_f32 v[202:203], v[154:155], v[94:95], v[202:203] op_sel:[0,1,0] op_sel_hi:[1,1,1]
v_pk_mul_f32 v[198:199], v[198:199], v[94:95] op_sel:[0,0] op_sel_hi:[1,0]
v_cvt_pk_bf16_f32 v196, v196, v197
v_pk_fma_f32 v[208:209], v[152:153], v[96:97], v[208:209] op_sel:[0,1,0] op_sel_hi:[1,1,1]
v_pk_fma_f32 v[210:211], v[154:155], v[96:97], v[210:211] op_sel:[0,1,0] op_sel_hi:[1,1,1]
v_pk_mul_f32 v[206:207], v[206:207], v[96:97] op_sel:[0,0] op_sel_hi:[1,0]
v_cvt_pk_bf16_f32 v204, v204, v205
v_pk_fma_f32 v[168:169], v[144:145], v[94:95], v[168:169] op_sel:[0,1,0] op_sel_hi:[1,1,1]
v_pk_fma_f32 v[170:171], v[146:147], v[94:95], v[170:171] op_sel:[0,1,0] op_sel_hi:[1,1,1]
v_cvt_pk_bf16_f32 v165, v166, v167
v_pk_fma_f32 v[176:177], v[144:145], v[96:97], v[176:177] op_sel:[0,1,0] op_sel_hi:[1,1,1]
v_pk_fma_f32 v[178:179], v[146:147], v[96:97], v[178:179] op_sel:[0,1,0] op_sel_hi:[1,1,1]
v_cvt_pk_bf16_f32 v173, v174, v175
v_pk_fma_f32 v[184:185], v[144:145], v[98:99], v[184:185] op_sel:[0,1,0] op_sel_hi:[1,1,1]
v_pk_fma_f32 v[186:187], v[146:147], v[98:99], v[186:187] op_sel:[0,1,0] op_sel_hi:[1,1,1]
v_cvt_pk_bf16_f32 v181, v182, v183
v_pk_mul_f32 v[192:193], v[192:193], v[92:93] op_sel:[0,0] op_sel_hi:[1,0]
v_pk_mul_f32 v[194:195], v[194:195], v[92:93] op_sel:[0,0] op_sel_hi:[1,0]
v_cvt_pk_bf16_f32 v189, v190, v191
v_pk_mul_f32 v[200:201], v[200:201], v[94:95] op_sel:[0,0] op_sel_hi:[1,0]
v_pk_mul_f32 v[202:203], v[202:203], v[94:95] op_sel:[0,0] op_sel_hi:[1,0]
v_cvt_pk_bf16_f32 v197, v198, v199
v_pk_mul_f32 v[208:209], v[208:209], v[96:97] op_sel:[0,0] op_sel_hi:[1,0]
v_pk_mul_f32 v[210:211], v[210:211], v[96:97] op_sel:[0,0] op_sel_hi:[1,0]
v_cvt_pk_bf16_f32 v205, v206, v207
v_cvt_pk_bf16_f32 v166, v168, v169
v_cvt_pk_bf16_f32 v167, v170, v171
v_cvt_pk_bf16_f32 v174, v176, v177
v_cvt_pk_bf16_f32 v175, v178, v179
v_cvt_pk_bf16_f32 v182, v184, v185
v_cvt_pk_bf16_f32 v183, v186, v187
v_cvt_pk_bf16_f32 v190, v192, v193
v_cvt_pk_bf16_f32 v191, v194, v195
v_mfma_f32_16x16x32_bf16 v[216:219], v[212:215], v[180:183], v[40:43]
v_cvt_pk_bf16_f32 v198, v200, v201
v_cvt_pk_bf16_f32 v199, v202, v203
v_mfma_f32_16x16x32_bf16 v[168:171], v[188:191], v[164:167], v[36:39]
v_cvt_pk_bf16_f32 v206, v208, v209
v_cvt_pk_bf16_f32 v207, v210, v211
v_mfma_f32_16x16x32_bf16 v[200:203], v[196:199], v[164:167], v[40:43]
v_mul_f32 v124, s66, v92
v_mul_f32 v125, s66, v94
v_mfma_f32_16x16x32_bf16 v[208:211], v[204:207], v[172:175], v[40:43]
v_mul_f32 v126, s66, v96
v_mul_f32 v127, s66, v98
v_mfma_f32_16x16x32_bf16 v[176:179], v[196:199], v[172:175], v[36:39]
v_max_f32 v164, v168, v169
v_max_f32 v165, v170, v171
v_mfma_f32_16x16x32_bf16 v[184:187], v[204:207], v[180:183], v[36:39]
v_max_f32 v166, v200, v201
v_max_f32 v182, v216, v217
v_max_f32 v174, v208, v209
v_max_f32 v167, v202, v203
v_max3_f32 v129, v164, v165, v166
v_pk_fma_f32 v[156:157], v[140:141], v[92:93], v[156:157] op_sel:[0,1,0] op_sel_hi:[1,1,1]
v_pk_fma_f32 v[158:159], v[142:143], v[92:93], v[158:159] op_sel:[0,1,0] op_sel_hi:[1,1,1]
v_cvt_pk_bf16_f32 v156, v156, v157
v_pk_fma_f32 v[160:161], v[144:145], v[92:93], v[160:161] op_sel:[0,1,0] op_sel_hi:[1,1,1]
v_pk_fma_f32 v[162:163], v[146:147], v[92:93], v[162:163] op_sel:[0,1,0] op_sel_hi:[1,1,1]
v_cvt_pk_bf16_f32 v157, v158, v159
v_cvt_pk_bf16_f32 v158, v160, v161
v_cvt_pk_bf16_f32 v159, v162, v163
v_pk_fma_f32 v[220:221], v[76:77], v[56:57], v[220:221] op_sel:[0,0,0] op_sel_hi:[1,0,1]
v_pk_fma_f32 v[222:223], v[78:79], v[56:57], v[222:223] op_sel:[0,0,0] op_sel_hi:[1,0,1]
v_mfma_f32_16x16x32_bf16 v[192:195], v[188:191], v[156:159], v[40:43]
v_max_f32 v172, v176, v177
v_max_f32 v173, v178, v179
v_max_f32 v180, v184, v185
v_max_f32 v181, v186, v187
v_max_f32_e64 v175, v210, v211
v_pk_fma_f32 v[224:225], v[76:77], v[56:57], v[224:225] op_sel:[0,1,0] op_sel_hi:[1,1,1]
v_pk_fma_f32 v[226:227], v[78:79], v[56:57], v[226:227] op_sel:[0,1,0] op_sel_hi:[1,1,1]
v_pk_fma_f32 v[228:229], v[80:81], v[56:57], v[228:229] op_sel:[0,0,0] op_sel_hi:[1,0,1]
v_pk_fma_f32 v[230:231], v[82:83], v[56:57], v[230:231] op_sel:[0,0,0] op_sel_hi:[1,0,1]
v_pk_fma_f32 v[232:233], v[80:81], v[56:57], v[232:233] op_sel:[0,1,0] op_sel_hi:[1,1,1]
v_pk_fma_f32 v[234:235], v[82:83], v[56:57], v[234:235] op_sel:[0,1,0] op_sel_hi:[1,1,1]
v_pk_fma_f32 v[236:237], v[84:85], v[56:57], v[236:237] op_sel:[0,0,0] op_sel_hi:[1,0,1]
v_pk_fma_f32 v[238:239], v[86:87], v[56:57], v[238:239] op_sel:[0,0,0] op_sel_hi:[1,0,1]
v_pk_fma_f32 v[240:241], v[84:85], v[56:57], v[240:241] op_sel:[0,1,0] op_sel_hi:[1,1,1]
v_pk_fma_f32 v[242:243], v[86:87], v[56:57], v[242:243] op_sel:[0,1,0] op_sel_hi:[1,1,1]
v_pk_mul_f32 v[220:221], v[220:221], v[60:61]
v_pk_mul_f32 v[222:223], v[222:223], v[62:63]
v_pk_mul_f32 v[224:225], v[224:225], v[60:61]
s_cmp_lg_u32 s44, 0
s_cbranch_scc1 else_106
buffer_load_dwordx4 v[120:123], v58, s[32:35], 0 offen sc1
buffer_load_dwordx2 v[100:101], v59, s[32:35], 0 offen offset:1024 sc1
buffer_load_dwordx2 v[110:111], v59, s[32:35], 0 offen offset:1536 sc1
else_106:
v_pk_mul_f32 v[226:227], v[226:227], v[62:63]
v_pk_mul_f32 v[228:229], v[228:229], v[64:65]
v_pk_mul_f32 v[230:231], v[230:231], v[66:67]
v_pk_mul_f32 v[232:233], v[232:233], v[64:65]
v_pk_mul_f32 v[234:235], v[234:235], v[66:67]
v_pk_mul_f32 v[236:237], v[236:237], v[68:69]
v_pk_mul_f32 v[238:239], v[238:239], v[70:71]
v_pk_mul_f32 v[240:241], v[240:241], v[68:69]
v_pk_mul_f32 v[242:243], v[242:243], v[70:71]
v_max3_f32 v130, v172, v173, v174
v_max_f32_e64 v183, v218, v219
v_max3_f32 v131, v180, v181, v182
v_cvt_pk_bf16_f32 v102, v220, v221
v_cvt_pk_bf16_f32 v103, v222, v223
v_cvt_pk_bf16_f32 v112, v224, v225
v_cvt_pk_bf16_f32 v113, v226, v227
v_cvt_pk_bf16_f32 v104, v228, v229
v_cvt_pk_bf16_f32 v105, v230, v231
v_cvt_pk_bf16_f32 v114, v232, v233
v_cvt_pk_bf16_f32 v115, v234, v235
v_cvt_pk_bf16_f32 v106, v236, v237
v_cvt_pk_bf16_f32 v107, v238, v239
v_cvt_pk_bf16_f32 v116, v240, v241
v_cvt_pk_bf16_f32 v117, v242, v243
v_max_f32 v129, v129, v167
v_max_f32 v130, v130, v175
v_max_f32 v131, v131, v183
s_cmp_lg_u32 s44, 0
s_cbranch_scc1 else_108
s_mov_b32 s63, 0
sent_110:
s_waitcnt vmcnt(0)
v_max_u32 v4, v120, v121
v_max3_u32 v4, v4, v122, v123
v_max3_u32 v4, v4, v100, v101
v_max3_u32 v4, v4, v110, v111
v_cmp_eq_u32 vcc, -1, v4
s_cbranch_vccz sentd_111
buffer_load_dwordx4 v[120:123], v58, s[32:35], 0 offen sc1
buffer_load_dwordx2 v[100:101], v59, s[32:35], 0 offen offset:1024 sc1
buffer_load_dwordx2 v[110:111], v59, s[32:35], 0 offen offset:1536 sc1
s_add_u32 s63, s63, 1
s_cmp_lt_u32 s63, 0x80000
s_cbranch_scc1 sent_110
s_waitcnt vmcnt(0)
sentd_111:
s_branch fi_109
else_108:
s_mov_b32 s63, 0
px_112:
ds_read_b32 v4, v19
ds_read_b128 v[120:123], v53
ds_read_b64 v[100:101], v55 offset:1024
ds_read_b64 v[110:111], v55 offset:1536
s_add_u32 s63, s63, 1
s_cmp_lt_u32 s63, 0x400000
s_waitcnt lgkmcnt(0)
v_cmp_ne_u32 vcc, 3, v4
s_cbranch_vccz pxd_113
s_cbranch_scc1 px_112
pxd_113:
fi_109:
s_cmp_eq_u32 s46, 0
s_cbranch_scc1 slow_114
.p2align 3
v_mfma_f32_16x16x32_bf16 v[160:163], v[120:123], v[156:159], v[44:47]
v_max_f32 v158, v192, v193
v_max_f32 v159, v194, v195
v_permlane32_swap_b32 v130, v131
s_nop 0
v_max_f32 v130, v130, v131
s_nop 2
v_max_f32 v156, v160, v161
v_max_f32 v157, v162, v163
v_max3_f32 v128, v156, v157, v158
v_max_f32 v128, v128, v159
s_nop 1
v_permlane32_swap_b32 v128, v129
s_nop 0
v_max_f32 v128, v128, v129
s_nop 1
v_permlane16_swap_b32 v128, v130
s_nop 0
v_max_f32 v128, v128, v130
v_mov_b32 v130, v128
s_nop 1
v_permlane16_swap_b32 v128, v130
s_nop 0
v_mov_b32 v129, v128
v_mov_b32 v131, v130
s_nop 0
v_permlane32_swap_b32 v128, v129
v_permlane32_swap_b32 v130, v131
v_mul_f32 v128, v128, v124
v_mul_f32 v129, v129, v125
v_pk_fma_f32 v[156:157], v[156:157], v[124:125], v[128:129] op_sel:[0,0,0] op_sel_hi:[1,0,0] neg_lo:[0,0,1] neg_hi:[0,0,1]
v_pk_fma_f32 v[158:159], v[158:159], v[124:125], v[128:129] op_sel:[0,0,0] op_sel_hi:[1,0,0] neg_lo:[0,0,1] neg_hi:[0,0,1]
v_mul_f32 v130, v130, v126
v_mul_f32 v131, v131, v127
v_exp_f32 v156, v156
v_exp_f32 v157, v157
v_exp_f32 v158, v158
v_exp_f32 v159, v159
v_pk_fma_f32 v[164:165], v[164:165], v[124:125], v[128:129] op_sel:[0,1,1] op_sel_hi:[1,1,1] neg_lo:[0,0,1] neg_hi:[0,0,1]
v_pk_fma_f32 v[166:167], v[166:167], v[124:125], v[128:129] op_sel:[0,1,1] op_sel_hi:[1,1,1] neg_lo:[0,0,1] neg_hi:[0,0,1]
v_exp_f32 v164, v164
v_exp_f32 v165, v165
v_exp_f32 v166, v166
v_exp_f32 v167, v167
v_pk_fma_f32 v[172:173], v[172:173], v[126:127], v[130:131] op_sel:[0,0,0] op_sel_hi:[1,0,0] neg_lo:[0,0,1] neg_hi:[0,0,1]
v_pk_fma_f32 v[174:175], v[174:175], v[126:127], v[130:131] op_sel:[0,0,0] op_sel_hi:[1,0,0] neg_lo:[0,0,1] neg_hi:[0,0,1]
v_cvt_pk_bf16_f32 v156, v156, v156
v_cvt_pk_bf16_f32 v157, v157, v157
v_cvt_pk_bf16_f32 v158, v158, v158
v_cvt_pk_bf16_f32 v159, v159, v159
v_exp_f32 v172, v172
v_exp_f32 v173, v173
v_exp_f32 v174, v174
v_exp_f32 v175, v175
v_pk_fma_f32 v[180:181], v[180:181], v[126:127], v[130:131] op_sel:[0,1,1] op_sel_hi:[1,1,1] neg_lo:[0,0,1] neg_hi:[0,0,1]
v_pk_fma_f32 v[182:183], v[182:183], v[126:127], v[130:131] op_sel:[0,1,1] op_sel_hi:[1,1,1] neg_lo:[0,0,1] neg_hi:[0,0,1]
v_and_b32 v156, v52, v156
v_and_b32 v157, v52, v157
v_and_b32 v158, v52, v158
v_and_b32 v159, v52, v159
v_cvt_pk_bf16_f32 v164, v164, v164
v_cvt_pk_bf16_f32 v165, v165, v165
v_mfma_f32_16x16x32_bf16 v[160:163], v[48:51], v[156:159], 0
v_cvt_pk_bf16_f32 v166, v166, v166
v_cvt_pk_bf16_f32 v167, v167, v167
v_mfma_f32_16x16x32_bf16 v[220:223], v[100:103], v[156:159], 0
v_exp_f32 v180, v180
v_mfma_f32_16x16x32_bf16 v[224:227], v[110:113], v[156:159], 0
v_exp_f32 v181, v181
v_exp_f32 v182, v182
v_exp_f32 v183, v183
v_and_b32 v164, v52, v164
v_and_b32 v165, v52, v165
v_and_b32 v166, v52, v166
v_and_b32 v167, v52, v167
v_cvt_pk_bf16_f32 v172, v172, v172
v_cvt_pk_bf16_f32 v173, v173, v173
v_mfma_f32_16x16x32_bf16 v[168:171], v[48:51], v[164:167], 0
v_cvt_pk_bf16_f32 v174, v174, v174
v_cvt_pk_bf16_f32 v175, v175, v175
v_mfma_f32_16x16x32_bf16 v[228:231], v[102:105], v[164:167], 0
v_and_b32 v172, v52, v172
v_and_b32 v173, v52, v173
v_mfma_f32_16x16x32_bf16 v[232:235], v[112:115], v[164:167], 0
v_and_b32 v174, v52, v174
v_and_b32 v175, v52, v175
v_cvt_pk_bf16_f32 v180, v180, v180
v_cvt_pk_bf16_f32 v181, v181, v181
v_mfma_f32_16x16x32_bf16 v[176:179], v[48:51], v[172:175], 0
v_cvt_pk_bf16_f32 v182, v182, v182
v_cvt_pk_bf16_f32 v183, v183, v183
v_mfma_f32_16x16x32_bf16 v[236:239], v[104:107], v[172:175], 0
v_and_b32 v180, v52, v180
v_and_b32 v181, v52, v181
v_mfma_f32_16x16x32_bf16 v[240:243], v[114:117], v[172:175], 0
v_and_b32 v182, v52, v182
v_and_b32 v183, v52, v183
v_rcp_f32 v160, v160
v_rcp_f32 v168, v168
v_pk_mul_f32 v[220:221], v[220:221], v[160:161] op_sel:[0,0] op_sel_hi:[1,0]
v_pk_mul_f32 v[222:223], v[222:223], v[160:161] op_sel:[0,0] op_sel_hi:[1,0]
v_pk_mul_f32 v[228:229], v[228:229], v[168:169] op_sel:[0,0] op_sel_hi:[1,0]
v_pk_mul_f32 v[224:225], v[224:225], v[160:161] op_sel:[0,0] op_sel_hi:[1,0]
v_pk_mul_f32 v[226:227], v[226:227], v[160:161] op_sel:[0,0] op_sel_hi:[1,0]
v_pk_mul_f32 v[230:231], v[230:231], v[168:169] op_sel:[0,0] op_sel_hi:[1,0]
v_pk_mul_f32 v[232:233], v[232:233], v[168:169] op_sel:[0,0] op_sel_hi:[1,0]
v_pk_mul_f32 v[234:235], v[234:235], v[168:169] op_sel:[0,0] op_sel_hi:[1,0]
v_mfma_f32_16x16x32_bf16 v[184:187], v[48:51], v[180:183], 0
v_rcp_f32_e64 v176, v176
v_cvt_pk_bf16_f32 v220, v220, v221
v_cvt_pk_bf16_f32 v221, v222, v223
v_cvt_pk_bf16_f32 v228, v228, v229
v_pk_mul_f32 v[236:237], v[236:237], v[176:177] op_sel:[0,0] op_sel_hi:[1,0]
v_mfma_f32_16x16x32_bf16 v[244:247], v[106:109], v[180:183], 0
v_cvt_pk_bf16_f32 v222, v224, v225
v_cvt_pk_bf16_f32 v223, v226, v227
v_rcp_f32_e64 v184, v184
v_cvt_pk_bf16_f32 v229, v230, v231
v_pk_mul_f32 v[238:239], v[238:239], v[176:177] op_sel:[0,0] op_sel_hi:[1,0]
v_pk_mul_f32 v[240:241], v[240:241], v[176:177] op_sel:[0,0] op_sel_hi:[1,0]
v_pk_mul_f32 v[242:243], v[242:243], v[176:177] op_sel:[0,0] op_sel_hi:[1,0]
v_cvt_pk_bf16_f32 v236, v236, v237
v_pk_mul_f32 v[244:245], v[244:245], v[184:185] op_sel:[0,0] op_sel_hi:[1,0]
v_pk_mul_f32 v[246:247], v[246:247], v[184:185] op_sel:[0,0] op_sel_hi:[1,0]
v_mfma_f32_16x16x32_bf16 v[248:251], v[116:119], v[180:183], 0
buffer_store_dwordx4 v[220:223], v18, s[32:35], s80 offen
v_cvt_pk_bf16_f32 v230, v232, v233
v_cvt_pk_bf16_f32 v231, v234, v235
v_cvt_pk_bf16_f32 v237, v238, v239
v_cvt_pk_bf16_f32 v244, v244, v245
buffer_store_dwordx4 v[228:231], v18, s[32:35], s81 offen
v_cvt_pk_bf16_f32 v238, v240, v241
v_cvt_pk_bf16_f32 v239, v242, v243
v_pk_mul_f32 v[248:249], v[248:249], v[184:185] op_sel:[0,0] op_sel_hi:[1,0]
v_pk_mul_f32 v[250:251], v[250:251], v[184:185] op_sel:[0,0] op_sel_hi:[1,0]
v_cvt_pk_bf16_f32 v245, v246, v247
buffer_store_dwordx4 v[236:239], v18, s[32:35], s82 offen
v_cvt_pk_bf16_f32 v246, v248, v249
v_cvt_pk_bf16_f32 v247, v250, v251
buffer_store_dwordx4 v[244:247], v18, s[32:35], s83 offen
back_115:
s_barrier
v_and_b32 v36, 31, v0
v_lshlrev_b32 v36, 2, v36
s_lshl_b32 s62, s45, 2
v_mov_b32 v4, s62
v_mov_b32 v5, 3
s_mov_b64 exec, 1
s_waitcnt vmcnt(0)
s_cmp_eq_u32 s46, 0
s_cbranch_scc1 slow_116
buffer_store_dword v5, v4, s[32:35], s84 offen
back_117:
s_mov_b64 exec, -1
v_lshrrev_b32 v4, 2, v2
v_and_b32 v5, 3, v0
v_lshl_add_u32 v6, v3, 3, v4
v_lshlrev_b32 v6, 7, v6
v_lshl_add_u32 v6, v5, 3, v6
v_lshrrev_b32 v7, 1, v4
v_and_b32 v8, 1, v3
v_lshl_add_u32 v7, v8, 1, v7
v_lshl_add_u32 v10, v7, 5, v6
v_xor_b32 v11, 32, v10
v_xor_b32 v12, 64, v10
v_xor_b32 v13, 96, v10
v_add_u32 v14, 0x10000, v10
v_add_u32 v15, 0x10000, v11
v_add_u32 v16, 0x10000, v12
v_add_u32 v17, 0x10000, v13
ds_read_b64_tr_b16 v[220:221], v10 offset:0
ds_read_b64_tr_b16 v[222:223], v10 offset:512
ds_read_b64_tr_b16 v[224:225], v11 offset:0
ds_read_b64_tr_b16 v[226:227], v11 offset:512
ds_read_b64_tr_b16 v[228:229], v12 offset:0
ds_read_b64_tr_b16 v[230:231], v12 offset:512
ds_read_b64_tr_b16 v[232:233], v13 offset:0
ds_read_b64_tr_b16 v[234:235], v13 offset:512
ds_read_b64_tr_b16 v[236:237], v10 offset:4096
ds_read_b64_tr_b16 v[238:239], v10 offset:4608
ds_read_b64_tr_b16 v[240:241], v11 offset:4096
ds_read_b64_tr_b16 v[242:243], v11 offset:4608
ds_read_b64_tr_b16 v[244:245], v12 offset:4096
ds_read_b64_tr_b16 v[246:247], v12 offset:4608
ds_read_b64_tr_b16 v[248:249], v13 offset:4096
ds_read_b64_tr_b16 v[250:251], v13 offset:4608
s_lshl_b32 s48, s41, 3
s_lshl_b32 s49, s40, 1
s_add_u32 s48, s48, s49
s_lshl_b32 s48, s48, 15
s_add_u32 s48, s48, 4194304
v_add_u32 v38, s48, v18
v_add_u32 v39, 32768, v38
s_lshl_b32 s57, s75, 11
s_add_u32 s87, s87, 262144
v_lshlrev_b32 v60, 16, v20
v_and_b32 v61, 0xffff0000, v20
v_lshlrev_b32 v62, 16, v21
v_and_b32 v63, 0xffff0000, v21
v_lshlrev_b32 v64, 16, v22
v_and_b32 v65, 0xffff0000, v22
v_lshlrev_b32 v66, 16, v23
v_and_b32 v67, 0xffff0000, v23
v_lshlrev_b32 v68, 16, v24
v_and_b32 v69, 0xffff0000, v24
v_lshlrev_b32 v70, 16, v25
v_and_b32 v71, 0xffff0000, v25
v_lshlrev_b32 v72, 16, v26
v_and_b32 v73, 0xffff0000, v26
v_lshlrev_b32 v74, 16, v27
v_and_b32 v75, 0xffff0000, v27
v_lshlrev_b32 v76, 16, v28
v_and_b32 v77, 0xffff0000, v28
v_lshlrev_b32 v78, 16, v29
v_and_b32 v79, 0xffff0000, v29
v_lshlrev_b32 v80, 16, v30
v_and_b32 v81, 0xffff0000, v30
v_lshlrev_b32 v82, 16, v31
v_and_b32 v83, 0xffff0000, v31
v_lshlrev_b32 v84, 16, v32
v_and_b32 v85, 0xffff0000, v32
v_lshlrev_b32 v86, 16, v33
v_and_b32 v87, 0xffff0000, v33
v_lshlrev_b32 v88, 16, v34
v_and_b32 v89, 0xffff0000, v34
v_lshlrev_b32 v90, 16, v35
v_and_b32 v91, 0xffff0000, v35
v_mov_b32 v6, 0
v_mov_b32 v7, 0
v_mov_b32 v8, 0
v_mov_b32 v9, 0
s_lshl_b32 s62, s42, 2
v_mov_b32 v4, s62
v_mov_b32 v5, 3
buffer_load_dword v37, v36, s[32:35], s84 offen sc1
s_mov_b32 s63, 0
s_waitcnt vmcnt(0)
poll_118:
v_cmp_gt_u32 vcc, 3, v37
s_cbranch_vccz polled_119
buffer_load_dword v37, v36, s[32:35], s84 offen sc1
s_add_u32 s63, s63, 1
s_cmp_lt_u32 s63, 0x80000
s_waitcnt vmcnt(0)
s_cbranch_scc1 poll_118
polled_119:
s_call_b64 s[94:95], R_oloop
s_cmp_eq_u32 s46, 0
s_cbranch_scc1 slow_120
s_nop 0
v_cvt_pk_bf16_f32 v20, v60, v61
v_cvt_pk_bf16_f32 v21, v62, v63
v_cvt_pk_bf16_f32 v22, v64, v65
v_cvt_pk_bf16_f32 v23, v66, v67
buffer_store_dwordx4 v[20:23], v18, s[32:35], s85 offen offset:0
v_cvt_pk_bf16_f32 v24, v68, v69
v_cvt_pk_bf16_f32 v25, v70, v71
v_cvt_pk_bf16_f32 v26, v72, v73
v_cvt_pk_bf16_f32 v27, v74, v75
buffer_store_dwordx4 v[24:27], v18, s[32:35], s85 offen offset:1024
v_cvt_pk_bf16_f32 v28, v76, v77
v_cvt_pk_bf16_f32 v29, v78, v79
v_cvt_pk_bf16_f32 v30, v80, v81
v_cvt_pk_bf16_f32 v31, v82, v83
buffer_store_dwordx4 v[28:31], v18, s[32:35], s86 offen offset:0
v_cvt_pk_bf16_f32 v32, v84, v85
v_cvt_pk_bf16_f32 v33, v86, v87
v_cvt_pk_bf16_f32 v34, v88, v89
v_cvt_pk_bf16_f32 v35, v90, v91
buffer_store_dwordx4 v[32:35], v18, s[32:35], s86 offen offset:1024
s_barrier
v_dot2c_f32_bf16 v6, v20, v48
v_dot2c_f32_bf16 v8, v20, v20
v_dot2c_f32_bf16 v7, v28, v48
v_dot2c_f32_bf16 v9, v28, v28
v_dot2c_f32_bf16 v6, v21, v48
v_dot2c_f32_bf16 v8, v21, v21
v_dot2c_f32_bf16 v7, v29, v48
v_dot2c_f32_bf16 v9, v29, v29
v_dot2c_f32_bf16 v6, v22, v48
v_dot2c_f32_bf16 v8, v22, v22
v_dot2c_f32_bf16 v7, v30, v48
v_dot2c_f32_bf16 v9, v30, v30
v_dot2c_f32_bf16 v6, v23, v48
v_dot2c_f32_bf16 v8, v23, v23
v_dot2c_f32_bf16 v7, v31, v48
v_dot2c_f32_bf16 v9, v31, v31
v_dot2c_f32_bf16 v6, v24, v48
v_dot2c_f32_bf16 v8, v24, v24
v_dot2c_f32_bf16 v7, v32, v48
v_dot2c_f32_bf16 v9, v32, v32
v_dot2c_f32_bf16 v6, v25, v48
v_dot2c_f32_bf16 v8, v25, v25
v_dot2c_f32_bf16 v7, v33, v48
v_dot2c_f32_bf16 v9, v33, v33
v_dot2c_f32_bf16 v6, v26, v48
v_dot2c_f32_bf16 v8, v26, v26
v_dot2c_f32_bf16 v7, v34, v48
v_dot2c_f32_bf16 v9, v34, v34
v_dot2c_f32_bf16 v6, v27, v48
v_dot2c_f32_bf16 v8, v27, v27
v_dot2c_f32_bf16 v7, v35, v48
v_dot2c_f32_bf16 v9, v35, v35
s_mov_b64 exec, 1
s_waitcnt vmcnt(0)
buffer_store_dword v5, v4, s[32:35], s88 offen
s_mov_b64 exec, -1
s_nop 1
v_permlane32_swap_b32 v6, v7
v_permlane32_swap_b32 v8, v9
v_add_f32 v6, v6, v7
v_add_f32 v8, v8, v9
s_nop 1
v_permlane16_swap_b32 v6, v8
s_nop 0
v_add_f32 v6, v6, v8
buffer_store_dword v6, v1, s[32:35], s87 offen
back_121:
s_lshl_b32 s49, s44, 13
v_add_u32 v10, s49, v18
v_add_u32 v11, 1024, v10
s_lshl_b32 s48, s43, 1
v_lshrrev_b32 v4, 2, v2
v_and_b32 v5, 3, v0
v_lshl_add_u32 v6, v3, 3, v4
v_lshlrev_b32 v6, 7, v6
v_lshl_add_u32 v6, v5, 3, v6
v_lshrrev_b32 v7, 1, v4
v_and_b32 v8, 1, v3
v_lshl_add_u32 v7, v8, 1, v7
v_xor_b32 v7, s48, v7
v_lshl_add_u32 v12, v7, 5, v6
v_add_u32 v12, 16384, v12
v_xor_b32 v13, 32, v12
v_mov_b32 v14, v10
v_mov_b32 v15, v11
v_add_u32 v16, 122880, v12
v_add_u32 v17, 122880, v13
v_mov_b32 v156, 0
v_mov_b32 v157, 0
v_mov_b32 v158, 0
v_mov_b32 v159, 0
v_mov_b32 v160, 0
v_mov_b32 v161, 0
v_mov_b32 v162, 0
v_mov_b32 v163, 0
v_mov_b32 v164, 0
v_mov_b32 v165, 0
v_mov_b32 v166, 0
v_mov_b32 v167, 0
v_mov_b32 v168, 0
v_mov_b32 v169, 0
v_mov_b32 v170, 0
v_mov_b32 v171, 0
v_mov_b32 v172, 0
v_mov_b32 v173, 0
v_mov_b32 v174, 0
v_mov_b32 v175, 0
v_mov_b32 v176, 0
v_mov_b32 v177, 0
v_mov_b32 v178, 0
v_mov_b32 v179, 0
v_mov_b32 v180, 0
v_mov_b32 v181, 0
v_mov_b32 v182, 0
v_mov_b32 v183, 0
v_mov_b32 v184, 0
v_mov_b32 v185, 0
v_mov_b32 v186, 0
v_mov_b32 v187, 0
v_mov_b32 v188, 0
v_mov_b32 v189, 0
v_mov_b32 v190, 0
v_mov_b32 v191, 0
v_mov_b32 v192, 0
v_mov_b32 v193, 0
v_mov_b32 v194, 0
v_mov_b32 v195, 0
v_mov_b32 v196, 0
v_mov_b32 v197, 0
v_mov_b32 v198, 0
v_mov_b32 v199, 0
v_mov_b32 v200, 0
v_mov_b32 v201, 0
v_mov_b32 v202, 0
v_mov_b32 v203, 0
v_mov_b32 v204, 0
v_mov_b32 v205, 0
v_mov_b32 v206, 0
v_mov_b32 v207, 0
v_mov_b32 v208, 0
v_mov_b32 v209, 0
v_mov_b32 v210, 0
v_mov_b32 v211, 0
v_mov_b32 v212, 0
v_mov_b32 v213, 0
v_mov_b32 v214, 0
v_mov_b32 v215, 0
v_mov_b32 v216, 0
v_mov_b32 v217, 0
v_mov_b32 v218, 0
v_mov_b32 v219, 0
v_mov_b32 v220, 0
v_mov_b32 v221, 0
v_mov_b32 v222, 0
v_mov_b32 v223, 0
v_mov_b32 v224, 0
v_mov_b32 v225, 0
v_mov_b32 v226, 0
v_mov_b32 v227, 0
v_mov_b32 v228, 0
v_mov_b32 v229, 0
v_mov_b32 v230, 0
v_mov_b32 v231, 0
v_mov_b32 v232, 0
v_mov_b32 v233, 0
v_mov_b32 v234, 0
v_mov_b32 v235, 0
v_mov_b32 v236, 0
v_mov_b32 v237, 0
v_mov_b32 v238, 0
v_mov_b32 v239, 0
v_mov_b32 v240, 0
v_mov_b32 v241, 0
v_mov_b32 v242, 0
v_mov_b32 v243, 0
v_mov_b32 v244, 0
v_mov_b32 v245, 0
v_mov_b32 v246, 0
v_mov_b32 v247, 0
v_mov_b32 v248, 0
v_mov_b32 v249, 0
v_mov_b32 v250, 0
v_mov_b32 v251, 0
v_lshrrev_b32 v6, 2, v2
v_cmp_eq_u32 vcc, v6, v3
v_and_b32 v7, 1, v0
v_lshlrev_b32 v7, 4, v7
v_mov_b32 v8, 0x3f80
v_lshlrev_b32 v9, v7, v8
v_cndmask_b32 v7, 0, v9, vcc
v_and_b32 v6, 2, v0
v_cmp_eq_u32 vcc, 0, v6
v_mov_b32 v36, 0
v_mov_b32 v37, 0
v_mov_b32 v40, 0
v_mov_b32 v41, 0
v_cndmask_b32 v38, 0, v7, vcc
v_cndmask_b32 v39, v7, 0, vcc
v_lshrrev_b32 v8, 1, v2
v_cmp_eq_u32 vcc, 0, v8
s_nop 1
v_cndmask_b32 v44, 0, v9, vcc
v_cmp_eq_u32 vcc, 1, v8
s_nop 1
v_cndmask_b32 v45, 0, v9, vcc
v_cmp_eq_u32 vcc, 2, v8
s_nop 1
v_cndmask_b32 v46, 0, v9, vcc
v_cmp_eq_u32 vcc, 3, v8
s_nop 1
v_cndmask_b32 v47, 0, v9, vcc
v_lshrrev_b32 v4, 2, v2
v_lshl_add_u32 v4, v3, 2, v4
v_lshlrev_b32 v4, 6, v4
v_and_b32 v5, 3, v0
v_lshl_add_u32 v4, v5, 3, v4
s_lshl_b32 s48, s43, 11
s_add_u32 s48, s48, 135168
v_add_u32 v53, s48, v4
s_mul_i32 s48, s40, 3072
s_add_u32 s48, s48, 139264
v_add_u32 v42, s48, v18
s_xor_b32 s49, s40, 2
s_mul_i32 s48, s49, 3072
s_add_u32 s48, s48, 139264
v_add_u32 v43, s48, v18
s_lshl_b32 s49, s49, 2
s_add_u32 s49, s49, 134672
v_mov_b32 v19, s49
v_xor_b32 v52, 8, v19
v_lshrrev_b32 v4, 3, v0
v_and_b32 v5, 7, v0
v_lshlrev_b32 v4, 11, v4
v_lshl_add_u32 v55, v5, 4, v4
v_lshlrev_b32 v4, 6, v2
v_lshl_add_u32 v58, v3, 4, v4
v_lshlrev_b32 v4, 4, v2
v_lshl_add_u32 v59, v3, 3, v4
s_mul_i32 s51, s42, 163840
s_add_u32 s51, s51, 9437184
s_lshl_b32 s50, s43, 1
s_add_u32 s50, s50, s44
s_lshl_b32 s48, s50, 15
s_add_u32 s48, s48, s51
s_add_u32 s48, s48, 0
s_lshl_b32 s49, s41, 7
s_add_u32 s53, s48, s49
s_add_u32 s54, s53, 16384
s_lshl_b32 s56, s50, 10
s_add_u32 s56, s56, s51
s_add_u32 s56, s56, 151552
s_xor_b32 s57, s56, 1024
s_lshl_b32 s58, s50, 11
s_add_u32 s58, s58, s51
s_add_u32 s58, s58, 139264
s_xor_b32 s59, s58, 2048
s_add_u32 s79, s58, s49
s_lshl_b32 s50, s41, 11
s_add_u32 s55, s48, s50
s_lshl_b32 s48, s43, 7
s_add_u32 s48, s48, 133888
v_lshl_add_u32 v7, v3, 4, s48
v_lshl_add_u32 v54, v2, 2, s48
s_lshl_b32 s49, s44, 6
v_add_u32 v8, s49, v2
v_lshlrev_b32 v8, 3, v8
v_add_u32 v8, 131072, v8
v_lshl_add_u32 v9, v3, 2, s49
v_lshlrev_b32 v9, 2, v9
v_add_u32 v9, 132096, v9
s_mov_b32 s64, 0
s_mov_b32 s65, 0
s_mov_b32 s66, 0x3fb8aa3b
s_mov_b32 s61, 4
ds_read_b64_tr_b16 v[84:85], v16 offset:8192
ds_read_b64_tr_b16 v[86:87], v16 offset:8704
ds_read_b64_tr_b16 v[88:89], v17 offset:8192
ds_read_b64_tr_b16 v[90:91], v17 offset:8704
ds_read_b64_tr_b16 v[92:93], v16 offset:16384
ds_read_b64_tr_b16 v[94:95], v16 offset:16896
ds_read_b64_tr_b16 v[96:97], v17 offset:16384
ds_read_b64_tr_b16 v[98:99], v17 offset:16896
ds_read_b64_tr_b16 v[76:77], v16 offset:0
ds_read_b64_tr_b16 v[78:79], v16 offset:512
ds_read_b64_tr_b16 v[80:81], v17 offset:0
ds_read_b64_tr_b16 v[82:83], v17 offset:512
s_barrier
ds_read_b128 v[60:63], v14 offset:0
ds_read_b128 v[64:67], v14 offset:2048
ds_read_b128 v[68:71], v14 offset:4096
ds_read_b128 v[72:75], v14 offset:6144
s_waitcnt lgkmcnt(0)
c3_loop:
v_mfma_f32_16x16x32_bf16 v[212:215], v[84:87], v[72:75], v[212:215]
ds_read_b128 v[100:103], v15 offset:0
v_mfma_f32_16x16x32_bf16 v[204:207], v[84:87], v[68:71], v[204:207]
ds_read_b128 v[104:107], v15 offset:2048
v_mfma_f32_16x16x32_bf16 v[196:199], v[84:87], v[64:67], v[196:199]
ds_read_b128 v[108:111], v15 offset:4096
v_mfma_f32_16x16x32_bf16 v[188:191], v[84:87], v[60:63], v[188:191]
ds_read_b128 v[112:115], v15 offset:6144
v_mfma_f32_16x16x32_bf16 v[192:195], v[88:91], v[60:63], v[192:195]
ds_read_b64_tr_b16 v[124:125], v16 offset:12288
v_mfma_f32_16x16x32_bf16 v[200:203], v[88:91], v[64:67], v[200:203]
ds_read_b64_tr_b16 v[126:127], v16 offset:12800
v_mfma_f32_16x16x32_bf16 v[208:211], v[88:91], v[68:71], v[208:211]
ds_read_b64_tr_b16 v[128:129], v17 offset:12288
v_mfma_f32_16x16x32_bf16 v[216:219], v[88:91], v[72:75], v[216:219]
ds_read_b64_tr_b16 v[130:131], v17 offset:12800
v_mfma_f32_16x16x32_bf16 v[244:247], v[72:75], v[92:95], v[244:247]
ds_read_b64_tr_b16 v[132:133], v16 offset:20480
v_mfma_f32_16x16x32_bf16 v[248:251], v[72:75], v[96:99], v[248:251]
ds_read_b64_tr_b16 v[134:135], v16 offset:20992
v_mfma_f32_16x16x32_bf16 v[240:243], v[68:71], v[96:99], v[240:243]
ds_read_b64_tr_b16 v[136:137], v17 offset:20480
v_mfma_f32_16x16x32_bf16 v[236:239], v[68:71], v[92:95], v[236:239]
ds_read_b64_tr_b16 v[138:139], v17 offset:20992
v_mfma_f32_16x16x32_bf16 v[228:231], v[64:67], v[92:95], v[228:231]
ds_read_b64_tr_b16 v[116:117], v16 offset:4096
v_mfma_f32_16x16x32_bf16 v[232:235], v[64:67], v[96:99], v[232:235]
ds_read_b64_tr_b16 v[118:119], v16 offset:4608
v_mfma_f32_16x16x32_bf16 v[224:227], v[60:63], v[96:99], v[224:227]
ds_read_b64_tr_b16 v[120:121], v17 offset:4096
v_mfma_f32_16x16x32_bf16 v[220:223], v[60:63], v[92:95], v[220:223]
ds_read_b64_tr_b16 v[122:123], v17 offset:4608
v_mfma_f32_16x16x32_bf16 v[156:159], v[76:79], v[60:63], v[156:159]
s_add_u32 s65, s65, 40960
s_cmp_eq_u32 s65, 122880
v_mfma_f32_16x16x32_bf16 v[164:167], v[76:79], v[64:67], v[164:167]
s_cselect_b32 s65, 0, s65
s_add_u32 s64, s64, 1
v_mfma_f32_16x16x32_bf16 v[172:175], v[76:79], v[68:71], v[172:175]
v_add_u32 v14, s65, v10
v_add_u32 v15, s65, v11
v_mfma_f32_16x16x32_bf16 v[180:183], v[76:79], v[72:75], v[180:183]
v_add_u32 v16, s65, v12
v_add_u32 v17, s65, v13
v_mfma_f32_16x16x32_bf16 v[184:187], v[80:83], v[72:75], v[184:187]
v_mfma_f32_16x16x32_bf16 v[176:179], v[80:83], v[68:71], v[176:179]
s_cmp_eq_u32 s64, 16
s_cbranch_scc1 c3_last
v_mfma_f32_16x16x32_bf16 v[168:171], v[80:83], v[64:67], v[168:171]
s_waitcnt lgkmcnt(0)
v_mfma_f32_16x16x32_bf16 v[160:163], v[80:83], v[60:63], v[160:163]
s_barrier
v_mfma_f32_16x16x32_bf16 v[212:215], v[124:127], v[112:115], v[212:215]
ds_read_b128 v[60:63], v14 offset:0
v_mfma_f32_16x16x32_bf16 v[204:207], v[124:127], v[108:111], v[204:207]
ds_read_b128 v[64:67], v14 offset:2048
v_mfma_f32_16x16x32_bf16 v[196:199], v[124:127], v[104:107], v[196:199]
ds_read_b128 v[68:71], v14 offset:4096
v_mfma_f32_16x16x32_bf16 v[188:191], v[124:127], v[100:103], v[188:191]
ds_read_b128 v[72:75], v14 offset:6144
v_mfma_f32_16x16x32_bf16 v[192:195], v[128:131], v[100:103], v[192:195]
ds_read_b64_tr_b16 v[84:85], v16 offset:8192
v_mfma_f32_16x16x32_bf16 v[200:203], v[128:131], v[104:107], v[200:203]
ds_read_b64_tr_b16 v[86:87], v16 offset:8704
v_mfma_f32_16x16x32_bf16 v[208:211], v[128:131], v[108:111], v[208:211]
ds_read_b64_tr_b16 v[88:89], v17 offset:8192
v_mfma_f32_16x16x32_bf16 v[216:219], v[128:131], v[112:115], v[216:219]
ds_read_b64_tr_b16 v[90:91], v17 offset:8704
v_mfma_f32_16x16x32_bf16 v[244:247], v[112:115], v[132:135], v[244:247]
ds_read_b64_tr_b16 v[92:93], v16 offset:16384
v_mfma_f32_16x16x32_bf16 v[248:251], v[112:115], v[136:139], v[248:251]
ds_read_b64_tr_b16 v[94:95], v16 offset:16896
v_mfma_f32_16x16x32_bf16 v[240:243], v[108:111], v[136:139], v[240:243]
ds_read_b64_tr_b16 v[96:97], v17 offset:16384
v_mfma_f32_16x16x32_bf16 v[236:239], v[108:111], v[132:135], v[236:239]
ds_read_b64_tr_b16 v[98:99], v17 offset:16896
v_mfma_f32_16x16x32_bf16 v[228:231], v[104:107], v[132:135], v[228:231]
ds_read_b64_tr_b16 v[76:77], v16 offset:0
v_mfma_f32_16x16x32_bf16 v[232:235], v[104:107], v[136:139], v[232:235]
ds_read_b64_tr_b16 v[78:79], v16 offset:512
v_mfma_f32_16x16x32_bf16 v[224:227], v[100:103], v[136:139], v[224:227]
ds_read_b64_tr_b16 v[80:81], v17 offset:0
v_mfma_f32_16x16x32_bf16 v[220:223], v[100:103], v[132:135], v[220:223]
ds_read_b64_tr_b16 v[82:83], v17 offset:512
v_mfma_f32_16x16x32_bf16 v[156:159], v[116:119], v[100:103], v[156:159]
v_mfma_f32_16x16x32_bf16 v[164:167], v[116:119], v[104:107], v[164:167]
v_mfma_f32_16x16x32_bf16 v[172:175], v[116:119], v[108:111], v[172:175]
v_mfma_f32_16x16x32_bf16 v[180:183], v[116:119], v[112:115], v[180:183]
v_mfma_f32_16x16x32_bf16 v[184:187], v[120:123], v[112:115], v[184:187]
v_mfma_f32_16x16x32_bf16 v[176:179], v[120:123], v[108:111], v[176:179]
v_mfma_f32_16x16x32_bf16 v[168:171], v[120:123], v[104:107], v[168:171]
s_waitcnt lgkmcnt(0)
v_mfma_f32_16x16x32_bf16 v[160:163], v[120:123], v[100:103], v[160:163]
s_branch c3_loop
c3_last:
v_mfma_f32_16x16x32_bf16 v[168:171], v[80:83], v[64:67], v[168:171]
s_waitcnt lgkmcnt(0)
v_mfma_f32_16x16x32_bf16 v[160:163], v[80:83], v[60:63], v[160:163]
v_mfma_f32_16x16x32_bf16 v[212:215], v[124:127], v[112:115], v[212:215]
ds_read_b64_tr_b16 v[10:11], v53 offset:0
ds_read_b64_tr_b16 v[12:13], v53 offset:1024
v_mfma_f32_16x16x32_bf16 v[204:207], v[124:127], v[108:111], v[204:207]
ds_read_b64_tr_b16 v[14:15], v53 offset:32
ds_read_b64_tr_b16 v[16:17], v53 offset:1056
v_mfma_f32_16x16x32_bf16 v[196:199], v[124:127], v[104:107], v[196:199]
ds_read_b128 v[140:143], v7 offset:0
s_mul_i32 s48, s44, 0x80008000
v_mfma_f32_16x16x32_bf16 v[188:191], v[124:127], v[100:103], v[188:191]
ds_read_b128 v[144:147], v7 offset:64
v_mfma_f32_16x16x32_bf16 v[192:195], v[128:131], v[100:103], v[192:195]
ds_read_b128 v[148:151], v7 offset:256
v_mfma_f32_16x16x32_bf16 v[200:203], v[128:131], v[104:107], v[200:203]
ds_read_b128 v[152:155], v7 offset:320
v_mfma_f32_16x16x32_bf16 v[208:211], v[128:131], v[108:111], v[208:211]
ds_read2_b32 v[56:57], v54 offset0:128 offset1:144
s_waitcnt lgkmcnt(5)
v_mfma_f32_16x16x32_bf16 v[216:219], v[128:131], v[112:115], v[216:219]
s_barrier
v_mfma_f32_16x16x32_bf16 v[244:247], v[112:115], v[132:135], v[244:247]
ds_read_b64 v[92:93], v8 offset:0
v_xor_b32 v10, s48, v10
v_mfma_f32_16x16x32_bf16 v[248:251], v[112:115], v[136:139], v[248:251]
ds_read_b64 v[94:95], v8 offset:128
v_xor_b32 v11, s48, v11
v_mfma_f32_16x16x32_bf16 v[240:243], v[108:111], v[136:139], v[240:243]
ds_read_b64 v[96:97], v8 offset:256
v_xor_b32 v12, s48, v12
v_mfma_f32_16x16x32_bf16 v[236:239], v[108:111], v[132:135], v[236:239]
ds_read_b64 v[98:99], v8 offset:384
v_xor_b32 v13, s48, v13
v_mfma_f32_16x16x32_bf16 v[228:231], v[104:107], v[132:135], v[228:231]
ds_read_b128 v[60:63], v9 offset:0
v_xor_b32 v14, s48, v14
v_mfma_f32_16x16x32_bf16 v[232:235], v[104:107], v[136:139], v[232:235]
ds_read_b128 v[64:67], v9 offset:64
v_xor_b32 v15, s48, v15
v_mfma_f32_16x16x32_bf16 v[224:227], v[100:103], v[136:139], v[224:227]
ds_read_b128 v[68:71], v9 offset:128
v_xor_b32 v16, s48, v16
v_mfma_f32_16x16x32_bf16 v[220:223], v[100:103], v[132:135], v[220:223]
ds_read_b128 v[72:75], v9 offset:192
v_xor_b32 v17, s48, v17
v_mfma_f32_16x16x32_bf16 v[156:159], v[116:119], v[100:103], v[156:159]
ds_read_b128 v[76:79], v9 offset:512
v_mfma_f32_16x16x32_bf16 v[164:167], v[116:119], v[104:107], v[164:167]
ds_read_b128 v[80:83], v9 offset:576
v_mfma_f32_16x16x32_bf16 v[172:175], v[116:119], v[108:111], v[172:175]
ds_read_b128 v[84:87], v9 offset:640
v_mfma_f32_16x16x32_bf16 v[180:183], v[116:119], v[112:115], v[180:183]
ds_read_b128 v[88:91], v9 offset:704
v_mfma_f32_16x16x32_bf16 v[184:187], v[120:123], v[112:115], v[184:187]
v_mfma_f32_16x16x32_bf16 v[176:179], v[120:123], v[108:111], v[176:179]
v_mfma_f32_16x16x32_bf16 v[168:171], v[120:123], v[104:107], v[168:171]
v_mfma_f32_16x16x32_bf16 v[160:163], v[120:123], v[100:103], v[160:163]
c3_epi:
s_waitcnt lgkmcnt(0)
.p2align 3
v_mul_f32 v129, s66, v94
v_mul_f32 v128, s66, v92
v_mul_f32 v131, s66, v98
v_mul_f32 v130, s66, v96
v_pk_fma_f32 v[190:191], v[150:151], v[92:93], v[190:191] op_sel:[0,1,0] op_sel_hi:[1,1,1]
v_pk_fma_f32 v[212:213], v[148:149], v[98:99], v[212:213] op_sel:[0,1,0] op_sel_hi:[1,1,1]
v_pk_fma_f32 v[214:215], v[150:151], v[98:99], v[214:215] op_sel:[0,1,0] op_sel_hi:[1,1,1]
v_pk_fma_f32 v[188:189], v[148:149], v[92:93], v[188:189] op_sel:[0,1,0] op_sel_hi:[1,1,1]
v_pk_fma_f32 v[218:219], v[154:155], v[98:99], v[218:219] op_sel:[0,1,0] op_sel_hi:[1,1,1]
v_cvt_pk_bf16_f32 v188, v188, v189
v_cvt_pk_bf16_f32 v189, v190, v191
v_pk_fma_f32 v[196:197], v[148:149], v[94:95], v[196:197] op_sel:[0,1,0] op_sel_hi:[1,1,1]
v_pk_fma_f32 v[200:201], v[152:153], v[94:95], v[200:201] op_sel:[0,1,0] op_sel_hi:[1,1,1]
v_pk_fma_f32 v[210:211], v[154:155], v[96:97], v[210:211] op_sel:[0,1,0] op_sel_hi:[1,1,1]
v_pk_fma_f32 v[240:241], v[84:85], v[56:57], v[240:241] op_sel:[0,1,0] op_sel_hi:[1,1,1]
v_pk_fma_f32 v[228:229], v[80:81], v[56:57], v[228:229] op_sel:[0,0,0] op_sel_hi:[1,0,1]
v_pk_fma_f32 v[226:227], v[78:79], v[56:57], v[226:227] op_sel:[0,1,0] op_sel_hi:[1,1,1]
v_pk_fma_f32 v[192:193], v[152:153], v[92:93], v[192:193] op_sel:[0,1,0] op_sel_hi:[1,1,1]
v_cvt_pk_bf16_f32 v190, v192, v193
v_pk_fma_f32 v[238:239], v[86:87], v[56:57], v[238:239] op_sel:[0,0,0] op_sel_hi:[1,0,1]
v_pk_fma_f32 v[234:235], v[82:83], v[56:57], v[234:235] op_sel:[0,1,0] op_sel_hi:[1,1,1]
v_pk_mul_f32 v[226:227], v[226:227], v[62:63]
v_pk_fma_f32 v[204:205], v[148:149], v[96:97], v[204:205] op_sel:[0,1,0] op_sel_hi:[1,1,1]
v_cvt_pk_bf16_f32 v204, v204, v205
v_pk_fma_f32 v[202:203], v[154:155], v[94:95], v[202:203] op_sel:[0,1,0] op_sel_hi:[1,1,1]
v_pk_fma_f32 v[224:225], v[76:77], v[56:57], v[224:225] op_sel:[0,1,0] op_sel_hi:[1,1,1]
v_pk_fma_f32 v[216:217], v[152:153], v[98:99], v[216:217] op_sel:[0,1,0] op_sel_hi:[1,1,1]
v_pk_fma_f32 v[244:245], v[88:89], v[56:57], v[244:245] op_sel:[0,0,0] op_sel_hi:[1,0,1]
v_pk_mul_f32 v[238:239], v[238:239], v[70:71]
v_pk_mul_f32 v[228:229], v[228:229], v[64:65]
v_pk_fma_f32 v[236:237], v[84:85], v[56:57], v[236:237] op_sel:[0,0,0] op_sel_hi:[1,0,1]
v_pk_fma_f32 v[220:221], v[76:77], v[56:57], v[220:221] op_sel:[0,0,0] op_sel_hi:[1,0,1]
v_pk_mul_f32 v[224:225], v[224:225], v[60:61]
v_cvt_pk_bf16_f32 v212, v212, v213
v_cvt_pk_bf16_f32 v213, v214, v215
v_cvt_pk_bf16_f32 v196, v196, v197
v_pk_mul_f32 v[240:241], v[240:241], v[68:69]
v_pk_fma_f32 v[198:199], v[150:151], v[94:95], v[198:199] op_sel:[0,1,0] op_sel_hi:[1,1,1]
v_cvt_pk_bf16_f32 v197, v198, v199
v_cvt_pk_bf16_f32 v198, v200, v201
v_cvt_pk_bf16_f32 v199, v202, v203
v_cvt_pk_bf16_f32 v215, v218, v219
v_pk_fma_f32 v[208:209], v[152:153], v[96:97], v[208:209] op_sel:[0,1,0] op_sel_hi:[1,1,1]
v_pk_fma_f32 v[246:247], v[90:91], v[56:57], v[246:247] op_sel:[0,0,0] op_sel_hi:[1,0,1]
v_pk_fma_f32 v[250:251], v[90:91], v[56:57], v[250:251] op_sel:[0,1,0] op_sel_hi:[1,1,1]
v_pk_mul_f32 v[250:251], v[250:251], v[74:75]
v_pk_fma_f32 v[206:207], v[150:151], v[96:97], v[206:207] op_sel:[0,1,0] op_sel_hi:[1,1,1]
v_cvt_pk_bf16_f32 v205, v206, v207
v_pk_fma_f32 v[242:243], v[86:87], v[56:57], v[242:243] op_sel:[0,1,0] op_sel_hi:[1,1,1]
v_cvt_pk_bf16_f32 v207, v210, v211
v_pk_mul_f32 v[236:237], v[236:237], v[68:69]
v_pk_fma_f32 v[230:231], v[82:83], v[56:57], v[230:231] op_sel:[0,0,0] op_sel_hi:[1,0,1]
v_pk_fma_f32 v[194:195], v[154:155], v[92:93], v[194:195] op_sel:[0,1,0] op_sel_hi:[1,1,1]
v_cvt_pk_bf16_f32 v191, v194, v195
v_pk_fma_f32 v[232:233], v[80:81], v[56:57], v[232:233] op_sel:[0,1,0] op_sel_hi:[1,1,1]
v_pk_mul_f32 v[232:233], v[232:233], v[64:65]
v_pk_mul_f32 v[230:231], v[230:231], v[66:67]
v_pk_fma_f32 v[248:249], v[88:89], v[56:57], v[248:249] op_sel:[0,1,0] op_sel_hi:[1,1,1]
v_pk_mul_f32 v[248:249], v[248:249], v[72:73]
v_pk_mul_f32 v[242:243], v[242:243], v[70:71]
v_mfma_f32_16x16x32_bf16 v[68:71], v[10:13], v[196:199], 0
v_cvt_pk_bf16_f32 v206, v208, v209
v_cvt_pk_bf16_f32 v214, v216, v217
v_cvt_pk_bf16_f32 v121, v226, v227
v_mfma_f32_16x16x32_bf16 v[80:83], v[14:17], v[204:207], 0
v_cvt_pk_bf16_f32 v120, v224, v225
v_cvt_pk_bf16_f32 v114, v228, v229
v_mfma_f32_16x16x32_bf16 v[84:87], v[10:13], v[212:215], 0
v_cvt_pk_bf16_f32 v116, v236, v237
v_min3_f32 v105, v68, v69, v70
v_mfma_f32_16x16x32_bf16 v[88:91], v[14:17], v[212:215], 0
v_max3_f32 v101, v68, v69, v70
v_cvt_pk_bf16_f32 v115, v230, v231
v_cvt_pk_bf16_f32 v122, v232, v233
v_cvt_pk_bf16_f32 v127, v250, v251
v_cvt_pk_bf16_f32 v124, v240, v241
v_pk_mul_f32 v[244:245], v[244:245], v[72:73]
v_pk_fma_f32 v[222:223], v[78:79], v[56:57], v[222:223] op_sel:[0,0,0] op_sel_hi:[1,0,1]
v_pk_mul_f32 v[222:223], v[222:223], v[62:63]
v_mfma_f32_16x16x32_bf16 v[76:79], v[10:13], v[204:207], 0
v_min3_f32 v107, v84, v85, v86
v_min3_f32 v107, v107, v87, v88
v_min3_f32 v107, v107, v89, v90
v_min_f32_e64 v107, v107, v91
v_max3_f32 v103, v84, v85, v86
v_pk_mul_f32 v[220:221], v[220:221], v[60:61]
v_mfma_f32_16x16x32_bf16 v[60:63], v[10:13], v[188:191], 0
v_max3_f32 v103, v103, v87, v88
v_min3_f32 v106, v76, v77, v78
v_min3_f32 v106, v106, v79, v80
v_min3_f32 v106, v106, v81, v82
v_min_f32 v106, v106, v83
v_pk_mul_f32 v[234:235], v[234:235], v[66:67]
v_mfma_f32_16x16x32_bf16 v[64:67], v[14:17], v[188:191], 0
v_permlane32_swap_b32 v106, v107
v_min3_f32 v104, v60, v61, v62
v_min_f32 v106, v106, v107
v_max3_f32 v103, v103, v89, v90
v_pk_mul_f32 v[246:247], v[246:247], v[74:75]
v_mfma_f32_16x16x32_bf16 v[72:75], v[14:17], v[196:199], 0
v_max_f32 v103, v103, v91
v_max3_f32 v102, v76, v77, v78
v_min3_f32 v104, v104, v63, v64
v_min3_f32 v104, v104, v65, v66
v_min_f32 v104, v104, v67
v_max3_f32 v102, v102, v79, v80
v_max3_f32 v102, v102, v81, v82
v_max_f32 v102, v102, v83
v_min3_f32 v105, v105, v71, v72
v_min3_f32 v105, v105, v73, v74
v_min_f32 v105, v105, v75
v_max3_f32 v101, v101, v71, v72
v_max3_f32 v101, v101, v73, v74
v_permlane32_swap_b32 v104, v105
v_permlane32_swap_b32 v102, v103
v_min_f32 v104, v104, v105
v_max_f32 v102, v102, v103
v_max_f32 v101, v101, v75
v_permlane16_swap_b32 v104, v106
v_max3_f32 v100, v60, v61, v62
v_min_f32 v104, v104, v106
v_mov_b32 v106, v104
v_max3_f32 v100, v100, v63, v64
v_max3_f32 v100, v100, v65, v66
v_max_f32 v100, v100, v67
v_permlane16_swap_b32 v104, v106
v_cvt_pk_bf16_f32 v112, v220, v221
v_permlane32_swap_b32 v100, v101
v_mov_b32 v105, v104
v_max_f32 v100, v100, v101
v_mov_b32 v107, v106
v_permlane32_swap_b32 v104, v105
v_permlane16_swap_b32 v100, v102
v_pk_mul_f32 v[104:105], v[104:105], v[128:129]
v_pk_fma_f32 v[226:227], v[66:67], v[128:129], v[104:105] op_sel:[0,0,0] op_sel_hi:[1,0,0] neg_lo:[1,0,0] neg_hi:[1,0,0]
v_pk_fma_f32 v[230:231], v[70:71], v[128:129], v[104:105] op_sel:[0,1,1] op_sel_hi:[1,1,1] neg_lo:[1,0,0] neg_hi:[1,0,0]
v_exp_f32 v226, v226
v_pk_fma_f32 v[224:225], v[64:65], v[128:129], v[104:105] op_sel:[0,0,0] op_sel_hi:[1,0,0] neg_lo:[1,0,0] neg_hi:[1,0,0]
v_exp_f32 v224, v224
v_pk_fma_f32 v[228:229], v[68:69], v[128:129], v[104:105] op_sel:[0,1,1] op_sel_hi:[1,1,1] neg_lo:[1,0,0] neg_hi:[1,0,0]
v_exp_f32 v231, v231
v_cvt_pk_bf16_f32 v113, v222, v223
v_pk_fma_f32 v[222:223], v[62:63], v[128:129], v[104:105] op_sel:[0,0,0] op_sel_hi:[1,0,0] neg_lo:[1,0,0] neg_hi:[1,0,0]
v_exp_f32 v222, v222
v_pk_fma_f32 v[220:221], v[60:61], v[128:129], v[104:105] op_sel:[0,0,0] op_sel_hi:[1,0,0] neg_lo:[1,0,0] neg_hi:[1,0,0]
v_exp_f32 v221, v221
v_exp_f32 v220, v220
v_max_f32 v100, v100, v102
v_exp_f32 v223, v223
v_mov_b32 v102, v100
v_pk_add_f32 v[110:111], v[220:221], v[222:223]
v_exp_f32 v225, v225
v_pk_fma_f32 v[232:233], v[72:73], v[128:129], v[104:105] op_sel:[0,1,1] op_sel_hi:[1,1,1] neg_lo:[1,0,0] neg_hi:[1,0,0]
v_exp_f32 v232, v232
v_exp_f32 v233, v233
v_pk_add_f32 v[110:111], v[110:111], v[224:225]
v_exp_f32 v229, v229
v_exp_f32 v228, v228
v_exp_f32 v227, v227
v_cvt_pk_bf16_f32 v123, v234, v235
v_pk_fma_f32 v[234:235], v[74:75], v[128:129], v[104:105] op_sel:[0,1,1] op_sel_hi:[1,1,1] neg_lo:[1,0,0] neg_hi:[1,0,0]
v_pk_add_f32 v[110:111], v[110:111], v[226:227]
v_add_f32 v104, v110, v111
v_cvt_pk_bf16_f32 v118, v244, v245
v_permlane32_swap_b32 v106, v107
v_permlane16_swap_b32 v100, v102
v_exp_f32 v234, v234
v_mov_b32 v101, v100
v_exp_f32 v235, v235
v_exp_f32_e64 v230, v230
v_cvt_pk_bf16_f32 v125, v242, v243
v_pk_add_f32 v[110:111], v[228:229], v[230:231]
v_pk_add_f32 v[110:111], v[110:111], v[232:233]
v_pk_add_f32 v[110:111], v[110:111], v[234:235]
v_cvt_pk_bf16_f32 v126, v248, v249
v_pk_mul_f32 v[106:107], v[106:107], v[130:131]
v_pk_fma_f32 v[236:237], v[76:77], v[130:131], v[106:107] op_sel:[0,0,0] op_sel_hi:[1,0,0] neg_lo:[1,0,0] neg_hi:[1,0,0]
v_exp_f32 v237, v237
v_exp_f32 v236, v236
v_pk_fma_f32 v[242:243], v[82:83], v[130:131], v[106:107] op_sel:[0,0,0] op_sel_hi:[1,0,0] neg_lo:[1,0,0] neg_hi:[1,0,0]
v_pk_fma_f32 v[250:251], v[90:91], v[130:131], v[106:107] op_sel:[0,1,1] op_sel_hi:[1,1,1] neg_lo:[1,0,0] neg_hi:[1,0,0]
v_add_f32 v105, v110, v111
v_exp_f32 v243, v243
v_cvt_pk_bf16_f32 v119, v246, v247
v_pk_fma_f32 v[246:247], v[86:87], v[130:131], v[106:107] op_sel:[0,1,1] op_sel_hi:[1,1,1] neg_lo:[1,0,0] neg_hi:[1,0,0]
v_exp_f32 v246, v246
v_cvt_pk_bf16_f32 v117, v238, v239
v_pk_fma_f32 v[238:239], v[78:79], v[130:131], v[106:107] op_sel:[0,0,0] op_sel_hi:[1,0,0] neg_lo:[1,0,0] neg_hi:[1,0,0]
v_exp_f32 v238, v238
v_exp_f32 v247, v247
v_pk_fma_f32 v[240:241], v[80:81], v[130:131], v[106:107] op_sel:[0,0,0] op_sel_hi:[1,0,0] neg_lo:[1,0,0] neg_hi:[1,0,0]
v_exp_f32 v240, v240
v_exp_f32 v241, v241
v_permlane32_swap_b32 v100, v101
v_exp_f32 v242, v242
v_pk_fma_f32 v[244:245], v[84:85], v[130:131], v[106:107] op_sel:[0,1,1] op_sel_hi:[1,1,1] neg_lo:[1,0,0] neg_hi:[1,0,0]
v_exp_f32 v244, v244
v_exp_f32_e64 v239, v239
v_pk_mul_f32 v[100:101], v[100:101], v[128:129]
v_pk_fma_f32 v[62:63], v[62:63], v[128:129], v[100:101] op_sel:[0,0,0] op_sel_hi:[1,0,0] neg_lo:[0,0,1] neg_hi:[0,0,1]
v_pk_add_f32 v[110:111], v[236:237], v[238:239]
v_pk_add_f32 v[110:111], v[110:111], v[240:241]
v_pk_add_f32 v[110:111], v[110:111], v[242:243]
v_pk_fma_f32 v[72:73], v[72:73], v[128:129], v[100:101] op_sel:[0,1,1] op_sel_hi:[1,1,1] neg_lo:[0,0,1] neg_hi:[0,0,1]
v_pk_fma_f32 v[66:67], v[66:67], v[128:129], v[100:101] op_sel:[0,0,0] op_sel_hi:[1,0,0] neg_lo:[0,0,1] neg_hi:[0,0,1]
v_exp_f32 v62, v62
v_pk_fma_f32 v[60:61], v[60:61], v[128:129], v[100:101] op_sel:[0,0,0] op_sel_hi:[1,0,0] neg_lo:[0,0,1] neg_hi:[0,0,1]
v_exp_f32 v60, v60
v_exp_f32 v245, v245
v_exp_f32 v73, v73
v_pk_fma_f32 v[248:249], v[88:89], v[130:131], v[106:107] op_sel:[0,1,1] op_sel_hi:[1,1,1] neg_lo:[1,0,0] neg_hi:[1,0,0]
v_add_f32 v106, v110, v111
v_exp_f32 v249, v249
v_pk_add_f32 v[110:111], v[244:245], v[246:247]
v_exp_f32 v248, v248
v_pk_fma_f32 v[64:65], v[64:65], v[128:129], v[100:101] op_sel:[0,0,0] op_sel_hi:[1,0,0] neg_lo:[0,0,1] neg_hi:[0,0,1]
v_exp_f32 v64, v64
v_pk_add_f32 v[110:111], v[110:111], v[248:249]
v_exp_f32 v65, v65
v_exp_f32 v61, v61
v_exp_f32 v66, v66
v_exp_f32 v251, v251
v_exp_f32 v63, v63
v_pk_fma_f32 v[74:75], v[74:75], v[128:129], v[100:101] op_sel:[0,1,1] op_sel_hi:[1,1,1] neg_lo:[0,0,1] neg_hi:[0,0,1]
v_pk_add_f32 v[108:109], v[60:61], v[62:63]
v_exp_f32 v67, v67
v_exp_f32 v250, v250
v_pk_fma_f32 v[68:69], v[68:69], v[128:129], v[100:101] op_sel:[0,1,1] op_sel_hi:[1,1,1] neg_lo:[0,0,1] neg_hi:[0,0,1]
v_pk_add_f32 v[110:111], v[110:111], v[250:251]
v_exp_f32 v68, v68
v_exp_f32 v69, v69
v_add_f32 v107, v110, v111
v_mov_b32 v103, v102
v_pk_fma_f32 v[70:71], v[70:71], v[128:129], v[100:101] op_sel:[0,1,1] op_sel_hi:[1,1,1] neg_lo:[0,0,1] neg_hi:[0,0,1]
v_exp_f32 v71, v71
v_exp_f32 v70, v70
v_permlane32_swap_b32 v106, v107
v_permlane32_swap_b32 v102, v103
v_pk_add_f32 v[108:109], v[108:109], v[64:65]
v_pk_add_f32 v[108:109], v[108:109], v[66:67]
v_add_f32 v100, v108, v109
v_pk_add_f32 v[108:109], v[68:69], v[70:71]
v_pk_mul_f32 v[102:103], v[102:103], v[130:131]
v_pk_fma_f32 v[78:79], v[78:79], v[130:131], v[102:103] op_sel:[0,0,0] op_sel_hi:[1,0,0] neg_lo:[0,0,1] neg_hi:[0,0,1]
v_exp_f32 v79, v79
v_exp_f32 v78, v78
v_exp_f32 v74, v74
v_exp_f32 v72, v72
v_pk_fma_f32 v[86:87], v[86:87], v[130:131], v[102:103] op_sel:[0,1,1] op_sel_hi:[1,1,1] neg_lo:[0,0,1] neg_hi:[0,0,1]
v_exp_f32 v87, v87
v_pk_fma_f32 v[76:77], v[76:77], v[130:131], v[102:103] op_sel:[0,0,0] op_sel_hi:[1,0,0] neg_lo:[0,0,1] neg_hi:[0,0,1]
v_exp_f32 v77, v77
v_add_f32 v106, v106, v107
v_pk_fma_f32 v[80:81], v[80:81], v[130:131], v[102:103] op_sel:[0,0,0] op_sel_hi:[1,0,0] neg_lo:[0,0,1] neg_hi:[0,0,1]
v_exp_f32 v81, v81
v_exp_f32 v80, v80
v_pk_add_f32 v[108:109], v[108:109], v[72:73]
v_permlane32_swap_b32 v104, v105
v_exp_f32 v75, v75
v_add_f32 v104, v104, v105
v_pk_fma_f32 v[82:83], v[82:83], v[130:131], v[102:103] op_sel:[0,0,0] op_sel_hi:[1,0,0] neg_lo:[0,0,1] neg_hi:[0,0,1]
v_exp_f32 v82, v82
v_exp_f32 v83, v83
v_permlane16_swap_b32 v104, v106
v_pk_add_f32 v[108:109], v[108:109], v[74:75]
v_add_f32 v101, v108, v109
v_exp_f32 v76, v76
v_add_f32 v104, v104, v106
v_rcp_f32 v104, v104
v_pk_fma_f32 v[84:85], v[84:85], v[130:131], v[102:103] op_sel:[0,1,1] op_sel_hi:[1,1,1] neg_lo:[0,0,1] neg_hi:[0,0,1]
v_exp_f32 v84, v84
v_exp_f32 v85, v85
v_mov_b32 v106, v104
v_pk_add_f32 v[108:109], v[76:77], v[78:79]
v_pk_add_f32 v[108:109], v[108:109], v[80:81]
v_pk_add_f32 v[108:109], v[108:109], v[82:83]
v_pk_fma_f32 v[88:89], v[88:89], v[130:131], v[102:103] op_sel:[0,1,1] op_sel_hi:[1,1,1] neg_lo:[0,0,1] neg_hi:[0,0,1]
v_exp_f32 v88, v88
v_exp_f32 v89, v89
v_exp_f32 v86, v86
v_pk_fma_f32 v[90:91], v[90:91], v[130:131], v[102:103] op_sel:[0,1,1] op_sel_hi:[1,1,1] neg_lo:[0,0,1] neg_hi:[0,0,1]
v_add_f32 v102, v108, v109
v_pk_add_f32 v[108:109], v[84:85], v[86:87]
v_pk_add_f32 v[108:109], v[108:109], v[88:89]
v_permlane16_swap_b32 v104, v106
v_exp_f32 v90, v90
v_exp_f32 v91, v91
v_permlane32_swap_b32 v100, v101
v_pk_add_f32 v[108:109], v[108:109], v[90:91]
v_add_f32 v103, v108, v109
v_add_f32 v100, v100, v101
v_mov_b32 v105, v104
v_permlane32_swap_b32 v102, v103
v_mov_b32 v107, v106
v_add_f32 v102, v102, v103
v_permlane32_swap_b32 v104, v105
v_permlane32_swap_b32 v106, v107
v_permlane16_swap_b32 v100, v102
v_pk_mul_f32 v[222:223], v[222:223], v[104:105] op_sel:[0,0] op_sel_hi:[1,0]
v_pk_mul_f32 v[226:227], v[226:227], v[104:105] op_sel:[0,0] op_sel_hi:[1,0]
v_pk_mul_f32 v[234:235], v[234:235], v[104:105] op_sel:[0,1] op_sel_hi:[1,1]
v_pk_mul_f32 v[232:233], v[232:233], v[104:105] op_sel:[0,1] op_sel_hi:[1,1]
v_pk_mul_f32 v[230:231], v[230:231], v[104:105] op_sel:[0,1] op_sel_hi:[1,1]
v_add_f32 v100, v100, v102
v_pk_mul_f32 v[228:229], v[228:229], v[104:105] op_sel:[0,1] op_sel_hi:[1,1]
v_cvt_pk_bf16_f32 v228, v228, v229
v_cvt_pk_bf16_f32 v229, v230, v231
v_cvt_pk_bf16_f32 v231, v234, v235
v_cvt_pk_bf16_f32 v230, v232, v233
v_pk_mul_f32 v[220:221], v[220:221], v[104:105] op_sel:[0,0] op_sel_hi:[1,0]
v_cvt_pk_bf16_f32 v220, v220, v221
v_pk_mul_f32 v[224:225], v[224:225], v[104:105] op_sel:[0,0] op_sel_hi:[1,0]
v_pk_mul_f32 v[236:237], v[236:237], v[106:107] op_sel:[0,0] op_sel_hi:[1,0]
v_pk_mul_f32 v[238:239], v[238:239], v[106:107] op_sel:[0,0] op_sel_hi:[1,0]
v_pk_mul_f32 v[240:241], v[240:241], v[106:107] op_sel:[0,0] op_sel_hi:[1,0]
v_pk_mul_f32 v[242:243], v[242:243], v[106:107] op_sel:[0,0] op_sel_hi:[1,0]
v_pk_mul_f32 v[248:249], v[248:249], v[106:107] op_sel:[0,1] op_sel_hi:[1,1]
v_rcp_f32 v100, v100
v_pk_mul_f32 v[244:245], v[244:245], v[106:107] op_sel:[0,1] op_sel_hi:[1,1]
v_mov_b32 v102, v100
v_pk_mul_f32 v[250:251], v[250:251], v[106:107] op_sel:[0,1] op_sel_hi:[1,1]
v_cvt_pk_bf16_f32 v221, v222, v223
v_pk_mul_f32 v[246:247], v[246:247], v[106:107] op_sel:[0,1] op_sel_hi:[1,1]
v_cvt_pk_bf16_f32 v222, v224, v225
v_mfma_f32_16x16x32_bf16 v[200:203], v[228:231], v[36:39], 0
v_cvt_pk_bf16_f32 v223, v226, v227
v_permlane16_swap_b32 v100, v102
v_mfma_f32_16x16x32_bf16 v[196:199], v[228:231], v[38:41], 0
v_mov_b32 v101, v100
v_cvt_pk_bf16_f32 v244, v244, v245
v_mfma_f32_16x16x32_bf16 v[212:215], v[220:223], v[38:41], 0
v_cvt_pk_bf16_f32 v245, v246, v247
v_cvt_pk_bf16_f32 v247, v250, v251
v_mfma_f32_16x16x32_bf16 v[216:219], v[220:223], v[36:39], 0
v_cvt_pk_bf16_f32 v234, v200, v201
v_cvt_pk_bf16_f32 v246, v248, v249
v_cvt_pk_bf16_f32 v226, v196, v197
v_cvt_pk_bf16_f32 v227, v198, v199
v_mfma_f32_16x16x32_bf16 v[196:199], v[244:247], v[38:41], 0
v_cvt_pk_bf16_f32 v225, v214, v215
v_cvt_pk_bf16_f32 v236, v236, v237
v_cvt_pk_bf16_f32 v237, v238, v239
v_cvt_pk_bf16_f32 v232, v216, v217
v_cvt_pk_bf16_f32 v233, v218, v219
v_cvt_pk_bf16_f32 v239, v242, v243
v_cvt_pk_bf16_f32 v238, v240, v241
v_cvt_pk_bf16_f32 v224, v212, v213
v_permlane32_swap_b32 v100, v101
v_mfma_f32_16x16x32_bf16 v[216:219], v[236:239], v[36:39], 0
v_mov_b32 v103, v102
v_cvt_pk_bf16_f32 v235, v202, v203
v_mfma_f32_16x16x32_bf16 v[212:215], v[236:239], v[38:41], 0
v_cvt_pk_bf16_f32 v243, v198, v199
v_permlane32_swap_b32 v102, v103
v_mfma_f32_16x16x32_bf16 v[200:203], v[244:247], v[36:39], 0
v_cvt_pk_bf16_f32 v242, v196, v197
v_mov_b32 v5, s61
v_mfma_f32_16x16x32_bf16 v[220:223], v[232:235], v[120:123], 0
v_cvt_pk_bf16_f32 v249, v218, v219
v_cvt_pk_bf16_f32 v248, v216, v217
v_cvt_pk_bf16_f32 v241, v214, v215
v_cvt_pk_bf16_f32 v240, v212, v213
v_cmp_eq_u32 s[50:51], s41, v2
v_pk_mul_f32 v[64:65], v[64:65], v[100:101] op_sel:[0,0] op_sel_hi:[1,0]
v_pk_mul_f32 v[74:75], v[74:75], v[100:101] op_sel:[0,1] op_sel_hi:[1,1]
v_pk_mul_f32 v[68:69], v[68:69], v[100:101] op_sel:[0,1] op_sel_hi:[1,1]
v_pk_mul_f32 v[72:73], v[72:73], v[100:101] op_sel:[0,1] op_sel_hi:[1,1]
v_pk_mul_f32 v[60:61], v[60:61], v[100:101] op_sel:[0,0] op_sel_hi:[1,0]
v_pk_mul_f32 v[62:63], v[62:63], v[100:101] op_sel:[0,0] op_sel_hi:[1,0]
v_pk_mul_f32 v[66:67], v[66:67], v[100:101] op_sel:[0,0] op_sel_hi:[1,0]
v_pk_mul_f32 v[76:77], v[76:77], v[102:103] op_sel:[0,0] op_sel_hi:[1,0]
v_pk_mul_f32 v[70:71], v[70:71], v[100:101] op_sel:[0,1] op_sel_hi:[1,1]
v_cvt_pk_bf16_f32 v60, v60, v61
v_pk_mul_f32 v[80:81], v[80:81], v[102:103] op_sel:[0,0] op_sel_hi:[1,0]
v_pk_mul_f32 v[78:79], v[78:79], v[102:103] op_sel:[0,0] op_sel_hi:[1,0]
v_pk_mul_f32 v[82:83], v[82:83], v[102:103] op_sel:[0,0] op_sel_hi:[1,0]
v_pk_mul_f32 v[86:87], v[86:87], v[102:103] op_sel:[0,1] op_sel_hi:[1,1]
v_cvt_pk_bf16_f32 v61, v62, v63
v_pk_mul_f32 v[84:85], v[84:85], v[102:103] op_sel:[0,1] op_sel_hi:[1,1]
v_cvt_pk_bf16_f32 v62, v64, v65
v_pk_mul_f32 v[88:89], v[88:89], v[102:103] op_sel:[0,1] op_sel_hi:[1,1]
v_cvt_pk_bf16_f32 v63, v66, v67
v_pk_mul_f32 v[90:91], v[90:91], v[102:103] op_sel:[0,1] op_sel_hi:[1,1]
v_cvt_pk_bf16_f32 v68, v68, v69
v_mfma_f32_16x16x32_bf16 v[208:211], v[60:63], v[36:39], 0
v_cvt_pk_bf16_f32 v69, v70, v71
v_cvt_pk_bf16_f32 v70, v72, v73
v_mfma_f32_16x16x32_bf16 v[204:207], v[60:63], v[38:41], 0
v_cvt_pk_bf16_f32 v71, v74, v75
v_cvt_pk_bf16_f32 v76, v76, v77
v_mfma_f32_16x16x32_bf16 v[60:63], v[232:235], v[112:115], 0
v_cvt_pk_bf16_f32 v250, v200, v201
v_cvt_pk_bf16_f32 v77, v78, v79
v_mfma_f32_16x16x32_bf16 v[192:195], v[68:71], v[36:39], 0
v_cvt_pk_bf16_f32 v78, v80, v81
v_cvt_pk_bf16_f32 v79, v82, v83
v_mfma_f32_16x16x32_bf16 v[188:191], v[68:71], v[38:41], 0
v_cvt_pk_bf16_f32 v65, v206, v207
v_cvt_pk_bf16_f32 v64, v204, v205
v_mfma_f32_16x16x32_bf16 v[68:71], v[224:227], v[120:123], 0
v_cvt_pk_bf16_f32 v251, v202, v203
v_cvt_pk_bf16_f32 v72, v208, v209
v_mfma_f32_16x16x32_bf16 v[152:155], v[224:227], v[112:115], 0
v_cvt_pk_bf16_f32 v73, v210, v211
v_cvt_pk_bf16_f32 v84, v84, v85
v_mfma_f32_16x16x32_bf16 v[60:63], v[248:251], v[116:119], v[60:63]
v_cvt_pk_bf16_f32 v85, v86, v87
v_cvt_pk_bf16_f32 v86, v88, v89
v_mfma_f32_16x16x32_bf16 v[228:231], v[224:227], v[48:51], 0
v_cvt_pk_bf16_f32 v67, v190, v191
v_cvt_pk_bf16_f32 v87, v90, v91
v_mfma_f32_16x16x32_bf16 v[220:223], v[248:251], v[124:127], v[220:223]
v_cvt_pk_bf16_f32 v66, v188, v189
v_cvt_pk_bf16_f32 v74, v192, v193
v_mfma_f32_16x16x32_bf16 v[152:155], v[240:243], v[116:119], v[152:155]
v_cvt_pk_bf16_f32 v75, v194, v195
v_mfma_f32_16x16x32_bf16 v[204:207], v[76:79], v[38:41], 0
v_mfma_f32_16x16x32_bf16 v[208:211], v[76:79], v[36:39], 0
v_mfma_f32_16x16x32_bf16 v[228:231], v[240:243], v[48:51], v[228:231]
v_mfma_f32_16x16x32_bf16 v[68:71], v[240:243], v[124:127], v[68:71]
v_mfma_f32_16x16x32_bf16 v[76:79], v[232:235], v[48:51], 0
s_nop 1
v_cvt_pk_bf16_f32 v152, v152, v153
v_mfma_f32_16x16x32_bf16 v[76:79], v[248:251], v[48:51], v[76:79]
v_cvt_pk_bf16_f32 v153, v154, v155
v_cvt_pk_bf16_f32 v154, v60, v61
v_mfma_f32_16x16x32_bf16 v[192:195], v[84:87], v[36:39], 0
v_cvt_pk_bf16_f32 v68, v68, v69
v_cvt_pk_bf16_f32 v155, v62, v63
v_mfma_f32_16x16x32_bf16 v[188:191], v[84:87], v[38:41], 0
ds_write_b128 v42, v[152:155] offset:0
v_mfma_f32_16x16x32_bf16 v[136:139], v[64:67], v[48:51], 0
v_cvt_pk_bf16_f32 v69, v70, v71
v_cvt_pk_bf16_f32 v228, v228, v229
v_mfma_f32_16x16x32_bf16 v[104:107], v[72:75], v[112:115], 0
v_cvt_pk_bf16_f32 v71, v222, v223
v_cvt_pk_bf16_f32 v229, v230, v231
v_mfma_f32_16x16x32_bf16 v[148:151], v[72:75], v[48:51], 0
v_cvt_pk_bf16_f32 v230, v76, v77
v_cvt_pk_bf16_f32 v70, v220, v221
v_mfma_f32_16x16x32_bf16 v[132:135], v[72:75], v[120:123], 0
ds_write_b128 v42, v[68:71] offset:1024
v_mfma_f32_16x16x32_bf16 v[108:111], v[64:67], v[120:123], 0
v_cvt_pk_bf16_f32 v231, v78, v79
ds_write_b128 v42, v[228:231] offset:2048
v_mfma_f32_16x16x32_bf16 v[100:103], v[64:67], v[112:115], 0
ds_write_b32 v52, v5
v_cvt_pk_bf16_f32 v88, v208, v209
v_cvt_pk_bf16_f32 v83, v190, v191
v_cvt_pk_bf16_f32 v91, v194, v195
v_cvt_pk_bf16_f32 v82, v188, v189
v_cvt_pk_bf16_f32 v80, v204, v205
v_cvt_pk_bf16_f32 v89, v210, v211
v_cvt_pk_bf16_f32 v81, v206, v207
v_cvt_pk_bf16_f32 v90, v192, v193
s_nop 0
v_mfma_f32_16x16x32_bf16 v[100:103], v[80:83], v[116:119], v[100:103]
v_mfma_f32_16x16x32_bf16 v[108:111], v[80:83], v[124:127], v[108:111]
v_mfma_f32_16x16x32_bf16 v[132:135], v[88:91], v[124:127], v[132:135]
v_mfma_f32_16x16x32_bf16 v[148:151], v[88:91], v[48:51], v[148:151]
v_mfma_f32_16x16x32_bf16 v[136:139], v[80:83], v[48:51], v[136:139]
v_mfma_f32_16x16x32_bf16 v[104:107], v[88:91], v[116:119], v[104:107]
s_mov_b32 s63, 0
px_122:
ds_read_b32 v4, v19
ds_read_b128 v[188:191], v43 offset:0
ds_read_b128 v[192:195], v43 offset:1024
ds_read_b128 v[196:199], v43 offset:2048
s_add_u32 s63, s63, 1
s_cmp_lt_u32 s63, 0x400000
s_waitcnt lgkmcnt(0)
v_cmp_ne_u32 vcc, s61, v4
s_cbranch_vccz pxd_123
s_cbranch_scc1 px_122
pxd_123:
v_mfma_f32_16x16x32_bf16 v[100:103], v[38:41], v[188:191], v[100:103]
v_mfma_f32_16x16x32_bf16 v[104:107], v[36:39], v[188:191], v[104:107]
v_mfma_f32_16x16x32_bf16 v[108:111], v[38:41], v[192:195], v[108:111]
v_mfma_f32_16x16x32_bf16 v[132:135], v[36:39], v[192:195], v[132:135]
v_mfma_f32_16x16x32_bf16 v[136:139], v[38:41], v[196:199], v[136:139]
v_mfma_f32_16x16x32_bf16 v[148:151], v[36:39], v[196:199], v[148:151]
s_nop 2
v_cvt_pk_bf16_f32 v100, v100, v101
v_cvt_pk_bf16_f32 v101, v102, v103
v_cvt_pk_bf16_f32 v102, v104, v105
v_cvt_pk_bf16_f32 v103, v106, v107
buffer_store_dwordx4 v[100:103], v55, s[32:35], s53 offen sc1
v_cvt_pk_bf16_f32 v108, v108, v109
v_cvt_pk_bf16_f32 v109, v110, v111
v_cvt_pk_bf16_f32 v110, v132, v133
v_cvt_pk_bf16_f32 v111, v134, v135
buffer_store_dwordx4 v[108:111], v55, s[32:35], s54 offen sc1
v_cvt_pk_bf16_f32 v136, v136, v137
v_cvt_pk_bf16_f32 v137, v138, v139
v_cvt_pk_bf16_f32 v138, v148, v149
v_cvt_pk_bf16_f32 v139, v150, v151
s_mov_b64 exec, s[50:51]
buffer_store_dwordx4 v[136:139], v58, s[32:35], s56 offen sc1
s_mov_b64 exec, -1
s_mov_b32 s51, 0
.p2align 3
v_pk_fma_f32 v[156:157], v[140:141], v[92:93], v[156:157] op_sel:[0,1,0] op_sel_hi:[1,1,1]
v_pk_fma_f32 v[164:165], v[140:141], v[94:95], v[164:165] op_sel:[0,1,0] op_sel_hi:[1,1,1]
v_pk_fma_f32 v[172:173], v[140:141], v[96:97], v[172:173] op_sel:[0,1,0] op_sel_hi:[1,1,1]
v_pk_fma_f32 v[180:181], v[140:141], v[98:99], v[180:181] op_sel:[0,1,0] op_sel_hi:[1,1,1]
v_pk_fma_f32 v[158:159], v[142:143], v[92:93], v[158:159] op_sel:[0,1,0] op_sel_hi:[1,1,1]
v_cvt_pk_bf16_f32 v156, v156, v157
v_pk_fma_f32 v[166:167], v[142:143], v[94:95], v[166:167] op_sel:[0,1,0] op_sel_hi:[1,1,1]
v_cvt_pk_bf16_f32 v164, v164, v165
v_pk_fma_f32 v[174:175], v[142:143], v[96:97], v[174:175] op_sel:[0,1,0] op_sel_hi:[1,1,1]
v_cvt_pk_bf16_f32 v172, v172, v173
v_pk_fma_f32 v[182:183], v[142:143], v[98:99], v[182:183] op_sel:[0,1,0] op_sel_hi:[1,1,1]
v_cvt_pk_bf16_f32 v180, v180, v181
v_pk_fma_f32 v[160:161], v[144:145], v[92:93], v[160:161] op_sel:[0,1,0] op_sel_hi:[1,1,1]
v_pk_fma_f32 v[162:163], v[146:147], v[92:93], v[162:163] op_sel:[0,1,0] op_sel_hi:[1,1,1]
v_cvt_pk_bf16_f32 v157, v158, v159
v_pk_fma_f32 v[168:169], v[144:145], v[94:95], v[168:169] op_sel:[0,1,0] op_sel_hi:[1,1,1]
v_pk_fma_f32 v[170:171], v[146:147], v[94:95], v[170:171] op_sel:[0,1,0] op_sel_hi:[1,1,1]
v_cvt_pk_bf16_f32 v165, v166, v167
v_pk_fma_f32 v[176:177], v[144:145], v[96:97], v[176:177] op_sel:[0,1,0] op_sel_hi:[1,1,1]
v_pk_fma_f32 v[178:179], v[146:147], v[96:97], v[178:179] op_sel:[0,1,0] op_sel_hi:[1,1,1]
v_cvt_pk_bf16_f32 v173, v174, v175
v_pk_fma_f32 v[184:185], v[144:145], v[98:99], v[184:185] op_sel:[0,1,0] op_sel_hi:[1,1,1]
v_pk_fma_f32 v[186:187], v[146:147], v[98:99], v[186:187] op_sel:[0,1,0] op_sel_hi:[1,1,1]
v_cvt_pk_bf16_f32 v181, v182, v183
v_cvt_pk_bf16_f32 v158, v160, v161
v_cvt_pk_bf16_f32 v159, v162, v163
v_cvt_pk_bf16_f32 v166, v168, v169
v_cvt_pk_bf16_f32 v167, v170, v171
v_mfma_f32_16x16x32_bf16 v[60:63], v[10:13], v[156:159], 0
v_cvt_pk_bf16_f32 v174, v176, v177
v_cvt_pk_bf16_f32 v175, v178, v179
v_mfma_f32_16x16x32_bf16 v[68:71], v[10:13], v[164:167], 0
v_cvt_pk_bf16_f32 v182, v184, v185
v_cvt_pk_bf16_f32 v183, v186, v187
v_mfma_f32_16x16x32_bf16 v[76:79], v[10:13], v[172:175], 0
s_nop 0
v_mfma_f32_16x16x32_bf16 v[84:87], v[10:13], v[180:183], 0
v_min3_f32 v104, v60, v61, v62
v_max3_f32 v100, v60, v61, v62
v_mfma_f32_16x16x32_bf16 v[64:67], v[14:17], v[156:159], 0
v_min3_f32 v105, v68, v69, v70
v_max3_f32 v101, v68, v69, v70
v_mfma_f32_16x16x32_bf16 v[72:75], v[14:17], v[164:167], 0
v_min3_f32 v106, v76, v77, v78
v_max3_f32 v102, v76, v77, v78
v_mfma_f32_16x16x32_bf16 v[80:83], v[14:17], v[172:175], 0
v_min3_f32 v107, v84, v85, v86
v_max3_f32 v103, v84, v85, v86
v_mfma_f32_16x16x32_bf16 v[88:91], v[14:17], v[180:183], 0
v_min3_f32 v104, v104, v63, v64
v_max3_f32 v100, v100, v63, v64
v_min3_f32 v105, v105, v71, v72
v_min3_f32 v104, v104, v65, v66
v_max3_f32 v101, v101, v71, v72
v_min3_f32 v106, v106, v79, v80
v_min3_f32 v105, v105, v73, v74
v_max3_f32 v102, v102, v79, v80
v_min3_f32 v107, v107, v87, v88
v_min3_f32 v106, v106, v81, v82
v_max3_f32 v103, v103, v87, v88
v_min3_f32 v107, v107, v89, v90
v_max3_f32 v100, v100, v65, v66
v_min_f32 v104, v104, v67
v_max3_f32 v101, v101, v73, v74
v_min_f32 v105, v105, v75
v_max3_f32 v102, v102, v81, v82
v_min_f32 v106, v106, v83
v_max3_f32 v103, v103, v89, v90
v_min_f32 v107, v107, v91
v_max_f32 v100, v100, v67
v_max_f32 v101, v101, v75
v_max_f32 v102, v102, v83
v_max_f32 v103, v103, v91
v_permlane32_swap_b32 v104, v105
v_permlane32_swap_b32 v106, v107
v_permlane32_swap_b32 v100, v101
v_permlane32_swap_b32 v102, v103
v_min_f32 v104, v104, v105
v_min_f32 v106, v106, v107
v_max_f32 v100, v100, v101
v_max_f32 v102, v102, v103
v_permlane16_swap_b32 v104, v106
s_nop 0
v_permlane16_swap_b32 v100, v102
v_min_f32 v104, v104, v106
v_max_f32 v100, v100, v102
v_mov_b32 v106, v104
v_mov_b32 v102, v100
s_nop 0
v_permlane16_swap_b32 v104, v106
v_permlane16_swap_b32 v100, v102
v_mov_b32 v105, v104
v_mov_b32 v101, v100
v_mov_b32 v103, v102
v_permlane32_swap_b32 v104, v105
v_mov_b32 v107, v106
v_permlane32_swap_b32_e64 v100, v101
v_pk_mul_f32 v[104:105], v[104:105], v[128:129]
v_pk_mul_f32 v[100:101], v[100:101], v[128:129]
v_pk_fma_f32 v[220:221], v[60:61], v[128:129], v[104:105] op_sel:[0,0,0] op_sel_hi:[1,0,0] neg_lo:[1,0,0] neg_hi:[1,0,0]
v_pk_fma_f32 v[222:223], v[62:63], v[128:129], v[104:105] op_sel:[0,0,0] op_sel_hi:[1,0,0] neg_lo:[1,0,0] neg_hi:[1,0,0]
v_pk_fma_f32 v[224:225], v[64:65], v[128:129], v[104:105] op_sel:[0,0,0] op_sel_hi:[1,0,0] neg_lo:[1,0,0] neg_hi:[1,0,0]
v_pk_fma_f32 v[226:227], v[66:67], v[128:129], v[104:105] op_sel:[0,0,0] op_sel_hi:[1,0,0] neg_lo:[1,0,0] neg_hi:[1,0,0]
v_pk_fma_f32 v[228:229], v[68:69], v[128:129], v[104:105] op_sel:[0,1,1] op_sel_hi:[1,1,1] neg_lo:[1,0,0] neg_hi:[1,0,0]
v_pk_fma_f32 v[230:231], v[70:71], v[128:129], v[104:105] op_sel:[0,1,1] op_sel_hi:[1,1,1] neg_lo:[1,0,0] neg_hi:[1,0,0]
v_pk_fma_f32 v[232:233], v[72:73], v[128:129], v[104:105] op_sel:[0,1,1] op_sel_hi:[1,1,1] neg_lo:[1,0,0] neg_hi:[1,0,0]
v_pk_fma_f32 v[234:235], v[74:75], v[128:129], v[104:105] op_sel:[0,1,1] op_sel_hi:[1,1,1] neg_lo:[1,0,0] neg_hi:[1,0,0]
v_permlane32_swap_b32 v102, v103
v_permlane32_swap_b32 v106, v107
v_pk_fma_f32 v[60:61], v[60:61], v[128:129], v[100:101] op_sel:[0,0,0] op_sel_hi:[1,0,0] neg_lo:[0,0,1] neg_hi:[0,0,1]
v_pk_fma_f32 v[62:63], v[62:63], v[128:129], v[100:101] op_sel:[0,0,0] op_sel_hi:[1,0,0] neg_lo:[0,0,1] neg_hi:[0,0,1]
v_pk_fma_f32 v[64:65], v[64:65], v[128:129], v[100:101] op_sel:[0,0,0] op_sel_hi:[1,0,0] neg_lo:[0,0,1] neg_hi:[0,0,1]
v_pk_fma_f32 v[66:67], v[66:67], v[128:129], v[100:101] op_sel:[0,0,0] op_sel_hi:[1,0,0] neg_lo:[0,0,1] neg_hi:[0,0,1]
v_pk_fma_f32 v[68:69], v[68:69], v[128:129], v[100:101] op_sel:[0,1,1] op_sel_hi:[1,1,1] neg_lo:[0,0,1] neg_hi:[0,0,1]
v_pk_fma_f32 v[70:71], v[70:71], v[128:129], v[100:101] op_sel:[0,1,1] op_sel_hi:[1,1,1] neg_lo:[0,0,1] neg_hi:[0,0,1]
v_pk_fma_f32 v[72:73], v[72:73], v[128:129], v[100:101] op_sel:[0,1,1] op_sel_hi:[1,1,1] neg_lo:[0,0,1] neg_hi:[0,0,1]
v_pk_fma_f32 v[74:75], v[74:75], v[128:129], v[100:101] op_sel:[0,1,1] op_sel_hi:[1,1,1] neg_lo:[0,0,1] neg_hi:[0,0,1]
v_exp_f32 v220, v220
v_exp_f32 v60, v60
v_exp_f32 v221, v221
v_exp_f32 v61, v61
v_exp_f32 v222, v222
v_exp_f32 v62, v62
v_exp_f32 v223, v223
v_exp_f32 v63, v63
v_exp_f32 v224, v224
v_exp_f32 v64, v64
v_exp_f32 v225, v225
v_exp_f32 v65, v65
v_exp_f32 v226, v226
v_exp_f32 v66, v66
v_exp_f32 v227, v227
v_exp_f32 v67, v67
v_exp_f32 v228, v228
v_exp_f32 v68, v68
v_exp_f32 v229, v229
v_exp_f32 v69, v69
v_exp_f32 v230, v230
v_exp_f32 v70, v70
v_exp_f32 v231, v231
v_exp_f32 v71, v71
v_exp_f32 v232, v232
v_exp_f32 v72, v72
v_exp_f32 v233, v233
v_exp_f32 v73, v73
v_exp_f32 v234, v234
v_exp_f32 v74, v74
v_exp_f32 v235, v235
v_exp_f32 v75, v75
v_pk_mul_f32 v[102:103], v[102:103], v[130:131]
v_pk_mul_f32 v[106:107], v[106:107], v[130:131]
buffer_load_dwordx4 v[212:215], v18, s[32:35], s55 offen offset:0 sc1
buffer_load_dwordx4 v[216:219], v18, s[32:35], s55 offen offset:1024 sc1
.p2align 3
v_pk_add_f32 v[108:109], v[60:61], v[62:63]
v_pk_add_f32 v[110:111], v[220:221], v[222:223]
v_pk_add_f32 v[108:109], v[108:109], v[64:65]
v_pk_add_f32 v[110:111], v[110:111], v[224:225]
v_pk_add_f32 v[108:109], v[108:109], v[66:67]
v_pk_add_f32 v[110:111], v[110:111], v[226:227]
v_add_f32 v100, v108, v109
v_add_f32 v104, v110, v111
v_pk_fma_f32 v[236:237], v[76:77], v[130:131], v[106:107] op_sel:[0,0,0] op_sel_hi:[1,0,0] neg_lo:[1,0,0] neg_hi:[1,0,0]
v_pk_fma_f32 v[238:239], v[78:79], v[130:131], v[106:107] op_sel:[0,0,0] op_sel_hi:[1,0,0] neg_lo:[1,0,0] neg_hi:[1,0,0]
v_pk_add_f32 v[108:109], v[68:69], v[70:71]
v_pk_add_f32 v[110:111], v[228:229], v[230:231]
v_pk_fma_f32 v[76:77], v[76:77], v[130:131], v[102:103] op_sel:[0,0,0] op_sel_hi:[1,0,0] neg_lo:[0,0,1] neg_hi:[0,0,1]
v_pk_fma_f32 v[78:79], v[78:79], v[130:131], v[102:103] op_sel:[0,0,0] op_sel_hi:[1,0,0] neg_lo:[0,0,1] neg_hi:[0,0,1]
v_pk_fma_f32 v[240:241], v[80:81], v[130:131], v[106:107] op_sel:[0,0,0] op_sel_hi:[1,0,0] neg_lo:[1,0,0] neg_hi:[1,0,0]
v_pk_add_f32 v[108:109], v[108:109], v[72:73]
v_pk_add_f32 v[110:111], v[110:111], v[232:233]
v_exp_f32 v236, v236
v_exp_f32 v76, v76
v_exp_f32 v237, v237
v_exp_f32 v77, v77
v_exp_f32 v238, v238
v_exp_f32 v78, v78
v_exp_f32 v239, v239
v_exp_f32 v79, v79
v_pk_fma_f32 v[80:81], v[80:81], v[130:131], v[102:103] op_sel:[0,0,0] op_sel_hi:[1,0,0] neg_lo:[0,0,1] neg_hi:[0,0,1]
v_pk_fma_f32 v[242:243], v[82:83], v[130:131], v[106:107] op_sel:[0,0,0] op_sel_hi:[1,0,0] neg_lo:[1,0,0] neg_hi:[1,0,0]
v_pk_add_f32 v[108:109], v[108:109], v[74:75]
v_pk_add_f32 v[110:111], v[110:111], v[234:235]
v_exp_f32 v240, v240
v_exp_f32 v80, v80
v_exp_f32 v241, v241
v_exp_f32 v81, v81
v_pk_fma_f32 v[82:83], v[82:83], v[130:131], v[102:103] op_sel:[0,0,0] op_sel_hi:[1,0,0] neg_lo:[0,0,1] neg_hi:[0,0,1]
v_add_f32 v101, v108, v109
v_add_f32 v105, v110, v111
v_exp_f32 v242, v242
v_exp_f32 v82, v82
v_exp_f32 v243, v243
v_exp_f32 v83, v83
v_pk_fma_f32 v[244:245], v[84:85], v[130:131], v[106:107] op_sel:[0,1,1] op_sel_hi:[1,1,1] neg_lo:[1,0,0] neg_hi:[1,0,0]
v_pk_fma_f32 v[246:247], v[86:87], v[130:131], v[106:107] op_sel:[0,1,1] op_sel_hi:[1,1,1] neg_lo:[1,0,0] neg_hi:[1,0,0]
v_pk_add_f32 v[108:109], v[76:77], v[78:79]
v_pk_add_f32 v[110:111], v[236:237], v[238:239]
v_pk_fma_f32 v[84:85], v[84:85], v[130:131], v[102:103] op_sel:[0,1,1] op_sel_hi:[1,1,1] neg_lo:[0,0,1] neg_hi:[0,0,1]
v_pk_fma_f32 v[86:87], v[86:87], v[130:131], v[102:103] op_sel:[0,1,1] op_sel_hi:[1,1,1] neg_lo:[0,0,1] neg_hi:[0,0,1]
v_pk_fma_f32 v[248:249], v[88:89], v[130:131], v[106:107] op_sel:[0,1,1] op_sel_hi:[1,1,1] neg_lo:[1,0,0] neg_hi:[1,0,0]
v_pk_fma_f32 v[250:251], v[90:91], v[130:131], v[106:107] op_sel:[0,1,1] op_sel_hi:[1,1,1] neg_lo:[1,0,0] neg_hi:[1,0,0]
v_pk_add_f32 v[108:109], v[108:109], v[80:81]
v_pk_add_f32 v[110:111], v[110:111], v[240:241]
v_exp_f32 v244, v244
v_exp_f32 v84, v84
v_exp_f32 v245, v245
v_exp_f32 v85, v85
v_exp_f32 v246, v246
v_exp_f32 v86, v86
v_exp_f32 v247, v247
v_exp_f32 v87, v87
v_pk_fma_f32 v[88:89], v[88:89], v[130:131], v[102:103] op_sel:[0,1,1] op_sel_hi:[1,1,1] neg_lo:[0,0,1] neg_hi:[0,0,1]
v_pk_fma_f32 v[90:91], v[90:91], v[130:131], v[102:103] op_sel:[0,1,1] op_sel_hi:[1,1,1] neg_lo:[0,0,1] neg_hi:[0,0,1]
v_pk_add_f32 v[108:109], v[108:109], v[82:83]
v_pk_add_f32 v[110:111], v[110:111], v[242:243]
v_exp_f32 v248, v248
v_exp_f32 v88, v88
v_exp_f32 v249, v249
v_exp_f32 v89, v89
v_add_f32 v102, v108, v109
v_add_f32 v106, v110, v111
v_exp_f32 v250, v250
v_exp_f32 v90, v90
v_exp_f32 v251, v251
v_exp_f32 v91, v91
v_pk_add_f32 v[108:109], v[84:85], v[86:87]
v_pk_add_f32 v[110:111], v[244:245], v[246:247]
v_pk_add_f32 v[108:109], v[108:109], v[88:89]
v_pk_add_f32 v[110:111], v[110:111], v[248:249]
v_pk_add_f32 v[108:109], v[108:109], v[90:91]
v_pk_add_f32 v[110:111], v[110:111], v[250:251]
v_add_f32 v103, v108, v109
v_add_f32 v107, v110, v111
s_cmp_eq_u32 s51, 1
s_cbranch_scc1 chk_124
s_waitcnt vmcnt(0)
v_max_u32 v4, v212, v213
v_max3_u32 v4, v4, v214, v215
v_max3_u32 v4, v4, v216, v217
v_max3_u32 v4, v4, v218, v219
v_cmp_eq_u32 vcc, -1, v4
s_cbranch_vccz red_125
buffer_load_dwordx4 v[212:215], v18, s[32:35], s55 offen offset:0 sc1
buffer_load_dwordx4 v[216:219], v18, s[32:35], s55 offen offset:1024 sc1
s_branch chk_124
red_125:
v_mfma_f32_16x16x32_bf16 v[132:135], v[44:47], v[212:215], 0
v_mfma_f32_16x16x32_bf16 v[132:135], v[44:47], v[216:219], v[132:135]
s_mov_b32 s51, 1
s_nop 6
v_add_f32_dpp v132, v132, v132 row_ror:8 row_mask:0xf bank_mask:0xf
v_add_f32_dpp v133, v133, v133 row_ror:8 row_mask:0xf bank_mask:0xf
v_add_f32_dpp v134, v134, v134 row_ror:8 row_mask:0xf bank_mask:0xf
v_add_f32_dpp v135, v135, v135 row_ror:8 row_mask:0xf bank_mask:0xf
v_cvt_pk_bf16_f32 v132, v132, v133
v_cvt_pk_bf16_f32 v133, v134, v135
s_mov_b64 exec, 0x00ff00ff
buffer_store_dwordx2 v[132:133], v59, s[32:35], s79 offen sc1
s_mov_b64 exec, -1
buffer_load_dwordx4 v[204:207], v58, s[32:35], s56 offen sc1
buffer_load_dwordx4 v[208:211], v58, s[32:35], s57 offen sc1
chk_124:
.p2align 3
v_permlane32_swap_b32 v100, v101
v_permlane32_swap_b32 v102, v103
v_permlane32_swap_b32 v104, v105
v_permlane32_swap_b32 v106, v107
v_add_f32 v100, v100, v101
v_add_f32 v102, v102, v103
v_add_f32 v104, v104, v105
v_add_f32 v106, v106, v107
v_permlane16_swap_b32 v100, v102
s_nop 0
v_permlane16_swap_b32 v104, v106
v_add_f32 v100, v100, v102
v_add_f32 v104, v104, v106
v_rcp_f32 v100, v100
v_rcp_f32 v104, v104
v_mov_b32 v102, v100
v_mov_b32 v106, v104
s_nop 0
v_permlane16_swap_b32 v100, v102
v_permlane16_swap_b32 v104, v106
v_mov_b32 v101, v100
v_mov_b32 v103, v102
v_mov_b32 v105, v104
v_mov_b32 v107, v106
v_permlane32_swap_b32 v100, v101
v_permlane32_swap_b32 v102, v103
v_permlane32_swap_b32 v104, v105
v_permlane32_swap_b32 v106, v107
v_pk_mul_f32 v[60:61], v[60:61], v[100:101] op_sel:[0,0] op_sel_hi:[1,0]
v_pk_mul_f32 v[220:221], v[220:221], v[104:105] op_sel:[0,0] op_sel_hi:[1,0]
v_pk_mul_f32 v[68:69], v[68:69], v[100:101] op_sel:[0,1] op_sel_hi:[1,1]
v_pk_mul_f32 v[228:229], v[228:229], v[104:105] op_sel:[0,1] op_sel_hi:[1,1]
v_pk_mul_f32 v[76:77], v[76:77], v[102:103] op_sel:[0,0] op_sel_hi:[1,0]
v_pk_mul_f32 v[236:237], v[236:237], v[106:107] op_sel:[0,0] op_sel_hi:[1,0]
v_pk_mul_f32 v[84:85], v[84:85], v[102:103] op_sel:[0,1] op_sel_hi:[1,1]
v_pk_mul_f32 v[244:245], v[244:245], v[106:107] op_sel:[0,1] op_sel_hi:[1,1]
v_pk_mul_f32 v[62:63], v[62:63], v[100:101] op_sel:[0,0] op_sel_hi:[1,0]
v_pk_mul_f32 v[222:223], v[222:223], v[104:105] op_sel:[0,0] op_sel_hi:[1,0]
v_cvt_pk_bf16_f32 v60, v60, v61
v_cvt_pk_bf16_f32 v220, v220, v221
v_pk_mul_f32 v[70:71], v[70:71], v[100:101] op_sel:[0,1] op_sel_hi:[1,1]
v_pk_mul_f32 v[230:231], v[230:231], v[104:105] op_sel:[0,1] op_sel_hi:[1,1]
v_cvt_pk_bf16_f32 v68, v68, v69
v_cvt_pk_bf16_f32 v228, v228, v229
v_pk_mul_f32 v[78:79], v[78:79], v[102:103] op_sel:[0,0] op_sel_hi:[1,0]
v_pk_mul_f32 v[238:239], v[238:239], v[106:107] op_sel:[0,0] op_sel_hi:[1,0]
v_cvt_pk_bf16_f32 v76, v76, v77
v_cvt_pk_bf16_f32 v236, v236, v237
v_pk_mul_f32 v[86:87], v[86:87], v[102:103] op_sel:[0,1] op_sel_hi:[1,1]
v_pk_mul_f32 v[246:247], v[246:247], v[106:107] op_sel:[0,1] op_sel_hi:[1,1]
v_cvt_pk_bf16_f32 v84, v84, v85
v_cvt_pk_bf16_f32 v244, v244, v245
v_pk_mul_f32 v[64:65], v[64:65], v[100:101] op_sel:[0,0] op_sel_hi:[1,0]
v_pk_mul_f32 v[66:67], v[66:67], v[100:101] op_sel:[0,0] op_sel_hi:[1,0]
v_pk_mul_f32 v[224:225], v[224:225], v[104:105] op_sel:[0,0] op_sel_hi:[1,0]
v_pk_mul_f32 v[226:227], v[226:227], v[104:105] op_sel:[0,0] op_sel_hi:[1,0]
v_cvt_pk_bf16_f32 v61, v62, v63
v_cvt_pk_bf16_f32 v221, v222, v223
v_pk_mul_f32 v[72:73], v[72:73], v[100:101] op_sel:[0,1] op_sel_hi:[1,1]
v_pk_mul_f32 v[74:75], v[74:75], v[100:101] op_sel:[0,1] op_sel_hi:[1,1]
v_pk_mul_f32 v[232:233], v[232:233], v[104:105] op_sel:[0,1] op_sel_hi:[1,1]
v_pk_mul_f32 v[234:235], v[234:235], v[104:105] op_sel:[0,1] op_sel_hi:[1,1]
v_cvt_pk_bf16_f32 v69, v70, v71
v_cvt_pk_bf16_f32 v229, v230, v231
v_pk_mul_f32 v[80:81], v[80:81], v[102:103] op_sel:[0,0] op_sel_hi:[1,0]
v_pk_mul_f32 v[82:83], v[82:83], v[102:103] op_sel:[0,0] op_sel_hi:[1,0]
v_pk_mul_f32 v[240:241], v[240:241], v[106:107] op_sel:[0,0] op_sel_hi:[1,0]
v_pk_mul_f32 v[242:243], v[242:243], v[106:107] op_sel:[0,0] op_sel_hi:[1,0]
v_cvt_pk_bf16_f32 v77, v78, v79
v_cvt_pk_bf16_f32 v237, v238, v239
v_pk_mul_f32 v[88:89], v[88:89], v[102:103] op_sel:[0,1] op_sel_hi:[1,1]
v_pk_mul_f32 v[90:91], v[90:91], v[102:103] op_sel:[0,1] op_sel_hi:[1,1]
v_pk_mul_f32 v[248:249], v[248:249], v[106:107] op_sel:[0,1] op_sel_hi:[1,1]
v_pk_mul_f32 v[250:251], v[250:251], v[106:107] op_sel:[0,1] op_sel_hi:[1,1]
v_cvt_pk_bf16_f32 v85, v86, v87
v_cvt_pk_bf16_f32 v245, v246, v247
v_cvt_pk_bf16_f32 v62, v64, v65
v_cvt_pk_bf16_f32 v63, v66, v67
v_cvt_pk_bf16_f32 v222, v224, v225
v_cvt_pk_bf16_f32 v223, v226, v227
v_cvt_pk_bf16_f32 v70, v72, v73
v_cvt_pk_bf16_f32 v71, v74, v75
v_cvt_pk_bf16_f32 v230, v232, v233
v_cvt_pk_bf16_f32 v231, v234, v235
v_cvt_pk_bf16_f32 v78, v80, v81
v_cvt_pk_bf16_f32 v79, v82, v83
v_cvt_pk_bf16_f32 v238, v240, v241
v_cvt_pk_bf16_f32 v239, v242, v243
v_cvt_pk_bf16_f32 v86, v88, v89
v_cvt_pk_bf16_f32 v87, v90, v91
v_cvt_pk_bf16_f32 v246, v248, v249
v_cvt_pk_bf16_f32 v247, v250, v251
s_cmp_lg_u32 s51, 0
s_cbranch_scc1 else_126
s_mov_b32 s63, 0
sent_128:
s_waitcnt vmcnt(0)
v_max_u32 v4, v212, v213
v_max3_u32 v4, v4, v214, v215
v_max3_u32 v4, v4, v216, v217
v_max3_u32 v4, v4, v218, v219
v_cmp_eq_u32 vcc, -1, v4
s_cbranch_vccz sentd_129
buffer_load_dwordx4 v[212:215], v18, s[32:35], s55 offen offset:0 sc1
buffer_load_dwordx4 v[216:219], v18, s[32:35], s55 offen offset:1024 sc1
s_add_u32 s63, s63, 1
s_cmp_lt_u32 s63, 0x80000
s_cbranch_scc1 sent_128
s_waitcnt vmcnt(0)
sentd_129:
v_mfma_f32_16x16x32_bf16 v[132:135], v[44:47], v[212:215], 0
v_mfma_f32_16x16x32_bf16 v[132:135], v[44:47], v[216:219], v[132:135]
s_mov_b32 s51, 1
s_nop 6
v_add_f32_dpp v132, v132, v132 row_ror:8 row_mask:0xf bank_mask:0xf
v_add_f32_dpp v133, v133, v133 row_ror:8 row_mask:0xf bank_mask:0xf
v_add_f32_dpp v134, v134, v134 row_ror:8 row_mask:0xf bank_mask:0xf
v_add_f32_dpp v135, v135, v135 row_ror:8 row_mask:0xf bank_mask:0xf
v_cvt_pk_bf16_f32 v132, v132, v133
v_cvt_pk_bf16_f32 v133, v134, v135
s_mov_b64 exec, 0x00ff00ff
buffer_store_dwordx2 v[132:133], v59, s[32:35], s79 offen sc1
s_mov_b64 exec, -1
buffer_load_dwordx4 v[204:207], v58, s[32:35], s56 offen sc1
buffer_load_dwordx4 v[208:211], v58, s[32:35], s57 offen sc1
else_126:
s_mov_b32 s63, 0
sent_130:
s_waitcnt vmcnt(0)
v_max_u32 v4, v204, v205
v_max3_u32 v4, v4, v206, v207
v_max3_u32 v4, v4, v208, v209
v_max3_u32 v4, v4, v210, v211
v_cmp_eq_u32 vcc, -1, v4
s_cbranch_vccz sentd_131
buffer_load_dwordx4 v[204:207], v58, s[32:35], s56 offen sc1
buffer_load_dwordx4 v[208:211], v58, s[32:35], s57 offen sc1
s_add_u32 s63, s63, 1
s_cmp_lt_u32 s63, 0x80000
s_cbranch_scc1 sent_130
s_waitcnt vmcnt(0)
sentd_131:
v_mfma_f32_16x16x32_bf16 v[112:115], v[204:207], v[60:63], 0
v_mfma_f32_16x16x32_bf16 v[116:119], v[204:207], v[68:71], 0
v_mfma_f32_16x16x32_bf16 v[120:123], v[204:207], v[76:79], 0
v_mfma_f32_16x16x32_bf16 v[124:127], v[204:207], v[84:87], 0
v_mfma_f32_16x16x32_bf16 v[112:115], v[208:211], v[220:223], v[112:115]
v_mfma_f32_16x16x32_bf16 v[116:119], v[208:211], v[228:231], v[116:119]
v_mfma_f32_16x16x32_bf16 v[120:123], v[208:211], v[236:239], v[120:123]
v_mfma_f32_16x16x32_bf16 v[124:127], v[208:211], v[244:247], v[124:127]
s_nop 4
v_add_f32 v100, v112, v113
v_add_f32 v114, v114, v115
v_add_f32 v100, v100, v114
v_add_f32 v101, v116, v117
v_add_f32 v118, v118, v119
v_add_f32 v101, v101, v118
v_add_f32 v102, v120, v121
v_add_f32 v122, v122, v123
v_add_f32 v102, v102, v122
v_add_f32 v103, v124, v125
v_add_f32 v126, v126, v127
v_add_f32 v103, v103, v126
s_nop 1
v_permlane32_swap_b32 v100, v101
v_permlane32_swap_b32 v102, v103
v_add_f32 v100, v100, v101
v_add_f32 v102, v102, v103
s_nop 1
v_permlane16_swap_b32 v100, v102
s_nop 0
v_add_f32 v100, v100, v102
v_add_f32 v100, 0x358637bd, v100
v_rcp_f32 v100, v100
s_nop 0
v_mov_b32 v102, v100
s_nop 1
v_permlane16_swap_b32 v100, v102
s_nop 0
v_mov_b32 v101, v100
v_mov_b32 v103, v102
s_nop 0
v_permlane32_swap_b32 v100, v101
v_permlane32_swap_b32 v102, v103
buffer_load_dwordx4 v[188:191], v18, s[32:35], s58 offen offset:0 sc1
buffer_load_dwordx4 v[192:195], v18, s[32:35], s58 offen offset:1024 sc1
buffer_load_dwordx4 v[196:199], v18, s[32:35], s59 offen offset:0 sc1
buffer_load_dwordx4 v[200:203], v18, s[32:35], s59 offen offset:1024 sc1
s_mov_b32 s63, 0
sent_132:
s_waitcnt vmcnt(0)
v_max_u32 v4, v188, v189
v_max3_u32 v4, v4, v190, v191
v_max3_u32 v4, v4, v192, v193
v_max3_u32 v4, v4, v194, v195
v_max3_u32 v4, v4, v196, v197
v_max3_u32 v4, v4, v198, v199
v_max3_u32 v4, v4, v200, v201
v_max3_u32 v4, v4, v202, v203
v_cmp_eq_u32 vcc, -1, v4
s_cbranch_vccz sentd_133
buffer_load_dwordx4 v[188:191], v18, s[32:35], s58 offen offset:0 sc1
buffer_load_dwordx4 v[192:195], v18, s[32:35], s58 offen offset:1024 sc1
buffer_load_dwordx4 v[196:199], v18, s[32:35], s59 offen offset:0 sc1
buffer_load_dwordx4 v[200:203], v18, s[32:35], s59 offen offset:1024 sc1
s_add_u32 s63, s63, 1
s_cmp_lt_u32 s63, 0x80000
s_cbranch_scc1 sent_132
s_waitcnt vmcnt(0)
sentd_133:
s_cmp_eq_u32 s46, 0
s_cbranch_scc1 slow_134
.p2align 3
v_mfma_f32_16x16x32_bf16 v[156:159], v[188:191], v[60:63], 0
v_mfma_f32_16x16x32_bf16 v[164:167], v[188:191], v[68:71], 0
v_mfma_f32_16x16x32_bf16 v[160:163], v[192:195], v[60:63], 0
v_mfma_f32_16x16x32_bf16 v[172:175], v[188:191], v[76:79], 0
v_mfma_f32_16x16x32_bf16 v[168:171], v[192:195], v[68:71], 0
v_mfma_f32_16x16x32_bf16 v[180:183], v[188:191], v[84:87], 0
v_mfma_f32_16x16x32_bf16 v[156:159], v[196:199], v[220:223], v[156:159]
v_mfma_f32_16x16x32_bf16 v[176:179], v[192:195], v[76:79], 0
v_mfma_f32_16x16x32_bf16 v[164:167], v[196:199], v[228:231], v[164:167]
v_mfma_f32_16x16x32_bf16 v[184:187], v[192:195], v[84:87], 0
v_mfma_f32_16x16x32_bf16 v[160:163], v[200:203], v[220:223], v[160:163]
v_mfma_f32_16x16x32_bf16 v[172:175], v[196:199], v[236:239], v[172:175]
v_mfma_f32_16x16x32_bf16 v[168:171], v[200:203], v[228:231], v[168:171]
v_mfma_f32_16x16x32_bf16 v[180:183], v[196:199], v[244:247], v[180:183]
v_mfma_f32_16x16x32_bf16 v[176:179], v[200:203], v[236:239], v[176:179]
v_mfma_f32_16x16x32_bf16 v[184:187], v[200:203], v[244:247], v[184:187]
v_pk_mul_f32 v[156:157], v[156:157], v[100:101] op_sel:[0,0] op_sel_hi:[1,0]
v_pk_mul_f32 v[158:159], v[158:159], v[100:101] op_sel:[0,0] op_sel_hi:[1,0]
v_cvt_pk_bf16_f32 v156, v156, v157
v_pk_mul_f32 v[164:165], v[164:165], v[100:101] op_sel:[0,1] op_sel_hi:[1,1]
v_pk_mul_f32 v[160:161], v[160:161], v[100:101] op_sel:[0,0] op_sel_hi:[1,0]
v_pk_mul_f32 v[162:163], v[162:163], v[100:101] op_sel:[0,0] op_sel_hi:[1,0]
v_cvt_pk_bf16_f32 v157, v158, v159
v_pk_mul_f32 v[166:167], v[166:167], v[100:101] op_sel:[0,1] op_sel_hi:[1,1]
v_cvt_pk_bf16_f32 v164, v164, v165
v_pk_mul_f32 v[172:173], v[172:173], v[102:103] op_sel:[0,0] op_sel_hi:[1,0]
v_cvt_pk_bf16_f32 v158, v160, v161
v_cvt_pk_bf16_f32 v159, v162, v163
v_pk_mul_f32 v[168:169], v[168:169], v[100:101] op_sel:[0,1] op_sel_hi:[1,1]
v_pk_mul_f32 v[170:171], v[170:171], v[100:101] op_sel:[0,1] op_sel_hi:[1,1]
v_cvt_pk_bf16_f32 v165, v166, v167
v_pk_mul_f32 v[174:175], v[174:175], v[102:103] op_sel:[0,0] op_sel_hi:[1,0]
v_cvt_pk_bf16_f32 v172, v172, v173
v_pk_mul_f32 v[180:181], v[180:181], v[102:103] op_sel:[0,1] op_sel_hi:[1,1]
buffer_store_dwordx4 v[156:159], v18, s[32:35], s80 offen
v_cvt_pk_bf16_f32 v166, v168, v169
v_cvt_pk_bf16_f32 v167, v170, v171
v_pk_mul_f32 v[176:177], v[176:177], v[102:103] op_sel:[0,0] op_sel_hi:[1,0]
v_pk_mul_f32 v[178:179], v[178:179], v[102:103] op_sel:[0,0] op_sel_hi:[1,0]
v_cvt_pk_bf16_f32 v173, v174, v175
v_pk_mul_f32 v[182:183], v[182:183], v[102:103] op_sel:[0,1] op_sel_hi:[1,1]
v_cvt_pk_bf16_f32 v180, v180, v181
buffer_store_dwordx4 v[164:167], v18, s[32:35], s81 offen
v_cvt_pk_bf16_f32 v174, v176, v177
v_cvt_pk_bf16_f32 v175, v178, v179
v_pk_mul_f32 v[184:185], v[184:185], v[102:103] op_sel:[0,1] op_sel_hi:[1,1]
v_pk_mul_f32 v[186:187], v[186:187], v[102:103] op_sel:[0,1] op_sel_hi:[1,1]
v_cvt_pk_bf16_f32 v181, v182, v183
buffer_store_dwordx4 v[172:175], v18, s[32:35], s82 offen
v_cvt_pk_bf16_f32 v182, v184, v185
v_cvt_pk_bf16_f32 v183, v186, v187
buffer_store_dwordx4 v[180:183], v18, s[32:35], s83 offen
back_135:
s_barrier
v_and_b32 v36, 31, v0
v_lshlrev_b32 v36, 2, v36
s_lshl_b32 s62, s45, 2
v_mov_b32 v4, s62
v_mov_b32 v5, 4
s_mov_b64 exec, 1
s_waitcnt vmcnt(0)
s_cmp_eq_u32 s46, 0
s_cbranch_scc1 slow_136
buffer_store_dword v5, v4, s[32:35], s84 offen
back_137:
s_mov_b64 exec, -1
v_lshrrev_b32 v4, 2, v2
v_and_b32 v5, 3, v0
v_lshl_add_u32 v6, v3, 3, v4
v_lshlrev_b32 v6, 7, v6
v_lshl_add_u32 v6, v5, 3, v6
v_lshrrev_b32 v7, 1, v4
v_and_b32 v8, 1, v3
v_lshl_add_u32 v7, v8, 1, v7
v_lshl_add_u32 v10, v7, 5, v6
v_xor_b32 v11, 32, v10
v_xor_b32 v12, 64, v10
v_xor_b32 v13, 96, v10
v_add_u32 v14, 0x10000, v10
v_add_u32 v15, 0x10000, v11
v_add_u32 v16, 0x10000, v12
v_add_u32 v17, 0x10000, v13
ds_read_b64_tr_b16 v[220:221], v10 offset:0
ds_read_b64_tr_b16 v[222:223], v10 offset:512
ds_read_b64_tr_b16 v[224:225], v11 offset:0
ds_read_b64_tr_b16 v[226:227], v11 offset:512
ds_read_b64_tr_b16 v[228:229], v12 offset:0
ds_read_b64_tr_b16 v[230:231], v12 offset:512
ds_read_b64_tr_b16 v[232:233], v13 offset:0
ds_read_b64_tr_b16 v[234:235], v13 offset:512
ds_read_b64_tr_b16 v[236:237], v10 offset:4096
ds_read_b64_tr_b16 v[238:239], v10 offset:4608
ds_read_b64_tr_b16 v[240:241], v11 offset:4096
ds_read_b64_tr_b16 v[242:243], v11 offset:4608
ds_read_b64_tr_b16 v[244:245], v12 offset:4096
ds_read_b64_tr_b16 v[246:247], v12 offset:4608
ds_read_b64_tr_b16 v[248:249], v13 offset:4096
ds_read_b64_tr_b16 v[250:251], v13 offset:4608
s_lshl_b32 s48, s41, 3
s_lshl_b32 s49, s40, 1
s_add_u32 s48, s48, s49
s_lshl_b32 s48, s48, 15
s_add_u32 s48, s48, 4194304
v_add_u32 v38, s48, v18
v_add_u32 v39, 32768, v38
s_lshl_b32 s57, s75, 11
s_add_u32 s87, s87, 262144
v_lshlrev_b32 v60, 16, v20
v_and_b32 v61, 0xffff0000, v20
v_lshlrev_b32 v62, 16, v21
v_and_b32 v63, 0xffff0000, v21
v_lshlrev_b32 v64, 16, v22
v_and_b32 v65, 0xffff0000, v22
v_lshlrev_b32 v66, 16, v23
v_and_b32 v67, 0xffff0000, v23
v_lshlrev_b32 v68, 16, v24
v_and_b32 v69, 0xffff0000, v24
v_lshlrev_b32 v70, 16, v25
v_and_b32 v71, 0xffff0000, v25
v_lshlrev_b32 v72, 16, v26
v_and_b32 v73, 0xffff0000, v26
v_lshlrev_b32 v74, 16, v27
v_and_b32 v75, 0xffff0000, v27
v_lshlrev_b32 v76, 16, v28
v_and_b32 v77, 0xffff0000, v28
v_lshlrev_b32 v78, 16, v29
v_and_b32 v79, 0xffff0000, v29
v_lshlrev_b32 v80, 16, v30
v_and_b32 v81, 0xffff0000, v30
v_lshlrev_b32 v82, 16, v31
v_and_b32 v83, 0xffff0000, v31
v_lshlrev_b32 v84, 16, v32
v_and_b32 v85, 0xffff0000, v32
v_lshlrev_b32 v86, 16, v33
v_and_b32 v87, 0xffff0000, v33
v_lshlrev_b32 v88, 16, v34
v_and_b32 v89, 0xffff0000, v34
v_lshlrev_b32 v90, 16, v35
v_and_b32 v91, 0xffff0000, v35
s_lshl_b32 s48, s40, 12
s_add_u32 s48, s48, 139264
v_lshrrev_b32 v4, 1, v2
v_lshrrev_b32 v5, 1, v3
v_xor_b32 v4, v4, v5
v_lshlrev_b32 v4, 4, v4
v_and_b32 v5, 1, v3
v_lshl_add_u32 v4, v5, 3, v4
v_lshl_add_u32 v4, v2, 7, v4
v_add_u32 v42, s48, v4
v_xor_b32 v43, 32, v42
v_xor_b32 v44, 64, v42
v_xor_b32 v45, 96, v42
v_add_u32 v46, s48, v18
s_lshl_b32 s48, s41, 7
s_lshl_b32 s49, s40, 5
s_add_u32 s48, s48, s49
s_lshl_b32 s48, s48, 11
s_lshl_b32 s49, s78, 7
s_add_u32 s48, s48, s49
s_add_u32 s49, s48, 32768
v_lshrrev_b32 v4, 3, v0
v_and_b32 v5, 7, v0
v_lshrrev_b32 v6, 1, v4
v_xor_b32 v5, v5, v6
v_lshlrev_b32 v4, 11, v4
v_lshl_add_u32 v40, v5, 4, v4
v_xor_b32 v41, 64, v40
v_add_u32 v41, 16384, v41
buffer_load_dword v37, v36, s[32:35], s84 offen sc1
s_mov_b32 s63, 0
s_waitcnt vmcnt(0)
poll_138:
v_cmp_gt_u32 vcc, 4, v37
s_cbranch_vccz polled_139
buffer_load_dword v37, v36, s[32:35], s84 offen sc1
s_add_u32 s63, s63, 1
s_cmp_lt_u32 s63, 0x80000
s_waitcnt vmcnt(0)
s_cbranch_scc1 poll_138
polled_139:
s_call_b64 s[94:95], R_oloop
s_nop 0
v_cvt_pk_bf16_f32 v20, v60, v61
v_cvt_pk_bf16_f32 v21, v62, v63
v_cvt_pk_bf16_f32 v22, v64, v65
v_cvt_pk_bf16_f32 v23, v66, v67
ds_write_b64 v42, v[20:21] offset:0
ds_write_b64 v43, v[22:23] offset:0
v_cvt_pk_bf16_f32 v24, v68, v69
v_cvt_pk_bf16_f32 v25, v70, v71
v_cvt_pk_bf16_f32 v26, v72, v73
v_cvt_pk_bf16_f32 v27, v74, v75
ds_write_b64 v44, v[24:25] offset:0
ds_write_b64 v45, v[26:27] offset:0
v_cvt_pk_bf16_f32 v28, v76, v77
v_cvt_pk_bf16_f32 v29, v78, v79
v_cvt_pk_bf16_f32 v30, v80, v81
v_cvt_pk_bf16_f32 v31, v82, v83
ds_write_b64 v42, v[28:29] offset:2048
ds_write_b64 v43, v[30:31] offset:2048
v_cvt_pk_bf16_f32 v32, v84, v85
v_cvt_pk_bf16_f32 v33, v86, v87
v_cvt_pk_bf16_f32 v34, v88, v89
v_cvt_pk_bf16_f32 v35, v90, v91
ds_write_b64 v44, v[32:33] offset:2048
ds_write_b64 v45, v[34:35] offset:2048
ds_read_b128 v[20:23], v46 offset:0
ds_read_b128 v[24:27], v46 offset:1024
ds_read_b128 v[28:31], v46 offset:2048
ds_read_b128 v[32:35], v46 offset:3072
s_waitcnt lgkmcnt(3)
buffer_store_dwordx4 v[20:23], v40, s[24:27], s48 offen sc1
s_waitcnt lgkmcnt(2)
buffer_store_dwordx4 v[24:27], v41, s[24:27], s48 offen sc1
s_waitcnt lgkmcnt(1)
buffer_store_dwordx4 v[28:31], v40, s[24:27], s49 offen sc1
s_waitcnt lgkmcnt(0)
buffer_store_dwordx4 v[32:35], v41, s[24:27], s49 offen sc1
s_endpgm
L_code_end:
again_22:
s_mov_b32 s63, 0
retry_24:
buffer_load_dwordx4 v[176:179], v37, s[32:35], 0 offen offset:0 sc1
buffer_load_dwordx4 v[180:183], v37, s[32:35], 0 offen offset:1024 sc1
buffer_load_dwordx4 v[184:187], v37, s[32:35], 0 offen offset:2048 sc1
buffer_load_dwordx4 v[188:191], v37, s[32:35], 0 offen offset:3072 sc1
s_waitcnt vmcnt(0)
v_add_f32 v176, v176, v184
v_add_f32 v177, v177, v185
v_add_f32 v178, v178, v186
v_add_f32 v179, v179, v187
v_add_f32 v180, v180, v188
v_add_f32 v181, v181, v189
v_add_f32 v182, v182, v190
v_add_f32 v183, v183, v191
v_add_f32 v176, v176, v180
v_add_f32 v177, v177, v181
v_add_f32 v178, v178, v182
v_add_f32 v179, v179, v183
s_nop 1
v_permlane32_swap_b32 v176, v177
v_permlane32_swap_b32 v178, v179
v_add_f32 v176, v176, v177
v_add_f32 v178, v178, v179
s_nop 1
v_permlane16_swap_b32 v176, v178
s_nop 0
v_add_f32 v176, v176, v178
v_cmp_u_f32 vcc, v176, v176
s_cbranch_vccz summed_23
s_add_u32 s63, s63, 1
s_cmp_lt_u32 s63, 0x10000
s_cbranch_scc1 retry_24
s_branch summed_23
again_25:
s_mov_b32 s63, 0
retry_27:
buffer_load_dwordx4 v[160:163], v38, s[32:35], 0 offen offset:0 sc1
buffer_load_dwordx4 v[164:167], v38, s[32:35], 0 offen offset:1024 sc1
buffer_load_dwordx4 v[168:171], v38, s[32:35], 0 offen offset:2048 sc1
buffer_load_dwordx4 v[172:175], v38, s[32:35], 0 offen offset:3072 sc1
s_waitcnt vmcnt(0)
v_add_f32 v160, v160, v168
v_add_f32 v161, v161, v169
v_add_f32 v162, v162, v170
v_add_f32 v163, v163, v171
v_add_f32 v164, v164, v172
v_add_f32 v165, v165, v173
v_add_f32 v166, v166, v174
v_add_f32 v167, v167, v175
v_add_f32 v160, v160, v164
v_add_f32 v161, v161, v165
v_add_f32 v162, v162, v166
v_add_f32 v163, v163, v167
s_nop 1
v_permlane32_swap_b32 v160, v161
v_permlane32_swap_b32 v162, v163
v_add_f32 v160, v160, v161
v_add_f32 v162, v162, v163
s_nop 1
v_permlane16_swap_b32 v160, v162
s_nop 0
v_add_f32 v160, v160, v162
v_cmp_u_f32 vcc, v160, v160
s_cbranch_vccz summed_26
s_add_u32 s63, s63, 1
s_cmp_lt_u32 s63, 0x10000
s_cbranch_scc1 retry_27
s_branch summed_26
again_35:
s_mov_b32 s63, 0
retry_37:
buffer_load_dwordx4 v[80:83], v37, s[32:35], 0 offen offset:0 sc1
buffer_load_dwordx4 v[84:87], v37, s[32:35], 0 offen offset:1024 sc1
buffer_load_dwordx4 v[88:91], v37, s[32:35], 0 offen offset:2048 sc1
buffer_load_dwordx4 v[92:95], v37, s[32:35], 0 offen offset:3072 sc1
s_waitcnt vmcnt(0)
v_add_f32 v80, v80, v88
v_add_f32 v81, v81, v89
v_add_f32 v82, v82, v90
v_add_f32 v83, v83, v91
v_add_f32 v84, v84, v92
v_add_f32 v85, v85, v93
v_add_f32 v86, v86, v94
v_add_f32 v87, v87, v95
v_add_f32 v80, v80, v84
v_add_f32 v81, v81, v85
v_add_f32 v82, v82, v86
v_add_f32 v83, v83, v87
s_nop 1
v_permlane32_swap_b32 v80, v81
v_permlane32_swap_b32 v82, v83
v_add_f32 v80, v80, v81
v_add_f32 v82, v82, v83
s_nop 1
v_permlane16_swap_b32 v80, v82
s_nop 0
v_add_f32 v80, v80, v82
v_cmp_u_f32 vcc, v80, v80
s_cbranch_vccz summed_36
s_add_u32 s63, s63, 1
s_cmp_lt_u32 s63, 0x10000
s_cbranch_scc1 retry_37
s_branch summed_36
again_38:
s_mov_b32 s63, 0
retry_40:
buffer_load_dwordx4 v[64:67], v38, s[32:35], 0 offen offset:0 sc1
buffer_load_dwordx4 v[68:71], v38, s[32:35], 0 offen offset:1024 sc1
buffer_load_dwordx4 v[72:75], v38, s[32:35], 0 offen offset:2048 sc1
buffer_load_dwordx4 v[76:79], v38, s[32:35], 0 offen offset:3072 sc1
s_waitcnt vmcnt(0)
v_add_f32 v64, v64, v72
v_add_f32 v65, v65, v73
v_add_f32 v66, v66, v74
v_add_f32 v67, v67, v75
v_add_f32 v68, v68, v76
v_add_f32 v69, v69, v77
v_add_f32 v70, v70, v78
v_add_f32 v71, v71, v79
v_add_f32 v64, v64, v68
v_add_f32 v65, v65, v69
v_add_f32 v66, v66, v70
v_add_f32 v67, v67, v71
s_nop 1
v_permlane32_swap_b32 v64, v65
v_permlane32_swap_b32 v66, v67
v_add_f32 v64, v64, v65
v_add_f32 v66, v66, v67
s_nop 1
v_permlane16_swap_b32 v64, v66
s_nop 0
v_add_f32 v64, v64, v66
v_cmp_u_f32 vcc, v64, v64
s_cbranch_vccz summed_39
s_add_u32 s63, s63, 1
s_cmp_lt_u32 s63, 0x10000
s_cbranch_scc1 retry_40
s_branch summed_39
again_44:
s_mov_b32 s63, 0
retry_46:
buffer_load_dwordx4 v[80:83], v37, s[32:35], 0 offen offset:0 sc1
buffer_load_dwordx4 v[84:87], v37, s[32:35], 0 offen offset:1024 sc1
buffer_load_dwordx4 v[88:91], v37, s[32:35], 0 offen offset:2048 sc1
buffer_load_dwordx4 v[92:95], v37, s[32:35], 0 offen offset:3072 sc1
s_waitcnt vmcnt(0)
v_add_f32 v80, v80, v88
v_add_f32 v81, v81, v89
v_add_f32 v82, v82, v90
v_add_f32 v83, v83, v91
v_add_f32 v84, v84, v92
v_add_f32 v85, v85, v93
v_add_f32 v86, v86, v94
v_add_f32 v87, v87, v95
v_add_f32 v80, v80, v84
v_add_f32 v81, v81, v85
v_add_f32 v82, v82, v86
v_add_f32 v83, v83, v87
s_nop 1
v_permlane32_swap_b32 v80, v81
v_permlane32_swap_b32 v82, v83
v_add_f32 v80, v80, v81
v_add_f32 v82, v82, v83
s_nop 1
v_permlane16_swap_b32 v80, v82
s_nop 0
v_add_f32 v80, v80, v82
v_cmp_u_f32 vcc, v80, v80
s_cbranch_vccz summed_45
s_add_u32 s63, s63, 1
s_cmp_lt_u32 s63, 0x10000
s_cbranch_scc1 retry_46
s_branch summed_45
again_52:
s_mov_b32 s63, 0
retry_54:
buffer_load_dwordx4 v[80:83], v37, s[32:35], 0 offen offset:0 sc1
buffer_load_dwordx4 v[84:87], v37, s[32:35], 0 offen offset:1024 sc1
buffer_load_dwordx4 v[88:91], v37, s[32:35], 0 offen offset:2048 sc1
buffer_load_dwordx4 v[92:95], v37, s[32:35], 0 offen offset:3072 sc1
s_waitcnt vmcnt(0)
v_add_f32 v80, v80, v88
v_add_f32 v81, v81, v89
v_add_f32 v82, v82, v90
v_add_f32 v83, v83, v91
v_add_f32 v84, v84, v92
v_add_f32 v85, v85, v93
v_add_f32 v86, v86, v94
v_add_f32 v87, v87, v95
v_add_f32 v80, v80, v84
v_add_f32 v81, v81, v85
v_add_f32 v82, v82, v86
v_add_f32 v83, v83, v87
s_nop 1
v_permlane32_swap_b32 v80, v81
v_permlane32_swap_b32 v82, v83
v_add_f32 v80, v80, v81
v_add_f32 v82, v82, v83
s_nop 1
v_permlane16_swap_b32 v80, v82
s_nop 0
v_add_f32 v80, v80, v82
v_cmp_u_f32 vcc, v80, v80
s_cbranch_vccz summed_53
s_add_u32 s63, s63, 1
s_cmp_lt_u32 s63, 0x10000
s_cbranch_scc1 retry_54
s_branch summed_53
slow_73:
.p2align 3
v_mfma_f32_16x16x32_bf16 v[160:163], v[120:123], v[156:159], v[44:47]
v_max_f32 v158, v192, v193
v_max_f32 v159, v194, v195
v_permlane32_swap_b32 v130, v131
s_nop 0
v_max_f32 v130, v130, v131
s_nop 2
v_max_f32 v156, v160, v161
v_max_f32 v157, v162, v163
v_max3_f32 v128, v156, v157, v158
v_max_f32 v128, v128, v159
s_nop 1
v_permlane32_swap_b32 v128, v129
s_nop 0
v_max_f32 v128, v128, v129
s_nop 1
v_permlane16_swap_b32 v128, v130
s_nop 0
v_max_f32 v128, v128, v130
v_mov_b32 v130, v128
s_nop 1
v_permlane16_swap_b32 v128, v130
s_nop 0
v_mov_b32 v129, v128
v_mov_b32 v131, v130
s_nop 0
v_permlane32_swap_b32 v128, v129
v_permlane32_swap_b32 v130, v131
v_mul_f32 v128, v128, v124
v_mul_f32 v129, v129, v125
v_pk_fma_f32 v[156:157], v[156:157], v[124:125], v[128:129] op_sel:[0,0,0] op_sel_hi:[1,0,0] neg_lo:[0,0,1] neg_hi:[0,0,1]
v_pk_fma_f32 v[158:159], v[158:159], v[124:125], v[128:129] op_sel:[0,0,0] op_sel_hi:[1,0,0] neg_lo:[0,0,1] neg_hi:[0,0,1]
v_mul_f32 v130, v130, v126
v_mul_f32 v131, v131, v127
v_exp_f32 v156, v156
v_exp_f32 v157, v157
v_exp_f32 v158, v158
v_exp_f32 v159, v159
v_pk_fma_f32 v[164:165], v[164:165], v[124:125], v[128:129] op_sel:[0,1,1] op_sel_hi:[1,1,1] neg_lo:[0,0,1] neg_hi:[0,0,1]
v_pk_fma_f32 v[166:167], v[166:167], v[124:125], v[128:129] op_sel:[0,1,1] op_sel_hi:[1,1,1] neg_lo:[0,0,1] neg_hi:[0,0,1]
v_exp_f32 v164, v164
v_exp_f32 v165, v165
v_exp_f32 v166, v166
v_exp_f32 v167, v167
v_pk_fma_f32 v[172:173], v[172:173], v[126:127], v[130:131] op_sel:[0,0,0] op_sel_hi:[1,0,0] neg_lo:[0,0,1] neg_hi:[0,0,1]
v_pk_fma_f32 v[174:175], v[174:175], v[126:127], v[130:131] op_sel:[0,0,0] op_sel_hi:[1,0,0] neg_lo:[0,0,1] neg_hi:[0,0,1]
v_cvt_pk_bf16_f32 v156, v156, v156
v_cvt_pk_bf16_f32 v157, v157, v157
v_cvt_pk_bf16_f32 v158, v158, v158
v_cvt_pk_bf16_f32 v159, v159, v159
v_exp_f32 v172, v172
v_exp_f32 v173, v173
v_exp_f32 v174, v174
v_exp_f32 v175, v175
v_pk_fma_f32 v[180:181], v[180:181], v[126:127], v[130:131] op_sel:[0,1,1] op_sel_hi:[1,1,1] neg_lo:[0,0,1] neg_hi:[0,0,1]
v_pk_fma_f32 v[182:183], v[182:183], v[126:127], v[130:131] op_sel:[0,1,1] op_sel_hi:[1,1,1] neg_lo:[0,0,1] neg_hi:[0,0,1]
v_and_b32 v156, v52, v156
v_and_b32 v157, v52, v157
v_and_b32 v158, v52, v158
v_and_b32 v159, v52, v159
v_cvt_pk_bf16_f32 v164, v164, v164
v_cvt_pk_bf16_f32 v165, v165, v165
v_mfma_f32_16x16x32_bf16 v[160:163], v[48:51], v[156:159], 0
v_cvt_pk_bf16_f32 v166, v166, v166
v_cvt_pk_bf16_f32 v167, v167, v167
v_mfma_f32_16x16x32_bf16 v[220:223], v[100:103], v[156:159], 0
v_exp_f32 v180, v180
v_mfma_f32_16x16x32_bf16 v[224:227], v[110:113], v[156:159], 0
v_exp_f32 v181, v181
v_exp_f32 v182, v182
v_exp_f32 v183, v183
v_and_b32 v164, v52, v164
v_and_b32 v165, v52, v165
v_and_b32 v166, v52, v166
v_and_b32 v167, v52, v167
v_cvt_pk_bf16_f32 v172, v172, v172
v_cvt_pk_bf16_f32 v173, v173, v173
v_mfma_f32_16x16x32_bf16 v[168:171], v[48:51], v[164:167], 0
v_cvt_pk_bf16_f32 v174, v174, v174
v_cvt_pk_bf16_f32 v175, v175, v175
v_mfma_f32_16x16x32_bf16 v[228:231], v[102:105], v[164:167], 0
v_and_b32 v172, v52, v172
v_and_b32 v173, v52, v173
v_mfma_f32_16x16x32_bf16 v[232:235], v[112:115], v[164:167], 0
v_and_b32 v174, v52, v174
v_and_b32 v175, v52, v175
v_cvt_pk_bf16_f32 v180, v180, v180
v_cvt_pk_bf16_f32 v181, v181, v181
v_mfma_f32_16x16x32_bf16 v[176:179], v[48:51], v[172:175], 0
v_cvt_pk_bf16_f32 v182, v182, v182
v_cvt_pk_bf16_f32 v183, v183, v183
v_mfma_f32_16x16x32_bf16 v[236:239], v[104:107], v[172:175], 0
v_and_b32 v180, v52, v180
v_and_b32 v181, v52, v181
v_mfma_f32_16x16x32_bf16 v[240:243], v[114:117], v[172:175], 0
v_and_b32 v182, v52, v182
v_and_b32 v183, v52, v183
v_rcp_f32 v160, v160
v_rcp_f32 v168, v168
v_pk_mul_f32 v[220:221], v[220:221], v[160:161] op_sel:[0,0] op_sel_hi:[1,0]
v_pk_mul_f32 v[222:223], v[222:223], v[160:161] op_sel:[0,0] op_sel_hi:[1,0]
v_pk_mul_f32 v[228:229], v[228:229], v[168:169] op_sel:[0,0] op_sel_hi:[1,0]
v_pk_mul_f32 v[224:225], v[224:225], v[160:161] op_sel:[0,0] op_sel_hi:[1,0]
v_pk_mul_f32 v[226:227], v[226:227], v[160:161] op_sel:[0,0] op_sel_hi:[1,0]
v_pk_mul_f32 v[230:231], v[230:231], v[168:169] op_sel:[0,0] op_sel_hi:[1,0]
v_pk_mul_f32 v[232:233], v[232:233], v[168:169] op_sel:[0,0] op_sel_hi:[1,0]
v_pk_mul_f32 v[234:235], v[234:235], v[168:169] op_sel:[0,0] op_sel_hi:[1,0]
v_mfma_f32_16x16x32_bf16 v[184:187], v[48:51], v[180:183], 0
v_rcp_f32_e64 v176, v176
v_cvt_pk_bf16_f32 v220, v220, v221
v_cvt_pk_bf16_f32 v221, v222, v223
v_cvt_pk_bf16_f32 v228, v228, v229
v_pk_mul_f32 v[236:237], v[236:237], v[176:177] op_sel:[0,0] op_sel_hi:[1,0]
v_mfma_f32_16x16x32_bf16 v[244:247], v[106:109], v[180:183], 0
v_cvt_pk_bf16_f32 v222, v224, v225
v_cvt_pk_bf16_f32 v223, v226, v227
v_rcp_f32_e64 v184, v184
v_cvt_pk_bf16_f32 v229, v230, v231
v_pk_mul_f32 v[238:239], v[238:239], v[176:177] op_sel:[0,0] op_sel_hi:[1,0]
v_pk_mul_f32 v[240:241], v[240:241], v[176:177] op_sel:[0,0] op_sel_hi:[1,0]
v_pk_mul_f32 v[242:243], v[242:243], v[176:177] op_sel:[0,0] op_sel_hi:[1,0]
v_cvt_pk_bf16_f32 v236, v236, v237
v_pk_mul_f32 v[244:245], v[244:245], v[184:185] op_sel:[0,0] op_sel_hi:[1,0]
v_pk_mul_f32 v[246:247], v[246:247], v[184:185] op_sel:[0,0] op_sel_hi:[1,0]
v_mfma_f32_16x16x32_bf16 v[248:251], v[116:119], v[180:183], 0
buffer_store_dwordx4 v[220:223], v18, s[32:35], s80 offen sc1
v_cvt_pk_bf16_f32 v230, v232, v233
v_cvt_pk_bf16_f32 v231, v234, v235
v_cvt_pk_bf16_f32 v237, v238, v239
v_cvt_pk_bf16_f32 v244, v244, v245
buffer_store_dwordx4 v[228:231], v18, s[32:35], s81 offen sc1
v_cvt_pk_bf16_f32 v238, v240, v241
v_cvt_pk_bf16_f32 v239, v242, v243
v_pk_mul_f32 v[248:249], v[248:249], v[184:185] op_sel:[0,0] op_sel_hi:[1,0]
v_pk_mul_f32 v[250:251], v[250:251], v[184:185] op_sel:[0,0] op_sel_hi:[1,0]
v_cvt_pk_bf16_f32 v245, v246, v247
buffer_store_dwordx4 v[236:239], v18, s[32:35], s82 offen sc1
v_cvt_pk_bf16_f32 v246, v248, v249
v_cvt_pk_bf16_f32 v247, v250, v251
buffer_store_dwordx4 v[244:247], v18, s[32:35], s83 offen sc1
s_branch back_74
slow_75:
buffer_store_dword v5, v4, s[32:35], s84 offen sc1
s_branch back_76
slow_80:
s_nop 0
v_cvt_pk_bf16_f32 v20, v60, v61
v_cvt_pk_bf16_f32 v21, v62, v63
v_cvt_pk_bf16_f32 v22, v64, v65
v_cvt_pk_bf16_f32 v23, v66, v67
buffer_store_dwordx4 v[20:23], v18, s[32:35], s85 offen offset:0 sc1
v_cvt_pk_bf16_f32 v24, v68, v69
v_cvt_pk_bf16_f32 v25, v70, v71
v_cvt_pk_bf16_f32 v26, v72, v73
v_cvt_pk_bf16_f32 v27, v74, v75
buffer_store_dwordx4 v[24:27], v18, s[32:35], s85 offen offset:1024 sc1
v_cvt_pk_bf16_f32 v28, v76, v77
v_cvt_pk_bf16_f32 v29, v78, v79
v_cvt_pk_bf16_f32 v30, v80, v81
v_cvt_pk_bf16_f32 v31, v82, v83
buffer_store_dwordx4 v[28:31], v18, s[32:35], s86 offen offset:0 sc1
v_cvt_pk_bf16_f32 v32, v84, v85
v_cvt_pk_bf16_f32 v33, v86, v87
v_cvt_pk_bf16_f32 v34, v88, v89
v_cvt_pk_bf16_f32 v35, v90, v91
buffer_store_dwordx4 v[32:35], v18, s[32:35], s86 offen offset:1024 sc1
s_barrier
v_dot2c_f32_bf16 v6, v20, v48
v_dot2c_f32_bf16 v8, v20, v20
v_dot2c_f32_bf16 v7, v28, v48
v_dot2c_f32_bf16 v9, v28, v28
v_dot2c_f32_bf16 v6, v21, v48
v_dot2c_f32_bf16 v8, v21, v21
v_dot2c_f32_bf16 v7, v29, v48
v_dot2c_f32_bf16 v9, v29, v29
v_dot2c_f32_bf16 v6, v22, v48
v_dot2c_f32_bf16 v8, v22, v22
v_dot2c_f32_bf16 v7, v30, v48
v_dot2c_f32_bf16 v9, v30, v30
v_dot2c_f32_bf16 v6, v23, v48
v_dot2c_f32_bf16 v8, v23, v23
v_dot2c_f32_bf16 v7, v31, v48
v_dot2c_f32_bf16 v9, v31, v31
v_dot2c_f32_bf16 v6, v24, v48
v_dot2c_f32_bf16 v8, v24, v24
v_dot2c_f32_bf16 v7, v32, v48
v_dot2c_f32_bf16 v9, v32, v32
v_dot2c_f32_bf16 v6, v25, v48
v_dot2c_f32_bf16 v8, v25, v25
v_dot2c_f32_bf16 v7, v33, v48
v_dot2c_f32_bf16 v9, v33, v33
v_dot2c_f32_bf16 v6, v26, v48
v_dot2c_f32_bf16 v8, v26, v26
v_dot2c_f32_bf16 v7, v34, v48
v_dot2c_f32_bf16 v9, v34, v34
v_dot2c_f32_bf16 v6, v27, v48
v_dot2c_f32_bf16 v8, v27, v27
v_dot2c_f32_bf16 v7, v35, v48
v_dot2c_f32_bf16 v9, v35, v35
s_mov_b64 exec, 1
s_waitcnt vmcnt(0)
buffer_store_dword v5, v4, s[32:35], s88 offen sc1
s_mov_b64 exec, -1
s_nop 1
v_permlane32_swap_b32 v6, v7
v_permlane32_swap_b32 v8, v9
v_add_f32 v6, v6, v7
v_add_f32 v8, v8, v9
s_nop 1
v_permlane16_swap_b32 v6, v8
s_nop 0
v_add_f32 v6, v6, v8
buffer_store_dword v6, v1, s[32:35], s87 offen sc1
s_branch back_81
slow_96:
.p2align 3
v_mfma_f32_16x16x32_bf16 v[156:159], v[188:191], v[60:63], 0
v_mfma_f32_16x16x32_bf16 v[164:167], v[188:191], v[68:71], 0
v_mfma_f32_16x16x32_bf16 v[160:163], v[192:195], v[60:63], 0
v_mfma_f32_16x16x32_bf16 v[172:175], v[188:191], v[76:79], 0
v_mfma_f32_16x16x32_bf16 v[168:171], v[192:195], v[68:71], 0
v_mfma_f32_16x16x32_bf16 v[180:183], v[188:191], v[84:87], 0
v_mfma_f32_16x16x32_bf16 v[156:159], v[196:199], v[220:223], v[156:159]
v_mfma_f32_16x16x32_bf16 v[176:179], v[192:195], v[76:79], 0
v_mfma_f32_16x16x32_bf16 v[164:167], v[196:199], v[228:231], v[164:167]
v_mfma_f32_16x16x32_bf16 v[184:187], v[192:195], v[84:87], 0
v_mfma_f32_16x16x32_bf16 v[160:163], v[200:203], v[220:223], v[160:163]
v_mfma_f32_16x16x32_bf16 v[172:175], v[196:199], v[236:239], v[172:175]
v_mfma_f32_16x16x32_bf16 v[168:171], v[200:203], v[228:231], v[168:171]
v_mfma_f32_16x16x32_bf16 v[180:183], v[196:199], v[244:247], v[180:183]
v_mfma_f32_16x16x32_bf16 v[176:179], v[200:203], v[236:239], v[176:179]
v_mfma_f32_16x16x32_bf16 v[184:187], v[200:203], v[244:247], v[184:187]
v_pk_mul_f32 v[156:157], v[156:157], v[100:101] op_sel:[0,0] op_sel_hi:[1,0]
v_pk_mul_f32 v[158:159], v[158:159], v[100:101] op_sel:[0,0] op_sel_hi:[1,0]
v_cvt_pk_bf16_f32 v156, v156, v157
v_pk_mul_f32 v[164:165], v[164:165], v[100:101] op_sel:[0,1] op_sel_hi:[1,1]
v_pk_mul_f32 v[160:161], v[160:161], v[100:101] op_sel:[0,0] op_sel_hi:[1,0]
v_pk_mul_f32 v[162:163], v[162:163], v[100:101] op_sel:[0,0] op_sel_hi:[1,0]
v_cvt_pk_bf16_f32 v157, v158, v159
v_pk_mul_f32 v[166:167], v[166:167], v[100:101] op_sel:[0,1] op_sel_hi:[1,1]
v_cvt_pk_bf16_f32 v164, v164, v165
v_pk_mul_f32 v[172:173], v[172:173], v[102:103] op_sel:[0,0] op_sel_hi:[1,0]
v_cvt_pk_bf16_f32 v158, v160, v161
v_cvt_pk_bf16_f32 v159, v162, v163
v_pk_mul_f32 v[168:169], v[168:169], v[100:101] op_sel:[0,1] op_sel_hi:[1,1]
v_pk_mul_f32 v[170:171], v[170:171], v[100:101] op_sel:[0,1] op_sel_hi:[1,1]
v_cvt_pk_bf16_f32 v165, v166, v167
v_pk_mul_f32 v[174:175], v[174:175], v[102:103] op_sel:[0,0] op_sel_hi:[1,0]
v_cvt_pk_bf16_f32 v172, v172, v173
v_pk_mul_f32 v[180:181], v[180:181], v[102:103] op_sel:[0,1] op_sel_hi:[1,1]
buffer_store_dwordx4 v[156:159], v18, s[32:35], s80 offen sc1
v_cvt_pk_bf16_f32 v166, v168, v169
v_cvt_pk_bf16_f32 v167, v170, v171
v_pk_mul_f32 v[176:177], v[176:177], v[102:103] op_sel:[0,0] op_sel_hi:[1,0]
v_pk_mul_f32 v[178:179], v[178:179], v[102:103] op_sel:[0,0] op_sel_hi:[1,0]
v_cvt_pk_bf16_f32 v173, v174, v175
v_pk_mul_f32 v[182:183], v[182:183], v[102:103] op_sel:[0,1] op_sel_hi:[1,1]
v_cvt_pk_bf16_f32 v180, v180, v181
buffer_store_dwordx4 v[164:167], v18, s[32:35], s81 offen sc1
v_cvt_pk_bf16_f32 v174, v176, v177
v_cvt_pk_bf16_f32 v175, v178, v179
v_pk_mul_f32 v[184:185], v[184:185], v[102:103] op_sel:[0,1] op_sel_hi:[1,1]
v_pk_mul_f32 v[186:187], v[186:187], v[102:103] op_sel:[0,1] op_sel_hi:[1,1]
v_cvt_pk_bf16_f32 v181, v182, v183
buffer_store_dwordx4 v[172:175], v18, s[32:35], s82 offen sc1
v_cvt_pk_bf16_f32 v182, v184, v185
v_cvt_pk_bf16_f32 v183, v186, v187
buffer_store_dwordx4 v[180:183], v18, s[32:35], s83 offen sc1
s_branch back_97
slow_98:
buffer_store_dword v5, v4, s[32:35], s84 offen sc1
s_branch back_99
slow_102:
s_nop 0
v_cvt_pk_bf16_f32 v20, v60, v61
v_cvt_pk_bf16_f32 v21, v62, v63
v_cvt_pk_bf16_f32 v22, v64, v65
v_cvt_pk_bf16_f32 v23, v66, v67
buffer_store_dwordx4 v[20:23], v18, s[32:35], s85 offen offset:0 sc1
v_cvt_pk_bf16_f32 v24, v68, v69
v_cvt_pk_bf16_f32 v25, v70, v71
v_cvt_pk_bf16_f32 v26, v72, v73
v_cvt_pk_bf16_f32 v27, v74, v75
buffer_store_dwordx4 v[24:27], v18, s[32:35], s85 offen offset:1024 sc1
v_cvt_pk_bf16_f32 v28, v76, v77
v_cvt_pk_bf16_f32 v29, v78, v79
v_cvt_pk_bf16_f32 v30, v80, v81
v_cvt_pk_bf16_f32 v31, v82, v83
buffer_store_dwordx4 v[28:31], v18, s[32:35], s86 offen offset:0 sc1
v_cvt_pk_bf16_f32 v32, v84, v85
v_cvt_pk_bf16_f32 v33, v86, v87
v_cvt_pk_bf16_f32 v34, v88, v89
v_cvt_pk_bf16_f32 v35, v90, v91
buffer_store_dwordx4 v[32:35], v18, s[32:35], s86 offen offset:1024 sc1
s_barrier
v_dot2c_f32_bf16 v6, v20, v48
v_dot2c_f32_bf16 v8, v20, v20
v_dot2c_f32_bf16 v7, v28, v48
v_dot2c_f32_bf16 v9, v28, v28
v_dot2c_f32_bf16 v6, v21, v48
v_dot2c_f32_bf16 v8, v21, v21
v_dot2c_f32_bf16 v7, v29, v48
v_dot2c_f32_bf16 v9, v29, v29
v_dot2c_f32_bf16 v6, v22, v48
v_dot2c_f32_bf16 v8, v22, v22
v_dot2c_f32_bf16 v7, v30, v48
v_dot2c_f32_bf16 v9, v30, v30
v_dot2c_f32_bf16 v6, v23, v48
v_dot2c_f32_bf16 v8, v23, v23
v_dot2c_f32_bf16 v7, v31, v48
v_dot2c_f32_bf16 v9, v31, v31
v_dot2c_f32_bf16 v6, v24, v48
v_dot2c_f32_bf16 v8, v24, v24
v_dot2c_f32_bf16 v7, v32, v48
v_dot2c_f32_bf16 v9, v32, v32
v_dot2c_f32_bf16 v6, v25, v48
v_dot2c_f32_bf16 v8, v25, v25
v_dot2c_f32_bf16 v7, v33, v48
v_dot2c_f32_bf16 v9, v33, v33
v_dot2c_f32_bf16 v6, v26, v48
v_dot2c_f32_bf16 v8, v26, v26
v_dot2c_f32_bf16 v7, v34, v48
v_dot2c_f32_bf16 v9, v34, v34
v_dot2c_f32_bf16 v6, v27, v48
v_dot2c_f32_bf16 v8, v27, v27
v_dot2c_f32_bf16 v7, v35, v48
v_dot2c_f32_bf16 v9, v35, v35
s_mov_b64 exec, 1
s_waitcnt vmcnt(0)
buffer_store_dword v5, v4, s[32:35], s88 offen sc1
s_mov_b64 exec, -1
s_nop 1
v_permlane32_swap_b32 v6, v7
v_permlane32_swap_b32 v8, v9
v_add_f32 v6, v6, v7
v_add_f32 v8, v8, v9
s_nop 1
v_permlane16_swap_b32 v6, v8
s_nop 0
v_add_f32 v6, v6, v8
buffer_store_dword v6, v1, s[32:35], s87 offen sc1
s_branch back_103
slow_114:
.p2align 3
v_mfma_f32_16x16x32_bf16 v[160:163], v[120:123], v[156:159], v[44:47]
v_max_f32 v158, v192, v193
v_max_f32 v159, v194, v195
v_permlane32_swap_b32 v130, v131
s_nop 0
v_max_f32 v130, v130, v131
s_nop 2
v_max_f32 v156, v160, v161
v_max_f32 v157, v162, v163
v_max3_f32 v128, v156, v157, v158
v_max_f32 v128, v128, v159
s_nop 1
v_permlane32_swap_b32 v128, v129
s_nop 0
v_max_f32 v128, v128, v129
s_nop 1
v_permlane16_swap_b32 v128, v130
s_nop 0
v_max_f32 v128, v128, v130
v_mov_b32 v130, v128
s_nop 1
v_permlane16_swap_b32 v128, v130
s_nop 0
v_mov_b32 v129, v128
v_mov_b32 v131, v130
s_nop 0
v_permlane32_swap_b32 v128, v129
v_permlane32_swap_b32 v130, v131
v_mul_f32 v128, v128, v124
v_mul_f32 v129, v129, v125
v_pk_fma_f32 v[156:157], v[156:157], v[124:125], v[128:129] op_sel:[0,0,0] op_sel_hi:[1,0,0] neg_lo:[0,0,1] neg_hi:[0,0,1]
v_pk_fma_f32 v[158:159], v[158:159], v[124:125], v[128:129] op_sel:[0,0,0] op_sel_hi:[1,0,0] neg_lo:[0,0,1] neg_hi:[0,0,1]
v_mul_f32 v130, v130, v126
v_mul_f32 v131, v131, v127
v_exp_f32 v156, v156
v_exp_f32 v157, v157
v_exp_f32 v158, v158
v_exp_f32 v159, v159
v_pk_fma_f32 v[164:165], v[164:165], v[124:125], v[128:129] op_sel:[0,1,1] op_sel_hi:[1,1,1] neg_lo:[0,0,1] neg_hi:[0,0,1]
v_pk_fma_f32 v[166:167], v[166:167], v[124:125], v[128:129] op_sel:[0,1,1] op_sel_hi:[1,1,1] neg_lo:[0,0,1] neg_hi:[0,0,1]
v_exp_f32 v164, v164
v_exp_f32 v165, v165
v_exp_f32 v166, v166
v_exp_f32 v167, v167
v_pk_fma_f32 v[172:173], v[172:173], v[126:127], v[130:131] op_sel:[0,0,0] op_sel_hi:[1,0,0] neg_lo:[0,0,1] neg_hi:[0,0,1]
v_pk_fma_f32 v[174:175], v[174:175], v[126:127], v[130:131] op_sel:[0,0,0] op_sel_hi:[1,0,0] neg_lo:[0,0,1] neg_hi:[0,0,1]
v_cvt_pk_bf16_f32 v156, v156, v156
v_cvt_pk_bf16_f32 v157, v157, v157
v_cvt_pk_bf16_f32 v158, v158, v158
v_cvt_pk_bf16_f32 v159, v159, v159
v_exp_f32 v172, v172
v_exp_f32 v173, v173
v_exp_f32 v174, v174
v_exp_f32 v175, v175
v_pk_fma_f32 v[180:181], v[180:181], v[126:127], v[130:131] op_sel:[0,1,1] op_sel_hi:[1,1,1] neg_lo:[0,0,1] neg_hi:[0,0,1]
v_pk_fma_f32 v[182:183], v[182:183], v[126:127], v[130:131] op_sel:[0,1,1] op_sel_hi:[1,1,1] neg_lo:[0,0,1] neg_hi:[0,0,1]
v_and_b32 v156, v52, v156
v_and_b32 v157, v52, v157
v_and_b32 v158, v52, v158
v_and_b32 v159, v52, v159
v_cvt_pk_bf16_f32 v164, v164, v164
v_cvt_pk_bf16_f32 v165, v165, v165
v_mfma_f32_16x16x32_bf16 v[160:163], v[48:51], v[156:159], 0
v_cvt_pk_bf16_f32 v166, v166, v166
v_cvt_pk_bf16_f32 v167, v167, v167
v_mfma_f32_16x16x32_bf16 v[220:223], v[100:103], v[156:159], 0
v_exp_f32 v180, v180
v_mfma_f32_16x16x32_bf16 v[224:227], v[110:113], v[156:159], 0
v_exp_f32 v181, v181
v_exp_f32 v182, v182
v_exp_f32 v183, v183
v_and_b32 v164, v52, v164
v_and_b32 v165, v52, v165
v_and_b32 v166, v52, v166
v_and_b32 v167, v52, v167
v_cvt_pk_bf16_f32 v172, v172, v172
v_cvt_pk_bf16_f32 v173, v173, v173
v_mfma_f32_16x16x32_bf16 v[168:171], v[48:51], v[164:167], 0
v_cvt_pk_bf16_f32 v174, v174, v174
v_cvt_pk_bf16_f32 v175, v175, v175
v_mfma_f32_16x16x32_bf16 v[228:231], v[102:105], v[164:167], 0
v_and_b32 v172, v52, v172
v_and_b32 v173, v52, v173
v_mfma_f32_16x16x32_bf16 v[232:235], v[112:115], v[164:167], 0
v_and_b32 v174, v52, v174
v_and_b32 v175, v52, v175
v_cvt_pk_bf16_f32 v180, v180, v180
v_cvt_pk_bf16_f32 v181, v181, v181
v_mfma_f32_16x16x32_bf16 v[176:179], v[48:51], v[172:175], 0
v_cvt_pk_bf16_f32 v182, v182, v182
v_cvt_pk_bf16_f32 v183, v183, v183
v_mfma_f32_16x16x32_bf16 v[236:239], v[104:107], v[172:175], 0
v_and_b32 v180, v52, v180
v_and_b32 v181, v52, v181
v_mfma_f32_16x16x32_bf16 v[240:243], v[114:117], v[172:175], 0
v_and_b32 v182, v52, v182
v_and_b32 v183, v52, v183
v_rcp_f32 v160, v160
v_rcp_f32 v168, v168
v_pk_mul_f32 v[220:221], v[220:221], v[160:161] op_sel:[0,0] op_sel_hi:[1,0]
v_pk_mul_f32 v[222:223], v[222:223], v[160:161] op_sel:[0,0] op_sel_hi:[1,0]
v_pk_mul_f32 v[228:229], v[228:229], v[168:169] op_sel:[0,0] op_sel_hi:[1,0]
v_pk_mul_f32 v[224:225], v[224:225], v[160:161] op_sel:[0,0] op_sel_hi:[1,0]
v_pk_mul_f32 v[226:227], v[226:227], v[160:161] op_sel:[0,0] op_sel_hi:[1,0]
v_pk_mul_f32 v[230:231], v[230:231], v[168:169] op_sel:[0,0] op_sel_hi:[1,0]
v_pk_mul_f32 v[232:233], v[232:233], v[168:169] op_sel:[0,0] op_sel_hi:[1,0]
v_pk_mul_f32 v[234:235], v[234:235], v[168:169] op_sel:[0,0] op_sel_hi:[1,0]
v_mfma_f32_16x16x32_bf16 v[184:187], v[48:51], v[180:183], 0
v_rcp_f32_e64 v176, v176
v_cvt_pk_bf16_f32 v220, v220, v221
v_cvt_pk_bf16_f32 v221, v222, v223
v_cvt_pk_bf16_f32 v228, v228, v229
v_pk_mul_f32 v[236:237], v[236:237], v[176:177] op_sel:[0,0] op_sel_hi:[1,0]
v_mfma_f32_16x16x32_bf16 v[244:247], v[106:109], v[180:183], 0
v_cvt_pk_bf16_f32 v222, v224, v225
v_cvt_pk_bf16_f32 v223, v226, v227
v_rcp_f32_e64 v184, v184
v_cvt_pk_bf16_f32 v229, v230, v231
v_pk_mul_f32 v[238:239], v[238:239], v[176:177] op_sel:[0,0] op_sel_hi:[1,0]
v_pk_mul_f32 v[240:241], v[240:241], v[176:177] op_sel:[0,0] op_sel_hi:[1,0]
v_pk_mul_f32 v[242:243], v[242:243], v[176:177] op_sel:[0,0] op_sel_hi:[1,0]
v_cvt_pk_bf16_f32 v236, v236, v237
v_pk_mul_f32 v[244:245], v[244:245], v[184:185] op_sel:[0,0] op_sel_hi:[1,0]
v_pk_mul_f32 v[246:247], v[246:247], v[184:185] op_sel:[0,0] op_sel_hi:[1,0]
v_mfma_f32_16x16x32_bf16 v[248:251], v[116:119], v[180:183], 0
buffer_store_dwordx4 v[220:223], v18, s[32:35], s80 offen sc1
v_cvt_pk_bf16_f32 v230, v232, v233
v_cvt_pk_bf16_f32 v231, v234, v235
v_cvt_pk_bf16_f32 v237, v238, v239
v_cvt_pk_bf16_f32 v244, v244, v245
buffer_store_dwordx4 v[228:231], v18, s[32:35], s81 offen sc1
v_cvt_pk_bf16_f32 v238, v240, v241
v_cvt_pk_bf16_f32 v239, v242, v243
v_pk_mul_f32 v[248:249], v[248:249], v[184:185] op_sel:[0,0] op_sel_hi:[1,0]
v_pk_mul_f32 v[250:251], v[250:251], v[184:185] op_sel:[0,0] op_sel_hi:[1,0]
v_cvt_pk_bf16_f32 v245, v246, v247
buffer_store_dwordx4 v[236:239], v18, s[32:35], s82 offen sc1
v_cvt_pk_bf16_f32 v246, v248, v249
v_cvt_pk_bf16_f32 v247, v250, v251
buffer_store_dwordx4 v[244:247], v18, s[32:35], s83 offen sc1
s_branch back_115
slow_116:
buffer_store_dword v5, v4, s[32:35], s84 offen sc1
s_branch back_117
slow_120:
s_nop 0
v_cvt_pk_bf16_f32 v20, v60, v61
v_cvt_pk_bf16_f32 v21, v62, v63
v_cvt_pk_bf16_f32 v22, v64, v65
v_cvt_pk_bf16_f32 v23, v66, v67
buffer_store_dwordx4 v[20:23], v18, s[32:35], s85 offen offset:0 sc1
v_cvt_pk_bf16_f32 v24, v68, v69
v_cvt_pk_bf16_f32 v25, v70, v71
v_cvt_pk_bf16_f32 v26, v72, v73
v_cvt_pk_bf16_f32 v27, v74, v75
buffer_store_dwordx4 v[24:27], v18, s[32:35], s85 offen offset:1024 sc1
v_cvt_pk_bf16_f32 v28, v76, v77
v_cvt_pk_bf16_f32 v29, v78, v79
v_cvt_pk_bf16_f32 v30, v80, v81
v_cvt_pk_bf16_f32 v31, v82, v83
buffer_store_dwordx4 v[28:31], v18, s[32:35], s86 offen offset:0 sc1
v_cvt_pk_bf16_f32 v32, v84, v85
v_cvt_pk_bf16_f32 v33, v86, v87
v_cvt_pk_bf16_f32 v34, v88, v89
v_cvt_pk_bf16_f32 v35, v90, v91
buffer_store_dwordx4 v[32:35], v18, s[32:35], s86 offen offset:1024 sc1
s_barrier
v_dot2c_f32_bf16 v6, v20, v48
v_dot2c_f32_bf16 v8, v20, v20
v_dot2c_f32_bf16 v7, v28, v48
v_dot2c_f32_bf16 v9, v28, v28
v_dot2c_f32_bf16 v6, v21, v48
v_dot2c_f32_bf16 v8, v21, v21
v_dot2c_f32_bf16 v7, v29, v48
v_dot2c_f32_bf16 v9, v29, v29
v_dot2c_f32_bf16 v6, v22, v48
v_dot2c_f32_bf16 v8, v22, v22
v_dot2c_f32_bf16 v7, v30, v48
v_dot2c_f32_bf16 v9, v30, v30
v_dot2c_f32_bf16 v6, v23, v48
v_dot2c_f32_bf16 v8, v23, v23
v_dot2c_f32_bf16 v7, v31, v48
v_dot2c_f32_bf16 v9, v31, v31
v_dot2c_f32_bf16 v6, v24, v48
v_dot2c_f32_bf16 v8, v24, v24
v_dot2c_f32_bf16 v7, v32, v48
v_dot2c_f32_bf16 v9, v32, v32
v_dot2c_f32_bf16 v6, v25, v48
v_dot2c_f32_bf16 v8, v25, v25
v_dot2c_f32_bf16 v7, v33, v48
v_dot2c_f32_bf16 v9, v33, v33
v_dot2c_f32_bf16 v6, v26, v48
v_dot2c_f32_bf16 v8, v26, v26
v_dot2c_f32_bf16 v7, v34, v48
v_dot2c_f32_bf16 v9, v34, v34
v_dot2c_f32_bf16 v6, v27, v48
v_dot2c_f32_bf16 v8, v27, v27
v_dot2c_f32_bf16 v7, v35, v48
v_dot2c_f32_bf16 v9, v35, v35
s_mov_b64 exec, 1
s_waitcnt vmcnt(0)
buffer_store_dword v5, v4, s[32:35], s88 offen sc1
s_mov_b64 exec, -1
s_nop 1
v_permlane32_swap_b32 v6, v7
v_permlane32_swap_b32 v8, v9
v_add_f32 v6, v6, v7
v_add_f32 v8, v8, v9
s_nop 1
v_permlane16_swap_b32 v6, v8
s_nop 0
v_add_f32 v6, v6, v8
buffer_store_dword v6, v1, s[32:35], s87 offen sc1
s_branch back_121
slow_134:
.p2align 3
v_mfma_f32_16x16x32_bf16 v[156:159], v[188:191], v[60:63], 0
v_mfma_f32_16x16x32_bf16 v[164:167], v[188:191], v[68:71], 0
v_mfma_f32_16x16x32_bf16 v[160:163], v[192:195], v[60:63], 0
v_mfma_f32_16x16x32_bf16 v[172:175], v[188:191], v[76:79], 0
v_mfma_f32_16x16x32_bf16 v[168:171], v[192:195], v[68:71], 0
v_mfma_f32_16x16x32_bf16 v[180:183], v[188:191], v[84:87], 0
v_mfma_f32_16x16x32_bf16 v[156:159], v[196:199], v[220:223], v[156:159]
v_mfma_f32_16x16x32_bf16 v[176:179], v[192:195], v[76:79], 0
v_mfma_f32_16x16x32_bf16 v[164:167], v[196:199], v[228:231], v[164:167]
v_mfma_f32_16x16x32_bf16 v[184:187], v[192:195], v[84:87], 0
v_mfma_f32_16x16x32_bf16 v[160:163], v[200:203], v[220:223], v[160:163]
v_mfma_f32_16x16x32_bf16 v[172:175], v[196:199], v[236:239], v[172:175]
v_mfma_f32_16x16x32_bf16 v[168:171], v[200:203], v[228:231], v[168:171]
v_mfma_f32_16x16x32_bf16 v[180:183], v[196:199], v[244:247], v[180:183]
v_mfma_f32_16x16x32_bf16 v[176:179], v[200:203], v[236:239], v[176:179]
v_mfma_f32_16x16x32_bf16 v[184:187], v[200:203], v[244:247], v[184:187]
v_pk_mul_f32 v[156:157], v[156:157], v[100:101] op_sel:[0,0] op_sel_hi:[1,0]
v_pk_mul_f32 v[158:159], v[158:159], v[100:101] op_sel:[0,0] op_sel_hi:[1,0]
v_cvt_pk_bf16_f32 v156, v156, v157
v_pk_mul_f32 v[164:165], v[164:165], v[100:101] op_sel:[0,1] op_sel_hi:[1,1]
v_pk_mul_f32 v[160:161], v[160:161], v[100:101] op_sel:[0,0] op_sel_hi:[1,0]
v_pk_mul_f32 v[162:163], v[162:163], v[100:101] op_sel:[0,0] op_sel_hi:[1,0]
v_cvt_pk_bf16_f32 v157, v158, v159
v_pk_mul_f32 v[166:167], v[166:167], v[100:101] op_sel:[0,1] op_sel_hi:[1,1]
v_cvt_pk_bf16_f32 v164, v164, v165
v_pk_mul_f32 v[172:173], v[172:173], v[102:103] op_sel:[0,0] op_sel_hi:[1,0]
v_cvt_pk_bf16_f32 v158, v160, v161
v_cvt_pk_bf16_f32 v159, v162, v163
v_pk_mul_f32 v[168:169], v[168:169], v[100:101] op_sel:[0,1] op_sel_hi:[1,1]
v_pk_mul_f32 v[170:171], v[170:171], v[100:101] op_sel:[0,1] op_sel_hi:[1,1]
v_cvt_pk_bf16_f32 v165, v166, v167
v_pk_mul_f32 v[174:175], v[174:175], v[102:103] op_sel:[0,0] op_sel_hi:[1,0]
v_cvt_pk_bf16_f32 v172, v172, v173
v_pk_mul_f32 v[180:181], v[180:181], v[102:103] op_sel:[0,1] op_sel_hi:[1,1]
buffer_store_dwordx4 v[156:159], v18, s[32:35], s80 offen sc1
v_cvt_pk_bf16_f32 v166, v168, v169
v_cvt_pk_bf16_f32 v167, v170, v171
v_pk_mul_f32 v[176:177], v[176:177], v[102:103] op_sel:[0,0] op_sel_hi:[1,0]
v_pk_mul_f32 v[178:179], v[178:179], v[102:103] op_sel:[0,0] op_sel_hi:[1,0]
v_cvt_pk_bf16_f32 v173, v174, v175
v_pk_mul_f32 v[182:183], v[182:183], v[102:103] op_sel:[0,1] op_sel_hi:[1,1]
v_cvt_pk_bf16_f32 v180, v180, v181
buffer_store_dwordx4 v[164:167], v18, s[32:35], s81 offen sc1
v_cvt_pk_bf16_f32 v174, v176, v177
v_cvt_pk_bf16_f32 v175, v178, v179
v_pk_mul_f32 v[184:185], v[184:185], v[102:103] op_sel:[0,1] op_sel_hi:[1,1]
v_pk_mul_f32 v[186:187], v[186:187], v[102:103] op_sel:[0,1] op_sel_hi:[1,1]
v_cvt_pk_bf16_f32 v181, v182, v183
buffer_store_dwordx4 v[172:175], v18, s[32:35], s82 offen sc1
v_cvt_pk_bf16_f32 v182, v184, v185
v_cvt_pk_bf16_f32 v183, v186, v187
buffer_store_dwordx4 v[180:183], v18, s[32:35], s83 offen sc1
s_branch back_135
slow_136:
buffer_store_dword v5, v4, s[32:35], s84 offen sc1
s_branch back_137
s_endpgm
.section .rodata,"a"
.p2align 6
.amdhsa_kernel interleave_layers__sliding_local_dilated__linear_kernel_hedgehog__prompt_kernel
  .amdhsa_next_free_vgpr 256
  .amdhsa_next_free_sgpr 102
  .amdhsa_accum_offset 256
  .amdhsa_group_segment_fixed_size 0
  .amdhsa_kernarg_size 80
  .amdhsa_user_sgpr_count 2
  .amdhsa_user_sgpr_kernarg_segment_ptr 1
  .amdhsa_system_sgpr_workgroup_id_x 1
.end_amdhsa_kernel
```
